```python
import torch

def _softmax(x, axis=-1):
    return torch.softmax(x, dim=axis)
def _gelu(x):
    return torch.nn.functional.gelu(x, approximate="tanh")
def _silu(x):
    return torch.nn.functional.silu(x)
def _sigmoid(x):
    return torch.sigmoid(x)
def _layernorm(x, axis=-1, eps=1e-5):
    m = x.mean(dim=axis, keepdim=True)
    v = x.var(dim=axis, keepdim=True, unbiased=False)
    return (x - m) / torch.sqrt(v + eps)
def _scatter_add(tgt, idx, src, axis=0):
    return tgt.clone().index_add_(axis, idx, src)
def _segment_sum(src, seg, n):
    out = torch.zeros((n,) + src.shape[1:], dtype=src.dtype)
    return out.index_add_(0, seg, src)
def _pad(x, pw):
    flat = tuple(v for pair in reversed(pw) for v in pair)
    return torch.nn.functional.pad(x, flat)

kernel_name = 'concat_heads__ssm_conv_h3__sliding_local_dilated__prompt'

def setup_inputs():

    _w = (lambda a: (lambda t: t.to(torch.bfloat16) if t.is_floating_point() else t)(torch.as_tensor(a)))
    def _A_setup():
        B, S, D = 1, 2048, 1024
        ks = 4
        return {
            "q": _w((lambda *s: torch.randn(*s, dtype=torch.bfloat16) * 0.05)(B, S, D)),
            "k": _w((lambda *s: torch.randn(*s, dtype=torch.bfloat16) * 1.6)(B, S, D)),
            "v": _w((lambda *s: torch.randn(*s, dtype=torch.bfloat16) * 0.8)(B, S, D)),
            "shift_k": _w((lambda *s: torch.randn(*s, dtype=torch.bfloat16) * 1.6)(D, ks) * 0.5),
            "ssm_k": _w((lambda *s: torch.randn(*s, dtype=torch.bfloat16) * 1.6)(D, S) * (1.0 / S ** 0.5)),
            "ssm_D": _w((lambda *s: torch.randn(*s, dtype=torch.bfloat16) * 0.8)(D)),
        }
    _A_in = _A_setup()

    def _B_setup():
        B, S, D = 1, 2048, 1024
        return {
            "x": _w((lambda *s: torch.randn(*s, dtype=torch.bfloat16) * 0.2)(B, S, D)),
            "wqkv": _w((lambda *s: torch.randn(*s, dtype=torch.bfloat16) * 0.2)(D, 3 * D)),
            "wo": _w((lambda *s: torch.randn(*s, dtype=torch.bfloat16) * 0.05)(D, D)),
        }
    _B_in = _B_setup()

    return {
        "A_q": _A_in["q"],
        "A_k": _A_in["k"],
        "A_v": _A_in["v"],
        "A_shift_k": _A_in["shift_k"],
        "A_ssm_k": _A_in["ssm_k"],
        "A_ssm_D": _A_in["ssm_D"],
        "B_x": _B_in["x"],
        "B_wqkv": _B_in["wqkv"],
        "B_wo": _B_in["wo"],
    }

def reference(A_q, A_k, A_v, A_shift_k, A_ssm_k, A_ssm_D, B_x, B_wqkv, B_wo):
    def _A_ref(q, k, v, shift_k, ssm_k, ssm_D):
        B, S, D = q.shape
        ks = shift_k.shape[-1]
        k_pad = _pad(k, ((0, 0), (ks - 1, 0), (0, 0)))
        k_shift = torch.zeros_like(k)
        for t in range(ks):
            k_shift = k_shift + k_pad[:, t:t + S, :] * shift_k[:, ks - 1 - t][None, None, :]
        kv = k_shift * v
        L = 2 * S
        kv_pad = _pad(kv, ((0, 0), (0, S), (0, 0)))
        kf_pad = _pad(ssm_k, ((0, 0), (0, S)))
        kv_f = (lambda x, axes=(-2,-1): torch.fft.rfft2(x.float(), dim=axes))(kv_pad[:, None, :, :], axes=(1, 2))
        kf_f = (lambda x, axes=(-2,-1): torch.fft.rfft2(x.float(), dim=axes))(kf_pad[:, None, :], axes=(1, 2))
        kf_f = (lambda x, *d: x.permute(*d))(kf_f, 1, 2, 0)
        y_f = kv_f * kf_f[None, :, :, :]
        y = (lambda x, s, axes=(-2,-1): torch.fft.irfft2(x, s=s, dim=axes).to(torch.bfloat16))(y_f, (1, L), axes=(1, 2))[:, 0, :S, :]
        y = y + kv * ssm_D[None, None, :]
        return q * y

    def _B_ref(x, wqkv, wo):
        B, S, D = x.shape
        H = 32; Dh = D // H
        W, dil = 8, 2
        qkv = (lambda x, *d: x.permute(*d))((x @ wqkv).reshape(B, S, 3, H, Dh), 2, 0, 3, 1, 4)
        q, k, v = qkv[0], qkv[1], qkv[2]
        scale = Dh ** -0.5
        pos = torch.arange(S)
        off = torch.arange(W) * dil
        idx = pos[:, None] - off[None, :]
        mask = idx >= 0
        idx_c = torch.where(mask, idx, 0).reshape(-1)
        kg = k[:, :, idx_c, :].reshape(B, H, S, W, Dh)
        vg = v[:, :, idx_c, :].reshape(B, H, S, W, Dh)
        logits = torch.einsum("bhsd,bhswd->bhsw", q, kg) * scale
        logits = torch.where(mask[None, None, :, :], logits, -1e9)
        attn = _softmax(logits, axis=-1)
        o = torch.einsum("bhsw,bhswd->bhsd", attn, vg)
        return (lambda x, *d: x.permute(*d))(o, 0, 2, 1, 3).reshape(B, S, D) @ wo

    a = _A_ref(A_q, A_k, A_v, A_shift_k, A_ssm_k, A_ssm_D)
    b = _B_ref(B_x, B_wqkv, B_wo)
    return torch.concatenate([a, b], axis=-1)
```

```asm
; @launch grid=(256,1,1) block=(512,1,1) lds=163840
.amdgcn_target "amdgcn-amd-amdhsa--gfx950"
.text
.globl concat_heads__ssm_conv_h3__sliding_local_dilated__prompt_kernel
.p2align 8
.type concat_heads__ssm_conv_h3__sliding_local_dilated__prompt_kernel,@function
concat_heads__ssm_conv_h3__sliding_local_dilated__prompt_kernel:
    s_cmp_ge_u32 s2, 256
    s_cbranch_scc1 L_end
    s_load_dwordx4 s[16:19], s[0:1], 48
    s_load_dwordx8 s[4:11], s[0:1], 0
    s_load_dwordx4 s[12:15], s[0:1], 32
    s_load_dwordx8 s[20:27], s[0:1], 64
    v_lshrrev_b32 v1, 6, v0
    v_and_b32 v0, 63, v0
    v_readfirstlane_b32 s3, v1
    s_and_b32 s78, s2, 7
    s_lshr_b32 s79, s2, 3
    s_and_b32 s80, s78, 1
    s_lshl_b32 s80, s80, 3
    s_lshr_b32 s81, s78, 1
    s_lshl_b32 s81, s81, 2
    s_and_b32 s72, s79, 7
    s_add_u32 s72, s72, s80
    s_lshr_b32 s73, s79, 3
    s_add_u32 s73, s73, s81
    s_and_b32 s76, s79, 3
    s_add_u32 s76, s76, s81
    s_lshr_b32 s77, s79, 2
    s_add_u32 s77, s77, s80
    s_lshr_b32 s74, s79, 4
    s_lshl_b32 s78, s78, 1
    s_add_u32 s74, s74, s78
    s_and_b32 s75, s79, 15
    s_cmp_ge_u32 s3, 4
    s_cbranch_scc1 L_B
    v_lshrrev_b32 v5, 3, v0
    v_and_b32 v6, 7, v0
    v_lshrrev_b32 v7, 4, v0
    s_and_b32 s78, s3, 1
    s_lshl_b32 s78, s78, 2
    s_lshl_b32 s79, s72, 7
    s_lshl_b32 s80, s3, 3
    s_add_u32 s81, s79, s80
    v_add_u32 v8, s78, v7
    v_xor_b32 v8, v8, v6
    v_lshlrev_b32 v8, 4, v8
    v_add_u32 v2, s81, v5
    v_lshl_add_u32 v2, v2, 11, v8
    v_and_b32 v8, 1, v7
    v_lshl_or_b32 v8, v8, 1, s78
    v_xor_b32 v8, v8, v6
    v_lshlrev_b32 v8, 4, v8
    v_add_u32 v4, s80, v5
    v_mul_u32_u24 v4, 6144, v4
    s_lshl_b32 s82, s73, 7
    v_add3_u32 v4, v4, v8, s82
    s_lshl_b32 s78, s3, 1
    s_lshl_b32 s80, s3, 2
    s_add_u32 s79, s79, s80
    s_sub_u32 s79, s79, 16
    v_add_u32 v8, s78, v7
    v_xor_b32 v8, v8, v6
    v_and_b32 v8, 7, v8
    v_lshlrev_b32 v8, 4, v8
    v_add_u32 v3, s79, v5
    v_lshl_add_u32 v3, v3, 11, v8
    s_lshl_b32 s86, s3, 10
    s_add_u32 s87, s86, 75776
    s_lshl_b32 s88, s3, 9
    s_add_u32 s88, s88, 73728
    s_waitcnt lgkmcnt(0)
    s_mov_b32 s28, s16
    s_mov_b32 s29, s17
    s_mov_b32 s30, 0x400000
    s_mov_b32 s31, 0x20000
    s_mov_b32 s32, s18
    s_mov_b32 s33, s19
    s_mov_b32 s34, 0x600000
    s_mov_b32 s35, 0x20000
    s_add_u32 m0, s87, 0
    s_mov_b32 s89, 0
    buffer_load_dwordx4 v2, s[28:31], s89 offen  lds
    s_add_u32 m0, s86, 0
    s_mov_b32 s89, 0
    buffer_load_dwordx4 v4, s[32:35], s89 offen  lds
    s_add_u32 m0, s86, 24576
    s_mov_b32 s89, 2048
    buffer_load_dwordx4 v4, s[32:35], s89 offen  lds
    s_add_u32 m0, s87, 4096
    s_mov_b32 s89, 65536
    buffer_load_dwordx4 v2, s[28:31], s89 offen  lds
    s_add_u32 m0, s86, 49152
    s_mov_b32 s89, 4096
    buffer_load_dwordx4 v4, s[32:35], s89 offen  lds
    s_add_u32 m0, s87, 8192
    s_mov_b32 s89, 131072
    buffer_load_dwordx4 v2, s[28:31], s89 offen  lds
    s_add_u32 m0, s86, 4096
    s_mov_b32 s89, 196608
    buffer_load_dwordx4 v4, s[32:35], s89 offen  lds
    s_add_u32 m0, s86, 28672
    s_mov_b32 s89, 198656
    buffer_load_dwordx4 v4, s[32:35], s89 offen  lds
    s_add_u32 m0, s87, 12288
    s_mov_b32 s89, 196608
    buffer_load_dwordx4 v2, s[28:31], s89 offen  lds
    s_add_u32 m0, s86, 53248
    s_mov_b32 s89, 200704
    buffer_load_dwordx4 v4, s[32:35], s89 offen  lds
    s_mov_b64 exec, 0xffffffff
    s_add_u32 m0, s88, 0
    s_mov_b32 s89, 0
    buffer_load_dwordx4 v3, s[28:31], s89 offen  lds
    s_mov_b64 exec, -1
    s_add_u32 m0, s87, 18432
    s_mov_b32 s89, 128
    buffer_load_dwordx4 v2, s[28:31], s89 offen  lds
    s_add_u32 m0, s86, 8192
    s_mov_b32 s89, 393216
    buffer_load_dwordx4 v4, s[32:35], s89 offen  lds
    s_add_u32 m0, s86, 32768
    s_mov_b32 s89, 395264
    buffer_load_dwordx4 v4, s[32:35], s89 offen  lds
    s_add_u32 m0, s87, 22528
    s_mov_b32 s89, 65664
    buffer_load_dwordx4 v2, s[28:31], s89 offen  lds
    s_add_u32 m0, s86, 57344
    s_mov_b32 s89, 397312
    buffer_load_dwordx4 v4, s[32:35], s89 offen  lds
    s_add_u32 m0, s87, 26624
    s_mov_b32 s89, 131200
    buffer_load_dwordx4 v2, s[28:31], s89 offen  lds
    s_add_u32 m0, s86, 12288
    s_mov_b32 s89, 589824
    buffer_load_dwordx4 v4, s[32:35], s89 offen  lds
    s_add_u32 m0, s86, 36864
    s_mov_b32 s89, 591872
    buffer_load_dwordx4 v4, s[32:35], s89 offen  lds
    s_add_u32 m0, s87, 30720
    s_mov_b32 s89, 196736
    buffer_load_dwordx4 v2, s[28:31], s89 offen  lds
    s_add_u32 m0, s86, 61440
    s_mov_b32 s89, 593920
    buffer_load_dwordx4 v4, s[32:35], s89 offen  lds
    s_mov_b64 exec, 0xffffffff
    s_add_u32 m0, s88, 18432
    s_mov_b32 s89, 128
    buffer_load_dwordx4 v3, s[28:31], s89 offen  lds
    s_mov_b64 exec, -1
    s_add_u32 m0, s87, 36864
    s_mov_b32 s89, 256
    buffer_load_dwordx4 v2, s[28:31], s89 offen  lds
    s_add_u32 m0, s86, 16384
    s_mov_b32 s89, 786432
    buffer_load_dwordx4 v4, s[32:35], s89 offen  lds
    s_add_u32 m0, s86, 40960
    s_mov_b32 s89, 788480
    buffer_load_dwordx4 v4, s[32:35], s89 offen  lds
    s_add_u32 m0, s87, 40960
    s_mov_b32 s89, 65792
    buffer_load_dwordx4 v2, s[28:31], s89 offen  lds
    s_add_u32 m0, s86, 65536
    s_mov_b32 s89, 790528
    buffer_load_dwordx4 v4, s[32:35], s89 offen  lds
    s_add_u32 m0, s87, 45056
    s_mov_b32 s89, 131328
    buffer_load_dwordx4 v2, s[28:31], s89 offen  lds
    s_add_u32 m0, s86, 20480
    s_mov_b32 s89, 983040
    buffer_load_dwordx4 v4, s[32:35], s89 offen  lds
    s_add_u32 m0, s86, 45056
    s_mov_b32 s89, 985088
    buffer_load_dwordx4 v4, s[32:35], s89 offen  lds
    s_add_u32 m0, s87, 49152
    s_mov_b32 s89, 196864
    buffer_load_dwordx4 v2, s[28:31], s89 offen  lds
    s_add_u32 m0, s86, 69632
    s_mov_b32 s89, 987136
    buffer_load_dwordx4 v4, s[32:35], s89 offen  lds
    s_mov_b64 exec, 0xffffffff
    s_add_u32 m0, s88, 36864
    s_mov_b32 s89, 256
    buffer_load_dwordx4 v3, s[28:31], s89 offen  lds
    s_mov_b64 exec, -1
    s_mov_b32 s36, s6
    s_mov_b32 s37, s7
    s_mov_b32 s38, 0x400000
    s_mov_b32 s39, 0x20000
    s_mov_b32 s40, s8
    s_mov_b32 s41, s9
    s_mov_b32 s42, 0x400000
    s_mov_b32 s43, 0x20000
    s_mov_b32 s44, s10
    s_mov_b32 s45, s11
    s_mov_b32 s46, 0x2000
    s_mov_b32 s47, 0x20000
    s_mov_b32 s48, s12
    s_mov_b32 s49, s13
    s_mov_b32 s50, 0x400000
    s_mov_b32 s51, 0x20000
    s_mov_b32 s52, s26
    s_mov_b32 s53, s27
    s_mov_b32 s54, 0x1000000
    s_mov_b32 s55, 0x20000
    s_mov_b32 s56, s4
    s_mov_b32 s57, s5
    s_mov_b32 s58, 0x400000
    s_mov_b32 s59, 0x20000
    s_mov_b32 s60, s22
    s_mov_b32 s61, s23
    s_mov_b32 s62, 0x800000
    s_mov_b32 s63, 0x20000
    s_mov_b32 s64, s20
    s_mov_b32 s65, s21
    s_mov_b32 s66, 0x200000
    s_mov_b32 s67, 0x20000
    v_bfe_u32 v5, v0, 3, 2
    v_lshrrev_b32 v6, 5, v0
    v_and_b32 v7, 7, v0
    s_lshl_b32 s78, s75, 7
    s_lshl_b32 s79, s3, 5
    s_add_u32 s78, s78, s79
    v_lshlrev_b32 v8, 3, v5
    v_lshl_add_u32 v8, v6, 2, v8
    v_add_u32 v8, s78, v8
    s_lshl_b32 s79, s74, 7
    v_lshl_add_u32 v11, v7, 4, s79
    v_lshl_add_u32 v9, v8, 11, v11
    v_lshl_add_u32 v13, v8, 12, v11
    v_subrev_u32 v10, 6144, v9
    v_lshlrev_b32 v11, 2, v11
    v_bfe_u32 v8, v0, 2, 1
    v_lshlrev_b32 v8, 1, v8
    v_add_u32 v8, v8, v6
    v_lshlrev_b32 v8, 16, v8
    v_lshl_add_u32 v8, v5, 6, v8
    v_and_b32 v7, 3, v0
    v_lshl_add_u32 v8, v7, 4, v8
    s_lshl_b32 s78, s78, 3
    s_lshl_b32 s79, s74, 18
    s_add_u32 s78, s78, s79
    v_add_u32 v12, s78, v8
    s_lshl_b32 s91, s74, 4
    s_add_u32 s91, s91, s75
    s_lshr_b32 s78, s91, 3
    s_lshl_b32 s78, s78, 5
    s_and_b32 s79, s91, 7
    s_add_u32 s78, s78, s79
    s_lshl_b32 s79, s3, 3
    s_add_u32 s90, s78, s79
    s_lshl_b32 s91, s91, 14
    s_lshr_b32 s78, s90, 1
    s_lshl_b32 s78, s78, 2
    s_lshl_b32 s79, s90, 12
    s_load_dword s92, s[14:15], s78
    s_load_dword s93, s[12:13], s79
    s_mul_i32 s94, s3, 8320
    s_add_u32 s94, s94, 129024
    s_lshl_b32 s95, s3, 14
    s_mov_b32 s96, 4096
    v_bfe_u32 v5, v0, 2, 2
    v_lshlrev_b32 v5, 1, v5
    v_lshl_add_u32 v5, v6, 3, v5
    v_bfe_u32 v8, v0, 4, 1
    v_add_u32 v5, v5, v8
    s_and_b32 s78, s3, 1
    s_lshl_b32 s78, s78, 1
    v_add_u32 v8, s78, v6
    v_xor_b32 v8, v8, v7
    v_lshlrev_b32 v8, 4, v8
    v_lshl_add_u32 v5, v5, 6, v8
    v_add_u32 v14, s86, v5
    v_lshlrev_b32 v15, 4, v0
    v_add_u32 v16, 2, v15
    v_lshrrev_b32 v5, 4, v0
    v_lshlrev_b32 v5, 1, v5
    v_and_b32 v8, 7, v0
    v_xor_b32 v5, v5, v8
    v_lshlrev_b32 v5, 4, v5
    v_lshrrev_b32 v8, 3, v0
    v_lshl_add_u32 v5, v8, 11, v5
    s_lshl_b32 s78, s77, 7
    v_add_u32 v17, s78, v5
    v_mov_b32 v18, 162304
    v_mov_b32 v19, 1
    s_waitcnt vmcnt(22)
    s_barrier
    buffer_load_dwordx4 v[84:87], v11, s[44:47], 0 offen offset:0
    buffer_load_dwordx4 v[88:91], v11, s[44:47], 0 offen offset:16
    buffer_load_dwordx4 v[92:95], v11, s[44:47], 0 offen offset:32
    buffer_load_dwordx4 v[96:99], v11, s[44:47], 0 offen offset:48
    buffer_load_dwordx4 v[40:43], v10, s[36:39], 0 offen offset:0 nt
    buffer_load_dwordx4 v[44:47], v10, s[36:39], 0 offen offset:2048 nt
    buffer_load_dwordx4 v[48:51], v10, s[36:39], s96 offen offset:0 nt
    buffer_load_dwordx4 v[52:55], v9, s[36:39], 0 offen offset:0 nt
    buffer_load_dwordx4 v[56:59], v9, s[36:39], 0 offen offset:2048 nt
    buffer_load_dwordx4 v[60:63], v9, s[36:39], s96 offen offset:0 nt
    buffer_load_dwordx4 v[64:67], v9, s[36:39], s96 offen offset:2048 nt
    buffer_load_dwordx4 v[68:71], v9, s[40:43], 0 offen offset:0 nt
    buffer_load_dwordx4 v[72:75], v9, s[40:43], 0 offen offset:2048 nt
    buffer_load_dwordx4 v[76:79], v9, s[40:43], s96 offen offset:0 nt
    buffer_load_dwordx4 v[80:83], v9, s[40:43], s96 offen offset:2048 nt
    v_and_b32 v5, 15, v0
    v_lshrrev_b32 v6, 4, v0
    v_add_u32 v7, 9, v5
    v_and_b32 v8, 1, v7
    v_mul_u32_u24 v8, 4160, v8
    v_lshrrev_b32 v7, 1, v7
    v_lshl_add_u32 v8, v7, 2, v8
    v_lshlrev_b32 v7, 4, v6
    v_sub_u32 v8, v8, v7
    s_add_u32 s78, s94, 32
    v_add_u32 v21, s78, v8
    v_add_u32 v22, 1024, v21
    v_add_u32 v23, 2048, v21
    v_add_u32 v24, 3072, v21
    v_lshl_add_u32 v7, v5, 1, v6
    v_add_u32 v7, 30, v7
    v_lshrrev_b32 v8, 3, v7
    v_and_b32 v25, 3, v8
    v_xor_b32 v25, s3, v25
    v_lshl_add_u32 v25, v8, 5, v25
    v_and_b32 v8, 1, v7
    v_lshl_add_u32 v25, v8, 4, v25
    v_bfe_u32 v8, v7, 1, 2
    v_lshl_add_u32 v25, v8, 2, v25
    v_lshlrev_b32 v25, 4, v25
    v_add_u32 v25, 92160, v25
    v_lshl_add_u32 v7, v5, 1, v6
    v_add_u32 v7, 26, v7
    v_lshrrev_b32 v8, 3, v7
    v_and_b32 v26, 3, v8
    v_xor_b32 v26, s3, v26
    v_lshl_add_u32 v26, v8, 5, v26
    v_and_b32 v8, 1, v7
    v_lshl_add_u32 v26, v8, 4, v26
    v_bfe_u32 v8, v7, 1, 2
    v_lshl_add_u32 v26, v8, 2, v26
    v_lshlrev_b32 v26, 4, v26
    v_add_u32 v26, 92160, v26
    v_lshl_add_u32 v7, v5, 1, v6
    v_add_u32 v7, 22, v7
    v_lshrrev_b32 v8, 3, v7
    v_and_b32 v27, 3, v8
    v_xor_b32 v27, s3, v27
    v_lshl_add_u32 v27, v8, 5, v27
    v_and_b32 v8, 1, v7
    v_lshl_add_u32 v27, v8, 4, v27
    v_bfe_u32 v8, v7, 1, 2
    v_lshl_add_u32 v27, v8, 2, v27
    v_lshlrev_b32 v27, 4, v27
    v_add_u32 v27, 92160, v27
    v_lshl_add_u32 v7, v5, 1, v6
    v_add_u32 v7, 18, v7
    v_lshrrev_b32 v8, 3, v7
    v_and_b32 v28, 3, v8
    v_xor_b32 v28, s3, v28
    v_lshl_add_u32 v28, v8, 5, v28
    v_and_b32 v8, 1, v7
    v_lshl_add_u32 v28, v8, 4, v28
    v_bfe_u32 v8, v7, 1, 2
    v_lshl_add_u32 v28, v8, 2, v28
    v_lshlrev_b32 v28, 4, v28
    v_add_u32 v28, 92160, v28
    v_lshl_add_u32 v7, v5, 1, v6
    v_add_u32 v7, 14, v7
    v_lshrrev_b32 v8, 3, v7
    v_and_b32 v29, 3, v8
    v_xor_b32 v29, s3, v29
    v_lshl_add_u32 v29, v8, 5, v29
    v_and_b32 v8, 1, v7
    v_lshl_add_u32 v29, v8, 4, v29
    v_bfe_u32 v8, v7, 1, 2
    v_lshl_add_u32 v29, v8, 2, v29
    v_lshlrev_b32 v29, 4, v29
    v_add_u32 v29, 92160, v29
    v_lshl_add_u32 v7, v5, 1, v6
    v_add_u32 v7, 10, v7
    v_lshrrev_b32 v8, 3, v7
    v_and_b32 v30, 3, v8
    v_xor_b32 v30, s3, v30
    v_lshl_add_u32 v30, v8, 5, v30
    v_and_b32 v8, 1, v7
    v_lshl_add_u32 v30, v8, 4, v30
    v_bfe_u32 v8, v7, 1, 2
    v_lshl_add_u32 v30, v8, 2, v30
    v_lshlrev_b32 v30, 4, v30
    v_add_u32 v30, 92160, v30
    v_lshl_add_u32 v7, v5, 1, v6
    v_add_u32 v7, 6, v7
    v_lshrrev_b32 v8, 3, v7
    v_and_b32 v31, 3, v8
    v_xor_b32 v31, s3, v31
    v_lshl_add_u32 v31, v8, 5, v31
    v_and_b32 v8, 1, v7
    v_lshl_add_u32 v31, v8, 4, v31
    v_bfe_u32 v8, v7, 1, 2
    v_lshl_add_u32 v31, v8, 2, v31
    v_lshlrev_b32 v31, 4, v31
    v_add_u32 v31, 92160, v31
    v_lshl_add_u32 v7, v5, 1, v6
    v_add_u32 v7, 2, v7
    v_lshrrev_b32 v8, 3, v7
    v_and_b32 v32, 3, v8
    v_xor_b32 v32, s3, v32
    v_lshl_add_u32 v32, v8, 5, v32
    v_and_b32 v8, 1, v7
    v_lshl_add_u32 v32, v8, 4, v32
    v_bfe_u32 v8, v7, 1, 2
    v_lshl_add_u32 v32, v8, 2, v32
    v_lshlrev_b32 v32, 4, v32
    v_add_u32 v32, 92160, v32
    v_lshrrev_b32 v7, 1, v6
    v_lshl_add_u32 v7, v5, 1, v7
    v_add_u32 v7, 32, v7
    v_lshrrev_b32 v8, 3, v7
    v_and_b32 v20, 3, v8
    v_xor_b32 v20, s3, v20
    v_lshl_add_u32 v20, v8, 5, v20
    v_and_b32 v8, 1, v7
    v_lshl_add_u32 v20, v8, 4, v20
    v_bfe_u32 v8, v7, 1, 2
    v_lshl_add_u32 v20, v8, 2, v20
    v_lshlrev_b32 v20, 4, v20
    v_add_u32 v20, 92160, v20
    v_and_b32 v8, 1, v6
    v_xor_b32 v8, 1, v8
    v_lshl_add_u32 v20, v8, 3, v20
    s_waitcnt vmcnt(26)
    s_barrier
    s_add_u32 m0, s87, 0
    s_mov_b32 s89, 384
    buffer_load_dwordx4 v2, s[28:31], s89 offen  lds
    s_add_u32 m0, s86, 0
    s_mov_b32 s89, 1179648
    buffer_load_dwordx4 v4, s[32:35], s89 offen  lds
    s_add_u32 m0, s86, 24576
    s_mov_b32 s89, 1181696
    buffer_load_dwordx4 v4, s[32:35], s89 offen  lds
    s_add_u32 m0, s87, 4096
    s_mov_b32 s89, 65920
    buffer_load_dwordx4 v2, s[28:31], s89 offen  lds
    s_add_u32 m0, s86, 49152
    s_mov_b32 s89, 1183744
    buffer_load_dwordx4 v4, s[32:35], s89 offen  lds
    s_add_u32 m0, s87, 8192
    s_mov_b32 s89, 131456
    buffer_load_dwordx4 v2, s[28:31], s89 offen  lds
    s_add_u32 m0, s86, 4096
    s_mov_b32 s89, 1376256
    buffer_load_dwordx4 v4, s[32:35], s89 offen  lds
    s_add_u32 m0, s86, 28672
    s_mov_b32 s89, 1378304
    buffer_load_dwordx4 v4, s[32:35], s89 offen  lds
    s_add_u32 m0, s87, 12288
    s_mov_b32 s89, 196992
    buffer_load_dwordx4 v2, s[28:31], s89 offen  lds
    s_add_u32 m0, s86, 53248
    s_mov_b32 s89, 1380352
    buffer_load_dwordx4 v4, s[32:35], s89 offen  lds
    s_mov_b64 exec, 0xffffffff
    s_add_u32 m0, s88, 0
    s_mov_b32 s89, 384
    buffer_load_dwordx4 v3, s[28:31], s89 offen  lds
    s_mov_b64 exec, -1
    s_waitcnt lgkmcnt(0)
    s_lshl_b32 s93, s93, 16
    s_and_b32 s78, s92, 0xffff0000
    s_lshl_b32 s92, s92, 16
    s_bitcmp1_b32 s90, 0
    s_cselect_b32 s92, s78, s92
    v_lshrrev_b32 v5, 3, v0
    v_mul_u32_u24 v5, 4160, v5
    v_and_b32 v6, 7, v0
    v_lshl_add_u32 v5, v6, 2, v5
    v_add_u32 v5, s94, v5
    v_mov_b32 v6, 0
    v_writelane_b32 v6, s93, 15
    s_mov_b64 exec, 0xffff
    ds_write_b32 v5, v6
    s_mov_b64 exec, -1
    s_waitcnt vmcnt(26)
    s_barrier
    s_add_u32 m0, s87, 18432
    s_mov_b32 s89, 512
    buffer_load_dwordx4 v2, s[28:31], s89 offen  lds
    s_add_u32 m0, s86, 8192
    s_mov_b32 s89, 1572864
    buffer_load_dwordx4 v4, s[32:35], s89 offen  lds
    s_add_u32 m0, s86, 32768
    s_mov_b32 s89, 1574912
    buffer_load_dwordx4 v4, s[32:35], s89 offen  lds
    s_add_u32 m0, s87, 22528
    s_mov_b32 s89, 66048
    buffer_load_dwordx4 v2, s[28:31], s89 offen  lds
    s_add_u32 m0, s86, 57344
    s_mov_b32 s89, 1576960
    buffer_load_dwordx4 v4, s[32:35], s89 offen  lds
    s_add_u32 m0, s87, 26624
    s_mov_b32 s89, 131584
    buffer_load_dwordx4 v2, s[28:31], s89 offen  lds
    s_add_u32 m0, s86, 12288
    s_mov_b32 s89, 1769472
    buffer_load_dwordx4 v4, s[32:35], s89 offen  lds
    s_add_u32 m0, s86, 36864
    s_mov_b32 s89, 1771520
    buffer_load_dwordx4 v4, s[32:35], s89 offen  lds
    s_add_u32 m0, s87, 30720
    s_mov_b32 s89, 197120
    buffer_load_dwordx4 v2, s[28:31], s89 offen  lds
    s_add_u32 m0, s86, 61440
    s_mov_b32 s89, 1773568
    buffer_load_dwordx4 v4, s[32:35], s89 offen  lds
    s_mov_b64 exec, 0xffffffff
    s_add_u32 m0, s88, 18432
    s_mov_b32 s89, 512
    buffer_load_dwordx4 v3, s[28:31], s89 offen  lds
    s_mov_b64 exec, -1
    s_waitcnt vmcnt(11)
    s_barrier
    s_add_u32 m0, s87, 36864
    s_mov_b32 s89, 640
    buffer_load_dwordx4 v2, s[28:31], s89 offen  lds
    s_add_u32 m0, s86, 16384
    s_mov_b32 s89, 1966080
    buffer_load_dwordx4 v4, s[32:35], s89 offen  lds
    s_add_u32 m0, s86, 40960
    s_mov_b32 s89, 1968128
    buffer_load_dwordx4 v4, s[32:35], s89 offen  lds
    s_add_u32 m0, s87, 40960
    s_mov_b32 s89, 66176
    buffer_load_dwordx4 v2, s[28:31], s89 offen  lds
    s_add_u32 m0, s86, 65536
    s_mov_b32 s89, 1970176
    buffer_load_dwordx4 v4, s[32:35], s89 offen  lds
    s_add_u32 m0, s87, 45056
    s_mov_b32 s89, 131712
    buffer_load_dwordx4 v2, s[28:31], s89 offen  lds
    s_add_u32 m0, s86, 20480
    s_mov_b32 s89, 2162688
    buffer_load_dwordx4 v4, s[32:35], s89 offen  lds
    s_add_u32 m0, s86, 45056
    s_mov_b32 s89, 2164736
    buffer_load_dwordx4 v4, s[32:35], s89 offen  lds
    s_add_u32 m0, s87, 49152
    s_mov_b32 s89, 197248
    buffer_load_dwordx4 v2, s[28:31], s89 offen  lds
    s_add_u32 m0, s86, 69632
    s_mov_b32 s89, 2166784
    buffer_load_dwordx4 v4, s[32:35], s89 offen  lds
    s_mov_b64 exec, 0xffffffff
    s_add_u32 m0, s88, 36864
    s_mov_b32 s89, 640
    buffer_load_dwordx4 v3, s[28:31], s89 offen  lds
    s_mov_b64 exec, -1
    v_lshlrev_b32 v116, 16, v40
    v_lshlrev_b32 v117, 16, v44
    v_lshlrev_b32 v118, 16, v48
    v_lshlrev_b32 v119, 16, v52
    v_lshlrev_b32 v120, 16, v56
    v_lshlrev_b32 v121, 16, v60
    v_lshlrev_b32 v122, 16, v64
    v_lshlrev_b32 v127, 16, v84
    v_and_b32 v128, 0xffff0000, v84
    v_lshlrev_b32 v129, 16, v85
    v_and_b32 v130, 0xffff0000, v85
    v_lshlrev_b32 v123, 16, v68
    v_lshlrev_b32 v124, 16, v72
    v_lshlrev_b32 v125, 16, v76
    v_lshlrev_b32 v126, 16, v80
    v_mul_f32 v131, v116, v130
    v_mul_f32 v132, v117, v130
    v_mul_f32 v133, v118, v130
    v_mul_f32 v134, v119, v130
    v_fmac_f32 v131, v117, v129
    v_fmac_f32 v132, v118, v129
    v_fmac_f32 v133, v119, v129
    v_fmac_f32 v134, v120, v129
    v_fmac_f32 v131, v118, v128
    v_fmac_f32 v132, v119, v128
    v_fmac_f32 v133, v120, v128
    v_fmac_f32 v134, v121, v128
    v_fmac_f32 v131, v119, v127
    v_fmac_f32 v132, v120, v127
    v_fmac_f32 v133, v121, v127
    v_fmac_f32 v134, v122, v127
    v_mul_f32 v131, v131, v123
    v_mul_f32 v132, v132, v124
    v_mul_f32 v133, v133, v125
    v_mul_f32 v134, v134, v126
    v_cvt_pk_bf16_f32 v102, v134, v133
    v_cvt_pk_bf16_f32 v103, v132, v131
    v_and_b32 v116, 0xffff0000, v40
    v_and_b32 v117, 0xffff0000, v44
    v_and_b32 v118, 0xffff0000, v48
    v_and_b32 v119, 0xffff0000, v52
    v_and_b32 v120, 0xffff0000, v56
    v_and_b32 v121, 0xffff0000, v60
    v_and_b32 v122, 0xffff0000, v64
    v_lshlrev_b32 v127, 16, v86
    v_and_b32 v128, 0xffff0000, v86
    v_lshlrev_b32 v129, 16, v87
    v_and_b32 v130, 0xffff0000, v87
    v_and_b32 v123, 0xffff0000, v68
    v_and_b32 v124, 0xffff0000, v72
    v_and_b32 v125, 0xffff0000, v76
    v_and_b32 v126, 0xffff0000, v80
    v_mul_f32 v131, v116, v130
    v_mul_f32 v132, v117, v130
    v_mul_f32 v133, v118, v130
    v_mul_f32 v134, v119, v130
    v_fmac_f32 v131, v117, v129
    v_fmac_f32 v132, v118, v129
    v_fmac_f32 v133, v119, v129
    v_fmac_f32 v134, v120, v129
    v_fmac_f32 v131, v118, v128
    v_fmac_f32 v132, v119, v128
    v_fmac_f32 v133, v120, v128
    v_fmac_f32 v134, v121, v128
    v_fmac_f32 v131, v119, v127
    v_fmac_f32 v132, v120, v127
    v_fmac_f32 v133, v121, v127
    v_fmac_f32 v134, v122, v127
    v_mul_f32 v131, v131, v123
    v_mul_f32 v132, v132, v124
    v_mul_f32 v133, v133, v125
    v_mul_f32 v134, v134, v126
    v_cvt_pk_bf16_f32 v106, v134, v133
    v_cvt_pk_bf16_f32 v107, v132, v131
    s_waitcnt vmcnt(11)
    s_barrier
    s_add_u32 m0, s87, 0
    s_mov_b32 s89, 768
    buffer_load_dwordx4 v2, s[28:31], s89 offen  lds
    s_add_u32 m0, s86, 0
    s_mov_b32 s89, 2359296
    buffer_load_dwordx4 v4, s[32:35], s89 offen  lds
    s_add_u32 m0, s86, 24576
    s_mov_b32 s89, 2361344
    buffer_load_dwordx4 v4, s[32:35], s89 offen  lds
    s_add_u32 m0, s87, 4096
    s_mov_b32 s89, 66304
    buffer_load_dwordx4 v2, s[28:31], s89 offen  lds
    s_add_u32 m0, s86, 49152
    s_mov_b32 s89, 2363392
    buffer_load_dwordx4 v4, s[32:35], s89 offen  lds
    s_add_u32 m0, s87, 8192
    s_mov_b32 s89, 131840
    buffer_load_dwordx4 v2, s[28:31], s89 offen  lds
    s_add_u32 m0, s86, 4096
    s_mov_b32 s89, 2555904
    buffer_load_dwordx4 v4, s[32:35], s89 offen  lds
    s_add_u32 m0, s86, 28672
    s_mov_b32 s89, 2557952
    buffer_load_dwordx4 v4, s[32:35], s89 offen  lds
    s_add_u32 m0, s87, 12288
    s_mov_b32 s89, 197376
    buffer_load_dwordx4 v2, s[28:31], s89 offen  lds
    s_add_u32 m0, s86, 53248
    s_mov_b32 s89, 2560000
    buffer_load_dwordx4 v4, s[32:35], s89 offen  lds
    s_mov_b64 exec, 0xffffffff
    s_add_u32 m0, s88, 0
    s_mov_b32 s89, 768
    buffer_load_dwordx4 v3, s[28:31], s89 offen  lds
    s_mov_b64 exec, -1
    v_lshlrev_b32 v116, 16, v41
    v_lshlrev_b32 v117, 16, v45
    v_lshlrev_b32 v118, 16, v49
    v_lshlrev_b32 v119, 16, v53
    v_lshlrev_b32 v120, 16, v57
    v_lshlrev_b32 v121, 16, v61
    v_lshlrev_b32 v122, 16, v65
    v_lshlrev_b32 v127, 16, v88
    v_and_b32 v128, 0xffff0000, v88
    v_lshlrev_b32 v129, 16, v89
    v_and_b32 v130, 0xffff0000, v89
    v_lshlrev_b32 v123, 16, v69
    v_lshlrev_b32 v124, 16, v73
    v_lshlrev_b32 v125, 16, v77
    v_lshlrev_b32 v126, 16, v81
    v_mul_f32 v131, v116, v130
    v_mul_f32 v132, v117, v130
    v_mul_f32 v133, v118, v130
    v_mul_f32 v134, v119, v130
    v_fmac_f32 v131, v117, v129
    v_fmac_f32 v132, v118, v129
    v_fmac_f32 v133, v119, v129
    v_fmac_f32 v134, v120, v129
    v_fmac_f32 v131, v118, v128
    v_fmac_f32 v132, v119, v128
    v_fmac_f32 v133, v120, v128
    v_fmac_f32 v134, v121, v128
    v_fmac_f32 v131, v119, v127
    v_fmac_f32 v132, v120, v127
    v_fmac_f32 v133, v121, v127
    v_fmac_f32 v134, v122, v127
    v_mul_f32 v131, v131, v123
    v_mul_f32 v132, v132, v124
    v_mul_f32 v133, v133, v125
    v_mul_f32 v134, v134, v126
    v_cvt_pk_bf16_f32 v110, v134, v133
    v_cvt_pk_bf16_f32 v111, v132, v131
    v_and_b32 v116, 0xffff0000, v41
    v_and_b32 v117, 0xffff0000, v45
    v_and_b32 v118, 0xffff0000, v49
    v_and_b32 v119, 0xffff0000, v53
    v_and_b32 v120, 0xffff0000, v57
    v_and_b32 v121, 0xffff0000, v61
    v_and_b32 v122, 0xffff0000, v65
    v_lshlrev_b32 v127, 16, v90
    v_and_b32 v128, 0xffff0000, v90
    v_lshlrev_b32 v129, 16, v91
    v_and_b32 v130, 0xffff0000, v91
    v_and_b32 v123, 0xffff0000, v69
    v_and_b32 v124, 0xffff0000, v73
    v_and_b32 v125, 0xffff0000, v77
    v_and_b32 v126, 0xffff0000, v81
    v_mul_f32 v131, v116, v130
    v_mul_f32 v132, v117, v130
    v_mul_f32 v133, v118, v130
    v_mul_f32 v134, v119, v130
    v_fmac_f32 v131, v117, v129
    v_fmac_f32 v132, v118, v129
    v_fmac_f32 v133, v119, v129
    v_fmac_f32 v134, v120, v129
    v_fmac_f32 v131, v118, v128
    v_fmac_f32 v132, v119, v128
    v_fmac_f32 v133, v120, v128
    v_fmac_f32 v134, v121, v128
    v_fmac_f32 v131, v119, v127
    v_fmac_f32 v132, v120, v127
    v_fmac_f32 v133, v121, v127
    v_fmac_f32 v134, v122, v127
    v_mul_f32 v131, v131, v123
    v_mul_f32 v132, v132, v124
    v_mul_f32 v133, v133, v125
    v_mul_f32 v134, v134, v126
    v_cvt_pk_bf16_f32 v114, v134, v133
    v_cvt_pk_bf16_f32 v115, v132, v131
    s_waitcnt vmcnt(11)
    s_barrier
    s_add_u32 m0, s87, 18432
    s_mov_b32 s89, 896
    buffer_load_dwordx4 v2, s[28:31], s89 offen  lds
    s_add_u32 m0, s86, 8192
    s_mov_b32 s89, 2752512
    buffer_load_dwordx4 v4, s[32:35], s89 offen  lds
    s_add_u32 m0, s86, 32768
    s_mov_b32 s89, 2754560
    buffer_load_dwordx4 v4, s[32:35], s89 offen  lds
    s_add_u32 m0, s87, 22528
    s_mov_b32 s89, 66432
    buffer_load_dwordx4 v2, s[28:31], s89 offen  lds
    s_add_u32 m0, s86, 57344
    s_mov_b32 s89, 2756608
    buffer_load_dwordx4 v4, s[32:35], s89 offen  lds
    s_add_u32 m0, s87, 26624
    s_mov_b32 s89, 131968
    buffer_load_dwordx4 v2, s[28:31], s89 offen  lds
    s_add_u32 m0, s86, 12288
    s_mov_b32 s89, 2949120
    buffer_load_dwordx4 v4, s[32:35], s89 offen  lds
    s_add_u32 m0, s86, 36864
    s_mov_b32 s89, 2951168
    buffer_load_dwordx4 v4, s[32:35], s89 offen  lds
    s_add_u32 m0, s87, 30720
    s_mov_b32 s89, 197504
    buffer_load_dwordx4 v2, s[28:31], s89 offen  lds
    s_add_u32 m0, s86, 61440
    s_mov_b32 s89, 2953216
    buffer_load_dwordx4 v4, s[32:35], s89 offen  lds
    s_mov_b64 exec, 0xffffffff
    s_add_u32 m0, s88, 18432
    s_mov_b32 s89, 896
    buffer_load_dwordx4 v3, s[28:31], s89 offen  lds
    s_mov_b64 exec, -1
    v_lshlrev_b32 v116, 16, v42
    v_lshlrev_b32 v117, 16, v46
    v_lshlrev_b32 v118, 16, v50
    v_lshlrev_b32 v119, 16, v54
    v_lshlrev_b32 v120, 16, v58
    v_lshlrev_b32 v121, 16, v62
    v_lshlrev_b32 v122, 16, v66
    v_lshlrev_b32 v127, 16, v92
    v_and_b32 v128, 0xffff0000, v92
    v_lshlrev_b32 v129, 16, v93
    v_and_b32 v130, 0xffff0000, v93
    v_lshlrev_b32 v123, 16, v70
    v_lshlrev_b32 v124, 16, v74
    v_lshlrev_b32 v125, 16, v78
    v_lshlrev_b32 v126, 16, v82
    v_mul_f32 v131, v116, v130
    v_mul_f32 v132, v117, v130
    v_mul_f32 v133, v118, v130
    v_mul_f32 v134, v119, v130
    v_fmac_f32 v131, v117, v129
    v_fmac_f32 v132, v118, v129
    v_fmac_f32 v133, v119, v129
    v_fmac_f32 v134, v120, v129
    v_fmac_f32 v131, v118, v128
    v_fmac_f32 v132, v119, v128
    v_fmac_f32 v133, v120, v128
    v_fmac_f32 v134, v121, v128
    v_fmac_f32 v131, v119, v127
    v_fmac_f32 v132, v120, v127
    v_fmac_f32 v133, v121, v127
    v_fmac_f32 v134, v122, v127
    v_mul_f32 v131, v131, v123
    v_mul_f32 v132, v132, v124
    v_mul_f32 v133, v133, v125
    v_mul_f32 v134, v134, v126
    v_cvt_pk_bf16_f32 v100, v134, v133
    v_cvt_pk_bf16_f32 v101, v132, v131
    v_and_b32 v116, 0xffff0000, v42
    v_and_b32 v117, 0xffff0000, v46
    v_and_b32 v118, 0xffff0000, v50
    v_and_b32 v119, 0xffff0000, v54
    v_and_b32 v120, 0xffff0000, v58
    v_and_b32 v121, 0xffff0000, v62
    v_and_b32 v122, 0xffff0000, v66
    v_lshlrev_b32 v127, 16, v94
    v_and_b32 v128, 0xffff0000, v94
    v_lshlrev_b32 v129, 16, v95
    v_and_b32 v130, 0xffff0000, v95
    v_and_b32 v123, 0xffff0000, v70
    v_and_b32 v124, 0xffff0000, v74
    v_and_b32 v125, 0xffff0000, v78
    v_and_b32 v126, 0xffff0000, v82
    v_mul_f32 v131, v116, v130
    v_mul_f32 v132, v117, v130
    v_mul_f32 v133, v118, v130
    v_mul_f32 v134, v119, v130
    v_fmac_f32 v131, v117, v129
    v_fmac_f32 v132, v118, v129
    v_fmac_f32 v133, v119, v129
    v_fmac_f32 v134, v120, v129
    v_fmac_f32 v131, v118, v128
    v_fmac_f32 v132, v119, v128
    v_fmac_f32 v133, v120, v128
    v_fmac_f32 v134, v121, v128
    v_fmac_f32 v131, v119, v127
    v_fmac_f32 v132, v120, v127
    v_fmac_f32 v133, v121, v127
    v_fmac_f32 v134, v122, v127
    v_mul_f32 v131, v131, v123
    v_mul_f32 v132, v132, v124
    v_mul_f32 v133, v133, v125
    v_mul_f32 v134, v134, v126
    v_cvt_pk_bf16_f32 v104, v134, v133
    v_cvt_pk_bf16_f32 v105, v132, v131
    s_waitcnt vmcnt(11)
    s_barrier
    s_add_u32 m0, s87, 36864
    s_mov_b32 s89, 1024
    buffer_load_dwordx4 v2, s[28:31], s89 offen  lds
    s_add_u32 m0, s86, 16384
    s_mov_b32 s89, 3145728
    buffer_load_dwordx4 v4, s[32:35], s89 offen  lds
    s_add_u32 m0, s86, 40960
    s_mov_b32 s89, 3147776
    buffer_load_dwordx4 v4, s[32:35], s89 offen  lds
    s_add_u32 m0, s87, 40960
    s_mov_b32 s89, 66560
    buffer_load_dwordx4 v2, s[28:31], s89 offen  lds
    s_add_u32 m0, s86, 65536
    s_mov_b32 s89, 3149824
    buffer_load_dwordx4 v4, s[32:35], s89 offen  lds
    s_add_u32 m0, s87, 45056
    s_mov_b32 s89, 132096
    buffer_load_dwordx4 v2, s[28:31], s89 offen  lds
    s_add_u32 m0, s86, 20480
    s_mov_b32 s89, 3342336
    buffer_load_dwordx4 v4, s[32:35], s89 offen  lds
    s_add_u32 m0, s86, 45056
    s_mov_b32 s89, 3344384
    buffer_load_dwordx4 v4, s[32:35], s89 offen  lds
    s_add_u32 m0, s87, 49152
    s_mov_b32 s89, 197632
    buffer_load_dwordx4 v2, s[28:31], s89 offen  lds
    s_add_u32 m0, s86, 69632
    s_mov_b32 s89, 3346432
    buffer_load_dwordx4 v4, s[32:35], s89 offen  lds
    s_mov_b64 exec, 0xffffffff
    s_add_u32 m0, s88, 36864
    s_mov_b32 s89, 1024
    buffer_load_dwordx4 v3, s[28:31], s89 offen  lds
    s_mov_b64 exec, -1
    v_lshlrev_b32 v116, 16, v43
    v_lshlrev_b32 v117, 16, v47
    v_lshlrev_b32 v118, 16, v51
    v_lshlrev_b32 v119, 16, v55
    v_lshlrev_b32 v120, 16, v59
    v_lshlrev_b32 v121, 16, v63
    v_lshlrev_b32 v122, 16, v67
    v_lshlrev_b32 v127, 16, v96
    v_and_b32 v128, 0xffff0000, v96
    v_lshlrev_b32 v129, 16, v97
    v_and_b32 v130, 0xffff0000, v97
    v_lshlrev_b32 v123, 16, v71
    v_lshlrev_b32 v124, 16, v75
    v_lshlrev_b32 v125, 16, v79
    v_lshlrev_b32 v126, 16, v83
    v_mul_f32 v131, v116, v130
    v_mul_f32 v132, v117, v130
    v_mul_f32 v133, v118, v130
    v_mul_f32 v134, v119, v130
    v_fmac_f32 v131, v117, v129
    v_fmac_f32 v132, v118, v129
    v_fmac_f32 v133, v119, v129
    v_fmac_f32 v134, v120, v129
    v_fmac_f32 v131, v118, v128
    v_fmac_f32 v132, v119, v128
    v_fmac_f32 v133, v120, v128
    v_fmac_f32 v134, v121, v128
    v_fmac_f32 v131, v119, v127
    v_fmac_f32 v132, v120, v127
    v_fmac_f32 v133, v121, v127
    v_fmac_f32 v134, v122, v127
    v_mul_f32 v131, v131, v123
    v_mul_f32 v132, v132, v124
    v_mul_f32 v133, v133, v125
    v_mul_f32 v134, v134, v126
    v_cvt_pk_bf16_f32 v108, v134, v133
    v_cvt_pk_bf16_f32 v109, v132, v131
    v_and_b32 v116, 0xffff0000, v43
    v_and_b32 v117, 0xffff0000, v47
    v_and_b32 v118, 0xffff0000, v51
    v_and_b32 v119, 0xffff0000, v55
    v_and_b32 v120, 0xffff0000, v59
    v_and_b32 v121, 0xffff0000, v63
    v_and_b32 v122, 0xffff0000, v67
    v_lshlrev_b32 v127, 16, v98
    v_and_b32 v128, 0xffff0000, v98
    v_lshlrev_b32 v129, 16, v99
    v_and_b32 v130, 0xffff0000, v99
    v_and_b32 v123, 0xffff0000, v71
    v_and_b32 v124, 0xffff0000, v75
    v_and_b32 v125, 0xffff0000, v79
    v_and_b32 v126, 0xffff0000, v83
    v_mul_f32 v131, v116, v130
    v_mul_f32 v132, v117, v130
    v_mul_f32 v133, v118, v130
    v_mul_f32 v134, v119, v130
    v_fmac_f32 v131, v117, v129
    v_fmac_f32 v132, v118, v129
    v_fmac_f32 v133, v119, v129
    v_fmac_f32 v134, v120, v129
    v_fmac_f32 v131, v118, v128
    v_fmac_f32 v132, v119, v128
    v_fmac_f32 v133, v120, v128
    v_fmac_f32 v134, v121, v128
    v_fmac_f32 v131, v119, v127
    v_fmac_f32 v132, v120, v127
    v_fmac_f32 v133, v121, v127
    v_fmac_f32 v134, v122, v127
    v_mul_f32 v131, v131, v123
    v_mul_f32 v132, v132, v124
    v_mul_f32 v133, v133, v125
    v_mul_f32 v134, v134, v126
    v_cvt_pk_bf16_f32 v112, v134, v133
    v_cvt_pk_bf16_f32 v113, v132, v131
    v_permlane32_swap_b32 v102, v100
    v_permlane32_swap_b32 v103, v101
    v_permlane32_swap_b32 v106, v104
    v_permlane32_swap_b32 v107, v105
    v_permlane32_swap_b32 v110, v108
    v_permlane32_swap_b32 v111, v109
    v_permlane32_swap_b32 v114, v112
    v_permlane32_swap_b32 v115, v113
    s_mov_b32 s89, 0
    buffer_store_dwordx4 v[100:103], v12, s[52:55], s89 offen sc1
    s_mov_b32 s89, 16384
    buffer_store_dwordx4 v[104:107], v12, s[52:55], s89 offen sc1
    s_mov_b32 s89, 32768
    buffer_store_dwordx4 v[108:111], v12, s[52:55], s89 offen sc1
    s_mov_b32 s89, 49152
    buffer_store_dwordx4 v[112:115], v12, s[52:55], s89 offen sc1
    s_waitcnt vmcnt(15)
    s_barrier
    s_add_u32 m0, s87, 0
    s_mov_b32 s89, 1152
    buffer_load_dwordx4 v2, s[28:31], s89 offen  lds
    s_add_u32 m0, s86, 0
    s_mov_b32 s89, 3538944
    buffer_load_dwordx4 v4, s[32:35], s89 offen  lds
    s_add_u32 m0, s86, 24576
    s_mov_b32 s89, 3540992
    buffer_load_dwordx4 v4, s[32:35], s89 offen  lds
    s_add_u32 m0, s87, 4096
    s_mov_b32 s89, 66688
    buffer_load_dwordx4 v2, s[28:31], s89 offen  lds
    s_add_u32 m0, s86, 49152
    s_mov_b32 s89, 3543040
    buffer_load_dwordx4 v4, s[32:35], s89 offen  lds
    s_add_u32 m0, s87, 8192
    s_mov_b32 s89, 132224
    buffer_load_dwordx4 v2, s[28:31], s89 offen  lds
    s_add_u32 m0, s86, 4096
    s_mov_b32 s89, 3735552
    buffer_load_dwordx4 v4, s[32:35], s89 offen  lds
    s_add_u32 m0, s86, 28672
    s_mov_b32 s89, 3737600
    buffer_load_dwordx4 v4, s[32:35], s89 offen  lds
    s_add_u32 m0, s87, 12288
    s_mov_b32 s89, 197760
    buffer_load_dwordx4 v2, s[28:31], s89 offen  lds
    s_add_u32 m0, s86, 53248
    s_mov_b32 s89, 3739648
    buffer_load_dwordx4 v4, s[32:35], s89 offen  lds
    s_mov_b64 exec, 0xffffffff
    s_add_u32 m0, s88, 0
    s_mov_b32 s89, 1152
    buffer_load_dwordx4 v3, s[28:31], s89 offen  lds
    s_mov_b64 exec, -1
    s_add_u32 m0, s94, 32
    s_lshl_b32 s89, s90, 12
    buffer_load_dwordx4 v15, s[48:51], s89 offen offset:0  lds
    buffer_load_dwordx4 v15, s[48:51], s89 offen offset:1024  lds
    buffer_load_dwordx4 v15, s[48:51], s89 offen offset:2048  lds
    buffer_load_dwordx4 v15, s[48:51], s89 offen offset:3072  lds
    s_waitcnt vmcnt(19)
    s_barrier
    s_add_u32 m0, s87, 18432
    s_mov_b32 s89, 1280
    buffer_load_dwordx4 v2, s[28:31], s89 offen  lds
    s_add_u32 m0, s86, 8192
    s_mov_b32 s89, 3932160
    buffer_load_dwordx4 v4, s[32:35], s89 offen  lds
    s_add_u32 m0, s86, 32768
    s_mov_b32 s89, 3934208
    buffer_load_dwordx4 v4, s[32:35], s89 offen  lds
    s_add_u32 m0, s87, 22528
    s_mov_b32 s89, 66816
    buffer_load_dwordx4 v2, s[28:31], s89 offen  lds
    s_add_u32 m0, s86, 57344
    s_mov_b32 s89, 3936256
    buffer_load_dwordx4 v4, s[32:35], s89 offen  lds
    s_add_u32 m0, s87, 26624
    s_mov_b32 s89, 132352
    buffer_load_dwordx4 v2, s[28:31], s89 offen  lds
    s_add_u32 m0, s86, 12288
    s_mov_b32 s89, 4128768
    buffer_load_dwordx4 v4, s[32:35], s89 offen  lds
    s_add_u32 m0, s86, 36864
    s_mov_b32 s89, 4130816
    buffer_load_dwordx4 v4, s[32:35], s89 offen  lds
    s_add_u32 m0, s87, 30720
    s_mov_b32 s89, 197888
    buffer_load_dwordx4 v2, s[28:31], s89 offen  lds
    s_add_u32 m0, s86, 61440
    s_mov_b32 s89, 4132864
    buffer_load_dwordx4 v4, s[32:35], s89 offen  lds
    s_mov_b64 exec, 0xffffffff
    s_add_u32 m0, s88, 18432
    s_mov_b32 s89, 1280
    buffer_load_dwordx4 v3, s[28:31], s89 offen  lds
    s_mov_b64 exec, -1
    s_add_u32 m0, s94, 4192
    s_lshl_b32 s89, s90, 12
    buffer_load_dwordx4 v16, s[48:51], s89 offen offset:0 nt lds
    buffer_load_dwordx4 v16, s[48:51], s89 offen offset:1024 nt lds
    buffer_load_dwordx4 v16, s[48:51], s89 offen offset:2048 nt lds
    buffer_load_dwordx4 v16, s[48:51], s89 offen offset:3072 nt lds
    s_waitcnt vmcnt(19)
    s_barrier
    s_add_u32 m0, s87, 36864
    s_mov_b32 s89, 1408
    buffer_load_dwordx4 v2, s[28:31], s89 offen  lds
    s_add_u32 m0, s86, 16384
    s_mov_b32 s89, 4325376
    buffer_load_dwordx4 v4, s[32:35], s89 offen  lds
    s_add_u32 m0, s86, 40960
    s_mov_b32 s89, 4327424
    buffer_load_dwordx4 v4, s[32:35], s89 offen  lds
    s_add_u32 m0, s87, 40960
    s_mov_b32 s89, 66944
    buffer_load_dwordx4 v2, s[28:31], s89 offen  lds
    s_add_u32 m0, s86, 65536
    s_mov_b32 s89, 4329472
    buffer_load_dwordx4 v4, s[32:35], s89 offen  lds
    s_add_u32 m0, s87, 45056
    s_mov_b32 s89, 132480
    buffer_load_dwordx4 v2, s[28:31], s89 offen  lds
    s_add_u32 m0, s86, 20480
    s_mov_b32 s89, 4521984
    buffer_load_dwordx4 v4, s[32:35], s89 offen  lds
    s_add_u32 m0, s86, 45056
    s_mov_b32 s89, 4524032
    buffer_load_dwordx4 v4, s[32:35], s89 offen  lds
    s_add_u32 m0, s87, 49152
    s_mov_b32 s89, 198016
    buffer_load_dwordx4 v2, s[28:31], s89 offen  lds
    s_add_u32 m0, s86, 69632
    s_mov_b32 s89, 4526080
    buffer_load_dwordx4 v4, s[32:35], s89 offen  lds
    s_mov_b64 exec, 0xffffffff
    s_add_u32 m0, s88, 36864
    s_mov_b32 s89, 1408
    buffer_load_dwordx4 v3, s[28:31], s89 offen  lds
    s_mov_b64 exec, -1
    s_waitcnt vmcnt(15)
    s_barrier
    s_add_u32 m0, s87, 0
    s_mov_b32 s89, 1536
    buffer_load_dwordx4 v2, s[28:31], s89 offen  lds
    s_add_u32 m0, s86, 0
    s_mov_b32 s89, 4718592
    buffer_load_dwordx4 v4, s[32:35], s89 offen  lds
    s_add_u32 m0, s86, 24576
    s_mov_b32 s89, 4720640
    buffer_load_dwordx4 v4, s[32:35], s89 offen  lds
    s_add_u32 m0, s87, 4096
    s_mov_b32 s89, 67072
    buffer_load_dwordx4 v2, s[28:31], s89 offen  lds
    s_add_u32 m0, s86, 49152
    s_mov_b32 s89, 4722688
    buffer_load_dwordx4 v4, s[32:35], s89 offen  lds
    s_add_u32 m0, s87, 8192
    s_mov_b32 s89, 132608
    buffer_load_dwordx4 v2, s[28:31], s89 offen  lds
    s_add_u32 m0, s86, 4096
    s_mov_b32 s89, 4915200
    buffer_load_dwordx4 v4, s[32:35], s89 offen  lds
    s_add_u32 m0, s86, 28672
    s_mov_b32 s89, 4917248
    buffer_load_dwordx4 v4, s[32:35], s89 offen  lds
    s_add_u32 m0, s87, 12288
    s_mov_b32 s89, 198144
    buffer_load_dwordx4 v2, s[28:31], s89 offen  lds
    s_add_u32 m0, s86, 53248
    s_mov_b32 s89, 4919296
    buffer_load_dwordx4 v4, s[32:35], s89 offen  lds
    s_mov_b64 exec, 0xffffffff
    s_add_u32 m0, s88, 0
    s_mov_b32 s89, 1536
    buffer_load_dwordx4 v3, s[28:31], s89 offen  lds
    s_mov_b64 exec, -1
    s_waitcnt vmcnt(11)
    s_barrier
    s_add_u32 m0, s87, 18432
    s_mov_b32 s89, 1664
    buffer_load_dwordx4 v2, s[28:31], s89 offen  lds
    s_add_u32 m0, s86, 8192
    s_mov_b32 s89, 5111808
    buffer_load_dwordx4 v4, s[32:35], s89 offen  lds
    s_add_u32 m0, s86, 32768
    s_mov_b32 s89, 5113856
    buffer_load_dwordx4 v4, s[32:35], s89 offen  lds
    s_add_u32 m0, s87, 22528
    s_mov_b32 s89, 67200
    buffer_load_dwordx4 v2, s[28:31], s89 offen  lds
    s_add_u32 m0, s86, 57344
    s_mov_b32 s89, 5115904
    buffer_load_dwordx4 v4, s[32:35], s89 offen  lds
    s_add_u32 m0, s87, 26624
    s_mov_b32 s89, 132736
    buffer_load_dwordx4 v2, s[28:31], s89 offen  lds
    s_add_u32 m0, s86, 12288
    s_mov_b32 s89, 5308416
    buffer_load_dwordx4 v4, s[32:35], s89 offen  lds
    s_add_u32 m0, s86, 36864
    s_mov_b32 s89, 5310464
    buffer_load_dwordx4 v4, s[32:35], s89 offen  lds
    s_add_u32 m0, s87, 30720
    s_mov_b32 s89, 198272
    buffer_load_dwordx4 v2, s[28:31], s89 offen  lds
    s_add_u32 m0, s86, 61440
    s_mov_b32 s89, 5312512
    buffer_load_dwordx4 v4, s[32:35], s89 offen  lds
    s_mov_b64 exec, 0xffffffff
    s_add_u32 m0, s88, 18432
    s_mov_b32 s89, 1664
    buffer_load_dwordx4 v3, s[28:31], s89 offen  lds
    s_mov_b64 exec, -1
    s_waitcnt vmcnt(11)
    s_barrier
    s_add_u32 m0, s87, 36864
    s_mov_b32 s89, 1792
    buffer_load_dwordx4 v2, s[28:31], s89 offen  lds
    s_add_u32 m0, s86, 16384
    s_mov_b32 s89, 5505024
    buffer_load_dwordx4 v4, s[32:35], s89 offen  lds
    s_add_u32 m0, s86, 40960
    s_mov_b32 s89, 5507072
    buffer_load_dwordx4 v4, s[32:35], s89 offen  lds
    s_add_u32 m0, s87, 40960
    s_mov_b32 s89, 67328
    buffer_load_dwordx4 v2, s[28:31], s89 offen  lds
    s_add_u32 m0, s86, 65536
    s_mov_b32 s89, 5509120
    buffer_load_dwordx4 v4, s[32:35], s89 offen  lds
    s_add_u32 m0, s87, 45056
    s_mov_b32 s89, 132864
    buffer_load_dwordx4 v2, s[28:31], s89 offen  lds
    s_add_u32 m0, s86, 20480
    s_mov_b32 s89, 5701632
    buffer_load_dwordx4 v4, s[32:35], s89 offen  lds
    s_add_u32 m0, s86, 45056
    s_mov_b32 s89, 5703680
    buffer_load_dwordx4 v4, s[32:35], s89 offen  lds
    s_add_u32 m0, s87, 49152
    s_mov_b32 s89, 198400
    buffer_load_dwordx4 v2, s[28:31], s89 offen  lds
    s_add_u32 m0, s86, 69632
    s_mov_b32 s89, 5705728
    buffer_load_dwordx4 v4, s[32:35], s89 offen  lds
    s_mov_b64 exec, 0xffffffff
    s_add_u32 m0, s88, 36864
    s_mov_b32 s89, 1792
    buffer_load_dwordx4 v3, s[28:31], s89 offen  lds
    s_mov_b64 exec, -1
    s_waitcnt vmcnt(11)
    s_barrier
    s_add_u32 m0, s87, 0
    s_mov_b32 s89, 1920
    buffer_load_dwordx4 v2, s[28:31], s89 offen  lds
    s_add_u32 m0, s86, 0
    s_mov_b32 s89, 5898240
    buffer_load_dwordx4 v4, s[32:35], s89 offen  lds
    s_add_u32 m0, s86, 24576
    s_mov_b32 s89, 5900288
    buffer_load_dwordx4 v4, s[32:35], s89 offen  lds
    s_add_u32 m0, s87, 4096
    s_mov_b32 s89, 67456
    buffer_load_dwordx4 v2, s[28:31], s89 offen  lds
    s_add_u32 m0, s86, 49152
    s_mov_b32 s89, 5902336
    buffer_load_dwordx4 v4, s[32:35], s89 offen  lds
    s_add_u32 m0, s87, 8192
    s_mov_b32 s89, 132992
    buffer_load_dwordx4 v2, s[28:31], s89 offen  lds
    s_add_u32 m0, s86, 4096
    s_mov_b32 s89, 6094848
    buffer_load_dwordx4 v4, s[32:35], s89 offen  lds
    s_add_u32 m0, s86, 28672
    s_mov_b32 s89, 6096896
    buffer_load_dwordx4 v4, s[32:35], s89 offen  lds
    s_add_u32 m0, s87, 12288
    s_mov_b32 s89, 198528
    buffer_load_dwordx4 v2, s[28:31], s89 offen  lds
    s_add_u32 m0, s86, 53248
    s_mov_b32 s89, 6098944
    buffer_load_dwordx4 v4, s[32:35], s89 offen  lds
    s_mov_b64 exec, 0xffffffff
    s_add_u32 m0, s88, 0
    s_mov_b32 s89, 1920
    buffer_load_dwordx4 v3, s[28:31], s89 offen  lds
    s_mov_b64 exec, -1
    s_waitcnt vmcnt(11)
    s_barrier
    s_add_u32 m0, s86, 94208
    s_add_u32 s89, s91, 0
    buffer_load_dwordx4 v14, s[52:55], s89 offen sc1 lds
    s_add_u32 m0, s86, 98304
    s_add_u32 s89, s91, 4096
    buffer_load_dwordx4 v14, s[52:55], s89 offen sc1 lds
    s_add_u32 m0, s86, 102400
    s_add_u32 s89, s91, 8192
    buffer_load_dwordx4 v14, s[52:55], s89 offen sc1 lds
    s_add_u32 m0, s86, 106496
    s_add_u32 s89, s91, 12288
    buffer_load_dwordx4 v14, s[52:55], s89 offen sc1 lds
    v_lshlrev_b32 v5, 3, v0
    s_add_u32 s78, s88, 18432
    v_add_u32 v5, s78, v5
    v_mov_b32 v6, 0
    v_mov_b32 v7, 0
    ds_write_b64 v5, v[6:7]
    s_waitcnt vmcnt(4)
    s_barrier
    s_waitcnt vmcnt(0) lgkmcnt(0)
    s_barrier
    ds_read2_b32 v[68:69], v21 offset0:0 offset1:1
    ds_read2_b32 v[70:71], v21 offset0:2 offset1:3
    ds_read_b128 v[100:103], v25 offset:0
    ds_read2_b32 v[72:73], v21 offset0:128 offset1:129
    ds_read2_b32 v[74:75], v21 offset0:130 offset1:131
    ds_read_b128 v[104:107], v25 offset:2048
    ds_read2_b32 v[76:77], v22 offset0:0 offset1:1
    ds_read2_b32 v[78:79], v22 offset0:2 offset1:3
    ds_read_b128 v[108:111], v25 offset:4096
    ds_read2_b32 v[80:81], v22 offset0:128 offset1:129
    ds_read2_b32 v[82:83], v22 offset0:130 offset1:131
    ds_read_b128 v[112:115], v25 offset:6144
    ds_read2_b32 v[84:85], v23 offset0:0 offset1:1
    ds_read2_b32 v[86:87], v23 offset0:2 offset1:3
    ds_read_b128 v[116:119], v25 offset:8192
    ds_read2_b32 v[88:89], v23 offset0:128 offset1:129
    ds_read2_b32 v[90:91], v23 offset0:130 offset1:131
    ds_read_b128 v[120:123], v25 offset:10240
    ds_read2_b32 v[92:93], v24 offset0:0 offset1:1
    ds_read2_b32 v[94:95], v24 offset0:2 offset1:3
    ds_read_b128 v[124:127], v25 offset:12288
    ds_read2_b32 v[96:97], v24 offset0:128 offset1:129
    ds_read2_b32 v[98:99], v24 offset0:130 offset1:131
    ds_read_b128 v[128:131], v25 offset:14336
    s_add_u32 m0, s86, 0
    s_add_u32 s89, s95, 0
    buffer_load_dwordx4 v17, s[64:67], s89 offen  lds
    s_add_u32 m0, s86, 4096
    s_add_u32 s89, s95, 65536
    buffer_load_dwordx4 v17, s[64:67], s89 offen  lds
    s_add_u32 m0, s86, 8192
    s_add_u32 s89, s95, 131072
    buffer_load_dwordx4 v17, s[64:67], s89 offen  lds
    s_add_u32 m0, s86, 12288
    s_add_u32 s89, s95, 196608
    buffer_load_dwordx4 v17, s[64:67], s89 offen  lds
    s_add_u32 m0, s86, 16384
    s_add_u32 s89, s95, 262144
    buffer_load_dwordx4 v17, s[64:67], s89 offen  lds
    s_add_u32 m0, s86, 20480
    s_add_u32 s89, s95, 327680
    buffer_load_dwordx4 v17, s[64:67], s89 offen  lds
    s_add_u32 m0, s86, 24576
    s_add_u32 s89, s95, 393216
    buffer_load_dwordx4 v17, s[64:67], s89 offen  lds
    s_add_u32 m0, s86, 28672
    s_add_u32 s89, s95, 458752
    buffer_load_dwordx4 v17, s[64:67], s89 offen  lds
    s_add_u32 m0, s86, 32768
    s_add_u32 s89, s95, 524288
    buffer_load_dwordx4 v17, s[64:67], s89 offen  lds
    s_add_u32 m0, s86, 36864
    s_add_u32 s89, s95, 589824
    buffer_load_dwordx4 v17, s[64:67], s89 offen  lds
    s_add_u32 m0, s86, 40960
    s_add_u32 s89, s95, 655360
    buffer_load_dwordx4 v17, s[64:67], s89 offen  lds
    s_add_u32 m0, s86, 45056
    s_add_u32 s89, s95, 720896
    buffer_load_dwordx4 v17, s[64:67], s89 offen  lds
    s_add_u32 m0, s86, 49152
    s_add_u32 s89, s95, 786432
    buffer_load_dwordx4 v17, s[64:67], s89 offen  lds
    s_add_u32 m0, s86, 53248
    s_add_u32 s89, s95, 851968
    buffer_load_dwordx4 v17, s[64:67], s89 offen  lds
    s_add_u32 m0, s86, 57344
    s_add_u32 s89, s95, 917504
    buffer_load_dwordx4 v17, s[64:67], s89 offen  lds
    s_add_u32 m0, s86, 61440
    s_add_u32 s89, s95, 983040
    buffer_load_dwordx4 v17, s[64:67], s89 offen  lds
    s_add_u32 m0, s86, 65536
    s_add_u32 s89, s95, 1048576
    buffer_load_dwordx4 v17, s[64:67], s89 offen  lds
    s_add_u32 m0, s86, 69632
    s_add_u32 s89, s95, 1114112
    buffer_load_dwordx4 v17, s[64:67], s89 offen  lds
    s_add_u32 m0, s86, 73728
    s_add_u32 s89, s95, 1179648
    buffer_load_dwordx4 v17, s[64:67], s89 offen  lds
    s_add_u32 m0, s86, 77824
    s_add_u32 s89, s95, 1245184
    buffer_load_dwordx4 v17, s[64:67], s89 offen  lds
    s_add_u32 m0, s86, 81920
    s_add_u32 s89, s95, 1310720
    buffer_load_dwordx4 v17, s[64:67], s89 offen  lds
    s_add_u32 m0, s86, 86016
    s_add_u32 s89, s95, 1376256
    buffer_load_dwordx4 v17, s[64:67], s89 offen  lds
    s_add_u32 m0, s86, 120832
    s_add_u32 s89, s95, 1441792
    buffer_load_dwordx4 v17, s[64:67], s89 offen  lds
    s_add_u32 m0, s86, 124928
    s_add_u32 s89, s95, 1507328
    buffer_load_dwordx4 v17, s[64:67], s89 offen  lds
    s_waitcnt lgkmcnt(0)
    v_mfma_f32_16x16x32_bf16 v[36:39], v[68:71], v[100:103], 0
    ds_read2_b32 v[132:133], v21 offset0:16 offset1:17
    v_mfma_f32_16x16x32_bf16 v[40:43], v[68:71], v[104:107], 0
    ds_read2_b32 v[134:135], v21 offset0:18 offset1:19
    v_mfma_f32_16x16x32_bf16 v[44:47], v[68:71], v[108:111], 0
    ds_read_b128 v[164:167], v26 offset:0
    v_mfma_f32_16x16x32_bf16 v[48:51], v[68:71], v[112:115], 0
    ds_read2_b32 v[136:137], v21 offset0:144 offset1:145
    v_mfma_f32_16x16x32_bf16 v[52:55], v[68:71], v[116:119], 0
    ds_read2_b32 v[138:139], v21 offset0:146 offset1:147
    v_mfma_f32_16x16x32_bf16 v[56:59], v[68:71], v[120:123], 0
    ds_read_b128 v[168:171], v26 offset:2048
    v_mfma_f32_16x16x32_bf16 v[60:63], v[68:71], v[124:127], 0
    ds_read2_b32 v[140:141], v22 offset0:16 offset1:17
    v_mfma_f32_16x16x32_bf16 v[64:67], v[68:71], v[128:131], 0
    ds_read2_b32 v[142:143], v22 offset0:18 offset1:19
    v_mfma_f32_16x16x32_bf16 v[40:43], v[72:75], v[100:103], v[40:43]
    ds_read_b128 v[172:175], v26 offset:4096
    v_mfma_f32_16x16x32_bf16 v[44:47], v[72:75], v[104:107], v[44:47]
    ds_read2_b32 v[144:145], v22 offset0:144 offset1:145
    v_mfma_f32_16x16x32_bf16 v[48:51], v[72:75], v[108:111], v[48:51]
    ds_read2_b32 v[146:147], v22 offset0:146 offset1:147
    v_mfma_f32_16x16x32_bf16 v[52:55], v[72:75], v[112:115], v[52:55]
    ds_read_b128 v[176:179], v26 offset:6144
    v_mfma_f32_16x16x32_bf16 v[56:59], v[72:75], v[116:119], v[56:59]
    ds_read2_b32 v[148:149], v23 offset0:16 offset1:17
    v_mfma_f32_16x16x32_bf16 v[60:63], v[72:75], v[120:123], v[60:63]
    ds_read2_b32 v[150:151], v23 offset0:18 offset1:19
    v_mfma_f32_16x16x32_bf16 v[64:67], v[72:75], v[124:127], v[64:67]
    ds_read_b128 v[180:183], v26 offset:8192
    v_mfma_f32_16x16x32_bf16 v[44:47], v[76:79], v[100:103], v[44:47]
    ds_read2_b32 v[152:153], v23 offset0:144 offset1:145
    v_mfma_f32_16x16x32_bf16 v[48:51], v[76:79], v[104:107], v[48:51]
    ds_read2_b32 v[154:155], v23 offset0:146 offset1:147
    v_mfma_f32_16x16x32_bf16 v[52:55], v[76:79], v[108:111], v[52:55]
    ds_read_b128 v[184:187], v26 offset:10240
    v_mfma_f32_16x16x32_bf16 v[56:59], v[76:79], v[112:115], v[56:59]
    ds_read2_b32 v[156:157], v24 offset0:16 offset1:17
    v_mfma_f32_16x16x32_bf16 v[60:63], v[76:79], v[116:119], v[60:63]
    ds_read2_b32 v[158:159], v24 offset0:18 offset1:19
    v_mfma_f32_16x16x32_bf16 v[64:67], v[76:79], v[120:123], v[64:67]
    ds_read_b128 v[188:191], v26 offset:12288
    v_mfma_f32_16x16x32_bf16 v[48:51], v[80:83], v[100:103], v[48:51]
    ds_read2_b32 v[160:161], v24 offset0:144 offset1:145
    v_mfma_f32_16x16x32_bf16 v[52:55], v[80:83], v[104:107], v[52:55]
    ds_read2_b32 v[162:163], v24 offset0:146 offset1:147
    v_mfma_f32_16x16x32_bf16 v[56:59], v[80:83], v[108:111], v[56:59]
    ds_read_b128 v[192:195], v26 offset:14336
    v_mfma_f32_16x16x32_bf16 v[60:63], v[80:83], v[112:115], v[60:63]
    v_mfma_f32_16x16x32_bf16 v[64:67], v[80:83], v[116:119], v[64:67]
    v_mfma_f32_16x16x32_bf16 v[52:55], v[84:87], v[100:103], v[52:55]
    v_mfma_f32_16x16x32_bf16 v[56:59], v[84:87], v[104:107], v[56:59]
    v_mfma_f32_16x16x32_bf16 v[60:63], v[84:87], v[108:111], v[60:63]
    v_mfma_f32_16x16x32_bf16 v[64:67], v[84:87], v[112:115], v[64:67]
    v_mfma_f32_16x16x32_bf16 v[56:59], v[88:91], v[100:103], v[56:59]
    v_mfma_f32_16x16x32_bf16 v[60:63], v[88:91], v[104:107], v[60:63]
    v_mfma_f32_16x16x32_bf16 v[64:67], v[88:91], v[108:111], v[64:67]
    v_mfma_f32_16x16x32_bf16 v[60:63], v[92:95], v[100:103], v[60:63]
    v_mfma_f32_16x16x32_bf16 v[64:67], v[92:95], v[104:107], v[64:67]
    v_mfma_f32_16x16x32_bf16 v[64:67], v[96:99], v[100:103], v[64:67]
    s_waitcnt lgkmcnt(0)
    v_mfma_f32_16x16x32_bf16 v[36:39], v[132:135], v[164:167], v[36:39]
    ds_read2_b32 v[68:69], v21 offset0:32 offset1:33
    v_mfma_f32_16x16x32_bf16 v[40:43], v[132:135], v[168:171], v[40:43]
    ds_read2_b32 v[70:71], v21 offset0:34 offset1:35
    v_mfma_f32_16x16x32_bf16 v[44:47], v[132:135], v[172:175], v[44:47]
    ds_read_b128 v[100:103], v27 offset:0
    v_mfma_f32_16x16x32_bf16 v[48:51], v[132:135], v[176:179], v[48:51]
    ds_read2_b32 v[72:73], v21 offset0:160 offset1:161
    v_mfma_f32_16x16x32_bf16 v[52:55], v[132:135], v[180:183], v[52:55]
    ds_read2_b32 v[74:75], v21 offset0:162 offset1:163
    v_mfma_f32_16x16x32_bf16 v[56:59], v[132:135], v[184:187], v[56:59]
    ds_read_b128 v[104:107], v27 offset:2048
    v_mfma_f32_16x16x32_bf16 v[60:63], v[132:135], v[188:191], v[60:63]
    ds_read2_b32 v[76:77], v22 offset0:32 offset1:33
    v_mfma_f32_16x16x32_bf16 v[64:67], v[132:135], v[192:195], v[64:67]
    ds_read2_b32 v[78:79], v22 offset0:34 offset1:35
    v_mfma_f32_16x16x32_bf16 v[40:43], v[136:139], v[164:167], v[40:43]
    ds_read_b128 v[108:111], v27 offset:4096
    v_mfma_f32_16x16x32_bf16 v[44:47], v[136:139], v[168:171], v[44:47]
    ds_read2_b32 v[80:81], v22 offset0:160 offset1:161
    v_mfma_f32_16x16x32_bf16 v[48:51], v[136:139], v[172:175], v[48:51]
    ds_read2_b32 v[82:83], v22 offset0:162 offset1:163
    v_mfma_f32_16x16x32_bf16 v[52:55], v[136:139], v[176:179], v[52:55]
    ds_read_b128 v[112:115], v27 offset:6144
    v_mfma_f32_16x16x32_bf16 v[56:59], v[136:139], v[180:183], v[56:59]
    ds_read2_b32 v[84:85], v23 offset0:32 offset1:33
    v_mfma_f32_16x16x32_bf16 v[60:63], v[136:139], v[184:187], v[60:63]
    ds_read2_b32 v[86:87], v23 offset0:34 offset1:35
    v_mfma_f32_16x16x32_bf16 v[64:67], v[136:139], v[188:191], v[64:67]
    ds_read_b128 v[116:119], v27 offset:8192
    v_mfma_f32_16x16x32_bf16 v[44:47], v[140:143], v[164:167], v[44:47]
    ds_read2_b32 v[88:89], v23 offset0:160 offset1:161
    v_mfma_f32_16x16x32_bf16 v[48:51], v[140:143], v[168:171], v[48:51]
    ds_read2_b32 v[90:91], v23 offset0:162 offset1:163
    v_mfma_f32_16x16x32_bf16 v[52:55], v[140:143], v[172:175], v[52:55]
    ds_read_b128 v[120:123], v27 offset:10240
    v_mfma_f32_16x16x32_bf16 v[56:59], v[140:143], v[176:179], v[56:59]
    ds_read2_b32 v[92:93], v24 offset0:32 offset1:33
    v_mfma_f32_16x16x32_bf16 v[60:63], v[140:143], v[180:183], v[60:63]
    ds_read2_b32 v[94:95], v24 offset0:34 offset1:35
    v_mfma_f32_16x16x32_bf16 v[64:67], v[140:143], v[184:187], v[64:67]
    ds_read_b128 v[124:127], v27 offset:12288
    v_mfma_f32_16x16x32_bf16 v[48:51], v[144:147], v[164:167], v[48:51]
    ds_read2_b32 v[96:97], v24 offset0:160 offset1:161
    v_mfma_f32_16x16x32_bf16 v[52:55], v[144:147], v[168:171], v[52:55]
    ds_read2_b32 v[98:99], v24 offset0:162 offset1:163
    v_mfma_f32_16x16x32_bf16 v[56:59], v[144:147], v[172:175], v[56:59]
    ds_read_b128 v[128:131], v27 offset:14336
    v_mfma_f32_16x16x32_bf16 v[60:63], v[144:147], v[176:179], v[60:63]
    v_mfma_f32_16x16x32_bf16 v[64:67], v[144:147], v[180:183], v[64:67]
    v_mfma_f32_16x16x32_bf16 v[52:55], v[148:151], v[164:167], v[52:55]
    v_mfma_f32_16x16x32_bf16 v[56:59], v[148:151], v[168:171], v[56:59]
    v_mfma_f32_16x16x32_bf16 v[60:63], v[148:151], v[172:175], v[60:63]
    v_mfma_f32_16x16x32_bf16 v[64:67], v[148:151], v[176:179], v[64:67]
    v_mfma_f32_16x16x32_bf16 v[56:59], v[152:155], v[164:167], v[56:59]
    v_mfma_f32_16x16x32_bf16 v[60:63], v[152:155], v[168:171], v[60:63]
    v_mfma_f32_16x16x32_bf16 v[64:67], v[152:155], v[172:175], v[64:67]
    v_mfma_f32_16x16x32_bf16 v[60:63], v[156:159], v[164:167], v[60:63]
    v_mfma_f32_16x16x32_bf16 v[64:67], v[156:159], v[168:171], v[64:67]
    v_mfma_f32_16x16x32_bf16 v[64:67], v[160:163], v[164:167], v[64:67]
    s_waitcnt lgkmcnt(0)
    v_mfma_f32_16x16x32_bf16 v[36:39], v[68:71], v[100:103], v[36:39]
    ds_read2_b32 v[132:133], v21 offset0:48 offset1:49
    v_mfma_f32_16x16x32_bf16 v[40:43], v[68:71], v[104:107], v[40:43]
    ds_read2_b32 v[134:135], v21 offset0:50 offset1:51
    v_mfma_f32_16x16x32_bf16 v[44:47], v[68:71], v[108:111], v[44:47]
    ds_read_b128 v[164:167], v28 offset:0
    v_mfma_f32_16x16x32_bf16 v[48:51], v[68:71], v[112:115], v[48:51]
    ds_read2_b32 v[136:137], v21 offset0:176 offset1:177
    v_mfma_f32_16x16x32_bf16 v[52:55], v[68:71], v[116:119], v[52:55]
    ds_read2_b32 v[138:139], v21 offset0:178 offset1:179
    v_mfma_f32_16x16x32_bf16 v[56:59], v[68:71], v[120:123], v[56:59]
    ds_read_b128 v[168:171], v28 offset:2048
    v_mfma_f32_16x16x32_bf16 v[60:63], v[68:71], v[124:127], v[60:63]
    ds_read2_b32 v[140:141], v22 offset0:48 offset1:49
    v_mfma_f32_16x16x32_bf16 v[64:67], v[68:71], v[128:131], v[64:67]
    ds_read2_b32 v[142:143], v22 offset0:50 offset1:51
    v_mfma_f32_16x16x32_bf16 v[40:43], v[72:75], v[100:103], v[40:43]
    ds_read_b128 v[172:175], v28 offset:4096
    v_mfma_f32_16x16x32_bf16 v[44:47], v[72:75], v[104:107], v[44:47]
    ds_read2_b32 v[144:145], v22 offset0:176 offset1:177
    v_mfma_f32_16x16x32_bf16 v[48:51], v[72:75], v[108:111], v[48:51]
    ds_read2_b32 v[146:147], v22 offset0:178 offset1:179
    v_mfma_f32_16x16x32_bf16 v[52:55], v[72:75], v[112:115], v[52:55]
    ds_read_b128 v[176:179], v28 offset:6144
    v_mfma_f32_16x16x32_bf16 v[56:59], v[72:75], v[116:119], v[56:59]
    ds_read2_b32 v[148:149], v23 offset0:48 offset1:49
    v_mfma_f32_16x16x32_bf16 v[60:63], v[72:75], v[120:123], v[60:63]
    ds_read2_b32 v[150:151], v23 offset0:50 offset1:51
    v_mfma_f32_16x16x32_bf16 v[64:67], v[72:75], v[124:127], v[64:67]
    ds_read_b128 v[180:183], v28 offset:8192
    v_mfma_f32_16x16x32_bf16 v[44:47], v[76:79], v[100:103], v[44:47]
    ds_read2_b32 v[152:153], v23 offset0:176 offset1:177
    v_mfma_f32_16x16x32_bf16 v[48:51], v[76:79], v[104:107], v[48:51]
    ds_read2_b32 v[154:155], v23 offset0:178 offset1:179
    v_mfma_f32_16x16x32_bf16 v[52:55], v[76:79], v[108:111], v[52:55]
    ds_read_b128 v[184:187], v28 offset:10240
    v_mfma_f32_16x16x32_bf16 v[56:59], v[76:79], v[112:115], v[56:59]
    ds_read2_b32 v[156:157], v24 offset0:48 offset1:49
    v_mfma_f32_16x16x32_bf16 v[60:63], v[76:79], v[116:119], v[60:63]
    ds_read2_b32 v[158:159], v24 offset0:50 offset1:51
    v_mfma_f32_16x16x32_bf16 v[64:67], v[76:79], v[120:123], v[64:67]
    ds_read_b128 v[188:191], v28 offset:12288
    v_mfma_f32_16x16x32_bf16 v[48:51], v[80:83], v[100:103], v[48:51]
    ds_read2_b32 v[160:161], v24 offset0:176 offset1:177
    v_mfma_f32_16x16x32_bf16 v[52:55], v[80:83], v[104:107], v[52:55]
    ds_read2_b32 v[162:163], v24 offset0:178 offset1:179
    v_mfma_f32_16x16x32_bf16 v[56:59], v[80:83], v[108:111], v[56:59]
    ds_read_b128 v[192:195], v28 offset:14336
    v_mfma_f32_16x16x32_bf16 v[60:63], v[80:83], v[112:115], v[60:63]
    v_mfma_f32_16x16x32_bf16 v[64:67], v[80:83], v[116:119], v[64:67]
    v_mfma_f32_16x16x32_bf16 v[52:55], v[84:87], v[100:103], v[52:55]
    v_mfma_f32_16x16x32_bf16 v[56:59], v[84:87], v[104:107], v[56:59]
    v_mfma_f32_16x16x32_bf16 v[60:63], v[84:87], v[108:111], v[60:63]
    v_mfma_f32_16x16x32_bf16 v[64:67], v[84:87], v[112:115], v[64:67]
    v_mfma_f32_16x16x32_bf16 v[56:59], v[88:91], v[100:103], v[56:59]
    v_mfma_f32_16x16x32_bf16 v[60:63], v[88:91], v[104:107], v[60:63]
    v_mfma_f32_16x16x32_bf16 v[64:67], v[88:91], v[108:111], v[64:67]
    v_mfma_f32_16x16x32_bf16 v[60:63], v[92:95], v[100:103], v[60:63]
    v_mfma_f32_16x16x32_bf16 v[64:67], v[92:95], v[104:107], v[64:67]
    v_mfma_f32_16x16x32_bf16 v[64:67], v[96:99], v[100:103], v[64:67]
    s_waitcnt lgkmcnt(0)
    v_mfma_f32_16x16x32_bf16 v[36:39], v[132:135], v[164:167], v[36:39]
    ds_read2_b32 v[68:69], v21 offset0:64 offset1:65
    v_mfma_f32_16x16x32_bf16 v[40:43], v[132:135], v[168:171], v[40:43]
    ds_read2_b32 v[70:71], v21 offset0:66 offset1:67
    v_mfma_f32_16x16x32_bf16 v[44:47], v[132:135], v[172:175], v[44:47]
    ds_read_b128 v[100:103], v29 offset:0
    v_mfma_f32_16x16x32_bf16 v[48:51], v[132:135], v[176:179], v[48:51]
    ds_read2_b32 v[72:73], v21 offset0:192 offset1:193
    v_mfma_f32_16x16x32_bf16 v[52:55], v[132:135], v[180:183], v[52:55]
    ds_read2_b32 v[74:75], v21 offset0:194 offset1:195
    v_mfma_f32_16x16x32_bf16 v[56:59], v[132:135], v[184:187], v[56:59]
    ds_read_b128 v[104:107], v29 offset:2048
    v_mfma_f32_16x16x32_bf16 v[60:63], v[132:135], v[188:191], v[60:63]
    ds_read2_b32 v[76:77], v22 offset0:64 offset1:65
    v_mfma_f32_16x16x32_bf16 v[64:67], v[132:135], v[192:195], v[64:67]
    ds_read2_b32 v[78:79], v22 offset0:66 offset1:67
    v_mfma_f32_16x16x32_bf16 v[40:43], v[136:139], v[164:167], v[40:43]
    ds_read_b128 v[108:111], v29 offset:4096
    v_mfma_f32_16x16x32_bf16 v[44:47], v[136:139], v[168:171], v[44:47]
    ds_read2_b32 v[80:81], v22 offset0:192 offset1:193
    v_mfma_f32_16x16x32_bf16 v[48:51], v[136:139], v[172:175], v[48:51]
    ds_read2_b32 v[82:83], v22 offset0:194 offset1:195
    v_mfma_f32_16x16x32_bf16 v[52:55], v[136:139], v[176:179], v[52:55]
    ds_read_b128 v[112:115], v29 offset:6144
    v_mfma_f32_16x16x32_bf16 v[56:59], v[136:139], v[180:183], v[56:59]
    ds_read2_b32 v[84:85], v23 offset0:64 offset1:65
    v_mfma_f32_16x16x32_bf16 v[60:63], v[136:139], v[184:187], v[60:63]
    ds_read2_b32 v[86:87], v23 offset0:66 offset1:67
    v_mfma_f32_16x16x32_bf16 v[64:67], v[136:139], v[188:191], v[64:67]
    ds_read_b128 v[116:119], v29 offset:8192
    v_mfma_f32_16x16x32_bf16 v[44:47], v[140:143], v[164:167], v[44:47]
    ds_read2_b32 v[88:89], v23 offset0:192 offset1:193
    v_mfma_f32_16x16x32_bf16 v[48:51], v[140:143], v[168:171], v[48:51]
    ds_read2_b32 v[90:91], v23 offset0:194 offset1:195
    v_mfma_f32_16x16x32_bf16 v[52:55], v[140:143], v[172:175], v[52:55]
    ds_read_b128 v[120:123], v29 offset:10240
    v_mfma_f32_16x16x32_bf16 v[56:59], v[140:143], v[176:179], v[56:59]
    ds_read2_b32 v[92:93], v24 offset0:64 offset1:65
    v_mfma_f32_16x16x32_bf16 v[60:63], v[140:143], v[180:183], v[60:63]
    ds_read2_b32 v[94:95], v24 offset0:66 offset1:67
    v_mfma_f32_16x16x32_bf16 v[64:67], v[140:143], v[184:187], v[64:67]
    ds_read_b128 v[124:127], v29 offset:12288
    v_mfma_f32_16x16x32_bf16 v[48:51], v[144:147], v[164:167], v[48:51]
    ds_read2_b32 v[96:97], v24 offset0:192 offset1:193
    v_mfma_f32_16x16x32_bf16 v[52:55], v[144:147], v[168:171], v[52:55]
    ds_read2_b32 v[98:99], v24 offset0:194 offset1:195
    v_mfma_f32_16x16x32_bf16 v[56:59], v[144:147], v[172:175], v[56:59]
    ds_read_b128 v[128:131], v29 offset:14336
    v_mfma_f32_16x16x32_bf16 v[60:63], v[144:147], v[176:179], v[60:63]
    v_mfma_f32_16x16x32_bf16 v[64:67], v[144:147], v[180:183], v[64:67]
    v_mfma_f32_16x16x32_bf16 v[52:55], v[148:151], v[164:167], v[52:55]
    v_mfma_f32_16x16x32_bf16 v[56:59], v[148:151], v[168:171], v[56:59]
    v_mfma_f32_16x16x32_bf16 v[60:63], v[148:151], v[172:175], v[60:63]
    v_mfma_f32_16x16x32_bf16 v[64:67], v[148:151], v[176:179], v[64:67]
    v_mfma_f32_16x16x32_bf16 v[56:59], v[152:155], v[164:167], v[56:59]
    v_mfma_f32_16x16x32_bf16 v[60:63], v[152:155], v[168:171], v[60:63]
    v_mfma_f32_16x16x32_bf16 v[64:67], v[152:155], v[172:175], v[64:67]
    v_mfma_f32_16x16x32_bf16 v[60:63], v[156:159], v[164:167], v[60:63]
    v_mfma_f32_16x16x32_bf16 v[64:67], v[156:159], v[168:171], v[64:67]
    v_mfma_f32_16x16x32_bf16 v[64:67], v[160:163], v[164:167], v[64:67]
    s_waitcnt lgkmcnt(0)
    v_mfma_f32_16x16x32_bf16 v[36:39], v[68:71], v[100:103], v[36:39]
    ds_read2_b32 v[132:133], v21 offset0:80 offset1:81
    v_mfma_f32_16x16x32_bf16 v[40:43], v[68:71], v[104:107], v[40:43]
    ds_read2_b32 v[134:135], v21 offset0:82 offset1:83
    v_mfma_f32_16x16x32_bf16 v[44:47], v[68:71], v[108:111], v[44:47]
    ds_read_b128 v[164:167], v30 offset:0
    v_mfma_f32_16x16x32_bf16 v[48:51], v[68:71], v[112:115], v[48:51]
    ds_read2_b32 v[136:137], v21 offset0:208 offset1:209
    v_mfma_f32_16x16x32_bf16 v[52:55], v[68:71], v[116:119], v[52:55]
    ds_read2_b32 v[138:139], v21 offset0:210 offset1:211
    v_mfma_f32_16x16x32_bf16 v[56:59], v[68:71], v[120:123], v[56:59]
    ds_read_b128 v[168:171], v30 offset:2048
    v_mfma_f32_16x16x32_bf16 v[60:63], v[68:71], v[124:127], v[60:63]
    ds_read2_b32 v[140:141], v22 offset0:80 offset1:81
    v_mfma_f32_16x16x32_bf16 v[64:67], v[68:71], v[128:131], v[64:67]
    ds_read2_b32 v[142:143], v22 offset0:82 offset1:83
    v_mfma_f32_16x16x32_bf16 v[40:43], v[72:75], v[100:103], v[40:43]
    ds_read_b128 v[172:175], v30 offset:4096
    v_mfma_f32_16x16x32_bf16 v[44:47], v[72:75], v[104:107], v[44:47]
    ds_read2_b32 v[144:145], v22 offset0:208 offset1:209
    v_mfma_f32_16x16x32_bf16 v[48:51], v[72:75], v[108:111], v[48:51]
    ds_read2_b32 v[146:147], v22 offset0:210 offset1:211
    v_mfma_f32_16x16x32_bf16 v[52:55], v[72:75], v[112:115], v[52:55]
    ds_read_b128 v[176:179], v30 offset:6144
    v_mfma_f32_16x16x32_bf16 v[56:59], v[72:75], v[116:119], v[56:59]
    ds_read2_b32 v[148:149], v23 offset0:80 offset1:81
    v_mfma_f32_16x16x32_bf16 v[60:63], v[72:75], v[120:123], v[60:63]
    ds_read2_b32 v[150:151], v23 offset0:82 offset1:83
    v_mfma_f32_16x16x32_bf16 v[64:67], v[72:75], v[124:127], v[64:67]
    ds_read_b128 v[180:183], v30 offset:8192
    v_mfma_f32_16x16x32_bf16 v[44:47], v[76:79], v[100:103], v[44:47]
    ds_read2_b32 v[152:153], v23 offset0:208 offset1:209
    v_mfma_f32_16x16x32_bf16 v[48:51], v[76:79], v[104:107], v[48:51]
    ds_read2_b32 v[154:155], v23 offset0:210 offset1:211
    v_mfma_f32_16x16x32_bf16 v[52:55], v[76:79], v[108:111], v[52:55]
    ds_read_b128 v[184:187], v30 offset:10240
    v_mfma_f32_16x16x32_bf16 v[56:59], v[76:79], v[112:115], v[56:59]
    ds_read2_b32 v[156:157], v24 offset0:80 offset1:81
    v_mfma_f32_16x16x32_bf16 v[60:63], v[76:79], v[116:119], v[60:63]
    ds_read2_b32 v[158:159], v24 offset0:82 offset1:83
    v_mfma_f32_16x16x32_bf16 v[64:67], v[76:79], v[120:123], v[64:67]
    ds_read_b128 v[188:191], v30 offset:12288
    v_mfma_f32_16x16x32_bf16 v[48:51], v[80:83], v[100:103], v[48:51]
    ds_read2_b32 v[160:161], v24 offset0:208 offset1:209
    v_mfma_f32_16x16x32_bf16 v[52:55], v[80:83], v[104:107], v[52:55]
    ds_read2_b32 v[162:163], v24 offset0:210 offset1:211
    v_mfma_f32_16x16x32_bf16 v[56:59], v[80:83], v[108:111], v[56:59]
    ds_read_b128 v[192:195], v30 offset:14336
    v_mfma_f32_16x16x32_bf16 v[60:63], v[80:83], v[112:115], v[60:63]
    v_mfma_f32_16x16x32_bf16 v[64:67], v[80:83], v[116:119], v[64:67]
    v_mfma_f32_16x16x32_bf16 v[52:55], v[84:87], v[100:103], v[52:55]
    v_mfma_f32_16x16x32_bf16 v[56:59], v[84:87], v[104:107], v[56:59]
    v_mfma_f32_16x16x32_bf16 v[60:63], v[84:87], v[108:111], v[60:63]
    v_mfma_f32_16x16x32_bf16 v[64:67], v[84:87], v[112:115], v[64:67]
    v_mfma_f32_16x16x32_bf16 v[56:59], v[88:91], v[100:103], v[56:59]
    v_mfma_f32_16x16x32_bf16 v[60:63], v[88:91], v[104:107], v[60:63]
    v_mfma_f32_16x16x32_bf16 v[64:67], v[88:91], v[108:111], v[64:67]
    v_mfma_f32_16x16x32_bf16 v[60:63], v[92:95], v[100:103], v[60:63]
    v_mfma_f32_16x16x32_bf16 v[64:67], v[92:95], v[104:107], v[64:67]
    v_mfma_f32_16x16x32_bf16 v[64:67], v[96:99], v[100:103], v[64:67]
    s_waitcnt vmcnt(0)
    s_mov_b64 exec, 1
    ds_add_u32 v18, v19 offset:8
    s_mov_b64 exec, -1
    s_waitcnt lgkmcnt(0)
    v_mfma_f32_16x16x32_bf16 v[36:39], v[132:135], v[164:167], v[36:39]
    ds_read2_b32 v[68:69], v21 offset0:96 offset1:97
    v_mfma_f32_16x16x32_bf16 v[40:43], v[132:135], v[168:171], v[40:43]
    ds_read2_b32 v[70:71], v21 offset0:98 offset1:99
    v_mfma_f32_16x16x32_bf16 v[44:47], v[132:135], v[172:175], v[44:47]
    ds_read_b128 v[100:103], v31 offset:0
    v_mfma_f32_16x16x32_bf16 v[48:51], v[132:135], v[176:179], v[48:51]
    ds_read2_b32 v[72:73], v21 offset0:224 offset1:225
    v_mfma_f32_16x16x32_bf16 v[52:55], v[132:135], v[180:183], v[52:55]
    ds_read2_b32 v[74:75], v21 offset0:226 offset1:227
    v_mfma_f32_16x16x32_bf16 v[56:59], v[132:135], v[184:187], v[56:59]
    ds_read_b128 v[104:107], v31 offset:2048
    v_mfma_f32_16x16x32_bf16 v[60:63], v[132:135], v[188:191], v[60:63]
    ds_read2_b32 v[76:77], v22 offset0:96 offset1:97
    v_mfma_f32_16x16x32_bf16 v[64:67], v[132:135], v[192:195], v[64:67]
    ds_read2_b32 v[78:79], v22 offset0:98 offset1:99
    v_mfma_f32_16x16x32_bf16 v[40:43], v[136:139], v[164:167], v[40:43]
    ds_read_b128 v[108:111], v31 offset:4096
    v_mfma_f32_16x16x32_bf16 v[44:47], v[136:139], v[168:171], v[44:47]
    ds_read2_b32 v[80:81], v22 offset0:224 offset1:225
    v_mfma_f32_16x16x32_bf16 v[48:51], v[136:139], v[172:175], v[48:51]
    ds_read2_b32 v[82:83], v22 offset0:226 offset1:227
    v_mfma_f32_16x16x32_bf16 v[52:55], v[136:139], v[176:179], v[52:55]
    ds_read_b128 v[112:115], v31 offset:6144
    v_mfma_f32_16x16x32_bf16 v[56:59], v[136:139], v[180:183], v[56:59]
    ds_read2_b32 v[84:85], v23 offset0:96 offset1:97
    v_mfma_f32_16x16x32_bf16 v[60:63], v[136:139], v[184:187], v[60:63]
    ds_read2_b32 v[86:87], v23 offset0:98 offset1:99
    v_mfma_f32_16x16x32_bf16 v[64:67], v[136:139], v[188:191], v[64:67]
    ds_read_b128 v[116:119], v31 offset:8192
    v_mfma_f32_16x16x32_bf16 v[44:47], v[140:143], v[164:167], v[44:47]
    ds_read2_b32 v[88:89], v23 offset0:224 offset1:225
    v_mfma_f32_16x16x32_bf16 v[48:51], v[140:143], v[168:171], v[48:51]
    ds_read2_b32 v[90:91], v23 offset0:226 offset1:227
    v_mfma_f32_16x16x32_bf16 v[52:55], v[140:143], v[172:175], v[52:55]
    ds_read_b128 v[120:123], v31 offset:10240
    v_mfma_f32_16x16x32_bf16 v[56:59], v[140:143], v[176:179], v[56:59]
    ds_read2_b32 v[92:93], v24 offset0:96 offset1:97
    v_mfma_f32_16x16x32_bf16 v[60:63], v[140:143], v[180:183], v[60:63]
    ds_read2_b32 v[94:95], v24 offset0:98 offset1:99
    v_mfma_f32_16x16x32_bf16 v[64:67], v[140:143], v[184:187], v[64:67]
    ds_read_b128 v[124:127], v31 offset:12288
    v_mfma_f32_16x16x32_bf16 v[48:51], v[144:147], v[164:167], v[48:51]
    ds_read2_b32 v[96:97], v24 offset0:224 offset1:225
    v_mfma_f32_16x16x32_bf16 v[52:55], v[144:147], v[168:171], v[52:55]
    ds_read2_b32 v[98:99], v24 offset0:226 offset1:227
    v_mfma_f32_16x16x32_bf16 v[56:59], v[144:147], v[172:175], v[56:59]
    ds_read_b128 v[128:131], v31 offset:14336
    v_mfma_f32_16x16x32_bf16 v[60:63], v[144:147], v[176:179], v[60:63]
    v_mfma_f32_16x16x32_bf16 v[64:67], v[144:147], v[180:183], v[64:67]
    v_mfma_f32_16x16x32_bf16 v[52:55], v[148:151], v[164:167], v[52:55]
    v_mfma_f32_16x16x32_bf16 v[56:59], v[148:151], v[168:171], v[56:59]
    v_mfma_f32_16x16x32_bf16 v[60:63], v[148:151], v[172:175], v[60:63]
    v_mfma_f32_16x16x32_bf16 v[64:67], v[148:151], v[176:179], v[64:67]
    v_mfma_f32_16x16x32_bf16 v[56:59], v[152:155], v[164:167], v[56:59]
    v_mfma_f32_16x16x32_bf16 v[60:63], v[152:155], v[168:171], v[60:63]
    v_mfma_f32_16x16x32_bf16 v[64:67], v[152:155], v[172:175], v[64:67]
    v_mfma_f32_16x16x32_bf16 v[60:63], v[156:159], v[164:167], v[60:63]
    v_mfma_f32_16x16x32_bf16 v[64:67], v[156:159], v[168:171], v[64:67]
    v_mfma_f32_16x16x32_bf16 v[64:67], v[160:163], v[164:167], v[64:67]
    s_waitcnt lgkmcnt(0)
    v_mfma_f32_16x16x32_bf16 v[36:39], v[68:71], v[100:103], v[36:39]
    ds_read2_b32 v[132:133], v21 offset0:112 offset1:113
    v_mfma_f32_16x16x32_bf16 v[40:43], v[68:71], v[104:107], v[40:43]
    ds_read2_b32 v[134:135], v21 offset0:114 offset1:115
    v_mfma_f32_16x16x32_bf16 v[44:47], v[68:71], v[108:111], v[44:47]
    ds_read_b128 v[164:167], v32 offset:0
    v_mfma_f32_16x16x32_bf16 v[48:51], v[68:71], v[112:115], v[48:51]
    ds_read2_b32 v[136:137], v21 offset0:240 offset1:241
    v_mfma_f32_16x16x32_bf16 v[52:55], v[68:71], v[116:119], v[52:55]
    ds_read2_b32 v[138:139], v21 offset0:242 offset1:243
    v_mfma_f32_16x16x32_bf16 v[56:59], v[68:71], v[120:123], v[56:59]
    ds_read_b128 v[168:171], v32 offset:2048
    v_mfma_f32_16x16x32_bf16 v[60:63], v[68:71], v[124:127], v[60:63]
    ds_read2_b32 v[140:141], v22 offset0:112 offset1:113
    v_mfma_f32_16x16x32_bf16 v[64:67], v[68:71], v[128:131], v[64:67]
    ds_read2_b32 v[142:143], v22 offset0:114 offset1:115
    v_mfma_f32_16x16x32_bf16 v[40:43], v[72:75], v[100:103], v[40:43]
    ds_read_b128 v[172:175], v32 offset:4096
    v_mfma_f32_16x16x32_bf16 v[44:47], v[72:75], v[104:107], v[44:47]
    ds_read2_b32 v[144:145], v22 offset0:240 offset1:241
    v_mfma_f32_16x16x32_bf16 v[48:51], v[72:75], v[108:111], v[48:51]
    ds_read2_b32 v[146:147], v22 offset0:242 offset1:243
    v_mfma_f32_16x16x32_bf16 v[52:55], v[72:75], v[112:115], v[52:55]
    ds_read_b128 v[176:179], v32 offset:6144
    v_mfma_f32_16x16x32_bf16 v[56:59], v[72:75], v[116:119], v[56:59]
    ds_read2_b32 v[148:149], v23 offset0:112 offset1:113
    v_mfma_f32_16x16x32_bf16 v[60:63], v[72:75], v[120:123], v[60:63]
    ds_read2_b32 v[150:151], v23 offset0:114 offset1:115
    v_mfma_f32_16x16x32_bf16 v[64:67], v[72:75], v[124:127], v[64:67]
    ds_read_b128 v[180:183], v32 offset:8192
    v_mfma_f32_16x16x32_bf16 v[44:47], v[76:79], v[100:103], v[44:47]
    ds_read2_b32 v[152:153], v23 offset0:240 offset1:241
    v_mfma_f32_16x16x32_bf16 v[48:51], v[76:79], v[104:107], v[48:51]
    ds_read2_b32 v[154:155], v23 offset0:242 offset1:243
    v_mfma_f32_16x16x32_bf16 v[52:55], v[76:79], v[108:111], v[52:55]
    ds_read_b128 v[184:187], v32 offset:10240
    v_mfma_f32_16x16x32_bf16 v[56:59], v[76:79], v[112:115], v[56:59]
    ds_read2_b32 v[156:157], v24 offset0:112 offset1:113
    v_mfma_f32_16x16x32_bf16 v[60:63], v[76:79], v[116:119], v[60:63]
    ds_read2_b32 v[158:159], v24 offset0:114 offset1:115
    v_mfma_f32_16x16x32_bf16 v[64:67], v[76:79], v[120:123], v[64:67]
    ds_read_b128 v[188:191], v32 offset:12288
    v_mfma_f32_16x16x32_bf16 v[48:51], v[80:83], v[100:103], v[48:51]
    ds_read2_b32 v[160:161], v24 offset0:240 offset1:241
    v_mfma_f32_16x16x32_bf16 v[52:55], v[80:83], v[104:107], v[52:55]
    ds_read2_b32 v[162:163], v24 offset0:242 offset1:243
    v_mfma_f32_16x16x32_bf16 v[56:59], v[80:83], v[108:111], v[56:59]
    ds_read_b128 v[192:195], v32 offset:14336
    v_mfma_f32_16x16x32_bf16 v[60:63], v[80:83], v[112:115], v[60:63]
    v_mfma_f32_16x16x32_bf16 v[64:67], v[80:83], v[116:119], v[64:67]
    v_mfma_f32_16x16x32_bf16 v[52:55], v[84:87], v[100:103], v[52:55]
    v_mfma_f32_16x16x32_bf16 v[56:59], v[84:87], v[104:107], v[56:59]
    v_mfma_f32_16x16x32_bf16 v[60:63], v[84:87], v[108:111], v[60:63]
    v_mfma_f32_16x16x32_bf16 v[64:67], v[84:87], v[112:115], v[64:67]
    v_mfma_f32_16x16x32_bf16 v[56:59], v[88:91], v[100:103], v[56:59]
    v_mfma_f32_16x16x32_bf16 v[60:63], v[88:91], v[104:107], v[60:63]
    v_mfma_f32_16x16x32_bf16 v[64:67], v[88:91], v[108:111], v[64:67]
    v_mfma_f32_16x16x32_bf16 v[60:63], v[92:95], v[100:103], v[60:63]
    v_mfma_f32_16x16x32_bf16 v[64:67], v[92:95], v[104:107], v[64:67]
    v_mfma_f32_16x16x32_bf16 v[64:67], v[96:99], v[100:103], v[64:67]
    s_waitcnt lgkmcnt(0)
    v_mfma_f32_16x16x32_bf16 v[36:39], v[132:135], v[164:167], v[36:39]
    s_lshl_b32 s80, s3, 17
    v_mfma_f32_16x16x32_bf16 v[40:43], v[132:135], v[168:171], v[40:43]
    s_add_u32 m0, s94, 0
    v_mfma_f32_16x16x32_bf16 v[44:47], v[132:135], v[172:175], v[44:47]
    s_add_u32 s89, s80, 1572864
    v_mfma_f32_16x16x32_bf16 v[48:51], v[132:135], v[176:179], v[48:51]
    buffer_load_dwordx4 v17, s[64:67], s89 offen  lds
    v_mfma_f32_16x16x32_bf16 v[52:55], v[132:135], v[180:183], v[52:55]
    s_add_u32 m0, s94, 1024
    v_mfma_f32_16x16x32_bf16 v[56:59], v[132:135], v[184:187], v[56:59]
    s_add_u32 s89, s80, 1589248
    v_mfma_f32_16x16x32_bf16 v[60:63], v[132:135], v[188:191], v[60:63]
    buffer_load_dwordx4 v17, s[64:67], s89 offen  lds
    v_mfma_f32_16x16x32_bf16 v[64:67], v[132:135], v[192:195], v[64:67]
    s_add_u32 m0, s94, 2048
    v_mfma_f32_16x16x32_bf16 v[40:43], v[136:139], v[164:167], v[40:43]
    s_add_u32 s89, s80, 1605632
    v_mfma_f32_16x16x32_bf16 v[44:47], v[136:139], v[168:171], v[44:47]
    buffer_load_dwordx4 v17, s[64:67], s89 offen  lds
    v_mfma_f32_16x16x32_bf16 v[48:51], v[136:139], v[172:175], v[48:51]
    s_add_u32 m0, s94, 3072
    v_mfma_f32_16x16x32_bf16 v[52:55], v[136:139], v[176:179], v[52:55]
    s_add_u32 s89, s80, 1622016
    v_mfma_f32_16x16x32_bf16 v[56:59], v[136:139], v[180:183], v[56:59]
    buffer_load_dwordx4 v17, s[64:67], s89 offen  lds
    v_mfma_f32_16x16x32_bf16 v[60:63], v[136:139], v[184:187], v[60:63]
    s_add_u32 m0, s94, 4096
    v_mfma_f32_16x16x32_bf16 v[64:67], v[136:139], v[188:191], v[64:67]
    s_add_u32 s89, s80, 1638400
    v_mfma_f32_16x16x32_bf16 v[44:47], v[140:143], v[164:167], v[44:47]
    buffer_load_dwordx4 v17, s[64:67], s89 offen  lds
    v_mfma_f32_16x16x32_bf16 v[48:51], v[140:143], v[168:171], v[48:51]
    s_add_u32 m0, s94, 5120
    v_mfma_f32_16x16x32_bf16 v[52:55], v[140:143], v[172:175], v[52:55]
    s_add_u32 s89, s80, 1654784
    v_mfma_f32_16x16x32_bf16 v[56:59], v[140:143], v[176:179], v[56:59]
    buffer_load_dwordx4 v17, s[64:67], s89 offen  lds
    v_mfma_f32_16x16x32_bf16 v[60:63], v[140:143], v[180:183], v[60:63]
    s_add_u32 m0, s94, 6144
    v_mfma_f32_16x16x32_bf16 v[64:67], v[140:143], v[184:187], v[64:67]
    s_add_u32 s89, s80, 1671168
    v_mfma_f32_16x16x32_bf16 v[48:51], v[144:147], v[164:167], v[48:51]
    buffer_load_dwordx4 v17, s[64:67], s89 offen  lds
    v_mfma_f32_16x16x32_bf16 v[52:55], v[144:147], v[168:171], v[52:55]
    s_add_u32 m0, s94, 7168
    v_mfma_f32_16x16x32_bf16 v[56:59], v[144:147], v[172:175], v[56:59]
    s_add_u32 s89, s80, 1687552
    v_mfma_f32_16x16x32_bf16 v[60:63], v[144:147], v[176:179], v[60:63]
    buffer_load_dwordx4 v17, s[64:67], s89 offen  lds
    v_mfma_f32_16x16x32_bf16 v[64:67], v[144:147], v[180:183], v[64:67]
    ds_read_b64 v[196:197], v20 offset:0
    v_mfma_f32_16x16x32_bf16 v[52:55], v[148:151], v[164:167], v[52:55]
    ds_read_b64 v[198:199], v20 offset:2048
    v_mfma_f32_16x16x32_bf16 v[56:59], v[148:151], v[168:171], v[56:59]
    ds_read_b64 v[200:201], v20 offset:4096
    v_mfma_f32_16x16x32_bf16 v[60:63], v[148:151], v[172:175], v[60:63]
    ds_read_b64 v[202:203], v20 offset:6144
    v_mfma_f32_16x16x32_bf16 v[64:67], v[148:151], v[176:179], v[64:67]
    ds_read_b64 v[204:205], v20 offset:8192
    v_mfma_f32_16x16x32_bf16 v[56:59], v[152:155], v[164:167], v[56:59]
    ds_read_b64 v[206:207], v20 offset:10240
    v_mfma_f32_16x16x32_bf16 v[60:63], v[152:155], v[168:171], v[60:63]
    ds_read_b64 v[208:209], v20 offset:12288
    v_mfma_f32_16x16x32_bf16 v[64:67], v[152:155], v[172:175], v[64:67]
    ds_read_b64 v[210:211], v20 offset:14336
    v_mfma_f32_16x16x32_bf16 v[60:63], v[156:159], v[164:167], v[60:63]
    v_mfma_f32_16x16x32_bf16 v[64:67], v[156:159], v[168:171], v[64:67]
    v_mfma_f32_16x16x32_bf16 v[64:67], v[160:163], v[164:167], v[64:67]
    s_waitcnt lgkmcnt(7)
    v_lshlrev_b32 v71, 16, v196
    v_and_b32 v70, 0xffff0000, v196
    v_lshlrev_b32 v69, 16, v197
    v_and_b32 v68, 0xffff0000, v197
    v_fmac_f32 v36, s92, v68
    v_fmac_f32 v37, s92, v69
    v_fmac_f32 v38, s92, v70
    v_fmac_f32 v39, s92, v71
    v_cvt_pk_bf16_f32 v196, v39, v38
    v_cvt_pk_bf16_f32 v197, v37, v36
    ds_write_b64 v20, v[196:197] offset:0
    s_waitcnt lgkmcnt(7)
    v_lshlrev_b32 v75, 16, v198
    v_and_b32 v74, 0xffff0000, v198
    v_lshlrev_b32 v73, 16, v199
    v_and_b32 v72, 0xffff0000, v199
    v_fmac_f32 v40, s92, v72
    v_fmac_f32 v41, s92, v73
    v_fmac_f32 v42, s92, v74
    v_fmac_f32 v43, s92, v75
    v_cvt_pk_bf16_f32 v198, v43, v42
    v_cvt_pk_bf16_f32 v199, v41, v40
    ds_write_b64 v20, v[198:199] offset:2048
    s_waitcnt lgkmcnt(7)
    v_lshlrev_b32 v71, 16, v200
    v_and_b32 v70, 0xffff0000, v200
    v_lshlrev_b32 v69, 16, v201
    v_and_b32 v68, 0xffff0000, v201
    v_fmac_f32 v44, s92, v68
    v_fmac_f32 v45, s92, v69
    v_fmac_f32 v46, s92, v70
    v_fmac_f32 v47, s92, v71
    v_cvt_pk_bf16_f32 v200, v47, v46
    v_cvt_pk_bf16_f32 v201, v45, v44
    ds_write_b64 v20, v[200:201] offset:4096
    s_waitcnt lgkmcnt(7)
    v_lshlrev_b32 v75, 16, v202
    v_and_b32 v74, 0xffff0000, v202
    v_lshlrev_b32 v73, 16, v203
    v_and_b32 v72, 0xffff0000, v203
    v_fmac_f32 v48, s92, v72
    v_fmac_f32 v49, s92, v73
    v_fmac_f32 v50, s92, v74
    v_fmac_f32 v51, s92, v75
    v_cvt_pk_bf16_f32 v202, v51, v50
    v_cvt_pk_bf16_f32 v203, v49, v48
    ds_write_b64 v20, v[202:203] offset:6144
    s_waitcnt lgkmcnt(7)
    v_lshlrev_b32 v71, 16, v204
    v_and_b32 v70, 0xffff0000, v204
    v_lshlrev_b32 v69, 16, v205
    v_and_b32 v68, 0xffff0000, v205
    v_fmac_f32 v52, s92, v68
    v_fmac_f32 v53, s92, v69
    v_fmac_f32 v54, s92, v70
    v_fmac_f32 v55, s92, v71
    v_cvt_pk_bf16_f32 v204, v55, v54
    v_cvt_pk_bf16_f32 v205, v53, v52
    ds_write_b64 v20, v[204:205] offset:8192
    s_waitcnt lgkmcnt(7)
    v_lshlrev_b32 v75, 16, v206
    v_and_b32 v74, 0xffff0000, v206
    v_lshlrev_b32 v73, 16, v207
    v_and_b32 v72, 0xffff0000, v207
    v_fmac_f32 v56, s92, v72
    v_fmac_f32 v57, s92, v73
    v_fmac_f32 v58, s92, v74
    v_fmac_f32 v59, s92, v75
    v_cvt_pk_bf16_f32 v206, v59, v58
    v_cvt_pk_bf16_f32 v207, v57, v56
    ds_write_b64 v20, v[206:207] offset:10240
    s_waitcnt lgkmcnt(7)
    v_lshlrev_b32 v71, 16, v208
    v_and_b32 v70, 0xffff0000, v208
    v_lshlrev_b32 v69, 16, v209
    v_and_b32 v68, 0xffff0000, v209
    v_fmac_f32 v60, s92, v68
    v_fmac_f32 v61, s92, v69
    v_fmac_f32 v62, s92, v70
    v_fmac_f32 v63, s92, v71
    v_cvt_pk_bf16_f32 v208, v63, v62
    v_cvt_pk_bf16_f32 v209, v61, v60
    ds_write_b64 v20, v[208:209] offset:12288
    s_waitcnt lgkmcnt(7)
    v_lshlrev_b32 v75, 16, v210
    v_and_b32 v74, 0xffff0000, v210
    v_lshlrev_b32 v73, 16, v211
    v_and_b32 v72, 0xffff0000, v211
    v_fmac_f32 v64, s92, v72
    v_fmac_f32 v65, s92, v73
    v_fmac_f32 v66, s92, v74
    v_fmac_f32 v67, s92, v75
    v_cvt_pk_bf16_f32 v210, v67, v66
    v_cvt_pk_bf16_f32 v211, v65, v64
    ds_write_b64 v20, v[210:211] offset:14336
    s_mov_b64 exec, 1
    ds_add_u32 v18, v19 offset:12
    s_mov_b64 exec, -1
    s_add_u32 s80, s86, 94208
    v_add_u32 v5, s80, v15
LA_s3:
    ds_read_b32 v6, v18 offset:12
    ds_read_b128 v[76:79], v5 offset:0
    ds_read_b128 v[80:83], v5 offset:4096
    ds_read_b128 v[84:87], v5 offset:8192
    ds_read_b128 v[88:91], v5 offset:12288
    s_waitcnt lgkmcnt(0)
    v_readfirstlane_b32 s78, v6
    s_nop 0
    s_cmp_ge_u32 s78, 4
    s_cbranch_scc0 LA_s3
    s_add_u32 s89, s91, 4194304
    buffer_store_dwordx4 v[76:79], v14, s[52:55], s89 offen sc1
    s_add_u32 s89, s91, 4198400
    buffer_store_dwordx4 v[80:83], v14, s[52:55], s89 offen sc1
    s_add_u32 s89, s91, 4202496
    buffer_store_dwordx4 v[84:87], v14, s[52:55], s89 offen sc1
    s_add_u32 s89, s91, 4206592
    buffer_store_dwordx4 v[88:91], v14, s[52:55], s89 offen sc1
    buffer_load_dwordx4 v[116:119], v9, s[56:59], 0 offen offset:0 nt
    buffer_load_dwordx4 v[120:123], v9, s[56:59], 0 offen offset:2048 nt
    buffer_load_dwordx4 v[124:127], v9, s[56:59], s96 offen offset:0 nt
    buffer_load_dwordx4 v[128:131], v9, s[56:59], s96 offen offset:2048 nt
    s_waitcnt vmcnt(8)
    s_mov_b64 exec, 1
    ds_add_u32 v18, v19 offset:16
    s_mov_b64 exec, -1
    s_lshl_b32 s80, s74, 2
    s_add_u32 s81, s80, s3
    s_lshl_b32 s81, s81, 8
    s_lshl_b32 s82, s75, 2
    s_add_u32 s81, s81, s82
    s_add_u32 s81, s81, 12587008
    s_and_b32 s82, s75, 3
    s_add_u32 s80, s80, s82
    s_lshl_b32 s80, s80, 8
    s_add_u32 s80, s80, 12587008
    v_mov_b32 v5, 0
    v_and_b32 v7, 15, v0
    v_lshlrev_b32 v7, 2, v7
    s_waitcnt vmcnt(4)
    s_mov_b64 exec, 1
    buffer_store_dword v19, v5, s[52:55], s81 offen sc1
    s_mov_b64 exec, -1
    s_waitcnt vmcnt(4)
    v_lshlrev_b32 v132, 16, v116
    v_and_b32 v133, 0xffff0000, v116
    v_lshlrev_b32 v134, 16, v117
    v_and_b32 v135, 0xffff0000, v117
    v_lshlrev_b32 v136, 16, v118
    v_and_b32 v137, 0xffff0000, v118
    v_lshlrev_b32 v138, 16, v119
    v_and_b32 v139, 0xffff0000, v119
    s_waitcnt vmcnt(3)
    v_lshlrev_b32 v140, 16, v120
    v_and_b32 v141, 0xffff0000, v120
    v_lshlrev_b32 v142, 16, v121
    v_and_b32 v143, 0xffff0000, v121
    v_lshlrev_b32 v144, 16, v122
    v_and_b32 v145, 0xffff0000, v122
    v_lshlrev_b32 v146, 16, v123
    v_and_b32 v147, 0xffff0000, v123
    s_waitcnt vmcnt(2)
    v_lshlrev_b32 v148, 16, v124
    v_and_b32 v149, 0xffff0000, v124
    v_lshlrev_b32 v150, 16, v125
    v_and_b32 v151, 0xffff0000, v125
    v_lshlrev_b32 v152, 16, v126
    v_and_b32 v153, 0xffff0000, v126
    v_lshlrev_b32 v154, 16, v127
    v_and_b32 v155, 0xffff0000, v127
    s_waitcnt vmcnt(1)
    v_lshlrev_b32 v156, 16, v128
    v_and_b32 v157, 0xffff0000, v128
    v_lshlrev_b32 v158, 16, v129
    v_and_b32 v159, 0xffff0000, v129
    v_lshlrev_b32 v160, 16, v130
    v_and_b32 v161, 0xffff0000, v130
    v_lshlrev_b32 v162, 16, v131
    v_and_b32 v163, 0xffff0000, v131
    s_mov_b32 s79, 0
LA_py:
    buffer_load_dword v6, v7, s[52:55], s80 offen sc1
    s_add_u32 s79, s79, 1
    s_cmp_gt_u32 s79, 200000
    s_cbranch_scc1 LA_py_x
    s_waitcnt vmcnt(0)
    v_cmp_ne_u32 vcc, 1, v6
    s_cbranch_vccz LA_py_x
    s_sleep 2
    s_branch LA_py
LA_py_x:
    s_waitcnt vmcnt(0)
    s_mov_b32 s89, 4194304
    buffer_load_dwordx4 v[100:103], v12, s[52:55], s89 offen sc1
    s_mov_b32 s89, 4210688
    buffer_load_dwordx4 v[104:107], v12, s[52:55], s89 offen sc1
    s_mov_b32 s89, 4227072
    buffer_load_dwordx4 v[108:111], v12, s[52:55], s89 offen sc1
    s_mov_b32 s89, 4243456
    buffer_load_dwordx4 v[112:115], v12, s[52:55], s89 offen sc1
    s_waitcnt vmcnt(3)
    v_permlane32_swap_b32 v102, v100
    v_permlane32_swap_b32 v103, v101
    s_waitcnt vmcnt(2)
    v_permlane32_swap_b32 v106, v104
    v_permlane32_swap_b32 v107, v105
    s_waitcnt vmcnt(1)
    v_permlane32_swap_b32 v110, v108
    v_permlane32_swap_b32 v111, v109
    s_waitcnt vmcnt(0)
    v_permlane32_swap_b32 v114, v112
    v_permlane32_swap_b32 v115, v113
    v_and_b32 v68, 0xffff0000, v103
    v_and_b32 v69, 0xffff0000, v107
    v_and_b32 v70, 0xffff0000, v111
    v_and_b32 v71, 0xffff0000, v115
    v_and_b32 v72, 0xffff0000, v101
    v_and_b32 v73, 0xffff0000, v105
    v_and_b32 v74, 0xffff0000, v109
    v_and_b32 v75, 0xffff0000, v113
    v_mul_f32 v68, v68, v132
    v_mul_f32 v69, v69, v133
    v_mul_f32 v70, v70, v134
    v_mul_f32 v71, v71, v135
    v_mul_f32 v72, v72, v136
    v_mul_f32 v73, v73, v137
    v_mul_f32 v74, v74, v138
    v_mul_f32 v75, v75, v139
    v_cvt_pk_bf16_f32 v36, v68, v69
    v_cvt_pk_bf16_f32 v37, v70, v71
    v_cvt_pk_bf16_f32 v38, v72, v73
    v_cvt_pk_bf16_f32 v39, v74, v75
    s_mov_b32 s89, 0
    buffer_store_dwordx4 v[36:39], v13, s[60:63], s89 offen
    v_lshlrev_b32 v68, 16, v103
    v_lshlrev_b32 v69, 16, v107
    v_lshlrev_b32 v70, 16, v111
    v_lshlrev_b32 v71, 16, v115
    v_lshlrev_b32 v72, 16, v101
    v_lshlrev_b32 v73, 16, v105
    v_lshlrev_b32 v74, 16, v109
    v_lshlrev_b32 v75, 16, v113
    v_mul_f32 v68, v68, v140
    v_mul_f32 v69, v69, v141
    v_mul_f32 v70, v70, v142
    v_mul_f32 v71, v71, v143
    v_mul_f32 v72, v72, v144
    v_mul_f32 v73, v73, v145
    v_mul_f32 v74, v74, v146
    v_mul_f32 v75, v75, v147
    v_cvt_pk_bf16_f32 v40, v68, v69
    v_cvt_pk_bf16_f32 v41, v70, v71
    v_cvt_pk_bf16_f32 v42, v72, v73
    v_cvt_pk_bf16_f32 v43, v74, v75
    s_mov_b32 s89, 4096
    buffer_store_dwordx4 v[40:43], v13, s[60:63], s89 offen
    v_and_b32 v68, 0xffff0000, v102
    v_and_b32 v69, 0xffff0000, v106
    v_and_b32 v70, 0xffff0000, v110
    v_and_b32 v71, 0xffff0000, v114
    v_and_b32 v72, 0xffff0000, v100
    v_and_b32 v73, 0xffff0000, v104
    v_and_b32 v74, 0xffff0000, v108
    v_and_b32 v75, 0xffff0000, v112
    v_mul_f32 v68, v68, v148
    v_mul_f32 v69, v69, v149
    v_mul_f32 v70, v70, v150
    v_mul_f32 v71, v71, v151
    v_mul_f32 v72, v72, v152
    v_mul_f32 v73, v73, v153
    v_mul_f32 v74, v74, v154
    v_mul_f32 v75, v75, v155
    v_cvt_pk_bf16_f32 v44, v68, v69
    v_cvt_pk_bf16_f32 v45, v70, v71
    v_cvt_pk_bf16_f32 v46, v72, v73
    v_cvt_pk_bf16_f32 v47, v74, v75
    s_mov_b32 s89, 8192
    buffer_store_dwordx4 v[44:47], v13, s[60:63], s89 offen
    v_lshlrev_b32 v68, 16, v102
    v_lshlrev_b32 v69, 16, v106
    v_lshlrev_b32 v70, 16, v110
    v_lshlrev_b32 v71, 16, v114
    v_lshlrev_b32 v72, 16, v100
    v_lshlrev_b32 v73, 16, v104
    v_lshlrev_b32 v74, 16, v108
    v_lshlrev_b32 v75, 16, v112
    v_mul_f32 v68, v68, v156
    v_mul_f32 v69, v69, v157
    v_mul_f32 v70, v70, v158
    v_mul_f32 v71, v71, v159
    v_mul_f32 v72, v72, v160
    v_mul_f32 v73, v73, v161
    v_mul_f32 v74, v74, v162
    v_mul_f32 v75, v75, v163
    v_cvt_pk_bf16_f32 v48, v68, v69
    v_cvt_pk_bf16_f32 v49, v70, v71
    v_cvt_pk_bf16_f32 v50, v72, v73
    v_cvt_pk_bf16_f32 v51, v74, v75
    s_mov_b32 s89, 12288
    buffer_store_dwordx4 v[48:51], v13, s[60:63], s89 offen
    s_endpgm
L_B:
    s_setprio 2
    s_and_b32 s3, s3, 3
    s_lshr_b32 s86, s3, 1
    s_and_b32 s87, s3, 1
    v_mov_b32 v10, 162304
    v_mov_b32 v11, 1
    v_lshlrev_b32 v12, 4, v0
    v_lshl_add_u32 v13, v0, 2, v10
    v_mov_b32 v14, 0
    ds_write_b32 v13, v14
    s_lshl_b32 s78, s75, 2
    s_lshl_b32 s96, s74, 8
    s_add_u32 s96, s96, 12582912
    s_add_u32 s79, s96, s78
    s_lshl_b32 s80, s74, 2
    s_add_u32 s80, s80, s3
    s_lshl_b32 s80, s80, 8
    s_add_u32 s80, s80, s78
    s_add_u32 s80, s80, 12587008
    s_lshl_b32 s81, s72, 1
    s_add_u32 s81, s81, s86
    s_lshl_b32 s81, s81, 8
    s_lshl_b32 s82, s73, 1
    s_add_u32 s82, s82, s87
    s_lshl_b32 s78, s82, 2
    s_add_u32 s81, s81, s78
    s_add_u32 s81, s81, 12603392
    v_mov_b32 v221, s79
    v_writelane_b32 v221, s80, 1
    v_writelane_b32 v221, s81, 2
    s_lshl_b32 s78, s72, 1
    s_add_u32 s78, s78, s86
    s_lshl_b32 s78, s78, 7
    s_add_u32 s78, s78, s82
    s_lshl_b32 s94, s78, 10
    s_add_u32 s94, s94, 8388608
    s_waitcnt lgkmcnt(0)
    s_mov_b32 s52, s26
    s_mov_b32 s53, s27
    s_mov_b32 s54, 0x1000000
    s_mov_b32 s55, 0x20000
    s_mov_b32 s68, s24
    s_mov_b32 s69, s25
    s_mov_b32 s70, 0x100
    s_mov_b32 s71, 0x20000
    s_mov_b32 s60, s22
    s_mov_b32 s61, s23
    s_mov_b32 s62, 0x800000
    s_mov_b32 s63, 0x20000
    s_mov_b64 exec, 7
    buffer_store_dword v14, v221, s[52:55], 0 offen sc1
    s_mov_b64 exec, -1
    s_getpc_b64 s[80:81]
LB_pc:
    s_sub_u32 s80, s80, LB_pc-concat_heads__ssm_conv_h3__sliding_local_dilated__prompt_kernel
    s_subb_u32 s81, s81, 0
    s_lshr_b32 s78, s2, 3
    s_and_b32 s78, s78, 7
    s_lshl_b32 s78, s78, 2
    s_add_u32 s78, s78, s3
    v_lshlrev_b32 v13, 5, v0
    v_add_u32 v13, s78, v13
    v_lshlrev_b32 v13, 7, v13
    v_cmp_gt_u32 vcc, L_end-concat_heads__ssm_conv_h3__sliding_local_dilated__prompt_kernel, v13
    s_nop 0
    s_and_saveexec_b64 s[82:83], vcc
    global_load_dword v222, v13, s[80:81]
    s_mov_b64 exec, -1
    v_and_b32 v13, 15, v0
    v_lshrrev_b32 v14, 4, v0
    v_lshrrev_b32 v15, 1, v13
    v_xor_b32 v15, v15, v14
    v_lshlrev_b32 v15, 4, v15
    v_lshl_add_u32 v15, v13, 7, v15
    v_add_u32 v2, 73728, v15
    v_xor_b32 v3, 64, v2
    s_lshl_b32 s78, s86, 13
    s_add_u32 s78, s78, 2048
    v_add_u32 v4, s78, v2
    v_add_u32 v5, s78, v3
    v_bfe_u32 v15, v0, 3, 2
    s_lshl_b32 s78, s87, 1
    s_add_u32 s78, s78, s86
    v_xor_b32 v15, s78, v15
    v_lshlrev_b32 v15, 5, v15
    v_and_b32 v223, 3, v0
    v_lshl_add_u32 v15, v223, 3, v15
    v_bfe_u32 v223, v0, 2, 2
    v_lshl_add_u32 v15, v223, 7, v15
    v_lshl_add_u32 v6, v14, 10, v15
    v_xor_b32 v7, 32, v6
    v_add_u32 v8, 49152, v6
    v_add_u32 v9, 49152, v7
    v_and_b32 v15, 1, v13
    v_cmp_eq_u32 s[88:89], 1, v15
    v_lshl_add_u32 v15, v14, 2, v15
    v_cmp_le_u32 s[90:91], v15, v13
    v_add_u32 v15, 2, v15
    v_cmp_le_u32 s[92:93], v15, v13
    v_mov_b32 v212, 0x0c0c0c0c
    v_mov_b32 v15, 0xc0c0100
    v_mov_b32 v223, 0x1000c0c
    v_cndmask_b32 v15, v15, v223, s[88:89]
    v_cndmask_b32 v208, v15, v212, s[90:91]
    v_cndmask_b32 v210, v212, v15, s[90:91]
    v_mov_b32 v15, 0xc0c0302
    v_mov_b32 v223, 0x3020c0c
    v_cndmask_b32 v15, v15, v223, s[88:89]
    v_cndmask_b32 v209, v15, v212, s[92:93]
    v_cndmask_b32 v211, v212, v15, s[92:93]
    s_or_b32 s78, s72, s86
    s_cmp_eq_u32 s78, 0
    s_cselect_b32 s78, 0xf149f2ca, 0
    v_mov_b32 v212, s78
    v_mov_b32 v213, s78
    v_mov_b32 v214, s78
    v_mov_b32 v215, s78
    s_lshl_b32 s78, s87, 12
    s_add_u32 s78, s78, 110592
    s_lshl_b32 s79, s86, 9
    s_add_u32 s79, s79, s78
    v_lshlrev_b32 v15, 3, v0
    v_add_u32 v216, s79, v15
    s_lshl_b32 s80, s86, 11
    v_add_u32 v218, s80, v216
    v_xor_b32 v219, 512, v218
    s_add_u32 s78, s78, 2048
    s_cmp_eq_u32 s86, 0
    s_cselect_b32 s78, s78, 118784
    v_add_u32 v217, s78, v15
    s_waitcnt lgkmcnt(0)
    s_barrier
    ds_read_b128 v[120:123], v4 offset:0
    ds_read_b128 v[124:127], v4 offset:2048
    ds_read_b128 v[128:131], v4 offset:4096
    ds_read_b128 v[132:135], v4 offset:6144
    ds_read_b128 v[136:139], v2 offset:0
    ds_read_b64_tr_b16 v[140:141], v6 offset:0
    ds_read_b64_tr_b16 v[142:143], v6 offset:512
    ds_read_b64_tr_b16 v[144:145], v7 offset:0
    ds_read_b64_tr_b16 v[146:147], v7 offset:512
    ds_read_b64_tr_b16 v[148:149], v6 offset:24576
    ds_read_b64_tr_b16 v[150:151], v6 offset:25088
    ds_read_b64_tr_b16 v[152:153], v7 offset:24576
    ds_read_b64_tr_b16 v[154:155], v7 offset:25088
    ds_read_b64_tr_b16 v[156:157], v8 offset:0
    ds_read_b64_tr_b16 v[158:159], v8 offset:512
    ds_read_b64_tr_b16 v[160:161], v9 offset:0
    ds_read_b64_tr_b16 v[162:163], v9 offset:512
    s_waitcnt lgkmcnt(0)
    v_mfma_f32_16x16x32_bf16 v[112:115], v[148:151], v[136:139], 0
    ds_read_b128 v[164:167], v5 offset:0
    v_mfma_f32_16x16x32_bf16 v[116:119], v[136:139], v[156:159], 0
    ds_read_b128 v[168:171], v5 offset:2048
    v_mfma_f32_16x16x32_bf16 v[72:75], v[148:151], v[132:135], 0
    ds_read_b128 v[172:175], v5 offset:4096
    v_mfma_f32_16x16x32_bf16 v[76:79], v[152:155], v[132:135], 0
    ds_read_b128 v[176:179], v5 offset:6144
    v_mfma_f32_16x16x32_bf16 v[104:107], v[132:135], v[156:159], 0
    ds_read_b128 v[180:183], v3 offset:0
    v_mfma_f32_16x16x32_bf16 v[108:111], v[132:135], v[160:163], 0
    ds_read_b64_tr_b16 v[184:185], v6 offset:4096
    v_mfma_f32_16x16x32_bf16 v[40:43], v[140:143], v[132:135], 0
    ds_read_b64_tr_b16 v[186:187], v6 offset:4608
    v_mfma_f32_16x16x32_bf16 v[44:47], v[144:147], v[132:135], 0
    ds_read_b64_tr_b16 v[188:189], v7 offset:4096
    v_mfma_f32_16x16x32_bf16 v[64:67], v[148:151], v[128:131], 0
    ds_read_b64_tr_b16 v[190:191], v7 offset:4608
    v_mfma_f32_16x16x32_bf16 v[68:71], v[152:155], v[128:131], 0
    ds_read_b64_tr_b16 v[192:193], v6 offset:28672
    v_mfma_f32_16x16x32_bf16 v[32:35], v[140:143], v[128:131], 0
    ds_read_b64_tr_b16 v[194:195], v6 offset:29184
    v_mfma_f32_16x16x32_bf16 v[36:39], v[144:147], v[128:131], 0
    ds_read_b64_tr_b16 v[196:197], v7 offset:28672
    v_mfma_f32_16x16x32_bf16 v[56:59], v[148:151], v[124:127], 0
    ds_read_b64_tr_b16 v[198:199], v7 offset:29184
    v_mfma_f32_16x16x32_bf16 v[60:63], v[152:155], v[124:127], 0
    ds_read_b64_tr_b16 v[200:201], v8 offset:4096
    v_mfma_f32_16x16x32_bf16 v[24:27], v[140:143], v[124:127], 0
    ds_read_b64_tr_b16 v[202:203], v8 offset:4608
    v_mfma_f32_16x16x32_bf16 v[28:31], v[144:147], v[124:127], 0
    ds_read_b64_tr_b16 v[204:205], v9 offset:4096
    v_mfma_f32_16x16x32_bf16 v[48:51], v[148:151], v[120:123], 0
    ds_read_b64_tr_b16 v[206:207], v9 offset:4608
    v_mfma_f32_16x16x32_bf16 v[52:55], v[152:155], v[120:123], 0
    v_mfma_f32_16x16x32_bf16 v[16:19], v[140:143], v[120:123], 0
    v_mfma_f32_16x16x32_bf16 v[20:23], v[144:147], v[120:123], 0
    v_mfma_f32_16x16x32_bf16 v[96:99], v[128:131], v[156:159], 0
    v_mfma_f32_16x16x32_bf16 v[100:103], v[128:131], v[160:163], 0
    v_mfma_f32_16x16x32_bf16 v[88:91], v[124:127], v[156:159], 0
    v_mfma_f32_16x16x32_bf16 v[92:95], v[124:127], v[160:163], 0
    v_mfma_f32_16x16x32_bf16 v[80:83], v[120:123], v[156:159], 0
    v_mfma_f32_16x16x32_bf16 v[84:87], v[120:123], v[160:163], 0
    s_waitcnt vmcnt(0)
    s_waitcnt lgkmcnt(0)
    s_barrier
    s_cmp_lg_u32 s3, 0
    s_cbranch_scc1 LB_sk1
    s_mov_b64 exec, 1
    s_and_b32 s78, s2, 1
    s_lshl_b32 s78, s78, 7
    v_mov_b32 v223, s78
    buffer_atomic_add v11, v223, s[68:71], 0 offen sc1
    s_mov_b64 exec, -1
LB_sk1:
    v_mfma_f32_16x16x32_bf16 v[112:115], v[192:195], v[180:183], v[112:115]
    ds_read_b128 v[120:123], v4 offset:18432
    v_mfma_f32_16x16x32_bf16 v[116:119], v[180:183], v[200:203], v[116:119]
    ds_read_b128 v[124:127], v4 offset:20480
    v_mfma_f32_16x16x32_bf16 v[72:75], v[192:195], v[176:179], v[72:75]
    ds_read_b128 v[128:131], v4 offset:22528
    v_mfma_f32_16x16x32_bf16 v[76:79], v[196:199], v[176:179], v[76:79]
    ds_read_b128 v[132:135], v4 offset:24576
    v_mfma_f32_16x16x32_bf16 v[104:107], v[176:179], v[200:203], v[104:107]
    ds_read_b128 v[136:139], v2 offset:18432
    v_mfma_f32_16x16x32_bf16 v[108:111], v[176:179], v[204:207], v[108:111]
    ds_read_b64_tr_b16 v[140:141], v6 offset:8192
    v_mfma_f32_16x16x32_bf16 v[40:43], v[184:187], v[176:179], v[40:43]
    ds_read_b64_tr_b16 v[142:143], v6 offset:8704
    v_mfma_f32_16x16x32_bf16 v[44:47], v[188:191], v[176:179], v[44:47]
    ds_read_b64_tr_b16 v[144:145], v7 offset:8192
    v_mfma_f32_16x16x32_bf16 v[64:67], v[192:195], v[172:175], v[64:67]
    ds_read_b64_tr_b16 v[146:147], v7 offset:8704
    v_mfma_f32_16x16x32_bf16 v[68:71], v[196:199], v[172:175], v[68:71]
    ds_read_b64_tr_b16 v[148:149], v6 offset:32768
    v_mfma_f32_16x16x32_bf16 v[32:35], v[184:187], v[172:175], v[32:35]
    ds_read_b64_tr_b16 v[150:151], v6 offset:33280
    v_mfma_f32_16x16x32_bf16 v[36:39], v[188:191], v[172:175], v[36:39]
    ds_read_b64_tr_b16 v[152:153], v7 offset:32768
    v_mfma_f32_16x16x32_bf16 v[56:59], v[192:195], v[168:171], v[56:59]
    ds_read_b64_tr_b16 v[154:155], v7 offset:33280
    v_mfma_f32_16x16x32_bf16 v[60:63], v[196:199], v[168:171], v[60:63]
    ds_read_b64_tr_b16 v[156:157], v8 offset:8192
    v_mfma_f32_16x16x32_bf16 v[24:27], v[184:187], v[168:171], v[24:27]
    ds_read_b64_tr_b16 v[158:159], v8 offset:8704
    v_mfma_f32_16x16x32_bf16 v[28:31], v[188:191], v[168:171], v[28:31]
    ds_read_b64_tr_b16 v[160:161], v9 offset:8192
    v_mfma_f32_16x16x32_bf16 v[48:51], v[192:195], v[164:167], v[48:51]
    ds_read_b64_tr_b16 v[162:163], v9 offset:8704
    v_mfma_f32_16x16x32_bf16 v[52:55], v[196:199], v[164:167], v[52:55]
    v_mfma_f32_16x16x32_bf16 v[16:19], v[184:187], v[164:167], v[16:19]
    v_mfma_f32_16x16x32_bf16 v[20:23], v[188:191], v[164:167], v[20:23]
    v_mfma_f32_16x16x32_bf16 v[96:99], v[172:175], v[200:203], v[96:99]
    v_mfma_f32_16x16x32_bf16 v[100:103], v[172:175], v[204:207], v[100:103]
    v_mfma_f32_16x16x32_bf16 v[88:91], v[168:171], v[200:203], v[88:91]
    v_mfma_f32_16x16x32_bf16 v[92:95], v[168:171], v[204:207], v[92:95]
    v_mfma_f32_16x16x32_bf16 v[80:83], v[164:167], v[200:203], v[80:83]
    v_mfma_f32_16x16x32_bf16 v[84:87], v[164:167], v[204:207], v[84:87]
    s_waitcnt lgkmcnt(0)
    v_mfma_f32_16x16x32_bf16 v[112:115], v[148:151], v[136:139], v[112:115]
    ds_read_b128 v[164:167], v5 offset:18432
    v_mfma_f32_16x16x32_bf16 v[116:119], v[136:139], v[156:159], v[116:119]
    ds_read_b128 v[168:171], v5 offset:20480
    v_mfma_f32_16x16x32_bf16 v[72:75], v[148:151], v[132:135], v[72:75]
    ds_read_b128 v[172:175], v5 offset:22528
    v_mfma_f32_16x16x32_bf16 v[76:79], v[152:155], v[132:135], v[76:79]
    ds_read_b128 v[176:179], v5 offset:24576
    v_mfma_f32_16x16x32_bf16 v[104:107], v[132:135], v[156:159], v[104:107]
    ds_read_b128 v[180:183], v3 offset:18432
    v_mfma_f32_16x16x32_bf16 v[108:111], v[132:135], v[160:163], v[108:111]
    ds_read_b64_tr_b16 v[184:185], v6 offset:12288
    v_mfma_f32_16x16x32_bf16 v[40:43], v[140:143], v[132:135], v[40:43]
    ds_read_b64_tr_b16 v[186:187], v6 offset:12800
    v_mfma_f32_16x16x32_bf16 v[44:47], v[144:147], v[132:135], v[44:47]
    ds_read_b64_tr_b16 v[188:189], v7 offset:12288
    v_mfma_f32_16x16x32_bf16 v[64:67], v[148:151], v[128:131], v[64:67]
    ds_read_b64_tr_b16 v[190:191], v7 offset:12800
    v_mfma_f32_16x16x32_bf16 v[68:71], v[152:155], v[128:131], v[68:71]
    ds_read_b64_tr_b16 v[192:193], v6 offset:36864
    v_mfma_f32_16x16x32_bf16 v[32:35], v[140:143], v[128:131], v[32:35]
    ds_read_b64_tr_b16 v[194:195], v6 offset:37376
    v_mfma_f32_16x16x32_bf16 v[36:39], v[144:147], v[128:131], v[36:39]
    ds_read_b64_tr_b16 v[196:197], v7 offset:36864
    v_mfma_f32_16x16x32_bf16 v[56:59], v[148:151], v[124:127], v[56:59]
    ds_read_b64_tr_b16 v[198:199], v7 offset:37376
    v_mfma_f32_16x16x32_bf16 v[60:63], v[152:155], v[124:127], v[60:63]
    ds_read_b64_tr_b16 v[200:201], v8 offset:12288
    v_mfma_f32_16x16x32_bf16 v[24:27], v[140:143], v[124:127], v[24:27]
    ds_read_b64_tr_b16 v[202:203], v8 offset:12800
    v_mfma_f32_16x16x32_bf16 v[28:31], v[144:147], v[124:127], v[28:31]
    ds_read_b64_tr_b16 v[204:205], v9 offset:12288
    v_mfma_f32_16x16x32_bf16 v[48:51], v[148:151], v[120:123], v[48:51]
    ds_read_b64_tr_b16 v[206:207], v9 offset:12800
    v_mfma_f32_16x16x32_bf16 v[52:55], v[152:155], v[120:123], v[52:55]
    v_mfma_f32_16x16x32_bf16 v[16:19], v[140:143], v[120:123], v[16:19]
    v_mfma_f32_16x16x32_bf16 v[20:23], v[144:147], v[120:123], v[20:23]
    v_mfma_f32_16x16x32_bf16 v[96:99], v[128:131], v[156:159], v[96:99]
    v_mfma_f32_16x16x32_bf16 v[100:103], v[128:131], v[160:163], v[100:103]
    v_mfma_f32_16x16x32_bf16 v[88:91], v[124:127], v[156:159], v[88:91]
    v_mfma_f32_16x16x32_bf16 v[92:95], v[124:127], v[160:163], v[92:95]
    v_mfma_f32_16x16x32_bf16 v[80:83], v[120:123], v[156:159], v[80:83]
    v_mfma_f32_16x16x32_bf16 v[84:87], v[120:123], v[160:163], v[84:87]
    s_waitcnt lgkmcnt(0)
    s_barrier
    v_mfma_f32_16x16x32_bf16 v[112:115], v[192:195], v[180:183], v[112:115]
    ds_read_b128 v[120:123], v4 offset:36864
    v_mfma_f32_16x16x32_bf16 v[116:119], v[180:183], v[200:203], v[116:119]
    ds_read_b128 v[124:127], v4 offset:38912
    v_mfma_f32_16x16x32_bf16 v[72:75], v[192:195], v[176:179], v[72:75]
    ds_read_b128 v[128:131], v4 offset:40960
    v_mfma_f32_16x16x32_bf16 v[76:79], v[196:199], v[176:179], v[76:79]
    ds_read_b128 v[132:135], v4 offset:43008
    v_mfma_f32_16x16x32_bf16 v[104:107], v[176:179], v[200:203], v[104:107]
    ds_read_b128 v[136:139], v2 offset:36864
    v_mfma_f32_16x16x32_bf16 v[108:111], v[176:179], v[204:207], v[108:111]
    ds_read_b64_tr_b16 v[140:141], v6 offset:16384
    v_mfma_f32_16x16x32_bf16 v[40:43], v[184:187], v[176:179], v[40:43]
    ds_read_b64_tr_b16 v[142:143], v6 offset:16896
    v_mfma_f32_16x16x32_bf16 v[44:47], v[188:191], v[176:179], v[44:47]
    ds_read_b64_tr_b16 v[144:145], v7 offset:16384
    v_mfma_f32_16x16x32_bf16 v[64:67], v[192:195], v[172:175], v[64:67]
    ds_read_b64_tr_b16 v[146:147], v7 offset:16896
    v_mfma_f32_16x16x32_bf16 v[68:71], v[196:199], v[172:175], v[68:71]
    ds_read_b64_tr_b16 v[148:149], v6 offset:40960
    v_mfma_f32_16x16x32_bf16 v[32:35], v[184:187], v[172:175], v[32:35]
    ds_read_b64_tr_b16 v[150:151], v6 offset:41472
    v_mfma_f32_16x16x32_bf16 v[36:39], v[188:191], v[172:175], v[36:39]
    ds_read_b64_tr_b16 v[152:153], v7 offset:40960
    v_mfma_f32_16x16x32_bf16 v[56:59], v[192:195], v[168:171], v[56:59]
    ds_read_b64_tr_b16 v[154:155], v7 offset:41472
    v_mfma_f32_16x16x32_bf16 v[60:63], v[196:199], v[168:171], v[60:63]
    ds_read_b64_tr_b16 v[156:157], v8 offset:16384
    v_mfma_f32_16x16x32_bf16 v[24:27], v[184:187], v[168:171], v[24:27]
    ds_read_b64_tr_b16 v[158:159], v8 offset:16896
    v_mfma_f32_16x16x32_bf16 v[28:31], v[188:191], v[168:171], v[28:31]
    ds_read_b64_tr_b16 v[160:161], v9 offset:16384
    v_mfma_f32_16x16x32_bf16 v[48:51], v[192:195], v[164:167], v[48:51]
    ds_read_b64_tr_b16 v[162:163], v9 offset:16896
    v_mfma_f32_16x16x32_bf16 v[52:55], v[196:199], v[164:167], v[52:55]
    v_mfma_f32_16x16x32_bf16 v[16:19], v[184:187], v[164:167], v[16:19]
    v_mfma_f32_16x16x32_bf16 v[20:23], v[188:191], v[164:167], v[20:23]
    v_mfma_f32_16x16x32_bf16 v[96:99], v[172:175], v[200:203], v[96:99]
    v_mfma_f32_16x16x32_bf16 v[100:103], v[172:175], v[204:207], v[100:103]
    v_mfma_f32_16x16x32_bf16 v[88:91], v[168:171], v[200:203], v[88:91]
    v_mfma_f32_16x16x32_bf16 v[92:95], v[168:171], v[204:207], v[92:95]
    v_mfma_f32_16x16x32_bf16 v[80:83], v[164:167], v[200:203], v[80:83]
    v_mfma_f32_16x16x32_bf16 v[84:87], v[164:167], v[204:207], v[84:87]
    s_waitcnt lgkmcnt(0)
    v_mfma_f32_16x16x32_bf16 v[112:115], v[148:151], v[136:139], v[112:115]
    ds_read_b128 v[164:167], v5 offset:36864
    v_mfma_f32_16x16x32_bf16 v[116:119], v[136:139], v[156:159], v[116:119]
    ds_read_b128 v[168:171], v5 offset:38912
    v_mfma_f32_16x16x32_bf16 v[72:75], v[148:151], v[132:135], v[72:75]
    ds_read_b128 v[172:175], v5 offset:40960
    v_mfma_f32_16x16x32_bf16 v[76:79], v[152:155], v[132:135], v[76:79]
    ds_read_b128 v[176:179], v5 offset:43008
    v_mfma_f32_16x16x32_bf16 v[104:107], v[132:135], v[156:159], v[104:107]
    ds_read_b128 v[180:183], v3 offset:36864
    v_mfma_f32_16x16x32_bf16 v[108:111], v[132:135], v[160:163], v[108:111]
    ds_read_b64_tr_b16 v[184:185], v6 offset:20480
    v_mfma_f32_16x16x32_bf16 v[40:43], v[140:143], v[132:135], v[40:43]
    ds_read_b64_tr_b16 v[186:187], v6 offset:20992
    v_mfma_f32_16x16x32_bf16 v[44:47], v[144:147], v[132:135], v[44:47]
    ds_read_b64_tr_b16 v[188:189], v7 offset:20480
    v_mfma_f32_16x16x32_bf16 v[64:67], v[148:151], v[128:131], v[64:67]
    ds_read_b64_tr_b16 v[190:191], v7 offset:20992
    v_mfma_f32_16x16x32_bf16 v[68:71], v[152:155], v[128:131], v[68:71]
    ds_read_b64_tr_b16 v[192:193], v6 offset:45056
    v_mfma_f32_16x16x32_bf16 v[32:35], v[140:143], v[128:131], v[32:35]
    ds_read_b64_tr_b16 v[194:195], v6 offset:45568
    v_mfma_f32_16x16x32_bf16 v[36:39], v[144:147], v[128:131], v[36:39]
    ds_read_b64_tr_b16 v[196:197], v7 offset:45056
    v_mfma_f32_16x16x32_bf16 v[56:59], v[148:151], v[124:127], v[56:59]
    ds_read_b64_tr_b16 v[198:199], v7 offset:45568
    v_mfma_f32_16x16x32_bf16 v[60:63], v[152:155], v[124:127], v[60:63]
    ds_read_b64_tr_b16 v[200:201], v8 offset:20480
    v_mfma_f32_16x16x32_bf16 v[24:27], v[140:143], v[124:127], v[24:27]
    ds_read_b64_tr_b16 v[202:203], v8 offset:20992
    v_mfma_f32_16x16x32_bf16 v[28:31], v[144:147], v[124:127], v[28:31]
    ds_read_b64_tr_b16 v[204:205], v9 offset:20480
    v_mfma_f32_16x16x32_bf16 v[48:51], v[148:151], v[120:123], v[48:51]
    ds_read_b64_tr_b16 v[206:207], v9 offset:20992
    v_mfma_f32_16x16x32_bf16 v[52:55], v[152:155], v[120:123], v[52:55]
    v_mfma_f32_16x16x32_bf16 v[16:19], v[140:143], v[120:123], v[16:19]
    v_mfma_f32_16x16x32_bf16 v[20:23], v[144:147], v[120:123], v[20:23]
    v_mfma_f32_16x16x32_bf16 v[96:99], v[128:131], v[156:159], v[96:99]
    v_mfma_f32_16x16x32_bf16 v[100:103], v[128:131], v[160:163], v[100:103]
    v_mfma_f32_16x16x32_bf16 v[88:91], v[124:127], v[156:159], v[88:91]
    v_mfma_f32_16x16x32_bf16 v[92:95], v[124:127], v[160:163], v[92:95]
    v_mfma_f32_16x16x32_bf16 v[80:83], v[120:123], v[156:159], v[80:83]
    v_mfma_f32_16x16x32_bf16 v[84:87], v[120:123], v[160:163], v[84:87]
    s_waitcnt lgkmcnt(0)
    s_barrier
    v_mfma_f32_16x16x32_bf16 v[112:115], v[192:195], v[180:183], v[112:115]
    ds_read_b128 v[120:123], v4 offset:0
    v_mfma_f32_16x16x32_bf16 v[116:119], v[180:183], v[200:203], v[116:119]
    ds_read_b128 v[124:127], v4 offset:2048
    v_mfma_f32_16x16x32_bf16 v[72:75], v[192:195], v[176:179], v[72:75]
    ds_read_b128 v[128:131], v4 offset:4096
    v_mfma_f32_16x16x32_bf16 v[76:79], v[196:199], v[176:179], v[76:79]
    ds_read_b128 v[132:135], v4 offset:6144
    v_mfma_f32_16x16x32_bf16 v[104:107], v[176:179], v[200:203], v[104:107]
    ds_read_b128 v[136:139], v2 offset:0
    v_mfma_f32_16x16x32_bf16 v[108:111], v[176:179], v[204:207], v[108:111]
    ds_read_b64_tr_b16 v[140:141], v6 offset:0
    v_mfma_f32_16x16x32_bf16 v[40:43], v[184:187], v[176:179], v[40:43]
    ds_read_b64_tr_b16 v[142:143], v6 offset:512
    v_mfma_f32_16x16x32_bf16 v[44:47], v[188:191], v[176:179], v[44:47]
    ds_read_b64_tr_b16 v[144:145], v7 offset:0
    v_mfma_f32_16x16x32_bf16 v[64:67], v[192:195], v[172:175], v[64:67]
    ds_read_b64_tr_b16 v[146:147], v7 offset:512
    v_mfma_f32_16x16x32_bf16 v[68:71], v[196:199], v[172:175], v[68:71]
    ds_read_b64_tr_b16 v[148:149], v6 offset:24576
    v_mfma_f32_16x16x32_bf16 v[32:35], v[184:187], v[172:175], v[32:35]
    ds_read_b64_tr_b16 v[150:151], v6 offset:25088
    v_mfma_f32_16x16x32_bf16 v[36:39], v[188:191], v[172:175], v[36:39]
    ds_read_b64_tr_b16 v[152:153], v7 offset:24576
    v_mfma_f32_16x16x32_bf16 v[56:59], v[192:195], v[168:171], v[56:59]
    ds_read_b64_tr_b16 v[154:155], v7 offset:25088
    v_mfma_f32_16x16x32_bf16 v[60:63], v[196:199], v[168:171], v[60:63]
    ds_read_b64_tr_b16 v[156:157], v8 offset:0
    v_mfma_f32_16x16x32_bf16 v[24:27], v[184:187], v[168:171], v[24:27]
    ds_read_b64_tr_b16 v[158:159], v8 offset:512
    v_mfma_f32_16x16x32_bf16 v[28:31], v[188:191], v[168:171], v[28:31]
    ds_read_b64_tr_b16 v[160:161], v9 offset:0
    v_mfma_f32_16x16x32_bf16 v[48:51], v[192:195], v[164:167], v[48:51]
    ds_read_b64_tr_b16 v[162:163], v9 offset:512
    v_mfma_f32_16x16x32_bf16 v[52:55], v[196:199], v[164:167], v[52:55]
    v_mfma_f32_16x16x32_bf16 v[16:19], v[184:187], v[164:167], v[16:19]
    v_mfma_f32_16x16x32_bf16 v[20:23], v[188:191], v[164:167], v[20:23]
    v_mfma_f32_16x16x32_bf16 v[96:99], v[172:175], v[200:203], v[96:99]
    v_mfma_f32_16x16x32_bf16 v[100:103], v[172:175], v[204:207], v[100:103]
    v_mfma_f32_16x16x32_bf16 v[88:91], v[168:171], v[200:203], v[88:91]
    v_mfma_f32_16x16x32_bf16 v[92:95], v[168:171], v[204:207], v[92:95]
    v_mfma_f32_16x16x32_bf16 v[80:83], v[164:167], v[200:203], v[80:83]
    v_mfma_f32_16x16x32_bf16 v[84:87], v[164:167], v[204:207], v[84:87]
    s_waitcnt lgkmcnt(0)
    v_mfma_f32_16x16x32_bf16 v[112:115], v[148:151], v[136:139], v[112:115]
    ds_read_b128 v[164:167], v5 offset:0
    v_mfma_f32_16x16x32_bf16 v[116:119], v[136:139], v[156:159], v[116:119]
    ds_read_b128 v[168:171], v5 offset:2048
    v_mfma_f32_16x16x32_bf16 v[72:75], v[148:151], v[132:135], v[72:75]
    ds_read_b128 v[172:175], v5 offset:4096
    v_mfma_f32_16x16x32_bf16 v[76:79], v[152:155], v[132:135], v[76:79]
    ds_read_b128 v[176:179], v5 offset:6144
    v_mfma_f32_16x16x32_bf16 v[104:107], v[132:135], v[156:159], v[104:107]
    ds_read_b128 v[180:183], v3 offset:0
    v_mfma_f32_16x16x32_bf16 v[108:111], v[132:135], v[160:163], v[108:111]
    ds_read_b64_tr_b16 v[184:185], v6 offset:4096
    v_mfma_f32_16x16x32_bf16 v[40:43], v[140:143], v[132:135], v[40:43]
    ds_read_b64_tr_b16 v[186:187], v6 offset:4608
    v_mfma_f32_16x16x32_bf16 v[44:47], v[144:147], v[132:135], v[44:47]
    ds_read_b64_tr_b16 v[188:189], v7 offset:4096
    v_mfma_f32_16x16x32_bf16 v[64:67], v[148:151], v[128:131], v[64:67]
    ds_read_b64_tr_b16 v[190:191], v7 offset:4608
    v_mfma_f32_16x16x32_bf16 v[68:71], v[152:155], v[128:131], v[68:71]
    ds_read_b64_tr_b16 v[192:193], v6 offset:28672
    v_mfma_f32_16x16x32_bf16 v[32:35], v[140:143], v[128:131], v[32:35]
    ds_read_b64_tr_b16 v[194:195], v6 offset:29184
    v_mfma_f32_16x16x32_bf16 v[36:39], v[144:147], v[128:131], v[36:39]
    ds_read_b64_tr_b16 v[196:197], v7 offset:28672
    v_mfma_f32_16x16x32_bf16 v[56:59], v[148:151], v[124:127], v[56:59]
    ds_read_b64_tr_b16 v[198:199], v7 offset:29184
    v_mfma_f32_16x16x32_bf16 v[60:63], v[152:155], v[124:127], v[60:63]
    ds_read_b64_tr_b16 v[200:201], v8 offset:4096
    v_mfma_f32_16x16x32_bf16 v[24:27], v[140:143], v[124:127], v[24:27]
    ds_read_b64_tr_b16 v[202:203], v8 offset:4608
    v_mfma_f32_16x16x32_bf16 v[28:31], v[144:147], v[124:127], v[28:31]
    ds_read_b64_tr_b16 v[204:205], v9 offset:4096
    v_mfma_f32_16x16x32_bf16 v[48:51], v[148:151], v[120:123], v[48:51]
    ds_read_b64_tr_b16 v[206:207], v9 offset:4608
    v_mfma_f32_16x16x32_bf16 v[52:55], v[152:155], v[120:123], v[52:55]
    v_mfma_f32_16x16x32_bf16 v[16:19], v[140:143], v[120:123], v[16:19]
    v_mfma_f32_16x16x32_bf16 v[20:23], v[144:147], v[120:123], v[20:23]
    v_mfma_f32_16x16x32_bf16 v[96:99], v[128:131], v[156:159], v[96:99]
    v_mfma_f32_16x16x32_bf16 v[100:103], v[128:131], v[160:163], v[100:103]
    v_mfma_f32_16x16x32_bf16 v[88:91], v[124:127], v[156:159], v[88:91]
    v_mfma_f32_16x16x32_bf16 v[92:95], v[124:127], v[160:163], v[92:95]
    v_mfma_f32_16x16x32_bf16 v[80:83], v[120:123], v[156:159], v[80:83]
    v_mfma_f32_16x16x32_bf16 v[84:87], v[120:123], v[160:163], v[84:87]
    s_waitcnt lgkmcnt(0)
    s_barrier
    v_mfma_f32_16x16x32_bf16 v[112:115], v[192:195], v[180:183], v[112:115]
    ds_read_b128 v[120:123], v4 offset:18432
    v_mfma_f32_16x16x32_bf16 v[116:119], v[180:183], v[200:203], v[116:119]
    ds_read_b128 v[124:127], v4 offset:20480
    v_mfma_f32_16x16x32_bf16 v[72:75], v[192:195], v[176:179], v[72:75]
    ds_read_b128 v[128:131], v4 offset:22528
    v_mfma_f32_16x16x32_bf16 v[76:79], v[196:199], v[176:179], v[76:79]
    ds_read_b128 v[132:135], v4 offset:24576
    v_mfma_f32_16x16x32_bf16 v[104:107], v[176:179], v[200:203], v[104:107]
    ds_read_b128 v[136:139], v2 offset:18432
    v_mfma_f32_16x16x32_bf16 v[108:111], v[176:179], v[204:207], v[108:111]
    ds_read_b64_tr_b16 v[140:141], v6 offset:8192
    v_mfma_f32_16x16x32_bf16 v[40:43], v[184:187], v[176:179], v[40:43]
    ds_read_b64_tr_b16 v[142:143], v6 offset:8704
    v_mfma_f32_16x16x32_bf16 v[44:47], v[188:191], v[176:179], v[44:47]
    ds_read_b64_tr_b16 v[144:145], v7 offset:8192
    v_mfma_f32_16x16x32_bf16 v[64:67], v[192:195], v[172:175], v[64:67]
    ds_read_b64_tr_b16 v[146:147], v7 offset:8704
    v_mfma_f32_16x16x32_bf16 v[68:71], v[196:199], v[172:175], v[68:71]
    ds_read_b64_tr_b16 v[148:149], v6 offset:32768
    v_mfma_f32_16x16x32_bf16 v[32:35], v[184:187], v[172:175], v[32:35]
    ds_read_b64_tr_b16 v[150:151], v6 offset:33280
    v_mfma_f32_16x16x32_bf16 v[36:39], v[188:191], v[172:175], v[36:39]
    ds_read_b64_tr_b16 v[152:153], v7 offset:32768
    v_mfma_f32_16x16x32_bf16 v[56:59], v[192:195], v[168:171], v[56:59]
    ds_read_b64_tr_b16 v[154:155], v7 offset:33280
    v_mfma_f32_16x16x32_bf16 v[60:63], v[196:199], v[168:171], v[60:63]
    ds_read_b64_tr_b16 v[156:157], v8 offset:8192
    v_mfma_f32_16x16x32_bf16 v[24:27], v[184:187], v[168:171], v[24:27]
    ds_read_b64_tr_b16 v[158:159], v8 offset:8704
    v_mfma_f32_16x16x32_bf16 v[28:31], v[188:191], v[168:171], v[28:31]
    ds_read_b64_tr_b16 v[160:161], v9 offset:8192
    v_mfma_f32_16x16x32_bf16 v[48:51], v[192:195], v[164:167], v[48:51]
    ds_read_b64_tr_b16 v[162:163], v9 offset:8704
    v_mfma_f32_16x16x32_bf16 v[52:55], v[196:199], v[164:167], v[52:55]
    v_mfma_f32_16x16x32_bf16 v[16:19], v[184:187], v[164:167], v[16:19]
    v_mfma_f32_16x16x32_bf16 v[20:23], v[188:191], v[164:167], v[20:23]
    v_mfma_f32_16x16x32_bf16 v[96:99], v[172:175], v[200:203], v[96:99]
    v_mfma_f32_16x16x32_bf16 v[100:103], v[172:175], v[204:207], v[100:103]
    v_mfma_f32_16x16x32_bf16 v[88:91], v[168:171], v[200:203], v[88:91]
    v_mfma_f32_16x16x32_bf16 v[92:95], v[168:171], v[204:207], v[92:95]
    v_mfma_f32_16x16x32_bf16 v[80:83], v[164:167], v[200:203], v[80:83]
    v_mfma_f32_16x16x32_bf16 v[84:87], v[164:167], v[204:207], v[84:87]
    s_waitcnt lgkmcnt(0)
    v_mfma_f32_16x16x32_bf16 v[112:115], v[148:151], v[136:139], v[112:115]
    ds_read_b128 v[164:167], v5 offset:18432
    v_mfma_f32_16x16x32_bf16 v[116:119], v[136:139], v[156:159], v[116:119]
    ds_read_b128 v[168:171], v5 offset:20480
    v_mfma_f32_16x16x32_bf16 v[72:75], v[148:151], v[132:135], v[72:75]
    ds_read_b128 v[172:175], v5 offset:22528
    v_mfma_f32_16x16x32_bf16 v[76:79], v[152:155], v[132:135], v[76:79]
    ds_read_b128 v[176:179], v5 offset:24576
    v_mfma_f32_16x16x32_bf16 v[104:107], v[132:135], v[156:159], v[104:107]
    ds_read_b128 v[180:183], v3 offset:18432
    v_mfma_f32_16x16x32_bf16 v[108:111], v[132:135], v[160:163], v[108:111]
    ds_read_b64_tr_b16 v[184:185], v6 offset:12288
    v_mfma_f32_16x16x32_bf16 v[40:43], v[140:143], v[132:135], v[40:43]
    ds_read_b64_tr_b16 v[186:187], v6 offset:12800
    v_mfma_f32_16x16x32_bf16 v[44:47], v[144:147], v[132:135], v[44:47]
    ds_read_b64_tr_b16 v[188:189], v7 offset:12288
    v_mfma_f32_16x16x32_bf16 v[64:67], v[148:151], v[128:131], v[64:67]
    ds_read_b64_tr_b16 v[190:191], v7 offset:12800
    v_mfma_f32_16x16x32_bf16 v[68:71], v[152:155], v[128:131], v[68:71]
    ds_read_b64_tr_b16 v[192:193], v6 offset:36864
    v_mfma_f32_16x16x32_bf16 v[32:35], v[140:143], v[128:131], v[32:35]
    ds_read_b64_tr_b16 v[194:195], v6 offset:37376
    v_mfma_f32_16x16x32_bf16 v[36:39], v[144:147], v[128:131], v[36:39]
    ds_read_b64_tr_b16 v[196:197], v7 offset:36864
    v_mfma_f32_16x16x32_bf16 v[56:59], v[148:151], v[124:127], v[56:59]
    ds_read_b64_tr_b16 v[198:199], v7 offset:37376
    v_mfma_f32_16x16x32_bf16 v[60:63], v[152:155], v[124:127], v[60:63]
    ds_read_b64_tr_b16 v[200:201], v8 offset:12288
    v_mfma_f32_16x16x32_bf16 v[24:27], v[140:143], v[124:127], v[24:27]
    ds_read_b64_tr_b16 v[202:203], v8 offset:12800
    v_mfma_f32_16x16x32_bf16 v[28:31], v[144:147], v[124:127], v[28:31]
    ds_read_b64_tr_b16 v[204:205], v9 offset:12288
    v_mfma_f32_16x16x32_bf16 v[48:51], v[148:151], v[120:123], v[48:51]
    ds_read_b64_tr_b16 v[206:207], v9 offset:12800
    v_mfma_f32_16x16x32_bf16 v[52:55], v[152:155], v[120:123], v[52:55]
    v_mfma_f32_16x16x32_bf16 v[16:19], v[140:143], v[120:123], v[16:19]
    v_mfma_f32_16x16x32_bf16 v[20:23], v[144:147], v[120:123], v[20:23]
    v_mfma_f32_16x16x32_bf16 v[96:99], v[128:131], v[156:159], v[96:99]
    v_mfma_f32_16x16x32_bf16 v[100:103], v[128:131], v[160:163], v[100:103]
    v_mfma_f32_16x16x32_bf16 v[88:91], v[124:127], v[156:159], v[88:91]
    v_mfma_f32_16x16x32_bf16 v[92:95], v[124:127], v[160:163], v[92:95]
    v_mfma_f32_16x16x32_bf16 v[80:83], v[120:123], v[156:159], v[80:83]
    v_mfma_f32_16x16x32_bf16 v[84:87], v[120:123], v[160:163], v[84:87]
    s_waitcnt lgkmcnt(0)
    s_barrier
    v_mfma_f32_16x16x32_bf16 v[112:115], v[192:195], v[180:183], v[112:115]
    ds_read_b128 v[120:123], v4 offset:36864
    v_mfma_f32_16x16x32_bf16 v[116:119], v[180:183], v[200:203], v[116:119]
    ds_read_b128 v[124:127], v4 offset:38912
    v_mfma_f32_16x16x32_bf16 v[72:75], v[192:195], v[176:179], v[72:75]
    ds_read_b128 v[128:131], v4 offset:40960
    v_mfma_f32_16x16x32_bf16 v[76:79], v[196:199], v[176:179], v[76:79]
    ds_read_b128 v[132:135], v4 offset:43008
    v_mfma_f32_16x16x32_bf16 v[104:107], v[176:179], v[200:203], v[104:107]
    ds_read_b128 v[136:139], v2 offset:36864
    v_mfma_f32_16x16x32_bf16 v[108:111], v[176:179], v[204:207], v[108:111]
    ds_read_b64_tr_b16 v[140:141], v6 offset:16384
    v_mfma_f32_16x16x32_bf16 v[40:43], v[184:187], v[176:179], v[40:43]
    ds_read_b64_tr_b16 v[142:143], v6 offset:16896
    v_mfma_f32_16x16x32_bf16 v[44:47], v[188:191], v[176:179], v[44:47]
    ds_read_b64_tr_b16 v[144:145], v7 offset:16384
    v_mfma_f32_16x16x32_bf16 v[64:67], v[192:195], v[172:175], v[64:67]
    ds_read_b64_tr_b16 v[146:147], v7 offset:16896
    v_mfma_f32_16x16x32_bf16 v[68:71], v[196:199], v[172:175], v[68:71]
    ds_read_b64_tr_b16 v[148:149], v6 offset:40960
    v_mfma_f32_16x16x32_bf16 v[32:35], v[184:187], v[172:175], v[32:35]
    ds_read_b64_tr_b16 v[150:151], v6 offset:41472
    v_mfma_f32_16x16x32_bf16 v[36:39], v[188:191], v[172:175], v[36:39]
    ds_read_b64_tr_b16 v[152:153], v7 offset:40960
    v_mfma_f32_16x16x32_bf16 v[56:59], v[192:195], v[168:171], v[56:59]
    ds_read_b64_tr_b16 v[154:155], v7 offset:41472
    v_mfma_f32_16x16x32_bf16 v[60:63], v[196:199], v[168:171], v[60:63]
    ds_read_b64_tr_b16 v[156:157], v8 offset:16384
    v_mfma_f32_16x16x32_bf16 v[24:27], v[184:187], v[168:171], v[24:27]
    ds_read_b64_tr_b16 v[158:159], v8 offset:16896
    v_mfma_f32_16x16x32_bf16 v[28:31], v[188:191], v[168:171], v[28:31]
    ds_read_b64_tr_b16 v[160:161], v9 offset:16384
    v_mfma_f32_16x16x32_bf16 v[48:51], v[192:195], v[164:167], v[48:51]
    ds_read_b64_tr_b16 v[162:163], v9 offset:16896
    v_mfma_f32_16x16x32_bf16 v[52:55], v[196:199], v[164:167], v[52:55]
    v_mfma_f32_16x16x32_bf16 v[16:19], v[184:187], v[164:167], v[16:19]
    v_mfma_f32_16x16x32_bf16 v[20:23], v[188:191], v[164:167], v[20:23]
    v_mfma_f32_16x16x32_bf16 v[96:99], v[172:175], v[200:203], v[96:99]
    v_mfma_f32_16x16x32_bf16 v[100:103], v[172:175], v[204:207], v[100:103]
    v_mfma_f32_16x16x32_bf16 v[88:91], v[168:171], v[200:203], v[88:91]
    v_mfma_f32_16x16x32_bf16 v[92:95], v[168:171], v[204:207], v[92:95]
    v_mfma_f32_16x16x32_bf16 v[80:83], v[164:167], v[200:203], v[80:83]
    v_mfma_f32_16x16x32_bf16 v[84:87], v[164:167], v[204:207], v[84:87]
    s_waitcnt lgkmcnt(0)
    v_mfma_f32_16x16x32_bf16 v[112:115], v[148:151], v[136:139], v[112:115]
    ds_read_b128 v[164:167], v5 offset:36864
    v_mfma_f32_16x16x32_bf16 v[116:119], v[136:139], v[156:159], v[116:119]
    ds_read_b128 v[168:171], v5 offset:38912
    v_mfma_f32_16x16x32_bf16 v[72:75], v[148:151], v[132:135], v[72:75]
    ds_read_b128 v[172:175], v5 offset:40960
    v_mfma_f32_16x16x32_bf16 v[76:79], v[152:155], v[132:135], v[76:79]
    ds_read_b128 v[176:179], v5 offset:43008
    v_mfma_f32_16x16x32_bf16 v[104:107], v[132:135], v[156:159], v[104:107]
    ds_read_b128 v[180:183], v3 offset:36864
    v_mfma_f32_16x16x32_bf16 v[108:111], v[132:135], v[160:163], v[108:111]
    ds_read_b64_tr_b16 v[184:185], v6 offset:20480
    v_mfma_f32_16x16x32_bf16 v[40:43], v[140:143], v[132:135], v[40:43]
    ds_read_b64_tr_b16 v[186:187], v6 offset:20992
    v_mfma_f32_16x16x32_bf16 v[44:47], v[144:147], v[132:135], v[44:47]
    ds_read_b64_tr_b16 v[188:189], v7 offset:20480
    v_mfma_f32_16x16x32_bf16 v[64:67], v[148:151], v[128:131], v[64:67]
    ds_read_b64_tr_b16 v[190:191], v7 offset:20992
    v_mfma_f32_16x16x32_bf16 v[68:71], v[152:155], v[128:131], v[68:71]
    ds_read_b64_tr_b16 v[192:193], v6 offset:45056
    v_mfma_f32_16x16x32_bf16 v[32:35], v[140:143], v[128:131], v[32:35]
    ds_read_b64_tr_b16 v[194:195], v6 offset:45568
    v_mfma_f32_16x16x32_bf16 v[36:39], v[144:147], v[128:131], v[36:39]
    ds_read_b64_tr_b16 v[196:197], v7 offset:45056
    v_mfma_f32_16x16x32_bf16 v[56:59], v[148:151], v[124:127], v[56:59]
    ds_read_b64_tr_b16 v[198:199], v7 offset:45568
    v_mfma_f32_16x16x32_bf16 v[60:63], v[152:155], v[124:127], v[60:63]
    ds_read_b64_tr_b16 v[200:201], v8 offset:20480
    v_mfma_f32_16x16x32_bf16 v[24:27], v[140:143], v[124:127], v[24:27]
    ds_read_b64_tr_b16 v[202:203], v8 offset:20992
    v_mfma_f32_16x16x32_bf16 v[28:31], v[144:147], v[124:127], v[28:31]
    ds_read_b64_tr_b16 v[204:205], v9 offset:20480
    v_mfma_f32_16x16x32_bf16 v[48:51], v[148:151], v[120:123], v[48:51]
    ds_read_b64_tr_b16 v[206:207], v9 offset:20992
    v_mfma_f32_16x16x32_bf16 v[52:55], v[152:155], v[120:123], v[52:55]
    v_mfma_f32_16x16x32_bf16 v[16:19], v[140:143], v[120:123], v[16:19]
    v_mfma_f32_16x16x32_bf16 v[20:23], v[144:147], v[120:123], v[20:23]
    v_mfma_f32_16x16x32_bf16 v[96:99], v[128:131], v[156:159], v[96:99]
    v_mfma_f32_16x16x32_bf16 v[100:103], v[128:131], v[160:163], v[100:103]
    v_mfma_f32_16x16x32_bf16 v[88:91], v[124:127], v[156:159], v[88:91]
    v_mfma_f32_16x16x32_bf16 v[92:95], v[124:127], v[160:163], v[92:95]
    v_mfma_f32_16x16x32_bf16 v[80:83], v[120:123], v[156:159], v[80:83]
    v_mfma_f32_16x16x32_bf16 v[84:87], v[120:123], v[160:163], v[84:87]
    s_waitcnt lgkmcnt(0)
    s_barrier
    v_mfma_f32_16x16x32_bf16 v[112:115], v[192:195], v[180:183], v[112:115]
    ds_read_b128 v[120:123], v4 offset:0
    v_mfma_f32_16x16x32_bf16 v[116:119], v[180:183], v[200:203], v[116:119]
    ds_read_b128 v[124:127], v4 offset:2048
    v_mfma_f32_16x16x32_bf16 v[72:75], v[192:195], v[176:179], v[72:75]
    ds_read_b128 v[128:131], v4 offset:4096
    v_mfma_f32_16x16x32_bf16 v[76:79], v[196:199], v[176:179], v[76:79]
    ds_read_b128 v[132:135], v4 offset:6144
    v_mfma_f32_16x16x32_bf16 v[104:107], v[176:179], v[200:203], v[104:107]
    ds_read_b128 v[136:139], v2 offset:0
    v_mfma_f32_16x16x32_bf16 v[108:111], v[176:179], v[204:207], v[108:111]
    ds_read_b64_tr_b16 v[140:141], v6 offset:0
    v_mfma_f32_16x16x32_bf16 v[40:43], v[184:187], v[176:179], v[40:43]
    ds_read_b64_tr_b16 v[142:143], v6 offset:512
    v_mfma_f32_16x16x32_bf16 v[44:47], v[188:191], v[176:179], v[44:47]
    ds_read_b64_tr_b16 v[144:145], v7 offset:0
    v_mfma_f32_16x16x32_bf16 v[64:67], v[192:195], v[172:175], v[64:67]
    ds_read_b64_tr_b16 v[146:147], v7 offset:512
    v_mfma_f32_16x16x32_bf16 v[68:71], v[196:199], v[172:175], v[68:71]
    ds_read_b64_tr_b16 v[148:149], v6 offset:24576
    v_mfma_f32_16x16x32_bf16 v[32:35], v[184:187], v[172:175], v[32:35]
    ds_read_b64_tr_b16 v[150:151], v6 offset:25088
    v_mfma_f32_16x16x32_bf16 v[36:39], v[188:191], v[172:175], v[36:39]
    ds_read_b64_tr_b16 v[152:153], v7 offset:24576
    v_mfma_f32_16x16x32_bf16 v[56:59], v[192:195], v[168:171], v[56:59]
    ds_read_b64_tr_b16 v[154:155], v7 offset:25088
    v_mfma_f32_16x16x32_bf16 v[60:63], v[196:199], v[168:171], v[60:63]
    ds_read_b64_tr_b16 v[156:157], v8 offset:0
    v_mfma_f32_16x16x32_bf16 v[24:27], v[184:187], v[168:171], v[24:27]
    ds_read_b64_tr_b16 v[158:159], v8 offset:512
    v_mfma_f32_16x16x32_bf16 v[28:31], v[188:191], v[168:171], v[28:31]
    ds_read_b64_tr_b16 v[160:161], v9 offset:0
    v_mfma_f32_16x16x32_bf16 v[48:51], v[192:195], v[164:167], v[48:51]
    ds_read_b64_tr_b16 v[162:163], v9 offset:512
    v_mfma_f32_16x16x32_bf16 v[52:55], v[196:199], v[164:167], v[52:55]
    v_mfma_f32_16x16x32_bf16 v[16:19], v[184:187], v[164:167], v[16:19]
    v_mfma_f32_16x16x32_bf16 v[20:23], v[188:191], v[164:167], v[20:23]
    v_mfma_f32_16x16x32_bf16 v[96:99], v[172:175], v[200:203], v[96:99]
    v_mfma_f32_16x16x32_bf16 v[100:103], v[172:175], v[204:207], v[100:103]
    v_mfma_f32_16x16x32_bf16 v[88:91], v[168:171], v[200:203], v[88:91]
    v_mfma_f32_16x16x32_bf16 v[92:95], v[168:171], v[204:207], v[92:95]
    v_mfma_f32_16x16x32_bf16 v[80:83], v[164:167], v[200:203], v[80:83]
    v_mfma_f32_16x16x32_bf16 v[84:87], v[164:167], v[204:207], v[84:87]
    s_waitcnt lgkmcnt(0)
    v_mfma_f32_16x16x32_bf16 v[112:115], v[148:151], v[136:139], v[112:115]
    ds_read_b128 v[164:167], v5 offset:0
    v_mfma_f32_16x16x32_bf16 v[116:119], v[136:139], v[156:159], v[116:119]
    ds_read_b128 v[168:171], v5 offset:2048
    v_mfma_f32_16x16x32_bf16 v[72:75], v[148:151], v[132:135], v[72:75]
    ds_read_b128 v[172:175], v5 offset:4096
    v_mfma_f32_16x16x32_bf16 v[76:79], v[152:155], v[132:135], v[76:79]
    ds_read_b128 v[176:179], v5 offset:6144
    v_mfma_f32_16x16x32_bf16 v[104:107], v[132:135], v[156:159], v[104:107]
    ds_read_b128 v[180:183], v3 offset:0
    v_mfma_f32_16x16x32_bf16 v[108:111], v[132:135], v[160:163], v[108:111]
    ds_read_b64_tr_b16 v[184:185], v6 offset:4096
    v_mfma_f32_16x16x32_bf16 v[40:43], v[140:143], v[132:135], v[40:43]
    ds_read_b64_tr_b16 v[186:187], v6 offset:4608
    v_mfma_f32_16x16x32_bf16 v[44:47], v[144:147], v[132:135], v[44:47]
    ds_read_b64_tr_b16 v[188:189], v7 offset:4096
    v_mfma_f32_16x16x32_bf16 v[64:67], v[148:151], v[128:131], v[64:67]
    ds_read_b64_tr_b16 v[190:191], v7 offset:4608
    v_mfma_f32_16x16x32_bf16 v[68:71], v[152:155], v[128:131], v[68:71]
    ds_read_b64_tr_b16 v[192:193], v6 offset:28672
    v_mfma_f32_16x16x32_bf16 v[32:35], v[140:143], v[128:131], v[32:35]
    ds_read_b64_tr_b16 v[194:195], v6 offset:29184
    v_mfma_f32_16x16x32_bf16 v[36:39], v[144:147], v[128:131], v[36:39]
    ds_read_b64_tr_b16 v[196:197], v7 offset:28672
    v_mfma_f32_16x16x32_bf16 v[56:59], v[148:151], v[124:127], v[56:59]
    ds_read_b64_tr_b16 v[198:199], v7 offset:29184
    v_mfma_f32_16x16x32_bf16 v[60:63], v[152:155], v[124:127], v[60:63]
    ds_read_b64_tr_b16 v[200:201], v8 offset:4096
    v_mfma_f32_16x16x32_bf16 v[24:27], v[140:143], v[124:127], v[24:27]
    ds_read_b64_tr_b16 v[202:203], v8 offset:4608
    v_mfma_f32_16x16x32_bf16 v[28:31], v[144:147], v[124:127], v[28:31]
    ds_read_b64_tr_b16 v[204:205], v9 offset:4096
    v_mfma_f32_16x16x32_bf16 v[48:51], v[148:151], v[120:123], v[48:51]
    ds_read_b64_tr_b16 v[206:207], v9 offset:4608
    v_mfma_f32_16x16x32_bf16 v[52:55], v[152:155], v[120:123], v[52:55]
    v_mfma_f32_16x16x32_bf16 v[16:19], v[140:143], v[120:123], v[16:19]
    v_mfma_f32_16x16x32_bf16 v[20:23], v[144:147], v[120:123], v[20:23]
    v_mfma_f32_16x16x32_bf16 v[96:99], v[128:131], v[156:159], v[96:99]
    v_mfma_f32_16x16x32_bf16 v[100:103], v[128:131], v[160:163], v[100:103]
    v_mfma_f32_16x16x32_bf16 v[88:91], v[124:127], v[156:159], v[88:91]
    v_mfma_f32_16x16x32_bf16 v[92:95], v[124:127], v[160:163], v[92:95]
    v_mfma_f32_16x16x32_bf16 v[80:83], v[120:123], v[156:159], v[80:83]
    v_mfma_f32_16x16x32_bf16 v[84:87], v[120:123], v[160:163], v[84:87]
    s_waitcnt lgkmcnt(0)
    s_barrier
    v_mfma_f32_16x16x32_bf16 v[112:115], v[192:195], v[180:183], v[112:115]
    ds_read_b128 v[120:123], v4 offset:18432
    v_mfma_f32_16x16x32_bf16 v[116:119], v[180:183], v[200:203], v[116:119]
    ds_read_b128 v[124:127], v4 offset:20480
    v_mfma_f32_16x16x32_bf16 v[72:75], v[192:195], v[176:179], v[72:75]
    ds_read_b128 v[128:131], v4 offset:22528
    v_mfma_f32_16x16x32_bf16 v[76:79], v[196:199], v[176:179], v[76:79]
    ds_read_b128 v[132:135], v4 offset:24576
    v_mfma_f32_16x16x32_bf16 v[104:107], v[176:179], v[200:203], v[104:107]
    ds_read_b128 v[136:139], v2 offset:18432
    v_mfma_f32_16x16x32_bf16 v[108:111], v[176:179], v[204:207], v[108:111]
    ds_read_b64_tr_b16 v[140:141], v6 offset:8192
    v_mfma_f32_16x16x32_bf16 v[40:43], v[184:187], v[176:179], v[40:43]
    ds_read_b64_tr_b16 v[142:143], v6 offset:8704
    v_mfma_f32_16x16x32_bf16 v[44:47], v[188:191], v[176:179], v[44:47]
    ds_read_b64_tr_b16 v[144:145], v7 offset:8192
    v_mfma_f32_16x16x32_bf16 v[64:67], v[192:195], v[172:175], v[64:67]
    ds_read_b64_tr_b16 v[146:147], v7 offset:8704
    v_mfma_f32_16x16x32_bf16 v[68:71], v[196:199], v[172:175], v[68:71]
    ds_read_b64_tr_b16 v[148:149], v6 offset:32768
    v_mfma_f32_16x16x32_bf16 v[32:35], v[184:187], v[172:175], v[32:35]
    ds_read_b64_tr_b16 v[150:151], v6 offset:33280
    v_mfma_f32_16x16x32_bf16 v[36:39], v[188:191], v[172:175], v[36:39]
    ds_read_b64_tr_b16 v[152:153], v7 offset:32768
    v_mfma_f32_16x16x32_bf16 v[56:59], v[192:195], v[168:171], v[56:59]
    ds_read_b64_tr_b16 v[154:155], v7 offset:33280
    v_mfma_f32_16x16x32_bf16 v[60:63], v[196:199], v[168:171], v[60:63]
    ds_read_b64_tr_b16 v[156:157], v8 offset:8192
    v_mfma_f32_16x16x32_bf16 v[24:27], v[184:187], v[168:171], v[24:27]
    ds_read_b64_tr_b16 v[158:159], v8 offset:8704
    v_mfma_f32_16x16x32_bf16 v[28:31], v[188:191], v[168:171], v[28:31]
    ds_read_b64_tr_b16 v[160:161], v9 offset:8192
    v_mfma_f32_16x16x32_bf16 v[48:51], v[192:195], v[164:167], v[48:51]
    ds_read_b64_tr_b16 v[162:163], v9 offset:8704
    v_mfma_f32_16x16x32_bf16 v[52:55], v[196:199], v[164:167], v[52:55]
    v_mfma_f32_16x16x32_bf16 v[16:19], v[184:187], v[164:167], v[16:19]
    v_mfma_f32_16x16x32_bf16 v[20:23], v[188:191], v[164:167], v[20:23]
    v_mfma_f32_16x16x32_bf16 v[96:99], v[172:175], v[200:203], v[96:99]
    v_mfma_f32_16x16x32_bf16 v[100:103], v[172:175], v[204:207], v[100:103]
    v_mfma_f32_16x16x32_bf16 v[88:91], v[168:171], v[200:203], v[88:91]
    v_mfma_f32_16x16x32_bf16 v[92:95], v[168:171], v[204:207], v[92:95]
    v_mfma_f32_16x16x32_bf16 v[80:83], v[164:167], v[200:203], v[80:83]
    v_mfma_f32_16x16x32_bf16 v[84:87], v[164:167], v[204:207], v[84:87]
    s_waitcnt lgkmcnt(0)
    v_mfma_f32_16x16x32_bf16 v[112:115], v[148:151], v[136:139], v[112:115]
    ds_read_b128 v[164:167], v5 offset:18432
    v_mfma_f32_16x16x32_bf16 v[116:119], v[136:139], v[156:159], v[116:119]
    ds_read_b128 v[168:171], v5 offset:20480
    v_mfma_f32_16x16x32_bf16 v[72:75], v[148:151], v[132:135], v[72:75]
    ds_read_b128 v[172:175], v5 offset:22528
    v_mfma_f32_16x16x32_bf16 v[76:79], v[152:155], v[132:135], v[76:79]
    ds_read_b128 v[176:179], v5 offset:24576
    v_mfma_f32_16x16x32_bf16 v[104:107], v[132:135], v[156:159], v[104:107]
    ds_read_b128 v[180:183], v3 offset:18432
    v_mfma_f32_16x16x32_bf16 v[108:111], v[132:135], v[160:163], v[108:111]
    ds_read_b64_tr_b16 v[184:185], v6 offset:12288
    v_mfma_f32_16x16x32_bf16 v[40:43], v[140:143], v[132:135], v[40:43]
    ds_read_b64_tr_b16 v[186:187], v6 offset:12800
    v_mfma_f32_16x16x32_bf16 v[44:47], v[144:147], v[132:135], v[44:47]
    ds_read_b64_tr_b16 v[188:189], v7 offset:12288
    v_mfma_f32_16x16x32_bf16 v[64:67], v[148:151], v[128:131], v[64:67]
    ds_read_b64_tr_b16 v[190:191], v7 offset:12800
    v_mfma_f32_16x16x32_bf16 v[68:71], v[152:155], v[128:131], v[68:71]
    ds_read_b64_tr_b16 v[192:193], v6 offset:36864
    v_mfma_f32_16x16x32_bf16 v[32:35], v[140:143], v[128:131], v[32:35]
    ds_read_b64_tr_b16 v[194:195], v6 offset:37376
    v_mfma_f32_16x16x32_bf16 v[36:39], v[144:147], v[128:131], v[36:39]
    ds_read_b64_tr_b16 v[196:197], v7 offset:36864
    v_mfma_f32_16x16x32_bf16 v[56:59], v[148:151], v[124:127], v[56:59]
    ds_read_b64_tr_b16 v[198:199], v7 offset:37376
    v_mfma_f32_16x16x32_bf16 v[60:63], v[152:155], v[124:127], v[60:63]
    ds_read_b64_tr_b16 v[200:201], v8 offset:12288
    v_mfma_f32_16x16x32_bf16 v[24:27], v[140:143], v[124:127], v[24:27]
    ds_read_b64_tr_b16 v[202:203], v8 offset:12800
    v_mfma_f32_16x16x32_bf16 v[28:31], v[144:147], v[124:127], v[28:31]
    ds_read_b64_tr_b16 v[204:205], v9 offset:12288
    v_mfma_f32_16x16x32_bf16 v[48:51], v[148:151], v[120:123], v[48:51]
    ds_read_b64_tr_b16 v[206:207], v9 offset:12800
    v_mfma_f32_16x16x32_bf16 v[52:55], v[152:155], v[120:123], v[52:55]
    v_mfma_f32_16x16x32_bf16 v[16:19], v[140:143], v[120:123], v[16:19]
    v_mfma_f32_16x16x32_bf16 v[20:23], v[144:147], v[120:123], v[20:23]
    v_mfma_f32_16x16x32_bf16 v[96:99], v[128:131], v[156:159], v[96:99]
    v_mfma_f32_16x16x32_bf16 v[100:103], v[128:131], v[160:163], v[100:103]
    v_mfma_f32_16x16x32_bf16 v[88:91], v[124:127], v[156:159], v[88:91]
    v_mfma_f32_16x16x32_bf16 v[92:95], v[124:127], v[160:163], v[92:95]
    v_mfma_f32_16x16x32_bf16 v[80:83], v[120:123], v[156:159], v[80:83]
    v_mfma_f32_16x16x32_bf16 v[84:87], v[120:123], v[160:163], v[84:87]
    s_waitcnt lgkmcnt(0)
    s_barrier
    v_mfma_f32_16x16x32_bf16 v[112:115], v[192:195], v[180:183], v[112:115]
    ds_read_b128 v[120:123], v4 offset:36864
    v_mfma_f32_16x16x32_bf16 v[116:119], v[180:183], v[200:203], v[116:119]
    ds_read_b128 v[124:127], v4 offset:38912
    v_mfma_f32_16x16x32_bf16 v[72:75], v[192:195], v[176:179], v[72:75]
    ds_read_b128 v[128:131], v4 offset:40960
    v_mfma_f32_16x16x32_bf16 v[76:79], v[196:199], v[176:179], v[76:79]
    ds_read_b128 v[132:135], v4 offset:43008
    v_mfma_f32_16x16x32_bf16 v[104:107], v[176:179], v[200:203], v[104:107]
    ds_read_b128 v[136:139], v2 offset:36864
    v_mfma_f32_16x16x32_bf16 v[108:111], v[176:179], v[204:207], v[108:111]
    ds_read_b64_tr_b16 v[140:141], v6 offset:16384
    v_mfma_f32_16x16x32_bf16 v[40:43], v[184:187], v[176:179], v[40:43]
    ds_read_b64_tr_b16 v[142:143], v6 offset:16896
    v_mfma_f32_16x16x32_bf16 v[44:47], v[188:191], v[176:179], v[44:47]
    ds_read_b64_tr_b16 v[144:145], v7 offset:16384
    v_mfma_f32_16x16x32_bf16 v[64:67], v[192:195], v[172:175], v[64:67]
    ds_read_b64_tr_b16 v[146:147], v7 offset:16896
    v_mfma_f32_16x16x32_bf16 v[68:71], v[196:199], v[172:175], v[68:71]
    ds_read_b64_tr_b16 v[148:149], v6 offset:40960
    v_mfma_f32_16x16x32_bf16 v[32:35], v[184:187], v[172:175], v[32:35]
    ds_read_b64_tr_b16 v[150:151], v6 offset:41472
    v_mfma_f32_16x16x32_bf16 v[36:39], v[188:191], v[172:175], v[36:39]
    ds_read_b64_tr_b16 v[152:153], v7 offset:40960
    v_mfma_f32_16x16x32_bf16 v[56:59], v[192:195], v[168:171], v[56:59]
    ds_read_b64_tr_b16 v[154:155], v7 offset:41472
    v_mfma_f32_16x16x32_bf16 v[60:63], v[196:199], v[168:171], v[60:63]
    ds_read_b64_tr_b16 v[156:157], v8 offset:16384
    v_mfma_f32_16x16x32_bf16 v[24:27], v[184:187], v[168:171], v[24:27]
    ds_read_b64_tr_b16 v[158:159], v8 offset:16896
    v_mfma_f32_16x16x32_bf16 v[28:31], v[188:191], v[168:171], v[28:31]
    ds_read_b64_tr_b16 v[160:161], v9 offset:16384
    v_mfma_f32_16x16x32_bf16 v[48:51], v[192:195], v[164:167], v[48:51]
    ds_read_b64_tr_b16 v[162:163], v9 offset:16896
    v_mfma_f32_16x16x32_bf16 v[52:55], v[196:199], v[164:167], v[52:55]
    v_mfma_f32_16x16x32_bf16 v[16:19], v[184:187], v[164:167], v[16:19]
    v_mfma_f32_16x16x32_bf16 v[20:23], v[188:191], v[164:167], v[20:23]
    v_mfma_f32_16x16x32_bf16 v[96:99], v[172:175], v[200:203], v[96:99]
    v_mfma_f32_16x16x32_bf16 v[100:103], v[172:175], v[204:207], v[100:103]
    v_mfma_f32_16x16x32_bf16 v[88:91], v[168:171], v[200:203], v[88:91]
    v_mfma_f32_16x16x32_bf16 v[92:95], v[168:171], v[204:207], v[92:95]
    v_mfma_f32_16x16x32_bf16 v[80:83], v[164:167], v[200:203], v[80:83]
    v_mfma_f32_16x16x32_bf16 v[84:87], v[164:167], v[204:207], v[84:87]
    s_waitcnt lgkmcnt(0)
    v_mfma_f32_16x16x32_bf16 v[112:115], v[148:151], v[136:139], v[112:115]
    ds_read_b128 v[164:167], v5 offset:36864
    v_mfma_f32_16x16x32_bf16 v[116:119], v[136:139], v[156:159], v[116:119]
    ds_read_b128 v[168:171], v5 offset:38912
    v_mfma_f32_16x16x32_bf16 v[72:75], v[148:151], v[132:135], v[72:75]
    ds_read_b128 v[172:175], v5 offset:40960
    v_mfma_f32_16x16x32_bf16 v[76:79], v[152:155], v[132:135], v[76:79]
    ds_read_b128 v[176:179], v5 offset:43008
    v_mfma_f32_16x16x32_bf16 v[104:107], v[132:135], v[156:159], v[104:107]
    ds_read_b128 v[180:183], v3 offset:36864
    v_mfma_f32_16x16x32_bf16 v[108:111], v[132:135], v[160:163], v[108:111]
    ds_read_b64_tr_b16 v[184:185], v6 offset:20480
    v_mfma_f32_16x16x32_bf16 v[40:43], v[140:143], v[132:135], v[40:43]
    ds_read_b64_tr_b16 v[186:187], v6 offset:20992
    v_mfma_f32_16x16x32_bf16 v[44:47], v[144:147], v[132:135], v[44:47]
    ds_read_b64_tr_b16 v[188:189], v7 offset:20480
    v_mfma_f32_16x16x32_bf16 v[64:67], v[148:151], v[128:131], v[64:67]
    ds_read_b64_tr_b16 v[190:191], v7 offset:20992
    v_mfma_f32_16x16x32_bf16 v[68:71], v[152:155], v[128:131], v[68:71]
    ds_read_b64_tr_b16 v[192:193], v6 offset:45056
    v_mfma_f32_16x16x32_bf16 v[32:35], v[140:143], v[128:131], v[32:35]
    ds_read_b64_tr_b16 v[194:195], v6 offset:45568
    v_mfma_f32_16x16x32_bf16 v[36:39], v[144:147], v[128:131], v[36:39]
    ds_read_b64_tr_b16 v[196:197], v7 offset:45056
    v_mfma_f32_16x16x32_bf16 v[56:59], v[148:151], v[124:127], v[56:59]
    ds_read_b64_tr_b16 v[198:199], v7 offset:45568
    v_mfma_f32_16x16x32_bf16 v[60:63], v[152:155], v[124:127], v[60:63]
    ds_read_b64_tr_b16 v[200:201], v8 offset:20480
    v_mfma_f32_16x16x32_bf16 v[24:27], v[140:143], v[124:127], v[24:27]
    ds_read_b64_tr_b16 v[202:203], v8 offset:20992
    v_mfma_f32_16x16x32_bf16 v[28:31], v[144:147], v[124:127], v[28:31]
    ds_read_b64_tr_b16 v[204:205], v9 offset:20480
    v_mfma_f32_16x16x32_bf16 v[48:51], v[148:151], v[120:123], v[48:51]
    ds_read_b64_tr_b16 v[206:207], v9 offset:20992
    v_mfma_f32_16x16x32_bf16 v[52:55], v[152:155], v[120:123], v[52:55]
    v_mfma_f32_16x16x32_bf16 v[16:19], v[140:143], v[120:123], v[16:19]
    v_mfma_f32_16x16x32_bf16 v[20:23], v[144:147], v[120:123], v[20:23]
    v_mfma_f32_16x16x32_bf16 v[96:99], v[128:131], v[156:159], v[96:99]
    v_mfma_f32_16x16x32_bf16 v[100:103], v[128:131], v[160:163], v[100:103]
    v_mfma_f32_16x16x32_bf16 v[88:91], v[124:127], v[156:159], v[88:91]
    v_mfma_f32_16x16x32_bf16 v[92:95], v[124:127], v[160:163], v[92:95]
    v_mfma_f32_16x16x32_bf16 v[80:83], v[120:123], v[156:159], v[80:83]
    v_mfma_f32_16x16x32_bf16 v[84:87], v[120:123], v[160:163], v[84:87]
    s_waitcnt lgkmcnt(0)
    s_barrier
    s_cmp_lg_u32 s3, 0
    s_cbranch_scc1 LB_sk9
    s_mov_b64 exec, 1
    buffer_store_dword v11, v221, s[52:55], 0 offen sc1
    s_mov_b64 exec, -1
LB_sk9:
    v_mfma_f32_16x16x32_bf16 v[112:115], v[192:195], v[180:183], v[112:115]
    ds_read_b128 v[120:123], v4 offset:0
    v_mfma_f32_16x16x32_bf16 v[116:119], v[180:183], v[200:203], v[116:119]
    ds_read_b128 v[124:127], v4 offset:2048
    v_mfma_f32_16x16x32_bf16 v[72:75], v[192:195], v[176:179], v[72:75]
    ds_read_b128 v[128:131], v4 offset:4096
    v_mfma_f32_16x16x32_bf16 v[76:79], v[196:199], v[176:179], v[76:79]
    ds_read_b128 v[132:135], v4 offset:6144
    v_mfma_f32_16x16x32_bf16 v[104:107], v[176:179], v[200:203], v[104:107]
    ds_read_b128 v[136:139], v2 offset:0
    v_mfma_f32_16x16x32_bf16 v[108:111], v[176:179], v[204:207], v[108:111]
    ds_read_b64_tr_b16 v[140:141], v6 offset:0
    v_mfma_f32_16x16x32_bf16 v[40:43], v[184:187], v[176:179], v[40:43]
    ds_read_b64_tr_b16 v[142:143], v6 offset:512
    v_mfma_f32_16x16x32_bf16 v[44:47], v[188:191], v[176:179], v[44:47]
    ds_read_b64_tr_b16 v[144:145], v7 offset:0
    v_mfma_f32_16x16x32_bf16 v[64:67], v[192:195], v[172:175], v[64:67]
    ds_read_b64_tr_b16 v[146:147], v7 offset:512
    v_mfma_f32_16x16x32_bf16 v[68:71], v[196:199], v[172:175], v[68:71]
    ds_read_b64_tr_b16 v[148:149], v6 offset:24576
    v_mfma_f32_16x16x32_bf16 v[32:35], v[184:187], v[172:175], v[32:35]
    ds_read_b64_tr_b16 v[150:151], v6 offset:25088
    v_mfma_f32_16x16x32_bf16 v[36:39], v[188:191], v[172:175], v[36:39]
    ds_read_b64_tr_b16 v[152:153], v7 offset:24576
    v_mfma_f32_16x16x32_bf16 v[56:59], v[192:195], v[168:171], v[56:59]
    ds_read_b64_tr_b16 v[154:155], v7 offset:25088
    v_mfma_f32_16x16x32_bf16 v[60:63], v[196:199], v[168:171], v[60:63]
    ds_read_b64_tr_b16 v[156:157], v8 offset:0
    v_mfma_f32_16x16x32_bf16 v[24:27], v[184:187], v[168:171], v[24:27]
    ds_read_b64_tr_b16 v[158:159], v8 offset:512
    v_mfma_f32_16x16x32_bf16 v[28:31], v[188:191], v[168:171], v[28:31]
    ds_read_b64_tr_b16 v[160:161], v9 offset:0
    v_mfma_f32_16x16x32_bf16 v[48:51], v[192:195], v[164:167], v[48:51]
    ds_read_b64_tr_b16 v[162:163], v9 offset:512
    v_mfma_f32_16x16x32_bf16 v[52:55], v[196:199], v[164:167], v[52:55]
    v_mfma_f32_16x16x32_bf16 v[16:19], v[184:187], v[164:167], v[16:19]
    v_mfma_f32_16x16x32_bf16 v[20:23], v[188:191], v[164:167], v[20:23]
    v_mfma_f32_16x16x32_bf16 v[96:99], v[172:175], v[200:203], v[96:99]
    v_mfma_f32_16x16x32_bf16 v[100:103], v[172:175], v[204:207], v[100:103]
    v_mfma_f32_16x16x32_bf16 v[88:91], v[168:171], v[200:203], v[88:91]
    v_mfma_f32_16x16x32_bf16 v[92:95], v[168:171], v[204:207], v[92:95]
    v_mfma_f32_16x16x32_bf16 v[80:83], v[164:167], v[200:203], v[80:83]
    v_mfma_f32_16x16x32_bf16 v[84:87], v[164:167], v[204:207], v[84:87]
    s_waitcnt lgkmcnt(0)
    v_mfma_f32_16x16x32_bf16 v[112:115], v[148:151], v[136:139], v[112:115]
    ds_read_b128 v[164:167], v5 offset:0
    v_mfma_f32_16x16x32_bf16 v[116:119], v[136:139], v[156:159], v[116:119]
    ds_read_b128 v[168:171], v5 offset:2048
    v_mfma_f32_16x16x32_bf16 v[72:75], v[148:151], v[132:135], v[72:75]
    ds_read_b128 v[172:175], v5 offset:4096
    v_mfma_f32_16x16x32_bf16 v[76:79], v[152:155], v[132:135], v[76:79]
    ds_read_b128 v[176:179], v5 offset:6144
    v_mfma_f32_16x16x32_bf16 v[104:107], v[132:135], v[156:159], v[104:107]
    ds_read_b128 v[180:183], v3 offset:0
    v_mfma_f32_16x16x32_bf16 v[108:111], v[132:135], v[160:163], v[108:111]
    ds_read_b64_tr_b16 v[184:185], v6 offset:4096
    v_mfma_f32_16x16x32_bf16 v[40:43], v[140:143], v[132:135], v[40:43]
    ds_read_b64_tr_b16 v[186:187], v6 offset:4608
    v_mfma_f32_16x16x32_bf16 v[44:47], v[144:147], v[132:135], v[44:47]
    ds_read_b64_tr_b16 v[188:189], v7 offset:4096
    v_mfma_f32_16x16x32_bf16 v[64:67], v[148:151], v[128:131], v[64:67]
    ds_read_b64_tr_b16 v[190:191], v7 offset:4608
    v_mfma_f32_16x16x32_bf16 v[68:71], v[152:155], v[128:131], v[68:71]
    ds_read_b64_tr_b16 v[192:193], v6 offset:28672
    v_mfma_f32_16x16x32_bf16 v[32:35], v[140:143], v[128:131], v[32:35]
    ds_read_b64_tr_b16 v[194:195], v6 offset:29184
    v_mfma_f32_16x16x32_bf16 v[36:39], v[144:147], v[128:131], v[36:39]
    ds_read_b64_tr_b16 v[196:197], v7 offset:28672
    v_mfma_f32_16x16x32_bf16 v[56:59], v[148:151], v[124:127], v[56:59]
    ds_read_b64_tr_b16 v[198:199], v7 offset:29184
    v_mfma_f32_16x16x32_bf16 v[60:63], v[152:155], v[124:127], v[60:63]
    ds_read_b64_tr_b16 v[200:201], v8 offset:4096
    v_mfma_f32_16x16x32_bf16 v[24:27], v[140:143], v[124:127], v[24:27]
    ds_read_b64_tr_b16 v[202:203], v8 offset:4608
    v_mfma_f32_16x16x32_bf16 v[28:31], v[144:147], v[124:127], v[28:31]
    ds_read_b64_tr_b16 v[204:205], v9 offset:4096
    v_mfma_f32_16x16x32_bf16 v[48:51], v[148:151], v[120:123], v[48:51]
    ds_read_b64_tr_b16 v[206:207], v9 offset:4608
    v_mfma_f32_16x16x32_bf16 v[52:55], v[152:155], v[120:123], v[52:55]
    v_and_b32 v223, 1, v0
    v_mfma_f32_16x16x32_bf16 v[16:19], v[140:143], v[120:123], v[16:19]
    v_lshlrev_b32 v223, 7, v223
    v_mfma_f32_16x16x32_bf16 v[20:23], v[144:147], v[120:123], v[20:23]
    buffer_load_dword v222, v223, s[68:71], 0 offen sc1
    v_mfma_f32_16x16x32_bf16 v[96:99], v[128:131], v[156:159], v[96:99]
    v_mfma_f32_16x16x32_bf16 v[100:103], v[128:131], v[160:163], v[100:103]
    v_mfma_f32_16x16x32_bf16 v[88:91], v[124:127], v[156:159], v[88:91]
    v_mfma_f32_16x16x32_bf16 v[92:95], v[124:127], v[160:163], v[92:95]
    v_mfma_f32_16x16x32_bf16 v[80:83], v[120:123], v[156:159], v[80:83]
    v_mfma_f32_16x16x32_bf16 v[84:87], v[120:123], v[160:163], v[84:87]
    s_waitcnt lgkmcnt(0)
    s_barrier
    v_mfma_f32_16x16x32_bf16 v[112:115], v[192:195], v[180:183], v[112:115]
    ds_read_b128 v[120:123], v4 offset:18432
    v_mfma_f32_16x16x32_bf16 v[116:119], v[180:183], v[200:203], v[116:119]
    ds_read_b128 v[124:127], v4 offset:20480
    v_mfma_f32_16x16x32_bf16 v[72:75], v[192:195], v[176:179], v[72:75]
    ds_read_b128 v[128:131], v4 offset:22528
    v_mfma_f32_16x16x32_bf16 v[76:79], v[196:199], v[176:179], v[76:79]
    ds_read_b128 v[132:135], v4 offset:24576
    v_mfma_f32_16x16x32_bf16 v[104:107], v[176:179], v[200:203], v[104:107]
    ds_read_b128 v[136:139], v2 offset:18432
    v_mfma_f32_16x16x32_bf16 v[108:111], v[176:179], v[204:207], v[108:111]
    ds_read_b64_tr_b16 v[140:141], v6 offset:8192
    v_mfma_f32_16x16x32_bf16 v[40:43], v[184:187], v[176:179], v[40:43]
    ds_read_b64_tr_b16 v[142:143], v6 offset:8704
    v_mfma_f32_16x16x32_bf16 v[44:47], v[188:191], v[176:179], v[44:47]
    ds_read_b64_tr_b16 v[144:145], v7 offset:8192
    v_mfma_f32_16x16x32_bf16 v[64:67], v[192:195], v[172:175], v[64:67]
    ds_read_b64_tr_b16 v[146:147], v7 offset:8704
    v_mfma_f32_16x16x32_bf16 v[68:71], v[196:199], v[172:175], v[68:71]
    ds_read_b64_tr_b16 v[148:149], v6 offset:32768
    v_mfma_f32_16x16x32_bf16 v[32:35], v[184:187], v[172:175], v[32:35]
    ds_read_b64_tr_b16 v[150:151], v6 offset:33280
    v_mfma_f32_16x16x32_bf16 v[36:39], v[188:191], v[172:175], v[36:39]
    ds_read_b64_tr_b16 v[152:153], v7 offset:32768
    v_mfma_f32_16x16x32_bf16 v[56:59], v[192:195], v[168:171], v[56:59]
    ds_read_b64_tr_b16 v[154:155], v7 offset:33280
    v_mfma_f32_16x16x32_bf16 v[60:63], v[196:199], v[168:171], v[60:63]
    ds_read_b64_tr_b16 v[156:157], v8 offset:8192
    v_mfma_f32_16x16x32_bf16 v[24:27], v[184:187], v[168:171], v[24:27]
    ds_read_b64_tr_b16 v[158:159], v8 offset:8704
    v_mfma_f32_16x16x32_bf16 v[28:31], v[188:191], v[168:171], v[28:31]
    ds_read_b64_tr_b16 v[160:161], v9 offset:8192
    v_mfma_f32_16x16x32_bf16 v[48:51], v[192:195], v[164:167], v[48:51]
    ds_read_b64_tr_b16 v[162:163], v9 offset:8704
    v_mfma_f32_16x16x32_bf16 v[52:55], v[196:199], v[164:167], v[52:55]
    v_mfma_f32_16x16x32_bf16 v[16:19], v[184:187], v[164:167], v[16:19]
    v_mfma_f32_16x16x32_bf16 v[20:23], v[188:191], v[164:167], v[20:23]
    v_mfma_f32_16x16x32_bf16 v[96:99], v[172:175], v[200:203], v[96:99]
    v_mfma_f32_16x16x32_bf16 v[100:103], v[172:175], v[204:207], v[100:103]
    v_mfma_f32_16x16x32_bf16 v[88:91], v[168:171], v[200:203], v[88:91]
    v_mfma_f32_16x16x32_bf16 v[92:95], v[168:171], v[204:207], v[92:95]
    v_mfma_f32_16x16x32_bf16 v[80:83], v[164:167], v[200:203], v[80:83]
    v_mfma_f32_16x16x32_bf16 v[84:87], v[164:167], v[204:207], v[84:87]
    s_waitcnt lgkmcnt(0)
    v_mfma_f32_16x16x32_bf16 v[112:115], v[148:151], v[136:139], v[112:115]
    ds_read_b128 v[164:167], v5 offset:18432
    v_mfma_f32_16x16x32_bf16 v[116:119], v[136:139], v[156:159], v[116:119]
    ds_read_b128 v[168:171], v5 offset:20480
    v_mfma_f32_16x16x32_bf16 v[72:75], v[148:151], v[132:135], v[72:75]
    ds_read_b128 v[172:175], v5 offset:22528
    v_mfma_f32_16x16x32_bf16 v[76:79], v[152:155], v[132:135], v[76:79]
    ds_read_b128 v[176:179], v5 offset:24576
    v_mfma_f32_16x16x32_bf16 v[104:107], v[132:135], v[156:159], v[104:107]
    ds_read_b128 v[180:183], v3 offset:18432
    v_mfma_f32_16x16x32_bf16 v[108:111], v[132:135], v[160:163], v[108:111]
    ds_read_b64_tr_b16 v[184:185], v6 offset:12288
    v_mfma_f32_16x16x32_bf16 v[40:43], v[140:143], v[132:135], v[40:43]
    ds_read_b64_tr_b16 v[186:187], v6 offset:12800
    v_mfma_f32_16x16x32_bf16 v[44:47], v[144:147], v[132:135], v[44:47]
    ds_read_b64_tr_b16 v[188:189], v7 offset:12288
    v_mfma_f32_16x16x32_bf16 v[64:67], v[148:151], v[128:131], v[64:67]
    ds_read_b64_tr_b16 v[190:191], v7 offset:12800
    v_mfma_f32_16x16x32_bf16 v[68:71], v[152:155], v[128:131], v[68:71]
    ds_read_b64_tr_b16 v[192:193], v6 offset:36864
    v_mfma_f32_16x16x32_bf16 v[32:35], v[140:143], v[128:131], v[32:35]
    ds_read_b64_tr_b16 v[194:195], v6 offset:37376
    v_mfma_f32_16x16x32_bf16 v[36:39], v[144:147], v[128:131], v[36:39]
    ds_read_b64_tr_b16 v[196:197], v7 offset:36864
    v_mfma_f32_16x16x32_bf16 v[56:59], v[148:151], v[124:127], v[56:59]
    ds_read_b64_tr_b16 v[198:199], v7 offset:37376
    v_mfma_f32_16x16x32_bf16 v[60:63], v[152:155], v[124:127], v[60:63]
    ds_read_b64_tr_b16 v[200:201], v8 offset:12288
    v_mfma_f32_16x16x32_bf16 v[24:27], v[140:143], v[124:127], v[24:27]
    ds_read_b64_tr_b16 v[202:203], v8 offset:12800
    v_mfma_f32_16x16x32_bf16 v[28:31], v[144:147], v[124:127], v[28:31]
    ds_read_b64_tr_b16 v[204:205], v9 offset:12288
    v_mfma_f32_16x16x32_bf16 v[48:51], v[148:151], v[120:123], v[48:51]
    ds_read_b64_tr_b16 v[206:207], v9 offset:12800
    v_mfma_f32_16x16x32_bf16 v[52:55], v[152:155], v[120:123], v[52:55]
    v_mfma_f32_16x16x32_bf16 v[16:19], v[140:143], v[120:123], v[16:19]
    v_mfma_f32_16x16x32_bf16 v[20:23], v[144:147], v[120:123], v[20:23]
    v_mfma_f32_16x16x32_bf16 v[96:99], v[128:131], v[156:159], v[96:99]
    v_mfma_f32_16x16x32_bf16 v[100:103], v[128:131], v[160:163], v[100:103]
    v_mfma_f32_16x16x32_bf16 v[88:91], v[124:127], v[156:159], v[88:91]
    v_mfma_f32_16x16x32_bf16 v[92:95], v[124:127], v[160:163], v[92:95]
    v_mfma_f32_16x16x32_bf16 v[80:83], v[120:123], v[156:159], v[80:83]
    v_mfma_f32_16x16x32_bf16 v[84:87], v[120:123], v[160:163], v[84:87]
    s_waitcnt lgkmcnt(0)
    s_barrier
    v_mfma_f32_16x16x32_bf16 v[112:115], v[192:195], v[180:183], v[112:115]
    ds_read_b128 v[120:123], v4 offset:36864
    v_mfma_f32_16x16x32_bf16 v[116:119], v[180:183], v[200:203], v[116:119]
    ds_read_b128 v[124:127], v4 offset:38912
    v_mfma_f32_16x16x32_bf16 v[72:75], v[192:195], v[176:179], v[72:75]
    ds_read_b128 v[128:131], v4 offset:40960
    v_mfma_f32_16x16x32_bf16 v[76:79], v[196:199], v[176:179], v[76:79]
    ds_read_b128 v[132:135], v4 offset:43008
    v_mfma_f32_16x16x32_bf16 v[104:107], v[176:179], v[200:203], v[104:107]
    ds_read_b128 v[136:139], v2 offset:36864
    v_mfma_f32_16x16x32_bf16 v[108:111], v[176:179], v[204:207], v[108:111]
    ds_read_b64_tr_b16 v[140:141], v6 offset:16384
    v_mfma_f32_16x16x32_bf16 v[40:43], v[184:187], v[176:179], v[40:43]
    ds_read_b64_tr_b16 v[142:143], v6 offset:16896
    v_mfma_f32_16x16x32_bf16 v[44:47], v[188:191], v[176:179], v[44:47]
    ds_read_b64_tr_b16 v[144:145], v7 offset:16384
    v_mfma_f32_16x16x32_bf16 v[64:67], v[192:195], v[172:175], v[64:67]
    ds_read_b64_tr_b16 v[146:147], v7 offset:16896
    v_mfma_f32_16x16x32_bf16 v[68:71], v[196:199], v[172:175], v[68:71]
    ds_read_b64_tr_b16 v[148:149], v6 offset:40960
    v_mfma_f32_16x16x32_bf16 v[32:35], v[184:187], v[172:175], v[32:35]
    ds_read_b64_tr_b16 v[150:151], v6 offset:41472
    v_mfma_f32_16x16x32_bf16 v[36:39], v[188:191], v[172:175], v[36:39]
    ds_read_b64_tr_b16 v[152:153], v7 offset:40960
    v_mfma_f32_16x16x32_bf16 v[56:59], v[192:195], v[168:171], v[56:59]
    ds_read_b64_tr_b16 v[154:155], v7 offset:41472
    v_mfma_f32_16x16x32_bf16 v[60:63], v[196:199], v[168:171], v[60:63]
    ds_read_b64_tr_b16 v[156:157], v8 offset:16384
    v_mfma_f32_16x16x32_bf16 v[24:27], v[184:187], v[168:171], v[24:27]
    ds_read_b64_tr_b16 v[158:159], v8 offset:16896
    v_mfma_f32_16x16x32_bf16 v[28:31], v[188:191], v[168:171], v[28:31]
    ds_read_b64_tr_b16 v[160:161], v9 offset:16384
    v_mfma_f32_16x16x32_bf16 v[48:51], v[192:195], v[164:167], v[48:51]
    ds_read_b64_tr_b16 v[162:163], v9 offset:16896
    v_mfma_f32_16x16x32_bf16 v[52:55], v[196:199], v[164:167], v[52:55]
    v_mfma_f32_16x16x32_bf16 v[16:19], v[184:187], v[164:167], v[16:19]
    v_mfma_f32_16x16x32_bf16 v[20:23], v[188:191], v[164:167], v[20:23]
    v_mfma_f32_16x16x32_bf16 v[96:99], v[172:175], v[200:203], v[96:99]
    v_mfma_f32_16x16x32_bf16 v[100:103], v[172:175], v[204:207], v[100:103]
    v_mfma_f32_16x16x32_bf16 v[88:91], v[168:171], v[200:203], v[88:91]
    v_mfma_f32_16x16x32_bf16 v[92:95], v[168:171], v[204:207], v[92:95]
    v_mfma_f32_16x16x32_bf16 v[80:83], v[164:167], v[200:203], v[80:83]
    v_mfma_f32_16x16x32_bf16 v[84:87], v[164:167], v[204:207], v[84:87]
    s_waitcnt lgkmcnt(0)
    v_mfma_f32_16x16x32_bf16 v[112:115], v[148:151], v[136:139], v[112:115]
    ds_read_b128 v[164:167], v5 offset:36864
    v_mfma_f32_16x16x32_bf16 v[116:119], v[136:139], v[156:159], v[116:119]
    ds_read_b128 v[168:171], v5 offset:38912
    v_mfma_f32_16x16x32_bf16 v[72:75], v[148:151], v[132:135], v[72:75]
    ds_read_b128 v[172:175], v5 offset:40960
    v_mfma_f32_16x16x32_bf16 v[76:79], v[152:155], v[132:135], v[76:79]
    ds_read_b128 v[176:179], v5 offset:43008
    v_mfma_f32_16x16x32_bf16 v[104:107], v[132:135], v[156:159], v[104:107]
    ds_read_b128 v[180:183], v3 offset:36864
    v_mfma_f32_16x16x32_bf16 v[108:111], v[132:135], v[160:163], v[108:111]
    ds_read_b64_tr_b16 v[184:185], v6 offset:20480
    v_mfma_f32_16x16x32_bf16 v[40:43], v[140:143], v[132:135], v[40:43]
    ds_read_b64_tr_b16 v[186:187], v6 offset:20992
    v_mfma_f32_16x16x32_bf16 v[44:47], v[144:147], v[132:135], v[44:47]
    ds_read_b64_tr_b16 v[188:189], v7 offset:20480
    v_mfma_f32_16x16x32_bf16 v[64:67], v[148:151], v[128:131], v[64:67]
    ds_read_b64_tr_b16 v[190:191], v7 offset:20992
    v_mfma_f32_16x16x32_bf16 v[68:71], v[152:155], v[128:131], v[68:71]
    ds_read_b64_tr_b16 v[192:193], v6 offset:45056
    v_mfma_f32_16x16x32_bf16 v[32:35], v[140:143], v[128:131], v[32:35]
    ds_read_b64_tr_b16 v[194:195], v6 offset:45568
    v_mfma_f32_16x16x32_bf16 v[36:39], v[144:147], v[128:131], v[36:39]
    ds_read_b64_tr_b16 v[196:197], v7 offset:45056
    v_mfma_f32_16x16x32_bf16 v[56:59], v[148:151], v[124:127], v[56:59]
    ds_read_b64_tr_b16 v[198:199], v7 offset:45568
    v_mfma_f32_16x16x32_bf16 v[60:63], v[152:155], v[124:127], v[60:63]
    ds_read_b64_tr_b16 v[200:201], v8 offset:20480
    v_mfma_f32_16x16x32_bf16 v[24:27], v[140:143], v[124:127], v[24:27]
    ds_read_b64_tr_b16 v[202:203], v8 offset:20992
    v_mfma_f32_16x16x32_bf16 v[28:31], v[144:147], v[124:127], v[28:31]
    ds_read_b64_tr_b16 v[204:205], v9 offset:20480
    v_mfma_f32_16x16x32_bf16 v[48:51], v[148:151], v[120:123], v[48:51]
    ds_read_b64_tr_b16 v[206:207], v9 offset:20992
    v_mfma_f32_16x16x32_bf16 v[52:55], v[152:155], v[120:123], v[52:55]
    v_mfma_f32_16x16x32_bf16 v[16:19], v[140:143], v[120:123], v[16:19]
    v_mfma_f32_16x16x32_bf16 v[20:23], v[144:147], v[120:123], v[20:23]
    v_mfma_f32_16x16x32_bf16 v[96:99], v[128:131], v[156:159], v[96:99]
    v_mfma_f32_16x16x32_bf16 v[100:103], v[128:131], v[160:163], v[100:103]
    v_mfma_f32_16x16x32_bf16 v[88:91], v[124:127], v[156:159], v[88:91]
    v_mfma_f32_16x16x32_bf16 v[92:95], v[124:127], v[160:163], v[92:95]
    v_mfma_f32_16x16x32_bf16 v[80:83], v[120:123], v[156:159], v[80:83]
    v_mfma_f32_16x16x32_bf16 v[84:87], v[120:123], v[160:163], v[84:87]
    s_waitcnt vmcnt(0)
    v_cmp_ne_u32 vcc, 128, v222
    s_cbranch_vccnz LB_slow11
LB_back11:
    s_waitcnt lgkmcnt(0)
    s_barrier
    v_mfma_f32_16x16x32_bf16 v[112:115], v[192:195], v[180:183], v[112:115]
    ds_read_b128 v[120:123], v4 offset:0
    v_mfma_f32_16x16x32_bf16 v[116:119], v[180:183], v[200:203], v[116:119]
    ds_read_b128 v[124:127], v4 offset:2048
    v_mfma_f32_16x16x32_bf16 v[72:75], v[192:195], v[176:179], v[72:75]
    ds_read_b128 v[128:131], v4 offset:4096
    v_mfma_f32_16x16x32_bf16 v[76:79], v[196:199], v[176:179], v[76:79]
    ds_read_b128 v[132:135], v4 offset:6144
    v_mfma_f32_16x16x32_bf16 v[104:107], v[176:179], v[200:203], v[104:107]
    ds_read_b128 v[136:139], v2 offset:0
    v_mfma_f32_16x16x32_bf16 v[108:111], v[176:179], v[204:207], v[108:111]
    ds_read_b64_tr_b16 v[140:141], v6 offset:0
    v_mfma_f32_16x16x32_bf16 v[40:43], v[184:187], v[176:179], v[40:43]
    ds_read_b64_tr_b16 v[142:143], v6 offset:512
    v_mfma_f32_16x16x32_bf16 v[44:47], v[188:191], v[176:179], v[44:47]
    ds_read_b64_tr_b16 v[144:145], v7 offset:0
    v_mfma_f32_16x16x32_bf16 v[64:67], v[192:195], v[172:175], v[64:67]
    ds_read_b64_tr_b16 v[146:147], v7 offset:512
    v_mfma_f32_16x16x32_bf16 v[68:71], v[196:199], v[172:175], v[68:71]
    ds_read_b64_tr_b16 v[148:149], v6 offset:24576
    v_mfma_f32_16x16x32_bf16 v[32:35], v[184:187], v[172:175], v[32:35]
    ds_read_b64_tr_b16 v[150:151], v6 offset:25088
    v_mfma_f32_16x16x32_bf16 v[36:39], v[188:191], v[172:175], v[36:39]
    ds_read_b64_tr_b16 v[152:153], v7 offset:24576
    v_mfma_f32_16x16x32_bf16 v[56:59], v[192:195], v[168:171], v[56:59]
    ds_read_b64_tr_b16 v[154:155], v7 offset:25088
    v_mfma_f32_16x16x32_bf16 v[60:63], v[196:199], v[168:171], v[60:63]
    ds_read_b64_tr_b16 v[156:157], v8 offset:0
    v_mfma_f32_16x16x32_bf16 v[24:27], v[184:187], v[168:171], v[24:27]
    ds_read_b64_tr_b16 v[158:159], v8 offset:512
    v_mfma_f32_16x16x32_bf16 v[28:31], v[188:191], v[168:171], v[28:31]
    ds_read_b64_tr_b16 v[160:161], v9 offset:0
    v_mfma_f32_16x16x32_bf16 v[48:51], v[192:195], v[164:167], v[48:51]
    ds_read_b64_tr_b16 v[162:163], v9 offset:512
    v_mfma_f32_16x16x32_bf16 v[52:55], v[196:199], v[164:167], v[52:55]
    v_mfma_f32_16x16x32_bf16 v[16:19], v[184:187], v[164:167], v[16:19]
    v_mfma_f32_16x16x32_bf16 v[20:23], v[188:191], v[164:167], v[20:23]
    v_mfma_f32_16x16x32_bf16 v[96:99], v[172:175], v[200:203], v[96:99]
    v_mfma_f32_16x16x32_bf16 v[100:103], v[172:175], v[204:207], v[100:103]
    v_mfma_f32_16x16x32_bf16 v[88:91], v[168:171], v[200:203], v[88:91]
    v_mfma_f32_16x16x32_bf16 v[92:95], v[168:171], v[204:207], v[92:95]
    v_mfma_f32_16x16x32_bf16 v[80:83], v[164:167], v[200:203], v[80:83]
    v_mfma_f32_16x16x32_bf16 v[84:87], v[164:167], v[204:207], v[84:87]
    s_waitcnt lgkmcnt(0)
    v_mfma_f32_16x16x32_bf16 v[112:115], v[148:151], v[136:139], v[112:115]
    ds_read_b128 v[164:167], v5 offset:0
    v_mfma_f32_16x16x32_bf16 v[116:119], v[136:139], v[156:159], v[116:119]
    ds_read_b128 v[168:171], v5 offset:2048
    v_mfma_f32_16x16x32_bf16 v[72:75], v[148:151], v[132:135], v[72:75]
    ds_read_b128 v[172:175], v5 offset:4096
    v_mfma_f32_16x16x32_bf16 v[76:79], v[152:155], v[132:135], v[76:79]
    ds_read_b128 v[176:179], v5 offset:6144
    v_mfma_f32_16x16x32_bf16 v[104:107], v[132:135], v[156:159], v[104:107]
    ds_read_b128 v[180:183], v3 offset:0
    v_mfma_f32_16x16x32_bf16 v[108:111], v[132:135], v[160:163], v[108:111]
    ds_read_b64_tr_b16 v[184:185], v6 offset:4096
    v_mfma_f32_16x16x32_bf16 v[40:43], v[140:143], v[132:135], v[40:43]
    ds_read_b64_tr_b16 v[186:187], v6 offset:4608
    v_mfma_f32_16x16x32_bf16 v[44:47], v[144:147], v[132:135], v[44:47]
    ds_read_b64_tr_b16 v[188:189], v7 offset:4096
    v_mfma_f32_16x16x32_bf16 v[64:67], v[148:151], v[128:131], v[64:67]
    ds_read_b64_tr_b16 v[190:191], v7 offset:4608
    v_mfma_f32_16x16x32_bf16 v[68:71], v[152:155], v[128:131], v[68:71]
    ds_read_b64_tr_b16 v[192:193], v6 offset:28672
    v_mfma_f32_16x16x32_bf16 v[32:35], v[140:143], v[128:131], v[32:35]
    ds_read_b64_tr_b16 v[194:195], v6 offset:29184
    v_mfma_f32_16x16x32_bf16 v[36:39], v[144:147], v[128:131], v[36:39]
    ds_read_b64_tr_b16 v[196:197], v7 offset:28672
    v_mfma_f32_16x16x32_bf16 v[56:59], v[148:151], v[124:127], v[56:59]
    ds_read_b64_tr_b16 v[198:199], v7 offset:29184
    v_mfma_f32_16x16x32_bf16 v[60:63], v[152:155], v[124:127], v[60:63]
    ds_read_b64_tr_b16 v[200:201], v8 offset:4096
    v_mfma_f32_16x16x32_bf16 v[24:27], v[140:143], v[124:127], v[24:27]
    ds_read_b64_tr_b16 v[202:203], v8 offset:4608
    v_mfma_f32_16x16x32_bf16 v[28:31], v[144:147], v[124:127], v[28:31]
    ds_read_b64_tr_b16 v[204:205], v9 offset:4096
    v_mfma_f32_16x16x32_bf16 v[48:51], v[148:151], v[120:123], v[48:51]
    ds_read_b64_tr_b16 v[206:207], v9 offset:4608
    v_mfma_f32_16x16x32_bf16 v[52:55], v[152:155], v[120:123], v[52:55]
    v_and_b32 v223, 15, v0
    v_mfma_f32_16x16x32_bf16 v[16:19], v[140:143], v[120:123], v[16:19]
    v_lshlrev_b32 v223, 2, v223
    v_mfma_f32_16x16x32_bf16 v[20:23], v[144:147], v[120:123], v[20:23]
    buffer_load_dword v222, v223, s[52:55], s96 offen sc1
    v_mfma_f32_16x16x32_bf16 v[96:99], v[128:131], v[156:159], v[96:99]
    v_mfma_f32_16x16x32_bf16 v[100:103], v[128:131], v[160:163], v[100:103]
    v_mfma_f32_16x16x32_bf16 v[88:91], v[124:127], v[156:159], v[88:91]
    v_mfma_f32_16x16x32_bf16 v[92:95], v[124:127], v[160:163], v[92:95]
    v_mfma_f32_16x16x32_bf16 v[80:83], v[120:123], v[156:159], v[80:83]
    v_mfma_f32_16x16x32_bf16 v[84:87], v[120:123], v[160:163], v[84:87]
    s_waitcnt lgkmcnt(0)
    s_barrier
    v_mfma_f32_16x16x32_bf16 v[112:115], v[192:195], v[180:183], v[112:115]
    ds_read_b128 v[120:123], v4 offset:18432
    v_mfma_f32_16x16x32_bf16 v[116:119], v[180:183], v[200:203], v[116:119]
    ds_read_b128 v[124:127], v4 offset:20480
    v_mfma_f32_16x16x32_bf16 v[72:75], v[192:195], v[176:179], v[72:75]
    ds_read_b128 v[128:131], v4 offset:22528
    v_mfma_f32_16x16x32_bf16 v[76:79], v[196:199], v[176:179], v[76:79]
    ds_read_b128 v[132:135], v4 offset:24576
    v_mfma_f32_16x16x32_bf16 v[104:107], v[176:179], v[200:203], v[104:107]
    ds_read_b128 v[136:139], v2 offset:18432
    v_mfma_f32_16x16x32_bf16 v[108:111], v[176:179], v[204:207], v[108:111]
    ds_read_b64_tr_b16 v[140:141], v6 offset:8192
    v_mfma_f32_16x16x32_bf16 v[40:43], v[184:187], v[176:179], v[40:43]
    ds_read_b64_tr_b16 v[142:143], v6 offset:8704
    v_mfma_f32_16x16x32_bf16 v[44:47], v[188:191], v[176:179], v[44:47]
    ds_read_b64_tr_b16 v[144:145], v7 offset:8192
    v_mfma_f32_16x16x32_bf16 v[64:67], v[192:195], v[172:175], v[64:67]
    ds_read_b64_tr_b16 v[146:147], v7 offset:8704
    v_mfma_f32_16x16x32_bf16 v[68:71], v[196:199], v[172:175], v[68:71]
    ds_read_b64_tr_b16 v[148:149], v6 offset:32768
    v_mfma_f32_16x16x32_bf16 v[32:35], v[184:187], v[172:175], v[32:35]
    ds_read_b64_tr_b16 v[150:151], v6 offset:33280
    v_mfma_f32_16x16x32_bf16 v[36:39], v[188:191], v[172:175], v[36:39]
    ds_read_b64_tr_b16 v[152:153], v7 offset:32768
    v_mfma_f32_16x16x32_bf16 v[56:59], v[192:195], v[168:171], v[56:59]
    ds_read_b64_tr_b16 v[154:155], v7 offset:33280
    v_mfma_f32_16x16x32_bf16 v[60:63], v[196:199], v[168:171], v[60:63]
    ds_read_b64_tr_b16 v[156:157], v8 offset:8192
    v_mfma_f32_16x16x32_bf16 v[24:27], v[184:187], v[168:171], v[24:27]
    ds_read_b64_tr_b16 v[158:159], v8 offset:8704
    v_mfma_f32_16x16x32_bf16 v[28:31], v[188:191], v[168:171], v[28:31]
    ds_read_b64_tr_b16 v[160:161], v9 offset:8192
    v_mfma_f32_16x16x32_bf16 v[48:51], v[192:195], v[164:167], v[48:51]
    ds_read_b64_tr_b16 v[162:163], v9 offset:8704
    v_mfma_f32_16x16x32_bf16 v[52:55], v[196:199], v[164:167], v[52:55]
    v_mfma_f32_16x16x32_bf16 v[16:19], v[184:187], v[164:167], v[16:19]
    v_mfma_f32_16x16x32_bf16 v[20:23], v[188:191], v[164:167], v[20:23]
    v_mfma_f32_16x16x32_bf16 v[96:99], v[172:175], v[200:203], v[96:99]
    v_mfma_f32_16x16x32_bf16 v[100:103], v[172:175], v[204:207], v[100:103]
    v_mfma_f32_16x16x32_bf16 v[88:91], v[168:171], v[200:203], v[88:91]
    v_mfma_f32_16x16x32_bf16 v[92:95], v[168:171], v[204:207], v[92:95]
    v_mfma_f32_16x16x32_bf16 v[80:83], v[164:167], v[200:203], v[80:83]
    v_mfma_f32_16x16x32_bf16 v[84:87], v[164:167], v[204:207], v[84:87]
    s_waitcnt lgkmcnt(0)
    v_mfma_f32_16x16x32_bf16 v[112:115], v[148:151], v[136:139], v[112:115]
    ds_read_b128 v[164:167], v5 offset:18432
    v_mfma_f32_16x16x32_bf16 v[116:119], v[136:139], v[156:159], v[116:119]
    ds_read_b128 v[168:171], v5 offset:20480
    v_mfma_f32_16x16x32_bf16 v[72:75], v[148:151], v[132:135], v[72:75]
    ds_read_b128 v[172:175], v5 offset:22528
    v_mfma_f32_16x16x32_bf16 v[76:79], v[152:155], v[132:135], v[76:79]
    ds_read_b128 v[176:179], v5 offset:24576
    v_mfma_f32_16x16x32_bf16 v[104:107], v[132:135], v[156:159], v[104:107]
    ds_read_b128 v[180:183], v3 offset:18432
    v_mfma_f32_16x16x32_bf16 v[108:111], v[132:135], v[160:163], v[108:111]
    ds_read_b64_tr_b16 v[184:185], v6 offset:12288
    v_mfma_f32_16x16x32_bf16 v[40:43], v[140:143], v[132:135], v[40:43]
    ds_read_b64_tr_b16 v[186:187], v6 offset:12800
    v_mfma_f32_16x16x32_bf16 v[44:47], v[144:147], v[132:135], v[44:47]
    ds_read_b64_tr_b16 v[188:189], v7 offset:12288
    v_mfma_f32_16x16x32_bf16 v[64:67], v[148:151], v[128:131], v[64:67]
    ds_read_b64_tr_b16 v[190:191], v7 offset:12800
    v_mfma_f32_16x16x32_bf16 v[68:71], v[152:155], v[128:131], v[68:71]
    ds_read_b64_tr_b16 v[192:193], v6 offset:36864
    v_mfma_f32_16x16x32_bf16 v[32:35], v[140:143], v[128:131], v[32:35]
    ds_read_b64_tr_b16 v[194:195], v6 offset:37376
    v_mfma_f32_16x16x32_bf16 v[36:39], v[144:147], v[128:131], v[36:39]
    ds_read_b64_tr_b16 v[196:197], v7 offset:36864
    v_mfma_f32_16x16x32_bf16 v[56:59], v[148:151], v[124:127], v[56:59]
    ds_read_b64_tr_b16 v[198:199], v7 offset:37376
    v_mfma_f32_16x16x32_bf16 v[60:63], v[152:155], v[124:127], v[60:63]
    ds_read_b64_tr_b16 v[200:201], v8 offset:12288
    v_mfma_f32_16x16x32_bf16 v[24:27], v[140:143], v[124:127], v[24:27]
    ds_read_b64_tr_b16 v[202:203], v8 offset:12800
    v_mfma_f32_16x16x32_bf16 v[28:31], v[144:147], v[124:127], v[28:31]
    ds_read_b64_tr_b16 v[204:205], v9 offset:12288
    v_mfma_f32_16x16x32_bf16 v[48:51], v[148:151], v[120:123], v[48:51]
    ds_read_b64_tr_b16 v[206:207], v9 offset:12800
    v_mfma_f32_16x16x32_bf16 v[52:55], v[152:155], v[120:123], v[52:55]
    v_mfma_f32_16x16x32_bf16 v[16:19], v[140:143], v[120:123], v[16:19]
    v_mfma_f32_16x16x32_bf16 v[20:23], v[144:147], v[120:123], v[20:23]
    v_mfma_f32_16x16x32_bf16 v[96:99], v[128:131], v[156:159], v[96:99]
    v_mfma_f32_16x16x32_bf16 v[100:103], v[128:131], v[160:163], v[100:103]
    v_mfma_f32_16x16x32_bf16 v[88:91], v[124:127], v[156:159], v[88:91]
    v_mfma_f32_16x16x32_bf16 v[92:95], v[124:127], v[160:163], v[92:95]
    v_mfma_f32_16x16x32_bf16 v[80:83], v[120:123], v[156:159], v[80:83]
    v_mfma_f32_16x16x32_bf16 v[84:87], v[120:123], v[160:163], v[84:87]
    s_waitcnt vmcnt(0)
    v_cmp_ne_u32 vcc, 1, v222
    s_cbranch_vccnz LB_slow13
LB_back13:
    s_waitcnt lgkmcnt(0)
    s_barrier
    v_mfma_f32_16x16x32_bf16 v[112:115], v[192:195], v[180:183], v[112:115]
    ds_read_b128 v[120:123], v4 offset:36864
    v_mfma_f32_16x16x32_bf16 v[116:119], v[180:183], v[200:203], v[116:119]
    ds_read_b128 v[124:127], v4 offset:38912
    v_mfma_f32_16x16x32_bf16 v[72:75], v[192:195], v[176:179], v[72:75]
    ds_read_b128 v[128:131], v4 offset:40960
    v_mfma_f32_16x16x32_bf16 v[76:79], v[196:199], v[176:179], v[76:79]
    ds_read_b128 v[132:135], v4 offset:43008
    v_mfma_f32_16x16x32_bf16 v[104:107], v[176:179], v[200:203], v[104:107]
    ds_read_b128 v[136:139], v2 offset:36864
    v_mfma_f32_16x16x32_bf16 v[108:111], v[176:179], v[204:207], v[108:111]
    ds_read_b64_tr_b16 v[140:141], v6 offset:16384
    v_mfma_f32_16x16x32_bf16 v[40:43], v[184:187], v[176:179], v[40:43]
    ds_read_b64_tr_b16 v[142:143], v6 offset:16896
    v_mfma_f32_16x16x32_bf16 v[44:47], v[188:191], v[176:179], v[44:47]
    ds_read_b64_tr_b16 v[144:145], v7 offset:16384
    v_mfma_f32_16x16x32_bf16 v[64:67], v[192:195], v[172:175], v[64:67]
    ds_read_b64_tr_b16 v[146:147], v7 offset:16896
    v_mfma_f32_16x16x32_bf16 v[68:71], v[196:199], v[172:175], v[68:71]
    ds_read_b64_tr_b16 v[148:149], v6 offset:40960
    v_mfma_f32_16x16x32_bf16 v[32:35], v[184:187], v[172:175], v[32:35]
    ds_read_b64_tr_b16 v[150:151], v6 offset:41472
    v_mfma_f32_16x16x32_bf16 v[36:39], v[188:191], v[172:175], v[36:39]
    ds_read_b64_tr_b16 v[152:153], v7 offset:40960
    v_mfma_f32_16x16x32_bf16 v[56:59], v[192:195], v[168:171], v[56:59]
    ds_read_b64_tr_b16 v[154:155], v7 offset:41472
    v_mfma_f32_16x16x32_bf16 v[60:63], v[196:199], v[168:171], v[60:63]
    ds_read_b64_tr_b16 v[156:157], v8 offset:16384
    v_mfma_f32_16x16x32_bf16 v[24:27], v[184:187], v[168:171], v[24:27]
    ds_read_b64_tr_b16 v[158:159], v8 offset:16896
    v_mfma_f32_16x16x32_bf16 v[28:31], v[188:191], v[168:171], v[28:31]
    ds_read_b64_tr_b16 v[160:161], v9 offset:16384
    v_mfma_f32_16x16x32_bf16 v[48:51], v[192:195], v[164:167], v[48:51]
    ds_read_b64_tr_b16 v[162:163], v9 offset:16896
    v_mfma_f32_16x16x32_bf16 v[52:55], v[196:199], v[164:167], v[52:55]
    v_mfma_f32_16x16x32_bf16 v[16:19], v[184:187], v[164:167], v[16:19]
    v_mfma_f32_16x16x32_bf16 v[20:23], v[188:191], v[164:167], v[20:23]
    v_mfma_f32_16x16x32_bf16 v[96:99], v[172:175], v[200:203], v[96:99]
    v_mfma_f32_16x16x32_bf16 v[100:103], v[172:175], v[204:207], v[100:103]
    v_mfma_f32_16x16x32_bf16 v[88:91], v[168:171], v[200:203], v[88:91]
    v_mfma_f32_16x16x32_bf16 v[92:95], v[168:171], v[204:207], v[92:95]
    v_mfma_f32_16x16x32_bf16 v[80:83], v[164:167], v[200:203], v[80:83]
    v_mfma_f32_16x16x32_bf16 v[84:87], v[164:167], v[204:207], v[84:87]
    s_waitcnt lgkmcnt(0)
    v_mfma_f32_16x16x32_bf16 v[112:115], v[148:151], v[136:139], v[112:115]
    ds_read_b128 v[164:167], v5 offset:36864
    v_mfma_f32_16x16x32_bf16 v[116:119], v[136:139], v[156:159], v[116:119]
    ds_read_b128 v[168:171], v5 offset:38912
    v_mfma_f32_16x16x32_bf16 v[72:75], v[148:151], v[132:135], v[72:75]
    ds_read_b128 v[172:175], v5 offset:40960
    v_mfma_f32_16x16x32_bf16 v[76:79], v[152:155], v[132:135], v[76:79]
    ds_read_b128 v[176:179], v5 offset:43008
    v_mfma_f32_16x16x32_bf16 v[104:107], v[132:135], v[156:159], v[104:107]
    ds_read_b128 v[180:183], v3 offset:36864
    v_mfma_f32_16x16x32_bf16 v[108:111], v[132:135], v[160:163], v[108:111]
    ds_read_b64_tr_b16 v[184:185], v6 offset:20480
    v_mfma_f32_16x16x32_bf16 v[40:43], v[140:143], v[132:135], v[40:43]
    ds_read_b64_tr_b16 v[186:187], v6 offset:20992
    v_mfma_f32_16x16x32_bf16 v[44:47], v[144:147], v[132:135], v[44:47]
    ds_read_b64_tr_b16 v[188:189], v7 offset:20480
    v_mfma_f32_16x16x32_bf16 v[64:67], v[148:151], v[128:131], v[64:67]
    ds_read_b64_tr_b16 v[190:191], v7 offset:20992
    v_mfma_f32_16x16x32_bf16 v[68:71], v[152:155], v[128:131], v[68:71]
    ds_read_b64_tr_b16 v[192:193], v6 offset:45056
    v_mfma_f32_16x16x32_bf16 v[32:35], v[140:143], v[128:131], v[32:35]
    ds_read_b64_tr_b16 v[194:195], v6 offset:45568
    v_mfma_f32_16x16x32_bf16 v[36:39], v[144:147], v[128:131], v[36:39]
    ds_read_b64_tr_b16 v[196:197], v7 offset:45056
    v_mfma_f32_16x16x32_bf16 v[56:59], v[148:151], v[124:127], v[56:59]
    ds_read_b64_tr_b16 v[198:199], v7 offset:45568
    v_mfma_f32_16x16x32_bf16 v[60:63], v[152:155], v[124:127], v[60:63]
    ds_read_b64_tr_b16 v[200:201], v8 offset:20480
    v_mfma_f32_16x16x32_bf16 v[24:27], v[140:143], v[124:127], v[24:27]
    ds_read_b64_tr_b16 v[202:203], v8 offset:20992
    v_mfma_f32_16x16x32_bf16 v[28:31], v[144:147], v[124:127], v[28:31]
    ds_read_b64_tr_b16 v[204:205], v9 offset:20480
    v_mfma_f32_16x16x32_bf16 v[48:51], v[148:151], v[120:123], v[48:51]
    ds_read_b64_tr_b16 v[206:207], v9 offset:20992
    v_mfma_f32_16x16x32_bf16 v[52:55], v[152:155], v[120:123], v[52:55]
    v_mfma_f32_16x16x32_bf16 v[16:19], v[140:143], v[120:123], v[16:19]
    v_mfma_f32_16x16x32_bf16 v[20:23], v[144:147], v[120:123], v[20:23]
    v_mfma_f32_16x16x32_bf16 v[96:99], v[128:131], v[156:159], v[96:99]
    v_mfma_f32_16x16x32_bf16 v[100:103], v[128:131], v[160:163], v[100:103]
    v_mfma_f32_16x16x32_bf16 v[88:91], v[124:127], v[156:159], v[88:91]
    v_mfma_f32_16x16x32_bf16 v[92:95], v[124:127], v[160:163], v[92:95]
    v_mfma_f32_16x16x32_bf16 v[80:83], v[120:123], v[156:159], v[80:83]
    v_mfma_f32_16x16x32_bf16 v[84:87], v[120:123], v[160:163], v[84:87]
    s_waitcnt lgkmcnt(0)
    s_barrier
    v_mfma_f32_16x16x32_bf16 v[112:115], v[192:195], v[180:183], v[112:115]
    ds_read_b128 v[120:123], v4 offset:0
    v_mfma_f32_16x16x32_bf16 v[116:119], v[180:183], v[200:203], v[116:119]
    ds_read_b128 v[124:127], v4 offset:2048
    v_mfma_f32_16x16x32_bf16 v[72:75], v[192:195], v[176:179], v[72:75]
    ds_read_b128 v[128:131], v4 offset:4096
    v_mfma_f32_16x16x32_bf16 v[76:79], v[196:199], v[176:179], v[76:79]
    ds_read_b128 v[132:135], v4 offset:6144
    v_mfma_f32_16x16x32_bf16 v[104:107], v[176:179], v[200:203], v[104:107]
    ds_read_b128 v[136:139], v2 offset:0
    v_mfma_f32_16x16x32_bf16 v[108:111], v[176:179], v[204:207], v[108:111]
    ds_read_b64_tr_b16 v[140:141], v6 offset:0
    v_mfma_f32_16x16x32_bf16 v[40:43], v[184:187], v[176:179], v[40:43]
    ds_read_b64_tr_b16 v[142:143], v6 offset:512
    v_mfma_f32_16x16x32_bf16 v[44:47], v[188:191], v[176:179], v[44:47]
    ds_read_b64_tr_b16 v[144:145], v7 offset:0
    v_mfma_f32_16x16x32_bf16 v[64:67], v[192:195], v[172:175], v[64:67]
    ds_read_b64_tr_b16 v[146:147], v7 offset:512
    v_mfma_f32_16x16x32_bf16 v[68:71], v[196:199], v[172:175], v[68:71]
    ds_read_b64_tr_b16 v[148:149], v6 offset:24576
    v_mfma_f32_16x16x32_bf16 v[32:35], v[184:187], v[172:175], v[32:35]
    ds_read_b64_tr_b16 v[150:151], v6 offset:25088
    v_mfma_f32_16x16x32_bf16 v[36:39], v[188:191], v[172:175], v[36:39]
    ds_read_b64_tr_b16 v[152:153], v7 offset:24576
    v_mfma_f32_16x16x32_bf16 v[56:59], v[192:195], v[168:171], v[56:59]
    ds_read_b64_tr_b16 v[154:155], v7 offset:25088
    v_mfma_f32_16x16x32_bf16 v[60:63], v[196:199], v[168:171], v[60:63]
    ds_read_b64_tr_b16 v[156:157], v8 offset:0
    v_mfma_f32_16x16x32_bf16 v[24:27], v[184:187], v[168:171], v[24:27]
    ds_read_b64_tr_b16 v[158:159], v8 offset:512
    v_mfma_f32_16x16x32_bf16 v[28:31], v[188:191], v[168:171], v[28:31]
    ds_read_b64_tr_b16 v[160:161], v9 offset:0
    v_mfma_f32_16x16x32_bf16 v[48:51], v[192:195], v[164:167], v[48:51]
    ds_read_b64_tr_b16 v[162:163], v9 offset:512
    v_mfma_f32_16x16x32_bf16 v[52:55], v[196:199], v[164:167], v[52:55]
    v_mfma_f32_16x16x32_bf16 v[16:19], v[184:187], v[164:167], v[16:19]
    v_mfma_f32_16x16x32_bf16 v[20:23], v[188:191], v[164:167], v[20:23]
    v_mfma_f32_16x16x32_bf16 v[96:99], v[172:175], v[200:203], v[96:99]
    v_mfma_f32_16x16x32_bf16 v[100:103], v[172:175], v[204:207], v[100:103]
    v_mfma_f32_16x16x32_bf16 v[88:91], v[168:171], v[200:203], v[88:91]
    v_mfma_f32_16x16x32_bf16 v[92:95], v[168:171], v[204:207], v[92:95]
    v_mfma_f32_16x16x32_bf16 v[80:83], v[164:167], v[200:203], v[80:83]
    v_mfma_f32_16x16x32_bf16 v[84:87], v[164:167], v[204:207], v[84:87]
    s_waitcnt lgkmcnt(0)
    v_mfma_f32_16x16x32_bf16 v[112:115], v[148:151], v[136:139], v[112:115]
    ds_read_b128 v[164:167], v5 offset:0
    v_mfma_f32_16x16x32_bf16 v[116:119], v[136:139], v[156:159], v[116:119]
    ds_read_b128 v[168:171], v5 offset:2048
    v_mfma_f32_16x16x32_bf16 v[72:75], v[148:151], v[132:135], v[72:75]
    ds_read_b128 v[172:175], v5 offset:4096
    v_mfma_f32_16x16x32_bf16 v[76:79], v[152:155], v[132:135], v[76:79]
    ds_read_b128 v[176:179], v5 offset:6144
    v_mfma_f32_16x16x32_bf16 v[104:107], v[132:135], v[156:159], v[104:107]
    ds_read_b128 v[180:183], v3 offset:0
    v_mfma_f32_16x16x32_bf16 v[108:111], v[132:135], v[160:163], v[108:111]
    ds_read_b64_tr_b16 v[184:185], v6 offset:4096
    v_mfma_f32_16x16x32_bf16 v[40:43], v[140:143], v[132:135], v[40:43]
    ds_read_b64_tr_b16 v[186:187], v6 offset:4608
    v_mfma_f32_16x16x32_bf16 v[44:47], v[144:147], v[132:135], v[44:47]
    ds_read_b64_tr_b16 v[188:189], v7 offset:4096
    v_mfma_f32_16x16x32_bf16 v[64:67], v[148:151], v[128:131], v[64:67]
    ds_read_b64_tr_b16 v[190:191], v7 offset:4608
    v_mfma_f32_16x16x32_bf16 v[68:71], v[152:155], v[128:131], v[68:71]
    ds_read_b64_tr_b16 v[192:193], v6 offset:28672
    v_mfma_f32_16x16x32_bf16 v[32:35], v[140:143], v[128:131], v[32:35]
    ds_read_b64_tr_b16 v[194:195], v6 offset:29184
    v_mfma_f32_16x16x32_bf16 v[36:39], v[144:147], v[128:131], v[36:39]
    ds_read_b64_tr_b16 v[196:197], v7 offset:28672
    v_mfma_f32_16x16x32_bf16 v[56:59], v[148:151], v[124:127], v[56:59]
    ds_read_b64_tr_b16 v[198:199], v7 offset:29184
    v_mfma_f32_16x16x32_bf16 v[60:63], v[152:155], v[124:127], v[60:63]
    ds_read_b64_tr_b16 v[200:201], v8 offset:4096
    v_mfma_f32_16x16x32_bf16 v[24:27], v[140:143], v[124:127], v[24:27]
    ds_read_b64_tr_b16 v[202:203], v8 offset:4608
    v_mfma_f32_16x16x32_bf16 v[28:31], v[144:147], v[124:127], v[28:31]
    ds_read_b64_tr_b16 v[204:205], v9 offset:4096
    v_mfma_f32_16x16x32_bf16 v[48:51], v[148:151], v[120:123], v[48:51]
    ds_read_b64_tr_b16 v[206:207], v9 offset:4608
    v_mfma_f32_16x16x32_bf16 v[52:55], v[152:155], v[120:123], v[52:55]
    v_mfma_f32_16x16x32_bf16 v[16:19], v[140:143], v[120:123], v[16:19]
    v_mfma_f32_16x16x32_bf16 v[20:23], v[144:147], v[120:123], v[20:23]
    v_mfma_f32_16x16x32_bf16 v[96:99], v[128:131], v[156:159], v[96:99]
    v_mfma_f32_16x16x32_bf16 v[100:103], v[128:131], v[160:163], v[100:103]
    v_mfma_f32_16x16x32_bf16 v[88:91], v[124:127], v[156:159], v[88:91]
    v_mfma_f32_16x16x32_bf16 v[92:95], v[124:127], v[160:163], v[92:95]
    v_mfma_f32_16x16x32_bf16 v[80:83], v[120:123], v[156:159], v[80:83]
    v_mfma_f32_16x16x32_bf16 v[84:87], v[120:123], v[160:163], v[84:87]
    s_waitcnt lgkmcnt(0)
    s_barrier
    s_lshl_b32 s78, s87, 2
    v_add_u32 v13, s78, v10
    v_mfma_f32_16x16x32_bf16 v[112:115], v[192:195], v[180:183], v[112:115]
    v_mfma_f32_16x16x32_bf16 v[116:119], v[180:183], v[200:203], v[116:119]
    v_mfma_f32_16x16x32_bf16 v[72:75], v[192:195], v[176:179], v[72:75]
    v_mfma_f32_16x16x32_bf16 v[76:79], v[196:199], v[176:179], v[76:79]
    v_mfma_f32_16x16x32_bf16 v[104:107], v[176:179], v[200:203], v[104:107]
    v_mfma_f32_16x16x32_bf16 v[108:111], v[176:179], v[204:207], v[108:111]
    v_mfma_f32_16x16x32_bf16 v[40:43], v[184:187], v[176:179], v[40:43]
    v_mfma_f32_16x16x32_bf16 v[44:47], v[188:191], v[176:179], v[44:47]
    v_mfma_f32_16x16x32_bf16 v[64:67], v[192:195], v[172:175], v[64:67]
    v_mfma_f32_16x16x32_bf16 v[68:71], v[196:199], v[172:175], v[68:71]
    v_cvt_pk_bf16_f32 v156, v112, v113
    v_cvt_pk_bf16_f32 v157, v114, v115
    v_mfma_f32_16x16x32_bf16 v[32:35], v[184:187], v[172:175], v[32:35]
    v_cvt_pk_bf16_f32 v158, v116, v117
    v_cvt_pk_bf16_f32 v159, v118, v119
    v_mfma_f32_16x16x32_bf16 v[36:39], v[188:191], v[172:175], v[36:39]
    v_cvt_pk_bf16_f32 v152, v72, v73
    v_cvt_pk_bf16_f32 v153, v74, v75
    v_mfma_f32_16x16x32_bf16 v[56:59], v[192:195], v[168:171], v[56:59]
    v_cvt_pk_bf16_f32 v154, v76, v77
    v_cvt_pk_bf16_f32 v155, v78, v79
    v_mfma_f32_16x16x32_bf16 v[60:63], v[196:199], v[168:171], v[60:63]
    v_cvt_pk_bf16_f32 v232, v104, v105
    v_cvt_pk_bf16_f32 v233, v106, v107
    v_mfma_f32_16x16x32_bf16 v[24:27], v[184:187], v[168:171], v[24:27]
    v_cvt_pk_bf16_f32 v242, v108, v109
    v_cvt_pk_bf16_f32 v243, v110, v111
    v_mfma_f32_16x16x32_bf16 v[28:31], v[188:191], v[168:171], v[28:31]
    ds_write_b64 v216, v[156:157]
    ds_write_b64 v216, v[158:159] offset:1024
    v_mfma_f32_16x16x32_bf16 v[48:51], v[192:195], v[164:167], v[48:51]
    ds_write_b64 v217, v[152:153] offset:0
    ds_write_b64 v217, v[232:233] offset:1024
    v_mfma_f32_16x16x32_bf16 v[52:55], v[196:199], v[164:167], v[52:55]
    ds_write_b64 v217, v[154:155] offset:512
    ds_write_b64 v217, v[242:243] offset:1536
    v_mfma_f32_16x16x32_bf16 v[16:19], v[184:187], v[164:167], v[16:19]
    v_cvt_pk_bf16_f32 v132, v40, v41
    v_cvt_pk_bf16_f32 v133, v42, v43
    v_mfma_f32_16x16x32_bf16 v[20:23], v[188:191], v[164:167], v[20:23]
    v_cvt_pk_bf16_f32 v134, v44, v45
    v_cvt_pk_bf16_f32 v135, v46, v47
    v_mfma_f32_16x16x32_bf16 v[96:99], v[172:175], v[200:203], v[96:99]
    v_cvt_pk_bf16_f32 v148, v64, v65
    v_cvt_pk_bf16_f32 v149, v66, v67
    v_mfma_f32_16x16x32_bf16 v[100:103], v[172:175], v[204:207], v[100:103]
    v_cvt_pk_bf16_f32 v150, v68, v69
    v_cvt_pk_bf16_f32 v151, v70, v71
    v_mfma_f32_16x16x32_bf16 v[88:91], v[168:171], v[200:203], v[88:91]
    v_cvt_pk_bf16_f32 v128, v32, v33
    v_cvt_pk_bf16_f32 v129, v34, v35
    v_mfma_f32_16x16x32_bf16 v[92:95], v[168:171], v[204:207], v[92:95]
    v_cvt_pk_bf16_f32 v130, v36, v37
    v_cvt_pk_bf16_f32 v131, v38, v39
    v_mfma_f32_16x16x32_bf16 v[80:83], v[164:167], v[200:203], v[80:83]
    v_cvt_pk_bf16_f32 v144, v56, v57
    v_cvt_pk_bf16_f32 v145, v58, v59
    v_mfma_f32_16x16x32_bf16 v[84:87], v[164:167], v[204:207], v[84:87]
    v_cvt_pk_bf16_f32 v146, v60, v61
    v_cvt_pk_bf16_f32 v147, v62, v63
    v_cvt_pk_bf16_f32 v124, v24, v25
    v_cvt_pk_bf16_f32 v125, v26, v27
    v_cvt_pk_bf16_f32 v126, v28, v29
    v_cvt_pk_bf16_f32 v127, v30, v31
    s_mov_b64 exec, 1
    ds_add_u32 v13, v11 offset:0
    s_mov_b64 exec, -1
    v_cvt_pk_bf16_f32 v140, v48, v49
    v_cvt_pk_bf16_f32 v141, v50, v51
    v_cvt_pk_bf16_f32 v142, v52, v53
    v_cvt_pk_bf16_f32 v143, v54, v55
    v_cvt_pk_bf16_f32 v120, v16, v17
    v_cvt_pk_bf16_f32 v121, v18, v19
    v_cvt_pk_bf16_f32 v122, v20, v21
    v_cvt_pk_bf16_f32 v123, v22, v23
    v_mfma_f32_16x16x32_bf16 v[44:47], v[152:155], v[132:135], 0
    v_cvt_pk_bf16_f32 v230, v96, v97
    v_cvt_pk_bf16_f32 v231, v98, v99
    v_mfma_f32_16x16x32_bf16 v[40:43], v[148:151], v[132:135], 0
    v_cvt_pk_bf16_f32 v240, v100, v101
    v_cvt_pk_bf16_f32 v241, v102, v103
    v_mfma_f32_16x16x32_bf16 v[36:39], v[148:151], v[128:131], 0
    v_cvt_pk_bf16_f32 v228, v88, v89
    v_cvt_pk_bf16_f32 v229, v90, v91
    v_mfma_f32_16x16x32_bf16 v[32:35], v[144:147], v[128:131], 0
    v_cvt_pk_bf16_f32 v238, v92, v93
    v_cvt_pk_bf16_f32 v239, v94, v95
    v_mfma_f32_16x16x32_bf16 v[28:31], v[144:147], v[124:127], 0
    v_cvt_pk_bf16_f32 v226, v80, v81
    v_cvt_pk_bf16_f32 v227, v82, v83
    v_mfma_f32_16x16x32_bf16 v[24:27], v[140:143], v[124:127], 0
    v_cvt_pk_bf16_f32 v236, v84, v85
    v_cvt_pk_bf16_f32 v237, v86, v87
    v_mfma_f32_16x16x32_bf16 v[20:23], v[140:143], v[120:123], 0
LB_s1:
    ds_read_b32 v14, v13 offset:0
    ds_read_b64 v[136:137], v218
    ds_read_b64 v[138:139], v219
    ds_read_b64 v[224:225], v218 offset:1024
    ds_read_b64 v[234:235], v219 offset:1024
    s_waitcnt lgkmcnt(0)
    v_readfirstlane_b32 s78, v14
    s_nop 0
    s_cmp_ge_u32 s78, 2
    s_cbranch_scc0 LB_s1
    v_mfma_f32_16x16x32_bf16 v[16:19], v[136:139], v[120:123], v[212:215]
    v_cndmask_b32 v60, v44, v45, s[88:89]
    v_cndmask_b32 v61, v40, v41, s[88:89]
    v_cndmask_b32 v54, v61, v60, s[90:91]
    v_cndmask_b32 v60, v46, v47, s[88:89]
    v_cndmask_b32 v61, v42, v43, s[88:89]
    v_cndmask_b32 v55, v61, v60, s[92:93]
    v_max_f32 v59, v54, v55
    v_cndmask_b32 v60, v36, v37, s[88:89]
    v_cndmask_b32 v61, v32, v33, s[88:89]
    v_cndmask_b32 v52, v61, v60, s[90:91]
    v_cndmask_b32 v60, v38, v39, s[88:89]
    v_cndmask_b32 v61, v34, v35, s[88:89]
    v_cndmask_b32 v53, v61, v60, s[92:93]
    v_max_f32 v58, v52, v53
    v_cndmask_b32 v60, v28, v29, s[88:89]
    v_cndmask_b32 v61, v24, v25, s[88:89]
    v_cndmask_b32 v50, v61, v60, s[90:91]
    v_cndmask_b32 v60, v30, v31, s[88:89]
    v_cndmask_b32 v61, v26, v27, s[88:89]
    v_cndmask_b32 v51, v61, v60, s[92:93]
    v_max_f32 v57, v50, v51
    v_cndmask_b32 v60, v20, v21, s[88:89]
    v_cndmask_b32 v61, v16, v17, s[88:89]
    v_cndmask_b32 v48, v61, v60, s[90:91]
    v_cndmask_b32 v60, v22, v23, s[88:89]
    v_cndmask_b32 v61, v18, v19, s[88:89]
    v_cndmask_b32 v49, v61, v60, s[92:93]
    v_max_f32 v56, v48, v49
    s_mov_b32 s80, 0x3e8293ee
    v_permlane32_swap_b32 v58, v59
    v_permlane32_swap_b32 v56, v57
    v_max_f32 v58, v58, v59
    v_max_f32 v56, v56, v57
    s_nop 1
    v_permlane16_swap_b32 v56, v58
    v_max_f32 v56, v56, v58
    v_mul_f32 v56, s80, v56
    v_mov_b32 v58, v56
    s_nop 1
    v_permlane16_swap_b32 v56, v58
    v_mov_b32 v57, v56
    v_mov_b32 v59, v58
    s_nop 0
    v_permlane32_swap_b32 v56, v57
    v_permlane32_swap_b32 v58, v59
    v_fma_f32 v48, v48, s80, -v56
    v_fma_f32 v49, v49, s80, -v56
    v_fma_f32 v50, v50, s80, -v57
    v_fma_f32 v51, v51, s80, -v57
    v_fma_f32 v52, v52, s80, -v58
    v_fma_f32 v53, v53, s80, -v58
    v_fma_f32 v54, v54, s80, -v59
    v_fma_f32 v55, v55, s80, -v59
    v_exp_f32 v48, v48
    v_exp_f32 v49, v49
    v_exp_f32 v50, v50
    v_exp_f32 v51, v51
    v_exp_f32 v52, v52
    v_exp_f32 v53, v53
    v_exp_f32 v54, v54
    v_exp_f32 v55, v55
    v_add_f32 v56, v48, v49
    v_add_f32 v57, v50, v51
    v_add_f32 v58, v52, v53
    v_add_f32 v59, v54, v55
    s_nop 1
    v_permlane32_swap_b32 v58, v59
    v_permlane32_swap_b32 v56, v57
    v_add_f32 v58, v58, v59
    v_add_f32 v56, v56, v57
    s_nop 1
    v_permlane16_swap_b32 v56, v58
    v_add_f32 v56, v56, v58
    v_rcp_f32 v56, v56
    s_nop 0
    v_mov_b32 v58, v56
    s_nop 1
    v_permlane16_swap_b32 v56, v58
    v_mov_b32 v57, v56
    v_mov_b32 v59, v58
    s_nop 0
    v_permlane32_swap_b32 v56, v57
    v_permlane32_swap_b32 v58, v59
    v_mul_f32 v48, v48, v56
    v_mul_f32 v49, v49, v56
    v_cvt_pk_bf16_f32 v48, v48, v49
    v_perm_b32 v64, v48, v48, v208
    v_perm_b32 v65, v48, v48, v209
    v_perm_b32 v66, v48, v48, v210
    v_perm_b32 v67, v48, v48, v211
    v_mul_f32 v50, v50, v57
    v_mul_f32 v51, v51, v57
    v_cvt_pk_bf16_f32 v50, v50, v51
    v_perm_b32 v68, v50, v50, v208
    v_perm_b32 v69, v50, v50, v209
    v_perm_b32 v70, v50, v50, v210
    v_perm_b32 v71, v50, v50, v211
    v_mfma_f32_16x16x32_bf16 v[16:19], v[224:227], v[64:67], 0
    v_mfma_f32_16x16x32_bf16 v[20:23], v[234:237], v[64:67], 0
    v_mul_f32 v52, v52, v58
    v_mul_f32 v53, v53, v58
    v_cvt_pk_bf16_f32 v52, v52, v53
    v_perm_b32 v72, v52, v52, v208
    v_perm_b32 v73, v52, v52, v209
    v_perm_b32 v74, v52, v52, v210
    v_perm_b32 v75, v52, v52, v211
    v_mfma_f32_16x16x32_bf16 v[24:27], v[226:229], v[68:71], 0
    v_mfma_f32_16x16x32_bf16 v[28:31], v[236:239], v[68:71], 0
    v_mul_f32 v54, v54, v59
    v_mul_f32 v55, v55, v59
    v_cvt_pk_bf16_f32 v54, v54, v55
    v_perm_b32 v76, v54, v54, v208
    v_perm_b32 v77, v54, v54, v209
    v_perm_b32 v78, v54, v54, v210
    v_perm_b32 v79, v54, v54, v211
    v_mfma_f32_16x16x32_bf16 v[32:35], v[228:231], v[72:75], 0
    v_mfma_f32_16x16x32_bf16 v[36:39], v[238:241], v[72:75], 0
    v_mfma_f32_16x16x32_bf16 v[40:43], v[230:233], v[76:79], 0
    v_mfma_f32_16x16x32_bf16 v[44:47], v[240:243], v[76:79], 0
    v_cvt_pk_bf16_f32 v80, v16, v17
    v_cvt_pk_bf16_f32 v81, v18, v19
    v_cvt_pk_bf16_f32 v82, v20, v21
    v_cvt_pk_bf16_f32 v83, v22, v23
    s_add_u32 s95, s94, 0
    buffer_store_dwordx4 v[80:83], v12, s[52:55], s95 offen sc1
    v_cvt_pk_bf16_f32 v84, v24, v25
    v_cvt_pk_bf16_f32 v85, v26, v27
    v_cvt_pk_bf16_f32 v86, v28, v29
    v_cvt_pk_bf16_f32 v87, v30, v31
    s_add_u32 s95, s94, 32768
    buffer_store_dwordx4 v[84:87], v12, s[52:55], s95 offen sc1
    v_cvt_pk_bf16_f32 v88, v32, v33
    v_cvt_pk_bf16_f32 v89, v34, v35
    v_cvt_pk_bf16_f32 v90, v36, v37
    v_cvt_pk_bf16_f32 v91, v38, v39
    s_add_u32 s95, s94, 65536
    buffer_store_dwordx4 v[88:91], v12, s[52:55], s95 offen sc1
    v_cvt_pk_bf16_f32 v92, v40, v41
    v_cvt_pk_bf16_f32 v93, v42, v43
    v_cvt_pk_bf16_f32 v94, v44, v45
    v_cvt_pk_bf16_f32 v95, v46, v47
    s_add_u32 s95, s94, 98304
    buffer_store_dwordx4 v[92:95], v12, s[52:55], s95 offen sc1
    v_bfe_u32 v14, v0, 3, 2
    v_lshlrev_b32 v14, 5, v14
    v_and_b32 v15, 3, v0
    v_lshl_add_u32 v14, v15, 3, v14
    v_lshrrev_b32 v15, 2, v0
    v_lshl_add_u32 v14, v15, 7, v14
    s_lshl_b32 s78, s86, 11
    v_add_u32 v14, s78, v14
    v_xor_b32 v2, 0, v14
    v_xor_b32 v3, 32, v14
    v_xor_b32 v4, 64, v14
    v_xor_b32 v5, 96, v14
    v_xor_b32 v6, 2048, v14
    v_xor_b32 v7, 2080, v14
    v_xor_b32 v8, 2112, v14
    v_xor_b32 v9, 2144, v14
    v_and_b32 v14, 15, v0
    s_lshl_b32 s78, s76, 2
    s_add_u32 s78, s78, s3
    s_lshl_b32 s79, s78, 5
    v_add_u32 v14, s79, v14
    v_lshlrev_b32 v14, 12, v14
    v_bfe_u32 v15, v0, 4, 1
    v_lshl_add_u32 v14, v15, 5, v14
    v_lshrrev_b32 v15, 5, v0
    v_lshl_add_u32 v14, v15, 4, v14
    s_lshl_b32 s79, s77, 7
    s_add_u32 s79, s79, 2048
    v_add_u32 v13, s79, v14
    s_lshl_b32 s88, s78, 16
    s_add_u32 s88, s88, 8388608
    s_lshl_b32 s90, s76, 1
    s_add_u32 s90, s90, s86
    s_lshl_b32 s90, s90, 8
    s_add_u32 s90, s90, 12603392
    v_and_b32 v15, 31, v0
    v_lshlrev_b32 v15, 2, v15
    s_waitcnt vmcnt(0)
    s_mov_b64 exec, 4
    buffer_store_dword v11, v221, s[52:55], 0 offen sc1
    s_mov_b64 exec, -1
LB_s2:
    ds_read_b32 v14, v10 offset:8
    ds_read_b64_tr_b16 v[48:49], v2 offset:0
    ds_read_b64_tr_b16 v[50:51], v6 offset:0
    ds_read_b64_tr_b16 v[52:53], v3 offset:0
    ds_read_b64_tr_b16 v[54:55], v7 offset:0
    ds_read_b64_tr_b16 v[56:57], v4 offset:0
    ds_read_b64_tr_b16 v[58:59], v8 offset:0
    ds_read_b64_tr_b16 v[60:61], v5 offset:0
    ds_read_b64_tr_b16 v[62:63], v9 offset:0
    s_waitcnt lgkmcnt(0)
    v_readfirstlane_b32 s78, v14
    s_nop 0
    s_cmp_ge_u32 s78, 4
    s_cbranch_scc0 LB_s2
    s_mov_b32 s79, 0
LB_po:
    buffer_load_dword v14, v15, s[52:55], s90 offen sc1
    s_add_u32 s79, s79, 1
    s_cmp_gt_u32 s79, 200000
    s_cbranch_scc1 LB_po_x
    s_waitcnt vmcnt(0)
    v_cmp_ne_u32 vcc, 1, v14
    s_cbranch_vccz LB_po_x
    s_sleep 2
    s_branch LB_po
LB_po_x:
    s_waitcnt vmcnt(0)
    s_add_u32 s89, s88, 0
    buffer_load_dwordx4 v[80:83], v12, s[52:55], s89 offen offset:0 sc1
    s_add_u32 s91, s88, 32768
    buffer_load_dwordx4 v[84:87], v12, s[52:55], s91 offen offset:0 sc1
    buffer_load_dwordx4 v[88:91], v12, s[52:55], s89 offen offset:1024 sc1
    buffer_load_dwordx4 v[92:95], v12, s[52:55], s91 offen offset:1024 sc1
    buffer_load_dwordx4 v[96:99], v12, s[52:55], s89 offen offset:2048 sc1
    buffer_load_dwordx4 v[100:103], v12, s[52:55], s91 offen offset:2048 sc1
    buffer_load_dwordx4 v[104:107], v12, s[52:55], s89 offen offset:3072 sc1
    buffer_load_dwordx4 v[108:111], v12, s[52:55], s91 offen offset:3072 sc1
    s_add_u32 s89, s88, 4096
    buffer_load_dwordx4 v[112:115], v12, s[52:55], s89 offen offset:0 sc1
    s_add_u32 s91, s88, 36864
    buffer_load_dwordx4 v[116:119], v12, s[52:55], s91 offen offset:0 sc1
    buffer_load_dwordx4 v[120:123], v12, s[52:55], s89 offen offset:1024 sc1
    buffer_load_dwordx4 v[124:127], v12, s[52:55], s91 offen offset:1024 sc1
    buffer_load_dwordx4 v[128:131], v12, s[52:55], s89 offen offset:2048 sc1
    buffer_load_dwordx4 v[132:135], v12, s[52:55], s91 offen offset:2048 sc1
    buffer_load_dwordx4 v[136:139], v12, s[52:55], s89 offen offset:3072 sc1
    buffer_load_dwordx4 v[140:143], v12, s[52:55], s91 offen offset:3072 sc1
    s_add_u32 s89, s88, 8192
    buffer_load_dwordx4 v[144:147], v12, s[52:55], s89 offen offset:0 sc1
    s_add_u32 s91, s88, 40960
    buffer_load_dwordx4 v[148:151], v12, s[52:55], s91 offen offset:0 sc1
    buffer_load_dwordx4 v[152:155], v12, s[52:55], s89 offen offset:1024 sc1
    buffer_load_dwordx4 v[156:159], v12, s[52:55], s91 offen offset:1024 sc1
    buffer_load_dwordx4 v[160:163], v12, s[52:55], s89 offen offset:2048 sc1
    buffer_load_dwordx4 v[164:167], v12, s[52:55], s91 offen offset:2048 sc1
    buffer_load_dwordx4 v[168:171], v12, s[52:55], s89 offen offset:3072 sc1
    buffer_load_dwordx4 v[172:175], v12, s[52:55], s91 offen offset:3072 sc1
    s_add_u32 s89, s88, 12288
    buffer_load_dwordx4 v[176:179], v12, s[52:55], s89 offen offset:0 sc1
    s_add_u32 s91, s88, 45056
    buffer_load_dwordx4 v[180:183], v12, s[52:55], s91 offen offset:0 sc1
    buffer_load_dwordx4 v[184:187], v12, s[52:55], s89 offen offset:1024 sc1
    buffer_load_dwordx4 v[188:191], v12, s[52:55], s91 offen offset:1024 sc1
    buffer_load_dwordx4 v[192:195], v12, s[52:55], s89 offen offset:2048 sc1
    buffer_load_dwordx4 v[196:199], v12, s[52:55], s91 offen offset:2048 sc1
    buffer_load_dwordx4 v[200:203], v12, s[52:55], s89 offen offset:3072 sc1
    buffer_load_dwordx4 v[204:207], v12, s[52:55], s91 offen offset:3072 sc1
    s_add_u32 s89, s88, 16384
    buffer_load_dwordx4 v[208:211], v12, s[52:55], s89 offen offset:0 sc1
    s_add_u32 s91, s88, 49152
    buffer_load_dwordx4 v[212:215], v12, s[52:55], s91 offen offset:0 sc1
    buffer_load_dwordx4 v[216:219], v12, s[52:55], s89 offen offset:1024 sc1
    buffer_load_dwordx4 v[220:223], v12, s[52:55], s91 offen offset:1024 sc1
    buffer_load_dwordx4 v[224:227], v12, s[52:55], s89 offen offset:2048 sc1
    buffer_load_dwordx4 v[228:231], v12, s[52:55], s91 offen offset:2048 sc1
    buffer_load_dwordx4 v[232:235], v12, s[52:55], s89 offen offset:3072 sc1
    buffer_load_dwordx4 v[236:239], v12, s[52:55], s91 offen offset:3072 sc1
    s_add_u32 s89, s88, 20480
    buffer_load_dwordx4 v[240:243], v12, s[52:55], s89 offen offset:0 sc1
    s_add_u32 s91, s88, 53248
    buffer_load_dwordx4 v[244:247], v12, s[52:55], s91 offen offset:0 sc1
    s_waitcnt lgkmcnt(0)
    s_waitcnt vmcnt(41)
    v_mfma_f32_16x16x32_bf16 v[16:19], v[48:51], v[80:83], 0
    ds_read_b64_tr_b16 v[64:65], v2 offset:4096
    ds_read_b64_tr_b16 v[66:67], v6 offset:4096
    v_mfma_f32_16x16x32_bf16 v[20:23], v[52:55], v[80:83], 0
    ds_read_b64_tr_b16 v[68:69], v3 offset:4096
    ds_read_b64_tr_b16 v[70:71], v7 offset:4096
    v_mfma_f32_16x16x32_bf16 v[24:27], v[56:59], v[80:83], 0
    ds_read_b64_tr_b16 v[72:73], v4 offset:4096
    ds_read_b64_tr_b16 v[74:75], v8 offset:4096
    v_mfma_f32_16x16x32_bf16 v[28:31], v[60:63], v[80:83], 0
    ds_read_b64_tr_b16 v[76:77], v5 offset:4096
    ds_read_b64_tr_b16 v[78:79], v9 offset:4096
    s_waitcnt vmcnt(40)
    v_mfma_f32_16x16x32_bf16 v[32:35], v[48:51], v[84:87], 0
    v_mfma_f32_16x16x32_bf16 v[36:39], v[52:55], v[84:87], 0
    v_mfma_f32_16x16x32_bf16 v[40:43], v[56:59], v[84:87], 0
    v_mfma_f32_16x16x32_bf16 v[44:47], v[60:63], v[84:87], 0
    s_waitcnt lgkmcnt(0)
    s_waitcnt vmcnt(39)
    v_mfma_f32_16x16x32_bf16 v[16:19], v[64:67], v[88:91], v[16:19]
    ds_read_b64_tr_b16 v[48:49], v2 offset:8192
    ds_read_b64_tr_b16 v[50:51], v6 offset:8192
    v_mfma_f32_16x16x32_bf16 v[20:23], v[68:71], v[88:91], v[20:23]
    ds_read_b64_tr_b16 v[52:53], v3 offset:8192
    ds_read_b64_tr_b16 v[54:55], v7 offset:8192
    v_mfma_f32_16x16x32_bf16 v[24:27], v[72:75], v[88:91], v[24:27]
    ds_read_b64_tr_b16 v[56:57], v4 offset:8192
    ds_read_b64_tr_b16 v[58:59], v8 offset:8192
    v_mfma_f32_16x16x32_bf16 v[28:31], v[76:79], v[88:91], v[28:31]
    ds_read_b64_tr_b16 v[60:61], v5 offset:8192
    ds_read_b64_tr_b16 v[62:63], v9 offset:8192
    s_waitcnt vmcnt(38)
    v_mfma_f32_16x16x32_bf16 v[32:35], v[64:67], v[92:95], v[32:35]
    buffer_load_dwordx4 v[80:83], v12, s[52:55], s89 offen offset:1024 sc1
    buffer_load_dwordx4 v[84:87], v12, s[52:55], s91 offen offset:1024 sc1
    v_mfma_f32_16x16x32_bf16 v[36:39], v[68:71], v[92:95], v[36:39]
    v_mfma_f32_16x16x32_bf16 v[40:43], v[72:75], v[92:95], v[40:43]
    v_mfma_f32_16x16x32_bf16 v[44:47], v[76:79], v[92:95], v[44:47]
    s_waitcnt lgkmcnt(0)
    s_waitcnt vmcnt(39)
    v_mfma_f32_16x16x32_bf16 v[16:19], v[48:51], v[96:99], v[16:19]
    ds_read_b64_tr_b16 v[64:65], v2 offset:12288
    ds_read_b64_tr_b16 v[66:67], v6 offset:12288
    v_mfma_f32_16x16x32_bf16 v[20:23], v[52:55], v[96:99], v[20:23]
    ds_read_b64_tr_b16 v[68:69], v3 offset:12288
    ds_read_b64_tr_b16 v[70:71], v7 offset:12288
    v_mfma_f32_16x16x32_bf16 v[24:27], v[56:59], v[96:99], v[24:27]
    ds_read_b64_tr_b16 v[72:73], v4 offset:12288
    ds_read_b64_tr_b16 v[74:75], v8 offset:12288
    v_mfma_f32_16x16x32_bf16 v[28:31], v[60:63], v[96:99], v[28:31]
    ds_read_b64_tr_b16 v[76:77], v5 offset:12288
    ds_read_b64_tr_b16 v[78:79], v9 offset:12288
    s_waitcnt vmcnt(38)
    v_mfma_f32_16x16x32_bf16 v[32:35], v[48:51], v[100:103], v[32:35]
    buffer_load_dwordx4 v[88:91], v12, s[52:55], s89 offen offset:2048 sc1
    buffer_load_dwordx4 v[92:95], v12, s[52:55], s91 offen offset:2048 sc1
    v_mfma_f32_16x16x32_bf16 v[36:39], v[52:55], v[100:103], v[36:39]
    v_mfma_f32_16x16x32_bf16 v[40:43], v[56:59], v[100:103], v[40:43]
    v_mfma_f32_16x16x32_bf16 v[44:47], v[60:63], v[100:103], v[44:47]
    s_waitcnt lgkmcnt(0)
    s_waitcnt vmcnt(39)
    v_mfma_f32_16x16x32_bf16 v[16:19], v[64:67], v[104:107], v[16:19]
    ds_read_b64_tr_b16 v[48:49], v2 offset:16384
    ds_read_b64_tr_b16 v[50:51], v6 offset:16384
    v_mfma_f32_16x16x32_bf16 v[20:23], v[68:71], v[104:107], v[20:23]
    ds_read_b64_tr_b16 v[52:53], v3 offset:16384
    ds_read_b64_tr_b16 v[54:55], v7 offset:16384
    v_mfma_f32_16x16x32_bf16 v[24:27], v[72:75], v[104:107], v[24:27]
    ds_read_b64_tr_b16 v[56:57], v4 offset:16384
    ds_read_b64_tr_b16 v[58:59], v8 offset:16384
    v_mfma_f32_16x16x32_bf16 v[28:31], v[76:79], v[104:107], v[28:31]
    ds_read_b64_tr_b16 v[60:61], v5 offset:16384
    ds_read_b64_tr_b16 v[62:63], v9 offset:16384
    s_waitcnt vmcnt(38)
    v_mfma_f32_16x16x32_bf16 v[32:35], v[64:67], v[108:111], v[32:35]
    buffer_load_dwordx4 v[96:99], v12, s[52:55], s89 offen offset:3072 sc1
    buffer_load_dwordx4 v[100:103], v12, s[52:55], s91 offen offset:3072 sc1
    v_mfma_f32_16x16x32_bf16 v[36:39], v[68:71], v[108:111], v[36:39]
    v_mfma_f32_16x16x32_bf16 v[40:43], v[72:75], v[108:111], v[40:43]
    v_mfma_f32_16x16x32_bf16 v[44:47], v[76:79], v[108:111], v[44:47]
    s_waitcnt lgkmcnt(0)
    s_waitcnt vmcnt(39)
    v_mfma_f32_16x16x32_bf16 v[16:19], v[48:51], v[112:115], v[16:19]
    ds_read_b64_tr_b16 v[64:65], v2 offset:20480
    ds_read_b64_tr_b16 v[66:67], v6 offset:20480
    v_mfma_f32_16x16x32_bf16 v[20:23], v[52:55], v[112:115], v[20:23]
    ds_read_b64_tr_b16 v[68:69], v3 offset:20480
    ds_read_b64_tr_b16 v[70:71], v7 offset:20480
    v_mfma_f32_16x16x32_bf16 v[24:27], v[56:59], v[112:115], v[24:27]
    ds_read_b64_tr_b16 v[72:73], v4 offset:20480
    ds_read_b64_tr_b16 v[74:75], v8 offset:20480
    v_mfma_f32_16x16x32_bf16 v[28:31], v[60:63], v[112:115], v[28:31]
    ds_read_b64_tr_b16 v[76:77], v5 offset:20480
    ds_read_b64_tr_b16 v[78:79], v9 offset:20480
    s_waitcnt vmcnt(38)
    v_mfma_f32_16x16x32_bf16 v[32:35], v[48:51], v[116:119], v[32:35]
    s_add_u32 s89, s88, 24576
    buffer_load_dwordx4 v[104:107], v12, s[52:55], s89 offen offset:0 sc1
    v_mfma_f32_16x16x32_bf16 v[36:39], v[52:55], v[116:119], v[36:39]
    s_add_u32 s91, s88, 57344
    buffer_load_dwordx4 v[108:111], v12, s[52:55], s91 offen offset:0 sc1
    v_mfma_f32_16x16x32_bf16 v[40:43], v[56:59], v[116:119], v[40:43]
    v_mfma_f32_16x16x32_bf16 v[44:47], v[60:63], v[116:119], v[44:47]
    s_waitcnt lgkmcnt(0)
    s_waitcnt vmcnt(39)
    v_mfma_f32_16x16x32_bf16 v[16:19], v[64:67], v[120:123], v[16:19]
    ds_read_b64_tr_b16 v[48:49], v2 offset:24576
    ds_read_b64_tr_b16 v[50:51], v6 offset:24576
    v_mfma_f32_16x16x32_bf16 v[20:23], v[68:71], v[120:123], v[20:23]
    ds_read_b64_tr_b16 v[52:53], v3 offset:24576
    ds_read_b64_tr_b16 v[54:55], v7 offset:24576
    v_mfma_f32_16x16x32_bf16 v[24:27], v[72:75], v[120:123], v[24:27]
    ds_read_b64_tr_b16 v[56:57], v4 offset:24576
    ds_read_b64_tr_b16 v[58:59], v8 offset:24576
    v_mfma_f32_16x16x32_bf16 v[28:31], v[76:79], v[120:123], v[28:31]
    ds_read_b64_tr_b16 v[60:61], v5 offset:24576
    ds_read_b64_tr_b16 v[62:63], v9 offset:24576
    s_waitcnt vmcnt(38)
    v_mfma_f32_16x16x32_bf16 v[32:35], v[64:67], v[124:127], v[32:35]
    buffer_load_dwordx4 v[112:115], v12, s[52:55], s89 offen offset:1024 sc1
    buffer_load_dwordx4 v[116:119], v12, s[52:55], s91 offen offset:1024 sc1
    v_mfma_f32_16x16x32_bf16 v[36:39], v[68:71], v[124:127], v[36:39]
    v_mfma_f32_16x16x32_bf16 v[40:43], v[72:75], v[124:127], v[40:43]
    v_mfma_f32_16x16x32_bf16 v[44:47], v[76:79], v[124:127], v[44:47]
    s_waitcnt lgkmcnt(0)
    s_waitcnt vmcnt(39)
    v_mfma_f32_16x16x32_bf16 v[16:19], v[48:51], v[128:131], v[16:19]
    ds_read_b64_tr_b16 v[64:65], v2 offset:28672
    ds_read_b64_tr_b16 v[66:67], v6 offset:28672
    v_mfma_f32_16x16x32_bf16 v[20:23], v[52:55], v[128:131], v[20:23]
    ds_read_b64_tr_b16 v[68:69], v3 offset:28672
    ds_read_b64_tr_b16 v[70:71], v7 offset:28672
    v_mfma_f32_16x16x32_bf16 v[24:27], v[56:59], v[128:131], v[24:27]
    ds_read_b64_tr_b16 v[72:73], v4 offset:28672
    ds_read_b64_tr_b16 v[74:75], v8 offset:28672
    v_mfma_f32_16x16x32_bf16 v[28:31], v[60:63], v[128:131], v[28:31]
    ds_read_b64_tr_b16 v[76:77], v5 offset:28672
    ds_read_b64_tr_b16 v[78:79], v9 offset:28672
    s_waitcnt vmcnt(38)
    v_mfma_f32_16x16x32_bf16 v[32:35], v[48:51], v[132:135], v[32:35]
    buffer_load_dwordx4 v[120:123], v12, s[52:55], s89 offen offset:2048 sc1
    buffer_load_dwordx4 v[124:127], v12, s[52:55], s91 offen offset:2048 sc1
    v_mfma_f32_16x16x32_bf16 v[36:39], v[52:55], v[132:135], v[36:39]
    v_mfma_f32_16x16x32_bf16 v[40:43], v[56:59], v[132:135], v[40:43]
    v_mfma_f32_16x16x32_bf16 v[44:47], v[60:63], v[132:135], v[44:47]
    s_waitcnt lgkmcnt(0)
    s_waitcnt vmcnt(39)
    v_mfma_f32_16x16x32_bf16 v[16:19], v[64:67], v[136:139], v[16:19]
    ds_read_b64_tr_b16 v[48:49], v2 offset:32768
    ds_read_b64_tr_b16 v[50:51], v6 offset:32768
    v_mfma_f32_16x16x32_bf16 v[20:23], v[68:71], v[136:139], v[20:23]
    ds_read_b64_tr_b16 v[52:53], v3 offset:32768
    ds_read_b64_tr_b16 v[54:55], v7 offset:32768
    v_mfma_f32_16x16x32_bf16 v[24:27], v[72:75], v[136:139], v[24:27]
    ds_read_b64_tr_b16 v[56:57], v4 offset:32768
    ds_read_b64_tr_b16 v[58:59], v8 offset:32768
    v_mfma_f32_16x16x32_bf16 v[28:31], v[76:79], v[136:139], v[28:31]
    ds_read_b64_tr_b16 v[60:61], v5 offset:32768
    ds_read_b64_tr_b16 v[62:63], v9 offset:32768
    s_waitcnt vmcnt(38)
    v_mfma_f32_16x16x32_bf16 v[32:35], v[64:67], v[140:143], v[32:35]
    buffer_load_dwordx4 v[128:131], v12, s[52:55], s89 offen offset:3072 sc1
    buffer_load_dwordx4 v[132:135], v12, s[52:55], s91 offen offset:3072 sc1
    v_mfma_f32_16x16x32_bf16 v[36:39], v[68:71], v[140:143], v[36:39]
    v_mfma_f32_16x16x32_bf16 v[40:43], v[72:75], v[140:143], v[40:43]
    v_mfma_f32_16x16x32_bf16 v[44:47], v[76:79], v[140:143], v[44:47]
    s_waitcnt lgkmcnt(0)
    s_waitcnt vmcnt(39)
    v_mfma_f32_16x16x32_bf16 v[16:19], v[48:51], v[144:147], v[16:19]
    ds_read_b64_tr_b16 v[64:65], v2 offset:36864
    ds_read_b64_tr_b16 v[66:67], v6 offset:36864
    v_mfma_f32_16x16x32_bf16 v[20:23], v[52:55], v[144:147], v[20:23]
    ds_read_b64_tr_b16 v[68:69], v3 offset:36864
    ds_read_b64_tr_b16 v[70:71], v7 offset:36864
    v_mfma_f32_16x16x32_bf16 v[24:27], v[56:59], v[144:147], v[24:27]
    ds_read_b64_tr_b16 v[72:73], v4 offset:36864
    ds_read_b64_tr_b16 v[74:75], v8 offset:36864
    v_mfma_f32_16x16x32_bf16 v[28:31], v[60:63], v[144:147], v[28:31]
    ds_read_b64_tr_b16 v[76:77], v5 offset:36864
    ds_read_b64_tr_b16 v[78:79], v9 offset:36864
    s_waitcnt vmcnt(38)
    v_mfma_f32_16x16x32_bf16 v[32:35], v[48:51], v[148:151], v[32:35]
    s_add_u32 s89, s88, 28672
    buffer_load_dwordx4 v[136:139], v12, s[52:55], s89 offen offset:0 sc1
    v_mfma_f32_16x16x32_bf16 v[36:39], v[52:55], v[148:151], v[36:39]
    s_add_u32 s91, s88, 61440
    buffer_load_dwordx4 v[140:143], v12, s[52:55], s91 offen offset:0 sc1
    v_mfma_f32_16x16x32_bf16 v[40:43], v[56:59], v[148:151], v[40:43]
    v_mfma_f32_16x16x32_bf16 v[44:47], v[60:63], v[148:151], v[44:47]
    s_waitcnt lgkmcnt(0)
    s_waitcnt vmcnt(39)
    v_mfma_f32_16x16x32_bf16 v[16:19], v[64:67], v[152:155], v[16:19]
    ds_read_b64_tr_b16 v[48:49], v2 offset:40960
    ds_read_b64_tr_b16 v[50:51], v6 offset:40960
    v_mfma_f32_16x16x32_bf16 v[20:23], v[68:71], v[152:155], v[20:23]
    ds_read_b64_tr_b16 v[52:53], v3 offset:40960
    ds_read_b64_tr_b16 v[54:55], v7 offset:40960
    v_mfma_f32_16x16x32_bf16 v[24:27], v[72:75], v[152:155], v[24:27]
    ds_read_b64_tr_b16 v[56:57], v4 offset:40960
    ds_read_b64_tr_b16 v[58:59], v8 offset:40960
    v_mfma_f32_16x16x32_bf16 v[28:31], v[76:79], v[152:155], v[28:31]
    ds_read_b64_tr_b16 v[60:61], v5 offset:40960
    ds_read_b64_tr_b16 v[62:63], v9 offset:40960
    s_waitcnt vmcnt(38)
    v_mfma_f32_16x16x32_bf16 v[32:35], v[64:67], v[156:159], v[32:35]
    buffer_load_dwordx4 v[144:147], v12, s[52:55], s89 offen offset:1024 sc1
    buffer_load_dwordx4 v[148:151], v12, s[52:55], s91 offen offset:1024 sc1
    v_mfma_f32_16x16x32_bf16 v[36:39], v[68:71], v[156:159], v[36:39]
    v_mfma_f32_16x16x32_bf16 v[40:43], v[72:75], v[156:159], v[40:43]
    v_mfma_f32_16x16x32_bf16 v[44:47], v[76:79], v[156:159], v[44:47]
    s_waitcnt lgkmcnt(0)
    s_waitcnt vmcnt(39)
    v_mfma_f32_16x16x32_bf16 v[16:19], v[48:51], v[160:163], v[16:19]
    ds_read_b64_tr_b16 v[64:65], v2 offset:45056
    ds_read_b64_tr_b16 v[66:67], v6 offset:45056
    v_mfma_f32_16x16x32_bf16 v[20:23], v[52:55], v[160:163], v[20:23]
    ds_read_b64_tr_b16 v[68:69], v3 offset:45056
    ds_read_b64_tr_b16 v[70:71], v7 offset:45056
    v_mfma_f32_16x16x32_bf16 v[24:27], v[56:59], v[160:163], v[24:27]
    ds_read_b64_tr_b16 v[72:73], v4 offset:45056
    ds_read_b64_tr_b16 v[74:75], v8 offset:45056
    v_mfma_f32_16x16x32_bf16 v[28:31], v[60:63], v[160:163], v[28:31]
    ds_read_b64_tr_b16 v[76:77], v5 offset:45056
    ds_read_b64_tr_b16 v[78:79], v9 offset:45056
    s_waitcnt vmcnt(38)
    v_mfma_f32_16x16x32_bf16 v[32:35], v[48:51], v[164:167], v[32:35]
    buffer_load_dwordx4 v[152:155], v12, s[52:55], s89 offen offset:2048 sc1
    buffer_load_dwordx4 v[156:159], v12, s[52:55], s91 offen offset:2048 sc1
    v_mfma_f32_16x16x32_bf16 v[36:39], v[52:55], v[164:167], v[36:39]
    v_mfma_f32_16x16x32_bf16 v[40:43], v[56:59], v[164:167], v[40:43]
    v_mfma_f32_16x16x32_bf16 v[44:47], v[60:63], v[164:167], v[44:47]
    s_waitcnt lgkmcnt(0)
    s_waitcnt vmcnt(39)
    v_mfma_f32_16x16x32_bf16 v[16:19], v[64:67], v[168:171], v[16:19]
    ds_read_b64_tr_b16 v[48:49], v2 offset:49152
    ds_read_b64_tr_b16 v[50:51], v6 offset:49152
    v_mfma_f32_16x16x32_bf16 v[20:23], v[68:71], v[168:171], v[20:23]
    ds_read_b64_tr_b16 v[52:53], v3 offset:49152
    ds_read_b64_tr_b16 v[54:55], v7 offset:49152
    v_mfma_f32_16x16x32_bf16 v[24:27], v[72:75], v[168:171], v[24:27]
    ds_read_b64_tr_b16 v[56:57], v4 offset:49152
    ds_read_b64_tr_b16 v[58:59], v8 offset:49152
    v_mfma_f32_16x16x32_bf16 v[28:31], v[76:79], v[168:171], v[28:31]
    ds_read_b64_tr_b16 v[60:61], v5 offset:49152
    ds_read_b64_tr_b16 v[62:63], v9 offset:49152
    s_waitcnt vmcnt(38)
    v_mfma_f32_16x16x32_bf16 v[32:35], v[64:67], v[172:175], v[32:35]
    buffer_load_dwordx4 v[160:163], v12, s[52:55], s89 offen offset:3072 sc1
    buffer_load_dwordx4 v[164:167], v12, s[52:55], s91 offen offset:3072 sc1
    v_mfma_f32_16x16x32_bf16 v[36:39], v[68:71], v[172:175], v[36:39]
    v_mfma_f32_16x16x32_bf16 v[40:43], v[72:75], v[172:175], v[40:43]
    v_mfma_f32_16x16x32_bf16 v[44:47], v[76:79], v[172:175], v[44:47]
    s_waitcnt lgkmcnt(0)
    s_waitcnt vmcnt(39)
    v_mfma_f32_16x16x32_bf16 v[16:19], v[48:51], v[176:179], v[16:19]
    ds_read_b64_tr_b16 v[64:65], v2 offset:53248
    ds_read_b64_tr_b16 v[66:67], v6 offset:53248
    v_mfma_f32_16x16x32_bf16 v[20:23], v[52:55], v[176:179], v[20:23]
    ds_read_b64_tr_b16 v[68:69], v3 offset:53248
    ds_read_b64_tr_b16 v[70:71], v7 offset:53248
    v_mfma_f32_16x16x32_bf16 v[24:27], v[56:59], v[176:179], v[24:27]
    ds_read_b64_tr_b16 v[72:73], v4 offset:53248
    ds_read_b64_tr_b16 v[74:75], v8 offset:53248
    v_mfma_f32_16x16x32_bf16 v[28:31], v[60:63], v[176:179], v[28:31]
    ds_read_b64_tr_b16 v[76:77], v5 offset:53248
    ds_read_b64_tr_b16 v[78:79], v9 offset:53248
    s_waitcnt vmcnt(38)
    v_mfma_f32_16x16x32_bf16 v[32:35], v[48:51], v[180:183], v[32:35]
    v_mfma_f32_16x16x32_bf16 v[36:39], v[52:55], v[180:183], v[36:39]
    v_mfma_f32_16x16x32_bf16 v[40:43], v[56:59], v[180:183], v[40:43]
    v_mfma_f32_16x16x32_bf16 v[44:47], v[60:63], v[180:183], v[44:47]
    s_waitcnt lgkmcnt(0)
    s_waitcnt vmcnt(37)
    v_mfma_f32_16x16x32_bf16 v[16:19], v[64:67], v[184:187], v[16:19]
    ds_read_b64_tr_b16 v[48:49], v2 offset:57344
    ds_read_b64_tr_b16 v[50:51], v6 offset:57344
    v_mfma_f32_16x16x32_bf16 v[20:23], v[68:71], v[184:187], v[20:23]
    ds_read_b64_tr_b16 v[52:53], v3 offset:57344
    ds_read_b64_tr_b16 v[54:55], v7 offset:57344
    v_mfma_f32_16x16x32_bf16 v[24:27], v[72:75], v[184:187], v[24:27]
    ds_read_b64_tr_b16 v[56:57], v4 offset:57344
    ds_read_b64_tr_b16 v[58:59], v8 offset:57344
    v_mfma_f32_16x16x32_bf16 v[28:31], v[76:79], v[184:187], v[28:31]
    ds_read_b64_tr_b16 v[60:61], v5 offset:57344
    ds_read_b64_tr_b16 v[62:63], v9 offset:57344
    s_waitcnt vmcnt(36)
    v_mfma_f32_16x16x32_bf16 v[32:35], v[64:67], v[188:191], v[32:35]
    v_mfma_f32_16x16x32_bf16 v[36:39], v[68:71], v[188:191], v[36:39]
    v_mfma_f32_16x16x32_bf16 v[40:43], v[72:75], v[188:191], v[40:43]
    v_mfma_f32_16x16x32_bf16 v[44:47], v[76:79], v[188:191], v[44:47]
    s_waitcnt lgkmcnt(0)
    s_waitcnt vmcnt(35)
    v_mfma_f32_16x16x32_bf16 v[16:19], v[48:51], v[192:195], v[16:19]
    ds_read_b64_tr_b16 v[64:65], v2 offset:61440
    ds_read_b64_tr_b16 v[66:67], v6 offset:61440
    v_mfma_f32_16x16x32_bf16 v[20:23], v[52:55], v[192:195], v[20:23]
    ds_read_b64_tr_b16 v[68:69], v3 offset:61440
    ds_read_b64_tr_b16 v[70:71], v7 offset:61440
    v_mfma_f32_16x16x32_bf16 v[24:27], v[56:59], v[192:195], v[24:27]
    ds_read_b64_tr_b16 v[72:73], v4 offset:61440
    ds_read_b64_tr_b16 v[74:75], v8 offset:61440
    v_mfma_f32_16x16x32_bf16 v[28:31], v[60:63], v[192:195], v[28:31]
    ds_read_b64_tr_b16 v[76:77], v5 offset:61440
    ds_read_b64_tr_b16 v[78:79], v9 offset:61440
    s_waitcnt vmcnt(34)
    v_mfma_f32_16x16x32_bf16 v[32:35], v[48:51], v[196:199], v[32:35]
    v_mfma_f32_16x16x32_bf16 v[36:39], v[52:55], v[196:199], v[36:39]
    v_mfma_f32_16x16x32_bf16 v[40:43], v[56:59], v[196:199], v[40:43]
    v_mfma_f32_16x16x32_bf16 v[44:47], v[60:63], v[196:199], v[44:47]
    s_waitcnt lgkmcnt(0)
    v_add_u32 v2, 65536, v2
    v_add_u32 v3, 65536, v3
    v_add_u32 v4, 65536, v4
    v_add_u32 v5, 65536, v5
    v_add_u32 v6, 65536, v6
    v_add_u32 v7, 65536, v7
    v_add_u32 v8, 65536, v8
    v_add_u32 v9, 65536, v9
    s_waitcnt vmcnt(33)
    v_mfma_f32_16x16x32_bf16 v[16:19], v[64:67], v[200:203], v[16:19]
    ds_read_b64_tr_b16 v[48:49], v2 offset:0
    ds_read_b64_tr_b16 v[50:51], v6 offset:0
    v_mfma_f32_16x16x32_bf16 v[20:23], v[68:71], v[200:203], v[20:23]
    ds_read_b64_tr_b16 v[52:53], v3 offset:0
    ds_read_b64_tr_b16 v[54:55], v7 offset:0
    v_mfma_f32_16x16x32_bf16 v[24:27], v[72:75], v[200:203], v[24:27]
    ds_read_b64_tr_b16 v[56:57], v4 offset:0
    ds_read_b64_tr_b16 v[58:59], v8 offset:0
    v_mfma_f32_16x16x32_bf16 v[28:31], v[76:79], v[200:203], v[28:31]
    ds_read_b64_tr_b16 v[60:61], v5 offset:0
    ds_read_b64_tr_b16 v[62:63], v9 offset:0
    s_waitcnt vmcnt(32)
    v_mfma_f32_16x16x32_bf16 v[32:35], v[64:67], v[204:207], v[32:35]
    v_mfma_f32_16x16x32_bf16 v[36:39], v[68:71], v[204:207], v[36:39]
    v_mfma_f32_16x16x32_bf16 v[40:43], v[72:75], v[204:207], v[40:43]
    v_mfma_f32_16x16x32_bf16 v[44:47], v[76:79], v[204:207], v[44:47]
    s_waitcnt lgkmcnt(0)
    s_waitcnt vmcnt(31)
    v_mfma_f32_16x16x32_bf16 v[16:19], v[48:51], v[208:211], v[16:19]
    ds_read_b64_tr_b16 v[64:65], v2 offset:4096
    ds_read_b64_tr_b16 v[66:67], v6 offset:4096
    v_mfma_f32_16x16x32_bf16 v[20:23], v[52:55], v[208:211], v[20:23]
    ds_read_b64_tr_b16 v[68:69], v3 offset:4096
    ds_read_b64_tr_b16 v[70:71], v7 offset:4096
    v_mfma_f32_16x16x32_bf16 v[24:27], v[56:59], v[208:211], v[24:27]
    ds_read_b64_tr_b16 v[72:73], v4 offset:4096
    ds_read_b64_tr_b16 v[74:75], v8 offset:4096
    v_mfma_f32_16x16x32_bf16 v[28:31], v[60:63], v[208:211], v[28:31]
    ds_read_b64_tr_b16 v[76:77], v5 offset:4096
    ds_read_b64_tr_b16 v[78:79], v9 offset:4096
    s_waitcnt vmcnt(30)
    v_mfma_f32_16x16x32_bf16 v[32:35], v[48:51], v[212:215], v[32:35]
    v_mfma_f32_16x16x32_bf16 v[36:39], v[52:55], v[212:215], v[36:39]
    v_mfma_f32_16x16x32_bf16 v[40:43], v[56:59], v[212:215], v[40:43]
    v_mfma_f32_16x16x32_bf16 v[44:47], v[60:63], v[212:215], v[44:47]
    s_waitcnt lgkmcnt(0)
    s_waitcnt vmcnt(29)
    v_mfma_f32_16x16x32_bf16 v[16:19], v[64:67], v[216:219], v[16:19]
    ds_read_b64_tr_b16 v[48:49], v2 offset:8192
    ds_read_b64_tr_b16 v[50:51], v6 offset:8192
    v_mfma_f32_16x16x32_bf16 v[20:23], v[68:71], v[216:219], v[20:23]
    ds_read_b64_tr_b16 v[52:53], v3 offset:8192
    ds_read_b64_tr_b16 v[54:55], v7 offset:8192
    v_mfma_f32_16x16x32_bf16 v[24:27], v[72:75], v[216:219], v[24:27]
    ds_read_b64_tr_b16 v[56:57], v4 offset:8192
    ds_read_b64_tr_b16 v[58:59], v8 offset:8192
    v_mfma_f32_16x16x32_bf16 v[28:31], v[76:79], v[216:219], v[28:31]
    ds_read_b64_tr_b16 v[60:61], v5 offset:8192
    ds_read_b64_tr_b16 v[62:63], v9 offset:8192
    s_waitcnt vmcnt(28)
    v_mfma_f32_16x16x32_bf16 v[32:35], v[64:67], v[220:223], v[32:35]
    v_mfma_f32_16x16x32_bf16 v[36:39], v[68:71], v[220:223], v[36:39]
    v_mfma_f32_16x16x32_bf16 v[40:43], v[72:75], v[220:223], v[40:43]
    v_mfma_f32_16x16x32_bf16 v[44:47], v[76:79], v[220:223], v[44:47]
    s_waitcnt lgkmcnt(0)
    s_waitcnt vmcnt(27)
    v_mfma_f32_16x16x32_bf16 v[16:19], v[48:51], v[224:227], v[16:19]
    ds_read_b64_tr_b16 v[64:65], v2 offset:12288
    ds_read_b64_tr_b16 v[66:67], v6 offset:12288
    v_mfma_f32_16x16x32_bf16 v[20:23], v[52:55], v[224:227], v[20:23]
    ds_read_b64_tr_b16 v[68:69], v3 offset:12288
    ds_read_b64_tr_b16 v[70:71], v7 offset:12288
    v_mfma_f32_16x16x32_bf16 v[24:27], v[56:59], v[224:227], v[24:27]
    ds_read_b64_tr_b16 v[72:73], v4 offset:12288
    ds_read_b64_tr_b16 v[74:75], v8 offset:12288
    v_mfma_f32_16x16x32_bf16 v[28:31], v[60:63], v[224:227], v[28:31]
    ds_read_b64_tr_b16 v[76:77], v5 offset:12288
    ds_read_b64_tr_b16 v[78:79], v9 offset:12288
    s_waitcnt vmcnt(26)
    v_mfma_f32_16x16x32_bf16 v[32:35], v[48:51], v[228:231], v[32:35]
    v_mfma_f32_16x16x32_bf16 v[36:39], v[52:55], v[228:231], v[36:39]
    v_mfma_f32_16x16x32_bf16 v[40:43], v[56:59], v[228:231], v[40:43]
    v_mfma_f32_16x16x32_bf16 v[44:47], v[60:63], v[228:231], v[44:47]
    s_waitcnt lgkmcnt(0)
    s_waitcnt vmcnt(25)
    v_mfma_f32_16x16x32_bf16 v[16:19], v[64:67], v[232:235], v[16:19]
    ds_read_b64_tr_b16 v[48:49], v2 offset:16384
    ds_read_b64_tr_b16 v[50:51], v6 offset:16384
    v_mfma_f32_16x16x32_bf16 v[20:23], v[68:71], v[232:235], v[20:23]
    ds_read_b64_tr_b16 v[52:53], v3 offset:16384
    ds_read_b64_tr_b16 v[54:55], v7 offset:16384
    v_mfma_f32_16x16x32_bf16 v[24:27], v[72:75], v[232:235], v[24:27]
    ds_read_b64_tr_b16 v[56:57], v4 offset:16384
    ds_read_b64_tr_b16 v[58:59], v8 offset:16384
    v_mfma_f32_16x16x32_bf16 v[28:31], v[76:79], v[232:235], v[28:31]
    ds_read_b64_tr_b16 v[60:61], v5 offset:16384
    ds_read_b64_tr_b16 v[62:63], v9 offset:16384
    s_waitcnt vmcnt(24)
    v_mfma_f32_16x16x32_bf16 v[32:35], v[64:67], v[236:239], v[32:35]
    v_mfma_f32_16x16x32_bf16 v[36:39], v[68:71], v[236:239], v[36:39]
    v_mfma_f32_16x16x32_bf16 v[40:43], v[72:75], v[236:239], v[40:43]
    v_mfma_f32_16x16x32_bf16 v[44:47], v[76:79], v[236:239], v[44:47]
    s_waitcnt lgkmcnt(0)
    s_waitcnt vmcnt(23)
    v_mfma_f32_16x16x32_bf16 v[16:19], v[48:51], v[240:243], v[16:19]
    ds_read_b64_tr_b16 v[64:65], v2 offset:20480
    ds_read_b64_tr_b16 v[66:67], v6 offset:20480
    v_mfma_f32_16x16x32_bf16 v[20:23], v[52:55], v[240:243], v[20:23]
    ds_read_b64_tr_b16 v[68:69], v3 offset:20480
    ds_read_b64_tr_b16 v[70:71], v7 offset:20480
    v_mfma_f32_16x16x32_bf16 v[24:27], v[56:59], v[240:243], v[24:27]
    ds_read_b64_tr_b16 v[72:73], v4 offset:20480
    ds_read_b64_tr_b16 v[74:75], v8 offset:20480
    v_mfma_f32_16x16x32_bf16 v[28:31], v[60:63], v[240:243], v[28:31]
    ds_read_b64_tr_b16 v[76:77], v5 offset:20480
    ds_read_b64_tr_b16 v[78:79], v9 offset:20480
    s_waitcnt vmcnt(22)
    v_mfma_f32_16x16x32_bf16 v[32:35], v[48:51], v[244:247], v[32:35]
    v_mfma_f32_16x16x32_bf16 v[36:39], v[52:55], v[244:247], v[36:39]
    v_mfma_f32_16x16x32_bf16 v[40:43], v[56:59], v[244:247], v[40:43]
    v_mfma_f32_16x16x32_bf16 v[44:47], v[60:63], v[244:247], v[44:47]
    s_waitcnt lgkmcnt(0)
    s_waitcnt vmcnt(21)
    v_mfma_f32_16x16x32_bf16 v[16:19], v[64:67], v[80:83], v[16:19]
    ds_read_b64_tr_b16 v[48:49], v2 offset:55296
    ds_read_b64_tr_b16 v[50:51], v6 offset:55296
    v_mfma_f32_16x16x32_bf16 v[20:23], v[68:71], v[80:83], v[20:23]
    ds_read_b64_tr_b16 v[52:53], v3 offset:55296
    ds_read_b64_tr_b16 v[54:55], v7 offset:55296
    v_mfma_f32_16x16x32_bf16 v[24:27], v[72:75], v[80:83], v[24:27]
    ds_read_b64_tr_b16 v[56:57], v4 offset:55296
    ds_read_b64_tr_b16 v[58:59], v8 offset:55296
    v_mfma_f32_16x16x32_bf16 v[28:31], v[76:79], v[80:83], v[28:31]
    ds_read_b64_tr_b16 v[60:61], v5 offset:55296
    ds_read_b64_tr_b16 v[62:63], v9 offset:55296
    s_waitcnt vmcnt(20)
    v_mfma_f32_16x16x32_bf16 v[32:35], v[64:67], v[84:87], v[32:35]
    v_mfma_f32_16x16x32_bf16 v[36:39], v[68:71], v[84:87], v[36:39]
    v_mfma_f32_16x16x32_bf16 v[40:43], v[72:75], v[84:87], v[40:43]
    v_mfma_f32_16x16x32_bf16 v[44:47], v[76:79], v[84:87], v[44:47]
    s_waitcnt lgkmcnt(0)
    s_waitcnt vmcnt(19)
    v_mfma_f32_16x16x32_bf16 v[16:19], v[48:51], v[88:91], v[16:19]
    ds_read_b64_tr_b16 v[64:65], v2 offset:59392
    ds_read_b64_tr_b16 v[66:67], v6 offset:59392
    v_mfma_f32_16x16x32_bf16 v[20:23], v[52:55], v[88:91], v[20:23]
    ds_read_b64_tr_b16 v[68:69], v3 offset:59392
    ds_read_b64_tr_b16 v[70:71], v7 offset:59392
    v_mfma_f32_16x16x32_bf16 v[24:27], v[56:59], v[88:91], v[24:27]
    ds_read_b64_tr_b16 v[72:73], v4 offset:59392
    ds_read_b64_tr_b16 v[74:75], v8 offset:59392
    v_mfma_f32_16x16x32_bf16 v[28:31], v[60:63], v[88:91], v[28:31]
    ds_read_b64_tr_b16 v[76:77], v5 offset:59392
    ds_read_b64_tr_b16 v[78:79], v9 offset:59392
    s_waitcnt vmcnt(18)
    v_mfma_f32_16x16x32_bf16 v[32:35], v[48:51], v[92:95], v[32:35]
    v_mfma_f32_16x16x32_bf16 v[36:39], v[52:55], v[92:95], v[36:39]
    v_mfma_f32_16x16x32_bf16 v[40:43], v[56:59], v[92:95], v[40:43]
    v_mfma_f32_16x16x32_bf16 v[44:47], v[60:63], v[92:95], v[44:47]
    s_waitcnt lgkmcnt(0)
    v_add_u32 v2, 63488, v2
    v_add_u32 v3, 63488, v3
    v_add_u32 v4, 63488, v4
    v_add_u32 v5, 63488, v5
    v_add_u32 v6, 63488, v6
    v_add_u32 v7, 63488, v7
    v_add_u32 v8, 63488, v8
    v_add_u32 v9, 63488, v9
LB_s4:
    ds_read_b32 v14, v10 offset:16
    s_waitcnt lgkmcnt(0)
    v_readfirstlane_b32 s78, v14
    s_nop 0
    s_cmp_ge_u32 s78, 4
    s_cbranch_scc0 LB_s4
    s_waitcnt vmcnt(17)
    v_mfma_f32_16x16x32_bf16 v[16:19], v[64:67], v[96:99], v[16:19]
    ds_read_b64_tr_b16 v[48:49], v2 offset:0
    ds_read_b64_tr_b16 v[50:51], v6 offset:0
    v_mfma_f32_16x16x32_bf16 v[20:23], v[68:71], v[96:99], v[20:23]
    ds_read_b64_tr_b16 v[52:53], v3 offset:0
    ds_read_b64_tr_b16 v[54:55], v7 offset:0
    v_mfma_f32_16x16x32_bf16 v[24:27], v[72:75], v[96:99], v[24:27]
    ds_read_b64_tr_b16 v[56:57], v4 offset:0
    ds_read_b64_tr_b16 v[58:59], v8 offset:0
    v_mfma_f32_16x16x32_bf16 v[28:31], v[76:79], v[96:99], v[28:31]
    ds_read_b64_tr_b16 v[60:61], v5 offset:0
    ds_read_b64_tr_b16 v[62:63], v9 offset:0
    s_waitcnt vmcnt(16)
    v_mfma_f32_16x16x32_bf16 v[32:35], v[64:67], v[100:103], v[32:35]
    v_mfma_f32_16x16x32_bf16 v[36:39], v[68:71], v[100:103], v[36:39]
    v_mfma_f32_16x16x32_bf16 v[40:43], v[72:75], v[100:103], v[40:43]
    v_mfma_f32_16x16x32_bf16 v[44:47], v[76:79], v[100:103], v[44:47]
    s_waitcnt lgkmcnt(0)
    s_waitcnt vmcnt(15)
    v_mfma_f32_16x16x32_bf16 v[16:19], v[48:51], v[104:107], v[16:19]
    ds_read_b64_tr_b16 v[64:65], v2 offset:4096
    ds_read_b64_tr_b16 v[66:67], v6 offset:4096
    v_mfma_f32_16x16x32_bf16 v[20:23], v[52:55], v[104:107], v[20:23]
    ds_read_b64_tr_b16 v[68:69], v3 offset:4096
    ds_read_b64_tr_b16 v[70:71], v7 offset:4096
    v_mfma_f32_16x16x32_bf16 v[24:27], v[56:59], v[104:107], v[24:27]
    ds_read_b64_tr_b16 v[72:73], v4 offset:4096
    ds_read_b64_tr_b16 v[74:75], v8 offset:4096
    v_mfma_f32_16x16x32_bf16 v[28:31], v[60:63], v[104:107], v[28:31]
    ds_read_b64_tr_b16 v[76:77], v5 offset:4096
    ds_read_b64_tr_b16 v[78:79], v9 offset:4096
    s_waitcnt vmcnt(14)
    v_mfma_f32_16x16x32_bf16 v[32:35], v[48:51], v[108:111], v[32:35]
    v_mfma_f32_16x16x32_bf16 v[36:39], v[52:55], v[108:111], v[36:39]
    v_mfma_f32_16x16x32_bf16 v[40:43], v[56:59], v[108:111], v[40:43]
    v_mfma_f32_16x16x32_bf16 v[44:47], v[60:63], v[108:111], v[44:47]
    s_waitcnt lgkmcnt(0)
    s_waitcnt vmcnt(13)
    v_mfma_f32_16x16x32_bf16 v[16:19], v[64:67], v[112:115], v[16:19]
    ds_read_b64_tr_b16 v[48:49], v2 offset:8320
    ds_read_b64_tr_b16 v[50:51], v6 offset:8320
    v_mfma_f32_16x16x32_bf16 v[20:23], v[68:71], v[112:115], v[20:23]
    ds_read_b64_tr_b16 v[52:53], v3 offset:8320
    ds_read_b64_tr_b16 v[54:55], v7 offset:8320
    v_mfma_f32_16x16x32_bf16 v[24:27], v[72:75], v[112:115], v[24:27]
    ds_read_b64_tr_b16 v[56:57], v4 offset:8320
    ds_read_b64_tr_b16 v[58:59], v8 offset:8320
    v_mfma_f32_16x16x32_bf16 v[28:31], v[76:79], v[112:115], v[28:31]
    ds_read_b64_tr_b16 v[60:61], v5 offset:8320
    ds_read_b64_tr_b16 v[62:63], v9 offset:8320
    s_waitcnt vmcnt(12)
    v_mfma_f32_16x16x32_bf16 v[32:35], v[64:67], v[116:119], v[32:35]
    v_mfma_f32_16x16x32_bf16 v[36:39], v[68:71], v[116:119], v[36:39]
    v_mfma_f32_16x16x32_bf16 v[40:43], v[72:75], v[116:119], v[40:43]
    v_mfma_f32_16x16x32_bf16 v[44:47], v[76:79], v[116:119], v[44:47]
    s_waitcnt lgkmcnt(0)
    s_waitcnt vmcnt(11)
    v_mfma_f32_16x16x32_bf16 v[16:19], v[48:51], v[120:123], v[16:19]
    ds_read_b64_tr_b16 v[64:65], v2 offset:12416
    ds_read_b64_tr_b16 v[66:67], v6 offset:12416
    v_mfma_f32_16x16x32_bf16 v[20:23], v[52:55], v[120:123], v[20:23]
    ds_read_b64_tr_b16 v[68:69], v3 offset:12416
    ds_read_b64_tr_b16 v[70:71], v7 offset:12416
    v_mfma_f32_16x16x32_bf16 v[24:27], v[56:59], v[120:123], v[24:27]
    ds_read_b64_tr_b16 v[72:73], v4 offset:12416
    ds_read_b64_tr_b16 v[74:75], v8 offset:12416
    v_mfma_f32_16x16x32_bf16 v[28:31], v[60:63], v[120:123], v[28:31]
    ds_read_b64_tr_b16 v[76:77], v5 offset:12416
    ds_read_b64_tr_b16 v[78:79], v9 offset:12416
    s_waitcnt vmcnt(10)
    v_mfma_f32_16x16x32_bf16 v[32:35], v[48:51], v[124:127], v[32:35]
    v_mfma_f32_16x16x32_bf16 v[36:39], v[52:55], v[124:127], v[36:39]
    v_mfma_f32_16x16x32_bf16 v[40:43], v[56:59], v[124:127], v[40:43]
    v_mfma_f32_16x16x32_bf16 v[44:47], v[60:63], v[124:127], v[44:47]
    s_waitcnt lgkmcnt(0)
    s_waitcnt vmcnt(9)
    v_mfma_f32_16x16x32_bf16 v[16:19], v[64:67], v[128:131], v[16:19]
    ds_read_b64_tr_b16 v[48:49], v2 offset:16640
    ds_read_b64_tr_b16 v[50:51], v6 offset:16640
    v_mfma_f32_16x16x32_bf16 v[20:23], v[68:71], v[128:131], v[20:23]
    ds_read_b64_tr_b16 v[52:53], v3 offset:16640
    ds_read_b64_tr_b16 v[54:55], v7 offset:16640
    v_mfma_f32_16x16x32_bf16 v[24:27], v[72:75], v[128:131], v[24:27]
    ds_read_b64_tr_b16 v[56:57], v4 offset:16640
    ds_read_b64_tr_b16 v[58:59], v8 offset:16640
    v_mfma_f32_16x16x32_bf16 v[28:31], v[76:79], v[128:131], v[28:31]
    ds_read_b64_tr_b16 v[60:61], v5 offset:16640
    ds_read_b64_tr_b16 v[62:63], v9 offset:16640
    s_waitcnt vmcnt(8)
    v_mfma_f32_16x16x32_bf16 v[32:35], v[64:67], v[132:135], v[32:35]
    v_mfma_f32_16x16x32_bf16 v[36:39], v[68:71], v[132:135], v[36:39]
    v_mfma_f32_16x16x32_bf16 v[40:43], v[72:75], v[132:135], v[40:43]
    v_mfma_f32_16x16x32_bf16 v[44:47], v[76:79], v[132:135], v[44:47]
    s_waitcnt lgkmcnt(0)
    s_waitcnt vmcnt(7)
    v_mfma_f32_16x16x32_bf16 v[16:19], v[48:51], v[136:139], v[16:19]
    ds_read_b64_tr_b16 v[64:65], v2 offset:20736
    ds_read_b64_tr_b16 v[66:67], v6 offset:20736
    v_mfma_f32_16x16x32_bf16 v[20:23], v[52:55], v[136:139], v[20:23]
    ds_read_b64_tr_b16 v[68:69], v3 offset:20736
    ds_read_b64_tr_b16 v[70:71], v7 offset:20736
    v_mfma_f32_16x16x32_bf16 v[24:27], v[56:59], v[136:139], v[24:27]
    ds_read_b64_tr_b16 v[72:73], v4 offset:20736
    ds_read_b64_tr_b16 v[74:75], v8 offset:20736
    v_mfma_f32_16x16x32_bf16 v[28:31], v[60:63], v[136:139], v[28:31]
    ds_read_b64_tr_b16 v[76:77], v5 offset:20736
    ds_read_b64_tr_b16 v[78:79], v9 offset:20736
    s_waitcnt vmcnt(6)
    v_mfma_f32_16x16x32_bf16 v[32:35], v[48:51], v[140:143], v[32:35]
    v_mfma_f32_16x16x32_bf16 v[36:39], v[52:55], v[140:143], v[36:39]
    v_mfma_f32_16x16x32_bf16 v[40:43], v[56:59], v[140:143], v[40:43]
    v_mfma_f32_16x16x32_bf16 v[44:47], v[60:63], v[140:143], v[44:47]
    s_waitcnt lgkmcnt(0)
    s_waitcnt vmcnt(5)
    v_mfma_f32_16x16x32_bf16 v[16:19], v[64:67], v[144:147], v[16:19]
    ds_read_b64_tr_b16 v[48:49], v2 offset:24960
    ds_read_b64_tr_b16 v[50:51], v6 offset:24960
    v_mfma_f32_16x16x32_bf16 v[20:23], v[68:71], v[144:147], v[20:23]
    ds_read_b64_tr_b16 v[52:53], v3 offset:24960
    ds_read_b64_tr_b16 v[54:55], v7 offset:24960
    v_mfma_f32_16x16x32_bf16 v[24:27], v[72:75], v[144:147], v[24:27]
    ds_read_b64_tr_b16 v[56:57], v4 offset:24960
    ds_read_b64_tr_b16 v[58:59], v8 offset:24960
    v_mfma_f32_16x16x32_bf16 v[28:31], v[76:79], v[144:147], v[28:31]
    ds_read_b64_tr_b16 v[60:61], v5 offset:24960
    ds_read_b64_tr_b16 v[62:63], v9 offset:24960
    s_waitcnt vmcnt(4)
    v_mfma_f32_16x16x32_bf16 v[32:35], v[64:67], v[148:151], v[32:35]
    v_mfma_f32_16x16x32_bf16 v[36:39], v[68:71], v[148:151], v[36:39]
    v_mfma_f32_16x16x32_bf16 v[40:43], v[72:75], v[148:151], v[40:43]
    v_mfma_f32_16x16x32_bf16 v[44:47], v[76:79], v[148:151], v[44:47]
    s_waitcnt lgkmcnt(0)
    s_waitcnt vmcnt(3)
    v_mfma_f32_16x16x32_bf16 v[16:19], v[48:51], v[152:155], v[16:19]
    ds_read_b64_tr_b16 v[64:65], v2 offset:29056
    ds_read_b64_tr_b16 v[66:67], v6 offset:29056
    v_mfma_f32_16x16x32_bf16 v[20:23], v[52:55], v[152:155], v[20:23]
    ds_read_b64_tr_b16 v[68:69], v3 offset:29056
    ds_read_b64_tr_b16 v[70:71], v7 offset:29056
    v_mfma_f32_16x16x32_bf16 v[24:27], v[56:59], v[152:155], v[24:27]
    ds_read_b64_tr_b16 v[72:73], v4 offset:29056
    ds_read_b64_tr_b16 v[74:75], v8 offset:29056
    v_mfma_f32_16x16x32_bf16 v[28:31], v[60:63], v[152:155], v[28:31]
    ds_read_b64_tr_b16 v[76:77], v5 offset:29056
    ds_read_b64_tr_b16 v[78:79], v9 offset:29056
    s_waitcnt vmcnt(2)
    v_mfma_f32_16x16x32_bf16 v[32:35], v[48:51], v[156:159], v[32:35]
    v_mfma_f32_16x16x32_bf16 v[36:39], v[52:55], v[156:159], v[36:39]
    v_mfma_f32_16x16x32_bf16 v[40:43], v[56:59], v[156:159], v[40:43]
    v_mfma_f32_16x16x32_bf16 v[44:47], v[60:63], v[156:159], v[44:47]
    s_waitcnt lgkmcnt(0)
    s_waitcnt vmcnt(1)
    v_mfma_f32_16x16x32_bf16 v[16:19], v[64:67], v[160:163], v[16:19]
    v_mfma_f32_16x16x32_bf16 v[20:23], v[68:71], v[160:163], v[20:23]
    v_mfma_f32_16x16x32_bf16 v[24:27], v[72:75], v[160:163], v[24:27]
    v_mfma_f32_16x16x32_bf16 v[28:31], v[76:79], v[160:163], v[28:31]
    s_waitcnt vmcnt(0)
    v_mfma_f32_16x16x32_bf16 v[32:35], v[64:67], v[164:167], v[32:35]
    v_mfma_f32_16x16x32_bf16 v[36:39], v[68:71], v[164:167], v[36:39]
    v_mfma_f32_16x16x32_bf16 v[40:43], v[72:75], v[164:167], v[40:43]
    v_mfma_f32_16x16x32_bf16 v[44:47], v[76:79], v[164:167], v[44:47]
    v_cvt_pk_bf16_f32 v48, v16, v17
    v_cvt_pk_bf16_f32 v49, v18, v19
    v_cvt_pk_bf16_f32 v50, v20, v21
    v_cvt_pk_bf16_f32 v51, v22, v23
    s_nop 0
    v_permlane16_swap_b32 v48, v50
    v_permlane16_swap_b32 v49, v51
    s_mov_b32 s95, 0
    buffer_store_dwordx4 v[48:51], v13, s[60:63], s95 offen offset:0
    v_cvt_pk_bf16_f32 v52, v24, v25
    v_cvt_pk_bf16_f32 v53, v26, v27
    v_cvt_pk_bf16_f32 v54, v28, v29
    v_cvt_pk_bf16_f32 v55, v30, v31
    s_nop 0
    v_permlane16_swap_b32 v52, v54
    v_permlane16_swap_b32 v53, v55
    s_mov_b32 s95, 0
    buffer_store_dwordx4 v[52:55], v13, s[60:63], s95 offen offset:64
    v_cvt_pk_bf16_f32 v56, v32, v33
    v_cvt_pk_bf16_f32 v57, v34, v35
    v_cvt_pk_bf16_f32 v58, v36, v37
    v_cvt_pk_bf16_f32 v59, v38, v39
    s_nop 0
    v_permlane16_swap_b32 v56, v58
    v_permlane16_swap_b32 v57, v59
    s_mov_b32 s95, 65536
    buffer_store_dwordx4 v[56:59], v13, s[60:63], s95 offen offset:0
    v_cvt_pk_bf16_f32 v60, v40, v41
    v_cvt_pk_bf16_f32 v61, v42, v43
    v_cvt_pk_bf16_f32 v62, v44, v45
    v_cvt_pk_bf16_f32 v63, v46, v47
    s_nop 0
    v_permlane16_swap_b32 v60, v62
    v_permlane16_swap_b32 v61, v63
    s_mov_b32 s95, 65536
    buffer_store_dwordx4 v[60:63], v13, s[60:63], s95 offen offset:64
    s_endpgm
LB_slow11:
    s_mov_b32 s79, 0
LB_pc11:
    buffer_load_dword v222, v223, s[68:71], 0 offen sc1
    s_add_u32 s79, s79, 1
    s_cmp_gt_u32 s79, 200000
    s_cbranch_scc1 LB_pc11_x
    s_waitcnt vmcnt(0)
    v_cmp_ne_u32 vcc, 128, v222
    s_cbranch_vccz LB_pc11_x
    s_sleep 2
    s_branch LB_pc11
LB_pc11_x:
    s_waitcnt vmcnt(0)
    s_branch LB_back11
LB_slow13:
    s_mov_b32 s79, 0
LB_pk13:
    buffer_load_dword v222, v223, s[52:55], s96 offen sc1
    s_add_u32 s79, s79, 1
    s_cmp_gt_u32 s79, 200000
    s_cbranch_scc1 LB_pk13_x
    s_waitcnt vmcnt(0)
    v_cmp_ne_u32 vcc, 1, v222
    s_cbranch_vccz LB_pk13_x
    s_sleep 2
    s_branch LB_pk13
LB_pk13_x:
    s_waitcnt vmcnt(0)
    s_branch LB_back13
L_end:
    s_endpgm
.section .rodata,"a"
.p2align 6
.amdhsa_kernel concat_heads__ssm_conv_h3__sliding_local_dilated__prompt_kernel
  .amdhsa_next_free_vgpr 256
  .amdhsa_next_free_sgpr 102
  .amdhsa_accum_offset 256
  .amdhsa_group_segment_fixed_size 0
  .amdhsa_kernarg_size 96
  .amdhsa_user_sgpr_count 2
  .amdhsa_user_sgpr_kernarg_segment_ptr 1
  .amdhsa_system_sgpr_workgroup_id_x 1
.end_amdhsa_kernel
```

```asm
; @launch grid=(256,1,1) block=(512,1,1) lds=163840
.amdgcn_target "amdgcn-amd-amdhsa--gfx950"
.text
.globl concat_heads__ssm_conv_h3__sliding_local_dilated__prompt_kernel
.p2align 8
.type concat_heads__ssm_conv_h3__sliding_local_dilated__prompt_kernel,@function
concat_heads__ssm_conv_h3__sliding_local_dilated__prompt_kernel:
    s_cmp_ge_u32 s2, 256
    s_cbranch_scc1 L_end
    s_load_dwordx4 s[16:19], s[0:1], 48
    s_load_dwordx8 s[4:11], s[0:1], 0
    s_load_dwordx4 s[12:15], s[0:1], 32
    s_load_dwordx8 s[20:27], s[0:1], 64
    v_lshrrev_b32 v1, 6, v0
    v_and_b32 v0, 63, v0
    v_readfirstlane_b32 s3, v1
    s_and_b32 s78, s2, 7
    s_lshr_b32 s79, s2, 3
    s_and_b32 s80, s78, 1
    s_lshl_b32 s80, s80, 3
    s_lshr_b32 s81, s78, 1
    s_lshl_b32 s81, s81, 2
    s_and_b32 s72, s79, 7
    s_add_u32 s72, s72, s80
    s_lshr_b32 s73, s79, 3
    s_add_u32 s73, s73, s81
    s_and_b32 s76, s79, 3
    s_add_u32 s76, s76, s81
    s_lshr_b32 s77, s79, 2
    s_add_u32 s77, s77, s80
    s_lshr_b32 s74, s79, 4
    s_xor_b32 s78, s78, 2
    s_lshl_b32 s78, s78, 1
    s_add_u32 s74, s74, s78
    s_and_b32 s75, s79, 15
    s_cmp_ge_u32 s3, 4
    s_cbranch_scc1 L_B
    v_lshrrev_b32 v5, 3, v0
    v_and_b32 v6, 7, v0
    v_lshrrev_b32 v7, 4, v0
    s_and_b32 s78, s3, 1
    s_lshl_b32 s78, s78, 2
    s_lshl_b32 s79, s72, 7
    s_lshl_b32 s80, s3, 3
    s_add_u32 s81, s79, s80
    v_add_u32 v8, s78, v7
    v_xor_b32 v8, v8, v6
    v_lshlrev_b32 v8, 4, v8
    v_add_u32 v2, s81, v5
    v_lshl_add_u32 v2, v2, 11, v8
    v_and_b32 v8, 1, v7
    v_lshl_or_b32 v8, v8, 1, s78
    v_xor_b32 v8, v8, v6
    v_lshlrev_b32 v8, 4, v8
    v_add_u32 v4, s80, v5
    v_mul_u32_u24 v4, 6144, v4
    s_lshl_b32 s82, s73, 7
    v_add3_u32 v4, v4, v8, s82
    s_lshl_b32 s78, s3, 1
    s_lshl_b32 s80, s3, 2
    s_add_u32 s79, s79, s80
    s_sub_u32 s79, s79, 16
    v_add_u32 v8, s78, v7
    v_xor_b32 v8, v8, v6
    v_and_b32 v8, 7, v8
    v_lshlrev_b32 v8, 4, v8
    v_add_u32 v3, s79, v5
    v_lshl_add_u32 v3, v3, 11, v8
    s_lshl_b32 s86, s3, 10
    s_add_u32 s87, s86, 75776
    s_lshl_b32 s88, s3, 9
    s_add_u32 s88, s88, 73728
    s_and_b32 s98, s73, 0
    s_and_b32 s78, s72, 8
    s_add_u32 s98, s98, s78
    s_add_u32 s78, s72, s73
    s_and_b32 s78, s78, 3
    s_waitcnt lgkmcnt(0)
    s_mov_b32 s28, s16
    s_mov_b32 s29, s17
    s_mov_b32 s30, 0x400000
    s_mov_b32 s31, 0x20000
    s_mov_b32 s32, s18
    s_mov_b32 s33, s19
    s_mov_b32 s34, 0x600000
    s_mov_b32 s35, 0x20000
    s_bfe_u32 s18, s72, 0x10002
    s_lshl_b32 s16, s18, 12
    s_xor_b32 s17, s16, 4096
    s_add_u32 s16, s16, s86
    s_add_u32 s17, s17, s86
    s_mul_i32 s18, s18, 196608
    s_cmp_eq_u32 s78, 1
    s_cbranch_scc1 LA_c1
    s_cmp_eq_u32 s78, 2
    s_cbranch_scc1 LA_c2
    s_cmp_eq_u32 s78, 3
    s_cbranch_scc1 LA_c3
LA_c0:
    s_add_u32 s97, s98, 0
    s_and_b32 s97, s97, 15
    s_lshr_b32 s99, s97, 3
    s_xor_b32 s97, s97, s99
    s_lshl_b32 s97, s97, 7
    s_add_u32 m0, s87, 0
    s_add_u32 s89, s97, 0
    buffer_load_dwordx4 v2, s[28:31], s89 offen  lds
    s_mul_i32 s99, s97, 3072
    s_sub_u32 s19, s99, s18
    s_add_u32 s99, s99, s18
    s_add_u32 m0, s16, 0
    s_add_u32 s89, s99, 0
    buffer_load_dwordx4 v4, s[32:35], s89 offen  lds
    s_add_u32 m0, s87, 4096
    s_add_u32 s89, s97, 65536
    buffer_load_dwordx4 v2, s[28:31], s89 offen  lds
    s_add_u32 m0, s16, 24576
    s_add_u32 s89, s99, 2048
    buffer_load_dwordx4 v4, s[32:35], s89 offen  lds
    s_add_u32 m0, s87, 8192
    s_add_u32 s89, s97, 131072
    buffer_load_dwordx4 v2, s[28:31], s89 offen  lds
    s_add_u32 m0, s16, 49152
    s_add_u32 s89, s99, 4096
    buffer_load_dwordx4 v4, s[32:35], s89 offen  lds
    s_add_u32 m0, s87, 12288
    s_add_u32 s89, s97, 196608
    buffer_load_dwordx4 v2, s[28:31], s89 offen  lds
    s_mov_b64 exec, 0xffffffff
    s_add_u32 m0, s88, 0
    s_add_u32 s89, s97, 0
    buffer_load_dwordx4 v3, s[28:31], s89 offen  lds
    s_mov_b64 exec, -1
    s_add_u32 m0, s17, 0
    s_add_u32 s89, s19, 196608
    buffer_load_dwordx4 v4, s[32:35], s89 offen  lds
    s_mov_b32 s36, s6
    s_mov_b32 s37, s7
    s_mov_b32 s38, 0x400000
    s_mov_b32 s39, 0x20000
    s_mov_b32 s40, s8
    s_mov_b32 s41, s9
    s_mov_b32 s42, 0x400000
    s_mov_b32 s43, 0x20000
    s_mov_b32 s44, s10
    s_mov_b32 s45, s11
    s_mov_b32 s46, 0x2000
    s_mov_b32 s47, 0x20000
    s_mov_b32 s48, s12
    s_mov_b32 s49, s13
    s_mov_b32 s50, 0x400000
    s_mov_b32 s51, 0x20000
    s_mov_b32 s52, s26
    s_mov_b32 s53, s27
    s_mov_b32 s54, 0x1000000
    s_mov_b32 s55, 0x20000
    s_mov_b32 s56, s4
    s_mov_b32 s57, s5
    s_mov_b32 s58, 0x400000
    s_mov_b32 s59, 0x20000
    s_mov_b32 s60, s22
    s_mov_b32 s61, s23
    s_mov_b32 s62, 0x800000
    s_mov_b32 s63, 0x20000
    s_mov_b32 s64, s20
    s_mov_b32 s65, s21
    s_mov_b32 s66, 0x200000
    s_add_u32 m0, s17, 24576
    s_add_u32 s89, s19, 198656
    buffer_load_dwordx4 v4, s[32:35], s89 offen  lds
    s_mov_b32 s67, 0x20000
    s_mov_b32 s68, s24
    s_mov_b32 s69, s25
    s_mov_b32 s70, 0x100
    s_mov_b32 s71, 0x20000
    v_and_b32 v7, 7, v0
    s_lshl_b32 s79, s74, 7
    v_lshl_add_u32 v7, v7, 4, s79
    s_lshl_b32 s78, s75, 7
    s_lshl_b32 s80, s3, 3
    s_add_u32 s80, s80, s78
    v_lshrrev_b32 v5, 3, v0
    s_and_b32 s79, s3, 1
    v_xor_b32 v5, s79, v5
    v_add_u32 v5, s80, v5
    v_lshl_add_u32 v10, v5, 11, v7
    s_xor_b32 s80, s3, 1
    s_add_u32 s80, s78, s80
    s_sub_u32 s80, s80, 4
    s_lshl_b32 s80, s80, 11
    v_add_u32 v11, s80, v7
    v_bfe_u32 v5, v0, 3, 2
    v_lshrrev_b32 v6, 5, v0
    s_lshl_b32 s80, s3, 5
    v_lshlrev_b32 v8, 3, v5
    v_lshl_add_u32 v8, v6, 2, v8
    v_add_u32 v8, s80, v8
    v_and_b32 v35, 7, v0
    v_lshlrev_b32 v16, 4, v35
    v_lshl_add_u32 v16, v8, 7, v16
    s_add_u32 m0, s17, 49152
    s_add_u32 s89, s19, 200704
    buffer_load_dwordx4 v4, s[32:35], s89 offen  lds
    v_add_u32 v232, 129024, v16
    v_and_b32 v231, 1, v5
    v_lshl_add_u32 v16, v231, 7, v232
    v_xor_b32 v233, v231, v6
    v_xor_b32 v233, 1, v233
    v_lshl_add_u32 v232, v233, 7, v232
    v_xor_b32 v231, 128, v16
    v_xor_b32 v233, 128, v232
    v_lshrrev_b32 v33, 2, v35
    v_lshlrev_b32 v35, 6, v35
    v_lshl_add_u32 v35, v33, 4, v35
    v_add_u32 v35, 162816, v35
    v_add_u32 v8, s78, v8
    v_lshl_add_u32 v9, v8, 11, v7
    v_lshl_add_u32 v13, v8, 12, v7
    v_bfe_u32 v8, v0, 2, 1
    v_lshlrev_b32 v8, 1, v8
    v_add_u32 v8, v8, v6
    v_lshlrev_b32 v8, 16, v8
    v_lshl_add_u32 v8, v5, 6, v8
    v_and_b32 v7, 3, v0
    v_lshl_add_u32 v8, v7, 4, v8
    s_add_u32 s78, s78, s80
    s_lshl_b32 s78, s78, 3
    s_lshl_b32 s79, s74, 18
    s_add_u32 s78, s78, s79
    v_add_u32 v12, s78, v8
    s_lshl_b32 s91, s74, 4
    s_add_u32 s91, s91, s75
    s_lshr_b32 s78, s91, 3
    s_lshl_b32 s78, s78, 5
    s_add_u32 s97, s98, 4
    s_and_b32 s97, s97, 15
    s_lshr_b32 s99, s97, 3
    s_xor_b32 s97, s97, s99
    s_lshl_b32 s97, s97, 7
    s_add_u32 m0, s87, 18432
    s_add_u32 s89, s97, 0
    buffer_load_dwordx4 v2, s[28:31], s89 offen  lds
    s_and_b32 s79, s91, 7
    s_add_u32 s78, s78, s79
    s_lshl_b32 s79, s3, 3
    s_add_u32 s90, s78, s79
    s_lshl_b32 s91, s91, 14
    s_lshr_b32 s78, s90, 1
    s_lshl_b32 s78, s78, 2
    s_load_dword s92, s[14:15], s78
    s_mul_i32 s94, s3, 8320
    s_add_u32 s94, s94, 129024
    s_lshl_b32 s95, s3, 14
    s_mov_b32 s96, 4096
    s_and_b32 s100, s76, 3
    s_lshl_b32 s100, s100, 19
    v_bfe_u32 v5, v0, 2, 2
    v_lshlrev_b32 v5, 1, v5
    v_lshl_add_u32 v5, v6, 3, v5
    v_bfe_u32 v8, v0, 4, 1
    v_add_u32 v5, v5, v8
    s_and_b32 s78, s3, 1
    s_lshl_b32 s78, s78, 1
    v_add_u32 v8, s78, v6
    v_xor_b32 v8, v8, v7
    v_lshlrev_b32 v8, 4, v8
    v_lshl_add_u32 v5, v5, 6, v8
    v_add_u32 v14, s86, v5
    v_lshlrev_b32 v15, 4, v0
    v_lshrrev_b32 v5, 4, v0
    v_lshlrev_b32 v5, 1, v5
    v_and_b32 v8, 7, v0
    s_mul_i32 s99, s97, 3072
    s_sub_u32 s19, s99, s18
    s_add_u32 s99, s99, s18
    s_add_u32 m0, s16, 8192
    s_add_u32 s89, s99, 0
    buffer_load_dwordx4 v4, s[32:35], s89 offen  lds
    v_xor_b32 v5, v5, v8
    v_lshlrev_b32 v5, 4, v5
    v_lshrrev_b32 v8, 3, v0
    v_lshl_add_u32 v5, v8, 11, v5
    s_lshl_b32 s78, s77, 7
    v_add_u32 v17, s78, v5
    v_add_u32 v228, s95, v17
    s_lshr_b32 s78, s2, 3
    s_lshl_b32 s78, s78, 16
    s_add_u32 s78, s78, s95
    s_and_b32 s79, s77, 8
    s_lshl_b32 s79, s79, 7
    s_add_u32 s78, s78, s79
    v_and_b32 v5, 7, v0
    v_lshlrev_b32 v5, 7, v5
    v_lshl_add_u32 v5, v8, 11, v5
    v_add_u32 v229, s78, v5
    v_mov_b32 v18, 162304
    v_mov_b32 v19, 1
    v_and_b32 v5, 3, v0
    s_lshl_b32 s78, s74, 4
    s_add_u32 s78, s78, s3
    v_lshl_add_u32 v6, v5, 2, s78
    s_lshr_b32 s78, s76, 3
    s_lshl_b32 s79, s3, 1
    s_add_u32 s78, s78, s79
    s_xor_b32 s78, s78, 2
    s_lshl_b32 s78, s78, 5
    s_and_b32 s79, s76, 7
    s_add_u32 s78, s78, s79
    v_lshl_add_u32 v7, v5, 3, s78
    s_add_u32 m0, s87, 22528
    s_add_u32 s89, s97, 65536
    buffer_load_dwordx4 v2, s[28:31], s89 offen  lds
    v_and_b32 v8, 4, v0
    v_cmp_eq_u32 vcc, 0, v8
    s_nop 1
    v_cndmask_b32 v6, v7, v6, vcc
    v_and_b32 v33, 0xf0, v6
    v_lshlrev_b32 v34, 8, v6
    v_add_u32 v34, 12582912, v34
    v_and_b32 v5, 15, v0
    v_lshrrev_b32 v6, 4, v0
    v_add_u32 v7, 9, v5
    v_and_b32 v8, 1, v7
    v_mul_u32_u24 v8, 4160, v8
    v_lshrrev_b32 v7, 1, v7
    v_lshl_add_u32 v8, v7, 2, v8
    v_lshlrev_b32 v7, 4, v6
    v_sub_u32 v8, v8, v7
    s_add_u32 s78, s94, 32
    v_add_u32 v21, s78, v8
    v_add_u32 v22, 1024, v21
    v_add_u32 v23, 2048, v21
    v_add_u32 v24, 3072, v21
    v_lshl_add_u32 v7, v5, 1, v6
    v_add_u32 v7, 30, v7
    v_lshrrev_b32 v8, 3, v7
    v_and_b32 v25, 3, v8
    v_xor_b32 v25, s3, v25
    v_lshl_add_u32 v25, v8, 5, v25
    v_and_b32 v8, 1, v7
    v_lshl_add_u32 v25, v8, 4, v25
    v_bfe_u32 v8, v7, 1, 2
    v_lshl_add_u32 v25, v8, 2, v25
    s_add_u32 m0, s16, 32768
    s_add_u32 s89, s99, 2048
    buffer_load_dwordx4 v4, s[32:35], s89 offen  lds
    v_lshlrev_b32 v25, 4, v25
    v_add_u32 v25, 92160, v25
    v_lshl_add_u32 v7, v5, 1, v6
    v_add_u32 v7, 26, v7
    v_lshrrev_b32 v8, 3, v7
    v_and_b32 v26, 3, v8
    v_xor_b32 v26, s3, v26
    v_lshl_add_u32 v26, v8, 5, v26
    v_and_b32 v8, 1, v7
    v_lshl_add_u32 v26, v8, 4, v26
    v_bfe_u32 v8, v7, 1, 2
    v_lshl_add_u32 v26, v8, 2, v26
    v_lshlrev_b32 v26, 4, v26
    v_add_u32 v26, 92160, v26
    v_lshl_add_u32 v7, v5, 1, v6
    v_add_u32 v7, 22, v7
    v_lshrrev_b32 v8, 3, v7
    v_and_b32 v27, 3, v8
    v_xor_b32 v27, s3, v27
    v_lshl_add_u32 v27, v8, 5, v27
    v_and_b32 v8, 1, v7
    v_lshl_add_u32 v27, v8, 4, v27
    v_bfe_u32 v8, v7, 1, 2
    v_lshl_add_u32 v27, v8, 2, v27
    v_lshlrev_b32 v27, 4, v27
    v_add_u32 v27, 92160, v27
    v_lshl_add_u32 v7, v5, 1, v6
    v_add_u32 v7, 18, v7
    v_lshrrev_b32 v8, 3, v7
    v_and_b32 v28, 3, v8
    v_xor_b32 v28, s3, v28
    s_add_u32 m0, s87, 26624
    s_add_u32 s89, s97, 131072
    buffer_load_dwordx4 v2, s[28:31], s89 offen  lds
    v_lshl_add_u32 v28, v8, 5, v28
    v_and_b32 v8, 1, v7
    v_lshl_add_u32 v28, v8, 4, v28
    v_bfe_u32 v8, v7, 1, 2
    v_lshl_add_u32 v28, v8, 2, v28
    v_lshlrev_b32 v28, 4, v28
    v_add_u32 v28, 92160, v28
    v_lshl_add_u32 v7, v5, 1, v6
    v_add_u32 v7, 14, v7
    v_lshrrev_b32 v8, 3, v7
    v_and_b32 v29, 3, v8
    v_xor_b32 v29, s3, v29
    v_lshl_add_u32 v29, v8, 5, v29
    v_and_b32 v8, 1, v7
    v_lshl_add_u32 v29, v8, 4, v29
    v_bfe_u32 v8, v7, 1, 2
    v_lshl_add_u32 v29, v8, 2, v29
    v_lshlrev_b32 v29, 4, v29
    v_add_u32 v29, 92160, v29
    v_lshl_add_u32 v7, v5, 1, v6
    v_add_u32 v7, 10, v7
    v_lshrrev_b32 v8, 3, v7
    v_and_b32 v30, 3, v8
    v_xor_b32 v30, s3, v30
    v_lshl_add_u32 v30, v8, 5, v30
    v_and_b32 v8, 1, v7
    v_lshl_add_u32 v30, v8, 4, v30
    v_bfe_u32 v8, v7, 1, 2
    v_lshl_add_u32 v30, v8, 2, v30
    v_lshlrev_b32 v30, 4, v30
    s_add_u32 m0, s16, 57344
    s_add_u32 s89, s99, 4096
    buffer_load_dwordx4 v4, s[32:35], s89 offen  lds
    v_add_u32 v30, 92160, v30
    v_lshl_add_u32 v7, v5, 1, v6
    v_add_u32 v7, 6, v7
    v_lshrrev_b32 v8, 3, v7
    v_and_b32 v31, 3, v8
    v_xor_b32 v31, s3, v31
    v_lshl_add_u32 v31, v8, 5, v31
    v_and_b32 v8, 1, v7
    v_lshl_add_u32 v31, v8, 4, v31
    v_bfe_u32 v8, v7, 1, 2
    v_lshl_add_u32 v31, v8, 2, v31
    v_lshlrev_b32 v31, 4, v31
    v_add_u32 v31, 92160, v31
    v_lshl_add_u32 v7, v5, 1, v6
    v_add_u32 v7, 2, v7
    v_lshrrev_b32 v8, 3, v7
    v_and_b32 v32, 3, v8
    v_xor_b32 v32, s3, v32
    v_lshl_add_u32 v32, v8, 5, v32
    v_and_b32 v8, 1, v7
    v_lshl_add_u32 v32, v8, 4, v32
    v_bfe_u32 v8, v7, 1, 2
    v_lshl_add_u32 v32, v8, 2, v32
    v_lshlrev_b32 v32, 4, v32
    v_add_u32 v32, 92160, v32
    v_lshrrev_b32 v7, 1, v6
    v_lshl_add_u32 v7, v5, 1, v7
    v_add_u32 v7, 32, v7
    v_lshrrev_b32 v8, 3, v7
    v_and_b32 v20, 3, v8
    v_xor_b32 v20, s3, v20
    s_add_u32 m0, s87, 30720
    s_add_u32 s89, s97, 196608
    buffer_load_dwordx4 v2, s[28:31], s89 offen  lds
    v_lshl_add_u32 v20, v8, 5, v20
    v_and_b32 v8, 1, v7
    v_lshl_add_u32 v20, v8, 4, v20
    v_bfe_u32 v8, v7, 1, 2
    v_lshl_add_u32 v20, v8, 2, v20
    v_lshlrev_b32 v20, 4, v20
    v_add_u32 v20, 92160, v20
    v_and_b32 v8, 1, v6
    v_xor_b32 v8, 1, v8
    v_lshl_add_u32 v20, v8, 3, v20
    s_waitcnt lgkmcnt(0)
    s_and_b32 s78, s92, 0xffff0000
    s_lshl_b32 s92, s92, 16
    s_bitcmp1_b32 s90, 0
    s_cselect_b32 s92, s78, s92
    v_lshlrev_b32 v7, 3, v6
    v_sub_u32 v7, v7, v5
    v_subrev_u32 v7, 9, v7
    v_and_b32 v8, 1, v7
    v_xor_b32 v8, 1, v8
    v_lshlrev_b32 v8, 4, v8
    v_lshrrev_b32 v8, v8, s92
    v_ashrrev_i32 v7, 1, v7
    v_cmp_eq_u32 vcc, 0, v7
    s_nop 1
    v_cndmask_b32 v236, 0, v8, vcc
    v_cmp_eq_u32 vcc, 1, v7
    s_nop 1
    v_cndmask_b32 v237, 0, v8, vcc
    v_cmp_eq_u32 vcc, 2, v7
    s_nop 1
    v_cndmask_b32 v238, 0, v8, vcc
    v_cmp_eq_u32 vcc, 3, v7
    s_nop 1
    v_cndmask_b32 v239, 0, v8, vcc
    s_waitcnt vmcnt(7)
    s_barrier
    s_mov_b64 exec, 0xffffffff
    s_add_u32 m0, s88, 18432
    s_add_u32 s89, s97, 0
    buffer_load_dwordx4 v3, s[28:31], s89 offen  lds
    s_mov_b64 exec, -1
    s_add_u32 m0, s17, 8192
    s_add_u32 s89, s19, 196608
    buffer_load_dwordx4 v4, s[32:35], s89 offen  lds
    s_add_u32 m0, s17, 32768
    s_add_u32 s89, s19, 198656
    buffer_load_dwordx4 v4, s[32:35], s89 offen  lds
    s_add_u32 m0, s17, 57344
    s_add_u32 s89, s19, 200704
    buffer_load_dwordx4 v4, s[32:35], s89 offen  lds
    s_add_u32 s97, s98, 1
    s_and_b32 s97, s97, 15
    s_lshr_b32 s99, s97, 3
    s_xor_b32 s97, s97, s99
    s_lshl_b32 s97, s97, 7
    s_add_u32 m0, s87, 36864
    s_add_u32 s89, s97, 0
    buffer_load_dwordx4 v2, s[28:31], s89 offen  lds
    s_mul_i32 s99, s97, 3072
    s_sub_u32 s19, s99, s18
    s_add_u32 s99, s99, s18
    s_add_u32 m0, s16, 16384
    s_add_u32 s89, s99, 0
    buffer_load_dwordx4 v4, s[32:35], s89 offen  lds
    s_add_u32 m0, s87, 40960
    s_add_u32 s89, s97, 65536
    buffer_load_dwordx4 v2, s[28:31], s89 offen  lds
    s_add_u32 m0, s16, 40960
    s_add_u32 s89, s99, 2048
    buffer_load_dwordx4 v4, s[32:35], s89 offen  lds
    s_add_u32 m0, s87, 45056
    s_add_u32 s89, s97, 131072
    buffer_load_dwordx4 v2, s[28:31], s89 offen  lds
    s_add_u32 m0, s16, 65536
    s_add_u32 s89, s99, 4096
    buffer_load_dwordx4 v4, s[32:35], s89 offen  lds
    s_add_u32 m0, s87, 49152
    s_add_u32 s89, s97, 196608
    buffer_load_dwordx4 v2, s[28:31], s89 offen  lds
    s_mov_b64 exec, 0xffffffff
    s_add_u32 m0, s88, 36864
    s_add_u32 s89, s97, 0
    buffer_load_dwordx4 v3, s[28:31], s89 offen  lds
    s_mov_b64 exec, -1
    s_add_u32 m0, s17, 16384
    s_add_u32 s89, s19, 196608
    buffer_load_dwordx4 v4, s[32:35], s89 offen  lds
    s_add_u32 m0, s17, 40960
    s_add_u32 s89, s19, 198656
    buffer_load_dwordx4 v4, s[32:35], s89 offen  lds
    s_waitcnt vmcnt(10)
    s_barrier
    s_add_u32 m0, s17, 65536
    s_add_u32 s89, s19, 200704
    buffer_load_dwordx4 v4, s[32:35], s89 offen  lds
    s_add_u32 m0, s86, 129536
    s_mov_b32 s89, 0
    buffer_load_dwordx4 v10, s[36:39], s89 offen nt lds
    s_add_u32 m0, s86, 145920
    s_mov_b32 s89, 0
    buffer_load_dwordx4 v10, s[40:43], s89 offen nt lds
    s_add_u32 m0, s86, 133632
    s_mov_b32 s89, 65536
    buffer_load_dwordx4 v10, s[36:39], s89 offen nt lds
    s_add_u32 m0, s86, 150016
    s_mov_b32 s89, 65536
    buffer_load_dwordx4 v10, s[40:43], s89 offen nt lds
    s_add_u32 m0, s86, 137728
    s_mov_b32 s89, 131072
    buffer_load_dwordx4 v10, s[36:39], s89 offen nt lds
    s_add_u32 m0, s86, 154112
    s_mov_b32 s89, 131072
    buffer_load_dwordx4 v10, s[40:43], s89 offen nt lds
    s_add_u32 m0, s86, 141824
    s_mov_b32 s89, 196608
    buffer_load_dwordx4 v10, s[36:39], s89 offen nt lds
    s_add_u32 m0, s86, 158208
    s_mov_b32 s89, 196608
    buffer_load_dwordx4 v10, s[40:43], s89 offen nt lds
    s_mov_b64 exec, 0xff
    s_lshl_b32 s82, s3, 7
    s_add_u32 m0, s82, 129024
    s_mov_b32 s89, 0
    buffer_load_dwordx4 v11, s[36:39], s89 offen nt lds
    s_lshl_b32 s83, s74, 9
    s_add_u32 s83, s83, s82
    s_and_b32 s89, s3, 2
    s_lshl_b32 s89, s89, 3
    s_add_u32 s82, s82, s89
    s_add_u32 m0, s82, 162816
    s_add_u32 s89, s83, 0
    buffer_load_dwordx4 v15, s[44:47], s89 offen  lds
    s_mov_b64 exec, -1
    s_add_u32 s97, s98, 2
    s_and_b32 s97, s97, 15
    s_lshr_b32 s99, s97, 3
    s_xor_b32 s97, s97, s99
    s_lshl_b32 s97, s97, 7
    s_add_u32 m0, s87, 0
    s_add_u32 s89, s97, 0
    buffer_load_dwordx4 v2, s[28:31], s89 offen  lds
    s_mul_i32 s99, s97, 3072
    s_sub_u32 s19, s99, s18
    s_add_u32 s99, s99, s18
    s_add_u32 m0, s16, 0
    s_add_u32 s89, s99, 0
    buffer_load_dwordx4 v4, s[32:35], s89 offen  lds
    s_add_u32 m0, s87, 4096
    s_add_u32 s89, s97, 65536
    buffer_load_dwordx4 v2, s[28:31], s89 offen  lds
    s_add_u32 m0, s16, 24576
    s_add_u32 s89, s99, 2048
    buffer_load_dwordx4 v4, s[32:35], s89 offen  lds
    s_waitcnt vmcnt(14)
    s_barrier
    s_add_u32 m0, s87, 8192
    s_add_u32 s89, s97, 131072
    buffer_load_dwordx4 v2, s[28:31], s89 offen  lds
    s_add_u32 m0, s16, 49152
    s_add_u32 s89, s99, 4096
    buffer_load_dwordx4 v4, s[32:35], s89 offen  lds
    s_add_u32 m0, s87, 12288
    s_add_u32 s89, s97, 196608
    buffer_load_dwordx4 v2, s[28:31], s89 offen  lds
    s_mov_b64 exec, 0xffffffff
    s_add_u32 m0, s88, 0
    s_add_u32 s89, s97, 0
    buffer_load_dwordx4 v3, s[28:31], s89 offen  lds
    s_mov_b64 exec, -1
    s_add_u32 m0, s17, 0
    s_add_u32 s89, s19, 196608
    buffer_load_dwordx4 v4, s[32:35], s89 offen  lds
    s_add_u32 m0, s17, 24576
    s_add_u32 s89, s19, 198656
    buffer_load_dwordx4 v4, s[32:35], s89 offen  lds
    s_add_u32 m0, s17, 49152
    s_add_u32 s89, s19, 200704
    buffer_load_dwordx4 v4, s[32:35], s89 offen  lds
    s_add_u32 s97, s98, 3
    s_and_b32 s97, s97, 15
    s_lshr_b32 s99, s97, 3
    s_xor_b32 s97, s97, s99
    s_lshl_b32 s97, s97, 7
    s_add_u32 m0, s87, 18432
    s_add_u32 s89, s97, 0
    buffer_load_dwordx4 v2, s[28:31], s89 offen  lds
    s_mul_i32 s99, s97, 3072
    s_sub_u32 s19, s99, s18
    s_add_u32 s99, s99, s18
    s_add_u32 m0, s16, 8192
    s_add_u32 s89, s99, 0
    buffer_load_dwordx4 v4, s[32:35], s89 offen  lds
    s_add_u32 m0, s87, 22528
    s_add_u32 s89, s97, 65536
    buffer_load_dwordx4 v2, s[28:31], s89 offen  lds
    s_add_u32 m0, s16, 32768
    s_add_u32 s89, s99, 2048
    buffer_load_dwordx4 v4, s[32:35], s89 offen  lds
    s_add_u32 m0, s87, 26624
    s_add_u32 s89, s97, 131072
    buffer_load_dwordx4 v2, s[28:31], s89 offen  lds
    s_add_u32 m0, s16, 57344
    s_add_u32 s89, s99, 4096
    buffer_load_dwordx4 v4, s[32:35], s89 offen  lds
    s_add_u32 m0, s87, 30720
    s_add_u32 s89, s97, 196608
    buffer_load_dwordx4 v2, s[28:31], s89 offen  lds
    s_waitcnt vmcnt(7)
    s_barrier
    s_mov_b64 exec, 0xffffffff
    s_add_u32 m0, s88, 18432
    s_add_u32 s89, s97, 0
    buffer_load_dwordx4 v3, s[28:31], s89 offen  lds
    s_mov_b64 exec, -1
    ds_read_b128 v[84:87], v35 offset:0
    ds_read_b128 v[88:91], v35 offset:16
    s_add_u32 m0, s17, 8192
    s_add_u32 s89, s19, 196608
    buffer_load_dwordx4 v4, s[32:35], s89 offen  lds
    ds_read_b128 v[92:95], v35 offset:32
    s_add_u32 m0, s17, 32768
    s_add_u32 s89, s19, 198656
    buffer_load_dwordx4 v4, s[32:35], s89 offen  lds
    ds_read_b128 v[96:99], v35 offset:48
    s_add_u32 m0, s17, 57344
    s_add_u32 s89, s19, 200704
    buffer_load_dwordx4 v4, s[32:35], s89 offen  lds
    ds_read_b128 v[40:43], v233 offset:0
    s_add_u32 s97, s98, 8
    s_and_b32 s97, s97, 15
    s_lshr_b32 s99, s97, 3
    s_xor_b32 s97, s97, s99
    s_lshl_b32 s97, s97, 7
    s_add_u32 m0, s87, 36864
    s_add_u32 s89, s97, 0
    buffer_load_dwordx4 v2, s[28:31], s89 offen  lds
    ds_read_b128 v[44:47], v232 offset:256
    s_mul_i32 s99, s97, 3072
    s_sub_u32 s19, s99, s18
    s_add_u32 s99, s99, s18
    s_add_u32 m0, s16, 16384
    s_add_u32 s89, s99, 0
    buffer_load_dwordx4 v4, s[32:35], s89 offen  lds
    ds_read_b128 v[48:51], v233 offset:256
    s_add_u32 m0, s87, 40960
    s_add_u32 s89, s97, 65536
    buffer_load_dwordx4 v2, s[28:31], s89 offen  lds
    ds_read_b128 v[52:55], v16 offset:512
    s_add_u32 m0, s16, 40960
    s_add_u32 s89, s99, 2048
    buffer_load_dwordx4 v4, s[32:35], s89 offen  lds
    ds_read_b128 v[56:59], v231 offset:512
    s_add_u32 m0, s87, 45056
    s_add_u32 s89, s97, 131072
    buffer_load_dwordx4 v2, s[28:31], s89 offen  lds
    ds_read_b128 v[60:63], v16 offset:768
    s_add_u32 m0, s16, 65536
    s_add_u32 s89, s99, 4096
    buffer_load_dwordx4 v4, s[32:35], s89 offen  lds
    ds_read_b128 v[64:67], v231 offset:768
    s_add_u32 m0, s87, 49152
    s_add_u32 s89, s97, 196608
    buffer_load_dwordx4 v2, s[28:31], s89 offen  lds
    ds_read_b128 v[68:71], v16 offset:16896
    s_mov_b64 exec, 0xffffffff
    s_add_u32 m0, s88, 36864
    s_add_u32 s89, s97, 0
    buffer_load_dwordx4 v3, s[28:31], s89 offen  lds
    s_mov_b64 exec, -1
    ds_read_b128 v[72:75], v231 offset:16896
    s_add_u32 m0, s17, 16384
    s_add_u32 s89, s19, 196608
    buffer_load_dwordx4 v4, s[32:35], s89 offen  lds
    ds_read_b128 v[76:79], v16 offset:17152
    s_add_u32 m0, s17, 40960
    s_add_u32 s89, s19, 198656
    buffer_load_dwordx4 v4, s[32:35], s89 offen  lds
    ds_read_b128 v[80:83], v231 offset:17152
    s_waitcnt vmcnt(10)
    s_waitcnt lgkmcnt(0)
    s_barrier
    s_add_u32 m0, s17, 65536
    s_add_u32 s89, s19, 200704
    buffer_load_dwordx4 v4, s[32:35], s89 offen  lds
    v_lshlrev_b32 v116, 16, v40
    v_lshlrev_b32 v117, 16, v44
    v_lshlrev_b32 v118, 16, v48
    v_lshlrev_b32 v119, 16, v52
    v_lshlrev_b32 v120, 16, v56
    v_lshlrev_b32 v121, 16, v60
    s_add_u32 s97, s98, 5
    s_and_b32 s97, s97, 15
    s_lshr_b32 s99, s97, 3
    s_xor_b32 s97, s97, s99
    s_lshl_b32 s97, s97, 7
    s_add_u32 m0, s87, 0
    s_add_u32 s89, s97, 0
    buffer_load_dwordx4 v2, s[28:31], s89 offen  lds
    v_lshlrev_b32 v122, 16, v64
    v_lshlrev_b32 v127, 16, v84
    v_and_b32 v128, 0xffff0000, v84
    v_lshlrev_b32 v129, 16, v85
    v_and_b32 v130, 0xffff0000, v85
    s_mul_i32 s99, s97, 3072
    s_sub_u32 s19, s99, s18
    s_add_u32 s99, s99, s18
    s_add_u32 m0, s16, 0
    s_add_u32 s89, s99, 0
    buffer_load_dwordx4 v4, s[32:35], s89 offen  lds
    v_lshlrev_b32 v123, 16, v68
    v_lshlrev_b32 v124, 16, v72
    v_lshlrev_b32 v125, 16, v76
    v_lshlrev_b32 v126, 16, v80
    v_mul_f32 v131, v116, v130
    s_add_u32 m0, s87, 4096
    s_add_u32 s89, s97, 65536
    buffer_load_dwordx4 v2, s[28:31], s89 offen  lds
    v_mul_f32 v132, v117, v130
    v_mul_f32 v133, v118, v130
    v_mul_f32 v134, v119, v130
    v_fmac_f32 v131, v117, v129
    v_fmac_f32 v132, v118, v129
    s_add_u32 m0, s16, 24576
    s_add_u32 s89, s99, 2048
    buffer_load_dwordx4 v4, s[32:35], s89 offen  lds
    v_fmac_f32 v133, v119, v129
    v_fmac_f32 v134, v120, v129
    v_fmac_f32 v131, v118, v128
    v_fmac_f32 v132, v119, v128
    v_fmac_f32 v133, v120, v128
    s_add_u32 m0, s87, 8192
    s_add_u32 s89, s97, 131072
    buffer_load_dwordx4 v2, s[28:31], s89 offen  lds
    v_fmac_f32 v134, v121, v128
    v_fmac_f32 v131, v119, v127
    v_fmac_f32 v132, v120, v127
    v_fmac_f32 v133, v121, v127
    v_fmac_f32 v134, v122, v127
    s_add_u32 m0, s16, 49152
    s_add_u32 s89, s99, 4096
    buffer_load_dwordx4 v4, s[32:35], s89 offen  lds
    v_mul_f32 v131, v131, v123
    v_mul_f32 v132, v132, v124
    v_mul_f32 v133, v133, v125
    v_mul_f32 v134, v134, v126
    v_cvt_pk_bf16_f32 v102, v134, v133
    v_cvt_pk_bf16_f32 v103, v132, v131
    s_add_u32 m0, s87, 12288
    s_add_u32 s89, s97, 196608
    buffer_load_dwordx4 v2, s[28:31], s89 offen  lds
    v_lshlrev_b32 v116, 16, v42
    v_lshlrev_b32 v117, 16, v46
    v_lshlrev_b32 v118, 16, v50
    v_lshlrev_b32 v119, 16, v54
    v_lshlrev_b32 v120, 16, v58
    s_mov_b64 exec, 0xffffffff
    s_add_u32 m0, s88, 0
    s_add_u32 s89, s97, 0
    buffer_load_dwordx4 v3, s[28:31], s89 offen  lds
    s_mov_b64 exec, -1
    v_lshlrev_b32 v121, 16, v62
    v_lshlrev_b32 v122, 16, v66
    v_lshlrev_b32 v127, 16, v92
    v_and_b32 v128, 0xffff0000, v92
    v_lshlrev_b32 v129, 16, v93
    s_add_u32 m0, s17, 0
    s_add_u32 s89, s19, 196608
    buffer_load_dwordx4 v4, s[32:35], s89 offen  lds
    v_and_b32 v130, 0xffff0000, v93
    v_lshlrev_b32 v123, 16, v70
    v_lshlrev_b32 v124, 16, v74
    v_lshlrev_b32 v125, 16, v78
    v_lshlrev_b32 v126, 16, v82
    s_add_u32 m0, s17, 24576
    s_add_u32 s89, s19, 198656
    buffer_load_dwordx4 v4, s[32:35], s89 offen  lds
    v_mul_f32 v131, v116, v130
    v_mul_f32 v132, v117, v130
    v_mul_f32 v133, v118, v130
    v_mul_f32 v134, v119, v130
    v_fmac_f32 v131, v117, v129
    s_add_u32 m0, s17, 49152
    s_add_u32 s89, s19, 200704
    buffer_load_dwordx4 v4, s[32:35], s89 offen  lds
    v_fmac_f32 v132, v118, v129
    v_fmac_f32 v133, v119, v129
    v_fmac_f32 v134, v120, v129
    v_fmac_f32 v131, v118, v128
    v_fmac_f32 v132, v119, v128
    s_waitcnt vmcnt(11)
    s_barrier
    s_add_u32 s97, s98, 6
    s_and_b32 s97, s97, 15
    s_lshr_b32 s99, s97, 3
    s_xor_b32 s97, s97, s99
    s_lshl_b32 s97, s97, 7
    s_add_u32 m0, s87, 18432
    s_add_u32 s89, s97, 0
    buffer_load_dwordx4 v2, s[28:31], s89 offen  lds
    v_fmac_f32 v133, v120, v128
    v_fmac_f32 v134, v121, v128
    v_fmac_f32 v131, v119, v127
    v_fmac_f32 v132, v120, v127
    v_fmac_f32 v133, v121, v127
    v_fmac_f32 v134, v122, v127
    s_mul_i32 s99, s97, 3072
    s_sub_u32 s19, s99, s18
    s_add_u32 s99, s99, s18
    s_add_u32 m0, s16, 8192
    s_add_u32 s89, s99, 0
    buffer_load_dwordx4 v4, s[32:35], s89 offen  lds
    v_mul_f32 v131, v131, v123
    v_mul_f32 v132, v132, v124
    v_mul_f32 v133, v133, v125
    v_mul_f32 v134, v134, v126
    v_cvt_pk_bf16_f32 v100, v134, v133
    v_cvt_pk_bf16_f32 v101, v132, v131
    s_add_u32 m0, s87, 22528
    s_add_u32 s89, s97, 65536
    buffer_load_dwordx4 v2, s[28:31], s89 offen  lds
    v_permlane32_swap_b32 v102, v100
    v_permlane32_swap_b32 v103, v101
    s_mov_b32 s89, 0
    buffer_store_dwordx4 v[100:103], v12, s[52:55], s89 offen sc1
    v_and_b32 v116, 0xffff0000, v40
    v_and_b32 v117, 0xffff0000, v44
    s_add_u32 m0, s16, 32768
    s_add_u32 s89, s99, 2048
    buffer_load_dwordx4 v4, s[32:35], s89 offen  lds
    v_and_b32 v118, 0xffff0000, v48
    v_and_b32 v119, 0xffff0000, v52
    v_and_b32 v120, 0xffff0000, v56
    v_and_b32 v121, 0xffff0000, v60
    v_and_b32 v122, 0xffff0000, v64
    v_lshlrev_b32 v127, 16, v86
    s_add_u32 m0, s87, 26624
    s_add_u32 s89, s97, 131072
    buffer_load_dwordx4 v2, s[28:31], s89 offen  lds
    v_and_b32 v128, 0xffff0000, v86
    v_lshlrev_b32 v129, 16, v87
    v_and_b32 v130, 0xffff0000, v87
    v_and_b32 v123, 0xffff0000, v68
    v_and_b32 v124, 0xffff0000, v72
    v_and_b32 v125, 0xffff0000, v76
    s_add_u32 m0, s16, 57344
    s_add_u32 s89, s99, 4096
    buffer_load_dwordx4 v4, s[32:35], s89 offen  lds
    v_and_b32 v126, 0xffff0000, v80
    v_mul_f32 v131, v116, v130
    v_mul_f32 v132, v117, v130
    v_mul_f32 v133, v118, v130
    v_mul_f32 v134, v119, v130
    s_add_u32 m0, s87, 30720
    s_add_u32 s89, s97, 196608
    buffer_load_dwordx4 v2, s[28:31], s89 offen  lds
    v_fmac_f32 v131, v117, v129
    v_fmac_f32 v132, v118, v129
    v_fmac_f32 v133, v119, v129
    v_fmac_f32 v134, v120, v129
    v_fmac_f32 v131, v118, v128
    v_fmac_f32 v132, v119, v128
    s_mov_b64 exec, 0xffffffff
    s_add_u32 m0, s88, 18432
    s_add_u32 s89, s97, 0
    buffer_load_dwordx4 v3, s[28:31], s89 offen  lds
    s_mov_b64 exec, -1
    v_fmac_f32 v133, v120, v128
    v_fmac_f32 v134, v121, v128
    v_fmac_f32 v131, v119, v127
    v_fmac_f32 v132, v120, v127
    v_fmac_f32 v133, v121, v127
    v_fmac_f32 v134, v122, v127
    s_add_u32 m0, s17, 8192
    s_add_u32 s89, s19, 196608
    buffer_load_dwordx4 v4, s[32:35], s89 offen  lds
    v_mul_f32 v131, v131, v123
    v_mul_f32 v132, v132, v124
    v_mul_f32 v133, v133, v125
    v_mul_f32 v134, v134, v126
    v_cvt_pk_bf16_f32 v106, v134, v133
    s_add_u32 m0, s17, 32768
    s_add_u32 s89, s19, 198656
    buffer_load_dwordx4 v4, s[32:35], s89 offen  lds
    v_cvt_pk_bf16_f32 v107, v132, v131
    v_and_b32 v116, 0xffff0000, v42
    v_and_b32 v117, 0xffff0000, v46
    v_and_b32 v118, 0xffff0000, v50
    v_and_b32 v119, 0xffff0000, v54
    v_and_b32 v120, 0xffff0000, v58
    s_add_u32 m0, s17, 57344
    s_add_u32 s89, s19, 200704
    buffer_load_dwordx4 v4, s[32:35], s89 offen  lds
    v_and_b32 v121, 0xffff0000, v62
    v_and_b32 v122, 0xffff0000, v66
    v_lshlrev_b32 v127, 16, v94
    v_and_b32 v128, 0xffff0000, v94
    v_lshlrev_b32 v129, 16, v95
    s_waitcnt vmcnt(12)
    s_barrier
    s_add_u32 s97, s98, 7
    s_and_b32 s97, s97, 15
    s_lshr_b32 s99, s97, 3
    s_xor_b32 s97, s97, s99
    s_lshl_b32 s97, s97, 7
    s_add_u32 m0, s87, 36864
    s_add_u32 s89, s97, 0
    buffer_load_dwordx4 v2, s[28:31], s89 offen  lds
    v_and_b32 v130, 0xffff0000, v95
    v_and_b32 v123, 0xffff0000, v70
    v_and_b32 v124, 0xffff0000, v74
    v_and_b32 v125, 0xffff0000, v78
    v_and_b32 v126, 0xffff0000, v82
    v_mul_f32 v131, v116, v130
    s_mul_i32 s99, s97, 3072
    s_sub_u32 s19, s99, s18
    s_add_u32 s99, s99, s18
    s_add_u32 m0, s16, 16384
    s_add_u32 s89, s99, 0
    buffer_load_dwordx4 v4, s[32:35], s89 offen  lds
    v_mul_f32 v132, v117, v130
    v_mul_f32 v133, v118, v130
    v_mul_f32 v134, v119, v130
    v_fmac_f32 v131, v117, v129
    v_fmac_f32 v132, v118, v129
    v_fmac_f32 v133, v119, v129
    s_add_u32 m0, s87, 40960
    s_add_u32 s89, s97, 65536
    buffer_load_dwordx4 v2, s[28:31], s89 offen  lds
    v_fmac_f32 v134, v120, v129
    v_fmac_f32 v131, v118, v128
    v_fmac_f32 v132, v119, v128
    v_fmac_f32 v133, v120, v128
    v_fmac_f32 v134, v121, v128
    s_add_u32 m0, s16, 40960
    s_add_u32 s89, s99, 2048
    buffer_load_dwordx4 v4, s[32:35], s89 offen  lds
    v_fmac_f32 v131, v119, v127
    v_fmac_f32 v132, v120, v127
    v_fmac_f32 v133, v121, v127
    v_fmac_f32 v134, v122, v127
    v_mul_f32 v131, v131, v123
    v_mul_f32 v132, v132, v124
    s_add_u32 m0, s87, 45056
    s_add_u32 s89, s97, 131072
    buffer_load_dwordx4 v2, s[28:31], s89 offen  lds
    v_mul_f32 v133, v133, v125
    v_mul_f32 v134, v134, v126
    v_cvt_pk_bf16_f32 v104, v134, v133
    v_cvt_pk_bf16_f32 v105, v132, v131
    s_nop 0
    v_permlane32_swap_b32 v106, v104
    v_permlane32_swap_b32 v107, v105
    s_add_u32 m0, s16, 65536
    s_add_u32 s89, s99, 4096
    buffer_load_dwordx4 v4, s[32:35], s89 offen  lds
    s_mov_b32 s89, 16384
    buffer_store_dwordx4 v[104:107], v12, s[52:55], s89 offen sc1
    v_lshlrev_b32 v116, 16, v41
    v_lshlrev_b32 v117, 16, v45
    v_lshlrev_b32 v118, 16, v49
    v_lshlrev_b32 v119, 16, v53
    s_add_u32 m0, s87, 49152
    s_add_u32 s89, s97, 196608
    buffer_load_dwordx4 v2, s[28:31], s89 offen  lds
    v_lshlrev_b32 v120, 16, v57
    v_lshlrev_b32 v121, 16, v61
    v_lshlrev_b32 v122, 16, v65
    v_lshlrev_b32 v127, 16, v88
    v_and_b32 v128, 0xffff0000, v88
    v_lshlrev_b32 v129, 16, v89
    s_mov_b64 exec, 0xffffffff
    s_add_u32 m0, s88, 36864
    s_add_u32 s89, s97, 0
    buffer_load_dwordx4 v3, s[28:31], s89 offen  lds
    s_mov_b64 exec, -1
    v_and_b32 v130, 0xffff0000, v89
    v_lshlrev_b32 v123, 16, v69
    v_lshlrev_b32 v124, 16, v73
    v_lshlrev_b32 v125, 16, v77
    v_lshlrev_b32 v126, 16, v81
    v_mul_f32 v131, v116, v130
    s_add_u32 m0, s17, 16384
    s_add_u32 s89, s19, 196608
    buffer_load_dwordx4 v4, s[32:35], s89 offen  lds
    v_mul_f32 v132, v117, v130
    v_mul_f32 v133, v118, v130
    v_mul_f32 v134, v119, v130
    v_fmac_f32 v131, v117, v129
    v_fmac_f32 v132, v118, v129
    s_add_u32 m0, s17, 40960
    s_add_u32 s89, s19, 198656
    buffer_load_dwordx4 v4, s[32:35], s89 offen  lds
    v_fmac_f32 v133, v119, v129
    v_fmac_f32 v134, v120, v129
    v_fmac_f32 v131, v118, v128
    v_fmac_f32 v132, v119, v128
    v_fmac_f32 v133, v120, v128
    v_fmac_f32 v134, v121, v128
    s_add_u32 m0, s17, 65536
    s_add_u32 s89, s19, 200704
    buffer_load_dwordx4 v4, s[32:35], s89 offen  lds
    v_fmac_f32 v131, v119, v127
    v_fmac_f32 v132, v120, v127
    v_fmac_f32 v133, v121, v127
    v_fmac_f32 v134, v122, v127
    v_mul_f32 v131, v131, v123
    s_waitcnt vmcnt(12)
    s_barrier
    s_add_u32 m0, s94, 32
    s_lshl_b32 s89, s90, 12
    buffer_load_dwordx4 v15, s[48:51], s89 offen offset:0 nt lds
    v_mul_f32 v132, v132, v124
    v_mul_f32 v133, v133, v125
    v_mul_f32 v134, v134, v126
    v_cvt_pk_bf16_f32 v110, v134, v133
    v_cvt_pk_bf16_f32 v111, v132, v131
    s_add_u32 m0, s94, 32
    s_lshl_b32 s89, s90, 12
    buffer_load_dwordx4 v15, s[48:51], s89 offen offset:1024 nt lds
    v_lshlrev_b32 v116, 16, v43
    v_lshlrev_b32 v117, 16, v47
    v_lshlrev_b32 v118, 16, v51
    v_lshlrev_b32 v119, 16, v55
    s_add_u32 m0, s94, 32
    s_lshl_b32 s89, s90, 12
    buffer_load_dwordx4 v15, s[48:51], s89 offen offset:2048 nt lds
    v_lshlrev_b32 v120, 16, v59
    v_lshlrev_b32 v121, 16, v63
    v_lshlrev_b32 v122, 16, v67
    v_lshlrev_b32 v127, 16, v96
    v_and_b32 v128, 0xffff0000, v96
    s_add_u32 m0, s94, 32
    s_lshl_b32 s89, s90, 12
    buffer_load_dwordx4 v15, s[48:51], s89 offen offset:3072 nt lds
    v_lshlrev_b32 v129, 16, v97
    v_and_b32 v130, 0xffff0000, v97
    v_lshlrev_b32 v123, 16, v71
    v_lshlrev_b32 v124, 16, v75
    buffer_load_dwordx4 v[212:215], v9, s[56:59], 0 offen offset:0 nt
    v_lshlrev_b32 v125, 16, v79
    v_lshlrev_b32 v126, 16, v83
    v_mul_f32 v131, v116, v130
    v_mul_f32 v132, v117, v130
    v_mul_f32 v133, v118, v130
    buffer_load_dwordx4 v[216:219], v9, s[56:59], 0 offen offset:2048 nt
    v_mul_f32 v134, v119, v130
    v_fmac_f32 v131, v117, v129
    v_fmac_f32 v132, v118, v129
    v_fmac_f32 v133, v119, v129
    buffer_load_dwordx4 v[220:223], v9, s[56:59], s96 offen offset:0 nt
    v_fmac_f32 v134, v120, v129
    v_fmac_f32 v131, v118, v128
    v_fmac_f32 v132, v119, v128
    v_fmac_f32 v133, v120, v128
    buffer_load_dwordx4 v[224:227], v9, s[56:59], s96 offen offset:2048 nt
    v_fmac_f32 v134, v121, v128
    v_fmac_f32 v131, v119, v127
    v_fmac_f32 v132, v120, v127
    v_fmac_f32 v133, v121, v127
    v_fmac_f32 v134, v122, v127
    s_add_u32 s97, s98, 12
    s_and_b32 s97, s97, 15
    s_lshr_b32 s99, s97, 3
    s_xor_b32 s97, s97, s99
    s_lshl_b32 s97, s97, 7
    s_add_u32 m0, s87, 0
    s_add_u32 s89, s97, 0
    buffer_load_dwordx4 v2, s[28:31], s89 offen  lds
    v_mul_f32 v131, v131, v123
    v_mul_f32 v132, v132, v124
    v_mul_f32 v133, v133, v125
    v_mul_f32 v134, v134, v126
    s_mul_i32 s99, s97, 3072
    s_sub_u32 s19, s99, s18
    s_add_u32 s99, s99, s18
    s_add_u32 m0, s16, 0
    s_add_u32 s89, s99, 0
    buffer_load_dwordx4 v4, s[32:35], s89 offen  lds
    v_cvt_pk_bf16_f32 v108, v134, v133
    v_cvt_pk_bf16_f32 v109, v132, v131
    s_nop 0
    v_permlane32_swap_b32 v110, v108
    v_permlane32_swap_b32 v111, v109
    s_mov_b32 s89, 32768
    buffer_store_dwordx4 v[108:111], v12, s[52:55], s89 offen sc1
    s_add_u32 m0, s87, 4096
    s_add_u32 s89, s97, 65536
    buffer_load_dwordx4 v2, s[28:31], s89 offen  lds
    v_and_b32 v116, 0xffff0000, v41
    v_and_b32 v117, 0xffff0000, v45
    v_and_b32 v118, 0xffff0000, v49
    v_and_b32 v119, 0xffff0000, v53
    s_add_u32 m0, s16, 24576
    s_add_u32 s89, s99, 2048
    buffer_load_dwordx4 v4, s[32:35], s89 offen  lds
    v_and_b32 v120, 0xffff0000, v57
    v_and_b32 v121, 0xffff0000, v61
    v_and_b32 v122, 0xffff0000, v65
    v_lshlrev_b32 v127, 16, v90
    v_and_b32 v128, 0xffff0000, v90
    s_add_u32 m0, s87, 8192
    s_add_u32 s89, s97, 131072
    buffer_load_dwordx4 v2, s[28:31], s89 offen  lds
    v_lshlrev_b32 v129, 16, v91
    v_and_b32 v130, 0xffff0000, v91
    v_and_b32 v123, 0xffff0000, v69
    v_and_b32 v124, 0xffff0000, v73
    s_add_u32 m0, s16, 49152
    s_add_u32 s89, s99, 4096
    buffer_load_dwordx4 v4, s[32:35], s89 offen  lds
    v_and_b32 v125, 0xffff0000, v77
    v_and_b32 v126, 0xffff0000, v81
    v_mul_f32 v131, v116, v130
    v_mul_f32 v132, v117, v130
    s_waitcnt vmcnt(15)
    s_barrier
    s_add_u32 m0, s87, 12288
    s_add_u32 s89, s97, 196608
    buffer_load_dwordx4 v2, s[28:31], s89 offen  lds
    v_mul_f32 v133, v118, v130
    v_mul_f32 v134, v119, v130
    v_fmac_f32 v131, v117, v129
    v_fmac_f32 v132, v118, v129
    v_fmac_f32 v133, v119, v129
    s_mov_b64 exec, 0xffffffff
    s_add_u32 m0, s88, 0
    s_add_u32 s89, s97, 0
    buffer_load_dwordx4 v3, s[28:31], s89 offen  lds
    s_mov_b64 exec, -1
    v_fmac_f32 v134, v120, v129
    v_fmac_f32 v131, v118, v128
    v_fmac_f32 v132, v119, v128
    v_fmac_f32 v133, v120, v128
    s_add_u32 m0, s17, 0
    s_add_u32 s89, s19, 196608
    buffer_load_dwordx4 v4, s[32:35], s89 offen  lds
    v_fmac_f32 v134, v121, v128
    v_fmac_f32 v131, v119, v127
    v_fmac_f32 v132, v120, v127
    v_fmac_f32 v133, v121, v127
    s_add_u32 m0, s17, 24576
    s_add_u32 s89, s19, 198656
    buffer_load_dwordx4 v4, s[32:35], s89 offen  lds
    v_fmac_f32 v134, v122, v127
    v_mul_f32 v131, v131, v123
    v_mul_f32 v132, v132, v124
    v_mul_f32 v133, v133, v125
    v_mul_f32 v134, v134, v126
    s_add_u32 m0, s17, 49152
    s_add_u32 s89, s19, 200704
    buffer_load_dwordx4 v4, s[32:35], s89 offen  lds
    v_cvt_pk_bf16_f32 v114, v134, v133
    v_cvt_pk_bf16_f32 v115, v132, v131
    v_and_b32 v116, 0xffff0000, v43
    v_and_b32 v117, 0xffff0000, v47
    s_add_u32 s97, s98, 9
    s_and_b32 s97, s97, 15
    s_lshr_b32 s99, s97, 3
    s_xor_b32 s97, s97, s99
    s_lshl_b32 s97, s97, 7
    s_add_u32 m0, s87, 18432
    s_add_u32 s89, s97, 0
    buffer_load_dwordx4 v2, s[28:31], s89 offen  lds
    v_and_b32 v118, 0xffff0000, v51
    v_and_b32 v119, 0xffff0000, v55
    v_and_b32 v120, 0xffff0000, v59
    v_and_b32 v121, 0xffff0000, v63
    s_mul_i32 s99, s97, 3072
    s_sub_u32 s19, s99, s18
    s_add_u32 s99, s99, s18
    s_add_u32 m0, s16, 8192
    s_add_u32 s89, s99, 0
    buffer_load_dwordx4 v4, s[32:35], s89 offen  lds
    v_and_b32 v122, 0xffff0000, v67
    v_lshlrev_b32 v127, 16, v98
    v_and_b32 v128, 0xffff0000, v98
    v_lshlrev_b32 v129, 16, v99
    s_add_u32 m0, s87, 22528
    s_add_u32 s89, s97, 65536
    buffer_load_dwordx4 v2, s[28:31], s89 offen  lds
    v_and_b32 v130, 0xffff0000, v99
    v_and_b32 v123, 0xffff0000, v71
    v_and_b32 v124, 0xffff0000, v75
    v_and_b32 v125, 0xffff0000, v79
    v_and_b32 v126, 0xffff0000, v83
    s_add_u32 m0, s16, 32768
    s_add_u32 s89, s99, 2048
    buffer_load_dwordx4 v4, s[32:35], s89 offen  lds
    v_mul_f32 v131, v116, v130
    v_mul_f32 v132, v117, v130
    v_mul_f32 v133, v118, v130
    v_mul_f32 v134, v119, v130
    s_add_u32 m0, s87, 26624
    s_add_u32 s89, s97, 131072
    buffer_load_dwordx4 v2, s[28:31], s89 offen  lds
    v_fmac_f32 v131, v117, v129
    v_fmac_f32 v132, v118, v129
    v_fmac_f32 v133, v119, v129
    v_fmac_f32 v134, v120, v129
    s_add_u32 m0, s16, 57344
    s_add_u32 s89, s99, 4096
    buffer_load_dwordx4 v4, s[32:35], s89 offen  lds
    v_fmac_f32 v131, v118, v128
    v_fmac_f32 v132, v119, v128
    v_fmac_f32 v133, v120, v128
    v_fmac_f32 v134, v121, v128
    v_fmac_f32 v131, v119, v127
    s_add_u32 m0, s87, 30720
    s_add_u32 s89, s97, 196608
    buffer_load_dwordx4 v2, s[28:31], s89 offen  lds
    v_fmac_f32 v132, v120, v127
    v_fmac_f32 v133, v121, v127
    v_fmac_f32 v134, v122, v127
    v_mul_f32 v131, v131, v123
    s_mov_b64 exec, 0xffffffff
    s_add_u32 m0, s88, 18432
    s_add_u32 s89, s97, 0
    buffer_load_dwordx4 v3, s[28:31], s89 offen  lds
    s_mov_b64 exec, -1
    v_mul_f32 v132, v132, v124
    v_mul_f32 v133, v133, v125
    v_mul_f32 v134, v134, v126
    v_cvt_pk_bf16_f32 v112, v134, v133
    s_add_u32 m0, s17, 8192
    s_add_u32 s89, s19, 196608
    buffer_load_dwordx4 v4, s[32:35], s89 offen  lds
    v_cvt_pk_bf16_f32 v113, v132, v131
    v_permlane32_swap_b32 v114, v112
    s_nop 0
    v_permlane32_swap_b32 v115, v113
    s_mov_b32 s89, 49152
    buffer_store_dwordx4 v[112:115], v12, s[52:55], s89 offen sc1
    s_waitcnt vmcnt(10)
    s_barrier
    s_add_u32 m0, s17, 32768
    s_add_u32 s89, s19, 198656
    buffer_load_dwordx4 v4, s[32:35], s89 offen  lds
    v_add_u32 v5, s94, v15
    ds_read_b128 v[140:143], v5 offset:32
    s_add_u32 m0, s17, 57344
    s_add_u32 s89, s19, 200704
    buffer_load_dwordx4 v4, s[32:35], s89 offen  lds
    ds_read_b32 v156, v5 offset:48
    s_add_u32 s97, s98, 10
    s_and_b32 s97, s97, 15
    s_lshr_b32 s99, s97, 3
    s_xor_b32 s97, s97, s99
    s_lshl_b32 s97, s97, 7
    s_add_u32 m0, s87, 36864
    s_add_u32 s89, s97, 0
    buffer_load_dwordx4 v2, s[28:31], s89 offen  lds
    ds_read_b128 v[144:147], v5 offset:1056
    s_mul_i32 s99, s97, 3072
    s_sub_u32 s19, s99, s18
    s_add_u32 s99, s99, s18
    s_add_u32 m0, s16, 16384
    s_add_u32 s89, s99, 0
    buffer_load_dwordx4 v4, s[32:35], s89 offen  lds
    ds_read_b32 v157, v5 offset:1072
    s_add_u32 m0, s87, 40960
    s_add_u32 s89, s97, 65536
    buffer_load_dwordx4 v2, s[28:31], s89 offen  lds
    ds_read_b128 v[148:151], v5 offset:2080
    s_add_u32 m0, s16, 40960
    s_add_u32 s89, s99, 2048
    buffer_load_dwordx4 v4, s[32:35], s89 offen  lds
    ds_read_b32 v158, v5 offset:2096
    s_add_u32 m0, s87, 45056
    s_add_u32 s89, s97, 131072
    buffer_load_dwordx4 v2, s[28:31], s89 offen  lds
    ds_read_b128 v[152:155], v5 offset:3104
    ds_read_b32 v159, v5 offset:3120
    s_add_u32 m0, s16, 65536
    s_add_u32 s89, s99, 4096
    buffer_load_dwordx4 v4, s[32:35], s89 offen  lds
    v_lshrrev_b32 v6, 3, v0
    s_add_u32 m0, s87, 49152
    s_add_u32 s89, s97, 196608
    buffer_load_dwordx4 v2, s[28:31], s89 offen  lds
    v_mul_u32_u24 v6, 4160, v6
    s_mov_b64 exec, 0xffffffff
    s_add_u32 m0, s88, 36864
    s_add_u32 s89, s97, 0
    buffer_load_dwordx4 v3, s[28:31], s89 offen  lds
    s_mov_b64 exec, -1
    v_and_b32 v7, 7, v0
    s_add_u32 m0, s17, 16384
    s_add_u32 s89, s19, 196608
    buffer_load_dwordx4 v4, s[32:35], s89 offen  lds
    v_lshl_add_u32 v6, v7, 2, v6
    s_add_u32 m0, s17, 40960
    s_add_u32 s89, s19, 198656
    buffer_load_dwordx4 v4, s[32:35], s89 offen  lds
    v_add_u32 v6, s94, v6
    s_add_u32 m0, s17, 65536
    s_add_u32 s89, s19, 200704
    buffer_load_dwordx4 v4, s[32:35], s89 offen  lds
    v_mov_b32 v7, 0
    s_waitcnt vmcnt(11)
    s_barrier
    buffer_load_dword v230, v229, s[64:67], 0 offen
    s_waitcnt lgkmcnt(0)
    v_readfirstlane_b32 s93, v140
    s_nop 0
    s_lshl_b32 s93, s93, 16
    s_add_u32 s97, s98, 11
    s_and_b32 s97, s97, 15
    s_lshr_b32 s99, s97, 3
    s_xor_b32 s97, s97, s99
    s_lshl_b32 s97, s97, 7
    s_add_u32 m0, s87, 0
    s_add_u32 s89, s97, 0
    buffer_load_dwordx4 v2, s[28:31], s89 offen  lds
    v_writelane_b32 v7, s93, 15
    v_alignbit_b32 v140, v141, v140, 16
    s_mul_i32 s99, s97, 3072
    s_sub_u32 s19, s99, s18
    s_add_u32 s99, s99, s18
    s_add_u32 m0, s16, 0
    s_add_u32 s89, s99, 0
    buffer_load_dwordx4 v4, s[32:35], s89 offen  lds
    v_alignbit_b32 v141, v142, v141, 16
    v_alignbit_b32 v142, v143, v142, 16
    s_add_u32 m0, s87, 4096
    s_add_u32 s89, s97, 65536
    buffer_load_dwordx4 v2, s[28:31], s89 offen  lds
    v_alignbit_b32 v143, v156, v143, 16
    v_alignbit_b32 v144, v145, v144, 16
    s_add_u32 m0, s16, 24576
    s_add_u32 s89, s99, 2048
    buffer_load_dwordx4 v4, s[32:35], s89 offen  lds
    v_alignbit_b32 v145, v146, v145, 16
    v_alignbit_b32 v146, v147, v146, 16
    s_add_u32 m0, s87, 8192
    s_add_u32 s89, s97, 131072
    buffer_load_dwordx4 v2, s[28:31], s89 offen  lds
    v_alignbit_b32 v147, v157, v147, 16
    v_alignbit_b32 v148, v149, v148, 16
    s_add_u32 m0, s16, 49152
    s_add_u32 s89, s99, 4096
    buffer_load_dwordx4 v4, s[32:35], s89 offen  lds
    v_alignbit_b32 v149, v150, v149, 16
    v_alignbit_b32 v150, v151, v150, 16
    s_add_u32 m0, s87, 12288
    s_add_u32 s89, s97, 196608
    buffer_load_dwordx4 v2, s[28:31], s89 offen  lds
    v_alignbit_b32 v151, v158, v151, 16
    v_alignbit_b32 v152, v153, v152, 16
    s_mov_b64 exec, 0xffffffff
    s_add_u32 m0, s88, 0
    s_add_u32 s89, s97, 0
    buffer_load_dwordx4 v3, s[28:31], s89 offen  lds
    s_mov_b64 exec, -1
    v_alignbit_b32 v153, v154, v153, 16
    v_alignbit_b32 v154, v155, v154, 16
    s_add_u32 m0, s17, 0
    s_add_u32 s89, s19, 196608
    buffer_load_dwordx4 v4, s[32:35], s89 offen  lds
    v_alignbit_b32 v155, v159, v155, 16
    v_lshlrev_b32 v8, 3, v0
    s_add_u32 m0, s17, 24576
    s_add_u32 s89, s19, 198656
    buffer_load_dwordx4 v4, s[32:35], s89 offen  lds
    s_add_u32 s78, s88, 18432
    v_add_u32 v8, s78, v8
    s_add_u32 m0, s17, 49152
    s_add_u32 s89, s19, 200704
    buffer_load_dwordx4 v4, s[32:35], s89 offen  lds
    v_mov_b32 v156, 0
    v_mov_b32 v157, 0
    s_waitcnt vmcnt(12)
    s_barrier
    s_add_u32 s97, s98, 13
    s_and_b32 s97, s97, 15
    s_lshr_b32 s99, s97, 3
    s_xor_b32 s97, s97, s99
    s_lshl_b32 s97, s97, 7
    s_add_u32 m0, s87, 18432
    s_add_u32 s89, s97, 0
    buffer_load_dwordx4 v2, s[28:31], s89 offen  lds
    s_mul_i32 s99, s97, 3072
    s_sub_u32 s19, s99, s18
    s_add_u32 s99, s99, s18
    s_add_u32 m0, s16, 8192
    s_add_u32 s89, s99, 0
    buffer_load_dwordx4 v4, s[32:35], s89 offen  lds
    s_add_u32 m0, s87, 22528
    s_add_u32 s89, s97, 65536
    buffer_load_dwordx4 v2, s[28:31], s89 offen  lds
    s_add_u32 m0, s16, 32768
    s_add_u32 s89, s99, 2048
    buffer_load_dwordx4 v4, s[32:35], s89 offen  lds
    s_add_u32 m0, s87, 26624
    s_add_u32 s89, s97, 131072
    buffer_load_dwordx4 v2, s[28:31], s89 offen  lds
    s_add_u32 m0, s16, 57344
    s_add_u32 s89, s99, 4096
    buffer_load_dwordx4 v4, s[32:35], s89 offen  lds
    s_add_u32 m0, s87, 30720
    s_add_u32 s89, s97, 196608
    buffer_load_dwordx4 v2, s[28:31], s89 offen  lds
    s_mov_b64 exec, 0xffffffff
    s_add_u32 m0, s88, 18432
    s_add_u32 s89, s97, 0
    buffer_load_dwordx4 v3, s[28:31], s89 offen  lds
    s_mov_b64 exec, -1
    s_add_u32 m0, s17, 8192
    s_add_u32 s89, s19, 196608
    buffer_load_dwordx4 v4, s[32:35], s89 offen  lds
    s_add_u32 m0, s17, 32768
    s_add_u32 s89, s19, 198656
    buffer_load_dwordx4 v4, s[32:35], s89 offen  lds
    s_add_u32 m0, s17, 57344
    s_add_u32 s89, s19, 200704
    buffer_load_dwordx4 v4, s[32:35], s89 offen  lds
    s_waitcnt vmcnt(11)
    s_barrier
    s_add_u32 s97, s98, 14
    s_and_b32 s97, s97, 15
    s_lshr_b32 s99, s97, 3
    s_xor_b32 s97, s97, s99
    s_lshl_b32 s97, s97, 7
    s_add_u32 m0, s87, 36864
    s_add_u32 s89, s97, 0
    buffer_load_dwordx4 v2, s[28:31], s89 offen  lds
    s_mul_i32 s99, s97, 3072
    s_sub_u32 s19, s99, s18
    s_add_u32 s99, s99, s18
    s_add_u32 m0, s16, 16384
    s_add_u32 s89, s99, 0
    buffer_load_dwordx4 v4, s[32:35], s89 offen  lds
    s_add_u32 m0, s87, 40960
    s_add_u32 s89, s97, 65536
    buffer_load_dwordx4 v2, s[28:31], s89 offen  lds
    s_add_u32 m0, s16, 40960
    s_add_u32 s89, s99, 2048
    buffer_load_dwordx4 v4, s[32:35], s89 offen  lds
    s_add_u32 m0, s87, 45056
    s_add_u32 s89, s97, 131072
    buffer_load_dwordx4 v2, s[28:31], s89 offen  lds
    s_add_u32 m0, s16, 65536
    s_add_u32 s89, s99, 4096
    buffer_load_dwordx4 v4, s[32:35], s89 offen  lds
    s_add_u32 m0, s87, 49152
    s_add_u32 s89, s97, 196608
    buffer_load_dwordx4 v2, s[28:31], s89 offen  lds
    s_mov_b64 exec, 0xffffffff
    s_add_u32 m0, s88, 36864
    s_add_u32 s89, s97, 0
    buffer_load_dwordx4 v3, s[28:31], s89 offen  lds
    s_mov_b64 exec, -1
    s_add_u32 m0, s17, 16384
    s_add_u32 s89, s19, 196608
    buffer_load_dwordx4 v4, s[32:35], s89 offen  lds
    s_add_u32 m0, s17, 40960
    s_add_u32 s89, s19, 198656
    buffer_load_dwordx4 v4, s[32:35], s89 offen  lds
    s_add_u32 m0, s17, 65536
    s_add_u32 s89, s19, 200704
    buffer_load_dwordx4 v4, s[32:35], s89 offen  lds
    s_waitcnt vmcnt(11)
    s_barrier
    s_add_u32 s97, s98, 15
    s_and_b32 s97, s97, 15
    s_lshr_b32 s99, s97, 3
    s_xor_b32 s97, s97, s99
    s_lshl_b32 s97, s97, 7
    s_add_u32 m0, s87, 0
    s_add_u32 s89, s97, 0
    buffer_load_dwordx4 v2, s[28:31], s89 offen  lds
    s_mul_i32 s99, s97, 3072
    s_sub_u32 s19, s99, s18
    s_add_u32 s99, s99, s18
    s_add_u32 m0, s16, 0
    s_add_u32 s89, s99, 0
    buffer_load_dwordx4 v4, s[32:35], s89 offen  lds
    s_add_u32 m0, s87, 4096
    s_add_u32 s89, s97, 65536
    buffer_load_dwordx4 v2, s[28:31], s89 offen  lds
    s_add_u32 m0, s16, 24576
    s_add_u32 s89, s99, 2048
    buffer_load_dwordx4 v4, s[32:35], s89 offen  lds
    s_add_u32 m0, s87, 8192
    s_add_u32 s89, s97, 131072
    buffer_load_dwordx4 v2, s[28:31], s89 offen  lds
    s_add_u32 m0, s16, 49152
    s_add_u32 s89, s99, 4096
    buffer_load_dwordx4 v4, s[32:35], s89 offen  lds
    s_add_u32 m0, s87, 12288
    s_add_u32 s89, s97, 196608
    buffer_load_dwordx4 v2, s[28:31], s89 offen  lds
    s_mov_b64 exec, 0xffffffff
    s_add_u32 m0, s88, 0
    s_add_u32 s89, s97, 0
    buffer_load_dwordx4 v3, s[28:31], s89 offen  lds
    s_mov_b64 exec, -1
    s_add_u32 m0, s17, 0
    s_add_u32 s89, s19, 196608
    buffer_load_dwordx4 v4, s[32:35], s89 offen  lds
    s_add_u32 m0, s17, 24576
    s_add_u32 s89, s19, 198656
    buffer_load_dwordx4 v4, s[32:35], s89 offen  lds
    s_add_u32 m0, s17, 49152
    s_add_u32 s89, s19, 200704
    buffer_load_dwordx4 v4, s[32:35], s89 offen  lds
    s_mov_b64 exec, 0xff
    buffer_load_dword v136, v33, s[68:71], 0 offen sc1
    buffer_load_dword v137, v34, s[52:55], 0 offen sc1
    s_mov_b64 exec, -1
    s_waitcnt vmcnt(13)
    s_barrier
    s_waitcnt vmcnt(0)
    s_branch LA_j
LA_c1:
    s_add_u32 s97, s98, 1
    s_and_b32 s97, s97, 15
    s_lshr_b32 s99, s97, 3
    s_xor_b32 s97, s97, s99
    s_lshl_b32 s97, s97, 7
    s_add_u32 m0, s87, 0
    s_add_u32 s89, s97, 0
    buffer_load_dwordx4 v2, s[28:31], s89 offen  lds
    s_mul_i32 s99, s97, 3072
    s_sub_u32 s19, s99, s18
    s_add_u32 s99, s99, s18
    s_add_u32 m0, s16, 0
    s_add_u32 s89, s99, 0
    buffer_load_dwordx4 v4, s[32:35], s89 offen  lds
    s_add_u32 m0, s87, 4096
    s_add_u32 s89, s97, 65536
    buffer_load_dwordx4 v2, s[28:31], s89 offen  lds
    s_add_u32 m0, s16, 24576
    s_add_u32 s89, s99, 2048
    buffer_load_dwordx4 v4, s[32:35], s89 offen  lds
    s_add_u32 m0, s87, 8192
    s_add_u32 s89, s97, 131072
    buffer_load_dwordx4 v2, s[28:31], s89 offen  lds
    s_add_u32 m0, s16, 49152
    s_add_u32 s89, s99, 4096
    buffer_load_dwordx4 v4, s[32:35], s89 offen  lds
    s_add_u32 m0, s87, 12288
    s_add_u32 s89, s97, 196608
    buffer_load_dwordx4 v2, s[28:31], s89 offen  lds
    s_mov_b64 exec, 0xffffffff
    s_add_u32 m0, s88, 0
    s_add_u32 s89, s97, 0
    buffer_load_dwordx4 v3, s[28:31], s89 offen  lds
    s_mov_b64 exec, -1
    s_add_u32 m0, s17, 0
    s_add_u32 s89, s19, 196608
    buffer_load_dwordx4 v4, s[32:35], s89 offen  lds
    s_mov_b32 s36, s6
    s_mov_b32 s37, s7
    s_mov_b32 s38, 0x400000
    s_mov_b32 s39, 0x20000
    s_mov_b32 s40, s8
    s_mov_b32 s41, s9
    s_mov_b32 s42, 0x400000
    s_mov_b32 s43, 0x20000
    s_mov_b32 s44, s10
    s_mov_b32 s45, s11
    s_mov_b32 s46, 0x2000
    s_mov_b32 s47, 0x20000
    s_mov_b32 s48, s12
    s_mov_b32 s49, s13
    s_mov_b32 s50, 0x400000
    s_mov_b32 s51, 0x20000
    s_mov_b32 s52, s26
    s_mov_b32 s53, s27
    s_mov_b32 s54, 0x1000000
    s_mov_b32 s55, 0x20000
    s_mov_b32 s56, s4
    s_mov_b32 s57, s5
    s_mov_b32 s58, 0x400000
    s_mov_b32 s59, 0x20000
    s_mov_b32 s60, s22
    s_mov_b32 s61, s23
    s_mov_b32 s62, 0x800000
    s_mov_b32 s63, 0x20000
    s_mov_b32 s64, s20
    s_mov_b32 s65, s21
    s_mov_b32 s66, 0x200000
    s_add_u32 m0, s17, 24576
    s_add_u32 s89, s19, 198656
    buffer_load_dwordx4 v4, s[32:35], s89 offen  lds
    s_mov_b32 s67, 0x20000
    s_mov_b32 s68, s24
    s_mov_b32 s69, s25
    s_mov_b32 s70, 0x100
    s_mov_b32 s71, 0x20000
    v_and_b32 v7, 7, v0
    s_lshl_b32 s79, s74, 7
    v_lshl_add_u32 v7, v7, 4, s79
    s_lshl_b32 s78, s75, 7
    s_lshl_b32 s80, s3, 3
    s_add_u32 s80, s80, s78
    v_lshrrev_b32 v5, 3, v0
    s_and_b32 s79, s3, 1
    v_xor_b32 v5, s79, v5
    v_add_u32 v5, s80, v5
    v_lshl_add_u32 v10, v5, 11, v7
    s_xor_b32 s80, s3, 1
    s_add_u32 s80, s78, s80
    s_sub_u32 s80, s80, 4
    s_lshl_b32 s80, s80, 11
    v_add_u32 v11, s80, v7
    v_bfe_u32 v5, v0, 3, 2
    v_lshrrev_b32 v6, 5, v0
    s_lshl_b32 s80, s3, 5
    v_lshlrev_b32 v8, 3, v5
    v_lshl_add_u32 v8, v6, 2, v8
    v_add_u32 v8, s80, v8
    v_and_b32 v35, 7, v0
    v_lshlrev_b32 v16, 4, v35
    v_lshl_add_u32 v16, v8, 7, v16
    s_add_u32 m0, s17, 49152
    s_add_u32 s89, s19, 200704
    buffer_load_dwordx4 v4, s[32:35], s89 offen  lds
    v_add_u32 v232, 129024, v16
    v_and_b32 v231, 1, v5
    v_lshl_add_u32 v16, v231, 7, v232
    v_xor_b32 v233, v231, v6
    v_xor_b32 v233, 1, v233
    v_lshl_add_u32 v232, v233, 7, v232
    v_xor_b32 v231, 128, v16
    v_xor_b32 v233, 128, v232
    v_lshrrev_b32 v33, 2, v35
    v_lshlrev_b32 v35, 6, v35
    v_lshl_add_u32 v35, v33, 4, v35
    v_add_u32 v35, 162816, v35
    v_add_u32 v8, s78, v8
    v_lshl_add_u32 v9, v8, 11, v7
    v_lshl_add_u32 v13, v8, 12, v7
    v_bfe_u32 v8, v0, 2, 1
    v_lshlrev_b32 v8, 1, v8
    v_add_u32 v8, v8, v6
    v_lshlrev_b32 v8, 16, v8
    v_lshl_add_u32 v8, v5, 6, v8
    v_and_b32 v7, 3, v0
    v_lshl_add_u32 v8, v7, 4, v8
    s_add_u32 s78, s78, s80
    s_lshl_b32 s78, s78, 3
    s_lshl_b32 s79, s74, 18
    s_add_u32 s78, s78, s79
    v_add_u32 v12, s78, v8
    s_lshl_b32 s91, s74, 4
    s_add_u32 s91, s91, s75
    s_lshr_b32 s78, s91, 3
    s_lshl_b32 s78, s78, 5
    s_add_u32 s97, s98, 0
    s_and_b32 s97, s97, 15
    s_lshr_b32 s99, s97, 3
    s_xor_b32 s97, s97, s99
    s_lshl_b32 s97, s97, 7
    s_add_u32 m0, s87, 18432
    s_add_u32 s89, s97, 0
    buffer_load_dwordx4 v2, s[28:31], s89 offen  lds
    s_and_b32 s79, s91, 7
    s_add_u32 s78, s78, s79
    s_lshl_b32 s79, s3, 3
    s_add_u32 s90, s78, s79
    s_lshl_b32 s91, s91, 14
    s_lshr_b32 s78, s90, 1
    s_lshl_b32 s78, s78, 2
    s_load_dword s92, s[14:15], s78
    s_mul_i32 s94, s3, 8320
    s_add_u32 s94, s94, 129024
    s_lshl_b32 s95, s3, 14
    s_mov_b32 s96, 4096
    s_and_b32 s100, s76, 3
    s_lshl_b32 s100, s100, 19
    v_bfe_u32 v5, v0, 2, 2
    v_lshlrev_b32 v5, 1, v5
    v_lshl_add_u32 v5, v6, 3, v5
    v_bfe_u32 v8, v0, 4, 1
    v_add_u32 v5, v5, v8
    s_and_b32 s78, s3, 1
    s_lshl_b32 s78, s78, 1
    v_add_u32 v8, s78, v6
    v_xor_b32 v8, v8, v7
    v_lshlrev_b32 v8, 4, v8
    v_lshl_add_u32 v5, v5, 6, v8
    v_add_u32 v14, s86, v5
    v_lshlrev_b32 v15, 4, v0
    v_lshrrev_b32 v5, 4, v0
    v_lshlrev_b32 v5, 1, v5
    v_and_b32 v8, 7, v0
    s_mul_i32 s99, s97, 3072
    s_sub_u32 s19, s99, s18
    s_add_u32 s99, s99, s18
    s_add_u32 m0, s16, 8192
    s_add_u32 s89, s99, 0
    buffer_load_dwordx4 v4, s[32:35], s89 offen  lds
    v_xor_b32 v5, v5, v8
    v_lshlrev_b32 v5, 4, v5
    v_lshrrev_b32 v8, 3, v0
    v_lshl_add_u32 v5, v8, 11, v5
    s_lshl_b32 s78, s77, 7
    v_add_u32 v17, s78, v5
    v_add_u32 v228, s95, v17
    s_lshr_b32 s78, s2, 3
    s_lshl_b32 s78, s78, 16
    s_add_u32 s78, s78, s95
    s_and_b32 s79, s77, 8
    s_lshl_b32 s79, s79, 7
    s_add_u32 s78, s78, s79
    v_and_b32 v5, 7, v0
    v_lshlrev_b32 v5, 7, v5
    v_lshl_add_u32 v5, v8, 11, v5
    v_add_u32 v229, s78, v5
    v_mov_b32 v18, 162304
    v_mov_b32 v19, 1
    v_and_b32 v5, 3, v0
    s_lshl_b32 s78, s74, 4
    s_add_u32 s78, s78, s3
    v_lshl_add_u32 v6, v5, 2, s78
    s_lshr_b32 s78, s76, 3
    s_lshl_b32 s79, s3, 1
    s_add_u32 s78, s78, s79
    s_xor_b32 s78, s78, 2
    s_lshl_b32 s78, s78, 5
    s_and_b32 s79, s76, 7
    s_add_u32 s78, s78, s79
    v_lshl_add_u32 v7, v5, 3, s78
    s_add_u32 m0, s87, 22528
    s_add_u32 s89, s97, 65536
    buffer_load_dwordx4 v2, s[28:31], s89 offen  lds
    v_and_b32 v8, 4, v0
    v_cmp_eq_u32 vcc, 0, v8
    s_nop 1
    v_cndmask_b32 v6, v7, v6, vcc
    v_and_b32 v33, 0xf0, v6
    v_lshlrev_b32 v34, 8, v6
    v_add_u32 v34, 12582912, v34
    v_and_b32 v5, 15, v0
    v_lshrrev_b32 v6, 4, v0
    v_add_u32 v7, 9, v5
    v_and_b32 v8, 1, v7
    v_mul_u32_u24 v8, 4160, v8
    v_lshrrev_b32 v7, 1, v7
    v_lshl_add_u32 v8, v7, 2, v8
    v_lshlrev_b32 v7, 4, v6
    v_sub_u32 v8, v8, v7
    s_add_u32 s78, s94, 32
    v_add_u32 v21, s78, v8
    v_add_u32 v22, 1024, v21
    v_add_u32 v23, 2048, v21
    v_add_u32 v24, 3072, v21
    v_lshl_add_u32 v7, v5, 1, v6
    v_add_u32 v7, 30, v7
    v_lshrrev_b32 v8, 3, v7
    v_and_b32 v25, 3, v8
    v_xor_b32 v25, s3, v25
    v_lshl_add_u32 v25, v8, 5, v25
    v_and_b32 v8, 1, v7
    v_lshl_add_u32 v25, v8, 4, v25
    v_bfe_u32 v8, v7, 1, 2
    v_lshl_add_u32 v25, v8, 2, v25
    s_add_u32 m0, s16, 32768
    s_add_u32 s89, s99, 2048
    buffer_load_dwordx4 v4, s[32:35], s89 offen  lds
    v_lshlrev_b32 v25, 4, v25
    v_add_u32 v25, 92160, v25
    v_lshl_add_u32 v7, v5, 1, v6
    v_add_u32 v7, 26, v7
    v_lshrrev_b32 v8, 3, v7
    v_and_b32 v26, 3, v8
    v_xor_b32 v26, s3, v26
    v_lshl_add_u32 v26, v8, 5, v26
    v_and_b32 v8, 1, v7
    v_lshl_add_u32 v26, v8, 4, v26
    v_bfe_u32 v8, v7, 1, 2
    v_lshl_add_u32 v26, v8, 2, v26
    v_lshlrev_b32 v26, 4, v26
    v_add_u32 v26, 92160, v26
    v_lshl_add_u32 v7, v5, 1, v6
    v_add_u32 v7, 22, v7
    v_lshrrev_b32 v8, 3, v7
    v_and_b32 v27, 3, v8
    v_xor_b32 v27, s3, v27
    v_lshl_add_u32 v27, v8, 5, v27
    v_and_b32 v8, 1, v7
    v_lshl_add_u32 v27, v8, 4, v27
    v_bfe_u32 v8, v7, 1, 2
    v_lshl_add_u32 v27, v8, 2, v27
    v_lshlrev_b32 v27, 4, v27
    v_add_u32 v27, 92160, v27
    v_lshl_add_u32 v7, v5, 1, v6
    v_add_u32 v7, 18, v7
    v_lshrrev_b32 v8, 3, v7
    v_and_b32 v28, 3, v8
    v_xor_b32 v28, s3, v28
    s_add_u32 m0, s87, 26624
    s_add_u32 s89, s97, 131072
    buffer_load_dwordx4 v2, s[28:31], s89 offen  lds
    v_lshl_add_u32 v28, v8, 5, v28
    v_and_b32 v8, 1, v7
    v_lshl_add_u32 v28, v8, 4, v28
    v_bfe_u32 v8, v7, 1, 2
    v_lshl_add_u32 v28, v8, 2, v28
    v_lshlrev_b32 v28, 4, v28
    v_add_u32 v28, 92160, v28
    v_lshl_add_u32 v7, v5, 1, v6
    v_add_u32 v7, 14, v7
    v_lshrrev_b32 v8, 3, v7
    v_and_b32 v29, 3, v8
    v_xor_b32 v29, s3, v29
    v_lshl_add_u32 v29, v8, 5, v29
    v_and_b32 v8, 1, v7
    v_lshl_add_u32 v29, v8, 4, v29
    v_bfe_u32 v8, v7, 1, 2
    v_lshl_add_u32 v29, v8, 2, v29
    v_lshlrev_b32 v29, 4, v29
    v_add_u32 v29, 92160, v29
    v_lshl_add_u32 v7, v5, 1, v6
    v_add_u32 v7, 10, v7
    v_lshrrev_b32 v8, 3, v7
    v_and_b32 v30, 3, v8
    v_xor_b32 v30, s3, v30
    v_lshl_add_u32 v30, v8, 5, v30
    v_and_b32 v8, 1, v7
    v_lshl_add_u32 v30, v8, 4, v30
    v_bfe_u32 v8, v7, 1, 2
    v_lshl_add_u32 v30, v8, 2, v30
    v_lshlrev_b32 v30, 4, v30
    s_add_u32 m0, s16, 57344
    s_add_u32 s89, s99, 4096
    buffer_load_dwordx4 v4, s[32:35], s89 offen  lds
    v_add_u32 v30, 92160, v30
    v_lshl_add_u32 v7, v5, 1, v6
    v_add_u32 v7, 6, v7
    v_lshrrev_b32 v8, 3, v7
    v_and_b32 v31, 3, v8
    v_xor_b32 v31, s3, v31
    v_lshl_add_u32 v31, v8, 5, v31
    v_and_b32 v8, 1, v7
    v_lshl_add_u32 v31, v8, 4, v31
    v_bfe_u32 v8, v7, 1, 2
    v_lshl_add_u32 v31, v8, 2, v31
    v_lshlrev_b32 v31, 4, v31
    v_add_u32 v31, 92160, v31
    v_lshl_add_u32 v7, v5, 1, v6
    v_add_u32 v7, 2, v7
    v_lshrrev_b32 v8, 3, v7
    v_and_b32 v32, 3, v8
    v_xor_b32 v32, s3, v32
    v_lshl_add_u32 v32, v8, 5, v32
    v_and_b32 v8, 1, v7
    v_lshl_add_u32 v32, v8, 4, v32
    v_bfe_u32 v8, v7, 1, 2
    v_lshl_add_u32 v32, v8, 2, v32
    v_lshlrev_b32 v32, 4, v32
    v_add_u32 v32, 92160, v32
    v_lshrrev_b32 v7, 1, v6
    v_lshl_add_u32 v7, v5, 1, v7
    v_add_u32 v7, 32, v7
    v_lshrrev_b32 v8, 3, v7
    v_and_b32 v20, 3, v8
    v_xor_b32 v20, s3, v20
    s_add_u32 m0, s87, 30720
    s_add_u32 s89, s97, 196608
    buffer_load_dwordx4 v2, s[28:31], s89 offen  lds
    v_lshl_add_u32 v20, v8, 5, v20
    v_and_b32 v8, 1, v7
    v_lshl_add_u32 v20, v8, 4, v20
    v_bfe_u32 v8, v7, 1, 2
    v_lshl_add_u32 v20, v8, 2, v20
    v_lshlrev_b32 v20, 4, v20
    v_add_u32 v20, 92160, v20
    v_and_b32 v8, 1, v6
    v_xor_b32 v8, 1, v8
    v_lshl_add_u32 v20, v8, 3, v20
    s_waitcnt lgkmcnt(0)
    s_and_b32 s78, s92, 0xffff0000
    s_lshl_b32 s92, s92, 16
    s_bitcmp1_b32 s90, 0
    s_cselect_b32 s92, s78, s92
    v_lshlrev_b32 v7, 3, v6
    v_sub_u32 v7, v7, v5
    v_subrev_u32 v7, 9, v7
    v_and_b32 v8, 1, v7
    v_xor_b32 v8, 1, v8
    v_lshlrev_b32 v8, 4, v8
    v_lshrrev_b32 v8, v8, s92
    v_ashrrev_i32 v7, 1, v7
    v_cmp_eq_u32 vcc, 0, v7
    s_nop 1
    v_cndmask_b32 v236, 0, v8, vcc
    v_cmp_eq_u32 vcc, 1, v7
    s_nop 1
    v_cndmask_b32 v237, 0, v8, vcc
    v_cmp_eq_u32 vcc, 2, v7
    s_nop 1
    v_cndmask_b32 v238, 0, v8, vcc
    v_cmp_eq_u32 vcc, 3, v7
    s_nop 1
    v_cndmask_b32 v239, 0, v8, vcc
    s_waitcnt vmcnt(7)
    s_barrier
    s_mov_b64 exec, 0xffffffff
    s_add_u32 m0, s88, 18432
    s_add_u32 s89, s97, 0
    buffer_load_dwordx4 v3, s[28:31], s89 offen  lds
    s_mov_b64 exec, -1
    s_add_u32 m0, s17, 8192
    s_add_u32 s89, s19, 196608
    buffer_load_dwordx4 v4, s[32:35], s89 offen  lds
    s_add_u32 m0, s17, 32768
    s_add_u32 s89, s19, 198656
    buffer_load_dwordx4 v4, s[32:35], s89 offen  lds
    s_add_u32 m0, s17, 57344
    s_add_u32 s89, s19, 200704
    buffer_load_dwordx4 v4, s[32:35], s89 offen  lds
    s_add_u32 s97, s98, 5
    s_and_b32 s97, s97, 15
    s_lshr_b32 s99, s97, 3
    s_xor_b32 s97, s97, s99
    s_lshl_b32 s97, s97, 7
    s_add_u32 m0, s87, 36864
    s_add_u32 s89, s97, 0
    buffer_load_dwordx4 v2, s[28:31], s89 offen  lds
    s_mul_i32 s99, s97, 3072
    s_sub_u32 s19, s99, s18
    s_add_u32 s99, s99, s18
    s_add_u32 m0, s16, 16384
    s_add_u32 s89, s99, 0
    buffer_load_dwordx4 v4, s[32:35], s89 offen  lds
    s_add_u32 m0, s87, 40960
    s_add_u32 s89, s97, 65536
    buffer_load_dwordx4 v2, s[28:31], s89 offen  lds
    s_add_u32 m0, s16, 40960
    s_add_u32 s89, s99, 2048
    buffer_load_dwordx4 v4, s[32:35], s89 offen  lds
    s_add_u32 m0, s87, 45056
    s_add_u32 s89, s97, 131072
    buffer_load_dwordx4 v2, s[28:31], s89 offen  lds
    s_add_u32 m0, s16, 65536
    s_add_u32 s89, s99, 4096
    buffer_load_dwordx4 v4, s[32:35], s89 offen  lds
    s_add_u32 m0, s87, 49152
    s_add_u32 s89, s97, 196608
    buffer_load_dwordx4 v2, s[28:31], s89 offen  lds
    s_mov_b64 exec, 0xffffffff
    s_add_u32 m0, s88, 36864
    s_add_u32 s89, s97, 0
    buffer_load_dwordx4 v3, s[28:31], s89 offen  lds
    s_mov_b64 exec, -1
    s_add_u32 m0, s17, 16384
    s_add_u32 s89, s19, 196608
    buffer_load_dwordx4 v4, s[32:35], s89 offen  lds
    s_add_u32 m0, s17, 40960
    s_add_u32 s89, s19, 198656
    buffer_load_dwordx4 v4, s[32:35], s89 offen  lds
    s_waitcnt vmcnt(10)
    s_barrier
    s_add_u32 m0, s17, 65536
    s_add_u32 s89, s19, 200704
    buffer_load_dwordx4 v4, s[32:35], s89 offen  lds
    s_add_u32 s97, s98, 2
    s_and_b32 s97, s97, 15
    s_lshr_b32 s99, s97, 3
    s_xor_b32 s97, s97, s99
    s_lshl_b32 s97, s97, 7
    s_add_u32 m0, s87, 0
    s_add_u32 s89, s97, 0
    buffer_load_dwordx4 v2, s[28:31], s89 offen  lds
    s_mul_i32 s99, s97, 3072
    s_sub_u32 s19, s99, s18
    s_add_u32 s99, s99, s18
    s_add_u32 m0, s16, 0
    s_add_u32 s89, s99, 0
    buffer_load_dwordx4 v4, s[32:35], s89 offen  lds
    s_add_u32 m0, s87, 4096
    s_add_u32 s89, s97, 65536
    buffer_load_dwordx4 v2, s[28:31], s89 offen  lds
    s_add_u32 m0, s16, 24576
    s_add_u32 s89, s99, 2048
    buffer_load_dwordx4 v4, s[32:35], s89 offen  lds
    s_add_u32 m0, s87, 8192
    s_add_u32 s89, s97, 131072
    buffer_load_dwordx4 v2, s[28:31], s89 offen  lds
    s_add_u32 m0, s16, 49152
    s_add_u32 s89, s99, 4096
    buffer_load_dwordx4 v4, s[32:35], s89 offen  lds
    s_add_u32 m0, s87, 12288
    s_add_u32 s89, s97, 196608
    buffer_load_dwordx4 v2, s[28:31], s89 offen  lds
    s_mov_b64 exec, 0xffffffff
    s_add_u32 m0, s88, 0
    s_add_u32 s89, s97, 0
    buffer_load_dwordx4 v3, s[28:31], s89 offen  lds
    s_mov_b64 exec, -1
    s_add_u32 m0, s17, 0
    s_add_u32 s89, s19, 196608
    buffer_load_dwordx4 v4, s[32:35], s89 offen  lds
    s_add_u32 m0, s17, 24576
    s_add_u32 s89, s19, 198656
    buffer_load_dwordx4 v4, s[32:35], s89 offen  lds
    s_add_u32 m0, s17, 49152
    s_add_u32 s89, s19, 200704
    buffer_load_dwordx4 v4, s[32:35], s89 offen  lds
    s_waitcnt vmcnt(11)
    s_barrier
    s_add_u32 m0, s86, 129536
    s_mov_b32 s89, 0
    buffer_load_dwordx4 v10, s[36:39], s89 offen nt lds
    s_add_u32 m0, s86, 145920
    s_mov_b32 s89, 0
    buffer_load_dwordx4 v10, s[40:43], s89 offen nt lds
    s_add_u32 m0, s86, 133632
    s_mov_b32 s89, 65536
    buffer_load_dwordx4 v10, s[36:39], s89 offen nt lds
    s_add_u32 m0, s86, 150016
    s_mov_b32 s89, 65536
    buffer_load_dwordx4 v10, s[40:43], s89 offen nt lds
    s_add_u32 m0, s86, 137728
    s_mov_b32 s89, 131072
    buffer_load_dwordx4 v10, s[36:39], s89 offen nt lds
    s_add_u32 m0, s86, 154112
    s_mov_b32 s89, 131072
    buffer_load_dwordx4 v10, s[40:43], s89 offen nt lds
    s_add_u32 m0, s86, 141824
    s_mov_b32 s89, 196608
    buffer_load_dwordx4 v10, s[36:39], s89 offen nt lds
    s_add_u32 m0, s86, 158208
    s_mov_b32 s89, 196608
    buffer_load_dwordx4 v10, s[40:43], s89 offen nt lds
    s_mov_b64 exec, 0xff
    s_lshl_b32 s82, s3, 7
    s_add_u32 m0, s82, 129024
    s_mov_b32 s89, 0
    buffer_load_dwordx4 v11, s[36:39], s89 offen nt lds
    s_lshl_b32 s83, s74, 9
    s_add_u32 s83, s83, s82
    s_and_b32 s89, s3, 2
    s_lshl_b32 s89, s89, 3
    s_add_u32 s82, s82, s89
    s_add_u32 m0, s82, 162816
    s_add_u32 s89, s83, 0
    buffer_load_dwordx4 v15, s[44:47], s89 offen  lds
    s_mov_b64 exec, -1
    s_add_u32 s97, s98, 3
    s_and_b32 s97, s97, 15
    s_lshr_b32 s99, s97, 3
    s_xor_b32 s97, s97, s99
    s_lshl_b32 s97, s97, 7
    s_add_u32 m0, s87, 18432
    s_add_u32 s89, s97, 0
    buffer_load_dwordx4 v2, s[28:31], s89 offen  lds
    s_mul_i32 s99, s97, 3072
    s_sub_u32 s19, s99, s18
    s_add_u32 s99, s99, s18
    s_add_u32 m0, s16, 8192
    s_add_u32 s89, s99, 0
    buffer_load_dwordx4 v4, s[32:35], s89 offen  lds
    s_add_u32 m0, s87, 22528
    s_add_u32 s89, s97, 65536
    buffer_load_dwordx4 v2, s[28:31], s89 offen  lds
    s_add_u32 m0, s16, 32768
    s_add_u32 s89, s99, 2048
    buffer_load_dwordx4 v4, s[32:35], s89 offen  lds
    s_add_u32 m0, s87, 26624
    s_add_u32 s89, s97, 131072
    buffer_load_dwordx4 v2, s[28:31], s89 offen  lds
    s_waitcnt vmcnt(15)
    s_barrier
    s_add_u32 m0, s16, 57344
    s_add_u32 s89, s99, 4096
    buffer_load_dwordx4 v4, s[32:35], s89 offen  lds
    s_add_u32 m0, s87, 30720
    s_add_u32 s89, s97, 196608
    buffer_load_dwordx4 v2, s[28:31], s89 offen  lds
    s_mov_b64 exec, 0xffffffff
    s_add_u32 m0, s88, 18432
    s_add_u32 s89, s97, 0
    buffer_load_dwordx4 v3, s[28:31], s89 offen  lds
    s_mov_b64 exec, -1
    s_add_u32 m0, s17, 8192
    s_add_u32 s89, s19, 196608
    buffer_load_dwordx4 v4, s[32:35], s89 offen  lds
    s_add_u32 m0, s17, 32768
    s_add_u32 s89, s19, 198656
    buffer_load_dwordx4 v4, s[32:35], s89 offen  lds
    s_add_u32 m0, s17, 57344
    s_add_u32 s89, s19, 200704
    buffer_load_dwordx4 v4, s[32:35], s89 offen  lds
    s_add_u32 s97, s98, 4
    s_and_b32 s97, s97, 15
    s_lshr_b32 s99, s97, 3
    s_xor_b32 s97, s97, s99
    s_lshl_b32 s97, s97, 7
    s_add_u32 m0, s87, 36864
    s_add_u32 s89, s97, 0
    buffer_load_dwordx4 v2, s[28:31], s89 offen  lds
    s_mul_i32 s99, s97, 3072
    s_sub_u32 s19, s99, s18
    s_add_u32 s99, s99, s18
    s_add_u32 m0, s16, 16384
    s_add_u32 s89, s99, 0
    buffer_load_dwordx4 v4, s[32:35], s89 offen  lds
    s_add_u32 m0, s87, 40960
    s_add_u32 s89, s97, 65536
    buffer_load_dwordx4 v2, s[28:31], s89 offen  lds
    s_add_u32 m0, s16, 40960
    s_add_u32 s89, s99, 2048
    buffer_load_dwordx4 v4, s[32:35], s89 offen  lds
    s_add_u32 m0, s87, 45056
    s_add_u32 s89, s97, 131072
    buffer_load_dwordx4 v2, s[28:31], s89 offen  lds
    s_add_u32 m0, s16, 65536
    s_add_u32 s89, s99, 4096
    buffer_load_dwordx4 v4, s[32:35], s89 offen  lds
    s_add_u32 m0, s87, 49152
    s_add_u32 s89, s97, 196608
    buffer_load_dwordx4 v2, s[28:31], s89 offen  lds
    s_mov_b64 exec, 0xffffffff
    s_add_u32 m0, s88, 36864
    s_add_u32 s89, s97, 0
    buffer_load_dwordx4 v3, s[28:31], s89 offen  lds
    s_mov_b64 exec, -1
    s_waitcnt vmcnt(8)
    s_barrier
    s_add_u32 m0, s17, 16384
    s_add_u32 s89, s19, 196608
    buffer_load_dwordx4 v4, s[32:35], s89 offen  lds
    ds_read_b128 v[84:87], v35 offset:0
    ds_read_b128 v[88:91], v35 offset:16
    s_add_u32 m0, s17, 40960
    s_add_u32 s89, s19, 198656
    buffer_load_dwordx4 v4, s[32:35], s89 offen  lds
    ds_read_b128 v[92:95], v35 offset:32
    s_add_u32 m0, s17, 65536
    s_add_u32 s89, s19, 200704
    buffer_load_dwordx4 v4, s[32:35], s89 offen  lds
    ds_read_b128 v[96:99], v35 offset:48
    s_add_u32 s97, s98, 9
    s_and_b32 s97, s97, 15
    s_lshr_b32 s99, s97, 3
    s_xor_b32 s97, s97, s99
    s_lshl_b32 s97, s97, 7
    s_add_u32 m0, s87, 0
    s_add_u32 s89, s97, 0
    buffer_load_dwordx4 v2, s[28:31], s89 offen  lds
    ds_read_b128 v[40:43], v233 offset:0
    s_mul_i32 s99, s97, 3072
    s_sub_u32 s19, s99, s18
    s_add_u32 s99, s99, s18
    s_add_u32 m0, s16, 0
    s_add_u32 s89, s99, 0
    buffer_load_dwordx4 v4, s[32:35], s89 offen  lds
    ds_read_b128 v[44:47], v232 offset:256
    s_add_u32 m0, s87, 4096
    s_add_u32 s89, s97, 65536
    buffer_load_dwordx4 v2, s[28:31], s89 offen  lds
    ds_read_b128 v[48:51], v233 offset:256
    s_add_u32 m0, s16, 24576
    s_add_u32 s89, s99, 2048
    buffer_load_dwordx4 v4, s[32:35], s89 offen  lds
    ds_read_b128 v[52:55], v16 offset:512
    s_add_u32 m0, s87, 8192
    s_add_u32 s89, s97, 131072
    buffer_load_dwordx4 v2, s[28:31], s89 offen  lds
    ds_read_b128 v[56:59], v231 offset:512
    s_add_u32 m0, s16, 49152
    s_add_u32 s89, s99, 4096
    buffer_load_dwordx4 v4, s[32:35], s89 offen  lds
    ds_read_b128 v[60:63], v16 offset:768
    s_add_u32 m0, s87, 12288
    s_add_u32 s89, s97, 196608
    buffer_load_dwordx4 v2, s[28:31], s89 offen  lds
    ds_read_b128 v[64:67], v231 offset:768
    s_mov_b64 exec, 0xffffffff
    s_add_u32 m0, s88, 0
    s_add_u32 s89, s97, 0
    buffer_load_dwordx4 v3, s[28:31], s89 offen  lds
    s_mov_b64 exec, -1
    ds_read_b128 v[68:71], v16 offset:16896
    s_add_u32 m0, s17, 0
    s_add_u32 s89, s19, 196608
    buffer_load_dwordx4 v4, s[32:35], s89 offen  lds
    ds_read_b128 v[72:75], v231 offset:16896
    s_add_u32 m0, s17, 24576
    s_add_u32 s89, s19, 198656
    buffer_load_dwordx4 v4, s[32:35], s89 offen  lds
    ds_read_b128 v[76:79], v16 offset:17152
    s_add_u32 m0, s17, 49152
    s_add_u32 s89, s19, 200704
    buffer_load_dwordx4 v4, s[32:35], s89 offen  lds
    ds_read_b128 v[80:83], v231 offset:17152
    s_waitcnt vmcnt(11)
    s_waitcnt lgkmcnt(0)
    s_barrier
    s_add_u32 s97, s98, 6
    s_and_b32 s97, s97, 15
    s_lshr_b32 s99, s97, 3
    s_xor_b32 s97, s97, s99
    s_lshl_b32 s97, s97, 7
    s_add_u32 m0, s87, 18432
    s_add_u32 s89, s97, 0
    buffer_load_dwordx4 v2, s[28:31], s89 offen  lds
    v_lshlrev_b32 v116, 16, v40
    v_lshlrev_b32 v117, 16, v44
    v_lshlrev_b32 v118, 16, v48
    v_lshlrev_b32 v119, 16, v52
    v_lshlrev_b32 v120, 16, v56
    v_lshlrev_b32 v121, 16, v60
    s_mul_i32 s99, s97, 3072
    s_sub_u32 s19, s99, s18
    s_add_u32 s99, s99, s18
    s_add_u32 m0, s16, 8192
    s_add_u32 s89, s99, 0
    buffer_load_dwordx4 v4, s[32:35], s89 offen  lds
    v_lshlrev_b32 v122, 16, v64
    v_lshlrev_b32 v127, 16, v84
    v_and_b32 v128, 0xffff0000, v84
    v_lshlrev_b32 v129, 16, v85
    v_and_b32 v130, 0xffff0000, v85
    v_lshlrev_b32 v123, 16, v68
    s_add_u32 m0, s87, 22528
    s_add_u32 s89, s97, 65536
    buffer_load_dwordx4 v2, s[28:31], s89 offen  lds
    v_lshlrev_b32 v124, 16, v72
    v_lshlrev_b32 v125, 16, v76
    v_lshlrev_b32 v126, 16, v80
    v_mul_f32 v131, v116, v130
    v_mul_f32 v132, v117, v130
    s_add_u32 m0, s16, 32768
    s_add_u32 s89, s99, 2048
    buffer_load_dwordx4 v4, s[32:35], s89 offen  lds
    v_mul_f32 v133, v118, v130
    v_mul_f32 v134, v119, v130
    v_fmac_f32 v131, v117, v129
    v_fmac_f32 v132, v118, v129
    v_fmac_f32 v133, v119, v129
    v_fmac_f32 v134, v120, v129
    s_add_u32 m0, s87, 26624
    s_add_u32 s89, s97, 131072
    buffer_load_dwordx4 v2, s[28:31], s89 offen  lds
    v_fmac_f32 v131, v118, v128
    v_fmac_f32 v132, v119, v128
    v_fmac_f32 v133, v120, v128
    v_fmac_f32 v134, v121, v128
    v_fmac_f32 v131, v119, v127
    v_fmac_f32 v132, v120, v127
    s_add_u32 m0, s16, 57344
    s_add_u32 s89, s99, 4096
    buffer_load_dwordx4 v4, s[32:35], s89 offen  lds
    v_fmac_f32 v133, v121, v127
    v_fmac_f32 v134, v122, v127
    v_mul_f32 v131, v131, v123
    v_mul_f32 v132, v132, v124
    v_mul_f32 v133, v133, v125
    s_add_u32 m0, s87, 30720
    s_add_u32 s89, s97, 196608
    buffer_load_dwordx4 v2, s[28:31], s89 offen  lds
    v_mul_f32 v134, v134, v126
    v_cvt_pk_bf16_f32 v102, v134, v133
    v_cvt_pk_bf16_f32 v103, v132, v131
    v_lshlrev_b32 v116, 16, v42
    v_lshlrev_b32 v117, 16, v46
    v_lshlrev_b32 v118, 16, v50
    s_mov_b64 exec, 0xffffffff
    s_add_u32 m0, s88, 18432
    s_add_u32 s89, s97, 0
    buffer_load_dwordx4 v3, s[28:31], s89 offen  lds
    s_mov_b64 exec, -1
    v_lshlrev_b32 v119, 16, v54
    v_lshlrev_b32 v120, 16, v58
    v_lshlrev_b32 v121, 16, v62
    v_lshlrev_b32 v122, 16, v66
    v_lshlrev_b32 v127, 16, v92
    v_and_b32 v128, 0xffff0000, v92
    s_add_u32 m0, s17, 8192
    s_add_u32 s89, s19, 196608
    buffer_load_dwordx4 v4, s[32:35], s89 offen  lds
    v_lshlrev_b32 v129, 16, v93
    v_and_b32 v130, 0xffff0000, v93
    v_lshlrev_b32 v123, 16, v70
    v_lshlrev_b32 v124, 16, v74
    v_lshlrev_b32 v125, 16, v78
    s_add_u32 m0, s17, 32768
    s_add_u32 s89, s19, 198656
    buffer_load_dwordx4 v4, s[32:35], s89 offen  lds
    v_lshlrev_b32 v126, 16, v82
    v_mul_f32 v131, v116, v130
    v_mul_f32 v132, v117, v130
    v_mul_f32 v133, v118, v130
    v_mul_f32 v134, v119, v130
    v_fmac_f32 v131, v117, v129
    s_add_u32 m0, s17, 57344
    s_add_u32 s89, s19, 200704
    buffer_load_dwordx4 v4, s[32:35], s89 offen  lds
    v_fmac_f32 v132, v118, v129
    v_fmac_f32 v133, v119, v129
    v_fmac_f32 v134, v120, v129
    v_fmac_f32 v131, v118, v128
    v_fmac_f32 v132, v119, v128
    s_waitcnt vmcnt(11)
    s_barrier
    s_add_u32 s97, s98, 7
    s_and_b32 s97, s97, 15
    s_lshr_b32 s99, s97, 3
    s_xor_b32 s97, s97, s99
    s_lshl_b32 s97, s97, 7
    s_add_u32 m0, s87, 36864
    s_add_u32 s89, s97, 0
    buffer_load_dwordx4 v2, s[28:31], s89 offen  lds
    v_fmac_f32 v133, v120, v128
    v_fmac_f32 v134, v121, v128
    v_fmac_f32 v131, v119, v127
    v_fmac_f32 v132, v120, v127
    v_fmac_f32 v133, v121, v127
    v_fmac_f32 v134, v122, v127
    s_mul_i32 s99, s97, 3072
    s_sub_u32 s19, s99, s18
    s_add_u32 s99, s99, s18
    s_add_u32 m0, s16, 16384
    s_add_u32 s89, s99, 0
    buffer_load_dwordx4 v4, s[32:35], s89 offen  lds
    v_mul_f32 v131, v131, v123
    v_mul_f32 v132, v132, v124
    v_mul_f32 v133, v133, v125
    v_mul_f32 v134, v134, v126
    v_cvt_pk_bf16_f32 v100, v134, v133
    v_cvt_pk_bf16_f32 v101, v132, v131
    s_add_u32 m0, s87, 40960
    s_add_u32 s89, s97, 65536
    buffer_load_dwordx4 v2, s[28:31], s89 offen  lds
    v_permlane32_swap_b32 v102, v100
    v_permlane32_swap_b32 v103, v101
    s_mov_b32 s89, 0
    buffer_store_dwordx4 v[100:103], v12, s[52:55], s89 offen sc1
    v_and_b32 v116, 0xffff0000, v40
    v_and_b32 v117, 0xffff0000, v44
    s_add_u32 m0, s16, 40960
    s_add_u32 s89, s99, 2048
    buffer_load_dwordx4 v4, s[32:35], s89 offen  lds
    v_and_b32 v118, 0xffff0000, v48
    v_and_b32 v119, 0xffff0000, v52
    v_and_b32 v120, 0xffff0000, v56
    v_and_b32 v121, 0xffff0000, v60
    v_and_b32 v122, 0xffff0000, v64
    v_lshlrev_b32 v127, 16, v86
    s_add_u32 m0, s87, 45056
    s_add_u32 s89, s97, 131072
    buffer_load_dwordx4 v2, s[28:31], s89 offen  lds
    v_and_b32 v128, 0xffff0000, v86
    v_lshlrev_b32 v129, 16, v87
    v_and_b32 v130, 0xffff0000, v87
    v_and_b32 v123, 0xffff0000, v68
    v_and_b32 v124, 0xffff0000, v72
    v_and_b32 v125, 0xffff0000, v76
    s_add_u32 m0, s16, 65536
    s_add_u32 s89, s99, 4096
    buffer_load_dwordx4 v4, s[32:35], s89 offen  lds
    v_and_b32 v126, 0xffff0000, v80
    v_mul_f32 v131, v116, v130
    v_mul_f32 v132, v117, v130
    v_mul_f32 v133, v118, v130
    v_mul_f32 v134, v119, v130
    s_add_u32 m0, s87, 49152
    s_add_u32 s89, s97, 196608
    buffer_load_dwordx4 v2, s[28:31], s89 offen  lds
    v_fmac_f32 v131, v117, v129
    v_fmac_f32 v132, v118, v129
    v_fmac_f32 v133, v119, v129
    v_fmac_f32 v134, v120, v129
    v_fmac_f32 v131, v118, v128
    v_fmac_f32 v132, v119, v128
    s_mov_b64 exec, 0xffffffff
    s_add_u32 m0, s88, 36864
    s_add_u32 s89, s97, 0
    buffer_load_dwordx4 v3, s[28:31], s89 offen  lds
    s_mov_b64 exec, -1
    v_fmac_f32 v133, v120, v128
    v_fmac_f32 v134, v121, v128
    v_fmac_f32 v131, v119, v127
    v_fmac_f32 v132, v120, v127
    v_fmac_f32 v133, v121, v127
    v_fmac_f32 v134, v122, v127
    s_add_u32 m0, s17, 16384
    s_add_u32 s89, s19, 196608
    buffer_load_dwordx4 v4, s[32:35], s89 offen  lds
    v_mul_f32 v131, v131, v123
    v_mul_f32 v132, v132, v124
    v_mul_f32 v133, v133, v125
    v_mul_f32 v134, v134, v126
    v_cvt_pk_bf16_f32 v106, v134, v133
    s_add_u32 m0, s17, 40960
    s_add_u32 s89, s19, 198656
    buffer_load_dwordx4 v4, s[32:35], s89 offen  lds
    v_cvt_pk_bf16_f32 v107, v132, v131
    v_and_b32 v116, 0xffff0000, v42
    v_and_b32 v117, 0xffff0000, v46
    v_and_b32 v118, 0xffff0000, v50
    v_and_b32 v119, 0xffff0000, v54
    v_and_b32 v120, 0xffff0000, v58
    s_add_u32 m0, s17, 65536
    s_add_u32 s89, s19, 200704
    buffer_load_dwordx4 v4, s[32:35], s89 offen  lds
    v_and_b32 v121, 0xffff0000, v62
    v_and_b32 v122, 0xffff0000, v66
    v_lshlrev_b32 v127, 16, v94
    v_and_b32 v128, 0xffff0000, v94
    v_lshlrev_b32 v129, 16, v95
    s_waitcnt vmcnt(12)
    s_barrier
    s_add_u32 s97, s98, 8
    s_and_b32 s97, s97, 15
    s_lshr_b32 s99, s97, 3
    s_xor_b32 s97, s97, s99
    s_lshl_b32 s97, s97, 7
    s_add_u32 m0, s87, 0
    s_add_u32 s89, s97, 0
    buffer_load_dwordx4 v2, s[28:31], s89 offen  lds
    v_and_b32 v130, 0xffff0000, v95
    v_and_b32 v123, 0xffff0000, v70
    v_and_b32 v124, 0xffff0000, v74
    v_and_b32 v125, 0xffff0000, v78
    v_and_b32 v126, 0xffff0000, v82
    v_mul_f32 v131, v116, v130
    s_mul_i32 s99, s97, 3072
    s_sub_u32 s19, s99, s18
    s_add_u32 s99, s99, s18
    s_add_u32 m0, s16, 0
    s_add_u32 s89, s99, 0
    buffer_load_dwordx4 v4, s[32:35], s89 offen  lds
    v_mul_f32 v132, v117, v130
    v_mul_f32 v133, v118, v130
    v_mul_f32 v134, v119, v130
    v_fmac_f32 v131, v117, v129
    v_fmac_f32 v132, v118, v129
    v_fmac_f32 v133, v119, v129
    s_add_u32 m0, s87, 4096
    s_add_u32 s89, s97, 65536
    buffer_load_dwordx4 v2, s[28:31], s89 offen  lds
    v_fmac_f32 v134, v120, v129
    v_fmac_f32 v131, v118, v128
    v_fmac_f32 v132, v119, v128
    v_fmac_f32 v133, v120, v128
    v_fmac_f32 v134, v121, v128
    s_add_u32 m0, s16, 24576
    s_add_u32 s89, s99, 2048
    buffer_load_dwordx4 v4, s[32:35], s89 offen  lds
    v_fmac_f32 v131, v119, v127
    v_fmac_f32 v132, v120, v127
    v_fmac_f32 v133, v121, v127
    v_fmac_f32 v134, v122, v127
    v_mul_f32 v131, v131, v123
    v_mul_f32 v132, v132, v124
    s_add_u32 m0, s87, 8192
    s_add_u32 s89, s97, 131072
    buffer_load_dwordx4 v2, s[28:31], s89 offen  lds
    v_mul_f32 v133, v133, v125
    v_mul_f32 v134, v134, v126
    v_cvt_pk_bf16_f32 v104, v134, v133
    v_cvt_pk_bf16_f32 v105, v132, v131
    s_nop 0
    v_permlane32_swap_b32 v106, v104
    v_permlane32_swap_b32 v107, v105
    s_add_u32 m0, s16, 49152
    s_add_u32 s89, s99, 4096
    buffer_load_dwordx4 v4, s[32:35], s89 offen  lds
    s_mov_b32 s89, 16384
    buffer_store_dwordx4 v[104:107], v12, s[52:55], s89 offen sc1
    v_lshlrev_b32 v116, 16, v41
    v_lshlrev_b32 v117, 16, v45
    v_lshlrev_b32 v118, 16, v49
    v_lshlrev_b32 v119, 16, v53
    s_add_u32 m0, s87, 12288
    s_add_u32 s89, s97, 196608
    buffer_load_dwordx4 v2, s[28:31], s89 offen  lds
    v_lshlrev_b32 v120, 16, v57
    v_lshlrev_b32 v121, 16, v61
    v_lshlrev_b32 v122, 16, v65
    v_lshlrev_b32 v127, 16, v88
    v_and_b32 v128, 0xffff0000, v88
    v_lshlrev_b32 v129, 16, v89
    s_mov_b64 exec, 0xffffffff
    s_add_u32 m0, s88, 0
    s_add_u32 s89, s97, 0
    buffer_load_dwordx4 v3, s[28:31], s89 offen  lds
    s_mov_b64 exec, -1
    v_and_b32 v130, 0xffff0000, v89
    v_lshlrev_b32 v123, 16, v69
    v_lshlrev_b32 v124, 16, v73
    v_lshlrev_b32 v125, 16, v77
    v_lshlrev_b32 v126, 16, v81
    v_mul_f32 v131, v116, v130
    s_add_u32 m0, s17, 0
    s_add_u32 s89, s19, 196608
    buffer_load_dwordx4 v4, s[32:35], s89 offen  lds
    v_mul_f32 v132, v117, v130
    v_mul_f32 v133, v118, v130
    v_mul_f32 v134, v119, v130
    v_fmac_f32 v131, v117, v129
    v_fmac_f32 v132, v118, v129
    s_add_u32 m0, s17, 24576
    s_add_u32 s89, s19, 198656
    buffer_load_dwordx4 v4, s[32:35], s89 offen  lds
    v_fmac_f32 v133, v119, v129
    v_fmac_f32 v134, v120, v129
    v_fmac_f32 v131, v118, v128
    v_fmac_f32 v132, v119, v128
    v_fmac_f32 v133, v120, v128
    v_fmac_f32 v134, v121, v128
    s_add_u32 m0, s17, 49152
    s_add_u32 s89, s19, 200704
    buffer_load_dwordx4 v4, s[32:35], s89 offen  lds
    v_fmac_f32 v131, v119, v127
    v_fmac_f32 v132, v120, v127
    v_fmac_f32 v133, v121, v127
    v_fmac_f32 v134, v122, v127
    v_mul_f32 v131, v131, v123
    s_waitcnt vmcnt(12)
    s_barrier
    s_add_u32 m0, s94, 32
    s_lshl_b32 s89, s90, 12
    buffer_load_dwordx4 v15, s[48:51], s89 offen offset:0 nt lds
    v_mul_f32 v132, v132, v124
    v_mul_f32 v133, v133, v125
    v_mul_f32 v134, v134, v126
    v_cvt_pk_bf16_f32 v110, v134, v133
    v_cvt_pk_bf16_f32 v111, v132, v131
    s_add_u32 m0, s94, 32
    s_lshl_b32 s89, s90, 12
    buffer_load_dwordx4 v15, s[48:51], s89 offen offset:1024 nt lds
    v_lshlrev_b32 v116, 16, v43
    v_lshlrev_b32 v117, 16, v47
    v_lshlrev_b32 v118, 16, v51
    v_lshlrev_b32 v119, 16, v55
    s_add_u32 m0, s94, 32
    s_lshl_b32 s89, s90, 12
    buffer_load_dwordx4 v15, s[48:51], s89 offen offset:2048 nt lds
    v_lshlrev_b32 v120, 16, v59
    v_lshlrev_b32 v121, 16, v63
    v_lshlrev_b32 v122, 16, v67
    v_lshlrev_b32 v127, 16, v96
    v_and_b32 v128, 0xffff0000, v96
    s_add_u32 m0, s94, 32
    s_lshl_b32 s89, s90, 12
    buffer_load_dwordx4 v15, s[48:51], s89 offen offset:3072 nt lds
    v_lshlrev_b32 v129, 16, v97
    v_and_b32 v130, 0xffff0000, v97
    v_lshlrev_b32 v123, 16, v71
    v_lshlrev_b32 v124, 16, v75
    buffer_load_dwordx4 v[212:215], v9, s[56:59], 0 offen offset:0 nt
    v_lshlrev_b32 v125, 16, v79
    v_lshlrev_b32 v126, 16, v83
    v_mul_f32 v131, v116, v130
    v_mul_f32 v132, v117, v130
    v_mul_f32 v133, v118, v130
    buffer_load_dwordx4 v[216:219], v9, s[56:59], 0 offen offset:2048 nt
    v_mul_f32 v134, v119, v130
    v_fmac_f32 v131, v117, v129
    v_fmac_f32 v132, v118, v129
    v_fmac_f32 v133, v119, v129
    buffer_load_dwordx4 v[220:223], v9, s[56:59], s96 offen offset:0 nt
    v_fmac_f32 v134, v120, v129
    v_fmac_f32 v131, v118, v128
    v_fmac_f32 v132, v119, v128
    v_fmac_f32 v133, v120, v128
    buffer_load_dwordx4 v[224:227], v9, s[56:59], s96 offen offset:2048 nt
    v_fmac_f32 v134, v121, v128
    v_fmac_f32 v131, v119, v127
    v_fmac_f32 v132, v120, v127
    v_fmac_f32 v133, v121, v127
    v_fmac_f32 v134, v122, v127
    s_add_u32 s97, s98, 13
    s_and_b32 s97, s97, 15
    s_lshr_b32 s99, s97, 3
    s_xor_b32 s97, s97, s99
    s_lshl_b32 s97, s97, 7
    s_add_u32 m0, s87, 18432
    s_add_u32 s89, s97, 0
    buffer_load_dwordx4 v2, s[28:31], s89 offen  lds
    v_mul_f32 v131, v131, v123
    v_mul_f32 v132, v132, v124
    v_mul_f32 v133, v133, v125
    v_mul_f32 v134, v134, v126
    s_mul_i32 s99, s97, 3072
    s_sub_u32 s19, s99, s18
    s_add_u32 s99, s99, s18
    s_add_u32 m0, s16, 8192
    s_add_u32 s89, s99, 0
    buffer_load_dwordx4 v4, s[32:35], s89 offen  lds
    v_cvt_pk_bf16_f32 v108, v134, v133
    v_cvt_pk_bf16_f32 v109, v132, v131
    s_nop 0
    v_permlane32_swap_b32 v110, v108
    v_permlane32_swap_b32 v111, v109
    s_mov_b32 s89, 32768
    buffer_store_dwordx4 v[108:111], v12, s[52:55], s89 offen sc1
    s_add_u32 m0, s87, 22528
    s_add_u32 s89, s97, 65536
    buffer_load_dwordx4 v2, s[28:31], s89 offen  lds
    v_and_b32 v116, 0xffff0000, v41
    v_and_b32 v117, 0xffff0000, v45
    v_and_b32 v118, 0xffff0000, v49
    v_and_b32 v119, 0xffff0000, v53
    s_add_u32 m0, s16, 32768
    s_add_u32 s89, s99, 2048
    buffer_load_dwordx4 v4, s[32:35], s89 offen  lds
    v_and_b32 v120, 0xffff0000, v57
    v_and_b32 v121, 0xffff0000, v61
    v_and_b32 v122, 0xffff0000, v65
    v_lshlrev_b32 v127, 16, v90
    v_and_b32 v128, 0xffff0000, v90
    s_add_u32 m0, s87, 26624
    s_add_u32 s89, s97, 131072
    buffer_load_dwordx4 v2, s[28:31], s89 offen  lds
    v_lshlrev_b32 v129, 16, v91
    v_and_b32 v130, 0xffff0000, v91
    v_and_b32 v123, 0xffff0000, v69
    v_and_b32 v124, 0xffff0000, v73
    s_add_u32 m0, s16, 57344
    s_add_u32 s89, s99, 4096
    buffer_load_dwordx4 v4, s[32:35], s89 offen  lds
    v_and_b32 v125, 0xffff0000, v77
    v_and_b32 v126, 0xffff0000, v81
    v_mul_f32 v131, v116, v130
    v_mul_f32 v132, v117, v130
    s_waitcnt vmcnt(15)
    s_barrier
    s_add_u32 m0, s87, 30720
    s_add_u32 s89, s97, 196608
    buffer_load_dwordx4 v2, s[28:31], s89 offen  lds
    v_mul_f32 v133, v118, v130
    v_mul_f32 v134, v119, v130
    v_fmac_f32 v131, v117, v129
    v_fmac_f32 v132, v118, v129
    v_fmac_f32 v133, v119, v129
    s_mov_b64 exec, 0xffffffff
    s_add_u32 m0, s88, 18432
    s_add_u32 s89, s97, 0
    buffer_load_dwordx4 v3, s[28:31], s89 offen  lds
    s_mov_b64 exec, -1
    v_fmac_f32 v134, v120, v129
    v_fmac_f32 v131, v118, v128
    v_fmac_f32 v132, v119, v128
    v_fmac_f32 v133, v120, v128
    s_add_u32 m0, s17, 8192
    s_add_u32 s89, s19, 196608
    buffer_load_dwordx4 v4, s[32:35], s89 offen  lds
    v_fmac_f32 v134, v121, v128
    v_fmac_f32 v131, v119, v127
    v_fmac_f32 v132, v120, v127
    v_fmac_f32 v133, v121, v127
    s_add_u32 m0, s17, 32768
    s_add_u32 s89, s19, 198656
    buffer_load_dwordx4 v4, s[32:35], s89 offen  lds
    v_fmac_f32 v134, v122, v127
    v_mul_f32 v131, v131, v123
    v_mul_f32 v132, v132, v124
    v_mul_f32 v133, v133, v125
    v_mul_f32 v134, v134, v126
    s_add_u32 m0, s17, 57344
    s_add_u32 s89, s19, 200704
    buffer_load_dwordx4 v4, s[32:35], s89 offen  lds
    v_cvt_pk_bf16_f32 v114, v134, v133
    v_cvt_pk_bf16_f32 v115, v132, v131
    v_and_b32 v116, 0xffff0000, v43
    v_and_b32 v117, 0xffff0000, v47
    s_add_u32 s97, s98, 10
    s_and_b32 s97, s97, 15
    s_lshr_b32 s99, s97, 3
    s_xor_b32 s97, s97, s99
    s_lshl_b32 s97, s97, 7
    s_add_u32 m0, s87, 36864
    s_add_u32 s89, s97, 0
    buffer_load_dwordx4 v2, s[28:31], s89 offen  lds
    v_and_b32 v118, 0xffff0000, v51
    v_and_b32 v119, 0xffff0000, v55
    v_and_b32 v120, 0xffff0000, v59
    v_and_b32 v121, 0xffff0000, v63
    s_mul_i32 s99, s97, 3072
    s_sub_u32 s19, s99, s18
    s_add_u32 s99, s99, s18
    s_add_u32 m0, s16, 16384
    s_add_u32 s89, s99, 0
    buffer_load_dwordx4 v4, s[32:35], s89 offen  lds
    v_and_b32 v122, 0xffff0000, v67
    v_lshlrev_b32 v127, 16, v98
    v_and_b32 v128, 0xffff0000, v98
    v_lshlrev_b32 v129, 16, v99
    s_add_u32 m0, s87, 40960
    s_add_u32 s89, s97, 65536
    buffer_load_dwordx4 v2, s[28:31], s89 offen  lds
    v_and_b32 v130, 0xffff0000, v99
    v_and_b32 v123, 0xffff0000, v71
    v_and_b32 v124, 0xffff0000, v75
    v_and_b32 v125, 0xffff0000, v79
    v_and_b32 v126, 0xffff0000, v83
    s_add_u32 m0, s16, 40960
    s_add_u32 s89, s99, 2048
    buffer_load_dwordx4 v4, s[32:35], s89 offen  lds
    v_mul_f32 v131, v116, v130
    v_mul_f32 v132, v117, v130
    v_mul_f32 v133, v118, v130
    v_mul_f32 v134, v119, v130
    s_add_u32 m0, s87, 45056
    s_add_u32 s89, s97, 131072
    buffer_load_dwordx4 v2, s[28:31], s89 offen  lds
    v_fmac_f32 v131, v117, v129
    v_fmac_f32 v132, v118, v129
    v_fmac_f32 v133, v119, v129
    v_fmac_f32 v134, v120, v129
    s_add_u32 m0, s16, 65536
    s_add_u32 s89, s99, 4096
    buffer_load_dwordx4 v4, s[32:35], s89 offen  lds
    v_fmac_f32 v131, v118, v128
    v_fmac_f32 v132, v119, v128
    v_fmac_f32 v133, v120, v128
    v_fmac_f32 v134, v121, v128
    v_fmac_f32 v131, v119, v127
    s_add_u32 m0, s87, 49152
    s_add_u32 s89, s97, 196608
    buffer_load_dwordx4 v2, s[28:31], s89 offen  lds
    v_fmac_f32 v132, v120, v127
    v_fmac_f32 v133, v121, v127
    v_fmac_f32 v134, v122, v127
    v_mul_f32 v131, v131, v123
    s_mov_b64 exec, 0xffffffff
    s_add_u32 m0, s88, 36864
    s_add_u32 s89, s97, 0
    buffer_load_dwordx4 v3, s[28:31], s89 offen  lds
    s_mov_b64 exec, -1
    v_mul_f32 v132, v132, v124
    v_mul_f32 v133, v133, v125
    v_mul_f32 v134, v134, v126
    v_cvt_pk_bf16_f32 v112, v134, v133
    s_add_u32 m0, s17, 16384
    s_add_u32 s89, s19, 196608
    buffer_load_dwordx4 v4, s[32:35], s89 offen  lds
    v_cvt_pk_bf16_f32 v113, v132, v131
    v_permlane32_swap_b32 v114, v112
    s_nop 0
    v_permlane32_swap_b32 v115, v113
    s_mov_b32 s89, 49152
    buffer_store_dwordx4 v[112:115], v12, s[52:55], s89 offen sc1
    s_waitcnt vmcnt(10)
    s_barrier
    s_add_u32 m0, s17, 40960
    s_add_u32 s89, s19, 198656
    buffer_load_dwordx4 v4, s[32:35], s89 offen  lds
    v_add_u32 v5, s94, v15
    ds_read_b128 v[140:143], v5 offset:32
    s_add_u32 m0, s17, 65536
    s_add_u32 s89, s19, 200704
    buffer_load_dwordx4 v4, s[32:35], s89 offen  lds
    ds_read_b32 v156, v5 offset:48
    s_add_u32 s97, s98, 11
    s_and_b32 s97, s97, 15
    s_lshr_b32 s99, s97, 3
    s_xor_b32 s97, s97, s99
    s_lshl_b32 s97, s97, 7
    s_add_u32 m0, s87, 0
    s_add_u32 s89, s97, 0
    buffer_load_dwordx4 v2, s[28:31], s89 offen  lds
    ds_read_b128 v[144:147], v5 offset:1056
    s_mul_i32 s99, s97, 3072
    s_sub_u32 s19, s99, s18
    s_add_u32 s99, s99, s18
    s_add_u32 m0, s16, 0
    s_add_u32 s89, s99, 0
    buffer_load_dwordx4 v4, s[32:35], s89 offen  lds
    ds_read_b32 v157, v5 offset:1072
    s_add_u32 m0, s87, 4096
    s_add_u32 s89, s97, 65536
    buffer_load_dwordx4 v2, s[28:31], s89 offen  lds
    ds_read_b128 v[148:151], v5 offset:2080
    s_add_u32 m0, s16, 24576
    s_add_u32 s89, s99, 2048
    buffer_load_dwordx4 v4, s[32:35], s89 offen  lds
    ds_read_b32 v158, v5 offset:2096
    s_add_u32 m0, s87, 8192
    s_add_u32 s89, s97, 131072
    buffer_load_dwordx4 v2, s[28:31], s89 offen  lds
    ds_read_b128 v[152:155], v5 offset:3104
    ds_read_b32 v159, v5 offset:3120
    s_add_u32 m0, s16, 49152
    s_add_u32 s89, s99, 4096
    buffer_load_dwordx4 v4, s[32:35], s89 offen  lds
    v_lshrrev_b32 v6, 3, v0
    s_add_u32 m0, s87, 12288
    s_add_u32 s89, s97, 196608
    buffer_load_dwordx4 v2, s[28:31], s89 offen  lds
    v_mul_u32_u24 v6, 4160, v6
    s_mov_b64 exec, 0xffffffff
    s_add_u32 m0, s88, 0
    s_add_u32 s89, s97, 0
    buffer_load_dwordx4 v3, s[28:31], s89 offen  lds
    s_mov_b64 exec, -1
    v_and_b32 v7, 7, v0
    s_add_u32 m0, s17, 0
    s_add_u32 s89, s19, 196608
    buffer_load_dwordx4 v4, s[32:35], s89 offen  lds
    v_lshl_add_u32 v6, v7, 2, v6
    s_add_u32 m0, s17, 24576
    s_add_u32 s89, s19, 198656
    buffer_load_dwordx4 v4, s[32:35], s89 offen  lds
    v_add_u32 v6, s94, v6
    s_add_u32 m0, s17, 49152
    s_add_u32 s89, s19, 200704
    buffer_load_dwordx4 v4, s[32:35], s89 offen  lds
    v_mov_b32 v7, 0
    s_waitcnt vmcnt(11)
    s_barrier
    buffer_load_dword v230, v229, s[64:67], 0 offen
    s_waitcnt lgkmcnt(0)
    v_readfirstlane_b32 s93, v140
    s_nop 0
    s_lshl_b32 s93, s93, 16
    s_add_u32 s97, s98, 12
    s_and_b32 s97, s97, 15
    s_lshr_b32 s99, s97, 3
    s_xor_b32 s97, s97, s99
    s_lshl_b32 s97, s97, 7
    s_add_u32 m0, s87, 18432
    s_add_u32 s89, s97, 0
    buffer_load_dwordx4 v2, s[28:31], s89 offen  lds
    v_writelane_b32 v7, s93, 15
    v_alignbit_b32 v140, v141, v140, 16
    s_mul_i32 s99, s97, 3072
    s_sub_u32 s19, s99, s18
    s_add_u32 s99, s99, s18
    s_add_u32 m0, s16, 8192
    s_add_u32 s89, s99, 0
    buffer_load_dwordx4 v4, s[32:35], s89 offen  lds
    v_alignbit_b32 v141, v142, v141, 16
    v_alignbit_b32 v142, v143, v142, 16
    s_add_u32 m0, s87, 22528
    s_add_u32 s89, s97, 65536
    buffer_load_dwordx4 v2, s[28:31], s89 offen  lds
    v_alignbit_b32 v143, v156, v143, 16
    v_alignbit_b32 v144, v145, v144, 16
    s_add_u32 m0, s16, 32768
    s_add_u32 s89, s99, 2048
    buffer_load_dwordx4 v4, s[32:35], s89 offen  lds
    v_alignbit_b32 v145, v146, v145, 16
    v_alignbit_b32 v146, v147, v146, 16
    s_add_u32 m0, s87, 26624
    s_add_u32 s89, s97, 131072
    buffer_load_dwordx4 v2, s[28:31], s89 offen  lds
    v_alignbit_b32 v147, v157, v147, 16
    v_alignbit_b32 v148, v149, v148, 16
    s_add_u32 m0, s16, 57344
    s_add_u32 s89, s99, 4096
    buffer_load_dwordx4 v4, s[32:35], s89 offen  lds
    v_alignbit_b32 v149, v150, v149, 16
    v_alignbit_b32 v150, v151, v150, 16
    s_add_u32 m0, s87, 30720
    s_add_u32 s89, s97, 196608
    buffer_load_dwordx4 v2, s[28:31], s89 offen  lds
    v_alignbit_b32 v151, v158, v151, 16
    v_alignbit_b32 v152, v153, v152, 16
    s_mov_b64 exec, 0xffffffff
    s_add_u32 m0, s88, 18432
    s_add_u32 s89, s97, 0
    buffer_load_dwordx4 v3, s[28:31], s89 offen  lds
    s_mov_b64 exec, -1
    v_alignbit_b32 v153, v154, v153, 16
    v_alignbit_b32 v154, v155, v154, 16
    s_add_u32 m0, s17, 8192
    s_add_u32 s89, s19, 196608
    buffer_load_dwordx4 v4, s[32:35], s89 offen  lds
    v_alignbit_b32 v155, v159, v155, 16
    v_lshlrev_b32 v8, 3, v0
    s_add_u32 m0, s17, 32768
    s_add_u32 s89, s19, 198656
    buffer_load_dwordx4 v4, s[32:35], s89 offen  lds
    s_add_u32 s78, s88, 18432
    v_add_u32 v8, s78, v8
    s_add_u32 m0, s17, 57344
    s_add_u32 s89, s19, 200704
    buffer_load_dwordx4 v4, s[32:35], s89 offen  lds
    v_mov_b32 v156, 0
    v_mov_b32 v157, 0
    s_waitcnt vmcnt(12)
    s_barrier
    s_add_u32 s97, s98, 14
    s_and_b32 s97, s97, 15
    s_lshr_b32 s99, s97, 3
    s_xor_b32 s97, s97, s99
    s_lshl_b32 s97, s97, 7
    s_add_u32 m0, s87, 36864
    s_add_u32 s89, s97, 0
    buffer_load_dwordx4 v2, s[28:31], s89 offen  lds
    s_mul_i32 s99, s97, 3072
    s_sub_u32 s19, s99, s18
    s_add_u32 s99, s99, s18
    s_add_u32 m0, s16, 16384
    s_add_u32 s89, s99, 0
    buffer_load_dwordx4 v4, s[32:35], s89 offen  lds
    s_add_u32 m0, s87, 40960
    s_add_u32 s89, s97, 65536
    buffer_load_dwordx4 v2, s[28:31], s89 offen  lds
    s_add_u32 m0, s16, 40960
    s_add_u32 s89, s99, 2048
    buffer_load_dwordx4 v4, s[32:35], s89 offen  lds
    s_add_u32 m0, s87, 45056
    s_add_u32 s89, s97, 131072
    buffer_load_dwordx4 v2, s[28:31], s89 offen  lds
    s_add_u32 m0, s16, 65536
    s_add_u32 s89, s99, 4096
    buffer_load_dwordx4 v4, s[32:35], s89 offen  lds
    s_add_u32 m0, s87, 49152
    s_add_u32 s89, s97, 196608
    buffer_load_dwordx4 v2, s[28:31], s89 offen  lds
    s_mov_b64 exec, 0xffffffff
    s_add_u32 m0, s88, 36864
    s_add_u32 s89, s97, 0
    buffer_load_dwordx4 v3, s[28:31], s89 offen  lds
    s_mov_b64 exec, -1
    s_add_u32 m0, s17, 16384
    s_add_u32 s89, s19, 196608
    buffer_load_dwordx4 v4, s[32:35], s89 offen  lds
    s_add_u32 m0, s17, 40960
    s_add_u32 s89, s19, 198656
    buffer_load_dwordx4 v4, s[32:35], s89 offen  lds
    s_add_u32 m0, s17, 65536
    s_add_u32 s89, s19, 200704
    buffer_load_dwordx4 v4, s[32:35], s89 offen  lds
    s_waitcnt vmcnt(11)
    s_barrier
    s_add_u32 s97, s98, 15
    s_and_b32 s97, s97, 15
    s_lshr_b32 s99, s97, 3
    s_xor_b32 s97, s97, s99
    s_lshl_b32 s97, s97, 7
    s_add_u32 m0, s87, 0
    s_add_u32 s89, s97, 0
    buffer_load_dwordx4 v2, s[28:31], s89 offen  lds
    s_mul_i32 s99, s97, 3072
    s_sub_u32 s19, s99, s18
    s_add_u32 s99, s99, s18
    s_add_u32 m0, s16, 0
    s_add_u32 s89, s99, 0
    buffer_load_dwordx4 v4, s[32:35], s89 offen  lds
    s_add_u32 m0, s87, 4096
    s_add_u32 s89, s97, 65536
    buffer_load_dwordx4 v2, s[28:31], s89 offen  lds
    s_add_u32 m0, s16, 24576
    s_add_u32 s89, s99, 2048
    buffer_load_dwordx4 v4, s[32:35], s89 offen  lds
    s_add_u32 m0, s87, 8192
    s_add_u32 s89, s97, 131072
    buffer_load_dwordx4 v2, s[28:31], s89 offen  lds
    s_add_u32 m0, s16, 49152
    s_add_u32 s89, s99, 4096
    buffer_load_dwordx4 v4, s[32:35], s89 offen  lds
    s_add_u32 m0, s87, 12288
    s_add_u32 s89, s97, 196608
    buffer_load_dwordx4 v2, s[28:31], s89 offen  lds
    s_mov_b64 exec, 0xffffffff
    s_add_u32 m0, s88, 0
    s_add_u32 s89, s97, 0
    buffer_load_dwordx4 v3, s[28:31], s89 offen  lds
    s_mov_b64 exec, -1
    s_add_u32 m0, s17, 0
    s_add_u32 s89, s19, 196608
    buffer_load_dwordx4 v4, s[32:35], s89 offen  lds
    s_add_u32 m0, s17, 24576
    s_add_u32 s89, s19, 198656
    buffer_load_dwordx4 v4, s[32:35], s89 offen  lds
    s_add_u32 m0, s17, 49152
    s_add_u32 s89, s19, 200704
    buffer_load_dwordx4 v4, s[32:35], s89 offen  lds
    s_mov_b64 exec, 0xff
    buffer_load_dword v136, v33, s[68:71], 0 offen sc1
    buffer_load_dword v137, v34, s[52:55], 0 offen sc1
    s_mov_b64 exec, -1
    s_waitcnt vmcnt(13)
    s_barrier
    s_waitcnt vmcnt(0)
    s_branch LA_j
LA_c2:
    s_add_u32 s97, s98, 2
    s_and_b32 s97, s97, 15
    s_lshr_b32 s99, s97, 3
    s_xor_b32 s97, s97, s99
    s_lshl_b32 s97, s97, 7
    s_add_u32 m0, s87, 0
    s_add_u32 s89, s97, 0
    buffer_load_dwordx4 v2, s[28:31], s89 offen  lds
    s_mul_i32 s99, s97, 3072
    s_sub_u32 s19, s99, s18
    s_add_u32 s99, s99, s18
    s_add_u32 m0, s16, 0
    s_add_u32 s89, s99, 0
    buffer_load_dwordx4 v4, s[32:35], s89 offen  lds
    s_add_u32 m0, s87, 4096
    s_add_u32 s89, s97, 65536
    buffer_load_dwordx4 v2, s[28:31], s89 offen  lds
    s_add_u32 m0, s16, 24576
    s_add_u32 s89, s99, 2048
    buffer_load_dwordx4 v4, s[32:35], s89 offen  lds
    s_add_u32 m0, s87, 8192
    s_add_u32 s89, s97, 131072
    buffer_load_dwordx4 v2, s[28:31], s89 offen  lds
    s_add_u32 m0, s16, 49152
    s_add_u32 s89, s99, 4096
    buffer_load_dwordx4 v4, s[32:35], s89 offen  lds
    s_add_u32 m0, s87, 12288
    s_add_u32 s89, s97, 196608
    buffer_load_dwordx4 v2, s[28:31], s89 offen  lds
    s_mov_b64 exec, 0xffffffff
    s_add_u32 m0, s88, 0
    s_add_u32 s89, s97, 0
    buffer_load_dwordx4 v3, s[28:31], s89 offen  lds
    s_mov_b64 exec, -1
    s_add_u32 m0, s17, 0
    s_add_u32 s89, s19, 196608
    buffer_load_dwordx4 v4, s[32:35], s89 offen  lds
    s_mov_b32 s36, s6
    s_mov_b32 s37, s7
    s_mov_b32 s38, 0x400000
    s_mov_b32 s39, 0x20000
    s_mov_b32 s40, s8
    s_mov_b32 s41, s9
    s_mov_b32 s42, 0x400000
    s_mov_b32 s43, 0x20000
    s_mov_b32 s44, s10
    s_mov_b32 s45, s11
    s_mov_b32 s46, 0x2000
    s_mov_b32 s47, 0x20000
    s_mov_b32 s48, s12
    s_mov_b32 s49, s13
    s_mov_b32 s50, 0x400000
    s_mov_b32 s51, 0x20000
    s_mov_b32 s52, s26
    s_mov_b32 s53, s27
    s_mov_b32 s54, 0x1000000
    s_mov_b32 s55, 0x20000
    s_mov_b32 s56, s4
    s_mov_b32 s57, s5
    s_mov_b32 s58, 0x400000
    s_mov_b32 s59, 0x20000
    s_mov_b32 s60, s22
    s_mov_b32 s61, s23
    s_mov_b32 s62, 0x800000
    s_mov_b32 s63, 0x20000
    s_mov_b32 s64, s20
    s_mov_b32 s65, s21
    s_mov_b32 s66, 0x200000
    s_add_u32 m0, s17, 24576
    s_add_u32 s89, s19, 198656
    buffer_load_dwordx4 v4, s[32:35], s89 offen  lds
    s_mov_b32 s67, 0x20000
    s_mov_b32 s68, s24
    s_mov_b32 s69, s25
    s_mov_b32 s70, 0x100
    s_mov_b32 s71, 0x20000
    v_and_b32 v7, 7, v0
    s_lshl_b32 s79, s74, 7
    v_lshl_add_u32 v7, v7, 4, s79
    s_lshl_b32 s78, s75, 7
    s_lshl_b32 s80, s3, 3
    s_add_u32 s80, s80, s78
    v_lshrrev_b32 v5, 3, v0
    s_and_b32 s79, s3, 1
    v_xor_b32 v5, s79, v5
    v_add_u32 v5, s80, v5
    v_lshl_add_u32 v10, v5, 11, v7
    s_xor_b32 s80, s3, 1
    s_add_u32 s80, s78, s80
    s_sub_u32 s80, s80, 4
    s_lshl_b32 s80, s80, 11
    v_add_u32 v11, s80, v7
    v_bfe_u32 v5, v0, 3, 2
    v_lshrrev_b32 v6, 5, v0
    s_lshl_b32 s80, s3, 5
    v_lshlrev_b32 v8, 3, v5
    v_lshl_add_u32 v8, v6, 2, v8
    v_add_u32 v8, s80, v8
    v_and_b32 v35, 7, v0
    v_lshlrev_b32 v16, 4, v35
    v_lshl_add_u32 v16, v8, 7, v16
    s_add_u32 m0, s17, 49152
    s_add_u32 s89, s19, 200704
    buffer_load_dwordx4 v4, s[32:35], s89 offen  lds
    v_add_u32 v232, 129024, v16
    v_and_b32 v231, 1, v5
    v_lshl_add_u32 v16, v231, 7, v232
    v_xor_b32 v233, v231, v6
    v_xor_b32 v233, 1, v233
    v_lshl_add_u32 v232, v233, 7, v232
    v_xor_b32 v231, 128, v16
    v_xor_b32 v233, 128, v232
    v_lshrrev_b32 v33, 2, v35
    v_lshlrev_b32 v35, 6, v35
    v_lshl_add_u32 v35, v33, 4, v35
    v_add_u32 v35, 162816, v35
    v_add_u32 v8, s78, v8
    v_lshl_add_u32 v9, v8, 11, v7
    v_lshl_add_u32 v13, v8, 12, v7
    v_bfe_u32 v8, v0, 2, 1
    v_lshlrev_b32 v8, 1, v8
    v_add_u32 v8, v8, v6
    v_lshlrev_b32 v8, 16, v8
    v_lshl_add_u32 v8, v5, 6, v8
    v_and_b32 v7, 3, v0
    v_lshl_add_u32 v8, v7, 4, v8
    s_add_u32 s78, s78, s80
    s_lshl_b32 s78, s78, 3
    s_lshl_b32 s79, s74, 18
    s_add_u32 s78, s78, s79
    v_add_u32 v12, s78, v8
    s_lshl_b32 s91, s74, 4
    s_add_u32 s91, s91, s75
    s_lshr_b32 s78, s91, 3
    s_lshl_b32 s78, s78, 5
    s_add_u32 s97, s98, 0
    s_and_b32 s97, s97, 15
    s_lshr_b32 s99, s97, 3
    s_xor_b32 s97, s97, s99
    s_lshl_b32 s97, s97, 7
    s_add_u32 m0, s87, 18432
    s_add_u32 s89, s97, 0
    buffer_load_dwordx4 v2, s[28:31], s89 offen  lds
    s_and_b32 s79, s91, 7
    s_add_u32 s78, s78, s79
    s_lshl_b32 s79, s3, 3
    s_add_u32 s90, s78, s79
    s_lshl_b32 s91, s91, 14
    s_lshr_b32 s78, s90, 1
    s_lshl_b32 s78, s78, 2
    s_load_dword s92, s[14:15], s78
    s_mul_i32 s94, s3, 8320
    s_add_u32 s94, s94, 129024
    s_lshl_b32 s95, s3, 14
    s_mov_b32 s96, 4096
    s_and_b32 s100, s76, 3
    s_lshl_b32 s100, s100, 19
    v_bfe_u32 v5, v0, 2, 2
    v_lshlrev_b32 v5, 1, v5
    v_lshl_add_u32 v5, v6, 3, v5
    v_bfe_u32 v8, v0, 4, 1
    v_add_u32 v5, v5, v8
    s_and_b32 s78, s3, 1
    s_lshl_b32 s78, s78, 1
    v_add_u32 v8, s78, v6
    v_xor_b32 v8, v8, v7
    v_lshlrev_b32 v8, 4, v8
    v_lshl_add_u32 v5, v5, 6, v8
    v_add_u32 v14, s86, v5
    v_lshlrev_b32 v15, 4, v0
    v_lshrrev_b32 v5, 4, v0
    v_lshlrev_b32 v5, 1, v5
    v_and_b32 v8, 7, v0
    s_mul_i32 s99, s97, 3072
    s_sub_u32 s19, s99, s18
    s_add_u32 s99, s99, s18
    s_add_u32 m0, s16, 8192
    s_add_u32 s89, s99, 0
    buffer_load_dwordx4 v4, s[32:35], s89 offen  lds
    v_xor_b32 v5, v5, v8
    v_lshlrev_b32 v5, 4, v5
    v_lshrrev_b32 v8, 3, v0
    v_lshl_add_u32 v5, v8, 11, v5
    s_lshl_b32 s78, s77, 7
    v_add_u32 v17, s78, v5
    v_add_u32 v228, s95, v17
    s_lshr_b32 s78, s2, 3
    s_lshl_b32 s78, s78, 16
    s_add_u32 s78, s78, s95
    s_and_b32 s79, s77, 8
    s_lshl_b32 s79, s79, 7
    s_add_u32 s78, s78, s79
    v_and_b32 v5, 7, v0
    v_lshlrev_b32 v5, 7, v5
    v_lshl_add_u32 v5, v8, 11, v5
    v_add_u32 v229, s78, v5
    v_mov_b32 v18, 162304
    v_mov_b32 v19, 1
    v_and_b32 v5, 3, v0
    s_lshl_b32 s78, s74, 4
    s_add_u32 s78, s78, s3
    v_lshl_add_u32 v6, v5, 2, s78
    s_lshr_b32 s78, s76, 3
    s_lshl_b32 s79, s3, 1
    s_add_u32 s78, s78, s79
    s_xor_b32 s78, s78, 2
    s_lshl_b32 s78, s78, 5
    s_and_b32 s79, s76, 7
    s_add_u32 s78, s78, s79
    v_lshl_add_u32 v7, v5, 3, s78
    s_add_u32 m0, s87, 22528
    s_add_u32 s89, s97, 65536
    buffer_load_dwordx4 v2, s[28:31], s89 offen  lds
    v_and_b32 v8, 4, v0
    v_cmp_eq_u32 vcc, 0, v8
    s_nop 1
    v_cndmask_b32 v6, v7, v6, vcc
    v_and_b32 v33, 0xf0, v6
    v_lshlrev_b32 v34, 8, v6
    v_add_u32 v34, 12582912, v34
    v_and_b32 v5, 15, v0
    v_lshrrev_b32 v6, 4, v0
    v_add_u32 v7, 9, v5
    v_and_b32 v8, 1, v7
    v_mul_u32_u24 v8, 4160, v8
    v_lshrrev_b32 v7, 1, v7
    v_lshl_add_u32 v8, v7, 2, v8
    v_lshlrev_b32 v7, 4, v6
    v_sub_u32 v8, v8, v7
    s_add_u32 s78, s94, 32
    v_add_u32 v21, s78, v8
    v_add_u32 v22, 1024, v21
    v_add_u32 v23, 2048, v21
    v_add_u32 v24, 3072, v21
    v_lshl_add_u32 v7, v5, 1, v6
    v_add_u32 v7, 30, v7
    v_lshrrev_b32 v8, 3, v7
    v_and_b32 v25, 3, v8
    v_xor_b32 v25, s3, v25
    v_lshl_add_u32 v25, v8, 5, v25
    v_and_b32 v8, 1, v7
    v_lshl_add_u32 v25, v8, 4, v25
    v_bfe_u32 v8, v7, 1, 2
    v_lshl_add_u32 v25, v8, 2, v25
    s_add_u32 m0, s16, 32768
    s_add_u32 s89, s99, 2048
    buffer_load_dwordx4 v4, s[32:35], s89 offen  lds
    v_lshlrev_b32 v25, 4, v25
    v_add_u32 v25, 92160, v25
    v_lshl_add_u32 v7, v5, 1, v6
    v_add_u32 v7, 26, v7
    v_lshrrev_b32 v8, 3, v7
    v_and_b32 v26, 3, v8
    v_xor_b32 v26, s3, v26
    v_lshl_add_u32 v26, v8, 5, v26
    v_and_b32 v8, 1, v7
    v_lshl_add_u32 v26, v8, 4, v26
    v_bfe_u32 v8, v7, 1, 2
    v_lshl_add_u32 v26, v8, 2, v26
    v_lshlrev_b32 v26, 4, v26
    v_add_u32 v26, 92160, v26
    v_lshl_add_u32 v7, v5, 1, v6
    v_add_u32 v7, 22, v7
    v_lshrrev_b32 v8, 3, v7
    v_and_b32 v27, 3, v8
    v_xor_b32 v27, s3, v27
    v_lshl_add_u32 v27, v8, 5, v27
    v_and_b32 v8, 1, v7
    v_lshl_add_u32 v27, v8, 4, v27
    v_bfe_u32 v8, v7, 1, 2
    v_lshl_add_u32 v27, v8, 2, v27
    v_lshlrev_b32 v27, 4, v27
    v_add_u32 v27, 92160, v27
    v_lshl_add_u32 v7, v5, 1, v6
    v_add_u32 v7, 18, v7
    v_lshrrev_b32 v8, 3, v7
    v_and_b32 v28, 3, v8
    v_xor_b32 v28, s3, v28
    s_add_u32 m0, s87, 26624
    s_add_u32 s89, s97, 131072
    buffer_load_dwordx4 v2, s[28:31], s89 offen  lds
    v_lshl_add_u32 v28, v8, 5, v28
    v_and_b32 v8, 1, v7
    v_lshl_add_u32 v28, v8, 4, v28
    v_bfe_u32 v8, v7, 1, 2
    v_lshl_add_u32 v28, v8, 2, v28
    v_lshlrev_b32 v28, 4, v28
    v_add_u32 v28, 92160, v28
    v_lshl_add_u32 v7, v5, 1, v6
    v_add_u32 v7, 14, v7
    v_lshrrev_b32 v8, 3, v7
    v_and_b32 v29, 3, v8
    v_xor_b32 v29, s3, v29
    v_lshl_add_u32 v29, v8, 5, v29
    v_and_b32 v8, 1, v7
    v_lshl_add_u32 v29, v8, 4, v29
    v_bfe_u32 v8, v7, 1, 2
    v_lshl_add_u32 v29, v8, 2, v29
    v_lshlrev_b32 v29, 4, v29
    v_add_u32 v29, 92160, v29
    v_lshl_add_u32 v7, v5, 1, v6
    v_add_u32 v7, 10, v7
    v_lshrrev_b32 v8, 3, v7
    v_and_b32 v30, 3, v8
    v_xor_b32 v30, s3, v30
    v_lshl_add_u32 v30, v8, 5, v30
    v_and_b32 v8, 1, v7
    v_lshl_add_u32 v30, v8, 4, v30
    v_bfe_u32 v8, v7, 1, 2
    v_lshl_add_u32 v30, v8, 2, v30
    v_lshlrev_b32 v30, 4, v30
    s_add_u32 m0, s16, 57344
    s_add_u32 s89, s99, 4096
    buffer_load_dwordx4 v4, s[32:35], s89 offen  lds
    v_add_u32 v30, 92160, v30
    v_lshl_add_u32 v7, v5, 1, v6
    v_add_u32 v7, 6, v7
    v_lshrrev_b32 v8, 3, v7
    v_and_b32 v31, 3, v8
    v_xor_b32 v31, s3, v31
    v_lshl_add_u32 v31, v8, 5, v31
    v_and_b32 v8, 1, v7
    v_lshl_add_u32 v31, v8, 4, v31
    v_bfe_u32 v8, v7, 1, 2
    v_lshl_add_u32 v31, v8, 2, v31
    v_lshlrev_b32 v31, 4, v31
    v_add_u32 v31, 92160, v31
    v_lshl_add_u32 v7, v5, 1, v6
    v_add_u32 v7, 2, v7
    v_lshrrev_b32 v8, 3, v7
    v_and_b32 v32, 3, v8
    v_xor_b32 v32, s3, v32
    v_lshl_add_u32 v32, v8, 5, v32
    v_and_b32 v8, 1, v7
    v_lshl_add_u32 v32, v8, 4, v32
    v_bfe_u32 v8, v7, 1, 2
    v_lshl_add_u32 v32, v8, 2, v32
    v_lshlrev_b32 v32, 4, v32
    v_add_u32 v32, 92160, v32
    v_lshrrev_b32 v7, 1, v6
    v_lshl_add_u32 v7, v5, 1, v7
    v_add_u32 v7, 32, v7
    v_lshrrev_b32 v8, 3, v7
    v_and_b32 v20, 3, v8
    v_xor_b32 v20, s3, v20
    s_add_u32 m0, s87, 30720
    s_add_u32 s89, s97, 196608
    buffer_load_dwordx4 v2, s[28:31], s89 offen  lds
    v_lshl_add_u32 v20, v8, 5, v20
    v_and_b32 v8, 1, v7
    v_lshl_add_u32 v20, v8, 4, v20
    v_bfe_u32 v8, v7, 1, 2
    v_lshl_add_u32 v20, v8, 2, v20
    v_lshlrev_b32 v20, 4, v20
    v_add_u32 v20, 92160, v20
    v_and_b32 v8, 1, v6
    v_xor_b32 v8, 1, v8
    v_lshl_add_u32 v20, v8, 3, v20
    s_waitcnt lgkmcnt(0)
    s_and_b32 s78, s92, 0xffff0000
    s_lshl_b32 s92, s92, 16
    s_bitcmp1_b32 s90, 0
    s_cselect_b32 s92, s78, s92
    v_lshlrev_b32 v7, 3, v6
    v_sub_u32 v7, v7, v5
    v_subrev_u32 v7, 9, v7
    v_and_b32 v8, 1, v7
    v_xor_b32 v8, 1, v8
    v_lshlrev_b32 v8, 4, v8
    v_lshrrev_b32 v8, v8, s92
    v_ashrrev_i32 v7, 1, v7
    v_cmp_eq_u32 vcc, 0, v7
    s_nop 1
    v_cndmask_b32 v236, 0, v8, vcc
    v_cmp_eq_u32 vcc, 1, v7
    s_nop 1
    v_cndmask_b32 v237, 0, v8, vcc
    v_cmp_eq_u32 vcc, 2, v7
    s_nop 1
    v_cndmask_b32 v238, 0, v8, vcc
    v_cmp_eq_u32 vcc, 3, v7
    s_nop 1
    v_cndmask_b32 v239, 0, v8, vcc
    s_waitcnt vmcnt(7)
    s_barrier
    s_mov_b64 exec, 0xffffffff
    s_add_u32 m0, s88, 18432
    s_add_u32 s89, s97, 0
    buffer_load_dwordx4 v3, s[28:31], s89 offen  lds
    s_mov_b64 exec, -1
    s_add_u32 m0, s17, 8192
    s_add_u32 s89, s19, 196608
    buffer_load_dwordx4 v4, s[32:35], s89 offen  lds
    s_add_u32 m0, s17, 32768
    s_add_u32 s89, s19, 198656
    buffer_load_dwordx4 v4, s[32:35], s89 offen  lds
    s_add_u32 m0, s17, 57344
    s_add_u32 s89, s19, 200704
    buffer_load_dwordx4 v4, s[32:35], s89 offen  lds
    s_add_u32 s97, s98, 1
    s_and_b32 s97, s97, 15
    s_lshr_b32 s99, s97, 3
    s_xor_b32 s97, s97, s99
    s_lshl_b32 s97, s97, 7
    s_add_u32 m0, s87, 36864
    s_add_u32 s89, s97, 0
    buffer_load_dwordx4 v2, s[28:31], s89 offen  lds
    s_mul_i32 s99, s97, 3072
    s_sub_u32 s19, s99, s18
    s_add_u32 s99, s99, s18
    s_add_u32 m0, s16, 16384
    s_add_u32 s89, s99, 0
    buffer_load_dwordx4 v4, s[32:35], s89 offen  lds
    s_add_u32 m0, s87, 40960
    s_add_u32 s89, s97, 65536
    buffer_load_dwordx4 v2, s[28:31], s89 offen  lds
    s_add_u32 m0, s16, 40960
    s_add_u32 s89, s99, 2048
    buffer_load_dwordx4 v4, s[32:35], s89 offen  lds
    s_add_u32 m0, s87, 45056
    s_add_u32 s89, s97, 131072
    buffer_load_dwordx4 v2, s[28:31], s89 offen  lds
    s_add_u32 m0, s16, 65536
    s_add_u32 s89, s99, 4096
    buffer_load_dwordx4 v4, s[32:35], s89 offen  lds
    s_add_u32 m0, s87, 49152
    s_add_u32 s89, s97, 196608
    buffer_load_dwordx4 v2, s[28:31], s89 offen  lds
    s_mov_b64 exec, 0xffffffff
    s_add_u32 m0, s88, 36864
    s_add_u32 s89, s97, 0
    buffer_load_dwordx4 v3, s[28:31], s89 offen  lds
    s_mov_b64 exec, -1
    s_add_u32 m0, s17, 16384
    s_add_u32 s89, s19, 196608
    buffer_load_dwordx4 v4, s[32:35], s89 offen  lds
    s_add_u32 m0, s17, 40960
    s_add_u32 s89, s19, 198656
    buffer_load_dwordx4 v4, s[32:35], s89 offen  lds
    s_waitcnt vmcnt(10)
    s_barrier
    s_add_u32 m0, s17, 65536
    s_add_u32 s89, s19, 200704
    buffer_load_dwordx4 v4, s[32:35], s89 offen  lds
    s_add_u32 s97, s98, 6
    s_and_b32 s97, s97, 15
    s_lshr_b32 s99, s97, 3
    s_xor_b32 s97, s97, s99
    s_lshl_b32 s97, s97, 7
    s_add_u32 m0, s87, 0
    s_add_u32 s89, s97, 0
    buffer_load_dwordx4 v2, s[28:31], s89 offen  lds
    s_mul_i32 s99, s97, 3072
    s_sub_u32 s19, s99, s18
    s_add_u32 s99, s99, s18
    s_add_u32 m0, s16, 0
    s_add_u32 s89, s99, 0
    buffer_load_dwordx4 v4, s[32:35], s89 offen  lds
    s_add_u32 m0, s87, 4096
    s_add_u32 s89, s97, 65536
    buffer_load_dwordx4 v2, s[28:31], s89 offen  lds
    s_add_u32 m0, s16, 24576
    s_add_u32 s89, s99, 2048
    buffer_load_dwordx4 v4, s[32:35], s89 offen  lds
    s_add_u32 m0, s87, 8192
    s_add_u32 s89, s97, 131072
    buffer_load_dwordx4 v2, s[28:31], s89 offen  lds
    s_add_u32 m0, s16, 49152
    s_add_u32 s89, s99, 4096
    buffer_load_dwordx4 v4, s[32:35], s89 offen  lds
    s_add_u32 m0, s87, 12288
    s_add_u32 s89, s97, 196608
    buffer_load_dwordx4 v2, s[28:31], s89 offen  lds
    s_mov_b64 exec, 0xffffffff
    s_add_u32 m0, s88, 0
    s_add_u32 s89, s97, 0
    buffer_load_dwordx4 v3, s[28:31], s89 offen  lds
    s_mov_b64 exec, -1
    s_add_u32 m0, s17, 0
    s_add_u32 s89, s19, 196608
    buffer_load_dwordx4 v4, s[32:35], s89 offen  lds
    s_add_u32 m0, s17, 24576
    s_add_u32 s89, s19, 198656
    buffer_load_dwordx4 v4, s[32:35], s89 offen  lds
    s_add_u32 m0, s17, 49152
    s_add_u32 s89, s19, 200704
    buffer_load_dwordx4 v4, s[32:35], s89 offen  lds
    s_waitcnt vmcnt(11)
    s_barrier
    s_add_u32 s97, s98, 3
    s_and_b32 s97, s97, 15
    s_lshr_b32 s99, s97, 3
    s_xor_b32 s97, s97, s99
    s_lshl_b32 s97, s97, 7
    s_add_u32 m0, s87, 18432
    s_add_u32 s89, s97, 0
    buffer_load_dwordx4 v2, s[28:31], s89 offen  lds
    s_mul_i32 s99, s97, 3072
    s_sub_u32 s19, s99, s18
    s_add_u32 s99, s99, s18
    s_add_u32 m0, s16, 8192
    s_add_u32 s89, s99, 0
    buffer_load_dwordx4 v4, s[32:35], s89 offen  lds
    s_add_u32 m0, s87, 22528
    s_add_u32 s89, s97, 65536
    buffer_load_dwordx4 v2, s[28:31], s89 offen  lds
    s_add_u32 m0, s16, 32768
    s_add_u32 s89, s99, 2048
    buffer_load_dwordx4 v4, s[32:35], s89 offen  lds
    s_add_u32 m0, s87, 26624
    s_add_u32 s89, s97, 131072
    buffer_load_dwordx4 v2, s[28:31], s89 offen  lds
    s_add_u32 m0, s16, 57344
    s_add_u32 s89, s99, 4096
    buffer_load_dwordx4 v4, s[32:35], s89 offen  lds
    s_add_u32 m0, s87, 30720
    s_add_u32 s89, s97, 196608
    buffer_load_dwordx4 v2, s[28:31], s89 offen  lds
    s_mov_b64 exec, 0xffffffff
    s_add_u32 m0, s88, 18432
    s_add_u32 s89, s97, 0
    buffer_load_dwordx4 v3, s[28:31], s89 offen  lds
    s_mov_b64 exec, -1
    s_add_u32 m0, s17, 8192
    s_add_u32 s89, s19, 196608
    buffer_load_dwordx4 v4, s[32:35], s89 offen  lds
    s_add_u32 m0, s17, 32768
    s_add_u32 s89, s19, 198656
    buffer_load_dwordx4 v4, s[32:35], s89 offen  lds
    s_add_u32 m0, s17, 57344
    s_add_u32 s89, s19, 200704
    buffer_load_dwordx4 v4, s[32:35], s89 offen  lds
    s_waitcnt vmcnt(11)
    s_barrier
    s_add_u32 m0, s86, 129536
    s_mov_b32 s89, 0
    buffer_load_dwordx4 v10, s[36:39], s89 offen nt lds
    s_add_u32 m0, s86, 145920
    s_mov_b32 s89, 0
    buffer_load_dwordx4 v10, s[40:43], s89 offen nt lds
    s_add_u32 m0, s86, 133632
    s_mov_b32 s89, 65536
    buffer_load_dwordx4 v10, s[36:39], s89 offen nt lds
    s_add_u32 m0, s86, 150016
    s_mov_b32 s89, 65536
    buffer_load_dwordx4 v10, s[40:43], s89 offen nt lds
    s_add_u32 m0, s86, 137728
    s_mov_b32 s89, 131072
    buffer_load_dwordx4 v10, s[36:39], s89 offen nt lds
    s_add_u32 m0, s86, 154112
    s_mov_b32 s89, 131072
    buffer_load_dwordx4 v10, s[40:43], s89 offen nt lds
    s_add_u32 m0, s86, 141824
    s_mov_b32 s89, 196608
    buffer_load_dwordx4 v10, s[36:39], s89 offen nt lds
    s_add_u32 m0, s86, 158208
    s_mov_b32 s89, 196608
    buffer_load_dwordx4 v10, s[40:43], s89 offen nt lds
    s_mov_b64 exec, 0xff
    s_lshl_b32 s82, s3, 7
    s_add_u32 m0, s82, 129024
    s_mov_b32 s89, 0
    buffer_load_dwordx4 v11, s[36:39], s89 offen nt lds
    s_lshl_b32 s83, s74, 9
    s_add_u32 s83, s83, s82
    s_and_b32 s89, s3, 2
    s_lshl_b32 s89, s89, 3
    s_add_u32 s82, s82, s89
    s_add_u32 m0, s82, 162816
    s_add_u32 s89, s83, 0
    buffer_load_dwordx4 v15, s[44:47], s89 offen  lds
    s_mov_b64 exec, -1
    s_add_u32 s97, s98, 4
    s_and_b32 s97, s97, 15
    s_lshr_b32 s99, s97, 3
    s_xor_b32 s97, s97, s99
    s_lshl_b32 s97, s97, 7
    s_add_u32 m0, s87, 36864
    s_add_u32 s89, s97, 0
    buffer_load_dwordx4 v2, s[28:31], s89 offen  lds
    s_mul_i32 s99, s97, 3072
    s_sub_u32 s19, s99, s18
    s_add_u32 s99, s99, s18
    s_add_u32 m0, s16, 16384
    s_add_u32 s89, s99, 0
    buffer_load_dwordx4 v4, s[32:35], s89 offen  lds
    s_add_u32 m0, s87, 40960
    s_add_u32 s89, s97, 65536
    buffer_load_dwordx4 v2, s[28:31], s89 offen  lds
    s_add_u32 m0, s16, 40960
    s_add_u32 s89, s99, 2048
    buffer_load_dwordx4 v4, s[32:35], s89 offen  lds
    s_add_u32 m0, s87, 45056
    s_add_u32 s89, s97, 131072
    buffer_load_dwordx4 v2, s[28:31], s89 offen  lds
    s_waitcnt vmcnt(15)
    s_barrier
    s_add_u32 m0, s16, 65536
    s_add_u32 s89, s99, 4096
    buffer_load_dwordx4 v4, s[32:35], s89 offen  lds
    s_add_u32 m0, s87, 49152
    s_add_u32 s89, s97, 196608
    buffer_load_dwordx4 v2, s[28:31], s89 offen  lds
    s_mov_b64 exec, 0xffffffff
    s_add_u32 m0, s88, 36864
    s_add_u32 s89, s97, 0
    buffer_load_dwordx4 v3, s[28:31], s89 offen  lds
    s_mov_b64 exec, -1
    s_add_u32 m0, s17, 16384
    s_add_u32 s89, s19, 196608
    buffer_load_dwordx4 v4, s[32:35], s89 offen  lds
    s_add_u32 m0, s17, 40960
    s_add_u32 s89, s19, 198656
    buffer_load_dwordx4 v4, s[32:35], s89 offen  lds
    s_add_u32 m0, s17, 65536
    s_add_u32 s89, s19, 200704
    buffer_load_dwordx4 v4, s[32:35], s89 offen  lds
    s_add_u32 s97, s98, 5
    s_and_b32 s97, s97, 15
    s_lshr_b32 s99, s97, 3
    s_xor_b32 s97, s97, s99
    s_lshl_b32 s97, s97, 7
    s_add_u32 m0, s87, 0
    s_add_u32 s89, s97, 0
    buffer_load_dwordx4 v2, s[28:31], s89 offen  lds
    s_mul_i32 s99, s97, 3072
    s_sub_u32 s19, s99, s18
    s_add_u32 s99, s99, s18
    s_add_u32 m0, s16, 0
    s_add_u32 s89, s99, 0
    buffer_load_dwordx4 v4, s[32:35], s89 offen  lds
    s_add_u32 m0, s87, 4096
    s_add_u32 s89, s97, 65536
    buffer_load_dwordx4 v2, s[28:31], s89 offen  lds
    s_add_u32 m0, s16, 24576
    s_add_u32 s89, s99, 2048
    buffer_load_dwordx4 v4, s[32:35], s89 offen  lds
    s_add_u32 m0, s87, 8192
    s_add_u32 s89, s97, 131072
    buffer_load_dwordx4 v2, s[28:31], s89 offen  lds
    s_add_u32 m0, s16, 49152
    s_add_u32 s89, s99, 4096
    buffer_load_dwordx4 v4, s[32:35], s89 offen  lds
    s_add_u32 m0, s87, 12288
    s_add_u32 s89, s97, 196608
    buffer_load_dwordx4 v2, s[28:31], s89 offen  lds
    s_mov_b64 exec, 0xffffffff
    s_add_u32 m0, s88, 0
    s_add_u32 s89, s97, 0
    buffer_load_dwordx4 v3, s[28:31], s89 offen  lds
    s_mov_b64 exec, -1
    s_waitcnt vmcnt(8)
    s_barrier
    s_add_u32 m0, s17, 0
    s_add_u32 s89, s19, 196608
    buffer_load_dwordx4 v4, s[32:35], s89 offen  lds
    ds_read_b128 v[84:87], v35 offset:0
    ds_read_b128 v[88:91], v35 offset:16
    s_add_u32 m0, s17, 24576
    s_add_u32 s89, s19, 198656
    buffer_load_dwordx4 v4, s[32:35], s89 offen  lds
    ds_read_b128 v[92:95], v35 offset:32
    s_add_u32 m0, s17, 49152
    s_add_u32 s89, s19, 200704
    buffer_load_dwordx4 v4, s[32:35], s89 offen  lds
    ds_read_b128 v[96:99], v35 offset:48
    s_add_u32 s97, s98, 10
    s_and_b32 s97, s97, 15
    s_lshr_b32 s99, s97, 3
    s_xor_b32 s97, s97, s99
    s_lshl_b32 s97, s97, 7
    s_add_u32 m0, s87, 18432
    s_add_u32 s89, s97, 0
    buffer_load_dwordx4 v2, s[28:31], s89 offen  lds
    ds_read_b128 v[40:43], v233 offset:0
    s_mul_i32 s99, s97, 3072
    s_sub_u32 s19, s99, s18
    s_add_u32 s99, s99, s18
    s_add_u32 m0, s16, 8192
    s_add_u32 s89, s99, 0
    buffer_load_dwordx4 v4, s[32:35], s89 offen  lds
    ds_read_b128 v[44:47], v232 offset:256
    s_add_u32 m0, s87, 22528
    s_add_u32 s89, s97, 65536
    buffer_load_dwordx4 v2, s[28:31], s89 offen  lds
    ds_read_b128 v[48:51], v233 offset:256
    s_add_u32 m0, s16, 32768
    s_add_u32 s89, s99, 2048
    buffer_load_dwordx4 v4, s[32:35], s89 offen  lds
    ds_read_b128 v[52:55], v16 offset:512
    s_add_u32 m0, s87, 26624
    s_add_u32 s89, s97, 131072
    buffer_load_dwordx4 v2, s[28:31], s89 offen  lds
    ds_read_b128 v[56:59], v231 offset:512
    s_add_u32 m0, s16, 57344
    s_add_u32 s89, s99, 4096
    buffer_load_dwordx4 v4, s[32:35], s89 offen  lds
    ds_read_b128 v[60:63], v16 offset:768
    s_add_u32 m0, s87, 30720
    s_add_u32 s89, s97, 196608
    buffer_load_dwordx4 v2, s[28:31], s89 offen  lds
    ds_read_b128 v[64:67], v231 offset:768
    s_mov_b64 exec, 0xffffffff
    s_add_u32 m0, s88, 18432
    s_add_u32 s89, s97, 0
    buffer_load_dwordx4 v3, s[28:31], s89 offen  lds
    s_mov_b64 exec, -1
    ds_read_b128 v[68:71], v16 offset:16896
    s_add_u32 m0, s17, 8192
    s_add_u32 s89, s19, 196608
    buffer_load_dwordx4 v4, s[32:35], s89 offen  lds
    ds_read_b128 v[72:75], v231 offset:16896
    s_add_u32 m0, s17, 32768
    s_add_u32 s89, s19, 198656
    buffer_load_dwordx4 v4, s[32:35], s89 offen  lds
    ds_read_b128 v[76:79], v16 offset:17152
    s_add_u32 m0, s17, 57344
    s_add_u32 s89, s19, 200704
    buffer_load_dwordx4 v4, s[32:35], s89 offen  lds
    ds_read_b128 v[80:83], v231 offset:17152
    s_waitcnt vmcnt(11)
    s_waitcnt lgkmcnt(0)
    s_barrier
    s_add_u32 s97, s98, 7
    s_and_b32 s97, s97, 15
    s_lshr_b32 s99, s97, 3
    s_xor_b32 s97, s97, s99
    s_lshl_b32 s97, s97, 7
    s_add_u32 m0, s87, 36864
    s_add_u32 s89, s97, 0
    buffer_load_dwordx4 v2, s[28:31], s89 offen  lds
    v_lshlrev_b32 v116, 16, v40
    v_lshlrev_b32 v117, 16, v44
    v_lshlrev_b32 v118, 16, v48
    v_lshlrev_b32 v119, 16, v52
    v_lshlrev_b32 v120, 16, v56
    v_lshlrev_b32 v121, 16, v60
    s_mul_i32 s99, s97, 3072
    s_sub_u32 s19, s99, s18
    s_add_u32 s99, s99, s18
    s_add_u32 m0, s16, 16384
    s_add_u32 s89, s99, 0
    buffer_load_dwordx4 v4, s[32:35], s89 offen  lds
    v_lshlrev_b32 v122, 16, v64
    v_lshlrev_b32 v127, 16, v84
    v_and_b32 v128, 0xffff0000, v84
    v_lshlrev_b32 v129, 16, v85
    v_and_b32 v130, 0xffff0000, v85
    v_lshlrev_b32 v123, 16, v68
    s_add_u32 m0, s87, 40960
    s_add_u32 s89, s97, 65536
    buffer_load_dwordx4 v2, s[28:31], s89 offen  lds
    v_lshlrev_b32 v124, 16, v72
    v_lshlrev_b32 v125, 16, v76
    v_lshlrev_b32 v126, 16, v80
    v_mul_f32 v131, v116, v130
    v_mul_f32 v132, v117, v130
    s_add_u32 m0, s16, 40960
    s_add_u32 s89, s99, 2048
    buffer_load_dwordx4 v4, s[32:35], s89 offen  lds
    v_mul_f32 v133, v118, v130
    v_mul_f32 v134, v119, v130
    v_fmac_f32 v131, v117, v129
    v_fmac_f32 v132, v118, v129
    v_fmac_f32 v133, v119, v129
    v_fmac_f32 v134, v120, v129
    s_add_u32 m0, s87, 45056
    s_add_u32 s89, s97, 131072
    buffer_load_dwordx4 v2, s[28:31], s89 offen  lds
    v_fmac_f32 v131, v118, v128
    v_fmac_f32 v132, v119, v128
    v_fmac_f32 v133, v120, v128
    v_fmac_f32 v134, v121, v128
    v_fmac_f32 v131, v119, v127
    v_fmac_f32 v132, v120, v127
    s_add_u32 m0, s16, 65536
    s_add_u32 s89, s99, 4096
    buffer_load_dwordx4 v4, s[32:35], s89 offen  lds
    v_fmac_f32 v133, v121, v127
    v_fmac_f32 v134, v122, v127
    v_mul_f32 v131, v131, v123
    v_mul_f32 v132, v132, v124
    v_mul_f32 v133, v133, v125
    s_add_u32 m0, s87, 49152
    s_add_u32 s89, s97, 196608
    buffer_load_dwordx4 v2, s[28:31], s89 offen  lds
    v_mul_f32 v134, v134, v126
    v_cvt_pk_bf16_f32 v102, v134, v133
    v_cvt_pk_bf16_f32 v103, v132, v131
    v_lshlrev_b32 v116, 16, v42
    v_lshlrev_b32 v117, 16, v46
    v_lshlrev_b32 v118, 16, v50
    s_mov_b64 exec, 0xffffffff
    s_add_u32 m0, s88, 36864
    s_add_u32 s89, s97, 0
    buffer_load_dwordx4 v3, s[28:31], s89 offen  lds
    s_mov_b64 exec, -1
    v_lshlrev_b32 v119, 16, v54
    v_lshlrev_b32 v120, 16, v58
    v_lshlrev_b32 v121, 16, v62
    v_lshlrev_b32 v122, 16, v66
    v_lshlrev_b32 v127, 16, v92
    v_and_b32 v128, 0xffff0000, v92
    s_add_u32 m0, s17, 16384
    s_add_u32 s89, s19, 196608
    buffer_load_dwordx4 v4, s[32:35], s89 offen  lds
    v_lshlrev_b32 v129, 16, v93
    v_and_b32 v130, 0xffff0000, v93
    v_lshlrev_b32 v123, 16, v70
    v_lshlrev_b32 v124, 16, v74
    v_lshlrev_b32 v125, 16, v78
    s_add_u32 m0, s17, 40960
    s_add_u32 s89, s19, 198656
    buffer_load_dwordx4 v4, s[32:35], s89 offen  lds
    v_lshlrev_b32 v126, 16, v82
    v_mul_f32 v131, v116, v130
    v_mul_f32 v132, v117, v130
    v_mul_f32 v133, v118, v130
    v_mul_f32 v134, v119, v130
    v_fmac_f32 v131, v117, v129
    s_add_u32 m0, s17, 65536
    s_add_u32 s89, s19, 200704
    buffer_load_dwordx4 v4, s[32:35], s89 offen  lds
    v_fmac_f32 v132, v118, v129
    v_fmac_f32 v133, v119, v129
    v_fmac_f32 v134, v120, v129
    v_fmac_f32 v131, v118, v128
    v_fmac_f32 v132, v119, v128
    s_waitcnt vmcnt(11)
    s_barrier
    s_add_u32 s97, s98, 8
    s_and_b32 s97, s97, 15
    s_lshr_b32 s99, s97, 3
    s_xor_b32 s97, s97, s99
    s_lshl_b32 s97, s97, 7
    s_add_u32 m0, s87, 0
    s_add_u32 s89, s97, 0
    buffer_load_dwordx4 v2, s[28:31], s89 offen  lds
    v_fmac_f32 v133, v120, v128
    v_fmac_f32 v134, v121, v128
    v_fmac_f32 v131, v119, v127
    v_fmac_f32 v132, v120, v127
    v_fmac_f32 v133, v121, v127
    v_fmac_f32 v134, v122, v127
    s_mul_i32 s99, s97, 3072
    s_sub_u32 s19, s99, s18
    s_add_u32 s99, s99, s18
    s_add_u32 m0, s16, 0
    s_add_u32 s89, s99, 0
    buffer_load_dwordx4 v4, s[32:35], s89 offen  lds
    v_mul_f32 v131, v131, v123
    v_mul_f32 v132, v132, v124
    v_mul_f32 v133, v133, v125
    v_mul_f32 v134, v134, v126
    v_cvt_pk_bf16_f32 v100, v134, v133
    v_cvt_pk_bf16_f32 v101, v132, v131
    s_add_u32 m0, s87, 4096
    s_add_u32 s89, s97, 65536
    buffer_load_dwordx4 v2, s[28:31], s89 offen  lds
    v_permlane32_swap_b32 v102, v100
    v_permlane32_swap_b32 v103, v101
    s_mov_b32 s89, 0
    buffer_store_dwordx4 v[100:103], v12, s[52:55], s89 offen sc1
    v_and_b32 v116, 0xffff0000, v40
    v_and_b32 v117, 0xffff0000, v44
    s_add_u32 m0, s16, 24576
    s_add_u32 s89, s99, 2048
    buffer_load_dwordx4 v4, s[32:35], s89 offen  lds
    v_and_b32 v118, 0xffff0000, v48
    v_and_b32 v119, 0xffff0000, v52
    v_and_b32 v120, 0xffff0000, v56
    v_and_b32 v121, 0xffff0000, v60
    v_and_b32 v122, 0xffff0000, v64
    v_lshlrev_b32 v127, 16, v86
    s_add_u32 m0, s87, 8192
    s_add_u32 s89, s97, 131072
    buffer_load_dwordx4 v2, s[28:31], s89 offen  lds
    v_and_b32 v128, 0xffff0000, v86
    v_lshlrev_b32 v129, 16, v87
    v_and_b32 v130, 0xffff0000, v87
    v_and_b32 v123, 0xffff0000, v68
    v_and_b32 v124, 0xffff0000, v72
    v_and_b32 v125, 0xffff0000, v76
    s_add_u32 m0, s16, 49152
    s_add_u32 s89, s99, 4096
    buffer_load_dwordx4 v4, s[32:35], s89 offen  lds
    v_and_b32 v126, 0xffff0000, v80
    v_mul_f32 v131, v116, v130
    v_mul_f32 v132, v117, v130
    v_mul_f32 v133, v118, v130
    v_mul_f32 v134, v119, v130
    s_add_u32 m0, s87, 12288
    s_add_u32 s89, s97, 196608
    buffer_load_dwordx4 v2, s[28:31], s89 offen  lds
    v_fmac_f32 v131, v117, v129
    v_fmac_f32 v132, v118, v129
    v_fmac_f32 v133, v119, v129
    v_fmac_f32 v134, v120, v129
    v_fmac_f32 v131, v118, v128
    v_fmac_f32 v132, v119, v128
    s_mov_b64 exec, 0xffffffff
    s_add_u32 m0, s88, 0
    s_add_u32 s89, s97, 0
    buffer_load_dwordx4 v3, s[28:31], s89 offen  lds
    s_mov_b64 exec, -1
    v_fmac_f32 v133, v120, v128
    v_fmac_f32 v134, v121, v128
    v_fmac_f32 v131, v119, v127
    v_fmac_f32 v132, v120, v127
    v_fmac_f32 v133, v121, v127
    v_fmac_f32 v134, v122, v127
    s_add_u32 m0, s17, 0
    s_add_u32 s89, s19, 196608
    buffer_load_dwordx4 v4, s[32:35], s89 offen  lds
    v_mul_f32 v131, v131, v123
    v_mul_f32 v132, v132, v124
    v_mul_f32 v133, v133, v125
    v_mul_f32 v134, v134, v126
    v_cvt_pk_bf16_f32 v106, v134, v133
    s_add_u32 m0, s17, 24576
    s_add_u32 s89, s19, 198656
    buffer_load_dwordx4 v4, s[32:35], s89 offen  lds
    v_cvt_pk_bf16_f32 v107, v132, v131
    v_and_b32 v116, 0xffff0000, v42
    v_and_b32 v117, 0xffff0000, v46
    v_and_b32 v118, 0xffff0000, v50
    v_and_b32 v119, 0xffff0000, v54
    v_and_b32 v120, 0xffff0000, v58
    s_add_u32 m0, s17, 49152
    s_add_u32 s89, s19, 200704
    buffer_load_dwordx4 v4, s[32:35], s89 offen  lds
    v_and_b32 v121, 0xffff0000, v62
    v_and_b32 v122, 0xffff0000, v66
    v_lshlrev_b32 v127, 16, v94
    v_and_b32 v128, 0xffff0000, v94
    v_lshlrev_b32 v129, 16, v95
    s_waitcnt vmcnt(12)
    s_barrier
    s_add_u32 s97, s98, 9
    s_and_b32 s97, s97, 15
    s_lshr_b32 s99, s97, 3
    s_xor_b32 s97, s97, s99
    s_lshl_b32 s97, s97, 7
    s_add_u32 m0, s87, 18432
    s_add_u32 s89, s97, 0
    buffer_load_dwordx4 v2, s[28:31], s89 offen  lds
    v_and_b32 v130, 0xffff0000, v95
    v_and_b32 v123, 0xffff0000, v70
    v_and_b32 v124, 0xffff0000, v74
    v_and_b32 v125, 0xffff0000, v78
    v_and_b32 v126, 0xffff0000, v82
    v_mul_f32 v131, v116, v130
    s_mul_i32 s99, s97, 3072
    s_sub_u32 s19, s99, s18
    s_add_u32 s99, s99, s18
    s_add_u32 m0, s16, 8192
    s_add_u32 s89, s99, 0
    buffer_load_dwordx4 v4, s[32:35], s89 offen  lds
    v_mul_f32 v132, v117, v130
    v_mul_f32 v133, v118, v130
    v_mul_f32 v134, v119, v130
    v_fmac_f32 v131, v117, v129
    v_fmac_f32 v132, v118, v129
    v_fmac_f32 v133, v119, v129
    s_add_u32 m0, s87, 22528
    s_add_u32 s89, s97, 65536
    buffer_load_dwordx4 v2, s[28:31], s89 offen  lds
    v_fmac_f32 v134, v120, v129
    v_fmac_f32 v131, v118, v128
    v_fmac_f32 v132, v119, v128
    v_fmac_f32 v133, v120, v128
    v_fmac_f32 v134, v121, v128
    s_add_u32 m0, s16, 32768
    s_add_u32 s89, s99, 2048
    buffer_load_dwordx4 v4, s[32:35], s89 offen  lds
    v_fmac_f32 v131, v119, v127
    v_fmac_f32 v132, v120, v127
    v_fmac_f32 v133, v121, v127
    v_fmac_f32 v134, v122, v127
    v_mul_f32 v131, v131, v123
    v_mul_f32 v132, v132, v124
    s_add_u32 m0, s87, 26624
    s_add_u32 s89, s97, 131072
    buffer_load_dwordx4 v2, s[28:31], s89 offen  lds
    v_mul_f32 v133, v133, v125
    v_mul_f32 v134, v134, v126
    v_cvt_pk_bf16_f32 v104, v134, v133
    v_cvt_pk_bf16_f32 v105, v132, v131
    s_nop 0
    v_permlane32_swap_b32 v106, v104
    v_permlane32_swap_b32 v107, v105
    s_add_u32 m0, s16, 57344
    s_add_u32 s89, s99, 4096
    buffer_load_dwordx4 v4, s[32:35], s89 offen  lds
    s_mov_b32 s89, 16384
    buffer_store_dwordx4 v[104:107], v12, s[52:55], s89 offen sc1
    v_lshlrev_b32 v116, 16, v41
    v_lshlrev_b32 v117, 16, v45
    v_lshlrev_b32 v118, 16, v49
    v_lshlrev_b32 v119, 16, v53
    s_add_u32 m0, s87, 30720
    s_add_u32 s89, s97, 196608
    buffer_load_dwordx4 v2, s[28:31], s89 offen  lds
    v_lshlrev_b32 v120, 16, v57
    v_lshlrev_b32 v121, 16, v61
    v_lshlrev_b32 v122, 16, v65
    v_lshlrev_b32 v127, 16, v88
    v_and_b32 v128, 0xffff0000, v88
    v_lshlrev_b32 v129, 16, v89
    s_mov_b64 exec, 0xffffffff
    s_add_u32 m0, s88, 18432
    s_add_u32 s89, s97, 0
    buffer_load_dwordx4 v3, s[28:31], s89 offen  lds
    s_mov_b64 exec, -1
    v_and_b32 v130, 0xffff0000, v89
    v_lshlrev_b32 v123, 16, v69
    v_lshlrev_b32 v124, 16, v73
    v_lshlrev_b32 v125, 16, v77
    v_lshlrev_b32 v126, 16, v81
    v_mul_f32 v131, v116, v130
    s_add_u32 m0, s17, 8192
    s_add_u32 s89, s19, 196608
    buffer_load_dwordx4 v4, s[32:35], s89 offen  lds
    v_mul_f32 v132, v117, v130
    v_mul_f32 v133, v118, v130
    v_mul_f32 v134, v119, v130
    v_fmac_f32 v131, v117, v129
    v_fmac_f32 v132, v118, v129
    s_add_u32 m0, s17, 32768
    s_add_u32 s89, s19, 198656
    buffer_load_dwordx4 v4, s[32:35], s89 offen  lds
    v_fmac_f32 v133, v119, v129
    v_fmac_f32 v134, v120, v129
    v_fmac_f32 v131, v118, v128
    v_fmac_f32 v132, v119, v128
    v_fmac_f32 v133, v120, v128
    v_fmac_f32 v134, v121, v128
    s_add_u32 m0, s17, 57344
    s_add_u32 s89, s19, 200704
    buffer_load_dwordx4 v4, s[32:35], s89 offen  lds
    v_fmac_f32 v131, v119, v127
    v_fmac_f32 v132, v120, v127
    v_fmac_f32 v133, v121, v127
    v_fmac_f32 v134, v122, v127
    v_mul_f32 v131, v131, v123
    s_waitcnt vmcnt(12)
    s_barrier
    s_add_u32 m0, s94, 32
    s_lshl_b32 s89, s90, 12
    buffer_load_dwordx4 v15, s[48:51], s89 offen offset:0 nt lds
    v_mul_f32 v132, v132, v124
    v_mul_f32 v133, v133, v125
    v_mul_f32 v134, v134, v126
    v_cvt_pk_bf16_f32 v110, v134, v133
    v_cvt_pk_bf16_f32 v111, v132, v131
    s_add_u32 m0, s94, 32
    s_lshl_b32 s89, s90, 12
    buffer_load_dwordx4 v15, s[48:51], s89 offen offset:1024 nt lds
    v_lshlrev_b32 v116, 16, v43
    v_lshlrev_b32 v117, 16, v47
    v_lshlrev_b32 v118, 16, v51
    v_lshlrev_b32 v119, 16, v55
    s_add_u32 m0, s94, 32
    s_lshl_b32 s89, s90, 12
    buffer_load_dwordx4 v15, s[48:51], s89 offen offset:2048 nt lds
    v_lshlrev_b32 v120, 16, v59
    v_lshlrev_b32 v121, 16, v63
    v_lshlrev_b32 v122, 16, v67
    v_lshlrev_b32 v127, 16, v96
    v_and_b32 v128, 0xffff0000, v96
    s_add_u32 m0, s94, 32
    s_lshl_b32 s89, s90, 12
    buffer_load_dwordx4 v15, s[48:51], s89 offen offset:3072 nt lds
    v_lshlrev_b32 v129, 16, v97
    v_and_b32 v130, 0xffff0000, v97
    v_lshlrev_b32 v123, 16, v71
    v_lshlrev_b32 v124, 16, v75
    buffer_load_dwordx4 v[212:215], v9, s[56:59], 0 offen offset:0 nt
    v_lshlrev_b32 v125, 16, v79
    v_lshlrev_b32 v126, 16, v83
    v_mul_f32 v131, v116, v130
    v_mul_f32 v132, v117, v130
    v_mul_f32 v133, v118, v130
    buffer_load_dwordx4 v[216:219], v9, s[56:59], 0 offen offset:2048 nt
    v_mul_f32 v134, v119, v130
    v_fmac_f32 v131, v117, v129
    v_fmac_f32 v132, v118, v129
    v_fmac_f32 v133, v119, v129
    buffer_load_dwordx4 v[220:223], v9, s[56:59], s96 offen offset:0 nt
    v_fmac_f32 v134, v120, v129
    v_fmac_f32 v131, v118, v128
    v_fmac_f32 v132, v119, v128
    v_fmac_f32 v133, v120, v128
    buffer_load_dwordx4 v[224:227], v9, s[56:59], s96 offen offset:2048 nt
    v_fmac_f32 v134, v121, v128
    v_fmac_f32 v131, v119, v127
    v_fmac_f32 v132, v120, v127
    v_fmac_f32 v133, v121, v127
    v_fmac_f32 v134, v122, v127
    s_add_u32 s97, s98, 14
    s_and_b32 s97, s97, 15
    s_lshr_b32 s99, s97, 3
    s_xor_b32 s97, s97, s99
    s_lshl_b32 s97, s97, 7
    s_add_u32 m0, s87, 36864
    s_add_u32 s89, s97, 0
    buffer_load_dwordx4 v2, s[28:31], s89 offen  lds
    v_mul_f32 v131, v131, v123
    v_mul_f32 v132, v132, v124
    v_mul_f32 v133, v133, v125
    v_mul_f32 v134, v134, v126
    s_mul_i32 s99, s97, 3072
    s_sub_u32 s19, s99, s18
    s_add_u32 s99, s99, s18
    s_add_u32 m0, s16, 16384
    s_add_u32 s89, s99, 0
    buffer_load_dwordx4 v4, s[32:35], s89 offen  lds
    v_cvt_pk_bf16_f32 v108, v134, v133
    v_cvt_pk_bf16_f32 v109, v132, v131
    s_nop 0
    v_permlane32_swap_b32 v110, v108
    v_permlane32_swap_b32 v111, v109
    s_mov_b32 s89, 32768
    buffer_store_dwordx4 v[108:111], v12, s[52:55], s89 offen sc1
    s_add_u32 m0, s87, 40960
    s_add_u32 s89, s97, 65536
    buffer_load_dwordx4 v2, s[28:31], s89 offen  lds
    v_and_b32 v116, 0xffff0000, v41
    v_and_b32 v117, 0xffff0000, v45
    v_and_b32 v118, 0xffff0000, v49
    v_and_b32 v119, 0xffff0000, v53
    s_add_u32 m0, s16, 40960
    s_add_u32 s89, s99, 2048
    buffer_load_dwordx4 v4, s[32:35], s89 offen  lds
    v_and_b32 v120, 0xffff0000, v57
    v_and_b32 v121, 0xffff0000, v61
    v_and_b32 v122, 0xffff0000, v65
    v_lshlrev_b32 v127, 16, v90
    v_and_b32 v128, 0xffff0000, v90
    s_add_u32 m0, s87, 45056
    s_add_u32 s89, s97, 131072
    buffer_load_dwordx4 v2, s[28:31], s89 offen  lds
    v_lshlrev_b32 v129, 16, v91
    v_and_b32 v130, 0xffff0000, v91
    v_and_b32 v123, 0xffff0000, v69
    v_and_b32 v124, 0xffff0000, v73
    s_add_u32 m0, s16, 65536
    s_add_u32 s89, s99, 4096
    buffer_load_dwordx4 v4, s[32:35], s89 offen  lds
    v_and_b32 v125, 0xffff0000, v77
    v_and_b32 v126, 0xffff0000, v81
    v_mul_f32 v131, v116, v130
    v_mul_f32 v132, v117, v130
    s_waitcnt vmcnt(15)
    s_barrier
    s_add_u32 m0, s87, 49152
    s_add_u32 s89, s97, 196608
    buffer_load_dwordx4 v2, s[28:31], s89 offen  lds
    v_mul_f32 v133, v118, v130
    v_mul_f32 v134, v119, v130
    v_fmac_f32 v131, v117, v129
    v_fmac_f32 v132, v118, v129
    v_fmac_f32 v133, v119, v129
    s_mov_b64 exec, 0xffffffff
    s_add_u32 m0, s88, 36864
    s_add_u32 s89, s97, 0
    buffer_load_dwordx4 v3, s[28:31], s89 offen  lds
    s_mov_b64 exec, -1
    v_fmac_f32 v134, v120, v129
    v_fmac_f32 v131, v118, v128
    v_fmac_f32 v132, v119, v128
    v_fmac_f32 v133, v120, v128
    s_add_u32 m0, s17, 16384
    s_add_u32 s89, s19, 196608
    buffer_load_dwordx4 v4, s[32:35], s89 offen  lds
    v_fmac_f32 v134, v121, v128
    v_fmac_f32 v131, v119, v127
    v_fmac_f32 v132, v120, v127
    v_fmac_f32 v133, v121, v127
    s_add_u32 m0, s17, 40960
    s_add_u32 s89, s19, 198656
    buffer_load_dwordx4 v4, s[32:35], s89 offen  lds
    v_fmac_f32 v134, v122, v127
    v_mul_f32 v131, v131, v123
    v_mul_f32 v132, v132, v124
    v_mul_f32 v133, v133, v125
    v_mul_f32 v134, v134, v126
    s_add_u32 m0, s17, 65536
    s_add_u32 s89, s19, 200704
    buffer_load_dwordx4 v4, s[32:35], s89 offen  lds
    v_cvt_pk_bf16_f32 v114, v134, v133
    v_cvt_pk_bf16_f32 v115, v132, v131
    v_and_b32 v116, 0xffff0000, v43
    v_and_b32 v117, 0xffff0000, v47
    s_add_u32 s97, s98, 11
    s_and_b32 s97, s97, 15
    s_lshr_b32 s99, s97, 3
    s_xor_b32 s97, s97, s99
    s_lshl_b32 s97, s97, 7
    s_add_u32 m0, s87, 0
    s_add_u32 s89, s97, 0
    buffer_load_dwordx4 v2, s[28:31], s89 offen  lds
    v_and_b32 v118, 0xffff0000, v51
    v_and_b32 v119, 0xffff0000, v55
    v_and_b32 v120, 0xffff0000, v59
    v_and_b32 v121, 0xffff0000, v63
    s_mul_i32 s99, s97, 3072
    s_sub_u32 s19, s99, s18
    s_add_u32 s99, s99, s18
    s_add_u32 m0, s16, 0
    s_add_u32 s89, s99, 0
    buffer_load_dwordx4 v4, s[32:35], s89 offen  lds
    v_and_b32 v122, 0xffff0000, v67
    v_lshlrev_b32 v127, 16, v98
    v_and_b32 v128, 0xffff0000, v98
    v_lshlrev_b32 v129, 16, v99
    s_add_u32 m0, s87, 4096
    s_add_u32 s89, s97, 65536
    buffer_load_dwordx4 v2, s[28:31], s89 offen  lds
    v_and_b32 v130, 0xffff0000, v99
    v_and_b32 v123, 0xffff0000, v71
    v_and_b32 v124, 0xffff0000, v75
    v_and_b32 v125, 0xffff0000, v79
    v_and_b32 v126, 0xffff0000, v83
    s_add_u32 m0, s16, 24576
    s_add_u32 s89, s99, 2048
    buffer_load_dwordx4 v4, s[32:35], s89 offen  lds
    v_mul_f32 v131, v116, v130
    v_mul_f32 v132, v117, v130
    v_mul_f32 v133, v118, v130
    v_mul_f32 v134, v119, v130
    s_add_u32 m0, s87, 8192
    s_add_u32 s89, s97, 131072
    buffer_load_dwordx4 v2, s[28:31], s89 offen  lds
    v_fmac_f32 v131, v117, v129
    v_fmac_f32 v132, v118, v129
    v_fmac_f32 v133, v119, v129
    v_fmac_f32 v134, v120, v129
    s_add_u32 m0, s16, 49152
    s_add_u32 s89, s99, 4096
    buffer_load_dwordx4 v4, s[32:35], s89 offen  lds
    v_fmac_f32 v131, v118, v128
    v_fmac_f32 v132, v119, v128
    v_fmac_f32 v133, v120, v128
    v_fmac_f32 v134, v121, v128
    v_fmac_f32 v131, v119, v127
    s_add_u32 m0, s87, 12288
    s_add_u32 s89, s97, 196608
    buffer_load_dwordx4 v2, s[28:31], s89 offen  lds
    v_fmac_f32 v132, v120, v127
    v_fmac_f32 v133, v121, v127
    v_fmac_f32 v134, v122, v127
    v_mul_f32 v131, v131, v123
    s_mov_b64 exec, 0xffffffff
    s_add_u32 m0, s88, 0
    s_add_u32 s89, s97, 0
    buffer_load_dwordx4 v3, s[28:31], s89 offen  lds
    s_mov_b64 exec, -1
    v_mul_f32 v132, v132, v124
    v_mul_f32 v133, v133, v125
    v_mul_f32 v134, v134, v126
    v_cvt_pk_bf16_f32 v112, v134, v133
    s_add_u32 m0, s17, 0
    s_add_u32 s89, s19, 196608
    buffer_load_dwordx4 v4, s[32:35], s89 offen  lds
    v_cvt_pk_bf16_f32 v113, v132, v131
    v_permlane32_swap_b32 v114, v112
    s_nop 0
    v_permlane32_swap_b32 v115, v113
    s_mov_b32 s89, 49152
    buffer_store_dwordx4 v[112:115], v12, s[52:55], s89 offen sc1
    s_waitcnt vmcnt(10)
    s_barrier
    s_add_u32 m0, s17, 24576
    s_add_u32 s89, s19, 198656
    buffer_load_dwordx4 v4, s[32:35], s89 offen  lds
    v_add_u32 v5, s94, v15
    ds_read_b128 v[140:143], v5 offset:32
    s_add_u32 m0, s17, 49152
    s_add_u32 s89, s19, 200704
    buffer_load_dwordx4 v4, s[32:35], s89 offen  lds
    ds_read_b32 v156, v5 offset:48
    s_add_u32 s97, s98, 12
    s_and_b32 s97, s97, 15
    s_lshr_b32 s99, s97, 3
    s_xor_b32 s97, s97, s99
    s_lshl_b32 s97, s97, 7
    s_add_u32 m0, s87, 18432
    s_add_u32 s89, s97, 0
    buffer_load_dwordx4 v2, s[28:31], s89 offen  lds
    ds_read_b128 v[144:147], v5 offset:1056
    s_mul_i32 s99, s97, 3072
    s_sub_u32 s19, s99, s18
    s_add_u32 s99, s99, s18
    s_add_u32 m0, s16, 8192
    s_add_u32 s89, s99, 0
    buffer_load_dwordx4 v4, s[32:35], s89 offen  lds
    ds_read_b32 v157, v5 offset:1072
    s_add_u32 m0, s87, 22528
    s_add_u32 s89, s97, 65536
    buffer_load_dwordx4 v2, s[28:31], s89 offen  lds
    ds_read_b128 v[148:151], v5 offset:2080
    s_add_u32 m0, s16, 32768
    s_add_u32 s89, s99, 2048
    buffer_load_dwordx4 v4, s[32:35], s89 offen  lds
    ds_read_b32 v158, v5 offset:2096
    s_add_u32 m0, s87, 26624
    s_add_u32 s89, s97, 131072
    buffer_load_dwordx4 v2, s[28:31], s89 offen  lds
    ds_read_b128 v[152:155], v5 offset:3104
    ds_read_b32 v159, v5 offset:3120
    s_add_u32 m0, s16, 57344
    s_add_u32 s89, s99, 4096
    buffer_load_dwordx4 v4, s[32:35], s89 offen  lds
    v_lshrrev_b32 v6, 3, v0
    s_add_u32 m0, s87, 30720
    s_add_u32 s89, s97, 196608
    buffer_load_dwordx4 v2, s[28:31], s89 offen  lds
    v_mul_u32_u24 v6, 4160, v6
    s_mov_b64 exec, 0xffffffff
    s_add_u32 m0, s88, 18432
    s_add_u32 s89, s97, 0
    buffer_load_dwordx4 v3, s[28:31], s89 offen  lds
    s_mov_b64 exec, -1
    v_and_b32 v7, 7, v0
    s_add_u32 m0, s17, 8192
    s_add_u32 s89, s19, 196608
    buffer_load_dwordx4 v4, s[32:35], s89 offen  lds
    v_lshl_add_u32 v6, v7, 2, v6
    s_add_u32 m0, s17, 32768
    s_add_u32 s89, s19, 198656
    buffer_load_dwordx4 v4, s[32:35], s89 offen  lds
    v_add_u32 v6, s94, v6
    s_add_u32 m0, s17, 57344
    s_add_u32 s89, s19, 200704
    buffer_load_dwordx4 v4, s[32:35], s89 offen  lds
    v_mov_b32 v7, 0
    s_waitcnt vmcnt(11)
    s_barrier
    buffer_load_dword v230, v229, s[64:67], 0 offen
    s_waitcnt lgkmcnt(0)
    v_readfirstlane_b32 s93, v140
    s_nop 0
    s_lshl_b32 s93, s93, 16
    s_add_u32 s97, s98, 13
    s_and_b32 s97, s97, 15
    s_lshr_b32 s99, s97, 3
    s_xor_b32 s97, s97, s99
    s_lshl_b32 s97, s97, 7
    s_add_u32 m0, s87, 36864
    s_add_u32 s89, s97, 0
    buffer_load_dwordx4 v2, s[28:31], s89 offen  lds
    v_writelane_b32 v7, s93, 15
    v_alignbit_b32 v140, v141, v140, 16
    s_mul_i32 s99, s97, 3072
    s_sub_u32 s19, s99, s18
    s_add_u32 s99, s99, s18
    s_add_u32 m0, s16, 16384
    s_add_u32 s89, s99, 0
    buffer_load_dwordx4 v4, s[32:35], s89 offen  lds
    v_alignbit_b32 v141, v142, v141, 16
    v_alignbit_b32 v142, v143, v142, 16
    s_add_u32 m0, s87, 40960
    s_add_u32 s89, s97, 65536
    buffer_load_dwordx4 v2, s[28:31], s89 offen  lds
    v_alignbit_b32 v143, v156, v143, 16
    v_alignbit_b32 v144, v145, v144, 16
    s_add_u32 m0, s16, 40960
    s_add_u32 s89, s99, 2048
    buffer_load_dwordx4 v4, s[32:35], s89 offen  lds
    v_alignbit_b32 v145, v146, v145, 16
    v_alignbit_b32 v146, v147, v146, 16
    s_add_u32 m0, s87, 45056
    s_add_u32 s89, s97, 131072
    buffer_load_dwordx4 v2, s[28:31], s89 offen  lds
    v_alignbit_b32 v147, v157, v147, 16
    v_alignbit_b32 v148, v149, v148, 16
    s_add_u32 m0, s16, 65536
    s_add_u32 s89, s99, 4096
    buffer_load_dwordx4 v4, s[32:35], s89 offen  lds
    v_alignbit_b32 v149, v150, v149, 16
    v_alignbit_b32 v150, v151, v150, 16
    s_add_u32 m0, s87, 49152
    s_add_u32 s89, s97, 196608
    buffer_load_dwordx4 v2, s[28:31], s89 offen  lds
    v_alignbit_b32 v151, v158, v151, 16
    v_alignbit_b32 v152, v153, v152, 16
    s_mov_b64 exec, 0xffffffff
    s_add_u32 m0, s88, 36864
    s_add_u32 s89, s97, 0
    buffer_load_dwordx4 v3, s[28:31], s89 offen  lds
    s_mov_b64 exec, -1
    v_alignbit_b32 v153, v154, v153, 16
    v_alignbit_b32 v154, v155, v154, 16
    s_add_u32 m0, s17, 16384
    s_add_u32 s89, s19, 196608
    buffer_load_dwordx4 v4, s[32:35], s89 offen  lds
    v_alignbit_b32 v155, v159, v155, 16
    v_lshlrev_b32 v8, 3, v0
    s_add_u32 m0, s17, 40960
    s_add_u32 s89, s19, 198656
    buffer_load_dwordx4 v4, s[32:35], s89 offen  lds
    s_add_u32 s78, s88, 18432
    v_add_u32 v8, s78, v8
    s_add_u32 m0, s17, 65536
    s_add_u32 s89, s19, 200704
    buffer_load_dwordx4 v4, s[32:35], s89 offen  lds
    v_mov_b32 v156, 0
    v_mov_b32 v157, 0
    s_waitcnt vmcnt(12)
    s_barrier
    s_add_u32 s97, s98, 15
    s_and_b32 s97, s97, 15
    s_lshr_b32 s99, s97, 3
    s_xor_b32 s97, s97, s99
    s_lshl_b32 s97, s97, 7
    s_add_u32 m0, s87, 0
    s_add_u32 s89, s97, 0
    buffer_load_dwordx4 v2, s[28:31], s89 offen  lds
    s_mul_i32 s99, s97, 3072
    s_sub_u32 s19, s99, s18
    s_add_u32 s99, s99, s18
    s_add_u32 m0, s16, 0
    s_add_u32 s89, s99, 0
    buffer_load_dwordx4 v4, s[32:35], s89 offen  lds
    s_add_u32 m0, s87, 4096
    s_add_u32 s89, s97, 65536
    buffer_load_dwordx4 v2, s[28:31], s89 offen  lds
    s_add_u32 m0, s16, 24576
    s_add_u32 s89, s99, 2048
    buffer_load_dwordx4 v4, s[32:35], s89 offen  lds
    s_add_u32 m0, s87, 8192
    s_add_u32 s89, s97, 131072
    buffer_load_dwordx4 v2, s[28:31], s89 offen  lds
    s_add_u32 m0, s16, 49152
    s_add_u32 s89, s99, 4096
    buffer_load_dwordx4 v4, s[32:35], s89 offen  lds
    s_add_u32 m0, s87, 12288
    s_add_u32 s89, s97, 196608
    buffer_load_dwordx4 v2, s[28:31], s89 offen  lds
    s_mov_b64 exec, 0xffffffff
    s_add_u32 m0, s88, 0
    s_add_u32 s89, s97, 0
    buffer_load_dwordx4 v3, s[28:31], s89 offen  lds
    s_mov_b64 exec, -1
    s_add_u32 m0, s17, 0
    s_add_u32 s89, s19, 196608
    buffer_load_dwordx4 v4, s[32:35], s89 offen  lds
    s_add_u32 m0, s17, 24576
    s_add_u32 s89, s19, 198656
    buffer_load_dwordx4 v4, s[32:35], s89 offen  lds
    s_add_u32 m0, s17, 49152
    s_add_u32 s89, s19, 200704
    buffer_load_dwordx4 v4, s[32:35], s89 offen  lds
    s_mov_b64 exec, 0xff
    buffer_load_dword v136, v33, s[68:71], 0 offen sc1
    buffer_load_dword v137, v34, s[52:55], 0 offen sc1
    s_mov_b64 exec, -1
    s_waitcnt vmcnt(13)
    s_barrier
    s_waitcnt vmcnt(0)
    s_branch LA_j
LA_c3:
    s_add_u32 s97, s98, 3
    s_and_b32 s97, s97, 15
    s_lshr_b32 s99, s97, 3
    s_xor_b32 s97, s97, s99
    s_lshl_b32 s97, s97, 7
    s_add_u32 m0, s87, 0
    s_add_u32 s89, s97, 0
    buffer_load_dwordx4 v2, s[28:31], s89 offen  lds
    s_mul_i32 s99, s97, 3072
    s_sub_u32 s19, s99, s18
    s_add_u32 s99, s99, s18
    s_add_u32 m0, s16, 0
    s_add_u32 s89, s99, 0
    buffer_load_dwordx4 v4, s[32:35], s89 offen  lds
    s_add_u32 m0, s87, 4096
    s_add_u32 s89, s97, 65536
    buffer_load_dwordx4 v2, s[28:31], s89 offen  lds
    s_add_u32 m0, s16, 24576
    s_add_u32 s89, s99, 2048
    buffer_load_dwordx4 v4, s[32:35], s89 offen  lds
    s_add_u32 m0, s87, 8192
    s_add_u32 s89, s97, 131072
    buffer_load_dwordx4 v2, s[28:31], s89 offen  lds
    s_add_u32 m0, s16, 49152
    s_add_u32 s89, s99, 4096
    buffer_load_dwordx4 v4, s[32:35], s89 offen  lds
    s_add_u32 m0, s87, 12288
    s_add_u32 s89, s97, 196608
    buffer_load_dwordx4 v2, s[28:31], s89 offen  lds
    s_mov_b64 exec, 0xffffffff
    s_add_u32 m0, s88, 0
    s_add_u32 s89, s97, 0
    buffer_load_dwordx4 v3, s[28:31], s89 offen  lds
    s_mov_b64 exec, -1
    s_add_u32 m0, s17, 0
    s_add_u32 s89, s19, 196608
    buffer_load_dwordx4 v4, s[32:35], s89 offen  lds
    s_mov_b32 s36, s6
    s_mov_b32 s37, s7
    s_mov_b32 s38, 0x400000
    s_mov_b32 s39, 0x20000
    s_mov_b32 s40, s8
    s_mov_b32 s41, s9
    s_mov_b32 s42, 0x400000
    s_mov_b32 s43, 0x20000
    s_mov_b32 s44, s10
    s_mov_b32 s45, s11
    s_mov_b32 s46, 0x2000
    s_mov_b32 s47, 0x20000
    s_mov_b32 s48, s12
    s_mov_b32 s49, s13
    s_mov_b32 s50, 0x400000
    s_mov_b32 s51, 0x20000
    s_mov_b32 s52, s26
    s_mov_b32 s53, s27
    s_mov_b32 s54, 0x1000000
    s_mov_b32 s55, 0x20000
    s_mov_b32 s56, s4
    s_mov_b32 s57, s5
    s_mov_b32 s58, 0x400000
    s_mov_b32 s59, 0x20000
    s_mov_b32 s60, s22
    s_mov_b32 s61, s23
    s_mov_b32 s62, 0x800000
    s_mov_b32 s63, 0x20000
    s_mov_b32 s64, s20
    s_mov_b32 s65, s21
    s_mov_b32 s66, 0x200000
    s_add_u32 m0, s17, 24576
    s_add_u32 s89, s19, 198656
    buffer_load_dwordx4 v4, s[32:35], s89 offen  lds
    s_mov_b32 s67, 0x20000
    s_mov_b32 s68, s24
    s_mov_b32 s69, s25
    s_mov_b32 s70, 0x100
    s_mov_b32 s71, 0x20000
    v_and_b32 v7, 7, v0
    s_lshl_b32 s79, s74, 7
    v_lshl_add_u32 v7, v7, 4, s79
    s_lshl_b32 s78, s75, 7
    s_lshl_b32 s80, s3, 3
    s_add_u32 s80, s80, s78
    v_lshrrev_b32 v5, 3, v0
    s_and_b32 s79, s3, 1
    v_xor_b32 v5, s79, v5
    v_add_u32 v5, s80, v5
    v_lshl_add_u32 v10, v5, 11, v7
    s_xor_b32 s80, s3, 1
    s_add_u32 s80, s78, s80
    s_sub_u32 s80, s80, 4
    s_lshl_b32 s80, s80, 11
    v_add_u32 v11, s80, v7
    v_bfe_u32 v5, v0, 3, 2
    v_lshrrev_b32 v6, 5, v0
    s_lshl_b32 s80, s3, 5
    v_lshlrev_b32 v8, 3, v5
    v_lshl_add_u32 v8, v6, 2, v8
    v_add_u32 v8, s80, v8
    v_and_b32 v35, 7, v0
    v_lshlrev_b32 v16, 4, v35
    v_lshl_add_u32 v16, v8, 7, v16
    s_add_u32 m0, s17, 49152
    s_add_u32 s89, s19, 200704
    buffer_load_dwordx4 v4, s[32:35], s89 offen  lds
    v_add_u32 v232, 129024, v16
    v_and_b32 v231, 1, v5
    v_lshl_add_u32 v16, v231, 7, v232
    v_xor_b32 v233, v231, v6
    v_xor_b32 v233, 1, v233
    v_lshl_add_u32 v232, v233, 7, v232
    v_xor_b32 v231, 128, v16
    v_xor_b32 v233, 128, v232
    v_lshrrev_b32 v33, 2, v35
    v_lshlrev_b32 v35, 6, v35
    v_lshl_add_u32 v35, v33, 4, v35
    v_add_u32 v35, 162816, v35
    v_add_u32 v8, s78, v8
    v_lshl_add_u32 v9, v8, 11, v7
    v_lshl_add_u32 v13, v8, 12, v7
    v_bfe_u32 v8, v0, 2, 1
    v_lshlrev_b32 v8, 1, v8
    v_add_u32 v8, v8, v6
    v_lshlrev_b32 v8, 16, v8
    v_lshl_add_u32 v8, v5, 6, v8
    v_and_b32 v7, 3, v0
    v_lshl_add_u32 v8, v7, 4, v8
    s_add_u32 s78, s78, s80
    s_lshl_b32 s78, s78, 3
    s_lshl_b32 s79, s74, 18
    s_add_u32 s78, s78, s79
    v_add_u32 v12, s78, v8
    s_lshl_b32 s91, s74, 4
    s_add_u32 s91, s91, s75
    s_lshr_b32 s78, s91, 3
    s_lshl_b32 s78, s78, 5
    s_add_u32 s97, s98, 0
    s_and_b32 s97, s97, 15
    s_lshr_b32 s99, s97, 3
    s_xor_b32 s97, s97, s99
    s_lshl_b32 s97, s97, 7
    s_add_u32 m0, s87, 18432
    s_add_u32 s89, s97, 0
    buffer_load_dwordx4 v2, s[28:31], s89 offen  lds
    s_and_b32 s79, s91, 7
    s_add_u32 s78, s78, s79
    s_lshl_b32 s79, s3, 3
    s_add_u32 s90, s78, s79
    s_lshl_b32 s91, s91, 14
    s_lshr_b32 s78, s90, 1
    s_lshl_b32 s78, s78, 2
    s_load_dword s92, s[14:15], s78
    s_mul_i32 s94, s3, 8320
    s_add_u32 s94, s94, 129024
    s_lshl_b32 s95, s3, 14
    s_mov_b32 s96, 4096
    s_and_b32 s100, s76, 3
    s_lshl_b32 s100, s100, 19
    v_bfe_u32 v5, v0, 2, 2
    v_lshlrev_b32 v5, 1, v5
    v_lshl_add_u32 v5, v6, 3, v5
    v_bfe_u32 v8, v0, 4, 1
    v_add_u32 v5, v5, v8
    s_and_b32 s78, s3, 1
    s_lshl_b32 s78, s78, 1
    v_add_u32 v8, s78, v6
    v_xor_b32 v8, v8, v7
    v_lshlrev_b32 v8, 4, v8
    v_lshl_add_u32 v5, v5, 6, v8
    v_add_u32 v14, s86, v5
    v_lshlrev_b32 v15, 4, v0
    v_lshrrev_b32 v5, 4, v0
    v_lshlrev_b32 v5, 1, v5
    v_and_b32 v8, 7, v0
    s_mul_i32 s99, s97, 3072
    s_sub_u32 s19, s99, s18
    s_add_u32 s99, s99, s18
    s_add_u32 m0, s16, 8192
    s_add_u32 s89, s99, 0
    buffer_load_dwordx4 v4, s[32:35], s89 offen  lds
    v_xor_b32 v5, v5, v8
    v_lshlrev_b32 v5, 4, v5
    v_lshrrev_b32 v8, 3, v0
    v_lshl_add_u32 v5, v8, 11, v5
    s_lshl_b32 s78, s77, 7
    v_add_u32 v17, s78, v5
    v_add_u32 v228, s95, v17
    s_lshr_b32 s78, s2, 3
    s_lshl_b32 s78, s78, 16
    s_add_u32 s78, s78, s95
    s_and_b32 s79, s77, 8
    s_lshl_b32 s79, s79, 7
    s_add_u32 s78, s78, s79
    v_and_b32 v5, 7, v0
    v_lshlrev_b32 v5, 7, v5
    v_lshl_add_u32 v5, v8, 11, v5
    v_add_u32 v229, s78, v5
    v_mov_b32 v18, 162304
    v_mov_b32 v19, 1
    v_and_b32 v5, 3, v0
    s_lshl_b32 s78, s74, 4
    s_add_u32 s78, s78, s3
    v_lshl_add_u32 v6, v5, 2, s78
    s_lshr_b32 s78, s76, 3
    s_lshl_b32 s79, s3, 1
    s_add_u32 s78, s78, s79
    s_xor_b32 s78, s78, 2
    s_lshl_b32 s78, s78, 5
    s_and_b32 s79, s76, 7
    s_add_u32 s78, s78, s79
    v_lshl_add_u32 v7, v5, 3, s78
    s_add_u32 m0, s87, 22528
    s_add_u32 s89, s97, 65536
    buffer_load_dwordx4 v2, s[28:31], s89 offen  lds
    v_and_b32 v8, 4, v0
    v_cmp_eq_u32 vcc, 0, v8
    s_nop 1
    v_cndmask_b32 v6, v7, v6, vcc
    v_and_b32 v33, 0xf0, v6
    v_lshlrev_b32 v34, 8, v6
    v_add_u32 v34, 12582912, v34
    v_and_b32 v5, 15, v0
    v_lshrrev_b32 v6, 4, v0
    v_add_u32 v7, 9, v5
    v_and_b32 v8, 1, v7
    v_mul_u32_u24 v8, 4160, v8
    v_lshrrev_b32 v7, 1, v7
    v_lshl_add_u32 v8, v7, 2, v8
    v_lshlrev_b32 v7, 4, v6
    v_sub_u32 v8, v8, v7
    s_add_u32 s78, s94, 32
    v_add_u32 v21, s78, v8
    v_add_u32 v22, 1024, v21
    v_add_u32 v23, 2048, v21
    v_add_u32 v24, 3072, v21
    v_lshl_add_u32 v7, v5, 1, v6
    v_add_u32 v7, 30, v7
    v_lshrrev_b32 v8, 3, v7
    v_and_b32 v25, 3, v8
    v_xor_b32 v25, s3, v25
    v_lshl_add_u32 v25, v8, 5, v25
    v_and_b32 v8, 1, v7
    v_lshl_add_u32 v25, v8, 4, v25
    v_bfe_u32 v8, v7, 1, 2
    v_lshl_add_u32 v25, v8, 2, v25
    s_add_u32 m0, s16, 32768
    s_add_u32 s89, s99, 2048
    buffer_load_dwordx4 v4, s[32:35], s89 offen  lds
    v_lshlrev_b32 v25, 4, v25
    v_add_u32 v25, 92160, v25
    v_lshl_add_u32 v7, v5, 1, v6
    v_add_u32 v7, 26, v7
    v_lshrrev_b32 v8, 3, v7
    v_and_b32 v26, 3, v8
    v_xor_b32 v26, s3, v26
    v_lshl_add_u32 v26, v8, 5, v26
    v_and_b32 v8, 1, v7
    v_lshl_add_u32 v26, v8, 4, v26
    v_bfe_u32 v8, v7, 1, 2
    v_lshl_add_u32 v26, v8, 2, v26
    v_lshlrev_b32 v26, 4, v26
    v_add_u32 v26, 92160, v26
    v_lshl_add_u32 v7, v5, 1, v6
    v_add_u32 v7, 22, v7
    v_lshrrev_b32 v8, 3, v7
    v_and_b32 v27, 3, v8
    v_xor_b32 v27, s3, v27
    v_lshl_add_u32 v27, v8, 5, v27
    v_and_b32 v8, 1, v7
    v_lshl_add_u32 v27, v8, 4, v27
    v_bfe_u32 v8, v7, 1, 2
    v_lshl_add_u32 v27, v8, 2, v27
    v_lshlrev_b32 v27, 4, v27
    v_add_u32 v27, 92160, v27
    v_lshl_add_u32 v7, v5, 1, v6
    v_add_u32 v7, 18, v7
    v_lshrrev_b32 v8, 3, v7
    v_and_b32 v28, 3, v8
    v_xor_b32 v28, s3, v28
    s_add_u32 m0, s87, 26624
    s_add_u32 s89, s97, 131072
    buffer_load_dwordx4 v2, s[28:31], s89 offen  lds
    v_lshl_add_u32 v28, v8, 5, v28
    v_and_b32 v8, 1, v7
    v_lshl_add_u32 v28, v8, 4, v28
    v_bfe_u32 v8, v7, 1, 2
    v_lshl_add_u32 v28, v8, 2, v28
    v_lshlrev_b32 v28, 4, v28
    v_add_u32 v28, 92160, v28
    v_lshl_add_u32 v7, v5, 1, v6
    v_add_u32 v7, 14, v7
    v_lshrrev_b32 v8, 3, v7
    v_and_b32 v29, 3, v8
    v_xor_b32 v29, s3, v29
    v_lshl_add_u32 v29, v8, 5, v29
    v_and_b32 v8, 1, v7
    v_lshl_add_u32 v29, v8, 4, v29
    v_bfe_u32 v8, v7, 1, 2
    v_lshl_add_u32 v29, v8, 2, v29
    v_lshlrev_b32 v29, 4, v29
    v_add_u32 v29, 92160, v29
    v_lshl_add_u32 v7, v5, 1, v6
    v_add_u32 v7, 10, v7
    v_lshrrev_b32 v8, 3, v7
    v_and_b32 v30, 3, v8
    v_xor_b32 v30, s3, v30
    v_lshl_add_u32 v30, v8, 5, v30
    v_and_b32 v8, 1, v7
    v_lshl_add_u32 v30, v8, 4, v30
    v_bfe_u32 v8, v7, 1, 2
    v_lshl_add_u32 v30, v8, 2, v30
    v_lshlrev_b32 v30, 4, v30
    s_add_u32 m0, s16, 57344
    s_add_u32 s89, s99, 4096
    buffer_load_dwordx4 v4, s[32:35], s89 offen  lds
    v_add_u32 v30, 92160, v30
    v_lshl_add_u32 v7, v5, 1, v6
    v_add_u32 v7, 6, v7
    v_lshrrev_b32 v8, 3, v7
    v_and_b32 v31, 3, v8
    v_xor_b32 v31, s3, v31
    v_lshl_add_u32 v31, v8, 5, v31
    v_and_b32 v8, 1, v7
    v_lshl_add_u32 v31, v8, 4, v31
    v_bfe_u32 v8, v7, 1, 2
    v_lshl_add_u32 v31, v8, 2, v31
    v_lshlrev_b32 v31, 4, v31
    v_add_u32 v31, 92160, v31
    v_lshl_add_u32 v7, v5, 1, v6
    v_add_u32 v7, 2, v7
    v_lshrrev_b32 v8, 3, v7
    v_and_b32 v32, 3, v8
    v_xor_b32 v32, s3, v32
    v_lshl_add_u32 v32, v8, 5, v32
    v_and_b32 v8, 1, v7
    v_lshl_add_u32 v32, v8, 4, v32
    v_bfe_u32 v8, v7, 1, 2
    v_lshl_add_u32 v32, v8, 2, v32
    v_lshlrev_b32 v32, 4, v32
    v_add_u32 v32, 92160, v32
    v_lshrrev_b32 v7, 1, v6
    v_lshl_add_u32 v7, v5, 1, v7
    v_add_u32 v7, 32, v7
    v_lshrrev_b32 v8, 3, v7
    v_and_b32 v20, 3, v8
    v_xor_b32 v20, s3, v20
    s_add_u32 m0, s87, 30720
    s_add_u32 s89, s97, 196608
    buffer_load_dwordx4 v2, s[28:31], s89 offen  lds
    v_lshl_add_u32 v20, v8, 5, v20
    v_and_b32 v8, 1, v7
    v_lshl_add_u32 v20, v8, 4, v20
    v_bfe_u32 v8, v7, 1, 2
    v_lshl_add_u32 v20, v8, 2, v20
    v_lshlrev_b32 v20, 4, v20
    v_add_u32 v20, 92160, v20
    v_and_b32 v8, 1, v6
    v_xor_b32 v8, 1, v8
    v_lshl_add_u32 v20, v8, 3, v20
    s_waitcnt lgkmcnt(0)
    s_and_b32 s78, s92, 0xffff0000
    s_lshl_b32 s92, s92, 16
    s_bitcmp1_b32 s90, 0
    s_cselect_b32 s92, s78, s92
    v_lshlrev_b32 v7, 3, v6
    v_sub_u32 v7, v7, v5
    v_subrev_u32 v7, 9, v7
    v_and_b32 v8, 1, v7
    v_xor_b32 v8, 1, v8
    v_lshlrev_b32 v8, 4, v8
    v_lshrrev_b32 v8, v8, s92
    v_ashrrev_i32 v7, 1, v7
    v_cmp_eq_u32 vcc, 0, v7
    s_nop 1
    v_cndmask_b32 v236, 0, v8, vcc
    v_cmp_eq_u32 vcc, 1, v7
    s_nop 1
    v_cndmask_b32 v237, 0, v8, vcc
    v_cmp_eq_u32 vcc, 2, v7
    s_nop 1
    v_cndmask_b32 v238, 0, v8, vcc
    v_cmp_eq_u32 vcc, 3, v7
    s_nop 1
    v_cndmask_b32 v239, 0, v8, vcc
    s_waitcnt vmcnt(7)
    s_barrier
    s_mov_b64 exec, 0xffffffff
    s_add_u32 m0, s88, 18432
    s_add_u32 s89, s97, 0
    buffer_load_dwordx4 v3, s[28:31], s89 offen  lds
    s_mov_b64 exec, -1
    s_add_u32 m0, s17, 8192
    s_add_u32 s89, s19, 196608
    buffer_load_dwordx4 v4, s[32:35], s89 offen  lds
    s_add_u32 m0, s17, 32768
    s_add_u32 s89, s19, 198656
    buffer_load_dwordx4 v4, s[32:35], s89 offen  lds
    s_add_u32 m0, s17, 57344
    s_add_u32 s89, s19, 200704
    buffer_load_dwordx4 v4, s[32:35], s89 offen  lds
    s_add_u32 s97, s98, 1
    s_and_b32 s97, s97, 15
    s_lshr_b32 s99, s97, 3
    s_xor_b32 s97, s97, s99
    s_lshl_b32 s97, s97, 7
    s_add_u32 m0, s87, 36864
    s_add_u32 s89, s97, 0
    buffer_load_dwordx4 v2, s[28:31], s89 offen  lds
    s_mul_i32 s99, s97, 3072
    s_sub_u32 s19, s99, s18
    s_add_u32 s99, s99, s18
    s_add_u32 m0, s16, 16384
    s_add_u32 s89, s99, 0
    buffer_load_dwordx4 v4, s[32:35], s89 offen  lds
    s_add_u32 m0, s87, 40960
    s_add_u32 s89, s97, 65536
    buffer_load_dwordx4 v2, s[28:31], s89 offen  lds
    s_add_u32 m0, s16, 40960
    s_add_u32 s89, s99, 2048
    buffer_load_dwordx4 v4, s[32:35], s89 offen  lds
    s_add_u32 m0, s87, 45056
    s_add_u32 s89, s97, 131072
    buffer_load_dwordx4 v2, s[28:31], s89 offen  lds
    s_add_u32 m0, s16, 65536
    s_add_u32 s89, s99, 4096
    buffer_load_dwordx4 v4, s[32:35], s89 offen  lds
    s_add_u32 m0, s87, 49152
    s_add_u32 s89, s97, 196608
    buffer_load_dwordx4 v2, s[28:31], s89 offen  lds
    s_mov_b64 exec, 0xffffffff
    s_add_u32 m0, s88, 36864
    s_add_u32 s89, s97, 0
    buffer_load_dwordx4 v3, s[28:31], s89 offen  lds
    s_mov_b64 exec, -1
    s_add_u32 m0, s17, 16384
    s_add_u32 s89, s19, 196608
    buffer_load_dwordx4 v4, s[32:35], s89 offen  lds
    s_add_u32 m0, s17, 40960
    s_add_u32 s89, s19, 198656
    buffer_load_dwordx4 v4, s[32:35], s89 offen  lds
    s_waitcnt vmcnt(10)
    s_barrier
    s_add_u32 m0, s17, 65536
    s_add_u32 s89, s19, 200704
    buffer_load_dwordx4 v4, s[32:35], s89 offen  lds
    s_add_u32 s97, s98, 2
    s_and_b32 s97, s97, 15
    s_lshr_b32 s99, s97, 3
    s_xor_b32 s97, s97, s99
    s_lshl_b32 s97, s97, 7
    s_add_u32 m0, s87, 0
    s_add_u32 s89, s97, 0
    buffer_load_dwordx4 v2, s[28:31], s89 offen  lds
    s_mul_i32 s99, s97, 3072
    s_sub_u32 s19, s99, s18
    s_add_u32 s99, s99, s18
    s_add_u32 m0, s16, 0
    s_add_u32 s89, s99, 0
    buffer_load_dwordx4 v4, s[32:35], s89 offen  lds
    s_add_u32 m0, s87, 4096
    s_add_u32 s89, s97, 65536
    buffer_load_dwordx4 v2, s[28:31], s89 offen  lds
    s_add_u32 m0, s16, 24576
    s_add_u32 s89, s99, 2048
    buffer_load_dwordx4 v4, s[32:35], s89 offen  lds
    s_add_u32 m0, s87, 8192
    s_add_u32 s89, s97, 131072
    buffer_load_dwordx4 v2, s[28:31], s89 offen  lds
    s_add_u32 m0, s16, 49152
    s_add_u32 s89, s99, 4096
    buffer_load_dwordx4 v4, s[32:35], s89 offen  lds
    s_add_u32 m0, s87, 12288
    s_add_u32 s89, s97, 196608
    buffer_load_dwordx4 v2, s[28:31], s89 offen  lds
    s_mov_b64 exec, 0xffffffff
    s_add_u32 m0, s88, 0
    s_add_u32 s89, s97, 0
    buffer_load_dwordx4 v3, s[28:31], s89 offen  lds
    s_mov_b64 exec, -1
    s_add_u32 m0, s17, 0
    s_add_u32 s89, s19, 196608
    buffer_load_dwordx4 v4, s[32:35], s89 offen  lds
    s_add_u32 m0, s17, 24576
    s_add_u32 s89, s19, 198656
    buffer_load_dwordx4 v4, s[32:35], s89 offen  lds
    s_add_u32 m0, s17, 49152
    s_add_u32 s89, s19, 200704
    buffer_load_dwordx4 v4, s[32:35], s89 offen  lds
    s_waitcnt vmcnt(11)
    s_barrier
    s_add_u32 s97, s98, 7
    s_and_b32 s97, s97, 15
    s_lshr_b32 s99, s97, 3
    s_xor_b32 s97, s97, s99
    s_lshl_b32 s97, s97, 7
    s_add_u32 m0, s87, 18432
    s_add_u32 s89, s97, 0
    buffer_load_dwordx4 v2, s[28:31], s89 offen  lds
    s_mul_i32 s99, s97, 3072
    s_sub_u32 s19, s99, s18
    s_add_u32 s99, s99, s18
    s_add_u32 m0, s16, 8192
    s_add_u32 s89, s99, 0
    buffer_load_dwordx4 v4, s[32:35], s89 offen  lds
    s_add_u32 m0, s87, 22528
    s_add_u32 s89, s97, 65536
    buffer_load_dwordx4 v2, s[28:31], s89 offen  lds
    s_add_u32 m0, s16, 32768
    s_add_u32 s89, s99, 2048
    buffer_load_dwordx4 v4, s[32:35], s89 offen  lds
    s_add_u32 m0, s87, 26624
    s_add_u32 s89, s97, 131072
    buffer_load_dwordx4 v2, s[28:31], s89 offen  lds
    s_add_u32 m0, s16, 57344
    s_add_u32 s89, s99, 4096
    buffer_load_dwordx4 v4, s[32:35], s89 offen  lds
    s_add_u32 m0, s87, 30720
    s_add_u32 s89, s97, 196608
    buffer_load_dwordx4 v2, s[28:31], s89 offen  lds
    s_mov_b64 exec, 0xffffffff
    s_add_u32 m0, s88, 18432
    s_add_u32 s89, s97, 0
    buffer_load_dwordx4 v3, s[28:31], s89 offen  lds
    s_mov_b64 exec, -1
    s_add_u32 m0, s17, 8192
    s_add_u32 s89, s19, 196608
    buffer_load_dwordx4 v4, s[32:35], s89 offen  lds
    s_add_u32 m0, s17, 32768
    s_add_u32 s89, s19, 198656
    buffer_load_dwordx4 v4, s[32:35], s89 offen  lds
    s_add_u32 m0, s17, 57344
    s_add_u32 s89, s19, 200704
    buffer_load_dwordx4 v4, s[32:35], s89 offen  lds
    s_waitcnt vmcnt(11)
    s_barrier
    s_add_u32 s97, s98, 4
    s_and_b32 s97, s97, 15
    s_lshr_b32 s99, s97, 3
    s_xor_b32 s97, s97, s99
    s_lshl_b32 s97, s97, 7
    s_add_u32 m0, s87, 36864
    s_add_u32 s89, s97, 0
    buffer_load_dwordx4 v2, s[28:31], s89 offen  lds
    s_mul_i32 s99, s97, 3072
    s_sub_u32 s19, s99, s18
    s_add_u32 s99, s99, s18
    s_add_u32 m0, s16, 16384
    s_add_u32 s89, s99, 0
    buffer_load_dwordx4 v4, s[32:35], s89 offen  lds
    s_add_u32 m0, s87, 40960
    s_add_u32 s89, s97, 65536
    buffer_load_dwordx4 v2, s[28:31], s89 offen  lds
    s_add_u32 m0, s16, 40960
    s_add_u32 s89, s99, 2048
    buffer_load_dwordx4 v4, s[32:35], s89 offen  lds
    s_add_u32 m0, s87, 45056
    s_add_u32 s89, s97, 131072
    buffer_load_dwordx4 v2, s[28:31], s89 offen  lds
    s_add_u32 m0, s16, 65536
    s_add_u32 s89, s99, 4096
    buffer_load_dwordx4 v4, s[32:35], s89 offen  lds
    s_add_u32 m0, s87, 49152
    s_add_u32 s89, s97, 196608
    buffer_load_dwordx4 v2, s[28:31], s89 offen  lds
    s_mov_b64 exec, 0xffffffff
    s_add_u32 m0, s88, 36864
    s_add_u32 s89, s97, 0
    buffer_load_dwordx4 v3, s[28:31], s89 offen  lds
    s_mov_b64 exec, -1
    s_add_u32 m0, s17, 16384
    s_add_u32 s89, s19, 196608
    buffer_load_dwordx4 v4, s[32:35], s89 offen  lds
    s_add_u32 m0, s17, 40960
    s_add_u32 s89, s19, 198656
    buffer_load_dwordx4 v4, s[32:35], s89 offen  lds
    s_add_u32 m0, s17, 65536
    s_add_u32 s89, s19, 200704
    buffer_load_dwordx4 v4, s[32:35], s89 offen  lds
    s_waitcnt vmcnt(11)
    s_barrier
    s_add_u32 m0, s86, 129536
    s_mov_b32 s89, 0
    buffer_load_dwordx4 v10, s[36:39], s89 offen nt lds
    s_add_u32 m0, s86, 145920
    s_mov_b32 s89, 0
    buffer_load_dwordx4 v10, s[40:43], s89 offen nt lds
    s_add_u32 m0, s86, 133632
    s_mov_b32 s89, 65536
    buffer_load_dwordx4 v10, s[36:39], s89 offen nt lds
    s_add_u32 m0, s86, 150016
    s_mov_b32 s89, 65536
    buffer_load_dwordx4 v10, s[40:43], s89 offen nt lds
    s_add_u32 m0, s86, 137728
    s_mov_b32 s89, 131072
    buffer_load_dwordx4 v10, s[36:39], s89 offen nt lds
    s_add_u32 m0, s86, 154112
    s_mov_b32 s89, 131072
    buffer_load_dwordx4 v10, s[40:43], s89 offen nt lds
    s_add_u32 m0, s86, 141824
    s_mov_b32 s89, 196608
    buffer_load_dwordx4 v10, s[36:39], s89 offen nt lds
    s_add_u32 m0, s86, 158208
    s_mov_b32 s89, 196608
    buffer_load_dwordx4 v10, s[40:43], s89 offen nt lds
    s_mov_b64 exec, 0xff
    s_lshl_b32 s82, s3, 7
    s_add_u32 m0, s82, 129024
    s_mov_b32 s89, 0
    buffer_load_dwordx4 v11, s[36:39], s89 offen nt lds
    s_lshl_b32 s83, s74, 9
    s_add_u32 s83, s83, s82
    s_and_b32 s89, s3, 2
    s_lshl_b32 s89, s89, 3
    s_add_u32 s82, s82, s89
    s_add_u32 m0, s82, 162816
    s_add_u32 s89, s83, 0
    buffer_load_dwordx4 v15, s[44:47], s89 offen  lds
    s_mov_b64 exec, -1
    s_add_u32 s97, s98, 5
    s_and_b32 s97, s97, 15
    s_lshr_b32 s99, s97, 3
    s_xor_b32 s97, s97, s99
    s_lshl_b32 s97, s97, 7
    s_add_u32 m0, s87, 0
    s_add_u32 s89, s97, 0
    buffer_load_dwordx4 v2, s[28:31], s89 offen  lds
    s_mul_i32 s99, s97, 3072
    s_sub_u32 s19, s99, s18
    s_add_u32 s99, s99, s18
    s_add_u32 m0, s16, 0
    s_add_u32 s89, s99, 0
    buffer_load_dwordx4 v4, s[32:35], s89 offen  lds
    s_add_u32 m0, s87, 4096
    s_add_u32 s89, s97, 65536
    buffer_load_dwordx4 v2, s[28:31], s89 offen  lds
    s_add_u32 m0, s16, 24576
    s_add_u32 s89, s99, 2048
    buffer_load_dwordx4 v4, s[32:35], s89 offen  lds
    s_add_u32 m0, s87, 8192
    s_add_u32 s89, s97, 131072
    buffer_load_dwordx4 v2, s[28:31], s89 offen  lds
    s_waitcnt vmcnt(15)
    s_barrier
    s_add_u32 m0, s16, 49152
    s_add_u32 s89, s99, 4096
    buffer_load_dwordx4 v4, s[32:35], s89 offen  lds
    s_add_u32 m0, s87, 12288
    s_add_u32 s89, s97, 196608
    buffer_load_dwordx4 v2, s[28:31], s89 offen  lds
    s_mov_b64 exec, 0xffffffff
    s_add_u32 m0, s88, 0
    s_add_u32 s89, s97, 0
    buffer_load_dwordx4 v3, s[28:31], s89 offen  lds
    s_mov_b64 exec, -1
    s_add_u32 m0, s17, 0
    s_add_u32 s89, s19, 196608
    buffer_load_dwordx4 v4, s[32:35], s89 offen  lds
    s_add_u32 m0, s17, 24576
    s_add_u32 s89, s19, 198656
    buffer_load_dwordx4 v4, s[32:35], s89 offen  lds
    s_add_u32 m0, s17, 49152
    s_add_u32 s89, s19, 200704
    buffer_load_dwordx4 v4, s[32:35], s89 offen  lds
    s_add_u32 s97, s98, 6
    s_and_b32 s97, s97, 15
    s_lshr_b32 s99, s97, 3
    s_xor_b32 s97, s97, s99
    s_lshl_b32 s97, s97, 7
    s_add_u32 m0, s87, 18432
    s_add_u32 s89, s97, 0
    buffer_load_dwordx4 v2, s[28:31], s89 offen  lds
    s_mul_i32 s99, s97, 3072
    s_sub_u32 s19, s99, s18
    s_add_u32 s99, s99, s18
    s_add_u32 m0, s16, 8192
    s_add_u32 s89, s99, 0
    buffer_load_dwordx4 v4, s[32:35], s89 offen  lds
    s_add_u32 m0, s87, 22528
    s_add_u32 s89, s97, 65536
    buffer_load_dwordx4 v2, s[28:31], s89 offen  lds
    s_add_u32 m0, s16, 32768
    s_add_u32 s89, s99, 2048
    buffer_load_dwordx4 v4, s[32:35], s89 offen  lds
    s_add_u32 m0, s87, 26624
    s_add_u32 s89, s97, 131072
    buffer_load_dwordx4 v2, s[28:31], s89 offen  lds
    s_add_u32 m0, s16, 57344
    s_add_u32 s89, s99, 4096
    buffer_load_dwordx4 v4, s[32:35], s89 offen  lds
    s_add_u32 m0, s87, 30720
    s_add_u32 s89, s97, 196608
    buffer_load_dwordx4 v2, s[28:31], s89 offen  lds
    s_mov_b64 exec, 0xffffffff
    s_add_u32 m0, s88, 18432
    s_add_u32 s89, s97, 0
    buffer_load_dwordx4 v3, s[28:31], s89 offen  lds
    s_mov_b64 exec, -1
    s_waitcnt vmcnt(8)
    s_barrier
    s_add_u32 m0, s17, 8192
    s_add_u32 s89, s19, 196608
    buffer_load_dwordx4 v4, s[32:35], s89 offen  lds
    ds_read_b128 v[84:87], v35 offset:0
    ds_read_b128 v[88:91], v35 offset:16
    s_add_u32 m0, s17, 32768
    s_add_u32 s89, s19, 198656
    buffer_load_dwordx4 v4, s[32:35], s89 offen  lds
    ds_read_b128 v[92:95], v35 offset:32
    s_add_u32 m0, s17, 57344
    s_add_u32 s89, s19, 200704
    buffer_load_dwordx4 v4, s[32:35], s89 offen  lds
    ds_read_b128 v[96:99], v35 offset:48
    s_add_u32 s97, s98, 11
    s_and_b32 s97, s97, 15
    s_lshr_b32 s99, s97, 3
    s_xor_b32 s97, s97, s99
    s_lshl_b32 s97, s97, 7
    s_add_u32 m0, s87, 36864
    s_add_u32 s89, s97, 0
    buffer_load_dwordx4 v2, s[28:31], s89 offen  lds
    ds_read_b128 v[40:43], v233 offset:0
    s_mul_i32 s99, s97, 3072
    s_sub_u32 s19, s99, s18
    s_add_u32 s99, s99, s18
    s_add_u32 m0, s16, 16384
    s_add_u32 s89, s99, 0
    buffer_load_dwordx4 v4, s[32:35], s89 offen  lds
    ds_read_b128 v[44:47], v232 offset:256
    s_add_u32 m0, s87, 40960
    s_add_u32 s89, s97, 65536
    buffer_load_dwordx4 v2, s[28:31], s89 offen  lds
    ds_read_b128 v[48:51], v233 offset:256
    s_add_u32 m0, s16, 40960
    s_add_u32 s89, s99, 2048
    buffer_load_dwordx4 v4, s[32:35], s89 offen  lds
    ds_read_b128 v[52:55], v16 offset:512
    s_add_u32 m0, s87, 45056
    s_add_u32 s89, s97, 131072
    buffer_load_dwordx4 v2, s[28:31], s89 offen  lds
    ds_read_b128 v[56:59], v231 offset:512
    s_add_u32 m0, s16, 65536
    s_add_u32 s89, s99, 4096
    buffer_load_dwordx4 v4, s[32:35], s89 offen  lds
    ds_read_b128 v[60:63], v16 offset:768
    s_add_u32 m0, s87, 49152
    s_add_u32 s89, s97, 196608
    buffer_load_dwordx4 v2, s[28:31], s89 offen  lds
    ds_read_b128 v[64:67], v231 offset:768
    s_mov_b64 exec, 0xffffffff
    s_add_u32 m0, s88, 36864
    s_add_u32 s89, s97, 0
    buffer_load_dwordx4 v3, s[28:31], s89 offen  lds
    s_mov_b64 exec, -1
    ds_read_b128 v[68:71], v16 offset:16896
    s_add_u32 m0, s17, 16384
    s_add_u32 s89, s19, 196608
    buffer_load_dwordx4 v4, s[32:35], s89 offen  lds
    ds_read_b128 v[72:75], v231 offset:16896
    s_add_u32 m0, s17, 40960
    s_add_u32 s89, s19, 198656
    buffer_load_dwordx4 v4, s[32:35], s89 offen  lds
    ds_read_b128 v[76:79], v16 offset:17152
    s_add_u32 m0, s17, 65536
    s_add_u32 s89, s19, 200704
    buffer_load_dwordx4 v4, s[32:35], s89 offen  lds
    ds_read_b128 v[80:83], v231 offset:17152
    s_waitcnt vmcnt(11)
    s_waitcnt lgkmcnt(0)
    s_barrier
    s_add_u32 s97, s98, 8
    s_and_b32 s97, s97, 15
    s_lshr_b32 s99, s97, 3
    s_xor_b32 s97, s97, s99
    s_lshl_b32 s97, s97, 7
    s_add_u32 m0, s87, 0
    s_add_u32 s89, s97, 0
    buffer_load_dwordx4 v2, s[28:31], s89 offen  lds
    v_lshlrev_b32 v116, 16, v40
    v_lshlrev_b32 v117, 16, v44
    v_lshlrev_b32 v118, 16, v48
    v_lshlrev_b32 v119, 16, v52
    v_lshlrev_b32 v120, 16, v56
    v_lshlrev_b32 v121, 16, v60
    s_mul_i32 s99, s97, 3072
    s_sub_u32 s19, s99, s18
    s_add_u32 s99, s99, s18
    s_add_u32 m0, s16, 0
    s_add_u32 s89, s99, 0
    buffer_load_dwordx4 v4, s[32:35], s89 offen  lds
    v_lshlrev_b32 v122, 16, v64
    v_lshlrev_b32 v127, 16, v84
    v_and_b32 v128, 0xffff0000, v84
    v_lshlrev_b32 v129, 16, v85
    v_and_b32 v130, 0xffff0000, v85
    v_lshlrev_b32 v123, 16, v68
    s_add_u32 m0, s87, 4096
    s_add_u32 s89, s97, 65536
    buffer_load_dwordx4 v2, s[28:31], s89 offen  lds
    v_lshlrev_b32 v124, 16, v72
    v_lshlrev_b32 v125, 16, v76
    v_lshlrev_b32 v126, 16, v80
    v_mul_f32 v131, v116, v130
    v_mul_f32 v132, v117, v130
    s_add_u32 m0, s16, 24576
    s_add_u32 s89, s99, 2048
    buffer_load_dwordx4 v4, s[32:35], s89 offen  lds
    v_mul_f32 v133, v118, v130
    v_mul_f32 v134, v119, v130
    v_fmac_f32 v131, v117, v129
    v_fmac_f32 v132, v118, v129
    v_fmac_f32 v133, v119, v129
    v_fmac_f32 v134, v120, v129
    s_add_u32 m0, s87, 8192
    s_add_u32 s89, s97, 131072
    buffer_load_dwordx4 v2, s[28:31], s89 offen  lds
    v_fmac_f32 v131, v118, v128
    v_fmac_f32 v132, v119, v128
    v_fmac_f32 v133, v120, v128
    v_fmac_f32 v134, v121, v128
    v_fmac_f32 v131, v119, v127
    v_fmac_f32 v132, v120, v127
    s_add_u32 m0, s16, 49152
    s_add_u32 s89, s99, 4096
    buffer_load_dwordx4 v4, s[32:35], s89 offen  lds
    v_fmac_f32 v133, v121, v127
    v_fmac_f32 v134, v122, v127
    v_mul_f32 v131, v131, v123
    v_mul_f32 v132, v132, v124
    v_mul_f32 v133, v133, v125
    s_add_u32 m0, s87, 12288
    s_add_u32 s89, s97, 196608
    buffer_load_dwordx4 v2, s[28:31], s89 offen  lds
    v_mul_f32 v134, v134, v126
    v_cvt_pk_bf16_f32 v102, v134, v133
    v_cvt_pk_bf16_f32 v103, v132, v131
    v_lshlrev_b32 v116, 16, v42
    v_lshlrev_b32 v117, 16, v46
    v_lshlrev_b32 v118, 16, v50
    s_mov_b64 exec, 0xffffffff
    s_add_u32 m0, s88, 0
    s_add_u32 s89, s97, 0
    buffer_load_dwordx4 v3, s[28:31], s89 offen  lds
    s_mov_b64 exec, -1
    v_lshlrev_b32 v119, 16, v54
    v_lshlrev_b32 v120, 16, v58
    v_lshlrev_b32 v121, 16, v62
    v_lshlrev_b32 v122, 16, v66
    v_lshlrev_b32 v127, 16, v92
    v_and_b32 v128, 0xffff0000, v92
    s_add_u32 m0, s17, 0
    s_add_u32 s89, s19, 196608
    buffer_load_dwordx4 v4, s[32:35], s89 offen  lds
    v_lshlrev_b32 v129, 16, v93
    v_and_b32 v130, 0xffff0000, v93
    v_lshlrev_b32 v123, 16, v70
    v_lshlrev_b32 v124, 16, v74
    v_lshlrev_b32 v125, 16, v78
    s_add_u32 m0, s17, 24576
    s_add_u32 s89, s19, 198656
    buffer_load_dwordx4 v4, s[32:35], s89 offen  lds
    v_lshlrev_b32 v126, 16, v82
    v_mul_f32 v131, v116, v130
    v_mul_f32 v132, v117, v130
    v_mul_f32 v133, v118, v130
    v_mul_f32 v134, v119, v130
    v_fmac_f32 v131, v117, v129
    s_add_u32 m0, s17, 49152
    s_add_u32 s89, s19, 200704
    buffer_load_dwordx4 v4, s[32:35], s89 offen  lds
    v_fmac_f32 v132, v118, v129
    v_fmac_f32 v133, v119, v129
    v_fmac_f32 v134, v120, v129
    v_fmac_f32 v131, v118, v128
    v_fmac_f32 v132, v119, v128
    s_waitcnt vmcnt(11)
    s_barrier
    s_add_u32 s97, s98, 9
    s_and_b32 s97, s97, 15
    s_lshr_b32 s99, s97, 3
    s_xor_b32 s97, s97, s99
    s_lshl_b32 s97, s97, 7
    s_add_u32 m0, s87, 18432
    s_add_u32 s89, s97, 0
    buffer_load_dwordx4 v2, s[28:31], s89 offen  lds
    v_fmac_f32 v133, v120, v128
    v_fmac_f32 v134, v121, v128
    v_fmac_f32 v131, v119, v127
    v_fmac_f32 v132, v120, v127
    v_fmac_f32 v133, v121, v127
    v_fmac_f32 v134, v122, v127
    s_mul_i32 s99, s97, 3072
    s_sub_u32 s19, s99, s18
    s_add_u32 s99, s99, s18
    s_add_u32 m0, s16, 8192
    s_add_u32 s89, s99, 0
    buffer_load_dwordx4 v4, s[32:35], s89 offen  lds
    v_mul_f32 v131, v131, v123
    v_mul_f32 v132, v132, v124
    v_mul_f32 v133, v133, v125
    v_mul_f32 v134, v134, v126
    v_cvt_pk_bf16_f32 v100, v134, v133
    v_cvt_pk_bf16_f32 v101, v132, v131
    s_add_u32 m0, s87, 22528
    s_add_u32 s89, s97, 65536
    buffer_load_dwordx4 v2, s[28:31], s89 offen  lds
    v_permlane32_swap_b32 v102, v100
    v_permlane32_swap_b32 v103, v101
    s_mov_b32 s89, 0
    buffer_store_dwordx4 v[100:103], v12, s[52:55], s89 offen sc1
    v_and_b32 v116, 0xffff0000, v40
    v_and_b32 v117, 0xffff0000, v44
    s_add_u32 m0, s16, 32768
    s_add_u32 s89, s99, 2048
    buffer_load_dwordx4 v4, s[32:35], s89 offen  lds
    v_and_b32 v118, 0xffff0000, v48
    v_and_b32 v119, 0xffff0000, v52
    v_and_b32 v120, 0xffff0000, v56
    v_and_b32 v121, 0xffff0000, v60
    v_and_b32 v122, 0xffff0000, v64
    v_lshlrev_b32 v127, 16, v86
    s_add_u32 m0, s87, 26624
    s_add_u32 s89, s97, 131072
    buffer_load_dwordx4 v2, s[28:31], s89 offen  lds
    v_and_b32 v128, 0xffff0000, v86
    v_lshlrev_b32 v129, 16, v87
    v_and_b32 v130, 0xffff0000, v87
    v_and_b32 v123, 0xffff0000, v68
    v_and_b32 v124, 0xffff0000, v72
    v_and_b32 v125, 0xffff0000, v76
    s_add_u32 m0, s16, 57344
    s_add_u32 s89, s99, 4096
    buffer_load_dwordx4 v4, s[32:35], s89 offen  lds
    v_and_b32 v126, 0xffff0000, v80
    v_mul_f32 v131, v116, v130
    v_mul_f32 v132, v117, v130
    v_mul_f32 v133, v118, v130
    v_mul_f32 v134, v119, v130
    s_add_u32 m0, s87, 30720
    s_add_u32 s89, s97, 196608
    buffer_load_dwordx4 v2, s[28:31], s89 offen  lds
    v_fmac_f32 v131, v117, v129
    v_fmac_f32 v132, v118, v129
    v_fmac_f32 v133, v119, v129
    v_fmac_f32 v134, v120, v129
    v_fmac_f32 v131, v118, v128
    v_fmac_f32 v132, v119, v128
    s_mov_b64 exec, 0xffffffff
    s_add_u32 m0, s88, 18432
    s_add_u32 s89, s97, 0
    buffer_load_dwordx4 v3, s[28:31], s89 offen  lds
    s_mov_b64 exec, -1
    v_fmac_f32 v133, v120, v128
    v_fmac_f32 v134, v121, v128
    v_fmac_f32 v131, v119, v127
    v_fmac_f32 v132, v120, v127
    v_fmac_f32 v133, v121, v127
    v_fmac_f32 v134, v122, v127
    s_add_u32 m0, s17, 8192
    s_add_u32 s89, s19, 196608
    buffer_load_dwordx4 v4, s[32:35], s89 offen  lds
    v_mul_f32 v131, v131, v123
    v_mul_f32 v132, v132, v124
    v_mul_f32 v133, v133, v125
    v_mul_f32 v134, v134, v126
    v_cvt_pk_bf16_f32 v106, v134, v133
    s_add_u32 m0, s17, 32768
    s_add_u32 s89, s19, 198656
    buffer_load_dwordx4 v4, s[32:35], s89 offen  lds
    v_cvt_pk_bf16_f32 v107, v132, v131
    v_and_b32 v116, 0xffff0000, v42
    v_and_b32 v117, 0xffff0000, v46
    v_and_b32 v118, 0xffff0000, v50
    v_and_b32 v119, 0xffff0000, v54
    v_and_b32 v120, 0xffff0000, v58
    s_add_u32 m0, s17, 57344
    s_add_u32 s89, s19, 200704
    buffer_load_dwordx4 v4, s[32:35], s89 offen  lds
    v_and_b32 v121, 0xffff0000, v62
    v_and_b32 v122, 0xffff0000, v66
    v_lshlrev_b32 v127, 16, v94
    v_and_b32 v128, 0xffff0000, v94
    v_lshlrev_b32 v129, 16, v95
    s_waitcnt vmcnt(12)
    s_barrier
    s_add_u32 s97, s98, 10
    s_and_b32 s97, s97, 15
    s_lshr_b32 s99, s97, 3
    s_xor_b32 s97, s97, s99
    s_lshl_b32 s97, s97, 7
    s_add_u32 m0, s87, 36864
    s_add_u32 s89, s97, 0
    buffer_load_dwordx4 v2, s[28:31], s89 offen  lds
    v_and_b32 v130, 0xffff0000, v95
    v_and_b32 v123, 0xffff0000, v70
    v_and_b32 v124, 0xffff0000, v74
    v_and_b32 v125, 0xffff0000, v78
    v_and_b32 v126, 0xffff0000, v82
    v_mul_f32 v131, v116, v130
    s_mul_i32 s99, s97, 3072
    s_sub_u32 s19, s99, s18
    s_add_u32 s99, s99, s18
    s_add_u32 m0, s16, 16384
    s_add_u32 s89, s99, 0
    buffer_load_dwordx4 v4, s[32:35], s89 offen  lds
    v_mul_f32 v132, v117, v130
    v_mul_f32 v133, v118, v130
    v_mul_f32 v134, v119, v130
    v_fmac_f32 v131, v117, v129
    v_fmac_f32 v132, v118, v129
    v_fmac_f32 v133, v119, v129
    s_add_u32 m0, s87, 40960
    s_add_u32 s89, s97, 65536
    buffer_load_dwordx4 v2, s[28:31], s89 offen  lds
    v_fmac_f32 v134, v120, v129
    v_fmac_f32 v131, v118, v128
    v_fmac_f32 v132, v119, v128
    v_fmac_f32 v133, v120, v128
    v_fmac_f32 v134, v121, v128
    s_add_u32 m0, s16, 40960
    s_add_u32 s89, s99, 2048
    buffer_load_dwordx4 v4, s[32:35], s89 offen  lds
    v_fmac_f32 v131, v119, v127
    v_fmac_f32 v132, v120, v127
    v_fmac_f32 v133, v121, v127
    v_fmac_f32 v134, v122, v127
    v_mul_f32 v131, v131, v123
    v_mul_f32 v132, v132, v124
    s_add_u32 m0, s87, 45056
    s_add_u32 s89, s97, 131072
    buffer_load_dwordx4 v2, s[28:31], s89 offen  lds
    v_mul_f32 v133, v133, v125
    v_mul_f32 v134, v134, v126
    v_cvt_pk_bf16_f32 v104, v134, v133
    v_cvt_pk_bf16_f32 v105, v132, v131
    s_nop 0
    v_permlane32_swap_b32 v106, v104
    v_permlane32_swap_b32 v107, v105
    s_add_u32 m0, s16, 65536
    s_add_u32 s89, s99, 4096
    buffer_load_dwordx4 v4, s[32:35], s89 offen  lds
    s_mov_b32 s89, 16384
    buffer_store_dwordx4 v[104:107], v12, s[52:55], s89 offen sc1
    v_lshlrev_b32 v116, 16, v41
    v_lshlrev_b32 v117, 16, v45
    v_lshlrev_b32 v118, 16, v49
    v_lshlrev_b32 v119, 16, v53
    s_add_u32 m0, s87, 49152
    s_add_u32 s89, s97, 196608
    buffer_load_dwordx4 v2, s[28:31], s89 offen  lds
    v_lshlrev_b32 v120, 16, v57
    v_lshlrev_b32 v121, 16, v61
    v_lshlrev_b32 v122, 16, v65
    v_lshlrev_b32 v127, 16, v88
    v_and_b32 v128, 0xffff0000, v88
    v_lshlrev_b32 v129, 16, v89
    s_mov_b64 exec, 0xffffffff
    s_add_u32 m0, s88, 36864
    s_add_u32 s89, s97, 0
    buffer_load_dwordx4 v3, s[28:31], s89 offen  lds
    s_mov_b64 exec, -1
    v_and_b32 v130, 0xffff0000, v89
    v_lshlrev_b32 v123, 16, v69
    v_lshlrev_b32 v124, 16, v73
    v_lshlrev_b32 v125, 16, v77
    v_lshlrev_b32 v126, 16, v81
    v_mul_f32 v131, v116, v130
    s_add_u32 m0, s17, 16384
    s_add_u32 s89, s19, 196608
    buffer_load_dwordx4 v4, s[32:35], s89 offen  lds
    v_mul_f32 v132, v117, v130
    v_mul_f32 v133, v118, v130
    v_mul_f32 v134, v119, v130
    v_fmac_f32 v131, v117, v129
    v_fmac_f32 v132, v118, v129
    s_add_u32 m0, s17, 40960
    s_add_u32 s89, s19, 198656
    buffer_load_dwordx4 v4, s[32:35], s89 offen  lds
    v_fmac_f32 v133, v119, v129
    v_fmac_f32 v134, v120, v129
    v_fmac_f32 v131, v118, v128
    v_fmac_f32 v132, v119, v128
    v_fmac_f32 v133, v120, v128
    v_fmac_f32 v134, v121, v128
    s_add_u32 m0, s17, 65536
    s_add_u32 s89, s19, 200704
    buffer_load_dwordx4 v4, s[32:35], s89 offen  lds
    v_fmac_f32 v131, v119, v127
    v_fmac_f32 v132, v120, v127
    v_fmac_f32 v133, v121, v127
    v_fmac_f32 v134, v122, v127
    v_mul_f32 v131, v131, v123
    s_waitcnt vmcnt(12)
    s_barrier
    s_add_u32 m0, s94, 32
    s_lshl_b32 s89, s90, 12
    buffer_load_dwordx4 v15, s[48:51], s89 offen offset:0 nt lds
    v_mul_f32 v132, v132, v124
    v_mul_f32 v133, v133, v125
    v_mul_f32 v134, v134, v126
    v_cvt_pk_bf16_f32 v110, v134, v133
    v_cvt_pk_bf16_f32 v111, v132, v131
    s_add_u32 m0, s94, 32
    s_lshl_b32 s89, s90, 12
    buffer_load_dwordx4 v15, s[48:51], s89 offen offset:1024 nt lds
    v_lshlrev_b32 v116, 16, v43
    v_lshlrev_b32 v117, 16, v47
    v_lshlrev_b32 v118, 16, v51
    v_lshlrev_b32 v119, 16, v55
    s_add_u32 m0, s94, 32
    s_lshl_b32 s89, s90, 12
    buffer_load_dwordx4 v15, s[48:51], s89 offen offset:2048 nt lds
    v_lshlrev_b32 v120, 16, v59
    v_lshlrev_b32 v121, 16, v63
    v_lshlrev_b32 v122, 16, v67
    v_lshlrev_b32 v127, 16, v96
    v_and_b32 v128, 0xffff0000, v96
    s_add_u32 m0, s94, 32
    s_lshl_b32 s89, s90, 12
    buffer_load_dwordx4 v15, s[48:51], s89 offen offset:3072 nt lds
    v_lshlrev_b32 v129, 16, v97
    v_and_b32 v130, 0xffff0000, v97
    v_lshlrev_b32 v123, 16, v71
    v_lshlrev_b32 v124, 16, v75
    buffer_load_dwordx4 v[212:215], v9, s[56:59], 0 offen offset:0 nt
    v_lshlrev_b32 v125, 16, v79
    v_lshlrev_b32 v126, 16, v83
    v_mul_f32 v131, v116, v130
    v_mul_f32 v132, v117, v130
    v_mul_f32 v133, v118, v130
    buffer_load_dwordx4 v[216:219], v9, s[56:59], 0 offen offset:2048 nt
    v_mul_f32 v134, v119, v130
    v_fmac_f32 v131, v117, v129
    v_fmac_f32 v132, v118, v129
    v_fmac_f32 v133, v119, v129
    buffer_load_dwordx4 v[220:223], v9, s[56:59], s96 offen offset:0 nt
    v_fmac_f32 v134, v120, v129
    v_fmac_f32 v131, v118, v128
    v_fmac_f32 v132, v119, v128
    v_fmac_f32 v133, v120, v128
    buffer_load_dwordx4 v[224:227], v9, s[56:59], s96 offen offset:2048 nt
    v_fmac_f32 v134, v121, v128
    v_fmac_f32 v131, v119, v127
    v_fmac_f32 v132, v120, v127
    v_fmac_f32 v133, v121, v127
    v_fmac_f32 v134, v122, v127
    s_add_u32 s97, s98, 15
    s_and_b32 s97, s97, 15
    s_lshr_b32 s99, s97, 3
    s_xor_b32 s97, s97, s99
    s_lshl_b32 s97, s97, 7
    s_add_u32 m0, s87, 0
    s_add_u32 s89, s97, 0
    buffer_load_dwordx4 v2, s[28:31], s89 offen  lds
    v_mul_f32 v131, v131, v123
    v_mul_f32 v132, v132, v124
    v_mul_f32 v133, v133, v125
    v_mul_f32 v134, v134, v126
    s_mul_i32 s99, s97, 3072
    s_sub_u32 s19, s99, s18
    s_add_u32 s99, s99, s18
    s_add_u32 m0, s16, 0
    s_add_u32 s89, s99, 0
    buffer_load_dwordx4 v4, s[32:35], s89 offen  lds
    v_cvt_pk_bf16_f32 v108, v134, v133
    v_cvt_pk_bf16_f32 v109, v132, v131
    s_nop 0
    v_permlane32_swap_b32 v110, v108
    v_permlane32_swap_b32 v111, v109
    s_mov_b32 s89, 32768
    buffer_store_dwordx4 v[108:111], v12, s[52:55], s89 offen sc1
    s_add_u32 m0, s87, 4096
    s_add_u32 s89, s97, 65536
    buffer_load_dwordx4 v2, s[28:31], s89 offen  lds
    v_and_b32 v116, 0xffff0000, v41
    v_and_b32 v117, 0xffff0000, v45
    v_and_b32 v118, 0xffff0000, v49
    v_and_b32 v119, 0xffff0000, v53
    s_add_u32 m0, s16, 24576
    s_add_u32 s89, s99, 2048
    buffer_load_dwordx4 v4, s[32:35], s89 offen  lds
    v_and_b32 v120, 0xffff0000, v57
    v_and_b32 v121, 0xffff0000, v61
    v_and_b32 v122, 0xffff0000, v65
    v_lshlrev_b32 v127, 16, v90
    v_and_b32 v128, 0xffff0000, v90
    s_add_u32 m0, s87, 8192
    s_add_u32 s89, s97, 131072
    buffer_load_dwordx4 v2, s[28:31], s89 offen  lds
    v_lshlrev_b32 v129, 16, v91
    v_and_b32 v130, 0xffff0000, v91
    v_and_b32 v123, 0xffff0000, v69
    v_and_b32 v124, 0xffff0000, v73
    s_add_u32 m0, s16, 49152
    s_add_u32 s89, s99, 4096
    buffer_load_dwordx4 v4, s[32:35], s89 offen  lds
    v_and_b32 v125, 0xffff0000, v77
    v_and_b32 v126, 0xffff0000, v81
    v_mul_f32 v131, v116, v130
    v_mul_f32 v132, v117, v130
    s_waitcnt vmcnt(15)
    s_barrier
    s_add_u32 m0, s87, 12288
    s_add_u32 s89, s97, 196608
    buffer_load_dwordx4 v2, s[28:31], s89 offen  lds
    v_mul_f32 v133, v118, v130
    v_mul_f32 v134, v119, v130
    v_fmac_f32 v131, v117, v129
    v_fmac_f32 v132, v118, v129
    v_fmac_f32 v133, v119, v129
    s_mov_b64 exec, 0xffffffff
    s_add_u32 m0, s88, 0
    s_add_u32 s89, s97, 0
    buffer_load_dwordx4 v3, s[28:31], s89 offen  lds
    s_mov_b64 exec, -1
    v_fmac_f32 v134, v120, v129
    v_fmac_f32 v131, v118, v128
    v_fmac_f32 v132, v119, v128
    v_fmac_f32 v133, v120, v128
    s_add_u32 m0, s17, 0
    s_add_u32 s89, s19, 196608
    buffer_load_dwordx4 v4, s[32:35], s89 offen  lds
    v_fmac_f32 v134, v121, v128
    v_fmac_f32 v131, v119, v127
    v_fmac_f32 v132, v120, v127
    v_fmac_f32 v133, v121, v127
    s_add_u32 m0, s17, 24576
    s_add_u32 s89, s19, 198656
    buffer_load_dwordx4 v4, s[32:35], s89 offen  lds
    v_fmac_f32 v134, v122, v127
    v_mul_f32 v131, v131, v123
    v_mul_f32 v132, v132, v124
    v_mul_f32 v133, v133, v125
    v_mul_f32 v134, v134, v126
    s_add_u32 m0, s17, 49152
    s_add_u32 s89, s19, 200704
    buffer_load_dwordx4 v4, s[32:35], s89 offen  lds
    v_cvt_pk_bf16_f32 v114, v134, v133
    v_cvt_pk_bf16_f32 v115, v132, v131
    v_and_b32 v116, 0xffff0000, v43
    v_and_b32 v117, 0xffff0000, v47
    s_add_u32 s97, s98, 12
    s_and_b32 s97, s97, 15
    s_lshr_b32 s99, s97, 3
    s_xor_b32 s97, s97, s99
    s_lshl_b32 s97, s97, 7
    s_add_u32 m0, s87, 18432
    s_add_u32 s89, s97, 0
    buffer_load_dwordx4 v2, s[28:31], s89 offen  lds
    v_and_b32 v118, 0xffff0000, v51
    v_and_b32 v119, 0xffff0000, v55
    v_and_b32 v120, 0xffff0000, v59
    v_and_b32 v121, 0xffff0000, v63
    s_mul_i32 s99, s97, 3072
    s_sub_u32 s19, s99, s18
    s_add_u32 s99, s99, s18
    s_add_u32 m0, s16, 8192
    s_add_u32 s89, s99, 0
    buffer_load_dwordx4 v4, s[32:35], s89 offen  lds
    v_and_b32 v122, 0xffff0000, v67
    v_lshlrev_b32 v127, 16, v98
    v_and_b32 v128, 0xffff0000, v98
    v_lshlrev_b32 v129, 16, v99
    s_add_u32 m0, s87, 22528
    s_add_u32 s89, s97, 65536
    buffer_load_dwordx4 v2, s[28:31], s89 offen  lds
    v_and_b32 v130, 0xffff0000, v99
    v_and_b32 v123, 0xffff0000, v71
    v_and_b32 v124, 0xffff0000, v75
    v_and_b32 v125, 0xffff0000, v79
    v_and_b32 v126, 0xffff0000, v83
    s_add_u32 m0, s16, 32768
    s_add_u32 s89, s99, 2048
    buffer_load_dwordx4 v4, s[32:35], s89 offen  lds
    v_mul_f32 v131, v116, v130
    v_mul_f32 v132, v117, v130
    v_mul_f32 v133, v118, v130
    v_mul_f32 v134, v119, v130
    s_add_u32 m0, s87, 26624
    s_add_u32 s89, s97, 131072
    buffer_load_dwordx4 v2, s[28:31], s89 offen  lds
    v_fmac_f32 v131, v117, v129
    v_fmac_f32 v132, v118, v129
    v_fmac_f32 v133, v119, v129
    v_fmac_f32 v134, v120, v129
    s_add_u32 m0, s16, 57344
    s_add_u32 s89, s99, 4096
    buffer_load_dwordx4 v4, s[32:35], s89 offen  lds
    v_fmac_f32 v131, v118, v128
    v_fmac_f32 v132, v119, v128
    v_fmac_f32 v133, v120, v128
    v_fmac_f32 v134, v121, v128
    v_fmac_f32 v131, v119, v127
    s_add_u32 m0, s87, 30720
    s_add_u32 s89, s97, 196608
    buffer_load_dwordx4 v2, s[28:31], s89 offen  lds
    v_fmac_f32 v132, v120, v127
    v_fmac_f32 v133, v121, v127
    v_fmac_f32 v134, v122, v127
    v_mul_f32 v131, v131, v123
    s_mov_b64 exec, 0xffffffff
    s_add_u32 m0, s88, 18432
    s_add_u32 s89, s97, 0
    buffer_load_dwordx4 v3, s[28:31], s89 offen  lds
    s_mov_b64 exec, -1
    v_mul_f32 v132, v132, v124
    v_mul_f32 v133, v133, v125
    v_mul_f32 v134, v134, v126
    v_cvt_pk_bf16_f32 v112, v134, v133
    s_add_u32 m0, s17, 8192
    s_add_u32 s89, s19, 196608
    buffer_load_dwordx4 v4, s[32:35], s89 offen  lds
    v_cvt_pk_bf16_f32 v113, v132, v131
    v_permlane32_swap_b32 v114, v112
    s_nop 0
    v_permlane32_swap_b32 v115, v113
    s_mov_b32 s89, 49152
    buffer_store_dwordx4 v[112:115], v12, s[52:55], s89 offen sc1
    s_waitcnt vmcnt(10)
    s_waitcnt vmcnt(0)
    s_barrier
    s_add_u32 m0, s17, 32768
    s_add_u32 s89, s19, 198656
    buffer_load_dwordx4 v4, s[32:35], s89 offen  lds
    v_add_u32 v5, s94, v15
    ds_read_b128 v[140:143], v5 offset:32
    s_add_u32 m0, s17, 57344
    s_add_u32 s89, s19, 200704
    buffer_load_dwordx4 v4, s[32:35], s89 offen  lds
    ds_read_b32 v156, v5 offset:48
    s_add_u32 s97, s98, 13
    s_and_b32 s97, s97, 15
    s_lshr_b32 s99, s97, 3
    s_xor_b32 s97, s97, s99
    s_lshl_b32 s97, s97, 7
    s_add_u32 m0, s87, 36864
    s_add_u32 s89, s97, 0
    buffer_load_dwordx4 v2, s[28:31], s89 offen  lds
    ds_read_b128 v[144:147], v5 offset:1056
    s_mul_i32 s99, s97, 3072
    s_sub_u32 s19, s99, s18
    s_add_u32 s99, s99, s18
    s_add_u32 m0, s16, 16384
    s_add_u32 s89, s99, 0
    buffer_load_dwordx4 v4, s[32:35], s89 offen  lds
    ds_read_b32 v157, v5 offset:1072
    s_add_u32 m0, s87, 40960
    s_add_u32 s89, s97, 65536
    buffer_load_dwordx4 v2, s[28:31], s89 offen  lds
    ds_read_b128 v[148:151], v5 offset:2080
    s_add_u32 m0, s16, 40960
    s_add_u32 s89, s99, 2048
    buffer_load_dwordx4 v4, s[32:35], s89 offen  lds
    ds_read_b32 v158, v5 offset:2096
    s_add_u32 m0, s87, 45056
    s_add_u32 s89, s97, 131072
    buffer_load_dwordx4 v2, s[28:31], s89 offen  lds
    ds_read_b128 v[152:155], v5 offset:3104
    ds_read_b32 v159, v5 offset:3120
    s_add_u32 m0, s16, 65536
    s_add_u32 s89, s99, 4096
    buffer_load_dwordx4 v4, s[32:35], s89 offen  lds
    v_lshrrev_b32 v6, 3, v0
    s_add_u32 m0, s87, 49152
    s_add_u32 s89, s97, 196608
    buffer_load_dwordx4 v2, s[28:31], s89 offen  lds
    v_mul_u32_u24 v6, 4160, v6
    s_mov_b64 exec, 0xffffffff
    s_add_u32 m0, s88, 36864
    s_add_u32 s89, s97, 0
    buffer_load_dwordx4 v3, s[28:31], s89 offen  lds
    s_mov_b64 exec, -1
    v_and_b32 v7, 7, v0
    s_add_u32 m0, s17, 16384
    s_add_u32 s89, s19, 196608
    buffer_load_dwordx4 v4, s[32:35], s89 offen  lds
    v_lshl_add_u32 v6, v7, 2, v6
    s_add_u32 m0, s17, 40960
    s_add_u32 s89, s19, 198656
    buffer_load_dwordx4 v4, s[32:35], s89 offen  lds
    v_add_u32 v6, s94, v6
    s_add_u32 m0, s17, 65536
    s_add_u32 s89, s19, 200704
    buffer_load_dwordx4 v4, s[32:35], s89 offen  lds
    v_mov_b32 v7, 0
    s_waitcnt vmcnt(11)
    s_barrier
    buffer_load_dword v230, v229, s[64:67], 0 offen
    s_waitcnt lgkmcnt(0)
    v_readfirstlane_b32 s93, v140
    s_add_u32 s97, s98, 14
    s_and_b32 s97, s97, 15
    s_lshr_b32 s99, s97, 3
    s_xor_b32 s97, s97, s99
    s_lshl_b32 s97, s97, 7
    s_add_u32 m0, s87, 0
    s_add_u32 s89, s97, 0
    buffer_load_dwordx4 v2, s[28:31], s89 offen  lds
    s_lshl_b32 s93, s93, 16
    v_writelane_b32 v7, s93, 15
    s_mul_i32 s99, s97, 3072
    s_sub_u32 s19, s99, s18
    s_add_u32 s99, s99, s18
    s_add_u32 m0, s16, 0
    s_add_u32 s89, s99, 0
    buffer_load_dwordx4 v4, s[32:35], s89 offen  lds
    v_alignbit_b32 v140, v141, v140, 16
    v_alignbit_b32 v141, v142, v141, 16
    s_add_u32 m0, s87, 4096
    s_add_u32 s89, s97, 65536
    buffer_load_dwordx4 v2, s[28:31], s89 offen  lds
    v_alignbit_b32 v142, v143, v142, 16
    v_alignbit_b32 v143, v156, v143, 16
    s_add_u32 m0, s16, 24576
    s_add_u32 s89, s99, 2048
    buffer_load_dwordx4 v4, s[32:35], s89 offen  lds
    v_alignbit_b32 v144, v145, v144, 16
    v_alignbit_b32 v145, v146, v145, 16
    s_add_u32 m0, s87, 8192
    s_add_u32 s89, s97, 131072
    buffer_load_dwordx4 v2, s[28:31], s89 offen  lds
    v_alignbit_b32 v146, v147, v146, 16
    v_alignbit_b32 v147, v157, v147, 16
    s_add_u32 m0, s16, 49152
    s_add_u32 s89, s99, 4096
    buffer_load_dwordx4 v4, s[32:35], s89 offen  lds
    v_alignbit_b32 v148, v149, v148, 16
    v_alignbit_b32 v149, v150, v149, 16
    s_add_u32 m0, s87, 12288
    s_add_u32 s89, s97, 196608
    buffer_load_dwordx4 v2, s[28:31], s89 offen  lds
    v_alignbit_b32 v150, v151, v150, 16
    v_alignbit_b32 v151, v158, v151, 16
    s_mov_b64 exec, 0xffffffff
    s_add_u32 m0, s88, 0
    s_add_u32 s89, s97, 0
    buffer_load_dwordx4 v3, s[28:31], s89 offen  lds
    s_mov_b64 exec, -1
    v_alignbit_b32 v152, v153, v152, 16
    v_alignbit_b32 v153, v154, v153, 16
    s_add_u32 m0, s17, 0
    s_add_u32 s89, s19, 196608
    buffer_load_dwordx4 v4, s[32:35], s89 offen  lds
    v_alignbit_b32 v154, v155, v154, 16
    v_alignbit_b32 v155, v159, v155, 16
    s_add_u32 m0, s17, 24576
    s_add_u32 s89, s19, 198656
    buffer_load_dwordx4 v4, s[32:35], s89 offen  lds
    v_lshlrev_b32 v8, 3, v0
    s_add_u32 s78, s88, 18432
    s_add_u32 m0, s17, 49152
    s_add_u32 s89, s19, 200704
    buffer_load_dwordx4 v4, s[32:35], s89 offen  lds
    v_add_u32 v8, s78, v8
    v_mov_b32 v156, 0
    s_mov_b64 exec, 0xff
    buffer_load_dword v136, v33, s[68:71], 0 offen sc1
    buffer_load_dword v137, v34, s[52:55], 0 offen sc1
    s_mov_b64 exec, -1
    v_mov_b32 v157, 0
    s_waitcnt vmcnt(14)
    s_barrier
    s_waitcnt vmcnt(0)
LA_j:
    s_mov_b64 exec, 0xff
    v_cmp_ne_u32 vcc, v136, v137
    v_cmp_gt_u32 s[80:81], s96, v136
    s_nop 0
    s_or_b64 vcc, vcc, s[80:81]
    s_mov_b64 exec, -1
    s_mov_b64 s[82:83], vcc
    s_cbranch_vccnz LA_nox
    s_add_u32 m0, s86, 94208
    s_add_u32 s89, s91, 0
    buffer_load_dwordx4 v14, s[52:55], s89 offen sc1 lds
    s_add_u32 m0, s86, 98304
    s_add_u32 s89, s91, 4096
    buffer_load_dwordx4 v14, s[52:55], s89 offen sc1 lds
    s_add_u32 m0, s86, 102400
    s_add_u32 s89, s91, 8192
    buffer_load_dwordx4 v14, s[52:55], s89 offen sc1 lds
    s_add_u32 m0, s86, 106496
    s_add_u32 s89, s91, 12288
    buffer_load_dwordx4 v14, s[52:55], s89 offen sc1 lds
LA_nox:
    s_mov_b64 exec, 0xffff
    ds_write_b32 v6, v7
    s_mov_b64 exec, -1
    ds_write_b128 v5, v[140:143] offset:4192
    ds_write_b128 v5, v[144:147] offset:5216
    ds_write_b128 v5, v[148:151] offset:6240
    ds_write_b128 v5, v[152:155] offset:7264
    ds_write_b64 v8, v[156:157]
    s_barrier
    s_cmp_lg_u64 s[82:83], 0
    s_cbranch_scc1 LA_slow
LA_back:
    s_add_u32 s89, s100, 0
    s_add_u32 m0, s86, 8192
    s_and_b32 s89, s89, 0x1f0000
    buffer_load_dwordx4 v228, s[64:67], s89 offen  lds
    s_add_u32 s89, s100, 65536
    s_add_u32 m0, s86, 12288
    s_and_b32 s89, s89, 0x1f0000
    buffer_load_dwordx4 v228, s[64:67], s89 offen  lds
    s_add_u32 s89, s100, 131072
    s_add_u32 m0, s86, 32768
    s_and_b32 s89, s89, 0x1f0000
    buffer_load_dwordx4 v228, s[64:67], s89 offen  lds
    s_add_u32 s89, s100, 196608
    s_add_u32 m0, s86, 36864
    s_and_b32 s89, s89, 0x1f0000
    buffer_load_dwordx4 v228, s[64:67], s89 offen  lds
    s_waitcnt vmcnt(4)
    s_mov_b64 exec, 1
    ds_add_u32 v18, v19 offset:20
    s_mov_b64 exec, -1
    s_add_u32 s89, s100, 262144
    s_add_u32 m0, s86, 57344
    s_and_b32 s89, s89, 0x1f0000
    buffer_load_dwordx4 v228, s[64:67], s89 offen  lds
    ds_read2_b32 v[68:69], v21 offset0:0 offset1:1
    ds_read2_b32 v[70:71], v21 offset0:2 offset1:3
    s_add_u32 s89, s100, 327680
    s_add_u32 m0, s86, 61440
    s_and_b32 s89, s89, 0x1f0000
    buffer_load_dwordx4 v228, s[64:67], s89 offen  lds
    ds_read2_b32 v[72:73], v21 offset0:128 offset1:129
    ds_read2_b32 v[74:75], v21 offset0:130 offset1:131
    s_add_u32 s89, s100, 393216
    s_add_u32 m0, s86, 16384
    s_and_b32 s89, s89, 0x1f0000
    buffer_load_dwordx4 v228, s[64:67], s89 offen  lds
    ds_read2_b32 v[76:77], v22 offset0:0 offset1:1
    ds_read2_b32 v[78:79], v22 offset0:2 offset1:3
    s_add_u32 s89, s100, 458752
    s_add_u32 m0, s86, 20480
    s_and_b32 s89, s89, 0x1f0000
    buffer_load_dwordx4 v228, s[64:67], s89 offen  lds
    ds_read2_b32 v[80:81], v22 offset0:128 offset1:129
    ds_read2_b32 v[82:83], v22 offset0:130 offset1:131
    s_add_u32 s89, s100, 524288
    s_add_u32 m0, s86, 40960
    s_and_b32 s89, s89, 0x1f0000
    buffer_load_dwordx4 v228, s[64:67], s89 offen  lds
    ds_read2_b32 v[84:85], v23 offset0:0 offset1:1
    ds_read2_b32 v[86:87], v23 offset0:2 offset1:3
    s_add_u32 s89, s100, 589824
    s_add_u32 m0, s86, 45056
    s_and_b32 s89, s89, 0x1f0000
    buffer_load_dwordx4 v228, s[64:67], s89 offen  lds
    ds_read2_b32 v[88:89], v23 offset0:128 offset1:129
    ds_read2_b32 v[90:91], v23 offset0:130 offset1:131
    s_add_u32 s89, s100, 655360
    s_add_u32 m0, s86, 65536
    s_and_b32 s89, s89, 0x1f0000
    buffer_load_dwordx4 v228, s[64:67], s89 offen  lds
    ds_read2_b32 v[92:93], v24 offset0:0 offset1:1
    ds_read2_b32 v[94:95], v24 offset0:2 offset1:3
    s_add_u32 s89, s100, 720896
    s_add_u32 m0, s86, 69632
    s_and_b32 s89, s89, 0x1f0000
    buffer_load_dwordx4 v228, s[64:67], s89 offen  lds
    ds_read2_b32 v[96:97], v24 offset0:128 offset1:129
    ds_read2_b32 v[98:99], v24 offset0:130 offset1:131
    s_branch LA_s5_in
LA_s5:
    s_sleep 1
LA_s5_in:
    ds_read_b32 v6, v18 offset:20
    ds_read_b128 v[100:103], v25 offset:0
    ds_read_b128 v[104:107], v25 offset:2048
    ds_read_b128 v[108:111], v25 offset:4096
    ds_read_b128 v[112:115], v25 offset:6144
    ds_read_b128 v[116:119], v25 offset:8192
    ds_read_b128 v[120:123], v25 offset:10240
    ds_read_b128 v[124:127], v25 offset:12288
    ds_read_b128 v[128:131], v25 offset:14336
    s_waitcnt lgkmcnt(0)
    v_readfirstlane_b32 s78, v6
    s_nop 0
    s_cmp_ge_u32 s78, 4
    s_cbranch_scc0 LA_s5
    s_waitcnt vmcnt(4)
    s_mov_b64 exec, 1
    ds_add_u32 v18, v19 offset:8
    s_mov_b64 exec, -1
    s_branch LA_s6_in
LA_s6:
    s_sleep 1
LA_s6_in:
    ds_read_b32 v6, v18 offset:24
    s_waitcnt lgkmcnt(0)
    v_readfirstlane_b32 s78, v6
    s_nop 0
    s_cmp_ge_u32 s78, 4
    s_cbranch_scc0 LA_s6
    s_setprio 2
    v_mfma_f32_16x16x32_bf16 v[36:39], v[236:239], v[100:103], 0
    ds_read2_b32 v[132:133], v21 offset0:16 offset1:17
    s_add_u32 s89, s100, 786432
    v_mfma_f32_16x16x32_bf16 v[40:43], v[236:239], v[104:107], 0
    ds_read2_b32 v[134:135], v21 offset0:18 offset1:19
    s_add_u32 m0, s86, 120832
    v_mfma_f32_16x16x32_bf16 v[44:47], v[236:239], v[108:111], 0
    v_mfma_f32_16x16x32_bf16 v[48:51], v[236:239], v[112:115], 0
    ds_read_b128 v[164:167], v26 offset:0
    s_and_b32 s89, s89, 0x1f0000
    v_mfma_f32_16x16x32_bf16 v[52:55], v[236:239], v[116:119], 0
    v_mfma_f32_16x16x32_bf16 v[56:59], v[236:239], v[120:123], 0
    ds_read_b128 v[168:171], v26 offset:2048
    buffer_load_dwordx4 v228, s[64:67], s89 offen  lds
    v_mfma_f32_16x16x32_bf16 v[60:63], v[236:239], v[124:127], 0
    ds_read_b128 v[172:175], v26 offset:4096
    v_mfma_f32_16x16x32_bf16 v[64:67], v[236:239], v[128:131], 0
    s_add_u32 s89, s100, 851968
    v_mfma_f32_16x16x32_bf16 v[36:39], v[68:71], v[100:103], v[36:39]
    ds_read_b128 v[176:179], v26 offset:6144
    v_mfma_f32_16x16x32_bf16 v[40:43], v[68:71], v[104:107], v[40:43]
    s_add_u32 m0, s86, 124928
    v_mfma_f32_16x16x32_bf16 v[44:47], v[68:71], v[108:111], v[44:47]
    ds_read_b128 v[180:183], v26 offset:8192
    v_mfma_f32_16x16x32_bf16 v[48:51], v[68:71], v[112:115], v[48:51]
    ds_read_b128 v[184:187], v26 offset:10240
    s_and_b32 s89, s89, 0x1f0000
    v_mfma_f32_16x16x32_bf16 v[52:55], v[68:71], v[116:119], v[52:55]
    buffer_load_dwordx4 v228, s[64:67], s89 offen  lds
    v_mfma_f32_16x16x32_bf16 v[56:59], v[68:71], v[120:123], v[56:59]
    ds_read_b128 v[188:191], v26 offset:12288
    v_mfma_f32_16x16x32_bf16 v[60:63], v[68:71], v[124:127], v[60:63]
    s_add_u32 s89, s100, 917504
    v_mfma_f32_16x16x32_bf16 v[64:67], v[68:71], v[128:131], v[64:67]
    ds_read_b128 v[192:195], v26 offset:14336
    v_mfma_f32_16x16x32_bf16 v[40:43], v[72:75], v[100:103], v[40:43]
    ds_read2_b32 v[136:137], v21 offset0:144 offset1:145
    s_add_u32 m0, s86, 0
    v_mfma_f32_16x16x32_bf16 v[44:47], v[72:75], v[104:107], v[44:47]
    v_mfma_f32_16x16x32_bf16 v[48:51], v[72:75], v[108:111], v[48:51]
    ds_read2_b32 v[138:139], v21 offset0:146 offset1:147
    s_and_b32 s89, s89, 0x1f0000
    v_mfma_f32_16x16x32_bf16 v[52:55], v[72:75], v[112:115], v[52:55]
    v_mfma_f32_16x16x32_bf16 v[56:59], v[72:75], v[116:119], v[56:59]
    ds_read2_b32 v[140:141], v22 offset0:16 offset1:17
    buffer_load_dwordx4 v228, s[64:67], s89 offen  lds
    v_mfma_f32_16x16x32_bf16 v[60:63], v[72:75], v[120:123], v[60:63]
    ds_read2_b32 v[142:143], v22 offset0:18 offset1:19
    v_mfma_f32_16x16x32_bf16 v[64:67], v[72:75], v[124:127], v[64:67]
    s_add_u32 s89, s100, 983040
    v_mfma_f32_16x16x32_bf16 v[44:47], v[76:79], v[100:103], v[44:47]
    ds_read2_b32 v[144:145], v22 offset0:144 offset1:145
    s_add_u32 m0, s86, 4096
    v_mfma_f32_16x16x32_bf16 v[48:51], v[76:79], v[104:107], v[48:51]
    v_mfma_f32_16x16x32_bf16 v[52:55], v[76:79], v[108:111], v[52:55]
    ds_read2_b32 v[146:147], v22 offset0:146 offset1:147
    s_and_b32 s89, s89, 0x1f0000
    v_mfma_f32_16x16x32_bf16 v[56:59], v[76:79], v[112:115], v[56:59]
    ds_read2_b32 v[148:149], v23 offset0:16 offset1:17
    v_mfma_f32_16x16x32_bf16 v[60:63], v[76:79], v[116:119], v[60:63]
    buffer_load_dwordx4 v228, s[64:67], s89 offen  lds
    v_mfma_f32_16x16x32_bf16 v[64:67], v[76:79], v[120:123], v[64:67]
    ds_read2_b32 v[150:151], v23 offset0:18 offset1:19
    v_mfma_f32_16x16x32_bf16 v[48:51], v[80:83], v[100:103], v[48:51]
    s_add_u32 s89, s100, 1048576
    v_mfma_f32_16x16x32_bf16 v[52:55], v[80:83], v[104:107], v[52:55]
    ds_read2_b32 v[152:153], v23 offset0:144 offset1:145
    v_mfma_f32_16x16x32_bf16 v[56:59], v[80:83], v[108:111], v[56:59]
    ds_read2_b32 v[154:155], v23 offset0:146 offset1:147
    s_add_u32 m0, s86, 24576
    v_mfma_f32_16x16x32_bf16 v[60:63], v[80:83], v[112:115], v[60:63]
    v_mfma_f32_16x16x32_bf16 v[64:67], v[80:83], v[116:119], v[64:67]
    ds_read2_b32 v[156:157], v24 offset0:16 offset1:17
    s_and_b32 s89, s89, 0x1f0000
    v_mfma_f32_16x16x32_bf16 v[52:55], v[84:87], v[100:103], v[52:55]
    buffer_load_dwordx4 v228, s[64:67], s89 offen  lds
    v_mfma_f32_16x16x32_bf16 v[56:59], v[84:87], v[104:107], v[56:59]
    ds_read2_b32 v[158:159], v24 offset0:18 offset1:19
    v_mfma_f32_16x16x32_bf16 v[60:63], v[84:87], v[108:111], v[60:63]
    ds_read2_b32 v[160:161], v24 offset0:144 offset1:145
    s_add_u32 s89, s100, 1114112
    v_mfma_f32_16x16x32_bf16 v[64:67], v[84:87], v[112:115], v[64:67]
    v_mfma_f32_16x16x32_bf16 v[56:59], v[88:91], v[100:103], v[56:59]
    ds_read2_b32 v[162:163], v24 offset0:146 offset1:147
    s_add_u32 m0, s86, 28672
    v_mfma_f32_16x16x32_bf16 v[60:63], v[88:91], v[104:107], v[60:63]
    v_mfma_f32_16x16x32_bf16 v[64:67], v[88:91], v[108:111], v[64:67]
    s_and_b32 s89, s89, 0x1f0000
    v_mfma_f32_16x16x32_bf16 v[60:63], v[92:95], v[100:103], v[60:63]
    v_mfma_f32_16x16x32_bf16 v[64:67], v[92:95], v[104:107], v[64:67]
    buffer_load_dwordx4 v228, s[64:67], s89 offen  lds
    v_mfma_f32_16x16x32_bf16 v[64:67], v[96:99], v[100:103], v[64:67]
    s_waitcnt lgkmcnt(14)
    v_mfma_f32_16x16x32_bf16 v[36:39], v[132:135], v[164:167], v[36:39]
    ds_read2_b32 v[68:69], v21 offset0:32 offset1:33
    s_add_u32 s89, s100, 1179648
    v_mfma_f32_16x16x32_bf16 v[40:43], v[132:135], v[168:171], v[40:43]
    ds_read2_b32 v[70:71], v21 offset0:34 offset1:35
    s_add_u32 m0, s86, 49152
    v_mfma_f32_16x16x32_bf16 v[44:47], v[132:135], v[172:175], v[44:47]
    ds_read_b128 v[100:103], v27 offset:0
    v_mfma_f32_16x16x32_bf16 v[48:51], v[132:135], v[176:179], v[48:51]
    s_and_b32 s89, s89, 0x1f0000
    v_mfma_f32_16x16x32_bf16 v[52:55], v[132:135], v[180:183], v[52:55]
    ds_read_b128 v[104:107], v27 offset:2048
    buffer_load_dwordx4 v228, s[64:67], s89 offen  lds
    v_mfma_f32_16x16x32_bf16 v[56:59], v[132:135], v[184:187], v[56:59]
    ds_read_b128 v[108:111], v27 offset:4096
    v_mfma_f32_16x16x32_bf16 v[60:63], v[132:135], v[188:191], v[60:63]
    ds_read_b128 v[112:115], v27 offset:6144
    s_add_u32 s89, s100, 1245184
    v_mfma_f32_16x16x32_bf16 v[64:67], v[132:135], v[192:195], v[64:67]
    s_add_u32 m0, s86, 53248
    s_waitcnt lgkmcnt(14)
    v_mfma_f32_16x16x32_bf16 v[40:43], v[136:139], v[164:167], v[40:43]
    ds_read_b128 v[116:119], v27 offset:8192
    v_mfma_f32_16x16x32_bf16 v[44:47], v[136:139], v[168:171], v[44:47]
    ds_read_b128 v[120:123], v27 offset:10240
    s_and_b32 s89, s89, 0x1f0000
    v_mfma_f32_16x16x32_bf16 v[48:51], v[136:139], v[172:175], v[48:51]
    ds_read_b128 v[124:127], v27 offset:12288
    buffer_load_dwordx4 v228, s[64:67], s89 offen  lds
    v_mfma_f32_16x16x32_bf16 v[52:55], v[136:139], v[176:179], v[52:55]
    v_mfma_f32_16x16x32_bf16 v[56:59], v[136:139], v[180:183], v[56:59]
    ds_read_b128 v[128:131], v27 offset:14336
    s_add_u32 s89, s100, 1310720
    v_mfma_f32_16x16x32_bf16 v[60:63], v[136:139], v[184:187], v[60:63]
    ds_read2_b32 v[72:73], v21 offset0:160 offset1:161
    s_add_u32 m0, s86, 73728
    v_mfma_f32_16x16x32_bf16 v[64:67], v[136:139], v[188:191], v[64:67]
    ds_read2_b32 v[74:75], v21 offset0:162 offset1:163
    v_mfma_f32_16x16x32_bf16 v[44:47], v[140:143], v[164:167], v[44:47]
    s_and_b32 s89, s89, 0x1f0000
    v_mfma_f32_16x16x32_bf16 v[48:51], v[140:143], v[168:171], v[48:51]
    ds_read2_b32 v[76:77], v22 offset0:32 offset1:33
    buffer_load_dwordx4 v228, s[64:67], s89 offen  lds
    v_mfma_f32_16x16x32_bf16 v[52:55], v[140:143], v[172:175], v[52:55]
    ds_read2_b32 v[78:79], v22 offset0:34 offset1:35
    v_mfma_f32_16x16x32_bf16 v[56:59], v[140:143], v[176:179], v[56:59]
    ds_read2_b32 v[80:81], v22 offset0:160 offset1:161
    s_add_u32 s89, s100, 1376256
    v_mfma_f32_16x16x32_bf16 v[60:63], v[140:143], v[180:183], v[60:63]
    s_add_u32 m0, s86, 77824
    v_mfma_f32_16x16x32_bf16 v[64:67], v[140:143], v[184:187], v[64:67]
    ds_read2_b32 v[82:83], v22 offset0:162 offset1:163
    v_mfma_f32_16x16x32_bf16 v[48:51], v[144:147], v[164:167], v[48:51]
    ds_read2_b32 v[84:85], v23 offset0:32 offset1:33
    s_and_b32 s89, s89, 0x1f0000
    v_mfma_f32_16x16x32_bf16 v[52:55], v[144:147], v[168:171], v[52:55]
    ds_read2_b32 v[86:87], v23 offset0:34 offset1:35
    buffer_load_dwordx4 v228, s[64:67], s89 offen  lds
    v_mfma_f32_16x16x32_bf16 v[56:59], v[144:147], v[172:175], v[56:59]
    v_mfma_f32_16x16x32_bf16 v[60:63], v[144:147], v[176:179], v[60:63]
    ds_read2_b32 v[88:89], v23 offset0:160 offset1:161
    s_add_u32 s89, s100, 1441792
    v_mfma_f32_16x16x32_bf16 v[64:67], v[144:147], v[180:183], v[64:67]
    ds_read2_b32 v[90:91], v23 offset0:162 offset1:163
    s_add_u32 m0, s86, 81920
    s_waitcnt lgkmcnt(14)
    v_mfma_f32_16x16x32_bf16 v[52:55], v[148:151], v[164:167], v[52:55]
    ds_read2_b32 v[92:93], v24 offset0:32 offset1:33
    v_mfma_f32_16x16x32_bf16 v[56:59], v[148:151], v[168:171], v[56:59]
    s_and_b32 s89, s89, 0x1f0000
    v_mfma_f32_16x16x32_bf16 v[60:63], v[148:151], v[172:175], v[60:63]
    ds_read2_b32 v[94:95], v24 offset0:34 offset1:35
    buffer_load_dwordx4 v228, s[64:67], s89 offen  lds
    v_mfma_f32_16x16x32_bf16 v[64:67], v[148:151], v[176:179], v[64:67]
    ds_read2_b32 v[96:97], v24 offset0:160 offset1:161
    v_mfma_f32_16x16x32_bf16 v[56:59], v[152:155], v[164:167], v[56:59]
    ds_read2_b32 v[98:99], v24 offset0:162 offset1:163
    s_add_u32 s89, s100, 1507328
    v_mfma_f32_16x16x32_bf16 v[60:63], v[152:155], v[168:171], v[60:63]
    s_add_u32 m0, s86, 86016
    v_mfma_f32_16x16x32_bf16 v[64:67], v[152:155], v[172:175], v[64:67]
    v_mfma_f32_16x16x32_bf16 v[60:63], v[156:159], v[164:167], v[60:63]
    s_and_b32 s89, s89, 0x1f0000
    v_mfma_f32_16x16x32_bf16 v[64:67], v[156:159], v[168:171], v[64:67]
    buffer_load_dwordx4 v228, s[64:67], s89 offen  lds
    v_mfma_f32_16x16x32_bf16 v[64:67], v[160:163], v[164:167], v[64:67]
    v_mfma_f32_16x16x32_bf16 v[36:39], v[68:71], v[100:103], v[36:39]
    ds_read2_b32 v[132:133], v21 offset0:48 offset1:49
    v_mfma_f32_16x16x32_bf16 v[40:43], v[68:71], v[104:107], v[40:43]
    ds_read2_b32 v[134:135], v21 offset0:50 offset1:51
    v_mfma_f32_16x16x32_bf16 v[44:47], v[68:71], v[108:111], v[44:47]
    ds_read_b128 v[164:167], v28 offset:0
    v_mfma_f32_16x16x32_bf16 v[48:51], v[68:71], v[112:115], v[48:51]
    s_waitcnt lgkmcnt(14)
    v_mfma_f32_16x16x32_bf16 v[52:55], v[68:71], v[116:119], v[52:55]
    ds_read_b128 v[168:171], v28 offset:2048
    v_mfma_f32_16x16x32_bf16 v[56:59], v[68:71], v[120:123], v[56:59]
    ds_read_b128 v[172:175], v28 offset:4096
    v_mfma_f32_16x16x32_bf16 v[60:63], v[68:71], v[124:127], v[60:63]
    ds_read_b128 v[176:179], v28 offset:6144
    v_mfma_f32_16x16x32_bf16 v[64:67], v[68:71], v[128:131], v[64:67]
    v_mfma_f32_16x16x32_bf16 v[40:43], v[72:75], v[100:103], v[40:43]
    ds_read_b128 v[180:183], v28 offset:8192
    v_mfma_f32_16x16x32_bf16 v[44:47], v[72:75], v[104:107], v[44:47]
    ds_read_b128 v[184:187], v28 offset:10240
    v_mfma_f32_16x16x32_bf16 v[48:51], v[72:75], v[108:111], v[48:51]
    ds_read_b128 v[188:191], v28 offset:12288
    v_mfma_f32_16x16x32_bf16 v[52:55], v[72:75], v[112:115], v[52:55]
    v_mfma_f32_16x16x32_bf16 v[56:59], v[72:75], v[116:119], v[56:59]
    ds_read_b128 v[192:195], v28 offset:14336
    v_mfma_f32_16x16x32_bf16 v[60:63], v[72:75], v[120:123], v[60:63]
    ds_read2_b32 v[136:137], v21 offset0:176 offset1:177
    v_mfma_f32_16x16x32_bf16 v[64:67], v[72:75], v[124:127], v[64:67]
    ds_read2_b32 v[138:139], v21 offset0:178 offset1:179
    s_waitcnt lgkmcnt(14)
    v_mfma_f32_16x16x32_bf16 v[44:47], v[76:79], v[100:103], v[44:47]
    v_mfma_f32_16x16x32_bf16 v[48:51], v[76:79], v[104:107], v[48:51]
    ds_read2_b32 v[140:141], v22 offset0:48 offset1:49
    v_mfma_f32_16x16x32_bf16 v[52:55], v[76:79], v[108:111], v[52:55]
    ds_read2_b32 v[142:143], v22 offset0:50 offset1:51
    v_mfma_f32_16x16x32_bf16 v[56:59], v[76:79], v[112:115], v[56:59]
    ds_read2_b32 v[144:145], v22 offset0:176 offset1:177
    v_mfma_f32_16x16x32_bf16 v[60:63], v[76:79], v[116:119], v[60:63]
    v_mfma_f32_16x16x32_bf16 v[64:67], v[76:79], v[120:123], v[64:67]
    ds_read2_b32 v[146:147], v22 offset0:178 offset1:179
    v_mfma_f32_16x16x32_bf16 v[48:51], v[80:83], v[100:103], v[48:51]
    ds_read2_b32 v[148:149], v23 offset0:48 offset1:49
    v_mfma_f32_16x16x32_bf16 v[52:55], v[80:83], v[104:107], v[52:55]
    ds_read2_b32 v[150:151], v23 offset0:50 offset1:51
    v_mfma_f32_16x16x32_bf16 v[56:59], v[80:83], v[108:111], v[56:59]
    v_mfma_f32_16x16x32_bf16 v[60:63], v[80:83], v[112:115], v[60:63]
    ds_read2_b32 v[152:153], v23 offset0:176 offset1:177
    v_mfma_f32_16x16x32_bf16 v[64:67], v[80:83], v[116:119], v[64:67]
    ds_read2_b32 v[154:155], v23 offset0:178 offset1:179
    v_mfma_f32_16x16x32_bf16 v[52:55], v[84:87], v[100:103], v[52:55]
    ds_read2_b32 v[156:157], v24 offset0:48 offset1:49
    v_mfma_f32_16x16x32_bf16 v[56:59], v[84:87], v[104:107], v[56:59]
    v_mfma_f32_16x16x32_bf16 v[60:63], v[84:87], v[108:111], v[60:63]
    ds_read2_b32 v[158:159], v24 offset0:50 offset1:51
    v_mfma_f32_16x16x32_bf16 v[64:67], v[84:87], v[112:115], v[64:67]
    ds_read2_b32 v[160:161], v24 offset0:176 offset1:177
    v_mfma_f32_16x16x32_bf16 v[56:59], v[88:91], v[100:103], v[56:59]
    ds_read2_b32 v[162:163], v24 offset0:178 offset1:179
    v_mfma_f32_16x16x32_bf16 v[60:63], v[88:91], v[104:107], v[60:63]
    v_mfma_f32_16x16x32_bf16 v[64:67], v[88:91], v[108:111], v[64:67]
    v_mfma_f32_16x16x32_bf16 v[60:63], v[92:95], v[100:103], v[60:63]
    v_mfma_f32_16x16x32_bf16 v[64:67], v[92:95], v[104:107], v[64:67]
    s_waitcnt lgkmcnt(14)
    v_mfma_f32_16x16x32_bf16 v[64:67], v[96:99], v[100:103], v[64:67]
    s_waitcnt vmcnt(0)
    s_mov_b64 exec, 1
    ds_add_u32 v18, v19 offset:16
    s_mov_b64 exec, -1
    v_mfma_f32_16x16x32_bf16 v[36:39], v[132:135], v[164:167], v[36:39]
    ds_read2_b32 v[68:69], v21 offset0:64 offset1:65
    v_lshlrev_b32 v196, 16, v212
    v_mfma_f32_16x16x32_bf16 v[40:43], v[132:135], v[168:171], v[40:43]
    ds_read2_b32 v[70:71], v21 offset0:66 offset1:67
    v_mfma_f32_16x16x32_bf16 v[44:47], v[132:135], v[172:175], v[44:47]
    ds_read_b128 v[100:103], v29 offset:0
    v_and_b32 v197, 0xffff0000, v212
    v_mfma_f32_16x16x32_bf16 v[48:51], v[132:135], v[176:179], v[48:51]
    v_mfma_f32_16x16x32_bf16 v[52:55], v[132:135], v[180:183], v[52:55]
    ds_read_b128 v[104:107], v29 offset:2048
    v_lshlrev_b32 v198, 16, v213
    v_mfma_f32_16x16x32_bf16 v[56:59], v[132:135], v[184:187], v[56:59]
    ds_read_b128 v[108:111], v29 offset:4096
    v_mfma_f32_16x16x32_bf16 v[60:63], v[132:135], v[188:191], v[60:63]
    ds_read_b128 v[112:115], v29 offset:6144
    v_and_b32 v199, 0xffff0000, v213
    v_mfma_f32_16x16x32_bf16 v[64:67], v[132:135], v[192:195], v[64:67]
    s_waitcnt lgkmcnt(14)
    v_mfma_f32_16x16x32_bf16 v[40:43], v[136:139], v[164:167], v[40:43]
    ds_read_b128 v[116:119], v29 offset:8192
    v_mfma_f32_16x16x32_bf16 v[44:47], v[136:139], v[168:171], v[44:47]
    ds_read_b128 v[120:123], v29 offset:10240
    v_lshlrev_b32 v200, 16, v214
    v_mfma_f32_16x16x32_bf16 v[48:51], v[136:139], v[172:175], v[48:51]
    ds_read_b128 v[124:127], v29 offset:12288
    v_mfma_f32_16x16x32_bf16 v[52:55], v[136:139], v[176:179], v[52:55]
    v_and_b32 v201, 0xffff0000, v214
    v_mfma_f32_16x16x32_bf16 v[56:59], v[136:139], v[180:183], v[56:59]
    ds_read_b128 v[128:131], v29 offset:14336
    v_mfma_f32_16x16x32_bf16 v[60:63], v[136:139], v[184:187], v[60:63]
    ds_read2_b32 v[72:73], v21 offset0:192 offset1:193
    v_lshlrev_b32 v202, 16, v215
    v_mfma_f32_16x16x32_bf16 v[64:67], v[136:139], v[188:191], v[64:67]
    ds_read2_b32 v[74:75], v21 offset0:194 offset1:195
    v_mfma_f32_16x16x32_bf16 v[44:47], v[140:143], v[164:167], v[44:47]
    v_and_b32 v203, 0xffff0000, v215
    v_mfma_f32_16x16x32_bf16 v[48:51], v[140:143], v[168:171], v[48:51]
    ds_read2_b32 v[76:77], v22 offset0:64 offset1:65
    v_mfma_f32_16x16x32_bf16 v[52:55], v[140:143], v[172:175], v[52:55]
    ds_read2_b32 v[78:79], v22 offset0:66 offset1:67
    v_mfma_f32_16x16x32_bf16 v[56:59], v[140:143], v[176:179], v[56:59]
    ds_read2_b32 v[80:81], v22 offset0:192 offset1:193
    v_lshlrev_b32 v204, 16, v216
    v_mfma_f32_16x16x32_bf16 v[60:63], v[140:143], v[180:183], v[60:63]
    v_mfma_f32_16x16x32_bf16 v[64:67], v[140:143], v[184:187], v[64:67]
    ds_read2_b32 v[82:83], v22 offset0:194 offset1:195
    v_and_b32 v205, 0xffff0000, v216
    v_mfma_f32_16x16x32_bf16 v[48:51], v[144:147], v[164:167], v[48:51]
    ds_read2_b32 v[84:85], v23 offset0:64 offset1:65
    v_mfma_f32_16x16x32_bf16 v[52:55], v[144:147], v[168:171], v[52:55]
    ds_read2_b32 v[86:87], v23 offset0:66 offset1:67
    v_lshlrev_b32 v206, 16, v217
    v_mfma_f32_16x16x32_bf16 v[56:59], v[144:147], v[172:175], v[56:59]
    v_mfma_f32_16x16x32_bf16 v[60:63], v[144:147], v[176:179], v[60:63]
    ds_read2_b32 v[88:89], v23 offset0:192 offset1:193
    v_and_b32 v207, 0xffff0000, v217
    v_mfma_f32_16x16x32_bf16 v[64:67], v[144:147], v[180:183], v[64:67]
    ds_read2_b32 v[90:91], v23 offset0:194 offset1:195
    s_waitcnt lgkmcnt(14)
    v_mfma_f32_16x16x32_bf16 v[52:55], v[148:151], v[164:167], v[52:55]
    ds_read2_b32 v[92:93], v24 offset0:64 offset1:65
    v_mfma_f32_16x16x32_bf16 v[56:59], v[148:151], v[168:171], v[56:59]
    v_lshlrev_b32 v208, 16, v218
    v_mfma_f32_16x16x32_bf16 v[60:63], v[148:151], v[172:175], v[60:63]
    ds_read2_b32 v[94:95], v24 offset0:66 offset1:67
    v_mfma_f32_16x16x32_bf16 v[64:67], v[148:151], v[176:179], v[64:67]
    ds_read2_b32 v[96:97], v24 offset0:192 offset1:193
    v_and_b32 v209, 0xffff0000, v218
    v_mfma_f32_16x16x32_bf16 v[56:59], v[152:155], v[164:167], v[56:59]
    ds_read2_b32 v[98:99], v24 offset0:194 offset1:195
    v_mfma_f32_16x16x32_bf16 v[60:63], v[152:155], v[168:171], v[60:63]
    v_lshlrev_b32 v210, 16, v219
    v_mfma_f32_16x16x32_bf16 v[64:67], v[152:155], v[172:175], v[64:67]
    v_mfma_f32_16x16x32_bf16 v[60:63], v[156:159], v[164:167], v[60:63]
    v_and_b32 v211, 0xffff0000, v219
    v_mfma_f32_16x16x32_bf16 v[64:67], v[156:159], v[168:171], v[64:67]
    v_mfma_f32_16x16x32_bf16 v[64:67], v[160:163], v[164:167], v[64:67]
    v_mfma_f32_16x16x32_bf16 v[36:39], v[68:71], v[100:103], v[36:39]
    ds_read2_b32 v[132:133], v21 offset0:80 offset1:81
    v_lshlrev_b32 v240, 16, v220
    v_mfma_f32_16x16x32_bf16 v[40:43], v[68:71], v[104:107], v[40:43]
    ds_read2_b32 v[134:135], v21 offset0:82 offset1:83
    v_mfma_f32_16x16x32_bf16 v[44:47], v[68:71], v[108:111], v[44:47]
    ds_read_b128 v[164:167], v30 offset:0
    v_and_b32 v241, 0xffff0000, v220
    v_mfma_f32_16x16x32_bf16 v[48:51], v[68:71], v[112:115], v[48:51]
    s_waitcnt lgkmcnt(14)
    v_mfma_f32_16x16x32_bf16 v[52:55], v[68:71], v[116:119], v[52:55]
    ds_read_b128 v[168:171], v30 offset:2048
    v_lshlrev_b32 v242, 16, v221
    v_mfma_f32_16x16x32_bf16 v[56:59], v[68:71], v[120:123], v[56:59]
    ds_read_b128 v[172:175], v30 offset:4096
    v_mfma_f32_16x16x32_bf16 v[60:63], v[68:71], v[124:127], v[60:63]
    ds_read_b128 v[176:179], v30 offset:6144
    v_and_b32 v243, 0xffff0000, v221
    v_mfma_f32_16x16x32_bf16 v[64:67], v[68:71], v[128:131], v[64:67]
    v_mfma_f32_16x16x32_bf16 v[40:43], v[72:75], v[100:103], v[40:43]
    ds_read_b128 v[180:183], v30 offset:8192
    v_mfma_f32_16x16x32_bf16 v[44:47], v[72:75], v[104:107], v[44:47]
    ds_read_b128 v[184:187], v30 offset:10240
    v_lshlrev_b32 v244, 16, v222
    v_mfma_f32_16x16x32_bf16 v[48:51], v[72:75], v[108:111], v[48:51]
    ds_read_b128 v[188:191], v30 offset:12288
    v_mfma_f32_16x16x32_bf16 v[52:55], v[72:75], v[112:115], v[52:55]
    v_and_b32 v245, 0xffff0000, v222
    v_mfma_f32_16x16x32_bf16 v[56:59], v[72:75], v[116:119], v[56:59]
    ds_read_b128 v[192:195], v30 offset:14336
    v_mfma_f32_16x16x32_bf16 v[60:63], v[72:75], v[120:123], v[60:63]
    ds_read2_b32 v[136:137], v21 offset0:208 offset1:209
    v_lshlrev_b32 v246, 16, v223
    v_mfma_f32_16x16x32_bf16 v[64:67], v[72:75], v[124:127], v[64:67]
    ds_read2_b32 v[138:139], v21 offset0:210 offset1:211
    s_waitcnt lgkmcnt(14)
    v_mfma_f32_16x16x32_bf16 v[44:47], v[76:79], v[100:103], v[44:47]
    v_and_b32 v247, 0xffff0000, v223
    v_mfma_f32_16x16x32_bf16 v[48:51], v[76:79], v[104:107], v[48:51]
    ds_read2_b32 v[140:141], v22 offset0:80 offset1:81
    v_mfma_f32_16x16x32_bf16 v[52:55], v[76:79], v[108:111], v[52:55]
    ds_read2_b32 v[142:143], v22 offset0:82 offset1:83
    v_mfma_f32_16x16x32_bf16 v[56:59], v[76:79], v[112:115], v[56:59]
    ds_read2_b32 v[144:145], v22 offset0:208 offset1:209
    v_lshlrev_b32 v248, 16, v224
    v_mfma_f32_16x16x32_bf16 v[60:63], v[76:79], v[116:119], v[60:63]
    v_mfma_f32_16x16x32_bf16 v[64:67], v[76:79], v[120:123], v[64:67]
    ds_read2_b32 v[146:147], v22 offset0:210 offset1:211
    v_and_b32 v249, 0xffff0000, v224
    v_mfma_f32_16x16x32_bf16 v[48:51], v[80:83], v[100:103], v[48:51]
    ds_read2_b32 v[148:149], v23 offset0:80 offset1:81
    v_mfma_f32_16x16x32_bf16 v[52:55], v[80:83], v[104:107], v[52:55]
    ds_read2_b32 v[150:151], v23 offset0:82 offset1:83
    v_lshlrev_b32 v250, 16, v225
    v_mfma_f32_16x16x32_bf16 v[56:59], v[80:83], v[108:111], v[56:59]
    v_mfma_f32_16x16x32_bf16 v[60:63], v[80:83], v[112:115], v[60:63]
    ds_read2_b32 v[152:153], v23 offset0:208 offset1:209
    v_and_b32 v251, 0xffff0000, v225
    v_mfma_f32_16x16x32_bf16 v[64:67], v[80:83], v[116:119], v[64:67]
    ds_read2_b32 v[154:155], v23 offset0:210 offset1:211
    v_mfma_f32_16x16x32_bf16 v[52:55], v[84:87], v[100:103], v[52:55]
    ds_read2_b32 v[156:157], v24 offset0:80 offset1:81
    v_mfma_f32_16x16x32_bf16 v[56:59], v[84:87], v[104:107], v[56:59]
    v_lshlrev_b32 v252, 16, v226
    v_mfma_f32_16x16x32_bf16 v[60:63], v[84:87], v[108:111], v[60:63]
    ds_read2_b32 v[158:159], v24 offset0:82 offset1:83
    v_mfma_f32_16x16x32_bf16 v[64:67], v[84:87], v[112:115], v[64:67]
    ds_read2_b32 v[160:161], v24 offset0:208 offset1:209
    v_and_b32 v253, 0xffff0000, v226
    v_mfma_f32_16x16x32_bf16 v[56:59], v[88:91], v[100:103], v[56:59]
    ds_read2_b32 v[162:163], v24 offset0:210 offset1:211
    v_mfma_f32_16x16x32_bf16 v[60:63], v[88:91], v[104:107], v[60:63]
    v_lshlrev_b32 v254, 16, v227
    v_mfma_f32_16x16x32_bf16 v[64:67], v[88:91], v[108:111], v[64:67]
    v_mfma_f32_16x16x32_bf16 v[60:63], v[92:95], v[100:103], v[60:63]
    v_and_b32 v255, 0xffff0000, v227
    v_mfma_f32_16x16x32_bf16 v[64:67], v[92:95], v[104:107], v[64:67]
    s_waitcnt lgkmcnt(14)
    v_mfma_f32_16x16x32_bf16 v[64:67], v[96:99], v[100:103], v[64:67]
    v_mfma_f32_16x16x32_bf16 v[36:39], v[132:135], v[164:167], v[36:39]
    ds_read2_b32 v[68:69], v21 offset0:96 offset1:97
    v_mfma_f32_16x16x32_bf16 v[40:43], v[132:135], v[168:171], v[40:43]
    ds_read2_b32 v[70:71], v21 offset0:98 offset1:99
    v_mfma_f32_16x16x32_bf16 v[44:47], v[132:135], v[172:175], v[44:47]
    ds_read_b128 v[100:103], v31 offset:0
    v_mfma_f32_16x16x32_bf16 v[48:51], v[132:135], v[176:179], v[48:51]
    v_mfma_f32_16x16x32_bf16 v[52:55], v[132:135], v[180:183], v[52:55]
    ds_read_b128 v[104:107], v31 offset:2048
    v_mfma_f32_16x16x32_bf16 v[56:59], v[132:135], v[184:187], v[56:59]
    ds_read_b128 v[108:111], v31 offset:4096
    v_mfma_f32_16x16x32_bf16 v[60:63], v[132:135], v[188:191], v[60:63]
    ds_read_b128 v[112:115], v31 offset:6144
    v_mfma_f32_16x16x32_bf16 v[64:67], v[132:135], v[192:195], v[64:67]
    s_waitcnt lgkmcnt(14)
    v_mfma_f32_16x16x32_bf16 v[40:43], v[136:139], v[164:167], v[40:43]
    ds_read_b128 v[116:119], v31 offset:8192
    v_mfma_f32_16x16x32_bf16 v[44:47], v[136:139], v[168:171], v[44:47]
    ds_read_b128 v[120:123], v31 offset:10240
    v_mfma_f32_16x16x32_bf16 v[48:51], v[136:139], v[172:175], v[48:51]
    ds_read_b128 v[124:127], v31 offset:12288
    v_mfma_f32_16x16x32_bf16 v[52:55], v[136:139], v[176:179], v[52:55]
    v_mfma_f32_16x16x32_bf16 v[56:59], v[136:139], v[180:183], v[56:59]
    ds_read_b128 v[128:131], v31 offset:14336
    v_mfma_f32_16x16x32_bf16 v[60:63], v[136:139], v[184:187], v[60:63]
    ds_read2_b32 v[72:73], v21 offset0:224 offset1:225
    v_mfma_f32_16x16x32_bf16 v[64:67], v[136:139], v[188:191], v[64:67]
    ds_read2_b32 v[74:75], v21 offset0:226 offset1:227
    v_mfma_f32_16x16x32_bf16 v[44:47], v[140:143], v[164:167], v[44:47]
    v_mfma_f32_16x16x32_bf16 v[48:51], v[140:143], v[168:171], v[48:51]
    ds_read2_b32 v[76:77], v22 offset0:96 offset1:97
    v_mfma_f32_16x16x32_bf16 v[52:55], v[140:143], v[172:175], v[52:55]
    ds_read2_b32 v[78:79], v22 offset0:98 offset1:99
    v_mfma_f32_16x16x32_bf16 v[56:59], v[140:143], v[176:179], v[56:59]
    ds_read2_b32 v[80:81], v22 offset0:224 offset1:225
    v_mfma_f32_16x16x32_bf16 v[60:63], v[140:143], v[180:183], v[60:63]
    v_mfma_f32_16x16x32_bf16 v[64:67], v[140:143], v[184:187], v[64:67]
    ds_read2_b32 v[82:83], v22 offset0:226 offset1:227
    v_mfma_f32_16x16x32_bf16 v[48:51], v[144:147], v[164:167], v[48:51]
    ds_read2_b32 v[84:85], v23 offset0:96 offset1:97
    v_mfma_f32_16x16x32_bf16 v[52:55], v[144:147], v[168:171], v[52:55]
    ds_read2_b32 v[86:87], v23 offset0:98 offset1:99
    v_mfma_f32_16x16x32_bf16 v[56:59], v[144:147], v[172:175], v[56:59]
    v_mfma_f32_16x16x32_bf16 v[60:63], v[144:147], v[176:179], v[60:63]
    ds_read2_b32 v[88:89], v23 offset0:224 offset1:225
    v_mfma_f32_16x16x32_bf16 v[64:67], v[144:147], v[180:183], v[64:67]
    ds_read2_b32 v[90:91], v23 offset0:226 offset1:227
    s_waitcnt lgkmcnt(14)
    v_mfma_f32_16x16x32_bf16 v[52:55], v[148:151], v[164:167], v[52:55]
    ds_read2_b32 v[92:93], v24 offset0:96 offset1:97
    v_mfma_f32_16x16x32_bf16 v[56:59], v[148:151], v[168:171], v[56:59]
    v_mfma_f32_16x16x32_bf16 v[60:63], v[148:151], v[172:175], v[60:63]
    ds_read2_b32 v[94:95], v24 offset0:98 offset1:99
    v_mfma_f32_16x16x32_bf16 v[64:67], v[148:151], v[176:179], v[64:67]
    ds_read2_b32 v[96:97], v24 offset0:224 offset1:225
    v_mfma_f32_16x16x32_bf16 v[56:59], v[152:155], v[164:167], v[56:59]
    ds_read2_b32 v[98:99], v24 offset0:226 offset1:227
    v_mfma_f32_16x16x32_bf16 v[60:63], v[152:155], v[168:171], v[60:63]
    v_mfma_f32_16x16x32_bf16 v[64:67], v[152:155], v[172:175], v[64:67]
    v_mfma_f32_16x16x32_bf16 v[60:63], v[156:159], v[164:167], v[60:63]
    v_mfma_f32_16x16x32_bf16 v[64:67], v[156:159], v[168:171], v[64:67]
    v_mfma_f32_16x16x32_bf16 v[64:67], v[160:163], v[164:167], v[64:67]
    v_mfma_f32_16x16x32_bf16 v[36:39], v[68:71], v[100:103], v[36:39]
    ds_read2_b32 v[132:133], v21 offset0:112 offset1:113
    v_mfma_f32_16x16x32_bf16 v[40:43], v[68:71], v[104:107], v[40:43]
    ds_read2_b32 v[134:135], v21 offset0:114 offset1:115
    v_mfma_f32_16x16x32_bf16 v[44:47], v[68:71], v[108:111], v[44:47]
    ds_read_b128 v[164:167], v32 offset:0
    v_mfma_f32_16x16x32_bf16 v[48:51], v[68:71], v[112:115], v[48:51]
    s_waitcnt lgkmcnt(14)
    v_mfma_f32_16x16x32_bf16 v[52:55], v[68:71], v[116:119], v[52:55]
    ds_read_b128 v[168:171], v32 offset:2048
    v_mfma_f32_16x16x32_bf16 v[56:59], v[68:71], v[120:123], v[56:59]
    ds_read_b128 v[172:175], v32 offset:4096
    v_mfma_f32_16x16x32_bf16 v[60:63], v[68:71], v[124:127], v[60:63]
    ds_read_b128 v[176:179], v32 offset:6144
    v_mfma_f32_16x16x32_bf16 v[64:67], v[68:71], v[128:131], v[64:67]
    v_mfma_f32_16x16x32_bf16 v[40:43], v[72:75], v[100:103], v[40:43]
    ds_read_b128 v[180:183], v32 offset:8192
    v_mfma_f32_16x16x32_bf16 v[44:47], v[72:75], v[104:107], v[44:47]
    ds_read_b128 v[184:187], v32 offset:10240
    v_mfma_f32_16x16x32_bf16 v[48:51], v[72:75], v[108:111], v[48:51]
    ds_read_b128 v[188:191], v32 offset:12288
    v_mfma_f32_16x16x32_bf16 v[52:55], v[72:75], v[112:115], v[52:55]
    v_mfma_f32_16x16x32_bf16 v[56:59], v[72:75], v[116:119], v[56:59]
    ds_read_b128 v[192:195], v32 offset:14336
    v_mfma_f32_16x16x32_bf16 v[60:63], v[72:75], v[120:123], v[60:63]
    ds_read2_b32 v[136:137], v21 offset0:240 offset1:241
    v_mfma_f32_16x16x32_bf16 v[64:67], v[72:75], v[124:127], v[64:67]
    ds_read2_b32 v[138:139], v21 offset0:242 offset1:243
    s_waitcnt lgkmcnt(14)
    v_mfma_f32_16x16x32_bf16 v[44:47], v[76:79], v[100:103], v[44:47]
    v_mfma_f32_16x16x32_bf16 v[48:51], v[76:79], v[104:107], v[48:51]
    ds_read2_b32 v[140:141], v22 offset0:112 offset1:113
    v_mfma_f32_16x16x32_bf16 v[52:55], v[76:79], v[108:111], v[52:55]
    ds_read2_b32 v[142:143], v22 offset0:114 offset1:115
    v_mfma_f32_16x16x32_bf16 v[56:59], v[76:79], v[112:115], v[56:59]
    ds_read2_b32 v[144:145], v22 offset0:240 offset1:241
    v_mfma_f32_16x16x32_bf16 v[60:63], v[76:79], v[116:119], v[60:63]
    v_mfma_f32_16x16x32_bf16 v[64:67], v[76:79], v[120:123], v[64:67]
    ds_read2_b32 v[146:147], v22 offset0:242 offset1:243
    v_mfma_f32_16x16x32_bf16 v[48:51], v[80:83], v[100:103], v[48:51]
    ds_read2_b32 v[148:149], v23 offset0:112 offset1:113
    v_mfma_f32_16x16x32_bf16 v[52:55], v[80:83], v[104:107], v[52:55]
    ds_read2_b32 v[150:151], v23 offset0:114 offset1:115
    v_mfma_f32_16x16x32_bf16 v[56:59], v[80:83], v[108:111], v[56:59]
    v_mfma_f32_16x16x32_bf16 v[60:63], v[80:83], v[112:115], v[60:63]
    ds_read2_b32 v[152:153], v23 offset0:240 offset1:241
    v_mfma_f32_16x16x32_bf16 v[64:67], v[80:83], v[116:119], v[64:67]
    ds_read2_b32 v[154:155], v23 offset0:242 offset1:243
    v_mfma_f32_16x16x32_bf16 v[52:55], v[84:87], v[100:103], v[52:55]
    ds_read2_b32 v[156:157], v24 offset0:112 offset1:113
    v_mfma_f32_16x16x32_bf16 v[56:59], v[84:87], v[104:107], v[56:59]
    v_mfma_f32_16x16x32_bf16 v[60:63], v[84:87], v[108:111], v[60:63]
    ds_read2_b32 v[158:159], v24 offset0:114 offset1:115
    v_mfma_f32_16x16x32_bf16 v[64:67], v[84:87], v[112:115], v[64:67]
    ds_read2_b32 v[160:161], v24 offset0:240 offset1:241
    v_mfma_f32_16x16x32_bf16 v[56:59], v[88:91], v[100:103], v[56:59]
    ds_read2_b32 v[162:163], v24 offset0:242 offset1:243
    v_mfma_f32_16x16x32_bf16 v[60:63], v[88:91], v[104:107], v[60:63]
    v_mfma_f32_16x16x32_bf16 v[64:67], v[88:91], v[108:111], v[64:67]
    v_mfma_f32_16x16x32_bf16 v[60:63], v[92:95], v[100:103], v[60:63]
    v_mfma_f32_16x16x32_bf16 v[64:67], v[92:95], v[104:107], v[64:67]
    s_waitcnt lgkmcnt(14)
    v_mfma_f32_16x16x32_bf16 v[64:67], v[96:99], v[100:103], v[64:67]
    v_mfma_f32_16x16x32_bf16 v[36:39], v[132:135], v[164:167], v[36:39]
    v_mfma_f32_16x16x32_bf16 v[40:43], v[132:135], v[168:171], v[40:43]
    v_mfma_f32_16x16x32_bf16 v[44:47], v[132:135], v[172:175], v[44:47]
    v_mfma_f32_16x16x32_bf16 v[48:51], v[132:135], v[176:179], v[48:51]
    v_mfma_f32_16x16x32_bf16 v[52:55], v[132:135], v[180:183], v[52:55]
    v_mfma_f32_16x16x32_bf16 v[56:59], v[132:135], v[184:187], v[56:59]
    v_mfma_f32_16x16x32_bf16 v[60:63], v[132:135], v[188:191], v[60:63]
    v_mfma_f32_16x16x32_bf16 v[64:67], v[132:135], v[192:195], v[64:67]
    s_waitcnt lgkmcnt(12)
    v_mfma_f32_16x16x32_bf16 v[40:43], v[136:139], v[164:167], v[40:43]
    v_cvt_pk_bf16_f32 v68, v39, v38
    v_cvt_pk_bf16_f32 v69, v37, v36
    v_mfma_f32_16x16x32_bf16 v[44:47], v[136:139], v[168:171], v[44:47]
    ds_write_b64 v20, v[68:69] offset:0
    v_mfma_f32_16x16x32_bf16 v[48:51], v[136:139], v[172:175], v[48:51]
    v_mfma_f32_16x16x32_bf16 v[52:55], v[136:139], v[176:179], v[52:55]
    v_mfma_f32_16x16x32_bf16 v[56:59], v[136:139], v[180:183], v[56:59]
    v_mfma_f32_16x16x32_bf16 v[60:63], v[136:139], v[184:187], v[60:63]
    v_mfma_f32_16x16x32_bf16 v[64:67], v[136:139], v[188:191], v[64:67]
    s_waitcnt lgkmcnt(11)
    v_mfma_f32_16x16x32_bf16 v[44:47], v[140:143], v[164:167], v[44:47]
    v_mfma_f32_16x16x32_bf16 v[48:51], v[140:143], v[168:171], v[48:51]
    v_cvt_pk_bf16_f32 v70, v43, v42
    v_cvt_pk_bf16_f32 v71, v41, v40
    v_mfma_f32_16x16x32_bf16 v[52:55], v[140:143], v[172:175], v[52:55]
    ds_write_b64 v20, v[70:71] offset:2048
    v_mfma_f32_16x16x32_bf16 v[56:59], v[140:143], v[176:179], v[56:59]
    v_mfma_f32_16x16x32_bf16 v[60:63], v[140:143], v[180:183], v[60:63]
    v_mfma_f32_16x16x32_bf16 v[64:67], v[140:143], v[184:187], v[64:67]
    s_waitcnt lgkmcnt(10)
    v_mfma_f32_16x16x32_bf16 v[48:51], v[144:147], v[164:167], v[48:51]
    v_mfma_f32_16x16x32_bf16 v[52:55], v[144:147], v[168:171], v[52:55]
    v_mfma_f32_16x16x32_bf16 v[56:59], v[144:147], v[172:175], v[56:59]
    v_cvt_pk_bf16_f32 v72, v47, v46
    v_cvt_pk_bf16_f32 v73, v45, v44
    v_mfma_f32_16x16x32_bf16 v[60:63], v[144:147], v[176:179], v[60:63]
    ds_write_b64 v20, v[72:73] offset:4096
    v_mfma_f32_16x16x32_bf16 v[64:67], v[144:147], v[180:183], v[64:67]
    s_waitcnt lgkmcnt(9)
    v_mfma_f32_16x16x32_bf16 v[52:55], v[148:151], v[164:167], v[52:55]
    v_mfma_f32_16x16x32_bf16 v[56:59], v[148:151], v[168:171], v[56:59]
    v_mfma_f32_16x16x32_bf16 v[60:63], v[148:151], v[172:175], v[60:63]
    v_mfma_f32_16x16x32_bf16 v[64:67], v[148:151], v[176:179], v[64:67]
    v_cvt_pk_bf16_f32 v74, v51, v50
    v_cvt_pk_bf16_f32 v75, v49, v48
    s_waitcnt lgkmcnt(7)
    v_mfma_f32_16x16x32_bf16 v[56:59], v[152:155], v[164:167], v[56:59]
    ds_write_b64 v20, v[74:75] offset:6144
    v_mfma_f32_16x16x32_bf16 v[60:63], v[152:155], v[168:171], v[60:63]
    v_mfma_f32_16x16x32_bf16 v[64:67], v[152:155], v[172:175], v[64:67]
    s_waitcnt lgkmcnt(6)
    v_mfma_f32_16x16x32_bf16 v[60:63], v[156:159], v[164:167], v[60:63]
    v_mfma_f32_16x16x32_bf16 v[64:67], v[156:159], v[168:171], v[64:67]
    v_cvt_pk_bf16_f32 v76, v55, v54
    v_cvt_pk_bf16_f32 v77, v53, v52
    s_waitcnt lgkmcnt(4)
    v_mfma_f32_16x16x32_bf16 v[64:67], v[160:163], v[164:167], v[64:67]
    ds_write_b64 v20, v[76:77] offset:8192
    v_cvt_pk_bf16_f32 v78, v59, v58
    v_cvt_pk_bf16_f32 v79, v57, v56
    ds_write_b64 v20, v[78:79] offset:10240
    v_cvt_pk_bf16_f32 v80, v63, v62
    v_cvt_pk_bf16_f32 v81, v61, v60
    ds_write_b64 v20, v[80:81] offset:12288
    s_nop 0
    v_cvt_pk_bf16_f32 v82, v67, v66
    v_cvt_pk_bf16_f32 v83, v65, v64
    ds_write_b64 v20, v[82:83] offset:14336
    s_mov_b64 exec, 1
    ds_add_u32 v18, v19 offset:12
    s_mov_b64 exec, -1
    s_add_u32 s80, s86, 94208
    v_add_u32 v5, s80, v15
    s_branch LA_s3_in
LA_s3:
    s_sleep 1
LA_s3_in:
    ds_read_b32 v6, v18 offset:12
    ds_read_b128 v[84:87], v5 offset:0
    ds_read_b128 v[88:91], v5 offset:4096
    ds_read_b128 v[92:95], v5 offset:8192
    ds_read_b128 v[96:99], v5 offset:12288
    s_waitcnt lgkmcnt(0)
    v_readfirstlane_b32 s78, v6
    s_nop 0
    s_cmp_ge_u32 s78, 4
    s_cbranch_scc0 LA_s3
    s_add_u32 s89, s91, 4194304
    buffer_store_dwordx4 v[84:87], v14, s[52:55], s89 offen sc1
    s_add_u32 s89, s91, 4198400
    buffer_store_dwordx4 v[88:91], v14, s[52:55], s89 offen sc1
    s_add_u32 s89, s91, 4202496
    buffer_store_dwordx4 v[92:95], v14, s[52:55], s89 offen sc1
    s_add_u32 s89, s91, 4206592
    buffer_store_dwordx4 v[96:99], v14, s[52:55], s89 offen sc1
    s_setprio 0
    s_lshr_b32 s81, s91, 4
    s_lshl_b32 s82, s3, 8
    s_add_u32 s81, s81, s82
    s_add_u32 s81, s81, 12648448
    s_lshl_b32 s80, s74, 14
    s_and_b32 s82, s75, 3
    s_lshl_b32 s82, s82, 8
    s_add_u32 s80, s80, s82
    s_add_u32 s80, s80, 12648448
    v_mov_b32 v5, 0
    v_lshlrev_b32 v7, 10, v0
    s_waitcnt vmcnt(0)
    s_mov_b64 exec, 1
    buffer_store_dword v19, v5, s[52:55], s81 offen sc1
    s_mov_b64 exec, 0xffff
    s_waitcnt vmcnt(0)
    s_branch LA_s7a_in
LA_s7a:
    s_sleep 1
LA_s7a_in:
    ds_read_b32 v6, v18 offset:28
    s_waitcnt lgkmcnt(0)
    v_readfirstlane_b32 s78, v6
    s_nop 0
    s_cmp_ge_u32 s78, 4
    s_cbranch_scc0 LA_s7a
    s_setprio 2
    s_mov_b32 s79, 0
LA_py:
    buffer_load_dword v6, v7, s[52:55], s80 offen sc1
    s_add_u32 s79, s79, 1
    s_cmp_gt_u32 s79, 200000
    s_cbranch_scc1 LA_py_x
    s_waitcnt vmcnt(0)
    v_cmp_ne_u32 vcc, 1, v6
    s_cbranch_vccz LA_py_x
    s_mov_b64 exec, vcc
    s_sleep 8
    s_branch LA_py
LA_py_x:
    s_waitcnt vmcnt(0)
    s_mov_b64 exec, -1
    s_mov_b32 s89, 4194304
    buffer_load_dwordx4 v[100:103], v12, s[52:55], s89 offen sc1
    s_mov_b32 s89, 4210688
    buffer_load_dwordx4 v[104:107], v12, s[52:55], s89 offen sc1
    s_mov_b32 s89, 4227072
    buffer_load_dwordx4 v[108:111], v12, s[52:55], s89 offen sc1
    s_mov_b32 s89, 4243456
    buffer_load_dwordx4 v[112:115], v12, s[52:55], s89 offen sc1
    s_waitcnt vmcnt(3)
    v_permlane32_swap_b32 v102, v100
    v_permlane32_swap_b32 v103, v101
    s_waitcnt vmcnt(2)
    v_permlane32_swap_b32 v106, v104
    v_permlane32_swap_b32 v107, v105
    s_waitcnt vmcnt(1)
    v_permlane32_swap_b32 v110, v108
    v_permlane32_swap_b32 v111, v109
    s_waitcnt vmcnt(0)
    v_permlane32_swap_b32 v114, v112
    v_permlane32_swap_b32 v115, v113
    v_and_b32 v68, 0xffff0000, v103
    v_and_b32 v69, 0xffff0000, v107
    v_and_b32 v70, 0xffff0000, v111
    v_and_b32 v71, 0xffff0000, v115
    v_and_b32 v72, 0xffff0000, v101
    v_and_b32 v73, 0xffff0000, v105
    v_and_b32 v74, 0xffff0000, v109
    v_and_b32 v75, 0xffff0000, v113
    v_mul_f32 v68, v68, v196
    v_mul_f32 v69, v69, v197
    v_mul_f32 v70, v70, v198
    v_mul_f32 v71, v71, v199
    v_mul_f32 v72, v72, v200
    v_mul_f32 v73, v73, v201
    v_mul_f32 v74, v74, v202
    v_mul_f32 v75, v75, v203
    v_cvt_pk_bf16_f32 v36, v68, v69
    v_cvt_pk_bf16_f32 v37, v70, v71
    v_cvt_pk_bf16_f32 v38, v72, v73
    v_cvt_pk_bf16_f32 v39, v74, v75
    s_mov_b32 s89, 0
    buffer_store_dwordx4 v[36:39], v13, s[60:63], s89 offen nt
    v_lshlrev_b32 v68, 16, v103
    v_lshlrev_b32 v69, 16, v107
    v_lshlrev_b32 v70, 16, v111
    v_lshlrev_b32 v71, 16, v115
    v_lshlrev_b32 v72, 16, v101
    v_lshlrev_b32 v73, 16, v105
    v_lshlrev_b32 v74, 16, v109
    v_lshlrev_b32 v75, 16, v113
    v_mul_f32 v68, v68, v204
    v_mul_f32 v69, v69, v205
    v_mul_f32 v70, v70, v206
    v_mul_f32 v71, v71, v207
    v_mul_f32 v72, v72, v208
    v_mul_f32 v73, v73, v209
    v_mul_f32 v74, v74, v210
    v_mul_f32 v75, v75, v211
    v_cvt_pk_bf16_f32 v40, v68, v69
    v_cvt_pk_bf16_f32 v41, v70, v71
    v_cvt_pk_bf16_f32 v42, v72, v73
    v_cvt_pk_bf16_f32 v43, v74, v75
    s_mov_b32 s89, 4096
    buffer_store_dwordx4 v[40:43], v13, s[60:63], s89 offen nt
    v_and_b32 v68, 0xffff0000, v102
    v_and_b32 v69, 0xffff0000, v106
    v_and_b32 v70, 0xffff0000, v110
    v_and_b32 v71, 0xffff0000, v114
    v_and_b32 v72, 0xffff0000, v100
    v_and_b32 v73, 0xffff0000, v104
    v_and_b32 v74, 0xffff0000, v108
    v_and_b32 v75, 0xffff0000, v112
    v_mul_f32 v68, v68, v240
    v_mul_f32 v69, v69, v241
    v_mul_f32 v70, v70, v242
    v_mul_f32 v71, v71, v243
    v_mul_f32 v72, v72, v244
    v_mul_f32 v73, v73, v245
    v_mul_f32 v74, v74, v246
    v_mul_f32 v75, v75, v247
    v_cvt_pk_bf16_f32 v44, v68, v69
    v_cvt_pk_bf16_f32 v45, v70, v71
    v_cvt_pk_bf16_f32 v46, v72, v73
    v_cvt_pk_bf16_f32 v47, v74, v75
    s_mov_b32 s89, 8192
    buffer_store_dwordx4 v[44:47], v13, s[60:63], s89 offen nt
    v_lshlrev_b32 v68, 16, v102
    v_lshlrev_b32 v69, 16, v106
    v_lshlrev_b32 v70, 16, v110
    v_lshlrev_b32 v71, 16, v114
    v_lshlrev_b32 v72, 16, v100
    v_lshlrev_b32 v73, 16, v104
    v_lshlrev_b32 v74, 16, v108
    v_lshlrev_b32 v75, 16, v112
    v_mul_f32 v68, v68, v248
    v_mul_f32 v69, v69, v249
    v_mul_f32 v70, v70, v250
    v_mul_f32 v71, v71, v251
    v_mul_f32 v72, v72, v252
    v_mul_f32 v73, v73, v253
    v_mul_f32 v74, v74, v254
    v_mul_f32 v75, v75, v255
    v_cvt_pk_bf16_f32 v48, v68, v69
    v_cvt_pk_bf16_f32 v49, v70, v71
    v_cvt_pk_bf16_f32 v50, v72, v73
    v_cvt_pk_bf16_f32 v51, v74, v75
    s_mov_b32 s89, 12288
    buffer_store_dwordx4 v[48:51], v13, s[60:63], s89 offen nt
    s_endpgm
L_B:
    s_setprio 3
    s_and_b32 s3, s3, 3
    s_lshr_b32 s86, s3, 1
    s_and_b32 s87, s3, 1
    v_mov_b32 v10, 162304
    v_mov_b32 v11, 1
    v_lshlrev_b32 v12, 4, v0
    v_lshl_add_u32 v13, v0, 2, v10
    v_mov_b32 v14, 0
    ds_write_b32 v13, v14
    s_lshl_b32 s78, s74, 4
    s_add_u32 s78, s78, s75
    s_lshl_b32 s96, s78, 8
    s_add_u32 s96, s96, 12582912
    s_lshl_b32 s78, s78, 2
    s_add_u32 s78, s78, s3
    s_lshl_b32 s78, s78, 8
    s_add_u32 s80, s78, 12648448
    s_lshl_b32 s81, s72, 1
    s_add_u32 s81, s81, s86
    s_lshl_b32 s97, s81, 4
    s_add_u32 s97, s97, s73
    s_lshl_b32 s97, s97, 8
    s_add_u32 s97, s97, 12910464
    v_mov_b32 v15, s80
    v_mov_b32 v223, s97
    v_cmp_gt_u32 vcc, 8, v0
    s_nop 1
    v_cndmask_b32 v15, v223, v15, vcc
    v_add_u32 v221, v15, v12
    s_lshl_b32 s78, s87, 2
    s_add_u32 s78, s78, 128
    s_add_u32 s97, s97, s78
    s_lshl_b32 s82, s73, 1
    s_add_u32 s82, s82, s87
    s_lshl_b32 s78, s81, 7
    s_add_u32 s78, s78, s82
    s_lshl_b32 s94, s78, 10
    s_add_u32 s94, s94, 8388608
    v_mov_b32 v212, 0
    v_mov_b32 v213, 0
    v_mov_b32 v214, 0
    v_mov_b32 v215, 0
    v_mov_b32 v220, 0
    s_waitcnt lgkmcnt(0)
    s_mov_b32 s52, s26
    s_mov_b32 s53, s27
    s_mov_b32 s54, 0x1000000
    s_mov_b32 s55, 0x20000
    s_mov_b32 s68, s24
    s_mov_b32 s69, s25
    s_mov_b32 s70, 0x100
    s_mov_b32 s71, 0x20000
    s_mov_b32 s60, s22
    s_mov_b32 s61, s23
    s_mov_b32 s62, 0x800000
    s_mov_b32 s63, 0x20000
    s_lshl_b32 s98, s74, 4
    s_or_b32 s78, s75, s3
    s_cmp_lg_u32 s78, 0
    s_cbranch_scc1 LB_notag
    s_mov_b64 exec, 0xffff
    v_lshlrev_b32 v15, 8, v0
    buffer_load_dword v223, v15, s[52:55], s96 offen sc1
    s_waitcnt vmcnt(0)
    v_lshrrev_b32 v223, v0, v223
    v_and_b32 v223, 1, v223
    v_cmp_eq_u32 vcc, 0, v223
    s_nop 1
    s_or_b32 s78, vcc_lo, 0x10000
    s_mov_b64 exec, 1
    v_mov_b32 v223, s78
    buffer_store_dword v223, v220, s[68:71], s98 offen sc1
LB_notag:
    s_lshl_b32 s78, s87, 3
    s_lshr_b32 exec_lo, 0xffff, s78
    s_mov_b32 exec_hi, 0
    buffer_store_dwordx4 v[212:215], v221, s[52:55], 0 offen sc1
    s_mov_b64 exec, -1
    s_getpc_b64 s[80:81]
LB_pc:
    s_sub_u32 s80, s80, LB_pc-concat_heads__ssm_conv_h3__sliding_local_dilated__prompt_kernel
    s_subb_u32 s81, s81, 0
    s_lshr_b32 s78, s2, 3
    s_and_b32 s78, s78, 7
    s_lshl_b32 s78, s78, 2
    s_add_u32 s78, s78, s3
    v_lshlrev_b32 v13, 5, v0
    v_add_u32 v13, s78, v13
    v_lshlrev_b32 v13, 7, v13
    v_cmp_gt_u32 vcc, L_end-concat_heads__ssm_conv_h3__sliding_local_dilated__prompt_kernel, v13
    s_nop 0
    s_and_saveexec_b64 s[82:83], vcc
    global_load_dword v222, v13, s[80:81]
    s_mov_b64 exec, -1
    v_and_b32 v13, 15, v0
    v_lshrrev_b32 v14, 4, v0
    v_lshrrev_b32 v15, 1, v13
    v_xor_b32 v15, v15, v14
    v_lshlrev_b32 v15, 4, v15
    v_lshl_add_u32 v15, v13, 7, v15
    v_add_u32 v2, 73728, v15
    v_xor_b32 v3, 64, v2
    s_lshl_b32 s78, s86, 13
    s_add_u32 s78, s78, 2048
    v_add_u32 v4, s78, v2
    v_add_u32 v5, s78, v3
    v_bfe_u32 v15, v0, 3, 2
    s_lshl_b32 s78, s87, 1
    s_add_u32 s78, s78, s86
    v_xor_b32 v15, s78, v15
    v_lshlrev_b32 v15, 5, v15
    v_and_b32 v223, 3, v0
    v_lshl_add_u32 v15, v223, 3, v15
    v_bfe_u32 v223, v0, 2, 2
    v_lshl_add_u32 v15, v223, 7, v15
    v_lshl_add_u32 v6, v14, 10, v15
    v_xor_b32 v7, 32, v6
    v_add_u32 v8, 49152, v6
    v_add_u32 v9, 49152, v7
    v_and_b32 v15, 1, v13
    v_cmp_eq_u32 s[88:89], 1, v15
    v_lshl_add_u32 v15, v14, 2, v15
    v_cmp_le_u32 s[90:91], v15, v13
    v_add_u32 v15, 2, v15
    v_cmp_le_u32 s[92:93], v15, v13
    v_mov_b32 v212, 0x0c0c0c0c
    v_mov_b32 v15, 0xc0c0100
    v_mov_b32 v223, 0x1000c0c
    v_cndmask_b32 v15, v15, v223, s[88:89]
    v_cndmask_b32 v208, v15, v212, s[90:91]
    v_cndmask_b32 v210, v212, v15, s[90:91]
    v_mov_b32 v15, 0xc0c0302
    v_mov_b32 v223, 0x3020c0c
    v_cndmask_b32 v15, v15, v223, s[88:89]
    v_cndmask_b32 v209, v15, v212, s[92:93]
    v_cndmask_b32 v211, v212, v15, s[92:93]
    s_or_b32 s78, s72, s86
    s_cmp_eq_u32 s78, 0
    s_cselect_b32 s78, 0xf149f2ca, 0
    v_mov_b32 v212, s78
    v_mov_b32 v213, s78
    v_mov_b32 v214, s78
    v_mov_b32 v215, s78
    s_lshl_b32 s78, s87, 12
    s_add_u32 s78, s78, 110592
    s_lshl_b32 s79, s86, 9
    s_add_u32 s79, s79, s78
    v_lshlrev_b32 v15, 3, v0
    v_add_u32 v216, s79, v15
    s_lshl_b32 s80, s86, 11
    v_add_u32 v218, s80, v216
    v_xor_b32 v219, 512, v218
    s_add_u32 s78, s78, 2048
    s_cmp_eq_u32 s86, 0
    s_cselect_b32 s78, s78, 118784
    v_add_u32 v217, s78, v15
    v_bfe_u32 v14, v0, 3, 2
    v_lshlrev_b32 v14, 5, v14
    v_and_b32 v15, 3, v0
    v_lshl_add_u32 v14, v15, 3, v14
    v_lshrrev_b32 v15, 2, v0
    v_lshl_add_u32 v14, v15, 7, v14
    s_lshl_b32 s78, s86, 11
    v_add_u32 v244, s78, v14
    s_mov_b32 s64, s20
    s_mov_b32 s65, s21
    s_mov_b32 s66, 0x200000
    s_mov_b32 s67, 0x20000
    v_lshrrev_b32 v14, 4, v0
    v_lshlrev_b32 v14, 1, v14
    v_and_b32 v15, 7, v0
    v_xor_b32 v14, v14, v15
    v_lshlrev_b32 v14, 4, v14
    v_lshrrev_b32 v15, 3, v0
    v_lshl_add_u32 v14, v15, 11, v14
    s_lshl_b32 s78, s77, 7
    s_lshl_b32 s79, s3, 14
    s_add_u32 s78, s78, s79
    v_add_u32 v245, s78, v14
    v_and_b32 v14, 15, v0
    s_lshl_b32 s78, s76, 2
    s_add_u32 s78, s78, s3
    s_lshl_b32 s79, s78, 5
    v_add_u32 v14, s79, v14
    v_lshlrev_b32 v14, 12, v14
    v_bfe_u32 v15, v0, 4, 1
    v_lshl_add_u32 v14, v15, 5, v14
    v_lshrrev_b32 v15, 5, v0
    v_lshl_add_u32 v14, v15, 4, v14
    s_lshl_b32 s79, s77, 7
    s_add_u32 s79, s79, 2048
    v_add_u32 v246, s79, v14
    s_lshl_b32 s28, s78, 16
    s_add_u32 s28, s28, 8388608
    s_lshl_b32 s30, s76, 1
    s_add_u32 s30, s30, s86
    s_lshl_b32 s30, s30, 12
    s_add_u32 s30, s30, 12910592
    v_lshrrev_b32 v15, 1, v0
    v_lshlrev_b32 v15, 8, v15
    v_and_b32 v14, 1, v0
    v_lshl_add_u32 v247, v14, 2, v15
    s_and_b32 s32, s76, 3
    s_lshl_b32 s32, s32, 13
    s_waitcnt lgkmcnt(0)
    s_barrier
    ds_read_b128 v[120:123], v4 offset:0
    ds_read_b128 v[124:127], v4 offset:2048
    ds_read_b128 v[128:131], v4 offset:4096
    ds_read_b128 v[132:135], v4 offset:6144
    ds_read_b128 v[136:139], v2 offset:0
    ds_read_b64_tr_b16 v[140:141], v6 offset:0
    ds_read_b64_tr_b16 v[142:143], v6 offset:512
    ds_read_b64_tr_b16 v[144:145], v7 offset:0
    ds_read_b64_tr_b16 v[146:147], v7 offset:512
    ds_read_b64_tr_b16 v[148:149], v6 offset:24576
    ds_read_b64_tr_b16 v[150:151], v6 offset:25088
    ds_read_b64_tr_b16 v[152:153], v7 offset:24576
    ds_read_b64_tr_b16 v[154:155], v7 offset:25088
    ds_read_b64_tr_b16 v[156:157], v8 offset:0
    ds_read_b64_tr_b16 v[158:159], v8 offset:512
    ds_read_b64_tr_b16 v[160:161], v9 offset:0
    ds_read_b64_tr_b16 v[162:163], v9 offset:512
    s_waitcnt lgkmcnt(0)
    v_mfma_f32_16x16x32_bf16 v[112:115], v[148:151], v[136:139], 0
    ds_read_b128 v[164:167], v5 offset:0
    v_mfma_f32_16x16x32_bf16 v[116:119], v[136:139], v[156:159], 0
    ds_read_b128 v[168:171], v5 offset:2048
    v_mfma_f32_16x16x32_bf16 v[72:75], v[148:151], v[132:135], 0
    ds_read_b128 v[172:175], v5 offset:4096
    v_mfma_f32_16x16x32_bf16 v[76:79], v[152:155], v[132:135], 0
    ds_read_b128 v[176:179], v5 offset:6144
    v_mfma_f32_16x16x32_bf16 v[104:107], v[132:135], v[156:159], 0
    ds_read_b128 v[180:183], v3 offset:0
    v_mfma_f32_16x16x32_bf16 v[108:111], v[132:135], v[160:163], 0
    ds_read_b64_tr_b16 v[184:185], v6 offset:4096
    v_mfma_f32_16x16x32_bf16 v[40:43], v[140:143], v[132:135], 0
    ds_read_b64_tr_b16 v[186:187], v6 offset:4608
    v_mfma_f32_16x16x32_bf16 v[44:47], v[144:147], v[132:135], 0
    ds_read_b64_tr_b16 v[188:189], v7 offset:4096
    v_mfma_f32_16x16x32_bf16 v[64:67], v[148:151], v[128:131], 0
    ds_read_b64_tr_b16 v[190:191], v7 offset:4608
    v_mfma_f32_16x16x32_bf16 v[68:71], v[152:155], v[128:131], 0
    ds_read_b64_tr_b16 v[192:193], v6 offset:28672
    v_mfma_f32_16x16x32_bf16 v[32:35], v[140:143], v[128:131], 0
    ds_read_b64_tr_b16 v[194:195], v6 offset:29184
    v_mfma_f32_16x16x32_bf16 v[36:39], v[144:147], v[128:131], 0
    ds_read_b64_tr_b16 v[196:197], v7 offset:28672
    v_mfma_f32_16x16x32_bf16 v[56:59], v[148:151], v[124:127], 0
    ds_read_b64_tr_b16 v[198:199], v7 offset:29184
    v_mfma_f32_16x16x32_bf16 v[60:63], v[152:155], v[124:127], 0
    ds_read_b64_tr_b16 v[200:201], v8 offset:4096
    v_mfma_f32_16x16x32_bf16 v[24:27], v[140:143], v[124:127], 0
    ds_read_b64_tr_b16 v[202:203], v8 offset:4608
    v_mfma_f32_16x16x32_bf16 v[28:31], v[144:147], v[124:127], 0
    ds_read_b64_tr_b16 v[204:205], v9 offset:4096
    v_mfma_f32_16x16x32_bf16 v[48:51], v[148:151], v[120:123], 0
    ds_read_b64_tr_b16 v[206:207], v9 offset:4608
    v_mfma_f32_16x16x32_bf16 v[52:55], v[152:155], v[120:123], 0
    v_mfma_f32_16x16x32_bf16 v[16:19], v[140:143], v[120:123], 0
    v_mfma_f32_16x16x32_bf16 v[20:23], v[144:147], v[120:123], 0
    v_mfma_f32_16x16x32_bf16 v[96:99], v[128:131], v[156:159], 0
    v_mfma_f32_16x16x32_bf16 v[100:103], v[128:131], v[160:163], 0
    v_mfma_f32_16x16x32_bf16 v[88:91], v[124:127], v[156:159], 0
    v_mfma_f32_16x16x32_bf16 v[92:95], v[124:127], v[160:163], 0
    v_mfma_f32_16x16x32_bf16 v[80:83], v[120:123], v[156:159], 0
    v_mfma_f32_16x16x32_bf16 v[84:87], v[120:123], v[160:163], 0
    s_waitcnt vmcnt(0)
    s_waitcnt lgkmcnt(0)
    s_barrier
    v_mfma_f32_16x16x32_bf16 v[112:115], v[192:195], v[180:183], v[112:115]
    ds_read_b128 v[120:123], v4 offset:18432
    v_mfma_f32_16x16x32_bf16 v[116:119], v[180:183], v[200:203], v[116:119]
    ds_read_b128 v[124:127], v4 offset:20480
    v_mfma_f32_16x16x32_bf16 v[72:75], v[192:195], v[176:179], v[72:75]
    ds_read_b128 v[128:131], v4 offset:22528
    v_mfma_f32_16x16x32_bf16 v[76:79], v[196:199], v[176:179], v[76:79]
    ds_read_b128 v[132:135], v4 offset:24576
    v_mfma_f32_16x16x32_bf16 v[104:107], v[176:179], v[200:203], v[104:107]
    ds_read_b128 v[136:139], v2 offset:18432
    v_mfma_f32_16x16x32_bf16 v[108:111], v[176:179], v[204:207], v[108:111]
    ds_read_b64_tr_b16 v[140:141], v6 offset:8192
    v_mfma_f32_16x16x32_bf16 v[40:43], v[184:187], v[176:179], v[40:43]
    ds_read_b64_tr_b16 v[142:143], v6 offset:8704
    v_mfma_f32_16x16x32_bf16 v[44:47], v[188:191], v[176:179], v[44:47]
    ds_read_b64_tr_b16 v[144:145], v7 offset:8192
    v_mfma_f32_16x16x32_bf16 v[64:67], v[192:195], v[172:175], v[64:67]
    ds_read_b64_tr_b16 v[146:147], v7 offset:8704
    v_mfma_f32_16x16x32_bf16 v[68:71], v[196:199], v[172:175], v[68:71]
    ds_read_b64_tr_b16 v[148:149], v6 offset:32768
    v_mfma_f32_16x16x32_bf16 v[32:35], v[184:187], v[172:175], v[32:35]
    ds_read_b64_tr_b16 v[150:151], v6 offset:33280
    v_mfma_f32_16x16x32_bf16 v[36:39], v[188:191], v[172:175], v[36:39]
    ds_read_b64_tr_b16 v[152:153], v7 offset:32768
    v_mfma_f32_16x16x32_bf16 v[56:59], v[192:195], v[168:171], v[56:59]
    ds_read_b64_tr_b16 v[154:155], v7 offset:33280
    v_mfma_f32_16x16x32_bf16 v[60:63], v[196:199], v[168:171], v[60:63]
    ds_read_b64_tr_b16 v[156:157], v8 offset:8192
    v_mfma_f32_16x16x32_bf16 v[24:27], v[184:187], v[168:171], v[24:27]
    ds_read_b64_tr_b16 v[158:159], v8 offset:8704
    v_mfma_f32_16x16x32_bf16 v[28:31], v[188:191], v[168:171], v[28:31]
    ds_read_b64_tr_b16 v[160:161], v9 offset:8192
    v_mfma_f32_16x16x32_bf16 v[48:51], v[192:195], v[164:167], v[48:51]
    ds_read_b64_tr_b16 v[162:163], v9 offset:8704
    v_mfma_f32_16x16x32_bf16 v[52:55], v[196:199], v[164:167], v[52:55]
    v_mfma_f32_16x16x32_bf16 v[16:19], v[184:187], v[164:167], v[16:19]
    v_mfma_f32_16x16x32_bf16 v[20:23], v[188:191], v[164:167], v[20:23]
    v_mfma_f32_16x16x32_bf16 v[96:99], v[172:175], v[200:203], v[96:99]
    v_mfma_f32_16x16x32_bf16 v[100:103], v[172:175], v[204:207], v[100:103]
    v_mfma_f32_16x16x32_bf16 v[88:91], v[168:171], v[200:203], v[88:91]
    v_mfma_f32_16x16x32_bf16 v[92:95], v[168:171], v[204:207], v[92:95]
    v_mfma_f32_16x16x32_bf16 v[80:83], v[164:167], v[200:203], v[80:83]
    v_mfma_f32_16x16x32_bf16 v[84:87], v[164:167], v[204:207], v[84:87]
    s_waitcnt lgkmcnt(0)
    v_mfma_f32_16x16x32_bf16 v[112:115], v[148:151], v[136:139], v[112:115]
    ds_read_b128 v[164:167], v5 offset:18432
    v_mfma_f32_16x16x32_bf16 v[116:119], v[136:139], v[156:159], v[116:119]
    ds_read_b128 v[168:171], v5 offset:20480
    v_mfma_f32_16x16x32_bf16 v[72:75], v[148:151], v[132:135], v[72:75]
    ds_read_b128 v[172:175], v5 offset:22528
    v_mfma_f32_16x16x32_bf16 v[76:79], v[152:155], v[132:135], v[76:79]
    ds_read_b128 v[176:179], v5 offset:24576
    v_mfma_f32_16x16x32_bf16 v[104:107], v[132:135], v[156:159], v[104:107]
    ds_read_b128 v[180:183], v3 offset:18432
    v_mfma_f32_16x16x32_bf16 v[108:111], v[132:135], v[160:163], v[108:111]
    ds_read_b64_tr_b16 v[184:185], v6 offset:12288
    v_mfma_f32_16x16x32_bf16 v[40:43], v[140:143], v[132:135], v[40:43]
    ds_read_b64_tr_b16 v[186:187], v6 offset:12800
    v_mfma_f32_16x16x32_bf16 v[44:47], v[144:147], v[132:135], v[44:47]
    ds_read_b64_tr_b16 v[188:189], v7 offset:12288
    v_mfma_f32_16x16x32_bf16 v[64:67], v[148:151], v[128:131], v[64:67]
    ds_read_b64_tr_b16 v[190:191], v7 offset:12800
    v_mfma_f32_16x16x32_bf16 v[68:71], v[152:155], v[128:131], v[68:71]
    ds_read_b64_tr_b16 v[192:193], v6 offset:36864
    v_mfma_f32_16x16x32_bf16 v[32:35], v[140:143], v[128:131], v[32:35]
    ds_read_b64_tr_b16 v[194:195], v6 offset:37376
    v_mfma_f32_16x16x32_bf16 v[36:39], v[144:147], v[128:131], v[36:39]
    ds_read_b64_tr_b16 v[196:197], v7 offset:36864
    v_mfma_f32_16x16x32_bf16 v[56:59], v[148:151], v[124:127], v[56:59]
    ds_read_b64_tr_b16 v[198:199], v7 offset:37376
    v_mfma_f32_16x16x32_bf16 v[60:63], v[152:155], v[124:127], v[60:63]
    ds_read_b64_tr_b16 v[200:201], v8 offset:12288
    v_mfma_f32_16x16x32_bf16 v[24:27], v[140:143], v[124:127], v[24:27]
    ds_read_b64_tr_b16 v[202:203], v8 offset:12800
    v_mfma_f32_16x16x32_bf16 v[28:31], v[144:147], v[124:127], v[28:31]
    ds_read_b64_tr_b16 v[204:205], v9 offset:12288
    v_mfma_f32_16x16x32_bf16 v[48:51], v[148:151], v[120:123], v[48:51]
    ds_read_b64_tr_b16 v[206:207], v9 offset:12800
    v_mfma_f32_16x16x32_bf16 v[52:55], v[152:155], v[120:123], v[52:55]
    v_mfma_f32_16x16x32_bf16 v[16:19], v[140:143], v[120:123], v[16:19]
    v_mfma_f32_16x16x32_bf16 v[20:23], v[144:147], v[120:123], v[20:23]
    v_mfma_f32_16x16x32_bf16 v[96:99], v[128:131], v[156:159], v[96:99]
    v_mfma_f32_16x16x32_bf16 v[100:103], v[128:131], v[160:163], v[100:103]
    v_mfma_f32_16x16x32_bf16 v[88:91], v[124:127], v[156:159], v[88:91]
    v_mfma_f32_16x16x32_bf16 v[92:95], v[124:127], v[160:163], v[92:95]
    v_mfma_f32_16x16x32_bf16 v[80:83], v[120:123], v[156:159], v[80:83]
    v_mfma_f32_16x16x32_bf16 v[84:87], v[120:123], v[160:163], v[84:87]
    s_waitcnt lgkmcnt(0)
    s_barrier
    v_mfma_f32_16x16x32_bf16 v[112:115], v[192:195], v[180:183], v[112:115]
    ds_read_b128 v[120:123], v4 offset:36864
    v_mfma_f32_16x16x32_bf16 v[116:119], v[180:183], v[200:203], v[116:119]
    ds_read_b128 v[124:127], v4 offset:38912
    v_mfma_f32_16x16x32_bf16 v[72:75], v[192:195], v[176:179], v[72:75]
    ds_read_b128 v[128:131], v4 offset:40960
    v_mfma_f32_16x16x32_bf16 v[76:79], v[196:199], v[176:179], v[76:79]
    ds_read_b128 v[132:135], v4 offset:43008
    v_mfma_f32_16x16x32_bf16 v[104:107], v[176:179], v[200:203], v[104:107]
    ds_read_b128 v[136:139], v2 offset:36864
    v_mfma_f32_16x16x32_bf16 v[108:111], v[176:179], v[204:207], v[108:111]
    ds_read_b64_tr_b16 v[140:141], v6 offset:16384
    v_mfma_f32_16x16x32_bf16 v[40:43], v[184:187], v[176:179], v[40:43]
    ds_read_b64_tr_b16 v[142:143], v6 offset:16896
    v_mfma_f32_16x16x32_bf16 v[44:47], v[188:191], v[176:179], v[44:47]
    ds_read_b64_tr_b16 v[144:145], v7 offset:16384
    v_mfma_f32_16x16x32_bf16 v[64:67], v[192:195], v[172:175], v[64:67]
    ds_read_b64_tr_b16 v[146:147], v7 offset:16896
    v_mfma_f32_16x16x32_bf16 v[68:71], v[196:199], v[172:175], v[68:71]
    ds_read_b64_tr_b16 v[148:149], v6 offset:40960
    v_mfma_f32_16x16x32_bf16 v[32:35], v[184:187], v[172:175], v[32:35]
    ds_read_b64_tr_b16 v[150:151], v6 offset:41472
    v_mfma_f32_16x16x32_bf16 v[36:39], v[188:191], v[172:175], v[36:39]
    ds_read_b64_tr_b16 v[152:153], v7 offset:40960
    v_mfma_f32_16x16x32_bf16 v[56:59], v[192:195], v[168:171], v[56:59]
    ds_read_b64_tr_b16 v[154:155], v7 offset:41472
    v_mfma_f32_16x16x32_bf16 v[60:63], v[196:199], v[168:171], v[60:63]
    ds_read_b64_tr_b16 v[156:157], v8 offset:16384
    v_mfma_f32_16x16x32_bf16 v[24:27], v[184:187], v[168:171], v[24:27]
    ds_read_b64_tr_b16 v[158:159], v8 offset:16896
    v_mfma_f32_16x16x32_bf16 v[28:31], v[188:191], v[168:171], v[28:31]
    ds_read_b64_tr_b16 v[160:161], v9 offset:16384
    v_mfma_f32_16x16x32_bf16 v[48:51], v[192:195], v[164:167], v[48:51]
    ds_read_b64_tr_b16 v[162:163], v9 offset:16896
    v_mfma_f32_16x16x32_bf16 v[52:55], v[196:199], v[164:167], v[52:55]
    v_mfma_f32_16x16x32_bf16 v[16:19], v[184:187], v[164:167], v[16:19]
    v_mfma_f32_16x16x32_bf16 v[20:23], v[188:191], v[164:167], v[20:23]
    v_mfma_f32_16x16x32_bf16 v[96:99], v[172:175], v[200:203], v[96:99]
    v_mfma_f32_16x16x32_bf16 v[100:103], v[172:175], v[204:207], v[100:103]
    v_mfma_f32_16x16x32_bf16 v[88:91], v[168:171], v[200:203], v[88:91]
    v_mfma_f32_16x16x32_bf16 v[92:95], v[168:171], v[204:207], v[92:95]
    v_mfma_f32_16x16x32_bf16 v[80:83], v[164:167], v[200:203], v[80:83]
    v_mfma_f32_16x16x32_bf16 v[84:87], v[164:167], v[204:207], v[84:87]
    s_waitcnt lgkmcnt(0)
    v_mfma_f32_16x16x32_bf16 v[112:115], v[148:151], v[136:139], v[112:115]
    ds_read_b128 v[164:167], v5 offset:36864
    v_mfma_f32_16x16x32_bf16 v[116:119], v[136:139], v[156:159], v[116:119]
    ds_read_b128 v[168:171], v5 offset:38912
    v_mfma_f32_16x16x32_bf16 v[72:75], v[148:151], v[132:135], v[72:75]
    ds_read_b128 v[172:175], v5 offset:40960
    v_mfma_f32_16x16x32_bf16 v[76:79], v[152:155], v[132:135], v[76:79]
    ds_read_b128 v[176:179], v5 offset:43008
    v_mfma_f32_16x16x32_bf16 v[104:107], v[132:135], v[156:159], v[104:107]
    ds_read_b128 v[180:183], v3 offset:36864
    v_mfma_f32_16x16x32_bf16 v[108:111], v[132:135], v[160:163], v[108:111]
    ds_read_b64_tr_b16 v[184:185], v6 offset:20480
    v_mfma_f32_16x16x32_bf16 v[40:43], v[140:143], v[132:135], v[40:43]
    ds_read_b64_tr_b16 v[186:187], v6 offset:20992
    v_mfma_f32_16x16x32_bf16 v[44:47], v[144:147], v[132:135], v[44:47]
    ds_read_b64_tr_b16 v[188:189], v7 offset:20480
    v_mfma_f32_16x16x32_bf16 v[64:67], v[148:151], v[128:131], v[64:67]
    ds_read_b64_tr_b16 v[190:191], v7 offset:20992
    v_mfma_f32_16x16x32_bf16 v[68:71], v[152:155], v[128:131], v[68:71]
    ds_read_b64_tr_b16 v[192:193], v6 offset:45056
    v_mfma_f32_16x16x32_bf16 v[32:35], v[140:143], v[128:131], v[32:35]
    ds_read_b64_tr_b16 v[194:195], v6 offset:45568
    v_mfma_f32_16x16x32_bf16 v[36:39], v[144:147], v[128:131], v[36:39]
    ds_read_b64_tr_b16 v[196:197], v7 offset:45056
    v_mfma_f32_16x16x32_bf16 v[56:59], v[148:151], v[124:127], v[56:59]
    ds_read_b64_tr_b16 v[198:199], v7 offset:45568
    v_mfma_f32_16x16x32_bf16 v[60:63], v[152:155], v[124:127], v[60:63]
    ds_read_b64_tr_b16 v[200:201], v8 offset:20480
    v_mfma_f32_16x16x32_bf16 v[24:27], v[140:143], v[124:127], v[24:27]
    ds_read_b64_tr_b16 v[202:203], v8 offset:20992
    v_mfma_f32_16x16x32_bf16 v[28:31], v[144:147], v[124:127], v[28:31]
    ds_read_b64_tr_b16 v[204:205], v9 offset:20480
    v_mfma_f32_16x16x32_bf16 v[48:51], v[148:151], v[120:123], v[48:51]
    ds_read_b64_tr_b16 v[206:207], v9 offset:20992
    v_mfma_f32_16x16x32_bf16 v[52:55], v[152:155], v[120:123], v[52:55]
    v_mfma_f32_16x16x32_bf16 v[16:19], v[140:143], v[120:123], v[16:19]
    v_mfma_f32_16x16x32_bf16 v[20:23], v[144:147], v[120:123], v[20:23]
    v_mfma_f32_16x16x32_bf16 v[96:99], v[128:131], v[156:159], v[96:99]
    v_mfma_f32_16x16x32_bf16 v[100:103], v[128:131], v[160:163], v[100:103]
    v_mfma_f32_16x16x32_bf16 v[88:91], v[124:127], v[156:159], v[88:91]
    v_mfma_f32_16x16x32_bf16 v[92:95], v[124:127], v[160:163], v[92:95]
    v_mfma_f32_16x16x32_bf16 v[80:83], v[120:123], v[156:159], v[80:83]
    v_mfma_f32_16x16x32_bf16 v[84:87], v[120:123], v[160:163], v[84:87]
    s_waitcnt lgkmcnt(0)
    s_barrier
    v_mfma_f32_16x16x32_bf16 v[112:115], v[192:195], v[180:183], v[112:115]
    ds_read_b128 v[120:123], v4 offset:0
    v_mfma_f32_16x16x32_bf16 v[116:119], v[180:183], v[200:203], v[116:119]
    ds_read_b128 v[124:127], v4 offset:2048
    v_mfma_f32_16x16x32_bf16 v[72:75], v[192:195], v[176:179], v[72:75]
    ds_read_b128 v[128:131], v4 offset:4096
    v_mfma_f32_16x16x32_bf16 v[76:79], v[196:199], v[176:179], v[76:79]
    ds_read_b128 v[132:135], v4 offset:6144
    v_mfma_f32_16x16x32_bf16 v[104:107], v[176:179], v[200:203], v[104:107]
    ds_read_b128 v[136:139], v2 offset:0
    v_mfma_f32_16x16x32_bf16 v[108:111], v[176:179], v[204:207], v[108:111]
    ds_read_b64_tr_b16 v[140:141], v6 offset:0
    v_mfma_f32_16x16x32_bf16 v[40:43], v[184:187], v[176:179], v[40:43]
    ds_read_b64_tr_b16 v[142:143], v6 offset:512
    v_mfma_f32_16x16x32_bf16 v[44:47], v[188:191], v[176:179], v[44:47]
    ds_read_b64_tr_b16 v[144:145], v7 offset:0
    v_mfma_f32_16x16x32_bf16 v[64:67], v[192:195], v[172:175], v[64:67]
    ds_read_b64_tr_b16 v[146:147], v7 offset:512
    v_mfma_f32_16x16x32_bf16 v[68:71], v[196:199], v[172:175], v[68:71]
    ds_read_b64_tr_b16 v[148:149], v6 offset:24576
    v_mfma_f32_16x16x32_bf16 v[32:35], v[184:187], v[172:175], v[32:35]
    ds_read_b64_tr_b16 v[150:151], v6 offset:25088
    v_mfma_f32_16x16x32_bf16 v[36:39], v[188:191], v[172:175], v[36:39]
    ds_read_b64_tr_b16 v[152:153], v7 offset:24576
    v_mfma_f32_16x16x32_bf16 v[56:59], v[192:195], v[168:171], v[56:59]
    ds_read_b64_tr_b16 v[154:155], v7 offset:25088
    v_mfma_f32_16x16x32_bf16 v[60:63], v[196:199], v[168:171], v[60:63]
    ds_read_b64_tr_b16 v[156:157], v8 offset:0
    v_mfma_f32_16x16x32_bf16 v[24:27], v[184:187], v[168:171], v[24:27]
    ds_read_b64_tr_b16 v[158:159], v8 offset:512
    v_mfma_f32_16x16x32_bf16 v[28:31], v[188:191], v[168:171], v[28:31]
    ds_read_b64_tr_b16 v[160:161], v9 offset:0
    v_mfma_f32_16x16x32_bf16 v[48:51], v[192:195], v[164:167], v[48:51]
    ds_read_b64_tr_b16 v[162:163], v9 offset:512
    v_mfma_f32_16x16x32_bf16 v[52:55], v[196:199], v[164:167], v[52:55]
    v_mfma_f32_16x16x32_bf16 v[16:19], v[184:187], v[164:167], v[16:19]
    v_mfma_f32_16x16x32_bf16 v[20:23], v[188:191], v[164:167], v[20:23]
    v_mfma_f32_16x16x32_bf16 v[96:99], v[172:175], v[200:203], v[96:99]
    v_mfma_f32_16x16x32_bf16 v[100:103], v[172:175], v[204:207], v[100:103]
    v_mfma_f32_16x16x32_bf16 v[88:91], v[168:171], v[200:203], v[88:91]
    v_mfma_f32_16x16x32_bf16 v[92:95], v[168:171], v[204:207], v[92:95]
    v_mfma_f32_16x16x32_bf16 v[80:83], v[164:167], v[200:203], v[80:83]
    v_mfma_f32_16x16x32_bf16 v[84:87], v[164:167], v[204:207], v[84:87]
    s_waitcnt lgkmcnt(0)
    v_mfma_f32_16x16x32_bf16 v[112:115], v[148:151], v[136:139], v[112:115]
    ds_read_b128 v[164:167], v5 offset:0
    v_mfma_f32_16x16x32_bf16 v[116:119], v[136:139], v[156:159], v[116:119]
    ds_read_b128 v[168:171], v5 offset:2048
    v_mfma_f32_16x16x32_bf16 v[72:75], v[148:151], v[132:135], v[72:75]
    ds_read_b128 v[172:175], v5 offset:4096
    v_mfma_f32_16x16x32_bf16 v[76:79], v[152:155], v[132:135], v[76:79]
    ds_read_b128 v[176:179], v5 offset:6144
    v_mfma_f32_16x16x32_bf16 v[104:107], v[132:135], v[156:159], v[104:107]
    ds_read_b128 v[180:183], v3 offset:0
    v_mfma_f32_16x16x32_bf16 v[108:111], v[132:135], v[160:163], v[108:111]
    ds_read_b64_tr_b16 v[184:185], v6 offset:4096
    v_mfma_f32_16x16x32_bf16 v[40:43], v[140:143], v[132:135], v[40:43]
    ds_read_b64_tr_b16 v[186:187], v6 offset:4608
    v_mfma_f32_16x16x32_bf16 v[44:47], v[144:147], v[132:135], v[44:47]
    ds_read_b64_tr_b16 v[188:189], v7 offset:4096
    v_mfma_f32_16x16x32_bf16 v[64:67], v[148:151], v[128:131], v[64:67]
    ds_read_b64_tr_b16 v[190:191], v7 offset:4608
    v_mfma_f32_16x16x32_bf16 v[68:71], v[152:155], v[128:131], v[68:71]
    ds_read_b64_tr_b16 v[192:193], v6 offset:28672
    v_mfma_f32_16x16x32_bf16 v[32:35], v[140:143], v[128:131], v[32:35]
    ds_read_b64_tr_b16 v[194:195], v6 offset:29184
    v_mfma_f32_16x16x32_bf16 v[36:39], v[144:147], v[128:131], v[36:39]
    ds_read_b64_tr_b16 v[196:197], v7 offset:28672
    v_mfma_f32_16x16x32_bf16 v[56:59], v[148:151], v[124:127], v[56:59]
    ds_read_b64_tr_b16 v[198:199], v7 offset:29184
    v_mfma_f32_16x16x32_bf16 v[60:63], v[152:155], v[124:127], v[60:63]
    ds_read_b64_tr_b16 v[200:201], v8 offset:4096
    v_mfma_f32_16x16x32_bf16 v[24:27], v[140:143], v[124:127], v[24:27]
    ds_read_b64_tr_b16 v[202:203], v8 offset:4608
    v_mfma_f32_16x16x32_bf16 v[28:31], v[144:147], v[124:127], v[28:31]
    ds_read_b64_tr_b16 v[204:205], v9 offset:4096
    v_mfma_f32_16x16x32_bf16 v[48:51], v[148:151], v[120:123], v[48:51]
    ds_read_b64_tr_b16 v[206:207], v9 offset:4608
    v_mfma_f32_16x16x32_bf16 v[52:55], v[152:155], v[120:123], v[52:55]
    v_mfma_f32_16x16x32_bf16 v[16:19], v[140:143], v[120:123], v[16:19]
    v_mfma_f32_16x16x32_bf16 v[20:23], v[144:147], v[120:123], v[20:23]
    v_mfma_f32_16x16x32_bf16 v[96:99], v[128:131], v[156:159], v[96:99]
    v_mfma_f32_16x16x32_bf16 v[100:103], v[128:131], v[160:163], v[100:103]
    v_mfma_f32_16x16x32_bf16 v[88:91], v[124:127], v[156:159], v[88:91]
    v_mfma_f32_16x16x32_bf16 v[92:95], v[124:127], v[160:163], v[92:95]
    v_mfma_f32_16x16x32_bf16 v[80:83], v[120:123], v[156:159], v[80:83]
    v_mfma_f32_16x16x32_bf16 v[84:87], v[120:123], v[160:163], v[84:87]
    s_waitcnt lgkmcnt(0)
    s_barrier
    v_mfma_f32_16x16x32_bf16 v[112:115], v[192:195], v[180:183], v[112:115]
    ds_read_b128 v[120:123], v4 offset:18432
    v_mfma_f32_16x16x32_bf16 v[116:119], v[180:183], v[200:203], v[116:119]
    ds_read_b128 v[124:127], v4 offset:20480
    v_mfma_f32_16x16x32_bf16 v[72:75], v[192:195], v[176:179], v[72:75]
    ds_read_b128 v[128:131], v4 offset:22528
    v_mfma_f32_16x16x32_bf16 v[76:79], v[196:199], v[176:179], v[76:79]
    ds_read_b128 v[132:135], v4 offset:24576
    v_mfma_f32_16x16x32_bf16 v[104:107], v[176:179], v[200:203], v[104:107]
    ds_read_b128 v[136:139], v2 offset:18432
    v_mfma_f32_16x16x32_bf16 v[108:111], v[176:179], v[204:207], v[108:111]
    ds_read_b64_tr_b16 v[140:141], v6 offset:8192
    v_mfma_f32_16x16x32_bf16 v[40:43], v[184:187], v[176:179], v[40:43]
    ds_read_b64_tr_b16 v[142:143], v6 offset:8704
    v_mfma_f32_16x16x32_bf16 v[44:47], v[188:191], v[176:179], v[44:47]
    ds_read_b64_tr_b16 v[144:145], v7 offset:8192
    v_mfma_f32_16x16x32_bf16 v[64:67], v[192:195], v[172:175], v[64:67]
    ds_read_b64_tr_b16 v[146:147], v7 offset:8704
    v_mfma_f32_16x16x32_bf16 v[68:71], v[196:199], v[172:175], v[68:71]
    ds_read_b64_tr_b16 v[148:149], v6 offset:32768
    v_mfma_f32_16x16x32_bf16 v[32:35], v[184:187], v[172:175], v[32:35]
    ds_read_b64_tr_b16 v[150:151], v6 offset:33280
    v_mfma_f32_16x16x32_bf16 v[36:39], v[188:191], v[172:175], v[36:39]
    ds_read_b64_tr_b16 v[152:153], v7 offset:32768
    v_mfma_f32_16x16x32_bf16 v[56:59], v[192:195], v[168:171], v[56:59]
    ds_read_b64_tr_b16 v[154:155], v7 offset:33280
    v_mfma_f32_16x16x32_bf16 v[60:63], v[196:199], v[168:171], v[60:63]
    ds_read_b64_tr_b16 v[156:157], v8 offset:8192
    v_mfma_f32_16x16x32_bf16 v[24:27], v[184:187], v[168:171], v[24:27]
    ds_read_b64_tr_b16 v[158:159], v8 offset:8704
    v_mfma_f32_16x16x32_bf16 v[28:31], v[188:191], v[168:171], v[28:31]
    ds_read_b64_tr_b16 v[160:161], v9 offset:8192
    v_mfma_f32_16x16x32_bf16 v[48:51], v[192:195], v[164:167], v[48:51]
    ds_read_b64_tr_b16 v[162:163], v9 offset:8704
    v_mfma_f32_16x16x32_bf16 v[52:55], v[196:199], v[164:167], v[52:55]
    v_mfma_f32_16x16x32_bf16 v[16:19], v[184:187], v[164:167], v[16:19]
    v_mfma_f32_16x16x32_bf16 v[20:23], v[188:191], v[164:167], v[20:23]
    v_mfma_f32_16x16x32_bf16 v[96:99], v[172:175], v[200:203], v[96:99]
    v_mfma_f32_16x16x32_bf16 v[100:103], v[172:175], v[204:207], v[100:103]
    v_mfma_f32_16x16x32_bf16 v[88:91], v[168:171], v[200:203], v[88:91]
    v_mfma_f32_16x16x32_bf16 v[92:95], v[168:171], v[204:207], v[92:95]
    v_mfma_f32_16x16x32_bf16 v[80:83], v[164:167], v[200:203], v[80:83]
    v_mfma_f32_16x16x32_bf16 v[84:87], v[164:167], v[204:207], v[84:87]
    s_waitcnt lgkmcnt(0)
    v_mfma_f32_16x16x32_bf16 v[112:115], v[148:151], v[136:139], v[112:115]
    ds_read_b128 v[164:167], v5 offset:18432
    v_mfma_f32_16x16x32_bf16 v[116:119], v[136:139], v[156:159], v[116:119]
    ds_read_b128 v[168:171], v5 offset:20480
    v_mfma_f32_16x16x32_bf16 v[72:75], v[148:151], v[132:135], v[72:75]
    ds_read_b128 v[172:175], v5 offset:22528
    v_mfma_f32_16x16x32_bf16 v[76:79], v[152:155], v[132:135], v[76:79]
    ds_read_b128 v[176:179], v5 offset:24576
    v_mfma_f32_16x16x32_bf16 v[104:107], v[132:135], v[156:159], v[104:107]
    ds_read_b128 v[180:183], v3 offset:18432
    v_mfma_f32_16x16x32_bf16 v[108:111], v[132:135], v[160:163], v[108:111]
    ds_read_b64_tr_b16 v[184:185], v6 offset:12288
    v_mfma_f32_16x16x32_bf16 v[40:43], v[140:143], v[132:135], v[40:43]
    ds_read_b64_tr_b16 v[186:187], v6 offset:12800
    v_mfma_f32_16x16x32_bf16 v[44:47], v[144:147], v[132:135], v[44:47]
    ds_read_b64_tr_b16 v[188:189], v7 offset:12288
    v_mfma_f32_16x16x32_bf16 v[64:67], v[148:151], v[128:131], v[64:67]
    ds_read_b64_tr_b16 v[190:191], v7 offset:12800
    v_mfma_f32_16x16x32_bf16 v[68:71], v[152:155], v[128:131], v[68:71]
    ds_read_b64_tr_b16 v[192:193], v6 offset:36864
    v_mfma_f32_16x16x32_bf16 v[32:35], v[140:143], v[128:131], v[32:35]
    ds_read_b64_tr_b16 v[194:195], v6 offset:37376
    v_mfma_f32_16x16x32_bf16 v[36:39], v[144:147], v[128:131], v[36:39]
    ds_read_b64_tr_b16 v[196:197], v7 offset:36864
    v_mfma_f32_16x16x32_bf16 v[56:59], v[148:151], v[124:127], v[56:59]
    ds_read_b64_tr_b16 v[198:199], v7 offset:37376
    v_mfma_f32_16x16x32_bf16 v[60:63], v[152:155], v[124:127], v[60:63]
    ds_read_b64_tr_b16 v[200:201], v8 offset:12288
    v_mfma_f32_16x16x32_bf16 v[24:27], v[140:143], v[124:127], v[24:27]
    ds_read_b64_tr_b16 v[202:203], v8 offset:12800
    v_mfma_f32_16x16x32_bf16 v[28:31], v[144:147], v[124:127], v[28:31]
    ds_read_b64_tr_b16 v[204:205], v9 offset:12288
    v_mfma_f32_16x16x32_bf16 v[48:51], v[148:151], v[120:123], v[48:51]
    ds_read_b64_tr_b16 v[206:207], v9 offset:12800
    v_mfma_f32_16x16x32_bf16 v[52:55], v[152:155], v[120:123], v[52:55]
    v_mfma_f32_16x16x32_bf16 v[16:19], v[140:143], v[120:123], v[16:19]
    v_mfma_f32_16x16x32_bf16 v[20:23], v[144:147], v[120:123], v[20:23]
    v_mfma_f32_16x16x32_bf16 v[96:99], v[128:131], v[156:159], v[96:99]
    v_mfma_f32_16x16x32_bf16 v[100:103], v[128:131], v[160:163], v[100:103]
    v_mfma_f32_16x16x32_bf16 v[88:91], v[124:127], v[156:159], v[88:91]
    v_mfma_f32_16x16x32_bf16 v[92:95], v[124:127], v[160:163], v[92:95]
    v_mfma_f32_16x16x32_bf16 v[80:83], v[120:123], v[156:159], v[80:83]
    v_mfma_f32_16x16x32_bf16 v[84:87], v[120:123], v[160:163], v[84:87]
    s_waitcnt lgkmcnt(0)
    s_barrier
    v_mfma_f32_16x16x32_bf16 v[112:115], v[192:195], v[180:183], v[112:115]
    ds_read_b128 v[120:123], v4 offset:36864
    v_mfma_f32_16x16x32_bf16 v[116:119], v[180:183], v[200:203], v[116:119]
    ds_read_b128 v[124:127], v4 offset:38912
    v_mfma_f32_16x16x32_bf16 v[72:75], v[192:195], v[176:179], v[72:75]
    ds_read_b128 v[128:131], v4 offset:40960
    v_mfma_f32_16x16x32_bf16 v[76:79], v[196:199], v[176:179], v[76:79]
    ds_read_b128 v[132:135], v4 offset:43008
    v_mfma_f32_16x16x32_bf16 v[104:107], v[176:179], v[200:203], v[104:107]
    ds_read_b128 v[136:139], v2 offset:36864
    v_mfma_f32_16x16x32_bf16 v[108:111], v[176:179], v[204:207], v[108:111]
    ds_read_b64_tr_b16 v[140:141], v6 offset:16384
    v_mfma_f32_16x16x32_bf16 v[40:43], v[184:187], v[176:179], v[40:43]
    ds_read_b64_tr_b16 v[142:143], v6 offset:16896
    v_mfma_f32_16x16x32_bf16 v[44:47], v[188:191], v[176:179], v[44:47]
    ds_read_b64_tr_b16 v[144:145], v7 offset:16384
    v_mfma_f32_16x16x32_bf16 v[64:67], v[192:195], v[172:175], v[64:67]
    ds_read_b64_tr_b16 v[146:147], v7 offset:16896
    v_mfma_f32_16x16x32_bf16 v[68:71], v[196:199], v[172:175], v[68:71]
    ds_read_b64_tr_b16 v[148:149], v6 offset:40960
    v_mfma_f32_16x16x32_bf16 v[32:35], v[184:187], v[172:175], v[32:35]
    ds_read_b64_tr_b16 v[150:151], v6 offset:41472
    v_mfma_f32_16x16x32_bf16 v[36:39], v[188:191], v[172:175], v[36:39]
    ds_read_b64_tr_b16 v[152:153], v7 offset:40960
    v_mfma_f32_16x16x32_bf16 v[56:59], v[192:195], v[168:171], v[56:59]
    ds_read_b64_tr_b16 v[154:155], v7 offset:41472
    v_mfma_f32_16x16x32_bf16 v[60:63], v[196:199], v[168:171], v[60:63]
    ds_read_b64_tr_b16 v[156:157], v8 offset:16384
    v_mfma_f32_16x16x32_bf16 v[24:27], v[184:187], v[168:171], v[24:27]
    ds_read_b64_tr_b16 v[158:159], v8 offset:16896
    v_mfma_f32_16x16x32_bf16 v[28:31], v[188:191], v[168:171], v[28:31]
    ds_read_b64_tr_b16 v[160:161], v9 offset:16384
    v_mfma_f32_16x16x32_bf16 v[48:51], v[192:195], v[164:167], v[48:51]
    ds_read_b64_tr_b16 v[162:163], v9 offset:16896
    v_mfma_f32_16x16x32_bf16 v[52:55], v[196:199], v[164:167], v[52:55]
    v_mfma_f32_16x16x32_bf16 v[16:19], v[184:187], v[164:167], v[16:19]
    v_mfma_f32_16x16x32_bf16 v[20:23], v[188:191], v[164:167], v[20:23]
    v_mfma_f32_16x16x32_bf16 v[96:99], v[172:175], v[200:203], v[96:99]
    v_mfma_f32_16x16x32_bf16 v[100:103], v[172:175], v[204:207], v[100:103]
    v_mfma_f32_16x16x32_bf16 v[88:91], v[168:171], v[200:203], v[88:91]
    v_mfma_f32_16x16x32_bf16 v[92:95], v[168:171], v[204:207], v[92:95]
    v_mfma_f32_16x16x32_bf16 v[80:83], v[164:167], v[200:203], v[80:83]
    v_mfma_f32_16x16x32_bf16 v[84:87], v[164:167], v[204:207], v[84:87]
    s_waitcnt lgkmcnt(0)
    v_mfma_f32_16x16x32_bf16 v[112:115], v[148:151], v[136:139], v[112:115]
    ds_read_b128 v[164:167], v5 offset:36864
    v_mfma_f32_16x16x32_bf16 v[116:119], v[136:139], v[156:159], v[116:119]
    ds_read_b128 v[168:171], v5 offset:38912
    v_mfma_f32_16x16x32_bf16 v[72:75], v[148:151], v[132:135], v[72:75]
    ds_read_b128 v[172:175], v5 offset:40960
    v_mfma_f32_16x16x32_bf16 v[76:79], v[152:155], v[132:135], v[76:79]
    ds_read_b128 v[176:179], v5 offset:43008
    v_mfma_f32_16x16x32_bf16 v[104:107], v[132:135], v[156:159], v[104:107]
    ds_read_b128 v[180:183], v3 offset:36864
    v_mfma_f32_16x16x32_bf16 v[108:111], v[132:135], v[160:163], v[108:111]
    ds_read_b64_tr_b16 v[184:185], v6 offset:20480
    v_mfma_f32_16x16x32_bf16 v[40:43], v[140:143], v[132:135], v[40:43]
    ds_read_b64_tr_b16 v[186:187], v6 offset:20992
    v_mfma_f32_16x16x32_bf16 v[44:47], v[144:147], v[132:135], v[44:47]
    ds_read_b64_tr_b16 v[188:189], v7 offset:20480
    v_mfma_f32_16x16x32_bf16 v[64:67], v[148:151], v[128:131], v[64:67]
    ds_read_b64_tr_b16 v[190:191], v7 offset:20992
    v_mfma_f32_16x16x32_bf16 v[68:71], v[152:155], v[128:131], v[68:71]
    ds_read_b64_tr_b16 v[192:193], v6 offset:45056
    v_mfma_f32_16x16x32_bf16 v[32:35], v[140:143], v[128:131], v[32:35]
    ds_read_b64_tr_b16 v[194:195], v6 offset:45568
    v_mfma_f32_16x16x32_bf16 v[36:39], v[144:147], v[128:131], v[36:39]
    ds_read_b64_tr_b16 v[196:197], v7 offset:45056
    v_mfma_f32_16x16x32_bf16 v[56:59], v[148:151], v[124:127], v[56:59]
    ds_read_b64_tr_b16 v[198:199], v7 offset:45568
    v_mfma_f32_16x16x32_bf16 v[60:63], v[152:155], v[124:127], v[60:63]
    ds_read_b64_tr_b16 v[200:201], v8 offset:20480
    v_mfma_f32_16x16x32_bf16 v[24:27], v[140:143], v[124:127], v[24:27]
    ds_read_b64_tr_b16 v[202:203], v8 offset:20992
    v_mfma_f32_16x16x32_bf16 v[28:31], v[144:147], v[124:127], v[28:31]
    ds_read_b64_tr_b16 v[204:205], v9 offset:20480
    v_mfma_f32_16x16x32_bf16 v[48:51], v[148:151], v[120:123], v[48:51]
    ds_read_b64_tr_b16 v[206:207], v9 offset:20992
    v_mfma_f32_16x16x32_bf16 v[52:55], v[152:155], v[120:123], v[52:55]
    v_mfma_f32_16x16x32_bf16 v[16:19], v[140:143], v[120:123], v[16:19]
    v_mfma_f32_16x16x32_bf16 v[20:23], v[144:147], v[120:123], v[20:23]
    v_mfma_f32_16x16x32_bf16 v[96:99], v[128:131], v[156:159], v[96:99]
    v_mfma_f32_16x16x32_bf16 v[100:103], v[128:131], v[160:163], v[100:103]
    v_mfma_f32_16x16x32_bf16 v[88:91], v[124:127], v[156:159], v[88:91]
    v_mfma_f32_16x16x32_bf16 v[92:95], v[124:127], v[160:163], v[92:95]
    v_mfma_f32_16x16x32_bf16 v[80:83], v[120:123], v[156:159], v[80:83]
    v_mfma_f32_16x16x32_bf16 v[84:87], v[120:123], v[160:163], v[84:87]
    s_waitcnt lgkmcnt(0)
    s_barrier
    v_mfma_f32_16x16x32_bf16 v[112:115], v[192:195], v[180:183], v[112:115]
    ds_read_b128 v[120:123], v4 offset:0
    v_mfma_f32_16x16x32_bf16 v[116:119], v[180:183], v[200:203], v[116:119]
    ds_read_b128 v[124:127], v4 offset:2048
    v_mfma_f32_16x16x32_bf16 v[72:75], v[192:195], v[176:179], v[72:75]
    ds_read_b128 v[128:131], v4 offset:4096
    v_mfma_f32_16x16x32_bf16 v[76:79], v[196:199], v[176:179], v[76:79]
    ds_read_b128 v[132:135], v4 offset:6144
    v_mfma_f32_16x16x32_bf16 v[104:107], v[176:179], v[200:203], v[104:107]
    ds_read_b128 v[136:139], v2 offset:0
    v_mfma_f32_16x16x32_bf16 v[108:111], v[176:179], v[204:207], v[108:111]
    ds_read_b64_tr_b16 v[140:141], v6 offset:0
    v_mfma_f32_16x16x32_bf16 v[40:43], v[184:187], v[176:179], v[40:43]
    ds_read_b64_tr_b16 v[142:143], v6 offset:512
    v_mfma_f32_16x16x32_bf16 v[44:47], v[188:191], v[176:179], v[44:47]
    ds_read_b64_tr_b16 v[144:145], v7 offset:0
    v_mfma_f32_16x16x32_bf16 v[64:67], v[192:195], v[172:175], v[64:67]
    ds_read_b64_tr_b16 v[146:147], v7 offset:512
    v_mfma_f32_16x16x32_bf16 v[68:71], v[196:199], v[172:175], v[68:71]
    ds_read_b64_tr_b16 v[148:149], v6 offset:24576
    v_mfma_f32_16x16x32_bf16 v[32:35], v[184:187], v[172:175], v[32:35]
    ds_read_b64_tr_b16 v[150:151], v6 offset:25088
    v_mfma_f32_16x16x32_bf16 v[36:39], v[188:191], v[172:175], v[36:39]
    ds_read_b64_tr_b16 v[152:153], v7 offset:24576
    v_mfma_f32_16x16x32_bf16 v[56:59], v[192:195], v[168:171], v[56:59]
    ds_read_b64_tr_b16 v[154:155], v7 offset:25088
    v_mfma_f32_16x16x32_bf16 v[60:63], v[196:199], v[168:171], v[60:63]
    ds_read_b64_tr_b16 v[156:157], v8 offset:0
    v_mfma_f32_16x16x32_bf16 v[24:27], v[184:187], v[168:171], v[24:27]
    ds_read_b64_tr_b16 v[158:159], v8 offset:512
    v_mfma_f32_16x16x32_bf16 v[28:31], v[188:191], v[168:171], v[28:31]
    ds_read_b64_tr_b16 v[160:161], v9 offset:0
    v_mfma_f32_16x16x32_bf16 v[48:51], v[192:195], v[164:167], v[48:51]
    ds_read_b64_tr_b16 v[162:163], v9 offset:512
    v_mfma_f32_16x16x32_bf16 v[52:55], v[196:199], v[164:167], v[52:55]
    v_mfma_f32_16x16x32_bf16 v[16:19], v[184:187], v[164:167], v[16:19]
    v_mfma_f32_16x16x32_bf16 v[20:23], v[188:191], v[164:167], v[20:23]
    v_mfma_f32_16x16x32_bf16 v[96:99], v[172:175], v[200:203], v[96:99]
    v_mfma_f32_16x16x32_bf16 v[100:103], v[172:175], v[204:207], v[100:103]
    v_mfma_f32_16x16x32_bf16 v[88:91], v[168:171], v[200:203], v[88:91]
    v_mfma_f32_16x16x32_bf16 v[92:95], v[168:171], v[204:207], v[92:95]
    v_mfma_f32_16x16x32_bf16 v[80:83], v[164:167], v[200:203], v[80:83]
    v_mfma_f32_16x16x32_bf16 v[84:87], v[164:167], v[204:207], v[84:87]
    s_waitcnt lgkmcnt(0)
    v_mfma_f32_16x16x32_bf16 v[112:115], v[148:151], v[136:139], v[112:115]
    ds_read_b128 v[164:167], v5 offset:0
    v_mfma_f32_16x16x32_bf16 v[116:119], v[136:139], v[156:159], v[116:119]
    ds_read_b128 v[168:171], v5 offset:2048
    v_mfma_f32_16x16x32_bf16 v[72:75], v[148:151], v[132:135], v[72:75]
    ds_read_b128 v[172:175], v5 offset:4096
    v_mfma_f32_16x16x32_bf16 v[76:79], v[152:155], v[132:135], v[76:79]
    ds_read_b128 v[176:179], v5 offset:6144
    v_mfma_f32_16x16x32_bf16 v[104:107], v[132:135], v[156:159], v[104:107]
    ds_read_b128 v[180:183], v3 offset:0
    v_mfma_f32_16x16x32_bf16 v[108:111], v[132:135], v[160:163], v[108:111]
    ds_read_b64_tr_b16 v[184:185], v6 offset:4096
    v_mfma_f32_16x16x32_bf16 v[40:43], v[140:143], v[132:135], v[40:43]
    ds_read_b64_tr_b16 v[186:187], v6 offset:4608
    v_mfma_f32_16x16x32_bf16 v[44:47], v[144:147], v[132:135], v[44:47]
    ds_read_b64_tr_b16 v[188:189], v7 offset:4096
    v_mfma_f32_16x16x32_bf16 v[64:67], v[148:151], v[128:131], v[64:67]
    ds_read_b64_tr_b16 v[190:191], v7 offset:4608
    v_mfma_f32_16x16x32_bf16 v[68:71], v[152:155], v[128:131], v[68:71]
    ds_read_b64_tr_b16 v[192:193], v6 offset:28672
    v_mfma_f32_16x16x32_bf16 v[32:35], v[140:143], v[128:131], v[32:35]
    ds_read_b64_tr_b16 v[194:195], v6 offset:29184
    v_mfma_f32_16x16x32_bf16 v[36:39], v[144:147], v[128:131], v[36:39]
    ds_read_b64_tr_b16 v[196:197], v7 offset:28672
    v_mfma_f32_16x16x32_bf16 v[56:59], v[148:151], v[124:127], v[56:59]
    ds_read_b64_tr_b16 v[198:199], v7 offset:29184
    v_mfma_f32_16x16x32_bf16 v[60:63], v[152:155], v[124:127], v[60:63]
    ds_read_b64_tr_b16 v[200:201], v8 offset:4096
    v_mfma_f32_16x16x32_bf16 v[24:27], v[140:143], v[124:127], v[24:27]
    ds_read_b64_tr_b16 v[202:203], v8 offset:4608
    v_mfma_f32_16x16x32_bf16 v[28:31], v[144:147], v[124:127], v[28:31]
    ds_read_b64_tr_b16 v[204:205], v9 offset:4096
    v_mfma_f32_16x16x32_bf16 v[48:51], v[148:151], v[120:123], v[48:51]
    ds_read_b64_tr_b16 v[206:207], v9 offset:4608
    v_mfma_f32_16x16x32_bf16 v[52:55], v[152:155], v[120:123], v[52:55]
    v_mfma_f32_16x16x32_bf16 v[16:19], v[140:143], v[120:123], v[16:19]
    v_mfma_f32_16x16x32_bf16 v[20:23], v[144:147], v[120:123], v[20:23]
    v_mfma_f32_16x16x32_bf16 v[96:99], v[128:131], v[156:159], v[96:99]
    v_mfma_f32_16x16x32_bf16 v[100:103], v[128:131], v[160:163], v[100:103]
    v_mfma_f32_16x16x32_bf16 v[88:91], v[124:127], v[156:159], v[88:91]
    v_mfma_f32_16x16x32_bf16 v[92:95], v[124:127], v[160:163], v[92:95]
    v_mfma_f32_16x16x32_bf16 v[80:83], v[120:123], v[156:159], v[80:83]
    v_mfma_f32_16x16x32_bf16 v[84:87], v[120:123], v[160:163], v[84:87]
    s_waitcnt lgkmcnt(0)
    s_barrier
    v_mfma_f32_16x16x32_bf16 v[112:115], v[192:195], v[180:183], v[112:115]
    ds_read_b128 v[120:123], v4 offset:18432
    v_mfma_f32_16x16x32_bf16 v[116:119], v[180:183], v[200:203], v[116:119]
    ds_read_b128 v[124:127], v4 offset:20480
    v_mfma_f32_16x16x32_bf16 v[72:75], v[192:195], v[176:179], v[72:75]
    ds_read_b128 v[128:131], v4 offset:22528
    v_mfma_f32_16x16x32_bf16 v[76:79], v[196:199], v[176:179], v[76:79]
    ds_read_b128 v[132:135], v4 offset:24576
    v_mfma_f32_16x16x32_bf16 v[104:107], v[176:179], v[200:203], v[104:107]
    ds_read_b128 v[136:139], v2 offset:18432
    v_mfma_f32_16x16x32_bf16 v[108:111], v[176:179], v[204:207], v[108:111]
    ds_read_b64_tr_b16 v[140:141], v6 offset:8192
    v_mfma_f32_16x16x32_bf16 v[40:43], v[184:187], v[176:179], v[40:43]
    ds_read_b64_tr_b16 v[142:143], v6 offset:8704
    v_mfma_f32_16x16x32_bf16 v[44:47], v[188:191], v[176:179], v[44:47]
    ds_read_b64_tr_b16 v[144:145], v7 offset:8192
    v_mfma_f32_16x16x32_bf16 v[64:67], v[192:195], v[172:175], v[64:67]
    ds_read_b64_tr_b16 v[146:147], v7 offset:8704
    v_mfma_f32_16x16x32_bf16 v[68:71], v[196:199], v[172:175], v[68:71]
    ds_read_b64_tr_b16 v[148:149], v6 offset:32768
    v_mfma_f32_16x16x32_bf16 v[32:35], v[184:187], v[172:175], v[32:35]
    ds_read_b64_tr_b16 v[150:151], v6 offset:33280
    v_mfma_f32_16x16x32_bf16 v[36:39], v[188:191], v[172:175], v[36:39]
    ds_read_b64_tr_b16 v[152:153], v7 offset:32768
    v_mfma_f32_16x16x32_bf16 v[56:59], v[192:195], v[168:171], v[56:59]
    ds_read_b64_tr_b16 v[154:155], v7 offset:33280
    v_mfma_f32_16x16x32_bf16 v[60:63], v[196:199], v[168:171], v[60:63]
    ds_read_b64_tr_b16 v[156:157], v8 offset:8192
    v_mfma_f32_16x16x32_bf16 v[24:27], v[184:187], v[168:171], v[24:27]
    ds_read_b64_tr_b16 v[158:159], v8 offset:8704
    v_mfma_f32_16x16x32_bf16 v[28:31], v[188:191], v[168:171], v[28:31]
    ds_read_b64_tr_b16 v[160:161], v9 offset:8192
    v_mfma_f32_16x16x32_bf16 v[48:51], v[192:195], v[164:167], v[48:51]
    ds_read_b64_tr_b16 v[162:163], v9 offset:8704
    v_mfma_f32_16x16x32_bf16 v[52:55], v[196:199], v[164:167], v[52:55]
    v_mfma_f32_16x16x32_bf16 v[16:19], v[184:187], v[164:167], v[16:19]
    v_mfma_f32_16x16x32_bf16 v[20:23], v[188:191], v[164:167], v[20:23]
    v_mfma_f32_16x16x32_bf16 v[96:99], v[172:175], v[200:203], v[96:99]
    v_mfma_f32_16x16x32_bf16 v[100:103], v[172:175], v[204:207], v[100:103]
    v_mfma_f32_16x16x32_bf16 v[88:91], v[168:171], v[200:203], v[88:91]
    v_mfma_f32_16x16x32_bf16 v[92:95], v[168:171], v[204:207], v[92:95]
    v_mfma_f32_16x16x32_bf16 v[80:83], v[164:167], v[200:203], v[80:83]
    v_mfma_f32_16x16x32_bf16 v[84:87], v[164:167], v[204:207], v[84:87]
    s_waitcnt lgkmcnt(0)
    v_mfma_f32_16x16x32_bf16 v[112:115], v[148:151], v[136:139], v[112:115]
    ds_read_b128 v[164:167], v5 offset:18432
    v_mfma_f32_16x16x32_bf16 v[116:119], v[136:139], v[156:159], v[116:119]
    ds_read_b128 v[168:171], v5 offset:20480
    v_mfma_f32_16x16x32_bf16 v[72:75], v[148:151], v[132:135], v[72:75]
    ds_read_b128 v[172:175], v5 offset:22528
    v_mfma_f32_16x16x32_bf16 v[76:79], v[152:155], v[132:135], v[76:79]
    ds_read_b128 v[176:179], v5 offset:24576
    v_mfma_f32_16x16x32_bf16 v[104:107], v[132:135], v[156:159], v[104:107]
    ds_read_b128 v[180:183], v3 offset:18432
    v_mfma_f32_16x16x32_bf16 v[108:111], v[132:135], v[160:163], v[108:111]
    ds_read_b64_tr_b16 v[184:185], v6 offset:12288
    v_mfma_f32_16x16x32_bf16 v[40:43], v[140:143], v[132:135], v[40:43]
    ds_read_b64_tr_b16 v[186:187], v6 offset:12800
    v_mfma_f32_16x16x32_bf16 v[44:47], v[144:147], v[132:135], v[44:47]
    ds_read_b64_tr_b16 v[188:189], v7 offset:12288
    v_mfma_f32_16x16x32_bf16 v[64:67], v[148:151], v[128:131], v[64:67]
    ds_read_b64_tr_b16 v[190:191], v7 offset:12800
    v_mfma_f32_16x16x32_bf16 v[68:71], v[152:155], v[128:131], v[68:71]
    ds_read_b64_tr_b16 v[192:193], v6 offset:36864
    v_mfma_f32_16x16x32_bf16 v[32:35], v[140:143], v[128:131], v[32:35]
    ds_read_b64_tr_b16 v[194:195], v6 offset:37376
    v_mfma_f32_16x16x32_bf16 v[36:39], v[144:147], v[128:131], v[36:39]
    ds_read_b64_tr_b16 v[196:197], v7 offset:36864
    v_mfma_f32_16x16x32_bf16 v[56:59], v[148:151], v[124:127], v[56:59]
    ds_read_b64_tr_b16 v[198:199], v7 offset:37376
    v_mfma_f32_16x16x32_bf16 v[60:63], v[152:155], v[124:127], v[60:63]
    ds_read_b64_tr_b16 v[200:201], v8 offset:12288
    v_mfma_f32_16x16x32_bf16 v[24:27], v[140:143], v[124:127], v[24:27]
    ds_read_b64_tr_b16 v[202:203], v8 offset:12800
    v_mfma_f32_16x16x32_bf16 v[28:31], v[144:147], v[124:127], v[28:31]
    ds_read_b64_tr_b16 v[204:205], v9 offset:12288
    v_mfma_f32_16x16x32_bf16 v[48:51], v[148:151], v[120:123], v[48:51]
    ds_read_b64_tr_b16 v[206:207], v9 offset:12800
    v_mfma_f32_16x16x32_bf16 v[52:55], v[152:155], v[120:123], v[52:55]
    v_mfma_f32_16x16x32_bf16 v[16:19], v[140:143], v[120:123], v[16:19]
    v_mfma_f32_16x16x32_bf16 v[20:23], v[144:147], v[120:123], v[20:23]
    v_mfma_f32_16x16x32_bf16 v[96:99], v[128:131], v[156:159], v[96:99]
    v_mfma_f32_16x16x32_bf16 v[100:103], v[128:131], v[160:163], v[100:103]
    v_mfma_f32_16x16x32_bf16 v[88:91], v[124:127], v[156:159], v[88:91]
    v_mfma_f32_16x16x32_bf16 v[92:95], v[124:127], v[160:163], v[92:95]
    v_mfma_f32_16x16x32_bf16 v[80:83], v[120:123], v[156:159], v[80:83]
    v_mfma_f32_16x16x32_bf16 v[84:87], v[120:123], v[160:163], v[84:87]
    s_waitcnt lgkmcnt(0)
    s_barrier
    v_mfma_f32_16x16x32_bf16 v[112:115], v[192:195], v[180:183], v[112:115]
    ds_read_b128 v[120:123], v4 offset:36864
    v_mfma_f32_16x16x32_bf16 v[116:119], v[180:183], v[200:203], v[116:119]
    ds_read_b128 v[124:127], v4 offset:38912
    v_mfma_f32_16x16x32_bf16 v[72:75], v[192:195], v[176:179], v[72:75]
    ds_read_b128 v[128:131], v4 offset:40960
    v_mfma_f32_16x16x32_bf16 v[76:79], v[196:199], v[176:179], v[76:79]
    ds_read_b128 v[132:135], v4 offset:43008
    v_mfma_f32_16x16x32_bf16 v[104:107], v[176:179], v[200:203], v[104:107]
    ds_read_b128 v[136:139], v2 offset:36864
    v_mfma_f32_16x16x32_bf16 v[108:111], v[176:179], v[204:207], v[108:111]
    ds_read_b64_tr_b16 v[140:141], v6 offset:16384
    v_mfma_f32_16x16x32_bf16 v[40:43], v[184:187], v[176:179], v[40:43]
    ds_read_b64_tr_b16 v[142:143], v6 offset:16896
    v_mfma_f32_16x16x32_bf16 v[44:47], v[188:191], v[176:179], v[44:47]
    ds_read_b64_tr_b16 v[144:145], v7 offset:16384
    v_mfma_f32_16x16x32_bf16 v[64:67], v[192:195], v[172:175], v[64:67]
    ds_read_b64_tr_b16 v[146:147], v7 offset:16896
    v_mfma_f32_16x16x32_bf16 v[68:71], v[196:199], v[172:175], v[68:71]
    ds_read_b64_tr_b16 v[148:149], v6 offset:40960
    v_mfma_f32_16x16x32_bf16 v[32:35], v[184:187], v[172:175], v[32:35]
    ds_read_b64_tr_b16 v[150:151], v6 offset:41472
    v_mfma_f32_16x16x32_bf16 v[36:39], v[188:191], v[172:175], v[36:39]
    ds_read_b64_tr_b16 v[152:153], v7 offset:40960
    v_mfma_f32_16x16x32_bf16 v[56:59], v[192:195], v[168:171], v[56:59]
    ds_read_b64_tr_b16 v[154:155], v7 offset:41472
    v_mfma_f32_16x16x32_bf16 v[60:63], v[196:199], v[168:171], v[60:63]
    ds_read_b64_tr_b16 v[156:157], v8 offset:16384
    v_mfma_f32_16x16x32_bf16 v[24:27], v[184:187], v[168:171], v[24:27]
    ds_read_b64_tr_b16 v[158:159], v8 offset:16896
    v_mfma_f32_16x16x32_bf16 v[28:31], v[188:191], v[168:171], v[28:31]
    ds_read_b64_tr_b16 v[160:161], v9 offset:16384
    v_mfma_f32_16x16x32_bf16 v[48:51], v[192:195], v[164:167], v[48:51]
    ds_read_b64_tr_b16 v[162:163], v9 offset:16896
    v_mfma_f32_16x16x32_bf16 v[52:55], v[196:199], v[164:167], v[52:55]
    v_mfma_f32_16x16x32_bf16 v[16:19], v[184:187], v[164:167], v[16:19]
    v_mfma_f32_16x16x32_bf16 v[20:23], v[188:191], v[164:167], v[20:23]
    v_mfma_f32_16x16x32_bf16 v[96:99], v[172:175], v[200:203], v[96:99]
    v_mfma_f32_16x16x32_bf16 v[100:103], v[172:175], v[204:207], v[100:103]
    v_mfma_f32_16x16x32_bf16 v[88:91], v[168:171], v[200:203], v[88:91]
    v_mfma_f32_16x16x32_bf16 v[92:95], v[168:171], v[204:207], v[92:95]
    v_mfma_f32_16x16x32_bf16 v[80:83], v[164:167], v[200:203], v[80:83]
    v_mfma_f32_16x16x32_bf16 v[84:87], v[164:167], v[204:207], v[84:87]
    s_waitcnt lgkmcnt(0)
    v_mfma_f32_16x16x32_bf16 v[112:115], v[148:151], v[136:139], v[112:115]
    ds_read_b128 v[164:167], v5 offset:36864
    v_mfma_f32_16x16x32_bf16 v[116:119], v[136:139], v[156:159], v[116:119]
    ds_read_b128 v[168:171], v5 offset:38912
    v_mfma_f32_16x16x32_bf16 v[72:75], v[148:151], v[132:135], v[72:75]
    ds_read_b128 v[172:175], v5 offset:40960
    v_mfma_f32_16x16x32_bf16 v[76:79], v[152:155], v[132:135], v[76:79]
    ds_read_b128 v[176:179], v5 offset:43008
    v_mfma_f32_16x16x32_bf16 v[104:107], v[132:135], v[156:159], v[104:107]
    ds_read_b128 v[180:183], v3 offset:36864
    v_mfma_f32_16x16x32_bf16 v[108:111], v[132:135], v[160:163], v[108:111]
    ds_read_b64_tr_b16 v[184:185], v6 offset:20480
    v_mfma_f32_16x16x32_bf16 v[40:43], v[140:143], v[132:135], v[40:43]
    ds_read_b64_tr_b16 v[186:187], v6 offset:20992
    v_mfma_f32_16x16x32_bf16 v[44:47], v[144:147], v[132:135], v[44:47]
    ds_read_b64_tr_b16 v[188:189], v7 offset:20480
    v_mfma_f32_16x16x32_bf16 v[64:67], v[148:151], v[128:131], v[64:67]
    ds_read_b64_tr_b16 v[190:191], v7 offset:20992
    v_mfma_f32_16x16x32_bf16 v[68:71], v[152:155], v[128:131], v[68:71]
    ds_read_b64_tr_b16 v[192:193], v6 offset:45056
    v_mfma_f32_16x16x32_bf16 v[32:35], v[140:143], v[128:131], v[32:35]
    ds_read_b64_tr_b16 v[194:195], v6 offset:45568
    v_mfma_f32_16x16x32_bf16 v[36:39], v[144:147], v[128:131], v[36:39]
    ds_read_b64_tr_b16 v[196:197], v7 offset:45056
    v_mfma_f32_16x16x32_bf16 v[56:59], v[148:151], v[124:127], v[56:59]
    ds_read_b64_tr_b16 v[198:199], v7 offset:45568
    v_mfma_f32_16x16x32_bf16 v[60:63], v[152:155], v[124:127], v[60:63]
    ds_read_b64_tr_b16 v[200:201], v8 offset:20480
    v_mfma_f32_16x16x32_bf16 v[24:27], v[140:143], v[124:127], v[24:27]
    ds_read_b64_tr_b16 v[202:203], v8 offset:20992
    v_mfma_f32_16x16x32_bf16 v[28:31], v[144:147], v[124:127], v[28:31]
    ds_read_b64_tr_b16 v[204:205], v9 offset:20480
    v_mfma_f32_16x16x32_bf16 v[48:51], v[148:151], v[120:123], v[48:51]
    ds_read_b64_tr_b16 v[206:207], v9 offset:20992
    v_mfma_f32_16x16x32_bf16 v[52:55], v[152:155], v[120:123], v[52:55]
    v_mfma_f32_16x16x32_bf16 v[16:19], v[140:143], v[120:123], v[16:19]
    v_mfma_f32_16x16x32_bf16 v[20:23], v[144:147], v[120:123], v[20:23]
    v_mfma_f32_16x16x32_bf16 v[96:99], v[128:131], v[156:159], v[96:99]
    v_mfma_f32_16x16x32_bf16 v[100:103], v[128:131], v[160:163], v[100:103]
    v_mfma_f32_16x16x32_bf16 v[88:91], v[124:127], v[156:159], v[88:91]
    v_mfma_f32_16x16x32_bf16 v[92:95], v[124:127], v[160:163], v[92:95]
    v_mfma_f32_16x16x32_bf16 v[80:83], v[120:123], v[156:159], v[80:83]
    v_mfma_f32_16x16x32_bf16 v[84:87], v[120:123], v[160:163], v[84:87]
    s_waitcnt lgkmcnt(0)
    s_barrier
    v_mfma_f32_16x16x32_bf16 v[112:115], v[192:195], v[180:183], v[112:115]
    ds_read_b128 v[120:123], v4 offset:0
    v_mfma_f32_16x16x32_bf16 v[116:119], v[180:183], v[200:203], v[116:119]
    ds_read_b128 v[124:127], v4 offset:2048
    v_mfma_f32_16x16x32_bf16 v[72:75], v[192:195], v[176:179], v[72:75]
    ds_read_b128 v[128:131], v4 offset:4096
    v_mfma_f32_16x16x32_bf16 v[76:79], v[196:199], v[176:179], v[76:79]
    ds_read_b128 v[132:135], v4 offset:6144
    v_mfma_f32_16x16x32_bf16 v[104:107], v[176:179], v[200:203], v[104:107]
    ds_read_b128 v[136:139], v2 offset:0
    v_mfma_f32_16x16x32_bf16 v[108:111], v[176:179], v[204:207], v[108:111]
    ds_read_b64_tr_b16 v[140:141], v6 offset:0
    v_mfma_f32_16x16x32_bf16 v[40:43], v[184:187], v[176:179], v[40:43]
    ds_read_b64_tr_b16 v[142:143], v6 offset:512
    v_mfma_f32_16x16x32_bf16 v[44:47], v[188:191], v[176:179], v[44:47]
    ds_read_b64_tr_b16 v[144:145], v7 offset:0
    v_mfma_f32_16x16x32_bf16 v[64:67], v[192:195], v[172:175], v[64:67]
    ds_read_b64_tr_b16 v[146:147], v7 offset:512
    v_mfma_f32_16x16x32_bf16 v[68:71], v[196:199], v[172:175], v[68:71]
    ds_read_b64_tr_b16 v[148:149], v6 offset:24576
    v_mfma_f32_16x16x32_bf16 v[32:35], v[184:187], v[172:175], v[32:35]
    ds_read_b64_tr_b16 v[150:151], v6 offset:25088
    v_mfma_f32_16x16x32_bf16 v[36:39], v[188:191], v[172:175], v[36:39]
    ds_read_b64_tr_b16 v[152:153], v7 offset:24576
    v_mfma_f32_16x16x32_bf16 v[56:59], v[192:195], v[168:171], v[56:59]
    ds_read_b64_tr_b16 v[154:155], v7 offset:25088
    v_mfma_f32_16x16x32_bf16 v[60:63], v[196:199], v[168:171], v[60:63]
    ds_read_b64_tr_b16 v[156:157], v8 offset:0
    v_mfma_f32_16x16x32_bf16 v[24:27], v[184:187], v[168:171], v[24:27]
    ds_read_b64_tr_b16 v[158:159], v8 offset:512
    v_mfma_f32_16x16x32_bf16 v[28:31], v[188:191], v[168:171], v[28:31]
    ds_read_b64_tr_b16 v[160:161], v9 offset:0
    v_mfma_f32_16x16x32_bf16 v[48:51], v[192:195], v[164:167], v[48:51]
    ds_read_b64_tr_b16 v[162:163], v9 offset:512
    v_mfma_f32_16x16x32_bf16 v[52:55], v[196:199], v[164:167], v[52:55]
    v_mfma_f32_16x16x32_bf16 v[16:19], v[184:187], v[164:167], v[16:19]
    v_mfma_f32_16x16x32_bf16 v[20:23], v[188:191], v[164:167], v[20:23]
    v_mfma_f32_16x16x32_bf16 v[96:99], v[172:175], v[200:203], v[96:99]
    v_mfma_f32_16x16x32_bf16 v[100:103], v[172:175], v[204:207], v[100:103]
    v_mfma_f32_16x16x32_bf16 v[88:91], v[168:171], v[200:203], v[88:91]
    v_mfma_f32_16x16x32_bf16 v[92:95], v[168:171], v[204:207], v[92:95]
    v_mfma_f32_16x16x32_bf16 v[80:83], v[164:167], v[200:203], v[80:83]
    v_mfma_f32_16x16x32_bf16 v[84:87], v[164:167], v[204:207], v[84:87]
    s_waitcnt lgkmcnt(0)
    v_mfma_f32_16x16x32_bf16 v[112:115], v[148:151], v[136:139], v[112:115]
    ds_read_b128 v[164:167], v5 offset:0
    v_mfma_f32_16x16x32_bf16 v[116:119], v[136:139], v[156:159], v[116:119]
    ds_read_b128 v[168:171], v5 offset:2048
    v_mfma_f32_16x16x32_bf16 v[72:75], v[148:151], v[132:135], v[72:75]
    ds_read_b128 v[172:175], v5 offset:4096
    v_mfma_f32_16x16x32_bf16 v[76:79], v[152:155], v[132:135], v[76:79]
    ds_read_b128 v[176:179], v5 offset:6144
    v_mfma_f32_16x16x32_bf16 v[104:107], v[132:135], v[156:159], v[104:107]
    ds_read_b128 v[180:183], v3 offset:0
    v_mfma_f32_16x16x32_bf16 v[108:111], v[132:135], v[160:163], v[108:111]
    ds_read_b64_tr_b16 v[184:185], v6 offset:4096
    v_mfma_f32_16x16x32_bf16 v[40:43], v[140:143], v[132:135], v[40:43]
    ds_read_b64_tr_b16 v[186:187], v6 offset:4608
    v_mfma_f32_16x16x32_bf16 v[44:47], v[144:147], v[132:135], v[44:47]
    ds_read_b64_tr_b16 v[188:189], v7 offset:4096
    v_mfma_f32_16x16x32_bf16 v[64:67], v[148:151], v[128:131], v[64:67]
    ds_read_b64_tr_b16 v[190:191], v7 offset:4608
    v_mfma_f32_16x16x32_bf16 v[68:71], v[152:155], v[128:131], v[68:71]
    ds_read_b64_tr_b16 v[192:193], v6 offset:28672
    v_mfma_f32_16x16x32_bf16 v[32:35], v[140:143], v[128:131], v[32:35]
    ds_read_b64_tr_b16 v[194:195], v6 offset:29184
    v_mfma_f32_16x16x32_bf16 v[36:39], v[144:147], v[128:131], v[36:39]
    ds_read_b64_tr_b16 v[196:197], v7 offset:28672
    v_mfma_f32_16x16x32_bf16 v[56:59], v[148:151], v[124:127], v[56:59]
    ds_read_b64_tr_b16 v[198:199], v7 offset:29184
    v_mfma_f32_16x16x32_bf16 v[60:63], v[152:155], v[124:127], v[60:63]
    ds_read_b64_tr_b16 v[200:201], v8 offset:4096
    v_mfma_f32_16x16x32_bf16 v[24:27], v[140:143], v[124:127], v[24:27]
    ds_read_b64_tr_b16 v[202:203], v8 offset:4608
    v_mfma_f32_16x16x32_bf16 v[28:31], v[144:147], v[124:127], v[28:31]
    ds_read_b64_tr_b16 v[204:205], v9 offset:4096
    v_mfma_f32_16x16x32_bf16 v[48:51], v[148:151], v[120:123], v[48:51]
    ds_read_b64_tr_b16 v[206:207], v9 offset:4608
    v_mfma_f32_16x16x32_bf16 v[52:55], v[152:155], v[120:123], v[52:55]
    buffer_load_dword v222, v220, s[68:71], s98 offen sc1
    v_mfma_f32_16x16x32_bf16 v[16:19], v[140:143], v[120:123], v[16:19]
    v_mfma_f32_16x16x32_bf16 v[20:23], v[144:147], v[120:123], v[20:23]
    v_mfma_f32_16x16x32_bf16 v[96:99], v[128:131], v[156:159], v[96:99]
    v_mfma_f32_16x16x32_bf16 v[100:103], v[128:131], v[160:163], v[100:103]
    v_mfma_f32_16x16x32_bf16 v[88:91], v[124:127], v[156:159], v[88:91]
    v_mfma_f32_16x16x32_bf16 v[92:95], v[124:127], v[160:163], v[92:95]
    v_mfma_f32_16x16x32_bf16 v[80:83], v[120:123], v[156:159], v[80:83]
    v_mfma_f32_16x16x32_bf16 v[84:87], v[120:123], v[160:163], v[84:87]
    s_waitcnt lgkmcnt(0)
    s_barrier
    v_mfma_f32_16x16x32_bf16 v[112:115], v[192:195], v[180:183], v[112:115]
    ds_read_b128 v[120:123], v4 offset:18432
    v_mfma_f32_16x16x32_bf16 v[116:119], v[180:183], v[200:203], v[116:119]
    ds_read_b128 v[124:127], v4 offset:20480
    v_mfma_f32_16x16x32_bf16 v[72:75], v[192:195], v[176:179], v[72:75]
    ds_read_b128 v[128:131], v4 offset:22528
    v_mfma_f32_16x16x32_bf16 v[76:79], v[196:199], v[176:179], v[76:79]
    ds_read_b128 v[132:135], v4 offset:24576
    v_mfma_f32_16x16x32_bf16 v[104:107], v[176:179], v[200:203], v[104:107]
    ds_read_b128 v[136:139], v2 offset:18432
    v_mfma_f32_16x16x32_bf16 v[108:111], v[176:179], v[204:207], v[108:111]
    ds_read_b64_tr_b16 v[140:141], v6 offset:8192
    v_mfma_f32_16x16x32_bf16 v[40:43], v[184:187], v[176:179], v[40:43]
    ds_read_b64_tr_b16 v[142:143], v6 offset:8704
    v_mfma_f32_16x16x32_bf16 v[44:47], v[188:191], v[176:179], v[44:47]
    ds_read_b64_tr_b16 v[144:145], v7 offset:8192
    v_mfma_f32_16x16x32_bf16 v[64:67], v[192:195], v[172:175], v[64:67]
    ds_read_b64_tr_b16 v[146:147], v7 offset:8704
    v_mfma_f32_16x16x32_bf16 v[68:71], v[196:199], v[172:175], v[68:71]
    ds_read_b64_tr_b16 v[148:149], v6 offset:32768
    v_mfma_f32_16x16x32_bf16 v[32:35], v[184:187], v[172:175], v[32:35]
    ds_read_b64_tr_b16 v[150:151], v6 offset:33280
    v_mfma_f32_16x16x32_bf16 v[36:39], v[188:191], v[172:175], v[36:39]
    ds_read_b64_tr_b16 v[152:153], v7 offset:32768
    v_mfma_f32_16x16x32_bf16 v[56:59], v[192:195], v[168:171], v[56:59]
    ds_read_b64_tr_b16 v[154:155], v7 offset:33280
    v_mfma_f32_16x16x32_bf16 v[60:63], v[196:199], v[168:171], v[60:63]
    ds_read_b64_tr_b16 v[156:157], v8 offset:8192
    v_mfma_f32_16x16x32_bf16 v[24:27], v[184:187], v[168:171], v[24:27]
    ds_read_b64_tr_b16 v[158:159], v8 offset:8704
    v_mfma_f32_16x16x32_bf16 v[28:31], v[188:191], v[168:171], v[28:31]
    ds_read_b64_tr_b16 v[160:161], v9 offset:8192
    v_mfma_f32_16x16x32_bf16 v[48:51], v[192:195], v[164:167], v[48:51]
    ds_read_b64_tr_b16 v[162:163], v9 offset:8704
    v_mfma_f32_16x16x32_bf16 v[52:55], v[196:199], v[164:167], v[52:55]
    v_mfma_f32_16x16x32_bf16 v[16:19], v[184:187], v[164:167], v[16:19]
    v_mfma_f32_16x16x32_bf16 v[20:23], v[188:191], v[164:167], v[20:23]
    v_mfma_f32_16x16x32_bf16 v[96:99], v[172:175], v[200:203], v[96:99]
    v_mfma_f32_16x16x32_bf16 v[100:103], v[172:175], v[204:207], v[100:103]
    v_mfma_f32_16x16x32_bf16 v[88:91], v[168:171], v[200:203], v[88:91]
    v_mfma_f32_16x16x32_bf16 v[92:95], v[168:171], v[204:207], v[92:95]
    v_mfma_f32_16x16x32_bf16 v[80:83], v[164:167], v[200:203], v[80:83]
    v_mfma_f32_16x16x32_bf16 v[84:87], v[164:167], v[204:207], v[84:87]
    s_waitcnt lgkmcnt(0)
    v_mfma_f32_16x16x32_bf16 v[112:115], v[148:151], v[136:139], v[112:115]
    ds_read_b128 v[164:167], v5 offset:18432
    v_mfma_f32_16x16x32_bf16 v[116:119], v[136:139], v[156:159], v[116:119]
    ds_read_b128 v[168:171], v5 offset:20480
    v_mfma_f32_16x16x32_bf16 v[72:75], v[148:151], v[132:135], v[72:75]
    ds_read_b128 v[172:175], v5 offset:22528
    v_mfma_f32_16x16x32_bf16 v[76:79], v[152:155], v[132:135], v[76:79]
    ds_read_b128 v[176:179], v5 offset:24576
    v_mfma_f32_16x16x32_bf16 v[104:107], v[132:135], v[156:159], v[104:107]
    ds_read_b128 v[180:183], v3 offset:18432
    v_mfma_f32_16x16x32_bf16 v[108:111], v[132:135], v[160:163], v[108:111]
    ds_read_b64_tr_b16 v[184:185], v6 offset:12288
    v_mfma_f32_16x16x32_bf16 v[40:43], v[140:143], v[132:135], v[40:43]
    ds_read_b64_tr_b16 v[186:187], v6 offset:12800
    v_mfma_f32_16x16x32_bf16 v[44:47], v[144:147], v[132:135], v[44:47]
    ds_read_b64_tr_b16 v[188:189], v7 offset:12288
    v_mfma_f32_16x16x32_bf16 v[64:67], v[148:151], v[128:131], v[64:67]
    ds_read_b64_tr_b16 v[190:191], v7 offset:12800
    v_mfma_f32_16x16x32_bf16 v[68:71], v[152:155], v[128:131], v[68:71]
    ds_read_b64_tr_b16 v[192:193], v6 offset:36864
    v_mfma_f32_16x16x32_bf16 v[32:35], v[140:143], v[128:131], v[32:35]
    ds_read_b64_tr_b16 v[194:195], v6 offset:37376
    v_mfma_f32_16x16x32_bf16 v[36:39], v[144:147], v[128:131], v[36:39]
    ds_read_b64_tr_b16 v[196:197], v7 offset:36864
    v_mfma_f32_16x16x32_bf16 v[56:59], v[148:151], v[124:127], v[56:59]
    ds_read_b64_tr_b16 v[198:199], v7 offset:37376
    v_mfma_f32_16x16x32_bf16 v[60:63], v[152:155], v[124:127], v[60:63]
    ds_read_b64_tr_b16 v[200:201], v8 offset:12288
    v_mfma_f32_16x16x32_bf16 v[24:27], v[140:143], v[124:127], v[24:27]
    ds_read_b64_tr_b16 v[202:203], v8 offset:12800
    v_mfma_f32_16x16x32_bf16 v[28:31], v[144:147], v[124:127], v[28:31]
    ds_read_b64_tr_b16 v[204:205], v9 offset:12288
    v_mfma_f32_16x16x32_bf16 v[48:51], v[148:151], v[120:123], v[48:51]
    ds_read_b64_tr_b16 v[206:207], v9 offset:12800
    v_mfma_f32_16x16x32_bf16 v[52:55], v[152:155], v[120:123], v[52:55]
    v_mfma_f32_16x16x32_bf16 v[16:19], v[140:143], v[120:123], v[16:19]
    v_mfma_f32_16x16x32_bf16 v[20:23], v[144:147], v[120:123], v[20:23]
    v_mfma_f32_16x16x32_bf16 v[96:99], v[128:131], v[156:159], v[96:99]
    v_mfma_f32_16x16x32_bf16 v[100:103], v[128:131], v[160:163], v[100:103]
    v_mfma_f32_16x16x32_bf16 v[88:91], v[124:127], v[156:159], v[88:91]
    v_mfma_f32_16x16x32_bf16 v[92:95], v[124:127], v[160:163], v[92:95]
    v_mfma_f32_16x16x32_bf16 v[80:83], v[120:123], v[156:159], v[80:83]
    v_mfma_f32_16x16x32_bf16 v[84:87], v[120:123], v[160:163], v[84:87]
    s_waitcnt lgkmcnt(0)
    s_barrier
    v_mfma_f32_16x16x32_bf16 v[112:115], v[192:195], v[180:183], v[112:115]
    ds_read_b128 v[120:123], v4 offset:36864
    v_mfma_f32_16x16x32_bf16 v[116:119], v[180:183], v[200:203], v[116:119]
    ds_read_b128 v[124:127], v4 offset:38912
    v_mfma_f32_16x16x32_bf16 v[72:75], v[192:195], v[176:179], v[72:75]
    ds_read_b128 v[128:131], v4 offset:40960
    v_mfma_f32_16x16x32_bf16 v[76:79], v[196:199], v[176:179], v[76:79]
    ds_read_b128 v[132:135], v4 offset:43008
    v_mfma_f32_16x16x32_bf16 v[104:107], v[176:179], v[200:203], v[104:107]
    ds_read_b128 v[136:139], v2 offset:36864
    v_mfma_f32_16x16x32_bf16 v[108:111], v[176:179], v[204:207], v[108:111]
    ds_read_b64_tr_b16 v[140:141], v6 offset:16384
    v_mfma_f32_16x16x32_bf16 v[40:43], v[184:187], v[176:179], v[40:43]
    ds_read_b64_tr_b16 v[142:143], v6 offset:16896
    v_mfma_f32_16x16x32_bf16 v[44:47], v[188:191], v[176:179], v[44:47]
    ds_read_b64_tr_b16 v[144:145], v7 offset:16384
    v_mfma_f32_16x16x32_bf16 v[64:67], v[192:195], v[172:175], v[64:67]
    ds_read_b64_tr_b16 v[146:147], v7 offset:16896
    v_mfma_f32_16x16x32_bf16 v[68:71], v[196:199], v[172:175], v[68:71]
    ds_read_b64_tr_b16 v[148:149], v6 offset:40960
    v_mfma_f32_16x16x32_bf16 v[32:35], v[184:187], v[172:175], v[32:35]
    ds_read_b64_tr_b16 v[150:151], v6 offset:41472
    v_mfma_f32_16x16x32_bf16 v[36:39], v[188:191], v[172:175], v[36:39]
    ds_read_b64_tr_b16 v[152:153], v7 offset:40960
    v_mfma_f32_16x16x32_bf16 v[56:59], v[192:195], v[168:171], v[56:59]
    ds_read_b64_tr_b16 v[154:155], v7 offset:41472
    v_mfma_f32_16x16x32_bf16 v[60:63], v[196:199], v[168:171], v[60:63]
    ds_read_b64_tr_b16 v[156:157], v8 offset:16384
    v_mfma_f32_16x16x32_bf16 v[24:27], v[184:187], v[168:171], v[24:27]
    ds_read_b64_tr_b16 v[158:159], v8 offset:16896
    v_mfma_f32_16x16x32_bf16 v[28:31], v[188:191], v[168:171], v[28:31]
    ds_read_b64_tr_b16 v[160:161], v9 offset:16384
    v_mfma_f32_16x16x32_bf16 v[48:51], v[192:195], v[164:167], v[48:51]
    ds_read_b64_tr_b16 v[162:163], v9 offset:16896
    v_mfma_f32_16x16x32_bf16 v[52:55], v[196:199], v[164:167], v[52:55]
    v_mfma_f32_16x16x32_bf16 v[16:19], v[184:187], v[164:167], v[16:19]
    v_mfma_f32_16x16x32_bf16 v[20:23], v[188:191], v[164:167], v[20:23]
    v_mfma_f32_16x16x32_bf16 v[96:99], v[172:175], v[200:203], v[96:99]
    v_mfma_f32_16x16x32_bf16 v[100:103], v[172:175], v[204:207], v[100:103]
    v_mfma_f32_16x16x32_bf16 v[88:91], v[168:171], v[200:203], v[88:91]
    v_mfma_f32_16x16x32_bf16 v[92:95], v[168:171], v[204:207], v[92:95]
    v_mfma_f32_16x16x32_bf16 v[80:83], v[164:167], v[200:203], v[80:83]
    v_mfma_f32_16x16x32_bf16 v[84:87], v[164:167], v[204:207], v[84:87]
    s_waitcnt lgkmcnt(0)
    v_mfma_f32_16x16x32_bf16 v[112:115], v[148:151], v[136:139], v[112:115]
    ds_read_b128 v[164:167], v5 offset:36864
    v_mfma_f32_16x16x32_bf16 v[116:119], v[136:139], v[156:159], v[116:119]
    ds_read_b128 v[168:171], v5 offset:38912
    v_mfma_f32_16x16x32_bf16 v[72:75], v[148:151], v[132:135], v[72:75]
    ds_read_b128 v[172:175], v5 offset:40960
    v_mfma_f32_16x16x32_bf16 v[76:79], v[152:155], v[132:135], v[76:79]
    ds_read_b128 v[176:179], v5 offset:43008
    v_mfma_f32_16x16x32_bf16 v[104:107], v[132:135], v[156:159], v[104:107]
    ds_read_b128 v[180:183], v3 offset:36864
    v_mfma_f32_16x16x32_bf16 v[108:111], v[132:135], v[160:163], v[108:111]
    ds_read_b64_tr_b16 v[184:185], v6 offset:20480
    v_mfma_f32_16x16x32_bf16 v[40:43], v[140:143], v[132:135], v[40:43]
    ds_read_b64_tr_b16 v[186:187], v6 offset:20992
    v_mfma_f32_16x16x32_bf16 v[44:47], v[144:147], v[132:135], v[44:47]
    ds_read_b64_tr_b16 v[188:189], v7 offset:20480
    v_mfma_f32_16x16x32_bf16 v[64:67], v[148:151], v[128:131], v[64:67]
    ds_read_b64_tr_b16 v[190:191], v7 offset:20992
    v_mfma_f32_16x16x32_bf16 v[68:71], v[152:155], v[128:131], v[68:71]
    ds_read_b64_tr_b16 v[192:193], v6 offset:45056
    v_mfma_f32_16x16x32_bf16 v[32:35], v[140:143], v[128:131], v[32:35]
    ds_read_b64_tr_b16 v[194:195], v6 offset:45568
    v_mfma_f32_16x16x32_bf16 v[36:39], v[144:147], v[128:131], v[36:39]
    ds_read_b64_tr_b16 v[196:197], v7 offset:45056
    v_mfma_f32_16x16x32_bf16 v[56:59], v[148:151], v[124:127], v[56:59]
    ds_read_b64_tr_b16 v[198:199], v7 offset:45568
    v_mfma_f32_16x16x32_bf16 v[60:63], v[152:155], v[124:127], v[60:63]
    ds_read_b64_tr_b16 v[200:201], v8 offset:20480
    v_mfma_f32_16x16x32_bf16 v[24:27], v[140:143], v[124:127], v[24:27]
    ds_read_b64_tr_b16 v[202:203], v8 offset:20992
    v_mfma_f32_16x16x32_bf16 v[28:31], v[144:147], v[124:127], v[28:31]
    ds_read_b64_tr_b16 v[204:205], v9 offset:20480
    v_mfma_f32_16x16x32_bf16 v[48:51], v[148:151], v[120:123], v[48:51]
    ds_read_b64_tr_b16 v[206:207], v9 offset:20992
    v_mfma_f32_16x16x32_bf16 v[52:55], v[152:155], v[120:123], v[52:55]
    v_mfma_f32_16x16x32_bf16 v[16:19], v[140:143], v[120:123], v[16:19]
    v_mfma_f32_16x16x32_bf16 v[20:23], v[144:147], v[120:123], v[20:23]
    v_mfma_f32_16x16x32_bf16 v[96:99], v[128:131], v[156:159], v[96:99]
    v_mfma_f32_16x16x32_bf16 v[100:103], v[128:131], v[160:163], v[100:103]
    v_mfma_f32_16x16x32_bf16 v[88:91], v[124:127], v[156:159], v[88:91]
    v_mfma_f32_16x16x32_bf16 v[92:95], v[124:127], v[160:163], v[92:95]
    v_mfma_f32_16x16x32_bf16 v[80:83], v[120:123], v[156:159], v[80:83]
    v_mfma_f32_16x16x32_bf16 v[84:87], v[120:123], v[160:163], v[84:87]
    s_waitcnt lgkmcnt(0)
    s_barrier
    s_cmp_lg_u32 s3, 0
    s_cbranch_scc1 LB_sk
    s_waitcnt vmcnt(0)
    v_cmp_eq_u32 vcc, 0, v222
    s_cbranch_vccnz LB_slow
LB_back:
    s_mov_b64 exec, 1
    buffer_store_dword v222, v220, s[52:55], s96 offen sc1
    s_mov_b64 exec, -1
LB_sk:
    v_mfma_f32_16x16x32_bf16 v[112:115], v[192:195], v[180:183], v[112:115]
    ds_read_b128 v[120:123], v4 offset:0
    v_mfma_f32_16x16x32_bf16 v[116:119], v[180:183], v[200:203], v[116:119]
    ds_read_b128 v[124:127], v4 offset:2048
    v_mfma_f32_16x16x32_bf16 v[72:75], v[192:195], v[176:179], v[72:75]
    ds_read_b128 v[128:131], v4 offset:4096
    v_mfma_f32_16x16x32_bf16 v[76:79], v[196:199], v[176:179], v[76:79]
    ds_read_b128 v[132:135], v4 offset:6144
    v_mfma_f32_16x16x32_bf16 v[104:107], v[176:179], v[200:203], v[104:107]
    ds_read_b128 v[136:139], v2 offset:0
    v_mfma_f32_16x16x32_bf16 v[108:111], v[176:179], v[204:207], v[108:111]
    ds_read_b64_tr_b16 v[140:141], v6 offset:0
    v_mfma_f32_16x16x32_bf16 v[40:43], v[184:187], v[176:179], v[40:43]
    ds_read_b64_tr_b16 v[142:143], v6 offset:512
    v_mfma_f32_16x16x32_bf16 v[44:47], v[188:191], v[176:179], v[44:47]
    ds_read_b64_tr_b16 v[144:145], v7 offset:0
    v_mfma_f32_16x16x32_bf16 v[64:67], v[192:195], v[172:175], v[64:67]
    ds_read_b64_tr_b16 v[146:147], v7 offset:512
    v_mfma_f32_16x16x32_bf16 v[68:71], v[196:199], v[172:175], v[68:71]
    ds_read_b64_tr_b16 v[148:149], v6 offset:24576
    v_mfma_f32_16x16x32_bf16 v[32:35], v[184:187], v[172:175], v[32:35]
    ds_read_b64_tr_b16 v[150:151], v6 offset:25088
    v_mfma_f32_16x16x32_bf16 v[36:39], v[188:191], v[172:175], v[36:39]
    ds_read_b64_tr_b16 v[152:153], v7 offset:24576
    v_mfma_f32_16x16x32_bf16 v[56:59], v[192:195], v[168:171], v[56:59]
    ds_read_b64_tr_b16 v[154:155], v7 offset:25088
    v_mfma_f32_16x16x32_bf16 v[60:63], v[196:199], v[168:171], v[60:63]
    ds_read_b64_tr_b16 v[156:157], v8 offset:0
    v_mfma_f32_16x16x32_bf16 v[24:27], v[184:187], v[168:171], v[24:27]
    ds_read_b64_tr_b16 v[158:159], v8 offset:512
    v_mfma_f32_16x16x32_bf16 v[28:31], v[188:191], v[168:171], v[28:31]
    ds_read_b64_tr_b16 v[160:161], v9 offset:0
    v_mfma_f32_16x16x32_bf16 v[48:51], v[192:195], v[164:167], v[48:51]
    ds_read_b64_tr_b16 v[162:163], v9 offset:512
    v_mfma_f32_16x16x32_bf16 v[52:55], v[196:199], v[164:167], v[52:55]
    v_mfma_f32_16x16x32_bf16 v[16:19], v[184:187], v[164:167], v[16:19]
    v_mfma_f32_16x16x32_bf16 v[20:23], v[188:191], v[164:167], v[20:23]
    v_mfma_f32_16x16x32_bf16 v[96:99], v[172:175], v[200:203], v[96:99]
    v_mfma_f32_16x16x32_bf16 v[100:103], v[172:175], v[204:207], v[100:103]
    v_mfma_f32_16x16x32_bf16 v[88:91], v[168:171], v[200:203], v[88:91]
    v_mfma_f32_16x16x32_bf16 v[92:95], v[168:171], v[204:207], v[92:95]
    v_mfma_f32_16x16x32_bf16 v[80:83], v[164:167], v[200:203], v[80:83]
    v_mfma_f32_16x16x32_bf16 v[84:87], v[164:167], v[204:207], v[84:87]
    s_waitcnt lgkmcnt(0)
    v_mfma_f32_16x16x32_bf16 v[112:115], v[148:151], v[136:139], v[112:115]
    ds_read_b128 v[164:167], v5 offset:0
    v_mfma_f32_16x16x32_bf16 v[116:119], v[136:139], v[156:159], v[116:119]
    ds_read_b128 v[168:171], v5 offset:2048
    v_mfma_f32_16x16x32_bf16 v[72:75], v[148:151], v[132:135], v[72:75]
    ds_read_b128 v[172:175], v5 offset:4096
    v_mfma_f32_16x16x32_bf16 v[76:79], v[152:155], v[132:135], v[76:79]
    ds_read_b128 v[176:179], v5 offset:6144
    v_mfma_f32_16x16x32_bf16 v[104:107], v[132:135], v[156:159], v[104:107]
    ds_read_b128 v[180:183], v3 offset:0
    v_mfma_f32_16x16x32_bf16 v[108:111], v[132:135], v[160:163], v[108:111]
    ds_read_b64_tr_b16 v[184:185], v6 offset:4096
    v_mfma_f32_16x16x32_bf16 v[40:43], v[140:143], v[132:135], v[40:43]
    ds_read_b64_tr_b16 v[186:187], v6 offset:4608
    v_mfma_f32_16x16x32_bf16 v[44:47], v[144:147], v[132:135], v[44:47]
    ds_read_b64_tr_b16 v[188:189], v7 offset:4096
    v_mfma_f32_16x16x32_bf16 v[64:67], v[148:151], v[128:131], v[64:67]
    ds_read_b64_tr_b16 v[190:191], v7 offset:4608
    v_mfma_f32_16x16x32_bf16 v[68:71], v[152:155], v[128:131], v[68:71]
    ds_read_b64_tr_b16 v[192:193], v6 offset:28672
    v_mfma_f32_16x16x32_bf16 v[32:35], v[140:143], v[128:131], v[32:35]
    ds_read_b64_tr_b16 v[194:195], v6 offset:29184
    v_mfma_f32_16x16x32_bf16 v[36:39], v[144:147], v[128:131], v[36:39]
    ds_read_b64_tr_b16 v[196:197], v7 offset:28672
    v_mfma_f32_16x16x32_bf16 v[56:59], v[148:151], v[124:127], v[56:59]
    ds_read_b64_tr_b16 v[198:199], v7 offset:29184
    v_mfma_f32_16x16x32_bf16 v[60:63], v[152:155], v[124:127], v[60:63]
    ds_read_b64_tr_b16 v[200:201], v8 offset:4096
    v_mfma_f32_16x16x32_bf16 v[24:27], v[140:143], v[124:127], v[24:27]
    ds_read_b64_tr_b16 v[202:203], v8 offset:4608
    v_mfma_f32_16x16x32_bf16 v[28:31], v[144:147], v[124:127], v[28:31]
    ds_read_b64_tr_b16 v[204:205], v9 offset:4096
    v_mfma_f32_16x16x32_bf16 v[48:51], v[148:151], v[120:123], v[48:51]
    ds_read_b64_tr_b16 v[206:207], v9 offset:4608
    v_mfma_f32_16x16x32_bf16 v[52:55], v[152:155], v[120:123], v[52:55]
    v_mfma_f32_16x16x32_bf16 v[16:19], v[140:143], v[120:123], v[16:19]
    v_mfma_f32_16x16x32_bf16 v[20:23], v[144:147], v[120:123], v[20:23]
    v_mfma_f32_16x16x32_bf16 v[96:99], v[128:131], v[156:159], v[96:99]
    v_mfma_f32_16x16x32_bf16 v[100:103], v[128:131], v[160:163], v[100:103]
    v_mfma_f32_16x16x32_bf16 v[88:91], v[124:127], v[156:159], v[88:91]
    v_mfma_f32_16x16x32_bf16 v[92:95], v[124:127], v[160:163], v[92:95]
    v_mfma_f32_16x16x32_bf16 v[80:83], v[120:123], v[156:159], v[80:83]
    v_mfma_f32_16x16x32_bf16 v[84:87], v[120:123], v[160:163], v[84:87]
    s_waitcnt lgkmcnt(0)
    s_barrier
    v_mfma_f32_16x16x32_bf16 v[112:115], v[192:195], v[180:183], v[112:115]
    ds_read_b128 v[120:123], v4 offset:18432
    v_mfma_f32_16x16x32_bf16 v[116:119], v[180:183], v[200:203], v[116:119]
    ds_read_b128 v[124:127], v4 offset:20480
    v_mfma_f32_16x16x32_bf16 v[72:75], v[192:195], v[176:179], v[72:75]
    ds_read_b128 v[128:131], v4 offset:22528
    v_mfma_f32_16x16x32_bf16 v[76:79], v[196:199], v[176:179], v[76:79]
    ds_read_b128 v[132:135], v4 offset:24576
    v_mfma_f32_16x16x32_bf16 v[104:107], v[176:179], v[200:203], v[104:107]
    ds_read_b128 v[136:139], v2 offset:18432
    v_mfma_f32_16x16x32_bf16 v[108:111], v[176:179], v[204:207], v[108:111]
    ds_read_b64_tr_b16 v[140:141], v6 offset:8192
    v_mfma_f32_16x16x32_bf16 v[40:43], v[184:187], v[176:179], v[40:43]
    ds_read_b64_tr_b16 v[142:143], v6 offset:8704
    v_mfma_f32_16x16x32_bf16 v[44:47], v[188:191], v[176:179], v[44:47]
    ds_read_b64_tr_b16 v[144:145], v7 offset:8192
    v_mfma_f32_16x16x32_bf16 v[64:67], v[192:195], v[172:175], v[64:67]
    ds_read_b64_tr_b16 v[146:147], v7 offset:8704
    v_mfma_f32_16x16x32_bf16 v[68:71], v[196:199], v[172:175], v[68:71]
    ds_read_b64_tr_b16 v[148:149], v6 offset:32768
    v_mfma_f32_16x16x32_bf16 v[32:35], v[184:187], v[172:175], v[32:35]
    ds_read_b64_tr_b16 v[150:151], v6 offset:33280
    v_mfma_f32_16x16x32_bf16 v[36:39], v[188:191], v[172:175], v[36:39]
    ds_read_b64_tr_b16 v[152:153], v7 offset:32768
    v_mfma_f32_16x16x32_bf16 v[56:59], v[192:195], v[168:171], v[56:59]
    ds_read_b64_tr_b16 v[154:155], v7 offset:33280
    v_mfma_f32_16x16x32_bf16 v[60:63], v[196:199], v[168:171], v[60:63]
    ds_read_b64_tr_b16 v[156:157], v8 offset:8192
    v_mfma_f32_16x16x32_bf16 v[24:27], v[184:187], v[168:171], v[24:27]
    ds_read_b64_tr_b16 v[158:159], v8 offset:8704
    v_mfma_f32_16x16x32_bf16 v[28:31], v[188:191], v[168:171], v[28:31]
    ds_read_b64_tr_b16 v[160:161], v9 offset:8192
    v_mfma_f32_16x16x32_bf16 v[48:51], v[192:195], v[164:167], v[48:51]
    ds_read_b64_tr_b16 v[162:163], v9 offset:8704
    v_mfma_f32_16x16x32_bf16 v[52:55], v[196:199], v[164:167], v[52:55]
    v_mfma_f32_16x16x32_bf16 v[16:19], v[184:187], v[164:167], v[16:19]
    v_mfma_f32_16x16x32_bf16 v[20:23], v[188:191], v[164:167], v[20:23]
    v_mfma_f32_16x16x32_bf16 v[96:99], v[172:175], v[200:203], v[96:99]
    v_mfma_f32_16x16x32_bf16 v[100:103], v[172:175], v[204:207], v[100:103]
    v_mfma_f32_16x16x32_bf16 v[88:91], v[168:171], v[200:203], v[88:91]
    v_mfma_f32_16x16x32_bf16 v[92:95], v[168:171], v[204:207], v[92:95]
    v_mfma_f32_16x16x32_bf16 v[80:83], v[164:167], v[200:203], v[80:83]
    v_mfma_f32_16x16x32_bf16 v[84:87], v[164:167], v[204:207], v[84:87]
    s_waitcnt lgkmcnt(0)
    v_mfma_f32_16x16x32_bf16 v[112:115], v[148:151], v[136:139], v[112:115]
    ds_read_b128 v[164:167], v5 offset:18432
    v_mfma_f32_16x16x32_bf16 v[116:119], v[136:139], v[156:159], v[116:119]
    ds_read_b128 v[168:171], v5 offset:20480
    v_mfma_f32_16x16x32_bf16 v[72:75], v[148:151], v[132:135], v[72:75]
    ds_read_b128 v[172:175], v5 offset:22528
    v_mfma_f32_16x16x32_bf16 v[76:79], v[152:155], v[132:135], v[76:79]
    ds_read_b128 v[176:179], v5 offset:24576
    v_mfma_f32_16x16x32_bf16 v[104:107], v[132:135], v[156:159], v[104:107]
    ds_read_b128 v[180:183], v3 offset:18432
    v_mfma_f32_16x16x32_bf16 v[108:111], v[132:135], v[160:163], v[108:111]
    ds_read_b64_tr_b16 v[184:185], v6 offset:12288
    v_mfma_f32_16x16x32_bf16 v[40:43], v[140:143], v[132:135], v[40:43]
    ds_read_b64_tr_b16 v[186:187], v6 offset:12800
    v_mfma_f32_16x16x32_bf16 v[44:47], v[144:147], v[132:135], v[44:47]
    ds_read_b64_tr_b16 v[188:189], v7 offset:12288
    v_mfma_f32_16x16x32_bf16 v[64:67], v[148:151], v[128:131], v[64:67]
    ds_read_b64_tr_b16 v[190:191], v7 offset:12800
    v_mfma_f32_16x16x32_bf16 v[68:71], v[152:155], v[128:131], v[68:71]
    ds_read_b64_tr_b16 v[192:193], v6 offset:36864
    v_mfma_f32_16x16x32_bf16 v[32:35], v[140:143], v[128:131], v[32:35]
    ds_read_b64_tr_b16 v[194:195], v6 offset:37376
    v_mfma_f32_16x16x32_bf16 v[36:39], v[144:147], v[128:131], v[36:39]
    ds_read_b64_tr_b16 v[196:197], v7 offset:36864
    v_mfma_f32_16x16x32_bf16 v[56:59], v[148:151], v[124:127], v[56:59]
    ds_read_b64_tr_b16 v[198:199], v7 offset:37376
    v_mfma_f32_16x16x32_bf16 v[60:63], v[152:155], v[124:127], v[60:63]
    ds_read_b64_tr_b16 v[200:201], v8 offset:12288
    v_mfma_f32_16x16x32_bf16 v[24:27], v[140:143], v[124:127], v[24:27]
    ds_read_b64_tr_b16 v[202:203], v8 offset:12800
    v_mfma_f32_16x16x32_bf16 v[28:31], v[144:147], v[124:127], v[28:31]
    ds_read_b64_tr_b16 v[204:205], v9 offset:12288
    v_mfma_f32_16x16x32_bf16 v[48:51], v[148:151], v[120:123], v[48:51]
    ds_read_b64_tr_b16 v[206:207], v9 offset:12800
    v_mfma_f32_16x16x32_bf16 v[52:55], v[152:155], v[120:123], v[52:55]
    v_mfma_f32_16x16x32_bf16 v[16:19], v[140:143], v[120:123], v[16:19]
    v_mfma_f32_16x16x32_bf16 v[20:23], v[144:147], v[120:123], v[20:23]
    v_mfma_f32_16x16x32_bf16 v[96:99], v[128:131], v[156:159], v[96:99]
    v_mfma_f32_16x16x32_bf16 v[100:103], v[128:131], v[160:163], v[100:103]
    v_mfma_f32_16x16x32_bf16 v[88:91], v[124:127], v[156:159], v[88:91]
    v_mfma_f32_16x16x32_bf16 v[92:95], v[124:127], v[160:163], v[92:95]
    v_mfma_f32_16x16x32_bf16 v[80:83], v[120:123], v[156:159], v[80:83]
    v_mfma_f32_16x16x32_bf16 v[84:87], v[120:123], v[160:163], v[84:87]
    s_waitcnt lgkmcnt(0)
    s_barrier
    v_mfma_f32_16x16x32_bf16 v[112:115], v[192:195], v[180:183], v[112:115]
    ds_read_b128 v[120:123], v4 offset:36864
    v_mfma_f32_16x16x32_bf16 v[116:119], v[180:183], v[200:203], v[116:119]
    ds_read_b128 v[124:127], v4 offset:38912
    v_mfma_f32_16x16x32_bf16 v[72:75], v[192:195], v[176:179], v[72:75]
    ds_read_b128 v[128:131], v4 offset:40960
    v_mfma_f32_16x16x32_bf16 v[76:79], v[196:199], v[176:179], v[76:79]
    ds_read_b128 v[132:135], v4 offset:43008
    v_mfma_f32_16x16x32_bf16 v[104:107], v[176:179], v[200:203], v[104:107]
    ds_read_b128 v[136:139], v2 offset:36864
    v_mfma_f32_16x16x32_bf16 v[108:111], v[176:179], v[204:207], v[108:111]
    ds_read_b64_tr_b16 v[140:141], v6 offset:16384
    v_mfma_f32_16x16x32_bf16 v[40:43], v[184:187], v[176:179], v[40:43]
    ds_read_b64_tr_b16 v[142:143], v6 offset:16896
    v_mfma_f32_16x16x32_bf16 v[44:47], v[188:191], v[176:179], v[44:47]
    ds_read_b64_tr_b16 v[144:145], v7 offset:16384
    v_mfma_f32_16x16x32_bf16 v[64:67], v[192:195], v[172:175], v[64:67]
    ds_read_b64_tr_b16 v[146:147], v7 offset:16896
    v_mfma_f32_16x16x32_bf16 v[68:71], v[196:199], v[172:175], v[68:71]
    ds_read_b64_tr_b16 v[148:149], v6 offset:40960
    v_mfma_f32_16x16x32_bf16 v[32:35], v[184:187], v[172:175], v[32:35]
    ds_read_b64_tr_b16 v[150:151], v6 offset:41472
    v_mfma_f32_16x16x32_bf16 v[36:39], v[188:191], v[172:175], v[36:39]
    ds_read_b64_tr_b16 v[152:153], v7 offset:40960
    v_mfma_f32_16x16x32_bf16 v[56:59], v[192:195], v[168:171], v[56:59]
    ds_read_b64_tr_b16 v[154:155], v7 offset:41472
    v_mfma_f32_16x16x32_bf16 v[60:63], v[196:199], v[168:171], v[60:63]
    ds_read_b64_tr_b16 v[156:157], v8 offset:16384
    v_mfma_f32_16x16x32_bf16 v[24:27], v[184:187], v[168:171], v[24:27]
    ds_read_b64_tr_b16 v[158:159], v8 offset:16896
    v_mfma_f32_16x16x32_bf16 v[28:31], v[188:191], v[168:171], v[28:31]
    ds_read_b64_tr_b16 v[160:161], v9 offset:16384
    v_mfma_f32_16x16x32_bf16 v[48:51], v[192:195], v[164:167], v[48:51]
    ds_read_b64_tr_b16 v[162:163], v9 offset:16896
    v_mfma_f32_16x16x32_bf16 v[52:55], v[196:199], v[164:167], v[52:55]
    v_mfma_f32_16x16x32_bf16 v[16:19], v[184:187], v[164:167], v[16:19]
    v_mfma_f32_16x16x32_bf16 v[20:23], v[188:191], v[164:167], v[20:23]
    v_mfma_f32_16x16x32_bf16 v[96:99], v[172:175], v[200:203], v[96:99]
    v_mfma_f32_16x16x32_bf16 v[100:103], v[172:175], v[204:207], v[100:103]
    v_mfma_f32_16x16x32_bf16 v[88:91], v[168:171], v[200:203], v[88:91]
    v_mfma_f32_16x16x32_bf16 v[92:95], v[168:171], v[204:207], v[92:95]
    v_mfma_f32_16x16x32_bf16 v[80:83], v[164:167], v[200:203], v[80:83]
    v_mfma_f32_16x16x32_bf16 v[84:87], v[164:167], v[204:207], v[84:87]
    s_waitcnt lgkmcnt(0)
    v_mfma_f32_16x16x32_bf16 v[112:115], v[148:151], v[136:139], v[112:115]
    ds_read_b128 v[164:167], v5 offset:36864
    v_mfma_f32_16x16x32_bf16 v[116:119], v[136:139], v[156:159], v[116:119]
    ds_read_b128 v[168:171], v5 offset:38912
    v_mfma_f32_16x16x32_bf16 v[72:75], v[148:151], v[132:135], v[72:75]
    ds_read_b128 v[172:175], v5 offset:40960
    v_mfma_f32_16x16x32_bf16 v[76:79], v[152:155], v[132:135], v[76:79]
    ds_read_b128 v[176:179], v5 offset:43008
    v_mfma_f32_16x16x32_bf16 v[104:107], v[132:135], v[156:159], v[104:107]
    ds_read_b128 v[180:183], v3 offset:36864
    v_mfma_f32_16x16x32_bf16 v[108:111], v[132:135], v[160:163], v[108:111]
    ds_read_b64_tr_b16 v[184:185], v6 offset:20480
    v_mfma_f32_16x16x32_bf16 v[40:43], v[140:143], v[132:135], v[40:43]
    ds_read_b64_tr_b16 v[186:187], v6 offset:20992
    v_mfma_f32_16x16x32_bf16 v[44:47], v[144:147], v[132:135], v[44:47]
    ds_read_b64_tr_b16 v[188:189], v7 offset:20480
    v_mfma_f32_16x16x32_bf16 v[64:67], v[148:151], v[128:131], v[64:67]
    ds_read_b64_tr_b16 v[190:191], v7 offset:20992
    v_mfma_f32_16x16x32_bf16 v[68:71], v[152:155], v[128:131], v[68:71]
    ds_read_b64_tr_b16 v[192:193], v6 offset:45056
    v_mfma_f32_16x16x32_bf16 v[32:35], v[140:143], v[128:131], v[32:35]
    ds_read_b64_tr_b16 v[194:195], v6 offset:45568
    v_mfma_f32_16x16x32_bf16 v[36:39], v[144:147], v[128:131], v[36:39]
    ds_read_b64_tr_b16 v[196:197], v7 offset:45056
    v_mfma_f32_16x16x32_bf16 v[56:59], v[148:151], v[124:127], v[56:59]
    ds_read_b64_tr_b16 v[198:199], v7 offset:45568
    v_mfma_f32_16x16x32_bf16 v[60:63], v[152:155], v[124:127], v[60:63]
    ds_read_b64_tr_b16 v[200:201], v8 offset:20480
    v_mfma_f32_16x16x32_bf16 v[24:27], v[140:143], v[124:127], v[24:27]
    ds_read_b64_tr_b16 v[202:203], v8 offset:20992
    v_mfma_f32_16x16x32_bf16 v[28:31], v[144:147], v[124:127], v[28:31]
    ds_read_b64_tr_b16 v[204:205], v9 offset:20480
    v_mfma_f32_16x16x32_bf16 v[48:51], v[148:151], v[120:123], v[48:51]
    ds_read_b64_tr_b16 v[206:207], v9 offset:20992
    v_mfma_f32_16x16x32_bf16 v[52:55], v[152:155], v[120:123], v[52:55]
    v_mfma_f32_16x16x32_bf16 v[16:19], v[140:143], v[120:123], v[16:19]
    v_mfma_f32_16x16x32_bf16 v[20:23], v[144:147], v[120:123], v[20:23]
    v_mfma_f32_16x16x32_bf16 v[96:99], v[128:131], v[156:159], v[96:99]
    v_mfma_f32_16x16x32_bf16 v[100:103], v[128:131], v[160:163], v[100:103]
    v_mfma_f32_16x16x32_bf16 v[88:91], v[124:127], v[156:159], v[88:91]
    v_mfma_f32_16x16x32_bf16 v[92:95], v[124:127], v[160:163], v[92:95]
    v_mfma_f32_16x16x32_bf16 v[80:83], v[120:123], v[156:159], v[80:83]
    v_mfma_f32_16x16x32_bf16 v[84:87], v[120:123], v[160:163], v[84:87]
    s_waitcnt lgkmcnt(0)
    s_barrier
    v_mfma_f32_16x16x32_bf16 v[112:115], v[192:195], v[180:183], v[112:115]
    ds_read_b128 v[120:123], v4 offset:0
    v_mfma_f32_16x16x32_bf16 v[116:119], v[180:183], v[200:203], v[116:119]
    ds_read_b128 v[124:127], v4 offset:2048
    v_mfma_f32_16x16x32_bf16 v[72:75], v[192:195], v[176:179], v[72:75]
    ds_read_b128 v[128:131], v4 offset:4096
    v_mfma_f32_16x16x32_bf16 v[76:79], v[196:199], v[176:179], v[76:79]
    ds_read_b128 v[132:135], v4 offset:6144
    v_mfma_f32_16x16x32_bf16 v[104:107], v[176:179], v[200:203], v[104:107]
    ds_read_b128 v[136:139], v2 offset:0
    v_mfma_f32_16x16x32_bf16 v[108:111], v[176:179], v[204:207], v[108:111]
    ds_read_b64_tr_b16 v[140:141], v6 offset:0
    v_mfma_f32_16x16x32_bf16 v[40:43], v[184:187], v[176:179], v[40:43]
    ds_read_b64_tr_b16 v[142:143], v6 offset:512
    v_mfma_f32_16x16x32_bf16 v[44:47], v[188:191], v[176:179], v[44:47]
    ds_read_b64_tr_b16 v[144:145], v7 offset:0
    v_mfma_f32_16x16x32_bf16 v[64:67], v[192:195], v[172:175], v[64:67]
    ds_read_b64_tr_b16 v[146:147], v7 offset:512
    v_mfma_f32_16x16x32_bf16 v[68:71], v[196:199], v[172:175], v[68:71]
    ds_read_b64_tr_b16 v[148:149], v6 offset:24576
    v_mfma_f32_16x16x32_bf16 v[32:35], v[184:187], v[172:175], v[32:35]
    ds_read_b64_tr_b16 v[150:151], v6 offset:25088
    v_mfma_f32_16x16x32_bf16 v[36:39], v[188:191], v[172:175], v[36:39]
    ds_read_b64_tr_b16 v[152:153], v7 offset:24576
    v_mfma_f32_16x16x32_bf16 v[56:59], v[192:195], v[168:171], v[56:59]
    ds_read_b64_tr_b16 v[154:155], v7 offset:25088
    v_mfma_f32_16x16x32_bf16 v[60:63], v[196:199], v[168:171], v[60:63]
    ds_read_b64_tr_b16 v[156:157], v8 offset:0
    v_mfma_f32_16x16x32_bf16 v[24:27], v[184:187], v[168:171], v[24:27]
    ds_read_b64_tr_b16 v[158:159], v8 offset:512
    v_mfma_f32_16x16x32_bf16 v[28:31], v[188:191], v[168:171], v[28:31]
    ds_read_b64_tr_b16 v[160:161], v9 offset:0
    v_mfma_f32_16x16x32_bf16 v[48:51], v[192:195], v[164:167], v[48:51]
    ds_read_b64_tr_b16 v[162:163], v9 offset:512
    v_mfma_f32_16x16x32_bf16 v[52:55], v[196:199], v[164:167], v[52:55]
    v_mfma_f32_16x16x32_bf16 v[16:19], v[184:187], v[164:167], v[16:19]
    v_mfma_f32_16x16x32_bf16 v[20:23], v[188:191], v[164:167], v[20:23]
    v_mfma_f32_16x16x32_bf16 v[96:99], v[172:175], v[200:203], v[96:99]
    v_mfma_f32_16x16x32_bf16 v[100:103], v[172:175], v[204:207], v[100:103]
    v_mfma_f32_16x16x32_bf16 v[88:91], v[168:171], v[200:203], v[88:91]
    v_mfma_f32_16x16x32_bf16 v[92:95], v[168:171], v[204:207], v[92:95]
    v_mfma_f32_16x16x32_bf16 v[80:83], v[164:167], v[200:203], v[80:83]
    v_mfma_f32_16x16x32_bf16 v[84:87], v[164:167], v[204:207], v[84:87]
    s_waitcnt lgkmcnt(0)
    v_mfma_f32_16x16x32_bf16 v[112:115], v[148:151], v[136:139], v[112:115]
    ds_read_b128 v[164:167], v5 offset:0
    v_mfma_f32_16x16x32_bf16 v[116:119], v[136:139], v[156:159], v[116:119]
    ds_read_b128 v[168:171], v5 offset:2048
    v_mfma_f32_16x16x32_bf16 v[72:75], v[148:151], v[132:135], v[72:75]
    ds_read_b128 v[172:175], v5 offset:4096
    v_mfma_f32_16x16x32_bf16 v[76:79], v[152:155], v[132:135], v[76:79]
    ds_read_b128 v[176:179], v5 offset:6144
    v_mfma_f32_16x16x32_bf16 v[104:107], v[132:135], v[156:159], v[104:107]
    ds_read_b128 v[180:183], v3 offset:0
    v_mfma_f32_16x16x32_bf16 v[108:111], v[132:135], v[160:163], v[108:111]
    ds_read_b64_tr_b16 v[184:185], v6 offset:4096
    v_mfma_f32_16x16x32_bf16 v[40:43], v[140:143], v[132:135], v[40:43]
    ds_read_b64_tr_b16 v[186:187], v6 offset:4608
    v_mfma_f32_16x16x32_bf16 v[44:47], v[144:147], v[132:135], v[44:47]
    ds_read_b64_tr_b16 v[188:189], v7 offset:4096
    v_mfma_f32_16x16x32_bf16 v[64:67], v[148:151], v[128:131], v[64:67]
    ds_read_b64_tr_b16 v[190:191], v7 offset:4608
    v_mfma_f32_16x16x32_bf16 v[68:71], v[152:155], v[128:131], v[68:71]
    ds_read_b64_tr_b16 v[192:193], v6 offset:28672
    v_mfma_f32_16x16x32_bf16 v[32:35], v[140:143], v[128:131], v[32:35]
    ds_read_b64_tr_b16 v[194:195], v6 offset:29184
    v_mfma_f32_16x16x32_bf16 v[36:39], v[144:147], v[128:131], v[36:39]
    ds_read_b64_tr_b16 v[196:197], v7 offset:28672
    v_mfma_f32_16x16x32_bf16 v[56:59], v[148:151], v[124:127], v[56:59]
    ds_read_b64_tr_b16 v[198:199], v7 offset:29184
    v_mfma_f32_16x16x32_bf16 v[60:63], v[152:155], v[124:127], v[60:63]
    ds_read_b64_tr_b16 v[200:201], v8 offset:4096
    v_mfma_f32_16x16x32_bf16 v[24:27], v[140:143], v[124:127], v[24:27]
    ds_read_b64_tr_b16 v[202:203], v8 offset:4608
    v_mfma_f32_16x16x32_bf16 v[28:31], v[144:147], v[124:127], v[28:31]
    ds_read_b64_tr_b16 v[204:205], v9 offset:4096
    v_mfma_f32_16x16x32_bf16 v[48:51], v[148:151], v[120:123], v[48:51]
    ds_read_b64_tr_b16 v[206:207], v9 offset:4608
    v_mfma_f32_16x16x32_bf16 v[52:55], v[152:155], v[120:123], v[52:55]
    v_mfma_f32_16x16x32_bf16 v[16:19], v[140:143], v[120:123], v[16:19]
    v_mfma_f32_16x16x32_bf16 v[20:23], v[144:147], v[120:123], v[20:23]
    v_mfma_f32_16x16x32_bf16 v[96:99], v[128:131], v[156:159], v[96:99]
    v_mfma_f32_16x16x32_bf16 v[100:103], v[128:131], v[160:163], v[100:103]
    v_mfma_f32_16x16x32_bf16 v[88:91], v[124:127], v[156:159], v[88:91]
    v_mfma_f32_16x16x32_bf16 v[92:95], v[124:127], v[160:163], v[92:95]
    v_mfma_f32_16x16x32_bf16 v[80:83], v[120:123], v[156:159], v[80:83]
    v_mfma_f32_16x16x32_bf16 v[84:87], v[120:123], v[160:163], v[84:87]
    s_waitcnt lgkmcnt(0)
    s_mov_b64 exec, 1
    ds_add_u32 v10, v11 offset:24
    s_mov_b64 exec, -1
    s_lshl_b32 s78, s87, 2
    v_add_u32 v13, s78, v10
    v_mfma_f32_16x16x32_bf16 v[112:115], v[192:195], v[180:183], v[112:115]
    v_mfma_f32_16x16x32_bf16 v[116:119], v[180:183], v[200:203], v[116:119]
    v_mfma_f32_16x16x32_bf16 v[72:75], v[192:195], v[176:179], v[72:75]
    v_mfma_f32_16x16x32_bf16 v[76:79], v[196:199], v[176:179], v[76:79]
    v_mfma_f32_16x16x32_bf16 v[104:107], v[176:179], v[200:203], v[104:107]
    v_mfma_f32_16x16x32_bf16 v[108:111], v[176:179], v[204:207], v[108:111]
    v_mfma_f32_16x16x32_bf16 v[40:43], v[184:187], v[176:179], v[40:43]
    v_mfma_f32_16x16x32_bf16 v[44:47], v[188:191], v[176:179], v[44:47]
    v_mfma_f32_16x16x32_bf16 v[64:67], v[192:195], v[172:175], v[64:67]
    v_mfma_f32_16x16x32_bf16 v[68:71], v[196:199], v[172:175], v[68:71]
    v_cvt_pk_bf16_f32 v156, v112, v113
    v_cvt_pk_bf16_f32 v157, v114, v115
    v_mfma_f32_16x16x32_bf16 v[32:35], v[184:187], v[172:175], v[32:35]
    v_cvt_pk_bf16_f32 v158, v116, v117
    v_cvt_pk_bf16_f32 v159, v118, v119
    v_mfma_f32_16x16x32_bf16 v[36:39], v[188:191], v[172:175], v[36:39]
    v_cvt_pk_bf16_f32 v152, v72, v73
    v_cvt_pk_bf16_f32 v153, v74, v75
    v_mfma_f32_16x16x32_bf16 v[56:59], v[192:195], v[168:171], v[56:59]
    v_cvt_pk_bf16_f32 v154, v76, v77
    v_cvt_pk_bf16_f32 v155, v78, v79
    v_mfma_f32_16x16x32_bf16 v[60:63], v[196:199], v[168:171], v[60:63]
    v_cvt_pk_bf16_f32 v232, v104, v105
    v_cvt_pk_bf16_f32 v233, v106, v107
    v_mfma_f32_16x16x32_bf16 v[24:27], v[184:187], v[168:171], v[24:27]
    v_cvt_pk_bf16_f32 v242, v108, v109
    v_cvt_pk_bf16_f32 v243, v110, v111
    v_mfma_f32_16x16x32_bf16 v[28:31], v[188:191], v[168:171], v[28:31]
    ds_write_b64 v216, v[156:157]
    ds_write_b64 v216, v[158:159] offset:1024
    v_mfma_f32_16x16x32_bf16 v[48:51], v[192:195], v[164:167], v[48:51]
    ds_write_b64 v217, v[152:153] offset:0
    ds_write_b64 v217, v[232:233] offset:1024
    v_mfma_f32_16x16x32_bf16 v[52:55], v[196:199], v[164:167], v[52:55]
    ds_write_b64 v217, v[154:155] offset:512
    ds_write_b64 v217, v[242:243] offset:1536
    v_mfma_f32_16x16x32_bf16 v[16:19], v[184:187], v[164:167], v[16:19]
    v_cvt_pk_bf16_f32 v132, v40, v41
    v_cvt_pk_bf16_f32 v133, v42, v43
    v_mfma_f32_16x16x32_bf16 v[20:23], v[188:191], v[164:167], v[20:23]
    v_cvt_pk_bf16_f32 v134, v44, v45
    v_cvt_pk_bf16_f32 v135, v46, v47
    v_mfma_f32_16x16x32_bf16 v[96:99], v[172:175], v[200:203], v[96:99]
    v_cvt_pk_bf16_f32 v148, v64, v65
    v_cvt_pk_bf16_f32 v149, v66, v67
    v_mfma_f32_16x16x32_bf16 v[100:103], v[172:175], v[204:207], v[100:103]
    v_cvt_pk_bf16_f32 v150, v68, v69
    v_cvt_pk_bf16_f32 v151, v70, v71
    v_mfma_f32_16x16x32_bf16 v[88:91], v[168:171], v[200:203], v[88:91]
    v_cvt_pk_bf16_f32 v128, v32, v33
    v_cvt_pk_bf16_f32 v129, v34, v35
    v_mfma_f32_16x16x32_bf16 v[92:95], v[168:171], v[204:207], v[92:95]
    v_cvt_pk_bf16_f32 v130, v36, v37
    v_cvt_pk_bf16_f32 v131, v38, v39
    v_mfma_f32_16x16x32_bf16 v[80:83], v[164:167], v[200:203], v[80:83]
    v_cvt_pk_bf16_f32 v144, v56, v57
    v_cvt_pk_bf16_f32 v145, v58, v59
    v_mfma_f32_16x16x32_bf16 v[84:87], v[164:167], v[204:207], v[84:87]
    v_cvt_pk_bf16_f32 v146, v60, v61
    v_cvt_pk_bf16_f32 v147, v62, v63
    v_cvt_pk_bf16_f32 v124, v24, v25
    v_cvt_pk_bf16_f32 v125, v26, v27
    v_cvt_pk_bf16_f32 v126, v28, v29
    v_cvt_pk_bf16_f32 v127, v30, v31
    s_mov_b64 exec, 1
    ds_add_u32 v13, v11 offset:0
    s_mov_b64 exec, -1
    v_cvt_pk_bf16_f32 v140, v48, v49
    v_cvt_pk_bf16_f32 v141, v50, v51
    v_cvt_pk_bf16_f32 v142, v52, v53
    v_cvt_pk_bf16_f32 v143, v54, v55
    v_cvt_pk_bf16_f32 v120, v16, v17
    v_cvt_pk_bf16_f32 v121, v18, v19
    v_cvt_pk_bf16_f32 v122, v20, v21
    v_cvt_pk_bf16_f32 v123, v22, v23
    v_mfma_f32_16x16x32_bf16 v[44:47], v[152:155], v[132:135], 0
    v_cvt_pk_bf16_f32 v230, v96, v97
    v_cvt_pk_bf16_f32 v231, v98, v99
    v_mfma_f32_16x16x32_bf16 v[40:43], v[148:151], v[132:135], 0
    v_cvt_pk_bf16_f32 v240, v100, v101
    v_cvt_pk_bf16_f32 v241, v102, v103
    v_mfma_f32_16x16x32_bf16 v[36:39], v[148:151], v[128:131], 0
    v_cvt_pk_bf16_f32 v228, v88, v89
    v_cvt_pk_bf16_f32 v229, v90, v91
    v_mfma_f32_16x16x32_bf16 v[32:35], v[144:147], v[128:131], 0
    v_cvt_pk_bf16_f32 v238, v92, v93
    v_cvt_pk_bf16_f32 v239, v94, v95
    v_mfma_f32_16x16x32_bf16 v[28:31], v[144:147], v[124:127], 0
    v_cvt_pk_bf16_f32 v226, v80, v81
    v_cvt_pk_bf16_f32 v227, v82, v83
    v_mfma_f32_16x16x32_bf16 v[24:27], v[140:143], v[124:127], 0
    v_cvt_pk_bf16_f32 v236, v84, v85
    v_cvt_pk_bf16_f32 v237, v86, v87
    v_mfma_f32_16x16x32_bf16 v[20:23], v[140:143], v[120:123], 0
    s_branch LB_s1_in
LB_s1:
    s_sleep 1
LB_s1_in:
    ds_read_b32 v14, v13 offset:0
    ds_read_b64 v[136:137], v218
    ds_read_b64 v[138:139], v219
    ds_read_b64 v[224:225], v218 offset:1024
    ds_read_b64 v[234:235], v219 offset:1024
    s_waitcnt lgkmcnt(0)
    v_readfirstlane_b32 s78, v14
    s_nop 0
    s_cmp_ge_u32 s78, 2
    s_cbranch_scc0 LB_s1
    v_mfma_f32_16x16x32_bf16 v[16:19], v[136:139], v[120:123], v[212:215]
    v_cndmask_b32 v60, v44, v45, s[88:89]
    v_cndmask_b32 v61, v40, v41, s[88:89]
    v_cndmask_b32 v54, v61, v60, s[90:91]
    v_cndmask_b32 v60, v46, v47, s[88:89]
    v_cndmask_b32 v61, v42, v43, s[88:89]
    v_cndmask_b32 v55, v61, v60, s[92:93]
    v_max_f32 v59, v54, v55
    v_cndmask_b32 v60, v36, v37, s[88:89]
    v_cndmask_b32 v61, v32, v33, s[88:89]
    v_cndmask_b32 v52, v61, v60, s[90:91]
    v_cndmask_b32 v60, v38, v39, s[88:89]
    v_cndmask_b32 v61, v34, v35, s[88:89]
    v_cndmask_b32 v53, v61, v60, s[92:93]
    v_max_f32 v58, v52, v53
    v_cndmask_b32 v60, v28, v29, s[88:89]
    v_cndmask_b32 v61, v24, v25, s[88:89]
    v_cndmask_b32 v50, v61, v60, s[90:91]
    v_cndmask_b32 v60, v30, v31, s[88:89]
    v_cndmask_b32 v61, v26, v27, s[88:89]
    v_cndmask_b32 v51, v61, v60, s[92:93]
    v_max_f32 v57, v50, v51
    v_cndmask_b32 v60, v20, v21, s[88:89]
    v_cndmask_b32 v61, v16, v17, s[88:89]
    v_cndmask_b32 v48, v61, v60, s[90:91]
    v_cndmask_b32 v60, v22, v23, s[88:89]
    v_cndmask_b32 v61, v18, v19, s[88:89]
    v_cndmask_b32 v49, v61, v60, s[92:93]
    v_max_f32 v56, v48, v49
    s_mov_b32 s80, 0x3e8293ee
    v_permlane32_swap_b32 v58, v59
    v_permlane32_swap_b32 v56, v57
    v_max_f32 v58, v58, v59
    v_max_f32 v56, v56, v57
    s_nop 1
    v_permlane16_swap_b32 v56, v58
    v_max_f32 v56, v56, v58
    v_mul_f32 v56, s80, v56
    v_mov_b32 v58, v56
    s_nop 1
    v_permlane16_swap_b32 v56, v58
    v_mov_b32 v57, v56
    v_mov_b32 v59, v58
    s_nop 0
    v_permlane32_swap_b32 v56, v57
    v_permlane32_swap_b32 v58, v59
    v_fma_f32 v48, v48, s80, -v56
    v_fma_f32 v49, v49, s80, -v56
    v_fma_f32 v50, v50, s80, -v57
    v_fma_f32 v51, v51, s80, -v57
    v_fma_f32 v52, v52, s80, -v58
    v_fma_f32 v53, v53, s80, -v58
    v_fma_f32 v54, v54, s80, -v59
    v_fma_f32 v55, v55, s80, -v59
    v_exp_f32 v48, v48
    v_exp_f32 v49, v49
    v_exp_f32 v50, v50
    v_exp_f32 v51, v51
    v_exp_f32 v52, v52
    v_exp_f32 v53, v53
    v_exp_f32 v54, v54
    v_exp_f32 v55, v55
    v_add_f32 v56, v48, v49
    v_add_f32 v57, v50, v51
    v_add_f32 v58, v52, v53
    v_add_f32 v59, v54, v55
    s_nop 1
    v_permlane32_swap_b32 v58, v59
    v_permlane32_swap_b32 v56, v57
    v_add_f32 v58, v58, v59
    v_add_f32 v56, v56, v57
    s_nop 1
    v_permlane16_swap_b32 v56, v58
    v_add_f32 v56, v56, v58
    v_rcp_f32 v56, v56
    s_nop 0
    v_mov_b32 v58, v56
    s_nop 1
    v_permlane16_swap_b32 v56, v58
    v_mov_b32 v57, v56
    v_mov_b32 v59, v58
    s_nop 0
    v_permlane32_swap_b32 v56, v57
    v_permlane32_swap_b32 v58, v59
    v_mul_f32 v48, v48, v56
    v_mul_f32 v49, v49, v56
    v_cvt_pk_bf16_f32 v48, v48, v49
    v_perm_b32 v64, v48, v48, v208
    v_perm_b32 v65, v48, v48, v209
    v_perm_b32 v66, v48, v48, v210
    v_perm_b32 v67, v48, v48, v211
    v_mul_f32 v50, v50, v57
    v_mul_f32 v51, v51, v57
    v_cvt_pk_bf16_f32 v50, v50, v51
    v_perm_b32 v68, v50, v50, v208
    v_perm_b32 v69, v50, v50, v209
    v_perm_b32 v70, v50, v50, v210
    v_perm_b32 v71, v50, v50, v211
    v_mfma_f32_16x16x32_bf16 v[16:19], v[224:227], v[64:67], 0
    v_mfma_f32_16x16x32_bf16 v[20:23], v[234:237], v[64:67], 0
    v_mul_f32 v52, v52, v58
    v_mul_f32 v53, v53, v58
    v_cvt_pk_bf16_f32 v52, v52, v53
    v_perm_b32 v72, v52, v52, v208
    v_perm_b32 v73, v52, v52, v209
    v_perm_b32 v74, v52, v52, v210
    v_perm_b32 v75, v52, v52, v211
    v_mfma_f32_16x16x32_bf16 v[24:27], v[226:229], v[68:71], 0
    v_mfma_f32_16x16x32_bf16 v[28:31], v[236:239], v[68:71], 0
    v_mul_f32 v54, v54, v59
    v_mul_f32 v55, v55, v59
    v_cvt_pk_bf16_f32 v54, v54, v55
    v_perm_b32 v76, v54, v54, v208
    v_perm_b32 v77, v54, v54, v209
    v_perm_b32 v78, v54, v54, v210
    v_perm_b32 v79, v54, v54, v211
    v_mfma_f32_16x16x32_bf16 v[32:35], v[228:231], v[72:75], 0
    v_mfma_f32_16x16x32_bf16 v[36:39], v[238:241], v[72:75], 0
    v_mfma_f32_16x16x32_bf16 v[40:43], v[230:233], v[76:79], 0
    v_mfma_f32_16x16x32_bf16 v[44:47], v[240:243], v[76:79], 0
    v_cvt_pk_bf16_f32 v80, v16, v17
    v_cvt_pk_bf16_f32 v81, v18, v19
    v_cvt_pk_bf16_f32 v82, v20, v21
    v_cvt_pk_bf16_f32 v83, v22, v23
    s_add_u32 s95, s94, 0
    buffer_store_dwordx4 v[80:83], v12, s[52:55], s95 offen sc1
    v_cvt_pk_bf16_f32 v84, v24, v25
    v_cvt_pk_bf16_f32 v85, v26, v27
    v_cvt_pk_bf16_f32 v86, v28, v29
    v_cvt_pk_bf16_f32 v87, v30, v31
    s_add_u32 s95, s94, 32768
    buffer_store_dwordx4 v[84:87], v12, s[52:55], s95 offen sc1
    v_cvt_pk_bf16_f32 v88, v32, v33
    v_cvt_pk_bf16_f32 v89, v34, v35
    v_cvt_pk_bf16_f32 v90, v36, v37
    v_cvt_pk_bf16_f32 v91, v38, v39
    s_add_u32 s95, s94, 65536
    buffer_store_dwordx4 v[88:91], v12, s[52:55], s95 offen sc1
    v_cvt_pk_bf16_f32 v92, v40, v41
    v_cvt_pk_bf16_f32 v93, v42, v43
    v_cvt_pk_bf16_f32 v94, v44, v45
    v_cvt_pk_bf16_f32 v95, v46, v47
    s_add_u32 s95, s94, 98304
    buffer_store_dwordx4 v[92:95], v12, s[52:55], s95 offen sc1
    v_xor_b32 v2, 0, v244
    v_xor_b32 v3, 32, v244
    v_xor_b32 v4, 64, v244
    v_xor_b32 v5, 96, v244
    v_xor_b32 v6, 2048, v244
    v_xor_b32 v7, 2080, v244
    v_xor_b32 v8, 2112, v244
    v_xor_b32 v9, 2144, v244
    s_branch LB_s2_in
LB_s2:
    s_sleep 1
LB_s2_in:
    ds_read_b32 v14, v10 offset:8
    s_waitcnt lgkmcnt(0)
    v_readfirstlane_b32 s78, v14
    s_nop 0
    s_cmp_ge_u32 s78, 4
    s_cbranch_scc0 LB_s2
    ds_read_b64_tr_b16 v[48:49], v2 offset:8192
    ds_read_b64_tr_b16 v[50:51], v6 offset:8192
    ds_read_b64_tr_b16 v[52:53], v3 offset:8192
    ds_read_b64_tr_b16 v[54:55], v7 offset:8192
    ds_read_b64_tr_b16 v[56:57], v4 offset:8192
    ds_read_b64_tr_b16 v[58:59], v8 offset:8192
    ds_read_b64_tr_b16 v[60:61], v5 offset:8192
    ds_read_b64_tr_b16 v[62:63], v9 offset:8192
    ds_read_b64_tr_b16 v[64:65], v2 offset:12288
    ds_read_b64_tr_b16 v[66:67], v6 offset:12288
    ds_read_b64_tr_b16 v[68:69], v3 offset:12288
    ds_read_b64_tr_b16 v[70:71], v7 offset:12288
    ds_read_b64_tr_b16 v[72:73], v4 offset:12288
    ds_read_b64_tr_b16 v[74:75], v8 offset:12288
    ds_read_b64_tr_b16 v[76:77], v5 offset:12288
    ds_read_b64_tr_b16 v[78:79], v9 offset:12288
    ds_read_b64_tr_b16 v[80:81], v2 offset:32768
    ds_read_b64_tr_b16 v[82:83], v6 offset:32768
    ds_read_b64_tr_b16 v[84:85], v3 offset:32768
    ds_read_b64_tr_b16 v[86:87], v7 offset:32768
    ds_read_b64_tr_b16 v[88:89], v4 offset:32768
    ds_read_b64_tr_b16 v[90:91], v8 offset:32768
    ds_read_b64_tr_b16 v[92:93], v5 offset:32768
    ds_read_b64_tr_b16 v[94:95], v9 offset:32768
    s_waitcnt vmcnt(0)
    s_mov_b64 exec, 1
    buffer_store_dword v11, v220, s[52:55], s97 offen sc1
    s_mov_b64 exec, -1
    ds_read_b64_tr_b16 v[96:97], v2 offset:36864
    ds_read_b64_tr_b16 v[98:99], v6 offset:36864
    ds_read_b64_tr_b16 v[100:101], v3 offset:36864
    ds_read_b64_tr_b16 v[102:103], v7 offset:36864
    ds_read_b64_tr_b16 v[104:105], v4 offset:36864
    ds_read_b64_tr_b16 v[106:107], v8 offset:36864
    ds_read_b64_tr_b16 v[108:109], v5 offset:36864
    ds_read_b64_tr_b16 v[110:111], v9 offset:36864
    ds_read_b64_tr_b16 v[112:113], v2 offset:57344
    ds_read_b64_tr_b16 v[114:115], v6 offset:57344
    ds_read_b64_tr_b16 v[116:117], v3 offset:57344
    ds_read_b64_tr_b16 v[118:119], v7 offset:57344
    ds_read_b64_tr_b16 v[120:121], v4 offset:57344
    ds_read_b64_tr_b16 v[122:123], v8 offset:57344
    ds_read_b64_tr_b16 v[124:125], v5 offset:57344
    ds_read_b64_tr_b16 v[126:127], v9 offset:57344
    ds_read_b64_tr_b16 v[128:129], v2 offset:61440
    ds_read_b64_tr_b16 v[130:131], v6 offset:61440
    ds_read_b64_tr_b16 v[132:133], v3 offset:61440
    ds_read_b64_tr_b16 v[134:135], v7 offset:61440
    ds_read_b64_tr_b16 v[136:137], v4 offset:61440
    ds_read_b64_tr_b16 v[138:139], v8 offset:61440
    ds_read_b64_tr_b16 v[140:141], v5 offset:61440
    ds_read_b64_tr_b16 v[142:143], v9 offset:61440
    ds_read_b64_tr_b16 v[144:145], v2 offset:16384
    ds_read_b64_tr_b16 v[146:147], v6 offset:16384
    ds_read_b64_tr_b16 v[148:149], v3 offset:16384
    ds_read_b64_tr_b16 v[150:151], v7 offset:16384
    ds_read_b64_tr_b16 v[152:153], v4 offset:16384
    ds_read_b64_tr_b16 v[154:155], v8 offset:16384
    ds_read_b64_tr_b16 v[156:157], v5 offset:16384
    ds_read_b64_tr_b16 v[158:159], v9 offset:16384
    ds_read_b64_tr_b16 v[160:161], v2 offset:20480
    ds_read_b64_tr_b16 v[162:163], v6 offset:20480
    ds_read_b64_tr_b16 v[164:165], v3 offset:20480
    ds_read_b64_tr_b16 v[166:167], v7 offset:20480
    ds_read_b64_tr_b16 v[168:169], v4 offset:20480
    ds_read_b64_tr_b16 v[170:171], v8 offset:20480
    ds_read_b64_tr_b16 v[172:173], v5 offset:20480
    ds_read_b64_tr_b16 v[174:175], v9 offset:20480
    v_add_u32 v224, 65536, v2
    v_add_u32 v225, 65536, v3
    v_add_u32 v226, 65536, v4
    v_add_u32 v227, 65536, v5
    v_add_u32 v228, 65536, v6
    v_add_u32 v229, 65536, v7
    v_add_u32 v230, 65536, v8
    v_add_u32 v231, 65536, v9
    s_waitcnt lgkmcnt(0)
    s_mov_b64 exec, 1
    ds_add_u32 v10, v11 offset:32
    s_mov_b64 exec, -1
    s_branch LB_s8_in
LB_s8:
    s_sleep 1
LB_s8_in:
    ds_read_b32 v14, v10 offset:32
    s_waitcnt lgkmcnt(0)
    v_readfirstlane_b32 s78, v14
    s_nop 0
    s_cmp_ge_u32 s78, 4
    s_cbranch_scc0 LB_s8
    s_lshl_b32 s80, s32, 6
    s_lshl_b32 s81, s3, 10
    s_add_u32 s95, s80, 1572864
    s_add_u32 m0, s81, 8192
    s_and_b32 s95, s95, 0x1f0000
    buffer_load_dwordx4 v245, s[64:67], s95 offen  lds
    s_add_u32 s95, s80, 1638400
    s_add_u32 m0, s81, 12288
    s_and_b32 s95, s95, 0x1f0000
    buffer_load_dwordx4 v245, s[64:67], s95 offen  lds
    s_add_u32 s95, s80, 1703936
    s_add_u32 m0, s81, 32768
    s_and_b32 s95, s95, 0x1f0000
    buffer_load_dwordx4 v245, s[64:67], s95 offen  lds
    s_add_u32 s95, s80, 1769472
    s_add_u32 m0, s81, 36864
    s_and_b32 s95, s95, 0x1f0000
    buffer_load_dwordx4 v245, s[64:67], s95 offen  lds
    s_add_u32 s95, s80, 1835008
    s_add_u32 m0, s81, 57344
    s_and_b32 s95, s95, 0x1f0000
    buffer_load_dwordx4 v245, s[64:67], s95 offen  lds
    s_add_u32 s95, s80, 1900544
    s_add_u32 m0, s81, 61440
    s_and_b32 s95, s95, 0x1f0000
    buffer_load_dwordx4 v245, s[64:67], s95 offen  lds
    s_add_u32 s95, s80, 1966080
    s_add_u32 m0, s81, 16384
    s_and_b32 s95, s95, 0x1f0000
    buffer_load_dwordx4 v245, s[64:67], s95 offen  lds
    s_add_u32 s95, s80, 2031616
    s_add_u32 m0, s81, 20480
    s_and_b32 s95, s95, 0x1f0000
    buffer_load_dwordx4 v245, s[64:67], s95 offen  lds
    s_waitcnt vmcnt(0)
    s_mov_b64 exec, 1
    ds_add_u32 v10, v11 offset:16
    s_mov_b64 exec, -1
    s_mov_b64 exec, 0xffffffff
    s_mov_b32 s79, 0
LB_po:
    buffer_load_dword v14, v247, s[52:55], s30 offen sc1
    s_add_u32 s79, s79, 1
    s_cmp_gt_u32 s79, 200000
    s_cbranch_scc1 LB_po_x
    s_waitcnt vmcnt(0)
    v_cmp_ne_u32 vcc, 1, v14
    s_cbranch_vccz LB_po_x
    s_mov_b64 exec, vcc
    s_sleep 8
    s_branch LB_po
LB_po_x:
    s_waitcnt vmcnt(0)
    s_mov_b64 exec, -1
    s_add_u32 s29, s32, 0
    s_and_b32 s29, s29, 0x7fff
    s_add_u32 s29, s29, s28
    buffer_load_dwordx4 v[176:179], v12, s[52:55], s29 offen offset:0 sc1
    s_add_u32 s31, s29, 32768
    buffer_load_dwordx4 v[180:183], v12, s[52:55], s31 offen offset:0 sc1
    buffer_load_dwordx4 v[184:187], v12, s[52:55], s29 offen offset:1024 sc1
    buffer_load_dwordx4 v[188:191], v12, s[52:55], s31 offen offset:1024 sc1
    buffer_load_dwordx4 v[192:195], v12, s[52:55], s29 offen offset:2048 sc1
    buffer_load_dwordx4 v[196:199], v12, s[52:55], s31 offen offset:2048 sc1
    buffer_load_dwordx4 v[200:203], v12, s[52:55], s29 offen offset:3072 sc1
    buffer_load_dwordx4 v[204:207], v12, s[52:55], s31 offen offset:3072 sc1
    s_add_u32 s29, s32, 4096
    s_and_b32 s29, s29, 0x7fff
    s_add_u32 s29, s29, s28
    buffer_load_dwordx4 v[208:211], v12, s[52:55], s29 offen offset:0 sc1
    s_add_u32 s31, s29, 32768
    buffer_load_dwordx4 v[212:215], v12, s[52:55], s31 offen offset:0 sc1
    s_setprio 1
    s_branch LB_s4_in
LB_s4:
    s_sleep 1
LB_s4_in:
    ds_read_b32 v14, v10 offset:16
    s_waitcnt lgkmcnt(0)
    v_readfirstlane_b32 s78, v14
    s_nop 0
    s_cmp_ge_u32 s78, 8
    s_cbranch_scc0 LB_s4
    s_waitcnt vmcnt(8)
    v_mfma_f32_16x16x32_bf16 v[16:19], v[48:51], v[176:179], 0
    buffer_load_dwordx4 v[216:219], v12, s[52:55], s29 offen offset:1024 sc1
    v_mfma_f32_16x16x32_bf16 v[20:23], v[52:55], v[176:179], 0
    v_mfma_f32_16x16x32_bf16 v[24:27], v[56:59], v[176:179], 0
    v_mfma_f32_16x16x32_bf16 v[28:31], v[60:63], v[176:179], 0
    v_mfma_f32_16x16x32_bf16 v[32:35], v[48:51], v[180:183], 0
    buffer_load_dwordx4 v[220:223], v12, s[52:55], s31 offen offset:1024 sc1
    v_mfma_f32_16x16x32_bf16 v[36:39], v[52:55], v[180:183], 0
    v_mfma_f32_16x16x32_bf16 v[40:43], v[56:59], v[180:183], 0
    v_mfma_f32_16x16x32_bf16 v[44:47], v[60:63], v[180:183], 0
    s_waitcnt vmcnt(8)
    v_mfma_f32_16x16x32_bf16 v[16:19], v[64:67], v[184:187], v[16:19]
    buffer_load_dwordx4 v[176:179], v12, s[52:55], s29 offen offset:2048 sc1
    v_mfma_f32_16x16x32_bf16 v[20:23], v[68:71], v[184:187], v[20:23]
    v_mfma_f32_16x16x32_bf16 v[24:27], v[72:75], v[184:187], v[24:27]
    v_mfma_f32_16x16x32_bf16 v[28:31], v[76:79], v[184:187], v[28:31]
    v_mfma_f32_16x16x32_bf16 v[32:35], v[64:67], v[188:191], v[32:35]
    buffer_load_dwordx4 v[180:183], v12, s[52:55], s31 offen offset:2048 sc1
    v_mfma_f32_16x16x32_bf16 v[36:39], v[68:71], v[188:191], v[36:39]
    v_mfma_f32_16x16x32_bf16 v[40:43], v[72:75], v[188:191], v[40:43]
    v_mfma_f32_16x16x32_bf16 v[44:47], v[76:79], v[188:191], v[44:47]
    s_waitcnt vmcnt(8)
    v_mfma_f32_16x16x32_bf16 v[16:19], v[80:83], v[192:195], v[16:19]
    buffer_load_dwordx4 v[184:187], v12, s[52:55], s29 offen offset:3072 sc1
    v_mfma_f32_16x16x32_bf16 v[20:23], v[84:87], v[192:195], v[20:23]
    v_mfma_f32_16x16x32_bf16 v[24:27], v[88:91], v[192:195], v[24:27]
    v_mfma_f32_16x16x32_bf16 v[28:31], v[92:95], v[192:195], v[28:31]
    v_mfma_f32_16x16x32_bf16 v[32:35], v[80:83], v[196:199], v[32:35]
    buffer_load_dwordx4 v[188:191], v12, s[52:55], s31 offen offset:3072 sc1
    v_mfma_f32_16x16x32_bf16 v[36:39], v[84:87], v[196:199], v[36:39]
    v_mfma_f32_16x16x32_bf16 v[40:43], v[88:91], v[196:199], v[40:43]
    v_mfma_f32_16x16x32_bf16 v[44:47], v[92:95], v[196:199], v[44:47]
    s_waitcnt vmcnt(8)
    v_mfma_f32_16x16x32_bf16 v[16:19], v[96:99], v[200:203], v[16:19]
    s_add_u32 s29, s32, 8192
    v_mfma_f32_16x16x32_bf16 v[20:23], v[100:103], v[200:203], v[20:23]
    s_and_b32 s29, s29, 0x7fff
    v_mfma_f32_16x16x32_bf16 v[24:27], v[104:107], v[200:203], v[24:27]
    s_add_u32 s29, s29, s28
    v_mfma_f32_16x16x32_bf16 v[28:31], v[108:111], v[200:203], v[28:31]
    v_mfma_f32_16x16x32_bf16 v[32:35], v[96:99], v[204:207], v[32:35]
    buffer_load_dwordx4 v[192:195], v12, s[52:55], s29 offen offset:0 sc1
    v_mfma_f32_16x16x32_bf16 v[36:39], v[100:103], v[204:207], v[36:39]
    s_add_u32 s31, s29, 32768
    v_mfma_f32_16x16x32_bf16 v[40:43], v[104:107], v[204:207], v[40:43]
    buffer_load_dwordx4 v[196:199], v12, s[52:55], s31 offen offset:0 sc1
    v_mfma_f32_16x16x32_bf16 v[44:47], v[108:111], v[204:207], v[44:47]
    s_waitcnt vmcnt(8)
    v_mfma_f32_16x16x32_bf16 v[16:19], v[112:115], v[208:211], v[16:19]
    buffer_load_dwordx4 v[200:203], v12, s[52:55], s29 offen offset:1024 sc1
    v_mfma_f32_16x16x32_bf16 v[20:23], v[116:119], v[208:211], v[20:23]
    v_mfma_f32_16x16x32_bf16 v[24:27], v[120:123], v[208:211], v[24:27]
    v_mfma_f32_16x16x32_bf16 v[28:31], v[124:127], v[208:211], v[28:31]
    v_mfma_f32_16x16x32_bf16 v[32:35], v[112:115], v[212:215], v[32:35]
    buffer_load_dwordx4 v[204:207], v12, s[52:55], s31 offen offset:1024 sc1
    v_mfma_f32_16x16x32_bf16 v[36:39], v[116:119], v[212:215], v[36:39]
    v_mfma_f32_16x16x32_bf16 v[40:43], v[120:123], v[212:215], v[40:43]
    v_mfma_f32_16x16x32_bf16 v[44:47], v[124:127], v[212:215], v[44:47]
    s_waitcnt vmcnt(8)
    v_mfma_f32_16x16x32_bf16 v[16:19], v[128:131], v[216:219], v[16:19]
    buffer_load_dwordx4 v[208:211], v12, s[52:55], s29 offen offset:2048 sc1
    v_mfma_f32_16x16x32_bf16 v[20:23], v[132:135], v[216:219], v[20:23]
    v_mfma_f32_16x16x32_bf16 v[24:27], v[136:139], v[216:219], v[24:27]
    v_mfma_f32_16x16x32_bf16 v[28:31], v[140:143], v[216:219], v[28:31]
    v_mfma_f32_16x16x32_bf16 v[32:35], v[128:131], v[220:223], v[32:35]
    buffer_load_dwordx4 v[212:215], v12, s[52:55], s31 offen offset:2048 sc1
    v_mfma_f32_16x16x32_bf16 v[36:39], v[132:135], v[220:223], v[36:39]
    v_mfma_f32_16x16x32_bf16 v[40:43], v[136:139], v[220:223], v[40:43]
    v_mfma_f32_16x16x32_bf16 v[44:47], v[140:143], v[220:223], v[44:47]
    s_waitcnt vmcnt(8)
    v_mfma_f32_16x16x32_bf16 v[16:19], v[144:147], v[176:179], v[16:19]
    buffer_load_dwordx4 v[216:219], v12, s[52:55], s29 offen offset:3072 sc1
    buffer_load_dwordx4 v[220:223], v12, s[52:55], s31 offen offset:3072 sc1
    v_mfma_f32_16x16x32_bf16 v[20:23], v[148:151], v[176:179], v[20:23]
    ds_read_b64_tr_b16 v[48:49], v2 offset:40960
    v_mfma_f32_16x16x32_bf16 v[24:27], v[152:155], v[176:179], v[24:27]
    ds_read_b64_tr_b16 v[50:51], v6 offset:40960
    v_mfma_f32_16x16x32_bf16 v[28:31], v[156:159], v[176:179], v[28:31]
    ds_read_b64_tr_b16 v[52:53], v3 offset:40960
    v_mfma_f32_16x16x32_bf16 v[32:35], v[144:147], v[180:183], v[32:35]
    ds_read_b64_tr_b16 v[54:55], v7 offset:40960
    ds_read_b64_tr_b16 v[56:57], v4 offset:40960
    v_mfma_f32_16x16x32_bf16 v[36:39], v[148:151], v[180:183], v[36:39]
    ds_read_b64_tr_b16 v[58:59], v8 offset:40960
    v_mfma_f32_16x16x32_bf16 v[40:43], v[152:155], v[180:183], v[40:43]
    ds_read_b64_tr_b16 v[60:61], v5 offset:40960
    v_mfma_f32_16x16x32_bf16 v[44:47], v[156:159], v[180:183], v[44:47]
    ds_read_b64_tr_b16 v[62:63], v9 offset:40960
    s_waitcnt vmcnt(8)
    v_mfma_f32_16x16x32_bf16 v[16:19], v[160:163], v[184:187], v[16:19]
    s_add_u32 s29, s32, 12288
    s_and_b32 s29, s29, 0x7fff
    v_mfma_f32_16x16x32_bf16 v[20:23], v[164:167], v[184:187], v[20:23]
    s_add_u32 s29, s29, s28
    buffer_load_dwordx4 v[176:179], v12, s[52:55], s29 offen offset:0 sc1
    v_mfma_f32_16x16x32_bf16 v[24:27], v[168:171], v[184:187], v[24:27]
    s_add_u32 s31, s29, 32768
    buffer_load_dwordx4 v[180:183], v12, s[52:55], s31 offen offset:0 sc1
    v_mfma_f32_16x16x32_bf16 v[28:31], v[172:175], v[184:187], v[28:31]
    ds_read_b64_tr_b16 v[64:65], v2 offset:45056
    v_mfma_f32_16x16x32_bf16 v[32:35], v[160:163], v[188:191], v[32:35]
    ds_read_b64_tr_b16 v[66:67], v6 offset:45056
    ds_read_b64_tr_b16 v[68:69], v3 offset:45056
    v_mfma_f32_16x16x32_bf16 v[36:39], v[164:167], v[188:191], v[36:39]
    ds_read_b64_tr_b16 v[70:71], v7 offset:45056
    ds_read_b64_tr_b16 v[72:73], v4 offset:45056
    v_mfma_f32_16x16x32_bf16 v[40:43], v[168:171], v[188:191], v[40:43]
    ds_read_b64_tr_b16 v[74:75], v8 offset:45056
    ds_read_b64_tr_b16 v[76:77], v5 offset:45056
    v_mfma_f32_16x16x32_bf16 v[44:47], v[172:175], v[188:191], v[44:47]
    ds_read_b64_tr_b16 v[78:79], v9 offset:45056
    s_waitcnt vmcnt(8) lgkmcnt(8)
    v_mfma_f32_16x16x32_bf16 v[16:19], v[48:51], v[192:195], v[16:19]
    buffer_load_dwordx4 v[184:187], v12, s[52:55], s29 offen offset:1024 sc1
    buffer_load_dwordx4 v[188:191], v12, s[52:55], s31 offen offset:1024 sc1
    v_mfma_f32_16x16x32_bf16 v[20:23], v[52:55], v[192:195], v[20:23]
    ds_read_b64_tr_b16 v[80:81], v224 offset:0
    v_mfma_f32_16x16x32_bf16 v[24:27], v[56:59], v[192:195], v[24:27]
    ds_read_b64_tr_b16 v[82:83], v228 offset:0
    v_mfma_f32_16x16x32_bf16 v[28:31], v[60:63], v[192:195], v[28:31]
    ds_read_b64_tr_b16 v[84:85], v225 offset:0
    v_mfma_f32_16x16x32_bf16 v[32:35], v[48:51], v[196:199], v[32:35]
    ds_read_b64_tr_b16 v[86:87], v229 offset:0
    ds_read_b64_tr_b16 v[88:89], v226 offset:0
    v_mfma_f32_16x16x32_bf16 v[36:39], v[52:55], v[196:199], v[36:39]
    ds_read_b64_tr_b16 v[90:91], v230 offset:0
    v_mfma_f32_16x16x32_bf16 v[40:43], v[56:59], v[196:199], v[40:43]
    ds_read_b64_tr_b16 v[92:93], v227 offset:0
    v_mfma_f32_16x16x32_bf16 v[44:47], v[60:63], v[196:199], v[44:47]
    ds_read_b64_tr_b16 v[94:95], v231 offset:0
    s_waitcnt vmcnt(8) lgkmcnt(8)
    v_mfma_f32_16x16x32_bf16 v[16:19], v[64:67], v[200:203], v[16:19]
    buffer_load_dwordx4 v[192:195], v12, s[52:55], s29 offen offset:2048 sc1
    buffer_load_dwordx4 v[196:199], v12, s[52:55], s31 offen offset:2048 sc1
    v_mfma_f32_16x16x32_bf16 v[20:23], v[68:71], v[200:203], v[20:23]
    ds_read_b64_tr_b16 v[96:97], v224 offset:4096
    v_mfma_f32_16x16x32_bf16 v[24:27], v[72:75], v[200:203], v[24:27]
    ds_read_b64_tr_b16 v[98:99], v228 offset:4096
    v_mfma_f32_16x16x32_bf16 v[28:31], v[76:79], v[200:203], v[28:31]
    ds_read_b64_tr_b16 v[100:101], v225 offset:4096
    v_mfma_f32_16x16x32_bf16 v[32:35], v[64:67], v[204:207], v[32:35]
    ds_read_b64_tr_b16 v[102:103], v229 offset:4096
    ds_read_b64_tr_b16 v[104:105], v226 offset:4096
    v_mfma_f32_16x16x32_bf16 v[36:39], v[68:71], v[204:207], v[36:39]
    ds_read_b64_tr_b16 v[106:107], v230 offset:4096
    v_mfma_f32_16x16x32_bf16 v[40:43], v[72:75], v[204:207], v[40:43]
    ds_read_b64_tr_b16 v[108:109], v227 offset:4096
    v_mfma_f32_16x16x32_bf16 v[44:47], v[76:79], v[204:207], v[44:47]
    ds_read_b64_tr_b16 v[110:111], v231 offset:4096
    s_waitcnt vmcnt(8) lgkmcnt(8)
    v_mfma_f32_16x16x32_bf16 v[16:19], v[80:83], v[208:211], v[16:19]
    buffer_load_dwordx4 v[200:203], v12, s[52:55], s29 offen offset:3072 sc1
    buffer_load_dwordx4 v[204:207], v12, s[52:55], s31 offen offset:3072 sc1
    v_mfma_f32_16x16x32_bf16 v[20:23], v[84:87], v[208:211], v[20:23]
    ds_read_b64_tr_b16 v[112:113], v224 offset:55296
    v_mfma_f32_16x16x32_bf16 v[24:27], v[88:91], v[208:211], v[24:27]
    ds_read_b64_tr_b16 v[114:115], v228 offset:55296
    v_mfma_f32_16x16x32_bf16 v[28:31], v[92:95], v[208:211], v[28:31]
    ds_read_b64_tr_b16 v[116:117], v225 offset:55296
    v_mfma_f32_16x16x32_bf16 v[32:35], v[80:83], v[212:215], v[32:35]
    ds_read_b64_tr_b16 v[118:119], v229 offset:55296
    ds_read_b64_tr_b16 v[120:121], v226 offset:55296
    v_mfma_f32_16x16x32_bf16 v[36:39], v[84:87], v[212:215], v[36:39]
    ds_read_b64_tr_b16 v[122:123], v230 offset:55296
    v_mfma_f32_16x16x32_bf16 v[40:43], v[88:91], v[212:215], v[40:43]
    ds_read_b64_tr_b16 v[124:125], v227 offset:55296
    v_mfma_f32_16x16x32_bf16 v[44:47], v[92:95], v[212:215], v[44:47]
    ds_read_b64_tr_b16 v[126:127], v231 offset:55296
    s_waitcnt vmcnt(8) lgkmcnt(8)
    v_mfma_f32_16x16x32_bf16 v[16:19], v[96:99], v[216:219], v[16:19]
    s_add_u32 s29, s32, 16384
    s_and_b32 s29, s29, 0x7fff
    v_mfma_f32_16x16x32_bf16 v[20:23], v[100:103], v[216:219], v[20:23]
    s_add_u32 s29, s29, s28
    buffer_load_dwordx4 v[208:211], v12, s[52:55], s29 offen offset:0 sc1
    v_mfma_f32_16x16x32_bf16 v[24:27], v[104:107], v[216:219], v[24:27]
    s_add_u32 s31, s29, 32768
    buffer_load_dwordx4 v[212:215], v12, s[52:55], s31 offen offset:0 sc1
    v_mfma_f32_16x16x32_bf16 v[28:31], v[108:111], v[216:219], v[28:31]
    ds_read_b64_tr_b16 v[128:129], v224 offset:59392
    v_mfma_f32_16x16x32_bf16 v[32:35], v[96:99], v[220:223], v[32:35]
    ds_read_b64_tr_b16 v[130:131], v228 offset:59392
    ds_read_b64_tr_b16 v[132:133], v225 offset:59392
    v_mfma_f32_16x16x32_bf16 v[36:39], v[100:103], v[220:223], v[36:39]
    ds_read_b64_tr_b16 v[134:135], v229 offset:59392
    ds_read_b64_tr_b16 v[136:137], v226 offset:59392
    v_mfma_f32_16x16x32_bf16 v[40:43], v[104:107], v[220:223], v[40:43]
    ds_read_b64_tr_b16 v[138:139], v230 offset:59392
    ds_read_b64_tr_b16 v[140:141], v227 offset:59392
    v_mfma_f32_16x16x32_bf16 v[44:47], v[108:111], v[220:223], v[44:47]
    ds_read_b64_tr_b16 v[142:143], v231 offset:59392
    s_waitcnt vmcnt(8) lgkmcnt(8)
    v_mfma_f32_16x16x32_bf16 v[16:19], v[112:115], v[176:179], v[16:19]
    buffer_load_dwordx4 v[216:219], v12, s[52:55], s29 offen offset:1024 sc1
    buffer_load_dwordx4 v[220:223], v12, s[52:55], s31 offen offset:1024 sc1
    v_mfma_f32_16x16x32_bf16 v[20:23], v[116:119], v[176:179], v[20:23]
    ds_read_b64_tr_b16 v[144:145], v2 offset:0
    v_mfma_f32_16x16x32_bf16 v[24:27], v[120:123], v[176:179], v[24:27]
    ds_read_b64_tr_b16 v[146:147], v6 offset:0
    v_mfma_f32_16x16x32_bf16 v[28:31], v[124:127], v[176:179], v[28:31]
    ds_read_b64_tr_b16 v[148:149], v3 offset:0
    v_mfma_f32_16x16x32_bf16 v[32:35], v[112:115], v[180:183], v[32:35]
    ds_read_b64_tr_b16 v[150:151], v7 offset:0
    ds_read_b64_tr_b16 v[152:153], v4 offset:0
    v_mfma_f32_16x16x32_bf16 v[36:39], v[116:119], v[180:183], v[36:39]
    ds_read_b64_tr_b16 v[154:155], v8 offset:0
    v_mfma_f32_16x16x32_bf16 v[40:43], v[120:123], v[180:183], v[40:43]
    ds_read_b64_tr_b16 v[156:157], v5 offset:0
    v_mfma_f32_16x16x32_bf16 v[44:47], v[124:127], v[180:183], v[44:47]
    ds_read_b64_tr_b16 v[158:159], v9 offset:0
    s_waitcnt vmcnt(8) lgkmcnt(8)
    v_mfma_f32_16x16x32_bf16 v[16:19], v[128:131], v[184:187], v[16:19]
    buffer_load_dwordx4 v[176:179], v12, s[52:55], s29 offen offset:2048 sc1
    buffer_load_dwordx4 v[180:183], v12, s[52:55], s31 offen offset:2048 sc1
    v_mfma_f32_16x16x32_bf16 v[20:23], v[132:135], v[184:187], v[20:23]
    ds_read_b64_tr_b16 v[160:161], v2 offset:4096
    v_mfma_f32_16x16x32_bf16 v[24:27], v[136:139], v[184:187], v[24:27]
    ds_read_b64_tr_b16 v[162:163], v6 offset:4096
    v_mfma_f32_16x16x32_bf16 v[28:31], v[140:143], v[184:187], v[28:31]
    ds_read_b64_tr_b16 v[164:165], v3 offset:4096
    v_mfma_f32_16x16x32_bf16 v[32:35], v[128:131], v[188:191], v[32:35]
    ds_read_b64_tr_b16 v[166:167], v7 offset:4096
    ds_read_b64_tr_b16 v[168:169], v4 offset:4096
    v_mfma_f32_16x16x32_bf16 v[36:39], v[132:135], v[188:191], v[36:39]
    ds_read_b64_tr_b16 v[170:171], v8 offset:4096
    v_mfma_f32_16x16x32_bf16 v[40:43], v[136:139], v[188:191], v[40:43]
    ds_read_b64_tr_b16 v[172:173], v5 offset:4096
    v_mfma_f32_16x16x32_bf16 v[44:47], v[140:143], v[188:191], v[44:47]
    ds_read_b64_tr_b16 v[174:175], v9 offset:4096
    s_waitcnt vmcnt(8) lgkmcnt(8)
    v_mfma_f32_16x16x32_bf16 v[16:19], v[144:147], v[192:195], v[16:19]
    buffer_load_dwordx4 v[184:187], v12, s[52:55], s29 offen offset:3072 sc1
    buffer_load_dwordx4 v[188:191], v12, s[52:55], s31 offen offset:3072 sc1
    v_mfma_f32_16x16x32_bf16 v[20:23], v[148:151], v[192:195], v[20:23]
    ds_read_b64_tr_b16 v[48:49], v2 offset:24576
    v_mfma_f32_16x16x32_bf16 v[24:27], v[152:155], v[192:195], v[24:27]
    ds_read_b64_tr_b16 v[50:51], v6 offset:24576
    v_mfma_f32_16x16x32_bf16 v[28:31], v[156:159], v[192:195], v[28:31]
    ds_read_b64_tr_b16 v[52:53], v3 offset:24576
    v_mfma_f32_16x16x32_bf16 v[32:35], v[144:147], v[196:199], v[32:35]
    ds_read_b64_tr_b16 v[54:55], v7 offset:24576
    ds_read_b64_tr_b16 v[56:57], v4 offset:24576
    v_mfma_f32_16x16x32_bf16 v[36:39], v[148:151], v[196:199], v[36:39]
    ds_read_b64_tr_b16 v[58:59], v8 offset:24576
    v_mfma_f32_16x16x32_bf16 v[40:43], v[152:155], v[196:199], v[40:43]
    ds_read_b64_tr_b16 v[60:61], v5 offset:24576
    v_mfma_f32_16x16x32_bf16 v[44:47], v[156:159], v[196:199], v[44:47]
    ds_read_b64_tr_b16 v[62:63], v9 offset:24576
    s_waitcnt vmcnt(8) lgkmcnt(8)
    v_mfma_f32_16x16x32_bf16 v[16:19], v[160:163], v[200:203], v[16:19]
    s_add_u32 s29, s32, 20480
    s_and_b32 s29, s29, 0x7fff
    v_mfma_f32_16x16x32_bf16 v[20:23], v[164:167], v[200:203], v[20:23]
    s_add_u32 s29, s29, s28
    buffer_load_dwordx4 v[192:195], v12, s[52:55], s29 offen offset:0 sc1
    v_mfma_f32_16x16x32_bf16 v[24:27], v[168:171], v[200:203], v[24:27]
    s_add_u32 s31, s29, 32768
    buffer_load_dwordx4 v[196:199], v12, s[52:55], s31 offen offset:0 sc1
    v_mfma_f32_16x16x32_bf16 v[28:31], v[172:175], v[200:203], v[28:31]
    ds_read_b64_tr_b16 v[64:65], v2 offset:28672
    v_mfma_f32_16x16x32_bf16 v[32:35], v[160:163], v[204:207], v[32:35]
    ds_read_b64_tr_b16 v[66:67], v6 offset:28672
    ds_read_b64_tr_b16 v[68:69], v3 offset:28672
    v_mfma_f32_16x16x32_bf16 v[36:39], v[164:167], v[204:207], v[36:39]
    ds_read_b64_tr_b16 v[70:71], v7 offset:28672
    ds_read_b64_tr_b16 v[72:73], v4 offset:28672
    v_mfma_f32_16x16x32_bf16 v[40:43], v[168:171], v[204:207], v[40:43]
    ds_read_b64_tr_b16 v[74:75], v8 offset:28672
    ds_read_b64_tr_b16 v[76:77], v5 offset:28672
    v_mfma_f32_16x16x32_bf16 v[44:47], v[172:175], v[204:207], v[44:47]
    ds_read_b64_tr_b16 v[78:79], v9 offset:28672
    s_waitcnt vmcnt(8) lgkmcnt(8)
    v_mfma_f32_16x16x32_bf16 v[16:19], v[48:51], v[208:211], v[16:19]
    buffer_load_dwordx4 v[200:203], v12, s[52:55], s29 offen offset:1024 sc1
    buffer_load_dwordx4 v[204:207], v12, s[52:55], s31 offen offset:1024 sc1
    v_mfma_f32_16x16x32_bf16 v[20:23], v[52:55], v[208:211], v[20:23]
    ds_read_b64_tr_b16 v[80:81], v2 offset:49152
    v_mfma_f32_16x16x32_bf16 v[24:27], v[56:59], v[208:211], v[24:27]
    ds_read_b64_tr_b16 v[82:83], v6 offset:49152
    v_mfma_f32_16x16x32_bf16 v[28:31], v[60:63], v[208:211], v[28:31]
    ds_read_b64_tr_b16 v[84:85], v3 offset:49152
    v_mfma_f32_16x16x32_bf16 v[32:35], v[48:51], v[212:215], v[32:35]
    ds_read_b64_tr_b16 v[86:87], v7 offset:49152
    ds_read_b64_tr_b16 v[88:89], v4 offset:49152
    v_mfma_f32_16x16x32_bf16 v[36:39], v[52:55], v[212:215], v[36:39]
    ds_read_b64_tr_b16 v[90:91], v8 offset:49152
    v_mfma_f32_16x16x32_bf16 v[40:43], v[56:59], v[212:215], v[40:43]
    ds_read_b64_tr_b16 v[92:93], v5 offset:49152
    v_mfma_f32_16x16x32_bf16 v[44:47], v[60:63], v[212:215], v[44:47]
    ds_read_b64_tr_b16 v[94:95], v9 offset:49152
    s_waitcnt vmcnt(8) lgkmcnt(8)
    v_mfma_f32_16x16x32_bf16 v[16:19], v[64:67], v[216:219], v[16:19]
    buffer_load_dwordx4 v[208:211], v12, s[52:55], s29 offen offset:2048 sc1
    buffer_load_dwordx4 v[212:215], v12, s[52:55], s31 offen offset:2048 sc1
    v_mfma_f32_16x16x32_bf16 v[20:23], v[68:71], v[216:219], v[20:23]
    ds_read_b64_tr_b16 v[96:97], v2 offset:53248
    v_mfma_f32_16x16x32_bf16 v[24:27], v[72:75], v[216:219], v[24:27]
    ds_read_b64_tr_b16 v[98:99], v6 offset:53248
    v_mfma_f32_16x16x32_bf16 v[28:31], v[76:79], v[216:219], v[28:31]
    ds_read_b64_tr_b16 v[100:101], v3 offset:53248
    v_mfma_f32_16x16x32_bf16 v[32:35], v[64:67], v[220:223], v[32:35]
    ds_read_b64_tr_b16 v[102:103], v7 offset:53248
    ds_read_b64_tr_b16 v[104:105], v4 offset:53248
    v_mfma_f32_16x16x32_bf16 v[36:39], v[68:71], v[220:223], v[36:39]
    ds_read_b64_tr_b16 v[106:107], v8 offset:53248
    v_mfma_f32_16x16x32_bf16 v[40:43], v[72:75], v[220:223], v[40:43]
    ds_read_b64_tr_b16 v[108:109], v5 offset:53248
    v_mfma_f32_16x16x32_bf16 v[44:47], v[76:79], v[220:223], v[44:47]
    ds_read_b64_tr_b16 v[110:111], v9 offset:53248
    s_waitcnt vmcnt(8) lgkmcnt(8)
    v_mfma_f32_16x16x32_bf16 v[16:19], v[80:83], v[176:179], v[16:19]
    buffer_load_dwordx4 v[216:219], v12, s[52:55], s29 offen offset:3072 sc1
    buffer_load_dwordx4 v[220:223], v12, s[52:55], s31 offen offset:3072 sc1
    v_mfma_f32_16x16x32_bf16 v[20:23], v[84:87], v[176:179], v[20:23]
    ds_read_b64_tr_b16 v[112:113], v224 offset:8192
    v_mfma_f32_16x16x32_bf16 v[24:27], v[88:91], v[176:179], v[24:27]
    ds_read_b64_tr_b16 v[114:115], v228 offset:8192
    v_mfma_f32_16x16x32_bf16 v[28:31], v[92:95], v[176:179], v[28:31]
    ds_read_b64_tr_b16 v[116:117], v225 offset:8192
    v_mfma_f32_16x16x32_bf16 v[32:35], v[80:83], v[180:183], v[32:35]
    ds_read_b64_tr_b16 v[118:119], v229 offset:8192
    ds_read_b64_tr_b16 v[120:121], v226 offset:8192
    v_mfma_f32_16x16x32_bf16 v[36:39], v[84:87], v[180:183], v[36:39]
    ds_read_b64_tr_b16 v[122:123], v230 offset:8192
    v_mfma_f32_16x16x32_bf16 v[40:43], v[88:91], v[180:183], v[40:43]
    ds_read_b64_tr_b16 v[124:125], v227 offset:8192
    v_mfma_f32_16x16x32_bf16 v[44:47], v[92:95], v[180:183], v[44:47]
    ds_read_b64_tr_b16 v[126:127], v231 offset:8192
    s_waitcnt vmcnt(8) lgkmcnt(8)
    v_mfma_f32_16x16x32_bf16 v[16:19], v[96:99], v[184:187], v[16:19]
    s_add_u32 s29, s32, 24576
    s_and_b32 s29, s29, 0x7fff
    v_mfma_f32_16x16x32_bf16 v[20:23], v[100:103], v[184:187], v[20:23]
    s_add_u32 s29, s29, s28
    buffer_load_dwordx4 v[176:179], v12, s[52:55], s29 offen offset:0 sc1
    v_mfma_f32_16x16x32_bf16 v[24:27], v[104:107], v[184:187], v[24:27]
    s_add_u32 s31, s29, 32768
    buffer_load_dwordx4 v[180:183], v12, s[52:55], s31 offen offset:0 sc1
    v_mfma_f32_16x16x32_bf16 v[28:31], v[108:111], v[184:187], v[28:31]
    ds_read_b64_tr_b16 v[128:129], v224 offset:12288
    v_mfma_f32_16x16x32_bf16 v[32:35], v[96:99], v[188:191], v[32:35]
    ds_read_b64_tr_b16 v[130:131], v228 offset:12288
    ds_read_b64_tr_b16 v[132:133], v225 offset:12288
    v_mfma_f32_16x16x32_bf16 v[36:39], v[100:103], v[188:191], v[36:39]
    ds_read_b64_tr_b16 v[134:135], v229 offset:12288
    ds_read_b64_tr_b16 v[136:137], v226 offset:12288
    v_mfma_f32_16x16x32_bf16 v[40:43], v[104:107], v[188:191], v[40:43]
    ds_read_b64_tr_b16 v[138:139], v230 offset:12288
    ds_read_b64_tr_b16 v[140:141], v227 offset:12288
    v_mfma_f32_16x16x32_bf16 v[44:47], v[108:111], v[188:191], v[44:47]
    ds_read_b64_tr_b16 v[142:143], v231 offset:12288
    s_waitcnt vmcnt(8) lgkmcnt(8)
    s_mov_b64 exec, 1
    ds_add_u32 v10, v11 offset:28
    s_mov_b64 exec, -1
    v_mfma_f32_16x16x32_bf16 v[16:19], v[112:115], v[192:195], v[16:19]
    buffer_load_dwordx4 v[184:187], v12, s[52:55], s29 offen offset:1024 sc1
    buffer_load_dwordx4 v[188:191], v12, s[52:55], s31 offen offset:1024 sc1
    v_mfma_f32_16x16x32_bf16 v[20:23], v[116:119], v[192:195], v[20:23]
    ds_read_b64_tr_b16 v[144:145], v224 offset:16384
    v_mfma_f32_16x16x32_bf16 v[24:27], v[120:123], v[192:195], v[24:27]
    ds_read_b64_tr_b16 v[146:147], v228 offset:16384
    v_mfma_f32_16x16x32_bf16 v[28:31], v[124:127], v[192:195], v[28:31]
    ds_read_b64_tr_b16 v[148:149], v225 offset:16384
    v_mfma_f32_16x16x32_bf16 v[32:35], v[112:115], v[196:199], v[32:35]
    ds_read_b64_tr_b16 v[150:151], v229 offset:16384
    ds_read_b64_tr_b16 v[152:153], v226 offset:16384
    v_mfma_f32_16x16x32_bf16 v[36:39], v[116:119], v[196:199], v[36:39]
    ds_read_b64_tr_b16 v[154:155], v230 offset:16384
    v_mfma_f32_16x16x32_bf16 v[40:43], v[120:123], v[196:199], v[40:43]
    ds_read_b64_tr_b16 v[156:157], v227 offset:16384
    v_mfma_f32_16x16x32_bf16 v[44:47], v[124:127], v[196:199], v[44:47]
    ds_read_b64_tr_b16 v[158:159], v231 offset:16384
    s_waitcnt vmcnt(8) lgkmcnt(9)
    v_mfma_f32_16x16x32_bf16 v[16:19], v[128:131], v[200:203], v[16:19]
    buffer_load_dwordx4 v[192:195], v12, s[52:55], s29 offen offset:2048 sc1
    buffer_load_dwordx4 v[196:199], v12, s[52:55], s31 offen offset:2048 sc1
    v_mfma_f32_16x16x32_bf16 v[20:23], v[132:135], v[200:203], v[20:23]
    ds_read_b64_tr_b16 v[160:161], v224 offset:20480
    v_mfma_f32_16x16x32_bf16 v[24:27], v[136:139], v[200:203], v[24:27]
    ds_read_b64_tr_b16 v[162:163], v228 offset:20480
    v_mfma_f32_16x16x32_bf16 v[28:31], v[140:143], v[200:203], v[28:31]
    ds_read_b64_tr_b16 v[164:165], v225 offset:20480
    v_mfma_f32_16x16x32_bf16 v[32:35], v[128:131], v[204:207], v[32:35]
    ds_read_b64_tr_b16 v[166:167], v229 offset:20480
    ds_read_b64_tr_b16 v[168:169], v226 offset:20480
    v_mfma_f32_16x16x32_bf16 v[36:39], v[132:135], v[204:207], v[36:39]
    ds_read_b64_tr_b16 v[170:171], v230 offset:20480
    v_mfma_f32_16x16x32_bf16 v[40:43], v[136:139], v[204:207], v[40:43]
    ds_read_b64_tr_b16 v[172:173], v227 offset:20480
    v_mfma_f32_16x16x32_bf16 v[44:47], v[140:143], v[204:207], v[44:47]
    ds_read_b64_tr_b16 v[174:175], v231 offset:20480
    s_waitcnt vmcnt(8) lgkmcnt(8)
    v_mfma_f32_16x16x32_bf16 v[16:19], v[144:147], v[208:211], v[16:19]
    buffer_load_dwordx4 v[200:203], v12, s[52:55], s29 offen offset:3072 sc1
    buffer_load_dwordx4 v[204:207], v12, s[52:55], s31 offen offset:3072 sc1
    v_mfma_f32_16x16x32_bf16 v[20:23], v[148:151], v[208:211], v[20:23]
    ds_read_b64_tr_b16 v[48:49], v2 offset:8192
    v_mfma_f32_16x16x32_bf16 v[24:27], v[152:155], v[208:211], v[24:27]
    ds_read_b64_tr_b16 v[50:51], v6 offset:8192
    v_mfma_f32_16x16x32_bf16 v[28:31], v[156:159], v[208:211], v[28:31]
    ds_read_b64_tr_b16 v[52:53], v3 offset:8192
    v_mfma_f32_16x16x32_bf16 v[32:35], v[144:147], v[212:215], v[32:35]
    ds_read_b64_tr_b16 v[54:55], v7 offset:8192
    ds_read_b64_tr_b16 v[56:57], v4 offset:8192
    v_mfma_f32_16x16x32_bf16 v[36:39], v[148:151], v[212:215], v[36:39]
    ds_read_b64_tr_b16 v[58:59], v8 offset:8192
    v_mfma_f32_16x16x32_bf16 v[40:43], v[152:155], v[212:215], v[40:43]
    ds_read_b64_tr_b16 v[60:61], v5 offset:8192
    v_mfma_f32_16x16x32_bf16 v[44:47], v[156:159], v[212:215], v[44:47]
    ds_read_b64_tr_b16 v[62:63], v9 offset:8192
    s_waitcnt vmcnt(8) lgkmcnt(8)
    v_mfma_f32_16x16x32_bf16 v[16:19], v[160:163], v[216:219], v[16:19]
    s_add_u32 s29, s32, 28672
    s_and_b32 s29, s29, 0x7fff
    v_mfma_f32_16x16x32_bf16 v[20:23], v[164:167], v[216:219], v[20:23]
    s_add_u32 s29, s29, s28
    buffer_load_dwordx4 v[208:211], v12, s[52:55], s29 offen offset:0 sc1
    v_mfma_f32_16x16x32_bf16 v[24:27], v[168:171], v[216:219], v[24:27]
    s_add_u32 s31, s29, 32768
    buffer_load_dwordx4 v[212:215], v12, s[52:55], s31 offen offset:0 sc1
    v_mfma_f32_16x16x32_bf16 v[28:31], v[172:175], v[216:219], v[28:31]
    ds_read_b64_tr_b16 v[64:65], v2 offset:12288
    v_mfma_f32_16x16x32_bf16 v[32:35], v[160:163], v[220:223], v[32:35]
    ds_read_b64_tr_b16 v[66:67], v6 offset:12288
    ds_read_b64_tr_b16 v[68:69], v3 offset:12288
    v_mfma_f32_16x16x32_bf16 v[36:39], v[164:167], v[220:223], v[36:39]
    ds_read_b64_tr_b16 v[70:71], v7 offset:12288
    ds_read_b64_tr_b16 v[72:73], v4 offset:12288
    v_mfma_f32_16x16x32_bf16 v[40:43], v[168:171], v[220:223], v[40:43]
    ds_read_b64_tr_b16 v[74:75], v8 offset:12288
    ds_read_b64_tr_b16 v[76:77], v5 offset:12288
    v_mfma_f32_16x16x32_bf16 v[44:47], v[172:175], v[220:223], v[44:47]
    ds_read_b64_tr_b16 v[78:79], v9 offset:12288
    s_waitcnt vmcnt(8) lgkmcnt(8)
    v_mfma_f32_16x16x32_bf16 v[16:19], v[48:51], v[176:179], v[16:19]
    buffer_load_dwordx4 v[216:219], v12, s[52:55], s29 offen offset:1024 sc1
    buffer_load_dwordx4 v[220:223], v12, s[52:55], s31 offen offset:1024 sc1
    v_mfma_f32_16x16x32_bf16 v[20:23], v[52:55], v[176:179], v[20:23]
    ds_read_b64_tr_b16 v[80:81], v2 offset:32768
    v_mfma_f32_16x16x32_bf16 v[24:27], v[56:59], v[176:179], v[24:27]
    ds_read_b64_tr_b16 v[82:83], v6 offset:32768
    v_mfma_f32_16x16x32_bf16 v[28:31], v[60:63], v[176:179], v[28:31]
    ds_read_b64_tr_b16 v[84:85], v3 offset:32768
    v_mfma_f32_16x16x32_bf16 v[32:35], v[48:51], v[180:183], v[32:35]
    ds_read_b64_tr_b16 v[86:87], v7 offset:32768
    ds_read_b64_tr_b16 v[88:89], v4 offset:32768
    v_mfma_f32_16x16x32_bf16 v[36:39], v[52:55], v[180:183], v[36:39]
    ds_read_b64_tr_b16 v[90:91], v8 offset:32768
    v_mfma_f32_16x16x32_bf16 v[40:43], v[56:59], v[180:183], v[40:43]
    ds_read_b64_tr_b16 v[92:93], v5 offset:32768
    v_mfma_f32_16x16x32_bf16 v[44:47], v[60:63], v[180:183], v[44:47]
    ds_read_b64_tr_b16 v[94:95], v9 offset:32768
    s_waitcnt vmcnt(8) lgkmcnt(8)
    v_mfma_f32_16x16x32_bf16 v[16:19], v[64:67], v[184:187], v[16:19]
    buffer_load_dwordx4 v[176:179], v12, s[52:55], s29 offen offset:2048 sc1
    buffer_load_dwordx4 v[180:183], v12, s[52:55], s31 offen offset:2048 sc1
    v_mfma_f32_16x16x32_bf16 v[20:23], v[68:71], v[184:187], v[20:23]
    ds_read_b64_tr_b16 v[96:97], v2 offset:36864
    v_mfma_f32_16x16x32_bf16 v[24:27], v[72:75], v[184:187], v[24:27]
    ds_read_b64_tr_b16 v[98:99], v6 offset:36864
    v_mfma_f32_16x16x32_bf16 v[28:31], v[76:79], v[184:187], v[28:31]
    ds_read_b64_tr_b16 v[100:101], v3 offset:36864
    v_mfma_f32_16x16x32_bf16 v[32:35], v[64:67], v[188:191], v[32:35]
    ds_read_b64_tr_b16 v[102:103], v7 offset:36864
    ds_read_b64_tr_b16 v[104:105], v4 offset:36864
    v_mfma_f32_16x16x32_bf16 v[36:39], v[68:71], v[188:191], v[36:39]
    ds_read_b64_tr_b16 v[106:107], v8 offset:36864
    v_mfma_f32_16x16x32_bf16 v[40:43], v[72:75], v[188:191], v[40:43]
    ds_read_b64_tr_b16 v[108:109], v5 offset:36864
    v_mfma_f32_16x16x32_bf16 v[44:47], v[76:79], v[188:191], v[44:47]
    ds_read_b64_tr_b16 v[110:111], v9 offset:36864
    s_waitcnt vmcnt(8) lgkmcnt(8)
    v_mfma_f32_16x16x32_bf16 v[16:19], v[80:83], v[192:195], v[16:19]
    buffer_load_dwordx4 v[184:187], v12, s[52:55], s29 offen offset:3072 sc1
    buffer_load_dwordx4 v[188:191], v12, s[52:55], s31 offen offset:3072 sc1
    v_mfma_f32_16x16x32_bf16 v[20:23], v[84:87], v[192:195], v[20:23]
    ds_read_b64_tr_b16 v[112:113], v2 offset:57344
    v_mfma_f32_16x16x32_bf16 v[24:27], v[88:91], v[192:195], v[24:27]
    ds_read_b64_tr_b16 v[114:115], v6 offset:57344
    v_mfma_f32_16x16x32_bf16 v[28:31], v[92:95], v[192:195], v[28:31]
    ds_read_b64_tr_b16 v[116:117], v3 offset:57344
    v_mfma_f32_16x16x32_bf16 v[32:35], v[80:83], v[196:199], v[32:35]
    ds_read_b64_tr_b16 v[118:119], v7 offset:57344
    ds_read_b64_tr_b16 v[120:121], v4 offset:57344
    v_mfma_f32_16x16x32_bf16 v[36:39], v[84:87], v[196:199], v[36:39]
    ds_read_b64_tr_b16 v[122:123], v8 offset:57344
    v_mfma_f32_16x16x32_bf16 v[40:43], v[88:91], v[196:199], v[40:43]
    ds_read_b64_tr_b16 v[124:125], v5 offset:57344
    v_mfma_f32_16x16x32_bf16 v[44:47], v[92:95], v[196:199], v[44:47]
    ds_read_b64_tr_b16 v[126:127], v9 offset:57344
    s_waitcnt vmcnt(8) lgkmcnt(8)
    v_mfma_f32_16x16x32_bf16 v[16:19], v[96:99], v[200:203], v[16:19]
    ds_read_b64_tr_b16 v[128:129], v2 offset:61440
    v_mfma_f32_16x16x32_bf16 v[20:23], v[100:103], v[200:203], v[20:23]
    ds_read_b64_tr_b16 v[130:131], v6 offset:61440
    v_mfma_f32_16x16x32_bf16 v[24:27], v[104:107], v[200:203], v[24:27]
    ds_read_b64_tr_b16 v[132:133], v3 offset:61440
    v_mfma_f32_16x16x32_bf16 v[28:31], v[108:111], v[200:203], v[28:31]
    ds_read_b64_tr_b16 v[134:135], v7 offset:61440
    v_mfma_f32_16x16x32_bf16 v[32:35], v[96:99], v[204:207], v[32:35]
    ds_read_b64_tr_b16 v[136:137], v4 offset:61440
    v_mfma_f32_16x16x32_bf16 v[36:39], v[100:103], v[204:207], v[36:39]
    ds_read_b64_tr_b16 v[138:139], v8 offset:61440
    v_mfma_f32_16x16x32_bf16 v[40:43], v[104:107], v[204:207], v[40:43]
    ds_read_b64_tr_b16 v[140:141], v5 offset:61440
    v_mfma_f32_16x16x32_bf16 v[44:47], v[108:111], v[204:207], v[44:47]
    ds_read_b64_tr_b16 v[142:143], v9 offset:61440
    s_waitcnt vmcnt(6) lgkmcnt(8)
    v_mfma_f32_16x16x32_bf16 v[16:19], v[112:115], v[208:211], v[16:19]
    ds_read_b64_tr_b16 v[144:145], v2 offset:16384
    v_mfma_f32_16x16x32_bf16 v[20:23], v[116:119], v[208:211], v[20:23]
    ds_read_b64_tr_b16 v[146:147], v6 offset:16384
    v_mfma_f32_16x16x32_bf16 v[24:27], v[120:123], v[208:211], v[24:27]
    ds_read_b64_tr_b16 v[148:149], v3 offset:16384
    v_mfma_f32_16x16x32_bf16 v[28:31], v[124:127], v[208:211], v[28:31]
    ds_read_b64_tr_b16 v[150:151], v7 offset:16384
    v_mfma_f32_16x16x32_bf16 v[32:35], v[112:115], v[212:215], v[32:35]
    ds_read_b64_tr_b16 v[152:153], v4 offset:16384
    v_mfma_f32_16x16x32_bf16 v[36:39], v[116:119], v[212:215], v[36:39]
    ds_read_b64_tr_b16 v[154:155], v8 offset:16384
    v_mfma_f32_16x16x32_bf16 v[40:43], v[120:123], v[212:215], v[40:43]
    ds_read_b64_tr_b16 v[156:157], v5 offset:16384
    v_mfma_f32_16x16x32_bf16 v[44:47], v[124:127], v[212:215], v[44:47]
    ds_read_b64_tr_b16 v[158:159], v9 offset:16384
    s_waitcnt vmcnt(4) lgkmcnt(8)
    v_mfma_f32_16x16x32_bf16 v[16:19], v[128:131], v[216:219], v[16:19]
    ds_read_b64_tr_b16 v[160:161], v2 offset:20480
    v_mfma_f32_16x16x32_bf16 v[20:23], v[132:135], v[216:219], v[20:23]
    ds_read_b64_tr_b16 v[162:163], v6 offset:20480
    v_mfma_f32_16x16x32_bf16 v[24:27], v[136:139], v[216:219], v[24:27]
    ds_read_b64_tr_b16 v[164:165], v3 offset:20480
    v_mfma_f32_16x16x32_bf16 v[28:31], v[140:143], v[216:219], v[28:31]
    ds_read_b64_tr_b16 v[166:167], v7 offset:20480
    v_mfma_f32_16x16x32_bf16 v[32:35], v[128:131], v[220:223], v[32:35]
    ds_read_b64_tr_b16 v[168:169], v4 offset:20480
    v_mfma_f32_16x16x32_bf16 v[36:39], v[132:135], v[220:223], v[36:39]
    ds_read_b64_tr_b16 v[170:171], v8 offset:20480
    v_mfma_f32_16x16x32_bf16 v[40:43], v[136:139], v[220:223], v[40:43]
    ds_read_b64_tr_b16 v[172:173], v5 offset:20480
    v_mfma_f32_16x16x32_bf16 v[44:47], v[140:143], v[220:223], v[44:47]
    ds_read_b64_tr_b16 v[174:175], v9 offset:20480
    s_waitcnt vmcnt(2) lgkmcnt(8)
    v_mfma_f32_16x16x32_bf16 v[16:19], v[144:147], v[176:179], v[16:19]
    v_mfma_f32_16x16x32_bf16 v[20:23], v[148:151], v[176:179], v[20:23]
    v_mfma_f32_16x16x32_bf16 v[24:27], v[152:155], v[176:179], v[24:27]
    v_mfma_f32_16x16x32_bf16 v[28:31], v[156:159], v[176:179], v[28:31]
    v_mfma_f32_16x16x32_bf16 v[32:35], v[144:147], v[180:183], v[32:35]
    v_mfma_f32_16x16x32_bf16 v[36:39], v[148:151], v[180:183], v[36:39]
    v_mfma_f32_16x16x32_bf16 v[40:43], v[152:155], v[180:183], v[40:43]
    v_mfma_f32_16x16x32_bf16 v[44:47], v[156:159], v[180:183], v[44:47]
    s_waitcnt vmcnt(0) lgkmcnt(0)
    v_mfma_f32_16x16x32_bf16 v[16:19], v[160:163], v[184:187], v[16:19]
    v_mfma_f32_16x16x32_bf16 v[20:23], v[164:167], v[184:187], v[20:23]
    v_mfma_f32_16x16x32_bf16 v[24:27], v[168:171], v[184:187], v[24:27]
    v_mfma_f32_16x16x32_bf16 v[28:31], v[172:175], v[184:187], v[28:31]
    v_mfma_f32_16x16x32_bf16 v[32:35], v[160:163], v[188:191], v[32:35]
    v_mfma_f32_16x16x32_bf16 v[36:39], v[164:167], v[188:191], v[36:39]
    v_mfma_f32_16x16x32_bf16 v[40:43], v[168:171], v[188:191], v[40:43]
    v_mfma_f32_16x16x32_bf16 v[44:47], v[172:175], v[188:191], v[44:47]
    s_nop 0
    v_cvt_pk_bf16_f32 v48, v16, v17
    v_cvt_pk_bf16_f32 v49, v18, v19
    v_cvt_pk_bf16_f32 v50, v20, v21
    v_cvt_pk_bf16_f32 v51, v22, v23
    s_nop 0
    v_permlane16_swap_b32 v48, v50
    v_permlane16_swap_b32 v49, v51
    s_mov_b32 s95, 0
    buffer_store_dwordx4 v[48:51], v246, s[60:63], s95 offen offset:0 nt
    v_cvt_pk_bf16_f32 v52, v24, v25
    v_cvt_pk_bf16_f32 v53, v26, v27
    v_cvt_pk_bf16_f32 v54, v28, v29
    v_cvt_pk_bf16_f32 v55, v30, v31
    s_nop 0
    v_permlane16_swap_b32 v52, v54
    v_permlane16_swap_b32 v53, v55
    s_mov_b32 s95, 0
    buffer_store_dwordx4 v[52:55], v246, s[60:63], s95 offen offset:64 nt
    v_cvt_pk_bf16_f32 v56, v32, v33
    v_cvt_pk_bf16_f32 v57, v34, v35
    v_cvt_pk_bf16_f32 v58, v36, v37
    v_cvt_pk_bf16_f32 v59, v38, v39
    s_nop 0
    v_permlane16_swap_b32 v56, v58
    v_permlane16_swap_b32 v57, v59
    s_mov_b32 s95, 65536
    buffer_store_dwordx4 v[56:59], v246, s[60:63], s95 offen offset:0 nt
    v_cvt_pk_bf16_f32 v60, v40, v41
    v_cvt_pk_bf16_f32 v61, v42, v43
    v_cvt_pk_bf16_f32 v62, v44, v45
    v_cvt_pk_bf16_f32 v63, v46, v47
    s_nop 0
    v_permlane16_swap_b32 v60, v62
    v_permlane16_swap_b32 v61, v63
    s_mov_b32 s95, 65536
    buffer_store_dwordx4 v[60:63], v246, s[60:63], s95 offen offset:64 nt
    s_endpgm
LA_slow:
    s_mov_b32 s79, 0
    s_mov_b64 vcc, s[82:83]
LA_slow1:
    s_mov_b64 exec, vcc
    buffer_load_dword v136, v33, s[68:71], 0 offen sc1
    buffer_load_dword v137, v34, s[52:55], 0 offen sc1
    s_add_u32 s79, s79, 1
    s_cmp_gt_u32 s79, 200000
    s_waitcnt vmcnt(0)
    s_cbranch_scc1 LA_slow2
    v_cmp_ne_u32 vcc, v136, v137
    v_cmp_gt_u32 s[80:81], s96, v136
    s_nop 0
    s_or_b64 vcc, vcc, s[80:81]
    s_cbranch_vccz LA_slow2
    s_sleep 8
    s_branch LA_slow1
LA_slow2:
    s_mov_b64 exec, -1
    s_add_u32 m0, s86, 94208
    s_add_u32 s89, s91, 0
    buffer_load_dwordx4 v14, s[52:55], s89 offen sc1 lds
    s_add_u32 m0, s86, 98304
    s_add_u32 s89, s91, 4096
    buffer_load_dwordx4 v14, s[52:55], s89 offen sc1 lds
    s_add_u32 m0, s86, 102400
    s_add_u32 s89, s91, 8192
    buffer_load_dwordx4 v14, s[52:55], s89 offen sc1 lds
    s_add_u32 m0, s86, 106496
    s_add_u32 s89, s91, 12288
    buffer_load_dwordx4 v14, s[52:55], s89 offen sc1 lds
    s_branch LA_back
LB_slow:
    s_mov_b32 s79, 0
LB_pt:
    buffer_load_dword v222, v220, s[68:71], s98 offen sc1
    s_add_u32 s79, s79, 1
    s_cmp_gt_u32 s79, 200000
    s_cbranch_scc1 LB_pt_x
    s_waitcnt vmcnt(0)
    v_cmp_gt_u32 vcc, 4096, v222
    s_cbranch_vccz LB_pt_x
    s_mov_b64 exec, vcc
    s_sleep 8
    s_branch LB_pt
LB_pt_x:
    s_waitcnt vmcnt(0)
    s_branch LB_back
L_end:
    s_endpgm
.section .rodata,"a"
.p2align 6
.amdhsa_kernel concat_heads__ssm_conv_h3__sliding_local_dilated__prompt_kernel
  .amdhsa_next_free_vgpr 256
  .amdhsa_next_free_sgpr 102
  .amdhsa_accum_offset 256
  .amdhsa_group_segment_fixed_size 0
  .amdhsa_kernarg_size 96
  .amdhsa_user_sgpr_count 2
  .amdhsa_user_sgpr_kernarg_segment_ptr 1
  .amdhsa_system_sgpr_workgroup_id_x 1
.end_amdhsa_kernel
```

```asm
; @launch grid=(256,1,1) block=(512,1,1) lds=163840
.amdgcn_target "amdgcn-amd-amdhsa--gfx950"
.text
.globl concat_heads__ssm_conv_h3__sliding_local_dilated__prompt_kernel
.p2align 8
.type concat_heads__ssm_conv_h3__sliding_local_dilated__prompt_kernel,@function
concat_heads__ssm_conv_h3__sliding_local_dilated__prompt_kernel:
    s_cmp_ge_u32 s2, 256
    s_cbranch_scc1 L_end
    s_load_dwordx4 s[16:19], s[0:1], 48
    s_load_dwordx8 s[4:11], s[0:1], 0
    s_load_dwordx4 s[12:15], s[0:1], 32
    s_load_dwordx8 s[20:27], s[0:1], 64
    v_lshrrev_b32 v1, 6, v0
    v_and_b32 v0, 63, v0
    v_readfirstlane_b32 s3, v1
    s_and_b32 s78, s2, 7
    s_lshr_b32 s79, s2, 3
    s_and_b32 s80, s78, 1
    s_lshl_b32 s80, s80, 3
    s_lshr_b32 s81, s78, 1
    s_lshl_b32 s81, s81, 2
    s_and_b32 s72, s79, 7
    s_add_u32 s72, s72, s80
    s_lshr_b32 s73, s79, 3
    s_add_u32 s73, s73, s81
    s_and_b32 s76, s79, 3
    s_add_u32 s76, s76, s81
    s_lshr_b32 s77, s79, 2
    s_add_u32 s77, s77, s80
    s_lshr_b32 s74, s79, 4
    s_xor_b32 s78, s78, 2
    s_lshl_b32 s78, s78, 1
    s_add_u32 s74, s74, s78
    s_and_b32 s75, s79, 15
    s_cmp_ge_u32 s3, 4
    s_cbranch_scc1 L_B
    v_lshrrev_b32 v5, 3, v0
    v_and_b32 v6, 7, v0
    v_lshrrev_b32 v7, 4, v0
    s_and_b32 s78, s3, 1
    s_lshl_b32 s78, s78, 2
    s_lshl_b32 s79, s72, 7
    s_lshl_b32 s80, s3, 3
    s_add_u32 s81, s79, s80
    v_add_u32 v8, s78, v7
    v_xor_b32 v8, v8, v6
    v_lshlrev_b32 v8, 4, v8
    v_add_u32 v2, s81, v5
    v_lshl_add_u32 v2, v2, 11, v8
    v_and_b32 v8, 1, v7
    v_lshl_or_b32 v8, v8, 1, s78
    v_xor_b32 v8, v8, v6
    v_lshlrev_b32 v8, 4, v8
    v_add_u32 v4, s80, v5
    v_mul_u32_u24 v4, 6144, v4
    s_lshl_b32 s82, s73, 7
    v_add3_u32 v4, v4, v8, s82
    s_lshl_b32 s78, s3, 1
    s_lshl_b32 s80, s3, 2
    s_add_u32 s79, s79, s80
    s_sub_u32 s79, s79, 16
    v_add_u32 v8, s78, v7
    v_xor_b32 v8, v8, v6
    v_and_b32 v8, 7, v8
    v_lshlrev_b32 v8, 4, v8
    v_add_u32 v3, s79, v5
    v_lshl_add_u32 v3, v3, 11, v8
    s_lshl_b32 s86, s3, 10
    s_add_u32 s87, s86, 75776
    s_lshl_b32 s88, s3, 9
    s_add_u32 s88, s88, 73728
    s_and_b32 s98, s73, 0
    s_and_b32 s78, s72, 8
    s_add_u32 s98, s98, s78
    s_add_u32 s101, s72, s73
    s_and_b32 s101, s101, 3
    s_mov_b32 s82, 0x65832140
    s_mov_b32 s83, 0xfedba9c7
    s_cmp_eq_u32 s101, 1
    s_cselect_b32 s82, 0x69432501, s82
    s_cselect_b32 s83, 0xfecbad87, s83
    s_cmp_eq_u32 s101, 2
    s_cselect_b32 s82, 0xa5436102, s82
    s_cselect_b32 s83, 0xfdcbe987, s83
    s_cmp_eq_u32 s101, 3
    s_cselect_b32 s82, 0x65472103, s82
    s_cselect_b32 s83, 0xedcfa98b, s83
    s_waitcnt lgkmcnt(0)
    s_mov_b64 s[0:1], s[82:83]
    s_mov_b32 s28, s16
    s_mov_b32 s29, s17
    s_mov_b32 s30, 0x400000
    s_mov_b32 s31, 0x20000
    s_mov_b32 s32, s18
    s_mov_b32 s33, s19
    s_mov_b32 s34, 0x600000
    s_mov_b32 s35, 0x20000
    s_bfe_u32 s18, s72, 0x10002
    s_lshl_b32 s16, s18, 12
    s_xor_b32 s17, s16, 4096
    s_add_u32 s16, s16, s86
    s_add_u32 s17, s17, s86
    s_mul_i32 s18, s18, 196608
    s_add_u32 s97, s98, s0
    s_lshr_b64 s[0:1], s[0:1], 4
    s_and_b32 s97, s97, 15
    s_lshr_b32 s99, s97, 3
    s_xor_b32 s97, s97, s99
    s_lshl_b32 s97, s97, 7
    s_add_u32 m0, s87, 0
    s_add_u32 s89, s97, 0
    buffer_load_dwordx4 v2, s[28:31], s89 offen  lds
    s_mul_i32 s99, s97, 3072
    s_sub_u32 s19, s99, s18
    s_add_u32 s99, s99, s18
    s_add_u32 m0, s16, 0
    s_add_u32 s89, s99, 0
    buffer_load_dwordx4 v4, s[32:35], s89 offen  lds
    s_add_u32 m0, s87, 4096
    s_add_u32 s89, s97, 65536
    buffer_load_dwordx4 v2, s[28:31], s89 offen  lds
    s_add_u32 m0, s16, 24576
    s_add_u32 s89, s99, 2048
    buffer_load_dwordx4 v4, s[32:35], s89 offen  lds
    s_add_u32 m0, s87, 8192
    s_add_u32 s89, s97, 131072
    buffer_load_dwordx4 v2, s[28:31], s89 offen  lds
    s_add_u32 m0, s16, 49152
    s_add_u32 s89, s99, 4096
    buffer_load_dwordx4 v4, s[32:35], s89 offen  lds
    s_add_u32 m0, s87, 12288
    s_add_u32 s89, s97, 196608
    buffer_load_dwordx4 v2, s[28:31], s89 offen  lds
    s_mov_b64 exec, 0xffffffff
    s_add_u32 m0, s88, 0
    s_add_u32 s89, s97, 0
    buffer_load_dwordx4 v3, s[28:31], s89 offen  lds
    s_mov_b64 exec, -1
    s_add_u32 m0, s17, 0
    s_add_u32 s89, s19, 196608
    buffer_load_dwordx4 v4, s[32:35], s89 offen  lds
    s_mov_b32 s36, s6
    s_mov_b32 s37, s7
    s_mov_b32 s38, 0x400000
    s_mov_b32 s39, 0x20000
    s_mov_b32 s40, s8
    s_mov_b32 s41, s9
    s_mov_b32 s42, 0x400000
    s_mov_b32 s43, 0x20000
    s_mov_b32 s44, s10
    s_mov_b32 s45, s11
    s_mov_b32 s46, 0x2000
    s_mov_b32 s47, 0x20000
    s_mov_b32 s48, s12
    s_mov_b32 s49, s13
    s_mov_b32 s50, 0x400000
    s_mov_b32 s51, 0x20000
    s_mov_b32 s52, s26
    s_mov_b32 s53, s27
    s_mov_b32 s54, 0x1000000
    s_mov_b32 s55, 0x20000
    s_mov_b32 s56, s4
    s_mov_b32 s57, s5
    s_mov_b32 s58, 0x400000
    s_mov_b32 s59, 0x20000
    s_mov_b32 s60, s22
    s_mov_b32 s61, s23
    s_mov_b32 s62, 0x800000
    s_mov_b32 s63, 0x20000
    s_mov_b32 s64, s20
    s_mov_b32 s65, s21
    s_mov_b32 s66, 0x200000
    s_add_u32 m0, s17, 24576
    s_add_u32 s89, s19, 198656
    buffer_load_dwordx4 v4, s[32:35], s89 offen  lds
    s_mov_b32 s67, 0x20000
    s_mov_b32 s68, s24
    s_mov_b32 s69, s25
    s_mov_b32 s70, 0x100
    s_mov_b32 s71, 0x20000
    v_and_b32 v7, 7, v0
    s_lshl_b32 s79, s74, 7
    v_lshl_add_u32 v7, v7, 4, s79
    s_lshl_b32 s78, s75, 7
    s_lshl_b32 s80, s3, 3
    s_add_u32 s80, s80, s78
    v_lshrrev_b32 v5, 3, v0
    s_and_b32 s79, s3, 1
    v_xor_b32 v5, s79, v5
    v_add_u32 v5, s80, v5
    v_lshl_add_u32 v10, v5, 11, v7
    s_xor_b32 s80, s3, 1
    s_add_u32 s80, s78, s80
    s_sub_u32 s80, s80, 4
    s_lshl_b32 s80, s80, 11
    v_add_u32 v11, s80, v7
    v_bfe_u32 v5, v0, 3, 2
    v_lshrrev_b32 v6, 5, v0
    s_lshl_b32 s80, s3, 5
    v_lshlrev_b32 v8, 3, v5
    v_lshl_add_u32 v8, v6, 2, v8
    v_add_u32 v8, s80, v8
    v_and_b32 v35, 7, v0
    v_lshlrev_b32 v16, 4, v35
    v_lshl_add_u32 v16, v8, 7, v16
    v_add_u32 v232, 129024, v16
    s_add_u32 m0, s17, 49152
    s_add_u32 s89, s19, 200704
    buffer_load_dwordx4 v4, s[32:35], s89 offen  lds
    v_and_b32 v231, 1, v5
    v_lshl_add_u32 v16, v231, 7, v232
    v_xor_b32 v233, v231, v6
    v_xor_b32 v233, 1, v233
    v_lshl_add_u32 v232, v233, 7, v232
    v_xor_b32 v231, 128, v16
    v_xor_b32 v233, 128, v232
    v_lshrrev_b32 v33, 2, v35
    v_lshlrev_b32 v35, 6, v35
    v_lshl_add_u32 v35, v33, 4, v35
    v_add_u32 v35, 162816, v35
    v_add_u32 v8, s78, v8
    v_lshl_add_u32 v9, v8, 11, v7
    v_lshl_add_u32 v13, v8, 12, v7
    v_bfe_u32 v8, v0, 2, 1
    v_lshlrev_b32 v8, 1, v8
    v_add_u32 v8, v8, v6
    v_lshlrev_b32 v8, 16, v8
    v_lshl_add_u32 v8, v5, 6, v8
    v_and_b32 v7, 3, v0
    v_lshl_add_u32 v8, v7, 4, v8
    s_add_u32 s78, s78, s80
    s_lshl_b32 s78, s78, 3
    s_lshl_b32 s79, s74, 18
    s_add_u32 s78, s78, s79
    v_add_u32 v12, s78, v8
    s_lshl_b32 s91, s74, 4
    s_add_u32 s91, s91, s75
    s_lshr_b32 s78, s91, 3
    s_lshl_b32 s78, s78, 5
    s_add_u32 s97, s98, s0
    s_lshr_b64 s[0:1], s[0:1], 4
    s_and_b32 s97, s97, 15
    s_lshr_b32 s99, s97, 3
    s_xor_b32 s97, s97, s99
    s_lshl_b32 s97, s97, 7
    s_add_u32 m0, s87, 18432
    s_add_u32 s89, s97, 0
    buffer_load_dwordx4 v2, s[28:31], s89 offen  lds
    s_and_b32 s79, s91, 7
    s_add_u32 s78, s78, s79
    s_lshl_b32 s79, s3, 3
    s_add_u32 s90, s78, s79
    s_lshl_b32 s91, s91, 14
    s_lshr_b32 s78, s90, 1
    s_lshl_b32 s78, s78, 2
    s_load_dword s92, s[14:15], s78
    s_mul_i32 s94, s3, 8320
    s_add_u32 s94, s94, 129024
    s_lshl_b32 s95, s3, 14
    s_mov_b32 s96, 4096
    s_and_b32 s100, s76, 3
    s_lshl_b32 s100, s100, 19
    v_bfe_u32 v5, v0, 2, 2
    v_lshlrev_b32 v5, 1, v5
    v_lshl_add_u32 v5, v6, 3, v5
    v_bfe_u32 v8, v0, 4, 1
    v_add_u32 v5, v5, v8
    s_and_b32 s78, s3, 1
    s_lshl_b32 s78, s78, 1
    v_add_u32 v8, s78, v6
    v_xor_b32 v8, v8, v7
    v_lshlrev_b32 v8, 4, v8
    v_lshl_add_u32 v5, v5, 6, v8
    v_add_u32 v14, s86, v5
    v_lshlrev_b32 v15, 4, v0
    v_lshrrev_b32 v5, 4, v0
    v_lshlrev_b32 v5, 1, v5
    v_and_b32 v8, 7, v0
    v_xor_b32 v5, v5, v8
    s_mul_i32 s99, s97, 3072
    s_sub_u32 s19, s99, s18
    s_add_u32 s99, s99, s18
    s_add_u32 m0, s16, 8192
    s_add_u32 s89, s99, 0
    buffer_load_dwordx4 v4, s[32:35], s89 offen  lds
    v_lshlrev_b32 v5, 4, v5
    v_lshrrev_b32 v8, 3, v0
    v_lshl_add_u32 v5, v8, 11, v5
    s_lshl_b32 s78, s77, 7
    v_add_u32 v17, s78, v5
    v_add_u32 v228, s95, v17
    s_lshr_b32 s78, s2, 3
    s_lshl_b32 s78, s78, 16
    s_add_u32 s78, s78, s95
    s_and_b32 s79, s77, 8
    s_lshl_b32 s79, s79, 7
    s_add_u32 s78, s78, s79
    v_and_b32 v5, 7, v0
    v_lshlrev_b32 v5, 7, v5
    v_lshl_add_u32 v5, v8, 11, v5
    v_add_u32 v229, s78, v5
    s_and_b32 s78, s73, 7
    s_cmp_eq_u32 s78, 3
    s_cselect_b32 s78, 0x40000000, 0
    v_or_b32 v229, s78, v229
    v_mov_b32 v18, 162304
    v_mov_b32 v19, 1
    v_and_b32 v5, 3, v0
    s_lshl_b32 s78, s74, 4
    s_add_u32 s78, s78, s3
    v_lshl_add_u32 v6, v5, 2, s78
    s_lshr_b32 s78, s76, 3
    s_lshl_b32 s79, s3, 1
    s_add_u32 s78, s78, s79
    s_xor_b32 s78, s78, 2
    s_lshl_b32 s78, s78, 5
    s_and_b32 s79, s76, 7
    s_add_u32 s78, s78, s79
    s_add_u32 m0, s87, 22528
    s_add_u32 s89, s97, 65536
    buffer_load_dwordx4 v2, s[28:31], s89 offen  lds
    v_lshl_add_u32 v7, v5, 3, s78
    v_and_b32 v8, 4, v0
    v_cmp_eq_u32 vcc, 0, v8
    s_nop 1
    v_cndmask_b32 v6, v7, v6, vcc
    v_and_b32 v33, 0xf0, v6
    v_lshlrev_b32 v34, 8, v6
    v_add_u32 v34, 12582912, v34
    v_and_b32 v5, 15, v0
    v_lshrrev_b32 v6, 4, v0
    v_add_u32 v7, 9, v5
    v_and_b32 v8, 1, v7
    v_mul_u32_u24 v8, 4160, v8
    v_lshrrev_b32 v7, 1, v7
    v_lshl_add_u32 v8, v7, 2, v8
    v_lshlrev_b32 v7, 4, v6
    v_sub_u32 v8, v8, v7
    s_add_u32 s78, s94, 32
    v_add_u32 v21, s78, v8
    v_add_u32 v22, 1024, v21
    v_add_u32 v23, 2048, v21
    v_add_u32 v24, 3072, v21
    v_lshl_add_u32 v7, v5, 1, v6
    v_add_u32 v7, 30, v7
    v_lshrrev_b32 v8, 3, v7
    v_and_b32 v25, 3, v8
    v_xor_b32 v25, s3, v25
    v_lshl_add_u32 v25, v8, 5, v25
    v_and_b32 v8, 1, v7
    v_lshl_add_u32 v25, v8, 4, v25
    v_bfe_u32 v8, v7, 1, 2
    v_lshl_add_u32 v25, v8, 2, v25
    s_add_u32 m0, s16, 32768
    s_add_u32 s89, s99, 2048
    buffer_load_dwordx4 v4, s[32:35], s89 offen  lds
    v_lshlrev_b32 v25, 4, v25
    v_add_u32 v25, 92160, v25
    v_lshl_add_u32 v7, v5, 1, v6
    v_add_u32 v7, 26, v7
    v_lshrrev_b32 v8, 3, v7
    v_and_b32 v26, 3, v8
    v_xor_b32 v26, s3, v26
    v_lshl_add_u32 v26, v8, 5, v26
    v_and_b32 v8, 1, v7
    v_lshl_add_u32 v26, v8, 4, v26
    v_bfe_u32 v8, v7, 1, 2
    v_lshl_add_u32 v26, v8, 2, v26
    v_lshlrev_b32 v26, 4, v26
    v_add_u32 v26, 92160, v26
    v_lshl_add_u32 v7, v5, 1, v6
    v_add_u32 v7, 22, v7
    v_lshrrev_b32 v8, 3, v7
    v_and_b32 v27, 3, v8
    v_xor_b32 v27, s3, v27
    v_lshl_add_u32 v27, v8, 5, v27
    v_and_b32 v8, 1, v7
    v_lshl_add_u32 v27, v8, 4, v27
    v_bfe_u32 v8, v7, 1, 2
    v_lshl_add_u32 v27, v8, 2, v27
    v_lshlrev_b32 v27, 4, v27
    v_add_u32 v27, 92160, v27
    v_lshl_add_u32 v7, v5, 1, v6
    v_add_u32 v7, 18, v7
    v_lshrrev_b32 v8, 3, v7
    v_and_b32 v28, 3, v8
    v_xor_b32 v28, s3, v28
    s_add_u32 m0, s87, 26624
    s_add_u32 s89, s97, 131072
    buffer_load_dwordx4 v2, s[28:31], s89 offen  lds
    v_lshl_add_u32 v28, v8, 5, v28
    v_and_b32 v8, 1, v7
    v_lshl_add_u32 v28, v8, 4, v28
    v_bfe_u32 v8, v7, 1, 2
    v_lshl_add_u32 v28, v8, 2, v28
    v_lshlrev_b32 v28, 4, v28
    v_add_u32 v28, 92160, v28
    v_lshl_add_u32 v7, v5, 1, v6
    v_add_u32 v7, 14, v7
    v_lshrrev_b32 v8, 3, v7
    v_and_b32 v29, 3, v8
    v_xor_b32 v29, s3, v29
    v_lshl_add_u32 v29, v8, 5, v29
    v_and_b32 v8, 1, v7
    v_lshl_add_u32 v29, v8, 4, v29
    v_bfe_u32 v8, v7, 1, 2
    v_lshl_add_u32 v29, v8, 2, v29
    v_lshlrev_b32 v29, 4, v29
    v_add_u32 v29, 92160, v29
    v_lshl_add_u32 v7, v5, 1, v6
    v_add_u32 v7, 10, v7
    v_lshrrev_b32 v8, 3, v7
    v_and_b32 v30, 3, v8
    v_xor_b32 v30, s3, v30
    v_lshl_add_u32 v30, v8, 5, v30
    v_and_b32 v8, 1, v7
    v_lshl_add_u32 v30, v8, 4, v30
    v_bfe_u32 v8, v7, 1, 2
    v_lshl_add_u32 v30, v8, 2, v30
    v_lshlrev_b32 v30, 4, v30
    s_add_u32 m0, s16, 57344
    s_add_u32 s89, s99, 4096
    buffer_load_dwordx4 v4, s[32:35], s89 offen  lds
    v_add_u32 v30, 92160, v30
    v_lshl_add_u32 v7, v5, 1, v6
    v_add_u32 v7, 6, v7
    v_lshrrev_b32 v8, 3, v7
    v_and_b32 v31, 3, v8
    v_xor_b32 v31, s3, v31
    v_lshl_add_u32 v31, v8, 5, v31
    v_and_b32 v8, 1, v7
    v_lshl_add_u32 v31, v8, 4, v31
    v_bfe_u32 v8, v7, 1, 2
    v_lshl_add_u32 v31, v8, 2, v31
    v_lshlrev_b32 v31, 4, v31
    v_add_u32 v31, 92160, v31
    v_lshl_add_u32 v7, v5, 1, v6
    v_add_u32 v7, 2, v7
    v_lshrrev_b32 v8, 3, v7
    v_and_b32 v32, 3, v8
    v_xor_b32 v32, s3, v32
    v_lshl_add_u32 v32, v8, 5, v32
    v_and_b32 v8, 1, v7
    v_lshl_add_u32 v32, v8, 4, v32
    v_bfe_u32 v8, v7, 1, 2
    v_lshl_add_u32 v32, v8, 2, v32
    v_lshlrev_b32 v32, 4, v32
    v_add_u32 v32, 92160, v32
    v_lshrrev_b32 v7, 1, v6
    v_lshl_add_u32 v7, v5, 1, v7
    v_add_u32 v7, 32, v7
    v_lshrrev_b32 v8, 3, v7
    v_and_b32 v20, 3, v8
    v_xor_b32 v20, s3, v20
    s_add_u32 m0, s87, 30720
    s_add_u32 s89, s97, 196608
    buffer_load_dwordx4 v2, s[28:31], s89 offen  lds
    v_lshl_add_u32 v20, v8, 5, v20
    v_and_b32 v8, 1, v7
    v_lshl_add_u32 v20, v8, 4, v20
    v_bfe_u32 v8, v7, 1, 2
    v_lshl_add_u32 v20, v8, 2, v20
    v_lshlrev_b32 v20, 4, v20
    v_add_u32 v20, 92160, v20
    v_and_b32 v8, 1, v6
    v_xor_b32 v8, 1, v8
    v_lshl_add_u32 v20, v8, 3, v20
    s_waitcnt lgkmcnt(0)
    s_and_b32 s78, s92, 0xffff0000
    s_lshl_b32 s92, s92, 16
    s_bitcmp1_b32 s90, 0
    s_cselect_b32 s92, s78, s92
    v_lshlrev_b32 v7, 3, v6
    v_sub_u32 v7, v7, v5
    v_subrev_u32 v7, 9, v7
    v_and_b32 v8, 1, v7
    v_xor_b32 v8, 1, v8
    v_lshlrev_b32 v8, 4, v8
    v_lshrrev_b32 v8, v8, s92
    v_ashrrev_i32 v7, 1, v7
    v_cmp_eq_u32 vcc, 0, v7
    s_nop 1
    v_cndmask_b32 v236, 0, v8, vcc
    v_cmp_eq_u32 vcc, 1, v7
    s_nop 1
    v_cndmask_b32 v237, 0, v8, vcc
    v_cmp_eq_u32 vcc, 2, v7
    s_nop 1
    v_cndmask_b32 v238, 0, v8, vcc
    v_cmp_eq_u32 vcc, 3, v7
    s_nop 1
    v_cndmask_b32 v239, 0, v8, vcc
    s_cmp_eq_u32 s101, 1
    s_cbranch_scc1 LA_c1
    s_cmp_eq_u32 s101, 2
    s_cbranch_scc1 LA_c2
    s_cmp_eq_u32 s101, 3
    s_cbranch_scc1 LA_c3
LA_c0:
    s_waitcnt vmcnt(7)
    s_barrier
    s_mov_b64 exec, 0xffffffff
    s_add_u32 m0, s88, 18432
    s_add_u32 s89, s97, 0
    buffer_load_dwordx4 v3, s[28:31], s89 offen  lds
    s_mov_b64 exec, -1
    s_add_u32 m0, s17, 8192
    s_add_u32 s89, s19, 196608
    buffer_load_dwordx4 v4, s[32:35], s89 offen  lds
    s_add_u32 m0, s17, 32768
    s_add_u32 s89, s19, 198656
    buffer_load_dwordx4 v4, s[32:35], s89 offen  lds
    s_add_u32 m0, s17, 57344
    s_add_u32 s89, s19, 200704
    buffer_load_dwordx4 v4, s[32:35], s89 offen  lds
    s_add_u32 s97, s98, s0
    s_lshr_b64 s[0:1], s[0:1], 4
    s_and_b32 s97, s97, 15
    s_lshr_b32 s99, s97, 3
    s_xor_b32 s97, s97, s99
    s_lshl_b32 s97, s97, 7
    s_add_u32 m0, s87, 36864
    s_add_u32 s89, s97, 0
    buffer_load_dwordx4 v2, s[28:31], s89 offen  lds
    s_mul_i32 s99, s97, 3072
    s_sub_u32 s19, s99, s18
    s_add_u32 s99, s99, s18
    s_add_u32 m0, s16, 16384
    s_add_u32 s89, s99, 0
    buffer_load_dwordx4 v4, s[32:35], s89 offen  lds
    s_add_u32 m0, s87, 40960
    s_add_u32 s89, s97, 65536
    buffer_load_dwordx4 v2, s[28:31], s89 offen  lds
    s_add_u32 m0, s16, 40960
    s_add_u32 s89, s99, 2048
    buffer_load_dwordx4 v4, s[32:35], s89 offen  lds
    s_add_u32 m0, s87, 45056
    s_add_u32 s89, s97, 131072
    buffer_load_dwordx4 v2, s[28:31], s89 offen  lds
    s_add_u32 m0, s16, 65536
    s_add_u32 s89, s99, 4096
    buffer_load_dwordx4 v4, s[32:35], s89 offen  lds
    s_add_u32 m0, s87, 49152
    s_add_u32 s89, s97, 196608
    buffer_load_dwordx4 v2, s[28:31], s89 offen  lds
    s_mov_b64 exec, 0xffffffff
    s_add_u32 m0, s88, 36864
    s_add_u32 s89, s97, 0
    buffer_load_dwordx4 v3, s[28:31], s89 offen  lds
    s_mov_b64 exec, -1
    s_add_u32 m0, s17, 16384
    s_add_u32 s89, s19, 196608
    buffer_load_dwordx4 v4, s[32:35], s89 offen  lds
    s_add_u32 m0, s17, 40960
    s_add_u32 s89, s19, 198656
    buffer_load_dwordx4 v4, s[32:35], s89 offen  lds
    s_add_u32 m0, s17, 65536
    s_add_u32 s89, s19, 200704
    buffer_load_dwordx4 v4, s[32:35], s89 offen  lds
    s_waitcnt vmcnt(11)
    s_barrier
    s_add_u32 m0, s86, 129536
    s_mov_b32 s89, 0
    buffer_load_dwordx4 v10, s[36:39], s89 offen nt lds
    s_add_u32 m0, s86, 145920
    s_mov_b32 s89, 0
    buffer_load_dwordx4 v10, s[40:43], s89 offen nt lds
    s_add_u32 m0, s86, 133632
    s_mov_b32 s89, 65536
    buffer_load_dwordx4 v10, s[36:39], s89 offen nt lds
    s_add_u32 m0, s86, 150016
    s_mov_b32 s89, 65536
    buffer_load_dwordx4 v10, s[40:43], s89 offen nt lds
    s_add_u32 m0, s86, 137728
    s_mov_b32 s89, 131072
    buffer_load_dwordx4 v10, s[36:39], s89 offen nt lds
    s_add_u32 m0, s86, 154112
    s_mov_b32 s89, 131072
    buffer_load_dwordx4 v10, s[40:43], s89 offen nt lds
    s_add_u32 m0, s86, 141824
    s_mov_b32 s89, 196608
    buffer_load_dwordx4 v10, s[36:39], s89 offen nt lds
    s_add_u32 m0, s86, 158208
    s_mov_b32 s89, 196608
    buffer_load_dwordx4 v10, s[40:43], s89 offen nt lds
    s_mov_b64 exec, 0xff
    s_lshl_b32 s82, s3, 7
    s_add_u32 m0, s82, 129024
    s_mov_b32 s89, 0
    buffer_load_dwordx4 v11, s[36:39], s89 offen nt lds
    s_lshl_b32 s83, s74, 9
    s_add_u32 s83, s83, s82
    s_and_b32 s89, s3, 2
    s_lshl_b32 s89, s89, 3
    s_add_u32 s82, s82, s89
    s_add_u32 m0, s82, 162816
    s_add_u32 s89, s83, 0
    buffer_load_dwordx4 v15, s[44:47], s89 offen  lds
    s_mov_b64 exec, -1
    s_add_u32 s97, s98, s0
    s_lshr_b64 s[0:1], s[0:1], 4
    s_and_b32 s97, s97, 15
    s_lshr_b32 s99, s97, 3
    s_xor_b32 s97, s97, s99
    s_lshl_b32 s97, s97, 7
    s_add_u32 m0, s87, 0
    s_add_u32 s89, s97, 0
    buffer_load_dwordx4 v2, s[28:31], s89 offen  lds
    s_mul_i32 s99, s97, 3072
    s_sub_u32 s19, s99, s18
    s_add_u32 s99, s99, s18
    s_add_u32 m0, s16, 0
    s_add_u32 s89, s99, 0
    buffer_load_dwordx4 v4, s[32:35], s89 offen  lds
    s_add_u32 m0, s87, 4096
    s_add_u32 s89, s97, 65536
    buffer_load_dwordx4 v2, s[28:31], s89 offen  lds
    s_add_u32 m0, s16, 24576
    s_add_u32 s89, s99, 2048
    buffer_load_dwordx4 v4, s[32:35], s89 offen  lds
    s_add_u32 m0, s87, 8192
    s_add_u32 s89, s97, 131072
    buffer_load_dwordx4 v2, s[28:31], s89 offen  lds
    s_add_u32 m0, s16, 49152
    s_add_u32 s89, s99, 4096
    buffer_load_dwordx4 v4, s[32:35], s89 offen  lds
    s_add_u32 m0, s87, 12288
    s_add_u32 s89, s97, 196608
    buffer_load_dwordx4 v2, s[28:31], s89 offen  lds
    s_waitcnt vmcnt(17)
    s_barrier
    s_mov_b64 exec, 0xffffffff
    s_add_u32 m0, s88, 0
    s_add_u32 s89, s97, 0
    buffer_load_dwordx4 v3, s[28:31], s89 offen  lds
    s_mov_b64 exec, -1
    s_add_u32 m0, s17, 0
    s_add_u32 s89, s19, 196608
    buffer_load_dwordx4 v4, s[32:35], s89 offen  lds
    s_add_u32 m0, s17, 24576
    s_add_u32 s89, s19, 198656
    buffer_load_dwordx4 v4, s[32:35], s89 offen  lds
    s_add_u32 m0, s17, 49152
    s_add_u32 s89, s19, 200704
    buffer_load_dwordx4 v4, s[32:35], s89 offen  lds
    s_add_u32 s97, s98, s0
    s_lshr_b64 s[0:1], s[0:1], 4
    s_and_b32 s97, s97, 15
    s_lshr_b32 s99, s97, 3
    s_xor_b32 s97, s97, s99
    s_lshl_b32 s97, s97, 7
    s_add_u32 m0, s87, 18432
    s_add_u32 s89, s97, 0
    buffer_load_dwordx4 v2, s[28:31], s89 offen  lds
    s_mul_i32 s99, s97, 3072
    s_sub_u32 s19, s99, s18
    s_add_u32 s99, s99, s18
    s_add_u32 m0, s16, 8192
    s_add_u32 s89, s99, 0
    buffer_load_dwordx4 v4, s[32:35], s89 offen  lds
    s_add_u32 m0, s87, 22528
    s_add_u32 s89, s97, 65536
    buffer_load_dwordx4 v2, s[28:31], s89 offen  lds
    s_add_u32 m0, s16, 32768
    s_add_u32 s89, s99, 2048
    buffer_load_dwordx4 v4, s[32:35], s89 offen  lds
    s_add_u32 m0, s87, 26624
    s_add_u32 s89, s97, 131072
    buffer_load_dwordx4 v2, s[28:31], s89 offen  lds
    s_add_u32 m0, s16, 57344
    s_add_u32 s89, s99, 4096
    buffer_load_dwordx4 v4, s[32:35], s89 offen  lds
    s_add_u32 m0, s87, 30720
    s_add_u32 s89, s97, 196608
    buffer_load_dwordx4 v2, s[28:31], s89 offen  lds
    s_mov_b64 exec, 0xffffffff
    s_add_u32 m0, s88, 18432
    s_add_u32 s89, s97, 0
    buffer_load_dwordx4 v3, s[28:31], s89 offen  lds
    s_mov_b64 exec, -1
    s_add_u32 m0, s17, 8192
    s_add_u32 s89, s19, 196608
    buffer_load_dwordx4 v4, s[32:35], s89 offen  lds
    s_add_u32 m0, s17, 32768
    s_add_u32 s89, s19, 198656
    buffer_load_dwordx4 v4, s[32:35], s89 offen  lds
    s_add_u32 m0, s17, 57344
    s_add_u32 s89, s19, 200704
    buffer_load_dwordx4 v4, s[32:35], s89 offen  lds
    s_waitcnt vmcnt(11)
    s_barrier
    s_add_u32 s97, s98, s0
    s_lshr_b64 s[0:1], s[0:1], 4
    s_and_b32 s97, s97, 15
    s_lshr_b32 s99, s97, 3
    s_xor_b32 s97, s97, s99
    s_lshl_b32 s97, s97, 7
    s_add_u32 m0, s87, 36864
    s_add_u32 s89, s97, 0
    buffer_load_dwordx4 v2, s[28:31], s89 offen  lds
    ds_read_b128 v[84:87], v35 offset:0
    ds_read_b128 v[88:91], v35 offset:16
    s_mul_i32 s99, s97, 3072
    s_sub_u32 s19, s99, s18
    s_add_u32 s99, s99, s18
    s_add_u32 m0, s16, 16384
    s_add_u32 s89, s99, 0
    buffer_load_dwordx4 v4, s[32:35], s89 offen  lds
    ds_read_b128 v[92:95], v35 offset:32
    s_add_u32 m0, s87, 40960
    s_add_u32 s89, s97, 65536
    buffer_load_dwordx4 v2, s[28:31], s89 offen  lds
    ds_read_b128 v[96:99], v35 offset:48
    ds_read_b128 v[40:43], v233 offset:0
    s_add_u32 m0, s16, 40960
    s_add_u32 s89, s99, 2048
    buffer_load_dwordx4 v4, s[32:35], s89 offen  lds
    ds_read_b128 v[44:47], v232 offset:256
    s_add_u32 m0, s87, 45056
    s_add_u32 s89, s97, 131072
    buffer_load_dwordx4 v2, s[28:31], s89 offen  lds
    ds_read_b128 v[48:51], v233 offset:256
    s_add_u32 m0, s16, 65536
    s_add_u32 s89, s99, 4096
    buffer_load_dwordx4 v4, s[32:35], s89 offen  lds
    ds_read_b128 v[52:55], v16 offset:512
    ds_read_b128 v[56:59], v231 offset:512
    s_add_u32 m0, s87, 49152
    s_add_u32 s89, s97, 196608
    buffer_load_dwordx4 v2, s[28:31], s89 offen  lds
    ds_read_b128 v[60:63], v16 offset:768
    s_mov_b64 exec, 0xffffffff
    s_add_u32 m0, s88, 36864
    s_add_u32 s89, s97, 0
    buffer_load_dwordx4 v3, s[28:31], s89 offen  lds
    s_mov_b64 exec, -1
    ds_read_b128 v[64:67], v231 offset:768
    s_add_u32 m0, s17, 16384
    s_add_u32 s89, s19, 196608
    buffer_load_dwordx4 v4, s[32:35], s89 offen  lds
    ds_read_b128 v[68:71], v16 offset:16896
    ds_read_b128 v[72:75], v231 offset:16896
    s_add_u32 m0, s17, 40960
    s_add_u32 s89, s19, 198656
    buffer_load_dwordx4 v4, s[32:35], s89 offen  lds
    ds_read_b128 v[76:79], v16 offset:17152
    s_add_u32 m0, s17, 65536
    s_add_u32 s89, s19, 200704
    buffer_load_dwordx4 v4, s[32:35], s89 offen  lds
    ds_read_b128 v[80:83], v231 offset:17152
    s_waitcnt vmcnt(11)
    s_waitcnt lgkmcnt(0)
    s_barrier
    s_add_u32 s97, s98, s0
    s_lshr_b64 s[0:1], s[0:1], 4
    s_and_b32 s97, s97, 15
    s_lshr_b32 s99, s97, 3
    s_xor_b32 s97, s97, s99
    s_lshl_b32 s97, s97, 7
    s_add_u32 m0, s87, 0
    s_add_u32 s89, s97, 0
    buffer_load_dwordx4 v2, s[28:31], s89 offen  lds
    v_lshlrev_b32 v116, 16, v40
    v_lshlrev_b32 v117, 16, v44
    v_lshlrev_b32 v118, 16, v48
    v_lshlrev_b32 v119, 16, v52
    v_lshlrev_b32 v120, 16, v56
    v_lshlrev_b32 v121, 16, v60
    s_mul_i32 s99, s97, 3072
    s_sub_u32 s19, s99, s18
    s_add_u32 s99, s99, s18
    s_add_u32 m0, s16, 0
    s_add_u32 s89, s99, 0
    buffer_load_dwordx4 v4, s[32:35], s89 offen  lds
    v_lshlrev_b32 v122, 16, v64
    v_lshlrev_b32 v127, 16, v84
    v_and_b32 v128, 0xffff0000, v84
    v_lshlrev_b32 v129, 16, v85
    v_and_b32 v130, 0xffff0000, v85
    v_lshlrev_b32 v123, 16, v68
    s_add_u32 m0, s87, 4096
    s_add_u32 s89, s97, 65536
    buffer_load_dwordx4 v2, s[28:31], s89 offen  lds
    v_lshlrev_b32 v124, 16, v72
    v_lshlrev_b32 v125, 16, v76
    v_lshlrev_b32 v126, 16, v80
    v_mul_f32 v131, v116, v130
    v_mul_f32 v132, v117, v130
    s_add_u32 m0, s16, 24576
    s_add_u32 s89, s99, 2048
    buffer_load_dwordx4 v4, s[32:35], s89 offen  lds
    v_mul_f32 v133, v118, v130
    v_mul_f32 v134, v119, v130
    v_fmac_f32 v131, v117, v129
    v_fmac_f32 v132, v118, v129
    v_fmac_f32 v133, v119, v129
    v_fmac_f32 v134, v120, v129
    s_add_u32 m0, s87, 8192
    s_add_u32 s89, s97, 131072
    buffer_load_dwordx4 v2, s[28:31], s89 offen  lds
    v_fmac_f32 v131, v118, v128
    v_fmac_f32 v132, v119, v128
    v_fmac_f32 v133, v120, v128
    v_fmac_f32 v134, v121, v128
    v_fmac_f32 v131, v119, v127
    v_fmac_f32 v132, v120, v127
    s_add_u32 m0, s16, 49152
    s_add_u32 s89, s99, 4096
    buffer_load_dwordx4 v4, s[32:35], s89 offen  lds
    v_fmac_f32 v133, v121, v127
    v_fmac_f32 v134, v122, v127
    v_mul_f32 v131, v131, v123
    v_mul_f32 v132, v132, v124
    v_mul_f32 v133, v133, v125
    s_add_u32 m0, s87, 12288
    s_add_u32 s89, s97, 196608
    buffer_load_dwordx4 v2, s[28:31], s89 offen  lds
    v_mul_f32 v134, v134, v126
    v_cvt_pk_bf16_f32 v102, v134, v133
    v_cvt_pk_bf16_f32 v103, v132, v131
    v_lshlrev_b32 v116, 16, v42
    v_lshlrev_b32 v117, 16, v46
    v_lshlrev_b32 v118, 16, v50
    s_mov_b64 exec, 0xffffffff
    s_add_u32 m0, s88, 0
    s_add_u32 s89, s97, 0
    buffer_load_dwordx4 v3, s[28:31], s89 offen  lds
    s_mov_b64 exec, -1
    v_lshlrev_b32 v119, 16, v54
    v_lshlrev_b32 v120, 16, v58
    v_lshlrev_b32 v121, 16, v62
    v_lshlrev_b32 v122, 16, v66
    v_lshlrev_b32 v127, 16, v92
    v_and_b32 v128, 0xffff0000, v92
    s_add_u32 m0, s17, 0
    s_add_u32 s89, s19, 196608
    buffer_load_dwordx4 v4, s[32:35], s89 offen  lds
    v_lshlrev_b32 v129, 16, v93
    v_and_b32 v130, 0xffff0000, v93
    v_lshlrev_b32 v123, 16, v70
    v_lshlrev_b32 v124, 16, v74
    v_lshlrev_b32 v125, 16, v78
    s_add_u32 m0, s17, 24576
    s_add_u32 s89, s19, 198656
    buffer_load_dwordx4 v4, s[32:35], s89 offen  lds
    v_lshlrev_b32 v126, 16, v82
    v_mul_f32 v131, v116, v130
    v_mul_f32 v132, v117, v130
    v_mul_f32 v133, v118, v130
    v_mul_f32 v134, v119, v130
    v_fmac_f32 v131, v117, v129
    s_add_u32 m0, s17, 49152
    s_add_u32 s89, s19, 200704
    buffer_load_dwordx4 v4, s[32:35], s89 offen  lds
    v_fmac_f32 v132, v118, v129
    v_fmac_f32 v133, v119, v129
    v_fmac_f32 v134, v120, v129
    v_fmac_f32 v131, v118, v128
    v_fmac_f32 v132, v119, v128
    s_waitcnt vmcnt(11)
    s_barrier
    s_add_u32 s97, s98, s0
    s_lshr_b64 s[0:1], s[0:1], 4
    s_and_b32 s97, s97, 15
    s_lshr_b32 s99, s97, 3
    s_xor_b32 s97, s97, s99
    s_lshl_b32 s97, s97, 7
    s_add_u32 m0, s87, 18432
    s_add_u32 s89, s97, 0
    buffer_load_dwordx4 v2, s[28:31], s89 offen  lds
    v_fmac_f32 v133, v120, v128
    v_fmac_f32 v134, v121, v128
    v_fmac_f32 v131, v119, v127
    v_fmac_f32 v132, v120, v127
    v_fmac_f32 v133, v121, v127
    v_fmac_f32 v134, v122, v127
    s_mul_i32 s99, s97, 3072
    s_sub_u32 s19, s99, s18
    s_add_u32 s99, s99, s18
    s_add_u32 m0, s16, 8192
    s_add_u32 s89, s99, 0
    buffer_load_dwordx4 v4, s[32:35], s89 offen  lds
    v_mul_f32 v131, v131, v123
    v_mul_f32 v132, v132, v124
    v_mul_f32 v133, v133, v125
    v_mul_f32 v134, v134, v126
    v_cvt_pk_bf16_f32 v100, v134, v133
    v_cvt_pk_bf16_f32 v101, v132, v131
    s_add_u32 m0, s87, 22528
    s_add_u32 s89, s97, 65536
    buffer_load_dwordx4 v2, s[28:31], s89 offen  lds
    v_permlane32_swap_b32 v102, v100
    v_permlane32_swap_b32 v103, v101
    s_mov_b32 s89, 0
    buffer_store_dwordx4 v[100:103], v12, s[52:55], s89 offen sc1
    v_and_b32 v116, 0xffff0000, v40
    v_and_b32 v117, 0xffff0000, v44
    s_add_u32 m0, s16, 32768
    s_add_u32 s89, s99, 2048
    buffer_load_dwordx4 v4, s[32:35], s89 offen  lds
    v_and_b32 v118, 0xffff0000, v48
    v_and_b32 v119, 0xffff0000, v52
    v_and_b32 v120, 0xffff0000, v56
    v_and_b32 v121, 0xffff0000, v60
    v_and_b32 v122, 0xffff0000, v64
    v_lshlrev_b32 v127, 16, v86
    s_add_u32 m0, s87, 26624
    s_add_u32 s89, s97, 131072
    buffer_load_dwordx4 v2, s[28:31], s89 offen  lds
    v_and_b32 v128, 0xffff0000, v86
    v_lshlrev_b32 v129, 16, v87
    v_and_b32 v130, 0xffff0000, v87
    v_and_b32 v123, 0xffff0000, v68
    v_and_b32 v124, 0xffff0000, v72
    v_and_b32 v125, 0xffff0000, v76
    s_add_u32 m0, s16, 57344
    s_add_u32 s89, s99, 4096
    buffer_load_dwordx4 v4, s[32:35], s89 offen  lds
    v_and_b32 v126, 0xffff0000, v80
    v_mul_f32 v131, v116, v130
    v_mul_f32 v132, v117, v130
    v_mul_f32 v133, v118, v130
    v_mul_f32 v134, v119, v130
    s_add_u32 m0, s87, 30720
    s_add_u32 s89, s97, 196608
    buffer_load_dwordx4 v2, s[28:31], s89 offen  lds
    v_fmac_f32 v131, v117, v129
    v_fmac_f32 v132, v118, v129
    v_fmac_f32 v133, v119, v129
    v_fmac_f32 v134, v120, v129
    v_fmac_f32 v131, v118, v128
    v_fmac_f32 v132, v119, v128
    s_mov_b64 exec, 0xffffffff
    s_add_u32 m0, s88, 18432
    s_add_u32 s89, s97, 0
    buffer_load_dwordx4 v3, s[28:31], s89 offen  lds
    s_mov_b64 exec, -1
    v_fmac_f32 v133, v120, v128
    v_fmac_f32 v134, v121, v128
    v_fmac_f32 v131, v119, v127
    v_fmac_f32 v132, v120, v127
    v_fmac_f32 v133, v121, v127
    v_fmac_f32 v134, v122, v127
    s_add_u32 m0, s17, 8192
    s_add_u32 s89, s19, 196608
    buffer_load_dwordx4 v4, s[32:35], s89 offen  lds
    v_mul_f32 v131, v131, v123
    v_mul_f32 v132, v132, v124
    v_mul_f32 v133, v133, v125
    v_mul_f32 v134, v134, v126
    v_cvt_pk_bf16_f32 v106, v134, v133
    s_add_u32 m0, s17, 32768
    s_add_u32 s89, s19, 198656
    buffer_load_dwordx4 v4, s[32:35], s89 offen  lds
    v_cvt_pk_bf16_f32 v107, v132, v131
    v_and_b32 v116, 0xffff0000, v42
    v_and_b32 v117, 0xffff0000, v46
    v_and_b32 v118, 0xffff0000, v50
    v_and_b32 v119, 0xffff0000, v54
    v_and_b32 v120, 0xffff0000, v58
    s_add_u32 m0, s17, 57344
    s_add_u32 s89, s19, 200704
    buffer_load_dwordx4 v4, s[32:35], s89 offen  lds
    v_and_b32 v121, 0xffff0000, v62
    v_and_b32 v122, 0xffff0000, v66
    v_lshlrev_b32 v127, 16, v94
    v_and_b32 v128, 0xffff0000, v94
    v_lshlrev_b32 v129, 16, v95
    s_waitcnt vmcnt(12)
    s_barrier
    s_add_u32 s97, s98, s0
    s_lshr_b64 s[0:1], s[0:1], 4
    s_and_b32 s97, s97, 15
    s_lshr_b32 s99, s97, 3
    s_xor_b32 s97, s97, s99
    s_lshl_b32 s97, s97, 7
    s_add_u32 m0, s87, 36864
    s_add_u32 s89, s97, 0
    buffer_load_dwordx4 v2, s[28:31], s89 offen  lds
    v_and_b32 v130, 0xffff0000, v95
    v_and_b32 v123, 0xffff0000, v70
    v_and_b32 v124, 0xffff0000, v74
    v_and_b32 v125, 0xffff0000, v78
    v_and_b32 v126, 0xffff0000, v82
    v_mul_f32 v131, v116, v130
    s_mul_i32 s99, s97, 3072
    s_sub_u32 s19, s99, s18
    s_add_u32 s99, s99, s18
    s_add_u32 m0, s16, 16384
    s_add_u32 s89, s99, 0
    buffer_load_dwordx4 v4, s[32:35], s89 offen  lds
    v_mul_f32 v132, v117, v130
    v_mul_f32 v133, v118, v130
    v_mul_f32 v134, v119, v130
    v_fmac_f32 v131, v117, v129
    v_fmac_f32 v132, v118, v129
    v_fmac_f32 v133, v119, v129
    s_add_u32 m0, s87, 40960
    s_add_u32 s89, s97, 65536
    buffer_load_dwordx4 v2, s[28:31], s89 offen  lds
    v_fmac_f32 v134, v120, v129
    v_fmac_f32 v131, v118, v128
    v_fmac_f32 v132, v119, v128
    v_fmac_f32 v133, v120, v128
    v_fmac_f32 v134, v121, v128
    s_add_u32 m0, s16, 40960
    s_add_u32 s89, s99, 2048
    buffer_load_dwordx4 v4, s[32:35], s89 offen  lds
    v_fmac_f32 v131, v119, v127
    v_fmac_f32 v132, v120, v127
    v_fmac_f32 v133, v121, v127
    v_fmac_f32 v134, v122, v127
    v_mul_f32 v131, v131, v123
    v_mul_f32 v132, v132, v124
    s_add_u32 m0, s87, 45056
    s_add_u32 s89, s97, 131072
    buffer_load_dwordx4 v2, s[28:31], s89 offen  lds
    v_mul_f32 v133, v133, v125
    v_mul_f32 v134, v134, v126
    v_cvt_pk_bf16_f32 v104, v134, v133
    v_cvt_pk_bf16_f32 v105, v132, v131
    s_nop 0
    v_permlane32_swap_b32 v106, v104
    v_permlane32_swap_b32 v107, v105
    s_add_u32 m0, s16, 65536
    s_add_u32 s89, s99, 4096
    buffer_load_dwordx4 v4, s[32:35], s89 offen  lds
    s_mov_b32 s89, 16384
    buffer_store_dwordx4 v[104:107], v12, s[52:55], s89 offen sc1
    v_lshlrev_b32 v116, 16, v41
    v_lshlrev_b32 v117, 16, v45
    v_lshlrev_b32 v118, 16, v49
    v_lshlrev_b32 v119, 16, v53
    s_add_u32 m0, s87, 49152
    s_add_u32 s89, s97, 196608
    buffer_load_dwordx4 v2, s[28:31], s89 offen  lds
    v_lshlrev_b32 v120, 16, v57
    v_lshlrev_b32 v121, 16, v61
    v_lshlrev_b32 v122, 16, v65
    v_lshlrev_b32 v127, 16, v88
    v_and_b32 v128, 0xffff0000, v88
    v_lshlrev_b32 v129, 16, v89
    s_mov_b64 exec, 0xffffffff
    s_add_u32 m0, s88, 36864
    s_add_u32 s89, s97, 0
    buffer_load_dwordx4 v3, s[28:31], s89 offen  lds
    s_mov_b64 exec, -1
    v_and_b32 v130, 0xffff0000, v89
    v_lshlrev_b32 v123, 16, v69
    v_lshlrev_b32 v124, 16, v73
    v_lshlrev_b32 v125, 16, v77
    v_lshlrev_b32 v126, 16, v81
    v_mul_f32 v131, v116, v130
    s_add_u32 m0, s17, 16384
    s_add_u32 s89, s19, 196608
    buffer_load_dwordx4 v4, s[32:35], s89 offen  lds
    v_mul_f32 v132, v117, v130
    v_mul_f32 v133, v118, v130
    v_mul_f32 v134, v119, v130
    v_fmac_f32 v131, v117, v129
    v_fmac_f32 v132, v118, v129
    s_add_u32 m0, s17, 40960
    s_add_u32 s89, s19, 198656
    buffer_load_dwordx4 v4, s[32:35], s89 offen  lds
    v_fmac_f32 v133, v119, v129
    v_fmac_f32 v134, v120, v129
    v_fmac_f32 v131, v118, v128
    v_fmac_f32 v132, v119, v128
    v_fmac_f32 v133, v120, v128
    v_fmac_f32 v134, v121, v128
    s_add_u32 m0, s17, 65536
    s_add_u32 s89, s19, 200704
    buffer_load_dwordx4 v4, s[32:35], s89 offen  lds
    v_fmac_f32 v131, v119, v127
    v_fmac_f32 v132, v120, v127
    v_fmac_f32 v133, v121, v127
    v_fmac_f32 v134, v122, v127
    v_mul_f32 v131, v131, v123
    s_waitcnt vmcnt(12)
    s_barrier
    s_add_u32 m0, s94, 32
    s_lshl_b32 s89, s90, 12
    buffer_load_dwordx4 v15, s[48:51], s89 offen offset:0 nt lds
    v_mul_f32 v132, v132, v124
    v_mul_f32 v133, v133, v125
    v_mul_f32 v134, v134, v126
    v_cvt_pk_bf16_f32 v110, v134, v133
    s_add_u32 m0, s94, 32
    s_lshl_b32 s89, s90, 12
    buffer_load_dwordx4 v15, s[48:51], s89 offen offset:1024 nt lds
    v_cvt_pk_bf16_f32 v111, v132, v131
    v_lshlrev_b32 v116, 16, v43
    v_lshlrev_b32 v117, 16, v47
    v_lshlrev_b32 v118, 16, v51
    s_add_u32 m0, s94, 32
    s_lshl_b32 s89, s90, 12
    buffer_load_dwordx4 v15, s[48:51], s89 offen offset:2048 nt lds
    v_lshlrev_b32 v119, 16, v55
    v_lshlrev_b32 v120, 16, v59
    v_lshlrev_b32 v121, 16, v63
    v_lshlrev_b32 v122, 16, v67
    s_add_u32 m0, s94, 32
    s_lshl_b32 s89, s90, 12
    buffer_load_dwordx4 v15, s[48:51], s89 offen offset:3072 nt lds
    v_lshlrev_b32 v127, 16, v96
    v_and_b32 v128, 0xffff0000, v96
    v_lshlrev_b32 v129, 16, v97
    v_and_b32 v130, 0xffff0000, v97
    buffer_load_dwordx4 v[212:215], v9, s[56:59], 0 offen offset:0 nt
    v_lshlrev_b32 v123, 16, v71
    v_lshlrev_b32 v124, 16, v75
    v_lshlrev_b32 v125, 16, v79
    v_lshlrev_b32 v126, 16, v83
    buffer_load_dwordx4 v[216:219], v9, s[56:59], 0 offen offset:2048 nt
    v_mul_f32 v131, v116, v130
    v_mul_f32 v132, v117, v130
    v_mul_f32 v133, v118, v130
    v_mul_f32 v134, v119, v130
    buffer_load_dwordx4 v[220:223], v9, s[56:59], s96 offen offset:0 nt
    v_fmac_f32 v131, v117, v129
    v_fmac_f32 v132, v118, v129
    v_fmac_f32 v133, v119, v129
    v_fmac_f32 v134, v120, v129
    buffer_load_dwordx4 v[224:227], v9, s[56:59], s96 offen offset:2048 nt
    v_fmac_f32 v131, v118, v128
    v_fmac_f32 v132, v119, v128
    v_fmac_f32 v133, v120, v128
    s_add_u32 s97, s98, s0
    s_lshr_b64 s[0:1], s[0:1], 4
    s_and_b32 s97, s97, 15
    s_lshr_b32 s99, s97, 3
    s_xor_b32 s97, s97, s99
    s_lshl_b32 s97, s97, 7
    s_add_u32 m0, s87, 0
    s_add_u32 s89, s97, 0
    buffer_load_dwordx4 v2, s[28:31], s89 offen  lds
    v_fmac_f32 v134, v121, v128
    v_fmac_f32 v131, v119, v127
    v_fmac_f32 v132, v120, v127
    v_fmac_f32 v133, v121, v127
    s_mul_i32 s99, s97, 3072
    s_sub_u32 s19, s99, s18
    s_add_u32 s99, s99, s18
    s_add_u32 m0, s16, 0
    s_add_u32 s89, s99, 0
    buffer_load_dwordx4 v4, s[32:35], s89 offen  lds
    v_fmac_f32 v134, v122, v127
    v_mul_f32 v131, v131, v123
    v_mul_f32 v132, v132, v124
    v_mul_f32 v133, v133, v125
    s_add_u32 m0, s87, 4096
    s_add_u32 s89, s97, 65536
    buffer_load_dwordx4 v2, s[28:31], s89 offen  lds
    v_mul_f32 v134, v134, v126
    v_cvt_pk_bf16_f32 v108, v134, v133
    v_cvt_pk_bf16_f32 v109, v132, v131
    s_nop 0
    v_permlane32_swap_b32 v110, v108
    s_add_u32 m0, s16, 24576
    s_add_u32 s89, s99, 2048
    buffer_load_dwordx4 v4, s[32:35], s89 offen  lds
    v_permlane32_swap_b32 v111, v109
    s_mov_b32 s89, 32768
    buffer_store_dwordx4 v[108:111], v12, s[52:55], s89 offen sc1
    v_and_b32 v116, 0xffff0000, v41
    v_and_b32 v117, 0xffff0000, v45
    s_add_u32 m0, s87, 8192
    s_add_u32 s89, s97, 131072
    buffer_load_dwordx4 v2, s[28:31], s89 offen  lds
    v_and_b32 v118, 0xffff0000, v49
    v_and_b32 v119, 0xffff0000, v53
    v_and_b32 v120, 0xffff0000, v57
    v_and_b32 v121, 0xffff0000, v61
    s_add_u32 m0, s16, 49152
    s_add_u32 s89, s99, 4096
    buffer_load_dwordx4 v4, s[32:35], s89 offen  lds
    v_and_b32 v122, 0xffff0000, v65
    v_lshlrev_b32 v127, 16, v90
    v_and_b32 v128, 0xffff0000, v90
    v_lshlrev_b32 v129, 16, v91
    s_add_u32 m0, s87, 12288
    s_add_u32 s89, s97, 196608
    buffer_load_dwordx4 v2, s[28:31], s89 offen  lds
    v_and_b32 v130, 0xffff0000, v91
    v_and_b32 v123, 0xffff0000, v69
    v_and_b32 v124, 0xffff0000, v73
    v_and_b32 v125, 0xffff0000, v77
    s_mov_b64 exec, 0xffffffff
    s_add_u32 m0, s88, 0
    s_add_u32 s89, s97, 0
    buffer_load_dwordx4 v3, s[28:31], s89 offen  lds
    s_mov_b64 exec, -1
    v_and_b32 v126, 0xffff0000, v81
    v_mul_f32 v131, v116, v130
    v_mul_f32 v132, v117, v130
    s_waitcnt vmcnt(17)
    s_barrier
    s_add_u32 m0, s17, 0
    s_add_u32 s89, s19, 196608
    buffer_load_dwordx4 v4, s[32:35], s89 offen  lds
    v_mul_f32 v133, v118, v130
    v_mul_f32 v134, v119, v130
    v_fmac_f32 v131, v117, v129
    v_fmac_f32 v132, v118, v129
    v_fmac_f32 v133, v119, v129
    s_add_u32 m0, s17, 24576
    s_add_u32 s89, s19, 198656
    buffer_load_dwordx4 v4, s[32:35], s89 offen  lds
    v_fmac_f32 v134, v120, v129
    v_fmac_f32 v131, v118, v128
    v_fmac_f32 v132, v119, v128
    v_fmac_f32 v133, v120, v128
    s_add_u32 m0, s17, 49152
    s_add_u32 s89, s19, 200704
    buffer_load_dwordx4 v4, s[32:35], s89 offen  lds
    v_fmac_f32 v134, v121, v128
    v_fmac_f32 v131, v119, v127
    v_fmac_f32 v132, v120, v127
    v_fmac_f32 v133, v121, v127
    s_add_u32 s97, s98, s0
    s_lshr_b64 s[0:1], s[0:1], 4
    s_and_b32 s97, s97, 15
    s_lshr_b32 s99, s97, 3
    s_xor_b32 s97, s97, s99
    s_lshl_b32 s97, s97, 7
    s_add_u32 m0, s87, 18432
    s_add_u32 s89, s97, 0
    buffer_load_dwordx4 v2, s[28:31], s89 offen  lds
    v_fmac_f32 v134, v122, v127
    v_mul_f32 v131, v131, v123
    v_mul_f32 v132, v132, v124
    v_mul_f32 v133, v133, v125
    v_mul_f32 v134, v134, v126
    s_mul_i32 s99, s97, 3072
    s_sub_u32 s19, s99, s18
    s_add_u32 s99, s99, s18
    s_add_u32 m0, s16, 8192
    s_add_u32 s89, s99, 0
    buffer_load_dwordx4 v4, s[32:35], s89 offen  lds
    v_cvt_pk_bf16_f32 v114, v134, v133
    v_cvt_pk_bf16_f32 v115, v132, v131
    v_and_b32 v116, 0xffff0000, v43
    v_and_b32 v117, 0xffff0000, v47
    s_add_u32 m0, s87, 22528
    s_add_u32 s89, s97, 65536
    buffer_load_dwordx4 v2, s[28:31], s89 offen  lds
    v_and_b32 v118, 0xffff0000, v51
    v_and_b32 v119, 0xffff0000, v55
    v_and_b32 v120, 0xffff0000, v59
    v_and_b32 v121, 0xffff0000, v63
    s_add_u32 m0, s16, 32768
    s_add_u32 s89, s99, 2048
    buffer_load_dwordx4 v4, s[32:35], s89 offen  lds
    v_and_b32 v122, 0xffff0000, v67
    v_lshlrev_b32 v127, 16, v98
    v_and_b32 v128, 0xffff0000, v98
    v_lshlrev_b32 v129, 16, v99
    s_add_u32 m0, s87, 26624
    s_add_u32 s89, s97, 131072
    buffer_load_dwordx4 v2, s[28:31], s89 offen  lds
    v_and_b32 v130, 0xffff0000, v99
    v_and_b32 v123, 0xffff0000, v71
    v_and_b32 v124, 0xffff0000, v75
    v_and_b32 v125, 0xffff0000, v79
    v_and_b32 v126, 0xffff0000, v83
    s_add_u32 m0, s16, 57344
    s_add_u32 s89, s99, 4096
    buffer_load_dwordx4 v4, s[32:35], s89 offen  lds
    v_mul_f32 v131, v116, v130
    v_mul_f32 v132, v117, v130
    v_mul_f32 v133, v118, v130
    v_mul_f32 v134, v119, v130
    s_add_u32 m0, s87, 30720
    s_add_u32 s89, s97, 196608
    buffer_load_dwordx4 v2, s[28:31], s89 offen  lds
    v_fmac_f32 v131, v117, v129
    v_fmac_f32 v132, v118, v129
    v_fmac_f32 v133, v119, v129
    v_fmac_f32 v134, v120, v129
    s_mov_b64 exec, 0xffffffff
    s_add_u32 m0, s88, 18432
    s_add_u32 s89, s97, 0
    buffer_load_dwordx4 v3, s[28:31], s89 offen  lds
    s_mov_b64 exec, -1
    v_fmac_f32 v131, v118, v128
    v_fmac_f32 v132, v119, v128
    v_fmac_f32 v133, v120, v128
    v_fmac_f32 v134, v121, v128
    v_fmac_f32 v131, v119, v127
    s_add_u32 m0, s17, 8192
    s_add_u32 s89, s19, 196608
    buffer_load_dwordx4 v4, s[32:35], s89 offen  lds
    v_fmac_f32 v132, v120, v127
    v_fmac_f32 v133, v121, v127
    v_fmac_f32 v134, v122, v127
    v_mul_f32 v131, v131, v123
    s_add_u32 m0, s17, 32768
    s_add_u32 s89, s19, 198656
    buffer_load_dwordx4 v4, s[32:35], s89 offen  lds
    v_mul_f32 v132, v132, v124
    v_mul_f32 v133, v133, v125
    v_mul_f32 v134, v134, v126
    v_cvt_pk_bf16_f32 v112, v134, v133
    s_add_u32 m0, s17, 57344
    s_add_u32 s89, s19, 200704
    buffer_load_dwordx4 v4, s[32:35], s89 offen  lds
    v_cvt_pk_bf16_f32 v113, v132, v131
    v_permlane32_swap_b32 v114, v112
    s_nop 0
    v_permlane32_swap_b32 v115, v113
    s_mov_b32 s89, 49152
    buffer_store_dwordx4 v[112:115], v12, s[52:55], s89 offen sc1
    s_waitcnt vmcnt(12)
    s_barrier
    s_add_u32 s97, s98, s0
    s_lshr_b64 s[0:1], s[0:1], 4
    s_and_b32 s97, s97, 15
    s_lshr_b32 s99, s97, 3
    s_xor_b32 s97, s97, s99
    s_lshl_b32 s97, s97, 7
    s_add_u32 m0, s87, 36864
    s_add_u32 s89, s97, 0
    buffer_load_dwordx4 v2, s[28:31], s89 offen  lds
    v_add_u32 v5, s94, v15
    ds_read_b128 v[140:143], v5 offset:32
    s_mul_i32 s99, s97, 3072
    s_sub_u32 s19, s99, s18
    s_add_u32 s99, s99, s18
    s_add_u32 m0, s16, 16384
    s_add_u32 s89, s99, 0
    buffer_load_dwordx4 v4, s[32:35], s89 offen  lds
    ds_read_b32 v156, v5 offset:48
    s_add_u32 m0, s87, 40960
    s_add_u32 s89, s97, 65536
    buffer_load_dwordx4 v2, s[28:31], s89 offen  lds
    ds_read_b128 v[144:147], v5 offset:1056
    ds_read_b32 v157, v5 offset:1072
    s_add_u32 m0, s16, 40960
    s_add_u32 s89, s99, 2048
    buffer_load_dwordx4 v4, s[32:35], s89 offen  lds
    ds_read_b128 v[148:151], v5 offset:2080
    s_add_u32 m0, s87, 45056
    s_add_u32 s89, s97, 131072
    buffer_load_dwordx4 v2, s[28:31], s89 offen  lds
    ds_read_b32 v158, v5 offset:2096
    s_add_u32 m0, s16, 65536
    s_add_u32 s89, s99, 4096
    buffer_load_dwordx4 v4, s[32:35], s89 offen  lds
    ds_read_b128 v[152:155], v5 offset:3104
    ds_read_b32 v159, v5 offset:3120
    s_add_u32 m0, s87, 49152
    s_add_u32 s89, s97, 196608
    buffer_load_dwordx4 v2, s[28:31], s89 offen  lds
    v_lshrrev_b32 v6, 3, v0
    s_mov_b64 exec, 0xffffffff
    s_add_u32 m0, s88, 36864
    s_add_u32 s89, s97, 0
    buffer_load_dwordx4 v3, s[28:31], s89 offen  lds
    s_mov_b64 exec, -1
    v_mul_u32_u24 v6, 4160, v6
    s_add_u32 m0, s17, 16384
    s_add_u32 s89, s19, 196608
    buffer_load_dwordx4 v4, s[32:35], s89 offen  lds
    v_and_b32 v7, 7, v0
    v_lshl_add_u32 v6, v7, 2, v6
    s_add_u32 m0, s17, 40960
    s_add_u32 s89, s19, 198656
    buffer_load_dwordx4 v4, s[32:35], s89 offen  lds
    v_add_u32 v6, s94, v6
    s_add_u32 m0, s17, 65536
    s_add_u32 s89, s19, 200704
    buffer_load_dwordx4 v4, s[32:35], s89 offen  lds
    v_mov_b32 v7, 0
    s_waitcnt vmcnt(12)
    s_barrier
    s_add_u32 s97, s98, s0
    s_lshr_b64 s[0:1], s[0:1], 4
    s_and_b32 s97, s97, 15
    s_lshr_b32 s99, s97, 3
    s_xor_b32 s97, s97, s99
    s_lshl_b32 s97, s97, 7
    s_add_u32 m0, s87, 0
    s_add_u32 s89, s97, 0
    buffer_load_dwordx4 v2, s[28:31], s89 offen  lds
    s_waitcnt lgkmcnt(0)
    v_readfirstlane_b32 s93, v140
    s_nop 0
    s_lshl_b32 s93, s93, 16
    s_mul_i32 s99, s97, 3072
    s_sub_u32 s19, s99, s18
    s_add_u32 s99, s99, s18
    s_add_u32 m0, s16, 0
    s_add_u32 s89, s99, 0
    buffer_load_dwordx4 v4, s[32:35], s89 offen  lds
    v_writelane_b32 v7, s93, 15
    v_alignbit_b32 v140, v141, v140, 16
    s_add_u32 m0, s87, 4096
    s_add_u32 s89, s97, 65536
    buffer_load_dwordx4 v2, s[28:31], s89 offen  lds
    v_alignbit_b32 v141, v142, v141, 16
    v_alignbit_b32 v142, v143, v142, 16
    s_add_u32 m0, s16, 24576
    s_add_u32 s89, s99, 2048
    buffer_load_dwordx4 v4, s[32:35], s89 offen  lds
    v_alignbit_b32 v143, v156, v143, 16
    v_alignbit_b32 v144, v145, v144, 16
    v_alignbit_b32 v145, v146, v145, 16
    s_add_u32 m0, s87, 8192
    s_add_u32 s89, s97, 131072
    buffer_load_dwordx4 v2, s[28:31], s89 offen  lds
    v_alignbit_b32 v146, v147, v146, 16
    v_alignbit_b32 v147, v157, v147, 16
    s_add_u32 m0, s16, 49152
    s_add_u32 s89, s99, 4096
    buffer_load_dwordx4 v4, s[32:35], s89 offen  lds
    v_alignbit_b32 v148, v149, v148, 16
    v_alignbit_b32 v149, v150, v149, 16
    s_add_u32 m0, s87, 12288
    s_add_u32 s89, s97, 196608
    buffer_load_dwordx4 v2, s[28:31], s89 offen  lds
    v_alignbit_b32 v150, v151, v150, 16
    v_alignbit_b32 v151, v158, v151, 16
    s_mov_b64 exec, 0xffffffff
    s_add_u32 m0, s88, 0
    s_add_u32 s89, s97, 0
    buffer_load_dwordx4 v3, s[28:31], s89 offen  lds
    s_mov_b64 exec, -1
    v_alignbit_b32 v152, v153, v152, 16
    v_alignbit_b32 v153, v154, v153, 16
    v_alignbit_b32 v154, v155, v154, 16
    s_add_u32 m0, s17, 0
    s_add_u32 s89, s19, 196608
    buffer_load_dwordx4 v4, s[32:35], s89 offen  lds
    v_alignbit_b32 v155, v159, v155, 16
    v_lshlrev_b32 v8, 3, v0
    s_add_u32 m0, s17, 24576
    s_add_u32 s89, s19, 198656
    buffer_load_dwordx4 v4, s[32:35], s89 offen  lds
    s_add_u32 s78, s88, 18432
    v_add_u32 v8, s78, v8
    s_add_u32 m0, s17, 49152
    s_add_u32 s89, s19, 200704
    buffer_load_dwordx4 v4, s[32:35], s89 offen  lds
    v_mov_b32 v156, 0
    v_mov_b32 v157, 0
    s_waitcnt vmcnt(11)
    s_barrier
    s_add_u32 s97, s98, s0
    s_lshr_b64 s[0:1], s[0:1], 4
    s_and_b32 s97, s97, 15
    s_lshr_b32 s99, s97, 3
    s_xor_b32 s97, s97, s99
    s_lshl_b32 s97, s97, 7
    s_add_u32 m0, s87, 18432
    s_add_u32 s89, s97, 0
    buffer_load_dwordx4 v2, s[28:31], s89 offen  lds
    s_mul_i32 s99, s97, 3072
    s_sub_u32 s19, s99, s18
    s_add_u32 s99, s99, s18
    s_add_u32 m0, s16, 8192
    s_add_u32 s89, s99, 0
    buffer_load_dwordx4 v4, s[32:35], s89 offen  lds
    s_add_u32 m0, s87, 22528
    s_add_u32 s89, s97, 65536
    buffer_load_dwordx4 v2, s[28:31], s89 offen  lds
    s_add_u32 m0, s16, 32768
    s_add_u32 s89, s99, 2048
    buffer_load_dwordx4 v4, s[32:35], s89 offen  lds
    s_add_u32 m0, s87, 26624
    s_add_u32 s89, s97, 131072
    buffer_load_dwordx4 v2, s[28:31], s89 offen  lds
    s_add_u32 m0, s16, 57344
    s_add_u32 s89, s99, 4096
    buffer_load_dwordx4 v4, s[32:35], s89 offen  lds
    s_add_u32 m0, s87, 30720
    s_add_u32 s89, s97, 196608
    buffer_load_dwordx4 v2, s[28:31], s89 offen  lds
    s_mov_b64 exec, 0xffffffff
    s_add_u32 m0, s88, 18432
    s_add_u32 s89, s97, 0
    buffer_load_dwordx4 v3, s[28:31], s89 offen  lds
    s_mov_b64 exec, -1
    s_add_u32 m0, s17, 8192
    s_add_u32 s89, s19, 196608
    buffer_load_dwordx4 v4, s[32:35], s89 offen  lds
    s_add_u32 m0, s17, 32768
    s_add_u32 s89, s19, 198656
    buffer_load_dwordx4 v4, s[32:35], s89 offen  lds
    s_add_u32 m0, s17, 57344
    s_add_u32 s89, s19, 200704
    buffer_load_dwordx4 v4, s[32:35], s89 offen  lds
    s_waitcnt vmcnt(11)
    s_barrier
    s_add_u32 s97, s98, s0
    s_lshr_b64 s[0:1], s[0:1], 4
    s_and_b32 s97, s97, 15
    s_lshr_b32 s99, s97, 3
    s_xor_b32 s97, s97, s99
    s_lshl_b32 s97, s97, 7
    s_add_u32 m0, s87, 36864
    s_add_u32 s89, s97, 0
    buffer_load_dwordx4 v2, s[28:31], s89 offen  lds
    s_mul_i32 s99, s97, 3072
    s_sub_u32 s19, s99, s18
    s_add_u32 s99, s99, s18
    s_add_u32 m0, s16, 16384
    s_add_u32 s89, s99, 0
    buffer_load_dwordx4 v4, s[32:35], s89 offen  lds
    s_add_u32 m0, s87, 40960
    s_add_u32 s89, s97, 65536
    buffer_load_dwordx4 v2, s[28:31], s89 offen  lds
    s_add_u32 m0, s16, 40960
    s_add_u32 s89, s99, 2048
    buffer_load_dwordx4 v4, s[32:35], s89 offen  lds
    s_add_u32 m0, s87, 45056
    s_add_u32 s89, s97, 131072
    buffer_load_dwordx4 v2, s[28:31], s89 offen  lds
    s_add_u32 m0, s16, 65536
    s_add_u32 s89, s99, 4096
    buffer_load_dwordx4 v4, s[32:35], s89 offen  lds
    s_add_u32 m0, s87, 49152
    s_add_u32 s89, s97, 196608
    buffer_load_dwordx4 v2, s[28:31], s89 offen  lds
    s_mov_b64 exec, 0xffffffff
    s_add_u32 m0, s88, 36864
    s_add_u32 s89, s97, 0
    buffer_load_dwordx4 v3, s[28:31], s89 offen  lds
    s_mov_b64 exec, -1
    s_add_u32 m0, s17, 16384
    s_add_u32 s89, s19, 196608
    buffer_load_dwordx4 v4, s[32:35], s89 offen  lds
    s_add_u32 m0, s17, 40960
    s_add_u32 s89, s19, 198656
    buffer_load_dwordx4 v4, s[32:35], s89 offen  lds
    s_add_u32 m0, s17, 65536
    s_add_u32 s89, s19, 200704
    buffer_load_dwordx4 v4, s[32:35], s89 offen  lds
    s_waitcnt vmcnt(11)
    s_barrier
    s_add_u32 s97, s98, s0
    s_lshr_b64 s[0:1], s[0:1], 4
    s_and_b32 s97, s97, 15
    s_lshr_b32 s99, s97, 3
    s_xor_b32 s97, s97, s99
    s_lshl_b32 s97, s97, 7
    s_add_u32 m0, s87, 0
    s_add_u32 s89, s97, 0
    buffer_load_dwordx4 v2, s[28:31], s89 offen  lds
    s_mul_i32 s99, s97, 3072
    s_sub_u32 s19, s99, s18
    s_add_u32 s99, s99, s18
    s_add_u32 m0, s16, 0
    s_add_u32 s89, s99, 0
    buffer_load_dwordx4 v4, s[32:35], s89 offen  lds
    s_add_u32 m0, s87, 4096
    s_add_u32 s89, s97, 65536
    buffer_load_dwordx4 v2, s[28:31], s89 offen  lds
    s_add_u32 m0, s16, 24576
    s_add_u32 s89, s99, 2048
    buffer_load_dwordx4 v4, s[32:35], s89 offen  lds
    s_add_u32 m0, s87, 8192
    s_add_u32 s89, s97, 131072
    buffer_load_dwordx4 v2, s[28:31], s89 offen  lds
    s_add_u32 m0, s16, 49152
    s_add_u32 s89, s99, 4096
    buffer_load_dwordx4 v4, s[32:35], s89 offen  lds
    s_add_u32 m0, s87, 12288
    s_add_u32 s89, s97, 196608
    buffer_load_dwordx4 v2, s[28:31], s89 offen  lds
    s_mov_b64 exec, 0xffffffff
    s_add_u32 m0, s88, 0
    s_add_u32 s89, s97, 0
    buffer_load_dwordx4 v3, s[28:31], s89 offen  lds
    s_mov_b64 exec, -1
    s_add_u32 m0, s17, 0
    s_add_u32 s89, s19, 196608
    buffer_load_dwordx4 v4, s[32:35], s89 offen  lds
    s_add_u32 m0, s17, 24576
    s_add_u32 s89, s19, 198656
    buffer_load_dwordx4 v4, s[32:35], s89 offen  lds
    s_add_u32 m0, s17, 49152
    s_add_u32 s89, s19, 200704
    buffer_load_dwordx4 v4, s[32:35], s89 offen  lds
    s_mov_b64 exec, 0xff
    buffer_load_dword v136, v33, s[68:71], 0 offen sc1
    buffer_load_dword v137, v34, s[52:55], 0 offen sc1
    s_mov_b64 exec, -1
    s_waitcnt vmcnt(13)
    s_barrier
    s_waitcnt vmcnt(0)
    s_branch LA_j
LA_c1:
    s_waitcnt vmcnt(7)
    s_barrier
    s_mov_b64 exec, 0xffffffff
    s_add_u32 m0, s88, 18432
    s_add_u32 s89, s97, 0
    buffer_load_dwordx4 v3, s[28:31], s89 offen  lds
    s_mov_b64 exec, -1
    s_add_u32 m0, s17, 8192
    s_add_u32 s89, s19, 196608
    buffer_load_dwordx4 v4, s[32:35], s89 offen  lds
    s_add_u32 m0, s17, 32768
    s_add_u32 s89, s19, 198656
    buffer_load_dwordx4 v4, s[32:35], s89 offen  lds
    s_add_u32 m0, s17, 57344
    s_add_u32 s89, s19, 200704
    buffer_load_dwordx4 v4, s[32:35], s89 offen  lds
    s_add_u32 s97, s98, s0
    s_lshr_b64 s[0:1], s[0:1], 4
    s_and_b32 s97, s97, 15
    s_lshr_b32 s99, s97, 3
    s_xor_b32 s97, s97, s99
    s_lshl_b32 s97, s97, 7
    s_add_u32 m0, s87, 36864
    s_add_u32 s89, s97, 0
    buffer_load_dwordx4 v2, s[28:31], s89 offen  lds
    s_mul_i32 s99, s97, 3072
    s_sub_u32 s19, s99, s18
    s_add_u32 s99, s99, s18
    s_add_u32 m0, s16, 16384
    s_add_u32 s89, s99, 0
    buffer_load_dwordx4 v4, s[32:35], s89 offen  lds
    s_add_u32 m0, s87, 40960
    s_add_u32 s89, s97, 65536
    buffer_load_dwordx4 v2, s[28:31], s89 offen  lds
    s_add_u32 m0, s16, 40960
    s_add_u32 s89, s99, 2048
    buffer_load_dwordx4 v4, s[32:35], s89 offen  lds
    s_add_u32 m0, s87, 45056
    s_add_u32 s89, s97, 131072
    buffer_load_dwordx4 v2, s[28:31], s89 offen  lds
    s_add_u32 m0, s16, 65536
    s_add_u32 s89, s99, 4096
    buffer_load_dwordx4 v4, s[32:35], s89 offen  lds
    s_add_u32 m0, s87, 49152
    s_add_u32 s89, s97, 196608
    buffer_load_dwordx4 v2, s[28:31], s89 offen  lds
    s_mov_b64 exec, 0xffffffff
    s_add_u32 m0, s88, 36864
    s_add_u32 s89, s97, 0
    buffer_load_dwordx4 v3, s[28:31], s89 offen  lds
    s_mov_b64 exec, -1
    s_add_u32 m0, s17, 16384
    s_add_u32 s89, s19, 196608
    buffer_load_dwordx4 v4, s[32:35], s89 offen  lds
    s_add_u32 m0, s17, 40960
    s_add_u32 s89, s19, 198656
    buffer_load_dwordx4 v4, s[32:35], s89 offen  lds
    s_add_u32 m0, s17, 65536
    s_add_u32 s89, s19, 200704
    buffer_load_dwordx4 v4, s[32:35], s89 offen  lds
    s_waitcnt vmcnt(11)
    s_barrier
    s_add_u32 s97, s98, s0
    s_lshr_b64 s[0:1], s[0:1], 4
    s_and_b32 s97, s97, 15
    s_lshr_b32 s99, s97, 3
    s_xor_b32 s97, s97, s99
    s_lshl_b32 s97, s97, 7
    s_add_u32 m0, s87, 0
    s_add_u32 s89, s97, 0
    buffer_load_dwordx4 v2, s[28:31], s89 offen  lds
    s_mul_i32 s99, s97, 3072
    s_sub_u32 s19, s99, s18
    s_add_u32 s99, s99, s18
    s_add_u32 m0, s16, 0
    s_add_u32 s89, s99, 0
    buffer_load_dwordx4 v4, s[32:35], s89 offen  lds
    s_add_u32 m0, s87, 4096
    s_add_u32 s89, s97, 65536
    buffer_load_dwordx4 v2, s[28:31], s89 offen  lds
    s_add_u32 m0, s16, 24576
    s_add_u32 s89, s99, 2048
    buffer_load_dwordx4 v4, s[32:35], s89 offen  lds
    s_add_u32 m0, s87, 8192
    s_add_u32 s89, s97, 131072
    buffer_load_dwordx4 v2, s[28:31], s89 offen  lds
    s_add_u32 m0, s16, 49152
    s_add_u32 s89, s99, 4096
    buffer_load_dwordx4 v4, s[32:35], s89 offen  lds
    s_add_u32 m0, s87, 12288
    s_add_u32 s89, s97, 196608
    buffer_load_dwordx4 v2, s[28:31], s89 offen  lds
    s_mov_b64 exec, 0xffffffff
    s_add_u32 m0, s88, 0
    s_add_u32 s89, s97, 0
    buffer_load_dwordx4 v3, s[28:31], s89 offen  lds
    s_mov_b64 exec, -1
    s_add_u32 m0, s17, 0
    s_add_u32 s89, s19, 196608
    buffer_load_dwordx4 v4, s[32:35], s89 offen  lds
    s_add_u32 m0, s17, 24576
    s_add_u32 s89, s19, 198656
    buffer_load_dwordx4 v4, s[32:35], s89 offen  lds
    s_add_u32 m0, s17, 49152
    s_add_u32 s89, s19, 200704
    buffer_load_dwordx4 v4, s[32:35], s89 offen  lds
    s_waitcnt vmcnt(11)
    s_barrier
    s_add_u32 m0, s86, 129536
    s_mov_b32 s89, 0
    buffer_load_dwordx4 v10, s[36:39], s89 offen nt lds
    s_add_u32 m0, s86, 145920
    s_mov_b32 s89, 0
    buffer_load_dwordx4 v10, s[40:43], s89 offen nt lds
    s_add_u32 m0, s86, 133632
    s_mov_b32 s89, 65536
    buffer_load_dwordx4 v10, s[36:39], s89 offen nt lds
    s_add_u32 m0, s86, 150016
    s_mov_b32 s89, 65536
    buffer_load_dwordx4 v10, s[40:43], s89 offen nt lds
    s_add_u32 m0, s86, 137728
    s_mov_b32 s89, 131072
    buffer_load_dwordx4 v10, s[36:39], s89 offen nt lds
    s_add_u32 m0, s86, 154112
    s_mov_b32 s89, 131072
    buffer_load_dwordx4 v10, s[40:43], s89 offen nt lds
    s_add_u32 m0, s86, 141824
    s_mov_b32 s89, 196608
    buffer_load_dwordx4 v10, s[36:39], s89 offen nt lds
    s_add_u32 m0, s86, 158208
    s_mov_b32 s89, 196608
    buffer_load_dwordx4 v10, s[40:43], s89 offen nt lds
    s_mov_b64 exec, 0xff
    s_lshl_b32 s82, s3, 7
    s_add_u32 m0, s82, 129024
    s_mov_b32 s89, 0
    buffer_load_dwordx4 v11, s[36:39], s89 offen nt lds
    s_lshl_b32 s83, s74, 9
    s_add_u32 s83, s83, s82
    s_and_b32 s89, s3, 2
    s_lshl_b32 s89, s89, 3
    s_add_u32 s82, s82, s89
    s_add_u32 m0, s82, 162816
    s_add_u32 s89, s83, 0
    buffer_load_dwordx4 v15, s[44:47], s89 offen  lds
    s_mov_b64 exec, -1
    s_add_u32 s97, s98, s0
    s_lshr_b64 s[0:1], s[0:1], 4
    s_and_b32 s97, s97, 15
    s_lshr_b32 s99, s97, 3
    s_xor_b32 s97, s97, s99
    s_lshl_b32 s97, s97, 7
    s_add_u32 m0, s87, 18432
    s_add_u32 s89, s97, 0
    buffer_load_dwordx4 v2, s[28:31], s89 offen  lds
    s_mul_i32 s99, s97, 3072
    s_sub_u32 s19, s99, s18
    s_add_u32 s99, s99, s18
    s_add_u32 m0, s16, 8192
    s_add_u32 s89, s99, 0
    buffer_load_dwordx4 v4, s[32:35], s89 offen  lds
    s_add_u32 m0, s87, 22528
    s_add_u32 s89, s97, 65536
    buffer_load_dwordx4 v2, s[28:31], s89 offen  lds
    s_add_u32 m0, s16, 32768
    s_add_u32 s89, s99, 2048
    buffer_load_dwordx4 v4, s[32:35], s89 offen  lds
    s_add_u32 m0, s87, 26624
    s_add_u32 s89, s97, 131072
    buffer_load_dwordx4 v2, s[28:31], s89 offen  lds
    s_add_u32 m0, s16, 57344
    s_add_u32 s89, s99, 4096
    buffer_load_dwordx4 v4, s[32:35], s89 offen  lds
    s_add_u32 m0, s87, 30720
    s_add_u32 s89, s97, 196608
    buffer_load_dwordx4 v2, s[28:31], s89 offen  lds
    s_waitcnt vmcnt(17)
    s_barrier
    s_mov_b64 exec, 0xffffffff
    s_add_u32 m0, s88, 18432
    s_add_u32 s89, s97, 0
    buffer_load_dwordx4 v3, s[28:31], s89 offen  lds
    s_mov_b64 exec, -1
    s_add_u32 m0, s17, 8192
    s_add_u32 s89, s19, 196608
    buffer_load_dwordx4 v4, s[32:35], s89 offen  lds
    s_add_u32 m0, s17, 32768
    s_add_u32 s89, s19, 198656
    buffer_load_dwordx4 v4, s[32:35], s89 offen  lds
    s_add_u32 m0, s17, 57344
    s_add_u32 s89, s19, 200704
    buffer_load_dwordx4 v4, s[32:35], s89 offen  lds
    s_add_u32 s97, s98, s0
    s_lshr_b64 s[0:1], s[0:1], 4
    s_and_b32 s97, s97, 15
    s_lshr_b32 s99, s97, 3
    s_xor_b32 s97, s97, s99
    s_lshl_b32 s97, s97, 7
    s_add_u32 m0, s87, 36864
    s_add_u32 s89, s97, 0
    buffer_load_dwordx4 v2, s[28:31], s89 offen  lds
    s_mul_i32 s99, s97, 3072
    s_sub_u32 s19, s99, s18
    s_add_u32 s99, s99, s18
    s_add_u32 m0, s16, 16384
    s_add_u32 s89, s99, 0
    buffer_load_dwordx4 v4, s[32:35], s89 offen  lds
    s_add_u32 m0, s87, 40960
    s_add_u32 s89, s97, 65536
    buffer_load_dwordx4 v2, s[28:31], s89 offen  lds
    s_add_u32 m0, s16, 40960
    s_add_u32 s89, s99, 2048
    buffer_load_dwordx4 v4, s[32:35], s89 offen  lds
    s_add_u32 m0, s87, 45056
    s_add_u32 s89, s97, 131072
    buffer_load_dwordx4 v2, s[28:31], s89 offen  lds
    s_add_u32 m0, s16, 65536
    s_add_u32 s89, s99, 4096
    buffer_load_dwordx4 v4, s[32:35], s89 offen  lds
    s_add_u32 m0, s87, 49152
    s_add_u32 s89, s97, 196608
    buffer_load_dwordx4 v2, s[28:31], s89 offen  lds
    s_mov_b64 exec, 0xffffffff
    s_add_u32 m0, s88, 36864
    s_add_u32 s89, s97, 0
    buffer_load_dwordx4 v3, s[28:31], s89 offen  lds
    s_mov_b64 exec, -1
    s_add_u32 m0, s17, 16384
    s_add_u32 s89, s19, 196608
    buffer_load_dwordx4 v4, s[32:35], s89 offen  lds
    s_add_u32 m0, s17, 40960
    s_add_u32 s89, s19, 198656
    buffer_load_dwordx4 v4, s[32:35], s89 offen  lds
    s_add_u32 m0, s17, 65536
    s_add_u32 s89, s19, 200704
    buffer_load_dwordx4 v4, s[32:35], s89 offen  lds
    s_waitcnt vmcnt(11)
    s_barrier
    s_add_u32 s97, s98, s0
    s_lshr_b64 s[0:1], s[0:1], 4
    s_and_b32 s97, s97, 15
    s_lshr_b32 s99, s97, 3
    s_xor_b32 s97, s97, s99
    s_lshl_b32 s97, s97, 7
    s_add_u32 m0, s87, 0
    s_add_u32 s89, s97, 0
    buffer_load_dwordx4 v2, s[28:31], s89 offen  lds
    ds_read_b128 v[84:87], v35 offset:0
    ds_read_b128 v[88:91], v35 offset:16
    s_mul_i32 s99, s97, 3072
    s_sub_u32 s19, s99, s18
    s_add_u32 s99, s99, s18
    s_add_u32 m0, s16, 0
    s_add_u32 s89, s99, 0
    buffer_load_dwordx4 v4, s[32:35], s89 offen  lds
    ds_read_b128 v[92:95], v35 offset:32
    s_add_u32 m0, s87, 4096
    s_add_u32 s89, s97, 65536
    buffer_load_dwordx4 v2, s[28:31], s89 offen  lds
    ds_read_b128 v[96:99], v35 offset:48
    ds_read_b128 v[40:43], v233 offset:0
    s_add_u32 m0, s16, 24576
    s_add_u32 s89, s99, 2048
    buffer_load_dwordx4 v4, s[32:35], s89 offen  lds
    ds_read_b128 v[44:47], v232 offset:256
    s_add_u32 m0, s87, 8192
    s_add_u32 s89, s97, 131072
    buffer_load_dwordx4 v2, s[28:31], s89 offen  lds
    ds_read_b128 v[48:51], v233 offset:256
    s_add_u32 m0, s16, 49152
    s_add_u32 s89, s99, 4096
    buffer_load_dwordx4 v4, s[32:35], s89 offen  lds
    ds_read_b128 v[52:55], v16 offset:512
    ds_read_b128 v[56:59], v231 offset:512
    s_add_u32 m0, s87, 12288
    s_add_u32 s89, s97, 196608
    buffer_load_dwordx4 v2, s[28:31], s89 offen  lds
    ds_read_b128 v[60:63], v16 offset:768
    s_mov_b64 exec, 0xffffffff
    s_add_u32 m0, s88, 0
    s_add_u32 s89, s97, 0
    buffer_load_dwordx4 v3, s[28:31], s89 offen  lds
    s_mov_b64 exec, -1
    ds_read_b128 v[64:67], v231 offset:768
    s_add_u32 m0, s17, 0
    s_add_u32 s89, s19, 196608
    buffer_load_dwordx4 v4, s[32:35], s89 offen  lds
    ds_read_b128 v[68:71], v16 offset:16896
    ds_read_b128 v[72:75], v231 offset:16896
    s_add_u32 m0, s17, 24576
    s_add_u32 s89, s19, 198656
    buffer_load_dwordx4 v4, s[32:35], s89 offen  lds
    ds_read_b128 v[76:79], v16 offset:17152
    s_add_u32 m0, s17, 49152
    s_add_u32 s89, s19, 200704
    buffer_load_dwordx4 v4, s[32:35], s89 offen  lds
    ds_read_b128 v[80:83], v231 offset:17152
    s_waitcnt vmcnt(11)
    s_waitcnt lgkmcnt(0)
    s_barrier
    s_add_u32 s97, s98, s0
    s_lshr_b64 s[0:1], s[0:1], 4
    s_and_b32 s97, s97, 15
    s_lshr_b32 s99, s97, 3
    s_xor_b32 s97, s97, s99
    s_lshl_b32 s97, s97, 7
    s_add_u32 m0, s87, 18432
    s_add_u32 s89, s97, 0
    buffer_load_dwordx4 v2, s[28:31], s89 offen  lds
    v_lshlrev_b32 v116, 16, v40
    v_lshlrev_b32 v117, 16, v44
    v_lshlrev_b32 v118, 16, v48
    v_lshlrev_b32 v119, 16, v52
    v_lshlrev_b32 v120, 16, v56
    v_lshlrev_b32 v121, 16, v60
    s_mul_i32 s99, s97, 3072
    s_sub_u32 s19, s99, s18
    s_add_u32 s99, s99, s18
    s_add_u32 m0, s16, 8192
    s_add_u32 s89, s99, 0
    buffer_load_dwordx4 v4, s[32:35], s89 offen  lds
    v_lshlrev_b32 v122, 16, v64
    v_lshlrev_b32 v127, 16, v84
    v_and_b32 v128, 0xffff0000, v84
    v_lshlrev_b32 v129, 16, v85
    v_and_b32 v130, 0xffff0000, v85
    v_lshlrev_b32 v123, 16, v68
    s_add_u32 m0, s87, 22528
    s_add_u32 s89, s97, 65536
    buffer_load_dwordx4 v2, s[28:31], s89 offen  lds
    v_lshlrev_b32 v124, 16, v72
    v_lshlrev_b32 v125, 16, v76
    v_lshlrev_b32 v126, 16, v80
    v_mul_f32 v131, v116, v130
    v_mul_f32 v132, v117, v130
    s_add_u32 m0, s16, 32768
    s_add_u32 s89, s99, 2048
    buffer_load_dwordx4 v4, s[32:35], s89 offen  lds
    v_mul_f32 v133, v118, v130
    v_mul_f32 v134, v119, v130
    v_fmac_f32 v131, v117, v129
    v_fmac_f32 v132, v118, v129
    v_fmac_f32 v133, v119, v129
    v_fmac_f32 v134, v120, v129
    s_add_u32 m0, s87, 26624
    s_add_u32 s89, s97, 131072
    buffer_load_dwordx4 v2, s[28:31], s89 offen  lds
    v_fmac_f32 v131, v118, v128
    v_fmac_f32 v132, v119, v128
    v_fmac_f32 v133, v120, v128
    v_fmac_f32 v134, v121, v128
    v_fmac_f32 v131, v119, v127
    v_fmac_f32 v132, v120, v127
    s_add_u32 m0, s16, 57344
    s_add_u32 s89, s99, 4096
    buffer_load_dwordx4 v4, s[32:35], s89 offen  lds
    v_fmac_f32 v133, v121, v127
    v_fmac_f32 v134, v122, v127
    v_mul_f32 v131, v131, v123
    v_mul_f32 v132, v132, v124
    v_mul_f32 v133, v133, v125
    s_add_u32 m0, s87, 30720
    s_add_u32 s89, s97, 196608
    buffer_load_dwordx4 v2, s[28:31], s89 offen  lds
    v_mul_f32 v134, v134, v126
    v_cvt_pk_bf16_f32 v102, v134, v133
    v_cvt_pk_bf16_f32 v103, v132, v131
    v_lshlrev_b32 v116, 16, v42
    v_lshlrev_b32 v117, 16, v46
    v_lshlrev_b32 v118, 16, v50
    s_mov_b64 exec, 0xffffffff
    s_add_u32 m0, s88, 18432
    s_add_u32 s89, s97, 0
    buffer_load_dwordx4 v3, s[28:31], s89 offen  lds
    s_mov_b64 exec, -1
    v_lshlrev_b32 v119, 16, v54
    v_lshlrev_b32 v120, 16, v58
    v_lshlrev_b32 v121, 16, v62
    v_lshlrev_b32 v122, 16, v66
    v_lshlrev_b32 v127, 16, v92
    v_and_b32 v128, 0xffff0000, v92
    s_add_u32 m0, s17, 8192
    s_add_u32 s89, s19, 196608
    buffer_load_dwordx4 v4, s[32:35], s89 offen  lds
    v_lshlrev_b32 v129, 16, v93
    v_and_b32 v130, 0xffff0000, v93
    v_lshlrev_b32 v123, 16, v70
    v_lshlrev_b32 v124, 16, v74
    v_lshlrev_b32 v125, 16, v78
    s_add_u32 m0, s17, 32768
    s_add_u32 s89, s19, 198656
    buffer_load_dwordx4 v4, s[32:35], s89 offen  lds
    v_lshlrev_b32 v126, 16, v82
    v_mul_f32 v131, v116, v130
    v_mul_f32 v132, v117, v130
    v_mul_f32 v133, v118, v130
    v_mul_f32 v134, v119, v130
    v_fmac_f32 v131, v117, v129
    s_add_u32 m0, s17, 57344
    s_add_u32 s89, s19, 200704
    buffer_load_dwordx4 v4, s[32:35], s89 offen  lds
    v_fmac_f32 v132, v118, v129
    v_fmac_f32 v133, v119, v129
    v_fmac_f32 v134, v120, v129
    v_fmac_f32 v131, v118, v128
    v_fmac_f32 v132, v119, v128
    s_waitcnt vmcnt(11)
    s_barrier
    s_add_u32 s97, s98, s0
    s_lshr_b64 s[0:1], s[0:1], 4
    s_and_b32 s97, s97, 15
    s_lshr_b32 s99, s97, 3
    s_xor_b32 s97, s97, s99
    s_lshl_b32 s97, s97, 7
    s_add_u32 m0, s87, 36864
    s_add_u32 s89, s97, 0
    buffer_load_dwordx4 v2, s[28:31], s89 offen  lds
    v_fmac_f32 v133, v120, v128
    v_fmac_f32 v134, v121, v128
    v_fmac_f32 v131, v119, v127
    v_fmac_f32 v132, v120, v127
    v_fmac_f32 v133, v121, v127
    v_fmac_f32 v134, v122, v127
    s_mul_i32 s99, s97, 3072
    s_sub_u32 s19, s99, s18
    s_add_u32 s99, s99, s18
    s_add_u32 m0, s16, 16384
    s_add_u32 s89, s99, 0
    buffer_load_dwordx4 v4, s[32:35], s89 offen  lds
    v_mul_f32 v131, v131, v123
    v_mul_f32 v132, v132, v124
    v_mul_f32 v133, v133, v125
    v_mul_f32 v134, v134, v126
    v_cvt_pk_bf16_f32 v100, v134, v133
    v_cvt_pk_bf16_f32 v101, v132, v131
    s_add_u32 m0, s87, 40960
    s_add_u32 s89, s97, 65536
    buffer_load_dwordx4 v2, s[28:31], s89 offen  lds
    v_permlane32_swap_b32 v102, v100
    v_permlane32_swap_b32 v103, v101
    s_mov_b32 s89, 0
    buffer_store_dwordx4 v[100:103], v12, s[52:55], s89 offen sc1
    v_and_b32 v116, 0xffff0000, v40
    v_and_b32 v117, 0xffff0000, v44
    s_add_u32 m0, s16, 40960
    s_add_u32 s89, s99, 2048
    buffer_load_dwordx4 v4, s[32:35], s89 offen  lds
    v_and_b32 v118, 0xffff0000, v48
    v_and_b32 v119, 0xffff0000, v52
    v_and_b32 v120, 0xffff0000, v56
    v_and_b32 v121, 0xffff0000, v60
    v_and_b32 v122, 0xffff0000, v64
    v_lshlrev_b32 v127, 16, v86
    s_add_u32 m0, s87, 45056
    s_add_u32 s89, s97, 131072
    buffer_load_dwordx4 v2, s[28:31], s89 offen  lds
    v_and_b32 v128, 0xffff0000, v86
    v_lshlrev_b32 v129, 16, v87
    v_and_b32 v130, 0xffff0000, v87
    v_and_b32 v123, 0xffff0000, v68
    v_and_b32 v124, 0xffff0000, v72
    v_and_b32 v125, 0xffff0000, v76
    s_add_u32 m0, s16, 65536
    s_add_u32 s89, s99, 4096
    buffer_load_dwordx4 v4, s[32:35], s89 offen  lds
    v_and_b32 v126, 0xffff0000, v80
    v_mul_f32 v131, v116, v130
    v_mul_f32 v132, v117, v130
    v_mul_f32 v133, v118, v130
    v_mul_f32 v134, v119, v130
    s_add_u32 m0, s87, 49152
    s_add_u32 s89, s97, 196608
    buffer_load_dwordx4 v2, s[28:31], s89 offen  lds
    v_fmac_f32 v131, v117, v129
    v_fmac_f32 v132, v118, v129
    v_fmac_f32 v133, v119, v129
    v_fmac_f32 v134, v120, v129
    v_fmac_f32 v131, v118, v128
    v_fmac_f32 v132, v119, v128
    s_mov_b64 exec, 0xffffffff
    s_add_u32 m0, s88, 36864
    s_add_u32 s89, s97, 0
    buffer_load_dwordx4 v3, s[28:31], s89 offen  lds
    s_mov_b64 exec, -1
    v_fmac_f32 v133, v120, v128
    v_fmac_f32 v134, v121, v128
    v_fmac_f32 v131, v119, v127
    v_fmac_f32 v132, v120, v127
    v_fmac_f32 v133, v121, v127
    v_fmac_f32 v134, v122, v127
    s_add_u32 m0, s17, 16384
    s_add_u32 s89, s19, 196608
    buffer_load_dwordx4 v4, s[32:35], s89 offen  lds
    v_mul_f32 v131, v131, v123
    v_mul_f32 v132, v132, v124
    v_mul_f32 v133, v133, v125
    v_mul_f32 v134, v134, v126
    v_cvt_pk_bf16_f32 v106, v134, v133
    s_add_u32 m0, s17, 40960
    s_add_u32 s89, s19, 198656
    buffer_load_dwordx4 v4, s[32:35], s89 offen  lds
    v_cvt_pk_bf16_f32 v107, v132, v131
    v_and_b32 v116, 0xffff0000, v42
    v_and_b32 v117, 0xffff0000, v46
    v_and_b32 v118, 0xffff0000, v50
    v_and_b32 v119, 0xffff0000, v54
    v_and_b32 v120, 0xffff0000, v58
    s_add_u32 m0, s17, 65536
    s_add_u32 s89, s19, 200704
    buffer_load_dwordx4 v4, s[32:35], s89 offen  lds
    v_and_b32 v121, 0xffff0000, v62
    v_and_b32 v122, 0xffff0000, v66
    v_lshlrev_b32 v127, 16, v94
    v_and_b32 v128, 0xffff0000, v94
    v_lshlrev_b32 v129, 16, v95
    s_waitcnt vmcnt(12)
    s_barrier
    s_add_u32 s97, s98, s0
    s_lshr_b64 s[0:1], s[0:1], 4
    s_and_b32 s97, s97, 15
    s_lshr_b32 s99, s97, 3
    s_xor_b32 s97, s97, s99
    s_lshl_b32 s97, s97, 7
    s_add_u32 m0, s87, 0
    s_add_u32 s89, s97, 0
    buffer_load_dwordx4 v2, s[28:31], s89 offen  lds
    v_and_b32 v130, 0xffff0000, v95
    v_and_b32 v123, 0xffff0000, v70
    v_and_b32 v124, 0xffff0000, v74
    v_and_b32 v125, 0xffff0000, v78
    v_and_b32 v126, 0xffff0000, v82
    v_mul_f32 v131, v116, v130
    s_mul_i32 s99, s97, 3072
    s_sub_u32 s19, s99, s18
    s_add_u32 s99, s99, s18
    s_add_u32 m0, s16, 0
    s_add_u32 s89, s99, 0
    buffer_load_dwordx4 v4, s[32:35], s89 offen  lds
    v_mul_f32 v132, v117, v130
    v_mul_f32 v133, v118, v130
    v_mul_f32 v134, v119, v130
    v_fmac_f32 v131, v117, v129
    v_fmac_f32 v132, v118, v129
    v_fmac_f32 v133, v119, v129
    s_add_u32 m0, s87, 4096
    s_add_u32 s89, s97, 65536
    buffer_load_dwordx4 v2, s[28:31], s89 offen  lds
    v_fmac_f32 v134, v120, v129
    v_fmac_f32 v131, v118, v128
    v_fmac_f32 v132, v119, v128
    v_fmac_f32 v133, v120, v128
    v_fmac_f32 v134, v121, v128
    s_add_u32 m0, s16, 24576
    s_add_u32 s89, s99, 2048
    buffer_load_dwordx4 v4, s[32:35], s89 offen  lds
    v_fmac_f32 v131, v119, v127
    v_fmac_f32 v132, v120, v127
    v_fmac_f32 v133, v121, v127
    v_fmac_f32 v134, v122, v127
    v_mul_f32 v131, v131, v123
    v_mul_f32 v132, v132, v124
    s_add_u32 m0, s87, 8192
    s_add_u32 s89, s97, 131072
    buffer_load_dwordx4 v2, s[28:31], s89 offen  lds
    v_mul_f32 v133, v133, v125
    v_mul_f32 v134, v134, v126
    v_cvt_pk_bf16_f32 v104, v134, v133
    v_cvt_pk_bf16_f32 v105, v132, v131
    s_nop 0
    v_permlane32_swap_b32 v106, v104
    v_permlane32_swap_b32 v107, v105
    s_add_u32 m0, s16, 49152
    s_add_u32 s89, s99, 4096
    buffer_load_dwordx4 v4, s[32:35], s89 offen  lds
    s_mov_b32 s89, 16384
    buffer_store_dwordx4 v[104:107], v12, s[52:55], s89 offen sc1
    v_lshlrev_b32 v116, 16, v41
    v_lshlrev_b32 v117, 16, v45
    v_lshlrev_b32 v118, 16, v49
    v_lshlrev_b32 v119, 16, v53
    s_add_u32 m0, s87, 12288
    s_add_u32 s89, s97, 196608
    buffer_load_dwordx4 v2, s[28:31], s89 offen  lds
    v_lshlrev_b32 v120, 16, v57
    v_lshlrev_b32 v121, 16, v61
    v_lshlrev_b32 v122, 16, v65
    v_lshlrev_b32 v127, 16, v88
    v_and_b32 v128, 0xffff0000, v88
    v_lshlrev_b32 v129, 16, v89
    s_mov_b64 exec, 0xffffffff
    s_add_u32 m0, s88, 0
    s_add_u32 s89, s97, 0
    buffer_load_dwordx4 v3, s[28:31], s89 offen  lds
    s_mov_b64 exec, -1
    v_and_b32 v130, 0xffff0000, v89
    v_lshlrev_b32 v123, 16, v69
    v_lshlrev_b32 v124, 16, v73
    v_lshlrev_b32 v125, 16, v77
    v_lshlrev_b32 v126, 16, v81
    v_mul_f32 v131, v116, v130
    s_add_u32 m0, s17, 0
    s_add_u32 s89, s19, 196608
    buffer_load_dwordx4 v4, s[32:35], s89 offen  lds
    v_mul_f32 v132, v117, v130
    v_mul_f32 v133, v118, v130
    v_mul_f32 v134, v119, v130
    v_fmac_f32 v131, v117, v129
    v_fmac_f32 v132, v118, v129
    s_add_u32 m0, s17, 24576
    s_add_u32 s89, s19, 198656
    buffer_load_dwordx4 v4, s[32:35], s89 offen  lds
    v_fmac_f32 v133, v119, v129
    v_fmac_f32 v134, v120, v129
    v_fmac_f32 v131, v118, v128
    v_fmac_f32 v132, v119, v128
    v_fmac_f32 v133, v120, v128
    v_fmac_f32 v134, v121, v128
    s_add_u32 m0, s17, 49152
    s_add_u32 s89, s19, 200704
    buffer_load_dwordx4 v4, s[32:35], s89 offen  lds
    v_fmac_f32 v131, v119, v127
    v_fmac_f32 v132, v120, v127
    v_fmac_f32 v133, v121, v127
    v_fmac_f32 v134, v122, v127
    v_mul_f32 v131, v131, v123
    s_waitcnt vmcnt(12)
    s_barrier
    s_add_u32 m0, s94, 32
    s_lshl_b32 s89, s90, 12
    buffer_load_dwordx4 v15, s[48:51], s89 offen offset:0 nt lds
    v_mul_f32 v132, v132, v124
    v_mul_f32 v133, v133, v125
    v_mul_f32 v134, v134, v126
    v_cvt_pk_bf16_f32 v110, v134, v133
    s_add_u32 m0, s94, 32
    s_lshl_b32 s89, s90, 12
    buffer_load_dwordx4 v15, s[48:51], s89 offen offset:1024 nt lds
    v_cvt_pk_bf16_f32 v111, v132, v131
    v_lshlrev_b32 v116, 16, v43
    v_lshlrev_b32 v117, 16, v47
    v_lshlrev_b32 v118, 16, v51
    s_add_u32 m0, s94, 32
    s_lshl_b32 s89, s90, 12
    buffer_load_dwordx4 v15, s[48:51], s89 offen offset:2048 nt lds
    v_lshlrev_b32 v119, 16, v55
    v_lshlrev_b32 v120, 16, v59
    v_lshlrev_b32 v121, 16, v63
    v_lshlrev_b32 v122, 16, v67
    s_add_u32 m0, s94, 32
    s_lshl_b32 s89, s90, 12
    buffer_load_dwordx4 v15, s[48:51], s89 offen offset:3072 nt lds
    v_lshlrev_b32 v127, 16, v96
    v_and_b32 v128, 0xffff0000, v96
    v_lshlrev_b32 v129, 16, v97
    v_and_b32 v130, 0xffff0000, v97
    buffer_load_dwordx4 v[212:215], v9, s[56:59], 0 offen offset:0 nt
    v_lshlrev_b32 v123, 16, v71
    v_lshlrev_b32 v124, 16, v75
    v_lshlrev_b32 v125, 16, v79
    v_lshlrev_b32 v126, 16, v83
    buffer_load_dwordx4 v[216:219], v9, s[56:59], 0 offen offset:2048 nt
    v_mul_f32 v131, v116, v130
    v_mul_f32 v132, v117, v130
    v_mul_f32 v133, v118, v130
    v_mul_f32 v134, v119, v130
    buffer_load_dwordx4 v[220:223], v9, s[56:59], s96 offen offset:0 nt
    v_fmac_f32 v131, v117, v129
    v_fmac_f32 v132, v118, v129
    v_fmac_f32 v133, v119, v129
    v_fmac_f32 v134, v120, v129
    buffer_load_dwordx4 v[224:227], v9, s[56:59], s96 offen offset:2048 nt
    v_fmac_f32 v131, v118, v128
    v_fmac_f32 v132, v119, v128
    v_fmac_f32 v133, v120, v128
    s_add_u32 s97, s98, s0
    s_lshr_b64 s[0:1], s[0:1], 4
    s_and_b32 s97, s97, 15
    s_lshr_b32 s99, s97, 3
    s_xor_b32 s97, s97, s99
    s_lshl_b32 s97, s97, 7
    s_add_u32 m0, s87, 18432
    s_add_u32 s89, s97, 0
    buffer_load_dwordx4 v2, s[28:31], s89 offen  lds
    v_fmac_f32 v134, v121, v128
    v_fmac_f32 v131, v119, v127
    v_fmac_f32 v132, v120, v127
    v_fmac_f32 v133, v121, v127
    s_mul_i32 s99, s97, 3072
    s_sub_u32 s19, s99, s18
    s_add_u32 s99, s99, s18
    s_add_u32 m0, s16, 8192
    s_add_u32 s89, s99, 0
    buffer_load_dwordx4 v4, s[32:35], s89 offen  lds
    v_fmac_f32 v134, v122, v127
    v_mul_f32 v131, v131, v123
    v_mul_f32 v132, v132, v124
    v_mul_f32 v133, v133, v125
    s_add_u32 m0, s87, 22528
    s_add_u32 s89, s97, 65536
    buffer_load_dwordx4 v2, s[28:31], s89 offen  lds
    v_mul_f32 v134, v134, v126
    v_cvt_pk_bf16_f32 v108, v134, v133
    v_cvt_pk_bf16_f32 v109, v132, v131
    s_nop 0
    v_permlane32_swap_b32 v110, v108
    s_add_u32 m0, s16, 32768
    s_add_u32 s89, s99, 2048
    buffer_load_dwordx4 v4, s[32:35], s89 offen  lds
    v_permlane32_swap_b32 v111, v109
    s_mov_b32 s89, 32768
    buffer_store_dwordx4 v[108:111], v12, s[52:55], s89 offen sc1
    v_and_b32 v116, 0xffff0000, v41
    v_and_b32 v117, 0xffff0000, v45
    s_add_u32 m0, s87, 26624
    s_add_u32 s89, s97, 131072
    buffer_load_dwordx4 v2, s[28:31], s89 offen  lds
    v_and_b32 v118, 0xffff0000, v49
    v_and_b32 v119, 0xffff0000, v53
    v_and_b32 v120, 0xffff0000, v57
    v_and_b32 v121, 0xffff0000, v61
    s_add_u32 m0, s16, 57344
    s_add_u32 s89, s99, 4096
    buffer_load_dwordx4 v4, s[32:35], s89 offen  lds
    v_and_b32 v122, 0xffff0000, v65
    v_lshlrev_b32 v127, 16, v90
    v_and_b32 v128, 0xffff0000, v90
    v_lshlrev_b32 v129, 16, v91
    s_add_u32 m0, s87, 30720
    s_add_u32 s89, s97, 196608
    buffer_load_dwordx4 v2, s[28:31], s89 offen  lds
    v_and_b32 v130, 0xffff0000, v91
    v_and_b32 v123, 0xffff0000, v69
    v_and_b32 v124, 0xffff0000, v73
    v_and_b32 v125, 0xffff0000, v77
    s_mov_b64 exec, 0xffffffff
    s_add_u32 m0, s88, 18432
    s_add_u32 s89, s97, 0
    buffer_load_dwordx4 v3, s[28:31], s89 offen  lds
    s_mov_b64 exec, -1
    v_and_b32 v126, 0xffff0000, v81
    v_mul_f32 v131, v116, v130
    v_mul_f32 v132, v117, v130
    s_waitcnt vmcnt(17)
    s_barrier
    s_add_u32 m0, s17, 8192
    s_add_u32 s89, s19, 196608
    buffer_load_dwordx4 v4, s[32:35], s89 offen  lds
    v_mul_f32 v133, v118, v130
    v_mul_f32 v134, v119, v130
    v_fmac_f32 v131, v117, v129
    v_fmac_f32 v132, v118, v129
    v_fmac_f32 v133, v119, v129
    s_add_u32 m0, s17, 32768
    s_add_u32 s89, s19, 198656
    buffer_load_dwordx4 v4, s[32:35], s89 offen  lds
    v_fmac_f32 v134, v120, v129
    v_fmac_f32 v131, v118, v128
    v_fmac_f32 v132, v119, v128
    v_fmac_f32 v133, v120, v128
    s_add_u32 m0, s17, 57344
    s_add_u32 s89, s19, 200704
    buffer_load_dwordx4 v4, s[32:35], s89 offen  lds
    v_fmac_f32 v134, v121, v128
    v_fmac_f32 v131, v119, v127
    v_fmac_f32 v132, v120, v127
    v_fmac_f32 v133, v121, v127
    s_add_u32 s97, s98, s0
    s_lshr_b64 s[0:1], s[0:1], 4
    s_and_b32 s97, s97, 15
    s_lshr_b32 s99, s97, 3
    s_xor_b32 s97, s97, s99
    s_lshl_b32 s97, s97, 7
    s_add_u32 m0, s87, 36864
    s_add_u32 s89, s97, 0
    buffer_load_dwordx4 v2, s[28:31], s89 offen  lds
    v_fmac_f32 v134, v122, v127
    v_mul_f32 v131, v131, v123
    v_mul_f32 v132, v132, v124
    v_mul_f32 v133, v133, v125
    v_mul_f32 v134, v134, v126
    s_mul_i32 s99, s97, 3072
    s_sub_u32 s19, s99, s18
    s_add_u32 s99, s99, s18
    s_add_u32 m0, s16, 16384
    s_add_u32 s89, s99, 0
    buffer_load_dwordx4 v4, s[32:35], s89 offen  lds
    v_cvt_pk_bf16_f32 v114, v134, v133
    v_cvt_pk_bf16_f32 v115, v132, v131
    v_and_b32 v116, 0xffff0000, v43
    v_and_b32 v117, 0xffff0000, v47
    s_add_u32 m0, s87, 40960
    s_add_u32 s89, s97, 65536
    buffer_load_dwordx4 v2, s[28:31], s89 offen  lds
    v_and_b32 v118, 0xffff0000, v51
    v_and_b32 v119, 0xffff0000, v55
    v_and_b32 v120, 0xffff0000, v59
    v_and_b32 v121, 0xffff0000, v63
    s_add_u32 m0, s16, 40960
    s_add_u32 s89, s99, 2048
    buffer_load_dwordx4 v4, s[32:35], s89 offen  lds
    v_and_b32 v122, 0xffff0000, v67
    v_lshlrev_b32 v127, 16, v98
    v_and_b32 v128, 0xffff0000, v98
    v_lshlrev_b32 v129, 16, v99
    s_add_u32 m0, s87, 45056
    s_add_u32 s89, s97, 131072
    buffer_load_dwordx4 v2, s[28:31], s89 offen  lds
    v_and_b32 v130, 0xffff0000, v99
    v_and_b32 v123, 0xffff0000, v71
    v_and_b32 v124, 0xffff0000, v75
    v_and_b32 v125, 0xffff0000, v79
    v_and_b32 v126, 0xffff0000, v83
    s_add_u32 m0, s16, 65536
    s_add_u32 s89, s99, 4096
    buffer_load_dwordx4 v4, s[32:35], s89 offen  lds
    v_mul_f32 v131, v116, v130
    v_mul_f32 v132, v117, v130
    v_mul_f32 v133, v118, v130
    v_mul_f32 v134, v119, v130
    s_add_u32 m0, s87, 49152
    s_add_u32 s89, s97, 196608
    buffer_load_dwordx4 v2, s[28:31], s89 offen  lds
    v_fmac_f32 v131, v117, v129
    v_fmac_f32 v132, v118, v129
    v_fmac_f32 v133, v119, v129
    v_fmac_f32 v134, v120, v129
    s_mov_b64 exec, 0xffffffff
    s_add_u32 m0, s88, 36864
    s_add_u32 s89, s97, 0
    buffer_load_dwordx4 v3, s[28:31], s89 offen  lds
    s_mov_b64 exec, -1
    v_fmac_f32 v131, v118, v128
    v_fmac_f32 v132, v119, v128
    v_fmac_f32 v133, v120, v128
    v_fmac_f32 v134, v121, v128
    v_fmac_f32 v131, v119, v127
    s_add_u32 m0, s17, 16384
    s_add_u32 s89, s19, 196608
    buffer_load_dwordx4 v4, s[32:35], s89 offen  lds
    v_fmac_f32 v132, v120, v127
    v_fmac_f32 v133, v121, v127
    v_fmac_f32 v134, v122, v127
    v_mul_f32 v131, v131, v123
    s_add_u32 m0, s17, 40960
    s_add_u32 s89, s19, 198656
    buffer_load_dwordx4 v4, s[32:35], s89 offen  lds
    v_mul_f32 v132, v132, v124
    v_mul_f32 v133, v133, v125
    v_mul_f32 v134, v134, v126
    v_cvt_pk_bf16_f32 v112, v134, v133
    s_add_u32 m0, s17, 65536
    s_add_u32 s89, s19, 200704
    buffer_load_dwordx4 v4, s[32:35], s89 offen  lds
    v_cvt_pk_bf16_f32 v113, v132, v131
    v_permlane32_swap_b32 v114, v112
    s_nop 0
    v_permlane32_swap_b32 v115, v113
    s_mov_b32 s89, 49152
    buffer_store_dwordx4 v[112:115], v12, s[52:55], s89 offen sc1
    s_waitcnt vmcnt(12)
    s_barrier
    s_add_u32 s97, s98, s0
    s_lshr_b64 s[0:1], s[0:1], 4
    s_and_b32 s97, s97, 15
    s_lshr_b32 s99, s97, 3
    s_xor_b32 s97, s97, s99
    s_lshl_b32 s97, s97, 7
    s_add_u32 m0, s87, 0
    s_add_u32 s89, s97, 0
    buffer_load_dwordx4 v2, s[28:31], s89 offen  lds
    v_add_u32 v5, s94, v15
    ds_read_b128 v[140:143], v5 offset:32
    s_mul_i32 s99, s97, 3072
    s_sub_u32 s19, s99, s18
    s_add_u32 s99, s99, s18
    s_add_u32 m0, s16, 0
    s_add_u32 s89, s99, 0
    buffer_load_dwordx4 v4, s[32:35], s89 offen  lds
    ds_read_b32 v156, v5 offset:48
    s_add_u32 m0, s87, 4096
    s_add_u32 s89, s97, 65536
    buffer_load_dwordx4 v2, s[28:31], s89 offen  lds
    ds_read_b128 v[144:147], v5 offset:1056
    ds_read_b32 v157, v5 offset:1072
    s_add_u32 m0, s16, 24576
    s_add_u32 s89, s99, 2048
    buffer_load_dwordx4 v4, s[32:35], s89 offen  lds
    ds_read_b128 v[148:151], v5 offset:2080
    s_add_u32 m0, s87, 8192
    s_add_u32 s89, s97, 131072
    buffer_load_dwordx4 v2, s[28:31], s89 offen  lds
    ds_read_b32 v158, v5 offset:2096
    s_add_u32 m0, s16, 49152
    s_add_u32 s89, s99, 4096
    buffer_load_dwordx4 v4, s[32:35], s89 offen  lds
    ds_read_b128 v[152:155], v5 offset:3104
    ds_read_b32 v159, v5 offset:3120
    s_add_u32 m0, s87, 12288
    s_add_u32 s89, s97, 196608
    buffer_load_dwordx4 v2, s[28:31], s89 offen  lds
    v_lshrrev_b32 v6, 3, v0
    s_mov_b64 exec, 0xffffffff
    s_add_u32 m0, s88, 0
    s_add_u32 s89, s97, 0
    buffer_load_dwordx4 v3, s[28:31], s89 offen  lds
    s_mov_b64 exec, -1
    v_mul_u32_u24 v6, 4160, v6
    s_add_u32 m0, s17, 0
    s_add_u32 s89, s19, 196608
    buffer_load_dwordx4 v4, s[32:35], s89 offen  lds
    v_and_b32 v7, 7, v0
    v_lshl_add_u32 v6, v7, 2, v6
    s_add_u32 m0, s17, 24576
    s_add_u32 s89, s19, 198656
    buffer_load_dwordx4 v4, s[32:35], s89 offen  lds
    v_add_u32 v6, s94, v6
    s_add_u32 m0, s17, 49152
    s_add_u32 s89, s19, 200704
    buffer_load_dwordx4 v4, s[32:35], s89 offen  lds
    v_mov_b32 v7, 0
    s_waitcnt vmcnt(12)
    s_barrier
    s_add_u32 s97, s98, s0
    s_lshr_b64 s[0:1], s[0:1], 4
    s_and_b32 s97, s97, 15
    s_lshr_b32 s99, s97, 3
    s_xor_b32 s97, s97, s99
    s_lshl_b32 s97, s97, 7
    s_add_u32 m0, s87, 18432
    s_add_u32 s89, s97, 0
    buffer_load_dwordx4 v2, s[28:31], s89 offen  lds
    s_waitcnt lgkmcnt(0)
    v_readfirstlane_b32 s93, v140
    s_nop 0
    s_lshl_b32 s93, s93, 16
    s_mul_i32 s99, s97, 3072
    s_sub_u32 s19, s99, s18
    s_add_u32 s99, s99, s18
    s_add_u32 m0, s16, 8192
    s_add_u32 s89, s99, 0
    buffer_load_dwordx4 v4, s[32:35], s89 offen  lds
    v_writelane_b32 v7, s93, 15
    v_alignbit_b32 v140, v141, v140, 16
    s_add_u32 m0, s87, 22528
    s_add_u32 s89, s97, 65536
    buffer_load_dwordx4 v2, s[28:31], s89 offen  lds
    v_alignbit_b32 v141, v142, v141, 16
    v_alignbit_b32 v142, v143, v142, 16
    s_add_u32 m0, s16, 32768
    s_add_u32 s89, s99, 2048
    buffer_load_dwordx4 v4, s[32:35], s89 offen  lds
    v_alignbit_b32 v143, v156, v143, 16
    v_alignbit_b32 v144, v145, v144, 16
    v_alignbit_b32 v145, v146, v145, 16
    s_add_u32 m0, s87, 26624
    s_add_u32 s89, s97, 131072
    buffer_load_dwordx4 v2, s[28:31], s89 offen  lds
    v_alignbit_b32 v146, v147, v146, 16
    v_alignbit_b32 v147, v157, v147, 16
    s_add_u32 m0, s16, 57344
    s_add_u32 s89, s99, 4096
    buffer_load_dwordx4 v4, s[32:35], s89 offen  lds
    v_alignbit_b32 v148, v149, v148, 16
    v_alignbit_b32 v149, v150, v149, 16
    s_add_u32 m0, s87, 30720
    s_add_u32 s89, s97, 196608
    buffer_load_dwordx4 v2, s[28:31], s89 offen  lds
    v_alignbit_b32 v150, v151, v150, 16
    v_alignbit_b32 v151, v158, v151, 16
    s_mov_b64 exec, 0xffffffff
    s_add_u32 m0, s88, 18432
    s_add_u32 s89, s97, 0
    buffer_load_dwordx4 v3, s[28:31], s89 offen  lds
    s_mov_b64 exec, -1
    v_alignbit_b32 v152, v153, v152, 16
    v_alignbit_b32 v153, v154, v153, 16
    v_alignbit_b32 v154, v155, v154, 16
    s_add_u32 m0, s17, 8192
    s_add_u32 s89, s19, 196608
    buffer_load_dwordx4 v4, s[32:35], s89 offen  lds
    v_alignbit_b32 v155, v159, v155, 16
    v_lshlrev_b32 v8, 3, v0
    s_add_u32 m0, s17, 32768
    s_add_u32 s89, s19, 198656
    buffer_load_dwordx4 v4, s[32:35], s89 offen  lds
    s_add_u32 s78, s88, 18432
    v_add_u32 v8, s78, v8
    s_add_u32 m0, s17, 57344
    s_add_u32 s89, s19, 200704
    buffer_load_dwordx4 v4, s[32:35], s89 offen  lds
    v_mov_b32 v156, 0
    v_mov_b32 v157, 0
    s_waitcnt vmcnt(11)
    s_barrier
    s_add_u32 s97, s98, s0
    s_lshr_b64 s[0:1], s[0:1], 4
    s_and_b32 s97, s97, 15
    s_lshr_b32 s99, s97, 3
    s_xor_b32 s97, s97, s99
    s_lshl_b32 s97, s97, 7
    s_add_u32 m0, s87, 36864
    s_add_u32 s89, s97, 0
    buffer_load_dwordx4 v2, s[28:31], s89 offen  lds
    s_mul_i32 s99, s97, 3072
    s_sub_u32 s19, s99, s18
    s_add_u32 s99, s99, s18
    s_add_u32 m0, s16, 16384
    s_add_u32 s89, s99, 0
    buffer_load_dwordx4 v4, s[32:35], s89 offen  lds
    s_add_u32 m0, s87, 40960
    s_add_u32 s89, s97, 65536
    buffer_load_dwordx4 v2, s[28:31], s89 offen  lds
    s_add_u32 m0, s16, 40960
    s_add_u32 s89, s99, 2048
    buffer_load_dwordx4 v4, s[32:35], s89 offen  lds
    s_add_u32 m0, s87, 45056
    s_add_u32 s89, s97, 131072
    buffer_load_dwordx4 v2, s[28:31], s89 offen  lds
    s_add_u32 m0, s16, 65536
    s_add_u32 s89, s99, 4096
    buffer_load_dwordx4 v4, s[32:35], s89 offen  lds
    s_add_u32 m0, s87, 49152
    s_add_u32 s89, s97, 196608
    buffer_load_dwordx4 v2, s[28:31], s89 offen  lds
    s_mov_b64 exec, 0xffffffff
    s_add_u32 m0, s88, 36864
    s_add_u32 s89, s97, 0
    buffer_load_dwordx4 v3, s[28:31], s89 offen  lds
    s_mov_b64 exec, -1
    s_add_u32 m0, s17, 16384
    s_add_u32 s89, s19, 196608
    buffer_load_dwordx4 v4, s[32:35], s89 offen  lds
    s_add_u32 m0, s17, 40960
    s_add_u32 s89, s19, 198656
    buffer_load_dwordx4 v4, s[32:35], s89 offen  lds
    s_add_u32 m0, s17, 65536
    s_add_u32 s89, s19, 200704
    buffer_load_dwordx4 v4, s[32:35], s89 offen  lds
    s_waitcnt vmcnt(11)
    s_barrier
    s_add_u32 s97, s98, s0
    s_lshr_b64 s[0:1], s[0:1], 4
    s_and_b32 s97, s97, 15
    s_lshr_b32 s99, s97, 3
    s_xor_b32 s97, s97, s99
    s_lshl_b32 s97, s97, 7
    s_add_u32 m0, s87, 0
    s_add_u32 s89, s97, 0
    buffer_load_dwordx4 v2, s[28:31], s89 offen  lds
    s_mul_i32 s99, s97, 3072
    s_sub_u32 s19, s99, s18
    s_add_u32 s99, s99, s18
    s_add_u32 m0, s16, 0
    s_add_u32 s89, s99, 0
    buffer_load_dwordx4 v4, s[32:35], s89 offen  lds
    s_add_u32 m0, s87, 4096
    s_add_u32 s89, s97, 65536
    buffer_load_dwordx4 v2, s[28:31], s89 offen  lds
    s_add_u32 m0, s16, 24576
    s_add_u32 s89, s99, 2048
    buffer_load_dwordx4 v4, s[32:35], s89 offen  lds
    s_add_u32 m0, s87, 8192
    s_add_u32 s89, s97, 131072
    buffer_load_dwordx4 v2, s[28:31], s89 offen  lds
    s_add_u32 m0, s16, 49152
    s_add_u32 s89, s99, 4096
    buffer_load_dwordx4 v4, s[32:35], s89 offen  lds
    s_add_u32 m0, s87, 12288
    s_add_u32 s89, s97, 196608
    buffer_load_dwordx4 v2, s[28:31], s89 offen  lds
    s_mov_b64 exec, 0xffffffff
    s_add_u32 m0, s88, 0
    s_add_u32 s89, s97, 0
    buffer_load_dwordx4 v3, s[28:31], s89 offen  lds
    s_mov_b64 exec, -1
    s_add_u32 m0, s17, 0
    s_add_u32 s89, s19, 196608
    buffer_load_dwordx4 v4, s[32:35], s89 offen  lds
    s_add_u32 m0, s17, 24576
    s_add_u32 s89, s19, 198656
    buffer_load_dwordx4 v4, s[32:35], s89 offen  lds
    s_add_u32 m0, s17, 49152
    s_add_u32 s89, s19, 200704
    buffer_load_dwordx4 v4, s[32:35], s89 offen  lds
    s_mov_b64 exec, 0xff
    buffer_load_dword v136, v33, s[68:71], 0 offen sc1
    buffer_load_dword v137, v34, s[52:55], 0 offen sc1
    s_mov_b64 exec, -1
    s_waitcnt vmcnt(13)
    s_barrier
    s_waitcnt vmcnt(0)
    s_branch LA_j
LA_c2:
    s_waitcnt vmcnt(7)
    s_barrier
    s_mov_b64 exec, 0xffffffff
    s_add_u32 m0, s88, 18432
    s_add_u32 s89, s97, 0
    buffer_load_dwordx4 v3, s[28:31], s89 offen  lds
    s_mov_b64 exec, -1
    s_add_u32 m0, s17, 8192
    s_add_u32 s89, s19, 196608
    buffer_load_dwordx4 v4, s[32:35], s89 offen  lds
    s_add_u32 m0, s17, 32768
    s_add_u32 s89, s19, 198656
    buffer_load_dwordx4 v4, s[32:35], s89 offen  lds
    s_add_u32 m0, s17, 57344
    s_add_u32 s89, s19, 200704
    buffer_load_dwordx4 v4, s[32:35], s89 offen  lds
    s_add_u32 s97, s98, s0
    s_lshr_b64 s[0:1], s[0:1], 4
    s_and_b32 s97, s97, 15
    s_lshr_b32 s99, s97, 3
    s_xor_b32 s97, s97, s99
    s_lshl_b32 s97, s97, 7
    s_add_u32 m0, s87, 36864
    s_add_u32 s89, s97, 0
    buffer_load_dwordx4 v2, s[28:31], s89 offen  lds
    s_mul_i32 s99, s97, 3072
    s_sub_u32 s19, s99, s18
    s_add_u32 s99, s99, s18
    s_add_u32 m0, s16, 16384
    s_add_u32 s89, s99, 0
    buffer_load_dwordx4 v4, s[32:35], s89 offen  lds
    s_add_u32 m0, s87, 40960
    s_add_u32 s89, s97, 65536
    buffer_load_dwordx4 v2, s[28:31], s89 offen  lds
    s_add_u32 m0, s16, 40960
    s_add_u32 s89, s99, 2048
    buffer_load_dwordx4 v4, s[32:35], s89 offen  lds
    s_add_u32 m0, s87, 45056
    s_add_u32 s89, s97, 131072
    buffer_load_dwordx4 v2, s[28:31], s89 offen  lds
    s_add_u32 m0, s16, 65536
    s_add_u32 s89, s99, 4096
    buffer_load_dwordx4 v4, s[32:35], s89 offen  lds
    s_add_u32 m0, s87, 49152
    s_add_u32 s89, s97, 196608
    buffer_load_dwordx4 v2, s[28:31], s89 offen  lds
    s_mov_b64 exec, 0xffffffff
    s_add_u32 m0, s88, 36864
    s_add_u32 s89, s97, 0
    buffer_load_dwordx4 v3, s[28:31], s89 offen  lds
    s_mov_b64 exec, -1
    s_add_u32 m0, s17, 16384
    s_add_u32 s89, s19, 196608
    buffer_load_dwordx4 v4, s[32:35], s89 offen  lds
    s_add_u32 m0, s17, 40960
    s_add_u32 s89, s19, 198656
    buffer_load_dwordx4 v4, s[32:35], s89 offen  lds
    s_add_u32 m0, s17, 65536
    s_add_u32 s89, s19, 200704
    buffer_load_dwordx4 v4, s[32:35], s89 offen  lds
    s_waitcnt vmcnt(11)
    s_barrier
    s_add_u32 s97, s98, s0
    s_lshr_b64 s[0:1], s[0:1], 4
    s_and_b32 s97, s97, 15
    s_lshr_b32 s99, s97, 3
    s_xor_b32 s97, s97, s99
    s_lshl_b32 s97, s97, 7
    s_add_u32 m0, s87, 0
    s_add_u32 s89, s97, 0
    buffer_load_dwordx4 v2, s[28:31], s89 offen  lds
    s_mul_i32 s99, s97, 3072
    s_sub_u32 s19, s99, s18
    s_add_u32 s99, s99, s18
    s_add_u32 m0, s16, 0
    s_add_u32 s89, s99, 0
    buffer_load_dwordx4 v4, s[32:35], s89 offen  lds
    s_add_u32 m0, s87, 4096
    s_add_u32 s89, s97, 65536
    buffer_load_dwordx4 v2, s[28:31], s89 offen  lds
    s_add_u32 m0, s16, 24576
    s_add_u32 s89, s99, 2048
    buffer_load_dwordx4 v4, s[32:35], s89 offen  lds
    s_add_u32 m0, s87, 8192
    s_add_u32 s89, s97, 131072
    buffer_load_dwordx4 v2, s[28:31], s89 offen  lds
    s_add_u32 m0, s16, 49152
    s_add_u32 s89, s99, 4096
    buffer_load_dwordx4 v4, s[32:35], s89 offen  lds
    s_add_u32 m0, s87, 12288
    s_add_u32 s89, s97, 196608
    buffer_load_dwordx4 v2, s[28:31], s89 offen  lds
    s_mov_b64 exec, 0xffffffff
    s_add_u32 m0, s88, 0
    s_add_u32 s89, s97, 0
    buffer_load_dwordx4 v3, s[28:31], s89 offen  lds
    s_mov_b64 exec, -1
    s_add_u32 m0, s17, 0
    s_add_u32 s89, s19, 196608
    buffer_load_dwordx4 v4, s[32:35], s89 offen  lds
    s_add_u32 m0, s17, 24576
    s_add_u32 s89, s19, 198656
    buffer_load_dwordx4 v4, s[32:35], s89 offen  lds
    s_add_u32 m0, s17, 49152
    s_add_u32 s89, s19, 200704
    buffer_load_dwordx4 v4, s[32:35], s89 offen  lds
    s_waitcnt vmcnt(11)
    s_barrier
    s_add_u32 s97, s98, s0
    s_lshr_b64 s[0:1], s[0:1], 4
    s_and_b32 s97, s97, 15
    s_lshr_b32 s99, s97, 3
    s_xor_b32 s97, s97, s99
    s_lshl_b32 s97, s97, 7
    s_add_u32 m0, s87, 18432
    s_add_u32 s89, s97, 0
    buffer_load_dwordx4 v2, s[28:31], s89 offen  lds
    s_mul_i32 s99, s97, 3072
    s_sub_u32 s19, s99, s18
    s_add_u32 s99, s99, s18
    s_add_u32 m0, s16, 8192
    s_add_u32 s89, s99, 0
    buffer_load_dwordx4 v4, s[32:35], s89 offen  lds
    s_add_u32 m0, s87, 22528
    s_add_u32 s89, s97, 65536
    buffer_load_dwordx4 v2, s[28:31], s89 offen  lds
    s_add_u32 m0, s16, 32768
    s_add_u32 s89, s99, 2048
    buffer_load_dwordx4 v4, s[32:35], s89 offen  lds
    s_add_u32 m0, s87, 26624
    s_add_u32 s89, s97, 131072
    buffer_load_dwordx4 v2, s[28:31], s89 offen  lds
    s_add_u32 m0, s16, 57344
    s_add_u32 s89, s99, 4096
    buffer_load_dwordx4 v4, s[32:35], s89 offen  lds
    s_add_u32 m0, s87, 30720
    s_add_u32 s89, s97, 196608
    buffer_load_dwordx4 v2, s[28:31], s89 offen  lds
    s_mov_b64 exec, 0xffffffff
    s_add_u32 m0, s88, 18432
    s_add_u32 s89, s97, 0
    buffer_load_dwordx4 v3, s[28:31], s89 offen  lds
    s_mov_b64 exec, -1
    s_add_u32 m0, s17, 8192
    s_add_u32 s89, s19, 196608
    buffer_load_dwordx4 v4, s[32:35], s89 offen  lds
    s_add_u32 m0, s17, 32768
    s_add_u32 s89, s19, 198656
    buffer_load_dwordx4 v4, s[32:35], s89 offen  lds
    s_add_u32 m0, s17, 57344
    s_add_u32 s89, s19, 200704
    buffer_load_dwordx4 v4, s[32:35], s89 offen  lds
    s_waitcnt vmcnt(11)
    s_barrier
    s_add_u32 m0, s86, 129536
    s_mov_b32 s89, 0
    buffer_load_dwordx4 v10, s[36:39], s89 offen nt lds
    s_add_u32 m0, s86, 145920
    s_mov_b32 s89, 0
    buffer_load_dwordx4 v10, s[40:43], s89 offen nt lds
    s_add_u32 m0, s86, 133632
    s_mov_b32 s89, 65536
    buffer_load_dwordx4 v10, s[36:39], s89 offen nt lds
    s_add_u32 m0, s86, 150016
    s_mov_b32 s89, 65536
    buffer_load_dwordx4 v10, s[40:43], s89 offen nt lds
    s_add_u32 m0, s86, 137728
    s_mov_b32 s89, 131072
    buffer_load_dwordx4 v10, s[36:39], s89 offen nt lds
    s_add_u32 m0, s86, 154112
    s_mov_b32 s89, 131072
    buffer_load_dwordx4 v10, s[40:43], s89 offen nt lds
    s_add_u32 m0, s86, 141824
    s_mov_b32 s89, 196608
    buffer_load_dwordx4 v10, s[36:39], s89 offen nt lds
    s_add_u32 m0, s86, 158208
    s_mov_b32 s89, 196608
    buffer_load_dwordx4 v10, s[40:43], s89 offen nt lds
    s_mov_b64 exec, 0xff
    s_lshl_b32 s82, s3, 7
    s_add_u32 m0, s82, 129024
    s_mov_b32 s89, 0
    buffer_load_dwordx4 v11, s[36:39], s89 offen nt lds
    s_lshl_b32 s83, s74, 9
    s_add_u32 s83, s83, s82
    s_and_b32 s89, s3, 2
    s_lshl_b32 s89, s89, 3
    s_add_u32 s82, s82, s89
    s_add_u32 m0, s82, 162816
    s_add_u32 s89, s83, 0
    buffer_load_dwordx4 v15, s[44:47], s89 offen  lds
    s_mov_b64 exec, -1
    s_add_u32 s97, s98, s0
    s_lshr_b64 s[0:1], s[0:1], 4
    s_and_b32 s97, s97, 15
    s_lshr_b32 s99, s97, 3
    s_xor_b32 s97, s97, s99
    s_lshl_b32 s97, s97, 7
    s_add_u32 m0, s87, 36864
    s_add_u32 s89, s97, 0
    buffer_load_dwordx4 v2, s[28:31], s89 offen  lds
    s_mul_i32 s99, s97, 3072
    s_sub_u32 s19, s99, s18
    s_add_u32 s99, s99, s18
    s_add_u32 m0, s16, 16384
    s_add_u32 s89, s99, 0
    buffer_load_dwordx4 v4, s[32:35], s89 offen  lds
    s_add_u32 m0, s87, 40960
    s_add_u32 s89, s97, 65536
    buffer_load_dwordx4 v2, s[28:31], s89 offen  lds
    s_add_u32 m0, s16, 40960
    s_add_u32 s89, s99, 2048
    buffer_load_dwordx4 v4, s[32:35], s89 offen  lds
    s_add_u32 m0, s87, 45056
    s_add_u32 s89, s97, 131072
    buffer_load_dwordx4 v2, s[28:31], s89 offen  lds
    s_add_u32 m0, s16, 65536
    s_add_u32 s89, s99, 4096
    buffer_load_dwordx4 v4, s[32:35], s89 offen  lds
    s_add_u32 m0, s87, 49152
    s_add_u32 s89, s97, 196608
    buffer_load_dwordx4 v2, s[28:31], s89 offen  lds
    s_waitcnt vmcnt(17)
    s_barrier
    s_mov_b64 exec, 0xffffffff
    s_add_u32 m0, s88, 36864
    s_add_u32 s89, s97, 0
    buffer_load_dwordx4 v3, s[28:31], s89 offen  lds
    s_mov_b64 exec, -1
    s_add_u32 m0, s17, 16384
    s_add_u32 s89, s19, 196608
    buffer_load_dwordx4 v4, s[32:35], s89 offen  lds
    s_add_u32 m0, s17, 40960
    s_add_u32 s89, s19, 198656
    buffer_load_dwordx4 v4, s[32:35], s89 offen  lds
    s_add_u32 m0, s17, 65536
    s_add_u32 s89, s19, 200704
    buffer_load_dwordx4 v4, s[32:35], s89 offen  lds
    s_add_u32 s97, s98, s0
    s_lshr_b64 s[0:1], s[0:1], 4
    s_and_b32 s97, s97, 15
    s_lshr_b32 s99, s97, 3
    s_xor_b32 s97, s97, s99
    s_lshl_b32 s97, s97, 7
    s_add_u32 m0, s87, 0
    s_add_u32 s89, s97, 0
    buffer_load_dwordx4 v2, s[28:31], s89 offen  lds
    s_mul_i32 s99, s97, 3072
    s_sub_u32 s19, s99, s18
    s_add_u32 s99, s99, s18
    s_add_u32 m0, s16, 0
    s_add_u32 s89, s99, 0
    buffer_load_dwordx4 v4, s[32:35], s89 offen  lds
    s_add_u32 m0, s87, 4096
    s_add_u32 s89, s97, 65536
    buffer_load_dwordx4 v2, s[28:31], s89 offen  lds
    s_add_u32 m0, s16, 24576
    s_add_u32 s89, s99, 2048
    buffer_load_dwordx4 v4, s[32:35], s89 offen  lds
    s_add_u32 m0, s87, 8192
    s_add_u32 s89, s97, 131072
    buffer_load_dwordx4 v2, s[28:31], s89 offen  lds
    s_add_u32 m0, s16, 49152
    s_add_u32 s89, s99, 4096
    buffer_load_dwordx4 v4, s[32:35], s89 offen  lds
    s_add_u32 m0, s87, 12288
    s_add_u32 s89, s97, 196608
    buffer_load_dwordx4 v2, s[28:31], s89 offen  lds
    s_mov_b64 exec, 0xffffffff
    s_add_u32 m0, s88, 0
    s_add_u32 s89, s97, 0
    buffer_load_dwordx4 v3, s[28:31], s89 offen  lds
    s_mov_b64 exec, -1
    s_add_u32 m0, s17, 0
    s_add_u32 s89, s19, 196608
    buffer_load_dwordx4 v4, s[32:35], s89 offen  lds
    s_add_u32 m0, s17, 24576
    s_add_u32 s89, s19, 198656
    buffer_load_dwordx4 v4, s[32:35], s89 offen  lds
    s_add_u32 m0, s17, 49152
    s_add_u32 s89, s19, 200704
    buffer_load_dwordx4 v4, s[32:35], s89 offen  lds
    s_waitcnt vmcnt(11)
    s_barrier
    s_add_u32 s97, s98, s0
    s_lshr_b64 s[0:1], s[0:1], 4
    s_and_b32 s97, s97, 15
    s_lshr_b32 s99, s97, 3
    s_xor_b32 s97, s97, s99
    s_lshl_b32 s97, s97, 7
    s_add_u32 m0, s87, 18432
    s_add_u32 s89, s97, 0
    buffer_load_dwordx4 v2, s[28:31], s89 offen  lds
    ds_read_b128 v[84:87], v35 offset:0
    ds_read_b128 v[88:91], v35 offset:16
    s_mul_i32 s99, s97, 3072
    s_sub_u32 s19, s99, s18
    s_add_u32 s99, s99, s18
    s_add_u32 m0, s16, 8192
    s_add_u32 s89, s99, 0
    buffer_load_dwordx4 v4, s[32:35], s89 offen  lds
    ds_read_b128 v[92:95], v35 offset:32
    s_add_u32 m0, s87, 22528
    s_add_u32 s89, s97, 65536
    buffer_load_dwordx4 v2, s[28:31], s89 offen  lds
    ds_read_b128 v[96:99], v35 offset:48
    ds_read_b128 v[40:43], v233 offset:0
    s_add_u32 m0, s16, 32768
    s_add_u32 s89, s99, 2048
    buffer_load_dwordx4 v4, s[32:35], s89 offen  lds
    ds_read_b128 v[44:47], v232 offset:256
    s_add_u32 m0, s87, 26624
    s_add_u32 s89, s97, 131072
    buffer_load_dwordx4 v2, s[28:31], s89 offen  lds
    ds_read_b128 v[48:51], v233 offset:256
    s_add_u32 m0, s16, 57344
    s_add_u32 s89, s99, 4096
    buffer_load_dwordx4 v4, s[32:35], s89 offen  lds
    ds_read_b128 v[52:55], v16 offset:512
    ds_read_b128 v[56:59], v231 offset:512
    s_add_u32 m0, s87, 30720
    s_add_u32 s89, s97, 196608
    buffer_load_dwordx4 v2, s[28:31], s89 offen  lds
    ds_read_b128 v[60:63], v16 offset:768
    s_mov_b64 exec, 0xffffffff
    s_add_u32 m0, s88, 18432
    s_add_u32 s89, s97, 0
    buffer_load_dwordx4 v3, s[28:31], s89 offen  lds
    s_mov_b64 exec, -1
    ds_read_b128 v[64:67], v231 offset:768
    s_add_u32 m0, s17, 8192
    s_add_u32 s89, s19, 196608
    buffer_load_dwordx4 v4, s[32:35], s89 offen  lds
    ds_read_b128 v[68:71], v16 offset:16896
    ds_read_b128 v[72:75], v231 offset:16896
    s_add_u32 m0, s17, 32768
    s_add_u32 s89, s19, 198656
    buffer_load_dwordx4 v4, s[32:35], s89 offen  lds
    ds_read_b128 v[76:79], v16 offset:17152
    s_add_u32 m0, s17, 57344
    s_add_u32 s89, s19, 200704
    buffer_load_dwordx4 v4, s[32:35], s89 offen  lds
    ds_read_b128 v[80:83], v231 offset:17152
    s_waitcnt vmcnt(11)
    s_waitcnt lgkmcnt(0)
    s_barrier
    s_add_u32 s97, s98, s0
    s_lshr_b64 s[0:1], s[0:1], 4
    s_and_b32 s97, s97, 15
    s_lshr_b32 s99, s97, 3
    s_xor_b32 s97, s97, s99
    s_lshl_b32 s97, s97, 7
    s_add_u32 m0, s87, 36864
    s_add_u32 s89, s97, 0
    buffer_load_dwordx4 v2, s[28:31], s89 offen  lds
    v_lshlrev_b32 v116, 16, v40
    v_lshlrev_b32 v117, 16, v44
    v_lshlrev_b32 v118, 16, v48
    v_lshlrev_b32 v119, 16, v52
    v_lshlrev_b32 v120, 16, v56
    v_lshlrev_b32 v121, 16, v60
    s_mul_i32 s99, s97, 3072
    s_sub_u32 s19, s99, s18
    s_add_u32 s99, s99, s18
    s_add_u32 m0, s16, 16384
    s_add_u32 s89, s99, 0
    buffer_load_dwordx4 v4, s[32:35], s89 offen  lds
    v_lshlrev_b32 v122, 16, v64
    v_lshlrev_b32 v127, 16, v84
    v_and_b32 v128, 0xffff0000, v84
    v_lshlrev_b32 v129, 16, v85
    v_and_b32 v130, 0xffff0000, v85
    v_lshlrev_b32 v123, 16, v68
    s_add_u32 m0, s87, 40960
    s_add_u32 s89, s97, 65536
    buffer_load_dwordx4 v2, s[28:31], s89 offen  lds
    v_lshlrev_b32 v124, 16, v72
    v_lshlrev_b32 v125, 16, v76
    v_lshlrev_b32 v126, 16, v80
    v_mul_f32 v131, v116, v130
    v_mul_f32 v132, v117, v130
    s_add_u32 m0, s16, 40960
    s_add_u32 s89, s99, 2048
    buffer_load_dwordx4 v4, s[32:35], s89 offen  lds
    v_mul_f32 v133, v118, v130
    v_mul_f32 v134, v119, v130
    v_fmac_f32 v131, v117, v129
    v_fmac_f32 v132, v118, v129
    v_fmac_f32 v133, v119, v129
    v_fmac_f32 v134, v120, v129
    s_add_u32 m0, s87, 45056
    s_add_u32 s89, s97, 131072
    buffer_load_dwordx4 v2, s[28:31], s89 offen  lds
    v_fmac_f32 v131, v118, v128
    v_fmac_f32 v132, v119, v128
    v_fmac_f32 v133, v120, v128
    v_fmac_f32 v134, v121, v128
    v_fmac_f32 v131, v119, v127
    v_fmac_f32 v132, v120, v127
    s_add_u32 m0, s16, 65536
    s_add_u32 s89, s99, 4096
    buffer_load_dwordx4 v4, s[32:35], s89 offen  lds
    v_fmac_f32 v133, v121, v127
    v_fmac_f32 v134, v122, v127
    v_mul_f32 v131, v131, v123
    v_mul_f32 v132, v132, v124
    v_mul_f32 v133, v133, v125
    s_add_u32 m0, s87, 49152
    s_add_u32 s89, s97, 196608
    buffer_load_dwordx4 v2, s[28:31], s89 offen  lds
    v_mul_f32 v134, v134, v126
    v_cvt_pk_bf16_f32 v102, v134, v133
    v_cvt_pk_bf16_f32 v103, v132, v131
    v_lshlrev_b32 v116, 16, v42
    v_lshlrev_b32 v117, 16, v46
    v_lshlrev_b32 v118, 16, v50
    s_mov_b64 exec, 0xffffffff
    s_add_u32 m0, s88, 36864
    s_add_u32 s89, s97, 0
    buffer_load_dwordx4 v3, s[28:31], s89 offen  lds
    s_mov_b64 exec, -1
    v_lshlrev_b32 v119, 16, v54
    v_lshlrev_b32 v120, 16, v58
    v_lshlrev_b32 v121, 16, v62
    v_lshlrev_b32 v122, 16, v66
    v_lshlrev_b32 v127, 16, v92
    v_and_b32 v128, 0xffff0000, v92
    s_add_u32 m0, s17, 16384
    s_add_u32 s89, s19, 196608
    buffer_load_dwordx4 v4, s[32:35], s89 offen  lds
    v_lshlrev_b32 v129, 16, v93
    v_and_b32 v130, 0xffff0000, v93
    v_lshlrev_b32 v123, 16, v70
    v_lshlrev_b32 v124, 16, v74
    v_lshlrev_b32 v125, 16, v78
    s_add_u32 m0, s17, 40960
    s_add_u32 s89, s19, 198656
    buffer_load_dwordx4 v4, s[32:35], s89 offen  lds
    v_lshlrev_b32 v126, 16, v82
    v_mul_f32 v131, v116, v130
    v_mul_f32 v132, v117, v130
    v_mul_f32 v133, v118, v130
    v_mul_f32 v134, v119, v130
    v_fmac_f32 v131, v117, v129
    s_add_u32 m0, s17, 65536
    s_add_u32 s89, s19, 200704
    buffer_load_dwordx4 v4, s[32:35], s89 offen  lds
    v_fmac_f32 v132, v118, v129
    v_fmac_f32 v133, v119, v129
    v_fmac_f32 v134, v120, v129
    v_fmac_f32 v131, v118, v128
    v_fmac_f32 v132, v119, v128
    s_waitcnt vmcnt(11)
    s_barrier
    s_add_u32 s97, s98, s0
    s_lshr_b64 s[0:1], s[0:1], 4
    s_and_b32 s97, s97, 15
    s_lshr_b32 s99, s97, 3
    s_xor_b32 s97, s97, s99
    s_lshl_b32 s97, s97, 7
    s_add_u32 m0, s87, 0
    s_add_u32 s89, s97, 0
    buffer_load_dwordx4 v2, s[28:31], s89 offen  lds
    v_fmac_f32 v133, v120, v128
    v_fmac_f32 v134, v121, v128
    v_fmac_f32 v131, v119, v127
    v_fmac_f32 v132, v120, v127
    v_fmac_f32 v133, v121, v127
    v_fmac_f32 v134, v122, v127
    s_mul_i32 s99, s97, 3072
    s_sub_u32 s19, s99, s18
    s_add_u32 s99, s99, s18
    s_add_u32 m0, s16, 0
    s_add_u32 s89, s99, 0
    buffer_load_dwordx4 v4, s[32:35], s89 offen  lds
    v_mul_f32 v131, v131, v123
    v_mul_f32 v132, v132, v124
    v_mul_f32 v133, v133, v125
    v_mul_f32 v134, v134, v126
    v_cvt_pk_bf16_f32 v100, v134, v133
    v_cvt_pk_bf16_f32 v101, v132, v131
    s_add_u32 m0, s87, 4096
    s_add_u32 s89, s97, 65536
    buffer_load_dwordx4 v2, s[28:31], s89 offen  lds
    v_permlane32_swap_b32 v102, v100
    v_permlane32_swap_b32 v103, v101
    s_mov_b32 s89, 0
    buffer_store_dwordx4 v[100:103], v12, s[52:55], s89 offen sc1
    v_and_b32 v116, 0xffff0000, v40
    v_and_b32 v117, 0xffff0000, v44
    s_add_u32 m0, s16, 24576
    s_add_u32 s89, s99, 2048
    buffer_load_dwordx4 v4, s[32:35], s89 offen  lds
    v_and_b32 v118, 0xffff0000, v48
    v_and_b32 v119, 0xffff0000, v52
    v_and_b32 v120, 0xffff0000, v56
    v_and_b32 v121, 0xffff0000, v60
    v_and_b32 v122, 0xffff0000, v64
    v_lshlrev_b32 v127, 16, v86
    s_add_u32 m0, s87, 8192
    s_add_u32 s89, s97, 131072
    buffer_load_dwordx4 v2, s[28:31], s89 offen  lds
    v_and_b32 v128, 0xffff0000, v86
    v_lshlrev_b32 v129, 16, v87
    v_and_b32 v130, 0xffff0000, v87
    v_and_b32 v123, 0xffff0000, v68
    v_and_b32 v124, 0xffff0000, v72
    v_and_b32 v125, 0xffff0000, v76
    s_add_u32 m0, s16, 49152
    s_add_u32 s89, s99, 4096
    buffer_load_dwordx4 v4, s[32:35], s89 offen  lds
    v_and_b32 v126, 0xffff0000, v80
    v_mul_f32 v131, v116, v130
    v_mul_f32 v132, v117, v130
    v_mul_f32 v133, v118, v130
    v_mul_f32 v134, v119, v130
    s_add_u32 m0, s87, 12288
    s_add_u32 s89, s97, 196608
    buffer_load_dwordx4 v2, s[28:31], s89 offen  lds
    v_fmac_f32 v131, v117, v129
    v_fmac_f32 v132, v118, v129
    v_fmac_f32 v133, v119, v129
    v_fmac_f32 v134, v120, v129
    v_fmac_f32 v131, v118, v128
    v_fmac_f32 v132, v119, v128
    s_mov_b64 exec, 0xffffffff
    s_add_u32 m0, s88, 0
    s_add_u32 s89, s97, 0
    buffer_load_dwordx4 v3, s[28:31], s89 offen  lds
    s_mov_b64 exec, -1
    v_fmac_f32 v133, v120, v128
    v_fmac_f32 v134, v121, v128
    v_fmac_f32 v131, v119, v127
    v_fmac_f32 v132, v120, v127
    v_fmac_f32 v133, v121, v127
    v_fmac_f32 v134, v122, v127
    s_add_u32 m0, s17, 0
    s_add_u32 s89, s19, 196608
    buffer_load_dwordx4 v4, s[32:35], s89 offen  lds
    v_mul_f32 v131, v131, v123
    v_mul_f32 v132, v132, v124
    v_mul_f32 v133, v133, v125
    v_mul_f32 v134, v134, v126
    v_cvt_pk_bf16_f32 v106, v134, v133
    s_add_u32 m0, s17, 24576
    s_add_u32 s89, s19, 198656
    buffer_load_dwordx4 v4, s[32:35], s89 offen  lds
    v_cvt_pk_bf16_f32 v107, v132, v131
    v_and_b32 v116, 0xffff0000, v42
    v_and_b32 v117, 0xffff0000, v46
    v_and_b32 v118, 0xffff0000, v50
    v_and_b32 v119, 0xffff0000, v54
    v_and_b32 v120, 0xffff0000, v58
    s_add_u32 m0, s17, 49152
    s_add_u32 s89, s19, 200704
    buffer_load_dwordx4 v4, s[32:35], s89 offen  lds
    v_and_b32 v121, 0xffff0000, v62
    v_and_b32 v122, 0xffff0000, v66
    v_lshlrev_b32 v127, 16, v94
    v_and_b32 v128, 0xffff0000, v94
    v_lshlrev_b32 v129, 16, v95
    s_waitcnt vmcnt(12)
    s_barrier
    s_add_u32 s97, s98, s0
    s_lshr_b64 s[0:1], s[0:1], 4
    s_and_b32 s97, s97, 15
    s_lshr_b32 s99, s97, 3
    s_xor_b32 s97, s97, s99
    s_lshl_b32 s97, s97, 7
    s_add_u32 m0, s87, 18432
    s_add_u32 s89, s97, 0
    buffer_load_dwordx4 v2, s[28:31], s89 offen  lds
    v_and_b32 v130, 0xffff0000, v95
    v_and_b32 v123, 0xffff0000, v70
    v_and_b32 v124, 0xffff0000, v74
    v_and_b32 v125, 0xffff0000, v78
    v_and_b32 v126, 0xffff0000, v82
    v_mul_f32 v131, v116, v130
    s_mul_i32 s99, s97, 3072
    s_sub_u32 s19, s99, s18
    s_add_u32 s99, s99, s18
    s_add_u32 m0, s16, 8192
    s_add_u32 s89, s99, 0
    buffer_load_dwordx4 v4, s[32:35], s89 offen  lds
    v_mul_f32 v132, v117, v130
    v_mul_f32 v133, v118, v130
    v_mul_f32 v134, v119, v130
    v_fmac_f32 v131, v117, v129
    v_fmac_f32 v132, v118, v129
    v_fmac_f32 v133, v119, v129
    s_add_u32 m0, s87, 22528
    s_add_u32 s89, s97, 65536
    buffer_load_dwordx4 v2, s[28:31], s89 offen  lds
    v_fmac_f32 v134, v120, v129
    v_fmac_f32 v131, v118, v128
    v_fmac_f32 v132, v119, v128
    v_fmac_f32 v133, v120, v128
    v_fmac_f32 v134, v121, v128
    s_add_u32 m0, s16, 32768
    s_add_u32 s89, s99, 2048
    buffer_load_dwordx4 v4, s[32:35], s89 offen  lds
    v_fmac_f32 v131, v119, v127
    v_fmac_f32 v132, v120, v127
    v_fmac_f32 v133, v121, v127
    v_fmac_f32 v134, v122, v127
    v_mul_f32 v131, v131, v123
    v_mul_f32 v132, v132, v124
    s_add_u32 m0, s87, 26624
    s_add_u32 s89, s97, 131072
    buffer_load_dwordx4 v2, s[28:31], s89 offen  lds
    v_mul_f32 v133, v133, v125
    v_mul_f32 v134, v134, v126
    v_cvt_pk_bf16_f32 v104, v134, v133
    v_cvt_pk_bf16_f32 v105, v132, v131
    s_nop 0
    v_permlane32_swap_b32 v106, v104
    v_permlane32_swap_b32 v107, v105
    s_add_u32 m0, s16, 57344
    s_add_u32 s89, s99, 4096
    buffer_load_dwordx4 v4, s[32:35], s89 offen  lds
    s_mov_b32 s89, 16384
    buffer_store_dwordx4 v[104:107], v12, s[52:55], s89 offen sc1
    v_lshlrev_b32 v116, 16, v41
    v_lshlrev_b32 v117, 16, v45
    v_lshlrev_b32 v118, 16, v49
    v_lshlrev_b32 v119, 16, v53
    s_add_u32 m0, s87, 30720
    s_add_u32 s89, s97, 196608
    buffer_load_dwordx4 v2, s[28:31], s89 offen  lds
    v_lshlrev_b32 v120, 16, v57
    v_lshlrev_b32 v121, 16, v61
    v_lshlrev_b32 v122, 16, v65
    v_lshlrev_b32 v127, 16, v88
    v_and_b32 v128, 0xffff0000, v88
    v_lshlrev_b32 v129, 16, v89
    s_mov_b64 exec, 0xffffffff
    s_add_u32 m0, s88, 18432
    s_add_u32 s89, s97, 0
    buffer_load_dwordx4 v3, s[28:31], s89 offen  lds
    s_mov_b64 exec, -1
    v_and_b32 v130, 0xffff0000, v89
    v_lshlrev_b32 v123, 16, v69
    v_lshlrev_b32 v124, 16, v73
    v_lshlrev_b32 v125, 16, v77
    v_lshlrev_b32 v126, 16, v81
    v_mul_f32 v131, v116, v130
    s_add_u32 m0, s17, 8192
    s_add_u32 s89, s19, 196608
    buffer_load_dwordx4 v4, s[32:35], s89 offen  lds
    v_mul_f32 v132, v117, v130
    v_mul_f32 v133, v118, v130
    v_mul_f32 v134, v119, v130
    v_fmac_f32 v131, v117, v129
    v_fmac_f32 v132, v118, v129
    s_add_u32 m0, s17, 32768
    s_add_u32 s89, s19, 198656
    buffer_load_dwordx4 v4, s[32:35], s89 offen  lds
    v_fmac_f32 v133, v119, v129
    v_fmac_f32 v134, v120, v129
    v_fmac_f32 v131, v118, v128
    v_fmac_f32 v132, v119, v128
    v_fmac_f32 v133, v120, v128
    v_fmac_f32 v134, v121, v128
    s_add_u32 m0, s17, 57344
    s_add_u32 s89, s19, 200704
    buffer_load_dwordx4 v4, s[32:35], s89 offen  lds
    v_fmac_f32 v131, v119, v127
    v_fmac_f32 v132, v120, v127
    v_fmac_f32 v133, v121, v127
    v_fmac_f32 v134, v122, v127
    v_mul_f32 v131, v131, v123
    s_waitcnt vmcnt(12)
    s_barrier
    s_add_u32 m0, s94, 32
    s_lshl_b32 s89, s90, 12
    buffer_load_dwordx4 v15, s[48:51], s89 offen offset:0 nt lds
    v_mul_f32 v132, v132, v124
    v_mul_f32 v133, v133, v125
    v_mul_f32 v134, v134, v126
    v_cvt_pk_bf16_f32 v110, v134, v133
    s_add_u32 m0, s94, 32
    s_lshl_b32 s89, s90, 12
    buffer_load_dwordx4 v15, s[48:51], s89 offen offset:1024 nt lds
    v_cvt_pk_bf16_f32 v111, v132, v131
    v_lshlrev_b32 v116, 16, v43
    v_lshlrev_b32 v117, 16, v47
    v_lshlrev_b32 v118, 16, v51
    s_add_u32 m0, s94, 32
    s_lshl_b32 s89, s90, 12
    buffer_load_dwordx4 v15, s[48:51], s89 offen offset:2048 nt lds
    v_lshlrev_b32 v119, 16, v55
    v_lshlrev_b32 v120, 16, v59
    v_lshlrev_b32 v121, 16, v63
    v_lshlrev_b32 v122, 16, v67
    s_add_u32 m0, s94, 32
    s_lshl_b32 s89, s90, 12
    buffer_load_dwordx4 v15, s[48:51], s89 offen offset:3072 nt lds
    v_lshlrev_b32 v127, 16, v96
    v_and_b32 v128, 0xffff0000, v96
    v_lshlrev_b32 v129, 16, v97
    v_and_b32 v130, 0xffff0000, v97
    buffer_load_dwordx4 v[212:215], v9, s[56:59], 0 offen offset:0 nt
    v_lshlrev_b32 v123, 16, v71
    v_lshlrev_b32 v124, 16, v75
    v_lshlrev_b32 v125, 16, v79
    v_lshlrev_b32 v126, 16, v83
    buffer_load_dwordx4 v[216:219], v9, s[56:59], 0 offen offset:2048 nt
    v_mul_f32 v131, v116, v130
    v_mul_f32 v132, v117, v130
    v_mul_f32 v133, v118, v130
    v_mul_f32 v134, v119, v130
    buffer_load_dwordx4 v[220:223], v9, s[56:59], s96 offen offset:0 nt
    v_fmac_f32 v131, v117, v129
    v_fmac_f32 v132, v118, v129
    v_fmac_f32 v133, v119, v129
    v_fmac_f32 v134, v120, v129
    buffer_load_dwordx4 v[224:227], v9, s[56:59], s96 offen offset:2048 nt
    v_fmac_f32 v131, v118, v128
    v_fmac_f32 v132, v119, v128
    v_fmac_f32 v133, v120, v128
    s_add_u32 s97, s98, s0
    s_lshr_b64 s[0:1], s[0:1], 4
    s_and_b32 s97, s97, 15
    s_lshr_b32 s99, s97, 3
    s_xor_b32 s97, s97, s99
    s_lshl_b32 s97, s97, 7
    s_add_u32 m0, s87, 36864
    s_add_u32 s89, s97, 0
    buffer_load_dwordx4 v2, s[28:31], s89 offen  lds
    v_fmac_f32 v134, v121, v128
    v_fmac_f32 v131, v119, v127
    v_fmac_f32 v132, v120, v127
    v_fmac_f32 v133, v121, v127
    s_mul_i32 s99, s97, 3072
    s_sub_u32 s19, s99, s18
    s_add_u32 s99, s99, s18
    s_add_u32 m0, s16, 16384
    s_add_u32 s89, s99, 0
    buffer_load_dwordx4 v4, s[32:35], s89 offen  lds
    v_fmac_f32 v134, v122, v127
    v_mul_f32 v131, v131, v123
    v_mul_f32 v132, v132, v124
    v_mul_f32 v133, v133, v125
    s_add_u32 m0, s87, 40960
    s_add_u32 s89, s97, 65536
    buffer_load_dwordx4 v2, s[28:31], s89 offen  lds
    v_mul_f32 v134, v134, v126
    v_cvt_pk_bf16_f32 v108, v134, v133
    v_cvt_pk_bf16_f32 v109, v132, v131
    s_nop 0
    v_permlane32_swap_b32 v110, v108
    s_add_u32 m0, s16, 40960
    s_add_u32 s89, s99, 2048
    buffer_load_dwordx4 v4, s[32:35], s89 offen  lds
    v_permlane32_swap_b32 v111, v109
    s_mov_b32 s89, 32768
    buffer_store_dwordx4 v[108:111], v12, s[52:55], s89 offen sc1
    v_and_b32 v116, 0xffff0000, v41
    v_and_b32 v117, 0xffff0000, v45
    s_add_u32 m0, s87, 45056
    s_add_u32 s89, s97, 131072
    buffer_load_dwordx4 v2, s[28:31], s89 offen  lds
    v_and_b32 v118, 0xffff0000, v49
    v_and_b32 v119, 0xffff0000, v53
    v_and_b32 v120, 0xffff0000, v57
    v_and_b32 v121, 0xffff0000, v61
    s_add_u32 m0, s16, 65536
    s_add_u32 s89, s99, 4096
    buffer_load_dwordx4 v4, s[32:35], s89 offen  lds
    v_and_b32 v122, 0xffff0000, v65
    v_lshlrev_b32 v127, 16, v90
    v_and_b32 v128, 0xffff0000, v90
    v_lshlrev_b32 v129, 16, v91
    s_add_u32 m0, s87, 49152
    s_add_u32 s89, s97, 196608
    buffer_load_dwordx4 v2, s[28:31], s89 offen  lds
    v_and_b32 v130, 0xffff0000, v91
    v_and_b32 v123, 0xffff0000, v69
    v_and_b32 v124, 0xffff0000, v73
    v_and_b32 v125, 0xffff0000, v77
    s_mov_b64 exec, 0xffffffff
    s_add_u32 m0, s88, 36864
    s_add_u32 s89, s97, 0
    buffer_load_dwordx4 v3, s[28:31], s89 offen  lds
    s_mov_b64 exec, -1
    v_and_b32 v126, 0xffff0000, v81
    v_mul_f32 v131, v116, v130
    v_mul_f32 v132, v117, v130
    s_waitcnt vmcnt(17)
    s_barrier
    s_add_u32 m0, s17, 16384
    s_add_u32 s89, s19, 196608
    buffer_load_dwordx4 v4, s[32:35], s89 offen  lds
    v_mul_f32 v133, v118, v130
    v_mul_f32 v134, v119, v130
    v_fmac_f32 v131, v117, v129
    v_fmac_f32 v132, v118, v129
    v_fmac_f32 v133, v119, v129
    s_add_u32 m0, s17, 40960
    s_add_u32 s89, s19, 198656
    buffer_load_dwordx4 v4, s[32:35], s89 offen  lds
    v_fmac_f32 v134, v120, v129
    v_fmac_f32 v131, v118, v128
    v_fmac_f32 v132, v119, v128
    v_fmac_f32 v133, v120, v128
    s_add_u32 m0, s17, 65536
    s_add_u32 s89, s19, 200704
    buffer_load_dwordx4 v4, s[32:35], s89 offen  lds
    v_fmac_f32 v134, v121, v128
    v_fmac_f32 v131, v119, v127
    v_fmac_f32 v132, v120, v127
    v_fmac_f32 v133, v121, v127
    s_add_u32 s97, s98, s0
    s_lshr_b64 s[0:1], s[0:1], 4
    s_and_b32 s97, s97, 15
    s_lshr_b32 s99, s97, 3
    s_xor_b32 s97, s97, s99
    s_lshl_b32 s97, s97, 7
    s_add_u32 m0, s87, 0
    s_add_u32 s89, s97, 0
    buffer_load_dwordx4 v2, s[28:31], s89 offen  lds
    v_fmac_f32 v134, v122, v127
    v_mul_f32 v131, v131, v123
    v_mul_f32 v132, v132, v124
    v_mul_f32 v133, v133, v125
    v_mul_f32 v134, v134, v126
    s_mul_i32 s99, s97, 3072
    s_sub_u32 s19, s99, s18
    s_add_u32 s99, s99, s18
    s_add_u32 m0, s16, 0
    s_add_u32 s89, s99, 0
    buffer_load_dwordx4 v4, s[32:35], s89 offen  lds
    v_cvt_pk_bf16_f32 v114, v134, v133
    v_cvt_pk_bf16_f32 v115, v132, v131
    v_and_b32 v116, 0xffff0000, v43
    v_and_b32 v117, 0xffff0000, v47
    s_add_u32 m0, s87, 4096
    s_add_u32 s89, s97, 65536
    buffer_load_dwordx4 v2, s[28:31], s89 offen  lds
    v_and_b32 v118, 0xffff0000, v51
    v_and_b32 v119, 0xffff0000, v55
    v_and_b32 v120, 0xffff0000, v59
    v_and_b32 v121, 0xffff0000, v63
    s_add_u32 m0, s16, 24576
    s_add_u32 s89, s99, 2048
    buffer_load_dwordx4 v4, s[32:35], s89 offen  lds
    v_and_b32 v122, 0xffff0000, v67
    v_lshlrev_b32 v127, 16, v98
    v_and_b32 v128, 0xffff0000, v98
    v_lshlrev_b32 v129, 16, v99
    s_add_u32 m0, s87, 8192
    s_add_u32 s89, s97, 131072
    buffer_load_dwordx4 v2, s[28:31], s89 offen  lds
    v_and_b32 v130, 0xffff0000, v99
    v_and_b32 v123, 0xffff0000, v71
    v_and_b32 v124, 0xffff0000, v75
    v_and_b32 v125, 0xffff0000, v79
    v_and_b32 v126, 0xffff0000, v83
    s_add_u32 m0, s16, 49152
    s_add_u32 s89, s99, 4096
    buffer_load_dwordx4 v4, s[32:35], s89 offen  lds
    v_mul_f32 v131, v116, v130
    v_mul_f32 v132, v117, v130
    v_mul_f32 v133, v118, v130
    v_mul_f32 v134, v119, v130
    s_add_u32 m0, s87, 12288
    s_add_u32 s89, s97, 196608
    buffer_load_dwordx4 v2, s[28:31], s89 offen  lds
    v_fmac_f32 v131, v117, v129
    v_fmac_f32 v132, v118, v129
    v_fmac_f32 v133, v119, v129
    v_fmac_f32 v134, v120, v129
    s_mov_b64 exec, 0xffffffff
    s_add_u32 m0, s88, 0
    s_add_u32 s89, s97, 0
    buffer_load_dwordx4 v3, s[28:31], s89 offen  lds
    s_mov_b64 exec, -1
    v_fmac_f32 v131, v118, v128
    v_fmac_f32 v132, v119, v128
    v_fmac_f32 v133, v120, v128
    v_fmac_f32 v134, v121, v128
    v_fmac_f32 v131, v119, v127
    s_add_u32 m0, s17, 0
    s_add_u32 s89, s19, 196608
    buffer_load_dwordx4 v4, s[32:35], s89 offen  lds
    v_fmac_f32 v132, v120, v127
    v_fmac_f32 v133, v121, v127
    v_fmac_f32 v134, v122, v127
    v_mul_f32 v131, v131, v123
    s_add_u32 m0, s17, 24576
    s_add_u32 s89, s19, 198656
    buffer_load_dwordx4 v4, s[32:35], s89 offen  lds
    v_mul_f32 v132, v132, v124
    v_mul_f32 v133, v133, v125
    v_mul_f32 v134, v134, v126
    v_cvt_pk_bf16_f32 v112, v134, v133
    s_add_u32 m0, s17, 49152
    s_add_u32 s89, s19, 200704
    buffer_load_dwordx4 v4, s[32:35], s89 offen  lds
    v_cvt_pk_bf16_f32 v113, v132, v131
    v_permlane32_swap_b32 v114, v112
    s_nop 0
    v_permlane32_swap_b32 v115, v113
    s_mov_b32 s89, 49152
    buffer_store_dwordx4 v[112:115], v12, s[52:55], s89 offen sc1
    s_waitcnt vmcnt(12)
    s_barrier
    s_add_u32 s97, s98, s0
    s_lshr_b64 s[0:1], s[0:1], 4
    s_and_b32 s97, s97, 15
    s_lshr_b32 s99, s97, 3
    s_xor_b32 s97, s97, s99
    s_lshl_b32 s97, s97, 7
    s_add_u32 m0, s87, 18432
    s_add_u32 s89, s97, 0
    buffer_load_dwordx4 v2, s[28:31], s89 offen  lds
    v_add_u32 v5, s94, v15
    ds_read_b128 v[140:143], v5 offset:32
    s_mul_i32 s99, s97, 3072
    s_sub_u32 s19, s99, s18
    s_add_u32 s99, s99, s18
    s_add_u32 m0, s16, 8192
    s_add_u32 s89, s99, 0
    buffer_load_dwordx4 v4, s[32:35], s89 offen  lds
    ds_read_b32 v156, v5 offset:48
    s_add_u32 m0, s87, 22528
    s_add_u32 s89, s97, 65536
    buffer_load_dwordx4 v2, s[28:31], s89 offen  lds
    ds_read_b128 v[144:147], v5 offset:1056
    ds_read_b32 v157, v5 offset:1072
    s_add_u32 m0, s16, 32768
    s_add_u32 s89, s99, 2048
    buffer_load_dwordx4 v4, s[32:35], s89 offen  lds
    ds_read_b128 v[148:151], v5 offset:2080
    s_add_u32 m0, s87, 26624
    s_add_u32 s89, s97, 131072
    buffer_load_dwordx4 v2, s[28:31], s89 offen  lds
    ds_read_b32 v158, v5 offset:2096
    s_add_u32 m0, s16, 57344
    s_add_u32 s89, s99, 4096
    buffer_load_dwordx4 v4, s[32:35], s89 offen  lds
    ds_read_b128 v[152:155], v5 offset:3104
    ds_read_b32 v159, v5 offset:3120
    s_add_u32 m0, s87, 30720
    s_add_u32 s89, s97, 196608
    buffer_load_dwordx4 v2, s[28:31], s89 offen  lds
    v_lshrrev_b32 v6, 3, v0
    s_mov_b64 exec, 0xffffffff
    s_add_u32 m0, s88, 18432
    s_add_u32 s89, s97, 0
    buffer_load_dwordx4 v3, s[28:31], s89 offen  lds
    s_mov_b64 exec, -1
    v_mul_u32_u24 v6, 4160, v6
    s_add_u32 m0, s17, 8192
    s_add_u32 s89, s19, 196608
    buffer_load_dwordx4 v4, s[32:35], s89 offen  lds
    v_and_b32 v7, 7, v0
    v_lshl_add_u32 v6, v7, 2, v6
    s_add_u32 m0, s17, 32768
    s_add_u32 s89, s19, 198656
    buffer_load_dwordx4 v4, s[32:35], s89 offen  lds
    v_add_u32 v6, s94, v6
    s_add_u32 m0, s17, 57344
    s_add_u32 s89, s19, 200704
    buffer_load_dwordx4 v4, s[32:35], s89 offen  lds
    v_mov_b32 v7, 0
    s_waitcnt vmcnt(12)
    s_waitcnt vmcnt(11)
    s_barrier
    s_add_u32 s97, s98, s0
    s_lshr_b64 s[0:1], s[0:1], 4
    s_and_b32 s97, s97, 15
    s_lshr_b32 s99, s97, 3
    s_xor_b32 s97, s97, s99
    s_lshl_b32 s97, s97, 7
    s_add_u32 m0, s87, 36864
    s_add_u32 s89, s97, 0
    buffer_load_dwordx4 v2, s[28:31], s89 offen  lds
    s_waitcnt lgkmcnt(0)
    v_readfirstlane_b32 s93, v140
    s_nop 0
    s_lshl_b32 s93, s93, 16
    s_mul_i32 s99, s97, 3072
    s_sub_u32 s19, s99, s18
    s_add_u32 s99, s99, s18
    s_add_u32 m0, s16, 16384
    s_add_u32 s89, s99, 0
    buffer_load_dwordx4 v4, s[32:35], s89 offen  lds
    v_writelane_b32 v7, s93, 15
    v_alignbit_b32 v140, v141, v140, 16
    s_add_u32 m0, s87, 40960
    s_add_u32 s89, s97, 65536
    buffer_load_dwordx4 v2, s[28:31], s89 offen  lds
    v_alignbit_b32 v141, v142, v141, 16
    v_alignbit_b32 v142, v143, v142, 16
    s_add_u32 m0, s16, 40960
    s_add_u32 s89, s99, 2048
    buffer_load_dwordx4 v4, s[32:35], s89 offen  lds
    v_alignbit_b32 v143, v156, v143, 16
    v_alignbit_b32 v144, v145, v144, 16
    v_alignbit_b32 v145, v146, v145, 16
    s_add_u32 m0, s87, 45056
    s_add_u32 s89, s97, 131072
    buffer_load_dwordx4 v2, s[28:31], s89 offen  lds
    v_alignbit_b32 v146, v147, v146, 16
    v_alignbit_b32 v147, v157, v147, 16
    s_add_u32 m0, s16, 65536
    s_add_u32 s89, s99, 4096
    buffer_load_dwordx4 v4, s[32:35], s89 offen  lds
    v_alignbit_b32 v148, v149, v148, 16
    v_alignbit_b32 v149, v150, v149, 16
    s_add_u32 m0, s87, 49152
    s_add_u32 s89, s97, 196608
    buffer_load_dwordx4 v2, s[28:31], s89 offen  lds
    v_alignbit_b32 v150, v151, v150, 16
    v_alignbit_b32 v151, v158, v151, 16
    s_mov_b64 exec, 0xffffffff
    s_add_u32 m0, s88, 36864
    s_add_u32 s89, s97, 0
    buffer_load_dwordx4 v3, s[28:31], s89 offen  lds
    s_mov_b64 exec, -1
    v_alignbit_b32 v152, v153, v152, 16
    v_alignbit_b32 v153, v154, v153, 16
    v_alignbit_b32 v154, v155, v154, 16
    s_add_u32 m0, s17, 16384
    s_add_u32 s89, s19, 196608
    buffer_load_dwordx4 v4, s[32:35], s89 offen  lds
    v_alignbit_b32 v155, v159, v155, 16
    v_lshlrev_b32 v8, 3, v0
    s_add_u32 m0, s17, 40960
    s_add_u32 s89, s19, 198656
    buffer_load_dwordx4 v4, s[32:35], s89 offen  lds
    s_add_u32 s78, s88, 18432
    v_add_u32 v8, s78, v8
    s_add_u32 m0, s17, 65536
    s_add_u32 s89, s19, 200704
    buffer_load_dwordx4 v4, s[32:35], s89 offen  lds
    v_mov_b32 v156, 0
    v_mov_b32 v157, 0
    s_waitcnt vmcnt(11)
    s_barrier
    s_add_u32 s97, s98, s0
    s_lshr_b64 s[0:1], s[0:1], 4
    s_and_b32 s97, s97, 15
    s_lshr_b32 s99, s97, 3
    s_xor_b32 s97, s97, s99
    s_lshl_b32 s97, s97, 7
    s_add_u32 m0, s87, 0
    s_add_u32 s89, s97, 0
    buffer_load_dwordx4 v2, s[28:31], s89 offen  lds
    s_mul_i32 s99, s97, 3072
    s_sub_u32 s19, s99, s18
    s_add_u32 s99, s99, s18
    s_add_u32 m0, s16, 0
    s_add_u32 s89, s99, 0
    buffer_load_dwordx4 v4, s[32:35], s89 offen  lds
    s_add_u32 m0, s87, 4096
    s_add_u32 s89, s97, 65536
    buffer_load_dwordx4 v2, s[28:31], s89 offen  lds
    s_add_u32 m0, s16, 24576
    s_add_u32 s89, s99, 2048
    buffer_load_dwordx4 v4, s[32:35], s89 offen  lds
    s_add_u32 m0, s87, 8192
    s_add_u32 s89, s97, 131072
    buffer_load_dwordx4 v2, s[28:31], s89 offen  lds
    s_add_u32 m0, s16, 49152
    s_add_u32 s89, s99, 4096
    buffer_load_dwordx4 v4, s[32:35], s89 offen  lds
    s_add_u32 m0, s87, 12288
    s_add_u32 s89, s97, 196608
    buffer_load_dwordx4 v2, s[28:31], s89 offen  lds
    s_mov_b64 exec, 0xffffffff
    s_add_u32 m0, s88, 0
    s_add_u32 s89, s97, 0
    buffer_load_dwordx4 v3, s[28:31], s89 offen  lds
    s_mov_b64 exec, -1
    s_add_u32 m0, s17, 0
    s_add_u32 s89, s19, 196608
    buffer_load_dwordx4 v4, s[32:35], s89 offen  lds
    s_add_u32 m0, s17, 24576
    s_add_u32 s89, s19, 198656
    buffer_load_dwordx4 v4, s[32:35], s89 offen  lds
    s_add_u32 m0, s17, 49152
    s_add_u32 s89, s19, 200704
    buffer_load_dwordx4 v4, s[32:35], s89 offen  lds
    s_mov_b64 exec, 0xff
    buffer_load_dword v136, v33, s[68:71], 0 offen sc1
    buffer_load_dword v137, v34, s[52:55], 0 offen sc1
    s_mov_b64 exec, -1
    s_waitcnt vmcnt(13)
    s_barrier
    s_waitcnt vmcnt(0)
    s_branch LA_j
LA_c3:
    s_waitcnt vmcnt(7)
    s_barrier
    s_mov_b64 exec, 0xffffffff
    s_add_u32 m0, s88, 18432
    s_add_u32 s89, s97, 0
    buffer_load_dwordx4 v3, s[28:31], s89 offen  lds
    s_mov_b64 exec, -1
    s_add_u32 m0, s17, 8192
    s_add_u32 s89, s19, 196608
    buffer_load_dwordx4 v4, s[32:35], s89 offen  lds
    s_add_u32 m0, s17, 32768
    s_add_u32 s89, s19, 198656
    buffer_load_dwordx4 v4, s[32:35], s89 offen  lds
    s_add_u32 m0, s17, 57344
    s_add_u32 s89, s19, 200704
    buffer_load_dwordx4 v4, s[32:35], s89 offen  lds
    s_add_u32 s97, s98, s0
    s_lshr_b64 s[0:1], s[0:1], 4
    s_and_b32 s97, s97, 15
    s_lshr_b32 s99, s97, 3
    s_xor_b32 s97, s97, s99
    s_lshl_b32 s97, s97, 7
    s_add_u32 m0, s87, 36864
    s_add_u32 s89, s97, 0
    buffer_load_dwordx4 v2, s[28:31], s89 offen  lds
    s_mul_i32 s99, s97, 3072
    s_sub_u32 s19, s99, s18
    s_add_u32 s99, s99, s18
    s_add_u32 m0, s16, 16384
    s_add_u32 s89, s99, 0
    buffer_load_dwordx4 v4, s[32:35], s89 offen  lds
    s_add_u32 m0, s87, 40960
    s_add_u32 s89, s97, 65536
    buffer_load_dwordx4 v2, s[28:31], s89 offen  lds
    s_add_u32 m0, s16, 40960
    s_add_u32 s89, s99, 2048
    buffer_load_dwordx4 v4, s[32:35], s89 offen  lds
    s_add_u32 m0, s87, 45056
    s_add_u32 s89, s97, 131072
    buffer_load_dwordx4 v2, s[28:31], s89 offen  lds
    s_add_u32 m0, s16, 65536
    s_add_u32 s89, s99, 4096
    buffer_load_dwordx4 v4, s[32:35], s89 offen  lds
    s_add_u32 m0, s87, 49152
    s_add_u32 s89, s97, 196608
    buffer_load_dwordx4 v2, s[28:31], s89 offen  lds
    s_mov_b64 exec, 0xffffffff
    s_add_u32 m0, s88, 36864
    s_add_u32 s89, s97, 0
    buffer_load_dwordx4 v3, s[28:31], s89 offen  lds
    s_mov_b64 exec, -1
    s_add_u32 m0, s17, 16384
    s_add_u32 s89, s19, 196608
    buffer_load_dwordx4 v4, s[32:35], s89 offen  lds
    s_add_u32 m0, s17, 40960
    s_add_u32 s89, s19, 198656
    buffer_load_dwordx4 v4, s[32:35], s89 offen  lds
    s_add_u32 m0, s17, 65536
    s_add_u32 s89, s19, 200704
    buffer_load_dwordx4 v4, s[32:35], s89 offen  lds
    s_waitcnt vmcnt(11)
    s_barrier
    s_add_u32 s97, s98, s0
    s_lshr_b64 s[0:1], s[0:1], 4
    s_and_b32 s97, s97, 15
    s_lshr_b32 s99, s97, 3
    s_xor_b32 s97, s97, s99
    s_lshl_b32 s97, s97, 7
    s_add_u32 m0, s87, 0
    s_add_u32 s89, s97, 0
    buffer_load_dwordx4 v2, s[28:31], s89 offen  lds
    s_mul_i32 s99, s97, 3072
    s_sub_u32 s19, s99, s18
    s_add_u32 s99, s99, s18
    s_add_u32 m0, s16, 0
    s_add_u32 s89, s99, 0
    buffer_load_dwordx4 v4, s[32:35], s89 offen  lds
    s_add_u32 m0, s87, 4096
    s_add_u32 s89, s97, 65536
    buffer_load_dwordx4 v2, s[28:31], s89 offen  lds
    s_add_u32 m0, s16, 24576
    s_add_u32 s89, s99, 2048
    buffer_load_dwordx4 v4, s[32:35], s89 offen  lds
    s_add_u32 m0, s87, 8192
    s_add_u32 s89, s97, 131072
    buffer_load_dwordx4 v2, s[28:31], s89 offen  lds
    s_add_u32 m0, s16, 49152
    s_add_u32 s89, s99, 4096
    buffer_load_dwordx4 v4, s[32:35], s89 offen  lds
    s_add_u32 m0, s87, 12288
    s_add_u32 s89, s97, 196608
    buffer_load_dwordx4 v2, s[28:31], s89 offen  lds
    s_mov_b64 exec, 0xffffffff
    s_add_u32 m0, s88, 0
    s_add_u32 s89, s97, 0
    buffer_load_dwordx4 v3, s[28:31], s89 offen  lds
    s_mov_b64 exec, -1
    s_add_u32 m0, s17, 0
    s_add_u32 s89, s19, 196608
    buffer_load_dwordx4 v4, s[32:35], s89 offen  lds
    s_add_u32 m0, s17, 24576
    s_add_u32 s89, s19, 198656
    buffer_load_dwordx4 v4, s[32:35], s89 offen  lds
    s_add_u32 m0, s17, 49152
    s_add_u32 s89, s19, 200704
    buffer_load_dwordx4 v4, s[32:35], s89 offen  lds
    s_waitcnt vmcnt(11)
    s_barrier
    s_add_u32 s97, s98, s0
    s_lshr_b64 s[0:1], s[0:1], 4
    s_and_b32 s97, s97, 15
    s_lshr_b32 s99, s97, 3
    s_xor_b32 s97, s97, s99
    s_lshl_b32 s97, s97, 7
    s_add_u32 m0, s87, 18432
    s_add_u32 s89, s97, 0
    buffer_load_dwordx4 v2, s[28:31], s89 offen  lds
    s_mul_i32 s99, s97, 3072
    s_sub_u32 s19, s99, s18
    s_add_u32 s99, s99, s18
    s_add_u32 m0, s16, 8192
    s_add_u32 s89, s99, 0
    buffer_load_dwordx4 v4, s[32:35], s89 offen  lds
    s_add_u32 m0, s87, 22528
    s_add_u32 s89, s97, 65536
    buffer_load_dwordx4 v2, s[28:31], s89 offen  lds
    s_add_u32 m0, s16, 32768
    s_add_u32 s89, s99, 2048
    buffer_load_dwordx4 v4, s[32:35], s89 offen  lds
    s_add_u32 m0, s87, 26624
    s_add_u32 s89, s97, 131072
    buffer_load_dwordx4 v2, s[28:31], s89 offen  lds
    s_add_u32 m0, s16, 57344
    s_add_u32 s89, s99, 4096
    buffer_load_dwordx4 v4, s[32:35], s89 offen  lds
    s_add_u32 m0, s87, 30720
    s_add_u32 s89, s97, 196608
    buffer_load_dwordx4 v2, s[28:31], s89 offen  lds
    s_mov_b64 exec, 0xffffffff
    s_add_u32 m0, s88, 18432
    s_add_u32 s89, s97, 0
    buffer_load_dwordx4 v3, s[28:31], s89 offen  lds
    s_mov_b64 exec, -1
    s_add_u32 m0, s17, 8192
    s_add_u32 s89, s19, 196608
    buffer_load_dwordx4 v4, s[32:35], s89 offen  lds
    s_add_u32 m0, s17, 32768
    s_add_u32 s89, s19, 198656
    buffer_load_dwordx4 v4, s[32:35], s89 offen  lds
    s_add_u32 m0, s17, 57344
    s_add_u32 s89, s19, 200704
    buffer_load_dwordx4 v4, s[32:35], s89 offen  lds
    s_waitcnt vmcnt(11)
    s_barrier
    s_add_u32 m0, s86, 129536
    s_mov_b32 s89, 0
    buffer_load_dwordx4 v10, s[36:39], s89 offen nt lds
    s_add_u32 m0, s86, 145920
    s_mov_b32 s89, 0
    buffer_load_dwordx4 v10, s[40:43], s89 offen nt lds
    s_add_u32 m0, s86, 133632
    s_mov_b32 s89, 65536
    buffer_load_dwordx4 v10, s[36:39], s89 offen nt lds
    s_add_u32 m0, s86, 150016
    s_mov_b32 s89, 65536
    buffer_load_dwordx4 v10, s[40:43], s89 offen nt lds
    s_add_u32 m0, s86, 137728
    s_mov_b32 s89, 131072
    buffer_load_dwordx4 v10, s[36:39], s89 offen nt lds
    s_add_u32 m0, s86, 154112
    s_mov_b32 s89, 131072
    buffer_load_dwordx4 v10, s[40:43], s89 offen nt lds
    s_add_u32 m0, s86, 141824
    s_mov_b32 s89, 196608
    buffer_load_dwordx4 v10, s[36:39], s89 offen nt lds
    s_add_u32 m0, s86, 158208
    s_mov_b32 s89, 196608
    buffer_load_dwordx4 v10, s[40:43], s89 offen nt lds
    s_mov_b64 exec, 0xff
    s_lshl_b32 s82, s3, 7
    s_add_u32 m0, s82, 129024
    s_mov_b32 s89, 0
    buffer_load_dwordx4 v11, s[36:39], s89 offen nt lds
    s_lshl_b32 s83, s74, 9
    s_add_u32 s83, s83, s82
    s_and_b32 s89, s3, 2
    s_lshl_b32 s89, s89, 3
    s_add_u32 s82, s82, s89
    s_add_u32 m0, s82, 162816
    s_add_u32 s89, s83, 0
    buffer_load_dwordx4 v15, s[44:47], s89 offen  lds
    s_mov_b64 exec, -1
    s_add_u32 s97, s98, s0
    s_lshr_b64 s[0:1], s[0:1], 4
    s_and_b32 s97, s97, 15
    s_lshr_b32 s99, s97, 3
    s_xor_b32 s97, s97, s99
    s_lshl_b32 s97, s97, 7
    s_add_u32 m0, s87, 36864
    s_add_u32 s89, s97, 0
    buffer_load_dwordx4 v2, s[28:31], s89 offen  lds
    s_mul_i32 s99, s97, 3072
    s_sub_u32 s19, s99, s18
    s_add_u32 s99, s99, s18
    s_add_u32 m0, s16, 16384
    s_add_u32 s89, s99, 0
    buffer_load_dwordx4 v4, s[32:35], s89 offen  lds
    s_add_u32 m0, s87, 40960
    s_add_u32 s89, s97, 65536
    buffer_load_dwordx4 v2, s[28:31], s89 offen  lds
    s_add_u32 m0, s16, 40960
    s_add_u32 s89, s99, 2048
    buffer_load_dwordx4 v4, s[32:35], s89 offen  lds
    s_add_u32 m0, s87, 45056
    s_add_u32 s89, s97, 131072
    buffer_load_dwordx4 v2, s[28:31], s89 offen  lds
    s_add_u32 m0, s16, 65536
    s_add_u32 s89, s99, 4096
    buffer_load_dwordx4 v4, s[32:35], s89 offen  lds
    s_add_u32 m0, s87, 49152
    s_add_u32 s89, s97, 196608
    buffer_load_dwordx4 v2, s[28:31], s89 offen  lds
    s_waitcnt vmcnt(17)
    s_barrier
    s_mov_b64 exec, 0xffffffff
    s_add_u32 m0, s88, 36864
    s_add_u32 s89, s97, 0
    buffer_load_dwordx4 v3, s[28:31], s89 offen  lds
    s_mov_b64 exec, -1
    s_add_u32 m0, s17, 16384
    s_add_u32 s89, s19, 196608
    buffer_load_dwordx4 v4, s[32:35], s89 offen  lds
    s_add_u32 m0, s17, 40960
    s_add_u32 s89, s19, 198656
    buffer_load_dwordx4 v4, s[32:35], s89 offen  lds
    s_add_u32 m0, s17, 65536
    s_add_u32 s89, s19, 200704
    buffer_load_dwordx4 v4, s[32:35], s89 offen  lds
    s_add_u32 s97, s98, s0
    s_lshr_b64 s[0:1], s[0:1], 4
    s_and_b32 s97, s97, 15
    s_lshr_b32 s99, s97, 3
    s_xor_b32 s97, s97, s99
    s_lshl_b32 s97, s97, 7
    s_add_u32 m0, s87, 0
    s_add_u32 s89, s97, 0
    buffer_load_dwordx4 v2, s[28:31], s89 offen  lds
    s_mul_i32 s99, s97, 3072
    s_sub_u32 s19, s99, s18
    s_add_u32 s99, s99, s18
    s_add_u32 m0, s16, 0
    s_add_u32 s89, s99, 0
    buffer_load_dwordx4 v4, s[32:35], s89 offen  lds
    s_add_u32 m0, s87, 4096
    s_add_u32 s89, s97, 65536
    buffer_load_dwordx4 v2, s[28:31], s89 offen  lds
    s_add_u32 m0, s16, 24576
    s_add_u32 s89, s99, 2048
    buffer_load_dwordx4 v4, s[32:35], s89 offen  lds
    s_add_u32 m0, s87, 8192
    s_add_u32 s89, s97, 131072
    buffer_load_dwordx4 v2, s[28:31], s89 offen  lds
    s_add_u32 m0, s16, 49152
    s_add_u32 s89, s99, 4096
    buffer_load_dwordx4 v4, s[32:35], s89 offen  lds
    s_add_u32 m0, s87, 12288
    s_add_u32 s89, s97, 196608
    buffer_load_dwordx4 v2, s[28:31], s89 offen  lds
    s_mov_b64 exec, 0xffffffff
    s_add_u32 m0, s88, 0
    s_add_u32 s89, s97, 0
    buffer_load_dwordx4 v3, s[28:31], s89 offen  lds
    s_mov_b64 exec, -1
    s_add_u32 m0, s17, 0
    s_add_u32 s89, s19, 196608
    buffer_load_dwordx4 v4, s[32:35], s89 offen  lds
    s_add_u32 m0, s17, 24576
    s_add_u32 s89, s19, 198656
    buffer_load_dwordx4 v4, s[32:35], s89 offen  lds
    s_add_u32 m0, s17, 49152
    s_add_u32 s89, s19, 200704
    buffer_load_dwordx4 v4, s[32:35], s89 offen  lds
    s_waitcnt vmcnt(11)
    s_barrier
    s_add_u32 s97, s98, s0
    s_lshr_b64 s[0:1], s[0:1], 4
    s_and_b32 s97, s97, 15
    s_lshr_b32 s99, s97, 3
    s_xor_b32 s97, s97, s99
    s_lshl_b32 s97, s97, 7
    s_add_u32 m0, s87, 18432
    s_add_u32 s89, s97, 0
    buffer_load_dwordx4 v2, s[28:31], s89 offen  lds
    ds_read_b128 v[84:87], v35 offset:0
    ds_read_b128 v[88:91], v35 offset:16
    s_mul_i32 s99, s97, 3072
    s_sub_u32 s19, s99, s18
    s_add_u32 s99, s99, s18
    s_add_u32 m0, s16, 8192
    s_add_u32 s89, s99, 0
    buffer_load_dwordx4 v4, s[32:35], s89 offen  lds
    ds_read_b128 v[92:95], v35 offset:32
    s_add_u32 m0, s87, 22528
    s_add_u32 s89, s97, 65536
    buffer_load_dwordx4 v2, s[28:31], s89 offen  lds
    ds_read_b128 v[96:99], v35 offset:48
    ds_read_b128 v[40:43], v233 offset:0
    s_add_u32 m0, s16, 32768
    s_add_u32 s89, s99, 2048
    buffer_load_dwordx4 v4, s[32:35], s89 offen  lds
    ds_read_b128 v[44:47], v232 offset:256
    s_add_u32 m0, s87, 26624
    s_add_u32 s89, s97, 131072
    buffer_load_dwordx4 v2, s[28:31], s89 offen  lds
    ds_read_b128 v[48:51], v233 offset:256
    s_add_u32 m0, s16, 57344
    s_add_u32 s89, s99, 4096
    buffer_load_dwordx4 v4, s[32:35], s89 offen  lds
    ds_read_b128 v[52:55], v16 offset:512
    ds_read_b128 v[56:59], v231 offset:512
    s_add_u32 m0, s87, 30720
    s_add_u32 s89, s97, 196608
    buffer_load_dwordx4 v2, s[28:31], s89 offen  lds
    ds_read_b128 v[60:63], v16 offset:768
    s_mov_b64 exec, 0xffffffff
    s_add_u32 m0, s88, 18432
    s_add_u32 s89, s97, 0
    buffer_load_dwordx4 v3, s[28:31], s89 offen  lds
    s_mov_b64 exec, -1
    ds_read_b128 v[64:67], v231 offset:768
    s_add_u32 m0, s17, 8192
    s_add_u32 s89, s19, 196608
    buffer_load_dwordx4 v4, s[32:35], s89 offen  lds
    ds_read_b128 v[68:71], v16 offset:16896
    ds_read_b128 v[72:75], v231 offset:16896
    s_add_u32 m0, s17, 32768
    s_add_u32 s89, s19, 198656
    buffer_load_dwordx4 v4, s[32:35], s89 offen  lds
    ds_read_b128 v[76:79], v16 offset:17152
    s_add_u32 m0, s17, 57344
    s_add_u32 s89, s19, 200704
    buffer_load_dwordx4 v4, s[32:35], s89 offen  lds
    ds_read_b128 v[80:83], v231 offset:17152
    s_waitcnt vmcnt(11)
    s_waitcnt lgkmcnt(0)
    s_barrier
    s_add_u32 s97, s98, s0
    s_lshr_b64 s[0:1], s[0:1], 4
    s_and_b32 s97, s97, 15
    s_lshr_b32 s99, s97, 3
    s_xor_b32 s97, s97, s99
    s_lshl_b32 s97, s97, 7
    s_add_u32 m0, s87, 36864
    s_add_u32 s89, s97, 0
    buffer_load_dwordx4 v2, s[28:31], s89 offen  lds
    v_lshlrev_b32 v116, 16, v40
    v_lshlrev_b32 v117, 16, v44
    v_lshlrev_b32 v118, 16, v48
    v_lshlrev_b32 v119, 16, v52
    v_lshlrev_b32 v120, 16, v56
    v_lshlrev_b32 v121, 16, v60
    s_mul_i32 s99, s97, 3072
    s_sub_u32 s19, s99, s18
    s_add_u32 s99, s99, s18
    s_add_u32 m0, s16, 16384
    s_add_u32 s89, s99, 0
    buffer_load_dwordx4 v4, s[32:35], s89 offen  lds
    v_lshlrev_b32 v122, 16, v64
    v_lshlrev_b32 v127, 16, v84
    v_and_b32 v128, 0xffff0000, v84
    v_lshlrev_b32 v129, 16, v85
    v_and_b32 v130, 0xffff0000, v85
    v_lshlrev_b32 v123, 16, v68
    s_add_u32 m0, s87, 40960
    s_add_u32 s89, s97, 65536
    buffer_load_dwordx4 v2, s[28:31], s89 offen  lds
    v_lshlrev_b32 v124, 16, v72
    v_lshlrev_b32 v125, 16, v76
    v_lshlrev_b32 v126, 16, v80
    v_mul_f32 v131, v116, v130
    v_mul_f32 v132, v117, v130
    s_add_u32 m0, s16, 40960
    s_add_u32 s89, s99, 2048
    buffer_load_dwordx4 v4, s[32:35], s89 offen  lds
    v_mul_f32 v133, v118, v130
    v_mul_f32 v134, v119, v130
    v_fmac_f32 v131, v117, v129
    v_fmac_f32 v132, v118, v129
    v_fmac_f32 v133, v119, v129
    v_fmac_f32 v134, v120, v129
    s_add_u32 m0, s87, 45056
    s_add_u32 s89, s97, 131072
    buffer_load_dwordx4 v2, s[28:31], s89 offen  lds
    v_fmac_f32 v131, v118, v128
    v_fmac_f32 v132, v119, v128
    v_fmac_f32 v133, v120, v128
    v_fmac_f32 v134, v121, v128
    v_fmac_f32 v131, v119, v127
    v_fmac_f32 v132, v120, v127
    s_add_u32 m0, s16, 65536
    s_add_u32 s89, s99, 4096
    buffer_load_dwordx4 v4, s[32:35], s89 offen  lds
    v_fmac_f32 v133, v121, v127
    v_fmac_f32 v134, v122, v127
    v_mul_f32 v131, v131, v123
    v_mul_f32 v132, v132, v124
    v_mul_f32 v133, v133, v125
    s_add_u32 m0, s87, 49152
    s_add_u32 s89, s97, 196608
    buffer_load_dwordx4 v2, s[28:31], s89 offen  lds
    v_mul_f32 v134, v134, v126
    v_cvt_pk_bf16_f32 v102, v134, v133
    v_cvt_pk_bf16_f32 v103, v132, v131
    v_lshlrev_b32 v116, 16, v42
    v_lshlrev_b32 v117, 16, v46
    v_lshlrev_b32 v118, 16, v50
    s_mov_b64 exec, 0xffffffff
    s_add_u32 m0, s88, 36864
    s_add_u32 s89, s97, 0
    buffer_load_dwordx4 v3, s[28:31], s89 offen  lds
    s_mov_b64 exec, -1
    v_lshlrev_b32 v119, 16, v54
    v_lshlrev_b32 v120, 16, v58
    v_lshlrev_b32 v121, 16, v62
    v_lshlrev_b32 v122, 16, v66
    v_lshlrev_b32 v127, 16, v92
    v_and_b32 v128, 0xffff0000, v92
    s_add_u32 m0, s17, 16384
    s_add_u32 s89, s19, 196608
    buffer_load_dwordx4 v4, s[32:35], s89 offen  lds
    v_lshlrev_b32 v129, 16, v93
    v_and_b32 v130, 0xffff0000, v93
    v_lshlrev_b32 v123, 16, v70
    v_lshlrev_b32 v124, 16, v74
    v_lshlrev_b32 v125, 16, v78
    s_add_u32 m0, s17, 40960
    s_add_u32 s89, s19, 198656
    buffer_load_dwordx4 v4, s[32:35], s89 offen  lds
    v_lshlrev_b32 v126, 16, v82
    v_mul_f32 v131, v116, v130
    v_mul_f32 v132, v117, v130
    v_mul_f32 v133, v118, v130
    v_mul_f32 v134, v119, v130
    v_fmac_f32 v131, v117, v129
    s_add_u32 m0, s17, 65536
    s_add_u32 s89, s19, 200704
    buffer_load_dwordx4 v4, s[32:35], s89 offen  lds
    v_fmac_f32 v132, v118, v129
    v_fmac_f32 v133, v119, v129
    v_fmac_f32 v134, v120, v129
    v_fmac_f32 v131, v118, v128
    v_fmac_f32 v132, v119, v128
    s_waitcnt vmcnt(11)
    s_barrier
    s_add_u32 s97, s98, s0
    s_lshr_b64 s[0:1], s[0:1], 4
    s_and_b32 s97, s97, 15
    s_lshr_b32 s99, s97, 3
    s_xor_b32 s97, s97, s99
    s_lshl_b32 s97, s97, 7
    s_add_u32 m0, s87, 0
    s_add_u32 s89, s97, 0
    buffer_load_dwordx4 v2, s[28:31], s89 offen  lds
    v_fmac_f32 v133, v120, v128
    v_fmac_f32 v134, v121, v128
    v_fmac_f32 v131, v119, v127
    v_fmac_f32 v132, v120, v127
    v_fmac_f32 v133, v121, v127
    v_fmac_f32 v134, v122, v127
    s_mul_i32 s99, s97, 3072
    s_sub_u32 s19, s99, s18
    s_add_u32 s99, s99, s18
    s_add_u32 m0, s16, 0
    s_add_u32 s89, s99, 0
    buffer_load_dwordx4 v4, s[32:35], s89 offen  lds
    v_mul_f32 v131, v131, v123
    v_mul_f32 v132, v132, v124
    v_mul_f32 v133, v133, v125
    v_mul_f32 v134, v134, v126
    v_cvt_pk_bf16_f32 v100, v134, v133
    v_cvt_pk_bf16_f32 v101, v132, v131
    s_add_u32 m0, s87, 4096
    s_add_u32 s89, s97, 65536
    buffer_load_dwordx4 v2, s[28:31], s89 offen  lds
    v_permlane32_swap_b32 v102, v100
    v_permlane32_swap_b32 v103, v101
    s_mov_b32 s89, 0
    buffer_store_dwordx4 v[100:103], v12, s[52:55], s89 offen sc1
    v_and_b32 v116, 0xffff0000, v40
    v_and_b32 v117, 0xffff0000, v44
    s_add_u32 m0, s16, 24576
    s_add_u32 s89, s99, 2048
    buffer_load_dwordx4 v4, s[32:35], s89 offen  lds
    v_and_b32 v118, 0xffff0000, v48
    v_and_b32 v119, 0xffff0000, v52
    v_and_b32 v120, 0xffff0000, v56
    v_and_b32 v121, 0xffff0000, v60
    v_and_b32 v122, 0xffff0000, v64
    v_lshlrev_b32 v127, 16, v86
    s_add_u32 m0, s87, 8192
    s_add_u32 s89, s97, 131072
    buffer_load_dwordx4 v2, s[28:31], s89 offen  lds
    v_and_b32 v128, 0xffff0000, v86
    v_lshlrev_b32 v129, 16, v87
    v_and_b32 v130, 0xffff0000, v87
    v_and_b32 v123, 0xffff0000, v68
    v_and_b32 v124, 0xffff0000, v72
    v_and_b32 v125, 0xffff0000, v76
    s_add_u32 m0, s16, 49152
    s_add_u32 s89, s99, 4096
    buffer_load_dwordx4 v4, s[32:35], s89 offen  lds
    v_and_b32 v126, 0xffff0000, v80
    v_mul_f32 v131, v116, v130
    v_mul_f32 v132, v117, v130
    v_mul_f32 v133, v118, v130
    v_mul_f32 v134, v119, v130
    s_add_u32 m0, s87, 12288
    s_add_u32 s89, s97, 196608
    buffer_load_dwordx4 v2, s[28:31], s89 offen  lds
    v_fmac_f32 v131, v117, v129
    v_fmac_f32 v132, v118, v129
    v_fmac_f32 v133, v119, v129
    v_fmac_f32 v134, v120, v129
    v_fmac_f32 v131, v118, v128
    v_fmac_f32 v132, v119, v128
    s_mov_b64 exec, 0xffffffff
    s_add_u32 m0, s88, 0
    s_add_u32 s89, s97, 0
    buffer_load_dwordx4 v3, s[28:31], s89 offen  lds
    s_mov_b64 exec, -1
    v_fmac_f32 v133, v120, v128
    v_fmac_f32 v134, v121, v128
    v_fmac_f32 v131, v119, v127
    v_fmac_f32 v132, v120, v127
    v_fmac_f32 v133, v121, v127
    v_fmac_f32 v134, v122, v127
    s_add_u32 m0, s17, 0
    s_add_u32 s89, s19, 196608
    buffer_load_dwordx4 v4, s[32:35], s89 offen  lds
    v_mul_f32 v131, v131, v123
    v_mul_f32 v132, v132, v124
    v_mul_f32 v133, v133, v125
    v_mul_f32 v134, v134, v126
    v_cvt_pk_bf16_f32 v106, v134, v133
    s_add_u32 m0, s17, 24576
    s_add_u32 s89, s19, 198656
    buffer_load_dwordx4 v4, s[32:35], s89 offen  lds
    v_cvt_pk_bf16_f32 v107, v132, v131
    v_and_b32 v116, 0xffff0000, v42
    v_and_b32 v117, 0xffff0000, v46
    v_and_b32 v118, 0xffff0000, v50
    v_and_b32 v119, 0xffff0000, v54
    v_and_b32 v120, 0xffff0000, v58
    s_add_u32 m0, s17, 49152
    s_add_u32 s89, s19, 200704
    buffer_load_dwordx4 v4, s[32:35], s89 offen  lds
    v_and_b32 v121, 0xffff0000, v62
    v_and_b32 v122, 0xffff0000, v66
    v_lshlrev_b32 v127, 16, v94
    v_and_b32 v128, 0xffff0000, v94
    v_lshlrev_b32 v129, 16, v95
    s_waitcnt vmcnt(12)
    s_barrier
    s_add_u32 s97, s98, s0
    s_lshr_b64 s[0:1], s[0:1], 4
    s_and_b32 s97, s97, 15
    s_lshr_b32 s99, s97, 3
    s_xor_b32 s97, s97, s99
    s_lshl_b32 s97, s97, 7
    s_add_u32 m0, s87, 18432
    s_add_u32 s89, s97, 0
    buffer_load_dwordx4 v2, s[28:31], s89 offen  lds
    v_and_b32 v130, 0xffff0000, v95
    v_and_b32 v123, 0xffff0000, v70
    v_and_b32 v124, 0xffff0000, v74
    v_and_b32 v125, 0xffff0000, v78
    v_and_b32 v126, 0xffff0000, v82
    v_mul_f32 v131, v116, v130
    s_mul_i32 s99, s97, 3072
    s_sub_u32 s19, s99, s18
    s_add_u32 s99, s99, s18
    s_add_u32 m0, s16, 8192
    s_add_u32 s89, s99, 0
    buffer_load_dwordx4 v4, s[32:35], s89 offen  lds
    v_mul_f32 v132, v117, v130
    v_mul_f32 v133, v118, v130
    v_mul_f32 v134, v119, v130
    v_fmac_f32 v131, v117, v129
    v_fmac_f32 v132, v118, v129
    v_fmac_f32 v133, v119, v129
    s_add_u32 m0, s87, 22528
    s_add_u32 s89, s97, 65536
    buffer_load_dwordx4 v2, s[28:31], s89 offen  lds
    v_fmac_f32 v134, v120, v129
    v_fmac_f32 v131, v118, v128
    v_fmac_f32 v132, v119, v128
    v_fmac_f32 v133, v120, v128
    v_fmac_f32 v134, v121, v128
    s_add_u32 m0, s16, 32768
    s_add_u32 s89, s99, 2048
    buffer_load_dwordx4 v4, s[32:35], s89 offen  lds
    v_fmac_f32 v131, v119, v127
    v_fmac_f32 v132, v120, v127
    v_fmac_f32 v133, v121, v127
    v_fmac_f32 v134, v122, v127
    v_mul_f32 v131, v131, v123
    v_mul_f32 v132, v132, v124
    s_add_u32 m0, s87, 26624
    s_add_u32 s89, s97, 131072
    buffer_load_dwordx4 v2, s[28:31], s89 offen  lds
    v_mul_f32 v133, v133, v125
    v_mul_f32 v134, v134, v126
    v_cvt_pk_bf16_f32 v104, v134, v133
    v_cvt_pk_bf16_f32 v105, v132, v131
    s_nop 0
    v_permlane32_swap_b32 v106, v104
    v_permlane32_swap_b32 v107, v105
    s_add_u32 m0, s16, 57344
    s_add_u32 s89, s99, 4096
    buffer_load_dwordx4 v4, s[32:35], s89 offen  lds
    s_mov_b32 s89, 16384
    buffer_store_dwordx4 v[104:107], v12, s[52:55], s89 offen sc1
    v_lshlrev_b32 v116, 16, v41
    v_lshlrev_b32 v117, 16, v45
    v_lshlrev_b32 v118, 16, v49
    v_lshlrev_b32 v119, 16, v53
    s_add_u32 m0, s87, 30720
    s_add_u32 s89, s97, 196608
    buffer_load_dwordx4 v2, s[28:31], s89 offen  lds
    v_lshlrev_b32 v120, 16, v57
    v_lshlrev_b32 v121, 16, v61
    v_lshlrev_b32 v122, 16, v65
    v_lshlrev_b32 v127, 16, v88
    v_and_b32 v128, 0xffff0000, v88
    v_lshlrev_b32 v129, 16, v89
    s_mov_b64 exec, 0xffffffff
    s_add_u32 m0, s88, 18432
    s_add_u32 s89, s97, 0
    buffer_load_dwordx4 v3, s[28:31], s89 offen  lds
    s_mov_b64 exec, -1
    v_and_b32 v130, 0xffff0000, v89
    v_lshlrev_b32 v123, 16, v69
    v_lshlrev_b32 v124, 16, v73
    v_lshlrev_b32 v125, 16, v77
    v_lshlrev_b32 v126, 16, v81
    v_mul_f32 v131, v116, v130
    s_add_u32 m0, s17, 8192
    s_add_u32 s89, s19, 196608
    buffer_load_dwordx4 v4, s[32:35], s89 offen  lds
    v_mul_f32 v132, v117, v130
    v_mul_f32 v133, v118, v130
    v_mul_f32 v134, v119, v130
    v_fmac_f32 v131, v117, v129
    v_fmac_f32 v132, v118, v129
    s_add_u32 m0, s17, 32768
    s_add_u32 s89, s19, 198656
    buffer_load_dwordx4 v4, s[32:35], s89 offen  lds
    v_fmac_f32 v133, v119, v129
    v_fmac_f32 v134, v120, v129
    v_fmac_f32 v131, v118, v128
    v_fmac_f32 v132, v119, v128
    v_fmac_f32 v133, v120, v128
    v_fmac_f32 v134, v121, v128
    s_add_u32 m0, s17, 57344
    s_add_u32 s89, s19, 200704
    buffer_load_dwordx4 v4, s[32:35], s89 offen  lds
    v_fmac_f32 v131, v119, v127
    v_fmac_f32 v132, v120, v127
    v_fmac_f32 v133, v121, v127
    v_fmac_f32 v134, v122, v127
    v_mul_f32 v131, v131, v123
    s_waitcnt vmcnt(12)
    s_barrier
    s_add_u32 s97, s98, s0
    s_lshr_b64 s[0:1], s[0:1], 4
    s_and_b32 s97, s97, 15
    s_lshr_b32 s99, s97, 3
    s_xor_b32 s97, s97, s99
    s_lshl_b32 s97, s97, 7
    s_add_u32 m0, s87, 36864
    s_add_u32 s89, s97, 0
    buffer_load_dwordx4 v2, s[28:31], s89 offen  lds
    v_mul_f32 v132, v132, v124
    v_mul_f32 v133, v133, v125
    v_mul_f32 v134, v134, v126
    v_cvt_pk_bf16_f32 v110, v134, v133
    v_cvt_pk_bf16_f32 v111, v132, v131
    v_lshlrev_b32 v116, 16, v43
    s_mul_i32 s99, s97, 3072
    s_sub_u32 s19, s99, s18
    s_add_u32 s99, s99, s18
    s_add_u32 m0, s16, 16384
    s_add_u32 s89, s99, 0
    buffer_load_dwordx4 v4, s[32:35], s89 offen  lds
    v_lshlrev_b32 v117, 16, v47
    v_lshlrev_b32 v118, 16, v51
    v_lshlrev_b32 v119, 16, v55
    v_lshlrev_b32 v120, 16, v59
    v_lshlrev_b32 v121, 16, v63
    v_lshlrev_b32 v122, 16, v67
    s_add_u32 m0, s87, 40960
    s_add_u32 s89, s97, 65536
    buffer_load_dwordx4 v2, s[28:31], s89 offen  lds
    v_lshlrev_b32 v127, 16, v96
    v_and_b32 v128, 0xffff0000, v96
    v_lshlrev_b32 v129, 16, v97
    v_and_b32 v130, 0xffff0000, v97
    v_lshlrev_b32 v123, 16, v71
    s_add_u32 m0, s16, 40960
    s_add_u32 s89, s99, 2048
    buffer_load_dwordx4 v4, s[32:35], s89 offen  lds
    v_lshlrev_b32 v124, 16, v75
    v_lshlrev_b32 v125, 16, v79
    v_lshlrev_b32 v126, 16, v83
    v_mul_f32 v131, v116, v130
    v_mul_f32 v132, v117, v130
    v_mul_f32 v133, v118, v130
    s_add_u32 m0, s87, 45056
    s_add_u32 s89, s97, 131072
    buffer_load_dwordx4 v2, s[28:31], s89 offen  lds
    v_mul_f32 v134, v119, v130
    v_fmac_f32 v131, v117, v129
    v_fmac_f32 v132, v118, v129
    v_fmac_f32 v133, v119, v129
    v_fmac_f32 v134, v120, v129
    v_fmac_f32 v131, v118, v128
    s_add_u32 m0, s16, 65536
    s_add_u32 s89, s99, 4096
    buffer_load_dwordx4 v4, s[32:35], s89 offen  lds
    v_fmac_f32 v132, v119, v128
    v_fmac_f32 v133, v120, v128
    v_fmac_f32 v134, v121, v128
    v_fmac_f32 v131, v119, v127
    v_fmac_f32 v132, v120, v127
    s_add_u32 m0, s87, 49152
    s_add_u32 s89, s97, 196608
    buffer_load_dwordx4 v2, s[28:31], s89 offen  lds
    v_fmac_f32 v133, v121, v127
    v_fmac_f32 v134, v122, v127
    v_mul_f32 v131, v131, v123
    v_mul_f32 v132, v132, v124
    v_mul_f32 v133, v133, v125
    v_mul_f32 v134, v134, v126
    s_mov_b64 exec, 0xffffffff
    s_add_u32 m0, s88, 36864
    s_add_u32 s89, s97, 0
    buffer_load_dwordx4 v3, s[28:31], s89 offen  lds
    s_mov_b64 exec, -1
    v_cvt_pk_bf16_f32 v108, v134, v133
    v_cvt_pk_bf16_f32 v109, v132, v131
    s_nop 0
    v_permlane32_swap_b32 v110, v108
    v_permlane32_swap_b32 v111, v109
    s_mov_b32 s89, 32768
    buffer_store_dwordx4 v[108:111], v12, s[52:55], s89 offen sc1
    v_and_b32 v116, 0xffff0000, v41
    s_add_u32 m0, s17, 16384
    s_add_u32 s89, s19, 196608
    buffer_load_dwordx4 v4, s[32:35], s89 offen  lds
    v_and_b32 v117, 0xffff0000, v45
    v_and_b32 v118, 0xffff0000, v49
    v_and_b32 v119, 0xffff0000, v53
    v_and_b32 v120, 0xffff0000, v57
    v_and_b32 v121, 0xffff0000, v61
    s_add_u32 m0, s17, 40960
    s_add_u32 s89, s19, 198656
    buffer_load_dwordx4 v4, s[32:35], s89 offen  lds
    v_and_b32 v122, 0xffff0000, v65
    v_lshlrev_b32 v127, 16, v90
    v_and_b32 v128, 0xffff0000, v90
    v_lshlrev_b32 v129, 16, v91
    v_and_b32 v130, 0xffff0000, v91
    v_and_b32 v123, 0xffff0000, v69
    s_add_u32 m0, s17, 65536
    s_add_u32 s89, s19, 200704
    buffer_load_dwordx4 v4, s[32:35], s89 offen  lds
    v_and_b32 v124, 0xffff0000, v73
    v_and_b32 v125, 0xffff0000, v77
    v_and_b32 v126, 0xffff0000, v81
    v_mul_f32 v131, v116, v130
    v_mul_f32 v132, v117, v130
    s_waitcnt vmcnt(12)
    s_barrier
    s_add_u32 m0, s94, 32
    s_lshl_b32 s89, s90, 12
    buffer_load_dwordx4 v15, s[48:51], s89 offen offset:0 nt lds
    v_mul_f32 v133, v118, v130
    v_mul_f32 v134, v119, v130
    v_fmac_f32 v131, v117, v129
    v_fmac_f32 v132, v118, v129
    s_add_u32 m0, s94, 32
    s_lshl_b32 s89, s90, 12
    buffer_load_dwordx4 v15, s[48:51], s89 offen offset:1024 nt lds
    v_fmac_f32 v133, v119, v129
    v_fmac_f32 v134, v120, v129
    v_fmac_f32 v131, v118, v128
    v_fmac_f32 v132, v119, v128
    s_add_u32 m0, s94, 32
    s_lshl_b32 s89, s90, 12
    buffer_load_dwordx4 v15, s[48:51], s89 offen offset:2048 nt lds
    v_fmac_f32 v133, v120, v128
    v_fmac_f32 v134, v121, v128
    v_fmac_f32 v131, v119, v127
    v_fmac_f32 v132, v120, v127
    s_add_u32 m0, s94, 32
    s_lshl_b32 s89, s90, 12
    buffer_load_dwordx4 v15, s[48:51], s89 offen offset:3072 nt lds
    v_fmac_f32 v133, v121, v127
    v_fmac_f32 v134, v122, v127
    v_mul_f32 v131, v131, v123
    buffer_load_dwordx4 v[212:215], v9, s[56:59], 0 offen offset:0 nt
    v_mul_f32 v132, v132, v124
    v_mul_f32 v133, v133, v125
    v_mul_f32 v134, v134, v126
    v_cvt_pk_bf16_f32 v114, v134, v133
    buffer_load_dwordx4 v[216:219], v9, s[56:59], 0 offen offset:2048 nt
    v_cvt_pk_bf16_f32 v115, v132, v131
    v_and_b32 v116, 0xffff0000, v43
    v_and_b32 v117, 0xffff0000, v47
    v_and_b32 v118, 0xffff0000, v51
    buffer_load_dwordx4 v[220:223], v9, s[56:59], s96 offen offset:0 nt
    v_and_b32 v119, 0xffff0000, v55
    v_and_b32 v120, 0xffff0000, v59
    v_and_b32 v121, 0xffff0000, v63
    v_and_b32 v122, 0xffff0000, v67
    buffer_load_dwordx4 v[224:227], v9, s[56:59], s96 offen offset:2048 nt
    v_lshlrev_b32 v127, 16, v98
    v_and_b32 v128, 0xffff0000, v98
    v_lshlrev_b32 v129, 16, v99
    s_add_u32 s97, s98, s0
    s_lshr_b64 s[0:1], s[0:1], 4
    s_and_b32 s97, s97, 15
    s_lshr_b32 s99, s97, 3
    s_xor_b32 s97, s97, s99
    s_lshl_b32 s97, s97, 7
    s_add_u32 m0, s87, 0
    s_add_u32 s89, s97, 0
    buffer_load_dwordx4 v2, s[28:31], s89 offen  lds
    v_and_b32 v130, 0xffff0000, v99
    v_and_b32 v123, 0xffff0000, v71
    v_and_b32 v124, 0xffff0000, v75
    v_and_b32 v125, 0xffff0000, v79
    s_mul_i32 s99, s97, 3072
    s_sub_u32 s19, s99, s18
    s_add_u32 s99, s99, s18
    s_add_u32 m0, s16, 0
    s_add_u32 s89, s99, 0
    buffer_load_dwordx4 v4, s[32:35], s89 offen  lds
    v_and_b32 v126, 0xffff0000, v83
    v_mul_f32 v131, v116, v130
    v_mul_f32 v132, v117, v130
    v_mul_f32 v133, v118, v130
    s_add_u32 m0, s87, 4096
    s_add_u32 s89, s97, 65536
    buffer_load_dwordx4 v2, s[28:31], s89 offen  lds
    v_mul_f32 v134, v119, v130
    v_fmac_f32 v131, v117, v129
    v_fmac_f32 v132, v118, v129
    v_fmac_f32 v133, v119, v129
    s_add_u32 m0, s16, 24576
    s_add_u32 s89, s99, 2048
    buffer_load_dwordx4 v4, s[32:35], s89 offen  lds
    v_fmac_f32 v134, v120, v129
    v_fmac_f32 v131, v118, v128
    v_fmac_f32 v132, v119, v128
    s_add_u32 m0, s87, 8192
    s_add_u32 s89, s97, 131072
    buffer_load_dwordx4 v2, s[28:31], s89 offen  lds
    v_fmac_f32 v133, v120, v128
    v_fmac_f32 v134, v121, v128
    v_fmac_f32 v131, v119, v127
    v_fmac_f32 v132, v120, v127
    s_add_u32 m0, s16, 49152
    s_add_u32 s89, s99, 4096
    buffer_load_dwordx4 v4, s[32:35], s89 offen  lds
    v_fmac_f32 v133, v121, v127
    v_fmac_f32 v134, v122, v127
    v_mul_f32 v131, v131, v123
    v_mul_f32 v132, v132, v124
    s_add_u32 m0, s87, 12288
    s_add_u32 s89, s97, 196608
    buffer_load_dwordx4 v2, s[28:31], s89 offen  lds
    v_mul_f32 v133, v133, v125
    v_mul_f32 v134, v134, v126
    v_cvt_pk_bf16_f32 v112, v134, v133
    v_cvt_pk_bf16_f32 v113, v132, v131
    s_mov_b64 exec, 0xffffffff
    s_add_u32 m0, s88, 0
    s_add_u32 s89, s97, 0
    buffer_load_dwordx4 v3, s[28:31], s89 offen  lds
    s_mov_b64 exec, -1
    v_permlane32_swap_b32 v114, v112
    v_permlane32_swap_b32 v115, v113
    s_mov_b32 s89, 49152
    buffer_store_dwordx4 v[112:115], v12, s[52:55], s89 offen sc1
    s_waitcnt vmcnt(17)
    s_barrier
    s_add_u32 m0, s17, 0
    s_add_u32 s89, s19, 196608
    buffer_load_dwordx4 v4, s[32:35], s89 offen  lds
    s_add_u32 m0, s17, 24576
    s_add_u32 s89, s19, 198656
    buffer_load_dwordx4 v4, s[32:35], s89 offen  lds
    s_add_u32 m0, s17, 49152
    s_add_u32 s89, s19, 200704
    buffer_load_dwordx4 v4, s[32:35], s89 offen  lds
    s_add_u32 s97, s98, s0
    s_lshr_b64 s[0:1], s[0:1], 4
    s_and_b32 s97, s97, 15
    s_lshr_b32 s99, s97, 3
    s_xor_b32 s97, s97, s99
    s_lshl_b32 s97, s97, 7
    s_add_u32 m0, s87, 18432
    s_add_u32 s89, s97, 0
    buffer_load_dwordx4 v2, s[28:31], s89 offen  lds
    s_mul_i32 s99, s97, 3072
    s_sub_u32 s19, s99, s18
    s_add_u32 s99, s99, s18
    s_add_u32 m0, s16, 8192
    s_add_u32 s89, s99, 0
    buffer_load_dwordx4 v4, s[32:35], s89 offen  lds
    s_add_u32 m0, s87, 22528
    s_add_u32 s89, s97, 65536
    buffer_load_dwordx4 v2, s[28:31], s89 offen  lds
    s_add_u32 m0, s16, 32768
    s_add_u32 s89, s99, 2048
    buffer_load_dwordx4 v4, s[32:35], s89 offen  lds
    s_add_u32 m0, s87, 26624
    s_add_u32 s89, s97, 131072
    buffer_load_dwordx4 v2, s[28:31], s89 offen  lds
    s_add_u32 m0, s16, 57344
    s_add_u32 s89, s99, 4096
    buffer_load_dwordx4 v4, s[32:35], s89 offen  lds
    s_add_u32 m0, s87, 30720
    s_add_u32 s89, s97, 196608
    buffer_load_dwordx4 v2, s[28:31], s89 offen  lds
    s_mov_b64 exec, 0xffffffff
    s_add_u32 m0, s88, 18432
    s_add_u32 s89, s97, 0
    buffer_load_dwordx4 v3, s[28:31], s89 offen  lds
    s_mov_b64 exec, -1
    s_add_u32 m0, s17, 8192
    s_add_u32 s89, s19, 196608
    buffer_load_dwordx4 v4, s[32:35], s89 offen  lds
    s_add_u32 m0, s17, 32768
    s_add_u32 s89, s19, 198656
    buffer_load_dwordx4 v4, s[32:35], s89 offen  lds
    s_add_u32 m0, s17, 57344
    s_add_u32 s89, s19, 200704
    buffer_load_dwordx4 v4, s[32:35], s89 offen  lds
    s_waitcnt vmcnt(11)
    s_barrier
    s_add_u32 s97, s98, s0
    s_lshr_b64 s[0:1], s[0:1], 4
    s_and_b32 s97, s97, 15
    s_lshr_b32 s99, s97, 3
    s_xor_b32 s97, s97, s99
    s_lshl_b32 s97, s97, 7
    s_add_u32 m0, s87, 36864
    s_add_u32 s89, s97, 0
    buffer_load_dwordx4 v2, s[28:31], s89 offen  lds
    v_add_u32 v5, s94, v15
    ds_read_b128 v[140:143], v5 offset:32
    s_mul_i32 s99, s97, 3072
    s_sub_u32 s19, s99, s18
    s_add_u32 s99, s99, s18
    s_add_u32 m0, s16, 16384
    s_add_u32 s89, s99, 0
    buffer_load_dwordx4 v4, s[32:35], s89 offen  lds
    ds_read_b32 v156, v5 offset:48
    s_add_u32 m0, s87, 40960
    s_add_u32 s89, s97, 65536
    buffer_load_dwordx4 v2, s[28:31], s89 offen  lds
    ds_read_b128 v[144:147], v5 offset:1056
    ds_read_b32 v157, v5 offset:1072
    s_add_u32 m0, s16, 40960
    s_add_u32 s89, s99, 2048
    buffer_load_dwordx4 v4, s[32:35], s89 offen  lds
    ds_read_b128 v[148:151], v5 offset:2080
    s_add_u32 m0, s87, 45056
    s_add_u32 s89, s97, 131072
    buffer_load_dwordx4 v2, s[28:31], s89 offen  lds
    ds_read_b32 v158, v5 offset:2096
    s_add_u32 m0, s16, 65536
    s_add_u32 s89, s99, 4096
    buffer_load_dwordx4 v4, s[32:35], s89 offen  lds
    ds_read_b128 v[152:155], v5 offset:3104
    ds_read_b32 v159, v5 offset:3120
    s_add_u32 m0, s87, 49152
    s_add_u32 s89, s97, 196608
    buffer_load_dwordx4 v2, s[28:31], s89 offen  lds
    v_lshrrev_b32 v6, 3, v0
    s_mov_b64 exec, 0xffffffff
    s_add_u32 m0, s88, 36864
    s_add_u32 s89, s97, 0
    buffer_load_dwordx4 v3, s[28:31], s89 offen  lds
    s_mov_b64 exec, -1
    v_mul_u32_u24 v6, 4160, v6
    s_add_u32 m0, s17, 16384
    s_add_u32 s89, s19, 196608
    buffer_load_dwordx4 v4, s[32:35], s89 offen  lds
    v_and_b32 v7, 7, v0
    v_lshl_add_u32 v6, v7, 2, v6
    s_add_u32 m0, s17, 40960
    s_add_u32 s89, s19, 198656
    buffer_load_dwordx4 v4, s[32:35], s89 offen  lds
    v_add_u32 v6, s94, v6
    s_add_u32 m0, s17, 65536
    s_add_u32 s89, s19, 200704
    buffer_load_dwordx4 v4, s[32:35], s89 offen  lds
    v_mov_b32 v7, 0
    s_waitcnt vmcnt(11)
    s_barrier
    s_add_u32 s97, s98, s0
    s_lshr_b64 s[0:1], s[0:1], 4
    s_and_b32 s97, s97, 15
    s_lshr_b32 s99, s97, 3
    s_xor_b32 s97, s97, s99
    s_lshl_b32 s97, s97, 7
    s_add_u32 m0, s87, 0
    s_add_u32 s89, s97, 0
    buffer_load_dwordx4 v2, s[28:31], s89 offen  lds
    s_waitcnt lgkmcnt(0)
    v_readfirstlane_b32 s93, v140
    s_nop 0
    s_lshl_b32 s93, s93, 16
    s_mul_i32 s99, s97, 3072
    s_sub_u32 s19, s99, s18
    s_add_u32 s99, s99, s18
    s_add_u32 m0, s16, 0
    s_add_u32 s89, s99, 0
    buffer_load_dwordx4 v4, s[32:35], s89 offen  lds
    v_writelane_b32 v7, s93, 15
    v_alignbit_b32 v140, v141, v140, 16
    s_add_u32 m0, s87, 4096
    s_add_u32 s89, s97, 65536
    buffer_load_dwordx4 v2, s[28:31], s89 offen  lds
    v_alignbit_b32 v141, v142, v141, 16
    v_alignbit_b32 v142, v143, v142, 16
    s_add_u32 m0, s16, 24576
    s_add_u32 s89, s99, 2048
    buffer_load_dwordx4 v4, s[32:35], s89 offen  lds
    v_alignbit_b32 v143, v156, v143, 16
    v_alignbit_b32 v144, v145, v144, 16
    s_add_u32 m0, s87, 8192
    s_add_u32 s89, s97, 131072
    buffer_load_dwordx4 v2, s[28:31], s89 offen  lds
    v_alignbit_b32 v145, v146, v145, 16
    v_alignbit_b32 v146, v147, v146, 16
    s_add_u32 m0, s16, 49152
    s_add_u32 s89, s99, 4096
    buffer_load_dwordx4 v4, s[32:35], s89 offen  lds
    v_alignbit_b32 v147, v157, v147, 16
    v_alignbit_b32 v148, v149, v148, 16
    s_add_u32 m0, s87, 12288
    s_add_u32 s89, s97, 196608
    buffer_load_dwordx4 v2, s[28:31], s89 offen  lds
    v_alignbit_b32 v149, v150, v149, 16
    v_alignbit_b32 v150, v151, v150, 16
    s_mov_b64 exec, 0xffffffff
    s_add_u32 m0, s88, 0
    s_add_u32 s89, s97, 0
    buffer_load_dwordx4 v3, s[28:31], s89 offen  lds
    s_mov_b64 exec, -1
    v_alignbit_b32 v151, v158, v151, 16
    v_alignbit_b32 v152, v153, v152, 16
    s_add_u32 m0, s17, 0
    s_add_u32 s89, s19, 196608
    buffer_load_dwordx4 v4, s[32:35], s89 offen  lds
    v_alignbit_b32 v153, v154, v153, 16
    v_alignbit_b32 v154, v155, v154, 16
    s_add_u32 m0, s17, 24576
    s_add_u32 s89, s19, 198656
    buffer_load_dwordx4 v4, s[32:35], s89 offen  lds
    v_alignbit_b32 v155, v159, v155, 16
    v_lshlrev_b32 v8, 3, v0
    s_add_u32 m0, s17, 49152
    s_add_u32 s89, s19, 200704
    buffer_load_dwordx4 v4, s[32:35], s89 offen  lds
    s_add_u32 s78, s88, 18432
    v_add_u32 v8, s78, v8
    s_mov_b64 exec, 0xff
    buffer_load_dword v136, v33, s[68:71], 0 offen sc1
    buffer_load_dword v137, v34, s[52:55], 0 offen sc1
    s_mov_b64 exec, -1
    v_mov_b32 v156, 0
    v_mov_b32 v157, 0
    s_waitcnt vmcnt(13)
    s_barrier
    s_waitcnt vmcnt(0)
LA_j:
    s_mov_b64 exec, 0xff
    v_cmp_ne_u32 vcc, v136, v137
    v_cmp_gt_u32 s[80:81], s96, v136
    s_nop 0
    s_or_b64 vcc, vcc, s[80:81]
    s_mov_b64 exec, -1
    s_mov_b64 s[82:83], vcc
    s_cbranch_vccnz LA_nox
    s_add_u32 m0, s86, 94208
    s_add_u32 s89, s91, 0
    buffer_load_dwordx4 v14, s[52:55], s89 offen sc1 lds
    s_add_u32 m0, s86, 98304
    s_add_u32 s89, s91, 4096
    buffer_load_dwordx4 v14, s[52:55], s89 offen sc1 lds
    s_add_u32 m0, s86, 102400
    s_add_u32 s89, s91, 8192
    buffer_load_dwordx4 v14, s[52:55], s89 offen sc1 lds
    s_add_u32 m0, s86, 106496
    s_add_u32 s89, s91, 12288
    buffer_load_dwordx4 v14, s[52:55], s89 offen sc1 lds
    buffer_load_dword v230, v229, s[64:67], 0 offen
LA_nox:
    s_mov_b64 exec, 0xffff
    ds_write_b32 v6, v7
    s_mov_b64 exec, -1
    ds_write_b128 v5, v[140:143] offset:4192
    ds_write_b128 v5, v[144:147] offset:5216
    ds_write_b128 v5, v[148:151] offset:6240
    ds_write_b128 v5, v[152:155] offset:7264
    ds_write_b64 v8, v[156:157]
    s_barrier
    s_cmp_lg_u64 s[82:83], 0
    s_cbranch_scc1 LA_slow
LA_back:
    s_add_u32 s89, s100, 0
    s_add_u32 m0, s86, 8192
    s_and_b32 s89, s89, 0x1f0000
    buffer_load_dwordx4 v228, s[64:67], s89 offen  lds
    s_add_u32 s89, s100, 65536
    s_add_u32 m0, s86, 12288
    s_and_b32 s89, s89, 0x1f0000
    buffer_load_dwordx4 v228, s[64:67], s89 offen  lds
    s_waitcnt vmcnt(3)
    s_mov_b64 exec, 1
    ds_add_u32 v18, v19 offset:20
    s_mov_b64 exec, -1
    s_add_u32 s89, s100, 131072
    s_add_u32 m0, s86, 32768
    s_and_b32 s89, s89, 0x1f0000
    buffer_load_dwordx4 v228, s[64:67], s89 offen  lds
    ds_read2_b32 v[68:69], v21 offset0:0 offset1:1
    ds_read2_b32 v[70:71], v21 offset0:2 offset1:3
    ds_read2_b32 v[72:73], v21 offset0:128 offset1:129
    ds_read2_b32 v[74:75], v21 offset0:130 offset1:131
    s_add_u32 s89, s100, 196608
    s_add_u32 m0, s86, 36864
    s_and_b32 s89, s89, 0x1f0000
    buffer_load_dwordx4 v228, s[64:67], s89 offen  lds
    ds_read2_b32 v[76:77], v22 offset0:0 offset1:1
    ds_read2_b32 v[78:79], v22 offset0:2 offset1:3
    ds_read2_b32 v[80:81], v22 offset0:128 offset1:129
    ds_read2_b32 v[82:83], v22 offset0:130 offset1:131
    s_add_u32 s89, s100, 262144
    s_add_u32 m0, s86, 57344
    s_and_b32 s89, s89, 0x1f0000
    buffer_load_dwordx4 v228, s[64:67], s89 offen  lds
    ds_read2_b32 v[84:85], v23 offset0:0 offset1:1
    ds_read2_b32 v[86:87], v23 offset0:2 offset1:3
    ds_read2_b32 v[88:89], v23 offset0:128 offset1:129
    ds_read2_b32 v[90:91], v23 offset0:130 offset1:131
    s_add_u32 s89, s100, 327680
    s_add_u32 m0, s86, 61440
    s_and_b32 s89, s89, 0x1f0000
    buffer_load_dwordx4 v228, s[64:67], s89 offen  lds
    ds_read2_b32 v[92:93], v24 offset0:0 offset1:1
    ds_read2_b32 v[94:95], v24 offset0:2 offset1:3
    ds_read2_b32 v[96:97], v24 offset0:128 offset1:129
    ds_read2_b32 v[98:99], v24 offset0:130 offset1:131
    s_branch LA_s5_in
LA_s5:
    s_sleep 1
LA_s5_in:
    ds_read_b32 v6, v18 offset:20
    s_waitcnt lgkmcnt(0)
    v_readfirstlane_b32 s78, v6
    s_nop 0
    s_cmp_ge_u32 s78, 4
    s_cbranch_scc0 LA_s5
    s_add_u32 s89, s100, 393216
    s_add_u32 m0, s86, 16384
    s_and_b32 s89, s89, 0x1f0000
    buffer_load_dwordx4 v228, s[64:67], s89 offen  lds
    ds_read_b128 v[100:103], v25 offset:0
    ds_read_b128 v[104:107], v25 offset:2048
    ds_read_b128 v[108:111], v25 offset:4096
    ds_read_b128 v[112:115], v25 offset:6144
    s_add_u32 s89, s100, 458752
    s_add_u32 m0, s86, 20480
    s_and_b32 s89, s89, 0x1f0000
    buffer_load_dwordx4 v228, s[64:67], s89 offen  lds
    ds_read_b128 v[116:119], v25 offset:8192
    ds_read_b128 v[120:123], v25 offset:10240
    ds_read_b128 v[124:127], v25 offset:12288
    ds_read_b128 v[128:131], v25 offset:14336
    s_setprio 2
    s_waitcnt lgkmcnt(7)
    v_mfma_f32_16x16x32_bf16 v[36:39], v[236:239], v[100:103], 0
    ds_read2_b32 v[132:133], v21 offset0:16 offset1:17
    s_waitcnt lgkmcnt(7)
    v_mfma_f32_16x16x32_bf16 v[40:43], v[236:239], v[104:107], 0
    ds_read2_b32 v[134:135], v21 offset0:18 offset1:19
    s_waitcnt lgkmcnt(7)
    v_mfma_f32_16x16x32_bf16 v[44:47], v[236:239], v[108:111], 0
    s_waitcnt lgkmcnt(6)
    v_mfma_f32_16x16x32_bf16 v[48:51], v[236:239], v[112:115], 0
    ds_read_b128 v[164:167], v26 offset:0
    s_waitcnt lgkmcnt(6)
    v_mfma_f32_16x16x32_bf16 v[52:55], v[236:239], v[116:119], 0
    s_waitcnt lgkmcnt(5)
    v_mfma_f32_16x16x32_bf16 v[56:59], v[236:239], v[120:123], 0
    ds_read_b128 v[168:171], v26 offset:2048
    s_waitcnt lgkmcnt(5)
    v_mfma_f32_16x16x32_bf16 v[60:63], v[236:239], v[124:127], 0
    ds_read_b128 v[172:175], v26 offset:4096
    s_waitcnt lgkmcnt(5)
    v_mfma_f32_16x16x32_bf16 v[64:67], v[236:239], v[128:131], 0
    v_mfma_f32_16x16x32_bf16 v[36:39], v[68:71], v[100:103], v[36:39]
    ds_read_b128 v[176:179], v26 offset:6144
    v_mfma_f32_16x16x32_bf16 v[40:43], v[68:71], v[104:107], v[40:43]
    v_mfma_f32_16x16x32_bf16 v[44:47], v[68:71], v[108:111], v[44:47]
    ds_read_b128 v[180:183], v26 offset:8192
    v_mfma_f32_16x16x32_bf16 v[48:51], v[68:71], v[112:115], v[48:51]
    ds_read_b128 v[184:187], v26 offset:10240
    v_mfma_f32_16x16x32_bf16 v[52:55], v[68:71], v[116:119], v[52:55]
    v_mfma_f32_16x16x32_bf16 v[56:59], v[68:71], v[120:123], v[56:59]
    ds_read_b128 v[188:191], v26 offset:12288
    v_mfma_f32_16x16x32_bf16 v[60:63], v[68:71], v[124:127], v[60:63]
    v_mfma_f32_16x16x32_bf16 v[64:67], v[68:71], v[128:131], v[64:67]
    ds_read_b128 v[192:195], v26 offset:14336
    v_mfma_f32_16x16x32_bf16 v[40:43], v[72:75], v[100:103], v[40:43]
    ds_read2_b32 v[136:137], v21 offset0:144 offset1:145
    v_mfma_f32_16x16x32_bf16 v[44:47], v[72:75], v[104:107], v[44:47]
    v_mfma_f32_16x16x32_bf16 v[48:51], v[72:75], v[108:111], v[48:51]
    ds_read2_b32 v[138:139], v21 offset0:146 offset1:147
    v_mfma_f32_16x16x32_bf16 v[52:55], v[72:75], v[112:115], v[52:55]
    v_mfma_f32_16x16x32_bf16 v[56:59], v[72:75], v[116:119], v[56:59]
    ds_read2_b32 v[140:141], v22 offset0:16 offset1:17
    v_mfma_f32_16x16x32_bf16 v[60:63], v[72:75], v[120:123], v[60:63]
    ds_read2_b32 v[142:143], v22 offset0:18 offset1:19
    v_mfma_f32_16x16x32_bf16 v[64:67], v[72:75], v[124:127], v[64:67]
    v_mfma_f32_16x16x32_bf16 v[44:47], v[76:79], v[100:103], v[44:47]
    ds_read2_b32 v[144:145], v22 offset0:144 offset1:145
    v_mfma_f32_16x16x32_bf16 v[48:51], v[76:79], v[104:107], v[48:51]
    v_mfma_f32_16x16x32_bf16 v[52:55], v[76:79], v[108:111], v[52:55]
    ds_read2_b32 v[146:147], v22 offset0:146 offset1:147
    v_mfma_f32_16x16x32_bf16 v[56:59], v[76:79], v[112:115], v[56:59]
    ds_read2_b32 v[148:149], v23 offset0:16 offset1:17
    v_mfma_f32_16x16x32_bf16 v[60:63], v[76:79], v[116:119], v[60:63]
    v_mfma_f32_16x16x32_bf16 v[64:67], v[76:79], v[120:123], v[64:67]
    ds_read2_b32 v[150:151], v23 offset0:18 offset1:19
    v_mfma_f32_16x16x32_bf16 v[48:51], v[80:83], v[100:103], v[48:51]
    v_mfma_f32_16x16x32_bf16 v[52:55], v[80:83], v[104:107], v[52:55]
    ds_read2_b32 v[152:153], v23 offset0:144 offset1:145
    v_mfma_f32_16x16x32_bf16 v[56:59], v[80:83], v[108:111], v[56:59]
    ds_read2_b32 v[154:155], v23 offset0:146 offset1:147
    v_mfma_f32_16x16x32_bf16 v[60:63], v[80:83], v[112:115], v[60:63]
    v_mfma_f32_16x16x32_bf16 v[64:67], v[80:83], v[116:119], v[64:67]
    ds_read2_b32 v[156:157], v24 offset0:16 offset1:17
    v_mfma_f32_16x16x32_bf16 v[52:55], v[84:87], v[100:103], v[52:55]
    v_mfma_f32_16x16x32_bf16 v[56:59], v[84:87], v[104:107], v[56:59]
    ds_read2_b32 v[158:159], v24 offset0:18 offset1:19
    v_mfma_f32_16x16x32_bf16 v[60:63], v[84:87], v[108:111], v[60:63]
    ds_read2_b32 v[160:161], v24 offset0:144 offset1:145
    v_mfma_f32_16x16x32_bf16 v[64:67], v[84:87], v[112:115], v[64:67]
    v_mfma_f32_16x16x32_bf16 v[56:59], v[88:91], v[100:103], v[56:59]
    ds_read2_b32 v[162:163], v24 offset0:146 offset1:147
    v_mfma_f32_16x16x32_bf16 v[60:63], v[88:91], v[104:107], v[60:63]
    v_mfma_f32_16x16x32_bf16 v[64:67], v[88:91], v[108:111], v[64:67]
    v_mfma_f32_16x16x32_bf16 v[60:63], v[92:95], v[100:103], v[60:63]
    v_mfma_f32_16x16x32_bf16 v[64:67], v[92:95], v[104:107], v[64:67]
    v_mfma_f32_16x16x32_bf16 v[64:67], v[96:99], v[100:103], v[64:67]
    s_waitcnt vmcnt(0)
    s_mov_b64 exec, 1
    ds_add_u32 v18, v19 offset:8
    s_mov_b64 exec, -1
    s_waitcnt lgkmcnt(14)
    v_mfma_f32_16x16x32_bf16 v[36:39], v[132:135], v[164:167], v[36:39]
    ds_read2_b32 v[68:69], v21 offset0:32 offset1:33
    v_mfma_f32_16x16x32_bf16 v[40:43], v[132:135], v[168:171], v[40:43]
    ds_read2_b32 v[70:71], v21 offset0:34 offset1:35
    v_mfma_f32_16x16x32_bf16 v[44:47], v[132:135], v[172:175], v[44:47]
    ds_read_b128 v[100:103], v27 offset:0
    v_mfma_f32_16x16x32_bf16 v[48:51], v[132:135], v[176:179], v[48:51]
    v_mfma_f32_16x16x32_bf16 v[52:55], v[132:135], v[180:183], v[52:55]
    ds_read_b128 v[104:107], v27 offset:2048
    v_mfma_f32_16x16x32_bf16 v[56:59], v[132:135], v[184:187], v[56:59]
    ds_read_b128 v[108:111], v27 offset:4096
    v_mfma_f32_16x16x32_bf16 v[60:63], v[132:135], v[188:191], v[60:63]
    ds_read_b128 v[112:115], v27 offset:6144
    v_mfma_f32_16x16x32_bf16 v[64:67], v[132:135], v[192:195], v[64:67]
    s_waitcnt lgkmcnt(14)
    v_mfma_f32_16x16x32_bf16 v[40:43], v[136:139], v[164:167], v[40:43]
    ds_read_b128 v[116:119], v27 offset:8192
    v_mfma_f32_16x16x32_bf16 v[44:47], v[136:139], v[168:171], v[44:47]
    ds_read_b128 v[120:123], v27 offset:10240
    v_mfma_f32_16x16x32_bf16 v[48:51], v[136:139], v[172:175], v[48:51]
    ds_read_b128 v[124:127], v27 offset:12288
    v_mfma_f32_16x16x32_bf16 v[52:55], v[136:139], v[176:179], v[52:55]
    v_mfma_f32_16x16x32_bf16 v[56:59], v[136:139], v[180:183], v[56:59]
    ds_read_b128 v[128:131], v27 offset:14336
    v_mfma_f32_16x16x32_bf16 v[60:63], v[136:139], v[184:187], v[60:63]
    ds_read2_b32 v[72:73], v21 offset0:160 offset1:161
    v_mfma_f32_16x16x32_bf16 v[64:67], v[136:139], v[188:191], v[64:67]
    ds_read2_b32 v[74:75], v21 offset0:162 offset1:163
    v_mfma_f32_16x16x32_bf16 v[44:47], v[140:143], v[164:167], v[44:47]
    v_mfma_f32_16x16x32_bf16 v[48:51], v[140:143], v[168:171], v[48:51]
    ds_read2_b32 v[76:77], v22 offset0:32 offset1:33
    v_mfma_f32_16x16x32_bf16 v[52:55], v[140:143], v[172:175], v[52:55]
    ds_read2_b32 v[78:79], v22 offset0:34 offset1:35
    v_mfma_f32_16x16x32_bf16 v[56:59], v[140:143], v[176:179], v[56:59]
    ds_read2_b32 v[80:81], v22 offset0:160 offset1:161
    v_mfma_f32_16x16x32_bf16 v[60:63], v[140:143], v[180:183], v[60:63]
    v_mfma_f32_16x16x32_bf16 v[64:67], v[140:143], v[184:187], v[64:67]
    ds_read2_b32 v[82:83], v22 offset0:162 offset1:163
    v_mfma_f32_16x16x32_bf16 v[48:51], v[144:147], v[164:167], v[48:51]
    ds_read2_b32 v[84:85], v23 offset0:32 offset1:33
    v_mfma_f32_16x16x32_bf16 v[52:55], v[144:147], v[168:171], v[52:55]
    ds_read2_b32 v[86:87], v23 offset0:34 offset1:35
    v_mfma_f32_16x16x32_bf16 v[56:59], v[144:147], v[172:175], v[56:59]
    v_mfma_f32_16x16x32_bf16 v[60:63], v[144:147], v[176:179], v[60:63]
    ds_read2_b32 v[88:89], v23 offset0:160 offset1:161
    v_mfma_f32_16x16x32_bf16 v[64:67], v[144:147], v[180:183], v[64:67]
    ds_read2_b32 v[90:91], v23 offset0:162 offset1:163
    s_waitcnt lgkmcnt(14)
    v_mfma_f32_16x16x32_bf16 v[52:55], v[148:151], v[164:167], v[52:55]
    ds_read2_b32 v[92:93], v24 offset0:32 offset1:33
    v_mfma_f32_16x16x32_bf16 v[56:59], v[148:151], v[168:171], v[56:59]
    v_mfma_f32_16x16x32_bf16 v[60:63], v[148:151], v[172:175], v[60:63]
    ds_read2_b32 v[94:95], v24 offset0:34 offset1:35
    v_mfma_f32_16x16x32_bf16 v[64:67], v[148:151], v[176:179], v[64:67]
    ds_read2_b32 v[96:97], v24 offset0:160 offset1:161
    v_mfma_f32_16x16x32_bf16 v[56:59], v[152:155], v[164:167], v[56:59]
    ds_read2_b32 v[98:99], v24 offset0:162 offset1:163
    v_mfma_f32_16x16x32_bf16 v[60:63], v[152:155], v[168:171], v[60:63]
    v_mfma_f32_16x16x32_bf16 v[64:67], v[152:155], v[172:175], v[64:67]
    v_mfma_f32_16x16x32_bf16 v[60:63], v[156:159], v[164:167], v[60:63]
    v_mfma_f32_16x16x32_bf16 v[64:67], v[156:159], v[168:171], v[64:67]
    v_mfma_f32_16x16x32_bf16 v[64:67], v[160:163], v[164:167], v[64:67]
    v_mfma_f32_16x16x32_bf16 v[36:39], v[68:71], v[100:103], v[36:39]
    ds_read2_b32 v[132:133], v21 offset0:48 offset1:49
    v_mfma_f32_16x16x32_bf16 v[40:43], v[68:71], v[104:107], v[40:43]
    ds_read2_b32 v[134:135], v21 offset0:50 offset1:51
    v_mfma_f32_16x16x32_bf16 v[44:47], v[68:71], v[108:111], v[44:47]
    ds_read_b128 v[164:167], v28 offset:0
    v_mfma_f32_16x16x32_bf16 v[48:51], v[68:71], v[112:115], v[48:51]
    s_waitcnt lgkmcnt(14)
    v_mfma_f32_16x16x32_bf16 v[52:55], v[68:71], v[116:119], v[52:55]
    ds_read_b128 v[168:171], v28 offset:2048
    v_mfma_f32_16x16x32_bf16 v[56:59], v[68:71], v[120:123], v[56:59]
    ds_read_b128 v[172:175], v28 offset:4096
    v_mfma_f32_16x16x32_bf16 v[60:63], v[68:71], v[124:127], v[60:63]
    ds_read_b128 v[176:179], v28 offset:6144
    v_mfma_f32_16x16x32_bf16 v[64:67], v[68:71], v[128:131], v[64:67]
    v_mfma_f32_16x16x32_bf16 v[40:43], v[72:75], v[100:103], v[40:43]
    ds_read_b128 v[180:183], v28 offset:8192
    v_mfma_f32_16x16x32_bf16 v[44:47], v[72:75], v[104:107], v[44:47]
    ds_read_b128 v[184:187], v28 offset:10240
    v_mfma_f32_16x16x32_bf16 v[48:51], v[72:75], v[108:111], v[48:51]
    ds_read_b128 v[188:191], v28 offset:12288
    v_mfma_f32_16x16x32_bf16 v[52:55], v[72:75], v[112:115], v[52:55]
    v_mfma_f32_16x16x32_bf16 v[56:59], v[72:75], v[116:119], v[56:59]
    ds_read_b128 v[192:195], v28 offset:14336
    v_mfma_f32_16x16x32_bf16 v[60:63], v[72:75], v[120:123], v[60:63]
    ds_read2_b32 v[136:137], v21 offset0:176 offset1:177
    v_mfma_f32_16x16x32_bf16 v[64:67], v[72:75], v[124:127], v[64:67]
    ds_read2_b32 v[138:139], v21 offset0:178 offset1:179
    s_waitcnt lgkmcnt(14)
    v_mfma_f32_16x16x32_bf16 v[44:47], v[76:79], v[100:103], v[44:47]
    v_mfma_f32_16x16x32_bf16 v[48:51], v[76:79], v[104:107], v[48:51]
    ds_read2_b32 v[140:141], v22 offset0:48 offset1:49
    v_mfma_f32_16x16x32_bf16 v[52:55], v[76:79], v[108:111], v[52:55]
    ds_read2_b32 v[142:143], v22 offset0:50 offset1:51
    v_mfma_f32_16x16x32_bf16 v[56:59], v[76:79], v[112:115], v[56:59]
    ds_read2_b32 v[144:145], v22 offset0:176 offset1:177
    v_mfma_f32_16x16x32_bf16 v[60:63], v[76:79], v[116:119], v[60:63]
    v_mfma_f32_16x16x32_bf16 v[64:67], v[76:79], v[120:123], v[64:67]
    ds_read2_b32 v[146:147], v22 offset0:178 offset1:179
    v_mfma_f32_16x16x32_bf16 v[48:51], v[80:83], v[100:103], v[48:51]
    ds_read2_b32 v[148:149], v23 offset0:48 offset1:49
    v_mfma_f32_16x16x32_bf16 v[52:55], v[80:83], v[104:107], v[52:55]
    ds_read2_b32 v[150:151], v23 offset0:50 offset1:51
    v_mfma_f32_16x16x32_bf16 v[56:59], v[80:83], v[108:111], v[56:59]
    v_mfma_f32_16x16x32_bf16 v[60:63], v[80:83], v[112:115], v[60:63]
    ds_read2_b32 v[152:153], v23 offset0:176 offset1:177
    v_mfma_f32_16x16x32_bf16 v[64:67], v[80:83], v[116:119], v[64:67]
    ds_read2_b32 v[154:155], v23 offset0:178 offset1:179
    v_mfma_f32_16x16x32_bf16 v[52:55], v[84:87], v[100:103], v[52:55]
    ds_read2_b32 v[156:157], v24 offset0:48 offset1:49
    v_mfma_f32_16x16x32_bf16 v[56:59], v[84:87], v[104:107], v[56:59]
    v_mfma_f32_16x16x32_bf16 v[60:63], v[84:87], v[108:111], v[60:63]
    ds_read2_b32 v[158:159], v24 offset0:50 offset1:51
    v_mfma_f32_16x16x32_bf16 v[64:67], v[84:87], v[112:115], v[64:67]
    ds_read2_b32 v[160:161], v24 offset0:176 offset1:177
    v_mfma_f32_16x16x32_bf16 v[56:59], v[88:91], v[100:103], v[56:59]
    ds_read2_b32 v[162:163], v24 offset0:178 offset1:179
    v_mfma_f32_16x16x32_bf16 v[60:63], v[88:91], v[104:107], v[60:63]
    v_mfma_f32_16x16x32_bf16 v[64:67], v[88:91], v[108:111], v[64:67]
    v_mfma_f32_16x16x32_bf16 v[60:63], v[92:95], v[100:103], v[60:63]
    v_mfma_f32_16x16x32_bf16 v[64:67], v[92:95], v[104:107], v[64:67]
    s_waitcnt lgkmcnt(14)
    v_mfma_f32_16x16x32_bf16 v[64:67], v[96:99], v[100:103], v[64:67]
    v_mfma_f32_16x16x32_bf16 v[36:39], v[132:135], v[164:167], v[36:39]
    ds_read2_b32 v[68:69], v21 offset0:64 offset1:65
    v_lshlrev_b32 v196, 16, v212
    v_mfma_f32_16x16x32_bf16 v[40:43], v[132:135], v[168:171], v[40:43]
    ds_read2_b32 v[70:71], v21 offset0:66 offset1:67
    v_mfma_f32_16x16x32_bf16 v[44:47], v[132:135], v[172:175], v[44:47]
    ds_read_b128 v[100:103], v29 offset:0
    v_and_b32 v197, 0xffff0000, v212
    v_mfma_f32_16x16x32_bf16 v[48:51], v[132:135], v[176:179], v[48:51]
    v_mfma_f32_16x16x32_bf16 v[52:55], v[132:135], v[180:183], v[52:55]
    ds_read_b128 v[104:107], v29 offset:2048
    v_lshlrev_b32 v198, 16, v213
    v_mfma_f32_16x16x32_bf16 v[56:59], v[132:135], v[184:187], v[56:59]
    ds_read_b128 v[108:111], v29 offset:4096
    v_mfma_f32_16x16x32_bf16 v[60:63], v[132:135], v[188:191], v[60:63]
    ds_read_b128 v[112:115], v29 offset:6144
    v_and_b32 v199, 0xffff0000, v213
    v_mfma_f32_16x16x32_bf16 v[64:67], v[132:135], v[192:195], v[64:67]
    s_waitcnt lgkmcnt(14)
    v_mfma_f32_16x16x32_bf16 v[40:43], v[136:139], v[164:167], v[40:43]
    ds_read_b128 v[116:119], v29 offset:8192
    v_mfma_f32_16x16x32_bf16 v[44:47], v[136:139], v[168:171], v[44:47]
    ds_read_b128 v[120:123], v29 offset:10240
    v_lshlrev_b32 v200, 16, v214
    v_mfma_f32_16x16x32_bf16 v[48:51], v[136:139], v[172:175], v[48:51]
    ds_read_b128 v[124:127], v29 offset:12288
    v_mfma_f32_16x16x32_bf16 v[52:55], v[136:139], v[176:179], v[52:55]
    v_and_b32 v201, 0xffff0000, v214
    v_mfma_f32_16x16x32_bf16 v[56:59], v[136:139], v[180:183], v[56:59]
    ds_read_b128 v[128:131], v29 offset:14336
    v_mfma_f32_16x16x32_bf16 v[60:63], v[136:139], v[184:187], v[60:63]
    ds_read2_b32 v[72:73], v21 offset0:192 offset1:193
    v_lshlrev_b32 v202, 16, v215
    v_mfma_f32_16x16x32_bf16 v[64:67], v[136:139], v[188:191], v[64:67]
    ds_read2_b32 v[74:75], v21 offset0:194 offset1:195
    v_mfma_f32_16x16x32_bf16 v[44:47], v[140:143], v[164:167], v[44:47]
    v_and_b32 v203, 0xffff0000, v215
    v_mfma_f32_16x16x32_bf16 v[48:51], v[140:143], v[168:171], v[48:51]
    ds_read2_b32 v[76:77], v22 offset0:64 offset1:65
    v_mfma_f32_16x16x32_bf16 v[52:55], v[140:143], v[172:175], v[52:55]
    ds_read2_b32 v[78:79], v22 offset0:66 offset1:67
    v_mfma_f32_16x16x32_bf16 v[56:59], v[140:143], v[176:179], v[56:59]
    ds_read2_b32 v[80:81], v22 offset0:192 offset1:193
    v_lshlrev_b32 v204, 16, v216
    v_mfma_f32_16x16x32_bf16 v[60:63], v[140:143], v[180:183], v[60:63]
    v_mfma_f32_16x16x32_bf16 v[64:67], v[140:143], v[184:187], v[64:67]
    ds_read2_b32 v[82:83], v22 offset0:194 offset1:195
    v_and_b32 v205, 0xffff0000, v216
    v_mfma_f32_16x16x32_bf16 v[48:51], v[144:147], v[164:167], v[48:51]
    ds_read2_b32 v[84:85], v23 offset0:64 offset1:65
    v_mfma_f32_16x16x32_bf16 v[52:55], v[144:147], v[168:171], v[52:55]
    ds_read2_b32 v[86:87], v23 offset0:66 offset1:67
    v_lshlrev_b32 v206, 16, v217
    v_mfma_f32_16x16x32_bf16 v[56:59], v[144:147], v[172:175], v[56:59]
    v_mfma_f32_16x16x32_bf16 v[60:63], v[144:147], v[176:179], v[60:63]
    ds_read2_b32 v[88:89], v23 offset0:192 offset1:193
    v_and_b32 v207, 0xffff0000, v217
    v_mfma_f32_16x16x32_bf16 v[64:67], v[144:147], v[180:183], v[64:67]
    ds_read2_b32 v[90:91], v23 offset0:194 offset1:195
    s_waitcnt lgkmcnt(14)
    v_mfma_f32_16x16x32_bf16 v[52:55], v[148:151], v[164:167], v[52:55]
    ds_read2_b32 v[92:93], v24 offset0:64 offset1:65
    v_mfma_f32_16x16x32_bf16 v[56:59], v[148:151], v[168:171], v[56:59]
    v_lshlrev_b32 v208, 16, v218
    v_mfma_f32_16x16x32_bf16 v[60:63], v[148:151], v[172:175], v[60:63]
    ds_read2_b32 v[94:95], v24 offset0:66 offset1:67
    v_mfma_f32_16x16x32_bf16 v[64:67], v[148:151], v[176:179], v[64:67]
    ds_read2_b32 v[96:97], v24 offset0:192 offset1:193
    v_and_b32 v209, 0xffff0000, v218
    v_mfma_f32_16x16x32_bf16 v[56:59], v[152:155], v[164:167], v[56:59]
    ds_read2_b32 v[98:99], v24 offset0:194 offset1:195
    v_mfma_f32_16x16x32_bf16 v[60:63], v[152:155], v[168:171], v[60:63]
    v_lshlrev_b32 v210, 16, v219
    v_mfma_f32_16x16x32_bf16 v[64:67], v[152:155], v[172:175], v[64:67]
    v_mfma_f32_16x16x32_bf16 v[60:63], v[156:159], v[164:167], v[60:63]
    v_and_b32 v211, 0xffff0000, v219
    v_mfma_f32_16x16x32_bf16 v[64:67], v[156:159], v[168:171], v[64:67]
    v_mfma_f32_16x16x32_bf16 v[64:67], v[160:163], v[164:167], v[64:67]
    v_mfma_f32_16x16x32_bf16 v[36:39], v[68:71], v[100:103], v[36:39]
    ds_read2_b32 v[132:133], v21 offset0:80 offset1:81
    v_lshlrev_b32 v240, 16, v220
    v_mfma_f32_16x16x32_bf16 v[40:43], v[68:71], v[104:107], v[40:43]
    ds_read2_b32 v[134:135], v21 offset0:82 offset1:83
    v_mfma_f32_16x16x32_bf16 v[44:47], v[68:71], v[108:111], v[44:47]
    ds_read_b128 v[164:167], v30 offset:0
    v_and_b32 v241, 0xffff0000, v220
    v_mfma_f32_16x16x32_bf16 v[48:51], v[68:71], v[112:115], v[48:51]
    s_waitcnt lgkmcnt(14)
    v_mfma_f32_16x16x32_bf16 v[52:55], v[68:71], v[116:119], v[52:55]
    ds_read_b128 v[168:171], v30 offset:2048
    v_lshlrev_b32 v242, 16, v221
    v_mfma_f32_16x16x32_bf16 v[56:59], v[68:71], v[120:123], v[56:59]
    ds_read_b128 v[172:175], v30 offset:4096
    v_mfma_f32_16x16x32_bf16 v[60:63], v[68:71], v[124:127], v[60:63]
    ds_read_b128 v[176:179], v30 offset:6144
    v_and_b32 v243, 0xffff0000, v221
    v_mfma_f32_16x16x32_bf16 v[64:67], v[68:71], v[128:131], v[64:67]
    v_mfma_f32_16x16x32_bf16 v[40:43], v[72:75], v[100:103], v[40:43]
    ds_read_b128 v[180:183], v30 offset:8192
    v_mfma_f32_16x16x32_bf16 v[44:47], v[72:75], v[104:107], v[44:47]
    ds_read_b128 v[184:187], v30 offset:10240
    v_lshlrev_b32 v244, 16, v222
    v_mfma_f32_16x16x32_bf16 v[48:51], v[72:75], v[108:111], v[48:51]
    ds_read_b128 v[188:191], v30 offset:12288
    v_mfma_f32_16x16x32_bf16 v[52:55], v[72:75], v[112:115], v[52:55]
    v_and_b32 v245, 0xffff0000, v222
    v_mfma_f32_16x16x32_bf16 v[56:59], v[72:75], v[116:119], v[56:59]
    ds_read_b128 v[192:195], v30 offset:14336
    v_mfma_f32_16x16x32_bf16 v[60:63], v[72:75], v[120:123], v[60:63]
    ds_read2_b32 v[136:137], v21 offset0:208 offset1:209
    v_lshlrev_b32 v246, 16, v223
    v_mfma_f32_16x16x32_bf16 v[64:67], v[72:75], v[124:127], v[64:67]
    ds_read2_b32 v[138:139], v21 offset0:210 offset1:211
    s_waitcnt lgkmcnt(14)
    v_mfma_f32_16x16x32_bf16 v[44:47], v[76:79], v[100:103], v[44:47]
    v_and_b32 v247, 0xffff0000, v223
    v_mfma_f32_16x16x32_bf16 v[48:51], v[76:79], v[104:107], v[48:51]
    ds_read2_b32 v[140:141], v22 offset0:80 offset1:81
    v_mfma_f32_16x16x32_bf16 v[52:55], v[76:79], v[108:111], v[52:55]
    ds_read2_b32 v[142:143], v22 offset0:82 offset1:83
    v_mfma_f32_16x16x32_bf16 v[56:59], v[76:79], v[112:115], v[56:59]
    ds_read2_b32 v[144:145], v22 offset0:208 offset1:209
    v_lshlrev_b32 v248, 16, v224
    v_mfma_f32_16x16x32_bf16 v[60:63], v[76:79], v[116:119], v[60:63]
    v_mfma_f32_16x16x32_bf16 v[64:67], v[76:79], v[120:123], v[64:67]
    ds_read2_b32 v[146:147], v22 offset0:210 offset1:211
    v_and_b32 v249, 0xffff0000, v224
    v_mfma_f32_16x16x32_bf16 v[48:51], v[80:83], v[100:103], v[48:51]
    ds_read2_b32 v[148:149], v23 offset0:80 offset1:81
    v_mfma_f32_16x16x32_bf16 v[52:55], v[80:83], v[104:107], v[52:55]
    ds_read2_b32 v[150:151], v23 offset0:82 offset1:83
    v_lshlrev_b32 v250, 16, v225
    v_mfma_f32_16x16x32_bf16 v[56:59], v[80:83], v[108:111], v[56:59]
    v_mfma_f32_16x16x32_bf16 v[60:63], v[80:83], v[112:115], v[60:63]
    ds_read2_b32 v[152:153], v23 offset0:208 offset1:209
    v_and_b32 v251, 0xffff0000, v225
    v_mfma_f32_16x16x32_bf16 v[64:67], v[80:83], v[116:119], v[64:67]
    ds_read2_b32 v[154:155], v23 offset0:210 offset1:211
    v_mfma_f32_16x16x32_bf16 v[52:55], v[84:87], v[100:103], v[52:55]
    ds_read2_b32 v[156:157], v24 offset0:80 offset1:81
    v_mfma_f32_16x16x32_bf16 v[56:59], v[84:87], v[104:107], v[56:59]
    v_lshlrev_b32 v252, 16, v226
    v_mfma_f32_16x16x32_bf16 v[60:63], v[84:87], v[108:111], v[60:63]
    ds_read2_b32 v[158:159], v24 offset0:82 offset1:83
    v_mfma_f32_16x16x32_bf16 v[64:67], v[84:87], v[112:115], v[64:67]
    ds_read2_b32 v[160:161], v24 offset0:208 offset1:209
    v_and_b32 v253, 0xffff0000, v226
    v_mfma_f32_16x16x32_bf16 v[56:59], v[88:91], v[100:103], v[56:59]
    ds_read2_b32 v[162:163], v24 offset0:210 offset1:211
    v_mfma_f32_16x16x32_bf16 v[60:63], v[88:91], v[104:107], v[60:63]
    v_lshlrev_b32 v254, 16, v227
    v_mfma_f32_16x16x32_bf16 v[64:67], v[88:91], v[108:111], v[64:67]
    v_mfma_f32_16x16x32_bf16 v[60:63], v[92:95], v[100:103], v[60:63]
    v_and_b32 v255, 0xffff0000, v227
    v_mfma_f32_16x16x32_bf16 v[64:67], v[92:95], v[104:107], v[64:67]
    s_waitcnt lgkmcnt(14)
    v_mfma_f32_16x16x32_bf16 v[64:67], v[96:99], v[100:103], v[64:67]
    v_mfma_f32_16x16x32_bf16 v[36:39], v[132:135], v[164:167], v[36:39]
    ds_read2_b32 v[68:69], v21 offset0:96 offset1:97
    v_mfma_f32_16x16x32_bf16 v[40:43], v[132:135], v[168:171], v[40:43]
    ds_read2_b32 v[70:71], v21 offset0:98 offset1:99
    v_mfma_f32_16x16x32_bf16 v[44:47], v[132:135], v[172:175], v[44:47]
    ds_read_b128 v[100:103], v31 offset:0
    v_mfma_f32_16x16x32_bf16 v[48:51], v[132:135], v[176:179], v[48:51]
    v_mfma_f32_16x16x32_bf16 v[52:55], v[132:135], v[180:183], v[52:55]
    ds_read_b128 v[104:107], v31 offset:2048
    v_mfma_f32_16x16x32_bf16 v[56:59], v[132:135], v[184:187], v[56:59]
    ds_read_b128 v[108:111], v31 offset:4096
    v_mfma_f32_16x16x32_bf16 v[60:63], v[132:135], v[188:191], v[60:63]
    ds_read_b128 v[112:115], v31 offset:6144
    v_mfma_f32_16x16x32_bf16 v[64:67], v[132:135], v[192:195], v[64:67]
    s_waitcnt lgkmcnt(14)
    v_mfma_f32_16x16x32_bf16 v[40:43], v[136:139], v[164:167], v[40:43]
    ds_read_b128 v[116:119], v31 offset:8192
    v_mfma_f32_16x16x32_bf16 v[44:47], v[136:139], v[168:171], v[44:47]
    ds_read_b128 v[120:123], v31 offset:10240
    v_mfma_f32_16x16x32_bf16 v[48:51], v[136:139], v[172:175], v[48:51]
    ds_read_b128 v[124:127], v31 offset:12288
    v_mfma_f32_16x16x32_bf16 v[52:55], v[136:139], v[176:179], v[52:55]
    v_mfma_f32_16x16x32_bf16 v[56:59], v[136:139], v[180:183], v[56:59]
    ds_read_b128 v[128:131], v31 offset:14336
    v_mfma_f32_16x16x32_bf16 v[60:63], v[136:139], v[184:187], v[60:63]
    ds_read2_b32 v[72:73], v21 offset0:224 offset1:225
    v_mfma_f32_16x16x32_bf16 v[64:67], v[136:139], v[188:191], v[64:67]
    ds_read2_b32 v[74:75], v21 offset0:226 offset1:227
    v_mfma_f32_16x16x32_bf16 v[44:47], v[140:143], v[164:167], v[44:47]
    v_mfma_f32_16x16x32_bf16 v[48:51], v[140:143], v[168:171], v[48:51]
    ds_read2_b32 v[76:77], v22 offset0:96 offset1:97
    v_mfma_f32_16x16x32_bf16 v[52:55], v[140:143], v[172:175], v[52:55]
    ds_read2_b32 v[78:79], v22 offset0:98 offset1:99
    v_mfma_f32_16x16x32_bf16 v[56:59], v[140:143], v[176:179], v[56:59]
    ds_read2_b32 v[80:81], v22 offset0:224 offset1:225
    v_mfma_f32_16x16x32_bf16 v[60:63], v[140:143], v[180:183], v[60:63]
    v_mfma_f32_16x16x32_bf16 v[64:67], v[140:143], v[184:187], v[64:67]
    ds_read2_b32 v[82:83], v22 offset0:226 offset1:227
    v_mfma_f32_16x16x32_bf16 v[48:51], v[144:147], v[164:167], v[48:51]
    ds_read2_b32 v[84:85], v23 offset0:96 offset1:97
    v_mfma_f32_16x16x32_bf16 v[52:55], v[144:147], v[168:171], v[52:55]
    ds_read2_b32 v[86:87], v23 offset0:98 offset1:99
    v_mfma_f32_16x16x32_bf16 v[56:59], v[144:147], v[172:175], v[56:59]
    v_mfma_f32_16x16x32_bf16 v[60:63], v[144:147], v[176:179], v[60:63]
    ds_read2_b32 v[88:89], v23 offset0:224 offset1:225
    v_mfma_f32_16x16x32_bf16 v[64:67], v[144:147], v[180:183], v[64:67]
    ds_read2_b32 v[90:91], v23 offset0:226 offset1:227
    s_waitcnt lgkmcnt(14)
    v_mfma_f32_16x16x32_bf16 v[52:55], v[148:151], v[164:167], v[52:55]
    ds_read2_b32 v[92:93], v24 offset0:96 offset1:97
    v_mfma_f32_16x16x32_bf16 v[56:59], v[148:151], v[168:171], v[56:59]
    v_mfma_f32_16x16x32_bf16 v[60:63], v[148:151], v[172:175], v[60:63]
    ds_read2_b32 v[94:95], v24 offset0:98 offset1:99
    v_mfma_f32_16x16x32_bf16 v[64:67], v[148:151], v[176:179], v[64:67]
    ds_read2_b32 v[96:97], v24 offset0:224 offset1:225
    v_mfma_f32_16x16x32_bf16 v[56:59], v[152:155], v[164:167], v[56:59]
    ds_read2_b32 v[98:99], v24 offset0:226 offset1:227
    v_mfma_f32_16x16x32_bf16 v[60:63], v[152:155], v[168:171], v[60:63]
    v_mfma_f32_16x16x32_bf16 v[64:67], v[152:155], v[172:175], v[64:67]
    v_mfma_f32_16x16x32_bf16 v[60:63], v[156:159], v[164:167], v[60:63]
    v_mfma_f32_16x16x32_bf16 v[64:67], v[156:159], v[168:171], v[64:67]
    v_mfma_f32_16x16x32_bf16 v[64:67], v[160:163], v[164:167], v[64:67]
    v_mfma_f32_16x16x32_bf16 v[36:39], v[68:71], v[100:103], v[36:39]
    ds_read2_b32 v[132:133], v21 offset0:112 offset1:113
    v_mfma_f32_16x16x32_bf16 v[40:43], v[68:71], v[104:107], v[40:43]
    ds_read2_b32 v[134:135], v21 offset0:114 offset1:115
    v_mfma_f32_16x16x32_bf16 v[44:47], v[68:71], v[108:111], v[44:47]
    ds_read_b128 v[164:167], v32 offset:0
    v_mfma_f32_16x16x32_bf16 v[48:51], v[68:71], v[112:115], v[48:51]
    s_waitcnt lgkmcnt(14)
    v_mfma_f32_16x16x32_bf16 v[52:55], v[68:71], v[116:119], v[52:55]
    ds_read_b128 v[168:171], v32 offset:2048
    v_mfma_f32_16x16x32_bf16 v[56:59], v[68:71], v[120:123], v[56:59]
    ds_read_b128 v[172:175], v32 offset:4096
    v_mfma_f32_16x16x32_bf16 v[60:63], v[68:71], v[124:127], v[60:63]
    ds_read_b128 v[176:179], v32 offset:6144
    v_mfma_f32_16x16x32_bf16 v[64:67], v[68:71], v[128:131], v[64:67]
    v_mfma_f32_16x16x32_bf16 v[40:43], v[72:75], v[100:103], v[40:43]
    ds_read_b128 v[180:183], v32 offset:8192
    v_mfma_f32_16x16x32_bf16 v[44:47], v[72:75], v[104:107], v[44:47]
    ds_read_b128 v[184:187], v32 offset:10240
    v_mfma_f32_16x16x32_bf16 v[48:51], v[72:75], v[108:111], v[48:51]
    ds_read_b128 v[188:191], v32 offset:12288
    v_mfma_f32_16x16x32_bf16 v[52:55], v[72:75], v[112:115], v[52:55]
    v_mfma_f32_16x16x32_bf16 v[56:59], v[72:75], v[116:119], v[56:59]
    ds_read_b128 v[192:195], v32 offset:14336
    v_mfma_f32_16x16x32_bf16 v[60:63], v[72:75], v[120:123], v[60:63]
    ds_read2_b32 v[136:137], v21 offset0:240 offset1:241
    v_mfma_f32_16x16x32_bf16 v[64:67], v[72:75], v[124:127], v[64:67]
    ds_read2_b32 v[138:139], v21 offset0:242 offset1:243
    s_waitcnt lgkmcnt(14)
    v_mfma_f32_16x16x32_bf16 v[44:47], v[76:79], v[100:103], v[44:47]
    v_mfma_f32_16x16x32_bf16 v[48:51], v[76:79], v[104:107], v[48:51]
    ds_read2_b32 v[140:141], v22 offset0:112 offset1:113
    v_mfma_f32_16x16x32_bf16 v[52:55], v[76:79], v[108:111], v[52:55]
    ds_read2_b32 v[142:143], v22 offset0:114 offset1:115
    v_mfma_f32_16x16x32_bf16 v[56:59], v[76:79], v[112:115], v[56:59]
    ds_read2_b32 v[144:145], v22 offset0:240 offset1:241
    v_mfma_f32_16x16x32_bf16 v[60:63], v[76:79], v[116:119], v[60:63]
    v_mfma_f32_16x16x32_bf16 v[64:67], v[76:79], v[120:123], v[64:67]
    ds_read2_b32 v[146:147], v22 offset0:242 offset1:243
    v_mfma_f32_16x16x32_bf16 v[48:51], v[80:83], v[100:103], v[48:51]
    ds_read2_b32 v[148:149], v23 offset0:112 offset1:113
    v_mfma_f32_16x16x32_bf16 v[52:55], v[80:83], v[104:107], v[52:55]
    ds_read2_b32 v[150:151], v23 offset0:114 offset1:115
    v_mfma_f32_16x16x32_bf16 v[56:59], v[80:83], v[108:111], v[56:59]
    v_mfma_f32_16x16x32_bf16 v[60:63], v[80:83], v[112:115], v[60:63]
    ds_read2_b32 v[152:153], v23 offset0:240 offset1:241
    v_mfma_f32_16x16x32_bf16 v[64:67], v[80:83], v[116:119], v[64:67]
    ds_read2_b32 v[154:155], v23 offset0:242 offset1:243
    v_mfma_f32_16x16x32_bf16 v[52:55], v[84:87], v[100:103], v[52:55]
    ds_read2_b32 v[156:157], v24 offset0:112 offset1:113
    v_mfma_f32_16x16x32_bf16 v[56:59], v[84:87], v[104:107], v[56:59]
    v_mfma_f32_16x16x32_bf16 v[60:63], v[84:87], v[108:111], v[60:63]
    ds_read2_b32 v[158:159], v24 offset0:114 offset1:115
    v_mfma_f32_16x16x32_bf16 v[64:67], v[84:87], v[112:115], v[64:67]
    ds_read2_b32 v[160:161], v24 offset0:240 offset1:241
    v_mfma_f32_16x16x32_bf16 v[56:59], v[88:91], v[100:103], v[56:59]
    ds_read2_b32 v[162:163], v24 offset0:242 offset1:243
    v_mfma_f32_16x16x32_bf16 v[60:63], v[88:91], v[104:107], v[60:63]
    v_mfma_f32_16x16x32_bf16 v[64:67], v[88:91], v[108:111], v[64:67]
    v_mfma_f32_16x16x32_bf16 v[60:63], v[92:95], v[100:103], v[60:63]
    v_mfma_f32_16x16x32_bf16 v[64:67], v[92:95], v[104:107], v[64:67]
    s_waitcnt lgkmcnt(14)
    v_mfma_f32_16x16x32_bf16 v[64:67], v[96:99], v[100:103], v[64:67]
    v_mfma_f32_16x16x32_bf16 v[36:39], v[132:135], v[164:167], v[36:39]
    v_mfma_f32_16x16x32_bf16 v[40:43], v[132:135], v[168:171], v[40:43]
    v_mfma_f32_16x16x32_bf16 v[44:47], v[132:135], v[172:175], v[44:47]
    v_mfma_f32_16x16x32_bf16 v[48:51], v[132:135], v[176:179], v[48:51]
    v_mfma_f32_16x16x32_bf16 v[52:55], v[132:135], v[180:183], v[52:55]
    v_mfma_f32_16x16x32_bf16 v[56:59], v[132:135], v[184:187], v[56:59]
    v_mfma_f32_16x16x32_bf16 v[60:63], v[132:135], v[188:191], v[60:63]
    v_mfma_f32_16x16x32_bf16 v[64:67], v[132:135], v[192:195], v[64:67]
    s_waitcnt lgkmcnt(12)
    v_mfma_f32_16x16x32_bf16 v[40:43], v[136:139], v[164:167], v[40:43]
    v_cvt_pk_bf16_f32 v68, v39, v38
    v_cvt_pk_bf16_f32 v69, v37, v36
    v_mfma_f32_16x16x32_bf16 v[44:47], v[136:139], v[168:171], v[44:47]
    ds_write_b64 v20, v[68:69] offset:0
    v_mfma_f32_16x16x32_bf16 v[48:51], v[136:139], v[172:175], v[48:51]
    v_mfma_f32_16x16x32_bf16 v[52:55], v[136:139], v[176:179], v[52:55]
    v_mfma_f32_16x16x32_bf16 v[56:59], v[136:139], v[180:183], v[56:59]
    v_mfma_f32_16x16x32_bf16 v[60:63], v[136:139], v[184:187], v[60:63]
    v_mfma_f32_16x16x32_bf16 v[64:67], v[136:139], v[188:191], v[64:67]
    s_waitcnt lgkmcnt(11)
    v_mfma_f32_16x16x32_bf16 v[44:47], v[140:143], v[164:167], v[44:47]
    v_mfma_f32_16x16x32_bf16 v[48:51], v[140:143], v[168:171], v[48:51]
    v_cvt_pk_bf16_f32 v70, v43, v42
    v_cvt_pk_bf16_f32 v71, v41, v40
    v_mfma_f32_16x16x32_bf16 v[52:55], v[140:143], v[172:175], v[52:55]
    ds_write_b64 v20, v[70:71] offset:2048
    v_mfma_f32_16x16x32_bf16 v[56:59], v[140:143], v[176:179], v[56:59]
    v_mfma_f32_16x16x32_bf16 v[60:63], v[140:143], v[180:183], v[60:63]
    v_mfma_f32_16x16x32_bf16 v[64:67], v[140:143], v[184:187], v[64:67]
    s_waitcnt lgkmcnt(10)
    v_mfma_f32_16x16x32_bf16 v[48:51], v[144:147], v[164:167], v[48:51]
    v_mfma_f32_16x16x32_bf16 v[52:55], v[144:147], v[168:171], v[52:55]
    v_mfma_f32_16x16x32_bf16 v[56:59], v[144:147], v[172:175], v[56:59]
    v_cvt_pk_bf16_f32 v72, v47, v46
    v_cvt_pk_bf16_f32 v73, v45, v44
    v_mfma_f32_16x16x32_bf16 v[60:63], v[144:147], v[176:179], v[60:63]
    ds_write_b64 v20, v[72:73] offset:4096
    v_mfma_f32_16x16x32_bf16 v[64:67], v[144:147], v[180:183], v[64:67]
    s_waitcnt lgkmcnt(9)
    v_mfma_f32_16x16x32_bf16 v[52:55], v[148:151], v[164:167], v[52:55]
    v_mfma_f32_16x16x32_bf16 v[56:59], v[148:151], v[168:171], v[56:59]
    v_mfma_f32_16x16x32_bf16 v[60:63], v[148:151], v[172:175], v[60:63]
    v_mfma_f32_16x16x32_bf16 v[64:67], v[148:151], v[176:179], v[64:67]
    v_cvt_pk_bf16_f32 v74, v51, v50
    v_cvt_pk_bf16_f32 v75, v49, v48
    s_waitcnt lgkmcnt(7)
    v_mfma_f32_16x16x32_bf16 v[56:59], v[152:155], v[164:167], v[56:59]
    ds_write_b64 v20, v[74:75] offset:6144
    v_mfma_f32_16x16x32_bf16 v[60:63], v[152:155], v[168:171], v[60:63]
    v_mfma_f32_16x16x32_bf16 v[64:67], v[152:155], v[172:175], v[64:67]
    s_waitcnt lgkmcnt(6)
    v_mfma_f32_16x16x32_bf16 v[60:63], v[156:159], v[164:167], v[60:63]
    v_mfma_f32_16x16x32_bf16 v[64:67], v[156:159], v[168:171], v[64:67]
    v_cvt_pk_bf16_f32 v76, v55, v54
    v_cvt_pk_bf16_f32 v77, v53, v52
    s_waitcnt lgkmcnt(4)
    v_mfma_f32_16x16x32_bf16 v[64:67], v[160:163], v[164:167], v[64:67]
    ds_write_b64 v20, v[76:77] offset:8192
    v_cvt_pk_bf16_f32 v78, v59, v58
    v_cvt_pk_bf16_f32 v79, v57, v56
    ds_write_b64 v20, v[78:79] offset:10240
    v_cvt_pk_bf16_f32 v80, v63, v62
    v_cvt_pk_bf16_f32 v81, v61, v60
    ds_write_b64 v20, v[80:81] offset:12288
    s_nop 0
    v_cvt_pk_bf16_f32 v82, v67, v66
    v_cvt_pk_bf16_f32 v83, v65, v64
    ds_write_b64 v20, v[82:83] offset:14336
    s_mov_b64 exec, 1
    ds_add_u32 v18, v19 offset:12
    s_mov_b64 exec, -1
    s_add_u32 s80, s86, 94208
    v_add_u32 v5, s80, v15
    s_branch LA_s3_in
LA_s3:
    s_sleep 1
LA_s3_in:
    ds_read_b32 v6, v18 offset:12
    ds_read_b128 v[84:87], v5 offset:0
    ds_read_b128 v[88:91], v5 offset:4096
    ds_read_b128 v[92:95], v5 offset:8192
    ds_read_b128 v[96:99], v5 offset:12288
    s_waitcnt lgkmcnt(0)
    v_readfirstlane_b32 s78, v6
    s_nop 0
    s_cmp_ge_u32 s78, 4
    s_cbranch_scc0 LA_s3
    s_add_u32 s89, s91, 4194304
    buffer_store_dwordx4 v[84:87], v14, s[52:55], s89 offen sc1
    s_add_u32 s89, s91, 4198400
    buffer_store_dwordx4 v[88:91], v14, s[52:55], s89 offen sc1
    s_add_u32 s89, s91, 4202496
    buffer_store_dwordx4 v[92:95], v14, s[52:55], s89 offen sc1
    s_add_u32 s89, s91, 4206592
    buffer_store_dwordx4 v[96:99], v14, s[52:55], s89 offen sc1
    s_setprio 0
    s_lshr_b32 s81, s91, 4
    s_lshl_b32 s82, s3, 8
    s_add_u32 s81, s81, s82
    s_add_u32 s81, s81, 12648448
    s_lshl_b32 s80, s74, 14
    s_and_b32 s82, s75, 3
    s_lshl_b32 s82, s82, 8
    s_add_u32 s80, s80, s82
    s_add_u32 s80, s80, 12648448
    v_mov_b32 v5, 0
    v_lshlrev_b32 v7, 10, v0
    s_waitcnt vmcnt(0)
    s_mov_b64 exec, 1
    buffer_store_dword v19, v5, s[52:55], s81 offen sc1
    s_mov_b64 exec, 0xffff
    s_waitcnt vmcnt(0)
    s_branch LA_s7a_in
LA_s7a:
    s_sleep 1
LA_s7a_in:
    ds_read_b32 v6, v18 offset:28
    s_waitcnt lgkmcnt(0)
    v_readfirstlane_b32 s78, v6
    s_nop 0
    s_cmp_ge_u32 s78, 4
    s_cbranch_scc0 LA_s7a
    s_setprio 2
    s_mov_b32 s79, 0
LA_py:
    buffer_load_dword v6, v7, s[52:55], s80 offen sc1
    s_add_u32 s79, s79, 1
    s_cmp_gt_u32 s79, 200000
    s_cbranch_scc1 LA_py_x
    s_waitcnt vmcnt(0)
    v_cmp_ne_u32 vcc, 1, v6
    s_cbranch_vccz LA_py_x
    s_mov_b64 exec, vcc
    s_sleep 8
    s_branch LA_py
LA_py_x:
    s_waitcnt vmcnt(0)
    s_mov_b64 exec, -1
    s_mov_b32 s89, 4194304
    buffer_load_dwordx4 v[100:103], v12, s[52:55], s89 offen sc1
    s_mov_b32 s89, 4210688
    buffer_load_dwordx4 v[104:107], v12, s[52:55], s89 offen sc1
    s_mov_b32 s89, 4227072
    buffer_load_dwordx4 v[108:111], v12, s[52:55], s89 offen sc1
    s_mov_b32 s89, 4243456
    buffer_load_dwordx4 v[112:115], v12, s[52:55], s89 offen sc1
    s_waitcnt vmcnt(3)
    v_permlane32_swap_b32 v102, v100
    v_permlane32_swap_b32 v103, v101
    s_waitcnt vmcnt(2)
    v_permlane32_swap_b32 v106, v104
    v_permlane32_swap_b32 v107, v105
    s_waitcnt vmcnt(1)
    v_permlane32_swap_b32 v110, v108
    v_permlane32_swap_b32 v111, v109
    s_waitcnt vmcnt(0)
    v_permlane32_swap_b32 v114, v112
    v_permlane32_swap_b32 v115, v113
    v_and_b32 v68, 0xffff0000, v103
    v_and_b32 v69, 0xffff0000, v107
    v_and_b32 v70, 0xffff0000, v111
    v_and_b32 v71, 0xffff0000, v115
    v_and_b32 v72, 0xffff0000, v101
    v_and_b32 v73, 0xffff0000, v105
    v_and_b32 v74, 0xffff0000, v109
    v_and_b32 v75, 0xffff0000, v113
    v_mul_f32 v68, v68, v196
    v_mul_f32 v69, v69, v197
    v_mul_f32 v70, v70, v198
    v_mul_f32 v71, v71, v199
    v_mul_f32 v72, v72, v200
    v_mul_f32 v73, v73, v201
    v_mul_f32 v74, v74, v202
    v_mul_f32 v75, v75, v203
    v_cvt_pk_bf16_f32 v36, v68, v69
    v_cvt_pk_bf16_f32 v37, v70, v71
    v_cvt_pk_bf16_f32 v38, v72, v73
    v_cvt_pk_bf16_f32 v39, v74, v75
    s_mov_b32 s89, 0
    buffer_store_dwordx4 v[36:39], v13, s[60:63], s89 offen nt
    v_lshlrev_b32 v68, 16, v103
    v_lshlrev_b32 v69, 16, v107
    v_lshlrev_b32 v70, 16, v111
    v_lshlrev_b32 v71, 16, v115
    v_lshlrev_b32 v72, 16, v101
    v_lshlrev_b32 v73, 16, v105
    v_lshlrev_b32 v74, 16, v109
    v_lshlrev_b32 v75, 16, v113
    v_mul_f32 v68, v68, v204
    v_mul_f32 v69, v69, v205
    v_mul_f32 v70, v70, v206
    v_mul_f32 v71, v71, v207
    v_mul_f32 v72, v72, v208
    v_mul_f32 v73, v73, v209
    v_mul_f32 v74, v74, v210
    v_mul_f32 v75, v75, v211
    v_cvt_pk_bf16_f32 v40, v68, v69
    v_cvt_pk_bf16_f32 v41, v70, v71
    v_cvt_pk_bf16_f32 v42, v72, v73
    v_cvt_pk_bf16_f32 v43, v74, v75
    s_mov_b32 s89, 4096
    buffer_store_dwordx4 v[40:43], v13, s[60:63], s89 offen nt
    v_and_b32 v68, 0xffff0000, v102
    v_and_b32 v69, 0xffff0000, v106
    v_and_b32 v70, 0xffff0000, v110
    v_and_b32 v71, 0xffff0000, v114
    v_and_b32 v72, 0xffff0000, v100
    v_and_b32 v73, 0xffff0000, v104
    v_and_b32 v74, 0xffff0000, v108
    v_and_b32 v75, 0xffff0000, v112
    v_mul_f32 v68, v68, v240
    v_mul_f32 v69, v69, v241
    v_mul_f32 v70, v70, v242
    v_mul_f32 v71, v71, v243
    v_mul_f32 v72, v72, v244
    v_mul_f32 v73, v73, v245
    v_mul_f32 v74, v74, v246
    v_mul_f32 v75, v75, v247
    v_cvt_pk_bf16_f32 v44, v68, v69
    v_cvt_pk_bf16_f32 v45, v70, v71
    v_cvt_pk_bf16_f32 v46, v72, v73
    v_cvt_pk_bf16_f32 v47, v74, v75
    s_mov_b32 s89, 8192
    buffer_store_dwordx4 v[44:47], v13, s[60:63], s89 offen nt
    v_lshlrev_b32 v68, 16, v102
    v_lshlrev_b32 v69, 16, v106
    v_lshlrev_b32 v70, 16, v110
    v_lshlrev_b32 v71, 16, v114
    v_lshlrev_b32 v72, 16, v100
    v_lshlrev_b32 v73, 16, v104
    v_lshlrev_b32 v74, 16, v108
    v_lshlrev_b32 v75, 16, v112
    v_mul_f32 v68, v68, v248
    v_mul_f32 v69, v69, v249
    v_mul_f32 v70, v70, v250
    v_mul_f32 v71, v71, v251
    v_mul_f32 v72, v72, v252
    v_mul_f32 v73, v73, v253
    v_mul_f32 v74, v74, v254
    v_mul_f32 v75, v75, v255
    v_cvt_pk_bf16_f32 v48, v68, v69
    v_cvt_pk_bf16_f32 v49, v70, v71
    v_cvt_pk_bf16_f32 v50, v72, v73
    v_cvt_pk_bf16_f32 v51, v74, v75
    s_mov_b32 s89, 12288
    buffer_store_dwordx4 v[48:51], v13, s[60:63], s89 offen nt
    s_endpgm
L_B:
    s_setprio 3
    s_and_b32 s3, s3, 3
    s_lshr_b32 s86, s3, 1
    s_and_b32 s87, s3, 1
    v_mov_b32 v10, 162304
    v_mov_b32 v11, 1
    v_lshlrev_b32 v12, 4, v0
    v_lshl_add_u32 v13, v0, 2, v10
    v_mov_b32 v14, 0
    ds_write_b32 v13, v14
    s_lshl_b32 s78, s74, 4
    s_add_u32 s78, s78, s75
    s_lshl_b32 s96, s78, 8
    s_add_u32 s96, s96, 12582912
    s_lshl_b32 s78, s78, 2
    s_add_u32 s78, s78, s3
    s_lshl_b32 s78, s78, 8
    s_add_u32 s80, s78, 12648448
    s_lshl_b32 s81, s72, 1
    s_add_u32 s81, s81, s86
    s_lshl_b32 s97, s81, 4
    s_add_u32 s97, s97, s73
    s_lshl_b32 s97, s97, 8
    s_add_u32 s97, s97, 12910464
    v_mov_b32 v15, s80
    v_mov_b32 v223, s97
    v_cmp_gt_u32 vcc, 8, v0
    s_nop 1
    v_cndmask_b32 v15, v223, v15, vcc
    v_add_u32 v221, v15, v12
    s_lshl_b32 s78, s87, 2
    s_add_u32 s78, s78, 128
    s_add_u32 s97, s97, s78
    s_lshl_b32 s82, s73, 1
    s_add_u32 s82, s82, s87
    s_lshl_b32 s78, s81, 7
    s_add_u32 s78, s78, s82
    s_lshl_b32 s94, s78, 10
    s_add_u32 s94, s94, 8388608
    v_mov_b32 v212, 0
    v_mov_b32 v213, 0
    v_mov_b32 v214, 0
    v_mov_b32 v215, 0
    v_mov_b32 v220, 0
    s_waitcnt lgkmcnt(0)
    s_mov_b32 s52, s26
    s_mov_b32 s53, s27
    s_mov_b32 s54, 0x1000000
    s_mov_b32 s55, 0x20000
    s_mov_b32 s68, s24
    s_mov_b32 s69, s25
    s_mov_b32 s70, 0x100
    s_mov_b32 s71, 0x20000
    s_mov_b32 s60, s22
    s_mov_b32 s61, s23
    s_mov_b32 s62, 0x800000
    s_mov_b32 s63, 0x20000
    s_lshl_b32 s98, s74, 4
    s_or_b32 s78, s75, s3
    s_cmp_lg_u32 s78, 0
    s_cbranch_scc1 LB_notag
    s_mov_b64 exec, 0xffff
    v_lshlrev_b32 v15, 8, v0
    buffer_load_dword v223, v15, s[52:55], s96 offen sc1
    s_waitcnt vmcnt(0)
    v_lshrrev_b32 v223, v0, v223
    v_and_b32 v223, 1, v223
    v_cmp_eq_u32 vcc, 0, v223
    s_nop 1
    s_or_b32 s78, vcc_lo, 0x10000
    s_mov_b64 exec, 1
    v_mov_b32 v223, s78
    buffer_store_dword v223, v220, s[68:71], s98 offen sc1
LB_notag:
    s_lshl_b32 s78, s87, 3
    s_lshr_b32 exec_lo, 0xffff, s78
    s_mov_b32 exec_hi, 0
    buffer_store_dwordx4 v[212:215], v221, s[52:55], 0 offen sc1
    s_mov_b64 exec, -1
    s_getpc_b64 s[80:81]
LB_pc:
    s_sub_u32 s80, s80, LB_pc-concat_heads__ssm_conv_h3__sliding_local_dilated__prompt_kernel
    s_subb_u32 s81, s81, 0
    s_lshr_b32 s78, s2, 3
    s_and_b32 s78, s78, 7
    s_lshl_b32 s78, s78, 2
    s_add_u32 s78, s78, s3
    v_lshlrev_b32 v13, 5, v0
    v_add_u32 v13, s78, v13
    v_lshlrev_b32 v13, 7, v13
    v_cmp_gt_u32 vcc, L_end-concat_heads__ssm_conv_h3__sliding_local_dilated__prompt_kernel, v13
    s_nop 0
    s_and_saveexec_b64 s[82:83], vcc
    global_load_dword v222, v13, s[80:81]
    s_mov_b64 exec, -1
    v_and_b32 v13, 15, v0
    v_lshrrev_b32 v14, 4, v0
    v_lshrrev_b32 v15, 1, v13
    v_xor_b32 v15, v15, v14
    v_lshlrev_b32 v15, 4, v15
    v_lshl_add_u32 v15, v13, 7, v15
    v_add_u32 v2, 73728, v15
    v_xor_b32 v3, 64, v2
    s_lshl_b32 s78, s86, 13
    s_add_u32 s78, s78, 2048
    v_add_u32 v4, s78, v2
    v_add_u32 v5, s78, v3
    v_bfe_u32 v15, v0, 3, 2
    s_lshl_b32 s78, s87, 1
    s_add_u32 s78, s78, s86
    v_xor_b32 v15, s78, v15
    v_lshlrev_b32 v15, 5, v15
    v_and_b32 v223, 3, v0
    v_lshl_add_u32 v15, v223, 3, v15
    v_bfe_u32 v223, v0, 2, 2
    v_lshl_add_u32 v15, v223, 7, v15
    v_lshl_add_u32 v6, v14, 10, v15
    v_xor_b32 v7, 32, v6
    v_add_u32 v8, 49152, v6
    v_add_u32 v9, 49152, v7
    v_and_b32 v15, 1, v13
    v_cmp_eq_u32 s[88:89], 1, v15
    v_lshl_add_u32 v15, v14, 2, v15
    v_cmp_le_u32 s[90:91], v15, v13
    v_add_u32 v15, 2, v15
    v_cmp_le_u32 s[92:93], v15, v13
    v_mov_b32 v212, 0x0c0c0c0c
    v_mov_b32 v15, 0xc0c0100
    v_mov_b32 v223, 0x1000c0c
    v_cndmask_b32 v15, v15, v223, s[88:89]
    v_cndmask_b32 v208, v15, v212, s[90:91]
    v_cndmask_b32 v210, v212, v15, s[90:91]
    v_mov_b32 v15, 0xc0c0302
    v_mov_b32 v223, 0x3020c0c
    v_cndmask_b32 v15, v15, v223, s[88:89]
    v_cndmask_b32 v209, v15, v212, s[92:93]
    v_cndmask_b32 v211, v212, v15, s[92:93]
    s_or_b32 s78, s72, s86
    s_cmp_eq_u32 s78, 0
    s_cselect_b32 s78, 0xf149f2ca, 0
    v_mov_b32 v212, s78
    v_mov_b32 v213, s78
    v_mov_b32 v214, s78
    v_mov_b32 v215, s78
    s_lshl_b32 s78, s87, 12
    s_add_u32 s78, s78, 110592
    s_lshl_b32 s79, s86, 9
    s_add_u32 s79, s79, s78
    v_lshlrev_b32 v15, 3, v0
    v_add_u32 v216, s79, v15
    s_lshl_b32 s80, s86, 11
    v_add_u32 v218, s80, v216
    v_xor_b32 v219, 512, v218
    s_add_u32 s78, s78, 2048
    s_cmp_eq_u32 s86, 0
    s_cselect_b32 s78, s78, 118784
    v_add_u32 v217, s78, v15
    v_bfe_u32 v14, v0, 3, 2
    v_lshlrev_b32 v14, 5, v14
    v_and_b32 v15, 3, v0
    v_lshl_add_u32 v14, v15, 3, v14
    v_lshrrev_b32 v15, 2, v0
    v_lshl_add_u32 v14, v15, 7, v14
    s_lshl_b32 s78, s86, 11
    v_add_u32 v244, s78, v14
    s_mov_b32 s64, s20
    s_mov_b32 s65, s21
    s_mov_b32 s66, 0x200000
    s_mov_b32 s67, 0x20000
    v_lshrrev_b32 v14, 4, v0
    v_lshlrev_b32 v14, 1, v14
    v_and_b32 v15, 7, v0
    v_xor_b32 v14, v14, v15
    v_lshlrev_b32 v14, 4, v14
    v_lshrrev_b32 v15, 3, v0
    v_lshl_add_u32 v14, v15, 11, v14
    s_lshl_b32 s78, s77, 7
    s_lshl_b32 s79, s3, 14
    s_add_u32 s78, s78, s79
    v_add_u32 v245, s78, v14
    v_and_b32 v14, 15, v0
    s_lshl_b32 s78, s76, 2
    s_add_u32 s78, s78, s3
    s_lshl_b32 s79, s78, 5
    v_add_u32 v14, s79, v14
    v_lshlrev_b32 v14, 12, v14
    v_bfe_u32 v15, v0, 4, 1
    v_lshl_add_u32 v14, v15, 5, v14
    v_lshrrev_b32 v15, 5, v0
    v_lshl_add_u32 v14, v15, 4, v14
    s_lshl_b32 s79, s77, 7
    s_add_u32 s79, s79, 2048
    v_add_u32 v246, s79, v14
    s_lshl_b32 s28, s78, 16
    s_add_u32 s28, s28, 8388608
    s_lshl_b32 s30, s76, 1
    s_add_u32 s30, s30, s86
    s_lshl_b32 s30, s30, 12
    s_add_u32 s30, s30, 12910592
    v_lshrrev_b32 v15, 1, v0
    v_lshlrev_b32 v15, 8, v15
    v_and_b32 v14, 1, v0
    v_lshl_add_u32 v247, v14, 2, v15
    s_and_b32 s32, s76, 3
    s_lshl_b32 s32, s32, 13
    s_waitcnt lgkmcnt(0)
    s_barrier
    ds_read_b128 v[120:123], v4 offset:0
    ds_read_b128 v[124:127], v4 offset:2048
    ds_read_b128 v[128:131], v4 offset:4096
    ds_read_b128 v[132:135], v4 offset:6144
    ds_read_b128 v[136:139], v2 offset:0
    ds_read_b64_tr_b16 v[140:141], v6 offset:0
    ds_read_b64_tr_b16 v[142:143], v6 offset:512
    ds_read_b64_tr_b16 v[144:145], v7 offset:0
    ds_read_b64_tr_b16 v[146:147], v7 offset:512
    ds_read_b64_tr_b16 v[148:149], v6 offset:24576
    ds_read_b64_tr_b16 v[150:151], v6 offset:25088
    ds_read_b64_tr_b16 v[152:153], v7 offset:24576
    ds_read_b64_tr_b16 v[154:155], v7 offset:25088
    ds_read_b64_tr_b16 v[156:157], v8 offset:0
    ds_read_b64_tr_b16 v[158:159], v8 offset:512
    ds_read_b64_tr_b16 v[160:161], v9 offset:0
    ds_read_b64_tr_b16 v[162:163], v9 offset:512
    s_waitcnt lgkmcnt(0)
    v_mfma_f32_16x16x32_bf16 v[112:115], v[148:151], v[136:139], 0
    ds_read_b128 v[164:167], v5 offset:0
    v_mfma_f32_16x16x32_bf16 v[116:119], v[136:139], v[156:159], 0
    ds_read_b128 v[168:171], v5 offset:2048
    v_mfma_f32_16x16x32_bf16 v[72:75], v[148:151], v[132:135], 0
    ds_read_b128 v[172:175], v5 offset:4096
    v_mfma_f32_16x16x32_bf16 v[76:79], v[152:155], v[132:135], 0
    ds_read_b128 v[176:179], v5 offset:6144
    v_mfma_f32_16x16x32_bf16 v[104:107], v[132:135], v[156:159], 0
    ds_read_b128 v[180:183], v3 offset:0
    v_mfma_f32_16x16x32_bf16 v[108:111], v[132:135], v[160:163], 0
    ds_read_b64_tr_b16 v[184:185], v6 offset:4096
    v_mfma_f32_16x16x32_bf16 v[40:43], v[140:143], v[132:135], 0
    ds_read_b64_tr_b16 v[186:187], v6 offset:4608
    v_mfma_f32_16x16x32_bf16 v[44:47], v[144:147], v[132:135], 0
    ds_read_b64_tr_b16 v[188:189], v7 offset:4096
    v_mfma_f32_16x16x32_bf16 v[64:67], v[148:151], v[128:131], 0
    ds_read_b64_tr_b16 v[190:191], v7 offset:4608
    v_mfma_f32_16x16x32_bf16 v[68:71], v[152:155], v[128:131], 0
    ds_read_b64_tr_b16 v[192:193], v6 offset:28672
    v_mfma_f32_16x16x32_bf16 v[32:35], v[140:143], v[128:131], 0
    ds_read_b64_tr_b16 v[194:195], v6 offset:29184
    v_mfma_f32_16x16x32_bf16 v[36:39], v[144:147], v[128:131], 0
    ds_read_b64_tr_b16 v[196:197], v7 offset:28672
    v_mfma_f32_16x16x32_bf16 v[56:59], v[148:151], v[124:127], 0
    ds_read_b64_tr_b16 v[198:199], v7 offset:29184
    v_mfma_f32_16x16x32_bf16 v[60:63], v[152:155], v[124:127], 0
    ds_read_b64_tr_b16 v[200:201], v8 offset:4096
    v_mfma_f32_16x16x32_bf16 v[24:27], v[140:143], v[124:127], 0
    ds_read_b64_tr_b16 v[202:203], v8 offset:4608
    v_mfma_f32_16x16x32_bf16 v[28:31], v[144:147], v[124:127], 0
    ds_read_b64_tr_b16 v[204:205], v9 offset:4096
    v_mfma_f32_16x16x32_bf16 v[48:51], v[148:151], v[120:123], 0
    ds_read_b64_tr_b16 v[206:207], v9 offset:4608
    v_mfma_f32_16x16x32_bf16 v[52:55], v[152:155], v[120:123], 0
    v_mfma_f32_16x16x32_bf16 v[16:19], v[140:143], v[120:123], 0
    v_mfma_f32_16x16x32_bf16 v[20:23], v[144:147], v[120:123], 0
    v_mfma_f32_16x16x32_bf16 v[96:99], v[128:131], v[156:159], 0
    v_mfma_f32_16x16x32_bf16 v[100:103], v[128:131], v[160:163], 0
    v_mfma_f32_16x16x32_bf16 v[88:91], v[124:127], v[156:159], 0
    v_mfma_f32_16x16x32_bf16 v[92:95], v[124:127], v[160:163], 0
    v_mfma_f32_16x16x32_bf16 v[80:83], v[120:123], v[156:159], 0
    v_mfma_f32_16x16x32_bf16 v[84:87], v[120:123], v[160:163], 0
    s_waitcnt vmcnt(0)
    s_waitcnt lgkmcnt(0)
    s_barrier
    v_mfma_f32_16x16x32_bf16 v[112:115], v[192:195], v[180:183], v[112:115]
    ds_read_b128 v[120:123], v4 offset:18432
    v_mfma_f32_16x16x32_bf16 v[116:119], v[180:183], v[200:203], v[116:119]
    ds_read_b128 v[124:127], v4 offset:20480
    v_mfma_f32_16x16x32_bf16 v[72:75], v[192:195], v[176:179], v[72:75]
    ds_read_b128 v[128:131], v4 offset:22528
    v_mfma_f32_16x16x32_bf16 v[76:79], v[196:199], v[176:179], v[76:79]
    ds_read_b128 v[132:135], v4 offset:24576
    v_mfma_f32_16x16x32_bf16 v[104:107], v[176:179], v[200:203], v[104:107]
    ds_read_b128 v[136:139], v2 offset:18432
    v_mfma_f32_16x16x32_bf16 v[108:111], v[176:179], v[204:207], v[108:111]
    ds_read_b64_tr_b16 v[140:141], v6 offset:8192
    v_mfma_f32_16x16x32_bf16 v[40:43], v[184:187], v[176:179], v[40:43]
    ds_read_b64_tr_b16 v[142:143], v6 offset:8704
    v_mfma_f32_16x16x32_bf16 v[44:47], v[188:191], v[176:179], v[44:47]
    ds_read_b64_tr_b16 v[144:145], v7 offset:8192
    v_mfma_f32_16x16x32_bf16 v[64:67], v[192:195], v[172:175], v[64:67]
    ds_read_b64_tr_b16 v[146:147], v7 offset:8704
    v_mfma_f32_16x16x32_bf16 v[68:71], v[196:199], v[172:175], v[68:71]
    ds_read_b64_tr_b16 v[148:149], v6 offset:32768
    v_mfma_f32_16x16x32_bf16 v[32:35], v[184:187], v[172:175], v[32:35]
    ds_read_b64_tr_b16 v[150:151], v6 offset:33280
    v_mfma_f32_16x16x32_bf16 v[36:39], v[188:191], v[172:175], v[36:39]
    ds_read_b64_tr_b16 v[152:153], v7 offset:32768
    v_mfma_f32_16x16x32_bf16 v[56:59], v[192:195], v[168:171], v[56:59]
    ds_read_b64_tr_b16 v[154:155], v7 offset:33280
    v_mfma_f32_16x16x32_bf16 v[60:63], v[196:199], v[168:171], v[60:63]
    ds_read_b64_tr_b16 v[156:157], v8 offset:8192
    v_mfma_f32_16x16x32_bf16 v[24:27], v[184:187], v[168:171], v[24:27]
    ds_read_b64_tr_b16 v[158:159], v8 offset:8704
    v_mfma_f32_16x16x32_bf16 v[28:31], v[188:191], v[168:171], v[28:31]
    ds_read_b64_tr_b16 v[160:161], v9 offset:8192
    v_mfma_f32_16x16x32_bf16 v[48:51], v[192:195], v[164:167], v[48:51]
    ds_read_b64_tr_b16 v[162:163], v9 offset:8704
    v_mfma_f32_16x16x32_bf16 v[52:55], v[196:199], v[164:167], v[52:55]
    v_mfma_f32_16x16x32_bf16 v[16:19], v[184:187], v[164:167], v[16:19]
    v_mfma_f32_16x16x32_bf16 v[20:23], v[188:191], v[164:167], v[20:23]
    v_mfma_f32_16x16x32_bf16 v[96:99], v[172:175], v[200:203], v[96:99]
    v_mfma_f32_16x16x32_bf16 v[100:103], v[172:175], v[204:207], v[100:103]
    v_mfma_f32_16x16x32_bf16 v[88:91], v[168:171], v[200:203], v[88:91]
    v_mfma_f32_16x16x32_bf16 v[92:95], v[168:171], v[204:207], v[92:95]
    v_mfma_f32_16x16x32_bf16 v[80:83], v[164:167], v[200:203], v[80:83]
    v_mfma_f32_16x16x32_bf16 v[84:87], v[164:167], v[204:207], v[84:87]
    s_waitcnt lgkmcnt(0)
    v_mfma_f32_16x16x32_bf16 v[112:115], v[148:151], v[136:139], v[112:115]
    ds_read_b128 v[164:167], v5 offset:18432
    v_mfma_f32_16x16x32_bf16 v[116:119], v[136:139], v[156:159], v[116:119]
    ds_read_b128 v[168:171], v5 offset:20480
    v_mfma_f32_16x16x32_bf16 v[72:75], v[148:151], v[132:135], v[72:75]
    ds_read_b128 v[172:175], v5 offset:22528
    v_mfma_f32_16x16x32_bf16 v[76:79], v[152:155], v[132:135], v[76:79]
    ds_read_b128 v[176:179], v5 offset:24576
    v_mfma_f32_16x16x32_bf16 v[104:107], v[132:135], v[156:159], v[104:107]
    ds_read_b128 v[180:183], v3 offset:18432
    v_mfma_f32_16x16x32_bf16 v[108:111], v[132:135], v[160:163], v[108:111]
    ds_read_b64_tr_b16 v[184:185], v6 offset:12288
    v_mfma_f32_16x16x32_bf16 v[40:43], v[140:143], v[132:135], v[40:43]
    ds_read_b64_tr_b16 v[186:187], v6 offset:12800
    v_mfma_f32_16x16x32_bf16 v[44:47], v[144:147], v[132:135], v[44:47]
    ds_read_b64_tr_b16 v[188:189], v7 offset:12288
    v_mfma_f32_16x16x32_bf16 v[64:67], v[148:151], v[128:131], v[64:67]
    ds_read_b64_tr_b16 v[190:191], v7 offset:12800
    v_mfma_f32_16x16x32_bf16 v[68:71], v[152:155], v[128:131], v[68:71]
    ds_read_b64_tr_b16 v[192:193], v6 offset:36864
    v_mfma_f32_16x16x32_bf16 v[32:35], v[140:143], v[128:131], v[32:35]
    ds_read_b64_tr_b16 v[194:195], v6 offset:37376
    v_mfma_f32_16x16x32_bf16 v[36:39], v[144:147], v[128:131], v[36:39]
    ds_read_b64_tr_b16 v[196:197], v7 offset:36864
    v_mfma_f32_16x16x32_bf16 v[56:59], v[148:151], v[124:127], v[56:59]
    ds_read_b64_tr_b16 v[198:199], v7 offset:37376
    v_mfma_f32_16x16x32_bf16 v[60:63], v[152:155], v[124:127], v[60:63]
    ds_read_b64_tr_b16 v[200:201], v8 offset:12288
    v_mfma_f32_16x16x32_bf16 v[24:27], v[140:143], v[124:127], v[24:27]
    ds_read_b64_tr_b16 v[202:203], v8 offset:12800
    v_mfma_f32_16x16x32_bf16 v[28:31], v[144:147], v[124:127], v[28:31]
    ds_read_b64_tr_b16 v[204:205], v9 offset:12288
    v_mfma_f32_16x16x32_bf16 v[48:51], v[148:151], v[120:123], v[48:51]
    ds_read_b64_tr_b16 v[206:207], v9 offset:12800
    v_mfma_f32_16x16x32_bf16 v[52:55], v[152:155], v[120:123], v[52:55]
    v_mfma_f32_16x16x32_bf16 v[16:19], v[140:143], v[120:123], v[16:19]
    v_mfma_f32_16x16x32_bf16 v[20:23], v[144:147], v[120:123], v[20:23]
    v_mfma_f32_16x16x32_bf16 v[96:99], v[128:131], v[156:159], v[96:99]
    v_mfma_f32_16x16x32_bf16 v[100:103], v[128:131], v[160:163], v[100:103]
    v_mfma_f32_16x16x32_bf16 v[88:91], v[124:127], v[156:159], v[88:91]
    v_mfma_f32_16x16x32_bf16 v[92:95], v[124:127], v[160:163], v[92:95]
    v_mfma_f32_16x16x32_bf16 v[80:83], v[120:123], v[156:159], v[80:83]
    v_mfma_f32_16x16x32_bf16 v[84:87], v[120:123], v[160:163], v[84:87]
    s_waitcnt lgkmcnt(0)
    s_barrier
    v_mfma_f32_16x16x32_bf16 v[112:115], v[192:195], v[180:183], v[112:115]
    ds_read_b128 v[120:123], v4 offset:36864
    v_mfma_f32_16x16x32_bf16 v[116:119], v[180:183], v[200:203], v[116:119]
    ds_read_b128 v[124:127], v4 offset:38912
    v_mfma_f32_16x16x32_bf16 v[72:75], v[192:195], v[176:179], v[72:75]
    ds_read_b128 v[128:131], v4 offset:40960
    v_mfma_f32_16x16x32_bf16 v[76:79], v[196:199], v[176:179], v[76:79]
    ds_read_b128 v[132:135], v4 offset:43008
    v_mfma_f32_16x16x32_bf16 v[104:107], v[176:179], v[200:203], v[104:107]
    ds_read_b128 v[136:139], v2 offset:36864
    v_mfma_f32_16x16x32_bf16 v[108:111], v[176:179], v[204:207], v[108:111]
    ds_read_b64_tr_b16 v[140:141], v6 offset:16384
    v_mfma_f32_16x16x32_bf16 v[40:43], v[184:187], v[176:179], v[40:43]
    ds_read_b64_tr_b16 v[142:143], v6 offset:16896
    v_mfma_f32_16x16x32_bf16 v[44:47], v[188:191], v[176:179], v[44:47]
    ds_read_b64_tr_b16 v[144:145], v7 offset:16384
    v_mfma_f32_16x16x32_bf16 v[64:67], v[192:195], v[172:175], v[64:67]
    ds_read_b64_tr_b16 v[146:147], v7 offset:16896
    v_mfma_f32_16x16x32_bf16 v[68:71], v[196:199], v[172:175], v[68:71]
    ds_read_b64_tr_b16 v[148:149], v6 offset:40960
    v_mfma_f32_16x16x32_bf16 v[32:35], v[184:187], v[172:175], v[32:35]
    ds_read_b64_tr_b16 v[150:151], v6 offset:41472
    v_mfma_f32_16x16x32_bf16 v[36:39], v[188:191], v[172:175], v[36:39]
    ds_read_b64_tr_b16 v[152:153], v7 offset:40960
    v_mfma_f32_16x16x32_bf16 v[56:59], v[192:195], v[168:171], v[56:59]
    ds_read_b64_tr_b16 v[154:155], v7 offset:41472
    v_mfma_f32_16x16x32_bf16 v[60:63], v[196:199], v[168:171], v[60:63]
    ds_read_b64_tr_b16 v[156:157], v8 offset:16384
    v_mfma_f32_16x16x32_bf16 v[24:27], v[184:187], v[168:171], v[24:27]
    ds_read_b64_tr_b16 v[158:159], v8 offset:16896
    v_mfma_f32_16x16x32_bf16 v[28:31], v[188:191], v[168:171], v[28:31]
    ds_read_b64_tr_b16 v[160:161], v9 offset:16384
    v_mfma_f32_16x16x32_bf16 v[48:51], v[192:195], v[164:167], v[48:51]
    ds_read_b64_tr_b16 v[162:163], v9 offset:16896
    v_mfma_f32_16x16x32_bf16 v[52:55], v[196:199], v[164:167], v[52:55]
    v_mfma_f32_16x16x32_bf16 v[16:19], v[184:187], v[164:167], v[16:19]
    v_mfma_f32_16x16x32_bf16 v[20:23], v[188:191], v[164:167], v[20:23]
    v_mfma_f32_16x16x32_bf16 v[96:99], v[172:175], v[200:203], v[96:99]
    v_mfma_f32_16x16x32_bf16 v[100:103], v[172:175], v[204:207], v[100:103]
    v_mfma_f32_16x16x32_bf16 v[88:91], v[168:171], v[200:203], v[88:91]
    v_mfma_f32_16x16x32_bf16 v[92:95], v[168:171], v[204:207], v[92:95]
    v_mfma_f32_16x16x32_bf16 v[80:83], v[164:167], v[200:203], v[80:83]
    v_mfma_f32_16x16x32_bf16 v[84:87], v[164:167], v[204:207], v[84:87]
    s_waitcnt lgkmcnt(0)
    v_mfma_f32_16x16x32_bf16 v[112:115], v[148:151], v[136:139], v[112:115]
    ds_read_b128 v[164:167], v5 offset:36864
    v_mfma_f32_16x16x32_bf16 v[116:119], v[136:139], v[156:159], v[116:119]
    ds_read_b128 v[168:171], v5 offset:38912
    v_mfma_f32_16x16x32_bf16 v[72:75], v[148:151], v[132:135], v[72:75]
    ds_read_b128 v[172:175], v5 offset:40960
    v_mfma_f32_16x16x32_bf16 v[76:79], v[152:155], v[132:135], v[76:79]
    ds_read_b128 v[176:179], v5 offset:43008
    v_mfma_f32_16x16x32_bf16 v[104:107], v[132:135], v[156:159], v[104:107]
    ds_read_b128 v[180:183], v3 offset:36864
    v_mfma_f32_16x16x32_bf16 v[108:111], v[132:135], v[160:163], v[108:111]
    ds_read_b64_tr_b16 v[184:185], v6 offset:20480
    v_mfma_f32_16x16x32_bf16 v[40:43], v[140:143], v[132:135], v[40:43]
    ds_read_b64_tr_b16 v[186:187], v6 offset:20992
    v_mfma_f32_16x16x32_bf16 v[44:47], v[144:147], v[132:135], v[44:47]
    ds_read_b64_tr_b16 v[188:189], v7 offset:20480
    v_mfma_f32_16x16x32_bf16 v[64:67], v[148:151], v[128:131], v[64:67]
    ds_read_b64_tr_b16 v[190:191], v7 offset:20992
    v_mfma_f32_16x16x32_bf16 v[68:71], v[152:155], v[128:131], v[68:71]
    ds_read_b64_tr_b16 v[192:193], v6 offset:45056
    v_mfma_f32_16x16x32_bf16 v[32:35], v[140:143], v[128:131], v[32:35]
    ds_read_b64_tr_b16 v[194:195], v6 offset:45568
    v_mfma_f32_16x16x32_bf16 v[36:39], v[144:147], v[128:131], v[36:39]
    ds_read_b64_tr_b16 v[196:197], v7 offset:45056
    v_mfma_f32_16x16x32_bf16 v[56:59], v[148:151], v[124:127], v[56:59]
    ds_read_b64_tr_b16 v[198:199], v7 offset:45568
    v_mfma_f32_16x16x32_bf16 v[60:63], v[152:155], v[124:127], v[60:63]
    ds_read_b64_tr_b16 v[200:201], v8 offset:20480
    v_mfma_f32_16x16x32_bf16 v[24:27], v[140:143], v[124:127], v[24:27]
    ds_read_b64_tr_b16 v[202:203], v8 offset:20992
    v_mfma_f32_16x16x32_bf16 v[28:31], v[144:147], v[124:127], v[28:31]
    ds_read_b64_tr_b16 v[204:205], v9 offset:20480
    v_mfma_f32_16x16x32_bf16 v[48:51], v[148:151], v[120:123], v[48:51]
    ds_read_b64_tr_b16 v[206:207], v9 offset:20992
    v_mfma_f32_16x16x32_bf16 v[52:55], v[152:155], v[120:123], v[52:55]
    v_mfma_f32_16x16x32_bf16 v[16:19], v[140:143], v[120:123], v[16:19]
    v_mfma_f32_16x16x32_bf16 v[20:23], v[144:147], v[120:123], v[20:23]
    v_mfma_f32_16x16x32_bf16 v[96:99], v[128:131], v[156:159], v[96:99]
    v_mfma_f32_16x16x32_bf16 v[100:103], v[128:131], v[160:163], v[100:103]
    v_mfma_f32_16x16x32_bf16 v[88:91], v[124:127], v[156:159], v[88:91]
    v_mfma_f32_16x16x32_bf16 v[92:95], v[124:127], v[160:163], v[92:95]
    v_mfma_f32_16x16x32_bf16 v[80:83], v[120:123], v[156:159], v[80:83]
    v_mfma_f32_16x16x32_bf16 v[84:87], v[120:123], v[160:163], v[84:87]
    s_waitcnt lgkmcnt(0)
    s_barrier
    v_mfma_f32_16x16x32_bf16 v[112:115], v[192:195], v[180:183], v[112:115]
    ds_read_b128 v[120:123], v4 offset:0
    v_mfma_f32_16x16x32_bf16 v[116:119], v[180:183], v[200:203], v[116:119]
    ds_read_b128 v[124:127], v4 offset:2048
    v_mfma_f32_16x16x32_bf16 v[72:75], v[192:195], v[176:179], v[72:75]
    ds_read_b128 v[128:131], v4 offset:4096
    v_mfma_f32_16x16x32_bf16 v[76:79], v[196:199], v[176:179], v[76:79]
    ds_read_b128 v[132:135], v4 offset:6144
    v_mfma_f32_16x16x32_bf16 v[104:107], v[176:179], v[200:203], v[104:107]
    ds_read_b128 v[136:139], v2 offset:0
    v_mfma_f32_16x16x32_bf16 v[108:111], v[176:179], v[204:207], v[108:111]
    ds_read_b64_tr_b16 v[140:141], v6 offset:0
    v_mfma_f32_16x16x32_bf16 v[40:43], v[184:187], v[176:179], v[40:43]
    ds_read_b64_tr_b16 v[142:143], v6 offset:512
    v_mfma_f32_16x16x32_bf16 v[44:47], v[188:191], v[176:179], v[44:47]
    ds_read_b64_tr_b16 v[144:145], v7 offset:0
    v_mfma_f32_16x16x32_bf16 v[64:67], v[192:195], v[172:175], v[64:67]
    ds_read_b64_tr_b16 v[146:147], v7 offset:512
    v_mfma_f32_16x16x32_bf16 v[68:71], v[196:199], v[172:175], v[68:71]
    ds_read_b64_tr_b16 v[148:149], v6 offset:24576
    v_mfma_f32_16x16x32_bf16 v[32:35], v[184:187], v[172:175], v[32:35]
    ds_read_b64_tr_b16 v[150:151], v6 offset:25088
    v_mfma_f32_16x16x32_bf16 v[36:39], v[188:191], v[172:175], v[36:39]
    ds_read_b64_tr_b16 v[152:153], v7 offset:24576
    v_mfma_f32_16x16x32_bf16 v[56:59], v[192:195], v[168:171], v[56:59]
    ds_read_b64_tr_b16 v[154:155], v7 offset:25088
    v_mfma_f32_16x16x32_bf16 v[60:63], v[196:199], v[168:171], v[60:63]
    ds_read_b64_tr_b16 v[156:157], v8 offset:0
    v_mfma_f32_16x16x32_bf16 v[24:27], v[184:187], v[168:171], v[24:27]
    ds_read_b64_tr_b16 v[158:159], v8 offset:512
    v_mfma_f32_16x16x32_bf16 v[28:31], v[188:191], v[168:171], v[28:31]
    ds_read_b64_tr_b16 v[160:161], v9 offset:0
    v_mfma_f32_16x16x32_bf16 v[48:51], v[192:195], v[164:167], v[48:51]
    ds_read_b64_tr_b16 v[162:163], v9 offset:512
    v_mfma_f32_16x16x32_bf16 v[52:55], v[196:199], v[164:167], v[52:55]
    v_mfma_f32_16x16x32_bf16 v[16:19], v[184:187], v[164:167], v[16:19]
    v_mfma_f32_16x16x32_bf16 v[20:23], v[188:191], v[164:167], v[20:23]
    v_mfma_f32_16x16x32_bf16 v[96:99], v[172:175], v[200:203], v[96:99]
    v_mfma_f32_16x16x32_bf16 v[100:103], v[172:175], v[204:207], v[100:103]
    v_mfma_f32_16x16x32_bf16 v[88:91], v[168:171], v[200:203], v[88:91]
    v_mfma_f32_16x16x32_bf16 v[92:95], v[168:171], v[204:207], v[92:95]
    v_mfma_f32_16x16x32_bf16 v[80:83], v[164:167], v[200:203], v[80:83]
    v_mfma_f32_16x16x32_bf16 v[84:87], v[164:167], v[204:207], v[84:87]
    s_waitcnt lgkmcnt(0)
    v_mfma_f32_16x16x32_bf16 v[112:115], v[148:151], v[136:139], v[112:115]
    ds_read_b128 v[164:167], v5 offset:0
    v_mfma_f32_16x16x32_bf16 v[116:119], v[136:139], v[156:159], v[116:119]
    ds_read_b128 v[168:171], v5 offset:2048
    v_mfma_f32_16x16x32_bf16 v[72:75], v[148:151], v[132:135], v[72:75]
    ds_read_b128 v[172:175], v5 offset:4096
    v_mfma_f32_16x16x32_bf16 v[76:79], v[152:155], v[132:135], v[76:79]
    ds_read_b128 v[176:179], v5 offset:6144
    v_mfma_f32_16x16x32_bf16 v[104:107], v[132:135], v[156:159], v[104:107]
    ds_read_b128 v[180:183], v3 offset:0
    v_mfma_f32_16x16x32_bf16 v[108:111], v[132:135], v[160:163], v[108:111]
    ds_read_b64_tr_b16 v[184:185], v6 offset:4096
    v_mfma_f32_16x16x32_bf16 v[40:43], v[140:143], v[132:135], v[40:43]
    ds_read_b64_tr_b16 v[186:187], v6 offset:4608
    v_mfma_f32_16x16x32_bf16 v[44:47], v[144:147], v[132:135], v[44:47]
    ds_read_b64_tr_b16 v[188:189], v7 offset:4096
    v_mfma_f32_16x16x32_bf16 v[64:67], v[148:151], v[128:131], v[64:67]
    ds_read_b64_tr_b16 v[190:191], v7 offset:4608
    v_mfma_f32_16x16x32_bf16 v[68:71], v[152:155], v[128:131], v[68:71]
    ds_read_b64_tr_b16 v[192:193], v6 offset:28672
    v_mfma_f32_16x16x32_bf16 v[32:35], v[140:143], v[128:131], v[32:35]
    ds_read_b64_tr_b16 v[194:195], v6 offset:29184
    v_mfma_f32_16x16x32_bf16 v[36:39], v[144:147], v[128:131], v[36:39]
    ds_read_b64_tr_b16 v[196:197], v7 offset:28672
    v_mfma_f32_16x16x32_bf16 v[56:59], v[148:151], v[124:127], v[56:59]
    ds_read_b64_tr_b16 v[198:199], v7 offset:29184
    v_mfma_f32_16x16x32_bf16 v[60:63], v[152:155], v[124:127], v[60:63]
    ds_read_b64_tr_b16 v[200:201], v8 offset:4096
    v_mfma_f32_16x16x32_bf16 v[24:27], v[140:143], v[124:127], v[24:27]
    ds_read_b64_tr_b16 v[202:203], v8 offset:4608
    v_mfma_f32_16x16x32_bf16 v[28:31], v[144:147], v[124:127], v[28:31]
    ds_read_b64_tr_b16 v[204:205], v9 offset:4096
    v_mfma_f32_16x16x32_bf16 v[48:51], v[148:151], v[120:123], v[48:51]
    ds_read_b64_tr_b16 v[206:207], v9 offset:4608
    v_mfma_f32_16x16x32_bf16 v[52:55], v[152:155], v[120:123], v[52:55]
    v_mfma_f32_16x16x32_bf16 v[16:19], v[140:143], v[120:123], v[16:19]
    v_mfma_f32_16x16x32_bf16 v[20:23], v[144:147], v[120:123], v[20:23]
    v_mfma_f32_16x16x32_bf16 v[96:99], v[128:131], v[156:159], v[96:99]
    v_mfma_f32_16x16x32_bf16 v[100:103], v[128:131], v[160:163], v[100:103]
    v_mfma_f32_16x16x32_bf16 v[88:91], v[124:127], v[156:159], v[88:91]
    v_mfma_f32_16x16x32_bf16 v[92:95], v[124:127], v[160:163], v[92:95]
    v_mfma_f32_16x16x32_bf16 v[80:83], v[120:123], v[156:159], v[80:83]
    v_mfma_f32_16x16x32_bf16 v[84:87], v[120:123], v[160:163], v[84:87]
    s_waitcnt lgkmcnt(0)
    s_barrier
    v_mfma_f32_16x16x32_bf16 v[112:115], v[192:195], v[180:183], v[112:115]
    ds_read_b128 v[120:123], v4 offset:18432
    v_mfma_f32_16x16x32_bf16 v[116:119], v[180:183], v[200:203], v[116:119]
    ds_read_b128 v[124:127], v4 offset:20480
    v_mfma_f32_16x16x32_bf16 v[72:75], v[192:195], v[176:179], v[72:75]
    ds_read_b128 v[128:131], v4 offset:22528
    v_mfma_f32_16x16x32_bf16 v[76:79], v[196:199], v[176:179], v[76:79]
    ds_read_b128 v[132:135], v4 offset:24576
    v_mfma_f32_16x16x32_bf16 v[104:107], v[176:179], v[200:203], v[104:107]
    ds_read_b128 v[136:139], v2 offset:18432
    v_mfma_f32_16x16x32_bf16 v[108:111], v[176:179], v[204:207], v[108:111]
    ds_read_b64_tr_b16 v[140:141], v6 offset:8192
    v_mfma_f32_16x16x32_bf16 v[40:43], v[184:187], v[176:179], v[40:43]
    ds_read_b64_tr_b16 v[142:143], v6 offset:8704
    v_mfma_f32_16x16x32_bf16 v[44:47], v[188:191], v[176:179], v[44:47]
    ds_read_b64_tr_b16 v[144:145], v7 offset:8192
    v_mfma_f32_16x16x32_bf16 v[64:67], v[192:195], v[172:175], v[64:67]
    ds_read_b64_tr_b16 v[146:147], v7 offset:8704
    v_mfma_f32_16x16x32_bf16 v[68:71], v[196:199], v[172:175], v[68:71]
    ds_read_b64_tr_b16 v[148:149], v6 offset:32768
    v_mfma_f32_16x16x32_bf16 v[32:35], v[184:187], v[172:175], v[32:35]
    ds_read_b64_tr_b16 v[150:151], v6 offset:33280
    v_mfma_f32_16x16x32_bf16 v[36:39], v[188:191], v[172:175], v[36:39]
    ds_read_b64_tr_b16 v[152:153], v7 offset:32768
    v_mfma_f32_16x16x32_bf16 v[56:59], v[192:195], v[168:171], v[56:59]
    ds_read_b64_tr_b16 v[154:155], v7 offset:33280
    v_mfma_f32_16x16x32_bf16 v[60:63], v[196:199], v[168:171], v[60:63]
    ds_read_b64_tr_b16 v[156:157], v8 offset:8192
    v_mfma_f32_16x16x32_bf16 v[24:27], v[184:187], v[168:171], v[24:27]
    ds_read_b64_tr_b16 v[158:159], v8 offset:8704
    v_mfma_f32_16x16x32_bf16 v[28:31], v[188:191], v[168:171], v[28:31]
    ds_read_b64_tr_b16 v[160:161], v9 offset:8192
    v_mfma_f32_16x16x32_bf16 v[48:51], v[192:195], v[164:167], v[48:51]
    ds_read_b64_tr_b16 v[162:163], v9 offset:8704
    v_mfma_f32_16x16x32_bf16 v[52:55], v[196:199], v[164:167], v[52:55]
    v_mfma_f32_16x16x32_bf16 v[16:19], v[184:187], v[164:167], v[16:19]
    v_mfma_f32_16x16x32_bf16 v[20:23], v[188:191], v[164:167], v[20:23]
    v_mfma_f32_16x16x32_bf16 v[96:99], v[172:175], v[200:203], v[96:99]
    v_mfma_f32_16x16x32_bf16 v[100:103], v[172:175], v[204:207], v[100:103]
    v_mfma_f32_16x16x32_bf16 v[88:91], v[168:171], v[200:203], v[88:91]
    v_mfma_f32_16x16x32_bf16 v[92:95], v[168:171], v[204:207], v[92:95]
    v_mfma_f32_16x16x32_bf16 v[80:83], v[164:167], v[200:203], v[80:83]
    v_mfma_f32_16x16x32_bf16 v[84:87], v[164:167], v[204:207], v[84:87]
    s_waitcnt lgkmcnt(0)
    v_mfma_f32_16x16x32_bf16 v[112:115], v[148:151], v[136:139], v[112:115]
    ds_read_b128 v[164:167], v5 offset:18432
    v_mfma_f32_16x16x32_bf16 v[116:119], v[136:139], v[156:159], v[116:119]
    ds_read_b128 v[168:171], v5 offset:20480
    v_mfma_f32_16x16x32_bf16 v[72:75], v[148:151], v[132:135], v[72:75]
    ds_read_b128 v[172:175], v5 offset:22528
    v_mfma_f32_16x16x32_bf16 v[76:79], v[152:155], v[132:135], v[76:79]
    ds_read_b128 v[176:179], v5 offset:24576
    v_mfma_f32_16x16x32_bf16 v[104:107], v[132:135], v[156:159], v[104:107]
    ds_read_b128 v[180:183], v3 offset:18432
    v_mfma_f32_16x16x32_bf16 v[108:111], v[132:135], v[160:163], v[108:111]
    ds_read_b64_tr_b16 v[184:185], v6 offset:12288
    v_mfma_f32_16x16x32_bf16 v[40:43], v[140:143], v[132:135], v[40:43]
    ds_read_b64_tr_b16 v[186:187], v6 offset:12800
    v_mfma_f32_16x16x32_bf16 v[44:47], v[144:147], v[132:135], v[44:47]
    ds_read_b64_tr_b16 v[188:189], v7 offset:12288
    v_mfma_f32_16x16x32_bf16 v[64:67], v[148:151], v[128:131], v[64:67]
    ds_read_b64_tr_b16 v[190:191], v7 offset:12800
    v_mfma_f32_16x16x32_bf16 v[68:71], v[152:155], v[128:131], v[68:71]
    ds_read_b64_tr_b16 v[192:193], v6 offset:36864
    v_mfma_f32_16x16x32_bf16 v[32:35], v[140:143], v[128:131], v[32:35]
    ds_read_b64_tr_b16 v[194:195], v6 offset:37376
    v_mfma_f32_16x16x32_bf16 v[36:39], v[144:147], v[128:131], v[36:39]
    ds_read_b64_tr_b16 v[196:197], v7 offset:36864
    v_mfma_f32_16x16x32_bf16 v[56:59], v[148:151], v[124:127], v[56:59]
    ds_read_b64_tr_b16 v[198:199], v7 offset:37376
    v_mfma_f32_16x16x32_bf16 v[60:63], v[152:155], v[124:127], v[60:63]
    ds_read_b64_tr_b16 v[200:201], v8 offset:12288
    v_mfma_f32_16x16x32_bf16 v[24:27], v[140:143], v[124:127], v[24:27]
    ds_read_b64_tr_b16 v[202:203], v8 offset:12800
    v_mfma_f32_16x16x32_bf16 v[28:31], v[144:147], v[124:127], v[28:31]
    ds_read_b64_tr_b16 v[204:205], v9 offset:12288
    v_mfma_f32_16x16x32_bf16 v[48:51], v[148:151], v[120:123], v[48:51]
    ds_read_b64_tr_b16 v[206:207], v9 offset:12800
    v_mfma_f32_16x16x32_bf16 v[52:55], v[152:155], v[120:123], v[52:55]
    v_mfma_f32_16x16x32_bf16 v[16:19], v[140:143], v[120:123], v[16:19]
    v_mfma_f32_16x16x32_bf16 v[20:23], v[144:147], v[120:123], v[20:23]
    v_mfma_f32_16x16x32_bf16 v[96:99], v[128:131], v[156:159], v[96:99]
    v_mfma_f32_16x16x32_bf16 v[100:103], v[128:131], v[160:163], v[100:103]
    v_mfma_f32_16x16x32_bf16 v[88:91], v[124:127], v[156:159], v[88:91]
    v_mfma_f32_16x16x32_bf16 v[92:95], v[124:127], v[160:163], v[92:95]
    v_mfma_f32_16x16x32_bf16 v[80:83], v[120:123], v[156:159], v[80:83]
    v_mfma_f32_16x16x32_bf16 v[84:87], v[120:123], v[160:163], v[84:87]
    s_waitcnt lgkmcnt(0)
    s_barrier
    v_mfma_f32_16x16x32_bf16 v[112:115], v[192:195], v[180:183], v[112:115]
    ds_read_b128 v[120:123], v4 offset:36864
    v_mfma_f32_16x16x32_bf16 v[116:119], v[180:183], v[200:203], v[116:119]
    ds_read_b128 v[124:127], v4 offset:38912
    v_mfma_f32_16x16x32_bf16 v[72:75], v[192:195], v[176:179], v[72:75]
    ds_read_b128 v[128:131], v4 offset:40960
    v_mfma_f32_16x16x32_bf16 v[76:79], v[196:199], v[176:179], v[76:79]
    ds_read_b128 v[132:135], v4 offset:43008
    v_mfma_f32_16x16x32_bf16 v[104:107], v[176:179], v[200:203], v[104:107]
    ds_read_b128 v[136:139], v2 offset:36864
    v_mfma_f32_16x16x32_bf16 v[108:111], v[176:179], v[204:207], v[108:111]
    ds_read_b64_tr_b16 v[140:141], v6 offset:16384
    v_mfma_f32_16x16x32_bf16 v[40:43], v[184:187], v[176:179], v[40:43]
    ds_read_b64_tr_b16 v[142:143], v6 offset:16896
    v_mfma_f32_16x16x32_bf16 v[44:47], v[188:191], v[176:179], v[44:47]
    ds_read_b64_tr_b16 v[144:145], v7 offset:16384
    v_mfma_f32_16x16x32_bf16 v[64:67], v[192:195], v[172:175], v[64:67]
    ds_read_b64_tr_b16 v[146:147], v7 offset:16896
    v_mfma_f32_16x16x32_bf16 v[68:71], v[196:199], v[172:175], v[68:71]
    ds_read_b64_tr_b16 v[148:149], v6 offset:40960
    v_mfma_f32_16x16x32_bf16 v[32:35], v[184:187], v[172:175], v[32:35]
    ds_read_b64_tr_b16 v[150:151], v6 offset:41472
    v_mfma_f32_16x16x32_bf16 v[36:39], v[188:191], v[172:175], v[36:39]
    ds_read_b64_tr_b16 v[152:153], v7 offset:40960
    v_mfma_f32_16x16x32_bf16 v[56:59], v[192:195], v[168:171], v[56:59]
    ds_read_b64_tr_b16 v[154:155], v7 offset:41472
    v_mfma_f32_16x16x32_bf16 v[60:63], v[196:199], v[168:171], v[60:63]
    ds_read_b64_tr_b16 v[156:157], v8 offset:16384
    v_mfma_f32_16x16x32_bf16 v[24:27], v[184:187], v[168:171], v[24:27]
    ds_read_b64_tr_b16 v[158:159], v8 offset:16896
    v_mfma_f32_16x16x32_bf16 v[28:31], v[188:191], v[168:171], v[28:31]
    ds_read_b64_tr_b16 v[160:161], v9 offset:16384
    v_mfma_f32_16x16x32_bf16 v[48:51], v[192:195], v[164:167], v[48:51]
    ds_read_b64_tr_b16 v[162:163], v9 offset:16896
    v_mfma_f32_16x16x32_bf16 v[52:55], v[196:199], v[164:167], v[52:55]
    v_mfma_f32_16x16x32_bf16 v[16:19], v[184:187], v[164:167], v[16:19]
    v_mfma_f32_16x16x32_bf16 v[20:23], v[188:191], v[164:167], v[20:23]
    v_mfma_f32_16x16x32_bf16 v[96:99], v[172:175], v[200:203], v[96:99]
    v_mfma_f32_16x16x32_bf16 v[100:103], v[172:175], v[204:207], v[100:103]
    v_mfma_f32_16x16x32_bf16 v[88:91], v[168:171], v[200:203], v[88:91]
    v_mfma_f32_16x16x32_bf16 v[92:95], v[168:171], v[204:207], v[92:95]
    v_mfma_f32_16x16x32_bf16 v[80:83], v[164:167], v[200:203], v[80:83]
    v_mfma_f32_16x16x32_bf16 v[84:87], v[164:167], v[204:207], v[84:87]
    s_waitcnt lgkmcnt(0)
    v_mfma_f32_16x16x32_bf16 v[112:115], v[148:151], v[136:139], v[112:115]
    ds_read_b128 v[164:167], v5 offset:36864
    v_mfma_f32_16x16x32_bf16 v[116:119], v[136:139], v[156:159], v[116:119]
    ds_read_b128 v[168:171], v5 offset:38912
    v_mfma_f32_16x16x32_bf16 v[72:75], v[148:151], v[132:135], v[72:75]
    ds_read_b128 v[172:175], v5 offset:40960
    v_mfma_f32_16x16x32_bf16 v[76:79], v[152:155], v[132:135], v[76:79]
    ds_read_b128 v[176:179], v5 offset:43008
    v_mfma_f32_16x16x32_bf16 v[104:107], v[132:135], v[156:159], v[104:107]
    ds_read_b128 v[180:183], v3 offset:36864
    v_mfma_f32_16x16x32_bf16 v[108:111], v[132:135], v[160:163], v[108:111]
    ds_read_b64_tr_b16 v[184:185], v6 offset:20480
    v_mfma_f32_16x16x32_bf16 v[40:43], v[140:143], v[132:135], v[40:43]
    ds_read_b64_tr_b16 v[186:187], v6 offset:20992
    v_mfma_f32_16x16x32_bf16 v[44:47], v[144:147], v[132:135], v[44:47]
    ds_read_b64_tr_b16 v[188:189], v7 offset:20480
    v_mfma_f32_16x16x32_bf16 v[64:67], v[148:151], v[128:131], v[64:67]
    ds_read_b64_tr_b16 v[190:191], v7 offset:20992
    v_mfma_f32_16x16x32_bf16 v[68:71], v[152:155], v[128:131], v[68:71]
    ds_read_b64_tr_b16 v[192:193], v6 offset:45056
    v_mfma_f32_16x16x32_bf16 v[32:35], v[140:143], v[128:131], v[32:35]
    ds_read_b64_tr_b16 v[194:195], v6 offset:45568
    v_mfma_f32_16x16x32_bf16 v[36:39], v[144:147], v[128:131], v[36:39]
    ds_read_b64_tr_b16 v[196:197], v7 offset:45056
    v_mfma_f32_16x16x32_bf16 v[56:59], v[148:151], v[124:127], v[56:59]
    ds_read_b64_tr_b16 v[198:199], v7 offset:45568
    v_mfma_f32_16x16x32_bf16 v[60:63], v[152:155], v[124:127], v[60:63]
    ds_read_b64_tr_b16 v[200:201], v8 offset:20480
    v_mfma_f32_16x16x32_bf16 v[24:27], v[140:143], v[124:127], v[24:27]
    ds_read_b64_tr_b16 v[202:203], v8 offset:20992
    v_mfma_f32_16x16x32_bf16 v[28:31], v[144:147], v[124:127], v[28:31]
    ds_read_b64_tr_b16 v[204:205], v9 offset:20480
    v_mfma_f32_16x16x32_bf16 v[48:51], v[148:151], v[120:123], v[48:51]
    ds_read_b64_tr_b16 v[206:207], v9 offset:20992
    v_mfma_f32_16x16x32_bf16 v[52:55], v[152:155], v[120:123], v[52:55]
    v_mfma_f32_16x16x32_bf16 v[16:19], v[140:143], v[120:123], v[16:19]
    v_mfma_f32_16x16x32_bf16 v[20:23], v[144:147], v[120:123], v[20:23]
    v_mfma_f32_16x16x32_bf16 v[96:99], v[128:131], v[156:159], v[96:99]
    v_mfma_f32_16x16x32_bf16 v[100:103], v[128:131], v[160:163], v[100:103]
    v_mfma_f32_16x16x32_bf16 v[88:91], v[124:127], v[156:159], v[88:91]
    v_mfma_f32_16x16x32_bf16 v[92:95], v[124:127], v[160:163], v[92:95]
    v_mfma_f32_16x16x32_bf16 v[80:83], v[120:123], v[156:159], v[80:83]
    v_mfma_f32_16x16x32_bf16 v[84:87], v[120:123], v[160:163], v[84:87]
    s_waitcnt lgkmcnt(0)
    s_barrier
    v_mfma_f32_16x16x32_bf16 v[112:115], v[192:195], v[180:183], v[112:115]
    ds_read_b128 v[120:123], v4 offset:0
    v_mfma_f32_16x16x32_bf16 v[116:119], v[180:183], v[200:203], v[116:119]
    ds_read_b128 v[124:127], v4 offset:2048
    v_mfma_f32_16x16x32_bf16 v[72:75], v[192:195], v[176:179], v[72:75]
    ds_read_b128 v[128:131], v4 offset:4096
    v_mfma_f32_16x16x32_bf16 v[76:79], v[196:199], v[176:179], v[76:79]
    ds_read_b128 v[132:135], v4 offset:6144
    v_mfma_f32_16x16x32_bf16 v[104:107], v[176:179], v[200:203], v[104:107]
    ds_read_b128 v[136:139], v2 offset:0
    v_mfma_f32_16x16x32_bf16 v[108:111], v[176:179], v[204:207], v[108:111]
    ds_read_b64_tr_b16 v[140:141], v6 offset:0
    v_mfma_f32_16x16x32_bf16 v[40:43], v[184:187], v[176:179], v[40:43]
    ds_read_b64_tr_b16 v[142:143], v6 offset:512
    v_mfma_f32_16x16x32_bf16 v[44:47], v[188:191], v[176:179], v[44:47]
    ds_read_b64_tr_b16 v[144:145], v7 offset:0
    v_mfma_f32_16x16x32_bf16 v[64:67], v[192:195], v[172:175], v[64:67]
    ds_read_b64_tr_b16 v[146:147], v7 offset:512
    v_mfma_f32_16x16x32_bf16 v[68:71], v[196:199], v[172:175], v[68:71]
    ds_read_b64_tr_b16 v[148:149], v6 offset:24576
    v_mfma_f32_16x16x32_bf16 v[32:35], v[184:187], v[172:175], v[32:35]
    ds_read_b64_tr_b16 v[150:151], v6 offset:25088
    v_mfma_f32_16x16x32_bf16 v[36:39], v[188:191], v[172:175], v[36:39]
    ds_read_b64_tr_b16 v[152:153], v7 offset:24576
    v_mfma_f32_16x16x32_bf16 v[56:59], v[192:195], v[168:171], v[56:59]
    ds_read_b64_tr_b16 v[154:155], v7 offset:25088
    v_mfma_f32_16x16x32_bf16 v[60:63], v[196:199], v[168:171], v[60:63]
    ds_read_b64_tr_b16 v[156:157], v8 offset:0
    v_mfma_f32_16x16x32_bf16 v[24:27], v[184:187], v[168:171], v[24:27]
    ds_read_b64_tr_b16 v[158:159], v8 offset:512
    v_mfma_f32_16x16x32_bf16 v[28:31], v[188:191], v[168:171], v[28:31]
    ds_read_b64_tr_b16 v[160:161], v9 offset:0
    v_mfma_f32_16x16x32_bf16 v[48:51], v[192:195], v[164:167], v[48:51]
    ds_read_b64_tr_b16 v[162:163], v9 offset:512
    v_mfma_f32_16x16x32_bf16 v[52:55], v[196:199], v[164:167], v[52:55]
    v_mfma_f32_16x16x32_bf16 v[16:19], v[184:187], v[164:167], v[16:19]
    v_mfma_f32_16x16x32_bf16 v[20:23], v[188:191], v[164:167], v[20:23]
    v_mfma_f32_16x16x32_bf16 v[96:99], v[172:175], v[200:203], v[96:99]
    v_mfma_f32_16x16x32_bf16 v[100:103], v[172:175], v[204:207], v[100:103]
    v_mfma_f32_16x16x32_bf16 v[88:91], v[168:171], v[200:203], v[88:91]
    v_mfma_f32_16x16x32_bf16 v[92:95], v[168:171], v[204:207], v[92:95]
    v_mfma_f32_16x16x32_bf16 v[80:83], v[164:167], v[200:203], v[80:83]
    v_mfma_f32_16x16x32_bf16 v[84:87], v[164:167], v[204:207], v[84:87]
    s_waitcnt lgkmcnt(0)
    v_mfma_f32_16x16x32_bf16 v[112:115], v[148:151], v[136:139], v[112:115]
    ds_read_b128 v[164:167], v5 offset:0
    v_mfma_f32_16x16x32_bf16 v[116:119], v[136:139], v[156:159], v[116:119]
    ds_read_b128 v[168:171], v5 offset:2048
    v_mfma_f32_16x16x32_bf16 v[72:75], v[148:151], v[132:135], v[72:75]
    ds_read_b128 v[172:175], v5 offset:4096
    v_mfma_f32_16x16x32_bf16 v[76:79], v[152:155], v[132:135], v[76:79]
    ds_read_b128 v[176:179], v5 offset:6144
    v_mfma_f32_16x16x32_bf16 v[104:107], v[132:135], v[156:159], v[104:107]
    ds_read_b128 v[180:183], v3 offset:0
    v_mfma_f32_16x16x32_bf16 v[108:111], v[132:135], v[160:163], v[108:111]
    ds_read_b64_tr_b16 v[184:185], v6 offset:4096
    v_mfma_f32_16x16x32_bf16 v[40:43], v[140:143], v[132:135], v[40:43]
    ds_read_b64_tr_b16 v[186:187], v6 offset:4608
    v_mfma_f32_16x16x32_bf16 v[44:47], v[144:147], v[132:135], v[44:47]
    ds_read_b64_tr_b16 v[188:189], v7 offset:4096
    v_mfma_f32_16x16x32_bf16 v[64:67], v[148:151], v[128:131], v[64:67]
    ds_read_b64_tr_b16 v[190:191], v7 offset:4608
    v_mfma_f32_16x16x32_bf16 v[68:71], v[152:155], v[128:131], v[68:71]
    ds_read_b64_tr_b16 v[192:193], v6 offset:28672
    v_mfma_f32_16x16x32_bf16 v[32:35], v[140:143], v[128:131], v[32:35]
    ds_read_b64_tr_b16 v[194:195], v6 offset:29184
    v_mfma_f32_16x16x32_bf16 v[36:39], v[144:147], v[128:131], v[36:39]
    ds_read_b64_tr_b16 v[196:197], v7 offset:28672
    v_mfma_f32_16x16x32_bf16 v[56:59], v[148:151], v[124:127], v[56:59]
    ds_read_b64_tr_b16 v[198:199], v7 offset:29184
    v_mfma_f32_16x16x32_bf16 v[60:63], v[152:155], v[124:127], v[60:63]
    ds_read_b64_tr_b16 v[200:201], v8 offset:4096
    v_mfma_f32_16x16x32_bf16 v[24:27], v[140:143], v[124:127], v[24:27]
    ds_read_b64_tr_b16 v[202:203], v8 offset:4608
    v_mfma_f32_16x16x32_bf16 v[28:31], v[144:147], v[124:127], v[28:31]
    ds_read_b64_tr_b16 v[204:205], v9 offset:4096
    v_mfma_f32_16x16x32_bf16 v[48:51], v[148:151], v[120:123], v[48:51]
    ds_read_b64_tr_b16 v[206:207], v9 offset:4608
    v_mfma_f32_16x16x32_bf16 v[52:55], v[152:155], v[120:123], v[52:55]
    v_mfma_f32_16x16x32_bf16 v[16:19], v[140:143], v[120:123], v[16:19]
    v_mfma_f32_16x16x32_bf16 v[20:23], v[144:147], v[120:123], v[20:23]
    v_mfma_f32_16x16x32_bf16 v[96:99], v[128:131], v[156:159], v[96:99]
    v_mfma_f32_16x16x32_bf16 v[100:103], v[128:131], v[160:163], v[100:103]
    v_mfma_f32_16x16x32_bf16 v[88:91], v[124:127], v[156:159], v[88:91]
    v_mfma_f32_16x16x32_bf16 v[92:95], v[124:127], v[160:163], v[92:95]
    v_mfma_f32_16x16x32_bf16 v[80:83], v[120:123], v[156:159], v[80:83]
    v_mfma_f32_16x16x32_bf16 v[84:87], v[120:123], v[160:163], v[84:87]
    s_waitcnt lgkmcnt(0)
    s_barrier
    v_mfma_f32_16x16x32_bf16 v[112:115], v[192:195], v[180:183], v[112:115]
    ds_read_b128 v[120:123], v4 offset:18432
    v_mfma_f32_16x16x32_bf16 v[116:119], v[180:183], v[200:203], v[116:119]
    ds_read_b128 v[124:127], v4 offset:20480
    v_mfma_f32_16x16x32_bf16 v[72:75], v[192:195], v[176:179], v[72:75]
    ds_read_b128 v[128:131], v4 offset:22528
    v_mfma_f32_16x16x32_bf16 v[76:79], v[196:199], v[176:179], v[76:79]
    ds_read_b128 v[132:135], v4 offset:24576
    v_mfma_f32_16x16x32_bf16 v[104:107], v[176:179], v[200:203], v[104:107]
    ds_read_b128 v[136:139], v2 offset:18432
    v_mfma_f32_16x16x32_bf16 v[108:111], v[176:179], v[204:207], v[108:111]
    ds_read_b64_tr_b16 v[140:141], v6 offset:8192
    v_mfma_f32_16x16x32_bf16 v[40:43], v[184:187], v[176:179], v[40:43]
    ds_read_b64_tr_b16 v[142:143], v6 offset:8704
    v_mfma_f32_16x16x32_bf16 v[44:47], v[188:191], v[176:179], v[44:47]
    ds_read_b64_tr_b16 v[144:145], v7 offset:8192
    v_mfma_f32_16x16x32_bf16 v[64:67], v[192:195], v[172:175], v[64:67]
    ds_read_b64_tr_b16 v[146:147], v7 offset:8704
    v_mfma_f32_16x16x32_bf16 v[68:71], v[196:199], v[172:175], v[68:71]
    ds_read_b64_tr_b16 v[148:149], v6 offset:32768
    v_mfma_f32_16x16x32_bf16 v[32:35], v[184:187], v[172:175], v[32:35]
    ds_read_b64_tr_b16 v[150:151], v6 offset:33280
    v_mfma_f32_16x16x32_bf16 v[36:39], v[188:191], v[172:175], v[36:39]
    ds_read_b64_tr_b16 v[152:153], v7 offset:32768
    v_mfma_f32_16x16x32_bf16 v[56:59], v[192:195], v[168:171], v[56:59]
    ds_read_b64_tr_b16 v[154:155], v7 offset:33280
    v_mfma_f32_16x16x32_bf16 v[60:63], v[196:199], v[168:171], v[60:63]
    ds_read_b64_tr_b16 v[156:157], v8 offset:8192
    v_mfma_f32_16x16x32_bf16 v[24:27], v[184:187], v[168:171], v[24:27]
    ds_read_b64_tr_b16 v[158:159], v8 offset:8704
    v_mfma_f32_16x16x32_bf16 v[28:31], v[188:191], v[168:171], v[28:31]
    ds_read_b64_tr_b16 v[160:161], v9 offset:8192
    v_mfma_f32_16x16x32_bf16 v[48:51], v[192:195], v[164:167], v[48:51]
    ds_read_b64_tr_b16 v[162:163], v9 offset:8704
    v_mfma_f32_16x16x32_bf16 v[52:55], v[196:199], v[164:167], v[52:55]
    v_mfma_f32_16x16x32_bf16 v[16:19], v[184:187], v[164:167], v[16:19]
    v_mfma_f32_16x16x32_bf16 v[20:23], v[188:191], v[164:167], v[20:23]
    v_mfma_f32_16x16x32_bf16 v[96:99], v[172:175], v[200:203], v[96:99]
    v_mfma_f32_16x16x32_bf16 v[100:103], v[172:175], v[204:207], v[100:103]
    v_mfma_f32_16x16x32_bf16 v[88:91], v[168:171], v[200:203], v[88:91]
    v_mfma_f32_16x16x32_bf16 v[92:95], v[168:171], v[204:207], v[92:95]
    v_mfma_f32_16x16x32_bf16 v[80:83], v[164:167], v[200:203], v[80:83]
    v_mfma_f32_16x16x32_bf16 v[84:87], v[164:167], v[204:207], v[84:87]
    s_waitcnt lgkmcnt(0)
    v_mfma_f32_16x16x32_bf16 v[112:115], v[148:151], v[136:139], v[112:115]
    ds_read_b128 v[164:167], v5 offset:18432
    v_mfma_f32_16x16x32_bf16 v[116:119], v[136:139], v[156:159], v[116:119]
    ds_read_b128 v[168:171], v5 offset:20480
    v_mfma_f32_16x16x32_bf16 v[72:75], v[148:151], v[132:135], v[72:75]
    ds_read_b128 v[172:175], v5 offset:22528
    v_mfma_f32_16x16x32_bf16 v[76:79], v[152:155], v[132:135], v[76:79]
    ds_read_b128 v[176:179], v5 offset:24576
    v_mfma_f32_16x16x32_bf16 v[104:107], v[132:135], v[156:159], v[104:107]
    ds_read_b128 v[180:183], v3 offset:18432
    v_mfma_f32_16x16x32_bf16 v[108:111], v[132:135], v[160:163], v[108:111]
    ds_read_b64_tr_b16 v[184:185], v6 offset:12288
    v_mfma_f32_16x16x32_bf16 v[40:43], v[140:143], v[132:135], v[40:43]
    ds_read_b64_tr_b16 v[186:187], v6 offset:12800
    v_mfma_f32_16x16x32_bf16 v[44:47], v[144:147], v[132:135], v[44:47]
    ds_read_b64_tr_b16 v[188:189], v7 offset:12288
    v_mfma_f32_16x16x32_bf16 v[64:67], v[148:151], v[128:131], v[64:67]
    ds_read_b64_tr_b16 v[190:191], v7 offset:12800
    v_mfma_f32_16x16x32_bf16 v[68:71], v[152:155], v[128:131], v[68:71]
    ds_read_b64_tr_b16 v[192:193], v6 offset:36864
    v_mfma_f32_16x16x32_bf16 v[32:35], v[140:143], v[128:131], v[32:35]
    ds_read_b64_tr_b16 v[194:195], v6 offset:37376
    v_mfma_f32_16x16x32_bf16 v[36:39], v[144:147], v[128:131], v[36:39]
    ds_read_b64_tr_b16 v[196:197], v7 offset:36864
    v_mfma_f32_16x16x32_bf16 v[56:59], v[148:151], v[124:127], v[56:59]
    ds_read_b64_tr_b16 v[198:199], v7 offset:37376
    v_mfma_f32_16x16x32_bf16 v[60:63], v[152:155], v[124:127], v[60:63]
    ds_read_b64_tr_b16 v[200:201], v8 offset:12288
    v_mfma_f32_16x16x32_bf16 v[24:27], v[140:143], v[124:127], v[24:27]
    ds_read_b64_tr_b16 v[202:203], v8 offset:12800
    v_mfma_f32_16x16x32_bf16 v[28:31], v[144:147], v[124:127], v[28:31]
    ds_read_b64_tr_b16 v[204:205], v9 offset:12288
    v_mfma_f32_16x16x32_bf16 v[48:51], v[148:151], v[120:123], v[48:51]
    ds_read_b64_tr_b16 v[206:207], v9 offset:12800
    v_mfma_f32_16x16x32_bf16 v[52:55], v[152:155], v[120:123], v[52:55]
    v_mfma_f32_16x16x32_bf16 v[16:19], v[140:143], v[120:123], v[16:19]
    v_mfma_f32_16x16x32_bf16 v[20:23], v[144:147], v[120:123], v[20:23]
    v_mfma_f32_16x16x32_bf16 v[96:99], v[128:131], v[156:159], v[96:99]
    v_mfma_f32_16x16x32_bf16 v[100:103], v[128:131], v[160:163], v[100:103]
    v_mfma_f32_16x16x32_bf16 v[88:91], v[124:127], v[156:159], v[88:91]
    v_mfma_f32_16x16x32_bf16 v[92:95], v[124:127], v[160:163], v[92:95]
    v_mfma_f32_16x16x32_bf16 v[80:83], v[120:123], v[156:159], v[80:83]
    v_mfma_f32_16x16x32_bf16 v[84:87], v[120:123], v[160:163], v[84:87]
    s_waitcnt lgkmcnt(0)
    s_barrier
    v_mfma_f32_16x16x32_bf16 v[112:115], v[192:195], v[180:183], v[112:115]
    ds_read_b128 v[120:123], v4 offset:36864
    v_mfma_f32_16x16x32_bf16 v[116:119], v[180:183], v[200:203], v[116:119]
    ds_read_b128 v[124:127], v4 offset:38912
    v_mfma_f32_16x16x32_bf16 v[72:75], v[192:195], v[176:179], v[72:75]
    ds_read_b128 v[128:131], v4 offset:40960
    v_mfma_f32_16x16x32_bf16 v[76:79], v[196:199], v[176:179], v[76:79]
    ds_read_b128 v[132:135], v4 offset:43008
    v_mfma_f32_16x16x32_bf16 v[104:107], v[176:179], v[200:203], v[104:107]
    ds_read_b128 v[136:139], v2 offset:36864
    v_mfma_f32_16x16x32_bf16 v[108:111], v[176:179], v[204:207], v[108:111]
    ds_read_b64_tr_b16 v[140:141], v6 offset:16384
    v_mfma_f32_16x16x32_bf16 v[40:43], v[184:187], v[176:179], v[40:43]
    ds_read_b64_tr_b16 v[142:143], v6 offset:16896
    v_mfma_f32_16x16x32_bf16 v[44:47], v[188:191], v[176:179], v[44:47]
    ds_read_b64_tr_b16 v[144:145], v7 offset:16384
    v_mfma_f32_16x16x32_bf16 v[64:67], v[192:195], v[172:175], v[64:67]
    ds_read_b64_tr_b16 v[146:147], v7 offset:16896
    v_mfma_f32_16x16x32_bf16 v[68:71], v[196:199], v[172:175], v[68:71]
    ds_read_b64_tr_b16 v[148:149], v6 offset:40960
    v_mfma_f32_16x16x32_bf16 v[32:35], v[184:187], v[172:175], v[32:35]
    ds_read_b64_tr_b16 v[150:151], v6 offset:41472
    v_mfma_f32_16x16x32_bf16 v[36:39], v[188:191], v[172:175], v[36:39]
    ds_read_b64_tr_b16 v[152:153], v7 offset:40960
    v_mfma_f32_16x16x32_bf16 v[56:59], v[192:195], v[168:171], v[56:59]
    ds_read_b64_tr_b16 v[154:155], v7 offset:41472
    v_mfma_f32_16x16x32_bf16 v[60:63], v[196:199], v[168:171], v[60:63]
    ds_read_b64_tr_b16 v[156:157], v8 offset:16384
    v_mfma_f32_16x16x32_bf16 v[24:27], v[184:187], v[168:171], v[24:27]
    ds_read_b64_tr_b16 v[158:159], v8 offset:16896
    v_mfma_f32_16x16x32_bf16 v[28:31], v[188:191], v[168:171], v[28:31]
    ds_read_b64_tr_b16 v[160:161], v9 offset:16384
    v_mfma_f32_16x16x32_bf16 v[48:51], v[192:195], v[164:167], v[48:51]
    ds_read_b64_tr_b16 v[162:163], v9 offset:16896
    v_mfma_f32_16x16x32_bf16 v[52:55], v[196:199], v[164:167], v[52:55]
    v_mfma_f32_16x16x32_bf16 v[16:19], v[184:187], v[164:167], v[16:19]
    v_mfma_f32_16x16x32_bf16 v[20:23], v[188:191], v[164:167], v[20:23]
    v_mfma_f32_16x16x32_bf16 v[96:99], v[172:175], v[200:203], v[96:99]
    v_mfma_f32_16x16x32_bf16 v[100:103], v[172:175], v[204:207], v[100:103]
    v_mfma_f32_16x16x32_bf16 v[88:91], v[168:171], v[200:203], v[88:91]
    v_mfma_f32_16x16x32_bf16 v[92:95], v[168:171], v[204:207], v[92:95]
    v_mfma_f32_16x16x32_bf16 v[80:83], v[164:167], v[200:203], v[80:83]
    v_mfma_f32_16x16x32_bf16 v[84:87], v[164:167], v[204:207], v[84:87]
    s_waitcnt lgkmcnt(0)
    v_mfma_f32_16x16x32_bf16 v[112:115], v[148:151], v[136:139], v[112:115]
    ds_read_b128 v[164:167], v5 offset:36864
    v_mfma_f32_16x16x32_bf16 v[116:119], v[136:139], v[156:159], v[116:119]
    ds_read_b128 v[168:171], v5 offset:38912
    v_mfma_f32_16x16x32_bf16 v[72:75], v[148:151], v[132:135], v[72:75]
    ds_read_b128 v[172:175], v5 offset:40960
    v_mfma_f32_16x16x32_bf16 v[76:79], v[152:155], v[132:135], v[76:79]
    ds_read_b128 v[176:179], v5 offset:43008
    v_mfma_f32_16x16x32_bf16 v[104:107], v[132:135], v[156:159], v[104:107]
    ds_read_b128 v[180:183], v3 offset:36864
    v_mfma_f32_16x16x32_bf16 v[108:111], v[132:135], v[160:163], v[108:111]
    ds_read_b64_tr_b16 v[184:185], v6 offset:20480
    v_mfma_f32_16x16x32_bf16 v[40:43], v[140:143], v[132:135], v[40:43]
    ds_read_b64_tr_b16 v[186:187], v6 offset:20992
    v_mfma_f32_16x16x32_bf16 v[44:47], v[144:147], v[132:135], v[44:47]
    ds_read_b64_tr_b16 v[188:189], v7 offset:20480
    v_mfma_f32_16x16x32_bf16 v[64:67], v[148:151], v[128:131], v[64:67]
    ds_read_b64_tr_b16 v[190:191], v7 offset:20992
    v_mfma_f32_16x16x32_bf16 v[68:71], v[152:155], v[128:131], v[68:71]
    ds_read_b64_tr_b16 v[192:193], v6 offset:45056
    v_mfma_f32_16x16x32_bf16 v[32:35], v[140:143], v[128:131], v[32:35]
    ds_read_b64_tr_b16 v[194:195], v6 offset:45568
    v_mfma_f32_16x16x32_bf16 v[36:39], v[144:147], v[128:131], v[36:39]
    ds_read_b64_tr_b16 v[196:197], v7 offset:45056
    v_mfma_f32_16x16x32_bf16 v[56:59], v[148:151], v[124:127], v[56:59]
    ds_read_b64_tr_b16 v[198:199], v7 offset:45568
    v_mfma_f32_16x16x32_bf16 v[60:63], v[152:155], v[124:127], v[60:63]
    ds_read_b64_tr_b16 v[200:201], v8 offset:20480
    v_mfma_f32_16x16x32_bf16 v[24:27], v[140:143], v[124:127], v[24:27]
    ds_read_b64_tr_b16 v[202:203], v8 offset:20992
    v_mfma_f32_16x16x32_bf16 v[28:31], v[144:147], v[124:127], v[28:31]
    ds_read_b64_tr_b16 v[204:205], v9 offset:20480
    v_mfma_f32_16x16x32_bf16 v[48:51], v[148:151], v[120:123], v[48:51]
    ds_read_b64_tr_b16 v[206:207], v9 offset:20992
    v_mfma_f32_16x16x32_bf16 v[52:55], v[152:155], v[120:123], v[52:55]
    v_mfma_f32_16x16x32_bf16 v[16:19], v[140:143], v[120:123], v[16:19]
    v_mfma_f32_16x16x32_bf16 v[20:23], v[144:147], v[120:123], v[20:23]
    v_mfma_f32_16x16x32_bf16 v[96:99], v[128:131], v[156:159], v[96:99]
    v_mfma_f32_16x16x32_bf16 v[100:103], v[128:131], v[160:163], v[100:103]
    v_mfma_f32_16x16x32_bf16 v[88:91], v[124:127], v[156:159], v[88:91]
    v_mfma_f32_16x16x32_bf16 v[92:95], v[124:127], v[160:163], v[92:95]
    v_mfma_f32_16x16x32_bf16 v[80:83], v[120:123], v[156:159], v[80:83]
    v_mfma_f32_16x16x32_bf16 v[84:87], v[120:123], v[160:163], v[84:87]
    s_waitcnt lgkmcnt(0)
    s_barrier
    v_mfma_f32_16x16x32_bf16 v[112:115], v[192:195], v[180:183], v[112:115]
    ds_read_b128 v[120:123], v4 offset:0
    v_mfma_f32_16x16x32_bf16 v[116:119], v[180:183], v[200:203], v[116:119]
    ds_read_b128 v[124:127], v4 offset:2048
    v_mfma_f32_16x16x32_bf16 v[72:75], v[192:195], v[176:179], v[72:75]
    ds_read_b128 v[128:131], v4 offset:4096
    v_mfma_f32_16x16x32_bf16 v[76:79], v[196:199], v[176:179], v[76:79]
    ds_read_b128 v[132:135], v4 offset:6144
    v_mfma_f32_16x16x32_bf16 v[104:107], v[176:179], v[200:203], v[104:107]
    ds_read_b128 v[136:139], v2 offset:0
    v_mfma_f32_16x16x32_bf16 v[108:111], v[176:179], v[204:207], v[108:111]
    ds_read_b64_tr_b16 v[140:141], v6 offset:0
    v_mfma_f32_16x16x32_bf16 v[40:43], v[184:187], v[176:179], v[40:43]
    ds_read_b64_tr_b16 v[142:143], v6 offset:512
    v_mfma_f32_16x16x32_bf16 v[44:47], v[188:191], v[176:179], v[44:47]
    ds_read_b64_tr_b16 v[144:145], v7 offset:0
    v_mfma_f32_16x16x32_bf16 v[64:67], v[192:195], v[172:175], v[64:67]
    ds_read_b64_tr_b16 v[146:147], v7 offset:512
    v_mfma_f32_16x16x32_bf16 v[68:71], v[196:199], v[172:175], v[68:71]
    ds_read_b64_tr_b16 v[148:149], v6 offset:24576
    v_mfma_f32_16x16x32_bf16 v[32:35], v[184:187], v[172:175], v[32:35]
    ds_read_b64_tr_b16 v[150:151], v6 offset:25088
    v_mfma_f32_16x16x32_bf16 v[36:39], v[188:191], v[172:175], v[36:39]
    ds_read_b64_tr_b16 v[152:153], v7 offset:24576
    v_mfma_f32_16x16x32_bf16 v[56:59], v[192:195], v[168:171], v[56:59]
    ds_read_b64_tr_b16 v[154:155], v7 offset:25088
    v_mfma_f32_16x16x32_bf16 v[60:63], v[196:199], v[168:171], v[60:63]
    ds_read_b64_tr_b16 v[156:157], v8 offset:0
    v_mfma_f32_16x16x32_bf16 v[24:27], v[184:187], v[168:171], v[24:27]
    ds_read_b64_tr_b16 v[158:159], v8 offset:512
    v_mfma_f32_16x16x32_bf16 v[28:31], v[188:191], v[168:171], v[28:31]
    ds_read_b64_tr_b16 v[160:161], v9 offset:0
    v_mfma_f32_16x16x32_bf16 v[48:51], v[192:195], v[164:167], v[48:51]
    ds_read_b64_tr_b16 v[162:163], v9 offset:512
    v_mfma_f32_16x16x32_bf16 v[52:55], v[196:199], v[164:167], v[52:55]
    v_mfma_f32_16x16x32_bf16 v[16:19], v[184:187], v[164:167], v[16:19]
    v_mfma_f32_16x16x32_bf16 v[20:23], v[188:191], v[164:167], v[20:23]
    v_mfma_f32_16x16x32_bf16 v[96:99], v[172:175], v[200:203], v[96:99]
    v_mfma_f32_16x16x32_bf16 v[100:103], v[172:175], v[204:207], v[100:103]
    v_mfma_f32_16x16x32_bf16 v[88:91], v[168:171], v[200:203], v[88:91]
    v_mfma_f32_16x16x32_bf16 v[92:95], v[168:171], v[204:207], v[92:95]
    v_mfma_f32_16x16x32_bf16 v[80:83], v[164:167], v[200:203], v[80:83]
    v_mfma_f32_16x16x32_bf16 v[84:87], v[164:167], v[204:207], v[84:87]
    s_waitcnt lgkmcnt(0)
    v_mfma_f32_16x16x32_bf16 v[112:115], v[148:151], v[136:139], v[112:115]
    ds_read_b128 v[164:167], v5 offset:0
    v_mfma_f32_16x16x32_bf16 v[116:119], v[136:139], v[156:159], v[116:119]
    ds_read_b128 v[168:171], v5 offset:2048
    v_mfma_f32_16x16x32_bf16 v[72:75], v[148:151], v[132:135], v[72:75]
    ds_read_b128 v[172:175], v5 offset:4096
    v_mfma_f32_16x16x32_bf16 v[76:79], v[152:155], v[132:135], v[76:79]
    ds_read_b128 v[176:179], v5 offset:6144
    v_mfma_f32_16x16x32_bf16 v[104:107], v[132:135], v[156:159], v[104:107]
    ds_read_b128 v[180:183], v3 offset:0
    v_mfma_f32_16x16x32_bf16 v[108:111], v[132:135], v[160:163], v[108:111]
    ds_read_b64_tr_b16 v[184:185], v6 offset:4096
    v_mfma_f32_16x16x32_bf16 v[40:43], v[140:143], v[132:135], v[40:43]
    ds_read_b64_tr_b16 v[186:187], v6 offset:4608
    v_mfma_f32_16x16x32_bf16 v[44:47], v[144:147], v[132:135], v[44:47]
    ds_read_b64_tr_b16 v[188:189], v7 offset:4096
    v_mfma_f32_16x16x32_bf16 v[64:67], v[148:151], v[128:131], v[64:67]
    ds_read_b64_tr_b16 v[190:191], v7 offset:4608
    v_mfma_f32_16x16x32_bf16 v[68:71], v[152:155], v[128:131], v[68:71]
    ds_read_b64_tr_b16 v[192:193], v6 offset:28672
    v_mfma_f32_16x16x32_bf16 v[32:35], v[140:143], v[128:131], v[32:35]
    ds_read_b64_tr_b16 v[194:195], v6 offset:29184
    v_mfma_f32_16x16x32_bf16 v[36:39], v[144:147], v[128:131], v[36:39]
    ds_read_b64_tr_b16 v[196:197], v7 offset:28672
    v_mfma_f32_16x16x32_bf16 v[56:59], v[148:151], v[124:127], v[56:59]
    ds_read_b64_tr_b16 v[198:199], v7 offset:29184
    v_mfma_f32_16x16x32_bf16 v[60:63], v[152:155], v[124:127], v[60:63]
    ds_read_b64_tr_b16 v[200:201], v8 offset:4096
    v_mfma_f32_16x16x32_bf16 v[24:27], v[140:143], v[124:127], v[24:27]
    ds_read_b64_tr_b16 v[202:203], v8 offset:4608
    v_mfma_f32_16x16x32_bf16 v[28:31], v[144:147], v[124:127], v[28:31]
    ds_read_b64_tr_b16 v[204:205], v9 offset:4096
    v_mfma_f32_16x16x32_bf16 v[48:51], v[148:151], v[120:123], v[48:51]
    ds_read_b64_tr_b16 v[206:207], v9 offset:4608
    v_mfma_f32_16x16x32_bf16 v[52:55], v[152:155], v[120:123], v[52:55]
    buffer_load_dword v222, v220, s[68:71], s98 offen sc1
    v_mfma_f32_16x16x32_bf16 v[16:19], v[140:143], v[120:123], v[16:19]
    v_mfma_f32_16x16x32_bf16 v[20:23], v[144:147], v[120:123], v[20:23]
    v_mfma_f32_16x16x32_bf16 v[96:99], v[128:131], v[156:159], v[96:99]
    v_mfma_f32_16x16x32_bf16 v[100:103], v[128:131], v[160:163], v[100:103]
    v_mfma_f32_16x16x32_bf16 v[88:91], v[124:127], v[156:159], v[88:91]
    v_mfma_f32_16x16x32_bf16 v[92:95], v[124:127], v[160:163], v[92:95]
    v_mfma_f32_16x16x32_bf16 v[80:83], v[120:123], v[156:159], v[80:83]
    v_mfma_f32_16x16x32_bf16 v[84:87], v[120:123], v[160:163], v[84:87]
    s_waitcnt lgkmcnt(0)
    s_barrier
    v_mfma_f32_16x16x32_bf16 v[112:115], v[192:195], v[180:183], v[112:115]
    ds_read_b128 v[120:123], v4 offset:18432
    v_mfma_f32_16x16x32_bf16 v[116:119], v[180:183], v[200:203], v[116:119]
    ds_read_b128 v[124:127], v4 offset:20480
    v_mfma_f32_16x16x32_bf16 v[72:75], v[192:195], v[176:179], v[72:75]
    ds_read_b128 v[128:131], v4 offset:22528
    v_mfma_f32_16x16x32_bf16 v[76:79], v[196:199], v[176:179], v[76:79]
    ds_read_b128 v[132:135], v4 offset:24576
    v_mfma_f32_16x16x32_bf16 v[104:107], v[176:179], v[200:203], v[104:107]
    ds_read_b128 v[136:139], v2 offset:18432
    v_mfma_f32_16x16x32_bf16 v[108:111], v[176:179], v[204:207], v[108:111]
    ds_read_b64_tr_b16 v[140:141], v6 offset:8192
    v_mfma_f32_16x16x32_bf16 v[40:43], v[184:187], v[176:179], v[40:43]
    ds_read_b64_tr_b16 v[142:143], v6 offset:8704
    v_mfma_f32_16x16x32_bf16 v[44:47], v[188:191], v[176:179], v[44:47]
    ds_read_b64_tr_b16 v[144:145], v7 offset:8192
    v_mfma_f32_16x16x32_bf16 v[64:67], v[192:195], v[172:175], v[64:67]
    ds_read_b64_tr_b16 v[146:147], v7 offset:8704
    v_mfma_f32_16x16x32_bf16 v[68:71], v[196:199], v[172:175], v[68:71]
    ds_read_b64_tr_b16 v[148:149], v6 offset:32768
    v_mfma_f32_16x16x32_bf16 v[32:35], v[184:187], v[172:175], v[32:35]
    ds_read_b64_tr_b16 v[150:151], v6 offset:33280
    v_mfma_f32_16x16x32_bf16 v[36:39], v[188:191], v[172:175], v[36:39]
    ds_read_b64_tr_b16 v[152:153], v7 offset:32768
    v_mfma_f32_16x16x32_bf16 v[56:59], v[192:195], v[168:171], v[56:59]
    ds_read_b64_tr_b16 v[154:155], v7 offset:33280
    v_mfma_f32_16x16x32_bf16 v[60:63], v[196:199], v[168:171], v[60:63]
    ds_read_b64_tr_b16 v[156:157], v8 offset:8192
    v_mfma_f32_16x16x32_bf16 v[24:27], v[184:187], v[168:171], v[24:27]
    ds_read_b64_tr_b16 v[158:159], v8 offset:8704
    v_mfma_f32_16x16x32_bf16 v[28:31], v[188:191], v[168:171], v[28:31]
    ds_read_b64_tr_b16 v[160:161], v9 offset:8192
    v_mfma_f32_16x16x32_bf16 v[48:51], v[192:195], v[164:167], v[48:51]
    ds_read_b64_tr_b16 v[162:163], v9 offset:8704
    v_mfma_f32_16x16x32_bf16 v[52:55], v[196:199], v[164:167], v[52:55]
    v_mfma_f32_16x16x32_bf16 v[16:19], v[184:187], v[164:167], v[16:19]
    v_mfma_f32_16x16x32_bf16 v[20:23], v[188:191], v[164:167], v[20:23]
    v_mfma_f32_16x16x32_bf16 v[96:99], v[172:175], v[200:203], v[96:99]
    v_mfma_f32_16x16x32_bf16 v[100:103], v[172:175], v[204:207], v[100:103]
    v_mfma_f32_16x16x32_bf16 v[88:91], v[168:171], v[200:203], v[88:91]
    v_mfma_f32_16x16x32_bf16 v[92:95], v[168:171], v[204:207], v[92:95]
    v_mfma_f32_16x16x32_bf16 v[80:83], v[164:167], v[200:203], v[80:83]
    v_mfma_f32_16x16x32_bf16 v[84:87], v[164:167], v[204:207], v[84:87]
    s_waitcnt lgkmcnt(0)
    v_mfma_f32_16x16x32_bf16 v[112:115], v[148:151], v[136:139], v[112:115]
    ds_read_b128 v[164:167], v5 offset:18432
    v_mfma_f32_16x16x32_bf16 v[116:119], v[136:139], v[156:159], v[116:119]
    ds_read_b128 v[168:171], v5 offset:20480
    v_mfma_f32_16x16x32_bf16 v[72:75], v[148:151], v[132:135], v[72:75]
    ds_read_b128 v[172:175], v5 offset:22528
    v_mfma_f32_16x16x32_bf16 v[76:79], v[152:155], v[132:135], v[76:79]
    ds_read_b128 v[176:179], v5 offset:24576
    v_mfma_f32_16x16x32_bf16 v[104:107], v[132:135], v[156:159], v[104:107]
    ds_read_b128 v[180:183], v3 offset:18432
    v_mfma_f32_16x16x32_bf16 v[108:111], v[132:135], v[160:163], v[108:111]
    ds_read_b64_tr_b16 v[184:185], v6 offset:12288
    v_mfma_f32_16x16x32_bf16 v[40:43], v[140:143], v[132:135], v[40:43]
    ds_read_b64_tr_b16 v[186:187], v6 offset:12800
    v_mfma_f32_16x16x32_bf16 v[44:47], v[144:147], v[132:135], v[44:47]
    ds_read_b64_tr_b16 v[188:189], v7 offset:12288
    v_mfma_f32_16x16x32_bf16 v[64:67], v[148:151], v[128:131], v[64:67]
    ds_read_b64_tr_b16 v[190:191], v7 offset:12800
    v_mfma_f32_16x16x32_bf16 v[68:71], v[152:155], v[128:131], v[68:71]
    ds_read_b64_tr_b16 v[192:193], v6 offset:36864
    v_mfma_f32_16x16x32_bf16 v[32:35], v[140:143], v[128:131], v[32:35]
    ds_read_b64_tr_b16 v[194:195], v6 offset:37376
    v_mfma_f32_16x16x32_bf16 v[36:39], v[144:147], v[128:131], v[36:39]
    ds_read_b64_tr_b16 v[196:197], v7 offset:36864
    v_mfma_f32_16x16x32_bf16 v[56:59], v[148:151], v[124:127], v[56:59]
    ds_read_b64_tr_b16 v[198:199], v7 offset:37376
    v_mfma_f32_16x16x32_bf16 v[60:63], v[152:155], v[124:127], v[60:63]
    ds_read_b64_tr_b16 v[200:201], v8 offset:12288
    v_mfma_f32_16x16x32_bf16 v[24:27], v[140:143], v[124:127], v[24:27]
    ds_read_b64_tr_b16 v[202:203], v8 offset:12800
    v_mfma_f32_16x16x32_bf16 v[28:31], v[144:147], v[124:127], v[28:31]
    ds_read_b64_tr_b16 v[204:205], v9 offset:12288
    v_mfma_f32_16x16x32_bf16 v[48:51], v[148:151], v[120:123], v[48:51]
    ds_read_b64_tr_b16 v[206:207], v9 offset:12800
    v_mfma_f32_16x16x32_bf16 v[52:55], v[152:155], v[120:123], v[52:55]
    v_mfma_f32_16x16x32_bf16 v[16:19], v[140:143], v[120:123], v[16:19]
    v_mfma_f32_16x16x32_bf16 v[20:23], v[144:147], v[120:123], v[20:23]
    v_mfma_f32_16x16x32_bf16 v[96:99], v[128:131], v[156:159], v[96:99]
    v_mfma_f32_16x16x32_bf16 v[100:103], v[128:131], v[160:163], v[100:103]
    v_mfma_f32_16x16x32_bf16 v[88:91], v[124:127], v[156:159], v[88:91]
    v_mfma_f32_16x16x32_bf16 v[92:95], v[124:127], v[160:163], v[92:95]
    v_mfma_f32_16x16x32_bf16 v[80:83], v[120:123], v[156:159], v[80:83]
    v_mfma_f32_16x16x32_bf16 v[84:87], v[120:123], v[160:163], v[84:87]
    s_waitcnt lgkmcnt(0)
    s_barrier
    v_mfma_f32_16x16x32_bf16 v[112:115], v[192:195], v[180:183], v[112:115]
    ds_read_b128 v[120:123], v4 offset:36864
    v_mfma_f32_16x16x32_bf16 v[116:119], v[180:183], v[200:203], v[116:119]
    ds_read_b128 v[124:127], v4 offset:38912
    v_mfma_f32_16x16x32_bf16 v[72:75], v[192:195], v[176:179], v[72:75]
    ds_read_b128 v[128:131], v4 offset:40960
    v_mfma_f32_16x16x32_bf16 v[76:79], v[196:199], v[176:179], v[76:79]
    ds_read_b128 v[132:135], v4 offset:43008
    v_mfma_f32_16x16x32_bf16 v[104:107], v[176:179], v[200:203], v[104:107]
    ds_read_b128 v[136:139], v2 offset:36864
    v_mfma_f32_16x16x32_bf16 v[108:111], v[176:179], v[204:207], v[108:111]
    ds_read_b64_tr_b16 v[140:141], v6 offset:16384
    v_mfma_f32_16x16x32_bf16 v[40:43], v[184:187], v[176:179], v[40:43]
    ds_read_b64_tr_b16 v[142:143], v6 offset:16896
    v_mfma_f32_16x16x32_bf16 v[44:47], v[188:191], v[176:179], v[44:47]
    ds_read_b64_tr_b16 v[144:145], v7 offset:16384
    v_mfma_f32_16x16x32_bf16 v[64:67], v[192:195], v[172:175], v[64:67]
    ds_read_b64_tr_b16 v[146:147], v7 offset:16896
    v_mfma_f32_16x16x32_bf16 v[68:71], v[196:199], v[172:175], v[68:71]
    ds_read_b64_tr_b16 v[148:149], v6 offset:40960
    v_mfma_f32_16x16x32_bf16 v[32:35], v[184:187], v[172:175], v[32:35]
    ds_read_b64_tr_b16 v[150:151], v6 offset:41472
    v_mfma_f32_16x16x32_bf16 v[36:39], v[188:191], v[172:175], v[36:39]
    ds_read_b64_tr_b16 v[152:153], v7 offset:40960
    v_mfma_f32_16x16x32_bf16 v[56:59], v[192:195], v[168:171], v[56:59]
    ds_read_b64_tr_b16 v[154:155], v7 offset:41472
    v_mfma_f32_16x16x32_bf16 v[60:63], v[196:199], v[168:171], v[60:63]
    ds_read_b64_tr_b16 v[156:157], v8 offset:16384
    v_mfma_f32_16x16x32_bf16 v[24:27], v[184:187], v[168:171], v[24:27]
    ds_read_b64_tr_b16 v[158:159], v8 offset:16896
    v_mfma_f32_16x16x32_bf16 v[28:31], v[188:191], v[168:171], v[28:31]
    ds_read_b64_tr_b16 v[160:161], v9 offset:16384
    v_mfma_f32_16x16x32_bf16 v[48:51], v[192:195], v[164:167], v[48:51]
    ds_read_b64_tr_b16 v[162:163], v9 offset:16896
    v_mfma_f32_16x16x32_bf16 v[52:55], v[196:199], v[164:167], v[52:55]
    v_mfma_f32_16x16x32_bf16 v[16:19], v[184:187], v[164:167], v[16:19]
    v_mfma_f32_16x16x32_bf16 v[20:23], v[188:191], v[164:167], v[20:23]
    v_mfma_f32_16x16x32_bf16 v[96:99], v[172:175], v[200:203], v[96:99]
    v_mfma_f32_16x16x32_bf16 v[100:103], v[172:175], v[204:207], v[100:103]
    v_mfma_f32_16x16x32_bf16 v[88:91], v[168:171], v[200:203], v[88:91]
    v_mfma_f32_16x16x32_bf16 v[92:95], v[168:171], v[204:207], v[92:95]
    v_mfma_f32_16x16x32_bf16 v[80:83], v[164:167], v[200:203], v[80:83]
    v_mfma_f32_16x16x32_bf16 v[84:87], v[164:167], v[204:207], v[84:87]
    s_waitcnt lgkmcnt(0)
    v_mfma_f32_16x16x32_bf16 v[112:115], v[148:151], v[136:139], v[112:115]
    ds_read_b128 v[164:167], v5 offset:36864
    v_mfma_f32_16x16x32_bf16 v[116:119], v[136:139], v[156:159], v[116:119]
    ds_read_b128 v[168:171], v5 offset:38912
    v_mfma_f32_16x16x32_bf16 v[72:75], v[148:151], v[132:135], v[72:75]
    ds_read_b128 v[172:175], v5 offset:40960
    v_mfma_f32_16x16x32_bf16 v[76:79], v[152:155], v[132:135], v[76:79]
    ds_read_b128 v[176:179], v5 offset:43008
    v_mfma_f32_16x16x32_bf16 v[104:107], v[132:135], v[156:159], v[104:107]
    ds_read_b128 v[180:183], v3 offset:36864
    v_mfma_f32_16x16x32_bf16 v[108:111], v[132:135], v[160:163], v[108:111]
    ds_read_b64_tr_b16 v[184:185], v6 offset:20480
    v_mfma_f32_16x16x32_bf16 v[40:43], v[140:143], v[132:135], v[40:43]
    ds_read_b64_tr_b16 v[186:187], v6 offset:20992
    v_mfma_f32_16x16x32_bf16 v[44:47], v[144:147], v[132:135], v[44:47]
    ds_read_b64_tr_b16 v[188:189], v7 offset:20480
    v_mfma_f32_16x16x32_bf16 v[64:67], v[148:151], v[128:131], v[64:67]
    ds_read_b64_tr_b16 v[190:191], v7 offset:20992
    v_mfma_f32_16x16x32_bf16 v[68:71], v[152:155], v[128:131], v[68:71]
    ds_read_b64_tr_b16 v[192:193], v6 offset:45056
    v_mfma_f32_16x16x32_bf16 v[32:35], v[140:143], v[128:131], v[32:35]
    ds_read_b64_tr_b16 v[194:195], v6 offset:45568
    v_mfma_f32_16x16x32_bf16 v[36:39], v[144:147], v[128:131], v[36:39]
    ds_read_b64_tr_b16 v[196:197], v7 offset:45056
    v_mfma_f32_16x16x32_bf16 v[56:59], v[148:151], v[124:127], v[56:59]
    ds_read_b64_tr_b16 v[198:199], v7 offset:45568
    v_mfma_f32_16x16x32_bf16 v[60:63], v[152:155], v[124:127], v[60:63]
    ds_read_b64_tr_b16 v[200:201], v8 offset:20480
    v_mfma_f32_16x16x32_bf16 v[24:27], v[140:143], v[124:127], v[24:27]
    ds_read_b64_tr_b16 v[202:203], v8 offset:20992
    v_mfma_f32_16x16x32_bf16 v[28:31], v[144:147], v[124:127], v[28:31]
    ds_read_b64_tr_b16 v[204:205], v9 offset:20480
    v_mfma_f32_16x16x32_bf16 v[48:51], v[148:151], v[120:123], v[48:51]
    ds_read_b64_tr_b16 v[206:207], v9 offset:20992
    v_mfma_f32_16x16x32_bf16 v[52:55], v[152:155], v[120:123], v[52:55]
    v_mfma_f32_16x16x32_bf16 v[16:19], v[140:143], v[120:123], v[16:19]
    v_mfma_f32_16x16x32_bf16 v[20:23], v[144:147], v[120:123], v[20:23]
    v_mfma_f32_16x16x32_bf16 v[96:99], v[128:131], v[156:159], v[96:99]
    v_mfma_f32_16x16x32_bf16 v[100:103], v[128:131], v[160:163], v[100:103]
    v_mfma_f32_16x16x32_bf16 v[88:91], v[124:127], v[156:159], v[88:91]
    v_mfma_f32_16x16x32_bf16 v[92:95], v[124:127], v[160:163], v[92:95]
    v_mfma_f32_16x16x32_bf16 v[80:83], v[120:123], v[156:159], v[80:83]
    v_mfma_f32_16x16x32_bf16 v[84:87], v[120:123], v[160:163], v[84:87]
    s_waitcnt lgkmcnt(0)
    s_barrier
    s_cmp_lg_u32 s3, 0
    s_cbranch_scc1 LB_sk
    s_waitcnt vmcnt(0)
    v_cmp_eq_u32 vcc, 0, v222
    s_cbranch_vccnz LB_slow
LB_back:
    s_mov_b64 exec, 1
    buffer_store_dword v222, v220, s[52:55], s96 offen sc1
    s_mov_b64 exec, -1
LB_sk:
    v_mfma_f32_16x16x32_bf16 v[112:115], v[192:195], v[180:183], v[112:115]
    ds_read_b128 v[120:123], v4 offset:0
    v_mfma_f32_16x16x32_bf16 v[116:119], v[180:183], v[200:203], v[116:119]
    ds_read_b128 v[124:127], v4 offset:2048
    v_mfma_f32_16x16x32_bf16 v[72:75], v[192:195], v[176:179], v[72:75]
    ds_read_b128 v[128:131], v4 offset:4096
    v_mfma_f32_16x16x32_bf16 v[76:79], v[196:199], v[176:179], v[76:79]
    ds_read_b128 v[132:135], v4 offset:6144
    v_mfma_f32_16x16x32_bf16 v[104:107], v[176:179], v[200:203], v[104:107]
    ds_read_b128 v[136:139], v2 offset:0
    v_mfma_f32_16x16x32_bf16 v[108:111], v[176:179], v[204:207], v[108:111]
    ds_read_b64_tr_b16 v[140:141], v6 offset:0
    v_mfma_f32_16x16x32_bf16 v[40:43], v[184:187], v[176:179], v[40:43]
    ds_read_b64_tr_b16 v[142:143], v6 offset:512
    v_mfma_f32_16x16x32_bf16 v[44:47], v[188:191], v[176:179], v[44:47]
    ds_read_b64_tr_b16 v[144:145], v7 offset:0
    v_mfma_f32_16x16x32_bf16 v[64:67], v[192:195], v[172:175], v[64:67]
    ds_read_b64_tr_b16 v[146:147], v7 offset:512
    v_mfma_f32_16x16x32_bf16 v[68:71], v[196:199], v[172:175], v[68:71]
    ds_read_b64_tr_b16 v[148:149], v6 offset:24576
    v_mfma_f32_16x16x32_bf16 v[32:35], v[184:187], v[172:175], v[32:35]
    ds_read_b64_tr_b16 v[150:151], v6 offset:25088
    v_mfma_f32_16x16x32_bf16 v[36:39], v[188:191], v[172:175], v[36:39]
    ds_read_b64_tr_b16 v[152:153], v7 offset:24576
    v_mfma_f32_16x16x32_bf16 v[56:59], v[192:195], v[168:171], v[56:59]
    ds_read_b64_tr_b16 v[154:155], v7 offset:25088
    v_mfma_f32_16x16x32_bf16 v[60:63], v[196:199], v[168:171], v[60:63]
    ds_read_b64_tr_b16 v[156:157], v8 offset:0
    v_mfma_f32_16x16x32_bf16 v[24:27], v[184:187], v[168:171], v[24:27]
    ds_read_b64_tr_b16 v[158:159], v8 offset:512
    v_mfma_f32_16x16x32_bf16 v[28:31], v[188:191], v[168:171], v[28:31]
    ds_read_b64_tr_b16 v[160:161], v9 offset:0
    v_mfma_f32_16x16x32_bf16 v[48:51], v[192:195], v[164:167], v[48:51]
    ds_read_b64_tr_b16 v[162:163], v9 offset:512
    v_mfma_f32_16x16x32_bf16 v[52:55], v[196:199], v[164:167], v[52:55]
    v_mfma_f32_16x16x32_bf16 v[16:19], v[184:187], v[164:167], v[16:19]
    v_mfma_f32_16x16x32_bf16 v[20:23], v[188:191], v[164:167], v[20:23]
    v_mfma_f32_16x16x32_bf16 v[96:99], v[172:175], v[200:203], v[96:99]
    v_mfma_f32_16x16x32_bf16 v[100:103], v[172:175], v[204:207], v[100:103]
    v_mfma_f32_16x16x32_bf16 v[88:91], v[168:171], v[200:203], v[88:91]
    v_mfma_f32_16x16x32_bf16 v[92:95], v[168:171], v[204:207], v[92:95]
    v_mfma_f32_16x16x32_bf16 v[80:83], v[164:167], v[200:203], v[80:83]
    v_mfma_f32_16x16x32_bf16 v[84:87], v[164:167], v[204:207], v[84:87]
    s_waitcnt lgkmcnt(0)
    v_mfma_f32_16x16x32_bf16 v[112:115], v[148:151], v[136:139], v[112:115]
    ds_read_b128 v[164:167], v5 offset:0
    v_mfma_f32_16x16x32_bf16 v[116:119], v[136:139], v[156:159], v[116:119]
    ds_read_b128 v[168:171], v5 offset:2048
    v_mfma_f32_16x16x32_bf16 v[72:75], v[148:151], v[132:135], v[72:75]
    ds_read_b128 v[172:175], v5 offset:4096
    v_mfma_f32_16x16x32_bf16 v[76:79], v[152:155], v[132:135], v[76:79]
    ds_read_b128 v[176:179], v5 offset:6144
    v_mfma_f32_16x16x32_bf16 v[104:107], v[132:135], v[156:159], v[104:107]
    ds_read_b128 v[180:183], v3 offset:0
    v_mfma_f32_16x16x32_bf16 v[108:111], v[132:135], v[160:163], v[108:111]
    ds_read_b64_tr_b16 v[184:185], v6 offset:4096
    v_mfma_f32_16x16x32_bf16 v[40:43], v[140:143], v[132:135], v[40:43]
    ds_read_b64_tr_b16 v[186:187], v6 offset:4608
    v_mfma_f32_16x16x32_bf16 v[44:47], v[144:147], v[132:135], v[44:47]
    ds_read_b64_tr_b16 v[188:189], v7 offset:4096
    v_mfma_f32_16x16x32_bf16 v[64:67], v[148:151], v[128:131], v[64:67]
    ds_read_b64_tr_b16 v[190:191], v7 offset:4608
    v_mfma_f32_16x16x32_bf16 v[68:71], v[152:155], v[128:131], v[68:71]
    ds_read_b64_tr_b16 v[192:193], v6 offset:28672
    v_mfma_f32_16x16x32_bf16 v[32:35], v[140:143], v[128:131], v[32:35]
    ds_read_b64_tr_b16 v[194:195], v6 offset:29184
    v_mfma_f32_16x16x32_bf16 v[36:39], v[144:147], v[128:131], v[36:39]
    ds_read_b64_tr_b16 v[196:197], v7 offset:28672
    v_mfma_f32_16x16x32_bf16 v[56:59], v[148:151], v[124:127], v[56:59]
    ds_read_b64_tr_b16 v[198:199], v7 offset:29184
    v_mfma_f32_16x16x32_bf16 v[60:63], v[152:155], v[124:127], v[60:63]
    ds_read_b64_tr_b16 v[200:201], v8 offset:4096
    v_mfma_f32_16x16x32_bf16 v[24:27], v[140:143], v[124:127], v[24:27]
    ds_read_b64_tr_b16 v[202:203], v8 offset:4608
    v_mfma_f32_16x16x32_bf16 v[28:31], v[144:147], v[124:127], v[28:31]
    ds_read_b64_tr_b16 v[204:205], v9 offset:4096
    v_mfma_f32_16x16x32_bf16 v[48:51], v[148:151], v[120:123], v[48:51]
    ds_read_b64_tr_b16 v[206:207], v9 offset:4608
    v_mfma_f32_16x16x32_bf16 v[52:55], v[152:155], v[120:123], v[52:55]
    v_mfma_f32_16x16x32_bf16 v[16:19], v[140:143], v[120:123], v[16:19]
    v_mfma_f32_16x16x32_bf16 v[20:23], v[144:147], v[120:123], v[20:23]
    v_mfma_f32_16x16x32_bf16 v[96:99], v[128:131], v[156:159], v[96:99]
    v_mfma_f32_16x16x32_bf16 v[100:103], v[128:131], v[160:163], v[100:103]
    v_mfma_f32_16x16x32_bf16 v[88:91], v[124:127], v[156:159], v[88:91]
    v_mfma_f32_16x16x32_bf16 v[92:95], v[124:127], v[160:163], v[92:95]
    v_mfma_f32_16x16x32_bf16 v[80:83], v[120:123], v[156:159], v[80:83]
    v_mfma_f32_16x16x32_bf16 v[84:87], v[120:123], v[160:163], v[84:87]
    s_waitcnt lgkmcnt(0)
    s_barrier
    v_mfma_f32_16x16x32_bf16 v[112:115], v[192:195], v[180:183], v[112:115]
    ds_read_b128 v[120:123], v4 offset:18432
    v_mfma_f32_16x16x32_bf16 v[116:119], v[180:183], v[200:203], v[116:119]
    ds_read_b128 v[124:127], v4 offset:20480
    v_mfma_f32_16x16x32_bf16 v[72:75], v[192:195], v[176:179], v[72:75]
    ds_read_b128 v[128:131], v4 offset:22528
    v_mfma_f32_16x16x32_bf16 v[76:79], v[196:199], v[176:179], v[76:79]
    ds_read_b128 v[132:135], v4 offset:24576
    v_mfma_f32_16x16x32_bf16 v[104:107], v[176:179], v[200:203], v[104:107]
    ds_read_b128 v[136:139], v2 offset:18432
    v_mfma_f32_16x16x32_bf16 v[108:111], v[176:179], v[204:207], v[108:111]
    ds_read_b64_tr_b16 v[140:141], v6 offset:8192
    v_mfma_f32_16x16x32_bf16 v[40:43], v[184:187], v[176:179], v[40:43]
    ds_read_b64_tr_b16 v[142:143], v6 offset:8704
    v_mfma_f32_16x16x32_bf16 v[44:47], v[188:191], v[176:179], v[44:47]
    ds_read_b64_tr_b16 v[144:145], v7 offset:8192
    v_mfma_f32_16x16x32_bf16 v[64:67], v[192:195], v[172:175], v[64:67]
    ds_read_b64_tr_b16 v[146:147], v7 offset:8704
    v_mfma_f32_16x16x32_bf16 v[68:71], v[196:199], v[172:175], v[68:71]
    ds_read_b64_tr_b16 v[148:149], v6 offset:32768
    v_mfma_f32_16x16x32_bf16 v[32:35], v[184:187], v[172:175], v[32:35]
    ds_read_b64_tr_b16 v[150:151], v6 offset:33280
    v_mfma_f32_16x16x32_bf16 v[36:39], v[188:191], v[172:175], v[36:39]
    ds_read_b64_tr_b16 v[152:153], v7 offset:32768
    v_mfma_f32_16x16x32_bf16 v[56:59], v[192:195], v[168:171], v[56:59]
    ds_read_b64_tr_b16 v[154:155], v7 offset:33280
    v_mfma_f32_16x16x32_bf16 v[60:63], v[196:199], v[168:171], v[60:63]
    ds_read_b64_tr_b16 v[156:157], v8 offset:8192
    v_mfma_f32_16x16x32_bf16 v[24:27], v[184:187], v[168:171], v[24:27]
    ds_read_b64_tr_b16 v[158:159], v8 offset:8704
    v_mfma_f32_16x16x32_bf16 v[28:31], v[188:191], v[168:171], v[28:31]
    ds_read_b64_tr_b16 v[160:161], v9 offset:8192
    v_mfma_f32_16x16x32_bf16 v[48:51], v[192:195], v[164:167], v[48:51]
    ds_read_b64_tr_b16 v[162:163], v9 offset:8704
    v_mfma_f32_16x16x32_bf16 v[52:55], v[196:199], v[164:167], v[52:55]
    v_mfma_f32_16x16x32_bf16 v[16:19], v[184:187], v[164:167], v[16:19]
    v_mfma_f32_16x16x32_bf16 v[20:23], v[188:191], v[164:167], v[20:23]
    v_mfma_f32_16x16x32_bf16 v[96:99], v[172:175], v[200:203], v[96:99]
    v_mfma_f32_16x16x32_bf16 v[100:103], v[172:175], v[204:207], v[100:103]
    v_mfma_f32_16x16x32_bf16 v[88:91], v[168:171], v[200:203], v[88:91]
    v_mfma_f32_16x16x32_bf16 v[92:95], v[168:171], v[204:207], v[92:95]
    v_mfma_f32_16x16x32_bf16 v[80:83], v[164:167], v[200:203], v[80:83]
    v_mfma_f32_16x16x32_bf16 v[84:87], v[164:167], v[204:207], v[84:87]
    s_waitcnt lgkmcnt(0)
    v_mfma_f32_16x16x32_bf16 v[112:115], v[148:151], v[136:139], v[112:115]
    ds_read_b128 v[164:167], v5 offset:18432
    v_mfma_f32_16x16x32_bf16 v[116:119], v[136:139], v[156:159], v[116:119]
    ds_read_b128 v[168:171], v5 offset:20480
    v_mfma_f32_16x16x32_bf16 v[72:75], v[148:151], v[132:135], v[72:75]
    ds_read_b128 v[172:175], v5 offset:22528
    v_mfma_f32_16x16x32_bf16 v[76:79], v[152:155], v[132:135], v[76:79]
    ds_read_b128 v[176:179], v5 offset:24576
    v_mfma_f32_16x16x32_bf16 v[104:107], v[132:135], v[156:159], v[104:107]
    ds_read_b128 v[180:183], v3 offset:18432
    v_mfma_f32_16x16x32_bf16 v[108:111], v[132:135], v[160:163], v[108:111]
    ds_read_b64_tr_b16 v[184:185], v6 offset:12288
    v_mfma_f32_16x16x32_bf16 v[40:43], v[140:143], v[132:135], v[40:43]
    ds_read_b64_tr_b16 v[186:187], v6 offset:12800
    v_mfma_f32_16x16x32_bf16 v[44:47], v[144:147], v[132:135], v[44:47]
    ds_read_b64_tr_b16 v[188:189], v7 offset:12288
    v_mfma_f32_16x16x32_bf16 v[64:67], v[148:151], v[128:131], v[64:67]
    ds_read_b64_tr_b16 v[190:191], v7 offset:12800
    v_mfma_f32_16x16x32_bf16 v[68:71], v[152:155], v[128:131], v[68:71]
    ds_read_b64_tr_b16 v[192:193], v6 offset:36864
    v_mfma_f32_16x16x32_bf16 v[32:35], v[140:143], v[128:131], v[32:35]
    ds_read_b64_tr_b16 v[194:195], v6 offset:37376
    v_mfma_f32_16x16x32_bf16 v[36:39], v[144:147], v[128:131], v[36:39]
    ds_read_b64_tr_b16 v[196:197], v7 offset:36864
    v_mfma_f32_16x16x32_bf16 v[56:59], v[148:151], v[124:127], v[56:59]
    ds_read_b64_tr_b16 v[198:199], v7 offset:37376
    v_mfma_f32_16x16x32_bf16 v[60:63], v[152:155], v[124:127], v[60:63]
    ds_read_b64_tr_b16 v[200:201], v8 offset:12288
    v_mfma_f32_16x16x32_bf16 v[24:27], v[140:143], v[124:127], v[24:27]
    ds_read_b64_tr_b16 v[202:203], v8 offset:12800
    v_mfma_f32_16x16x32_bf16 v[28:31], v[144:147], v[124:127], v[28:31]
    ds_read_b64_tr_b16 v[204:205], v9 offset:12288
    v_mfma_f32_16x16x32_bf16 v[48:51], v[148:151], v[120:123], v[48:51]
    ds_read_b64_tr_b16 v[206:207], v9 offset:12800
    v_mfma_f32_16x16x32_bf16 v[52:55], v[152:155], v[120:123], v[52:55]
    v_mfma_f32_16x16x32_bf16 v[16:19], v[140:143], v[120:123], v[16:19]
    v_mfma_f32_16x16x32_bf16 v[20:23], v[144:147], v[120:123], v[20:23]
    v_mfma_f32_16x16x32_bf16 v[96:99], v[128:131], v[156:159], v[96:99]
    v_mfma_f32_16x16x32_bf16 v[100:103], v[128:131], v[160:163], v[100:103]
    v_mfma_f32_16x16x32_bf16 v[88:91], v[124:127], v[156:159], v[88:91]
    v_mfma_f32_16x16x32_bf16 v[92:95], v[124:127], v[160:163], v[92:95]
    v_mfma_f32_16x16x32_bf16 v[80:83], v[120:123], v[156:159], v[80:83]
    v_mfma_f32_16x16x32_bf16 v[84:87], v[120:123], v[160:163], v[84:87]
    s_waitcnt lgkmcnt(0)
    s_barrier
    v_mfma_f32_16x16x32_bf16 v[112:115], v[192:195], v[180:183], v[112:115]
    ds_read_b128 v[120:123], v4 offset:36864
    v_mfma_f32_16x16x32_bf16 v[116:119], v[180:183], v[200:203], v[116:119]
    ds_read_b128 v[124:127], v4 offset:38912
    v_mfma_f32_16x16x32_bf16 v[72:75], v[192:195], v[176:179], v[72:75]
    ds_read_b128 v[128:131], v4 offset:40960
    v_mfma_f32_16x16x32_bf16 v[76:79], v[196:199], v[176:179], v[76:79]
    ds_read_b128 v[132:135], v4 offset:43008
    v_mfma_f32_16x16x32_bf16 v[104:107], v[176:179], v[200:203], v[104:107]
    ds_read_b128 v[136:139], v2 offset:36864
    v_mfma_f32_16x16x32_bf16 v[108:111], v[176:179], v[204:207], v[108:111]
    ds_read_b64_tr_b16 v[140:141], v6 offset:16384
    v_mfma_f32_16x16x32_bf16 v[40:43], v[184:187], v[176:179], v[40:43]
    ds_read_b64_tr_b16 v[142:143], v6 offset:16896
    v_mfma_f32_16x16x32_bf16 v[44:47], v[188:191], v[176:179], v[44:47]
    ds_read_b64_tr_b16 v[144:145], v7 offset:16384
    v_mfma_f32_16x16x32_bf16 v[64:67], v[192:195], v[172:175], v[64:67]
    ds_read_b64_tr_b16 v[146:147], v7 offset:16896
    v_mfma_f32_16x16x32_bf16 v[68:71], v[196:199], v[172:175], v[68:71]
    ds_read_b64_tr_b16 v[148:149], v6 offset:40960
    v_mfma_f32_16x16x32_bf16 v[32:35], v[184:187], v[172:175], v[32:35]
    ds_read_b64_tr_b16 v[150:151], v6 offset:41472
    v_mfma_f32_16x16x32_bf16 v[36:39], v[188:191], v[172:175], v[36:39]
    ds_read_b64_tr_b16 v[152:153], v7 offset:40960
    v_mfma_f32_16x16x32_bf16 v[56:59], v[192:195], v[168:171], v[56:59]
    ds_read_b64_tr_b16 v[154:155], v7 offset:41472
    v_mfma_f32_16x16x32_bf16 v[60:63], v[196:199], v[168:171], v[60:63]
    ds_read_b64_tr_b16 v[156:157], v8 offset:16384
    v_mfma_f32_16x16x32_bf16 v[24:27], v[184:187], v[168:171], v[24:27]
    ds_read_b64_tr_b16 v[158:159], v8 offset:16896
    v_mfma_f32_16x16x32_bf16 v[28:31], v[188:191], v[168:171], v[28:31]
    ds_read_b64_tr_b16 v[160:161], v9 offset:16384
    v_mfma_f32_16x16x32_bf16 v[48:51], v[192:195], v[164:167], v[48:51]
    ds_read_b64_tr_b16 v[162:163], v9 offset:16896
    v_mfma_f32_16x16x32_bf16 v[52:55], v[196:199], v[164:167], v[52:55]
    v_mfma_f32_16x16x32_bf16 v[16:19], v[184:187], v[164:167], v[16:19]
    v_mfma_f32_16x16x32_bf16 v[20:23], v[188:191], v[164:167], v[20:23]
    v_mfma_f32_16x16x32_bf16 v[96:99], v[172:175], v[200:203], v[96:99]
    v_mfma_f32_16x16x32_bf16 v[100:103], v[172:175], v[204:207], v[100:103]
    v_mfma_f32_16x16x32_bf16 v[88:91], v[168:171], v[200:203], v[88:91]
    v_mfma_f32_16x16x32_bf16 v[92:95], v[168:171], v[204:207], v[92:95]
    v_mfma_f32_16x16x32_bf16 v[80:83], v[164:167], v[200:203], v[80:83]
    v_mfma_f32_16x16x32_bf16 v[84:87], v[164:167], v[204:207], v[84:87]
    s_waitcnt lgkmcnt(0)
    v_mfma_f32_16x16x32_bf16 v[112:115], v[148:151], v[136:139], v[112:115]
    ds_read_b128 v[164:167], v5 offset:36864
    v_mfma_f32_16x16x32_bf16 v[116:119], v[136:139], v[156:159], v[116:119]
    ds_read_b128 v[168:171], v5 offset:38912
    v_mfma_f32_16x16x32_bf16 v[72:75], v[148:151], v[132:135], v[72:75]
    ds_read_b128 v[172:175], v5 offset:40960
    v_mfma_f32_16x16x32_bf16 v[76:79], v[152:155], v[132:135], v[76:79]
    ds_read_b128 v[176:179], v5 offset:43008
    v_mfma_f32_16x16x32_bf16 v[104:107], v[132:135], v[156:159], v[104:107]
    ds_read_b128 v[180:183], v3 offset:36864
    v_mfma_f32_16x16x32_bf16 v[108:111], v[132:135], v[160:163], v[108:111]
    ds_read_b64_tr_b16 v[184:185], v6 offset:20480
    v_mfma_f32_16x16x32_bf16 v[40:43], v[140:143], v[132:135], v[40:43]
    ds_read_b64_tr_b16 v[186:187], v6 offset:20992
    v_mfma_f32_16x16x32_bf16 v[44:47], v[144:147], v[132:135], v[44:47]
    ds_read_b64_tr_b16 v[188:189], v7 offset:20480
    v_mfma_f32_16x16x32_bf16 v[64:67], v[148:151], v[128:131], v[64:67]
    ds_read_b64_tr_b16 v[190:191], v7 offset:20992
    v_mfma_f32_16x16x32_bf16 v[68:71], v[152:155], v[128:131], v[68:71]
    ds_read_b64_tr_b16 v[192:193], v6 offset:45056
    v_mfma_f32_16x16x32_bf16 v[32:35], v[140:143], v[128:131], v[32:35]
    ds_read_b64_tr_b16 v[194:195], v6 offset:45568
    v_mfma_f32_16x16x32_bf16 v[36:39], v[144:147], v[128:131], v[36:39]
    ds_read_b64_tr_b16 v[196:197], v7 offset:45056
    v_mfma_f32_16x16x32_bf16 v[56:59], v[148:151], v[124:127], v[56:59]
    ds_read_b64_tr_b16 v[198:199], v7 offset:45568
    v_mfma_f32_16x16x32_bf16 v[60:63], v[152:155], v[124:127], v[60:63]
    ds_read_b64_tr_b16 v[200:201], v8 offset:20480
    v_mfma_f32_16x16x32_bf16 v[24:27], v[140:143], v[124:127], v[24:27]
    ds_read_b64_tr_b16 v[202:203], v8 offset:20992
    v_mfma_f32_16x16x32_bf16 v[28:31], v[144:147], v[124:127], v[28:31]
    ds_read_b64_tr_b16 v[204:205], v9 offset:20480
    v_mfma_f32_16x16x32_bf16 v[48:51], v[148:151], v[120:123], v[48:51]
    ds_read_b64_tr_b16 v[206:207], v9 offset:20992
    v_mfma_f32_16x16x32_bf16 v[52:55], v[152:155], v[120:123], v[52:55]
    v_mfma_f32_16x16x32_bf16 v[16:19], v[140:143], v[120:123], v[16:19]
    v_mfma_f32_16x16x32_bf16 v[20:23], v[144:147], v[120:123], v[20:23]
    v_mfma_f32_16x16x32_bf16 v[96:99], v[128:131], v[156:159], v[96:99]
    v_mfma_f32_16x16x32_bf16 v[100:103], v[128:131], v[160:163], v[100:103]
    v_mfma_f32_16x16x32_bf16 v[88:91], v[124:127], v[156:159], v[88:91]
    v_mfma_f32_16x16x32_bf16 v[92:95], v[124:127], v[160:163], v[92:95]
    v_mfma_f32_16x16x32_bf16 v[80:83], v[120:123], v[156:159], v[80:83]
    v_mfma_f32_16x16x32_bf16 v[84:87], v[120:123], v[160:163], v[84:87]
    s_waitcnt lgkmcnt(0)
    s_barrier
    v_mfma_f32_16x16x32_bf16 v[112:115], v[192:195], v[180:183], v[112:115]
    ds_read_b128 v[120:123], v4 offset:0
    v_mfma_f32_16x16x32_bf16 v[116:119], v[180:183], v[200:203], v[116:119]
    ds_read_b128 v[124:127], v4 offset:2048
    v_mfma_f32_16x16x32_bf16 v[72:75], v[192:195], v[176:179], v[72:75]
    ds_read_b128 v[128:131], v4 offset:4096
    v_mfma_f32_16x16x32_bf16 v[76:79], v[196:199], v[176:179], v[76:79]
    ds_read_b128 v[132:135], v4 offset:6144
    v_mfma_f32_16x16x32_bf16 v[104:107], v[176:179], v[200:203], v[104:107]
    ds_read_b128 v[136:139], v2 offset:0
    v_mfma_f32_16x16x32_bf16 v[108:111], v[176:179], v[204:207], v[108:111]
    ds_read_b64_tr_b16 v[140:141], v6 offset:0
    v_mfma_f32_16x16x32_bf16 v[40:43], v[184:187], v[176:179], v[40:43]
    ds_read_b64_tr_b16 v[142:143], v6 offset:512
    v_mfma_f32_16x16x32_bf16 v[44:47], v[188:191], v[176:179], v[44:47]
    ds_read_b64_tr_b16 v[144:145], v7 offset:0
    v_mfma_f32_16x16x32_bf16 v[64:67], v[192:195], v[172:175], v[64:67]
    ds_read_b64_tr_b16 v[146:147], v7 offset:512
    v_mfma_f32_16x16x32_bf16 v[68:71], v[196:199], v[172:175], v[68:71]
    ds_read_b64_tr_b16 v[148:149], v6 offset:24576
    v_mfma_f32_16x16x32_bf16 v[32:35], v[184:187], v[172:175], v[32:35]
    ds_read_b64_tr_b16 v[150:151], v6 offset:25088
    v_mfma_f32_16x16x32_bf16 v[36:39], v[188:191], v[172:175], v[36:39]
    ds_read_b64_tr_b16 v[152:153], v7 offset:24576
    v_mfma_f32_16x16x32_bf16 v[56:59], v[192:195], v[168:171], v[56:59]
    ds_read_b64_tr_b16 v[154:155], v7 offset:25088
    v_mfma_f32_16x16x32_bf16 v[60:63], v[196:199], v[168:171], v[60:63]
    ds_read_b64_tr_b16 v[156:157], v8 offset:0
    v_mfma_f32_16x16x32_bf16 v[24:27], v[184:187], v[168:171], v[24:27]
    ds_read_b64_tr_b16 v[158:159], v8 offset:512
    v_mfma_f32_16x16x32_bf16 v[28:31], v[188:191], v[168:171], v[28:31]
    ds_read_b64_tr_b16 v[160:161], v9 offset:0
    v_mfma_f32_16x16x32_bf16 v[48:51], v[192:195], v[164:167], v[48:51]
    ds_read_b64_tr_b16 v[162:163], v9 offset:512
    v_mfma_f32_16x16x32_bf16 v[52:55], v[196:199], v[164:167], v[52:55]
    v_mfma_f32_16x16x32_bf16 v[16:19], v[184:187], v[164:167], v[16:19]
    v_mfma_f32_16x16x32_bf16 v[20:23], v[188:191], v[164:167], v[20:23]
    v_mfma_f32_16x16x32_bf16 v[96:99], v[172:175], v[200:203], v[96:99]
    v_mfma_f32_16x16x32_bf16 v[100:103], v[172:175], v[204:207], v[100:103]
    v_mfma_f32_16x16x32_bf16 v[88:91], v[168:171], v[200:203], v[88:91]
    v_mfma_f32_16x16x32_bf16 v[92:95], v[168:171], v[204:207], v[92:95]
    v_mfma_f32_16x16x32_bf16 v[80:83], v[164:167], v[200:203], v[80:83]
    v_mfma_f32_16x16x32_bf16 v[84:87], v[164:167], v[204:207], v[84:87]
    s_waitcnt lgkmcnt(0)
    v_mfma_f32_16x16x32_bf16 v[112:115], v[148:151], v[136:139], v[112:115]
    ds_read_b128 v[164:167], v5 offset:0
    v_mfma_f32_16x16x32_bf16 v[116:119], v[136:139], v[156:159], v[116:119]
    ds_read_b128 v[168:171], v5 offset:2048
    v_mfma_f32_16x16x32_bf16 v[72:75], v[148:151], v[132:135], v[72:75]
    ds_read_b128 v[172:175], v5 offset:4096
    v_mfma_f32_16x16x32_bf16 v[76:79], v[152:155], v[132:135], v[76:79]
    ds_read_b128 v[176:179], v5 offset:6144
    v_mfma_f32_16x16x32_bf16 v[104:107], v[132:135], v[156:159], v[104:107]
    ds_read_b128 v[180:183], v3 offset:0
    v_mfma_f32_16x16x32_bf16 v[108:111], v[132:135], v[160:163], v[108:111]
    ds_read_b64_tr_b16 v[184:185], v6 offset:4096
    v_mfma_f32_16x16x32_bf16 v[40:43], v[140:143], v[132:135], v[40:43]
    ds_read_b64_tr_b16 v[186:187], v6 offset:4608
    v_mfma_f32_16x16x32_bf16 v[44:47], v[144:147], v[132:135], v[44:47]
    ds_read_b64_tr_b16 v[188:189], v7 offset:4096
    v_mfma_f32_16x16x32_bf16 v[64:67], v[148:151], v[128:131], v[64:67]
    ds_read_b64_tr_b16 v[190:191], v7 offset:4608
    v_mfma_f32_16x16x32_bf16 v[68:71], v[152:155], v[128:131], v[68:71]
    ds_read_b64_tr_b16 v[192:193], v6 offset:28672
    v_mfma_f32_16x16x32_bf16 v[32:35], v[140:143], v[128:131], v[32:35]
    ds_read_b64_tr_b16 v[194:195], v6 offset:29184
    v_mfma_f32_16x16x32_bf16 v[36:39], v[144:147], v[128:131], v[36:39]
    ds_read_b64_tr_b16 v[196:197], v7 offset:28672
    v_mfma_f32_16x16x32_bf16 v[56:59], v[148:151], v[124:127], v[56:59]
    ds_read_b64_tr_b16 v[198:199], v7 offset:29184
    v_mfma_f32_16x16x32_bf16 v[60:63], v[152:155], v[124:127], v[60:63]
    ds_read_b64_tr_b16 v[200:201], v8 offset:4096
    v_mfma_f32_16x16x32_bf16 v[24:27], v[140:143], v[124:127], v[24:27]
    ds_read_b64_tr_b16 v[202:203], v8 offset:4608
    v_mfma_f32_16x16x32_bf16 v[28:31], v[144:147], v[124:127], v[28:31]
    ds_read_b64_tr_b16 v[204:205], v9 offset:4096
    v_mfma_f32_16x16x32_bf16 v[48:51], v[148:151], v[120:123], v[48:51]
    ds_read_b64_tr_b16 v[206:207], v9 offset:4608
    v_mfma_f32_16x16x32_bf16 v[52:55], v[152:155], v[120:123], v[52:55]
    v_mfma_f32_16x16x32_bf16 v[16:19], v[140:143], v[120:123], v[16:19]
    v_mfma_f32_16x16x32_bf16 v[20:23], v[144:147], v[120:123], v[20:23]
    v_mfma_f32_16x16x32_bf16 v[96:99], v[128:131], v[156:159], v[96:99]
    v_mfma_f32_16x16x32_bf16 v[100:103], v[128:131], v[160:163], v[100:103]
    v_mfma_f32_16x16x32_bf16 v[88:91], v[124:127], v[156:159], v[88:91]
    v_mfma_f32_16x16x32_bf16 v[92:95], v[124:127], v[160:163], v[92:95]
    v_mfma_f32_16x16x32_bf16 v[80:83], v[120:123], v[156:159], v[80:83]
    v_mfma_f32_16x16x32_bf16 v[84:87], v[120:123], v[160:163], v[84:87]
    s_waitcnt lgkmcnt(0)
    s_mov_b64 exec, 1
    ds_add_u32 v10, v11 offset:8
    s_mov_b64 exec, -1
    s_lshl_b32 s78, s87, 2
    v_add_u32 v13, s78, v10
    v_mfma_f32_16x16x32_bf16 v[112:115], v[192:195], v[180:183], v[112:115]
    v_mfma_f32_16x16x32_bf16 v[116:119], v[180:183], v[200:203], v[116:119]
    v_mfma_f32_16x16x32_bf16 v[72:75], v[192:195], v[176:179], v[72:75]
    v_mfma_f32_16x16x32_bf16 v[76:79], v[196:199], v[176:179], v[76:79]
    v_mfma_f32_16x16x32_bf16 v[104:107], v[176:179], v[200:203], v[104:107]
    v_mfma_f32_16x16x32_bf16 v[108:111], v[176:179], v[204:207], v[108:111]
    v_mfma_f32_16x16x32_bf16 v[40:43], v[184:187], v[176:179], v[40:43]
    v_mfma_f32_16x16x32_bf16 v[44:47], v[188:191], v[176:179], v[44:47]
    v_mfma_f32_16x16x32_bf16 v[64:67], v[192:195], v[172:175], v[64:67]
    v_mfma_f32_16x16x32_bf16 v[68:71], v[196:199], v[172:175], v[68:71]
    v_cvt_pk_bf16_f32 v156, v112, v113
    v_cvt_pk_bf16_f32 v157, v114, v115
    v_mfma_f32_16x16x32_bf16 v[32:35], v[184:187], v[172:175], v[32:35]
    v_cvt_pk_bf16_f32 v158, v116, v117
    v_cvt_pk_bf16_f32 v159, v118, v119
    v_mfma_f32_16x16x32_bf16 v[36:39], v[188:191], v[172:175], v[36:39]
    v_cvt_pk_bf16_f32 v152, v72, v73
    v_cvt_pk_bf16_f32 v153, v74, v75
    v_mfma_f32_16x16x32_bf16 v[56:59], v[192:195], v[168:171], v[56:59]
    v_cvt_pk_bf16_f32 v154, v76, v77
    v_cvt_pk_bf16_f32 v155, v78, v79
    v_mfma_f32_16x16x32_bf16 v[60:63], v[196:199], v[168:171], v[60:63]
    v_cvt_pk_bf16_f32 v232, v104, v105
    v_cvt_pk_bf16_f32 v233, v106, v107
    v_mfma_f32_16x16x32_bf16 v[24:27], v[184:187], v[168:171], v[24:27]
    v_cvt_pk_bf16_f32 v242, v108, v109
    v_cvt_pk_bf16_f32 v243, v110, v111
    v_mfma_f32_16x16x32_bf16 v[28:31], v[188:191], v[168:171], v[28:31]
    ds_write_b64 v216, v[156:157]
    ds_write_b64 v216, v[158:159] offset:1024
    v_mfma_f32_16x16x32_bf16 v[48:51], v[192:195], v[164:167], v[48:51]
    ds_write_b64 v217, v[152:153] offset:0
    ds_write_b64 v217, v[232:233] offset:1024
    v_mfma_f32_16x16x32_bf16 v[52:55], v[196:199], v[164:167], v[52:55]
    ds_write_b64 v217, v[154:155] offset:512
    ds_write_b64 v217, v[242:243] offset:1536
    v_mfma_f32_16x16x32_bf16 v[16:19], v[184:187], v[164:167], v[16:19]
    v_cvt_pk_bf16_f32 v132, v40, v41
    v_cvt_pk_bf16_f32 v133, v42, v43
    v_mfma_f32_16x16x32_bf16 v[20:23], v[188:191], v[164:167], v[20:23]
    v_cvt_pk_bf16_f32 v134, v44, v45
    v_cvt_pk_bf16_f32 v135, v46, v47
    v_mfma_f32_16x16x32_bf16 v[96:99], v[172:175], v[200:203], v[96:99]
    v_cvt_pk_bf16_f32 v148, v64, v65
    v_cvt_pk_bf16_f32 v149, v66, v67
    v_mfma_f32_16x16x32_bf16 v[100:103], v[172:175], v[204:207], v[100:103]
    v_cvt_pk_bf16_f32 v150, v68, v69
    v_cvt_pk_bf16_f32 v151, v70, v71
    v_mfma_f32_16x16x32_bf16 v[88:91], v[168:171], v[200:203], v[88:91]
    v_cvt_pk_bf16_f32 v128, v32, v33
    v_cvt_pk_bf16_f32 v129, v34, v35
    v_mfma_f32_16x16x32_bf16 v[92:95], v[168:171], v[204:207], v[92:95]
    v_cvt_pk_bf16_f32 v130, v36, v37
    v_cvt_pk_bf16_f32 v131, v38, v39
    v_mfma_f32_16x16x32_bf16 v[80:83], v[164:167], v[200:203], v[80:83]
    v_cvt_pk_bf16_f32 v144, v56, v57
    v_cvt_pk_bf16_f32 v145, v58, v59
    v_mfma_f32_16x16x32_bf16 v[84:87], v[164:167], v[204:207], v[84:87]
    v_cvt_pk_bf16_f32 v146, v60, v61
    v_cvt_pk_bf16_f32 v147, v62, v63
    v_cvt_pk_bf16_f32 v124, v24, v25
    v_cvt_pk_bf16_f32 v125, v26, v27
    v_cvt_pk_bf16_f32 v126, v28, v29
    v_cvt_pk_bf16_f32 v127, v30, v31
    s_mov_b64 exec, 1
    ds_add_u32 v13, v11 offset:0
    s_mov_b64 exec, -1
    v_cvt_pk_bf16_f32 v140, v48, v49
    v_cvt_pk_bf16_f32 v141, v50, v51
    v_cvt_pk_bf16_f32 v142, v52, v53
    v_cvt_pk_bf16_f32 v143, v54, v55
    v_cvt_pk_bf16_f32 v120, v16, v17
    v_cvt_pk_bf16_f32 v121, v18, v19
    v_cvt_pk_bf16_f32 v122, v20, v21
    v_cvt_pk_bf16_f32 v123, v22, v23
    v_mfma_f32_16x16x32_bf16 v[44:47], v[152:155], v[132:135], 0
    v_cvt_pk_bf16_f32 v230, v96, v97
    v_cvt_pk_bf16_f32 v231, v98, v99
    v_mfma_f32_16x16x32_bf16 v[40:43], v[148:151], v[132:135], 0
    v_cvt_pk_bf16_f32 v240, v100, v101
    v_cvt_pk_bf16_f32 v241, v102, v103
    v_mfma_f32_16x16x32_bf16 v[36:39], v[148:151], v[128:131], 0
    v_cvt_pk_bf16_f32 v228, v88, v89
    v_cvt_pk_bf16_f32 v229, v90, v91
    v_mfma_f32_16x16x32_bf16 v[32:35], v[144:147], v[128:131], 0
    v_cvt_pk_bf16_f32 v238, v92, v93
    v_cvt_pk_bf16_f32 v239, v94, v95
    v_mfma_f32_16x16x32_bf16 v[28:31], v[144:147], v[124:127], 0
    v_cvt_pk_bf16_f32 v226, v80, v81
    v_cvt_pk_bf16_f32 v227, v82, v83
    v_mfma_f32_16x16x32_bf16 v[24:27], v[140:143], v[124:127], 0
    v_cvt_pk_bf16_f32 v236, v84, v85
    v_cvt_pk_bf16_f32 v237, v86, v87
    v_mfma_f32_16x16x32_bf16 v[20:23], v[140:143], v[120:123], 0
    s_branch LB_s1_in
LB_s1:
    s_sleep 1
LB_s1_in:
    ds_read_b32 v14, v13 offset:0
    ds_read_b64 v[136:137], v218
    ds_read_b64 v[138:139], v219
    ds_read_b64 v[224:225], v218 offset:1024
    ds_read_b64 v[234:235], v219 offset:1024
    s_waitcnt lgkmcnt(0)
    v_readfirstlane_b32 s78, v14
    s_nop 0
    s_cmp_ge_u32 s78, 2
    s_cbranch_scc0 LB_s1
    v_mfma_f32_16x16x32_bf16 v[16:19], v[136:139], v[120:123], v[212:215]
    v_cndmask_b32 v60, v44, v45, s[88:89]
    v_cndmask_b32 v61, v40, v41, s[88:89]
    v_cndmask_b32 v54, v61, v60, s[90:91]
    v_cndmask_b32 v60, v46, v47, s[88:89]
    v_cndmask_b32 v61, v42, v43, s[88:89]
    v_cndmask_b32 v55, v61, v60, s[92:93]
    v_max_f32 v59, v54, v55
    v_cndmask_b32 v60, v36, v37, s[88:89]
    v_cndmask_b32 v61, v32, v33, s[88:89]
    v_cndmask_b32 v52, v61, v60, s[90:91]
    v_cndmask_b32 v60, v38, v39, s[88:89]
    v_cndmask_b32 v61, v34, v35, s[88:89]
    v_cndmask_b32 v53, v61, v60, s[92:93]
    v_max_f32 v58, v52, v53
    v_cndmask_b32 v60, v28, v29, s[88:89]
    v_cndmask_b32 v61, v24, v25, s[88:89]
    v_cndmask_b32 v50, v61, v60, s[90:91]
    v_cndmask_b32 v60, v30, v31, s[88:89]
    v_cndmask_b32 v61, v26, v27, s[88:89]
    v_cndmask_b32 v51, v61, v60, s[92:93]
    v_max_f32 v57, v50, v51
    v_cndmask_b32 v60, v20, v21, s[88:89]
    v_cndmask_b32 v61, v16, v17, s[88:89]
    v_cndmask_b32 v48, v61, v60, s[90:91]
    v_cndmask_b32 v60, v22, v23, s[88:89]
    v_cndmask_b32 v61, v18, v19, s[88:89]
    v_cndmask_b32 v49, v61, v60, s[92:93]
    v_max_f32 v56, v48, v49
    s_mov_b32 s80, 0x3e8293ee
    v_permlane32_swap_b32 v58, v59
    v_permlane32_swap_b32 v56, v57
    v_max_f32 v58, v58, v59
    v_max_f32 v56, v56, v57
    s_nop 1
    v_permlane16_swap_b32 v56, v58
    v_max_f32 v56, v56, v58
    v_mul_f32 v56, s80, v56
    v_mov_b32 v58, v56
    s_nop 1
    v_permlane16_swap_b32 v56, v58
    v_mov_b32 v57, v56
    v_mov_b32 v59, v58
    s_nop 0
    v_permlane32_swap_b32 v56, v57
    v_permlane32_swap_b32 v58, v59
    v_fma_f32 v48, v48, s80, -v56
    v_fma_f32 v49, v49, s80, -v56
    v_fma_f32 v50, v50, s80, -v57
    v_fma_f32 v51, v51, s80, -v57
    v_fma_f32 v52, v52, s80, -v58
    v_fma_f32 v53, v53, s80, -v58
    v_fma_f32 v54, v54, s80, -v59
    v_fma_f32 v55, v55, s80, -v59
    v_exp_f32 v48, v48
    v_exp_f32 v49, v49
    v_exp_f32 v50, v50
    v_exp_f32 v51, v51
    v_exp_f32 v52, v52
    v_exp_f32 v53, v53
    v_exp_f32 v54, v54
    v_exp_f32 v55, v55
    v_add_f32 v56, v48, v49
    v_add_f32 v57, v50, v51
    v_add_f32 v58, v52, v53
    v_add_f32 v59, v54, v55
    s_nop 1
    v_permlane32_swap_b32 v58, v59
    v_permlane32_swap_b32 v56, v57
    v_add_f32 v58, v58, v59
    v_add_f32 v56, v56, v57
    s_nop 1
    v_permlane16_swap_b32 v56, v58
    v_add_f32 v56, v56, v58
    v_rcp_f32 v56, v56
    s_nop 0
    v_mov_b32 v58, v56
    s_nop 1
    v_permlane16_swap_b32 v56, v58
    v_mov_b32 v57, v56
    v_mov_b32 v59, v58
    s_nop 0
    v_permlane32_swap_b32 v56, v57
    v_permlane32_swap_b32 v58, v59
    v_mul_f32 v48, v48, v56
    v_mul_f32 v49, v49, v56
    v_cvt_pk_bf16_f32 v48, v48, v49
    v_perm_b32 v64, v48, v48, v208
    v_perm_b32 v65, v48, v48, v209
    v_perm_b32 v66, v48, v48, v210
    v_perm_b32 v67, v48, v48, v211
    v_mul_f32 v50, v50, v57
    v_mul_f32 v51, v51, v57
    v_cvt_pk_bf16_f32 v50, v50, v51
    v_perm_b32 v68, v50, v50, v208
    v_perm_b32 v69, v50, v50, v209
    v_perm_b32 v70, v50, v50, v210
    v_perm_b32 v71, v50, v50, v211
    v_mfma_f32_16x16x32_bf16 v[16:19], v[224:227], v[64:67], 0
    v_mfma_f32_16x16x32_bf16 v[20:23], v[234:237], v[64:67], 0
    v_mul_f32 v52, v52, v58
    v_mul_f32 v53, v53, v58
    v_cvt_pk_bf16_f32 v52, v52, v53
    v_perm_b32 v72, v52, v52, v208
    v_perm_b32 v73, v52, v52, v209
    v_perm_b32 v74, v52, v52, v210
    v_perm_b32 v75, v52, v52, v211
    v_mfma_f32_16x16x32_bf16 v[24:27], v[226:229], v[68:71], 0
    v_mfma_f32_16x16x32_bf16 v[28:31], v[236:239], v[68:71], 0
    v_mul_f32 v54, v54, v59
    v_mul_f32 v55, v55, v59
    v_cvt_pk_bf16_f32 v54, v54, v55
    v_perm_b32 v76, v54, v54, v208
    v_perm_b32 v77, v54, v54, v209
    v_perm_b32 v78, v54, v54, v210
    v_perm_b32 v79, v54, v54, v211
    v_mfma_f32_16x16x32_bf16 v[32:35], v[228:231], v[72:75], 0
    v_mfma_f32_16x16x32_bf16 v[36:39], v[238:241], v[72:75], 0
    v_mfma_f32_16x16x32_bf16 v[40:43], v[230:233], v[76:79], 0
    v_mfma_f32_16x16x32_bf16 v[44:47], v[240:243], v[76:79], 0
    v_cvt_pk_bf16_f32 v80, v16, v17
    v_cvt_pk_bf16_f32 v81, v18, v19
    v_cvt_pk_bf16_f32 v82, v20, v21
    v_cvt_pk_bf16_f32 v83, v22, v23
    s_add_u32 s95, s94, 0
    buffer_store_dwordx4 v[80:83], v12, s[52:55], s95 offen sc1
    v_cvt_pk_bf16_f32 v84, v24, v25
    v_cvt_pk_bf16_f32 v85, v26, v27
    v_cvt_pk_bf16_f32 v86, v28, v29
    v_cvt_pk_bf16_f32 v87, v30, v31
    s_add_u32 s95, s94, 32768
    buffer_store_dwordx4 v[84:87], v12, s[52:55], s95 offen sc1
    v_cvt_pk_bf16_f32 v88, v32, v33
    v_cvt_pk_bf16_f32 v89, v34, v35
    v_cvt_pk_bf16_f32 v90, v36, v37
    v_cvt_pk_bf16_f32 v91, v38, v39
    s_add_u32 s95, s94, 65536
    buffer_store_dwordx4 v[88:91], v12, s[52:55], s95 offen sc1
    v_cvt_pk_bf16_f32 v92, v40, v41
    v_cvt_pk_bf16_f32 v93, v42, v43
    v_cvt_pk_bf16_f32 v94, v44, v45
    v_cvt_pk_bf16_f32 v95, v46, v47
    s_add_u32 s95, s94, 98304
    buffer_store_dwordx4 v[92:95], v12, s[52:55], s95 offen sc1
    v_xor_b32 v2, 0, v244
    v_xor_b32 v3, 32, v244
    v_xor_b32 v4, 64, v244
    v_xor_b32 v5, 96, v244
    v_xor_b32 v6, 2048, v244
    v_xor_b32 v7, 2080, v244
    v_xor_b32 v8, 2112, v244
    v_xor_b32 v9, 2144, v244
    s_lshl_b32 s80, s32, 6
    s_lshl_b32 s81, s3, 10
    s_add_u32 s95, s80, 524288
    s_add_u32 m0, s81, 40960
    s_and_b32 s95, s95, 0x1f0000
    buffer_load_dwordx4 v245, s[64:67], s95 offen  lds
    s_add_u32 s95, s80, 589824
    s_add_u32 m0, s81, 45056
    s_and_b32 s95, s95, 0x1f0000
    buffer_load_dwordx4 v245, s[64:67], s95 offen  lds
    s_add_u32 s95, s80, 655360
    s_add_u32 m0, s81, 65536
    s_and_b32 s95, s95, 0x1f0000
    buffer_load_dwordx4 v245, s[64:67], s95 offen  lds
    s_add_u32 s95, s80, 720896
    s_add_u32 m0, s81, 69632
    s_and_b32 s95, s95, 0x1f0000
    buffer_load_dwordx4 v245, s[64:67], s95 offen  lds
    s_add_u32 s95, s80, 786432
    s_add_u32 m0, s81, 120832
    s_and_b32 s95, s95, 0x1f0000
    buffer_load_dwordx4 v245, s[64:67], s95 offen  lds
    s_add_u32 s95, s80, 851968
    s_add_u32 m0, s81, 124928
    s_and_b32 s95, s95, 0x1f0000
    buffer_load_dwordx4 v245, s[64:67], s95 offen  lds
    s_waitcnt vmcnt(6)
    s_mov_b64 exec, 1
    buffer_store_dword v11, v220, s[52:55], s97 offen sc1
    s_mov_b64 exec, -1
    s_branch LB_s2_in
LB_s2:
    s_sleep 1
LB_s2_in:
    ds_read_b32 v14, v10 offset:8
    s_waitcnt lgkmcnt(0)
    v_readfirstlane_b32 s78, v14
    s_nop 0
    s_cmp_ge_u32 s78, 8
    s_cbranch_scc0 LB_s2
    s_add_u32 s95, s80, 917504
    s_add_u32 m0, s81, 0
    s_and_b32 s95, s95, 0x1f0000
    buffer_load_dwordx4 v245, s[64:67], s95 offen  lds
    ds_read_b64_tr_b16 v[48:49], v2 offset:8192
    ds_read_b64_tr_b16 v[50:51], v6 offset:8192
    ds_read_b64_tr_b16 v[52:53], v3 offset:8192
    ds_read_b64_tr_b16 v[54:55], v7 offset:8192
    ds_read_b64_tr_b16 v[56:57], v4 offset:8192
    ds_read_b64_tr_b16 v[58:59], v8 offset:8192
    ds_read_b64_tr_b16 v[60:61], v5 offset:8192
    s_add_u32 s95, s80, 983040
    s_add_u32 m0, s81, 4096
    s_and_b32 s95, s95, 0x1f0000
    buffer_load_dwordx4 v245, s[64:67], s95 offen  lds
    ds_read_b64_tr_b16 v[62:63], v9 offset:8192
    ds_read_b64_tr_b16 v[64:65], v2 offset:12288
    ds_read_b64_tr_b16 v[66:67], v6 offset:12288
    ds_read_b64_tr_b16 v[68:69], v3 offset:12288
    ds_read_b64_tr_b16 v[70:71], v7 offset:12288
    ds_read_b64_tr_b16 v[72:73], v4 offset:12288
    s_add_u32 s95, s80, 1048576
    s_add_u32 m0, s81, 24576
    s_and_b32 s95, s95, 0x1f0000
    buffer_load_dwordx4 v245, s[64:67], s95 offen  lds
    ds_read_b64_tr_b16 v[74:75], v8 offset:12288
    ds_read_b64_tr_b16 v[76:77], v5 offset:12288
    ds_read_b64_tr_b16 v[78:79], v9 offset:12288
    ds_read_b64_tr_b16 v[80:81], v2 offset:32768
    ds_read_b64_tr_b16 v[82:83], v6 offset:32768
    ds_read_b64_tr_b16 v[84:85], v3 offset:32768
    ds_read_b64_tr_b16 v[86:87], v7 offset:32768
    s_add_u32 s95, s80, 1114112
    s_add_u32 m0, s81, 28672
    s_and_b32 s95, s95, 0x1f0000
    buffer_load_dwordx4 v245, s[64:67], s95 offen  lds
    ds_read_b64_tr_b16 v[88:89], v4 offset:32768
    ds_read_b64_tr_b16 v[90:91], v8 offset:32768
    ds_read_b64_tr_b16 v[92:93], v5 offset:32768
    ds_read_b64_tr_b16 v[94:95], v9 offset:32768
    ds_read_b64_tr_b16 v[96:97], v2 offset:36864
    ds_read_b64_tr_b16 v[98:99], v6 offset:36864
    s_add_u32 s95, s80, 1179648
    s_add_u32 m0, s81, 49152
    s_and_b32 s95, s95, 0x1f0000
    buffer_load_dwordx4 v245, s[64:67], s95 offen  lds
    ds_read_b64_tr_b16 v[100:101], v3 offset:36864
    ds_read_b64_tr_b16 v[102:103], v7 offset:36864
    ds_read_b64_tr_b16 v[104:105], v4 offset:36864
    ds_read_b64_tr_b16 v[106:107], v8 offset:36864
    ds_read_b64_tr_b16 v[108:109], v5 offset:36864
    ds_read_b64_tr_b16 v[110:111], v9 offset:36864
    s_add_u32 s95, s80, 1245184
    s_add_u32 m0, s81, 53248
    s_and_b32 s95, s95, 0x1f0000
    buffer_load_dwordx4 v245, s[64:67], s95 offen  lds
    ds_read_b64_tr_b16 v[112:113], v2 offset:57344
    ds_read_b64_tr_b16 v[114:115], v6 offset:57344
    ds_read_b64_tr_b16 v[116:117], v3 offset:57344
    ds_read_b64_tr_b16 v[118:119], v7 offset:57344
    ds_read_b64_tr_b16 v[120:121], v4 offset:57344
    ds_read_b64_tr_b16 v[122:123], v8 offset:57344
    ds_read_b64_tr_b16 v[124:125], v5 offset:57344
    s_add_u32 s95, s80, 1310720
    s_add_u32 m0, s81, 73728
    s_and_b32 s95, s95, 0x1f0000
    buffer_load_dwordx4 v245, s[64:67], s95 offen  lds
    ds_read_b64_tr_b16 v[126:127], v9 offset:57344
    ds_read_b64_tr_b16 v[128:129], v2 offset:61440
    ds_read_b64_tr_b16 v[130:131], v6 offset:61440
    ds_read_b64_tr_b16 v[132:133], v3 offset:61440
    ds_read_b64_tr_b16 v[134:135], v7 offset:61440
    ds_read_b64_tr_b16 v[136:137], v4 offset:61440
    s_add_u32 s95, s80, 1376256
    s_add_u32 m0, s81, 77824
    s_and_b32 s95, s95, 0x1f0000
    buffer_load_dwordx4 v245, s[64:67], s95 offen  lds
    ds_read_b64_tr_b16 v[138:139], v8 offset:61440
    ds_read_b64_tr_b16 v[140:141], v5 offset:61440
    ds_read_b64_tr_b16 v[142:143], v9 offset:61440
    ds_read_b64_tr_b16 v[144:145], v2 offset:16384
    ds_read_b64_tr_b16 v[146:147], v6 offset:16384
    ds_read_b64_tr_b16 v[148:149], v3 offset:16384
    ds_read_b64_tr_b16 v[150:151], v7 offset:16384
    s_add_u32 s95, s80, 1441792
    s_add_u32 m0, s81, 81920
    s_and_b32 s95, s95, 0x1f0000
    buffer_load_dwordx4 v245, s[64:67], s95 offen  lds
    ds_read_b64_tr_b16 v[152:153], v4 offset:16384
    ds_read_b64_tr_b16 v[154:155], v8 offset:16384
    ds_read_b64_tr_b16 v[156:157], v5 offset:16384
    ds_read_b64_tr_b16 v[158:159], v9 offset:16384
    ds_read_b64_tr_b16 v[160:161], v2 offset:20480
    ds_read_b64_tr_b16 v[162:163], v6 offset:20480
    s_add_u32 s95, s80, 1507328
    s_add_u32 m0, s81, 86016
    s_and_b32 s95, s95, 0x1f0000
    buffer_load_dwordx4 v245, s[64:67], s95 offen  lds
    ds_read_b64_tr_b16 v[164:165], v3 offset:20480
    ds_read_b64_tr_b16 v[166:167], v7 offset:20480
    ds_read_b64_tr_b16 v[168:169], v4 offset:20480
    ds_read_b64_tr_b16 v[170:171], v8 offset:20480
    ds_read_b64_tr_b16 v[172:173], v5 offset:20480
    ds_read_b64_tr_b16 v[174:175], v9 offset:20480
    s_waitcnt lgkmcnt(0)
    s_mov_b64 exec, 1
    ds_add_u32 v10, v11 offset:32
    s_mov_b64 exec, -1
    v_add_u32 v224, 65536, v2
    v_add_u32 v225, 65536, v3
    v_add_u32 v226, 65536, v4
    v_add_u32 v227, 65536, v5
    v_add_u32 v228, 65536, v6
    v_add_u32 v229, 65536, v7
    v_add_u32 v230, 65536, v8
    v_add_u32 v231, 65536, v9
    s_branch LB_s8_in
LB_s8:
    s_sleep 1
LB_s8_in:
    ds_read_b32 v14, v10 offset:32
    s_waitcnt lgkmcnt(0)
    v_readfirstlane_b32 s78, v14
    s_nop 0
    s_cmp_ge_u32 s78, 4
    s_cbranch_scc0 LB_s8
    s_add_u32 s95, s80, 1572864
    s_add_u32 m0, s81, 8192
    s_and_b32 s95, s95, 0x1f0000
    buffer_load_dwordx4 v245, s[64:67], s95 offen  lds
    s_add_u32 s95, s80, 1638400
    s_add_u32 m0, s81, 12288
    s_and_b32 s95, s95, 0x1f0000
    buffer_load_dwordx4 v245, s[64:67], s95 offen  lds
    s_add_u32 s95, s80, 1703936
    s_add_u32 m0, s81, 32768
    s_and_b32 s95, s95, 0x1f0000
    buffer_load_dwordx4 v245, s[64:67], s95 offen  lds
    s_add_u32 s95, s80, 1769472
    s_add_u32 m0, s81, 36864
    s_and_b32 s95, s95, 0x1f0000
    buffer_load_dwordx4 v245, s[64:67], s95 offen  lds
    s_add_u32 s95, s80, 1835008
    s_add_u32 m0, s81, 57344
    s_and_b32 s95, s95, 0x1f0000
    buffer_load_dwordx4 v245, s[64:67], s95 offen  lds
    s_add_u32 s95, s80, 1900544
    s_add_u32 m0, s81, 61440
    s_and_b32 s95, s95, 0x1f0000
    buffer_load_dwordx4 v245, s[64:67], s95 offen  lds
    s_add_u32 s95, s80, 1966080
    s_add_u32 m0, s81, 16384
    s_and_b32 s95, s95, 0x1f0000
    buffer_load_dwordx4 v245, s[64:67], s95 offen  lds
    s_add_u32 s95, s80, 2031616
    s_add_u32 m0, s81, 20480
    s_and_b32 s95, s95, 0x1f0000
    buffer_load_dwordx4 v245, s[64:67], s95 offen  lds
    s_waitcnt vmcnt(0)
    s_mov_b64 exec, 1
    ds_add_u32 v10, v11 offset:16
    s_mov_b64 exec, -1
    s_mov_b64 exec, 0xffffffff
    s_mov_b32 s79, 0
LB_po:
    buffer_load_dword v14, v247, s[52:55], s30 offen sc1
    s_add_u32 s79, s79, 1
    s_cmp_gt_u32 s79, 200000
    s_cbranch_scc1 LB_po_x
    s_waitcnt vmcnt(0)
    v_cmp_ne_u32 vcc, 1, v14
    s_cbranch_vccz LB_po_x
    s_mov_b64 exec, vcc
    s_sleep 8
    s_branch LB_po
LB_po_x:
    s_waitcnt vmcnt(0)
    s_mov_b64 exec, -1
    s_add_u32 s29, s32, 0
    s_and_b32 s29, s29, 0x7fff
    s_add_u32 s29, s29, s28
    buffer_load_dwordx4 v[176:179], v12, s[52:55], s29 offen offset:0 sc1
    s_add_u32 s31, s29, 32768
    buffer_load_dwordx4 v[180:183], v12, s[52:55], s31 offen offset:0 sc1
    buffer_load_dwordx4 v[184:187], v12, s[52:55], s29 offen offset:1024 sc1
    buffer_load_dwordx4 v[188:191], v12, s[52:55], s31 offen offset:1024 sc1
    buffer_load_dwordx4 v[192:195], v12, s[52:55], s29 offen offset:2048 sc1
    buffer_load_dwordx4 v[196:199], v12, s[52:55], s31 offen offset:2048 sc1
    buffer_load_dwordx4 v[200:203], v12, s[52:55], s29 offen offset:3072 sc1
    buffer_load_dwordx4 v[204:207], v12, s[52:55], s31 offen offset:3072 sc1
    s_add_u32 s29, s32, 4096
    s_and_b32 s29, s29, 0x7fff
    s_add_u32 s29, s29, s28
    buffer_load_dwordx4 v[208:211], v12, s[52:55], s29 offen offset:0 sc1
    s_add_u32 s31, s29, 32768
    buffer_load_dwordx4 v[212:215], v12, s[52:55], s31 offen offset:0 sc1
    s_setprio 1
    s_branch LB_s4_in
LB_s4:
    s_sleep 1
LB_s4_in:
    ds_read_b32 v14, v10 offset:16
    s_waitcnt lgkmcnt(0)
    v_readfirstlane_b32 s78, v14
    s_nop 0
    s_cmp_ge_u32 s78, 4
    s_cbranch_scc0 LB_s4
    s_waitcnt vmcnt(8)
    v_mfma_f32_16x16x32_bf16 v[16:19], v[48:51], v[176:179], 0
    buffer_load_dwordx4 v[216:219], v12, s[52:55], s29 offen offset:1024 sc1
    v_mfma_f32_16x16x32_bf16 v[20:23], v[52:55], v[176:179], 0
    v_mfma_f32_16x16x32_bf16 v[24:27], v[56:59], v[176:179], 0
    v_mfma_f32_16x16x32_bf16 v[28:31], v[60:63], v[176:179], 0
    v_mfma_f32_16x16x32_bf16 v[32:35], v[48:51], v[180:183], 0
    buffer_load_dwordx4 v[220:223], v12, s[52:55], s31 offen offset:1024 sc1
    v_mfma_f32_16x16x32_bf16 v[36:39], v[52:55], v[180:183], 0
    v_mfma_f32_16x16x32_bf16 v[40:43], v[56:59], v[180:183], 0
    v_mfma_f32_16x16x32_bf16 v[44:47], v[60:63], v[180:183], 0
    s_waitcnt vmcnt(8)
    v_mfma_f32_16x16x32_bf16 v[16:19], v[64:67], v[184:187], v[16:19]
    buffer_load_dwordx4 v[176:179], v12, s[52:55], s29 offen offset:2048 sc1
    v_mfma_f32_16x16x32_bf16 v[20:23], v[68:71], v[184:187], v[20:23]
    v_mfma_f32_16x16x32_bf16 v[24:27], v[72:75], v[184:187], v[24:27]
    v_mfma_f32_16x16x32_bf16 v[28:31], v[76:79], v[184:187], v[28:31]
    v_mfma_f32_16x16x32_bf16 v[32:35], v[64:67], v[188:191], v[32:35]
    buffer_load_dwordx4 v[180:183], v12, s[52:55], s31 offen offset:2048 sc1
    v_mfma_f32_16x16x32_bf16 v[36:39], v[68:71], v[188:191], v[36:39]
    v_mfma_f32_16x16x32_bf16 v[40:43], v[72:75], v[188:191], v[40:43]
    v_mfma_f32_16x16x32_bf16 v[44:47], v[76:79], v[188:191], v[44:47]
    s_waitcnt vmcnt(8)
    v_mfma_f32_16x16x32_bf16 v[16:19], v[80:83], v[192:195], v[16:19]
    buffer_load_dwordx4 v[184:187], v12, s[52:55], s29 offen offset:3072 sc1
    v_mfma_f32_16x16x32_bf16 v[20:23], v[84:87], v[192:195], v[20:23]
    v_mfma_f32_16x16x32_bf16 v[24:27], v[88:91], v[192:195], v[24:27]
    v_mfma_f32_16x16x32_bf16 v[28:31], v[92:95], v[192:195], v[28:31]
    v_mfma_f32_16x16x32_bf16 v[32:35], v[80:83], v[196:199], v[32:35]
    buffer_load_dwordx4 v[188:191], v12, s[52:55], s31 offen offset:3072 sc1
    v_mfma_f32_16x16x32_bf16 v[36:39], v[84:87], v[196:199], v[36:39]
    v_mfma_f32_16x16x32_bf16 v[40:43], v[88:91], v[196:199], v[40:43]
    v_mfma_f32_16x16x32_bf16 v[44:47], v[92:95], v[196:199], v[44:47]
    s_waitcnt vmcnt(8)
    v_mfma_f32_16x16x32_bf16 v[16:19], v[96:99], v[200:203], v[16:19]
    s_add_u32 s29, s32, 8192
    v_mfma_f32_16x16x32_bf16 v[20:23], v[100:103], v[200:203], v[20:23]
    s_and_b32 s29, s29, 0x7fff
    v_mfma_f32_16x16x32_bf16 v[24:27], v[104:107], v[200:203], v[24:27]
    s_add_u32 s29, s29, s28
    v_mfma_f32_16x16x32_bf16 v[28:31], v[108:111], v[200:203], v[28:31]
    v_mfma_f32_16x16x32_bf16 v[32:35], v[96:99], v[204:207], v[32:35]
    buffer_load_dwordx4 v[192:195], v12, s[52:55], s29 offen offset:0 sc1
    v_mfma_f32_16x16x32_bf16 v[36:39], v[100:103], v[204:207], v[36:39]
    s_add_u32 s31, s29, 32768
    v_mfma_f32_16x16x32_bf16 v[40:43], v[104:107], v[204:207], v[40:43]
    buffer_load_dwordx4 v[196:199], v12, s[52:55], s31 offen offset:0 sc1
    v_mfma_f32_16x16x32_bf16 v[44:47], v[108:111], v[204:207], v[44:47]
    s_waitcnt vmcnt(8)
    v_mfma_f32_16x16x32_bf16 v[16:19], v[112:115], v[208:211], v[16:19]
    buffer_load_dwordx4 v[200:203], v12, s[52:55], s29 offen offset:1024 sc1
    v_mfma_f32_16x16x32_bf16 v[20:23], v[116:119], v[208:211], v[20:23]
    v_mfma_f32_16x16x32_bf16 v[24:27], v[120:123], v[208:211], v[24:27]
    v_mfma_f32_16x16x32_bf16 v[28:31], v[124:127], v[208:211], v[28:31]
    v_mfma_f32_16x16x32_bf16 v[32:35], v[112:115], v[212:215], v[32:35]
    buffer_load_dwordx4 v[204:207], v12, s[52:55], s31 offen offset:1024 sc1
    v_mfma_f32_16x16x32_bf16 v[36:39], v[116:119], v[212:215], v[36:39]
    v_mfma_f32_16x16x32_bf16 v[40:43], v[120:123], v[212:215], v[40:43]
    v_mfma_f32_16x16x32_bf16 v[44:47], v[124:127], v[212:215], v[44:47]
    s_waitcnt vmcnt(8)
    v_mfma_f32_16x16x32_bf16 v[16:19], v[128:131], v[216:219], v[16:19]
    buffer_load_dwordx4 v[208:211], v12, s[52:55], s29 offen offset:2048 sc1
    v_mfma_f32_16x16x32_bf16 v[20:23], v[132:135], v[216:219], v[20:23]
    v_mfma_f32_16x16x32_bf16 v[24:27], v[136:139], v[216:219], v[24:27]
    v_mfma_f32_16x16x32_bf16 v[28:31], v[140:143], v[216:219], v[28:31]
    v_mfma_f32_16x16x32_bf16 v[32:35], v[128:131], v[220:223], v[32:35]
    buffer_load_dwordx4 v[212:215], v12, s[52:55], s31 offen offset:2048 sc1
    v_mfma_f32_16x16x32_bf16 v[36:39], v[132:135], v[220:223], v[36:39]
    v_mfma_f32_16x16x32_bf16 v[40:43], v[136:139], v[220:223], v[40:43]
    v_mfma_f32_16x16x32_bf16 v[44:47], v[140:143], v[220:223], v[44:47]
    s_waitcnt vmcnt(8)
    v_mfma_f32_16x16x32_bf16 v[16:19], v[144:147], v[176:179], v[16:19]
    buffer_load_dwordx4 v[216:219], v12, s[52:55], s29 offen offset:3072 sc1
    buffer_load_dwordx4 v[220:223], v12, s[52:55], s31 offen offset:3072 sc1
    v_mfma_f32_16x16x32_bf16 v[20:23], v[148:151], v[176:179], v[20:23]
    ds_read_b64_tr_b16 v[48:49], v2 offset:40960
    v_mfma_f32_16x16x32_bf16 v[24:27], v[152:155], v[176:179], v[24:27]
    ds_read_b64_tr_b16 v[50:51], v6 offset:40960
    v_mfma_f32_16x16x32_bf16 v[28:31], v[156:159], v[176:179], v[28:31]
    ds_read_b64_tr_b16 v[52:53], v3 offset:40960
    v_mfma_f32_16x16x32_bf16 v[32:35], v[144:147], v[180:183], v[32:35]
    ds_read_b64_tr_b16 v[54:55], v7 offset:40960
    ds_read_b64_tr_b16 v[56:57], v4 offset:40960
    v_mfma_f32_16x16x32_bf16 v[36:39], v[148:151], v[180:183], v[36:39]
    ds_read_b64_tr_b16 v[58:59], v8 offset:40960
    v_mfma_f32_16x16x32_bf16 v[40:43], v[152:155], v[180:183], v[40:43]
    ds_read_b64_tr_b16 v[60:61], v5 offset:40960
    v_mfma_f32_16x16x32_bf16 v[44:47], v[156:159], v[180:183], v[44:47]
    ds_read_b64_tr_b16 v[62:63], v9 offset:40960
    s_waitcnt vmcnt(8)
    v_mfma_f32_16x16x32_bf16 v[16:19], v[160:163], v[184:187], v[16:19]
    s_add_u32 s29, s32, 12288
    s_and_b32 s29, s29, 0x7fff
    v_mfma_f32_16x16x32_bf16 v[20:23], v[164:167], v[184:187], v[20:23]
    s_add_u32 s29, s29, s28
    buffer_load_dwordx4 v[176:179], v12, s[52:55], s29 offen offset:0 sc1
    v_mfma_f32_16x16x32_bf16 v[24:27], v[168:171], v[184:187], v[24:27]
    s_add_u32 s31, s29, 32768
    buffer_load_dwordx4 v[180:183], v12, s[52:55], s31 offen offset:0 sc1
    v_mfma_f32_16x16x32_bf16 v[28:31], v[172:175], v[184:187], v[28:31]
    ds_read_b64_tr_b16 v[64:65], v2 offset:45056
    v_mfma_f32_16x16x32_bf16 v[32:35], v[160:163], v[188:191], v[32:35]
    ds_read_b64_tr_b16 v[66:67], v6 offset:45056
    ds_read_b64_tr_b16 v[68:69], v3 offset:45056
    v_mfma_f32_16x16x32_bf16 v[36:39], v[164:167], v[188:191], v[36:39]
    ds_read_b64_tr_b16 v[70:71], v7 offset:45056
    ds_read_b64_tr_b16 v[72:73], v4 offset:45056
    v_mfma_f32_16x16x32_bf16 v[40:43], v[168:171], v[188:191], v[40:43]
    ds_read_b64_tr_b16 v[74:75], v8 offset:45056
    ds_read_b64_tr_b16 v[76:77], v5 offset:45056
    v_mfma_f32_16x16x32_bf16 v[44:47], v[172:175], v[188:191], v[44:47]
    ds_read_b64_tr_b16 v[78:79], v9 offset:45056
    s_waitcnt vmcnt(8) lgkmcnt(8)
    v_mfma_f32_16x16x32_bf16 v[16:19], v[48:51], v[192:195], v[16:19]
    buffer_load_dwordx4 v[184:187], v12, s[52:55], s29 offen offset:1024 sc1
    buffer_load_dwordx4 v[188:191], v12, s[52:55], s31 offen offset:1024 sc1
    v_mfma_f32_16x16x32_bf16 v[20:23], v[52:55], v[192:195], v[20:23]
    ds_read_b64_tr_b16 v[80:81], v224 offset:0
    v_mfma_f32_16x16x32_bf16 v[24:27], v[56:59], v[192:195], v[24:27]
    ds_read_b64_tr_b16 v[82:83], v228 offset:0
    v_mfma_f32_16x16x32_bf16 v[28:31], v[60:63], v[192:195], v[28:31]
    ds_read_b64_tr_b16 v[84:85], v225 offset:0
    v_mfma_f32_16x16x32_bf16 v[32:35], v[48:51], v[196:199], v[32:35]
    ds_read_b64_tr_b16 v[86:87], v229 offset:0
    ds_read_b64_tr_b16 v[88:89], v226 offset:0
    v_mfma_f32_16x16x32_bf16 v[36:39], v[52:55], v[196:199], v[36:39]
    ds_read_b64_tr_b16 v[90:91], v230 offset:0
    v_mfma_f32_16x16x32_bf16 v[40:43], v[56:59], v[196:199], v[40:43]
    ds_read_b64_tr_b16 v[92:93], v227 offset:0
    v_mfma_f32_16x16x32_bf16 v[44:47], v[60:63], v[196:199], v[44:47]
    ds_read_b64_tr_b16 v[94:95], v231 offset:0
    s_waitcnt vmcnt(8) lgkmcnt(8)
    v_mfma_f32_16x16x32_bf16 v[16:19], v[64:67], v[200:203], v[16:19]
    buffer_load_dwordx4 v[192:195], v12, s[52:55], s29 offen offset:2048 sc1
    buffer_load_dwordx4 v[196:199], v12, s[52:55], s31 offen offset:2048 sc1
    v_mfma_f32_16x16x32_bf16 v[20:23], v[68:71], v[200:203], v[20:23]
    ds_read_b64_tr_b16 v[96:97], v224 offset:4096
    v_mfma_f32_16x16x32_bf16 v[24:27], v[72:75], v[200:203], v[24:27]
    ds_read_b64_tr_b16 v[98:99], v228 offset:4096
    v_mfma_f32_16x16x32_bf16 v[28:31], v[76:79], v[200:203], v[28:31]
    ds_read_b64_tr_b16 v[100:101], v225 offset:4096
    v_mfma_f32_16x16x32_bf16 v[32:35], v[64:67], v[204:207], v[32:35]
    ds_read_b64_tr_b16 v[102:103], v229 offset:4096
    ds_read_b64_tr_b16 v[104:105], v226 offset:4096
    v_mfma_f32_16x16x32_bf16 v[36:39], v[68:71], v[204:207], v[36:39]
    ds_read_b64_tr_b16 v[106:107], v230 offset:4096
    v_mfma_f32_16x16x32_bf16 v[40:43], v[72:75], v[204:207], v[40:43]
    ds_read_b64_tr_b16 v[108:109], v227 offset:4096
    v_mfma_f32_16x16x32_bf16 v[44:47], v[76:79], v[204:207], v[44:47]
    ds_read_b64_tr_b16 v[110:111], v231 offset:4096
    s_waitcnt vmcnt(8) lgkmcnt(8)
    v_mfma_f32_16x16x32_bf16 v[16:19], v[80:83], v[208:211], v[16:19]
    buffer_load_dwordx4 v[200:203], v12, s[52:55], s29 offen offset:3072 sc1
    buffer_load_dwordx4 v[204:207], v12, s[52:55], s31 offen offset:3072 sc1
    v_mfma_f32_16x16x32_bf16 v[20:23], v[84:87], v[208:211], v[20:23]
    ds_read_b64_tr_b16 v[112:113], v224 offset:55296
    v_mfma_f32_16x16x32_bf16 v[24:27], v[88:91], v[208:211], v[24:27]
    ds_read_b64_tr_b16 v[114:115], v228 offset:55296
    v_mfma_f32_16x16x32_bf16 v[28:31], v[92:95], v[208:211], v[28:31]
    ds_read_b64_tr_b16 v[116:117], v225 offset:55296
    v_mfma_f32_16x16x32_bf16 v[32:35], v[80:83], v[212:215], v[32:35]
    ds_read_b64_tr_b16 v[118:119], v229 offset:55296
    ds_read_b64_tr_b16 v[120:121], v226 offset:55296
    v_mfma_f32_16x16x32_bf16 v[36:39], v[84:87], v[212:215], v[36:39]
    ds_read_b64_tr_b16 v[122:123], v230 offset:55296
    v_mfma_f32_16x16x32_bf16 v[40:43], v[88:91], v[212:215], v[40:43]
    ds_read_b64_tr_b16 v[124:125], v227 offset:55296
    v_mfma_f32_16x16x32_bf16 v[44:47], v[92:95], v[212:215], v[44:47]
    ds_read_b64_tr_b16 v[126:127], v231 offset:55296
    s_waitcnt vmcnt(8) lgkmcnt(8)
    v_mfma_f32_16x16x32_bf16 v[16:19], v[96:99], v[216:219], v[16:19]
    s_add_u32 s29, s32, 16384
    s_and_b32 s29, s29, 0x7fff
    v_mfma_f32_16x16x32_bf16 v[20:23], v[100:103], v[216:219], v[20:23]
    s_add_u32 s29, s29, s28
    buffer_load_dwordx4 v[208:211], v12, s[52:55], s29 offen offset:0 sc1
    v_mfma_f32_16x16x32_bf16 v[24:27], v[104:107], v[216:219], v[24:27]
    s_add_u32 s31, s29, 32768
    buffer_load_dwordx4 v[212:215], v12, s[52:55], s31 offen offset:0 sc1
    v_mfma_f32_16x16x32_bf16 v[28:31], v[108:111], v[216:219], v[28:31]
    ds_read_b64_tr_b16 v[128:129], v224 offset:59392
    v_mfma_f32_16x16x32_bf16 v[32:35], v[96:99], v[220:223], v[32:35]
    ds_read_b64_tr_b16 v[130:131], v228 offset:59392
    ds_read_b64_tr_b16 v[132:133], v225 offset:59392
    v_mfma_f32_16x16x32_bf16 v[36:39], v[100:103], v[220:223], v[36:39]
    ds_read_b64_tr_b16 v[134:135], v229 offset:59392
    ds_read_b64_tr_b16 v[136:137], v226 offset:59392
    v_mfma_f32_16x16x32_bf16 v[40:43], v[104:107], v[220:223], v[40:43]
    ds_read_b64_tr_b16 v[138:139], v230 offset:59392
    ds_read_b64_tr_b16 v[140:141], v227 offset:59392
    v_mfma_f32_16x16x32_bf16 v[44:47], v[108:111], v[220:223], v[44:47]
    ds_read_b64_tr_b16 v[142:143], v231 offset:59392
    s_waitcnt vmcnt(8) lgkmcnt(8)
    v_mfma_f32_16x16x32_bf16 v[16:19], v[112:115], v[176:179], v[16:19]
    buffer_load_dwordx4 v[216:219], v12, s[52:55], s29 offen offset:1024 sc1
    buffer_load_dwordx4 v[220:223], v12, s[52:55], s31 offen offset:1024 sc1
    v_mfma_f32_16x16x32_bf16 v[20:23], v[116:119], v[176:179], v[20:23]
    ds_read_b64_tr_b16 v[144:145], v2 offset:0
    v_mfma_f32_16x16x32_bf16 v[24:27], v[120:123], v[176:179], v[24:27]
    ds_read_b64_tr_b16 v[146:147], v6 offset:0
    v_mfma_f32_16x16x32_bf16 v[28:31], v[124:127], v[176:179], v[28:31]
    ds_read_b64_tr_b16 v[148:149], v3 offset:0
    v_mfma_f32_16x16x32_bf16 v[32:35], v[112:115], v[180:183], v[32:35]
    ds_read_b64_tr_b16 v[150:151], v7 offset:0
    ds_read_b64_tr_b16 v[152:153], v4 offset:0
    v_mfma_f32_16x16x32_bf16 v[36:39], v[116:119], v[180:183], v[36:39]
    ds_read_b64_tr_b16 v[154:155], v8 offset:0
    v_mfma_f32_16x16x32_bf16 v[40:43], v[120:123], v[180:183], v[40:43]
    ds_read_b64_tr_b16 v[156:157], v5 offset:0
    v_mfma_f32_16x16x32_bf16 v[44:47], v[124:127], v[180:183], v[44:47]
    ds_read_b64_tr_b16 v[158:159], v9 offset:0
    s_waitcnt vmcnt(8) lgkmcnt(8)
    v_mfma_f32_16x16x32_bf16 v[16:19], v[128:131], v[184:187], v[16:19]
    buffer_load_dwordx4 v[176:179], v12, s[52:55], s29 offen offset:2048 sc1
    buffer_load_dwordx4 v[180:183], v12, s[52:55], s31 offen offset:2048 sc1
    v_mfma_f32_16x16x32_bf16 v[20:23], v[132:135], v[184:187], v[20:23]
    ds_read_b64_tr_b16 v[160:161], v2 offset:4096
    v_mfma_f32_16x16x32_bf16 v[24:27], v[136:139], v[184:187], v[24:27]
    ds_read_b64_tr_b16 v[162:163], v6 offset:4096
    v_mfma_f32_16x16x32_bf16 v[28:31], v[140:143], v[184:187], v[28:31]
    ds_read_b64_tr_b16 v[164:165], v3 offset:4096
    v_mfma_f32_16x16x32_bf16 v[32:35], v[128:131], v[188:191], v[32:35]
    ds_read_b64_tr_b16 v[166:167], v7 offset:4096
    ds_read_b64_tr_b16 v[168:169], v4 offset:4096
    v_mfma_f32_16x16x32_bf16 v[36:39], v[132:135], v[188:191], v[36:39]
    ds_read_b64_tr_b16 v[170:171], v8 offset:4096
    v_mfma_f32_16x16x32_bf16 v[40:43], v[136:139], v[188:191], v[40:43]
    ds_read_b64_tr_b16 v[172:173], v5 offset:4096
    v_mfma_f32_16x16x32_bf16 v[44:47], v[140:143], v[188:191], v[44:47]
    ds_read_b64_tr_b16 v[174:175], v9 offset:4096
    s_waitcnt vmcnt(8) lgkmcnt(8)
    v_mfma_f32_16x16x32_bf16 v[16:19], v[144:147], v[192:195], v[16:19]
    buffer_load_dwordx4 v[184:187], v12, s[52:55], s29 offen offset:3072 sc1
    buffer_load_dwordx4 v[188:191], v12, s[52:55], s31 offen offset:3072 sc1
    v_mfma_f32_16x16x32_bf16 v[20:23], v[148:151], v[192:195], v[20:23]
    ds_read_b64_tr_b16 v[48:49], v2 offset:24576
    v_mfma_f32_16x16x32_bf16 v[24:27], v[152:155], v[192:195], v[24:27]
    ds_read_b64_tr_b16 v[50:51], v6 offset:24576
    v_mfma_f32_16x16x32_bf16 v[28:31], v[156:159], v[192:195], v[28:31]
    ds_read_b64_tr_b16 v[52:53], v3 offset:24576
    v_mfma_f32_16x16x32_bf16 v[32:35], v[144:147], v[196:199], v[32:35]
    ds_read_b64_tr_b16 v[54:55], v7 offset:24576
    ds_read_b64_tr_b16 v[56:57], v4 offset:24576
    v_mfma_f32_16x16x32_bf16 v[36:39], v[148:151], v[196:199], v[36:39]
    ds_read_b64_tr_b16 v[58:59], v8 offset:24576
    v_mfma_f32_16x16x32_bf16 v[40:43], v[152:155], v[196:199], v[40:43]
    ds_read_b64_tr_b16 v[60:61], v5 offset:24576
    v_mfma_f32_16x16x32_bf16 v[44:47], v[156:159], v[196:199], v[44:47]
    ds_read_b64_tr_b16 v[62:63], v9 offset:24576
    s_waitcnt vmcnt(8) lgkmcnt(8)
    v_mfma_f32_16x16x32_bf16 v[16:19], v[160:163], v[200:203], v[16:19]
    s_add_u32 s29, s32, 20480
    s_and_b32 s29, s29, 0x7fff
    v_mfma_f32_16x16x32_bf16 v[20:23], v[164:167], v[200:203], v[20:23]
    s_add_u32 s29, s29, s28
    buffer_load_dwordx4 v[192:195], v12, s[52:55], s29 offen offset:0 sc1
    v_mfma_f32_16x16x32_bf16 v[24:27], v[168:171], v[200:203], v[24:27]
    s_add_u32 s31, s29, 32768
    buffer_load_dwordx4 v[196:199], v12, s[52:55], s31 offen offset:0 sc1
    v_mfma_f32_16x16x32_bf16 v[28:31], v[172:175], v[200:203], v[28:31]
    ds_read_b64_tr_b16 v[64:65], v2 offset:28672
    v_mfma_f32_16x16x32_bf16 v[32:35], v[160:163], v[204:207], v[32:35]
    ds_read_b64_tr_b16 v[66:67], v6 offset:28672
    ds_read_b64_tr_b16 v[68:69], v3 offset:28672
    v_mfma_f32_16x16x32_bf16 v[36:39], v[164:167], v[204:207], v[36:39]
    ds_read_b64_tr_b16 v[70:71], v7 offset:28672
    ds_read_b64_tr_b16 v[72:73], v4 offset:28672
    v_mfma_f32_16x16x32_bf16 v[40:43], v[168:171], v[204:207], v[40:43]
    ds_read_b64_tr_b16 v[74:75], v8 offset:28672
    ds_read_b64_tr_b16 v[76:77], v5 offset:28672
    v_mfma_f32_16x16x32_bf16 v[44:47], v[172:175], v[204:207], v[44:47]
    ds_read_b64_tr_b16 v[78:79], v9 offset:28672
    s_waitcnt vmcnt(8) lgkmcnt(8)
    v_mfma_f32_16x16x32_bf16 v[16:19], v[48:51], v[208:211], v[16:19]
    buffer_load_dwordx4 v[200:203], v12, s[52:55], s29 offen offset:1024 sc1
    buffer_load_dwordx4 v[204:207], v12, s[52:55], s31 offen offset:1024 sc1
    v_mfma_f32_16x16x32_bf16 v[20:23], v[52:55], v[208:211], v[20:23]
    ds_read_b64_tr_b16 v[80:81], v2 offset:49152
    v_mfma_f32_16x16x32_bf16 v[24:27], v[56:59], v[208:211], v[24:27]
    ds_read_b64_tr_b16 v[82:83], v6 offset:49152
    v_mfma_f32_16x16x32_bf16 v[28:31], v[60:63], v[208:211], v[28:31]
    ds_read_b64_tr_b16 v[84:85], v3 offset:49152
    v_mfma_f32_16x16x32_bf16 v[32:35], v[48:51], v[212:215], v[32:35]
    ds_read_b64_tr_b16 v[86:87], v7 offset:49152
    ds_read_b64_tr_b16 v[88:89], v4 offset:49152
    v_mfma_f32_16x16x32_bf16 v[36:39], v[52:55], v[212:215], v[36:39]
    ds_read_b64_tr_b16 v[90:91], v8 offset:49152
    v_mfma_f32_16x16x32_bf16 v[40:43], v[56:59], v[212:215], v[40:43]
    ds_read_b64_tr_b16 v[92:93], v5 offset:49152
    v_mfma_f32_16x16x32_bf16 v[44:47], v[60:63], v[212:215], v[44:47]
    ds_read_b64_tr_b16 v[94:95], v9 offset:49152
    s_waitcnt vmcnt(8) lgkmcnt(8)
    v_mfma_f32_16x16x32_bf16 v[16:19], v[64:67], v[216:219], v[16:19]
    buffer_load_dwordx4 v[208:211], v12, s[52:55], s29 offen offset:2048 sc1
    buffer_load_dwordx4 v[212:215], v12, s[52:55], s31 offen offset:2048 sc1
    v_mfma_f32_16x16x32_bf16 v[20:23], v[68:71], v[216:219], v[20:23]
    ds_read_b64_tr_b16 v[96:97], v2 offset:53248
    v_mfma_f32_16x16x32_bf16 v[24:27], v[72:75], v[216:219], v[24:27]
    ds_read_b64_tr_b16 v[98:99], v6 offset:53248
    v_mfma_f32_16x16x32_bf16 v[28:31], v[76:79], v[216:219], v[28:31]
    ds_read_b64_tr_b16 v[100:101], v3 offset:53248
    v_mfma_f32_16x16x32_bf16 v[32:35], v[64:67], v[220:223], v[32:35]
    ds_read_b64_tr_b16 v[102:103], v7 offset:53248
    ds_read_b64_tr_b16 v[104:105], v4 offset:53248
    v_mfma_f32_16x16x32_bf16 v[36:39], v[68:71], v[220:223], v[36:39]
    ds_read_b64_tr_b16 v[106:107], v8 offset:53248
    v_mfma_f32_16x16x32_bf16 v[40:43], v[72:75], v[220:223], v[40:43]
    ds_read_b64_tr_b16 v[108:109], v5 offset:53248
    v_mfma_f32_16x16x32_bf16 v[44:47], v[76:79], v[220:223], v[44:47]
    ds_read_b64_tr_b16 v[110:111], v9 offset:53248
    s_waitcnt vmcnt(8) lgkmcnt(8)
    v_mfma_f32_16x16x32_bf16 v[16:19], v[80:83], v[176:179], v[16:19]
    buffer_load_dwordx4 v[216:219], v12, s[52:55], s29 offen offset:3072 sc1
    buffer_load_dwordx4 v[220:223], v12, s[52:55], s31 offen offset:3072 sc1
    v_mfma_f32_16x16x32_bf16 v[20:23], v[84:87], v[176:179], v[20:23]
    ds_read_b64_tr_b16 v[112:113], v224 offset:8192
    v_mfma_f32_16x16x32_bf16 v[24:27], v[88:91], v[176:179], v[24:27]
    ds_read_b64_tr_b16 v[114:115], v228 offset:8192
    v_mfma_f32_16x16x32_bf16 v[28:31], v[92:95], v[176:179], v[28:31]
    ds_read_b64_tr_b16 v[116:117], v225 offset:8192
    v_mfma_f32_16x16x32_bf16 v[32:35], v[80:83], v[180:183], v[32:35]
    ds_read_b64_tr_b16 v[118:119], v229 offset:8192
    ds_read_b64_tr_b16 v[120:121], v226 offset:8192
    v_mfma_f32_16x16x32_bf16 v[36:39], v[84:87], v[180:183], v[36:39]
    ds_read_b64_tr_b16 v[122:123], v230 offset:8192
    v_mfma_f32_16x16x32_bf16 v[40:43], v[88:91], v[180:183], v[40:43]
    ds_read_b64_tr_b16 v[124:125], v227 offset:8192
    v_mfma_f32_16x16x32_bf16 v[44:47], v[92:95], v[180:183], v[44:47]
    ds_read_b64_tr_b16 v[126:127], v231 offset:8192
    s_waitcnt vmcnt(8) lgkmcnt(8)
    v_mfma_f32_16x16x32_bf16 v[16:19], v[96:99], v[184:187], v[16:19]
    s_add_u32 s29, s32, 24576
    s_and_b32 s29, s29, 0x7fff
    v_mfma_f32_16x16x32_bf16 v[20:23], v[100:103], v[184:187], v[20:23]
    s_add_u32 s29, s29, s28
    buffer_load_dwordx4 v[176:179], v12, s[52:55], s29 offen offset:0 sc1
    v_mfma_f32_16x16x32_bf16 v[24:27], v[104:107], v[184:187], v[24:27]
    s_add_u32 s31, s29, 32768
    buffer_load_dwordx4 v[180:183], v12, s[52:55], s31 offen offset:0 sc1
    v_mfma_f32_16x16x32_bf16 v[28:31], v[108:111], v[184:187], v[28:31]
    ds_read_b64_tr_b16 v[128:129], v224 offset:12288
    v_mfma_f32_16x16x32_bf16 v[32:35], v[96:99], v[188:191], v[32:35]
    ds_read_b64_tr_b16 v[130:131], v228 offset:12288
    ds_read_b64_tr_b16 v[132:133], v225 offset:12288
    v_mfma_f32_16x16x32_bf16 v[36:39], v[100:103], v[188:191], v[36:39]
    ds_read_b64_tr_b16 v[134:135], v229 offset:12288
    ds_read_b64_tr_b16 v[136:137], v226 offset:12288
    v_mfma_f32_16x16x32_bf16 v[40:43], v[104:107], v[188:191], v[40:43]
    ds_read_b64_tr_b16 v[138:139], v230 offset:12288
    ds_read_b64_tr_b16 v[140:141], v227 offset:12288
    v_mfma_f32_16x16x32_bf16 v[44:47], v[108:111], v[188:191], v[44:47]
    ds_read_b64_tr_b16 v[142:143], v231 offset:12288
    s_waitcnt vmcnt(8) lgkmcnt(8)
    s_mov_b64 exec, 1
    ds_add_u32 v10, v11 offset:28
    s_mov_b64 exec, -1
    v_mfma_f32_16x16x32_bf16 v[16:19], v[112:115], v[192:195], v[16:19]
    buffer_load_dwordx4 v[184:187], v12, s[52:55], s29 offen offset:1024 sc1
    buffer_load_dwordx4 v[188:191], v12, s[52:55], s31 offen offset:1024 sc1
    v_mfma_f32_16x16x32_bf16 v[20:23], v[116:119], v[192:195], v[20:23]
    ds_read_b64_tr_b16 v[144:145], v224 offset:16384
    v_mfma_f32_16x16x32_bf16 v[24:27], v[120:123], v[192:195], v[24:27]
    ds_read_b64_tr_b16 v[146:147], v228 offset:16384
    v_mfma_f32_16x16x32_bf16 v[28:31], v[124:127], v[192:195], v[28:31]
    ds_read_b64_tr_b16 v[148:149], v225 offset:16384
    v_mfma_f32_16x16x32_bf16 v[32:35], v[112:115], v[196:199], v[32:35]
    ds_read_b64_tr_b16 v[150:151], v229 offset:16384
    ds_read_b64_tr_b16 v[152:153], v226 offset:16384
    v_mfma_f32_16x16x32_bf16 v[36:39], v[116:119], v[196:199], v[36:39]
    ds_read_b64_tr_b16 v[154:155], v230 offset:16384
    v_mfma_f32_16x16x32_bf16 v[40:43], v[120:123], v[196:199], v[40:43]
    ds_read_b64_tr_b16 v[156:157], v227 offset:16384
    v_mfma_f32_16x16x32_bf16 v[44:47], v[124:127], v[196:199], v[44:47]
    ds_read_b64_tr_b16 v[158:159], v231 offset:16384
    s_waitcnt vmcnt(8) lgkmcnt(9)
    v_mfma_f32_16x16x32_bf16 v[16:19], v[128:131], v[200:203], v[16:19]
    buffer_load_dwordx4 v[192:195], v12, s[52:55], s29 offen offset:2048 sc1
    buffer_load_dwordx4 v[196:199], v12, s[52:55], s31 offen offset:2048 sc1
    v_mfma_f32_16x16x32_bf16 v[20:23], v[132:135], v[200:203], v[20:23]
    ds_read_b64_tr_b16 v[160:161], v224 offset:20480
    v_mfma_f32_16x16x32_bf16 v[24:27], v[136:139], v[200:203], v[24:27]
    ds_read_b64_tr_b16 v[162:163], v228 offset:20480
    v_mfma_f32_16x16x32_bf16 v[28:31], v[140:143], v[200:203], v[28:31]
    ds_read_b64_tr_b16 v[164:165], v225 offset:20480
    v_mfma_f32_16x16x32_bf16 v[32:35], v[128:131], v[204:207], v[32:35]
    ds_read_b64_tr_b16 v[166:167], v229 offset:20480
    ds_read_b64_tr_b16 v[168:169], v226 offset:20480
    v_mfma_f32_16x16x32_bf16 v[36:39], v[132:135], v[204:207], v[36:39]
    ds_read_b64_tr_b16 v[170:171], v230 offset:20480
    v_mfma_f32_16x16x32_bf16 v[40:43], v[136:139], v[204:207], v[40:43]
    ds_read_b64_tr_b16 v[172:173], v227 offset:20480
    v_mfma_f32_16x16x32_bf16 v[44:47], v[140:143], v[204:207], v[44:47]
    ds_read_b64_tr_b16 v[174:175], v231 offset:20480
    s_waitcnt vmcnt(8) lgkmcnt(8)
    v_mfma_f32_16x16x32_bf16 v[16:19], v[144:147], v[208:211], v[16:19]
    buffer_load_dwordx4 v[200:203], v12, s[52:55], s29 offen offset:3072 sc1
    buffer_load_dwordx4 v[204:207], v12, s[52:55], s31 offen offset:3072 sc1
    v_mfma_f32_16x16x32_bf16 v[20:23], v[148:151], v[208:211], v[20:23]
    ds_read_b64_tr_b16 v[48:49], v2 offset:8192
    v_mfma_f32_16x16x32_bf16 v[24:27], v[152:155], v[208:211], v[24:27]
    ds_read_b64_tr_b16 v[50:51], v6 offset:8192
    v_mfma_f32_16x16x32_bf16 v[28:31], v[156:159], v[208:211], v[28:31]
    ds_read_b64_tr_b16 v[52:53], v3 offset:8192
    v_mfma_f32_16x16x32_bf16 v[32:35], v[144:147], v[212:215], v[32:35]
    ds_read_b64_tr_b16 v[54:55], v7 offset:8192
    ds_read_b64_tr_b16 v[56:57], v4 offset:8192
    v_mfma_f32_16x16x32_bf16 v[36:39], v[148:151], v[212:215], v[36:39]
    ds_read_b64_tr_b16 v[58:59], v8 offset:8192
    v_mfma_f32_16x16x32_bf16 v[40:43], v[152:155], v[212:215], v[40:43]
    ds_read_b64_tr_b16 v[60:61], v5 offset:8192
    v_mfma_f32_16x16x32_bf16 v[44:47], v[156:159], v[212:215], v[44:47]
    ds_read_b64_tr_b16 v[62:63], v9 offset:8192
    s_waitcnt vmcnt(8) lgkmcnt(8)
    v_mfma_f32_16x16x32_bf16 v[16:19], v[160:163], v[216:219], v[16:19]
    s_add_u32 s29, s32, 28672
    s_and_b32 s29, s29, 0x7fff
    v_mfma_f32_16x16x32_bf16 v[20:23], v[164:167], v[216:219], v[20:23]
    s_add_u32 s29, s29, s28
    buffer_load_dwordx4 v[208:211], v12, s[52:55], s29 offen offset:0 sc1
    v_mfma_f32_16x16x32_bf16 v[24:27], v[168:171], v[216:219], v[24:27]
    s_add_u32 s31, s29, 32768
    buffer_load_dwordx4 v[212:215], v12, s[52:55], s31 offen offset:0 sc1
    v_mfma_f32_16x16x32_bf16 v[28:31], v[172:175], v[216:219], v[28:31]
    ds_read_b64_tr_b16 v[64:65], v2 offset:12288
    v_mfma_f32_16x16x32_bf16 v[32:35], v[160:163], v[220:223], v[32:35]
    ds_read_b64_tr_b16 v[66:67], v6 offset:12288
    ds_read_b64_tr_b16 v[68:69], v3 offset:12288
    v_mfma_f32_16x16x32_bf16 v[36:39], v[164:167], v[220:223], v[36:39]
    ds_read_b64_tr_b16 v[70:71], v7 offset:12288
    ds_read_b64_tr_b16 v[72:73], v4 offset:12288
    v_mfma_f32_16x16x32_bf16 v[40:43], v[168:171], v[220:223], v[40:43]
    ds_read_b64_tr_b16 v[74:75], v8 offset:12288
    ds_read_b64_tr_b16 v[76:77], v5 offset:12288
    v_mfma_f32_16x16x32_bf16 v[44:47], v[172:175], v[220:223], v[44:47]
    ds_read_b64_tr_b16 v[78:79], v9 offset:12288
    s_waitcnt vmcnt(8) lgkmcnt(8)
    v_mfma_f32_16x16x32_bf16 v[16:19], v[48:51], v[176:179], v[16:19]
    buffer_load_dwordx4 v[216:219], v12, s[52:55], s29 offen offset:1024 sc1
    buffer_load_dwordx4 v[220:223], v12, s[52:55], s31 offen offset:1024 sc1
    v_mfma_f32_16x16x32_bf16 v[20:23], v[52:55], v[176:179], v[20:23]
    ds_read_b64_tr_b16 v[80:81], v2 offset:32768
    v_mfma_f32_16x16x32_bf16 v[24:27], v[56:59], v[176:179], v[24:27]
    ds_read_b64_tr_b16 v[82:83], v6 offset:32768
    v_mfma_f32_16x16x32_bf16 v[28:31], v[60:63], v[176:179], v[28:31]
    ds_read_b64_tr_b16 v[84:85], v3 offset:32768
    v_mfma_f32_16x16x32_bf16 v[32:35], v[48:51], v[180:183], v[32:35]
    ds_read_b64_tr_b16 v[86:87], v7 offset:32768
    ds_read_b64_tr_b16 v[88:89], v4 offset:32768
    v_mfma_f32_16x16x32_bf16 v[36:39], v[52:55], v[180:183], v[36:39]
    ds_read_b64_tr_b16 v[90:91], v8 offset:32768
    v_mfma_f32_16x16x32_bf16 v[40:43], v[56:59], v[180:183], v[40:43]
    ds_read_b64_tr_b16 v[92:93], v5 offset:32768
    v_mfma_f32_16x16x32_bf16 v[44:47], v[60:63], v[180:183], v[44:47]
    ds_read_b64_tr_b16 v[94:95], v9 offset:32768
    s_waitcnt vmcnt(8) lgkmcnt(8)
    v_mfma_f32_16x16x32_bf16 v[16:19], v[64:67], v[184:187], v[16:19]
    buffer_load_dwordx4 v[176:179], v12, s[52:55], s29 offen offset:2048 sc1
    buffer_load_dwordx4 v[180:183], v12, s[52:55], s31 offen offset:2048 sc1
    v_mfma_f32_16x16x32_bf16 v[20:23], v[68:71], v[184:187], v[20:23]
    ds_read_b64_tr_b16 v[96:97], v2 offset:36864
    v_mfma_f32_16x16x32_bf16 v[24:27], v[72:75], v[184:187], v[24:27]
    ds_read_b64_tr_b16 v[98:99], v6 offset:36864
    v_mfma_f32_16x16x32_bf16 v[28:31], v[76:79], v[184:187], v[28:31]
    ds_read_b64_tr_b16 v[100:101], v3 offset:36864
    v_mfma_f32_16x16x32_bf16 v[32:35], v[64:67], v[188:191], v[32:35]
    ds_read_b64_tr_b16 v[102:103], v7 offset:36864
    ds_read_b64_tr_b16 v[104:105], v4 offset:36864
    v_mfma_f32_16x16x32_bf16 v[36:39], v[68:71], v[188:191], v[36:39]
    ds_read_b64_tr_b16 v[106:107], v8 offset:36864
    v_mfma_f32_16x16x32_bf16 v[40:43], v[72:75], v[188:191], v[40:43]
    ds_read_b64_tr_b16 v[108:109], v5 offset:36864
    v_mfma_f32_16x16x32_bf16 v[44:47], v[76:79], v[188:191], v[44:47]
    ds_read_b64_tr_b16 v[110:111], v9 offset:36864
    s_waitcnt vmcnt(8) lgkmcnt(8)
    v_mfma_f32_16x16x32_bf16 v[16:19], v[80:83], v[192:195], v[16:19]
    buffer_load_dwordx4 v[184:187], v12, s[52:55], s29 offen offset:3072 sc1
    buffer_load_dwordx4 v[188:191], v12, s[52:55], s31 offen offset:3072 sc1
    v_mfma_f32_16x16x32_bf16 v[20:23], v[84:87], v[192:195], v[20:23]
    ds_read_b64_tr_b16 v[112:113], v2 offset:57344
    v_mfma_f32_16x16x32_bf16 v[24:27], v[88:91], v[192:195], v[24:27]
    ds_read_b64_tr_b16 v[114:115], v6 offset:57344
    v_mfma_f32_16x16x32_bf16 v[28:31], v[92:95], v[192:195], v[28:31]
    ds_read_b64_tr_b16 v[116:117], v3 offset:57344
    v_mfma_f32_16x16x32_bf16 v[32:35], v[80:83], v[196:199], v[32:35]
    ds_read_b64_tr_b16 v[118:119], v7 offset:57344
    ds_read_b64_tr_b16 v[120:121], v4 offset:57344
    v_mfma_f32_16x16x32_bf16 v[36:39], v[84:87], v[196:199], v[36:39]
    ds_read_b64_tr_b16 v[122:123], v8 offset:57344
    v_mfma_f32_16x16x32_bf16 v[40:43], v[88:91], v[196:199], v[40:43]
    ds_read_b64_tr_b16 v[124:125], v5 offset:57344
    v_mfma_f32_16x16x32_bf16 v[44:47], v[92:95], v[196:199], v[44:47]
    ds_read_b64_tr_b16 v[126:127], v9 offset:57344
    s_waitcnt vmcnt(8) lgkmcnt(8)
    v_mfma_f32_16x16x32_bf16 v[16:19], v[96:99], v[200:203], v[16:19]
    ds_read_b64_tr_b16 v[128:129], v2 offset:61440
    v_mfma_f32_16x16x32_bf16 v[20:23], v[100:103], v[200:203], v[20:23]
    ds_read_b64_tr_b16 v[130:131], v6 offset:61440
    v_mfma_f32_16x16x32_bf16 v[24:27], v[104:107], v[200:203], v[24:27]
    ds_read_b64_tr_b16 v[132:133], v3 offset:61440
    v_mfma_f32_16x16x32_bf16 v[28:31], v[108:111], v[200:203], v[28:31]
    ds_read_b64_tr_b16 v[134:135], v7 offset:61440
    v_mfma_f32_16x16x32_bf16 v[32:35], v[96:99], v[204:207], v[32:35]
    ds_read_b64_tr_b16 v[136:137], v4 offset:61440
    v_mfma_f32_16x16x32_bf16 v[36:39], v[100:103], v[204:207], v[36:39]
    ds_read_b64_tr_b16 v[138:139], v8 offset:61440
    v_mfma_f32_16x16x32_bf16 v[40:43], v[104:107], v[204:207], v[40:43]
    ds_read_b64_tr_b16 v[140:141], v5 offset:61440
    v_mfma_f32_16x16x32_bf16 v[44:47], v[108:111], v[204:207], v[44:47]
    ds_read_b64_tr_b16 v[142:143], v9 offset:61440
    s_waitcnt vmcnt(6) lgkmcnt(8)
    v_mfma_f32_16x16x32_bf16 v[16:19], v[112:115], v[208:211], v[16:19]
    ds_read_b64_tr_b16 v[144:145], v2 offset:16384
    v_mfma_f32_16x16x32_bf16 v[20:23], v[116:119], v[208:211], v[20:23]
    ds_read_b64_tr_b16 v[146:147], v6 offset:16384
    v_mfma_f32_16x16x32_bf16 v[24:27], v[120:123], v[208:211], v[24:27]
    ds_read_b64_tr_b16 v[148:149], v3 offset:16384
    v_mfma_f32_16x16x32_bf16 v[28:31], v[124:127], v[208:211], v[28:31]
    ds_read_b64_tr_b16 v[150:151], v7 offset:16384
    v_mfma_f32_16x16x32_bf16 v[32:35], v[112:115], v[212:215], v[32:35]
    ds_read_b64_tr_b16 v[152:153], v4 offset:16384
    v_mfma_f32_16x16x32_bf16 v[36:39], v[116:119], v[212:215], v[36:39]
    ds_read_b64_tr_b16 v[154:155], v8 offset:16384
    v_mfma_f32_16x16x32_bf16 v[40:43], v[120:123], v[212:215], v[40:43]
    ds_read_b64_tr_b16 v[156:157], v5 offset:16384
    v_mfma_f32_16x16x32_bf16 v[44:47], v[124:127], v[212:215], v[44:47]
    ds_read_b64_tr_b16 v[158:159], v9 offset:16384
    s_waitcnt vmcnt(4) lgkmcnt(8)
    v_mfma_f32_16x16x32_bf16 v[16:19], v[128:131], v[216:219], v[16:19]
    ds_read_b64_tr_b16 v[160:161], v2 offset:20480
    v_mfma_f32_16x16x32_bf16 v[20:23], v[132:135], v[216:219], v[20:23]
    ds_read_b64_tr_b16 v[162:163], v6 offset:20480
    v_mfma_f32_16x16x32_bf16 v[24:27], v[136:139], v[216:219], v[24:27]
    ds_read_b64_tr_b16 v[164:165], v3 offset:20480
    v_mfma_f32_16x16x32_bf16 v[28:31], v[140:143], v[216:219], v[28:31]
    ds_read_b64_tr_b16 v[166:167], v7 offset:20480
    v_mfma_f32_16x16x32_bf16 v[32:35], v[128:131], v[220:223], v[32:35]
    ds_read_b64_tr_b16 v[168:169], v4 offset:20480
    v_mfma_f32_16x16x32_bf16 v[36:39], v[132:135], v[220:223], v[36:39]
    ds_read_b64_tr_b16 v[170:171], v8 offset:20480
    v_mfma_f32_16x16x32_bf16 v[40:43], v[136:139], v[220:223], v[40:43]
    ds_read_b64_tr_b16 v[172:173], v5 offset:20480
    v_mfma_f32_16x16x32_bf16 v[44:47], v[140:143], v[220:223], v[44:47]
    ds_read_b64_tr_b16 v[174:175], v9 offset:20480
    s_waitcnt vmcnt(2) lgkmcnt(8)
    v_mfma_f32_16x16x32_bf16 v[16:19], v[144:147], v[176:179], v[16:19]
    v_mfma_f32_16x16x32_bf16 v[20:23], v[148:151], v[176:179], v[20:23]
    v_mfma_f32_16x16x32_bf16 v[24:27], v[152:155], v[176:179], v[24:27]
    v_mfma_f32_16x16x32_bf16 v[28:31], v[156:159], v[176:179], v[28:31]
    v_mfma_f32_16x16x32_bf16 v[32:35], v[144:147], v[180:183], v[32:35]
    v_mfma_f32_16x16x32_bf16 v[36:39], v[148:151], v[180:183], v[36:39]
    v_mfma_f32_16x16x32_bf16 v[40:43], v[152:155], v[180:183], v[40:43]
    v_mfma_f32_16x16x32_bf16 v[44:47], v[156:159], v[180:183], v[44:47]
    s_waitcnt vmcnt(0) lgkmcnt(0)
    v_mfma_f32_16x16x32_bf16 v[16:19], v[160:163], v[184:187], v[16:19]
    v_mfma_f32_16x16x32_bf16 v[20:23], v[164:167], v[184:187], v[20:23]
    v_mfma_f32_16x16x32_bf16 v[24:27], v[168:171], v[184:187], v[24:27]
    v_mfma_f32_16x16x32_bf16 v[28:31], v[172:175], v[184:187], v[28:31]
    v_mfma_f32_16x16x32_bf16 v[32:35], v[160:163], v[188:191], v[32:35]
    v_mfma_f32_16x16x32_bf16 v[36:39], v[164:167], v[188:191], v[36:39]
    v_mfma_f32_16x16x32_bf16 v[40:43], v[168:171], v[188:191], v[40:43]
    v_mfma_f32_16x16x32_bf16 v[44:47], v[172:175], v[188:191], v[44:47]
    s_nop 0
    v_cvt_pk_bf16_f32 v48, v16, v17
    v_cvt_pk_bf16_f32 v49, v18, v19
    v_cvt_pk_bf16_f32 v50, v20, v21
    v_cvt_pk_bf16_f32 v51, v22, v23
    s_nop 0
    v_permlane16_swap_b32 v48, v50
    v_permlane16_swap_b32 v49, v51
    s_mov_b32 s95, 0
    buffer_store_dwordx4 v[48:51], v246, s[60:63], s95 offen offset:0 nt
    v_cvt_pk_bf16_f32 v52, v24, v25
    v_cvt_pk_bf16_f32 v53, v26, v27
    v_cvt_pk_bf16_f32 v54, v28, v29
    v_cvt_pk_bf16_f32 v55, v30, v31
    s_nop 0
    v_permlane16_swap_b32 v52, v54
    v_permlane16_swap_b32 v53, v55
    s_mov_b32 s95, 0
    buffer_store_dwordx4 v[52:55], v246, s[60:63], s95 offen offset:64 nt
    v_cvt_pk_bf16_f32 v56, v32, v33
    v_cvt_pk_bf16_f32 v57, v34, v35
    v_cvt_pk_bf16_f32 v58, v36, v37
    v_cvt_pk_bf16_f32 v59, v38, v39
    s_nop 0
    v_permlane16_swap_b32 v56, v58
    v_permlane16_swap_b32 v57, v59
    s_mov_b32 s95, 65536
    buffer_store_dwordx4 v[56:59], v246, s[60:63], s95 offen offset:0 nt
    v_cvt_pk_bf16_f32 v60, v40, v41
    v_cvt_pk_bf16_f32 v61, v42, v43
    v_cvt_pk_bf16_f32 v62, v44, v45
    v_cvt_pk_bf16_f32 v63, v46, v47
    s_nop 0
    v_permlane16_swap_b32 v60, v62
    v_permlane16_swap_b32 v61, v63
    s_mov_b32 s95, 65536
    buffer_store_dwordx4 v[60:63], v246, s[60:63], s95 offen offset:64 nt
    s_endpgm
LA_slow:
    s_mov_b32 s79, 0
    s_mov_b64 vcc, s[82:83]
LA_slow1:
    s_mov_b64 exec, vcc
    buffer_load_dword v136, v33, s[68:71], 0 offen sc1
    buffer_load_dword v137, v34, s[52:55], 0 offen sc1
    s_add_u32 s79, s79, 1
    s_cmp_gt_u32 s79, 200000
    s_waitcnt vmcnt(0)
    s_cbranch_scc1 LA_slow2
    v_cmp_ne_u32 vcc, v136, v137
    v_cmp_gt_u32 s[80:81], s96, v136
    s_nop 0
    s_or_b64 vcc, vcc, s[80:81]
    s_cbranch_vccz LA_slow2
    s_sleep 8
    s_branch LA_slow1
LA_slow2:
    s_mov_b64 exec, -1
    s_add_u32 m0, s86, 94208
    s_add_u32 s89, s91, 0
    buffer_load_dwordx4 v14, s[52:55], s89 offen sc1 lds
    s_add_u32 m0, s86, 98304
    s_add_u32 s89, s91, 4096
    buffer_load_dwordx4 v14, s[52:55], s89 offen sc1 lds
    s_add_u32 m0, s86, 102400
    s_add_u32 s89, s91, 8192
    buffer_load_dwordx4 v14, s[52:55], s89 offen sc1 lds
    s_add_u32 m0, s86, 106496
    s_add_u32 s89, s91, 12288
    buffer_load_dwordx4 v14, s[52:55], s89 offen sc1 lds
    buffer_load_dword v230, v229, s[64:67], 0 offen
    s_branch LA_back
LB_slow:
    s_mov_b32 s79, 0
LB_pt:
    buffer_load_dword v222, v220, s[68:71], s98 offen sc1
    s_add_u32 s79, s79, 1
    s_cmp_gt_u32 s79, 200000
    s_cbranch_scc1 LB_pt_x
    s_waitcnt vmcnt(0)
    v_cmp_gt_u32 vcc, 4096, v222
    s_cbranch_vccz LB_pt_x
    s_mov_b64 exec, vcc
    s_sleep 8
    s_branch LB_pt
LB_pt_x:
    s_waitcnt vmcnt(0)
    s_branch LB_back
L_end:
    s_endpgm
.section .rodata,"a"
.p2align 6
.amdhsa_kernel concat_heads__ssm_conv_h3__sliding_local_dilated__prompt_kernel
  .amdhsa_next_free_vgpr 256
  .amdhsa_next_free_sgpr 102
  .amdhsa_accum_offset 256
  .amdhsa_group_segment_fixed_size 0
  .amdhsa_kernarg_size 96
  .amdhsa_user_sgpr_count 2
  .amdhsa_user_sgpr_kernarg_segment_ptr 1
  .amdhsa_system_sgpr_workgroup_id_x 1
.end_amdhsa_kernel
```

```asm
; @launch grid=(256,1,1) block=(512,1,1) lds=163840
.amdgcn_target "amdgcn-amd-amdhsa--gfx950"
.text
.globl concat_heads__ssm_conv_h3__sliding_local_dilated__prompt_kernel
.p2align 8
.type concat_heads__ssm_conv_h3__sliding_local_dilated__prompt_kernel,@function
concat_heads__ssm_conv_h3__sliding_local_dilated__prompt_kernel:
    s_cmp_ge_u32 s2, 256
    s_cbranch_scc1 L_end
    s_load_dwordx4 s[16:19], s[0:1], 48
    s_load_dwordx8 s[4:11], s[0:1], 0
    s_load_dwordx4 s[12:15], s[0:1], 32
    s_load_dwordx8 s[20:27], s[0:1], 64
    v_lshrrev_b32 v1, 6, v0
    v_and_b32 v0, 63, v0
    v_readfirstlane_b32 s3, v1
    s_nop 0
    s_cmp_lg_u32 s3, 4
    s_cbranch_scc1 L_nopf
    s_getpc_b64 s[80:81]
L_pc:
    s_bfe_u32 s78, s2, 0x40003
    v_lshl_add_u32 v1, v0, 4, s78
    v_lshlrev_b32 v1, 7, v1
    v_cmp_gt_u32 vcc, L_end-L_pc, v1
    s_nop 0
    s_and_saveexec_b64 s[82:83], vcc
    global_load_dword v222, v1, s[80:81]
    s_mov_b64 exec, -1
L_nopf:
    s_and_b32 s78, s2, 7
    s_lshr_b32 s79, s2, 3
    s_lshl_b32 s78, s78, 2
    s_lshr_b32 s78, 0x76325410, s78
    s_and_b32 s78, s78, 7
    s_and_b32 s80, s78, 1
    s_lshl_b32 s80, s80, 3
    s_lshr_b32 s81, s78, 1
    s_lshl_b32 s81, s81, 2
    s_and_b32 s72, s79, 7
    s_add_u32 s72, s72, s80
    s_lshr_b32 s73, s79, 3
    s_xor_b32 s73, s73, 3
    s_add_u32 s73, s73, s81
    s_and_b32 s76, s79, 3
    s_add_u32 s76, s76, s81
    s_lshr_b32 s77, s79, 2
    s_add_u32 s77, s77, s80
    s_lshr_b32 s74, s79, 4
    s_xor_b32 s78, s78, 0
    s_lshl_b32 s78, s78, 1
    s_add_u32 s74, s74, s78
    s_and_b32 s75, s79, 15
    s_cmp_ge_u32 s3, 4
    s_cbranch_scc1 L_B
    v_lshrrev_b32 v5, 3, v0
    v_and_b32 v6, 7, v0
    v_lshrrev_b32 v7, 4, v0
    s_lshl_b32 s79, s72, 7
    s_lshl_b32 s80, s3, 5
    s_add_u32 s81, s79, s80
    v_xor_b32 v8, v7, v6
    v_lshlrev_b32 v8, 4, v8
    v_add_u32 v240, s81, v5
    v_lshl_add_u32 v240, v240, 11, v8
    v_xor_b32 v241, 64, v240
    v_add_u32 v241, 15360, v241
    v_add_u32 v242, 30720, v240
    v_add_u32 v243, 30720, v241
    s_and_b32 s78, s3, 1
    s_lshl_b32 s78, s78, 2
    s_lshl_b32 s80, s3, 3
    v_and_b32 v8, 1, v7
    v_lshl_or_b32 v8, v8, 1, s78
    v_xor_b32 v8, v8, v6
    v_lshlrev_b32 v8, 4, v8
    v_add_u32 v244, s80, v5
    v_mul_u32_u24 v244, 6144, v244
    s_lshl_b32 s82, s73, 7
    v_add3_u32 v244, v244, v8, s82
    v_add_u32 v245, 1024, v244
    v_add_u32 v246, 2048, v244
    s_lshl_b32 s78, s3, 1
    s_lshl_b32 s80, s3, 2
    s_add_u32 s79, s79, s80
    s_sub_u32 s79, s79, 16
    v_add_u32 v8, s78, v7
    v_xor_b32 v8, v8, v6
    v_and_b32 v8, 7, v8
    v_lshlrev_b32 v8, 4, v8
    v_add_u32 v3, s79, v5
    v_lshl_add_u32 v3, v3, 11, v8
    s_lshl_b32 s86, s3, 10
    s_lshl_b32 s87, s3, 12
    s_add_u32 s87, s87, 75776
    s_lshl_b32 s88, s3, 9
    s_add_u32 s88, s88, 73728
    s_and_b32 s98, s73, 0
    s_and_b32 s78, s72, 8
    s_add_u32 s98, s98, s78
    s_add_u32 s101, s72, s73
    s_and_b32 s101, s101, 3
    s_mov_b32 s82, 0x65832140
    s_mov_b32 s83, 0xfedba9c7
    s_cmp_eq_u32 s101, 1
    s_cselect_b32 s82, 0x69432501, s82
    s_cselect_b32 s83, 0xfecbad87, s83
    s_cmp_eq_u32 s101, 2
    s_cselect_b32 s82, 0xa5436102, s82
    s_cselect_b32 s83, 0xfdcbe987, s83
    s_cmp_eq_u32 s101, 3
    s_cselect_b32 s82, 0x65472103, s82
    s_cselect_b32 s83, 0xedcfa98b, s83
    s_bfe_u32 s62, s72, 0x10002
    s_mul_i32 s78, s62, 12288
    s_mul_i32 s79, s3, 3072
    s_add_u32 s60, s79, s78
    s_sub_u32 s61, s79, s78
    s_mul_i32 s62, s62, 196608
    s_sub_u32 s63, 196608, s62
    s_mov_b32 s30, 0x400000
    s_mov_b32 s31, 0x20000
    s_mov_b32 s34, 0x600000
    s_mov_b32 s35, 0x20000
    s_waitcnt lgkmcnt(0)
    s_mov_b64 s[28:29], s[16:17]
    s_mov_b64 s[32:33], s[18:19]
    s_mov_b64 s[0:1], s[82:83]
    s_add_u32 s97, s98, s0
    s_lshr_b64 s[0:1], s[0:1], 4
    s_and_b32 s97, s97, 15
    s_lshr_b32 s99, s97, 3
    s_xor_b32 s97, s97, s99
    s_add_u32 m0, s87, 0
    s_lshl_b32 s97, s97, 7
    buffer_load_dwordx4 v240, s[28:31], s97 offen offset:0  lds
    buffer_load_dwordx4 v241, s[28:31], s97 offen offset:1024  lds
    buffer_load_dwordx4 v242, s[28:31], s97 offen offset:2048  lds
    buffer_load_dwordx4 v243, s[28:31], s97 offen offset:3072  lds
    s_add_u32 m0, s88, 0
    s_mov_b64 exec, 0xffffffff
    buffer_load_dwordx4 v3, s[28:31], s97 offen offset:0  lds
    s_mov_b64 exec, -1
    s_mul_i32 s16, s97, 3072
    s_add_u32 m0, s60, 0
    s_add_u32 s99, s16, s62
    buffer_load_dwordx4 v244, s[32:35], s99 offen offset:0  lds
    buffer_load_dwordx4 v245, s[32:35], s99 offen offset:1024  lds
    buffer_load_dwordx4 v246, s[32:35], s99 offen offset:2048  lds
    s_add_u32 m0, s61, 12288
    s_add_u32 s16, s16, s63
    buffer_load_dwordx4 v244, s[32:35], s16 offen offset:0  lds
    buffer_load_dwordx4 v245, s[32:35], s16 offen offset:1024  lds
    buffer_load_dwordx4 v246, s[32:35], s16 offen offset:2048  lds
    s_add_u32 s97, s98, s0
    s_lshr_b64 s[0:1], s[0:1], 4
    s_and_b32 s97, s97, 15
    s_lshr_b32 s99, s97, 3
    s_xor_b32 s97, s97, s99
    s_add_u32 m0, s87, 18432
    s_lshl_b32 s97, s97, 7
    buffer_load_dwordx4 v240, s[28:31], s97 offen offset:0  lds
    s_mov_b32 s36, s6
    s_mov_b32 s37, s7
    s_mov_b32 s38, 0x400000
    s_mov_b32 s39, 0x20000
    s_mov_b32 s40, s8
    s_mov_b32 s41, s9
    s_mov_b32 s42, 0x400000
    s_mov_b32 s43, 0x20000
    s_mov_b32 s44, s10
    s_mov_b32 s45, s11
    s_mov_b32 s46, 0x2000
    s_mov_b32 s47, 0x20000
    s_mov_b32 s52, s26
    s_mov_b32 s53, s27
    s_mov_b32 s54, 0x1000000
    s_mov_b32 s55, 0x20000
    v_lshlrev_b32 v15, 4, v0
    v_and_b32 v7, 7, v0
    s_lshl_b32 s79, s74, 7
    v_lshl_add_u32 v7, v7, 4, s79
    s_lshl_b32 s78, s75, 7
    s_lshl_b32 s80, s3, 3
    s_add_u32 s80, s80, s78
    v_lshrrev_b32 v5, 3, v0
    s_and_b32 s79, s3, 1
    v_xor_b32 v5, s79, v5
    v_add_u32 v5, s80, v5
    v_lshl_add_u32 v10, v5, 11, v7
    s_xor_b32 s80, s3, 1
    s_add_u32 s80, s78, s80
    s_sub_u32 s80, s80, 4
    s_lshl_b32 s80, s80, 11
    v_add_u32 v11, s80, v7
    v_bfe_u32 v5, v0, 3, 2
    v_lshrrev_b32 v6, 5, v0
    s_lshl_b32 s80, s3, 5
    v_lshlrev_b32 v8, 3, v5
    v_lshl_add_u32 v8, v6, 2, v8
    v_add_u32 v8, s80, v8
    v_and_b32 v35, 7, v0
    v_lshlrev_b32 v16, 4, v35
    v_lshl_add_u32 v16, v8, 7, v16
    v_add_u32 v232, 129024, v16
    v_and_b32 v231, 1, v5
    v_lshl_add_u32 v16, v231, 7, v232
    v_xor_b32 v233, v231, v6
    v_xor_b32 v233, 1, v233
    v_lshl_add_u32 v232, v233, 7, v232
    v_xor_b32 v231, 128, v16
    v_xor_b32 v233, 128, v232
    v_lshrrev_b32 v33, 2, v35
    v_lshlrev_b32 v35, 6, v35
    v_lshl_add_u32 v35, v33, 4, v35
    v_add_u32 v35, 162816, v35
    v_add_u32 v8, s78, v8
    v_lshl_add_u32 v9, v8, 11, v7
    v_lshl_add_u32 v13, v8, 12, v7
    v_bfe_u32 v8, v0, 2, 1
    v_lshlrev_b32 v8, 1, v8
    v_add_u32 v8, v8, v6
    v_lshlrev_b32 v8, 16, v8
    v_lshl_add_u32 v8, v5, 6, v8
    v_and_b32 v7, 3, v0
    v_lshl_add_u32 v8, v7, 4, v8
    s_add_u32 s78, s78, s80
    s_lshl_b32 s78, s78, 3
    s_lshl_b32 s79, s74, 18
    s_add_u32 s78, s78, s79
    v_add_u32 v12, s78, v8
    s_mov_b32 s48, s12
    s_mov_b32 s49, s13
    s_mov_b32 s50, 0x400000
    s_mov_b32 s51, 0x20000
    s_mov_b32 s56, s4
    s_mov_b32 s57, s5
    s_mov_b32 s58, 0x400000
    s_mov_b32 s59, 0x20000
    s_mov_b32 s64, s20
    s_mov_b32 s65, s21
    s_mov_b32 s66, 0x200000
    s_mov_b32 s67, 0x20000
    s_lshl_b32 s91, s74, 4
    s_add_u32 s91, s91, s75
    s_lshr_b32 s78, s91, 3
    s_lshl_b32 s78, s78, 5
    s_and_b32 s79, s91, 7
    s_add_u32 s78, s78, s79
    s_lshl_b32 s79, s3, 3
    s_add_u32 s90, s78, s79
    s_lshl_b32 s91, s91, 14
    s_mov_b32 s96, 4096
    s_lshl_b32 s78, s90, 12
    v_lshl_add_u32 v228, v0, 7, s78
    s_lshr_b32 s78, s2, 3
    s_lshl_b32 s78, s78, 2
    s_add_u32 s78, s78, s3
    s_lshl_b32 s78, s78, 14
    s_and_b32 s79, s77, 8
    s_lshl_b32 s79, s79, 7
    s_add_u32 s78, s78, s79
    v_and_b32 v5, 7, v0
    v_lshlrev_b32 v5, 7, v5
    v_lshrrev_b32 v8, 3, v0
    v_lshl_add_u32 v5, v8, 11, v5
    v_add_u32 v229, s78, v5
    s_and_b32 s78, s73, 7
    s_cmp_eq_u32 s78, 3
    s_cselect_b32 s78, 0x40000000, 0
    v_or_b32 v229, s78, v229
    buffer_load_dwordx4 v241, s[28:31], s97 offen offset:1024  lds
    buffer_load_dwordx4 v242, s[28:31], s97 offen offset:2048  lds
    buffer_load_dwordx4 v243, s[28:31], s97 offen offset:3072  lds
    s_add_u32 m0, s88, 18432
    s_mov_b64 exec, 0xffffffff
    buffer_load_dwordx4 v3, s[28:31], s97 offen offset:0  lds
    s_mov_b64 exec, -1
    s_mul_i32 s16, s97, 3072
    s_add_u32 m0, s60, 24576
    s_add_u32 s99, s16, s62
    buffer_load_dwordx4 v244, s[32:35], s99 offen offset:0  lds
    buffer_load_dwordx4 v245, s[32:35], s99 offen offset:1024  lds
    s_cmp_eq_u32 s101, 1
    s_cbranch_scc1 LA_c1
    s_cmp_eq_u32 s101, 2
    s_cbranch_scc1 LA_c2
    s_cmp_eq_u32 s101, 3
    s_cbranch_scc1 LA_c3
LA_c0:
    s_waitcnt vmcnt(7)
    s_barrier
    buffer_load_dwordx4 v246, s[32:35], s99 offen offset:2048  lds
    s_add_u32 m0, s61, 36864
    s_add_u32 s16, s16, s63
    buffer_load_dwordx4 v244, s[32:35], s16 offen offset:0  lds
    buffer_load_dwordx4 v245, s[32:35], s16 offen offset:1024  lds
    buffer_load_dwordx4 v246, s[32:35], s16 offen offset:2048  lds
    s_add_u32 s97, s98, s0
    s_lshr_b64 s[0:1], s[0:1], 4
    s_and_b32 s97, s97, 15
    s_lshr_b32 s99, s97, 3
    s_xor_b32 s97, s97, s99
    s_add_u32 m0, s87, 36864
    s_lshl_b32 s97, s97, 7
    buffer_load_dwordx4 v240, s[28:31], s97 offen offset:0  lds
    buffer_load_dwordx4 v241, s[28:31], s97 offen offset:1024  lds
    buffer_load_dwordx4 v242, s[28:31], s97 offen offset:2048  lds
    buffer_load_dwordx4 v243, s[28:31], s97 offen offset:3072  lds
    s_add_u32 m0, s88, 36864
    s_mov_b64 exec, 0xffffffff
    buffer_load_dwordx4 v3, s[28:31], s97 offen offset:0  lds
    s_mov_b64 exec, -1
    s_mul_i32 s16, s97, 3072
    s_add_u32 m0, s60, 49152
    s_add_u32 s99, s16, s62
    buffer_load_dwordx4 v244, s[32:35], s99 offen offset:0  lds
    buffer_load_dwordx4 v245, s[32:35], s99 offen offset:1024  lds
    buffer_load_dwordx4 v246, s[32:35], s99 offen offset:2048  lds
    s_add_u32 m0, s61, 61440
    s_add_u32 s16, s16, s63
    buffer_load_dwordx4 v244, s[32:35], s16 offen offset:0  lds
    buffer_load_dwordx4 v245, s[32:35], s16 offen offset:1024  lds
    buffer_load_dwordx4 v246, s[32:35], s16 offen offset:2048  lds
    s_waitcnt vmcnt(11)
    s_barrier
    s_add_u32 m0, s86, 129536
    s_mov_b32 s89, 0
    buffer_load_dwordx4 v10, s[36:39], s89 offen nt lds
    s_mov_b32 s68, s24
    s_mov_b32 s69, s25
    s_mov_b32 s70, 0x100
    s_mov_b32 s71, 0x20000
    s_add_u32 m0, s86, 145920
    s_mov_b32 s89, 0
    buffer_load_dwordx4 v10, s[40:43], s89 offen nt lds
    v_lshrrev_b32 v6, 5, v0
    v_and_b32 v7, 3, v0
    s_lshr_b32 s78, s90, 1
    s_lshl_b32 s78, s78, 2
    s_add_u32 m0, s86, 133632
    s_mov_b32 s89, 65536
    buffer_load_dwordx4 v10, s[36:39], s89 offen nt lds
    s_load_dword s92, s[14:15], s78
    s_mul_i32 s94, s3, 8320
    s_add_u32 s94, s94, 129024
    v_bfe_u32 v5, v0, 2, 2
    s_add_u32 m0, s86, 150016
    s_mov_b32 s89, 65536
    buffer_load_dwordx4 v10, s[40:43], s89 offen nt lds
    v_lshlrev_b32 v5, 1, v5
    v_lshl_add_u32 v5, v6, 3, v5
    v_bfe_u32 v8, v0, 4, 1
    s_add_u32 m0, s86, 137728
    s_mov_b32 s89, 131072
    buffer_load_dwordx4 v10, s[36:39], s89 offen nt lds
    v_add_u32 v5, v5, v8
    s_and_b32 s78, s3, 1
    s_lshl_b32 s78, s78, 1
    v_add_u32 v8, s78, v6
    s_add_u32 m0, s86, 154112
    s_mov_b32 s89, 131072
    buffer_load_dwordx4 v10, s[40:43], s89 offen nt lds
    v_xor_b32 v8, v8, v7
    v_lshlrev_b32 v8, 4, v8
    v_lshl_add_u32 v5, v5, 6, v8
    v_add_u32 v14, s86, v5
    s_add_u32 m0, s86, 141824
    s_mov_b32 s89, 196608
    buffer_load_dwordx4 v10, s[36:39], s89 offen nt lds
    v_mov_b32 v18, 162304
    v_mov_b32 v19, 1
    v_and_b32 v5, 3, v0
    s_lshl_b32 s78, s74, 4
    s_add_u32 m0, s86, 158208
    s_mov_b32 s89, 196608
    buffer_load_dwordx4 v10, s[40:43], s89 offen nt lds
    s_add_u32 s78, s78, s3
    v_lshl_add_u32 v6, v5, 2, s78
    s_lshr_b32 s78, s76, 3
    s_mov_b64 exec, 0xff
    s_lshl_b32 s82, s3, 7
    s_add_u32 m0, s82, 129024
    s_mov_b32 s89, 0
    buffer_load_dwordx4 v11, s[36:39], s89 offen nt lds
    s_lshl_b32 s83, s74, 9
    s_add_u32 s83, s83, s82
    s_and_b32 s89, s3, 2
    s_lshl_b32 s89, s89, 3
    s_add_u32 s82, s82, s89
    s_add_u32 m0, s82, 162816
    s_add_u32 s89, s83, 0
    buffer_load_dwordx4 v15, s[44:47], s89 offen  lds
    s_mov_b64 exec, -1
    s_lshl_b32 s79, s3, 1
    s_add_u32 s78, s78, s79
    s_xor_b32 s78, s78, 0
    s_lshl_b32 s78, s78, 5
    s_add_u32 s97, s98, s0
    s_lshr_b64 s[0:1], s[0:1], 4
    s_and_b32 s97, s97, 15
    s_lshr_b32 s99, s97, 3
    s_xor_b32 s97, s97, s99
    s_add_u32 m0, s87, 0
    s_lshl_b32 s97, s97, 7
    buffer_load_dwordx4 v240, s[28:31], s97 offen offset:0  lds
    s_and_b32 s79, s76, 7
    s_add_u32 s78, s78, s79
    v_lshl_add_u32 v7, v5, 3, s78
    v_and_b32 v8, 4, v0
    buffer_load_dwordx4 v241, s[28:31], s97 offen offset:1024  lds
    v_cmp_eq_u32 vcc, 0, v8
    s_nop 1
    v_cndmask_b32 v6, v7, v6, vcc
    v_and_b32 v33, 0xf0, v6
    v_lshlrev_b32 v34, 8, v6
    buffer_load_dwordx4 v242, s[28:31], s97 offen offset:2048  lds
    v_add_u32 v34, 12582912, v34
    v_and_b32 v5, 15, v0
    v_lshrrev_b32 v6, 4, v0
    buffer_load_dwordx4 v243, s[28:31], s97 offen offset:3072  lds
    v_add_u32 v7, 9, v5
    v_and_b32 v8, 1, v7
    v_mul_u32_u24 v8, 4160, v8
    v_lshrrev_b32 v7, 1, v7
    s_add_u32 m0, s88, 0
    s_mov_b64 exec, 0xffffffff
    buffer_load_dwordx4 v3, s[28:31], s97 offen offset:0  lds
    s_mov_b64 exec, -1
    v_lshl_add_u32 v8, v7, 2, v8
    v_lshlrev_b32 v7, 4, v6
    v_sub_u32 v8, v8, v7
    s_add_u32 s78, s94, 32
    s_mul_i32 s16, s97, 3072
    s_add_u32 m0, s60, 0
    s_add_u32 s99, s16, s62
    buffer_load_dwordx4 v244, s[32:35], s99 offen offset:0  lds
    v_add_u32 v21, s78, v8
    v_add_u32 v22, 1024, v21
    v_add_u32 v23, 2048, v21
    v_add_u32 v24, 3072, v21
    buffer_load_dwordx4 v245, s[32:35], s99 offen offset:1024  lds
    v_lshl_add_u32 v7, v5, 1, v6
    v_add_u32 v7, 30, v7
    v_and_b32 v8, 1, v7
    s_waitcnt vmcnt(17)
    s_barrier
    buffer_load_dwordx4 v246, s[32:35], s99 offen offset:2048  lds
    v_bfe_u32 v136, v7, 1, 2
    v_lshl_add_u32 v136, v8, 2, v136
    v_lshlrev_b32 v136, 6, v136
    v_lshrrev_b32 v7, 3, v7
    s_add_u32 m0, s61, 12288
    s_add_u32 s16, s16, s63
    buffer_load_dwordx4 v244, s[32:35], s16 offen offset:0  lds
    v_lshl_add_u32 v136, v7, 9, v136
    v_bitop3_b32 v8, v7, 3, s3 bitop3:0x6a
    v_lshl_add_u32 v25, v8, 4, v136
    v_add_u32 v25, 92160, v25
    buffer_load_dwordx4 v245, s[32:35], s16 offen offset:1024  lds
    v_subrev_u32 v7, 1, v7
    v_bitop3_b32 v8, v7, 3, s3 bitop3:0x6a
    v_lshl_add_u32 v27, v8, 4, v136
    v_add_u32 v27, 91648, v27
    buffer_load_dwordx4 v246, s[32:35], s16 offen offset:2048  lds
    v_subrev_u32 v7, 1, v7
    v_bitop3_b32 v8, v7, 3, s3 bitop3:0x6a
    v_lshl_add_u32 v29, v8, 4, v136
    v_add_u32 v29, 91136, v29
    s_add_u32 s97, s98, s0
    s_lshr_b64 s[0:1], s[0:1], 4
    s_and_b32 s97, s97, 15
    s_lshr_b32 s99, s97, 3
    s_xor_b32 s97, s97, s99
    s_add_u32 m0, s87, 18432
    s_lshl_b32 s97, s97, 7
    buffer_load_dwordx4 v240, s[28:31], s97 offen offset:0  lds
    v_subrev_u32 v7, 1, v7
    v_bitop3_b32 v8, v7, 3, s3 bitop3:0x6a
    v_lshl_add_u32 v31, v8, 4, v136
    v_add_u32 v31, 90624, v31
    buffer_load_dwordx4 v241, s[28:31], s97 offen offset:1024  lds
    v_lshl_add_u32 v7, v5, 1, v6
    v_add_u32 v7, 26, v7
    v_and_b32 v8, 1, v7
    v_bfe_u32 v136, v7, 1, 2
    buffer_load_dwordx4 v242, s[28:31], s97 offen offset:2048  lds
    v_lshl_add_u32 v136, v8, 2, v136
    v_lshlrev_b32 v136, 6, v136
    v_lshrrev_b32 v7, 3, v7
    v_lshl_add_u32 v136, v7, 9, v136
    buffer_load_dwordx4 v243, s[28:31], s97 offen offset:3072  lds
    v_bitop3_b32 v8, v7, 3, s3 bitop3:0x6a
    v_lshl_add_u32 v26, v8, 4, v136
    v_add_u32 v26, 92160, v26
    v_subrev_u32 v7, 1, v7
    s_add_u32 m0, s88, 18432
    s_mov_b64 exec, 0xffffffff
    buffer_load_dwordx4 v3, s[28:31], s97 offen offset:0  lds
    s_mov_b64 exec, -1
    v_bitop3_b32 v8, v7, 3, s3 bitop3:0x6a
    v_lshl_add_u32 v28, v8, 4, v136
    v_add_u32 v28, 91648, v28
    v_subrev_u32 v7, 1, v7
    s_mul_i32 s16, s97, 3072
    s_add_u32 m0, s60, 24576
    s_add_u32 s99, s16, s62
    buffer_load_dwordx4 v244, s[32:35], s99 offen offset:0  lds
    v_bitop3_b32 v8, v7, 3, s3 bitop3:0x6a
    v_lshl_add_u32 v30, v8, 4, v136
    v_add_u32 v30, 91136, v30
    v_subrev_u32 v7, 1, v7
    buffer_load_dwordx4 v245, s[32:35], s99 offen offset:1024  lds
    v_bitop3_b32 v8, v7, 3, s3 bitop3:0x6a
    v_lshl_add_u32 v32, v8, 4, v136
    v_add_u32 v32, 90624, v32
    v_lshrrev_b32 v7, 1, v6
    buffer_load_dwordx4 v246, s[32:35], s99 offen offset:2048  lds
    v_lshl_add_u32 v7, v5, 1, v7
    v_add_u32 v7, 32, v7
    v_and_b32 v8, 1, v7
    v_bfe_u32 v136, v7, 1, 2
    s_add_u32 m0, s61, 36864
    s_add_u32 s16, s16, s63
    buffer_load_dwordx4 v244, s[32:35], s16 offen offset:0  lds
    v_lshl_add_u32 v136, v8, 2, v136
    v_lshlrev_b32 v136, 6, v136
    v_lshrrev_b32 v7, 3, v7
    v_lshl_add_u32 v136, v7, 9, v136
    buffer_load_dwordx4 v245, s[32:35], s16 offen offset:1024  lds
    v_bitop3_b32 v8, v7, 3, s3 bitop3:0x6a
    v_lshl_add_u32 v20, v8, 4, v136
    v_add_u32 v20, 92160, v20
    v_and_b32 v8, 1, v6
    buffer_load_dwordx4 v246, s[32:35], s16 offen offset:2048  lds
    v_xor_b32 v8, 1, v8
    v_lshl_add_u32 v20, v8, 3, v20
    s_waitcnt lgkmcnt(0)
    s_and_b32 s78, s92, 0xffff0000
    s_waitcnt vmcnt(11)
    s_barrier
    s_add_u32 s97, s98, s0
    s_lshr_b64 s[0:1], s[0:1], 4
    s_and_b32 s97, s97, 15
    s_lshr_b32 s99, s97, 3
    s_xor_b32 s97, s97, s99
    s_add_u32 m0, s87, 36864
    s_lshl_b32 s97, s97, 7
    buffer_load_dwordx4 v240, s[28:31], s97 offen offset:0  lds
    ds_read_b128 v[84:87], v35 offset:0
    ds_read_b128 v[88:91], v35 offset:16
    buffer_load_dwordx4 v241, s[28:31], s97 offen offset:1024  lds
    ds_read_b128 v[92:95], v35 offset:32
    buffer_load_dwordx4 v242, s[28:31], s97 offen offset:2048  lds
    ds_read_b128 v[96:99], v35 offset:48
    ds_read_b128 v[40:43], v233 offset:0
    buffer_load_dwordx4 v243, s[28:31], s97 offen offset:3072  lds
    ds_read_b128 v[44:47], v232 offset:256
    s_add_u32 m0, s88, 36864
    s_mov_b64 exec, 0xffffffff
    buffer_load_dwordx4 v3, s[28:31], s97 offen offset:0  lds
    s_mov_b64 exec, -1
    ds_read_b128 v[48:51], v233 offset:256
    s_mul_i32 s16, s97, 3072
    s_add_u32 m0, s60, 49152
    s_add_u32 s99, s16, s62
    buffer_load_dwordx4 v244, s[32:35], s99 offen offset:0  lds
    ds_read_b128 v[52:55], v16 offset:512
    ds_read_b128 v[56:59], v231 offset:512
    buffer_load_dwordx4 v245, s[32:35], s99 offen offset:1024  lds
    ds_read_b128 v[60:63], v16 offset:768
    buffer_load_dwordx4 v246, s[32:35], s99 offen offset:2048  lds
    ds_read_b128 v[64:67], v231 offset:768
    s_add_u32 m0, s61, 61440
    s_add_u32 s16, s16, s63
    buffer_load_dwordx4 v244, s[32:35], s16 offen offset:0  lds
    ds_read_b128 v[68:71], v16 offset:16896
    ds_read_b128 v[72:75], v231 offset:16896
    buffer_load_dwordx4 v245, s[32:35], s16 offen offset:1024  lds
    ds_read_b128 v[76:79], v16 offset:17152
    buffer_load_dwordx4 v246, s[32:35], s16 offen offset:2048  lds
    ds_read_b128 v[80:83], v231 offset:17152
    s_waitcnt vmcnt(11)
    s_waitcnt lgkmcnt(0)
    s_barrier
    s_add_u32 s97, s98, s0
    s_lshr_b64 s[0:1], s[0:1], 4
    s_and_b32 s97, s97, 15
    s_lshr_b32 s99, s97, 3
    s_xor_b32 s97, s97, s99
    s_add_u32 m0, s87, 0
    s_lshl_b32 s97, s97, 7
    buffer_load_dwordx4 v240, s[28:31], s97 offen offset:0  lds
    v_lshlrev_b32 v116, 16, v40
    v_lshlrev_b32 v117, 16, v44
    v_lshlrev_b32 v118, 16, v48
    v_lshlrev_b32 v119, 16, v52
    v_lshlrev_b32 v120, 16, v56
    buffer_load_dwordx4 v241, s[28:31], s97 offen offset:1024  lds
    v_lshlrev_b32 v121, 16, v60
    v_lshlrev_b32 v122, 16, v64
    v_lshlrev_b32 v127, 16, v84
    v_and_b32 v128, 0xffff0000, v84
    v_lshlrev_b32 v129, 16, v85
    buffer_load_dwordx4 v242, s[28:31], s97 offen offset:2048  lds
    v_and_b32 v130, 0xffff0000, v85
    v_lshlrev_b32 v123, 16, v68
    v_lshlrev_b32 v124, 16, v72
    v_lshlrev_b32 v125, 16, v76
    v_lshlrev_b32 v126, 16, v80
    buffer_load_dwordx4 v243, s[28:31], s97 offen offset:3072  lds
    v_mul_f32 v131, v116, v130
    v_mul_f32 v132, v117, v130
    v_mul_f32 v133, v118, v130
    v_mul_f32 v134, v119, v130
    v_fmac_f32 v131, v117, v129
    s_add_u32 m0, s88, 0
    s_mov_b64 exec, 0xffffffff
    buffer_load_dwordx4 v3, s[28:31], s97 offen offset:0  lds
    s_mov_b64 exec, -1
    v_fmac_f32 v132, v118, v129
    v_fmac_f32 v133, v119, v129
    v_fmac_f32 v134, v120, v129
    v_fmac_f32 v131, v118, v128
    v_fmac_f32 v132, v119, v128
    s_mul_i32 s16, s97, 3072
    s_add_u32 m0, s60, 0
    s_add_u32 s99, s16, s62
    buffer_load_dwordx4 v244, s[32:35], s99 offen offset:0  lds
    v_fmac_f32 v133, v120, v128
    v_fmac_f32 v134, v121, v128
    v_fmac_f32 v131, v119, v127
    v_fmac_f32 v132, v120, v127
    v_fmac_f32 v133, v121, v127
    buffer_load_dwordx4 v245, s[32:35], s99 offen offset:1024  lds
    v_fmac_f32 v134, v122, v127
    v_mul_f32 v131, v131, v123
    v_mul_f32 v132, v132, v124
    v_mul_f32 v133, v133, v125
    v_mul_f32 v134, v134, v126
    buffer_load_dwordx4 v246, s[32:35], s99 offen offset:2048  lds
    v_cvt_pk_bf16_f32 v102, v134, v133
    v_cvt_pk_bf16_f32 v103, v132, v131
    v_lshlrev_b32 v116, 16, v42
    v_lshlrev_b32 v117, 16, v46
    v_lshlrev_b32 v118, 16, v50
    s_add_u32 m0, s61, 12288
    s_add_u32 s16, s16, s63
    buffer_load_dwordx4 v244, s[32:35], s16 offen offset:0  lds
    v_lshlrev_b32 v119, 16, v54
    v_lshlrev_b32 v120, 16, v58
    v_lshlrev_b32 v121, 16, v62
    v_lshlrev_b32 v122, 16, v66
    v_lshlrev_b32 v127, 16, v92
    buffer_load_dwordx4 v245, s[32:35], s16 offen offset:1024  lds
    v_and_b32 v128, 0xffff0000, v92
    v_lshlrev_b32 v129, 16, v93
    v_and_b32 v130, 0xffff0000, v93
    v_lshlrev_b32 v123, 16, v70
    v_lshlrev_b32 v124, 16, v74
    buffer_load_dwordx4 v246, s[32:35], s16 offen offset:2048  lds
    v_lshlrev_b32 v125, 16, v78
    v_lshlrev_b32 v126, 16, v82
    v_mul_f32 v131, v116, v130
    v_mul_f32 v132, v117, v130
    v_mul_f32 v133, v118, v130
    v_mul_f32 v134, v119, v130
    v_fmac_f32 v131, v117, v129
    v_fmac_f32 v132, v118, v129
    v_fmac_f32 v133, v119, v129
    v_fmac_f32 v134, v120, v129
    v_fmac_f32 v131, v118, v128
    v_fmac_f32 v132, v119, v128
    s_waitcnt vmcnt(11)
    s_barrier
    s_add_u32 s97, s98, s0
    s_lshr_b64 s[0:1], s[0:1], 4
    s_and_b32 s97, s97, 15
    s_lshr_b32 s99, s97, 3
    s_xor_b32 s97, s97, s99
    s_add_u32 m0, s87, 18432
    s_lshl_b32 s97, s97, 7
    buffer_load_dwordx4 v240, s[28:31], s97 offen offset:0  lds
    v_fmac_f32 v133, v120, v128
    v_fmac_f32 v134, v121, v128
    v_fmac_f32 v131, v119, v127
    v_fmac_f32 v132, v120, v127
    v_fmac_f32 v133, v121, v127
    buffer_load_dwordx4 v241, s[28:31], s97 offen offset:1024  lds
    v_fmac_f32 v134, v122, v127
    v_mul_f32 v131, v131, v123
    v_mul_f32 v132, v132, v124
    v_mul_f32 v133, v133, v125
    v_mul_f32 v134, v134, v126
    buffer_load_dwordx4 v242, s[28:31], s97 offen offset:2048  lds
    v_cvt_pk_bf16_f32 v100, v134, v133
    v_cvt_pk_bf16_f32 v101, v132, v131
    s_nop 0
    v_permlane32_swap_b32 v102, v100
    v_permlane32_swap_b32 v103, v101
    s_mov_b32 s89, 0
    buffer_store_dwordx4 v[100:103], v12, s[52:55], s89 offen sc1
    buffer_load_dwordx4 v243, s[28:31], s97 offen offset:3072  lds
    v_and_b32 v116, 0xffff0000, v40
    v_and_b32 v117, 0xffff0000, v44
    v_and_b32 v118, 0xffff0000, v48
    v_and_b32 v119, 0xffff0000, v52
    v_and_b32 v120, 0xffff0000, v56
    s_add_u32 m0, s88, 18432
    s_mov_b64 exec, 0xffffffff
    buffer_load_dwordx4 v3, s[28:31], s97 offen offset:0  lds
    s_mov_b64 exec, -1
    v_and_b32 v121, 0xffff0000, v60
    v_and_b32 v122, 0xffff0000, v64
    v_lshlrev_b32 v127, 16, v86
    v_and_b32 v128, 0xffff0000, v86
    v_lshlrev_b32 v129, 16, v87
    s_mul_i32 s16, s97, 3072
    s_add_u32 m0, s60, 24576
    s_add_u32 s99, s16, s62
    buffer_load_dwordx4 v244, s[32:35], s99 offen offset:0  lds
    v_and_b32 v130, 0xffff0000, v87
    v_and_b32 v123, 0xffff0000, v68
    v_and_b32 v124, 0xffff0000, v72
    v_and_b32 v125, 0xffff0000, v76
    v_and_b32 v126, 0xffff0000, v80
    buffer_load_dwordx4 v245, s[32:35], s99 offen offset:1024  lds
    v_mul_f32 v131, v116, v130
    v_mul_f32 v132, v117, v130
    v_mul_f32 v133, v118, v130
    v_mul_f32 v134, v119, v130
    v_fmac_f32 v131, v117, v129
    buffer_load_dwordx4 v246, s[32:35], s99 offen offset:2048  lds
    v_fmac_f32 v132, v118, v129
    v_fmac_f32 v133, v119, v129
    v_fmac_f32 v134, v120, v129
    v_fmac_f32 v131, v118, v128
    v_fmac_f32 v132, v119, v128
    s_add_u32 m0, s61, 36864
    s_add_u32 s16, s16, s63
    buffer_load_dwordx4 v244, s[32:35], s16 offen offset:0  lds
    v_fmac_f32 v133, v120, v128
    v_fmac_f32 v134, v121, v128
    v_fmac_f32 v131, v119, v127
    v_fmac_f32 v132, v120, v127
    v_fmac_f32 v133, v121, v127
    buffer_load_dwordx4 v245, s[32:35], s16 offen offset:1024  lds
    v_fmac_f32 v134, v122, v127
    v_mul_f32 v131, v131, v123
    v_mul_f32 v132, v132, v124
    v_mul_f32 v133, v133, v125
    v_mul_f32 v134, v134, v126
    buffer_load_dwordx4 v246, s[32:35], s16 offen offset:2048  lds
    v_cvt_pk_bf16_f32 v106, v134, v133
    v_cvt_pk_bf16_f32 v107, v132, v131
    v_and_b32 v116, 0xffff0000, v42
    v_and_b32 v117, 0xffff0000, v46
    v_and_b32 v118, 0xffff0000, v50
    v_and_b32 v119, 0xffff0000, v54
    v_and_b32 v120, 0xffff0000, v58
    v_and_b32 v121, 0xffff0000, v62
    v_and_b32 v122, 0xffff0000, v66
    v_lshlrev_b32 v127, 16, v94
    v_and_b32 v128, 0xffff0000, v94
    v_lshlrev_b32 v129, 16, v95
    s_waitcnt vmcnt(12)
    s_barrier
    buffer_load_dword v230, v229, s[64:67], 0 offen
    v_and_b32 v130, 0xffff0000, v95
    v_and_b32 v123, 0xffff0000, v70
    v_and_b32 v124, 0xffff0000, v74
    v_and_b32 v125, 0xffff0000, v78
    v_and_b32 v126, 0xffff0000, v82
    s_add_u32 s97, s98, s0
    s_lshr_b64 s[0:1], s[0:1], 4
    s_and_b32 s97, s97, 15
    s_lshr_b32 s99, s97, 3
    s_xor_b32 s97, s97, s99
    s_add_u32 m0, s87, 36864
    s_lshl_b32 s97, s97, 7
    buffer_load_dwordx4 v240, s[28:31], s97 offen offset:0  lds
    v_mul_f32 v131, v116, v130
    v_mul_f32 v132, v117, v130
    v_mul_f32 v133, v118, v130
    v_mul_f32 v134, v119, v130
    v_fmac_f32 v131, v117, v129
    buffer_load_dwordx4 v241, s[28:31], s97 offen offset:1024  lds
    v_fmac_f32 v132, v118, v129
    v_fmac_f32 v133, v119, v129
    v_fmac_f32 v134, v120, v129
    v_fmac_f32 v131, v118, v128
    v_fmac_f32 v132, v119, v128
    buffer_load_dwordx4 v242, s[28:31], s97 offen offset:2048  lds
    v_fmac_f32 v133, v120, v128
    v_fmac_f32 v134, v121, v128
    v_fmac_f32 v131, v119, v127
    v_fmac_f32 v132, v120, v127
    v_fmac_f32 v133, v121, v127
    buffer_load_dwordx4 v243, s[28:31], s97 offen offset:3072  lds
    v_fmac_f32 v134, v122, v127
    v_mul_f32 v131, v131, v123
    v_mul_f32 v132, v132, v124
    v_mul_f32 v133, v133, v125
    v_mul_f32 v134, v134, v126
    s_add_u32 m0, s88, 36864
    s_mov_b64 exec, 0xffffffff
    buffer_load_dwordx4 v3, s[28:31], s97 offen offset:0  lds
    s_mov_b64 exec, -1
    v_cvt_pk_bf16_f32 v104, v134, v133
    v_cvt_pk_bf16_f32 v105, v132, v131
    s_nop 0
    v_permlane32_swap_b32 v106, v104
    v_permlane32_swap_b32 v107, v105
    s_mov_b32 s89, 16384
    buffer_store_dwordx4 v[104:107], v12, s[52:55], s89 offen sc1
    s_mul_i32 s16, s97, 3072
    s_add_u32 m0, s60, 49152
    s_add_u32 s99, s16, s62
    buffer_load_dwordx4 v244, s[32:35], s99 offen offset:0  lds
    v_lshlrev_b32 v116, 16, v41
    v_lshlrev_b32 v117, 16, v45
    v_lshlrev_b32 v118, 16, v49
    v_lshlrev_b32 v119, 16, v53
    v_lshlrev_b32 v120, 16, v57
    buffer_load_dwordx4 v245, s[32:35], s99 offen offset:1024  lds
    v_lshlrev_b32 v121, 16, v61
    v_lshlrev_b32 v122, 16, v65
    v_lshlrev_b32 v127, 16, v88
    v_and_b32 v128, 0xffff0000, v88
    v_lshlrev_b32 v129, 16, v89
    buffer_load_dwordx4 v246, s[32:35], s99 offen offset:2048  lds
    v_and_b32 v130, 0xffff0000, v89
    v_lshlrev_b32 v123, 16, v69
    v_lshlrev_b32 v124, 16, v73
    v_lshlrev_b32 v125, 16, v77
    v_lshlrev_b32 v126, 16, v81
    s_add_u32 m0, s61, 61440
    s_add_u32 s16, s16, s63
    buffer_load_dwordx4 v244, s[32:35], s16 offen offset:0  lds
    v_mul_f32 v131, v116, v130
    v_mul_f32 v132, v117, v130
    v_mul_f32 v133, v118, v130
    v_mul_f32 v134, v119, v130
    v_fmac_f32 v131, v117, v129
    buffer_load_dwordx4 v245, s[32:35], s16 offen offset:1024  lds
    v_fmac_f32 v132, v118, v129
    v_fmac_f32 v133, v119, v129
    v_fmac_f32 v134, v120, v129
    v_fmac_f32 v131, v118, v128
    v_fmac_f32 v132, v119, v128
    buffer_load_dwordx4 v246, s[32:35], s16 offen offset:2048  lds
    v_fmac_f32 v133, v120, v128
    v_fmac_f32 v134, v121, v128
    v_fmac_f32 v131, v119, v127
    v_fmac_f32 v132, v120, v127
    v_fmac_f32 v133, v121, v127
    v_fmac_f32 v134, v122, v127
    v_mul_f32 v131, v131, v123
    s_waitcnt vmcnt(13)
    s_barrier
    s_add_u32 s97, s98, s0
    s_lshr_b64 s[0:1], s[0:1], 4
    s_and_b32 s97, s97, 15
    s_lshr_b32 s99, s97, 3
    s_xor_b32 s97, s97, s99
    s_add_u32 m0, s87, 0
    s_lshl_b32 s97, s97, 7
    buffer_load_dwordx4 v240, s[28:31], s97 offen offset:0  lds
    v_mul_f32 v132, v132, v124
    v_mul_f32 v133, v133, v125
    v_mul_f32 v134, v134, v126
    v_cvt_pk_bf16_f32 v110, v134, v133
    v_cvt_pk_bf16_f32 v111, v132, v131
    buffer_load_dwordx4 v241, s[28:31], s97 offen offset:1024  lds
    v_lshlrev_b32 v116, 16, v43
    v_lshlrev_b32 v117, 16, v47
    v_lshlrev_b32 v118, 16, v51
    v_lshlrev_b32 v119, 16, v55
    v_lshlrev_b32 v120, 16, v59
    buffer_load_dwordx4 v242, s[28:31], s97 offen offset:2048  lds
    v_lshlrev_b32 v121, 16, v63
    v_lshlrev_b32 v122, 16, v67
    v_lshlrev_b32 v127, 16, v96
    v_and_b32 v128, 0xffff0000, v96
    v_lshlrev_b32 v129, 16, v97
    buffer_load_dwordx4 v243, s[28:31], s97 offen offset:3072  lds
    v_and_b32 v130, 0xffff0000, v97
    v_lshlrev_b32 v123, 16, v71
    v_lshlrev_b32 v124, 16, v75
    v_lshlrev_b32 v125, 16, v79
    v_lshlrev_b32 v126, 16, v83
    s_add_u32 m0, s88, 0
    s_mov_b64 exec, 0xffffffff
    buffer_load_dwordx4 v3, s[28:31], s97 offen offset:0  lds
    s_mov_b64 exec, -1
    v_mul_f32 v131, v116, v130
    v_mul_f32 v132, v117, v130
    v_mul_f32 v133, v118, v130
    v_mul_f32 v134, v119, v130
    v_fmac_f32 v131, v117, v129
    s_mul_i32 s16, s97, 3072
    s_add_u32 m0, s60, 0
    s_add_u32 s99, s16, s62
    buffer_load_dwordx4 v244, s[32:35], s99 offen offset:0  lds
    v_fmac_f32 v132, v118, v129
    v_fmac_f32 v133, v119, v129
    v_fmac_f32 v134, v120, v129
    v_fmac_f32 v131, v118, v128
    v_fmac_f32 v132, v119, v128
    buffer_load_dwordx4 v245, s[32:35], s99 offen offset:1024  lds
    v_fmac_f32 v133, v120, v128
    v_fmac_f32 v134, v121, v128
    v_fmac_f32 v131, v119, v127
    v_fmac_f32 v132, v120, v127
    v_fmac_f32 v133, v121, v127
    buffer_load_dwordx4 v246, s[32:35], s99 offen offset:2048  lds
    v_fmac_f32 v134, v122, v127
    v_mul_f32 v131, v131, v123
    v_mul_f32 v132, v132, v124
    v_mul_f32 v133, v133, v125
    v_mul_f32 v134, v134, v126
    s_add_u32 m0, s61, 12288
    s_add_u32 s16, s16, s63
    buffer_load_dwordx4 v244, s[32:35], s16 offen offset:0  lds
    v_cvt_pk_bf16_f32 v108, v134, v133
    v_cvt_pk_bf16_f32 v109, v132, v131
    s_nop 0
    v_permlane32_swap_b32 v110, v108
    v_permlane32_swap_b32 v111, v109
    s_mov_b32 s89, 32768
    buffer_store_dwordx4 v[108:111], v12, s[52:55], s89 offen sc1
    buffer_load_dwordx4 v245, s[32:35], s16 offen offset:1024  lds
    v_and_b32 v116, 0xffff0000, v41
    v_and_b32 v117, 0xffff0000, v45
    v_and_b32 v118, 0xffff0000, v49
    v_and_b32 v119, 0xffff0000, v53
    v_and_b32 v120, 0xffff0000, v57
    buffer_load_dwordx4 v246, s[32:35], s16 offen offset:2048  lds
    v_and_b32 v121, 0xffff0000, v61
    v_and_b32 v122, 0xffff0000, v65
    v_lshlrev_b32 v127, 16, v90
    v_and_b32 v128, 0xffff0000, v90
    v_lshlrev_b32 v129, 16, v91
    v_and_b32 v130, 0xffff0000, v91
    v_and_b32 v123, 0xffff0000, v69
    v_and_b32 v124, 0xffff0000, v73
    v_and_b32 v125, 0xffff0000, v77
    v_and_b32 v126, 0xffff0000, v81
    v_mul_f32 v131, v116, v130
    v_mul_f32 v132, v117, v130
    s_waitcnt vmcnt(12)
    s_barrier
    s_add_u32 s97, s98, s0
    s_lshr_b64 s[0:1], s[0:1], 4
    s_and_b32 s97, s97, 15
    s_lshr_b32 s99, s97, 3
    s_xor_b32 s97, s97, s99
    s_add_u32 m0, s87, 18432
    s_lshl_b32 s97, s97, 7
    buffer_load_dwordx4 v240, s[28:31], s97 offen offset:0  lds
    v_mul_f32 v133, v118, v130
    v_mul_f32 v134, v119, v130
    v_fmac_f32 v131, v117, v129
    v_fmac_f32 v132, v118, v129
    v_fmac_f32 v133, v119, v129
    buffer_load_dwordx4 v241, s[28:31], s97 offen offset:1024  lds
    v_fmac_f32 v134, v120, v129
    v_fmac_f32 v131, v118, v128
    v_fmac_f32 v132, v119, v128
    v_fmac_f32 v133, v120, v128
    v_fmac_f32 v134, v121, v128
    buffer_load_dwordx4 v242, s[28:31], s97 offen offset:2048  lds
    v_fmac_f32 v131, v119, v127
    v_fmac_f32 v132, v120, v127
    v_fmac_f32 v133, v121, v127
    v_fmac_f32 v134, v122, v127
    v_mul_f32 v131, v131, v123
    buffer_load_dwordx4 v243, s[28:31], s97 offen offset:3072  lds
    v_mul_f32 v132, v132, v124
    v_mul_f32 v133, v133, v125
    v_mul_f32 v134, v134, v126
    v_cvt_pk_bf16_f32 v114, v134, v133
    v_cvt_pk_bf16_f32 v115, v132, v131
    s_add_u32 m0, s88, 18432
    s_mov_b64 exec, 0xffffffff
    buffer_load_dwordx4 v3, s[28:31], s97 offen offset:0  lds
    s_mov_b64 exec, -1
    v_and_b32 v116, 0xffff0000, v43
    v_and_b32 v117, 0xffff0000, v47
    v_and_b32 v118, 0xffff0000, v51
    v_and_b32 v119, 0xffff0000, v55
    v_and_b32 v120, 0xffff0000, v59
    s_mul_i32 s16, s97, 3072
    s_add_u32 m0, s60, 24576
    s_add_u32 s99, s16, s62
    buffer_load_dwordx4 v244, s[32:35], s99 offen offset:0  lds
    v_and_b32 v121, 0xffff0000, v63
    v_and_b32 v122, 0xffff0000, v67
    v_lshlrev_b32 v127, 16, v98
    v_and_b32 v128, 0xffff0000, v98
    v_lshlrev_b32 v129, 16, v99
    buffer_load_dwordx4 v245, s[32:35], s99 offen offset:1024  lds
    v_and_b32 v130, 0xffff0000, v99
    v_and_b32 v123, 0xffff0000, v71
    v_and_b32 v124, 0xffff0000, v75
    v_and_b32 v125, 0xffff0000, v79
    v_and_b32 v126, 0xffff0000, v83
    buffer_load_dwordx4 v246, s[32:35], s99 offen offset:2048  lds
    v_mul_f32 v131, v116, v130
    v_mul_f32 v132, v117, v130
    v_mul_f32 v133, v118, v130
    v_mul_f32 v134, v119, v130
    v_fmac_f32 v131, v117, v129
    s_add_u32 m0, s61, 36864
    s_add_u32 s16, s16, s63
    buffer_load_dwordx4 v244, s[32:35], s16 offen offset:0  lds
    v_fmac_f32 v132, v118, v129
    v_fmac_f32 v133, v119, v129
    v_fmac_f32 v134, v120, v129
    v_fmac_f32 v131, v118, v128
    v_fmac_f32 v132, v119, v128
    buffer_load_dwordx4 v245, s[32:35], s16 offen offset:1024  lds
    v_fmac_f32 v133, v120, v128
    v_fmac_f32 v134, v121, v128
    v_fmac_f32 v131, v119, v127
    v_fmac_f32 v132, v120, v127
    v_fmac_f32 v133, v121, v127
    buffer_load_dwordx4 v246, s[32:35], s16 offen offset:2048  lds
    v_fmac_f32 v134, v122, v127
    v_mul_f32 v131, v131, v123
    v_mul_f32 v132, v132, v124
    v_mul_f32 v133, v133, v125
    v_mul_f32 v134, v134, v126
    v_cvt_pk_bf16_f32 v112, v134, v133
    v_cvt_pk_bf16_f32 v113, v132, v131
    s_nop 0
    v_permlane32_swap_b32 v114, v112
    v_permlane32_swap_b32 v115, v113
    s_mov_b32 s89, 49152
    buffer_store_dwordx4 v[112:115], v12, s[52:55], s89 offen sc1
    s_waitcnt vmcnt(12)
    s_barrier
    s_add_u32 s97, s98, s0
    s_lshr_b64 s[0:1], s[0:1], 4
    s_and_b32 s97, s97, 15
    s_lshr_b32 s99, s97, 3
    s_xor_b32 s97, s97, s99
    s_add_u32 m0, s87, 36864
    s_lshl_b32 s97, s97, 7
    buffer_load_dwordx4 v240, s[28:31], s97 offen offset:0  lds
    s_lshl_b32 s92, s92, 16
    s_bitcmp1_b32 s90, 0
    s_cselect_b32 s92, s78, s92
    buffer_load_dwordx4 v241, s[28:31], s97 offen offset:1024  lds
    v_lshlrev_b32 v7, 3, v6
    v_sub_u32 v7, v7, v5
    buffer_load_dwordx4 v242, s[28:31], s97 offen offset:2048  lds
    v_subrev_u32 v7, 9, v7
    buffer_load_dwordx4 v243, s[28:31], s97 offen offset:3072  lds
    v_and_b32 v8, 1, v7
    v_xor_b32 v8, 1, v8
    s_add_u32 m0, s88, 36864
    s_mov_b64 exec, 0xffffffff
    buffer_load_dwordx4 v3, s[28:31], s97 offen offset:0  lds
    s_mov_b64 exec, -1
    v_lshlrev_b32 v8, 4, v8
    v_lshrrev_b32 v8, v8, s92
    s_mul_i32 s16, s97, 3072
    s_add_u32 m0, s60, 49152
    s_add_u32 s99, s16, s62
    buffer_load_dwordx4 v244, s[32:35], s99 offen offset:0  lds
    v_ashrrev_i32 v7, 1, v7
    buffer_load_dwordx4 v245, s[32:35], s99 offen offset:1024  lds
    v_cmp_eq_u32 vcc, 0, v7
    s_nop 1
    v_cndmask_b32 v236, 0, v8, vcc
    buffer_load_dwordx4 v246, s[32:35], s99 offen offset:2048  lds
    v_cmp_eq_u32 vcc, 1, v7
    s_nop 1
    v_cndmask_b32 v237, 0, v8, vcc
    s_add_u32 m0, s61, 61440
    s_add_u32 s16, s16, s63
    buffer_load_dwordx4 v244, s[32:35], s16 offen offset:0  lds
    v_cmp_eq_u32 vcc, 2, v7
    buffer_load_dwordx4 v245, s[32:35], s16 offen offset:1024  lds
    s_nop 0
    v_cndmask_b32 v238, 0, v8, vcc
    v_cmp_eq_u32 vcc, 3, v7
    buffer_load_dwordx4 v246, s[32:35], s16 offen offset:2048  lds
    s_nop 0
    v_cndmask_b32 v239, 0, v8, vcc
    s_waitcnt vmcnt(12)
    s_barrier
    s_add_u32 m0, s94, 32
    s_lshl_b32 s89, s90, 12
    buffer_load_dwordx4 v15, s[48:51], s89 offen offset:0 nt lds
    s_add_u32 m0, s94, 32
    s_lshl_b32 s89, s90, 12
    buffer_load_dwordx4 v15, s[48:51], s89 offen offset:1024 nt lds
    s_add_u32 m0, s94, 32
    s_lshl_b32 s89, s90, 12
    buffer_load_dwordx4 v15, s[48:51], s89 offen offset:2048 nt lds
    s_add_u32 m0, s94, 32
    s_lshl_b32 s89, s90, 12
    buffer_load_dwordx4 v15, s[48:51], s89 offen offset:3072 nt lds
    s_add_u32 s97, s98, s0
    s_lshr_b64 s[0:1], s[0:1], 4
    s_and_b32 s97, s97, 15
    s_lshr_b32 s99, s97, 3
    s_xor_b32 s97, s97, s99
    s_add_u32 m0, s87, 0
    s_lshl_b32 s97, s97, 7
    buffer_load_dwordx4 v240, s[28:31], s97 offen offset:0  lds
    buffer_load_dwordx4 v241, s[28:31], s97 offen offset:1024  lds
    buffer_load_dwordx4 v242, s[28:31], s97 offen offset:2048  lds
    buffer_load_dwordx4 v243, s[28:31], s97 offen offset:3072  lds
    s_add_u32 m0, s88, 0
    s_mov_b64 exec, 0xffffffff
    buffer_load_dwordx4 v3, s[28:31], s97 offen offset:0  lds
    s_mov_b64 exec, -1
    s_mul_i32 s16, s97, 3072
    s_add_u32 m0, s60, 0
    s_add_u32 s99, s16, s62
    buffer_load_dwordx4 v244, s[32:35], s99 offen offset:0  lds
    buffer_load_dwordx4 v245, s[32:35], s99 offen offset:1024  lds
    buffer_load_dwordx4 v246, s[32:35], s99 offen offset:2048  lds
    s_add_u32 m0, s61, 12288
    s_add_u32 s16, s16, s63
    buffer_load_dwordx4 v244, s[32:35], s16 offen offset:0  lds
    buffer_load_dwordx4 v245, s[32:35], s16 offen offset:1024  lds
    buffer_load_dwordx4 v246, s[32:35], s16 offen offset:2048  lds
    s_waitcnt vmcnt(15)
    s_barrier
    s_add_u32 s97, s98, s0
    s_lshr_b64 s[0:1], s[0:1], 4
    s_and_b32 s97, s97, 15
    s_lshr_b32 s99, s97, 3
    s_xor_b32 s97, s97, s99
    s_add_u32 m0, s87, 18432
    s_lshl_b32 s97, s97, 7
    buffer_load_dwordx4 v240, s[28:31], s97 offen offset:0  lds
    buffer_load_dwordx4 v241, s[28:31], s97 offen offset:1024  lds
    buffer_load_dwordx4 v242, s[28:31], s97 offen offset:2048  lds
    buffer_load_dwordx4 v243, s[28:31], s97 offen offset:3072  lds
    s_add_u32 m0, s88, 18432
    s_mov_b64 exec, 0xffffffff
    buffer_load_dwordx4 v3, s[28:31], s97 offen offset:0  lds
    s_mov_b64 exec, -1
    s_mul_i32 s16, s97, 3072
    s_add_u32 m0, s60, 24576
    s_add_u32 s99, s16, s62
    buffer_load_dwordx4 v244, s[32:35], s99 offen offset:0  lds
    buffer_load_dwordx4 v245, s[32:35], s99 offen offset:1024  lds
    buffer_load_dwordx4 v246, s[32:35], s99 offen offset:2048  lds
    s_add_u32 m0, s61, 36864
    s_add_u32 s16, s16, s63
    buffer_load_dwordx4 v244, s[32:35], s16 offen offset:0  lds
    buffer_load_dwordx4 v245, s[32:35], s16 offen offset:1024  lds
    buffer_load_dwordx4 v246, s[32:35], s16 offen offset:2048  lds
    s_waitcnt vmcnt(11)
    s_barrier
    s_add_u32 s97, s98, s0
    s_lshr_b64 s[0:1], s[0:1], 4
    s_and_b32 s97, s97, 15
    s_lshr_b32 s99, s97, 3
    s_xor_b32 s97, s97, s99
    s_add_u32 m0, s87, 36864
    s_lshl_b32 s97, s97, 7
    buffer_load_dwordx4 v240, s[28:31], s97 offen offset:0  lds
    v_add_u32 v5, s94, v15
    ds_read_b128 v[140:143], v5 offset:32
    ds_read_b32 v156, v5 offset:48
    ds_read_b128 v[144:147], v5 offset:1056
    buffer_load_dwordx4 v241, s[28:31], s97 offen offset:1024  lds
    ds_read_b32 v157, v5 offset:1072
    ds_read_b128 v[148:151], v5 offset:2080
    ds_read_b32 v158, v5 offset:2096
    ds_read_b128 v[152:155], v5 offset:3104
    buffer_load_dwordx4 v242, s[28:31], s97 offen offset:2048  lds
    ds_read_b32 v159, v5 offset:3120
    v_lshrrev_b32 v6, 3, v0
    v_mul_u32_u24 v6, 4160, v6
    buffer_load_dwordx4 v243, s[28:31], s97 offen offset:3072  lds
    v_and_b32 v7, 7, v0
    v_lshl_add_u32 v6, v7, 2, v6
    v_add_u32 v6, s94, v6
    v_mov_b32 v7, 0
    s_add_u32 m0, s88, 36864
    s_mov_b64 exec, 0xffffffff
    buffer_load_dwordx4 v3, s[28:31], s97 offen offset:0  lds
    s_mov_b64 exec, -1
    s_waitcnt lgkmcnt(0)
    v_readfirstlane_b32 s93, v140
    s_nop 0
    s_lshl_b32 s93, s93, 16
    s_nop 1
    v_writelane_b32 v7, s93, 15
    s_mul_i32 s16, s97, 3072
    s_add_u32 m0, s60, 49152
    s_add_u32 s99, s16, s62
    buffer_load_dwordx4 v244, s[32:35], s99 offen offset:0  lds
    v_alignbit_b32 v140, v141, v140, 16
    v_alignbit_b32 v141, v142, v141, 16
    v_alignbit_b32 v142, v143, v142, 16
    buffer_load_dwordx4 v245, s[32:35], s99 offen offset:1024  lds
    v_alignbit_b32 v143, v156, v143, 16
    v_alignbit_b32 v144, v145, v144, 16
    v_alignbit_b32 v145, v146, v145, 16
    v_alignbit_b32 v146, v147, v146, 16
    buffer_load_dwordx4 v246, s[32:35], s99 offen offset:2048  lds
    v_alignbit_b32 v147, v157, v147, 16
    v_alignbit_b32 v148, v149, v148, 16
    v_alignbit_b32 v149, v150, v149, 16
    v_alignbit_b32 v150, v151, v150, 16
    s_add_u32 m0, s61, 61440
    s_add_u32 s16, s16, s63
    buffer_load_dwordx4 v244, s[32:35], s16 offen offset:0  lds
    v_alignbit_b32 v151, v158, v151, 16
    v_alignbit_b32 v152, v153, v152, 16
    v_alignbit_b32 v153, v154, v153, 16
    buffer_load_dwordx4 v245, s[32:35], s16 offen offset:1024  lds
    v_alignbit_b32 v154, v155, v154, 16
    v_alignbit_b32 v155, v159, v155, 16
    v_lshlrev_b32 v8, 3, v0
    s_add_u32 s78, s88, 18432
    buffer_load_dwordx4 v246, s[32:35], s16 offen offset:2048  lds
    v_add_u32 v8, s78, v8
    v_mov_b32 v156, 0
    v_mov_b32 v157, 0
    s_waitcnt vmcnt(11)
    s_barrier
    s_add_u32 s97, s98, s0
    s_lshr_b64 s[0:1], s[0:1], 4
    s_and_b32 s97, s97, 15
    s_lshr_b32 s99, s97, 3
    s_xor_b32 s97, s97, s99
    s_add_u32 m0, s87, 0
    s_lshl_b32 s97, s97, 7
    buffer_load_dwordx4 v240, s[28:31], s97 offen offset:0  lds
    buffer_load_dwordx4 v241, s[28:31], s97 offen offset:1024  lds
    buffer_load_dwordx4 v242, s[28:31], s97 offen offset:2048  lds
    buffer_load_dwordx4 v243, s[28:31], s97 offen offset:3072  lds
    s_add_u32 m0, s88, 0
    s_mov_b64 exec, 0xffffffff
    buffer_load_dwordx4 v3, s[28:31], s97 offen offset:0  lds
    s_mov_b64 exec, -1
    s_mul_i32 s16, s97, 3072
    s_add_u32 m0, s60, 0
    s_add_u32 s99, s16, s62
    buffer_load_dwordx4 v244, s[32:35], s99 offen offset:0  lds
    buffer_load_dwordx4 v245, s[32:35], s99 offen offset:1024  lds
    buffer_load_dwordx4 v246, s[32:35], s99 offen offset:2048  lds
    s_add_u32 m0, s61, 12288
    s_add_u32 s16, s16, s63
    buffer_load_dwordx4 v244, s[32:35], s16 offen offset:0  lds
    buffer_load_dwordx4 v245, s[32:35], s16 offen offset:1024  lds
    buffer_load_dwordx4 v246, s[32:35], s16 offen offset:2048  lds
    s_mov_b64 exec, 0xff
    buffer_load_dword v136, v33, s[68:71], 0 offen sc1
    buffer_load_dword v137, v34, s[52:55], 0 offen sc1
    s_mov_b64 exec, -1
    s_waitcnt vmcnt(13)
    s_barrier
    s_waitcnt vmcnt(0)
    s_branch LA_j
LA_c1:
    s_waitcnt vmcnt(7)
    s_barrier
    buffer_load_dwordx4 v246, s[32:35], s99 offen offset:2048  lds
    s_add_u32 m0, s61, 36864
    s_add_u32 s16, s16, s63
    buffer_load_dwordx4 v244, s[32:35], s16 offen offset:0  lds
    buffer_load_dwordx4 v245, s[32:35], s16 offen offset:1024  lds
    buffer_load_dwordx4 v246, s[32:35], s16 offen offset:2048  lds
    s_add_u32 s97, s98, s0
    s_lshr_b64 s[0:1], s[0:1], 4
    s_and_b32 s97, s97, 15
    s_lshr_b32 s99, s97, 3
    s_xor_b32 s97, s97, s99
    s_add_u32 m0, s87, 36864
    s_lshl_b32 s97, s97, 7
    buffer_load_dwordx4 v240, s[28:31], s97 offen offset:0  lds
    buffer_load_dwordx4 v241, s[28:31], s97 offen offset:1024  lds
    buffer_load_dwordx4 v242, s[28:31], s97 offen offset:2048  lds
    buffer_load_dwordx4 v243, s[28:31], s97 offen offset:3072  lds
    s_add_u32 m0, s88, 36864
    s_mov_b64 exec, 0xffffffff
    buffer_load_dwordx4 v3, s[28:31], s97 offen offset:0  lds
    s_mov_b64 exec, -1
    s_mul_i32 s16, s97, 3072
    s_add_u32 m0, s60, 49152
    s_add_u32 s99, s16, s62
    buffer_load_dwordx4 v244, s[32:35], s99 offen offset:0  lds
    buffer_load_dwordx4 v245, s[32:35], s99 offen offset:1024  lds
    buffer_load_dwordx4 v246, s[32:35], s99 offen offset:2048  lds
    s_add_u32 m0, s61, 61440
    s_add_u32 s16, s16, s63
    buffer_load_dwordx4 v244, s[32:35], s16 offen offset:0  lds
    buffer_load_dwordx4 v245, s[32:35], s16 offen offset:1024  lds
    buffer_load_dwordx4 v246, s[32:35], s16 offen offset:2048  lds
    s_waitcnt vmcnt(11)
    s_barrier
    s_add_u32 s97, s98, s0
    s_lshr_b64 s[0:1], s[0:1], 4
    s_and_b32 s97, s97, 15
    s_lshr_b32 s99, s97, 3
    s_xor_b32 s97, s97, s99
    s_add_u32 m0, s87, 0
    s_lshl_b32 s97, s97, 7
    buffer_load_dwordx4 v240, s[28:31], s97 offen offset:0  lds
    s_mov_b32 s68, s24
    s_mov_b32 s69, s25
    s_mov_b32 s70, 0x100
    s_mov_b32 s71, 0x20000
    v_lshrrev_b32 v6, 5, v0
    buffer_load_dwordx4 v241, s[28:31], s97 offen offset:1024  lds
    v_and_b32 v7, 3, v0
    s_lshr_b32 s78, s90, 1
    s_lshl_b32 s78, s78, 2
    s_load_dword s92, s[14:15], s78
    s_mul_i32 s94, s3, 8320
    buffer_load_dwordx4 v242, s[28:31], s97 offen offset:2048  lds
    s_add_u32 s94, s94, 129024
    v_bfe_u32 v5, v0, 2, 2
    v_lshlrev_b32 v5, 1, v5
    v_lshl_add_u32 v5, v6, 3, v5
    v_bfe_u32 v8, v0, 4, 1
    buffer_load_dwordx4 v243, s[28:31], s97 offen offset:3072  lds
    v_add_u32 v5, v5, v8
    s_and_b32 s78, s3, 1
    s_lshl_b32 s78, s78, 1
    v_add_u32 v8, s78, v6
    v_xor_b32 v8, v8, v7
    s_add_u32 m0, s88, 0
    s_mov_b64 exec, 0xffffffff
    buffer_load_dwordx4 v3, s[28:31], s97 offen offset:0  lds
    s_mov_b64 exec, -1
    v_lshlrev_b32 v8, 4, v8
    v_lshl_add_u32 v5, v5, 6, v8
    v_add_u32 v14, s86, v5
    v_mov_b32 v18, 162304
    v_mov_b32 v19, 1
    s_mul_i32 s16, s97, 3072
    s_add_u32 m0, s60, 0
    s_add_u32 s99, s16, s62
    buffer_load_dwordx4 v244, s[32:35], s99 offen offset:0  lds
    v_and_b32 v5, 3, v0
    s_lshl_b32 s78, s74, 4
    s_add_u32 s78, s78, s3
    v_lshl_add_u32 v6, v5, 2, s78
    s_lshr_b32 s78, s76, 3
    buffer_load_dwordx4 v245, s[32:35], s99 offen offset:1024  lds
    s_lshl_b32 s79, s3, 1
    s_add_u32 s78, s78, s79
    s_xor_b32 s78, s78, 0
    s_lshl_b32 s78, s78, 5
    s_and_b32 s79, s76, 7
    buffer_load_dwordx4 v246, s[32:35], s99 offen offset:2048  lds
    s_add_u32 s78, s78, s79
    v_lshl_add_u32 v7, v5, 3, s78
    v_and_b32 v8, 4, v0
    v_cmp_eq_u32 vcc, 0, v8
    s_nop 1
    v_cndmask_b32 v6, v7, v6, vcc
    s_add_u32 m0, s61, 12288
    s_add_u32 s16, s16, s63
    buffer_load_dwordx4 v244, s[32:35], s16 offen offset:0  lds
    v_and_b32 v33, 0xf0, v6
    v_lshlrev_b32 v34, 8, v6
    v_add_u32 v34, 12582912, v34
    v_and_b32 v5, 15, v0
    v_lshrrev_b32 v6, 4, v0
    buffer_load_dwordx4 v245, s[32:35], s16 offen offset:1024  lds
    v_add_u32 v7, 9, v5
    v_and_b32 v8, 1, v7
    v_mul_u32_u24 v8, 4160, v8
    v_lshrrev_b32 v7, 1, v7
    v_lshl_add_u32 v8, v7, 2, v8
    buffer_load_dwordx4 v246, s[32:35], s16 offen offset:2048  lds
    v_lshlrev_b32 v7, 4, v6
    v_sub_u32 v8, v8, v7
    s_add_u32 s78, s94, 32
    v_add_u32 v21, s78, v8
    v_add_u32 v22, 1024, v21
    v_add_u32 v23, 2048, v21
    v_add_u32 v24, 3072, v21
    v_lshl_add_u32 v7, v5, 1, v6
    v_add_u32 v7, 30, v7
    v_and_b32 v8, 1, v7
    s_waitcnt vmcnt(11)
    s_barrier
    s_add_u32 m0, s86, 129536
    s_mov_b32 s89, 0
    buffer_load_dwordx4 v10, s[36:39], s89 offen nt lds
    v_bfe_u32 v136, v7, 1, 2
    v_lshl_add_u32 v136, v8, 2, v136
    v_lshlrev_b32 v136, 6, v136
    v_lshrrev_b32 v7, 3, v7
    s_add_u32 m0, s86, 145920
    s_mov_b32 s89, 0
    buffer_load_dwordx4 v10, s[40:43], s89 offen nt lds
    v_lshl_add_u32 v136, v7, 9, v136
    v_bitop3_b32 v8, v7, 3, s3 bitop3:0x6a
    v_lshl_add_u32 v25, v8, 4, v136
    v_add_u32 v25, 92160, v25
    s_add_u32 m0, s86, 133632
    s_mov_b32 s89, 65536
    buffer_load_dwordx4 v10, s[36:39], s89 offen nt lds
    v_subrev_u32 v7, 1, v7
    v_bitop3_b32 v8, v7, 3, s3 bitop3:0x6a
    v_lshl_add_u32 v27, v8, 4, v136
    v_add_u32 v27, 91648, v27
    s_add_u32 m0, s86, 150016
    s_mov_b32 s89, 65536
    buffer_load_dwordx4 v10, s[40:43], s89 offen nt lds
    v_subrev_u32 v7, 1, v7
    v_bitop3_b32 v8, v7, 3, s3 bitop3:0x6a
    v_lshl_add_u32 v29, v8, 4, v136
    s_add_u32 m0, s86, 137728
    s_mov_b32 s89, 131072
    buffer_load_dwordx4 v10, s[36:39], s89 offen nt lds
    v_add_u32 v29, 91136, v29
    v_subrev_u32 v7, 1, v7
    v_bitop3_b32 v8, v7, 3, s3 bitop3:0x6a
    v_lshl_add_u32 v31, v8, 4, v136
    s_add_u32 m0, s86, 154112
    s_mov_b32 s89, 131072
    buffer_load_dwordx4 v10, s[40:43], s89 offen nt lds
    v_add_u32 v31, 90624, v31
    v_lshl_add_u32 v7, v5, 1, v6
    v_add_u32 v7, 26, v7
    v_and_b32 v8, 1, v7
    s_add_u32 m0, s86, 141824
    s_mov_b32 s89, 196608
    buffer_load_dwordx4 v10, s[36:39], s89 offen nt lds
    v_bfe_u32 v136, v7, 1, 2
    v_lshl_add_u32 v136, v8, 2, v136
    v_lshlrev_b32 v136, 6, v136
    v_lshrrev_b32 v7, 3, v7
    s_add_u32 m0, s86, 158208
    s_mov_b32 s89, 196608
    buffer_load_dwordx4 v10, s[40:43], s89 offen nt lds
    v_lshl_add_u32 v136, v7, 9, v136
    v_bitop3_b32 v8, v7, 3, s3 bitop3:0x6a
    v_lshl_add_u32 v26, v8, 4, v136
    s_mov_b64 exec, 0xff
    s_lshl_b32 s82, s3, 7
    s_add_u32 m0, s82, 129024
    s_mov_b32 s89, 0
    buffer_load_dwordx4 v11, s[36:39], s89 offen nt lds
    s_lshl_b32 s83, s74, 9
    s_add_u32 s83, s83, s82
    s_and_b32 s89, s3, 2
    s_lshl_b32 s89, s89, 3
    s_add_u32 s82, s82, s89
    s_add_u32 m0, s82, 162816
    s_add_u32 s89, s83, 0
    buffer_load_dwordx4 v15, s[44:47], s89 offen  lds
    s_mov_b64 exec, -1
    v_add_u32 v26, 92160, v26
    v_subrev_u32 v7, 1, v7
    v_bitop3_b32 v8, v7, 3, s3 bitop3:0x6a
    v_lshl_add_u32 v28, v8, 4, v136
    s_add_u32 s97, s98, s0
    s_lshr_b64 s[0:1], s[0:1], 4
    s_and_b32 s97, s97, 15
    s_lshr_b32 s99, s97, 3
    s_xor_b32 s97, s97, s99
    s_add_u32 m0, s87, 18432
    s_lshl_b32 s97, s97, 7
    buffer_load_dwordx4 v240, s[28:31], s97 offen offset:0  lds
    v_add_u32 v28, 91648, v28
    v_subrev_u32 v7, 1, v7
    v_bitop3_b32 v8, v7, 3, s3 bitop3:0x6a
    v_lshl_add_u32 v30, v8, 4, v136
    buffer_load_dwordx4 v241, s[28:31], s97 offen offset:1024  lds
    v_add_u32 v30, 91136, v30
    v_subrev_u32 v7, 1, v7
    v_bitop3_b32 v8, v7, 3, s3 bitop3:0x6a
    v_lshl_add_u32 v32, v8, 4, v136
    buffer_load_dwordx4 v242, s[28:31], s97 offen offset:2048  lds
    v_add_u32 v32, 90624, v32
    v_lshrrev_b32 v7, 1, v6
    v_lshl_add_u32 v7, v5, 1, v7
    buffer_load_dwordx4 v243, s[28:31], s97 offen offset:3072  lds
    v_add_u32 v7, 32, v7
    v_and_b32 v8, 1, v7
    v_bfe_u32 v136, v7, 1, 2
    v_lshl_add_u32 v136, v8, 2, v136
    s_add_u32 m0, s88, 18432
    s_mov_b64 exec, 0xffffffff
    buffer_load_dwordx4 v3, s[28:31], s97 offen offset:0  lds
    s_mov_b64 exec, -1
    v_lshlrev_b32 v136, 6, v136
    v_lshrrev_b32 v7, 3, v7
    v_lshl_add_u32 v136, v7, 9, v136
    v_bitop3_b32 v8, v7, 3, s3 bitop3:0x6a
    s_mul_i32 s16, s97, 3072
    s_add_u32 m0, s60, 24576
    s_add_u32 s99, s16, s62
    buffer_load_dwordx4 v244, s[32:35], s99 offen offset:0  lds
    v_lshl_add_u32 v20, v8, 4, v136
    v_add_u32 v20, 92160, v20
    v_and_b32 v8, 1, v6
    v_xor_b32 v8, 1, v8
    buffer_load_dwordx4 v245, s[32:35], s99 offen offset:1024  lds
    v_lshl_add_u32 v20, v8, 3, v20
    s_waitcnt lgkmcnt(0)
    s_and_b32 s78, s92, 0xffff0000
    s_waitcnt vmcnt(17)
    s_barrier
    buffer_load_dwordx4 v246, s[32:35], s99 offen offset:2048  lds
    s_lshl_b32 s92, s92, 16
    s_bitcmp1_b32 s90, 0
    s_cselect_b32 s92, s78, s92
    s_add_u32 m0, s61, 36864
    s_add_u32 s16, s16, s63
    buffer_load_dwordx4 v244, s[32:35], s16 offen offset:0  lds
    v_lshlrev_b32 v7, 3, v6
    buffer_load_dwordx4 v245, s[32:35], s16 offen offset:1024  lds
    v_sub_u32 v7, v7, v5
    buffer_load_dwordx4 v246, s[32:35], s16 offen offset:2048  lds
    v_subrev_u32 v7, 9, v7
    s_add_u32 s97, s98, s0
    s_lshr_b64 s[0:1], s[0:1], 4
    s_and_b32 s97, s97, 15
    s_lshr_b32 s99, s97, 3
    s_xor_b32 s97, s97, s99
    s_add_u32 m0, s87, 36864
    s_lshl_b32 s97, s97, 7
    buffer_load_dwordx4 v240, s[28:31], s97 offen offset:0  lds
    v_and_b32 v8, 1, v7
    buffer_load_dwordx4 v241, s[28:31], s97 offen offset:1024  lds
    v_xor_b32 v8, 1, v8
    v_lshlrev_b32 v8, 4, v8
    buffer_load_dwordx4 v242, s[28:31], s97 offen offset:2048  lds
    v_lshrrev_b32 v8, v8, s92
    buffer_load_dwordx4 v243, s[28:31], s97 offen offset:3072  lds
    v_ashrrev_i32 v7, 1, v7
    s_add_u32 m0, s88, 36864
    s_mov_b64 exec, 0xffffffff
    buffer_load_dwordx4 v3, s[28:31], s97 offen offset:0  lds
    s_mov_b64 exec, -1
    v_cmp_eq_u32 vcc, 0, v7
    s_mul_i32 s16, s97, 3072
    s_add_u32 m0, s60, 49152
    s_add_u32 s99, s16, s62
    buffer_load_dwordx4 v244, s[32:35], s99 offen offset:0  lds
    v_cndmask_b32 v236, 0, v8, vcc
    buffer_load_dwordx4 v245, s[32:35], s99 offen offset:1024  lds
    v_cmp_eq_u32 vcc, 1, v7
    s_nop 1
    v_cndmask_b32 v237, 0, v8, vcc
    buffer_load_dwordx4 v246, s[32:35], s99 offen offset:2048  lds
    v_cmp_eq_u32 vcc, 2, v7
    s_add_u32 m0, s61, 61440
    s_add_u32 s16, s16, s63
    buffer_load_dwordx4 v244, s[32:35], s16 offen offset:0  lds
    v_cndmask_b32 v238, 0, v8, vcc
    buffer_load_dwordx4 v245, s[32:35], s16 offen offset:1024  lds
    v_cmp_eq_u32 vcc, 3, v7
    buffer_load_dwordx4 v246, s[32:35], s16 offen offset:2048  lds
    s_nop 0
    v_cndmask_b32 v239, 0, v8, vcc
    s_waitcnt vmcnt(11)
    s_barrier
    buffer_load_dword v230, v229, s[64:67], 0 offen
    ds_read_b128 v[84:87], v35 offset:0
    ds_read_b128 v[88:91], v35 offset:16
    s_add_u32 s97, s98, s0
    s_lshr_b64 s[0:1], s[0:1], 4
    s_and_b32 s97, s97, 15
    s_lshr_b32 s99, s97, 3
    s_xor_b32 s97, s97, s99
    s_add_u32 m0, s87, 0
    s_lshl_b32 s97, s97, 7
    buffer_load_dwordx4 v240, s[28:31], s97 offen offset:0  lds
    ds_read_b128 v[92:95], v35 offset:32
    buffer_load_dwordx4 v241, s[28:31], s97 offen offset:1024  lds
    ds_read_b128 v[96:99], v35 offset:48
    buffer_load_dwordx4 v242, s[28:31], s97 offen offset:2048  lds
    ds_read_b128 v[40:43], v233 offset:0
    buffer_load_dwordx4 v243, s[28:31], s97 offen offset:3072  lds
    ds_read_b128 v[44:47], v232 offset:256
    ds_read_b128 v[48:51], v233 offset:256
    s_add_u32 m0, s88, 0
    s_mov_b64 exec, 0xffffffff
    buffer_load_dwordx4 v3, s[28:31], s97 offen offset:0  lds
    s_mov_b64 exec, -1
    ds_read_b128 v[52:55], v16 offset:512
    s_mul_i32 s16, s97, 3072
    s_add_u32 m0, s60, 0
    s_add_u32 s99, s16, s62
    buffer_load_dwordx4 v244, s[32:35], s99 offen offset:0  lds
    ds_read_b128 v[56:59], v231 offset:512
    buffer_load_dwordx4 v245, s[32:35], s99 offen offset:1024  lds
    ds_read_b128 v[60:63], v16 offset:768
    buffer_load_dwordx4 v246, s[32:35], s99 offen offset:2048  lds
    ds_read_b128 v[64:67], v231 offset:768
    ds_read_b128 v[68:71], v16 offset:16896
    s_add_u32 m0, s61, 12288
    s_add_u32 s16, s16, s63
    buffer_load_dwordx4 v244, s[32:35], s16 offen offset:0  lds
    ds_read_b128 v[72:75], v231 offset:16896
    buffer_load_dwordx4 v245, s[32:35], s16 offen offset:1024  lds
    ds_read_b128 v[76:79], v16 offset:17152
    buffer_load_dwordx4 v246, s[32:35], s16 offen offset:2048  lds
    ds_read_b128 v[80:83], v231 offset:17152
    s_waitcnt vmcnt(12)
    s_waitcnt lgkmcnt(0)
    s_barrier
    s_add_u32 s97, s98, s0
    s_lshr_b64 s[0:1], s[0:1], 4
    s_and_b32 s97, s97, 15
    s_lshr_b32 s99, s97, 3
    s_xor_b32 s97, s97, s99
    s_add_u32 m0, s87, 18432
    s_lshl_b32 s97, s97, 7
    buffer_load_dwordx4 v240, s[28:31], s97 offen offset:0  lds
    v_lshlrev_b32 v116, 16, v40
    v_lshlrev_b32 v117, 16, v44
    v_lshlrev_b32 v118, 16, v48
    v_lshlrev_b32 v119, 16, v52
    v_lshlrev_b32 v120, 16, v56
    buffer_load_dwordx4 v241, s[28:31], s97 offen offset:1024  lds
    v_lshlrev_b32 v121, 16, v60
    v_lshlrev_b32 v122, 16, v64
    v_lshlrev_b32 v127, 16, v84
    v_and_b32 v128, 0xffff0000, v84
    v_lshlrev_b32 v129, 16, v85
    buffer_load_dwordx4 v242, s[28:31], s97 offen offset:2048  lds
    v_and_b32 v130, 0xffff0000, v85
    v_lshlrev_b32 v123, 16, v68
    v_lshlrev_b32 v124, 16, v72
    v_lshlrev_b32 v125, 16, v76
    v_lshlrev_b32 v126, 16, v80
    buffer_load_dwordx4 v243, s[28:31], s97 offen offset:3072  lds
    v_mul_f32 v131, v116, v130
    v_mul_f32 v132, v117, v130
    v_mul_f32 v133, v118, v130
    v_mul_f32 v134, v119, v130
    v_fmac_f32 v131, v117, v129
    s_add_u32 m0, s88, 18432
    s_mov_b64 exec, 0xffffffff
    buffer_load_dwordx4 v3, s[28:31], s97 offen offset:0  lds
    s_mov_b64 exec, -1
    v_fmac_f32 v132, v118, v129
    v_fmac_f32 v133, v119, v129
    v_fmac_f32 v134, v120, v129
    v_fmac_f32 v131, v118, v128
    v_fmac_f32 v132, v119, v128
    s_mul_i32 s16, s97, 3072
    s_add_u32 m0, s60, 24576
    s_add_u32 s99, s16, s62
    buffer_load_dwordx4 v244, s[32:35], s99 offen offset:0  lds
    v_fmac_f32 v133, v120, v128
    v_fmac_f32 v134, v121, v128
    v_fmac_f32 v131, v119, v127
    v_fmac_f32 v132, v120, v127
    v_fmac_f32 v133, v121, v127
    buffer_load_dwordx4 v245, s[32:35], s99 offen offset:1024  lds
    v_fmac_f32 v134, v122, v127
    v_mul_f32 v131, v131, v123
    v_mul_f32 v132, v132, v124
    v_mul_f32 v133, v133, v125
    v_mul_f32 v134, v134, v126
    buffer_load_dwordx4 v246, s[32:35], s99 offen offset:2048  lds
    v_cvt_pk_bf16_f32 v102, v134, v133
    v_cvt_pk_bf16_f32 v103, v132, v131
    v_lshlrev_b32 v116, 16, v42
    v_lshlrev_b32 v117, 16, v46
    v_lshlrev_b32 v118, 16, v50
    s_add_u32 m0, s61, 36864
    s_add_u32 s16, s16, s63
    buffer_load_dwordx4 v244, s[32:35], s16 offen offset:0  lds
    v_lshlrev_b32 v119, 16, v54
    v_lshlrev_b32 v120, 16, v58
    v_lshlrev_b32 v121, 16, v62
    v_lshlrev_b32 v122, 16, v66
    v_lshlrev_b32 v127, 16, v92
    buffer_load_dwordx4 v245, s[32:35], s16 offen offset:1024  lds
    v_and_b32 v128, 0xffff0000, v92
    v_lshlrev_b32 v129, 16, v93
    v_and_b32 v130, 0xffff0000, v93
    v_lshlrev_b32 v123, 16, v70
    v_lshlrev_b32 v124, 16, v74
    buffer_load_dwordx4 v246, s[32:35], s16 offen offset:2048  lds
    v_lshlrev_b32 v125, 16, v78
    v_lshlrev_b32 v126, 16, v82
    v_mul_f32 v131, v116, v130
    v_mul_f32 v132, v117, v130
    v_mul_f32 v133, v118, v130
    v_mul_f32 v134, v119, v130
    v_fmac_f32 v131, v117, v129
    v_fmac_f32 v132, v118, v129
    v_fmac_f32 v133, v119, v129
    v_fmac_f32 v134, v120, v129
    v_fmac_f32 v131, v118, v128
    v_fmac_f32 v132, v119, v128
    s_waitcnt vmcnt(11)
    s_barrier
    s_add_u32 s97, s98, s0
    s_lshr_b64 s[0:1], s[0:1], 4
    s_and_b32 s97, s97, 15
    s_lshr_b32 s99, s97, 3
    s_xor_b32 s97, s97, s99
    s_add_u32 m0, s87, 36864
    s_lshl_b32 s97, s97, 7
    buffer_load_dwordx4 v240, s[28:31], s97 offen offset:0  lds
    v_fmac_f32 v133, v120, v128
    v_fmac_f32 v134, v121, v128
    v_fmac_f32 v131, v119, v127
    v_fmac_f32 v132, v120, v127
    v_fmac_f32 v133, v121, v127
    buffer_load_dwordx4 v241, s[28:31], s97 offen offset:1024  lds
    v_fmac_f32 v134, v122, v127
    v_mul_f32 v131, v131, v123
    v_mul_f32 v132, v132, v124
    v_mul_f32 v133, v133, v125
    v_mul_f32 v134, v134, v126
    buffer_load_dwordx4 v242, s[28:31], s97 offen offset:2048  lds
    v_cvt_pk_bf16_f32 v100, v134, v133
    v_cvt_pk_bf16_f32 v101, v132, v131
    s_nop 0
    v_permlane32_swap_b32 v102, v100
    v_permlane32_swap_b32 v103, v101
    s_mov_b32 s89, 0
    buffer_store_dwordx4 v[100:103], v12, s[52:55], s89 offen sc1
    buffer_load_dwordx4 v243, s[28:31], s97 offen offset:3072  lds
    v_and_b32 v116, 0xffff0000, v40
    v_and_b32 v117, 0xffff0000, v44
    v_and_b32 v118, 0xffff0000, v48
    v_and_b32 v119, 0xffff0000, v52
    v_and_b32 v120, 0xffff0000, v56
    s_add_u32 m0, s88, 36864
    s_mov_b64 exec, 0xffffffff
    buffer_load_dwordx4 v3, s[28:31], s97 offen offset:0  lds
    s_mov_b64 exec, -1
    v_and_b32 v121, 0xffff0000, v60
    v_and_b32 v122, 0xffff0000, v64
    v_lshlrev_b32 v127, 16, v86
    v_and_b32 v128, 0xffff0000, v86
    v_lshlrev_b32 v129, 16, v87
    s_mul_i32 s16, s97, 3072
    s_add_u32 m0, s60, 49152
    s_add_u32 s99, s16, s62
    buffer_load_dwordx4 v244, s[32:35], s99 offen offset:0  lds
    v_and_b32 v130, 0xffff0000, v87
    v_and_b32 v123, 0xffff0000, v68
    v_and_b32 v124, 0xffff0000, v72
    v_and_b32 v125, 0xffff0000, v76
    v_and_b32 v126, 0xffff0000, v80
    buffer_load_dwordx4 v245, s[32:35], s99 offen offset:1024  lds
    v_mul_f32 v131, v116, v130
    v_mul_f32 v132, v117, v130
    v_mul_f32 v133, v118, v130
    v_mul_f32 v134, v119, v130
    v_fmac_f32 v131, v117, v129
    buffer_load_dwordx4 v246, s[32:35], s99 offen offset:2048  lds
    v_fmac_f32 v132, v118, v129
    v_fmac_f32 v133, v119, v129
    v_fmac_f32 v134, v120, v129
    v_fmac_f32 v131, v118, v128
    v_fmac_f32 v132, v119, v128
    s_add_u32 m0, s61, 61440
    s_add_u32 s16, s16, s63
    buffer_load_dwordx4 v244, s[32:35], s16 offen offset:0  lds
    v_fmac_f32 v133, v120, v128
    v_fmac_f32 v134, v121, v128
    v_fmac_f32 v131, v119, v127
    v_fmac_f32 v132, v120, v127
    v_fmac_f32 v133, v121, v127
    buffer_load_dwordx4 v245, s[32:35], s16 offen offset:1024  lds
    v_fmac_f32 v134, v122, v127
    v_mul_f32 v131, v131, v123
    v_mul_f32 v132, v132, v124
    v_mul_f32 v133, v133, v125
    v_mul_f32 v134, v134, v126
    buffer_load_dwordx4 v246, s[32:35], s16 offen offset:2048  lds
    v_cvt_pk_bf16_f32 v106, v134, v133
    v_cvt_pk_bf16_f32 v107, v132, v131
    v_and_b32 v116, 0xffff0000, v42
    v_and_b32 v117, 0xffff0000, v46
    v_and_b32 v118, 0xffff0000, v50
    v_and_b32 v119, 0xffff0000, v54
    v_and_b32 v120, 0xffff0000, v58
    v_and_b32 v121, 0xffff0000, v62
    v_and_b32 v122, 0xffff0000, v66
    v_lshlrev_b32 v127, 16, v94
    v_and_b32 v128, 0xffff0000, v94
    v_lshlrev_b32 v129, 16, v95
    s_waitcnt vmcnt(12)
    s_barrier
    s_add_u32 s97, s98, s0
    s_lshr_b64 s[0:1], s[0:1], 4
    s_and_b32 s97, s97, 15
    s_lshr_b32 s99, s97, 3
    s_xor_b32 s97, s97, s99
    s_add_u32 m0, s87, 0
    s_lshl_b32 s97, s97, 7
    buffer_load_dwordx4 v240, s[28:31], s97 offen offset:0  lds
    v_and_b32 v130, 0xffff0000, v95
    v_and_b32 v123, 0xffff0000, v70
    v_and_b32 v124, 0xffff0000, v74
    v_and_b32 v125, 0xffff0000, v78
    v_and_b32 v126, 0xffff0000, v82
    buffer_load_dwordx4 v241, s[28:31], s97 offen offset:1024  lds
    v_mul_f32 v131, v116, v130
    v_mul_f32 v132, v117, v130
    v_mul_f32 v133, v118, v130
    v_mul_f32 v134, v119, v130
    v_fmac_f32 v131, v117, v129
    buffer_load_dwordx4 v242, s[28:31], s97 offen offset:2048  lds
    v_fmac_f32 v132, v118, v129
    v_fmac_f32 v133, v119, v129
    v_fmac_f32 v134, v120, v129
    v_fmac_f32 v131, v118, v128
    v_fmac_f32 v132, v119, v128
    buffer_load_dwordx4 v243, s[28:31], s97 offen offset:3072  lds
    v_fmac_f32 v133, v120, v128
    v_fmac_f32 v134, v121, v128
    v_fmac_f32 v131, v119, v127
    v_fmac_f32 v132, v120, v127
    v_fmac_f32 v133, v121, v127
    s_add_u32 m0, s88, 0
    s_mov_b64 exec, 0xffffffff
    buffer_load_dwordx4 v3, s[28:31], s97 offen offset:0  lds
    s_mov_b64 exec, -1
    v_fmac_f32 v134, v122, v127
    v_mul_f32 v131, v131, v123
    v_mul_f32 v132, v132, v124
    v_mul_f32 v133, v133, v125
    v_mul_f32 v134, v134, v126
    s_mul_i32 s16, s97, 3072
    s_add_u32 m0, s60, 0
    s_add_u32 s99, s16, s62
    buffer_load_dwordx4 v244, s[32:35], s99 offen offset:0  lds
    v_cvt_pk_bf16_f32 v104, v134, v133
    v_cvt_pk_bf16_f32 v105, v132, v131
    s_nop 0
    v_permlane32_swap_b32 v106, v104
    v_permlane32_swap_b32 v107, v105
    s_mov_b32 s89, 16384
    buffer_store_dwordx4 v[104:107], v12, s[52:55], s89 offen sc1
    buffer_load_dwordx4 v245, s[32:35], s99 offen offset:1024  lds
    v_lshlrev_b32 v116, 16, v41
    v_lshlrev_b32 v117, 16, v45
    v_lshlrev_b32 v118, 16, v49
    v_lshlrev_b32 v119, 16, v53
    v_lshlrev_b32 v120, 16, v57
    buffer_load_dwordx4 v246, s[32:35], s99 offen offset:2048  lds
    v_lshlrev_b32 v121, 16, v61
    v_lshlrev_b32 v122, 16, v65
    v_lshlrev_b32 v127, 16, v88
    v_and_b32 v128, 0xffff0000, v88
    v_lshlrev_b32 v129, 16, v89
    s_add_u32 m0, s61, 12288
    s_add_u32 s16, s16, s63
    buffer_load_dwordx4 v244, s[32:35], s16 offen offset:0  lds
    v_and_b32 v130, 0xffff0000, v89
    v_lshlrev_b32 v123, 16, v69
    v_lshlrev_b32 v124, 16, v73
    v_lshlrev_b32 v125, 16, v77
    v_lshlrev_b32 v126, 16, v81
    buffer_load_dwordx4 v245, s[32:35], s16 offen offset:1024  lds
    v_mul_f32 v131, v116, v130
    v_mul_f32 v132, v117, v130
    v_mul_f32 v133, v118, v130
    v_mul_f32 v134, v119, v130
    v_fmac_f32 v131, v117, v129
    buffer_load_dwordx4 v246, s[32:35], s16 offen offset:2048  lds
    v_fmac_f32 v132, v118, v129
    v_fmac_f32 v133, v119, v129
    v_fmac_f32 v134, v120, v129
    v_fmac_f32 v131, v118, v128
    v_fmac_f32 v132, v119, v128
    v_fmac_f32 v133, v120, v128
    v_fmac_f32 v134, v121, v128
    v_fmac_f32 v131, v119, v127
    v_fmac_f32 v132, v120, v127
    v_fmac_f32 v133, v121, v127
    v_fmac_f32 v134, v122, v127
    v_mul_f32 v131, v131, v123
    s_waitcnt vmcnt(12)
    s_barrier
    s_add_u32 s97, s98, s0
    s_lshr_b64 s[0:1], s[0:1], 4
    s_and_b32 s97, s97, 15
    s_lshr_b32 s99, s97, 3
    s_xor_b32 s97, s97, s99
    s_add_u32 m0, s87, 18432
    s_lshl_b32 s97, s97, 7
    buffer_load_dwordx4 v240, s[28:31], s97 offen offset:0  lds
    v_mul_f32 v132, v132, v124
    v_mul_f32 v133, v133, v125
    v_mul_f32 v134, v134, v126
    v_cvt_pk_bf16_f32 v110, v134, v133
    v_cvt_pk_bf16_f32 v111, v132, v131
    buffer_load_dwordx4 v241, s[28:31], s97 offen offset:1024  lds
    v_lshlrev_b32 v116, 16, v43
    v_lshlrev_b32 v117, 16, v47
    v_lshlrev_b32 v118, 16, v51
    v_lshlrev_b32 v119, 16, v55
    v_lshlrev_b32 v120, 16, v59
    buffer_load_dwordx4 v242, s[28:31], s97 offen offset:2048  lds
    v_lshlrev_b32 v121, 16, v63
    v_lshlrev_b32 v122, 16, v67
    v_lshlrev_b32 v127, 16, v96
    v_and_b32 v128, 0xffff0000, v96
    v_lshlrev_b32 v129, 16, v97
    buffer_load_dwordx4 v243, s[28:31], s97 offen offset:3072  lds
    v_and_b32 v130, 0xffff0000, v97
    v_lshlrev_b32 v123, 16, v71
    v_lshlrev_b32 v124, 16, v75
    v_lshlrev_b32 v125, 16, v79
    v_lshlrev_b32 v126, 16, v83
    s_add_u32 m0, s88, 18432
    s_mov_b64 exec, 0xffffffff
    buffer_load_dwordx4 v3, s[28:31], s97 offen offset:0  lds
    s_mov_b64 exec, -1
    v_mul_f32 v131, v116, v130
    v_mul_f32 v132, v117, v130
    v_mul_f32 v133, v118, v130
    v_mul_f32 v134, v119, v130
    v_fmac_f32 v131, v117, v129
    s_mul_i32 s16, s97, 3072
    s_add_u32 m0, s60, 24576
    s_add_u32 s99, s16, s62
    buffer_load_dwordx4 v244, s[32:35], s99 offen offset:0  lds
    v_fmac_f32 v132, v118, v129
    v_fmac_f32 v133, v119, v129
    v_fmac_f32 v134, v120, v129
    v_fmac_f32 v131, v118, v128
    v_fmac_f32 v132, v119, v128
    buffer_load_dwordx4 v245, s[32:35], s99 offen offset:1024  lds
    v_fmac_f32 v133, v120, v128
    v_fmac_f32 v134, v121, v128
    v_fmac_f32 v131, v119, v127
    v_fmac_f32 v132, v120, v127
    v_fmac_f32 v133, v121, v127
    buffer_load_dwordx4 v246, s[32:35], s99 offen offset:2048  lds
    v_fmac_f32 v134, v122, v127
    v_mul_f32 v131, v131, v123
    v_mul_f32 v132, v132, v124
    v_mul_f32 v133, v133, v125
    v_mul_f32 v134, v134, v126
    s_add_u32 m0, s61, 36864
    s_add_u32 s16, s16, s63
    buffer_load_dwordx4 v244, s[32:35], s16 offen offset:0  lds
    v_cvt_pk_bf16_f32 v108, v134, v133
    v_cvt_pk_bf16_f32 v109, v132, v131
    s_nop 0
    v_permlane32_swap_b32 v110, v108
    v_permlane32_swap_b32 v111, v109
    s_mov_b32 s89, 32768
    buffer_store_dwordx4 v[108:111], v12, s[52:55], s89 offen sc1
    buffer_load_dwordx4 v245, s[32:35], s16 offen offset:1024  lds
    v_and_b32 v116, 0xffff0000, v41
    v_and_b32 v117, 0xffff0000, v45
    v_and_b32 v118, 0xffff0000, v49
    v_and_b32 v119, 0xffff0000, v53
    v_and_b32 v120, 0xffff0000, v57
    buffer_load_dwordx4 v246, s[32:35], s16 offen offset:2048  lds
    v_and_b32 v121, 0xffff0000, v61
    v_and_b32 v122, 0xffff0000, v65
    v_lshlrev_b32 v127, 16, v90
    v_and_b32 v128, 0xffff0000, v90
    v_lshlrev_b32 v129, 16, v91
    v_and_b32 v130, 0xffff0000, v91
    v_and_b32 v123, 0xffff0000, v69
    v_and_b32 v124, 0xffff0000, v73
    v_and_b32 v125, 0xffff0000, v77
    v_and_b32 v126, 0xffff0000, v81
    v_mul_f32 v131, v116, v130
    v_mul_f32 v132, v117, v130
    s_waitcnt vmcnt(12)
    s_barrier
    s_add_u32 s97, s98, s0
    s_lshr_b64 s[0:1], s[0:1], 4
    s_and_b32 s97, s97, 15
    s_lshr_b32 s99, s97, 3
    s_xor_b32 s97, s97, s99
    s_add_u32 m0, s87, 36864
    s_lshl_b32 s97, s97, 7
    buffer_load_dwordx4 v240, s[28:31], s97 offen offset:0  lds
    v_mul_f32 v133, v118, v130
    v_mul_f32 v134, v119, v130
    v_fmac_f32 v131, v117, v129
    v_fmac_f32 v132, v118, v129
    v_fmac_f32 v133, v119, v129
    buffer_load_dwordx4 v241, s[28:31], s97 offen offset:1024  lds
    v_fmac_f32 v134, v120, v129
    v_fmac_f32 v131, v118, v128
    v_fmac_f32 v132, v119, v128
    v_fmac_f32 v133, v120, v128
    v_fmac_f32 v134, v121, v128
    buffer_load_dwordx4 v242, s[28:31], s97 offen offset:2048  lds
    v_fmac_f32 v131, v119, v127
    v_fmac_f32 v132, v120, v127
    v_fmac_f32 v133, v121, v127
    v_fmac_f32 v134, v122, v127
    v_mul_f32 v131, v131, v123
    buffer_load_dwordx4 v243, s[28:31], s97 offen offset:3072  lds
    v_mul_f32 v132, v132, v124
    v_mul_f32 v133, v133, v125
    v_mul_f32 v134, v134, v126
    v_cvt_pk_bf16_f32 v114, v134, v133
    v_cvt_pk_bf16_f32 v115, v132, v131
    s_add_u32 m0, s88, 36864
    s_mov_b64 exec, 0xffffffff
    buffer_load_dwordx4 v3, s[28:31], s97 offen offset:0  lds
    s_mov_b64 exec, -1
    v_and_b32 v116, 0xffff0000, v43
    v_and_b32 v117, 0xffff0000, v47
    v_and_b32 v118, 0xffff0000, v51
    v_and_b32 v119, 0xffff0000, v55
    v_and_b32 v120, 0xffff0000, v59
    s_mul_i32 s16, s97, 3072
    s_add_u32 m0, s60, 49152
    s_add_u32 s99, s16, s62
    buffer_load_dwordx4 v244, s[32:35], s99 offen offset:0  lds
    v_and_b32 v121, 0xffff0000, v63
    v_and_b32 v122, 0xffff0000, v67
    v_lshlrev_b32 v127, 16, v98
    v_and_b32 v128, 0xffff0000, v98
    v_lshlrev_b32 v129, 16, v99
    buffer_load_dwordx4 v245, s[32:35], s99 offen offset:1024  lds
    v_and_b32 v130, 0xffff0000, v99
    v_and_b32 v123, 0xffff0000, v71
    v_and_b32 v124, 0xffff0000, v75
    v_and_b32 v125, 0xffff0000, v79
    v_and_b32 v126, 0xffff0000, v83
    buffer_load_dwordx4 v246, s[32:35], s99 offen offset:2048  lds
    v_mul_f32 v131, v116, v130
    v_mul_f32 v132, v117, v130
    v_mul_f32 v133, v118, v130
    v_mul_f32 v134, v119, v130
    v_fmac_f32 v131, v117, v129
    s_add_u32 m0, s61, 61440
    s_add_u32 s16, s16, s63
    buffer_load_dwordx4 v244, s[32:35], s16 offen offset:0  lds
    v_fmac_f32 v132, v118, v129
    v_fmac_f32 v133, v119, v129
    v_fmac_f32 v134, v120, v129
    v_fmac_f32 v131, v118, v128
    v_fmac_f32 v132, v119, v128
    buffer_load_dwordx4 v245, s[32:35], s16 offen offset:1024  lds
    v_fmac_f32 v133, v120, v128
    v_fmac_f32 v134, v121, v128
    v_fmac_f32 v131, v119, v127
    v_fmac_f32 v132, v120, v127
    v_fmac_f32 v133, v121, v127
    buffer_load_dwordx4 v246, s[32:35], s16 offen offset:2048  lds
    v_fmac_f32 v134, v122, v127
    v_mul_f32 v131, v131, v123
    v_mul_f32 v132, v132, v124
    v_mul_f32 v133, v133, v125
    v_mul_f32 v134, v134, v126
    v_cvt_pk_bf16_f32 v112, v134, v133
    v_cvt_pk_bf16_f32 v113, v132, v131
    s_nop 0
    v_permlane32_swap_b32 v114, v112
    v_permlane32_swap_b32 v115, v113
    s_mov_b32 s89, 49152
    buffer_store_dwordx4 v[112:115], v12, s[52:55], s89 offen sc1
    s_waitcnt vmcnt(12)
    s_barrier
    s_add_u32 m0, s94, 32
    s_lshl_b32 s89, s90, 12
    buffer_load_dwordx4 v15, s[48:51], s89 offen offset:0 nt lds
    s_add_u32 m0, s94, 32
    s_lshl_b32 s89, s90, 12
    buffer_load_dwordx4 v15, s[48:51], s89 offen offset:1024 nt lds
    s_add_u32 m0, s94, 32
    s_lshl_b32 s89, s90, 12
    buffer_load_dwordx4 v15, s[48:51], s89 offen offset:2048 nt lds
    s_add_u32 m0, s94, 32
    s_lshl_b32 s89, s90, 12
    buffer_load_dwordx4 v15, s[48:51], s89 offen offset:3072 nt lds
    s_add_u32 s97, s98, s0
    s_lshr_b64 s[0:1], s[0:1], 4
    s_and_b32 s97, s97, 15
    s_lshr_b32 s99, s97, 3
    s_xor_b32 s97, s97, s99
    s_add_u32 m0, s87, 0
    s_lshl_b32 s97, s97, 7
    buffer_load_dwordx4 v240, s[28:31], s97 offen offset:0  lds
    buffer_load_dwordx4 v241, s[28:31], s97 offen offset:1024  lds
    buffer_load_dwordx4 v242, s[28:31], s97 offen offset:2048  lds
    buffer_load_dwordx4 v243, s[28:31], s97 offen offset:3072  lds
    s_add_u32 m0, s88, 0
    s_mov_b64 exec, 0xffffffff
    buffer_load_dwordx4 v3, s[28:31], s97 offen offset:0  lds
    s_mov_b64 exec, -1
    s_mul_i32 s16, s97, 3072
    s_add_u32 m0, s60, 0
    s_add_u32 s99, s16, s62
    buffer_load_dwordx4 v244, s[32:35], s99 offen offset:0  lds
    buffer_load_dwordx4 v245, s[32:35], s99 offen offset:1024  lds
    buffer_load_dwordx4 v246, s[32:35], s99 offen offset:2048  lds
    s_add_u32 m0, s61, 12288
    s_add_u32 s16, s16, s63
    buffer_load_dwordx4 v244, s[32:35], s16 offen offset:0  lds
    buffer_load_dwordx4 v245, s[32:35], s16 offen offset:1024  lds
    buffer_load_dwordx4 v246, s[32:35], s16 offen offset:2048  lds
    s_waitcnt vmcnt(16)
    s_barrier
    s_add_u32 s97, s98, s0
    s_lshr_b64 s[0:1], s[0:1], 4
    s_and_b32 s97, s97, 15
    s_lshr_b32 s99, s97, 3
    s_xor_b32 s97, s97, s99
    s_add_u32 m0, s87, 18432
    s_lshl_b32 s97, s97, 7
    buffer_load_dwordx4 v240, s[28:31], s97 offen offset:0  lds
    buffer_load_dwordx4 v241, s[28:31], s97 offen offset:1024  lds
    buffer_load_dwordx4 v242, s[28:31], s97 offen offset:2048  lds
    buffer_load_dwordx4 v243, s[28:31], s97 offen offset:3072  lds
    s_add_u32 m0, s88, 18432
    s_mov_b64 exec, 0xffffffff
    buffer_load_dwordx4 v3, s[28:31], s97 offen offset:0  lds
    s_mov_b64 exec, -1
    s_mul_i32 s16, s97, 3072
    s_add_u32 m0, s60, 24576
    s_add_u32 s99, s16, s62
    buffer_load_dwordx4 v244, s[32:35], s99 offen offset:0  lds
    buffer_load_dwordx4 v245, s[32:35], s99 offen offset:1024  lds
    buffer_load_dwordx4 v246, s[32:35], s99 offen offset:2048  lds
    s_add_u32 m0, s61, 36864
    s_add_u32 s16, s16, s63
    buffer_load_dwordx4 v244, s[32:35], s16 offen offset:0  lds
    buffer_load_dwordx4 v245, s[32:35], s16 offen offset:1024  lds
    buffer_load_dwordx4 v246, s[32:35], s16 offen offset:2048  lds
    s_waitcnt vmcnt(11)
    s_barrier
    s_add_u32 s97, s98, s0
    s_lshr_b64 s[0:1], s[0:1], 4
    s_and_b32 s97, s97, 15
    s_lshr_b32 s99, s97, 3
    s_xor_b32 s97, s97, s99
    s_add_u32 m0, s87, 36864
    s_lshl_b32 s97, s97, 7
    buffer_load_dwordx4 v240, s[28:31], s97 offen offset:0  lds
    v_add_u32 v5, s94, v15
    ds_read_b128 v[140:143], v5 offset:32
    ds_read_b32 v156, v5 offset:48
    ds_read_b128 v[144:147], v5 offset:1056
    buffer_load_dwordx4 v241, s[28:31], s97 offen offset:1024  lds
    ds_read_b32 v157, v5 offset:1072
    ds_read_b128 v[148:151], v5 offset:2080
    ds_read_b32 v158, v5 offset:2096
    ds_read_b128 v[152:155], v5 offset:3104
    buffer_load_dwordx4 v242, s[28:31], s97 offen offset:2048  lds
    ds_read_b32 v159, v5 offset:3120
    v_lshrrev_b32 v6, 3, v0
    v_mul_u32_u24 v6, 4160, v6
    buffer_load_dwordx4 v243, s[28:31], s97 offen offset:3072  lds
    v_and_b32 v7, 7, v0
    v_lshl_add_u32 v6, v7, 2, v6
    v_add_u32 v6, s94, v6
    v_mov_b32 v7, 0
    s_add_u32 m0, s88, 36864
    s_mov_b64 exec, 0xffffffff
    buffer_load_dwordx4 v3, s[28:31], s97 offen offset:0  lds
    s_mov_b64 exec, -1
    s_waitcnt lgkmcnt(0)
    v_readfirstlane_b32 s93, v140
    s_nop 0
    s_lshl_b32 s93, s93, 16
    s_nop 1
    v_writelane_b32 v7, s93, 15
    s_mul_i32 s16, s97, 3072
    s_add_u32 m0, s60, 49152
    s_add_u32 s99, s16, s62
    buffer_load_dwordx4 v244, s[32:35], s99 offen offset:0  lds
    v_alignbit_b32 v140, v141, v140, 16
    v_alignbit_b32 v141, v142, v141, 16
    v_alignbit_b32 v142, v143, v142, 16
    buffer_load_dwordx4 v245, s[32:35], s99 offen offset:1024  lds
    v_alignbit_b32 v143, v156, v143, 16
    v_alignbit_b32 v144, v145, v144, 16
    v_alignbit_b32 v145, v146, v145, 16
    v_alignbit_b32 v146, v147, v146, 16
    buffer_load_dwordx4 v246, s[32:35], s99 offen offset:2048  lds
    v_alignbit_b32 v147, v157, v147, 16
    v_alignbit_b32 v148, v149, v148, 16
    v_alignbit_b32 v149, v150, v149, 16
    v_alignbit_b32 v150, v151, v150, 16
    s_add_u32 m0, s61, 61440
    s_add_u32 s16, s16, s63
    buffer_load_dwordx4 v244, s[32:35], s16 offen offset:0  lds
    v_alignbit_b32 v151, v158, v151, 16
    v_alignbit_b32 v152, v153, v152, 16
    v_alignbit_b32 v153, v154, v153, 16
    buffer_load_dwordx4 v245, s[32:35], s16 offen offset:1024  lds
    v_alignbit_b32 v154, v155, v154, 16
    v_alignbit_b32 v155, v159, v155, 16
    v_lshlrev_b32 v8, 3, v0
    s_add_u32 s78, s88, 18432
    buffer_load_dwordx4 v246, s[32:35], s16 offen offset:2048  lds
    v_add_u32 v8, s78, v8
    v_mov_b32 v156, 0
    v_mov_b32 v157, 0
    s_waitcnt vmcnt(11)
    s_barrier
    s_add_u32 s97, s98, s0
    s_lshr_b64 s[0:1], s[0:1], 4
    s_and_b32 s97, s97, 15
    s_lshr_b32 s99, s97, 3
    s_xor_b32 s97, s97, s99
    s_add_u32 m0, s87, 0
    s_lshl_b32 s97, s97, 7
    buffer_load_dwordx4 v240, s[28:31], s97 offen offset:0  lds
    buffer_load_dwordx4 v241, s[28:31], s97 offen offset:1024  lds
    buffer_load_dwordx4 v242, s[28:31], s97 offen offset:2048  lds
    buffer_load_dwordx4 v243, s[28:31], s97 offen offset:3072  lds
    s_add_u32 m0, s88, 0
    s_mov_b64 exec, 0xffffffff
    buffer_load_dwordx4 v3, s[28:31], s97 offen offset:0  lds
    s_mov_b64 exec, -1
    s_mul_i32 s16, s97, 3072
    s_add_u32 m0, s60, 0
    s_add_u32 s99, s16, s62
    buffer_load_dwordx4 v244, s[32:35], s99 offen offset:0  lds
    buffer_load_dwordx4 v245, s[32:35], s99 offen offset:1024  lds
    buffer_load_dwordx4 v246, s[32:35], s99 offen offset:2048  lds
    s_add_u32 m0, s61, 12288
    s_add_u32 s16, s16, s63
    buffer_load_dwordx4 v244, s[32:35], s16 offen offset:0  lds
    buffer_load_dwordx4 v245, s[32:35], s16 offen offset:1024  lds
    buffer_load_dwordx4 v246, s[32:35], s16 offen offset:2048  lds
    s_mov_b64 exec, 0xff
    buffer_load_dword v136, v33, s[68:71], 0 offen sc1
    buffer_load_dword v137, v34, s[52:55], 0 offen sc1
    s_mov_b64 exec, -1
    s_waitcnt vmcnt(13)
    s_barrier
    s_waitcnt vmcnt(0)
    s_branch LA_j
LA_c2:
    s_waitcnt vmcnt(7)
    s_barrier
    buffer_load_dwordx4 v246, s[32:35], s99 offen offset:2048  lds
    s_add_u32 m0, s61, 36864
    s_add_u32 s16, s16, s63
    buffer_load_dwordx4 v244, s[32:35], s16 offen offset:0  lds
    buffer_load_dwordx4 v245, s[32:35], s16 offen offset:1024  lds
    buffer_load_dwordx4 v246, s[32:35], s16 offen offset:2048  lds
    s_add_u32 s97, s98, s0
    s_lshr_b64 s[0:1], s[0:1], 4
    s_and_b32 s97, s97, 15
    s_lshr_b32 s99, s97, 3
    s_xor_b32 s97, s97, s99
    s_add_u32 m0, s87, 36864
    s_lshl_b32 s97, s97, 7
    buffer_load_dwordx4 v240, s[28:31], s97 offen offset:0  lds
    buffer_load_dwordx4 v241, s[28:31], s97 offen offset:1024  lds
    buffer_load_dwordx4 v242, s[28:31], s97 offen offset:2048  lds
    buffer_load_dwordx4 v243, s[28:31], s97 offen offset:3072  lds
    s_add_u32 m0, s88, 36864
    s_mov_b64 exec, 0xffffffff
    buffer_load_dwordx4 v3, s[28:31], s97 offen offset:0  lds
    s_mov_b64 exec, -1
    s_mul_i32 s16, s97, 3072
    s_add_u32 m0, s60, 49152
    s_add_u32 s99, s16, s62
    buffer_load_dwordx4 v244, s[32:35], s99 offen offset:0  lds
    buffer_load_dwordx4 v245, s[32:35], s99 offen offset:1024  lds
    buffer_load_dwordx4 v246, s[32:35], s99 offen offset:2048  lds
    s_add_u32 m0, s61, 61440
    s_add_u32 s16, s16, s63
    buffer_load_dwordx4 v244, s[32:35], s16 offen offset:0  lds
    buffer_load_dwordx4 v245, s[32:35], s16 offen offset:1024  lds
    buffer_load_dwordx4 v246, s[32:35], s16 offen offset:2048  lds
    s_waitcnt vmcnt(11)
    s_barrier
    s_add_u32 s97, s98, s0
    s_lshr_b64 s[0:1], s[0:1], 4
    s_and_b32 s97, s97, 15
    s_lshr_b32 s99, s97, 3
    s_xor_b32 s97, s97, s99
    s_add_u32 m0, s87, 0
    s_lshl_b32 s97, s97, 7
    buffer_load_dwordx4 v240, s[28:31], s97 offen offset:0  lds
    s_mov_b32 s68, s24
    s_mov_b32 s69, s25
    s_mov_b32 s70, 0x100
    s_mov_b32 s71, 0x20000
    v_lshrrev_b32 v6, 5, v0
    buffer_load_dwordx4 v241, s[28:31], s97 offen offset:1024  lds
    v_and_b32 v7, 3, v0
    s_lshr_b32 s78, s90, 1
    s_lshl_b32 s78, s78, 2
    s_load_dword s92, s[14:15], s78
    s_mul_i32 s94, s3, 8320
    buffer_load_dwordx4 v242, s[28:31], s97 offen offset:2048  lds
    s_add_u32 s94, s94, 129024
    v_bfe_u32 v5, v0, 2, 2
    v_lshlrev_b32 v5, 1, v5
    v_lshl_add_u32 v5, v6, 3, v5
    v_bfe_u32 v8, v0, 4, 1
    buffer_load_dwordx4 v243, s[28:31], s97 offen offset:3072  lds
    v_add_u32 v5, v5, v8
    s_and_b32 s78, s3, 1
    s_lshl_b32 s78, s78, 1
    v_add_u32 v8, s78, v6
    v_xor_b32 v8, v8, v7
    s_add_u32 m0, s88, 0
    s_mov_b64 exec, 0xffffffff
    buffer_load_dwordx4 v3, s[28:31], s97 offen offset:0  lds
    s_mov_b64 exec, -1
    v_lshlrev_b32 v8, 4, v8
    v_lshl_add_u32 v5, v5, 6, v8
    v_add_u32 v14, s86, v5
    v_mov_b32 v18, 162304
    v_mov_b32 v19, 1
    s_mul_i32 s16, s97, 3072
    s_add_u32 m0, s60, 0
    s_add_u32 s99, s16, s62
    buffer_load_dwordx4 v244, s[32:35], s99 offen offset:0  lds
    v_and_b32 v5, 3, v0
    s_lshl_b32 s78, s74, 4
    s_add_u32 s78, s78, s3
    v_lshl_add_u32 v6, v5, 2, s78
    s_lshr_b32 s78, s76, 3
    buffer_load_dwordx4 v245, s[32:35], s99 offen offset:1024  lds
    s_lshl_b32 s79, s3, 1
    s_add_u32 s78, s78, s79
    s_xor_b32 s78, s78, 0
    s_lshl_b32 s78, s78, 5
    s_and_b32 s79, s76, 7
    buffer_load_dwordx4 v246, s[32:35], s99 offen offset:2048  lds
    s_add_u32 s78, s78, s79
    v_lshl_add_u32 v7, v5, 3, s78
    v_and_b32 v8, 4, v0
    v_cmp_eq_u32 vcc, 0, v8
    s_nop 1
    v_cndmask_b32 v6, v7, v6, vcc
    s_add_u32 m0, s61, 12288
    s_add_u32 s16, s16, s63
    buffer_load_dwordx4 v244, s[32:35], s16 offen offset:0  lds
    v_and_b32 v33, 0xf0, v6
    v_lshlrev_b32 v34, 8, v6
    v_add_u32 v34, 12582912, v34
    v_and_b32 v5, 15, v0
    v_lshrrev_b32 v6, 4, v0
    buffer_load_dwordx4 v245, s[32:35], s16 offen offset:1024  lds
    v_add_u32 v7, 9, v5
    v_and_b32 v8, 1, v7
    v_mul_u32_u24 v8, 4160, v8
    v_lshrrev_b32 v7, 1, v7
    v_lshl_add_u32 v8, v7, 2, v8
    buffer_load_dwordx4 v246, s[32:35], s16 offen offset:2048  lds
    v_lshlrev_b32 v7, 4, v6
    v_sub_u32 v8, v8, v7
    s_add_u32 s78, s94, 32
    v_add_u32 v21, s78, v8
    v_add_u32 v22, 1024, v21
    v_add_u32 v23, 2048, v21
    v_add_u32 v24, 3072, v21
    v_lshl_add_u32 v7, v5, 1, v6
    v_add_u32 v7, 30, v7
    v_and_b32 v8, 1, v7
    s_waitcnt vmcnt(11)
    s_barrier
    s_add_u32 s97, s98, s0
    s_lshr_b64 s[0:1], s[0:1], 4
    s_and_b32 s97, s97, 15
    s_lshr_b32 s99, s97, 3
    s_xor_b32 s97, s97, s99
    s_add_u32 m0, s87, 18432
    s_lshl_b32 s97, s97, 7
    buffer_load_dwordx4 v240, s[28:31], s97 offen offset:0  lds
    v_bfe_u32 v136, v7, 1, 2
    v_lshl_add_u32 v136, v8, 2, v136
    v_lshlrev_b32 v136, 6, v136
    v_lshrrev_b32 v7, 3, v7
    v_lshl_add_u32 v136, v7, 9, v136
    buffer_load_dwordx4 v241, s[28:31], s97 offen offset:1024  lds
    v_bitop3_b32 v8, v7, 3, s3 bitop3:0x6a
    v_lshl_add_u32 v25, v8, 4, v136
    v_add_u32 v25, 92160, v25
    v_subrev_u32 v7, 1, v7
    v_bitop3_b32 v8, v7, 3, s3 bitop3:0x6a
    buffer_load_dwordx4 v242, s[28:31], s97 offen offset:2048  lds
    v_lshl_add_u32 v27, v8, 4, v136
    v_add_u32 v27, 91648, v27
    v_subrev_u32 v7, 1, v7
    v_bitop3_b32 v8, v7, 3, s3 bitop3:0x6a
    v_lshl_add_u32 v29, v8, 4, v136
    buffer_load_dwordx4 v243, s[28:31], s97 offen offset:3072  lds
    v_add_u32 v29, 91136, v29
    v_subrev_u32 v7, 1, v7
    v_bitop3_b32 v8, v7, 3, s3 bitop3:0x6a
    v_lshl_add_u32 v31, v8, 4, v136
    v_add_u32 v31, 90624, v31
    s_add_u32 m0, s88, 18432
    s_mov_b64 exec, 0xffffffff
    buffer_load_dwordx4 v3, s[28:31], s97 offen offset:0  lds
    s_mov_b64 exec, -1
    v_lshl_add_u32 v7, v5, 1, v6
    v_add_u32 v7, 26, v7
    v_and_b32 v8, 1, v7
    v_bfe_u32 v136, v7, 1, 2
    v_lshl_add_u32 v136, v8, 2, v136
    s_mul_i32 s16, s97, 3072
    s_add_u32 m0, s60, 24576
    s_add_u32 s99, s16, s62
    buffer_load_dwordx4 v244, s[32:35], s99 offen offset:0  lds
    v_lshlrev_b32 v136, 6, v136
    v_lshrrev_b32 v7, 3, v7
    v_lshl_add_u32 v136, v7, 9, v136
    v_bitop3_b32 v8, v7, 3, s3 bitop3:0x6a
    v_lshl_add_u32 v26, v8, 4, v136
    buffer_load_dwordx4 v245, s[32:35], s99 offen offset:1024  lds
    v_add_u32 v26, 92160, v26
    v_subrev_u32 v7, 1, v7
    v_bitop3_b32 v8, v7, 3, s3 bitop3:0x6a
    v_lshl_add_u32 v28, v8, 4, v136
    v_add_u32 v28, 91648, v28
    buffer_load_dwordx4 v246, s[32:35], s99 offen offset:2048  lds
    v_subrev_u32 v7, 1, v7
    v_bitop3_b32 v8, v7, 3, s3 bitop3:0x6a
    v_lshl_add_u32 v30, v8, 4, v136
    v_add_u32 v30, 91136, v30
    v_subrev_u32 v7, 1, v7
    s_add_u32 m0, s61, 36864
    s_add_u32 s16, s16, s63
    buffer_load_dwordx4 v244, s[32:35], s16 offen offset:0  lds
    v_bitop3_b32 v8, v7, 3, s3 bitop3:0x6a
    v_lshl_add_u32 v32, v8, 4, v136
    v_add_u32 v32, 90624, v32
    v_lshrrev_b32 v7, 1, v6
    v_lshl_add_u32 v7, v5, 1, v7
    buffer_load_dwordx4 v245, s[32:35], s16 offen offset:1024  lds
    v_add_u32 v7, 32, v7
    v_and_b32 v8, 1, v7
    v_bfe_u32 v136, v7, 1, 2
    v_lshl_add_u32 v136, v8, 2, v136
    v_lshlrev_b32 v136, 6, v136
    buffer_load_dwordx4 v246, s[32:35], s16 offen offset:2048  lds
    v_lshrrev_b32 v7, 3, v7
    v_lshl_add_u32 v136, v7, 9, v136
    v_bitop3_b32 v8, v7, 3, s3 bitop3:0x6a
    v_lshl_add_u32 v20, v8, 4, v136
    v_add_u32 v20, 92160, v20
    v_and_b32 v8, 1, v6
    v_xor_b32 v8, 1, v8
    v_lshl_add_u32 v20, v8, 3, v20
    s_waitcnt lgkmcnt(0)
    s_and_b32 s78, s92, 0xffff0000
    s_waitcnt vmcnt(11)
    s_barrier
    s_add_u32 m0, s86, 129536
    s_mov_b32 s89, 0
    buffer_load_dwordx4 v10, s[36:39], s89 offen nt lds
    s_lshl_b32 s92, s92, 16
    s_bitcmp1_b32 s90, 0
    s_cselect_b32 s92, s78, s92
    s_add_u32 m0, s86, 145920
    s_mov_b32 s89, 0
    buffer_load_dwordx4 v10, s[40:43], s89 offen nt lds
    v_lshlrev_b32 v7, 3, v6
    s_add_u32 m0, s86, 133632
    s_mov_b32 s89, 65536
    buffer_load_dwordx4 v10, s[36:39], s89 offen nt lds
    v_sub_u32 v7, v7, v5
    s_add_u32 m0, s86, 150016
    s_mov_b32 s89, 65536
    buffer_load_dwordx4 v10, s[40:43], s89 offen nt lds
    v_subrev_u32 v7, 9, v7
    s_add_u32 m0, s86, 137728
    s_mov_b32 s89, 131072
    buffer_load_dwordx4 v10, s[36:39], s89 offen nt lds
    v_and_b32 v8, 1, v7
    s_add_u32 m0, s86, 154112
    s_mov_b32 s89, 131072
    buffer_load_dwordx4 v10, s[40:43], s89 offen nt lds
    v_xor_b32 v8, 1, v8
    s_add_u32 m0, s86, 141824
    s_mov_b32 s89, 196608
    buffer_load_dwordx4 v10, s[36:39], s89 offen nt lds
    v_lshlrev_b32 v8, 4, v8
    s_add_u32 m0, s86, 158208
    s_mov_b32 s89, 196608
    buffer_load_dwordx4 v10, s[40:43], s89 offen nt lds
    v_lshrrev_b32 v8, v8, s92
    s_mov_b64 exec, 0xff
    s_lshl_b32 s82, s3, 7
    s_add_u32 m0, s82, 129024
    s_mov_b32 s89, 0
    buffer_load_dwordx4 v11, s[36:39], s89 offen nt lds
    s_lshl_b32 s83, s74, 9
    s_add_u32 s83, s83, s82
    s_and_b32 s89, s3, 2
    s_lshl_b32 s89, s89, 3
    s_add_u32 s82, s82, s89
    s_add_u32 m0, s82, 162816
    s_add_u32 s89, s83, 0
    buffer_load_dwordx4 v15, s[44:47], s89 offen  lds
    s_mov_b64 exec, -1
    v_ashrrev_i32 v7, 1, v7
    v_cmp_eq_u32 vcc, 0, v7
    s_add_u32 s97, s98, s0
    s_lshr_b64 s[0:1], s[0:1], 4
    s_and_b32 s97, s97, 15
    s_lshr_b32 s99, s97, 3
    s_xor_b32 s97, s97, s99
    s_add_u32 m0, s87, 36864
    s_lshl_b32 s97, s97, 7
    buffer_load_dwordx4 v240, s[28:31], s97 offen offset:0  lds
    v_cndmask_b32 v236, 0, v8, vcc
    buffer_load_dwordx4 v241, s[28:31], s97 offen offset:1024  lds
    v_cmp_eq_u32 vcc, 1, v7
    buffer_load_dwordx4 v242, s[28:31], s97 offen offset:2048  lds
    s_nop 0
    v_cndmask_b32 v237, 0, v8, vcc
    buffer_load_dwordx4 v243, s[28:31], s97 offen offset:3072  lds
    v_cmp_eq_u32 vcc, 2, v7
    s_add_u32 m0, s88, 36864
    s_mov_b64 exec, 0xffffffff
    buffer_load_dwordx4 v3, s[28:31], s97 offen offset:0  lds
    s_mov_b64 exec, -1
    v_cndmask_b32 v238, 0, v8, vcc
    s_mul_i32 s16, s97, 3072
    s_add_u32 m0, s60, 49152
    s_add_u32 s99, s16, s62
    buffer_load_dwordx4 v244, s[32:35], s99 offen offset:0  lds
    v_cmp_eq_u32 vcc, 3, v7
    buffer_load_dwordx4 v245, s[32:35], s99 offen offset:1024  lds
    s_nop 0
    v_cndmask_b32 v239, 0, v8, vcc
    s_waitcnt vmcnt(17)
    s_barrier
    buffer_load_dwordx4 v246, s[32:35], s99 offen offset:2048  lds
    s_add_u32 m0, s61, 61440
    s_add_u32 s16, s16, s63
    buffer_load_dwordx4 v244, s[32:35], s16 offen offset:0  lds
    buffer_load_dwordx4 v245, s[32:35], s16 offen offset:1024  lds
    buffer_load_dwordx4 v246, s[32:35], s16 offen offset:2048  lds
    s_add_u32 s97, s98, s0
    s_lshr_b64 s[0:1], s[0:1], 4
    s_and_b32 s97, s97, 15
    s_lshr_b32 s99, s97, 3
    s_xor_b32 s97, s97, s99
    s_add_u32 m0, s87, 0
    s_lshl_b32 s97, s97, 7
    buffer_load_dwordx4 v240, s[28:31], s97 offen offset:0  lds
    buffer_load_dwordx4 v241, s[28:31], s97 offen offset:1024  lds
    buffer_load_dwordx4 v242, s[28:31], s97 offen offset:2048  lds
    buffer_load_dwordx4 v243, s[28:31], s97 offen offset:3072  lds
    s_add_u32 m0, s88, 0
    s_mov_b64 exec, 0xffffffff
    buffer_load_dwordx4 v3, s[28:31], s97 offen offset:0  lds
    s_mov_b64 exec, -1
    s_mul_i32 s16, s97, 3072
    s_add_u32 m0, s60, 0
    s_add_u32 s99, s16, s62
    buffer_load_dwordx4 v244, s[32:35], s99 offen offset:0  lds
    buffer_load_dwordx4 v245, s[32:35], s99 offen offset:1024  lds
    buffer_load_dwordx4 v246, s[32:35], s99 offen offset:2048  lds
    s_add_u32 m0, s61, 12288
    s_add_u32 s16, s16, s63
    buffer_load_dwordx4 v244, s[32:35], s16 offen offset:0  lds
    buffer_load_dwordx4 v245, s[32:35], s16 offen offset:1024  lds
    buffer_load_dwordx4 v246, s[32:35], s16 offen offset:2048  lds
    s_waitcnt vmcnt(11)
    s_barrier
    buffer_load_dword v230, v229, s[64:67], 0 offen
    ds_read_b128 v[84:87], v35 offset:0
    ds_read_b128 v[88:91], v35 offset:16
    s_add_u32 s97, s98, s0
    s_lshr_b64 s[0:1], s[0:1], 4
    s_and_b32 s97, s97, 15
    s_lshr_b32 s99, s97, 3
    s_xor_b32 s97, s97, s99
    s_add_u32 m0, s87, 18432
    s_lshl_b32 s97, s97, 7
    buffer_load_dwordx4 v240, s[28:31], s97 offen offset:0  lds
    ds_read_b128 v[92:95], v35 offset:32
    buffer_load_dwordx4 v241, s[28:31], s97 offen offset:1024  lds
    ds_read_b128 v[96:99], v35 offset:48
    buffer_load_dwordx4 v242, s[28:31], s97 offen offset:2048  lds
    ds_read_b128 v[40:43], v233 offset:0
    buffer_load_dwordx4 v243, s[28:31], s97 offen offset:3072  lds
    ds_read_b128 v[44:47], v232 offset:256
    ds_read_b128 v[48:51], v233 offset:256
    s_add_u32 m0, s88, 18432
    s_mov_b64 exec, 0xffffffff
    buffer_load_dwordx4 v3, s[28:31], s97 offen offset:0  lds
    s_mov_b64 exec, -1
    ds_read_b128 v[52:55], v16 offset:512
    s_mul_i32 s16, s97, 3072
    s_add_u32 m0, s60, 24576
    s_add_u32 s99, s16, s62
    buffer_load_dwordx4 v244, s[32:35], s99 offen offset:0  lds
    ds_read_b128 v[56:59], v231 offset:512
    buffer_load_dwordx4 v245, s[32:35], s99 offen offset:1024  lds
    ds_read_b128 v[60:63], v16 offset:768
    buffer_load_dwordx4 v246, s[32:35], s99 offen offset:2048  lds
    ds_read_b128 v[64:67], v231 offset:768
    ds_read_b128 v[68:71], v16 offset:16896
    s_add_u32 m0, s61, 36864
    s_add_u32 s16, s16, s63
    buffer_load_dwordx4 v244, s[32:35], s16 offen offset:0  lds
    ds_read_b128 v[72:75], v231 offset:16896
    buffer_load_dwordx4 v245, s[32:35], s16 offen offset:1024  lds
    ds_read_b128 v[76:79], v16 offset:17152
    buffer_load_dwordx4 v246, s[32:35], s16 offen offset:2048  lds
    ds_read_b128 v[80:83], v231 offset:17152
    s_waitcnt vmcnt(12)
    s_waitcnt lgkmcnt(0)
    s_barrier
    s_add_u32 s97, s98, s0
    s_lshr_b64 s[0:1], s[0:1], 4
    s_and_b32 s97, s97, 15
    s_lshr_b32 s99, s97, 3
    s_xor_b32 s97, s97, s99
    s_add_u32 m0, s87, 36864
    s_lshl_b32 s97, s97, 7
    buffer_load_dwordx4 v240, s[28:31], s97 offen offset:0  lds
    v_lshlrev_b32 v116, 16, v40
    v_lshlrev_b32 v117, 16, v44
    v_lshlrev_b32 v118, 16, v48
    v_lshlrev_b32 v119, 16, v52
    v_lshlrev_b32 v120, 16, v56
    buffer_load_dwordx4 v241, s[28:31], s97 offen offset:1024  lds
    v_lshlrev_b32 v121, 16, v60
    v_lshlrev_b32 v122, 16, v64
    v_lshlrev_b32 v127, 16, v84
    v_and_b32 v128, 0xffff0000, v84
    v_lshlrev_b32 v129, 16, v85
    buffer_load_dwordx4 v242, s[28:31], s97 offen offset:2048  lds
    v_and_b32 v130, 0xffff0000, v85
    v_lshlrev_b32 v123, 16, v68
    v_lshlrev_b32 v124, 16, v72
    v_lshlrev_b32 v125, 16, v76
    v_lshlrev_b32 v126, 16, v80
    buffer_load_dwordx4 v243, s[28:31], s97 offen offset:3072  lds
    v_mul_f32 v131, v116, v130
    v_mul_f32 v132, v117, v130
    v_mul_f32 v133, v118, v130
    v_mul_f32 v134, v119, v130
    v_fmac_f32 v131, v117, v129
    s_add_u32 m0, s88, 36864
    s_mov_b64 exec, 0xffffffff
    buffer_load_dwordx4 v3, s[28:31], s97 offen offset:0  lds
    s_mov_b64 exec, -1
    v_fmac_f32 v132, v118, v129
    v_fmac_f32 v133, v119, v129
    v_fmac_f32 v134, v120, v129
    v_fmac_f32 v131, v118, v128
    v_fmac_f32 v132, v119, v128
    s_mul_i32 s16, s97, 3072
    s_add_u32 m0, s60, 49152
    s_add_u32 s99, s16, s62
    buffer_load_dwordx4 v244, s[32:35], s99 offen offset:0  lds
    v_fmac_f32 v133, v120, v128
    v_fmac_f32 v134, v121, v128
    v_fmac_f32 v131, v119, v127
    v_fmac_f32 v132, v120, v127
    v_fmac_f32 v133, v121, v127
    buffer_load_dwordx4 v245, s[32:35], s99 offen offset:1024  lds
    v_fmac_f32 v134, v122, v127
    v_mul_f32 v131, v131, v123
    v_mul_f32 v132, v132, v124
    v_mul_f32 v133, v133, v125
    v_mul_f32 v134, v134, v126
    buffer_load_dwordx4 v246, s[32:35], s99 offen offset:2048  lds
    v_cvt_pk_bf16_f32 v102, v134, v133
    v_cvt_pk_bf16_f32 v103, v132, v131
    v_lshlrev_b32 v116, 16, v42
    v_lshlrev_b32 v117, 16, v46
    v_lshlrev_b32 v118, 16, v50
    s_add_u32 m0, s61, 61440
    s_add_u32 s16, s16, s63
    buffer_load_dwordx4 v244, s[32:35], s16 offen offset:0  lds
    v_lshlrev_b32 v119, 16, v54
    v_lshlrev_b32 v120, 16, v58
    v_lshlrev_b32 v121, 16, v62
    v_lshlrev_b32 v122, 16, v66
    v_lshlrev_b32 v127, 16, v92
    buffer_load_dwordx4 v245, s[32:35], s16 offen offset:1024  lds
    v_and_b32 v128, 0xffff0000, v92
    v_lshlrev_b32 v129, 16, v93
    v_and_b32 v130, 0xffff0000, v93
    v_lshlrev_b32 v123, 16, v70
    v_lshlrev_b32 v124, 16, v74
    buffer_load_dwordx4 v246, s[32:35], s16 offen offset:2048  lds
    v_lshlrev_b32 v125, 16, v78
    v_lshlrev_b32 v126, 16, v82
    v_mul_f32 v131, v116, v130
    v_mul_f32 v132, v117, v130
    v_mul_f32 v133, v118, v130
    v_mul_f32 v134, v119, v130
    v_fmac_f32 v131, v117, v129
    v_fmac_f32 v132, v118, v129
    v_fmac_f32 v133, v119, v129
    v_fmac_f32 v134, v120, v129
    v_fmac_f32 v131, v118, v128
    v_fmac_f32 v132, v119, v128
    s_waitcnt vmcnt(11)
    s_barrier
    s_add_u32 s97, s98, s0
    s_lshr_b64 s[0:1], s[0:1], 4
    s_and_b32 s97, s97, 15
    s_lshr_b32 s99, s97, 3
    s_xor_b32 s97, s97, s99
    s_add_u32 m0, s87, 0
    s_lshl_b32 s97, s97, 7
    buffer_load_dwordx4 v240, s[28:31], s97 offen offset:0  lds
    v_fmac_f32 v133, v120, v128
    v_fmac_f32 v134, v121, v128
    v_fmac_f32 v131, v119, v127
    v_fmac_f32 v132, v120, v127
    v_fmac_f32 v133, v121, v127
    buffer_load_dwordx4 v241, s[28:31], s97 offen offset:1024  lds
    v_fmac_f32 v134, v122, v127
    v_mul_f32 v131, v131, v123
    v_mul_f32 v132, v132, v124
    v_mul_f32 v133, v133, v125
    v_mul_f32 v134, v134, v126
    buffer_load_dwordx4 v242, s[28:31], s97 offen offset:2048  lds
    v_cvt_pk_bf16_f32 v100, v134, v133
    v_cvt_pk_bf16_f32 v101, v132, v131
    s_nop 0
    v_permlane32_swap_b32 v102, v100
    v_permlane32_swap_b32 v103, v101
    s_mov_b32 s89, 0
    buffer_store_dwordx4 v[100:103], v12, s[52:55], s89 offen sc1
    buffer_load_dwordx4 v243, s[28:31], s97 offen offset:3072  lds
    v_and_b32 v116, 0xffff0000, v40
    v_and_b32 v117, 0xffff0000, v44
    v_and_b32 v118, 0xffff0000, v48
    v_and_b32 v119, 0xffff0000, v52
    v_and_b32 v120, 0xffff0000, v56
    s_add_u32 m0, s88, 0
    s_mov_b64 exec, 0xffffffff
    buffer_load_dwordx4 v3, s[28:31], s97 offen offset:0  lds
    s_mov_b64 exec, -1
    v_and_b32 v121, 0xffff0000, v60
    v_and_b32 v122, 0xffff0000, v64
    v_lshlrev_b32 v127, 16, v86
    v_and_b32 v128, 0xffff0000, v86
    v_lshlrev_b32 v129, 16, v87
    s_mul_i32 s16, s97, 3072
    s_add_u32 m0, s60, 0
    s_add_u32 s99, s16, s62
    buffer_load_dwordx4 v244, s[32:35], s99 offen offset:0  lds
    v_and_b32 v130, 0xffff0000, v87
    v_and_b32 v123, 0xffff0000, v68
    v_and_b32 v124, 0xffff0000, v72
    v_and_b32 v125, 0xffff0000, v76
    v_and_b32 v126, 0xffff0000, v80
    buffer_load_dwordx4 v245, s[32:35], s99 offen offset:1024  lds
    v_mul_f32 v131, v116, v130
    v_mul_f32 v132, v117, v130
    v_mul_f32 v133, v118, v130
    v_mul_f32 v134, v119, v130
    v_fmac_f32 v131, v117, v129
    buffer_load_dwordx4 v246, s[32:35], s99 offen offset:2048  lds
    v_fmac_f32 v132, v118, v129
    v_fmac_f32 v133, v119, v129
    v_fmac_f32 v134, v120, v129
    v_fmac_f32 v131, v118, v128
    v_fmac_f32 v132, v119, v128
    s_add_u32 m0, s61, 12288
    s_add_u32 s16, s16, s63
    buffer_load_dwordx4 v244, s[32:35], s16 offen offset:0  lds
    v_fmac_f32 v133, v120, v128
    v_fmac_f32 v134, v121, v128
    v_fmac_f32 v131, v119, v127
    v_fmac_f32 v132, v120, v127
    v_fmac_f32 v133, v121, v127
    buffer_load_dwordx4 v245, s[32:35], s16 offen offset:1024  lds
    v_fmac_f32 v134, v122, v127
    v_mul_f32 v131, v131, v123
    v_mul_f32 v132, v132, v124
    v_mul_f32 v133, v133, v125
    v_mul_f32 v134, v134, v126
    buffer_load_dwordx4 v246, s[32:35], s16 offen offset:2048  lds
    v_cvt_pk_bf16_f32 v106, v134, v133
    v_cvt_pk_bf16_f32 v107, v132, v131
    v_and_b32 v116, 0xffff0000, v42
    v_and_b32 v117, 0xffff0000, v46
    v_and_b32 v118, 0xffff0000, v50
    v_and_b32 v119, 0xffff0000, v54
    v_and_b32 v120, 0xffff0000, v58
    v_and_b32 v121, 0xffff0000, v62
    v_and_b32 v122, 0xffff0000, v66
    v_lshlrev_b32 v127, 16, v94
    v_and_b32 v128, 0xffff0000, v94
    v_lshlrev_b32 v129, 16, v95
    s_waitcnt vmcnt(12)
    s_barrier
    s_add_u32 s97, s98, s0
    s_lshr_b64 s[0:1], s[0:1], 4
    s_and_b32 s97, s97, 15
    s_lshr_b32 s99, s97, 3
    s_xor_b32 s97, s97, s99
    s_add_u32 m0, s87, 18432
    s_lshl_b32 s97, s97, 7
    buffer_load_dwordx4 v240, s[28:31], s97 offen offset:0  lds
    v_and_b32 v130, 0xffff0000, v95
    v_and_b32 v123, 0xffff0000, v70
    v_and_b32 v124, 0xffff0000, v74
    v_and_b32 v125, 0xffff0000, v78
    v_and_b32 v126, 0xffff0000, v82
    buffer_load_dwordx4 v241, s[28:31], s97 offen offset:1024  lds
    v_mul_f32 v131, v116, v130
    v_mul_f32 v132, v117, v130
    v_mul_f32 v133, v118, v130
    v_mul_f32 v134, v119, v130
    v_fmac_f32 v131, v117, v129
    buffer_load_dwordx4 v242, s[28:31], s97 offen offset:2048  lds
    v_fmac_f32 v132, v118, v129
    v_fmac_f32 v133, v119, v129
    v_fmac_f32 v134, v120, v129
    v_fmac_f32 v131, v118, v128
    v_fmac_f32 v132, v119, v128
    buffer_load_dwordx4 v243, s[28:31], s97 offen offset:3072  lds
    v_fmac_f32 v133, v120, v128
    v_fmac_f32 v134, v121, v128
    v_fmac_f32 v131, v119, v127
    v_fmac_f32 v132, v120, v127
    v_fmac_f32 v133, v121, v127
    s_add_u32 m0, s88, 18432
    s_mov_b64 exec, 0xffffffff
    buffer_load_dwordx4 v3, s[28:31], s97 offen offset:0  lds
    s_mov_b64 exec, -1
    v_fmac_f32 v134, v122, v127
    v_mul_f32 v131, v131, v123
    v_mul_f32 v132, v132, v124
    v_mul_f32 v133, v133, v125
    v_mul_f32 v134, v134, v126
    s_mul_i32 s16, s97, 3072
    s_add_u32 m0, s60, 24576
    s_add_u32 s99, s16, s62
    buffer_load_dwordx4 v244, s[32:35], s99 offen offset:0  lds
    v_cvt_pk_bf16_f32 v104, v134, v133
    v_cvt_pk_bf16_f32 v105, v132, v131
    s_nop 0
    v_permlane32_swap_b32 v106, v104
    v_permlane32_swap_b32 v107, v105
    s_mov_b32 s89, 16384
    buffer_store_dwordx4 v[104:107], v12, s[52:55], s89 offen sc1
    buffer_load_dwordx4 v245, s[32:35], s99 offen offset:1024  lds
    v_lshlrev_b32 v116, 16, v41
    v_lshlrev_b32 v117, 16, v45
    v_lshlrev_b32 v118, 16, v49
    v_lshlrev_b32 v119, 16, v53
    v_lshlrev_b32 v120, 16, v57
    buffer_load_dwordx4 v246, s[32:35], s99 offen offset:2048  lds
    v_lshlrev_b32 v121, 16, v61
    v_lshlrev_b32 v122, 16, v65
    v_lshlrev_b32 v127, 16, v88
    v_and_b32 v128, 0xffff0000, v88
    v_lshlrev_b32 v129, 16, v89
    s_add_u32 m0, s61, 36864
    s_add_u32 s16, s16, s63
    buffer_load_dwordx4 v244, s[32:35], s16 offen offset:0  lds
    v_and_b32 v130, 0xffff0000, v89
    v_lshlrev_b32 v123, 16, v69
    v_lshlrev_b32 v124, 16, v73
    v_lshlrev_b32 v125, 16, v77
    v_lshlrev_b32 v126, 16, v81
    buffer_load_dwordx4 v245, s[32:35], s16 offen offset:1024  lds
    v_mul_f32 v131, v116, v130
    v_mul_f32 v132, v117, v130
    v_mul_f32 v133, v118, v130
    v_mul_f32 v134, v119, v130
    v_fmac_f32 v131, v117, v129
    buffer_load_dwordx4 v246, s[32:35], s16 offen offset:2048  lds
    v_fmac_f32 v132, v118, v129
    v_fmac_f32 v133, v119, v129
    v_fmac_f32 v134, v120, v129
    v_fmac_f32 v131, v118, v128
    v_fmac_f32 v132, v119, v128
    v_fmac_f32 v133, v120, v128
    v_fmac_f32 v134, v121, v128
    v_fmac_f32 v131, v119, v127
    v_fmac_f32 v132, v120, v127
    v_fmac_f32 v133, v121, v127
    v_fmac_f32 v134, v122, v127
    v_mul_f32 v131, v131, v123
    s_waitcnt vmcnt(12)
    s_barrier
    s_add_u32 s97, s98, s0
    s_lshr_b64 s[0:1], s[0:1], 4
    s_and_b32 s97, s97, 15
    s_lshr_b32 s99, s97, 3
    s_xor_b32 s97, s97, s99
    s_add_u32 m0, s87, 36864
    s_lshl_b32 s97, s97, 7
    buffer_load_dwordx4 v240, s[28:31], s97 offen offset:0  lds
    v_mul_f32 v132, v132, v124
    v_mul_f32 v133, v133, v125
    v_mul_f32 v134, v134, v126
    v_cvt_pk_bf16_f32 v110, v134, v133
    v_cvt_pk_bf16_f32 v111, v132, v131
    buffer_load_dwordx4 v241, s[28:31], s97 offen offset:1024  lds
    v_lshlrev_b32 v116, 16, v43
    v_lshlrev_b32 v117, 16, v47
    v_lshlrev_b32 v118, 16, v51
    v_lshlrev_b32 v119, 16, v55
    v_lshlrev_b32 v120, 16, v59
    buffer_load_dwordx4 v242, s[28:31], s97 offen offset:2048  lds
    v_lshlrev_b32 v121, 16, v63
    v_lshlrev_b32 v122, 16, v67
    v_lshlrev_b32 v127, 16, v96
    v_and_b32 v128, 0xffff0000, v96
    v_lshlrev_b32 v129, 16, v97
    buffer_load_dwordx4 v243, s[28:31], s97 offen offset:3072  lds
    v_and_b32 v130, 0xffff0000, v97
    v_lshlrev_b32 v123, 16, v71
    v_lshlrev_b32 v124, 16, v75
    v_lshlrev_b32 v125, 16, v79
    v_lshlrev_b32 v126, 16, v83
    s_add_u32 m0, s88, 36864
    s_mov_b64 exec, 0xffffffff
    buffer_load_dwordx4 v3, s[28:31], s97 offen offset:0  lds
    s_mov_b64 exec, -1
    v_mul_f32 v131, v116, v130
    v_mul_f32 v132, v117, v130
    v_mul_f32 v133, v118, v130
    v_mul_f32 v134, v119, v130
    v_fmac_f32 v131, v117, v129
    s_mul_i32 s16, s97, 3072
    s_add_u32 m0, s60, 49152
    s_add_u32 s99, s16, s62
    buffer_load_dwordx4 v244, s[32:35], s99 offen offset:0  lds
    v_fmac_f32 v132, v118, v129
    v_fmac_f32 v133, v119, v129
    v_fmac_f32 v134, v120, v129
    v_fmac_f32 v131, v118, v128
    v_fmac_f32 v132, v119, v128
    buffer_load_dwordx4 v245, s[32:35], s99 offen offset:1024  lds
    v_fmac_f32 v133, v120, v128
    v_fmac_f32 v134, v121, v128
    v_fmac_f32 v131, v119, v127
    v_fmac_f32 v132, v120, v127
    v_fmac_f32 v133, v121, v127
    buffer_load_dwordx4 v246, s[32:35], s99 offen offset:2048  lds
    v_fmac_f32 v134, v122, v127
    v_mul_f32 v131, v131, v123
    v_mul_f32 v132, v132, v124
    v_mul_f32 v133, v133, v125
    v_mul_f32 v134, v134, v126
    s_add_u32 m0, s61, 61440
    s_add_u32 s16, s16, s63
    buffer_load_dwordx4 v244, s[32:35], s16 offen offset:0  lds
    v_cvt_pk_bf16_f32 v108, v134, v133
    v_cvt_pk_bf16_f32 v109, v132, v131
    s_nop 0
    v_permlane32_swap_b32 v110, v108
    v_permlane32_swap_b32 v111, v109
    s_mov_b32 s89, 32768
    buffer_store_dwordx4 v[108:111], v12, s[52:55], s89 offen sc1
    buffer_load_dwordx4 v245, s[32:35], s16 offen offset:1024  lds
    v_and_b32 v116, 0xffff0000, v41
    v_and_b32 v117, 0xffff0000, v45
    v_and_b32 v118, 0xffff0000, v49
    v_and_b32 v119, 0xffff0000, v53
    v_and_b32 v120, 0xffff0000, v57
    buffer_load_dwordx4 v246, s[32:35], s16 offen offset:2048  lds
    v_and_b32 v121, 0xffff0000, v61
    v_and_b32 v122, 0xffff0000, v65
    v_lshlrev_b32 v127, 16, v90
    v_and_b32 v128, 0xffff0000, v90
    v_lshlrev_b32 v129, 16, v91
    v_and_b32 v130, 0xffff0000, v91
    v_and_b32 v123, 0xffff0000, v69
    v_and_b32 v124, 0xffff0000, v73
    v_and_b32 v125, 0xffff0000, v77
    v_and_b32 v126, 0xffff0000, v81
    v_mul_f32 v131, v116, v130
    v_mul_f32 v132, v117, v130
    s_waitcnt vmcnt(12)
    s_barrier
    s_add_u32 s97, s98, s0
    s_lshr_b64 s[0:1], s[0:1], 4
    s_and_b32 s97, s97, 15
    s_lshr_b32 s99, s97, 3
    s_xor_b32 s97, s97, s99
    s_add_u32 m0, s87, 0
    s_lshl_b32 s97, s97, 7
    buffer_load_dwordx4 v240, s[28:31], s97 offen offset:0  lds
    v_mul_f32 v133, v118, v130
    v_mul_f32 v134, v119, v130
    v_fmac_f32 v131, v117, v129
    v_fmac_f32 v132, v118, v129
    v_fmac_f32 v133, v119, v129
    buffer_load_dwordx4 v241, s[28:31], s97 offen offset:1024  lds
    v_fmac_f32 v134, v120, v129
    v_fmac_f32 v131, v118, v128
    v_fmac_f32 v132, v119, v128
    v_fmac_f32 v133, v120, v128
    v_fmac_f32 v134, v121, v128
    buffer_load_dwordx4 v242, s[28:31], s97 offen offset:2048  lds
    v_fmac_f32 v131, v119, v127
    v_fmac_f32 v132, v120, v127
    v_fmac_f32 v133, v121, v127
    v_fmac_f32 v134, v122, v127
    v_mul_f32 v131, v131, v123
    buffer_load_dwordx4 v243, s[28:31], s97 offen offset:3072  lds
    v_mul_f32 v132, v132, v124
    v_mul_f32 v133, v133, v125
    v_mul_f32 v134, v134, v126
    v_cvt_pk_bf16_f32 v114, v134, v133
    v_cvt_pk_bf16_f32 v115, v132, v131
    s_add_u32 m0, s88, 0
    s_mov_b64 exec, 0xffffffff
    buffer_load_dwordx4 v3, s[28:31], s97 offen offset:0  lds
    s_mov_b64 exec, -1
    v_and_b32 v116, 0xffff0000, v43
    v_and_b32 v117, 0xffff0000, v47
    v_and_b32 v118, 0xffff0000, v51
    v_and_b32 v119, 0xffff0000, v55
    v_and_b32 v120, 0xffff0000, v59
    s_mul_i32 s16, s97, 3072
    s_add_u32 m0, s60, 0
    s_add_u32 s99, s16, s62
    buffer_load_dwordx4 v244, s[32:35], s99 offen offset:0  lds
    v_and_b32 v121, 0xffff0000, v63
    v_and_b32 v122, 0xffff0000, v67
    v_lshlrev_b32 v127, 16, v98
    v_and_b32 v128, 0xffff0000, v98
    v_lshlrev_b32 v129, 16, v99
    buffer_load_dwordx4 v245, s[32:35], s99 offen offset:1024  lds
    v_and_b32 v130, 0xffff0000, v99
    v_and_b32 v123, 0xffff0000, v71
    v_and_b32 v124, 0xffff0000, v75
    v_and_b32 v125, 0xffff0000, v79
    v_and_b32 v126, 0xffff0000, v83
    buffer_load_dwordx4 v246, s[32:35], s99 offen offset:2048  lds
    v_mul_f32 v131, v116, v130
    v_mul_f32 v132, v117, v130
    v_mul_f32 v133, v118, v130
    v_mul_f32 v134, v119, v130
    v_fmac_f32 v131, v117, v129
    s_add_u32 m0, s61, 12288
    s_add_u32 s16, s16, s63
    buffer_load_dwordx4 v244, s[32:35], s16 offen offset:0  lds
    v_fmac_f32 v132, v118, v129
    v_fmac_f32 v133, v119, v129
    v_fmac_f32 v134, v120, v129
    v_fmac_f32 v131, v118, v128
    v_fmac_f32 v132, v119, v128
    buffer_load_dwordx4 v245, s[32:35], s16 offen offset:1024  lds
    v_fmac_f32 v133, v120, v128
    v_fmac_f32 v134, v121, v128
    v_fmac_f32 v131, v119, v127
    v_fmac_f32 v132, v120, v127
    v_fmac_f32 v133, v121, v127
    buffer_load_dwordx4 v246, s[32:35], s16 offen offset:2048  lds
    v_fmac_f32 v134, v122, v127
    v_mul_f32 v131, v131, v123
    v_mul_f32 v132, v132, v124
    v_mul_f32 v133, v133, v125
    v_mul_f32 v134, v134, v126
    v_cvt_pk_bf16_f32 v112, v134, v133
    v_cvt_pk_bf16_f32 v113, v132, v131
    s_nop 0
    v_permlane32_swap_b32 v114, v112
    v_permlane32_swap_b32 v115, v113
    s_mov_b32 s89, 49152
    buffer_store_dwordx4 v[112:115], v12, s[52:55], s89 offen sc1
    s_waitcnt vmcnt(12)
    s_barrier
    s_add_u32 m0, s94, 32
    s_lshl_b32 s89, s90, 12
    buffer_load_dwordx4 v15, s[48:51], s89 offen offset:0 nt lds
    s_add_u32 m0, s94, 32
    s_lshl_b32 s89, s90, 12
    buffer_load_dwordx4 v15, s[48:51], s89 offen offset:1024 nt lds
    s_add_u32 m0, s94, 32
    s_lshl_b32 s89, s90, 12
    buffer_load_dwordx4 v15, s[48:51], s89 offen offset:2048 nt lds
    s_add_u32 m0, s94, 32
    s_lshl_b32 s89, s90, 12
    buffer_load_dwordx4 v15, s[48:51], s89 offen offset:3072 nt lds
    s_add_u32 s97, s98, s0
    s_lshr_b64 s[0:1], s[0:1], 4
    s_and_b32 s97, s97, 15
    s_lshr_b32 s99, s97, 3
    s_xor_b32 s97, s97, s99
    s_add_u32 m0, s87, 18432
    s_lshl_b32 s97, s97, 7
    buffer_load_dwordx4 v240, s[28:31], s97 offen offset:0  lds
    buffer_load_dwordx4 v241, s[28:31], s97 offen offset:1024  lds
    buffer_load_dwordx4 v242, s[28:31], s97 offen offset:2048  lds
    buffer_load_dwordx4 v243, s[28:31], s97 offen offset:3072  lds
    s_add_u32 m0, s88, 18432
    s_mov_b64 exec, 0xffffffff
    buffer_load_dwordx4 v3, s[28:31], s97 offen offset:0  lds
    s_mov_b64 exec, -1
    s_mul_i32 s16, s97, 3072
    s_add_u32 m0, s60, 24576
    s_add_u32 s99, s16, s62
    buffer_load_dwordx4 v244, s[32:35], s99 offen offset:0  lds
    buffer_load_dwordx4 v245, s[32:35], s99 offen offset:1024  lds
    buffer_load_dwordx4 v246, s[32:35], s99 offen offset:2048  lds
    s_add_u32 m0, s61, 36864
    s_add_u32 s16, s16, s63
    buffer_load_dwordx4 v244, s[32:35], s16 offen offset:0  lds
    buffer_load_dwordx4 v245, s[32:35], s16 offen offset:1024  lds
    buffer_load_dwordx4 v246, s[32:35], s16 offen offset:2048  lds
    s_waitcnt vmcnt(16)
    s_waitcnt vmcnt(15)
    s_barrier
    s_add_u32 s97, s98, s0
    s_lshr_b64 s[0:1], s[0:1], 4
    s_and_b32 s97, s97, 15
    s_lshr_b32 s99, s97, 3
    s_xor_b32 s97, s97, s99
    s_add_u32 m0, s87, 36864
    s_lshl_b32 s97, s97, 7
    buffer_load_dwordx4 v240, s[28:31], s97 offen offset:0  lds
    buffer_load_dwordx4 v241, s[28:31], s97 offen offset:1024  lds
    buffer_load_dwordx4 v242, s[28:31], s97 offen offset:2048  lds
    buffer_load_dwordx4 v243, s[28:31], s97 offen offset:3072  lds
    s_add_u32 m0, s88, 36864
    s_mov_b64 exec, 0xffffffff
    buffer_load_dwordx4 v3, s[28:31], s97 offen offset:0  lds
    s_mov_b64 exec, -1
    s_mul_i32 s16, s97, 3072
    s_add_u32 m0, s60, 49152
    s_add_u32 s99, s16, s62
    buffer_load_dwordx4 v244, s[32:35], s99 offen offset:0  lds
    buffer_load_dwordx4 v245, s[32:35], s99 offen offset:1024  lds
    buffer_load_dwordx4 v246, s[32:35], s99 offen offset:2048  lds
    s_add_u32 m0, s61, 61440
    s_add_u32 s16, s16, s63
    buffer_load_dwordx4 v244, s[32:35], s16 offen offset:0  lds
    buffer_load_dwordx4 v245, s[32:35], s16 offen offset:1024  lds
    buffer_load_dwordx4 v246, s[32:35], s16 offen offset:2048  lds
    s_waitcnt vmcnt(11)
    s_barrier
    s_add_u32 s97, s98, s0
    s_lshr_b64 s[0:1], s[0:1], 4
    s_and_b32 s97, s97, 15
    s_lshr_b32 s99, s97, 3
    s_xor_b32 s97, s97, s99
    s_add_u32 m0, s87, 0
    s_lshl_b32 s97, s97, 7
    buffer_load_dwordx4 v240, s[28:31], s97 offen offset:0  lds
    v_add_u32 v5, s94, v15
    ds_read_b128 v[140:143], v5 offset:32
    ds_read_b32 v156, v5 offset:48
    ds_read_b128 v[144:147], v5 offset:1056
    buffer_load_dwordx4 v241, s[28:31], s97 offen offset:1024  lds
    ds_read_b32 v157, v5 offset:1072
    ds_read_b128 v[148:151], v5 offset:2080
    ds_read_b32 v158, v5 offset:2096
    buffer_load_dwordx4 v242, s[28:31], s97 offen offset:2048  lds
    ds_read_b128 v[152:155], v5 offset:3104
    ds_read_b32 v159, v5 offset:3120
    v_lshrrev_b32 v6, 3, v0
    buffer_load_dwordx4 v243, s[28:31], s97 offen offset:3072  lds
    v_mul_u32_u24 v6, 4160, v6
    v_and_b32 v7, 7, v0
    v_lshl_add_u32 v6, v7, 2, v6
    v_add_u32 v6, s94, v6
    s_add_u32 m0, s88, 0
    s_mov_b64 exec, 0xffffffff
    buffer_load_dwordx4 v3, s[28:31], s97 offen offset:0  lds
    s_mov_b64 exec, -1
    v_mov_b32 v7, 0
    s_waitcnt lgkmcnt(0)
    v_readfirstlane_b32 s93, v140
    s_mul_i32 s16, s97, 3072
    s_add_u32 m0, s60, 0
    s_add_u32 s99, s16, s62
    buffer_load_dwordx4 v244, s[32:35], s99 offen offset:0  lds
    s_lshl_b32 s93, s93, 16
    v_writelane_b32 v7, s93, 15
    v_alignbit_b32 v140, v141, v140, 16
    buffer_load_dwordx4 v245, s[32:35], s99 offen offset:1024  lds
    v_alignbit_b32 v141, v142, v141, 16
    v_alignbit_b32 v142, v143, v142, 16
    v_alignbit_b32 v143, v156, v143, 16
    v_alignbit_b32 v144, v145, v144, 16
    buffer_load_dwordx4 v246, s[32:35], s99 offen offset:2048  lds
    v_alignbit_b32 v145, v146, v145, 16
    v_alignbit_b32 v146, v147, v146, 16
    v_alignbit_b32 v147, v157, v147, 16
    s_add_u32 m0, s61, 12288
    s_add_u32 s16, s16, s63
    buffer_load_dwordx4 v244, s[32:35], s16 offen offset:0  lds
    v_alignbit_b32 v148, v149, v148, 16
    v_alignbit_b32 v149, v150, v149, 16
    v_alignbit_b32 v150, v151, v150, 16
    buffer_load_dwordx4 v245, s[32:35], s16 offen offset:1024  lds
    v_alignbit_b32 v151, v158, v151, 16
    v_alignbit_b32 v152, v153, v152, 16
    v_alignbit_b32 v153, v154, v153, 16
    v_alignbit_b32 v154, v155, v154, 16
    buffer_load_dwordx4 v246, s[32:35], s16 offen offset:2048  lds
    v_alignbit_b32 v155, v159, v155, 16
    v_lshlrev_b32 v8, 3, v0
    s_add_u32 s78, s88, 18432
    s_mov_b64 exec, 0xff
    buffer_load_dword v136, v33, s[68:71], 0 offen sc1
    buffer_load_dword v137, v34, s[52:55], 0 offen sc1
    s_mov_b64 exec, -1
    v_add_u32 v8, s78, v8
    v_mov_b32 v156, 0
    v_mov_b32 v157, 0
    s_waitcnt vmcnt(13)
    s_barrier
    s_waitcnt vmcnt(0)
    s_branch LA_j
LA_c3:
    s_waitcnt vmcnt(7)
    s_barrier
    buffer_load_dwordx4 v246, s[32:35], s99 offen offset:2048  lds
    s_add_u32 m0, s61, 36864
    s_add_u32 s16, s16, s63
    buffer_load_dwordx4 v244, s[32:35], s16 offen offset:0  lds
    buffer_load_dwordx4 v245, s[32:35], s16 offen offset:1024  lds
    buffer_load_dwordx4 v246, s[32:35], s16 offen offset:2048  lds
    s_add_u32 s97, s98, s0
    s_lshr_b64 s[0:1], s[0:1], 4
    s_and_b32 s97, s97, 15
    s_lshr_b32 s99, s97, 3
    s_xor_b32 s97, s97, s99
    s_add_u32 m0, s87, 36864
    s_lshl_b32 s97, s97, 7
    buffer_load_dwordx4 v240, s[28:31], s97 offen offset:0  lds
    buffer_load_dwordx4 v241, s[28:31], s97 offen offset:1024  lds
    buffer_load_dwordx4 v242, s[28:31], s97 offen offset:2048  lds
    buffer_load_dwordx4 v243, s[28:31], s97 offen offset:3072  lds
    s_add_u32 m0, s88, 36864
    s_mov_b64 exec, 0xffffffff
    buffer_load_dwordx4 v3, s[28:31], s97 offen offset:0  lds
    s_mov_b64 exec, -1
    s_mul_i32 s16, s97, 3072
    s_add_u32 m0, s60, 49152
    s_add_u32 s99, s16, s62
    buffer_load_dwordx4 v244, s[32:35], s99 offen offset:0  lds
    buffer_load_dwordx4 v245, s[32:35], s99 offen offset:1024  lds
    buffer_load_dwordx4 v246, s[32:35], s99 offen offset:2048  lds
    s_add_u32 m0, s61, 61440
    s_add_u32 s16, s16, s63
    buffer_load_dwordx4 v244, s[32:35], s16 offen offset:0  lds
    buffer_load_dwordx4 v245, s[32:35], s16 offen offset:1024  lds
    buffer_load_dwordx4 v246, s[32:35], s16 offen offset:2048  lds
    s_waitcnt vmcnt(11)
    s_barrier
    buffer_load_dword v230, v229, s[64:67], 0 offen
    s_mov_b32 s68, s24
    s_mov_b32 s69, s25
    s_mov_b32 s70, 0x100
    s_mov_b32 s71, 0x20000
    v_lshrrev_b32 v6, 5, v0
    s_add_u32 s97, s98, s0
    s_lshr_b64 s[0:1], s[0:1], 4
    s_and_b32 s97, s97, 15
    s_lshr_b32 s99, s97, 3
    s_xor_b32 s97, s97, s99
    s_add_u32 m0, s87, 0
    s_lshl_b32 s97, s97, 7
    buffer_load_dwordx4 v240, s[28:31], s97 offen offset:0  lds
    v_and_b32 v7, 3, v0
    s_lshr_b32 s78, s90, 1
    s_lshl_b32 s78, s78, 2
    s_load_dword s92, s[14:15], s78
    s_mul_i32 s94, s3, 8320
    buffer_load_dwordx4 v241, s[28:31], s97 offen offset:1024  lds
    s_add_u32 s94, s94, 129024
    v_bfe_u32 v5, v0, 2, 2
    v_lshlrev_b32 v5, 1, v5
    v_lshl_add_u32 v5, v6, 3, v5
    v_bfe_u32 v8, v0, 4, 1
    buffer_load_dwordx4 v242, s[28:31], s97 offen offset:2048  lds
    v_add_u32 v5, v5, v8
    s_and_b32 s78, s3, 1
    s_lshl_b32 s78, s78, 1
    v_add_u32 v8, s78, v6
    v_xor_b32 v8, v8, v7
    buffer_load_dwordx4 v243, s[28:31], s97 offen offset:3072  lds
    v_lshlrev_b32 v8, 4, v8
    v_lshl_add_u32 v5, v5, 6, v8
    v_add_u32 v14, s86, v5
    v_mov_b32 v18, 162304
    v_mov_b32 v19, 1
    s_add_u32 m0, s88, 0
    s_mov_b64 exec, 0xffffffff
    buffer_load_dwordx4 v3, s[28:31], s97 offen offset:0  lds
    s_mov_b64 exec, -1
    v_and_b32 v5, 3, v0
    s_lshl_b32 s78, s74, 4
    s_add_u32 s78, s78, s3
    v_lshl_add_u32 v6, v5, 2, s78
    s_lshr_b32 s78, s76, 3
    s_mul_i32 s16, s97, 3072
    s_add_u32 m0, s60, 0
    s_add_u32 s99, s16, s62
    buffer_load_dwordx4 v244, s[32:35], s99 offen offset:0  lds
    s_lshl_b32 s79, s3, 1
    s_add_u32 s78, s78, s79
    s_xor_b32 s78, s78, 0
    s_lshl_b32 s78, s78, 5
    s_and_b32 s79, s76, 7
    buffer_load_dwordx4 v245, s[32:35], s99 offen offset:1024  lds
    s_add_u32 s78, s78, s79
    v_lshl_add_u32 v7, v5, 3, s78
    v_and_b32 v8, 4, v0
    v_cmp_eq_u32 vcc, 0, v8
    s_nop 1
    v_cndmask_b32 v6, v7, v6, vcc
    buffer_load_dwordx4 v246, s[32:35], s99 offen offset:2048  lds
    v_and_b32 v33, 0xf0, v6
    v_lshlrev_b32 v34, 8, v6
    v_add_u32 v34, 12582912, v34
    v_and_b32 v5, 15, v0
    v_lshrrev_b32 v6, 4, v0
    s_add_u32 m0, s61, 12288
    s_add_u32 s16, s16, s63
    buffer_load_dwordx4 v244, s[32:35], s16 offen offset:0  lds
    v_add_u32 v7, 9, v5
    v_and_b32 v8, 1, v7
    v_mul_u32_u24 v8, 4160, v8
    v_lshrrev_b32 v7, 1, v7
    v_lshl_add_u32 v8, v7, 2, v8
    buffer_load_dwordx4 v245, s[32:35], s16 offen offset:1024  lds
    v_lshlrev_b32 v7, 4, v6
    v_sub_u32 v8, v8, v7
    s_add_u32 s78, s94, 32
    v_add_u32 v21, s78, v8
    v_add_u32 v22, 1024, v21
    buffer_load_dwordx4 v246, s[32:35], s16 offen offset:2048  lds
    v_add_u32 v23, 2048, v21
    v_add_u32 v24, 3072, v21
    v_lshl_add_u32 v7, v5, 1, v6
    v_add_u32 v7, 30, v7
    v_and_b32 v8, 1, v7
    s_waitcnt vmcnt(12)
    s_barrier
    s_add_u32 s97, s98, s0
    s_lshr_b64 s[0:1], s[0:1], 4
    s_and_b32 s97, s97, 15
    s_lshr_b32 s99, s97, 3
    s_xor_b32 s97, s97, s99
    s_add_u32 m0, s87, 18432
    s_lshl_b32 s97, s97, 7
    buffer_load_dwordx4 v240, s[28:31], s97 offen offset:0  lds
    v_bfe_u32 v136, v7, 1, 2
    v_lshl_add_u32 v136, v8, 2, v136
    v_lshlrev_b32 v136, 6, v136
    v_lshrrev_b32 v7, 3, v7
    v_lshl_add_u32 v136, v7, 9, v136
    buffer_load_dwordx4 v241, s[28:31], s97 offen offset:1024  lds
    v_bitop3_b32 v8, v7, 3, s3 bitop3:0x6a
    v_lshl_add_u32 v25, v8, 4, v136
    v_add_u32 v25, 92160, v25
    v_subrev_u32 v7, 1, v7
    v_bitop3_b32 v8, v7, 3, s3 bitop3:0x6a
    buffer_load_dwordx4 v242, s[28:31], s97 offen offset:2048  lds
    v_lshl_add_u32 v27, v8, 4, v136
    v_add_u32 v27, 91648, v27
    v_subrev_u32 v7, 1, v7
    v_bitop3_b32 v8, v7, 3, s3 bitop3:0x6a
    v_lshl_add_u32 v29, v8, 4, v136
    buffer_load_dwordx4 v243, s[28:31], s97 offen offset:3072  lds
    v_add_u32 v29, 91136, v29
    v_subrev_u32 v7, 1, v7
    v_bitop3_b32 v8, v7, 3, s3 bitop3:0x6a
    v_lshl_add_u32 v31, v8, 4, v136
    v_add_u32 v31, 90624, v31
    s_add_u32 m0, s88, 18432
    s_mov_b64 exec, 0xffffffff
    buffer_load_dwordx4 v3, s[28:31], s97 offen offset:0  lds
    s_mov_b64 exec, -1
    v_lshl_add_u32 v7, v5, 1, v6
    v_add_u32 v7, 26, v7
    v_and_b32 v8, 1, v7
    v_bfe_u32 v136, v7, 1, 2
    v_lshl_add_u32 v136, v8, 2, v136
    s_mul_i32 s16, s97, 3072
    s_add_u32 m0, s60, 24576
    s_add_u32 s99, s16, s62
    buffer_load_dwordx4 v244, s[32:35], s99 offen offset:0  lds
    v_lshlrev_b32 v136, 6, v136
    v_lshrrev_b32 v7, 3, v7
    v_lshl_add_u32 v136, v7, 9, v136
    v_bitop3_b32 v8, v7, 3, s3 bitop3:0x6a
    v_lshl_add_u32 v26, v8, 4, v136
    buffer_load_dwordx4 v245, s[32:35], s99 offen offset:1024  lds
    v_add_u32 v26, 92160, v26
    v_subrev_u32 v7, 1, v7
    v_bitop3_b32 v8, v7, 3, s3 bitop3:0x6a
    v_lshl_add_u32 v28, v8, 4, v136
    v_add_u32 v28, 91648, v28
    buffer_load_dwordx4 v246, s[32:35], s99 offen offset:2048  lds
    v_subrev_u32 v7, 1, v7
    v_bitop3_b32 v8, v7, 3, s3 bitop3:0x6a
    v_lshl_add_u32 v30, v8, 4, v136
    v_add_u32 v30, 91136, v30
    v_subrev_u32 v7, 1, v7
    s_add_u32 m0, s61, 36864
    s_add_u32 s16, s16, s63
    buffer_load_dwordx4 v244, s[32:35], s16 offen offset:0  lds
    v_bitop3_b32 v8, v7, 3, s3 bitop3:0x6a
    v_lshl_add_u32 v32, v8, 4, v136
    v_add_u32 v32, 90624, v32
    v_lshrrev_b32 v7, 1, v6
    v_lshl_add_u32 v7, v5, 1, v7
    buffer_load_dwordx4 v245, s[32:35], s16 offen offset:1024  lds
    v_add_u32 v7, 32, v7
    v_and_b32 v8, 1, v7
    v_bfe_u32 v136, v7, 1, 2
    v_lshl_add_u32 v136, v8, 2, v136
    v_lshlrev_b32 v136, 6, v136
    buffer_load_dwordx4 v246, s[32:35], s16 offen offset:2048  lds
    v_lshrrev_b32 v7, 3, v7
    v_lshl_add_u32 v136, v7, 9, v136
    v_bitop3_b32 v8, v7, 3, s3 bitop3:0x6a
    v_lshl_add_u32 v20, v8, 4, v136
    v_add_u32 v20, 92160, v20
    v_and_b32 v8, 1, v6
    v_xor_b32 v8, 1, v8
    v_lshl_add_u32 v20, v8, 3, v20
    s_waitcnt lgkmcnt(0)
    s_and_b32 s78, s92, 0xffff0000
    s_waitcnt vmcnt(11)
    s_barrier
    s_add_u32 m0, s86, 129536
    s_mov_b32 s89, 0
    buffer_load_dwordx4 v10, s[36:39], s89 offen nt lds
    s_lshl_b32 s92, s92, 16
    s_bitcmp1_b32 s90, 0
    s_cselect_b32 s92, s78, s92
    s_add_u32 m0, s86, 145920
    s_mov_b32 s89, 0
    buffer_load_dwordx4 v10, s[40:43], s89 offen nt lds
    v_lshlrev_b32 v7, 3, v6
    s_add_u32 m0, s86, 133632
    s_mov_b32 s89, 65536
    buffer_load_dwordx4 v10, s[36:39], s89 offen nt lds
    v_sub_u32 v7, v7, v5
    s_add_u32 m0, s86, 150016
    s_mov_b32 s89, 65536
    buffer_load_dwordx4 v10, s[40:43], s89 offen nt lds
    v_subrev_u32 v7, 9, v7
    s_add_u32 m0, s86, 137728
    s_mov_b32 s89, 131072
    buffer_load_dwordx4 v10, s[36:39], s89 offen nt lds
    v_and_b32 v8, 1, v7
    s_add_u32 m0, s86, 154112
    s_mov_b32 s89, 131072
    buffer_load_dwordx4 v10, s[40:43], s89 offen nt lds
    v_xor_b32 v8, 1, v8
    s_add_u32 m0, s86, 141824
    s_mov_b32 s89, 196608
    buffer_load_dwordx4 v10, s[36:39], s89 offen nt lds
    v_lshlrev_b32 v8, 4, v8
    s_add_u32 m0, s86, 158208
    s_mov_b32 s89, 196608
    buffer_load_dwordx4 v10, s[40:43], s89 offen nt lds
    v_lshrrev_b32 v8, v8, s92
    s_mov_b64 exec, 0xff
    s_lshl_b32 s82, s3, 7
    s_add_u32 m0, s82, 129024
    s_mov_b32 s89, 0
    buffer_load_dwordx4 v11, s[36:39], s89 offen nt lds
    s_lshl_b32 s83, s74, 9
    s_add_u32 s83, s83, s82
    s_and_b32 s89, s3, 2
    s_lshl_b32 s89, s89, 3
    s_add_u32 s82, s82, s89
    s_add_u32 m0, s82, 162816
    s_add_u32 s89, s83, 0
    buffer_load_dwordx4 v15, s[44:47], s89 offen  lds
    s_mov_b64 exec, -1
    v_ashrrev_i32 v7, 1, v7
    v_cmp_eq_u32 vcc, 0, v7
    s_add_u32 s97, s98, s0
    s_lshr_b64 s[0:1], s[0:1], 4
    s_and_b32 s97, s97, 15
    s_lshr_b32 s99, s97, 3
    s_xor_b32 s97, s97, s99
    s_add_u32 m0, s87, 36864
    s_lshl_b32 s97, s97, 7
    buffer_load_dwordx4 v240, s[28:31], s97 offen offset:0  lds
    v_cndmask_b32 v236, 0, v8, vcc
    buffer_load_dwordx4 v241, s[28:31], s97 offen offset:1024  lds
    v_cmp_eq_u32 vcc, 1, v7
    buffer_load_dwordx4 v242, s[28:31], s97 offen offset:2048  lds
    s_nop 0
    v_cndmask_b32 v237, 0, v8, vcc
    buffer_load_dwordx4 v243, s[28:31], s97 offen offset:3072  lds
    v_cmp_eq_u32 vcc, 2, v7
    s_add_u32 m0, s88, 36864
    s_mov_b64 exec, 0xffffffff
    buffer_load_dwordx4 v3, s[28:31], s97 offen offset:0  lds
    s_mov_b64 exec, -1
    v_cndmask_b32 v238, 0, v8, vcc
    s_mul_i32 s16, s97, 3072
    s_add_u32 m0, s60, 49152
    s_add_u32 s99, s16, s62
    buffer_load_dwordx4 v244, s[32:35], s99 offen offset:0  lds
    v_cmp_eq_u32 vcc, 3, v7
    buffer_load_dwordx4 v245, s[32:35], s99 offen offset:1024  lds
    s_nop 0
    v_cndmask_b32 v239, 0, v8, vcc
    s_waitcnt vmcnt(17)
    s_barrier
    buffer_load_dwordx4 v246, s[32:35], s99 offen offset:2048  lds
    s_add_u32 m0, s61, 61440
    s_add_u32 s16, s16, s63
    buffer_load_dwordx4 v244, s[32:35], s16 offen offset:0  lds
    buffer_load_dwordx4 v245, s[32:35], s16 offen offset:1024  lds
    buffer_load_dwordx4 v246, s[32:35], s16 offen offset:2048  lds
    s_add_u32 s97, s98, s0
    s_lshr_b64 s[0:1], s[0:1], 4
    s_and_b32 s97, s97, 15
    s_lshr_b32 s99, s97, 3
    s_xor_b32 s97, s97, s99
    s_add_u32 m0, s87, 0
    s_lshl_b32 s97, s97, 7
    buffer_load_dwordx4 v240, s[28:31], s97 offen offset:0  lds
    buffer_load_dwordx4 v241, s[28:31], s97 offen offset:1024  lds
    buffer_load_dwordx4 v242, s[28:31], s97 offen offset:2048  lds
    buffer_load_dwordx4 v243, s[28:31], s97 offen offset:3072  lds
    s_add_u32 m0, s88, 0
    s_mov_b64 exec, 0xffffffff
    buffer_load_dwordx4 v3, s[28:31], s97 offen offset:0  lds
    s_mov_b64 exec, -1
    s_mul_i32 s16, s97, 3072
    s_add_u32 m0, s60, 0
    s_add_u32 s99, s16, s62
    buffer_load_dwordx4 v244, s[32:35], s99 offen offset:0  lds
    buffer_load_dwordx4 v245, s[32:35], s99 offen offset:1024  lds
    buffer_load_dwordx4 v246, s[32:35], s99 offen offset:2048  lds
    s_add_u32 m0, s61, 12288
    s_add_u32 s16, s16, s63
    buffer_load_dwordx4 v244, s[32:35], s16 offen offset:0  lds
    buffer_load_dwordx4 v245, s[32:35], s16 offen offset:1024  lds
    buffer_load_dwordx4 v246, s[32:35], s16 offen offset:2048  lds
    s_waitcnt vmcnt(11)
    s_barrier
    s_add_u32 s97, s98, s0
    s_lshr_b64 s[0:1], s[0:1], 4
    s_and_b32 s97, s97, 15
    s_lshr_b32 s99, s97, 3
    s_xor_b32 s97, s97, s99
    s_add_u32 m0, s87, 18432
    s_lshl_b32 s97, s97, 7
    buffer_load_dwordx4 v240, s[28:31], s97 offen offset:0  lds
    ds_read_b128 v[84:87], v35 offset:0
    ds_read_b128 v[88:91], v35 offset:16
    buffer_load_dwordx4 v241, s[28:31], s97 offen offset:1024  lds
    ds_read_b128 v[92:95], v35 offset:32
    buffer_load_dwordx4 v242, s[28:31], s97 offen offset:2048  lds
    ds_read_b128 v[96:99], v35 offset:48
    ds_read_b128 v[40:43], v233 offset:0
    buffer_load_dwordx4 v243, s[28:31], s97 offen offset:3072  lds
    ds_read_b128 v[44:47], v232 offset:256
    s_add_u32 m0, s88, 18432
    s_mov_b64 exec, 0xffffffff
    buffer_load_dwordx4 v3, s[28:31], s97 offen offset:0  lds
    s_mov_b64 exec, -1
    ds_read_b128 v[48:51], v233 offset:256
    s_mul_i32 s16, s97, 3072
    s_add_u32 m0, s60, 24576
    s_add_u32 s99, s16, s62
    buffer_load_dwordx4 v244, s[32:35], s99 offen offset:0  lds
    ds_read_b128 v[52:55], v16 offset:512
    ds_read_b128 v[56:59], v231 offset:512
    buffer_load_dwordx4 v245, s[32:35], s99 offen offset:1024  lds
    ds_read_b128 v[60:63], v16 offset:768
    buffer_load_dwordx4 v246, s[32:35], s99 offen offset:2048  lds
    ds_read_b128 v[64:67], v231 offset:768
    s_add_u32 m0, s61, 36864
    s_add_u32 s16, s16, s63
    buffer_load_dwordx4 v244, s[32:35], s16 offen offset:0  lds
    ds_read_b128 v[68:71], v16 offset:16896
    ds_read_b128 v[72:75], v231 offset:16896
    buffer_load_dwordx4 v245, s[32:35], s16 offen offset:1024  lds
    ds_read_b128 v[76:79], v16 offset:17152
    buffer_load_dwordx4 v246, s[32:35], s16 offen offset:2048  lds
    ds_read_b128 v[80:83], v231 offset:17152
    s_waitcnt vmcnt(11)
    s_waitcnt lgkmcnt(0)
    s_barrier
    s_add_u32 s97, s98, s0
    s_lshr_b64 s[0:1], s[0:1], 4
    s_and_b32 s97, s97, 15
    s_lshr_b32 s99, s97, 3
    s_xor_b32 s97, s97, s99
    s_add_u32 m0, s87, 36864
    s_lshl_b32 s97, s97, 7
    buffer_load_dwordx4 v240, s[28:31], s97 offen offset:0  lds
    v_lshlrev_b32 v116, 16, v40
    v_lshlrev_b32 v117, 16, v44
    v_lshlrev_b32 v118, 16, v48
    v_lshlrev_b32 v119, 16, v52
    v_lshlrev_b32 v120, 16, v56
    buffer_load_dwordx4 v241, s[28:31], s97 offen offset:1024  lds
    v_lshlrev_b32 v121, 16, v60
    v_lshlrev_b32 v122, 16, v64
    v_lshlrev_b32 v127, 16, v84
    v_and_b32 v128, 0xffff0000, v84
    v_lshlrev_b32 v129, 16, v85
    buffer_load_dwordx4 v242, s[28:31], s97 offen offset:2048  lds
    v_and_b32 v130, 0xffff0000, v85
    v_lshlrev_b32 v123, 16, v68
    v_lshlrev_b32 v124, 16, v72
    v_lshlrev_b32 v125, 16, v76
    v_lshlrev_b32 v126, 16, v80
    buffer_load_dwordx4 v243, s[28:31], s97 offen offset:3072  lds
    v_mul_f32 v131, v116, v130
    v_mul_f32 v132, v117, v130
    v_mul_f32 v133, v118, v130
    v_mul_f32 v134, v119, v130
    v_fmac_f32 v131, v117, v129
    s_add_u32 m0, s88, 36864
    s_mov_b64 exec, 0xffffffff
    buffer_load_dwordx4 v3, s[28:31], s97 offen offset:0  lds
    s_mov_b64 exec, -1
    v_fmac_f32 v132, v118, v129
    v_fmac_f32 v133, v119, v129
    v_fmac_f32 v134, v120, v129
    v_fmac_f32 v131, v118, v128
    v_fmac_f32 v132, v119, v128
    s_mul_i32 s16, s97, 3072
    s_add_u32 m0, s60, 49152
    s_add_u32 s99, s16, s62
    buffer_load_dwordx4 v244, s[32:35], s99 offen offset:0  lds
    v_fmac_f32 v133, v120, v128
    v_fmac_f32 v134, v121, v128
    v_fmac_f32 v131, v119, v127
    v_fmac_f32 v132, v120, v127
    v_fmac_f32 v133, v121, v127
    buffer_load_dwordx4 v245, s[32:35], s99 offen offset:1024  lds
    v_fmac_f32 v134, v122, v127
    v_mul_f32 v131, v131, v123
    v_mul_f32 v132, v132, v124
    v_mul_f32 v133, v133, v125
    v_mul_f32 v134, v134, v126
    buffer_load_dwordx4 v246, s[32:35], s99 offen offset:2048  lds
    v_cvt_pk_bf16_f32 v102, v134, v133
    v_cvt_pk_bf16_f32 v103, v132, v131
    v_lshlrev_b32 v116, 16, v42
    v_lshlrev_b32 v117, 16, v46
    v_lshlrev_b32 v118, 16, v50
    s_add_u32 m0, s61, 61440
    s_add_u32 s16, s16, s63
    buffer_load_dwordx4 v244, s[32:35], s16 offen offset:0  lds
    v_lshlrev_b32 v119, 16, v54
    v_lshlrev_b32 v120, 16, v58
    v_lshlrev_b32 v121, 16, v62
    v_lshlrev_b32 v122, 16, v66
    v_lshlrev_b32 v127, 16, v92
    buffer_load_dwordx4 v245, s[32:35], s16 offen offset:1024  lds
    v_and_b32 v128, 0xffff0000, v92
    v_lshlrev_b32 v129, 16, v93
    v_and_b32 v130, 0xffff0000, v93
    v_lshlrev_b32 v123, 16, v70
    v_lshlrev_b32 v124, 16, v74
    buffer_load_dwordx4 v246, s[32:35], s16 offen offset:2048  lds
    v_lshlrev_b32 v125, 16, v78
    v_lshlrev_b32 v126, 16, v82
    v_mul_f32 v131, v116, v130
    v_mul_f32 v132, v117, v130
    v_mul_f32 v133, v118, v130
    v_mul_f32 v134, v119, v130
    v_fmac_f32 v131, v117, v129
    v_fmac_f32 v132, v118, v129
    v_fmac_f32 v133, v119, v129
    v_fmac_f32 v134, v120, v129
    v_fmac_f32 v131, v118, v128
    v_fmac_f32 v132, v119, v128
    s_waitcnt vmcnt(11)
    s_barrier
    s_add_u32 s97, s98, s0
    s_lshr_b64 s[0:1], s[0:1], 4
    s_and_b32 s97, s97, 15
    s_lshr_b32 s99, s97, 3
    s_xor_b32 s97, s97, s99
    s_add_u32 m0, s87, 0
    s_lshl_b32 s97, s97, 7
    buffer_load_dwordx4 v240, s[28:31], s97 offen offset:0  lds
    v_fmac_f32 v133, v120, v128
    v_fmac_f32 v134, v121, v128
    v_fmac_f32 v131, v119, v127
    v_fmac_f32 v132, v120, v127
    v_fmac_f32 v133, v121, v127
    buffer_load_dwordx4 v241, s[28:31], s97 offen offset:1024  lds
    v_fmac_f32 v134, v122, v127
    v_mul_f32 v131, v131, v123
    v_mul_f32 v132, v132, v124
    v_mul_f32 v133, v133, v125
    v_mul_f32 v134, v134, v126
    buffer_load_dwordx4 v242, s[28:31], s97 offen offset:2048  lds
    v_cvt_pk_bf16_f32 v100, v134, v133
    v_cvt_pk_bf16_f32 v101, v132, v131
    s_nop 0
    v_permlane32_swap_b32 v102, v100
    v_permlane32_swap_b32 v103, v101
    s_mov_b32 s89, 0
    buffer_store_dwordx4 v[100:103], v12, s[52:55], s89 offen sc1
    buffer_load_dwordx4 v243, s[28:31], s97 offen offset:3072  lds
    v_and_b32 v116, 0xffff0000, v40
    v_and_b32 v117, 0xffff0000, v44
    v_and_b32 v118, 0xffff0000, v48
    v_and_b32 v119, 0xffff0000, v52
    v_and_b32 v120, 0xffff0000, v56
    s_add_u32 m0, s88, 0
    s_mov_b64 exec, 0xffffffff
    buffer_load_dwordx4 v3, s[28:31], s97 offen offset:0  lds
    s_mov_b64 exec, -1
    v_and_b32 v121, 0xffff0000, v60
    v_and_b32 v122, 0xffff0000, v64
    v_lshlrev_b32 v127, 16, v86
    v_and_b32 v128, 0xffff0000, v86
    v_lshlrev_b32 v129, 16, v87
    s_mul_i32 s16, s97, 3072
    s_add_u32 m0, s60, 0
    s_add_u32 s99, s16, s62
    buffer_load_dwordx4 v244, s[32:35], s99 offen offset:0  lds
    v_and_b32 v130, 0xffff0000, v87
    v_and_b32 v123, 0xffff0000, v68
    v_and_b32 v124, 0xffff0000, v72
    v_and_b32 v125, 0xffff0000, v76
    v_and_b32 v126, 0xffff0000, v80
    buffer_load_dwordx4 v245, s[32:35], s99 offen offset:1024  lds
    v_mul_f32 v131, v116, v130
    v_mul_f32 v132, v117, v130
    v_mul_f32 v133, v118, v130
    v_mul_f32 v134, v119, v130
    v_fmac_f32 v131, v117, v129
    buffer_load_dwordx4 v246, s[32:35], s99 offen offset:2048  lds
    v_fmac_f32 v132, v118, v129
    v_fmac_f32 v133, v119, v129
    v_fmac_f32 v134, v120, v129
    v_fmac_f32 v131, v118, v128
    v_fmac_f32 v132, v119, v128
    s_add_u32 m0, s61, 12288
    s_add_u32 s16, s16, s63
    buffer_load_dwordx4 v244, s[32:35], s16 offen offset:0  lds
    v_fmac_f32 v133, v120, v128
    v_fmac_f32 v134, v121, v128
    v_fmac_f32 v131, v119, v127
    v_fmac_f32 v132, v120, v127
    v_fmac_f32 v133, v121, v127
    buffer_load_dwordx4 v245, s[32:35], s16 offen offset:1024  lds
    v_fmac_f32 v134, v122, v127
    v_mul_f32 v131, v131, v123
    v_mul_f32 v132, v132, v124
    v_mul_f32 v133, v133, v125
    v_mul_f32 v134, v134, v126
    buffer_load_dwordx4 v246, s[32:35], s16 offen offset:2048  lds
    v_cvt_pk_bf16_f32 v106, v134, v133
    v_cvt_pk_bf16_f32 v107, v132, v131
    v_and_b32 v116, 0xffff0000, v42
    v_and_b32 v117, 0xffff0000, v46
    v_and_b32 v118, 0xffff0000, v50
    v_and_b32 v119, 0xffff0000, v54
    v_and_b32 v120, 0xffff0000, v58
    v_and_b32 v121, 0xffff0000, v62
    v_and_b32 v122, 0xffff0000, v66
    v_lshlrev_b32 v127, 16, v94
    v_and_b32 v128, 0xffff0000, v94
    v_lshlrev_b32 v129, 16, v95
    s_waitcnt vmcnt(12)
    s_barrier
    s_add_u32 s97, s98, s0
    s_lshr_b64 s[0:1], s[0:1], 4
    s_and_b32 s97, s97, 15
    s_lshr_b32 s99, s97, 3
    s_xor_b32 s97, s97, s99
    s_add_u32 m0, s87, 18432
    s_lshl_b32 s97, s97, 7
    buffer_load_dwordx4 v240, s[28:31], s97 offen offset:0  lds
    v_and_b32 v130, 0xffff0000, v95
    v_and_b32 v123, 0xffff0000, v70
    v_and_b32 v124, 0xffff0000, v74
    v_and_b32 v125, 0xffff0000, v78
    v_and_b32 v126, 0xffff0000, v82
    buffer_load_dwordx4 v241, s[28:31], s97 offen offset:1024  lds
    v_mul_f32 v131, v116, v130
    v_mul_f32 v132, v117, v130
    v_mul_f32 v133, v118, v130
    v_mul_f32 v134, v119, v130
    v_fmac_f32 v131, v117, v129
    buffer_load_dwordx4 v242, s[28:31], s97 offen offset:2048  lds
    v_fmac_f32 v132, v118, v129
    v_fmac_f32 v133, v119, v129
    v_fmac_f32 v134, v120, v129
    v_fmac_f32 v131, v118, v128
    v_fmac_f32 v132, v119, v128
    buffer_load_dwordx4 v243, s[28:31], s97 offen offset:3072  lds
    v_fmac_f32 v133, v120, v128
    v_fmac_f32 v134, v121, v128
    v_fmac_f32 v131, v119, v127
    v_fmac_f32 v132, v120, v127
    v_fmac_f32 v133, v121, v127
    s_add_u32 m0, s88, 18432
    s_mov_b64 exec, 0xffffffff
    buffer_load_dwordx4 v3, s[28:31], s97 offen offset:0  lds
    s_mov_b64 exec, -1
    v_fmac_f32 v134, v122, v127
    v_mul_f32 v131, v131, v123
    v_mul_f32 v132, v132, v124
    v_mul_f32 v133, v133, v125
    v_mul_f32 v134, v134, v126
    s_mul_i32 s16, s97, 3072
    s_add_u32 m0, s60, 24576
    s_add_u32 s99, s16, s62
    buffer_load_dwordx4 v244, s[32:35], s99 offen offset:0  lds
    v_cvt_pk_bf16_f32 v104, v134, v133
    v_cvt_pk_bf16_f32 v105, v132, v131
    s_nop 0
    v_permlane32_swap_b32 v106, v104
    v_permlane32_swap_b32 v107, v105
    s_mov_b32 s89, 16384
    buffer_store_dwordx4 v[104:107], v12, s[52:55], s89 offen sc1
    buffer_load_dwordx4 v245, s[32:35], s99 offen offset:1024  lds
    v_lshlrev_b32 v116, 16, v41
    v_lshlrev_b32 v117, 16, v45
    v_lshlrev_b32 v118, 16, v49
    v_lshlrev_b32 v119, 16, v53
    v_lshlrev_b32 v120, 16, v57
    buffer_load_dwordx4 v246, s[32:35], s99 offen offset:2048  lds
    v_lshlrev_b32 v121, 16, v61
    v_lshlrev_b32 v122, 16, v65
    v_lshlrev_b32 v127, 16, v88
    v_and_b32 v128, 0xffff0000, v88
    v_lshlrev_b32 v129, 16, v89
    s_add_u32 m0, s61, 36864
    s_add_u32 s16, s16, s63
    buffer_load_dwordx4 v244, s[32:35], s16 offen offset:0  lds
    v_and_b32 v130, 0xffff0000, v89
    v_lshlrev_b32 v123, 16, v69
    v_lshlrev_b32 v124, 16, v73
    v_lshlrev_b32 v125, 16, v77
    v_lshlrev_b32 v126, 16, v81
    buffer_load_dwordx4 v245, s[32:35], s16 offen offset:1024  lds
    v_mul_f32 v131, v116, v130
    v_mul_f32 v132, v117, v130
    v_mul_f32 v133, v118, v130
    v_mul_f32 v134, v119, v130
    v_fmac_f32 v131, v117, v129
    buffer_load_dwordx4 v246, s[32:35], s16 offen offset:2048  lds
    v_fmac_f32 v132, v118, v129
    v_fmac_f32 v133, v119, v129
    v_fmac_f32 v134, v120, v129
    v_fmac_f32 v131, v118, v128
    v_fmac_f32 v132, v119, v128
    v_fmac_f32 v133, v120, v128
    v_fmac_f32 v134, v121, v128
    v_fmac_f32 v131, v119, v127
    v_fmac_f32 v132, v120, v127
    v_fmac_f32 v133, v121, v127
    v_fmac_f32 v134, v122, v127
    v_mul_f32 v131, v131, v123
    s_waitcnt vmcnt(12)
    s_barrier
    s_add_u32 s97, s98, s0
    s_lshr_b64 s[0:1], s[0:1], 4
    s_and_b32 s97, s97, 15
    s_lshr_b32 s99, s97, 3
    s_xor_b32 s97, s97, s99
    s_add_u32 m0, s87, 36864
    s_lshl_b32 s97, s97, 7
    buffer_load_dwordx4 v240, s[28:31], s97 offen offset:0  lds
    v_mul_f32 v132, v132, v124
    v_mul_f32 v133, v133, v125
    v_mul_f32 v134, v134, v126
    v_cvt_pk_bf16_f32 v110, v134, v133
    v_cvt_pk_bf16_f32 v111, v132, v131
    buffer_load_dwordx4 v241, s[28:31], s97 offen offset:1024  lds
    v_lshlrev_b32 v116, 16, v43
    v_lshlrev_b32 v117, 16, v47
    v_lshlrev_b32 v118, 16, v51
    v_lshlrev_b32 v119, 16, v55
    v_lshlrev_b32 v120, 16, v59
    buffer_load_dwordx4 v242, s[28:31], s97 offen offset:2048  lds
    v_lshlrev_b32 v121, 16, v63
    v_lshlrev_b32 v122, 16, v67
    v_lshlrev_b32 v127, 16, v96
    v_and_b32 v128, 0xffff0000, v96
    v_lshlrev_b32 v129, 16, v97
    buffer_load_dwordx4 v243, s[28:31], s97 offen offset:3072  lds
    v_and_b32 v130, 0xffff0000, v97
    v_lshlrev_b32 v123, 16, v71
    v_lshlrev_b32 v124, 16, v75
    v_lshlrev_b32 v125, 16, v79
    v_lshlrev_b32 v126, 16, v83
    s_add_u32 m0, s88, 36864
    s_mov_b64 exec, 0xffffffff
    buffer_load_dwordx4 v3, s[28:31], s97 offen offset:0  lds
    s_mov_b64 exec, -1
    v_mul_f32 v131, v116, v130
    v_mul_f32 v132, v117, v130
    v_mul_f32 v133, v118, v130
    v_mul_f32 v134, v119, v130
    v_fmac_f32 v131, v117, v129
    s_mul_i32 s16, s97, 3072
    s_add_u32 m0, s60, 49152
    s_add_u32 s99, s16, s62
    buffer_load_dwordx4 v244, s[32:35], s99 offen offset:0  lds
    v_fmac_f32 v132, v118, v129
    v_fmac_f32 v133, v119, v129
    v_fmac_f32 v134, v120, v129
    v_fmac_f32 v131, v118, v128
    v_fmac_f32 v132, v119, v128
    buffer_load_dwordx4 v245, s[32:35], s99 offen offset:1024  lds
    v_fmac_f32 v133, v120, v128
    v_fmac_f32 v134, v121, v128
    v_fmac_f32 v131, v119, v127
    v_fmac_f32 v132, v120, v127
    v_fmac_f32 v133, v121, v127
    buffer_load_dwordx4 v246, s[32:35], s99 offen offset:2048  lds
    v_fmac_f32 v134, v122, v127
    v_mul_f32 v131, v131, v123
    v_mul_f32 v132, v132, v124
    v_mul_f32 v133, v133, v125
    v_mul_f32 v134, v134, v126
    s_add_u32 m0, s61, 61440
    s_add_u32 s16, s16, s63
    buffer_load_dwordx4 v244, s[32:35], s16 offen offset:0  lds
    v_cvt_pk_bf16_f32 v108, v134, v133
    v_cvt_pk_bf16_f32 v109, v132, v131
    s_nop 0
    v_permlane32_swap_b32 v110, v108
    v_permlane32_swap_b32 v111, v109
    s_mov_b32 s89, 32768
    buffer_store_dwordx4 v[108:111], v12, s[52:55], s89 offen sc1
    buffer_load_dwordx4 v245, s[32:35], s16 offen offset:1024  lds
    v_and_b32 v116, 0xffff0000, v41
    v_and_b32 v117, 0xffff0000, v45
    v_and_b32 v118, 0xffff0000, v49
    v_and_b32 v119, 0xffff0000, v53
    v_and_b32 v120, 0xffff0000, v57
    buffer_load_dwordx4 v246, s[32:35], s16 offen offset:2048  lds
    v_and_b32 v121, 0xffff0000, v61
    v_and_b32 v122, 0xffff0000, v65
    v_lshlrev_b32 v127, 16, v90
    v_and_b32 v128, 0xffff0000, v90
    v_lshlrev_b32 v129, 16, v91
    v_and_b32 v130, 0xffff0000, v91
    v_and_b32 v123, 0xffff0000, v69
    v_and_b32 v124, 0xffff0000, v73
    v_and_b32 v125, 0xffff0000, v77
    v_and_b32 v126, 0xffff0000, v81
    v_mul_f32 v131, v116, v130
    v_mul_f32 v132, v117, v130
    s_waitcnt vmcnt(12)
    s_barrier
    s_add_u32 s97, s98, s0
    s_lshr_b64 s[0:1], s[0:1], 4
    s_and_b32 s97, s97, 15
    s_lshr_b32 s99, s97, 3
    s_xor_b32 s97, s97, s99
    s_add_u32 m0, s87, 0
    s_lshl_b32 s97, s97, 7
    buffer_load_dwordx4 v240, s[28:31], s97 offen offset:0  lds
    v_mul_f32 v133, v118, v130
    v_mul_f32 v134, v119, v130
    v_fmac_f32 v131, v117, v129
    v_fmac_f32 v132, v118, v129
    v_fmac_f32 v133, v119, v129
    buffer_load_dwordx4 v241, s[28:31], s97 offen offset:1024  lds
    v_fmac_f32 v134, v120, v129
    v_fmac_f32 v131, v118, v128
    v_fmac_f32 v132, v119, v128
    v_fmac_f32 v133, v120, v128
    v_fmac_f32 v134, v121, v128
    buffer_load_dwordx4 v242, s[28:31], s97 offen offset:2048  lds
    v_fmac_f32 v131, v119, v127
    v_fmac_f32 v132, v120, v127
    v_fmac_f32 v133, v121, v127
    v_fmac_f32 v134, v122, v127
    v_mul_f32 v131, v131, v123
    buffer_load_dwordx4 v243, s[28:31], s97 offen offset:3072  lds
    v_mul_f32 v132, v132, v124
    v_mul_f32 v133, v133, v125
    v_mul_f32 v134, v134, v126
    v_cvt_pk_bf16_f32 v114, v134, v133
    v_cvt_pk_bf16_f32 v115, v132, v131
    s_add_u32 m0, s88, 0
    s_mov_b64 exec, 0xffffffff
    buffer_load_dwordx4 v3, s[28:31], s97 offen offset:0  lds
    s_mov_b64 exec, -1
    v_and_b32 v116, 0xffff0000, v43
    v_and_b32 v117, 0xffff0000, v47
    v_and_b32 v118, 0xffff0000, v51
    v_and_b32 v119, 0xffff0000, v55
    v_and_b32 v120, 0xffff0000, v59
    s_mul_i32 s16, s97, 3072
    s_add_u32 m0, s60, 0
    s_add_u32 s99, s16, s62
    buffer_load_dwordx4 v244, s[32:35], s99 offen offset:0  lds
    v_and_b32 v121, 0xffff0000, v63
    v_and_b32 v122, 0xffff0000, v67
    v_lshlrev_b32 v127, 16, v98
    v_and_b32 v128, 0xffff0000, v98
    v_lshlrev_b32 v129, 16, v99
    buffer_load_dwordx4 v245, s[32:35], s99 offen offset:1024  lds
    v_and_b32 v130, 0xffff0000, v99
    v_and_b32 v123, 0xffff0000, v71
    v_and_b32 v124, 0xffff0000, v75
    v_and_b32 v125, 0xffff0000, v79
    v_and_b32 v126, 0xffff0000, v83
    buffer_load_dwordx4 v246, s[32:35], s99 offen offset:2048  lds
    v_mul_f32 v131, v116, v130
    v_mul_f32 v132, v117, v130
    v_mul_f32 v133, v118, v130
    v_mul_f32 v134, v119, v130
    v_fmac_f32 v131, v117, v129
    s_add_u32 m0, s61, 12288
    s_add_u32 s16, s16, s63
    buffer_load_dwordx4 v244, s[32:35], s16 offen offset:0  lds
    v_fmac_f32 v132, v118, v129
    v_fmac_f32 v133, v119, v129
    v_fmac_f32 v134, v120, v129
    v_fmac_f32 v131, v118, v128
    v_fmac_f32 v132, v119, v128
    buffer_load_dwordx4 v245, s[32:35], s16 offen offset:1024  lds
    v_fmac_f32 v133, v120, v128
    v_fmac_f32 v134, v121, v128
    v_fmac_f32 v131, v119, v127
    v_fmac_f32 v132, v120, v127
    v_fmac_f32 v133, v121, v127
    buffer_load_dwordx4 v246, s[32:35], s16 offen offset:2048  lds
    v_fmac_f32 v134, v122, v127
    v_mul_f32 v131, v131, v123
    v_mul_f32 v132, v132, v124
    v_mul_f32 v133, v133, v125
    v_mul_f32 v134, v134, v126
    v_cvt_pk_bf16_f32 v112, v134, v133
    v_cvt_pk_bf16_f32 v113, v132, v131
    s_nop 0
    v_permlane32_swap_b32 v114, v112
    v_permlane32_swap_b32 v115, v113
    s_mov_b32 s89, 49152
    buffer_store_dwordx4 v[112:115], v12, s[52:55], s89 offen sc1
    s_waitcnt vmcnt(12)
    s_barrier
    s_add_u32 m0, s94, 32
    s_lshl_b32 s89, s90, 12
    buffer_load_dwordx4 v15, s[48:51], s89 offen offset:0 nt lds
    s_add_u32 m0, s94, 32
    s_lshl_b32 s89, s90, 12
    buffer_load_dwordx4 v15, s[48:51], s89 offen offset:1024 nt lds
    s_add_u32 m0, s94, 32
    s_lshl_b32 s89, s90, 12
    buffer_load_dwordx4 v15, s[48:51], s89 offen offset:2048 nt lds
    s_add_u32 m0, s94, 32
    s_lshl_b32 s89, s90, 12
    buffer_load_dwordx4 v15, s[48:51], s89 offen offset:3072 nt lds
    s_add_u32 s97, s98, s0
    s_lshr_b64 s[0:1], s[0:1], 4
    s_and_b32 s97, s97, 15
    s_lshr_b32 s99, s97, 3
    s_xor_b32 s97, s97, s99
    s_add_u32 m0, s87, 18432
    s_lshl_b32 s97, s97, 7
    buffer_load_dwordx4 v240, s[28:31], s97 offen offset:0  lds
    buffer_load_dwordx4 v241, s[28:31], s97 offen offset:1024  lds
    buffer_load_dwordx4 v242, s[28:31], s97 offen offset:2048  lds
    buffer_load_dwordx4 v243, s[28:31], s97 offen offset:3072  lds
    s_add_u32 m0, s88, 18432
    s_mov_b64 exec, 0xffffffff
    buffer_load_dwordx4 v3, s[28:31], s97 offen offset:0  lds
    s_mov_b64 exec, -1
    s_mul_i32 s16, s97, 3072
    s_add_u32 m0, s60, 24576
    s_add_u32 s99, s16, s62
    buffer_load_dwordx4 v244, s[32:35], s99 offen offset:0  lds
    buffer_load_dwordx4 v245, s[32:35], s99 offen offset:1024  lds
    buffer_load_dwordx4 v246, s[32:35], s99 offen offset:2048  lds
    s_add_u32 m0, s61, 36864
    s_add_u32 s16, s16, s63
    buffer_load_dwordx4 v244, s[32:35], s16 offen offset:0  lds
    buffer_load_dwordx4 v245, s[32:35], s16 offen offset:1024  lds
    buffer_load_dwordx4 v246, s[32:35], s16 offen offset:2048  lds
    s_waitcnt vmcnt(16)
    s_waitcnt vmcnt(15)
    s_barrier
    s_add_u32 s97, s98, s0
    s_lshr_b64 s[0:1], s[0:1], 4
    s_and_b32 s97, s97, 15
    s_lshr_b32 s99, s97, 3
    s_xor_b32 s97, s97, s99
    s_add_u32 m0, s87, 36864
    s_lshl_b32 s97, s97, 7
    buffer_load_dwordx4 v240, s[28:31], s97 offen offset:0  lds
    buffer_load_dwordx4 v241, s[28:31], s97 offen offset:1024  lds
    buffer_load_dwordx4 v242, s[28:31], s97 offen offset:2048  lds
    buffer_load_dwordx4 v243, s[28:31], s97 offen offset:3072  lds
    s_add_u32 m0, s88, 36864
    s_mov_b64 exec, 0xffffffff
    buffer_load_dwordx4 v3, s[28:31], s97 offen offset:0  lds
    s_mov_b64 exec, -1
    s_mul_i32 s16, s97, 3072
    s_add_u32 m0, s60, 49152
    s_add_u32 s99, s16, s62
    buffer_load_dwordx4 v244, s[32:35], s99 offen offset:0  lds
    buffer_load_dwordx4 v245, s[32:35], s99 offen offset:1024  lds
    buffer_load_dwordx4 v246, s[32:35], s99 offen offset:2048  lds
    s_add_u32 m0, s61, 61440
    s_add_u32 s16, s16, s63
    buffer_load_dwordx4 v244, s[32:35], s16 offen offset:0  lds
    buffer_load_dwordx4 v245, s[32:35], s16 offen offset:1024  lds
    buffer_load_dwordx4 v246, s[32:35], s16 offen offset:2048  lds
    s_waitcnt vmcnt(11)
    s_barrier
    s_add_u32 s97, s98, s0
    s_lshr_b64 s[0:1], s[0:1], 4
    s_and_b32 s97, s97, 15
    s_lshr_b32 s99, s97, 3
    s_xor_b32 s97, s97, s99
    s_add_u32 m0, s87, 0
    s_lshl_b32 s97, s97, 7
    buffer_load_dwordx4 v240, s[28:31], s97 offen offset:0  lds
    v_add_u32 v5, s94, v15
    ds_read_b128 v[140:143], v5 offset:32
    ds_read_b32 v156, v5 offset:48
    ds_read_b128 v[144:147], v5 offset:1056
    buffer_load_dwordx4 v241, s[28:31], s97 offen offset:1024  lds
    ds_read_b32 v157, v5 offset:1072
    ds_read_b128 v[148:151], v5 offset:2080
    ds_read_b32 v158, v5 offset:2096
    buffer_load_dwordx4 v242, s[28:31], s97 offen offset:2048  lds
    ds_read_b128 v[152:155], v5 offset:3104
    ds_read_b32 v159, v5 offset:3120
    v_lshrrev_b32 v6, 3, v0
    buffer_load_dwordx4 v243, s[28:31], s97 offen offset:3072  lds
    v_mul_u32_u24 v6, 4160, v6
    v_and_b32 v7, 7, v0
    v_lshl_add_u32 v6, v7, 2, v6
    v_add_u32 v6, s94, v6
    s_add_u32 m0, s88, 0
    s_mov_b64 exec, 0xffffffff
    buffer_load_dwordx4 v3, s[28:31], s97 offen offset:0  lds
    s_mov_b64 exec, -1
    v_mov_b32 v7, 0
    s_waitcnt lgkmcnt(0)
    v_readfirstlane_b32 s93, v140
    s_mul_i32 s16, s97, 3072
    s_add_u32 m0, s60, 0
    s_add_u32 s99, s16, s62
    buffer_load_dwordx4 v244, s[32:35], s99 offen offset:0  lds
    s_lshl_b32 s93, s93, 16
    v_writelane_b32 v7, s93, 15
    v_alignbit_b32 v140, v141, v140, 16
    buffer_load_dwordx4 v245, s[32:35], s99 offen offset:1024  lds
    v_alignbit_b32 v141, v142, v141, 16
    v_alignbit_b32 v142, v143, v142, 16
    v_alignbit_b32 v143, v156, v143, 16
    v_alignbit_b32 v144, v145, v144, 16
    buffer_load_dwordx4 v246, s[32:35], s99 offen offset:2048  lds
    v_alignbit_b32 v145, v146, v145, 16
    v_alignbit_b32 v146, v147, v146, 16
    v_alignbit_b32 v147, v157, v147, 16
    s_add_u32 m0, s61, 12288
    s_add_u32 s16, s16, s63
    buffer_load_dwordx4 v244, s[32:35], s16 offen offset:0  lds
    v_alignbit_b32 v148, v149, v148, 16
    v_alignbit_b32 v149, v150, v149, 16
    v_alignbit_b32 v150, v151, v150, 16
    buffer_load_dwordx4 v245, s[32:35], s16 offen offset:1024  lds
    v_alignbit_b32 v151, v158, v151, 16
    v_alignbit_b32 v152, v153, v152, 16
    v_alignbit_b32 v153, v154, v153, 16
    v_alignbit_b32 v154, v155, v154, 16
    buffer_load_dwordx4 v246, s[32:35], s16 offen offset:2048  lds
    v_alignbit_b32 v155, v159, v155, 16
    v_lshlrev_b32 v8, 3, v0
    s_add_u32 s78, s88, 18432
    s_mov_b64 exec, 0xff
    buffer_load_dword v136, v33, s[68:71], 0 offen sc1
    buffer_load_dword v137, v34, s[52:55], 0 offen sc1
    s_mov_b64 exec, -1
    v_add_u32 v8, s78, v8
    v_mov_b32 v156, 0
    v_mov_b32 v157, 0
    s_waitcnt vmcnt(13)
    s_barrier
    s_waitcnt vmcnt(0)
LA_j:
    s_mov_b64 exec, 1
    ds_add_u32 v18, v19 offset:24
    s_mov_b64 exec, -1
    s_mov_b64 exec, 0xff
    v_cmp_ne_u32 vcc, v136, v137
    v_cmp_gt_u32 s[80:81], s96, v136
    s_nop 0
    s_or_b64 vcc, vcc, s[80:81]
    s_cbranch_vccnz LA_slow
LA_back:
    s_mov_b64 exec, -1
    s_add_u32 m0, s86, 94208
    s_add_u32 s89, s91, 0
    buffer_load_dwordx4 v14, s[52:55], s89 offen sc1 lds
    s_add_u32 m0, s86, 98304
    s_add_u32 s89, s91, 4096
    buffer_load_dwordx4 v14, s[52:55], s89 offen sc1 lds
    s_add_u32 m0, s86, 102400
    s_add_u32 s89, s91, 8192
    buffer_load_dwordx4 v14, s[52:55], s89 offen sc1 lds
    s_add_u32 m0, s86, 106496
    s_add_u32 s89, s91, 12288
    buffer_load_dwordx4 v14, s[52:55], s89 offen sc1 lds
    s_mov_b64 exec, 0xffff
    ds_write_b32 v6, v7
    s_mov_b64 exec, -1
    ds_write_b128 v5, v[140:143] offset:4192
    ds_write_b128 v5, v[144:147] offset:5216
    ds_write_b128 v5, v[148:151] offset:6240
    ds_write_b128 v5, v[152:155] offset:7264
    ds_write_b64 v8, v[156:157]
    ds_read2_b32 v[68:69], v21 offset0:0 offset1:1
    ds_read2_b32 v[70:71], v21 offset0:2 offset1:3
    ds_read2_b32 v[72:73], v21 offset0:128 offset1:129
    ds_read2_b32 v[74:75], v21 offset0:130 offset1:131
    ds_read2_b32 v[76:77], v22 offset0:0 offset1:1
    ds_read2_b32 v[78:79], v22 offset0:2 offset1:3
    ds_read2_b32 v[80:81], v22 offset0:128 offset1:129
    ds_read2_b32 v[82:83], v22 offset0:130 offset1:131
    ds_read2_b32 v[84:85], v23 offset0:0 offset1:1
    ds_read2_b32 v[86:87], v23 offset0:2 offset1:3
    ds_read2_b32 v[88:89], v23 offset0:128 offset1:129
    ds_read2_b32 v[90:91], v23 offset0:130 offset1:131
    ds_read2_b32 v[92:93], v24 offset0:0 offset1:1
    ds_read2_b32 v[94:95], v24 offset0:2 offset1:3
    ds_read2_b32 v[96:97], v24 offset0:128 offset1:129
    ds_read2_b32 v[98:99], v24 offset0:130 offset1:131
    s_waitcnt vmcnt(0)
    s_mov_b64 exec, 1
    ds_add_u32 v18, v19 offset:20
    s_mov_b64 exec, -1
    buffer_load_dwordx4 v[212:215], v9, s[56:59], 0 offen offset:0 nt
    buffer_load_dwordx4 v[216:219], v9, s[56:59], 0 offen offset:2048 nt
    buffer_load_dwordx4 v[220:223], v9, s[56:59], s96 offen offset:0 nt
    buffer_load_dwordx4 v[224:227], v9, s[56:59], s96 offen offset:2048 nt
    s_branch LA_s5_in
LA_s5:
    s_sleep 1
LA_s5_in:
    ds_read_b32 v6, v18 offset:20
    s_waitcnt lgkmcnt(0)
    v_readfirstlane_b32 s78, v6
    s_nop 0
    s_cmp_ge_u32 s78, 4
    s_cbranch_scc0 LA_s5
    s_mov_b64 exec, 1
    ds_add_u32 v18, v19 offset:8
    s_mov_b64 exec, -1
    ds_read_b128 v[100:103], v25 offset:0
    ds_read_b128 v[104:107], v25 offset:2048
    ds_read_b128 v[108:111], v25 offset:4096
    ds_read_b128 v[112:115], v25 offset:6144
    ds_read_b128 v[116:119], v25 offset:8192
    ds_read_b128 v[120:123], v25 offset:10240
    ds_read_b128 v[124:127], v25 offset:12288
    ds_read_b128 v[128:131], v25 offset:14336
    s_setprio 2
    s_waitcnt lgkmcnt(7)
    v_mfma_f32_16x16x32_bf16 v[36:39], v[236:239], v[100:103], 0
    ds_read2_b32 v[132:133], v21 offset0:16 offset1:17
    s_waitcnt lgkmcnt(7)
    v_mfma_f32_16x16x32_bf16 v[40:43], v[236:239], v[104:107], 0
    ds_read2_b32 v[134:135], v21 offset0:18 offset1:19
    s_waitcnt lgkmcnt(7)
    v_mfma_f32_16x16x32_bf16 v[44:47], v[236:239], v[108:111], 0
    s_waitcnt lgkmcnt(6)
    v_mfma_f32_16x16x32_bf16 v[48:51], v[236:239], v[112:115], 0
    ds_read_b128 v[164:167], v26 offset:0
    s_waitcnt lgkmcnt(6)
    v_mfma_f32_16x16x32_bf16 v[52:55], v[236:239], v[116:119], 0
    s_waitcnt lgkmcnt(5)
    v_mfma_f32_16x16x32_bf16 v[56:59], v[236:239], v[120:123], 0
    ds_read_b128 v[168:171], v26 offset:2048
    s_waitcnt lgkmcnt(5)
    v_mfma_f32_16x16x32_bf16 v[60:63], v[236:239], v[124:127], 0
    ds_read_b128 v[172:175], v26 offset:4096
    s_waitcnt lgkmcnt(5)
    v_mfma_f32_16x16x32_bf16 v[64:67], v[236:239], v[128:131], 0
    v_mfma_f32_16x16x32_bf16 v[36:39], v[68:71], v[100:103], v[36:39]
    ds_read_b128 v[176:179], v26 offset:6144
    v_mfma_f32_16x16x32_bf16 v[40:43], v[68:71], v[104:107], v[40:43]
    v_mfma_f32_16x16x32_bf16 v[44:47], v[68:71], v[108:111], v[44:47]
    ds_read_b128 v[180:183], v26 offset:8192
    v_mfma_f32_16x16x32_bf16 v[48:51], v[68:71], v[112:115], v[48:51]
    ds_read_b128 v[184:187], v26 offset:10240
    v_mfma_f32_16x16x32_bf16 v[52:55], v[68:71], v[116:119], v[52:55]
    v_mfma_f32_16x16x32_bf16 v[56:59], v[68:71], v[120:123], v[56:59]
    ds_read_b128 v[188:191], v26 offset:12288
    v_mfma_f32_16x16x32_bf16 v[60:63], v[68:71], v[124:127], v[60:63]
    v_mfma_f32_16x16x32_bf16 v[64:67], v[68:71], v[128:131], v[64:67]
    ds_read_b128 v[192:195], v26 offset:14336
    v_mfma_f32_16x16x32_bf16 v[40:43], v[72:75], v[100:103], v[40:43]
    ds_read2_b32 v[136:137], v21 offset0:144 offset1:145
    v_mfma_f32_16x16x32_bf16 v[44:47], v[72:75], v[104:107], v[44:47]
    v_mfma_f32_16x16x32_bf16 v[48:51], v[72:75], v[108:111], v[48:51]
    ds_read2_b32 v[138:139], v21 offset0:146 offset1:147
    v_mfma_f32_16x16x32_bf16 v[52:55], v[72:75], v[112:115], v[52:55]
    v_mfma_f32_16x16x32_bf16 v[56:59], v[72:75], v[116:119], v[56:59]
    ds_read2_b32 v[140:141], v22 offset0:16 offset1:17
    v_mfma_f32_16x16x32_bf16 v[60:63], v[72:75], v[120:123], v[60:63]
    ds_read2_b32 v[142:143], v22 offset0:18 offset1:19
    v_mfma_f32_16x16x32_bf16 v[64:67], v[72:75], v[124:127], v[64:67]
    v_mfma_f32_16x16x32_bf16 v[44:47], v[76:79], v[100:103], v[44:47]
    ds_read2_b32 v[144:145], v22 offset0:144 offset1:145
    v_mfma_f32_16x16x32_bf16 v[48:51], v[76:79], v[104:107], v[48:51]
    v_mfma_f32_16x16x32_bf16 v[52:55], v[76:79], v[108:111], v[52:55]
    ds_read2_b32 v[146:147], v22 offset0:146 offset1:147
    v_mfma_f32_16x16x32_bf16 v[56:59], v[76:79], v[112:115], v[56:59]
    ds_read2_b32 v[148:149], v23 offset0:16 offset1:17
    v_mfma_f32_16x16x32_bf16 v[60:63], v[76:79], v[116:119], v[60:63]
    v_mfma_f32_16x16x32_bf16 v[64:67], v[76:79], v[120:123], v[64:67]
    ds_read2_b32 v[150:151], v23 offset0:18 offset1:19
    v_mfma_f32_16x16x32_bf16 v[48:51], v[80:83], v[100:103], v[48:51]
    v_mfma_f32_16x16x32_bf16 v[52:55], v[80:83], v[104:107], v[52:55]
    ds_read2_b32 v[152:153], v23 offset0:144 offset1:145
    v_mfma_f32_16x16x32_bf16 v[56:59], v[80:83], v[108:111], v[56:59]
    ds_read2_b32 v[154:155], v23 offset0:146 offset1:147
    v_mfma_f32_16x16x32_bf16 v[60:63], v[80:83], v[112:115], v[60:63]
    v_mfma_f32_16x16x32_bf16 v[64:67], v[80:83], v[116:119], v[64:67]
    ds_read2_b32 v[156:157], v24 offset0:16 offset1:17
    v_mfma_f32_16x16x32_bf16 v[52:55], v[84:87], v[100:103], v[52:55]
    v_mfma_f32_16x16x32_bf16 v[56:59], v[84:87], v[104:107], v[56:59]
    ds_read2_b32 v[158:159], v24 offset0:18 offset1:19
    v_mfma_f32_16x16x32_bf16 v[60:63], v[84:87], v[108:111], v[60:63]
    ds_read2_b32 v[160:161], v24 offset0:144 offset1:145
    v_mfma_f32_16x16x32_bf16 v[64:67], v[84:87], v[112:115], v[64:67]
    v_mfma_f32_16x16x32_bf16 v[56:59], v[88:91], v[100:103], v[56:59]
    ds_read2_b32 v[162:163], v24 offset0:146 offset1:147
    v_mfma_f32_16x16x32_bf16 v[60:63], v[88:91], v[104:107], v[60:63]
    v_mfma_f32_16x16x32_bf16 v[64:67], v[88:91], v[108:111], v[64:67]
    v_mfma_f32_16x16x32_bf16 v[60:63], v[92:95], v[100:103], v[60:63]
    v_mfma_f32_16x16x32_bf16 v[64:67], v[92:95], v[104:107], v[64:67]
    v_mfma_f32_16x16x32_bf16 v[64:67], v[96:99], v[100:103], v[64:67]
    s_waitcnt lgkmcnt(14)
    v_mfma_f32_16x16x32_bf16 v[36:39], v[132:135], v[164:167], v[36:39]
    ds_read2_b32 v[68:69], v21 offset0:32 offset1:33
    v_mfma_f32_16x16x32_bf16 v[40:43], v[132:135], v[168:171], v[40:43]
    ds_read2_b32 v[70:71], v21 offset0:34 offset1:35
    v_mfma_f32_16x16x32_bf16 v[44:47], v[132:135], v[172:175], v[44:47]
    ds_read_b128 v[100:103], v27 offset:0
    v_mfma_f32_16x16x32_bf16 v[48:51], v[132:135], v[176:179], v[48:51]
    v_mfma_f32_16x16x32_bf16 v[52:55], v[132:135], v[180:183], v[52:55]
    ds_read_b128 v[104:107], v27 offset:2048
    v_mfma_f32_16x16x32_bf16 v[56:59], v[132:135], v[184:187], v[56:59]
    ds_read_b128 v[108:111], v27 offset:4096
    v_mfma_f32_16x16x32_bf16 v[60:63], v[132:135], v[188:191], v[60:63]
    ds_read_b128 v[112:115], v27 offset:6144
    v_mfma_f32_16x16x32_bf16 v[64:67], v[132:135], v[192:195], v[64:67]
    s_waitcnt lgkmcnt(14)
    v_mfma_f32_16x16x32_bf16 v[40:43], v[136:139], v[164:167], v[40:43]
    ds_read_b128 v[116:119], v27 offset:8192
    v_mfma_f32_16x16x32_bf16 v[44:47], v[136:139], v[168:171], v[44:47]
    ds_read_b128 v[120:123], v27 offset:10240
    v_mfma_f32_16x16x32_bf16 v[48:51], v[136:139], v[172:175], v[48:51]
    ds_read_b128 v[124:127], v27 offset:12288
    v_mfma_f32_16x16x32_bf16 v[52:55], v[136:139], v[176:179], v[52:55]
    v_mfma_f32_16x16x32_bf16 v[56:59], v[136:139], v[180:183], v[56:59]
    ds_read_b128 v[128:131], v27 offset:14336
    v_mfma_f32_16x16x32_bf16 v[60:63], v[136:139], v[184:187], v[60:63]
    ds_read2_b32 v[72:73], v21 offset0:160 offset1:161
    v_mfma_f32_16x16x32_bf16 v[64:67], v[136:139], v[188:191], v[64:67]
    ds_read2_b32 v[74:75], v21 offset0:162 offset1:163
    v_mfma_f32_16x16x32_bf16 v[44:47], v[140:143], v[164:167], v[44:47]
    v_mfma_f32_16x16x32_bf16 v[48:51], v[140:143], v[168:171], v[48:51]
    ds_read2_b32 v[76:77], v22 offset0:32 offset1:33
    v_mfma_f32_16x16x32_bf16 v[52:55], v[140:143], v[172:175], v[52:55]
    ds_read2_b32 v[78:79], v22 offset0:34 offset1:35
    v_mfma_f32_16x16x32_bf16 v[56:59], v[140:143], v[176:179], v[56:59]
    ds_read2_b32 v[80:81], v22 offset0:160 offset1:161
    v_mfma_f32_16x16x32_bf16 v[60:63], v[140:143], v[180:183], v[60:63]
    v_mfma_f32_16x16x32_bf16 v[64:67], v[140:143], v[184:187], v[64:67]
    ds_read2_b32 v[82:83], v22 offset0:162 offset1:163
    v_mfma_f32_16x16x32_bf16 v[48:51], v[144:147], v[164:167], v[48:51]
    ds_read2_b32 v[84:85], v23 offset0:32 offset1:33
    v_mfma_f32_16x16x32_bf16 v[52:55], v[144:147], v[168:171], v[52:55]
    ds_read2_b32 v[86:87], v23 offset0:34 offset1:35
    v_mfma_f32_16x16x32_bf16 v[56:59], v[144:147], v[172:175], v[56:59]
    v_mfma_f32_16x16x32_bf16 v[60:63], v[144:147], v[176:179], v[60:63]
    ds_read2_b32 v[88:89], v23 offset0:160 offset1:161
    v_mfma_f32_16x16x32_bf16 v[64:67], v[144:147], v[180:183], v[64:67]
    ds_read2_b32 v[90:91], v23 offset0:162 offset1:163
    s_waitcnt lgkmcnt(14)
    v_mfma_f32_16x16x32_bf16 v[52:55], v[148:151], v[164:167], v[52:55]
    ds_read2_b32 v[92:93], v24 offset0:32 offset1:33
    v_mfma_f32_16x16x32_bf16 v[56:59], v[148:151], v[168:171], v[56:59]
    v_mfma_f32_16x16x32_bf16 v[60:63], v[148:151], v[172:175], v[60:63]
    ds_read2_b32 v[94:95], v24 offset0:34 offset1:35
    v_mfma_f32_16x16x32_bf16 v[64:67], v[148:151], v[176:179], v[64:67]
    ds_read2_b32 v[96:97], v24 offset0:160 offset1:161
    v_mfma_f32_16x16x32_bf16 v[56:59], v[152:155], v[164:167], v[56:59]
    ds_read2_b32 v[98:99], v24 offset0:162 offset1:163
    v_mfma_f32_16x16x32_bf16 v[60:63], v[152:155], v[168:171], v[60:63]
    v_mfma_f32_16x16x32_bf16 v[64:67], v[152:155], v[172:175], v[64:67]
    v_mfma_f32_16x16x32_bf16 v[60:63], v[156:159], v[164:167], v[60:63]
    v_mfma_f32_16x16x32_bf16 v[64:67], v[156:159], v[168:171], v[64:67]
    v_mfma_f32_16x16x32_bf16 v[64:67], v[160:163], v[164:167], v[64:67]
    v_mfma_f32_16x16x32_bf16 v[36:39], v[68:71], v[100:103], v[36:39]
    ds_read2_b32 v[132:133], v21 offset0:48 offset1:49
    v_mfma_f32_16x16x32_bf16 v[40:43], v[68:71], v[104:107], v[40:43]
    ds_read2_b32 v[134:135], v21 offset0:50 offset1:51
    v_mfma_f32_16x16x32_bf16 v[44:47], v[68:71], v[108:111], v[44:47]
    ds_read_b128 v[164:167], v28 offset:0
    v_mfma_f32_16x16x32_bf16 v[48:51], v[68:71], v[112:115], v[48:51]
    s_waitcnt lgkmcnt(14)
    v_mfma_f32_16x16x32_bf16 v[52:55], v[68:71], v[116:119], v[52:55]
    ds_read_b128 v[168:171], v28 offset:2048
    v_mfma_f32_16x16x32_bf16 v[56:59], v[68:71], v[120:123], v[56:59]
    ds_read_b128 v[172:175], v28 offset:4096
    v_mfma_f32_16x16x32_bf16 v[60:63], v[68:71], v[124:127], v[60:63]
    ds_read_b128 v[176:179], v28 offset:6144
    v_mfma_f32_16x16x32_bf16 v[64:67], v[68:71], v[128:131], v[64:67]
    v_mfma_f32_16x16x32_bf16 v[40:43], v[72:75], v[100:103], v[40:43]
    ds_read_b128 v[180:183], v28 offset:8192
    v_mfma_f32_16x16x32_bf16 v[44:47], v[72:75], v[104:107], v[44:47]
    ds_read_b128 v[184:187], v28 offset:10240
    v_mfma_f32_16x16x32_bf16 v[48:51], v[72:75], v[108:111], v[48:51]
    ds_read_b128 v[188:191], v28 offset:12288
    v_mfma_f32_16x16x32_bf16 v[52:55], v[72:75], v[112:115], v[52:55]
    v_mfma_f32_16x16x32_bf16 v[56:59], v[72:75], v[116:119], v[56:59]
    ds_read_b128 v[192:195], v28 offset:14336
    v_mfma_f32_16x16x32_bf16 v[60:63], v[72:75], v[120:123], v[60:63]
    ds_read2_b32 v[136:137], v21 offset0:176 offset1:177
    v_mfma_f32_16x16x32_bf16 v[64:67], v[72:75], v[124:127], v[64:67]
    ds_read2_b32 v[138:139], v21 offset0:178 offset1:179
    s_waitcnt lgkmcnt(14)
    v_mfma_f32_16x16x32_bf16 v[44:47], v[76:79], v[100:103], v[44:47]
    v_mfma_f32_16x16x32_bf16 v[48:51], v[76:79], v[104:107], v[48:51]
    ds_read2_b32 v[140:141], v22 offset0:48 offset1:49
    v_mfma_f32_16x16x32_bf16 v[52:55], v[76:79], v[108:111], v[52:55]
    ds_read2_b32 v[142:143], v22 offset0:50 offset1:51
    v_mfma_f32_16x16x32_bf16 v[56:59], v[76:79], v[112:115], v[56:59]
    ds_read2_b32 v[144:145], v22 offset0:176 offset1:177
    v_mfma_f32_16x16x32_bf16 v[60:63], v[76:79], v[116:119], v[60:63]
    v_mfma_f32_16x16x32_bf16 v[64:67], v[76:79], v[120:123], v[64:67]
    ds_read2_b32 v[146:147], v22 offset0:178 offset1:179
    v_mfma_f32_16x16x32_bf16 v[48:51], v[80:83], v[100:103], v[48:51]
    ds_read2_b32 v[148:149], v23 offset0:48 offset1:49
    v_mfma_f32_16x16x32_bf16 v[52:55], v[80:83], v[104:107], v[52:55]
    ds_read2_b32 v[150:151], v23 offset0:50 offset1:51
    v_mfma_f32_16x16x32_bf16 v[56:59], v[80:83], v[108:111], v[56:59]
    v_mfma_f32_16x16x32_bf16 v[60:63], v[80:83], v[112:115], v[60:63]
    ds_read2_b32 v[152:153], v23 offset0:176 offset1:177
    v_mfma_f32_16x16x32_bf16 v[64:67], v[80:83], v[116:119], v[64:67]
    ds_read2_b32 v[154:155], v23 offset0:178 offset1:179
    v_mfma_f32_16x16x32_bf16 v[52:55], v[84:87], v[100:103], v[52:55]
    ds_read2_b32 v[156:157], v24 offset0:48 offset1:49
    v_mfma_f32_16x16x32_bf16 v[56:59], v[84:87], v[104:107], v[56:59]
    v_mfma_f32_16x16x32_bf16 v[60:63], v[84:87], v[108:111], v[60:63]
    ds_read2_b32 v[158:159], v24 offset0:50 offset1:51
    v_mfma_f32_16x16x32_bf16 v[64:67], v[84:87], v[112:115], v[64:67]
    ds_read2_b32 v[160:161], v24 offset0:176 offset1:177
    v_mfma_f32_16x16x32_bf16 v[56:59], v[88:91], v[100:103], v[56:59]
    ds_read2_b32 v[162:163], v24 offset0:178 offset1:179
    v_mfma_f32_16x16x32_bf16 v[60:63], v[88:91], v[104:107], v[60:63]
    v_mfma_f32_16x16x32_bf16 v[64:67], v[88:91], v[108:111], v[64:67]
    v_mfma_f32_16x16x32_bf16 v[60:63], v[92:95], v[100:103], v[60:63]
    v_mfma_f32_16x16x32_bf16 v[64:67], v[92:95], v[104:107], v[64:67]
    s_waitcnt lgkmcnt(14)
    v_mfma_f32_16x16x32_bf16 v[64:67], v[96:99], v[100:103], v[64:67]
    v_mfma_f32_16x16x32_bf16 v[36:39], v[132:135], v[164:167], v[36:39]
    ds_read2_b32 v[68:69], v21 offset0:64 offset1:65
    s_and_b32 s78, s77, 7
    v_mfma_f32_16x16x32_bf16 v[40:43], v[132:135], v[168:171], v[40:43]
    ds_read2_b32 v[70:71], v21 offset0:66 offset1:67
    s_mov_b32 s97, 0x76543210
    v_mfma_f32_16x16x32_bf16 v[44:47], v[132:135], v[172:175], v[44:47]
    ds_read_b128 v[100:103], v29 offset:0
    v_mfma_f32_16x16x32_bf16 v[48:51], v[132:135], v[176:179], v[48:51]
    s_cmp_eq_u32 s78, 1
    v_mfma_f32_16x16x32_bf16 v[52:55], v[132:135], v[180:183], v[52:55]
    ds_read_b128 v[104:107], v29 offset:2048
    s_cselect_b32 s97, 0x76543201, s97
    v_mfma_f32_16x16x32_bf16 v[56:59], v[132:135], v[184:187], v[56:59]
    ds_read_b128 v[108:111], v29 offset:4096
    v_mfma_f32_16x16x32_bf16 v[60:63], v[132:135], v[188:191], v[60:63]
    ds_read_b128 v[112:115], v29 offset:6144
    s_cmp_eq_u32 s78, 2
    v_mfma_f32_16x16x32_bf16 v[64:67], v[132:135], v[192:195], v[64:67]
    s_cselect_b32 s97, 0x76543120, s97
    s_waitcnt lgkmcnt(14)
    v_mfma_f32_16x16x32_bf16 v[40:43], v[136:139], v[164:167], v[40:43]
    ds_read_b128 v[116:119], v29 offset:8192
    v_mfma_f32_16x16x32_bf16 v[44:47], v[136:139], v[168:171], v[44:47]
    ds_read_b128 v[120:123], v29 offset:10240
    s_cmp_eq_u32 s78, 3
    v_mfma_f32_16x16x32_bf16 v[48:51], v[136:139], v[172:175], v[48:51]
    ds_read_b128 v[124:127], v29 offset:12288
    s_cselect_b32 s97, 0x76542310, s97
    v_mfma_f32_16x16x32_bf16 v[52:55], v[136:139], v[176:179], v[52:55]
    v_mfma_f32_16x16x32_bf16 v[56:59], v[136:139], v[180:183], v[56:59]
    ds_read_b128 v[128:131], v29 offset:14336
    s_cmp_eq_u32 s78, 4
    v_mfma_f32_16x16x32_bf16 v[60:63], v[136:139], v[184:187], v[60:63]
    ds_read2_b32 v[72:73], v21 offset0:192 offset1:193
    v_mfma_f32_16x16x32_bf16 v[64:67], v[136:139], v[188:191], v[64:67]
    ds_read2_b32 v[74:75], v21 offset0:194 offset1:195
    s_cselect_b32 s97, 0x76534210, s97
    v_mfma_f32_16x16x32_bf16 v[44:47], v[140:143], v[164:167], v[44:47]
    s_cmp_eq_u32 s78, 5
    v_mfma_f32_16x16x32_bf16 v[48:51], v[140:143], v[168:171], v[48:51]
    ds_read2_b32 v[76:77], v22 offset0:64 offset1:65
    v_mfma_f32_16x16x32_bf16 v[52:55], v[140:143], v[172:175], v[52:55]
    ds_read2_b32 v[78:79], v22 offset0:66 offset1:67
    s_cselect_b32 s97, 0x76453210, s97
    v_mfma_f32_16x16x32_bf16 v[56:59], v[140:143], v[176:179], v[56:59]
    ds_read2_b32 v[80:81], v22 offset0:192 offset1:193
    s_cmp_eq_u32 s78, 6
    v_mfma_f32_16x16x32_bf16 v[60:63], v[140:143], v[180:183], v[60:63]
    v_mfma_f32_16x16x32_bf16 v[64:67], v[140:143], v[184:187], v[64:67]
    ds_read2_b32 v[82:83], v22 offset0:194 offset1:195
    s_cselect_b32 s97, 0x75643210, s97
    v_mfma_f32_16x16x32_bf16 v[48:51], v[144:147], v[164:167], v[48:51]
    ds_read2_b32 v[84:85], v23 offset0:64 offset1:65
    s_cmp_eq_u32 s78, 7
    v_mfma_f32_16x16x32_bf16 v[52:55], v[144:147], v[168:171], v[52:55]
    ds_read2_b32 v[86:87], v23 offset0:66 offset1:67
    v_mfma_f32_16x16x32_bf16 v[56:59], v[144:147], v[172:175], v[56:59]
    s_cselect_b32 s97, 0x67543210, s97
    v_mfma_f32_16x16x32_bf16 v[60:63], v[144:147], v[176:179], v[60:63]
    ds_read2_b32 v[88:89], v23 offset0:192 offset1:193
    v_mfma_f32_16x16x32_bf16 v[64:67], v[144:147], v[180:183], v[64:67]
    ds_read2_b32 v[90:91], v23 offset0:194 offset1:195
    s_and_b32 s78, s76, 3
    s_waitcnt lgkmcnt(14)
    v_mfma_f32_16x16x32_bf16 v[52:55], v[148:151], v[164:167], v[52:55]
    ds_read2_b32 v[92:93], v24 offset0:64 offset1:65
    s_mul_i32 s78, s78, 0x22222222
    v_mfma_f32_16x16x32_bf16 v[56:59], v[148:151], v[168:171], v[56:59]
    v_mfma_f32_16x16x32_bf16 v[60:63], v[148:151], v[172:175], v[60:63]
    ds_read2_b32 v[94:95], v24 offset0:66 offset1:67
    s_add_u32 s97, s97, s78
    v_mfma_f32_16x16x32_bf16 v[64:67], v[148:151], v[176:179], v[64:67]
    ds_read2_b32 v[96:97], v24 offset0:192 offset1:193
    s_bfe_u32 s99, s97, 0x3001c
    v_mfma_f32_16x16x32_bf16 v[56:59], v[152:155], v[164:167], v[56:59]
    ds_read2_b32 v[98:99], v24 offset0:194 offset1:195
    v_mfma_f32_16x16x32_bf16 v[60:63], v[152:155], v[168:171], v[60:63]
    s_lshl_b32 s99, s99, 18
    v_mfma_f32_16x16x32_bf16 v[64:67], v[152:155], v[172:175], v[64:67]
    s_bfe_u32 s97, s97, 0x30018
    v_mfma_f32_16x16x32_bf16 v[60:63], v[156:159], v[164:167], v[60:63]
    v_mfma_f32_16x16x32_bf16 v[64:67], v[156:159], v[168:171], v[64:67]
    s_lshl_b32 s97, s97, 18
    v_mfma_f32_16x16x32_bf16 v[64:67], v[160:163], v[164:167], v[64:67]
    v_mfma_f32_16x16x32_bf16 v[36:39], v[68:71], v[100:103], v[36:39]
    ds_read2_b32 v[132:133], v21 offset0:80 offset1:81
    v_lshrrev_b32 v5, 4, v0
    v_mfma_f32_16x16x32_bf16 v[40:43], v[68:71], v[104:107], v[40:43]
    ds_read2_b32 v[134:135], v21 offset0:82 offset1:83
    v_mfma_f32_16x16x32_bf16 v[44:47], v[68:71], v[108:111], v[44:47]
    ds_read_b128 v[164:167], v30 offset:0
    v_mfma_f32_16x16x32_bf16 v[48:51], v[68:71], v[112:115], v[48:51]
    v_lshlrev_b32 v5, 1, v5
    s_waitcnt lgkmcnt(14)
    v_mfma_f32_16x16x32_bf16 v[52:55], v[68:71], v[116:119], v[52:55]
    ds_read_b128 v[168:171], v30 offset:2048
    v_mfma_f32_16x16x32_bf16 v[56:59], v[68:71], v[120:123], v[56:59]
    ds_read_b128 v[172:175], v30 offset:4096
    v_mfma_f32_16x16x32_bf16 v[60:63], v[68:71], v[124:127], v[60:63]
    ds_read_b128 v[176:179], v30 offset:6144
    v_and_b32 v8, 7, v0
    v_mfma_f32_16x16x32_bf16 v[64:67], v[68:71], v[128:131], v[64:67]
    v_mfma_f32_16x16x32_bf16 v[40:43], v[72:75], v[100:103], v[40:43]
    ds_read_b128 v[180:183], v30 offset:8192
    v_mfma_f32_16x16x32_bf16 v[44:47], v[72:75], v[104:107], v[44:47]
    ds_read_b128 v[184:187], v30 offset:10240
    v_xor_b32 v5, v5, v8
    v_mfma_f32_16x16x32_bf16 v[48:51], v[72:75], v[108:111], v[48:51]
    ds_read_b128 v[188:191], v30 offset:12288
    v_mfma_f32_16x16x32_bf16 v[52:55], v[72:75], v[112:115], v[52:55]
    v_mfma_f32_16x16x32_bf16 v[56:59], v[72:75], v[116:119], v[56:59]
    ds_read_b128 v[192:195], v30 offset:14336
    v_mfma_f32_16x16x32_bf16 v[60:63], v[72:75], v[120:123], v[60:63]
    ds_read2_b32 v[136:137], v21 offset0:208 offset1:209
    v_lshlrev_b32 v5, 4, v5
    v_mfma_f32_16x16x32_bf16 v[64:67], v[72:75], v[124:127], v[64:67]
    ds_read2_b32 v[138:139], v21 offset0:210 offset1:211
    s_waitcnt lgkmcnt(14)
    v_mfma_f32_16x16x32_bf16 v[44:47], v[76:79], v[100:103], v[44:47]
    v_mfma_f32_16x16x32_bf16 v[48:51], v[76:79], v[104:107], v[48:51]
    ds_read2_b32 v[140:141], v22 offset0:80 offset1:81
    v_lshrrev_b32 v8, 3, v0
    v_mfma_f32_16x16x32_bf16 v[52:55], v[76:79], v[108:111], v[52:55]
    ds_read2_b32 v[142:143], v22 offset0:82 offset1:83
    v_mfma_f32_16x16x32_bf16 v[56:59], v[76:79], v[112:115], v[56:59]
    ds_read2_b32 v[144:145], v22 offset0:208 offset1:209
    v_mfma_f32_16x16x32_bf16 v[60:63], v[76:79], v[116:119], v[60:63]
    v_lshl_add_u32 v5, v8, 11, v5
    v_mfma_f32_16x16x32_bf16 v[64:67], v[76:79], v[120:123], v[64:67]
    ds_read2_b32 v[146:147], v22 offset0:210 offset1:211
    v_mfma_f32_16x16x32_bf16 v[48:51], v[80:83], v[100:103], v[48:51]
    ds_read2_b32 v[148:149], v23 offset0:80 offset1:81
    v_mfma_f32_16x16x32_bf16 v[52:55], v[80:83], v[104:107], v[52:55]
    ds_read2_b32 v[150:151], v23 offset0:82 offset1:83
    s_lshl_b32 s78, s77, 7
    v_mfma_f32_16x16x32_bf16 v[56:59], v[80:83], v[108:111], v[56:59]
    v_mfma_f32_16x16x32_bf16 v[60:63], v[80:83], v[112:115], v[60:63]
    ds_read2_b32 v[152:153], v23 offset0:208 offset1:209
    v_mfma_f32_16x16x32_bf16 v[64:67], v[80:83], v[116:119], v[64:67]
    ds_read2_b32 v[154:155], v23 offset0:210 offset1:211
    v_mfma_f32_16x16x32_bf16 v[52:55], v[84:87], v[100:103], v[52:55]
    ds_read2_b32 v[156:157], v24 offset0:80 offset1:81
    s_lshl_b32 s79, s3, 14
    v_mfma_f32_16x16x32_bf16 v[56:59], v[84:87], v[104:107], v[56:59]
    v_mfma_f32_16x16x32_bf16 v[60:63], v[84:87], v[108:111], v[60:63]
    ds_read2_b32 v[158:159], v24 offset0:82 offset1:83
    v_mfma_f32_16x16x32_bf16 v[64:67], v[84:87], v[112:115], v[64:67]
    ds_read2_b32 v[160:161], v24 offset0:208 offset1:209
    s_add_u32 s78, s78, s79
    v_mfma_f32_16x16x32_bf16 v[56:59], v[88:91], v[100:103], v[56:59]
    ds_read2_b32 v[162:163], v24 offset0:210 offset1:211
    v_mfma_f32_16x16x32_bf16 v[60:63], v[88:91], v[104:107], v[60:63]
    v_mfma_f32_16x16x32_bf16 v[64:67], v[88:91], v[108:111], v[64:67]
    v_add_u32 v17, s78, v5
    v_mfma_f32_16x16x32_bf16 v[60:63], v[92:95], v[100:103], v[60:63]
    v_mfma_f32_16x16x32_bf16 v[64:67], v[92:95], v[104:107], v[64:67]
    s_waitcnt lgkmcnt(14)
    v_mfma_f32_16x16x32_bf16 v[64:67], v[96:99], v[100:103], v[64:67]
    v_mfma_f32_16x16x32_bf16 v[36:39], v[132:135], v[164:167], v[36:39]
    ds_read2_b32 v[68:69], v21 offset0:96 offset1:97
    s_waitcnt vmcnt(3)
    v_lshlrev_b32 v196, 16, v212
    v_mfma_f32_16x16x32_bf16 v[40:43], v[132:135], v[168:171], v[40:43]
    ds_read2_b32 v[70:71], v21 offset0:98 offset1:99
    v_mfma_f32_16x16x32_bf16 v[44:47], v[132:135], v[172:175], v[44:47]
    ds_read_b128 v[100:103], v31 offset:0
    v_and_b32 v197, 0xffff0000, v212
    v_mfma_f32_16x16x32_bf16 v[48:51], v[132:135], v[176:179], v[48:51]
    v_mfma_f32_16x16x32_bf16 v[52:55], v[132:135], v[180:183], v[52:55]
    ds_read_b128 v[104:107], v31 offset:2048
    v_lshlrev_b32 v198, 16, v213
    v_mfma_f32_16x16x32_bf16 v[56:59], v[132:135], v[184:187], v[56:59]
    ds_read_b128 v[108:111], v31 offset:4096
    v_mfma_f32_16x16x32_bf16 v[60:63], v[132:135], v[188:191], v[60:63]
    ds_read_b128 v[112:115], v31 offset:6144
    v_and_b32 v199, 0xffff0000, v213
    v_mfma_f32_16x16x32_bf16 v[64:67], v[132:135], v[192:195], v[64:67]
    s_waitcnt lgkmcnt(14)
    v_mfma_f32_16x16x32_bf16 v[40:43], v[136:139], v[164:167], v[40:43]
    ds_read_b128 v[116:119], v31 offset:8192
    v_mfma_f32_16x16x32_bf16 v[44:47], v[136:139], v[168:171], v[44:47]
    ds_read_b128 v[120:123], v31 offset:10240
    v_lshlrev_b32 v200, 16, v214
    v_mfma_f32_16x16x32_bf16 v[48:51], v[136:139], v[172:175], v[48:51]
    ds_read_b128 v[124:127], v31 offset:12288
    v_mfma_f32_16x16x32_bf16 v[52:55], v[136:139], v[176:179], v[52:55]
    v_and_b32 v201, 0xffff0000, v214
    v_mfma_f32_16x16x32_bf16 v[56:59], v[136:139], v[180:183], v[56:59]
    ds_read_b128 v[128:131], v31 offset:14336
    v_mfma_f32_16x16x32_bf16 v[60:63], v[136:139], v[184:187], v[60:63]
    ds_read2_b32 v[72:73], v21 offset0:224 offset1:225
    v_lshlrev_b32 v202, 16, v215
    v_mfma_f32_16x16x32_bf16 v[64:67], v[136:139], v[188:191], v[64:67]
    ds_read2_b32 v[74:75], v21 offset0:226 offset1:227
    v_mfma_f32_16x16x32_bf16 v[44:47], v[140:143], v[164:167], v[44:47]
    v_and_b32 v203, 0xffff0000, v215
    v_mfma_f32_16x16x32_bf16 v[48:51], v[140:143], v[168:171], v[48:51]
    ds_read2_b32 v[76:77], v22 offset0:96 offset1:97
    v_mfma_f32_16x16x32_bf16 v[52:55], v[140:143], v[172:175], v[52:55]
    ds_read2_b32 v[78:79], v22 offset0:98 offset1:99
    v_mfma_f32_16x16x32_bf16 v[56:59], v[140:143], v[176:179], v[56:59]
    ds_read2_b32 v[80:81], v22 offset0:224 offset1:225
    s_waitcnt vmcnt(2)
    v_lshlrev_b32 v204, 16, v216
    v_mfma_f32_16x16x32_bf16 v[60:63], v[140:143], v[180:183], v[60:63]
    v_mfma_f32_16x16x32_bf16 v[64:67], v[140:143], v[184:187], v[64:67]
    ds_read2_b32 v[82:83], v22 offset0:226 offset1:227
    v_and_b32 v205, 0xffff0000, v216
    v_mfma_f32_16x16x32_bf16 v[48:51], v[144:147], v[164:167], v[48:51]
    ds_read2_b32 v[84:85], v23 offset0:96 offset1:97
    v_mfma_f32_16x16x32_bf16 v[52:55], v[144:147], v[168:171], v[52:55]
    ds_read2_b32 v[86:87], v23 offset0:98 offset1:99
    v_lshlrev_b32 v206, 16, v217
    v_mfma_f32_16x16x32_bf16 v[56:59], v[144:147], v[172:175], v[56:59]
    v_mfma_f32_16x16x32_bf16 v[60:63], v[144:147], v[176:179], v[60:63]
    ds_read2_b32 v[88:89], v23 offset0:224 offset1:225
    v_and_b32 v207, 0xffff0000, v217
    v_mfma_f32_16x16x32_bf16 v[64:67], v[144:147], v[180:183], v[64:67]
    ds_read2_b32 v[90:91], v23 offset0:226 offset1:227
    s_waitcnt lgkmcnt(14)
    v_mfma_f32_16x16x32_bf16 v[52:55], v[148:151], v[164:167], v[52:55]
    ds_read2_b32 v[92:93], v24 offset0:96 offset1:97
    v_mfma_f32_16x16x32_bf16 v[56:59], v[148:151], v[168:171], v[56:59]
    v_lshlrev_b32 v208, 16, v218
    v_mfma_f32_16x16x32_bf16 v[60:63], v[148:151], v[172:175], v[60:63]
    ds_read2_b32 v[94:95], v24 offset0:98 offset1:99
    v_mfma_f32_16x16x32_bf16 v[64:67], v[148:151], v[176:179], v[64:67]
    ds_read2_b32 v[96:97], v24 offset0:224 offset1:225
    v_and_b32 v209, 0xffff0000, v218
    v_mfma_f32_16x16x32_bf16 v[56:59], v[152:155], v[164:167], v[56:59]
    ds_read2_b32 v[98:99], v24 offset0:226 offset1:227
    v_mfma_f32_16x16x32_bf16 v[60:63], v[152:155], v[168:171], v[60:63]
    v_lshlrev_b32 v210, 16, v219
    v_mfma_f32_16x16x32_bf16 v[64:67], v[152:155], v[172:175], v[64:67]
    v_mfma_f32_16x16x32_bf16 v[60:63], v[156:159], v[164:167], v[60:63]
    v_and_b32 v211, 0xffff0000, v219
    v_mfma_f32_16x16x32_bf16 v[64:67], v[156:159], v[168:171], v[64:67]
    v_mfma_f32_16x16x32_bf16 v[64:67], v[160:163], v[164:167], v[64:67]
    v_mfma_f32_16x16x32_bf16 v[36:39], v[68:71], v[100:103], v[36:39]
    ds_read2_b32 v[132:133], v21 offset0:112 offset1:113
    s_waitcnt vmcnt(1)
    v_lshlrev_b32 v240, 16, v220
    v_mfma_f32_16x16x32_bf16 v[40:43], v[68:71], v[104:107], v[40:43]
    ds_read2_b32 v[134:135], v21 offset0:114 offset1:115
    v_mfma_f32_16x16x32_bf16 v[44:47], v[68:71], v[108:111], v[44:47]
    ds_read_b128 v[164:167], v32 offset:0
    v_and_b32 v241, 0xffff0000, v220
    v_mfma_f32_16x16x32_bf16 v[48:51], v[68:71], v[112:115], v[48:51]
    s_waitcnt lgkmcnt(14)
    v_mfma_f32_16x16x32_bf16 v[52:55], v[68:71], v[116:119], v[52:55]
    ds_read_b128 v[168:171], v32 offset:2048
    v_lshlrev_b32 v242, 16, v221
    v_mfma_f32_16x16x32_bf16 v[56:59], v[68:71], v[120:123], v[56:59]
    ds_read_b128 v[172:175], v32 offset:4096
    v_mfma_f32_16x16x32_bf16 v[60:63], v[68:71], v[124:127], v[60:63]
    ds_read_b128 v[176:179], v32 offset:6144
    v_and_b32 v243, 0xffff0000, v221
    v_mfma_f32_16x16x32_bf16 v[64:67], v[68:71], v[128:131], v[64:67]
    v_mfma_f32_16x16x32_bf16 v[40:43], v[72:75], v[100:103], v[40:43]
    ds_read_b128 v[180:183], v32 offset:8192
    v_mfma_f32_16x16x32_bf16 v[44:47], v[72:75], v[104:107], v[44:47]
    ds_read_b128 v[184:187], v32 offset:10240
    v_lshlrev_b32 v244, 16, v222
    v_mfma_f32_16x16x32_bf16 v[48:51], v[72:75], v[108:111], v[48:51]
    ds_read_b128 v[188:191], v32 offset:12288
    v_mfma_f32_16x16x32_bf16 v[52:55], v[72:75], v[112:115], v[52:55]
    v_and_b32 v245, 0xffff0000, v222
    v_mfma_f32_16x16x32_bf16 v[56:59], v[72:75], v[116:119], v[56:59]
    ds_read_b128 v[192:195], v32 offset:14336
    v_mfma_f32_16x16x32_bf16 v[60:63], v[72:75], v[120:123], v[60:63]
    ds_read2_b32 v[136:137], v21 offset0:240 offset1:241
    v_lshlrev_b32 v246, 16, v223
    v_mfma_f32_16x16x32_bf16 v[64:67], v[72:75], v[124:127], v[64:67]
    ds_read2_b32 v[138:139], v21 offset0:242 offset1:243
    s_waitcnt lgkmcnt(14)
    v_mfma_f32_16x16x32_bf16 v[44:47], v[76:79], v[100:103], v[44:47]
    v_and_b32 v247, 0xffff0000, v223
    v_mfma_f32_16x16x32_bf16 v[48:51], v[76:79], v[104:107], v[48:51]
    ds_read2_b32 v[140:141], v22 offset0:112 offset1:113
    v_mfma_f32_16x16x32_bf16 v[52:55], v[76:79], v[108:111], v[52:55]
    ds_read2_b32 v[142:143], v22 offset0:114 offset1:115
    v_mfma_f32_16x16x32_bf16 v[56:59], v[76:79], v[112:115], v[56:59]
    ds_read2_b32 v[144:145], v22 offset0:240 offset1:241
    s_waitcnt vmcnt(0)
    v_lshlrev_b32 v248, 16, v224
    v_mfma_f32_16x16x32_bf16 v[60:63], v[76:79], v[116:119], v[60:63]
    v_mfma_f32_16x16x32_bf16 v[64:67], v[76:79], v[120:123], v[64:67]
    ds_read2_b32 v[146:147], v22 offset0:242 offset1:243
    v_and_b32 v249, 0xffff0000, v224
    v_mfma_f32_16x16x32_bf16 v[48:51], v[80:83], v[100:103], v[48:51]
    ds_read2_b32 v[148:149], v23 offset0:112 offset1:113
    v_mfma_f32_16x16x32_bf16 v[52:55], v[80:83], v[104:107], v[52:55]
    ds_read2_b32 v[150:151], v23 offset0:114 offset1:115
    v_lshlrev_b32 v250, 16, v225
    v_mfma_f32_16x16x32_bf16 v[56:59], v[80:83], v[108:111], v[56:59]
    v_mfma_f32_16x16x32_bf16 v[60:63], v[80:83], v[112:115], v[60:63]
    ds_read2_b32 v[152:153], v23 offset0:240 offset1:241
    v_and_b32 v251, 0xffff0000, v225
    v_mfma_f32_16x16x32_bf16 v[64:67], v[80:83], v[116:119], v[64:67]
    ds_read2_b32 v[154:155], v23 offset0:242 offset1:243
    v_mfma_f32_16x16x32_bf16 v[52:55], v[84:87], v[100:103], v[52:55]
    ds_read2_b32 v[156:157], v24 offset0:112 offset1:113
    v_mfma_f32_16x16x32_bf16 v[56:59], v[84:87], v[104:107], v[56:59]
    v_lshlrev_b32 v252, 16, v226
    v_mfma_f32_16x16x32_bf16 v[60:63], v[84:87], v[108:111], v[60:63]
    ds_read2_b32 v[158:159], v24 offset0:114 offset1:115
    v_mfma_f32_16x16x32_bf16 v[64:67], v[84:87], v[112:115], v[64:67]
    ds_read2_b32 v[160:161], v24 offset0:240 offset1:241
    v_and_b32 v253, 0xffff0000, v226
    v_mfma_f32_16x16x32_bf16 v[56:59], v[88:91], v[100:103], v[56:59]
    ds_read2_b32 v[162:163], v24 offset0:242 offset1:243
    v_mfma_f32_16x16x32_bf16 v[60:63], v[88:91], v[104:107], v[60:63]
    v_lshlrev_b32 v254, 16, v227
    v_mfma_f32_16x16x32_bf16 v[64:67], v[88:91], v[108:111], v[64:67]
    v_mfma_f32_16x16x32_bf16 v[60:63], v[92:95], v[100:103], v[60:63]
    v_and_b32 v255, 0xffff0000, v227
    v_mfma_f32_16x16x32_bf16 v[64:67], v[92:95], v[104:107], v[64:67]
    s_waitcnt lgkmcnt(14)
    v_mfma_f32_16x16x32_bf16 v[64:67], v[96:99], v[100:103], v[64:67]
    v_mfma_f32_16x16x32_bf16 v[36:39], v[132:135], v[164:167], v[36:39]
    v_mfma_f32_16x16x32_bf16 v[40:43], v[132:135], v[168:171], v[40:43]
    v_mfma_f32_16x16x32_bf16 v[44:47], v[132:135], v[172:175], v[44:47]
    v_mfma_f32_16x16x32_bf16 v[48:51], v[132:135], v[176:179], v[48:51]
    v_mfma_f32_16x16x32_bf16 v[52:55], v[132:135], v[180:183], v[52:55]
    v_mfma_f32_16x16x32_bf16 v[56:59], v[132:135], v[184:187], v[56:59]
    v_mfma_f32_16x16x32_bf16 v[60:63], v[132:135], v[188:191], v[60:63]
    v_mfma_f32_16x16x32_bf16 v[64:67], v[132:135], v[192:195], v[64:67]
    s_waitcnt lgkmcnt(12)
    v_mfma_f32_16x16x32_bf16 v[40:43], v[136:139], v[164:167], v[40:43]
    v_cvt_pk_bf16_f32 v68, v39, v38
    v_cvt_pk_bf16_f32 v69, v37, v36
    v_mfma_f32_16x16x32_bf16 v[44:47], v[136:139], v[168:171], v[44:47]
    ds_write_b64 v20, v[68:69] offset:0
    v_mfma_f32_16x16x32_bf16 v[48:51], v[136:139], v[172:175], v[48:51]
    v_mfma_f32_16x16x32_bf16 v[52:55], v[136:139], v[176:179], v[52:55]
    v_mfma_f32_16x16x32_bf16 v[56:59], v[136:139], v[180:183], v[56:59]
    v_mfma_f32_16x16x32_bf16 v[60:63], v[136:139], v[184:187], v[60:63]
    v_mfma_f32_16x16x32_bf16 v[64:67], v[136:139], v[188:191], v[64:67]
    s_waitcnt lgkmcnt(11)
    v_mfma_f32_16x16x32_bf16 v[44:47], v[140:143], v[164:167], v[44:47]
    v_mfma_f32_16x16x32_bf16 v[48:51], v[140:143], v[168:171], v[48:51]
    v_cvt_pk_bf16_f32 v70, v43, v42
    v_cvt_pk_bf16_f32 v71, v41, v40
    v_mfma_f32_16x16x32_bf16 v[52:55], v[140:143], v[172:175], v[52:55]
    ds_write_b64 v20, v[70:71] offset:2048
    v_mfma_f32_16x16x32_bf16 v[56:59], v[140:143], v[176:179], v[56:59]
    v_mfma_f32_16x16x32_bf16 v[60:63], v[140:143], v[180:183], v[60:63]
    v_mfma_f32_16x16x32_bf16 v[64:67], v[140:143], v[184:187], v[64:67]
    s_waitcnt lgkmcnt(10)
    v_mfma_f32_16x16x32_bf16 v[48:51], v[144:147], v[164:167], v[48:51]
    v_mfma_f32_16x16x32_bf16 v[52:55], v[144:147], v[168:171], v[52:55]
    v_mfma_f32_16x16x32_bf16 v[56:59], v[144:147], v[172:175], v[56:59]
    v_cvt_pk_bf16_f32 v72, v47, v46
    v_cvt_pk_bf16_f32 v73, v45, v44
    v_mfma_f32_16x16x32_bf16 v[60:63], v[144:147], v[176:179], v[60:63]
    ds_write_b64 v20, v[72:73] offset:4096
    v_mfma_f32_16x16x32_bf16 v[64:67], v[144:147], v[180:183], v[64:67]
    s_waitcnt lgkmcnt(9)
    v_mfma_f32_16x16x32_bf16 v[52:55], v[148:151], v[164:167], v[52:55]
    v_mfma_f32_16x16x32_bf16 v[56:59], v[148:151], v[168:171], v[56:59]
    v_mfma_f32_16x16x32_bf16 v[60:63], v[148:151], v[172:175], v[60:63]
    v_mfma_f32_16x16x32_bf16 v[64:67], v[148:151], v[176:179], v[64:67]
    v_cvt_pk_bf16_f32 v74, v51, v50
    v_cvt_pk_bf16_f32 v75, v49, v48
    s_waitcnt lgkmcnt(7)
    v_mfma_f32_16x16x32_bf16 v[56:59], v[152:155], v[164:167], v[56:59]
    ds_write_b64 v20, v[74:75] offset:6144
    v_mfma_f32_16x16x32_bf16 v[60:63], v[152:155], v[168:171], v[60:63]
    v_mfma_f32_16x16x32_bf16 v[64:67], v[152:155], v[172:175], v[64:67]
    s_waitcnt lgkmcnt(6)
    v_mfma_f32_16x16x32_bf16 v[60:63], v[156:159], v[164:167], v[60:63]
    v_mfma_f32_16x16x32_bf16 v[64:67], v[156:159], v[168:171], v[64:67]
    v_cvt_pk_bf16_f32 v76, v55, v54
    v_cvt_pk_bf16_f32 v77, v53, v52
    s_waitcnt lgkmcnt(4)
    v_mfma_f32_16x16x32_bf16 v[64:67], v[160:163], v[164:167], v[64:67]
    ds_write_b64 v20, v[76:77] offset:8192
    v_cvt_pk_bf16_f32 v78, v59, v58
    v_cvt_pk_bf16_f32 v79, v57, v56
    ds_write_b64 v20, v[78:79] offset:10240
    v_cvt_pk_bf16_f32 v80, v63, v62
    v_cvt_pk_bf16_f32 v81, v61, v60
    ds_write_b64 v20, v[80:81] offset:12288
    s_nop 0
    v_cvt_pk_bf16_f32 v82, v67, v66
    v_cvt_pk_bf16_f32 v83, v65, v64
    ds_write_b64 v20, v[82:83] offset:14336
    s_mov_b64 exec, 1
    ds_add_u32 v18, v19 offset:12
    s_mov_b64 exec, -1
    s_add_u32 s80, s86, 94208
    v_add_u32 v5, s80, v15
    s_branch LA_s3_in
LA_s3:
    s_sleep 1
LA_s3_in:
    ds_read_b32 v6, v18 offset:12
    ds_read_b128 v[84:87], v5 offset:0
    ds_read_b128 v[88:91], v5 offset:4096
    ds_read_b128 v[92:95], v5 offset:8192
    ds_read_b128 v[96:99], v5 offset:12288
    s_waitcnt lgkmcnt(0)
    v_readfirstlane_b32 s78, v6
    s_nop 0
    s_cmp_ge_u32 s78, 4
    s_cbranch_scc0 LA_s3
    s_add_u32 s89, s91, 4194304
    buffer_store_dwordx4 v[84:87], v14, s[52:55], s89 offen sc1
    s_add_u32 s89, s91, 4198400
    buffer_store_dwordx4 v[88:91], v14, s[52:55], s89 offen sc1
    s_add_u32 s89, s91, 4202496
    buffer_store_dwordx4 v[92:95], v14, s[52:55], s89 offen sc1
    s_add_u32 s89, s91, 4206592
    buffer_store_dwordx4 v[96:99], v14, s[52:55], s89 offen sc1
    s_add_u32 m0, s86, 129024
    s_add_u32 s89, s97, 131072
    buffer_load_dwordx4 v17, s[64:67], s89 offen  lds
    s_add_u32 m0, s86, 133120
    s_add_u32 s89, s97, 196608
    buffer_load_dwordx4 v17, s[64:67], s89 offen  lds
    s_add_u32 m0, s86, 137216
    s_add_u32 s89, s99, 0
    buffer_load_dwordx4 v17, s[64:67], s89 offen  lds
    s_add_u32 m0, s86, 141312
    s_add_u32 s89, s99, 65536
    buffer_load_dwordx4 v17, s[64:67], s89 offen  lds
    s_add_u32 m0, s86, 145408
    s_add_u32 s89, s99, 131072
    buffer_load_dwordx4 v17, s[64:67], s89 offen  lds
    s_add_u32 m0, s86, 149504
    s_add_u32 s89, s99, 196608
    buffer_load_dwordx4 v17, s[64:67], s89 offen  lds
    s_setprio 0
    s_mov_b32 s60, s22
    s_mov_b32 s61, s23
    s_mov_b32 s62, 0x800000
    s_mov_b32 s63, 0x20000
    s_lshr_b32 s81, s91, 4
    s_lshl_b32 s82, s3, 8
    s_add_u32 s81, s81, s82
    s_add_u32 s81, s81, 12648448
    s_lshl_b32 s80, s74, 14
    s_and_b32 s82, s75, 3
    s_lshl_b32 s82, s82, 8
    s_add_u32 s80, s80, s82
    s_add_u32 s80, s80, 12648448
    v_mov_b32 v5, 0
    v_lshlrev_b32 v7, 10, v0
    s_waitcnt vmcnt(6)
    s_mov_b64 exec, 1
    buffer_store_dword v19, v5, s[52:55], s81 offen sc1
    s_mov_b64 exec, 0xffff
    s_waitcnt vmcnt(1)
    s_mov_b64 exec, 1
    ds_add_u32 v18, v19 offset:32
    s_mov_b64 exec, -1
    s_mov_b64 exec, 0xffff
    s_waitcnt vmcnt(0)
    s_branch LA_s7a_in
LA_s7a:
    s_sleep 1
LA_s7a_in:
    ds_read_b32 v6, v18 offset:28
    s_waitcnt lgkmcnt(0)
    v_readfirstlane_b32 s78, v6
    s_nop 0
    s_cmp_ge_u32 s78, 4
    s_cbranch_scc0 LA_s7a
    s_setprio 2
    s_mov_b32 s79, 0
LA_py:
    buffer_load_dword v6, v7, s[52:55], s80 offen sc1
    s_add_u32 s79, s79, 1
    s_cmp_gt_u32 s79, 200000
    s_cbranch_scc1 LA_py_x
    s_waitcnt vmcnt(0)
    v_cmp_ne_u32 vcc, 1, v6
    s_cbranch_vccz LA_py_x
    s_mov_b64 exec, vcc
    s_sleep 8
    s_branch LA_py
LA_py_x:
    s_waitcnt vmcnt(0)
    s_mov_b64 exec, -1
    s_mov_b32 s89, 4194304
    buffer_load_dwordx4 v[100:103], v12, s[52:55], s89 offen sc1
    s_mov_b32 s89, 4210688
    buffer_load_dwordx4 v[104:107], v12, s[52:55], s89 offen sc1
    s_mov_b32 s89, 4227072
    buffer_load_dwordx4 v[108:111], v12, s[52:55], s89 offen sc1
    s_mov_b32 s89, 4243456
    buffer_load_dwordx4 v[112:115], v12, s[52:55], s89 offen sc1
    s_waitcnt vmcnt(3)
    v_permlane32_swap_b32 v102, v100
    v_permlane32_swap_b32 v103, v101
    s_waitcnt vmcnt(2)
    v_permlane32_swap_b32 v106, v104
    v_permlane32_swap_b32 v107, v105
    s_waitcnt vmcnt(1)
    v_permlane32_swap_b32 v110, v108
    v_permlane32_swap_b32 v111, v109
    s_waitcnt vmcnt(0)
    v_permlane32_swap_b32 v114, v112
    v_permlane32_swap_b32 v115, v113
    v_and_b32 v68, 0xffff0000, v103
    v_and_b32 v69, 0xffff0000, v107
    v_and_b32 v70, 0xffff0000, v111
    v_and_b32 v71, 0xffff0000, v115
    v_and_b32 v72, 0xffff0000, v101
    v_and_b32 v73, 0xffff0000, v105
    v_and_b32 v74, 0xffff0000, v109
    v_and_b32 v75, 0xffff0000, v113
    v_mul_f32 v68, v68, v196
    v_mul_f32 v69, v69, v197
    v_mul_f32 v70, v70, v198
    v_mul_f32 v71, v71, v199
    v_mul_f32 v72, v72, v200
    v_mul_f32 v73, v73, v201
    v_mul_f32 v74, v74, v202
    v_mul_f32 v75, v75, v203
    v_cvt_pk_bf16_f32 v36, v68, v69
    v_cvt_pk_bf16_f32 v37, v70, v71
    v_cvt_pk_bf16_f32 v38, v72, v73
    v_cvt_pk_bf16_f32 v39, v74, v75
    s_mov_b32 s89, 0
    buffer_store_dwordx4 v[36:39], v13, s[60:63], s89 offen nt
    v_lshlrev_b32 v68, 16, v103
    v_lshlrev_b32 v69, 16, v107
    v_lshlrev_b32 v70, 16, v111
    v_lshlrev_b32 v71, 16, v115
    v_lshlrev_b32 v72, 16, v101
    v_lshlrev_b32 v73, 16, v105
    v_lshlrev_b32 v74, 16, v109
    v_lshlrev_b32 v75, 16, v113
    v_mul_f32 v68, v68, v204
    v_mul_f32 v69, v69, v205
    v_mul_f32 v70, v70, v206
    v_mul_f32 v71, v71, v207
    v_mul_f32 v72, v72, v208
    v_mul_f32 v73, v73, v209
    v_mul_f32 v74, v74, v210
    v_mul_f32 v75, v75, v211
    v_cvt_pk_bf16_f32 v40, v68, v69
    v_cvt_pk_bf16_f32 v41, v70, v71
    v_cvt_pk_bf16_f32 v42, v72, v73
    v_cvt_pk_bf16_f32 v43, v74, v75
    s_mov_b32 s89, 4096
    buffer_store_dwordx4 v[40:43], v13, s[60:63], s89 offen nt
    v_and_b32 v68, 0xffff0000, v102
    v_and_b32 v69, 0xffff0000, v106
    v_and_b32 v70, 0xffff0000, v110
    v_and_b32 v71, 0xffff0000, v114
    v_and_b32 v72, 0xffff0000, v100
    v_and_b32 v73, 0xffff0000, v104
    v_and_b32 v74, 0xffff0000, v108
    v_and_b32 v75, 0xffff0000, v112
    v_mul_f32 v68, v68, v240
    v_mul_f32 v69, v69, v241
    v_mul_f32 v70, v70, v242
    v_mul_f32 v71, v71, v243
    v_mul_f32 v72, v72, v244
    v_mul_f32 v73, v73, v245
    v_mul_f32 v74, v74, v246
    v_mul_f32 v75, v75, v247
    v_cvt_pk_bf16_f32 v44, v68, v69
    v_cvt_pk_bf16_f32 v45, v70, v71
    v_cvt_pk_bf16_f32 v46, v72, v73
    v_cvt_pk_bf16_f32 v47, v74, v75
    s_mov_b32 s89, 8192
    buffer_store_dwordx4 v[44:47], v13, s[60:63], s89 offen nt
    v_lshlrev_b32 v68, 16, v102
    v_lshlrev_b32 v69, 16, v106
    v_lshlrev_b32 v70, 16, v110
    v_lshlrev_b32 v71, 16, v114
    v_lshlrev_b32 v72, 16, v100
    v_lshlrev_b32 v73, 16, v104
    v_lshlrev_b32 v74, 16, v108
    v_lshlrev_b32 v75, 16, v112
    v_mul_f32 v68, v68, v248
    v_mul_f32 v69, v69, v249
    v_mul_f32 v70, v70, v250
    v_mul_f32 v71, v71, v251
    v_mul_f32 v72, v72, v252
    v_mul_f32 v73, v73, v253
    v_mul_f32 v74, v74, v254
    v_mul_f32 v75, v75, v255
    v_cvt_pk_bf16_f32 v48, v68, v69
    v_cvt_pk_bf16_f32 v49, v70, v71
    v_cvt_pk_bf16_f32 v50, v72, v73
    v_cvt_pk_bf16_f32 v51, v74, v75
    s_mov_b32 s89, 12288
    buffer_store_dwordx4 v[48:51], v13, s[60:63], s89 offen nt
    s_endpgm
L_B:
    s_setprio 3
    s_and_b32 s3, s3, 3
    s_lshr_b32 s86, s3, 1
    s_and_b32 s87, s3, 1
    v_mov_b32 v10, 162304
    v_mov_b32 v11, 1
    v_lshlrev_b32 v12, 4, v0
    v_lshl_add_u32 v13, v0, 2, v10
    v_mov_b32 v14, 0
    ds_write_b32 v13, v14
    s_lshl_b32 s78, s74, 4
    s_add_u32 s78, s78, s75
    s_lshl_b32 s96, s78, 8
    s_add_u32 s96, s96, 12582912
    s_lshl_b32 s78, s78, 2
    s_add_u32 s78, s78, s3
    s_lshl_b32 s78, s78, 8
    s_add_u32 s80, s78, 12648448
    s_lshl_b32 s81, s72, 1
    s_add_u32 s81, s81, s86
    s_lshl_b32 s97, s81, 4
    s_add_u32 s97, s97, s73
    s_lshl_b32 s97, s97, 8
    s_add_u32 s97, s97, 12910464
    v_mov_b32 v15, s80
    v_mov_b32 v223, s97
    v_cmp_gt_u32 vcc, 8, v0
    s_nop 1
    v_cndmask_b32 v15, v223, v15, vcc
    v_add_u32 v221, v15, v12
    s_lshl_b32 s78, s87, 2
    s_add_u32 s78, s78, 128
    s_add_u32 s97, s97, s78
    s_lshl_b32 s82, s73, 1
    s_add_u32 s82, s82, s87
    s_lshl_b32 s78, s81, 7
    s_add_u32 s78, s78, s82
    s_lshl_b32 s94, s78, 10
    s_add_u32 s94, s94, 8388608
    v_mov_b32 v212, 0
    v_mov_b32 v213, 0
    v_mov_b32 v214, 0
    v_mov_b32 v215, 0
    v_mov_b32 v220, 0
    s_waitcnt lgkmcnt(0)
    s_mov_b32 s52, s26
    s_mov_b32 s53, s27
    s_mov_b32 s54, 0x1000000
    s_mov_b32 s55, 0x20000
    s_mov_b32 s68, s24
    s_mov_b32 s69, s25
    s_mov_b32 s70, 0x100
    s_mov_b32 s71, 0x20000
    s_lshl_b32 s98, s74, 4
    s_or_b32 s78, s75, s3
    s_cmp_lg_u32 s78, 0
    s_cbranch_scc1 LB_notag
    s_mov_b64 exec, 0xffff
    v_lshlrev_b32 v15, 8, v0
    buffer_load_dword v223, v15, s[52:55], s96 offen sc1
    s_waitcnt vmcnt(0)
    v_lshrrev_b32 v223, v0, v223
    v_and_b32 v223, 1, v223
    v_cmp_eq_u32 vcc, 0, v223
    s_nop 1
    s_or_b32 s78, vcc_lo, 0x10000
    s_mov_b64 exec, 1
    v_mov_b32 v223, s78
    buffer_store_dword v223, v220, s[68:71], s98 offen sc1
LB_notag:
    s_lshl_b32 s78, s87, 3
    s_lshr_b32 exec_lo, 0xffff, s78
    s_mov_b32 exec_hi, 0
    buffer_store_dwordx4 v[212:215], v221, s[52:55], 0 offen sc1
    s_mov_b64 exec, -1
    v_and_b32 v13, 15, v0
    v_lshrrev_b32 v14, 4, v0
    v_lshrrev_b32 v15, 1, v13
    v_xor_b32 v15, v15, v14
    v_lshlrev_b32 v15, 4, v15
    v_lshl_add_u32 v15, v13, 7, v15
    v_add_u32 v2, 73728, v15
    v_xor_b32 v3, 64, v2
    s_lshl_b32 s78, s86, 13
    s_add_u32 s78, s78, 2048
    v_add_u32 v4, s78, v2
    v_add_u32 v5, s78, v3
    v_bfe_u32 v15, v0, 3, 2
    s_lshl_b32 s78, s87, 1
    s_add_u32 s78, s78, s86
    v_xor_b32 v15, s78, v15
    v_lshlrev_b32 v15, 5, v15
    v_and_b32 v223, 3, v0
    v_lshl_add_u32 v15, v223, 3, v15
    v_bfe_u32 v223, v0, 2, 2
    v_lshl_add_u32 v15, v223, 7, v15
    v_mul_u32_u24 v223, 3072, v14
    v_add_u32 v6, v223, v15
    v_xor_b32 v7, 32, v6
    s_mov_b32 s60, s22
    s_mov_b32 s61, s23
    s_mov_b32 s62, 0x800000
    s_mov_b32 s63, 0x20000
    v_and_b32 v15, 1, v13
    v_cmp_eq_u32 s[88:89], 1, v15
    v_lshl_add_u32 v15, v14, 2, v15
    v_cmp_le_u32 s[90:91], v15, v13
    v_add_u32 v15, 2, v15
    v_cmp_le_u32 s[92:93], v15, v13
    v_mov_b32 v212, 0x0c0c0c0c
    v_mov_b32 v15, 0xc0c0100
    v_mov_b32 v223, 0x1000c0c
    v_cndmask_b32 v15, v15, v223, s[88:89]
    v_cndmask_b32 v208, v15, v212, s[90:91]
    v_cndmask_b32 v210, v212, v15, s[90:91]
    v_mov_b32 v15, 0xc0c0302
    v_mov_b32 v223, 0x3020c0c
    v_cndmask_b32 v15, v15, v223, s[88:89]
    v_cndmask_b32 v209, v15, v212, s[92:93]
    v_cndmask_b32 v211, v212, v15, s[92:93]
    s_or_b32 s78, s72, s86
    s_cmp_eq_u32 s78, 0
    s_cselect_b32 s78, 0xf149f2ca, 0
    v_mov_b32 v212, s78
    v_mov_b32 v213, s78
    v_mov_b32 v214, s78
    v_mov_b32 v215, s78
    s_lshl_b32 s78, s87, 12
    s_add_u32 s78, s78, 24576
    s_lshl_b32 s79, s86, 9
    s_add_u32 s79, s79, s78
    v_lshlrev_b32 v15, 3, v0
    v_add_u32 v216, s79, v15
    s_lshl_b32 s80, s86, 11
    v_add_u32 v218, s80, v216
    v_xor_b32 v219, 512, v218
    s_add_u32 s78, s78, 2048
    s_cmp_eq_u32 s86, 0
    s_cselect_b32 s78, s78, 32768
    v_add_u32 v217, s78, v15
    v_bfe_u32 v14, v0, 3, 2
    v_lshlrev_b32 v14, 5, v14
    v_and_b32 v15, 3, v0
    v_lshl_add_u32 v14, v15, 3, v14
    v_lshrrev_b32 v15, 2, v0
    v_lshl_add_u32 v14, v15, 7, v14
    s_lshl_b32 s78, s86, 11
    v_add_u32 v244, s78, v14
    s_mov_b32 s64, s20
    s_mov_b32 s65, s21
    s_mov_b32 s66, 0x200000
    s_mov_b32 s67, 0x20000
    v_lshrrev_b32 v14, 4, v0
    v_lshlrev_b32 v14, 1, v14
    v_and_b32 v15, 7, v0
    v_xor_b32 v14, v14, v15
    v_lshlrev_b32 v14, 4, v14
    v_lshrrev_b32 v15, 3, v0
    v_lshl_add_u32 v14, v15, 11, v14
    s_lshl_b32 s78, s77, 7
    s_lshl_b32 s79, s3, 14
    s_add_u32 s78, s78, s79
    v_add_u32 v245, s78, v14
    v_and_b32 v14, 15, v0
    s_lshl_b32 s78, s76, 2
    s_add_u32 s78, s78, s3
    s_lshl_b32 s79, s78, 5
    v_add_u32 v14, s79, v14
    v_lshlrev_b32 v14, 12, v14
    v_bfe_u32 v15, v0, 4, 1
    v_lshl_add_u32 v14, v15, 5, v14
    v_lshrrev_b32 v15, 5, v0
    v_lshl_add_u32 v14, v15, 4, v14
    s_lshl_b32 s79, s77, 7
    s_add_u32 s79, s79, 2048
    v_add_u32 v246, s79, v14
    s_lshl_b32 s28, s78, 16
    s_add_u32 s28, s28, 8388608
    s_lshl_b32 s30, s76, 1
    s_add_u32 s30, s30, s86
    s_lshl_b32 s30, s30, 12
    s_add_u32 s30, s30, 12910592
    v_lshrrev_b32 v15, 1, v0
    v_lshlrev_b32 v15, 8, v15
    v_and_b32 v14, 1, v0
    v_lshl_add_u32 v247, v14, 2, v15
    s_and_b32 s78, s77, 7
    s_mov_b32 s79, 0x76543210
    s_cmp_eq_u32 s78, 1
    s_cselect_b32 s79, 0x76543201, s79
    s_cmp_eq_u32 s78, 2
    s_cselect_b32 s79, 0x76543120, s79
    s_cmp_eq_u32 s78, 3
    s_cselect_b32 s79, 0x76542310, s79
    s_cmp_eq_u32 s78, 4
    s_cselect_b32 s79, 0x76534210, s79
    s_cmp_eq_u32 s78, 5
    s_cselect_b32 s79, 0x76453210, s79
    s_cmp_eq_u32 s78, 6
    s_cselect_b32 s79, 0x75643210, s79
    s_cmp_eq_u32 s78, 7
    s_cselect_b32 s79, 0x67543210, s79
    s_and_b32 s78, s76, 3
    s_mul_i32 s78, s78, 0x22222222
    s_add_u32 s79, s79, s78
    s_bfe_u32 s78, s79, 0x30000
    s_lshl_b32 s44, s78, 18
    s_lshl_b32 s78, s78, 12
    s_add_u32 s36, s78, s28
    s_bfe_u32 s78, s79, 0x30004
    s_lshl_b32 s45, s78, 18
    s_lshl_b32 s78, s78, 12
    s_add_u32 s37, s78, s28
    s_bfe_u32 s78, s79, 0x30008
    s_lshl_b32 s46, s78, 18
    s_lshl_b32 s78, s78, 12
    s_add_u32 s38, s78, s28
    s_bfe_u32 s78, s79, 0x3000c
    s_lshl_b32 s47, s78, 18
    s_lshl_b32 s78, s78, 12
    s_add_u32 s39, s78, s28
    s_bfe_u32 s78, s79, 0x30010
    s_lshl_b32 s48, s78, 18
    s_lshl_b32 s78, s78, 12
    s_add_u32 s40, s78, s28
    s_bfe_u32 s78, s79, 0x30014
    s_lshl_b32 s49, s78, 18
    s_lshl_b32 s78, s78, 12
    s_add_u32 s41, s78, s28
    s_bfe_u32 s78, s79, 0x30018
    s_lshl_b32 s50, s78, 18
    s_lshl_b32 s78, s78, 12
    s_add_u32 s42, s78, s28
    s_bfe_u32 s78, s79, 0x3001c
    s_lshl_b32 s51, s78, 18
    s_lshl_b32 s78, s78, 12
    s_add_u32 s43, s78, s28
    s_lshl_b32 s34, s3, 10
    v_bfe_u32 v14, v0, 4, 1
    v_lshrrev_b32 v15, 5, v0
    v_lshl_add_u32 v14, v14, 1, v15
    v_and_b32 v15, 7, v0
    v_xor_b32 v14, v14, v15
    v_lshlrev_b32 v14, 4, v14
    v_and_b32 v223, 15, v0
    v_lshl_add_u32 v14, v223, 7, v14
    s_lshl_b32 s78, s3, 12
    v_add_u32 v248, s78, v14
    v_xor_b32 v249, 64, v248
    v_add_u32 v250, s78, v12
    v_lshrrev_b32 v14, 3, v0
    v_xor_b32 v15, v15, v14
    v_lshlrev_b32 v15, 4, v15
    v_lshl_add_u32 v14, v14, 12, v15
    s_lshl_b32 s78, s76, 2
    s_add_u32 s78, s78, s3
    s_lshl_b32 s78, s78, 17
    s_lshl_b32 s79, s77, 7
    s_add_u32 s78, s78, s79
    s_add_u32 s78, s78, 2048
    v_add_u32 v246, s78, v14
    s_waitcnt lgkmcnt(0)
    s_barrier
    ds_read_b128 v[120:123], v4 offset:0
    ds_read_b128 v[124:127], v4 offset:2048
    ds_read_b128 v[128:131], v4 offset:4096
    ds_read_b128 v[132:135], v4 offset:6144
    ds_read_b128 v[136:139], v2 offset:0
    ds_read_b64_tr_b16 v[140:141], v6 offset:0
    ds_read_b64_tr_b16 v[142:143], v6 offset:512
    ds_read_b64_tr_b16 v[144:145], v7 offset:0
    ds_read_b64_tr_b16 v[146:147], v7 offset:512
    ds_read_b64_tr_b16 v[148:149], v6 offset:1024
    ds_read_b64_tr_b16 v[150:151], v6 offset:1536
    ds_read_b64_tr_b16 v[152:153], v7 offset:1024
    ds_read_b64_tr_b16 v[154:155], v7 offset:1536
    ds_read_b64_tr_b16 v[156:157], v6 offset:2048
    ds_read_b64_tr_b16 v[158:159], v6 offset:2560
    ds_read_b64_tr_b16 v[160:161], v7 offset:2048
    ds_read_b64_tr_b16 v[162:163], v7 offset:2560
    s_waitcnt lgkmcnt(0)
    v_mfma_f32_16x16x32_bf16 v[16:19], v[140:143], v[120:123], 0
    ds_read_b128 v[164:167], v5 offset:0
    v_mfma_f32_16x16x32_bf16 v[20:23], v[144:147], v[120:123], 0
    ds_read_b128 v[168:171], v5 offset:2048
    v_mfma_f32_16x16x32_bf16 v[52:55], v[152:155], v[120:123], 0
    ds_read_b128 v[172:175], v5 offset:4096
    v_mfma_f32_16x16x32_bf16 v[48:51], v[148:151], v[120:123], 0
    ds_read_b128 v[176:179], v5 offset:6144
    v_mfma_f32_16x16x32_bf16 v[56:59], v[148:151], v[124:127], 0
    ds_read_b128 v[180:183], v3 offset:0
    v_mfma_f32_16x16x32_bf16 v[60:63], v[152:155], v[124:127], 0
    ds_read_b64_tr_b16 v[184:185], v6 offset:12288
    v_mfma_f32_16x16x32_bf16 v[28:31], v[144:147], v[124:127], 0
    ds_read_b64_tr_b16 v[186:187], v6 offset:12800
    v_mfma_f32_16x16x32_bf16 v[24:27], v[140:143], v[124:127], 0
    ds_read_b64_tr_b16 v[188:189], v7 offset:12288
    v_mfma_f32_16x16x32_bf16 v[32:35], v[140:143], v[128:131], 0
    ds_read_b64_tr_b16 v[190:191], v7 offset:12800
    v_mfma_f32_16x16x32_bf16 v[36:39], v[144:147], v[128:131], 0
    ds_read_b64_tr_b16 v[192:193], v6 offset:13312
    v_mfma_f32_16x16x32_bf16 v[68:71], v[152:155], v[128:131], 0
    ds_read_b64_tr_b16 v[194:195], v6 offset:13824
    v_mfma_f32_16x16x32_bf16 v[64:67], v[148:151], v[128:131], 0
    ds_read_b64_tr_b16 v[196:197], v7 offset:13312
    v_mfma_f32_16x16x32_bf16 v[112:115], v[148:151], v[136:139], 0
    ds_read_b64_tr_b16 v[198:199], v7 offset:13824
    v_mfma_f32_16x16x32_bf16 v[72:75], v[148:151], v[132:135], 0
    ds_read_b64_tr_b16 v[200:201], v6 offset:14336
    v_mfma_f32_16x16x32_bf16 v[76:79], v[152:155], v[132:135], 0
    ds_read_b64_tr_b16 v[202:203], v6 offset:14848
    v_mfma_f32_16x16x32_bf16 v[44:47], v[144:147], v[132:135], 0
    ds_read_b64_tr_b16 v[204:205], v7 offset:14336
    v_mfma_f32_16x16x32_bf16 v[40:43], v[140:143], v[132:135], 0
    ds_read_b64_tr_b16 v[206:207], v7 offset:14848
    v_mfma_f32_16x16x32_bf16 v[104:107], v[132:135], v[156:159], 0
    v_mfma_f32_16x16x32_bf16 v[108:111], v[132:135], v[160:163], 0
    v_mfma_f32_16x16x32_bf16 v[100:103], v[128:131], v[160:163], 0
    v_mfma_f32_16x16x32_bf16 v[96:99], v[128:131], v[156:159], 0
    v_mfma_f32_16x16x32_bf16 v[88:91], v[124:127], v[156:159], 0
    v_mfma_f32_16x16x32_bf16 v[92:95], v[124:127], v[160:163], 0
    v_mfma_f32_16x16x32_bf16 v[84:87], v[120:123], v[160:163], 0
    v_mfma_f32_16x16x32_bf16 v[80:83], v[120:123], v[156:159], 0
    v_mfma_f32_16x16x32_bf16 v[116:119], v[136:139], v[156:159], 0
    s_waitcnt vmcnt(0)
    s_waitcnt lgkmcnt(0)
    s_barrier
    v_mfma_f32_16x16x32_bf16 v[16:19], v[184:187], v[164:167], v[16:19]
    ds_read_b128 v[120:123], v4 offset:18432
    v_mfma_f32_16x16x32_bf16 v[20:23], v[188:191], v[164:167], v[20:23]
    ds_read_b128 v[124:127], v4 offset:20480
    v_mfma_f32_16x16x32_bf16 v[52:55], v[196:199], v[164:167], v[52:55]
    ds_read_b128 v[128:131], v4 offset:22528
    v_mfma_f32_16x16x32_bf16 v[48:51], v[192:195], v[164:167], v[48:51]
    ds_read_b128 v[132:135], v4 offset:24576
    v_mfma_f32_16x16x32_bf16 v[56:59], v[192:195], v[168:171], v[56:59]
    ds_read_b128 v[136:139], v2 offset:18432
    v_mfma_f32_16x16x32_bf16 v[60:63], v[196:199], v[168:171], v[60:63]
    ds_read_b64_tr_b16 v[140:141], v6 offset:24576
    v_mfma_f32_16x16x32_bf16 v[28:31], v[188:191], v[168:171], v[28:31]
    ds_read_b64_tr_b16 v[142:143], v6 offset:25088
    v_mfma_f32_16x16x32_bf16 v[24:27], v[184:187], v[168:171], v[24:27]
    ds_read_b64_tr_b16 v[144:145], v7 offset:24576
    v_mfma_f32_16x16x32_bf16 v[32:35], v[184:187], v[172:175], v[32:35]
    ds_read_b64_tr_b16 v[146:147], v7 offset:25088
    v_mfma_f32_16x16x32_bf16 v[36:39], v[188:191], v[172:175], v[36:39]
    ds_read_b64_tr_b16 v[148:149], v6 offset:25600
    v_mfma_f32_16x16x32_bf16 v[68:71], v[196:199], v[172:175], v[68:71]
    ds_read_b64_tr_b16 v[150:151], v6 offset:26112
    v_mfma_f32_16x16x32_bf16 v[64:67], v[192:195], v[172:175], v[64:67]
    ds_read_b64_tr_b16 v[152:153], v7 offset:25600
    v_mfma_f32_16x16x32_bf16 v[112:115], v[192:195], v[180:183], v[112:115]
    ds_read_b64_tr_b16 v[154:155], v7 offset:26112
    v_mfma_f32_16x16x32_bf16 v[72:75], v[192:195], v[176:179], v[72:75]
    ds_read_b64_tr_b16 v[156:157], v6 offset:26624
    v_mfma_f32_16x16x32_bf16 v[76:79], v[196:199], v[176:179], v[76:79]
    ds_read_b64_tr_b16 v[158:159], v6 offset:27136
    v_mfma_f32_16x16x32_bf16 v[44:47], v[188:191], v[176:179], v[44:47]
    ds_read_b64_tr_b16 v[160:161], v7 offset:26624
    v_mfma_f32_16x16x32_bf16 v[40:43], v[184:187], v[176:179], v[40:43]
    ds_read_b64_tr_b16 v[162:163], v7 offset:27136
    v_mfma_f32_16x16x32_bf16 v[104:107], v[176:179], v[200:203], v[104:107]
    v_mfma_f32_16x16x32_bf16 v[108:111], v[176:179], v[204:207], v[108:111]
    v_mfma_f32_16x16x32_bf16 v[100:103], v[172:175], v[204:207], v[100:103]
    v_mfma_f32_16x16x32_bf16 v[96:99], v[172:175], v[200:203], v[96:99]
    v_mfma_f32_16x16x32_bf16 v[88:91], v[168:171], v[200:203], v[88:91]
    v_mfma_f32_16x16x32_bf16 v[92:95], v[168:171], v[204:207], v[92:95]
    v_mfma_f32_16x16x32_bf16 v[84:87], v[164:167], v[204:207], v[84:87]
    v_mfma_f32_16x16x32_bf16 v[80:83], v[164:167], v[200:203], v[80:83]
    v_mfma_f32_16x16x32_bf16 v[116:119], v[180:183], v[200:203], v[116:119]
    s_waitcnt lgkmcnt(0)
    v_mfma_f32_16x16x32_bf16 v[16:19], v[140:143], v[120:123], v[16:19]
    ds_read_b128 v[164:167], v5 offset:18432
    v_mfma_f32_16x16x32_bf16 v[20:23], v[144:147], v[120:123], v[20:23]
    ds_read_b128 v[168:171], v5 offset:20480
    v_mfma_f32_16x16x32_bf16 v[52:55], v[152:155], v[120:123], v[52:55]
    ds_read_b128 v[172:175], v5 offset:22528
    v_mfma_f32_16x16x32_bf16 v[48:51], v[148:151], v[120:123], v[48:51]
    ds_read_b128 v[176:179], v5 offset:24576
    v_mfma_f32_16x16x32_bf16 v[56:59], v[148:151], v[124:127], v[56:59]
    ds_read_b128 v[180:183], v3 offset:18432
    v_mfma_f32_16x16x32_bf16 v[60:63], v[152:155], v[124:127], v[60:63]
    ds_read_b64_tr_b16 v[184:185], v6 offset:36864
    v_mfma_f32_16x16x32_bf16 v[28:31], v[144:147], v[124:127], v[28:31]
    ds_read_b64_tr_b16 v[186:187], v6 offset:37376
    v_mfma_f32_16x16x32_bf16 v[24:27], v[140:143], v[124:127], v[24:27]
    ds_read_b64_tr_b16 v[188:189], v7 offset:36864
    v_mfma_f32_16x16x32_bf16 v[32:35], v[140:143], v[128:131], v[32:35]
    ds_read_b64_tr_b16 v[190:191], v7 offset:37376
    v_mfma_f32_16x16x32_bf16 v[36:39], v[144:147], v[128:131], v[36:39]
    ds_read_b64_tr_b16 v[192:193], v6 offset:37888
    v_mfma_f32_16x16x32_bf16 v[68:71], v[152:155], v[128:131], v[68:71]
    ds_read_b64_tr_b16 v[194:195], v6 offset:38400
    v_mfma_f32_16x16x32_bf16 v[64:67], v[148:151], v[128:131], v[64:67]
    ds_read_b64_tr_b16 v[196:197], v7 offset:37888
    v_mfma_f32_16x16x32_bf16 v[112:115], v[148:151], v[136:139], v[112:115]
    ds_read_b64_tr_b16 v[198:199], v7 offset:38400
    v_mfma_f32_16x16x32_bf16 v[72:75], v[148:151], v[132:135], v[72:75]
    ds_read_b64_tr_b16 v[200:201], v6 offset:38912
    v_mfma_f32_16x16x32_bf16 v[76:79], v[152:155], v[132:135], v[76:79]
    ds_read_b64_tr_b16 v[202:203], v6 offset:39424
    v_mfma_f32_16x16x32_bf16 v[44:47], v[144:147], v[132:135], v[44:47]
    ds_read_b64_tr_b16 v[204:205], v7 offset:38912
    v_mfma_f32_16x16x32_bf16 v[40:43], v[140:143], v[132:135], v[40:43]
    ds_read_b64_tr_b16 v[206:207], v7 offset:39424
    v_mfma_f32_16x16x32_bf16 v[104:107], v[132:135], v[156:159], v[104:107]
    v_mfma_f32_16x16x32_bf16 v[108:111], v[132:135], v[160:163], v[108:111]
    v_mfma_f32_16x16x32_bf16 v[100:103], v[128:131], v[160:163], v[100:103]
    v_mfma_f32_16x16x32_bf16 v[96:99], v[128:131], v[156:159], v[96:99]
    v_mfma_f32_16x16x32_bf16 v[88:91], v[124:127], v[156:159], v[88:91]
    v_mfma_f32_16x16x32_bf16 v[92:95], v[124:127], v[160:163], v[92:95]
    v_mfma_f32_16x16x32_bf16 v[84:87], v[120:123], v[160:163], v[84:87]
    v_mfma_f32_16x16x32_bf16 v[80:83], v[120:123], v[156:159], v[80:83]
    v_mfma_f32_16x16x32_bf16 v[116:119], v[136:139], v[156:159], v[116:119]
    s_waitcnt lgkmcnt(0)
    s_barrier
    v_mfma_f32_16x16x32_bf16 v[16:19], v[184:187], v[164:167], v[16:19]
    ds_read_b128 v[120:123], v4 offset:36864
    v_mfma_f32_16x16x32_bf16 v[20:23], v[188:191], v[164:167], v[20:23]
    ds_read_b128 v[124:127], v4 offset:38912
    v_mfma_f32_16x16x32_bf16 v[52:55], v[196:199], v[164:167], v[52:55]
    ds_read_b128 v[128:131], v4 offset:40960
    v_mfma_f32_16x16x32_bf16 v[48:51], v[192:195], v[164:167], v[48:51]
    ds_read_b128 v[132:135], v4 offset:43008
    v_mfma_f32_16x16x32_bf16 v[56:59], v[192:195], v[168:171], v[56:59]
    ds_read_b128 v[136:139], v2 offset:36864
    v_mfma_f32_16x16x32_bf16 v[60:63], v[196:199], v[168:171], v[60:63]
    ds_read_b64_tr_b16 v[140:141], v6 offset:49152
    v_mfma_f32_16x16x32_bf16 v[28:31], v[188:191], v[168:171], v[28:31]
    ds_read_b64_tr_b16 v[142:143], v6 offset:49664
    v_mfma_f32_16x16x32_bf16 v[24:27], v[184:187], v[168:171], v[24:27]
    ds_read_b64_tr_b16 v[144:145], v7 offset:49152
    v_mfma_f32_16x16x32_bf16 v[32:35], v[184:187], v[172:175], v[32:35]
    ds_read_b64_tr_b16 v[146:147], v7 offset:49664
    v_mfma_f32_16x16x32_bf16 v[36:39], v[188:191], v[172:175], v[36:39]
    ds_read_b64_tr_b16 v[148:149], v6 offset:50176
    v_mfma_f32_16x16x32_bf16 v[68:71], v[196:199], v[172:175], v[68:71]
    ds_read_b64_tr_b16 v[150:151], v6 offset:50688
    v_mfma_f32_16x16x32_bf16 v[64:67], v[192:195], v[172:175], v[64:67]
    ds_read_b64_tr_b16 v[152:153], v7 offset:50176
    v_mfma_f32_16x16x32_bf16 v[112:115], v[192:195], v[180:183], v[112:115]
    ds_read_b64_tr_b16 v[154:155], v7 offset:50688
    v_mfma_f32_16x16x32_bf16 v[72:75], v[192:195], v[176:179], v[72:75]
    ds_read_b64_tr_b16 v[156:157], v6 offset:51200
    v_mfma_f32_16x16x32_bf16 v[76:79], v[196:199], v[176:179], v[76:79]
    ds_read_b64_tr_b16 v[158:159], v6 offset:51712
    v_mfma_f32_16x16x32_bf16 v[44:47], v[188:191], v[176:179], v[44:47]
    ds_read_b64_tr_b16 v[160:161], v7 offset:51200
    v_mfma_f32_16x16x32_bf16 v[40:43], v[184:187], v[176:179], v[40:43]
    ds_read_b64_tr_b16 v[162:163], v7 offset:51712
    v_mfma_f32_16x16x32_bf16 v[104:107], v[176:179], v[200:203], v[104:107]
    v_mfma_f32_16x16x32_bf16 v[108:111], v[176:179], v[204:207], v[108:111]
    v_mfma_f32_16x16x32_bf16 v[100:103], v[172:175], v[204:207], v[100:103]
    v_mfma_f32_16x16x32_bf16 v[96:99], v[172:175], v[200:203], v[96:99]
    v_mfma_f32_16x16x32_bf16 v[88:91], v[168:171], v[200:203], v[88:91]
    v_mfma_f32_16x16x32_bf16 v[92:95], v[168:171], v[204:207], v[92:95]
    v_mfma_f32_16x16x32_bf16 v[84:87], v[164:167], v[204:207], v[84:87]
    v_mfma_f32_16x16x32_bf16 v[80:83], v[164:167], v[200:203], v[80:83]
    v_mfma_f32_16x16x32_bf16 v[116:119], v[180:183], v[200:203], v[116:119]
    s_waitcnt lgkmcnt(0)
    v_mfma_f32_16x16x32_bf16 v[16:19], v[140:143], v[120:123], v[16:19]
    ds_read_b128 v[164:167], v5 offset:36864
    v_mfma_f32_16x16x32_bf16 v[20:23], v[144:147], v[120:123], v[20:23]
    ds_read_b128 v[168:171], v5 offset:38912
    v_mfma_f32_16x16x32_bf16 v[52:55], v[152:155], v[120:123], v[52:55]
    ds_read_b128 v[172:175], v5 offset:40960
    v_mfma_f32_16x16x32_bf16 v[48:51], v[148:151], v[120:123], v[48:51]
    ds_read_b128 v[176:179], v5 offset:43008
    v_mfma_f32_16x16x32_bf16 v[56:59], v[148:151], v[124:127], v[56:59]
    ds_read_b128 v[180:183], v3 offset:36864
    v_mfma_f32_16x16x32_bf16 v[60:63], v[152:155], v[124:127], v[60:63]
    ds_read_b64_tr_b16 v[184:185], v6 offset:61440
    v_mfma_f32_16x16x32_bf16 v[28:31], v[144:147], v[124:127], v[28:31]
    ds_read_b64_tr_b16 v[186:187], v6 offset:61952
    v_mfma_f32_16x16x32_bf16 v[24:27], v[140:143], v[124:127], v[24:27]
    ds_read_b64_tr_b16 v[188:189], v7 offset:61440
    v_mfma_f32_16x16x32_bf16 v[32:35], v[140:143], v[128:131], v[32:35]
    ds_read_b64_tr_b16 v[190:191], v7 offset:61952
    v_mfma_f32_16x16x32_bf16 v[36:39], v[144:147], v[128:131], v[36:39]
    ds_read_b64_tr_b16 v[192:193], v6 offset:62464
    v_mfma_f32_16x16x32_bf16 v[68:71], v[152:155], v[128:131], v[68:71]
    ds_read_b64_tr_b16 v[194:195], v6 offset:62976
    v_mfma_f32_16x16x32_bf16 v[64:67], v[148:151], v[128:131], v[64:67]
    ds_read_b64_tr_b16 v[196:197], v7 offset:62464
    v_mfma_f32_16x16x32_bf16 v[112:115], v[148:151], v[136:139], v[112:115]
    ds_read_b64_tr_b16 v[198:199], v7 offset:62976
    v_mfma_f32_16x16x32_bf16 v[72:75], v[148:151], v[132:135], v[72:75]
    ds_read_b64_tr_b16 v[200:201], v6 offset:63488
    v_mfma_f32_16x16x32_bf16 v[76:79], v[152:155], v[132:135], v[76:79]
    ds_read_b64_tr_b16 v[202:203], v6 offset:64000
    v_mfma_f32_16x16x32_bf16 v[44:47], v[144:147], v[132:135], v[44:47]
    ds_read_b64_tr_b16 v[204:205], v7 offset:63488
    v_mfma_f32_16x16x32_bf16 v[40:43], v[140:143], v[132:135], v[40:43]
    ds_read_b64_tr_b16 v[206:207], v7 offset:64000
    v_mfma_f32_16x16x32_bf16 v[104:107], v[132:135], v[156:159], v[104:107]
    v_mfma_f32_16x16x32_bf16 v[108:111], v[132:135], v[160:163], v[108:111]
    v_mfma_f32_16x16x32_bf16 v[100:103], v[128:131], v[160:163], v[100:103]
    v_mfma_f32_16x16x32_bf16 v[96:99], v[128:131], v[156:159], v[96:99]
    v_mfma_f32_16x16x32_bf16 v[88:91], v[124:127], v[156:159], v[88:91]
    v_mfma_f32_16x16x32_bf16 v[92:95], v[124:127], v[160:163], v[92:95]
    v_mfma_f32_16x16x32_bf16 v[84:87], v[120:123], v[160:163], v[84:87]
    v_mfma_f32_16x16x32_bf16 v[80:83], v[120:123], v[156:159], v[80:83]
    v_mfma_f32_16x16x32_bf16 v[116:119], v[136:139], v[156:159], v[116:119]
    s_waitcnt lgkmcnt(0)
    s_barrier
    v_mfma_f32_16x16x32_bf16 v[16:19], v[184:187], v[164:167], v[16:19]
    ds_read_b128 v[120:123], v4 offset:0
    v_mfma_f32_16x16x32_bf16 v[20:23], v[188:191], v[164:167], v[20:23]
    ds_read_b128 v[124:127], v4 offset:2048
    v_mfma_f32_16x16x32_bf16 v[52:55], v[196:199], v[164:167], v[52:55]
    ds_read_b128 v[128:131], v4 offset:4096
    v_mfma_f32_16x16x32_bf16 v[48:51], v[192:195], v[164:167], v[48:51]
    ds_read_b128 v[132:135], v4 offset:6144
    v_mfma_f32_16x16x32_bf16 v[56:59], v[192:195], v[168:171], v[56:59]
    ds_read_b128 v[136:139], v2 offset:0
    v_mfma_f32_16x16x32_bf16 v[60:63], v[196:199], v[168:171], v[60:63]
    ds_read_b64_tr_b16 v[140:141], v6 offset:0
    v_mfma_f32_16x16x32_bf16 v[28:31], v[188:191], v[168:171], v[28:31]
    ds_read_b64_tr_b16 v[142:143], v6 offset:512
    v_mfma_f32_16x16x32_bf16 v[24:27], v[184:187], v[168:171], v[24:27]
    ds_read_b64_tr_b16 v[144:145], v7 offset:0
    v_mfma_f32_16x16x32_bf16 v[32:35], v[184:187], v[172:175], v[32:35]
    ds_read_b64_tr_b16 v[146:147], v7 offset:512
    v_mfma_f32_16x16x32_bf16 v[36:39], v[188:191], v[172:175], v[36:39]
    ds_read_b64_tr_b16 v[148:149], v6 offset:1024
    v_mfma_f32_16x16x32_bf16 v[68:71], v[196:199], v[172:175], v[68:71]
    ds_read_b64_tr_b16 v[150:151], v6 offset:1536
    v_mfma_f32_16x16x32_bf16 v[64:67], v[192:195], v[172:175], v[64:67]
    ds_read_b64_tr_b16 v[152:153], v7 offset:1024
    v_mfma_f32_16x16x32_bf16 v[112:115], v[192:195], v[180:183], v[112:115]
    ds_read_b64_tr_b16 v[154:155], v7 offset:1536
    v_mfma_f32_16x16x32_bf16 v[72:75], v[192:195], v[176:179], v[72:75]
    ds_read_b64_tr_b16 v[156:157], v6 offset:2048
    v_mfma_f32_16x16x32_bf16 v[76:79], v[196:199], v[176:179], v[76:79]
    ds_read_b64_tr_b16 v[158:159], v6 offset:2560
    v_mfma_f32_16x16x32_bf16 v[44:47], v[188:191], v[176:179], v[44:47]
    ds_read_b64_tr_b16 v[160:161], v7 offset:2048
    v_mfma_f32_16x16x32_bf16 v[40:43], v[184:187], v[176:179], v[40:43]
    ds_read_b64_tr_b16 v[162:163], v7 offset:2560
    v_mfma_f32_16x16x32_bf16 v[104:107], v[176:179], v[200:203], v[104:107]
    v_mfma_f32_16x16x32_bf16 v[108:111], v[176:179], v[204:207], v[108:111]
    v_mfma_f32_16x16x32_bf16 v[100:103], v[172:175], v[204:207], v[100:103]
    v_mfma_f32_16x16x32_bf16 v[96:99], v[172:175], v[200:203], v[96:99]
    v_mfma_f32_16x16x32_bf16 v[88:91], v[168:171], v[200:203], v[88:91]
    v_mfma_f32_16x16x32_bf16 v[92:95], v[168:171], v[204:207], v[92:95]
    v_mfma_f32_16x16x32_bf16 v[84:87], v[164:167], v[204:207], v[84:87]
    v_mfma_f32_16x16x32_bf16 v[80:83], v[164:167], v[200:203], v[80:83]
    v_mfma_f32_16x16x32_bf16 v[116:119], v[180:183], v[200:203], v[116:119]
    s_waitcnt lgkmcnt(0)
    v_mfma_f32_16x16x32_bf16 v[16:19], v[140:143], v[120:123], v[16:19]
    ds_read_b128 v[164:167], v5 offset:0
    v_mfma_f32_16x16x32_bf16 v[20:23], v[144:147], v[120:123], v[20:23]
    ds_read_b128 v[168:171], v5 offset:2048
    v_mfma_f32_16x16x32_bf16 v[52:55], v[152:155], v[120:123], v[52:55]
    ds_read_b128 v[172:175], v5 offset:4096
    v_mfma_f32_16x16x32_bf16 v[48:51], v[148:151], v[120:123], v[48:51]
    ds_read_b128 v[176:179], v5 offset:6144
    v_mfma_f32_16x16x32_bf16 v[56:59], v[148:151], v[124:127], v[56:59]
    ds_read_b128 v[180:183], v3 offset:0
    v_mfma_f32_16x16x32_bf16 v[60:63], v[152:155], v[124:127], v[60:63]
    ds_read_b64_tr_b16 v[184:185], v6 offset:12288
    v_mfma_f32_16x16x32_bf16 v[28:31], v[144:147], v[124:127], v[28:31]
    ds_read_b64_tr_b16 v[186:187], v6 offset:12800
    v_mfma_f32_16x16x32_bf16 v[24:27], v[140:143], v[124:127], v[24:27]
    ds_read_b64_tr_b16 v[188:189], v7 offset:12288
    v_mfma_f32_16x16x32_bf16 v[32:35], v[140:143], v[128:131], v[32:35]
    ds_read_b64_tr_b16 v[190:191], v7 offset:12800
    v_mfma_f32_16x16x32_bf16 v[36:39], v[144:147], v[128:131], v[36:39]
    ds_read_b64_tr_b16 v[192:193], v6 offset:13312
    v_mfma_f32_16x16x32_bf16 v[68:71], v[152:155], v[128:131], v[68:71]
    ds_read_b64_tr_b16 v[194:195], v6 offset:13824
    v_mfma_f32_16x16x32_bf16 v[64:67], v[148:151], v[128:131], v[64:67]
    ds_read_b64_tr_b16 v[196:197], v7 offset:13312
    v_mfma_f32_16x16x32_bf16 v[112:115], v[148:151], v[136:139], v[112:115]
    ds_read_b64_tr_b16 v[198:199], v7 offset:13824
    v_mfma_f32_16x16x32_bf16 v[72:75], v[148:151], v[132:135], v[72:75]
    ds_read_b64_tr_b16 v[200:201], v6 offset:14336
    v_mfma_f32_16x16x32_bf16 v[76:79], v[152:155], v[132:135], v[76:79]
    ds_read_b64_tr_b16 v[202:203], v6 offset:14848
    v_mfma_f32_16x16x32_bf16 v[44:47], v[144:147], v[132:135], v[44:47]
    ds_read_b64_tr_b16 v[204:205], v7 offset:14336
    v_mfma_f32_16x16x32_bf16 v[40:43], v[140:143], v[132:135], v[40:43]
    ds_read_b64_tr_b16 v[206:207], v7 offset:14848
    v_mfma_f32_16x16x32_bf16 v[104:107], v[132:135], v[156:159], v[104:107]
    v_mfma_f32_16x16x32_bf16 v[108:111], v[132:135], v[160:163], v[108:111]
    v_mfma_f32_16x16x32_bf16 v[100:103], v[128:131], v[160:163], v[100:103]
    v_mfma_f32_16x16x32_bf16 v[96:99], v[128:131], v[156:159], v[96:99]
    v_mfma_f32_16x16x32_bf16 v[88:91], v[124:127], v[156:159], v[88:91]
    v_mfma_f32_16x16x32_bf16 v[92:95], v[124:127], v[160:163], v[92:95]
    v_mfma_f32_16x16x32_bf16 v[84:87], v[120:123], v[160:163], v[84:87]
    v_mfma_f32_16x16x32_bf16 v[80:83], v[120:123], v[156:159], v[80:83]
    v_mfma_f32_16x16x32_bf16 v[116:119], v[136:139], v[156:159], v[116:119]
    s_waitcnt lgkmcnt(0)
    s_barrier
    v_mfma_f32_16x16x32_bf16 v[16:19], v[184:187], v[164:167], v[16:19]
    ds_read_b128 v[120:123], v4 offset:18432
    v_mfma_f32_16x16x32_bf16 v[20:23], v[188:191], v[164:167], v[20:23]
    ds_read_b128 v[124:127], v4 offset:20480
    v_mfma_f32_16x16x32_bf16 v[52:55], v[196:199], v[164:167], v[52:55]
    ds_read_b128 v[128:131], v4 offset:22528
    v_mfma_f32_16x16x32_bf16 v[48:51], v[192:195], v[164:167], v[48:51]
    ds_read_b128 v[132:135], v4 offset:24576
    v_mfma_f32_16x16x32_bf16 v[56:59], v[192:195], v[168:171], v[56:59]
    ds_read_b128 v[136:139], v2 offset:18432
    v_mfma_f32_16x16x32_bf16 v[60:63], v[196:199], v[168:171], v[60:63]
    ds_read_b64_tr_b16 v[140:141], v6 offset:24576
    v_mfma_f32_16x16x32_bf16 v[28:31], v[188:191], v[168:171], v[28:31]
    ds_read_b64_tr_b16 v[142:143], v6 offset:25088
    v_mfma_f32_16x16x32_bf16 v[24:27], v[184:187], v[168:171], v[24:27]
    ds_read_b64_tr_b16 v[144:145], v7 offset:24576
    v_mfma_f32_16x16x32_bf16 v[32:35], v[184:187], v[172:175], v[32:35]
    ds_read_b64_tr_b16 v[146:147], v7 offset:25088
    v_mfma_f32_16x16x32_bf16 v[36:39], v[188:191], v[172:175], v[36:39]
    ds_read_b64_tr_b16 v[148:149], v6 offset:25600
    v_mfma_f32_16x16x32_bf16 v[68:71], v[196:199], v[172:175], v[68:71]
    ds_read_b64_tr_b16 v[150:151], v6 offset:26112
    v_mfma_f32_16x16x32_bf16 v[64:67], v[192:195], v[172:175], v[64:67]
    ds_read_b64_tr_b16 v[152:153], v7 offset:25600
    v_mfma_f32_16x16x32_bf16 v[112:115], v[192:195], v[180:183], v[112:115]
    ds_read_b64_tr_b16 v[154:155], v7 offset:26112
    v_mfma_f32_16x16x32_bf16 v[72:75], v[192:195], v[176:179], v[72:75]
    ds_read_b64_tr_b16 v[156:157], v6 offset:26624
    v_mfma_f32_16x16x32_bf16 v[76:79], v[196:199], v[176:179], v[76:79]
    ds_read_b64_tr_b16 v[158:159], v6 offset:27136
    v_mfma_f32_16x16x32_bf16 v[44:47], v[188:191], v[176:179], v[44:47]
    ds_read_b64_tr_b16 v[160:161], v7 offset:26624
    v_mfma_f32_16x16x32_bf16 v[40:43], v[184:187], v[176:179], v[40:43]
    ds_read_b64_tr_b16 v[162:163], v7 offset:27136
    v_mfma_f32_16x16x32_bf16 v[104:107], v[176:179], v[200:203], v[104:107]
    v_mfma_f32_16x16x32_bf16 v[108:111], v[176:179], v[204:207], v[108:111]
    v_mfma_f32_16x16x32_bf16 v[100:103], v[172:175], v[204:207], v[100:103]
    v_mfma_f32_16x16x32_bf16 v[96:99], v[172:175], v[200:203], v[96:99]
    v_mfma_f32_16x16x32_bf16 v[88:91], v[168:171], v[200:203], v[88:91]
    v_mfma_f32_16x16x32_bf16 v[92:95], v[168:171], v[204:207], v[92:95]
    v_mfma_f32_16x16x32_bf16 v[84:87], v[164:167], v[204:207], v[84:87]
    v_mfma_f32_16x16x32_bf16 v[80:83], v[164:167], v[200:203], v[80:83]
    v_mfma_f32_16x16x32_bf16 v[116:119], v[180:183], v[200:203], v[116:119]
    s_waitcnt lgkmcnt(0)
    v_mfma_f32_16x16x32_bf16 v[16:19], v[140:143], v[120:123], v[16:19]
    ds_read_b128 v[164:167], v5 offset:18432
    v_mfma_f32_16x16x32_bf16 v[20:23], v[144:147], v[120:123], v[20:23]
    ds_read_b128 v[168:171], v5 offset:20480
    v_mfma_f32_16x16x32_bf16 v[52:55], v[152:155], v[120:123], v[52:55]
    ds_read_b128 v[172:175], v5 offset:22528
    v_mfma_f32_16x16x32_bf16 v[48:51], v[148:151], v[120:123], v[48:51]
    ds_read_b128 v[176:179], v5 offset:24576
    v_mfma_f32_16x16x32_bf16 v[56:59], v[148:151], v[124:127], v[56:59]
    ds_read_b128 v[180:183], v3 offset:18432
    v_mfma_f32_16x16x32_bf16 v[60:63], v[152:155], v[124:127], v[60:63]
    ds_read_b64_tr_b16 v[184:185], v6 offset:36864
    v_mfma_f32_16x16x32_bf16 v[28:31], v[144:147], v[124:127], v[28:31]
    ds_read_b64_tr_b16 v[186:187], v6 offset:37376
    v_mfma_f32_16x16x32_bf16 v[24:27], v[140:143], v[124:127], v[24:27]
    ds_read_b64_tr_b16 v[188:189], v7 offset:36864
    v_mfma_f32_16x16x32_bf16 v[32:35], v[140:143], v[128:131], v[32:35]
    ds_read_b64_tr_b16 v[190:191], v7 offset:37376
    v_mfma_f32_16x16x32_bf16 v[36:39], v[144:147], v[128:131], v[36:39]
    ds_read_b64_tr_b16 v[192:193], v6 offset:37888
    v_mfma_f32_16x16x32_bf16 v[68:71], v[152:155], v[128:131], v[68:71]
    ds_read_b64_tr_b16 v[194:195], v6 offset:38400
    v_mfma_f32_16x16x32_bf16 v[64:67], v[148:151], v[128:131], v[64:67]
    ds_read_b64_tr_b16 v[196:197], v7 offset:37888
    v_mfma_f32_16x16x32_bf16 v[112:115], v[148:151], v[136:139], v[112:115]
    ds_read_b64_tr_b16 v[198:199], v7 offset:38400
    v_mfma_f32_16x16x32_bf16 v[72:75], v[148:151], v[132:135], v[72:75]
    ds_read_b64_tr_b16 v[200:201], v6 offset:38912
    v_mfma_f32_16x16x32_bf16 v[76:79], v[152:155], v[132:135], v[76:79]
    ds_read_b64_tr_b16 v[202:203], v6 offset:39424
    v_mfma_f32_16x16x32_bf16 v[44:47], v[144:147], v[132:135], v[44:47]
    ds_read_b64_tr_b16 v[204:205], v7 offset:38912
    v_mfma_f32_16x16x32_bf16 v[40:43], v[140:143], v[132:135], v[40:43]
    ds_read_b64_tr_b16 v[206:207], v7 offset:39424
    v_mfma_f32_16x16x32_bf16 v[104:107], v[132:135], v[156:159], v[104:107]
    v_mfma_f32_16x16x32_bf16 v[108:111], v[132:135], v[160:163], v[108:111]
    v_mfma_f32_16x16x32_bf16 v[100:103], v[128:131], v[160:163], v[100:103]
    v_mfma_f32_16x16x32_bf16 v[96:99], v[128:131], v[156:159], v[96:99]
    v_mfma_f32_16x16x32_bf16 v[88:91], v[124:127], v[156:159], v[88:91]
    v_mfma_f32_16x16x32_bf16 v[92:95], v[124:127], v[160:163], v[92:95]
    v_mfma_f32_16x16x32_bf16 v[84:87], v[120:123], v[160:163], v[84:87]
    v_mfma_f32_16x16x32_bf16 v[80:83], v[120:123], v[156:159], v[80:83]
    v_mfma_f32_16x16x32_bf16 v[116:119], v[136:139], v[156:159], v[116:119]
    s_waitcnt lgkmcnt(0)
    s_barrier
    v_mfma_f32_16x16x32_bf16 v[16:19], v[184:187], v[164:167], v[16:19]
    ds_read_b128 v[120:123], v4 offset:36864
    v_mfma_f32_16x16x32_bf16 v[20:23], v[188:191], v[164:167], v[20:23]
    ds_read_b128 v[124:127], v4 offset:38912
    v_mfma_f32_16x16x32_bf16 v[52:55], v[196:199], v[164:167], v[52:55]
    ds_read_b128 v[128:131], v4 offset:40960
    v_mfma_f32_16x16x32_bf16 v[48:51], v[192:195], v[164:167], v[48:51]
    ds_read_b128 v[132:135], v4 offset:43008
    v_mfma_f32_16x16x32_bf16 v[56:59], v[192:195], v[168:171], v[56:59]
    ds_read_b128 v[136:139], v2 offset:36864
    v_mfma_f32_16x16x32_bf16 v[60:63], v[196:199], v[168:171], v[60:63]
    ds_read_b64_tr_b16 v[140:141], v6 offset:49152
    v_mfma_f32_16x16x32_bf16 v[28:31], v[188:191], v[168:171], v[28:31]
    ds_read_b64_tr_b16 v[142:143], v6 offset:49664
    v_mfma_f32_16x16x32_bf16 v[24:27], v[184:187], v[168:171], v[24:27]
    ds_read_b64_tr_b16 v[144:145], v7 offset:49152
    v_mfma_f32_16x16x32_bf16 v[32:35], v[184:187], v[172:175], v[32:35]
    ds_read_b64_tr_b16 v[146:147], v7 offset:49664
    v_mfma_f32_16x16x32_bf16 v[36:39], v[188:191], v[172:175], v[36:39]
    ds_read_b64_tr_b16 v[148:149], v6 offset:50176
    v_mfma_f32_16x16x32_bf16 v[68:71], v[196:199], v[172:175], v[68:71]
    ds_read_b64_tr_b16 v[150:151], v6 offset:50688
    v_mfma_f32_16x16x32_bf16 v[64:67], v[192:195], v[172:175], v[64:67]
    ds_read_b64_tr_b16 v[152:153], v7 offset:50176
    v_mfma_f32_16x16x32_bf16 v[112:115], v[192:195], v[180:183], v[112:115]
    ds_read_b64_tr_b16 v[154:155], v7 offset:50688
    v_mfma_f32_16x16x32_bf16 v[72:75], v[192:195], v[176:179], v[72:75]
    ds_read_b64_tr_b16 v[156:157], v6 offset:51200
    v_mfma_f32_16x16x32_bf16 v[76:79], v[196:199], v[176:179], v[76:79]
    ds_read_b64_tr_b16 v[158:159], v6 offset:51712
    v_mfma_f32_16x16x32_bf16 v[44:47], v[188:191], v[176:179], v[44:47]
    ds_read_b64_tr_b16 v[160:161], v7 offset:51200
    v_mfma_f32_16x16x32_bf16 v[40:43], v[184:187], v[176:179], v[40:43]
    ds_read_b64_tr_b16 v[162:163], v7 offset:51712
    v_mfma_f32_16x16x32_bf16 v[104:107], v[176:179], v[200:203], v[104:107]
    v_mfma_f32_16x16x32_bf16 v[108:111], v[176:179], v[204:207], v[108:111]
    v_mfma_f32_16x16x32_bf16 v[100:103], v[172:175], v[204:207], v[100:103]
    v_mfma_f32_16x16x32_bf16 v[96:99], v[172:175], v[200:203], v[96:99]
    v_mfma_f32_16x16x32_bf16 v[88:91], v[168:171], v[200:203], v[88:91]
    v_mfma_f32_16x16x32_bf16 v[92:95], v[168:171], v[204:207], v[92:95]
    v_mfma_f32_16x16x32_bf16 v[84:87], v[164:167], v[204:207], v[84:87]
    v_mfma_f32_16x16x32_bf16 v[80:83], v[164:167], v[200:203], v[80:83]
    v_mfma_f32_16x16x32_bf16 v[116:119], v[180:183], v[200:203], v[116:119]
    s_waitcnt lgkmcnt(0)
    v_mfma_f32_16x16x32_bf16 v[16:19], v[140:143], v[120:123], v[16:19]
    ds_read_b128 v[164:167], v5 offset:36864
    v_mfma_f32_16x16x32_bf16 v[20:23], v[144:147], v[120:123], v[20:23]
    ds_read_b128 v[168:171], v5 offset:38912
    v_mfma_f32_16x16x32_bf16 v[52:55], v[152:155], v[120:123], v[52:55]
    ds_read_b128 v[172:175], v5 offset:40960
    v_mfma_f32_16x16x32_bf16 v[48:51], v[148:151], v[120:123], v[48:51]
    ds_read_b128 v[176:179], v5 offset:43008
    v_mfma_f32_16x16x32_bf16 v[56:59], v[148:151], v[124:127], v[56:59]
    ds_read_b128 v[180:183], v3 offset:36864
    v_mfma_f32_16x16x32_bf16 v[60:63], v[152:155], v[124:127], v[60:63]
    ds_read_b64_tr_b16 v[184:185], v6 offset:61440
    v_mfma_f32_16x16x32_bf16 v[28:31], v[144:147], v[124:127], v[28:31]
    ds_read_b64_tr_b16 v[186:187], v6 offset:61952
    v_mfma_f32_16x16x32_bf16 v[24:27], v[140:143], v[124:127], v[24:27]
    ds_read_b64_tr_b16 v[188:189], v7 offset:61440
    v_mfma_f32_16x16x32_bf16 v[32:35], v[140:143], v[128:131], v[32:35]
    ds_read_b64_tr_b16 v[190:191], v7 offset:61952
    v_mfma_f32_16x16x32_bf16 v[36:39], v[144:147], v[128:131], v[36:39]
    ds_read_b64_tr_b16 v[192:193], v6 offset:62464
    v_mfma_f32_16x16x32_bf16 v[68:71], v[152:155], v[128:131], v[68:71]
    ds_read_b64_tr_b16 v[194:195], v6 offset:62976
    v_mfma_f32_16x16x32_bf16 v[64:67], v[148:151], v[128:131], v[64:67]
    ds_read_b64_tr_b16 v[196:197], v7 offset:62464
    v_mfma_f32_16x16x32_bf16 v[112:115], v[148:151], v[136:139], v[112:115]
    ds_read_b64_tr_b16 v[198:199], v7 offset:62976
    v_mfma_f32_16x16x32_bf16 v[72:75], v[148:151], v[132:135], v[72:75]
    ds_read_b64_tr_b16 v[200:201], v6 offset:63488
    v_mfma_f32_16x16x32_bf16 v[76:79], v[152:155], v[132:135], v[76:79]
    ds_read_b64_tr_b16 v[202:203], v6 offset:64000
    v_mfma_f32_16x16x32_bf16 v[44:47], v[144:147], v[132:135], v[44:47]
    ds_read_b64_tr_b16 v[204:205], v7 offset:63488
    v_mfma_f32_16x16x32_bf16 v[40:43], v[140:143], v[132:135], v[40:43]
    ds_read_b64_tr_b16 v[206:207], v7 offset:64000
    v_mfma_f32_16x16x32_bf16 v[104:107], v[132:135], v[156:159], v[104:107]
    v_mfma_f32_16x16x32_bf16 v[108:111], v[132:135], v[160:163], v[108:111]
    v_mfma_f32_16x16x32_bf16 v[100:103], v[128:131], v[160:163], v[100:103]
    v_mfma_f32_16x16x32_bf16 v[96:99], v[128:131], v[156:159], v[96:99]
    v_mfma_f32_16x16x32_bf16 v[88:91], v[124:127], v[156:159], v[88:91]
    v_mfma_f32_16x16x32_bf16 v[92:95], v[124:127], v[160:163], v[92:95]
    v_mfma_f32_16x16x32_bf16 v[84:87], v[120:123], v[160:163], v[84:87]
    v_mfma_f32_16x16x32_bf16 v[80:83], v[120:123], v[156:159], v[80:83]
    v_mfma_f32_16x16x32_bf16 v[116:119], v[136:139], v[156:159], v[116:119]
    s_waitcnt lgkmcnt(0)
    s_barrier
    v_mfma_f32_16x16x32_bf16 v[16:19], v[184:187], v[164:167], v[16:19]
    ds_read_b128 v[120:123], v4 offset:0
    v_mfma_f32_16x16x32_bf16 v[20:23], v[188:191], v[164:167], v[20:23]
    ds_read_b128 v[124:127], v4 offset:2048
    v_mfma_f32_16x16x32_bf16 v[52:55], v[196:199], v[164:167], v[52:55]
    ds_read_b128 v[128:131], v4 offset:4096
    v_mfma_f32_16x16x32_bf16 v[48:51], v[192:195], v[164:167], v[48:51]
    ds_read_b128 v[132:135], v4 offset:6144
    v_mfma_f32_16x16x32_bf16 v[56:59], v[192:195], v[168:171], v[56:59]
    ds_read_b128 v[136:139], v2 offset:0
    v_mfma_f32_16x16x32_bf16 v[60:63], v[196:199], v[168:171], v[60:63]
    ds_read_b64_tr_b16 v[140:141], v6 offset:0
    v_mfma_f32_16x16x32_bf16 v[28:31], v[188:191], v[168:171], v[28:31]
    ds_read_b64_tr_b16 v[142:143], v6 offset:512
    v_mfma_f32_16x16x32_bf16 v[24:27], v[184:187], v[168:171], v[24:27]
    ds_read_b64_tr_b16 v[144:145], v7 offset:0
    v_mfma_f32_16x16x32_bf16 v[32:35], v[184:187], v[172:175], v[32:35]
    ds_read_b64_tr_b16 v[146:147], v7 offset:512
    v_mfma_f32_16x16x32_bf16 v[36:39], v[188:191], v[172:175], v[36:39]
    ds_read_b64_tr_b16 v[148:149], v6 offset:1024
    v_mfma_f32_16x16x32_bf16 v[68:71], v[196:199], v[172:175], v[68:71]
    ds_read_b64_tr_b16 v[150:151], v6 offset:1536
    v_mfma_f32_16x16x32_bf16 v[64:67], v[192:195], v[172:175], v[64:67]
    ds_read_b64_tr_b16 v[152:153], v7 offset:1024
    v_mfma_f32_16x16x32_bf16 v[112:115], v[192:195], v[180:183], v[112:115]
    ds_read_b64_tr_b16 v[154:155], v7 offset:1536
    v_mfma_f32_16x16x32_bf16 v[72:75], v[192:195], v[176:179], v[72:75]
    ds_read_b64_tr_b16 v[156:157], v6 offset:2048
    v_mfma_f32_16x16x32_bf16 v[76:79], v[196:199], v[176:179], v[76:79]
    ds_read_b64_tr_b16 v[158:159], v6 offset:2560
    v_mfma_f32_16x16x32_bf16 v[44:47], v[188:191], v[176:179], v[44:47]
    ds_read_b64_tr_b16 v[160:161], v7 offset:2048
    v_mfma_f32_16x16x32_bf16 v[40:43], v[184:187], v[176:179], v[40:43]
    ds_read_b64_tr_b16 v[162:163], v7 offset:2560
    v_mfma_f32_16x16x32_bf16 v[104:107], v[176:179], v[200:203], v[104:107]
    v_mfma_f32_16x16x32_bf16 v[108:111], v[176:179], v[204:207], v[108:111]
    v_mfma_f32_16x16x32_bf16 v[100:103], v[172:175], v[204:207], v[100:103]
    v_mfma_f32_16x16x32_bf16 v[96:99], v[172:175], v[200:203], v[96:99]
    v_mfma_f32_16x16x32_bf16 v[88:91], v[168:171], v[200:203], v[88:91]
    v_mfma_f32_16x16x32_bf16 v[92:95], v[168:171], v[204:207], v[92:95]
    v_mfma_f32_16x16x32_bf16 v[84:87], v[164:167], v[204:207], v[84:87]
    v_mfma_f32_16x16x32_bf16 v[80:83], v[164:167], v[200:203], v[80:83]
    v_mfma_f32_16x16x32_bf16 v[116:119], v[180:183], v[200:203], v[116:119]
    s_waitcnt lgkmcnt(0)
    v_mfma_f32_16x16x32_bf16 v[16:19], v[140:143], v[120:123], v[16:19]
    ds_read_b128 v[164:167], v5 offset:0
    v_mfma_f32_16x16x32_bf16 v[20:23], v[144:147], v[120:123], v[20:23]
    ds_read_b128 v[168:171], v5 offset:2048
    v_mfma_f32_16x16x32_bf16 v[52:55], v[152:155], v[120:123], v[52:55]
    ds_read_b128 v[172:175], v5 offset:4096
    v_mfma_f32_16x16x32_bf16 v[48:51], v[148:151], v[120:123], v[48:51]
    ds_read_b128 v[176:179], v5 offset:6144
    v_mfma_f32_16x16x32_bf16 v[56:59], v[148:151], v[124:127], v[56:59]
    ds_read_b128 v[180:183], v3 offset:0
    v_mfma_f32_16x16x32_bf16 v[60:63], v[152:155], v[124:127], v[60:63]
    ds_read_b64_tr_b16 v[184:185], v6 offset:12288
    v_mfma_f32_16x16x32_bf16 v[28:31], v[144:147], v[124:127], v[28:31]
    ds_read_b64_tr_b16 v[186:187], v6 offset:12800
    v_mfma_f32_16x16x32_bf16 v[24:27], v[140:143], v[124:127], v[24:27]
    ds_read_b64_tr_b16 v[188:189], v7 offset:12288
    v_mfma_f32_16x16x32_bf16 v[32:35], v[140:143], v[128:131], v[32:35]
    ds_read_b64_tr_b16 v[190:191], v7 offset:12800
    v_mfma_f32_16x16x32_bf16 v[36:39], v[144:147], v[128:131], v[36:39]
    ds_read_b64_tr_b16 v[192:193], v6 offset:13312
    v_mfma_f32_16x16x32_bf16 v[68:71], v[152:155], v[128:131], v[68:71]
    ds_read_b64_tr_b16 v[194:195], v6 offset:13824
    v_mfma_f32_16x16x32_bf16 v[64:67], v[148:151], v[128:131], v[64:67]
    ds_read_b64_tr_b16 v[196:197], v7 offset:13312
    v_mfma_f32_16x16x32_bf16 v[112:115], v[148:151], v[136:139], v[112:115]
    ds_read_b64_tr_b16 v[198:199], v7 offset:13824
    v_mfma_f32_16x16x32_bf16 v[72:75], v[148:151], v[132:135], v[72:75]
    ds_read_b64_tr_b16 v[200:201], v6 offset:14336
    v_mfma_f32_16x16x32_bf16 v[76:79], v[152:155], v[132:135], v[76:79]
    ds_read_b64_tr_b16 v[202:203], v6 offset:14848
    v_mfma_f32_16x16x32_bf16 v[44:47], v[144:147], v[132:135], v[44:47]
    ds_read_b64_tr_b16 v[204:205], v7 offset:14336
    v_mfma_f32_16x16x32_bf16 v[40:43], v[140:143], v[132:135], v[40:43]
    ds_read_b64_tr_b16 v[206:207], v7 offset:14848
    v_mfma_f32_16x16x32_bf16 v[104:107], v[132:135], v[156:159], v[104:107]
    v_mfma_f32_16x16x32_bf16 v[108:111], v[132:135], v[160:163], v[108:111]
    v_mfma_f32_16x16x32_bf16 v[100:103], v[128:131], v[160:163], v[100:103]
    v_mfma_f32_16x16x32_bf16 v[96:99], v[128:131], v[156:159], v[96:99]
    v_mfma_f32_16x16x32_bf16 v[88:91], v[124:127], v[156:159], v[88:91]
    v_mfma_f32_16x16x32_bf16 v[92:95], v[124:127], v[160:163], v[92:95]
    v_mfma_f32_16x16x32_bf16 v[84:87], v[120:123], v[160:163], v[84:87]
    v_mfma_f32_16x16x32_bf16 v[80:83], v[120:123], v[156:159], v[80:83]
    v_mfma_f32_16x16x32_bf16 v[116:119], v[136:139], v[156:159], v[116:119]
    s_waitcnt lgkmcnt(0)
    s_barrier
    v_mfma_f32_16x16x32_bf16 v[16:19], v[184:187], v[164:167], v[16:19]
    ds_read_b128 v[120:123], v4 offset:18432
    v_mfma_f32_16x16x32_bf16 v[20:23], v[188:191], v[164:167], v[20:23]
    ds_read_b128 v[124:127], v4 offset:20480
    v_mfma_f32_16x16x32_bf16 v[52:55], v[196:199], v[164:167], v[52:55]
    ds_read_b128 v[128:131], v4 offset:22528
    v_mfma_f32_16x16x32_bf16 v[48:51], v[192:195], v[164:167], v[48:51]
    ds_read_b128 v[132:135], v4 offset:24576
    v_mfma_f32_16x16x32_bf16 v[56:59], v[192:195], v[168:171], v[56:59]
    ds_read_b128 v[136:139], v2 offset:18432
    v_mfma_f32_16x16x32_bf16 v[60:63], v[196:199], v[168:171], v[60:63]
    ds_read_b64_tr_b16 v[140:141], v6 offset:24576
    v_mfma_f32_16x16x32_bf16 v[28:31], v[188:191], v[168:171], v[28:31]
    ds_read_b64_tr_b16 v[142:143], v6 offset:25088
    v_mfma_f32_16x16x32_bf16 v[24:27], v[184:187], v[168:171], v[24:27]
    ds_read_b64_tr_b16 v[144:145], v7 offset:24576
    v_mfma_f32_16x16x32_bf16 v[32:35], v[184:187], v[172:175], v[32:35]
    ds_read_b64_tr_b16 v[146:147], v7 offset:25088
    v_mfma_f32_16x16x32_bf16 v[36:39], v[188:191], v[172:175], v[36:39]
    ds_read_b64_tr_b16 v[148:149], v6 offset:25600
    v_mfma_f32_16x16x32_bf16 v[68:71], v[196:199], v[172:175], v[68:71]
    ds_read_b64_tr_b16 v[150:151], v6 offset:26112
    v_mfma_f32_16x16x32_bf16 v[64:67], v[192:195], v[172:175], v[64:67]
    ds_read_b64_tr_b16 v[152:153], v7 offset:25600
    v_mfma_f32_16x16x32_bf16 v[112:115], v[192:195], v[180:183], v[112:115]
    ds_read_b64_tr_b16 v[154:155], v7 offset:26112
    v_mfma_f32_16x16x32_bf16 v[72:75], v[192:195], v[176:179], v[72:75]
    ds_read_b64_tr_b16 v[156:157], v6 offset:26624
    v_mfma_f32_16x16x32_bf16 v[76:79], v[196:199], v[176:179], v[76:79]
    ds_read_b64_tr_b16 v[158:159], v6 offset:27136
    v_mfma_f32_16x16x32_bf16 v[44:47], v[188:191], v[176:179], v[44:47]
    ds_read_b64_tr_b16 v[160:161], v7 offset:26624
    v_mfma_f32_16x16x32_bf16 v[40:43], v[184:187], v[176:179], v[40:43]
    ds_read_b64_tr_b16 v[162:163], v7 offset:27136
    v_mfma_f32_16x16x32_bf16 v[104:107], v[176:179], v[200:203], v[104:107]
    v_mfma_f32_16x16x32_bf16 v[108:111], v[176:179], v[204:207], v[108:111]
    v_mfma_f32_16x16x32_bf16 v[100:103], v[172:175], v[204:207], v[100:103]
    v_mfma_f32_16x16x32_bf16 v[96:99], v[172:175], v[200:203], v[96:99]
    v_mfma_f32_16x16x32_bf16 v[88:91], v[168:171], v[200:203], v[88:91]
    v_mfma_f32_16x16x32_bf16 v[92:95], v[168:171], v[204:207], v[92:95]
    v_mfma_f32_16x16x32_bf16 v[84:87], v[164:167], v[204:207], v[84:87]
    v_mfma_f32_16x16x32_bf16 v[80:83], v[164:167], v[200:203], v[80:83]
    v_mfma_f32_16x16x32_bf16 v[116:119], v[180:183], v[200:203], v[116:119]
    s_waitcnt lgkmcnt(0)
    v_mfma_f32_16x16x32_bf16 v[16:19], v[140:143], v[120:123], v[16:19]
    ds_read_b128 v[164:167], v5 offset:18432
    v_mfma_f32_16x16x32_bf16 v[20:23], v[144:147], v[120:123], v[20:23]
    ds_read_b128 v[168:171], v5 offset:20480
    v_mfma_f32_16x16x32_bf16 v[52:55], v[152:155], v[120:123], v[52:55]
    ds_read_b128 v[172:175], v5 offset:22528
    v_mfma_f32_16x16x32_bf16 v[48:51], v[148:151], v[120:123], v[48:51]
    ds_read_b128 v[176:179], v5 offset:24576
    v_mfma_f32_16x16x32_bf16 v[56:59], v[148:151], v[124:127], v[56:59]
    ds_read_b128 v[180:183], v3 offset:18432
    v_mfma_f32_16x16x32_bf16 v[60:63], v[152:155], v[124:127], v[60:63]
    ds_read_b64_tr_b16 v[184:185], v6 offset:36864
    v_mfma_f32_16x16x32_bf16 v[28:31], v[144:147], v[124:127], v[28:31]
    ds_read_b64_tr_b16 v[186:187], v6 offset:37376
    v_mfma_f32_16x16x32_bf16 v[24:27], v[140:143], v[124:127], v[24:27]
    ds_read_b64_tr_b16 v[188:189], v7 offset:36864
    v_mfma_f32_16x16x32_bf16 v[32:35], v[140:143], v[128:131], v[32:35]
    ds_read_b64_tr_b16 v[190:191], v7 offset:37376
    v_mfma_f32_16x16x32_bf16 v[36:39], v[144:147], v[128:131], v[36:39]
    ds_read_b64_tr_b16 v[192:193], v6 offset:37888
    v_mfma_f32_16x16x32_bf16 v[68:71], v[152:155], v[128:131], v[68:71]
    ds_read_b64_tr_b16 v[194:195], v6 offset:38400
    v_mfma_f32_16x16x32_bf16 v[64:67], v[148:151], v[128:131], v[64:67]
    ds_read_b64_tr_b16 v[196:197], v7 offset:37888
    v_mfma_f32_16x16x32_bf16 v[112:115], v[148:151], v[136:139], v[112:115]
    ds_read_b64_tr_b16 v[198:199], v7 offset:38400
    v_mfma_f32_16x16x32_bf16 v[72:75], v[148:151], v[132:135], v[72:75]
    ds_read_b64_tr_b16 v[200:201], v6 offset:38912
    v_mfma_f32_16x16x32_bf16 v[76:79], v[152:155], v[132:135], v[76:79]
    ds_read_b64_tr_b16 v[202:203], v6 offset:39424
    v_mfma_f32_16x16x32_bf16 v[44:47], v[144:147], v[132:135], v[44:47]
    ds_read_b64_tr_b16 v[204:205], v7 offset:38912
    v_mfma_f32_16x16x32_bf16 v[40:43], v[140:143], v[132:135], v[40:43]
    ds_read_b64_tr_b16 v[206:207], v7 offset:39424
    v_mfma_f32_16x16x32_bf16 v[104:107], v[132:135], v[156:159], v[104:107]
    v_mfma_f32_16x16x32_bf16 v[108:111], v[132:135], v[160:163], v[108:111]
    v_mfma_f32_16x16x32_bf16 v[100:103], v[128:131], v[160:163], v[100:103]
    v_mfma_f32_16x16x32_bf16 v[96:99], v[128:131], v[156:159], v[96:99]
    v_mfma_f32_16x16x32_bf16 v[88:91], v[124:127], v[156:159], v[88:91]
    v_mfma_f32_16x16x32_bf16 v[92:95], v[124:127], v[160:163], v[92:95]
    v_mfma_f32_16x16x32_bf16 v[84:87], v[120:123], v[160:163], v[84:87]
    v_mfma_f32_16x16x32_bf16 v[80:83], v[120:123], v[156:159], v[80:83]
    v_mfma_f32_16x16x32_bf16 v[116:119], v[136:139], v[156:159], v[116:119]
    s_waitcnt lgkmcnt(0)
    s_barrier
    v_mfma_f32_16x16x32_bf16 v[16:19], v[184:187], v[164:167], v[16:19]
    ds_read_b128 v[120:123], v4 offset:36864
    v_mfma_f32_16x16x32_bf16 v[20:23], v[188:191], v[164:167], v[20:23]
    ds_read_b128 v[124:127], v4 offset:38912
    v_mfma_f32_16x16x32_bf16 v[52:55], v[196:199], v[164:167], v[52:55]
    ds_read_b128 v[128:131], v4 offset:40960
    v_mfma_f32_16x16x32_bf16 v[48:51], v[192:195], v[164:167], v[48:51]
    ds_read_b128 v[132:135], v4 offset:43008
    v_mfma_f32_16x16x32_bf16 v[56:59], v[192:195], v[168:171], v[56:59]
    ds_read_b128 v[136:139], v2 offset:36864
    v_mfma_f32_16x16x32_bf16 v[60:63], v[196:199], v[168:171], v[60:63]
    ds_read_b64_tr_b16 v[140:141], v6 offset:49152
    v_mfma_f32_16x16x32_bf16 v[28:31], v[188:191], v[168:171], v[28:31]
    ds_read_b64_tr_b16 v[142:143], v6 offset:49664
    v_mfma_f32_16x16x32_bf16 v[24:27], v[184:187], v[168:171], v[24:27]
    ds_read_b64_tr_b16 v[144:145], v7 offset:49152
    v_mfma_f32_16x16x32_bf16 v[32:35], v[184:187], v[172:175], v[32:35]
    ds_read_b64_tr_b16 v[146:147], v7 offset:49664
    v_mfma_f32_16x16x32_bf16 v[36:39], v[188:191], v[172:175], v[36:39]
    ds_read_b64_tr_b16 v[148:149], v6 offset:50176
    v_mfma_f32_16x16x32_bf16 v[68:71], v[196:199], v[172:175], v[68:71]
    ds_read_b64_tr_b16 v[150:151], v6 offset:50688
    v_mfma_f32_16x16x32_bf16 v[64:67], v[192:195], v[172:175], v[64:67]
    ds_read_b64_tr_b16 v[152:153], v7 offset:50176
    v_mfma_f32_16x16x32_bf16 v[112:115], v[192:195], v[180:183], v[112:115]
    ds_read_b64_tr_b16 v[154:155], v7 offset:50688
    v_mfma_f32_16x16x32_bf16 v[72:75], v[192:195], v[176:179], v[72:75]
    ds_read_b64_tr_b16 v[156:157], v6 offset:51200
    v_mfma_f32_16x16x32_bf16 v[76:79], v[196:199], v[176:179], v[76:79]
    ds_read_b64_tr_b16 v[158:159], v6 offset:51712
    v_mfma_f32_16x16x32_bf16 v[44:47], v[188:191], v[176:179], v[44:47]
    ds_read_b64_tr_b16 v[160:161], v7 offset:51200
    v_mfma_f32_16x16x32_bf16 v[40:43], v[184:187], v[176:179], v[40:43]
    ds_read_b64_tr_b16 v[162:163], v7 offset:51712
    v_mfma_f32_16x16x32_bf16 v[104:107], v[176:179], v[200:203], v[104:107]
    v_mfma_f32_16x16x32_bf16 v[108:111], v[176:179], v[204:207], v[108:111]
    v_mfma_f32_16x16x32_bf16 v[100:103], v[172:175], v[204:207], v[100:103]
    v_mfma_f32_16x16x32_bf16 v[96:99], v[172:175], v[200:203], v[96:99]
    v_mfma_f32_16x16x32_bf16 v[88:91], v[168:171], v[200:203], v[88:91]
    v_mfma_f32_16x16x32_bf16 v[92:95], v[168:171], v[204:207], v[92:95]
    v_mfma_f32_16x16x32_bf16 v[84:87], v[164:167], v[204:207], v[84:87]
    v_mfma_f32_16x16x32_bf16 v[80:83], v[164:167], v[200:203], v[80:83]
    v_mfma_f32_16x16x32_bf16 v[116:119], v[180:183], v[200:203], v[116:119]
    s_waitcnt lgkmcnt(0)
    v_mfma_f32_16x16x32_bf16 v[16:19], v[140:143], v[120:123], v[16:19]
    ds_read_b128 v[164:167], v5 offset:36864
    v_mfma_f32_16x16x32_bf16 v[20:23], v[144:147], v[120:123], v[20:23]
    ds_read_b128 v[168:171], v5 offset:38912
    v_mfma_f32_16x16x32_bf16 v[52:55], v[152:155], v[120:123], v[52:55]
    ds_read_b128 v[172:175], v5 offset:40960
    v_mfma_f32_16x16x32_bf16 v[48:51], v[148:151], v[120:123], v[48:51]
    ds_read_b128 v[176:179], v5 offset:43008
    v_mfma_f32_16x16x32_bf16 v[56:59], v[148:151], v[124:127], v[56:59]
    ds_read_b128 v[180:183], v3 offset:36864
    v_mfma_f32_16x16x32_bf16 v[60:63], v[152:155], v[124:127], v[60:63]
    ds_read_b64_tr_b16 v[184:185], v6 offset:61440
    v_mfma_f32_16x16x32_bf16 v[28:31], v[144:147], v[124:127], v[28:31]
    ds_read_b64_tr_b16 v[186:187], v6 offset:61952
    v_mfma_f32_16x16x32_bf16 v[24:27], v[140:143], v[124:127], v[24:27]
    ds_read_b64_tr_b16 v[188:189], v7 offset:61440
    v_mfma_f32_16x16x32_bf16 v[32:35], v[140:143], v[128:131], v[32:35]
    ds_read_b64_tr_b16 v[190:191], v7 offset:61952
    v_mfma_f32_16x16x32_bf16 v[36:39], v[144:147], v[128:131], v[36:39]
    ds_read_b64_tr_b16 v[192:193], v6 offset:62464
    v_mfma_f32_16x16x32_bf16 v[68:71], v[152:155], v[128:131], v[68:71]
    ds_read_b64_tr_b16 v[194:195], v6 offset:62976
    v_mfma_f32_16x16x32_bf16 v[64:67], v[148:151], v[128:131], v[64:67]
    ds_read_b64_tr_b16 v[196:197], v7 offset:62464
    v_mfma_f32_16x16x32_bf16 v[112:115], v[148:151], v[136:139], v[112:115]
    ds_read_b64_tr_b16 v[198:199], v7 offset:62976
    v_mfma_f32_16x16x32_bf16 v[72:75], v[148:151], v[132:135], v[72:75]
    ds_read_b64_tr_b16 v[200:201], v6 offset:63488
    v_mfma_f32_16x16x32_bf16 v[76:79], v[152:155], v[132:135], v[76:79]
    ds_read_b64_tr_b16 v[202:203], v6 offset:64000
    v_mfma_f32_16x16x32_bf16 v[44:47], v[144:147], v[132:135], v[44:47]
    ds_read_b64_tr_b16 v[204:205], v7 offset:63488
    v_mfma_f32_16x16x32_bf16 v[40:43], v[140:143], v[132:135], v[40:43]
    ds_read_b64_tr_b16 v[206:207], v7 offset:64000
    v_mfma_f32_16x16x32_bf16 v[104:107], v[132:135], v[156:159], v[104:107]
    v_mfma_f32_16x16x32_bf16 v[108:111], v[132:135], v[160:163], v[108:111]
    v_mfma_f32_16x16x32_bf16 v[100:103], v[128:131], v[160:163], v[100:103]
    v_mfma_f32_16x16x32_bf16 v[96:99], v[128:131], v[156:159], v[96:99]
    v_mfma_f32_16x16x32_bf16 v[88:91], v[124:127], v[156:159], v[88:91]
    v_mfma_f32_16x16x32_bf16 v[92:95], v[124:127], v[160:163], v[92:95]
    v_mfma_f32_16x16x32_bf16 v[84:87], v[120:123], v[160:163], v[84:87]
    v_mfma_f32_16x16x32_bf16 v[80:83], v[120:123], v[156:159], v[80:83]
    v_mfma_f32_16x16x32_bf16 v[116:119], v[136:139], v[156:159], v[116:119]
    s_waitcnt lgkmcnt(0)
    s_barrier
    v_mfma_f32_16x16x32_bf16 v[16:19], v[184:187], v[164:167], v[16:19]
    ds_read_b128 v[120:123], v4 offset:0
    v_mfma_f32_16x16x32_bf16 v[20:23], v[188:191], v[164:167], v[20:23]
    ds_read_b128 v[124:127], v4 offset:2048
    v_mfma_f32_16x16x32_bf16 v[52:55], v[196:199], v[164:167], v[52:55]
    ds_read_b128 v[128:131], v4 offset:4096
    v_mfma_f32_16x16x32_bf16 v[48:51], v[192:195], v[164:167], v[48:51]
    ds_read_b128 v[132:135], v4 offset:6144
    v_mfma_f32_16x16x32_bf16 v[56:59], v[192:195], v[168:171], v[56:59]
    ds_read_b128 v[136:139], v2 offset:0
    v_mfma_f32_16x16x32_bf16 v[60:63], v[196:199], v[168:171], v[60:63]
    ds_read_b64_tr_b16 v[140:141], v6 offset:0
    v_mfma_f32_16x16x32_bf16 v[28:31], v[188:191], v[168:171], v[28:31]
    ds_read_b64_tr_b16 v[142:143], v6 offset:512
    v_mfma_f32_16x16x32_bf16 v[24:27], v[184:187], v[168:171], v[24:27]
    ds_read_b64_tr_b16 v[144:145], v7 offset:0
    v_mfma_f32_16x16x32_bf16 v[32:35], v[184:187], v[172:175], v[32:35]
    ds_read_b64_tr_b16 v[146:147], v7 offset:512
    v_mfma_f32_16x16x32_bf16 v[36:39], v[188:191], v[172:175], v[36:39]
    ds_read_b64_tr_b16 v[148:149], v6 offset:1024
    v_mfma_f32_16x16x32_bf16 v[68:71], v[196:199], v[172:175], v[68:71]
    ds_read_b64_tr_b16 v[150:151], v6 offset:1536
    v_mfma_f32_16x16x32_bf16 v[64:67], v[192:195], v[172:175], v[64:67]
    ds_read_b64_tr_b16 v[152:153], v7 offset:1024
    v_mfma_f32_16x16x32_bf16 v[112:115], v[192:195], v[180:183], v[112:115]
    ds_read_b64_tr_b16 v[154:155], v7 offset:1536
    v_mfma_f32_16x16x32_bf16 v[72:75], v[192:195], v[176:179], v[72:75]
    ds_read_b64_tr_b16 v[156:157], v6 offset:2048
    v_mfma_f32_16x16x32_bf16 v[76:79], v[196:199], v[176:179], v[76:79]
    ds_read_b64_tr_b16 v[158:159], v6 offset:2560
    v_mfma_f32_16x16x32_bf16 v[44:47], v[188:191], v[176:179], v[44:47]
    ds_read_b64_tr_b16 v[160:161], v7 offset:2048
    v_mfma_f32_16x16x32_bf16 v[40:43], v[184:187], v[176:179], v[40:43]
    ds_read_b64_tr_b16 v[162:163], v7 offset:2560
    v_mfma_f32_16x16x32_bf16 v[104:107], v[176:179], v[200:203], v[104:107]
    v_mfma_f32_16x16x32_bf16 v[108:111], v[176:179], v[204:207], v[108:111]
    v_mfma_f32_16x16x32_bf16 v[100:103], v[172:175], v[204:207], v[100:103]
    v_mfma_f32_16x16x32_bf16 v[96:99], v[172:175], v[200:203], v[96:99]
    v_mfma_f32_16x16x32_bf16 v[88:91], v[168:171], v[200:203], v[88:91]
    v_mfma_f32_16x16x32_bf16 v[92:95], v[168:171], v[204:207], v[92:95]
    v_mfma_f32_16x16x32_bf16 v[84:87], v[164:167], v[204:207], v[84:87]
    v_mfma_f32_16x16x32_bf16 v[80:83], v[164:167], v[200:203], v[80:83]
    v_mfma_f32_16x16x32_bf16 v[116:119], v[180:183], v[200:203], v[116:119]
    s_waitcnt lgkmcnt(0)
    v_mfma_f32_16x16x32_bf16 v[16:19], v[140:143], v[120:123], v[16:19]
    ds_read_b128 v[164:167], v5 offset:0
    v_mfma_f32_16x16x32_bf16 v[20:23], v[144:147], v[120:123], v[20:23]
    ds_read_b128 v[168:171], v5 offset:2048
    v_mfma_f32_16x16x32_bf16 v[52:55], v[152:155], v[120:123], v[52:55]
    ds_read_b128 v[172:175], v5 offset:4096
    v_mfma_f32_16x16x32_bf16 v[48:51], v[148:151], v[120:123], v[48:51]
    ds_read_b128 v[176:179], v5 offset:6144
    v_mfma_f32_16x16x32_bf16 v[56:59], v[148:151], v[124:127], v[56:59]
    ds_read_b128 v[180:183], v3 offset:0
    v_mfma_f32_16x16x32_bf16 v[60:63], v[152:155], v[124:127], v[60:63]
    ds_read_b64_tr_b16 v[184:185], v6 offset:12288
    v_mfma_f32_16x16x32_bf16 v[28:31], v[144:147], v[124:127], v[28:31]
    ds_read_b64_tr_b16 v[186:187], v6 offset:12800
    v_mfma_f32_16x16x32_bf16 v[24:27], v[140:143], v[124:127], v[24:27]
    ds_read_b64_tr_b16 v[188:189], v7 offset:12288
    v_mfma_f32_16x16x32_bf16 v[32:35], v[140:143], v[128:131], v[32:35]
    ds_read_b64_tr_b16 v[190:191], v7 offset:12800
    v_mfma_f32_16x16x32_bf16 v[36:39], v[144:147], v[128:131], v[36:39]
    ds_read_b64_tr_b16 v[192:193], v6 offset:13312
    v_mfma_f32_16x16x32_bf16 v[68:71], v[152:155], v[128:131], v[68:71]
    ds_read_b64_tr_b16 v[194:195], v6 offset:13824
    v_mfma_f32_16x16x32_bf16 v[64:67], v[148:151], v[128:131], v[64:67]
    ds_read_b64_tr_b16 v[196:197], v7 offset:13312
    v_mfma_f32_16x16x32_bf16 v[112:115], v[148:151], v[136:139], v[112:115]
    ds_read_b64_tr_b16 v[198:199], v7 offset:13824
    v_mfma_f32_16x16x32_bf16 v[72:75], v[148:151], v[132:135], v[72:75]
    ds_read_b64_tr_b16 v[200:201], v6 offset:14336
    v_mfma_f32_16x16x32_bf16 v[76:79], v[152:155], v[132:135], v[76:79]
    ds_read_b64_tr_b16 v[202:203], v6 offset:14848
    v_mfma_f32_16x16x32_bf16 v[44:47], v[144:147], v[132:135], v[44:47]
    ds_read_b64_tr_b16 v[204:205], v7 offset:14336
    v_mfma_f32_16x16x32_bf16 v[40:43], v[140:143], v[132:135], v[40:43]
    ds_read_b64_tr_b16 v[206:207], v7 offset:14848
    v_mfma_f32_16x16x32_bf16 v[104:107], v[132:135], v[156:159], v[104:107]
    buffer_load_dword v222, v220, s[68:71], s98 offen sc1
    v_mfma_f32_16x16x32_bf16 v[108:111], v[132:135], v[160:163], v[108:111]
    v_mfma_f32_16x16x32_bf16 v[100:103], v[128:131], v[160:163], v[100:103]
    v_mfma_f32_16x16x32_bf16 v[96:99], v[128:131], v[156:159], v[96:99]
    v_mfma_f32_16x16x32_bf16 v[88:91], v[124:127], v[156:159], v[88:91]
    v_mfma_f32_16x16x32_bf16 v[92:95], v[124:127], v[160:163], v[92:95]
    v_mfma_f32_16x16x32_bf16 v[84:87], v[120:123], v[160:163], v[84:87]
    v_mfma_f32_16x16x32_bf16 v[80:83], v[120:123], v[156:159], v[80:83]
    v_mfma_f32_16x16x32_bf16 v[116:119], v[136:139], v[156:159], v[116:119]
    s_waitcnt lgkmcnt(0)
    s_barrier
    v_mfma_f32_16x16x32_bf16 v[16:19], v[184:187], v[164:167], v[16:19]
    ds_read_b128 v[120:123], v4 offset:18432
    v_mfma_f32_16x16x32_bf16 v[20:23], v[188:191], v[164:167], v[20:23]
    ds_read_b128 v[124:127], v4 offset:20480
    v_mfma_f32_16x16x32_bf16 v[52:55], v[196:199], v[164:167], v[52:55]
    ds_read_b128 v[128:131], v4 offset:22528
    v_mfma_f32_16x16x32_bf16 v[48:51], v[192:195], v[164:167], v[48:51]
    ds_read_b128 v[132:135], v4 offset:24576
    v_mfma_f32_16x16x32_bf16 v[56:59], v[192:195], v[168:171], v[56:59]
    ds_read_b128 v[136:139], v2 offset:18432
    v_mfma_f32_16x16x32_bf16 v[60:63], v[196:199], v[168:171], v[60:63]
    ds_read_b64_tr_b16 v[140:141], v6 offset:24576
    v_mfma_f32_16x16x32_bf16 v[28:31], v[188:191], v[168:171], v[28:31]
    ds_read_b64_tr_b16 v[142:143], v6 offset:25088
    v_mfma_f32_16x16x32_bf16 v[24:27], v[184:187], v[168:171], v[24:27]
    ds_read_b64_tr_b16 v[144:145], v7 offset:24576
    v_mfma_f32_16x16x32_bf16 v[32:35], v[184:187], v[172:175], v[32:35]
    ds_read_b64_tr_b16 v[146:147], v7 offset:25088
    v_mfma_f32_16x16x32_bf16 v[36:39], v[188:191], v[172:175], v[36:39]
    ds_read_b64_tr_b16 v[148:149], v6 offset:25600
    v_mfma_f32_16x16x32_bf16 v[68:71], v[196:199], v[172:175], v[68:71]
    ds_read_b64_tr_b16 v[150:151], v6 offset:26112
    v_mfma_f32_16x16x32_bf16 v[64:67], v[192:195], v[172:175], v[64:67]
    ds_read_b64_tr_b16 v[152:153], v7 offset:25600
    v_mfma_f32_16x16x32_bf16 v[112:115], v[192:195], v[180:183], v[112:115]
    ds_read_b64_tr_b16 v[154:155], v7 offset:26112
    v_mfma_f32_16x16x32_bf16 v[72:75], v[192:195], v[176:179], v[72:75]
    ds_read_b64_tr_b16 v[156:157], v6 offset:26624
    v_mfma_f32_16x16x32_bf16 v[76:79], v[196:199], v[176:179], v[76:79]
    ds_read_b64_tr_b16 v[158:159], v6 offset:27136
    v_mfma_f32_16x16x32_bf16 v[44:47], v[188:191], v[176:179], v[44:47]
    ds_read_b64_tr_b16 v[160:161], v7 offset:26624
    v_mfma_f32_16x16x32_bf16 v[40:43], v[184:187], v[176:179], v[40:43]
    ds_read_b64_tr_b16 v[162:163], v7 offset:27136
    v_mfma_f32_16x16x32_bf16 v[104:107], v[176:179], v[200:203], v[104:107]
    v_mfma_f32_16x16x32_bf16 v[108:111], v[176:179], v[204:207], v[108:111]
    v_mfma_f32_16x16x32_bf16 v[100:103], v[172:175], v[204:207], v[100:103]
    v_mfma_f32_16x16x32_bf16 v[96:99], v[172:175], v[200:203], v[96:99]
    v_mfma_f32_16x16x32_bf16 v[88:91], v[168:171], v[200:203], v[88:91]
    v_mfma_f32_16x16x32_bf16 v[92:95], v[168:171], v[204:207], v[92:95]
    v_mfma_f32_16x16x32_bf16 v[84:87], v[164:167], v[204:207], v[84:87]
    v_mfma_f32_16x16x32_bf16 v[80:83], v[164:167], v[200:203], v[80:83]
    v_mfma_f32_16x16x32_bf16 v[116:119], v[180:183], v[200:203], v[116:119]
    s_waitcnt lgkmcnt(0)
    v_mfma_f32_16x16x32_bf16 v[16:19], v[140:143], v[120:123], v[16:19]
    ds_read_b128 v[164:167], v5 offset:18432
    v_mfma_f32_16x16x32_bf16 v[20:23], v[144:147], v[120:123], v[20:23]
    ds_read_b128 v[168:171], v5 offset:20480
    v_mfma_f32_16x16x32_bf16 v[52:55], v[152:155], v[120:123], v[52:55]
    ds_read_b128 v[172:175], v5 offset:22528
    v_mfma_f32_16x16x32_bf16 v[48:51], v[148:151], v[120:123], v[48:51]
    ds_read_b128 v[176:179], v5 offset:24576
    v_mfma_f32_16x16x32_bf16 v[56:59], v[148:151], v[124:127], v[56:59]
    ds_read_b128 v[180:183], v3 offset:18432
    v_mfma_f32_16x16x32_bf16 v[60:63], v[152:155], v[124:127], v[60:63]
    ds_read_b64_tr_b16 v[184:185], v6 offset:36864
    v_mfma_f32_16x16x32_bf16 v[28:31], v[144:147], v[124:127], v[28:31]
    ds_read_b64_tr_b16 v[186:187], v6 offset:37376
    v_mfma_f32_16x16x32_bf16 v[24:27], v[140:143], v[124:127], v[24:27]
    ds_read_b64_tr_b16 v[188:189], v7 offset:36864
    v_mfma_f32_16x16x32_bf16 v[32:35], v[140:143], v[128:131], v[32:35]
    ds_read_b64_tr_b16 v[190:191], v7 offset:37376
    v_mfma_f32_16x16x32_bf16 v[36:39], v[144:147], v[128:131], v[36:39]
    ds_read_b64_tr_b16 v[192:193], v6 offset:37888
    v_mfma_f32_16x16x32_bf16 v[68:71], v[152:155], v[128:131], v[68:71]
    ds_read_b64_tr_b16 v[194:195], v6 offset:38400
    v_mfma_f32_16x16x32_bf16 v[64:67], v[148:151], v[128:131], v[64:67]
    ds_read_b64_tr_b16 v[196:197], v7 offset:37888
    v_mfma_f32_16x16x32_bf16 v[112:115], v[148:151], v[136:139], v[112:115]
    ds_read_b64_tr_b16 v[198:199], v7 offset:38400
    v_mfma_f32_16x16x32_bf16 v[72:75], v[148:151], v[132:135], v[72:75]
    ds_read_b64_tr_b16 v[200:201], v6 offset:38912
    v_mfma_f32_16x16x32_bf16 v[76:79], v[152:155], v[132:135], v[76:79]
    ds_read_b64_tr_b16 v[202:203], v6 offset:39424
    v_mfma_f32_16x16x32_bf16 v[44:47], v[144:147], v[132:135], v[44:47]
    ds_read_b64_tr_b16 v[204:205], v7 offset:38912
    v_mfma_f32_16x16x32_bf16 v[40:43], v[140:143], v[132:135], v[40:43]
    ds_read_b64_tr_b16 v[206:207], v7 offset:39424
    v_mfma_f32_16x16x32_bf16 v[104:107], v[132:135], v[156:159], v[104:107]
    v_mfma_f32_16x16x32_bf16 v[108:111], v[132:135], v[160:163], v[108:111]
    v_mfma_f32_16x16x32_bf16 v[100:103], v[128:131], v[160:163], v[100:103]
    v_mfma_f32_16x16x32_bf16 v[96:99], v[128:131], v[156:159], v[96:99]
    v_mfma_f32_16x16x32_bf16 v[88:91], v[124:127], v[156:159], v[88:91]
    v_mfma_f32_16x16x32_bf16 v[92:95], v[124:127], v[160:163], v[92:95]
    v_mfma_f32_16x16x32_bf16 v[84:87], v[120:123], v[160:163], v[84:87]
    v_mfma_f32_16x16x32_bf16 v[80:83], v[120:123], v[156:159], v[80:83]
    v_mfma_f32_16x16x32_bf16 v[116:119], v[136:139], v[156:159], v[116:119]
    s_waitcnt lgkmcnt(0)
    s_barrier
    v_mfma_f32_16x16x32_bf16 v[16:19], v[184:187], v[164:167], v[16:19]
    ds_read_b128 v[120:123], v4 offset:36864
    v_mfma_f32_16x16x32_bf16 v[20:23], v[188:191], v[164:167], v[20:23]
    ds_read_b128 v[124:127], v4 offset:38912
    v_mfma_f32_16x16x32_bf16 v[52:55], v[196:199], v[164:167], v[52:55]
    ds_read_b128 v[128:131], v4 offset:40960
    v_mfma_f32_16x16x32_bf16 v[48:51], v[192:195], v[164:167], v[48:51]
    ds_read_b128 v[132:135], v4 offset:43008
    v_mfma_f32_16x16x32_bf16 v[56:59], v[192:195], v[168:171], v[56:59]
    ds_read_b128 v[136:139], v2 offset:36864
    v_mfma_f32_16x16x32_bf16 v[60:63], v[196:199], v[168:171], v[60:63]
    ds_read_b64_tr_b16 v[140:141], v6 offset:49152
    v_mfma_f32_16x16x32_bf16 v[28:31], v[188:191], v[168:171], v[28:31]
    ds_read_b64_tr_b16 v[142:143], v6 offset:49664
    v_mfma_f32_16x16x32_bf16 v[24:27], v[184:187], v[168:171], v[24:27]
    ds_read_b64_tr_b16 v[144:145], v7 offset:49152
    v_mfma_f32_16x16x32_bf16 v[32:35], v[184:187], v[172:175], v[32:35]
    ds_read_b64_tr_b16 v[146:147], v7 offset:49664
    v_mfma_f32_16x16x32_bf16 v[36:39], v[188:191], v[172:175], v[36:39]
    ds_read_b64_tr_b16 v[148:149], v6 offset:50176
    v_mfma_f32_16x16x32_bf16 v[68:71], v[196:199], v[172:175], v[68:71]
    ds_read_b64_tr_b16 v[150:151], v6 offset:50688
    v_mfma_f32_16x16x32_bf16 v[64:67], v[192:195], v[172:175], v[64:67]
    ds_read_b64_tr_b16 v[152:153], v7 offset:50176
    v_mfma_f32_16x16x32_bf16 v[112:115], v[192:195], v[180:183], v[112:115]
    ds_read_b64_tr_b16 v[154:155], v7 offset:50688
    v_mfma_f32_16x16x32_bf16 v[72:75], v[192:195], v[176:179], v[72:75]
    ds_read_b64_tr_b16 v[156:157], v6 offset:51200
    v_mfma_f32_16x16x32_bf16 v[76:79], v[196:199], v[176:179], v[76:79]
    ds_read_b64_tr_b16 v[158:159], v6 offset:51712
    v_mfma_f32_16x16x32_bf16 v[44:47], v[188:191], v[176:179], v[44:47]
    ds_read_b64_tr_b16 v[160:161], v7 offset:51200
    v_mfma_f32_16x16x32_bf16 v[40:43], v[184:187], v[176:179], v[40:43]
    ds_read_b64_tr_b16 v[162:163], v7 offset:51712
    v_mfma_f32_16x16x32_bf16 v[104:107], v[176:179], v[200:203], v[104:107]
    v_mfma_f32_16x16x32_bf16 v[108:111], v[176:179], v[204:207], v[108:111]
    v_mfma_f32_16x16x32_bf16 v[100:103], v[172:175], v[204:207], v[100:103]
    v_mfma_f32_16x16x32_bf16 v[96:99], v[172:175], v[200:203], v[96:99]
    v_mfma_f32_16x16x32_bf16 v[88:91], v[168:171], v[200:203], v[88:91]
    v_mfma_f32_16x16x32_bf16 v[92:95], v[168:171], v[204:207], v[92:95]
    v_mfma_f32_16x16x32_bf16 v[84:87], v[164:167], v[204:207], v[84:87]
    v_mfma_f32_16x16x32_bf16 v[80:83], v[164:167], v[200:203], v[80:83]
    v_mfma_f32_16x16x32_bf16 v[116:119], v[180:183], v[200:203], v[116:119]
    s_waitcnt lgkmcnt(0)
    v_mfma_f32_16x16x32_bf16 v[16:19], v[140:143], v[120:123], v[16:19]
    ds_read_b128 v[164:167], v5 offset:36864
    v_mfma_f32_16x16x32_bf16 v[20:23], v[144:147], v[120:123], v[20:23]
    ds_read_b128 v[168:171], v5 offset:38912
    v_mfma_f32_16x16x32_bf16 v[52:55], v[152:155], v[120:123], v[52:55]
    ds_read_b128 v[172:175], v5 offset:40960
    v_mfma_f32_16x16x32_bf16 v[48:51], v[148:151], v[120:123], v[48:51]
    ds_read_b128 v[176:179], v5 offset:43008
    v_mfma_f32_16x16x32_bf16 v[56:59], v[148:151], v[124:127], v[56:59]
    ds_read_b128 v[180:183], v3 offset:36864
    v_mfma_f32_16x16x32_bf16 v[60:63], v[152:155], v[124:127], v[60:63]
    ds_read_b64_tr_b16 v[184:185], v6 offset:61440
    v_mfma_f32_16x16x32_bf16 v[28:31], v[144:147], v[124:127], v[28:31]
    ds_read_b64_tr_b16 v[186:187], v6 offset:61952
    v_mfma_f32_16x16x32_bf16 v[24:27], v[140:143], v[124:127], v[24:27]
    ds_read_b64_tr_b16 v[188:189], v7 offset:61440
    v_mfma_f32_16x16x32_bf16 v[32:35], v[140:143], v[128:131], v[32:35]
    ds_read_b64_tr_b16 v[190:191], v7 offset:61952
    v_mfma_f32_16x16x32_bf16 v[36:39], v[144:147], v[128:131], v[36:39]
    ds_read_b64_tr_b16 v[192:193], v6 offset:62464
    v_mfma_f32_16x16x32_bf16 v[68:71], v[152:155], v[128:131], v[68:71]
    ds_read_b64_tr_b16 v[194:195], v6 offset:62976
    v_mfma_f32_16x16x32_bf16 v[64:67], v[148:151], v[128:131], v[64:67]
    ds_read_b64_tr_b16 v[196:197], v7 offset:62464
    v_mfma_f32_16x16x32_bf16 v[112:115], v[148:151], v[136:139], v[112:115]
    ds_read_b64_tr_b16 v[198:199], v7 offset:62976
    v_mfma_f32_16x16x32_bf16 v[72:75], v[148:151], v[132:135], v[72:75]
    ds_read_b64_tr_b16 v[200:201], v6 offset:63488
    v_mfma_f32_16x16x32_bf16 v[76:79], v[152:155], v[132:135], v[76:79]
    ds_read_b64_tr_b16 v[202:203], v6 offset:64000
    v_mfma_f32_16x16x32_bf16 v[44:47], v[144:147], v[132:135], v[44:47]
    ds_read_b64_tr_b16 v[204:205], v7 offset:63488
    v_mfma_f32_16x16x32_bf16 v[40:43], v[140:143], v[132:135], v[40:43]
    ds_read_b64_tr_b16 v[206:207], v7 offset:64000
    v_mfma_f32_16x16x32_bf16 v[104:107], v[132:135], v[156:159], v[104:107]
    v_mfma_f32_16x16x32_bf16 v[108:111], v[132:135], v[160:163], v[108:111]
    v_mfma_f32_16x16x32_bf16 v[100:103], v[128:131], v[160:163], v[100:103]
    v_mfma_f32_16x16x32_bf16 v[96:99], v[128:131], v[156:159], v[96:99]
    v_mfma_f32_16x16x32_bf16 v[88:91], v[124:127], v[156:159], v[88:91]
    v_mfma_f32_16x16x32_bf16 v[92:95], v[124:127], v[160:163], v[92:95]
    v_mfma_f32_16x16x32_bf16 v[84:87], v[120:123], v[160:163], v[84:87]
    v_mfma_f32_16x16x32_bf16 v[80:83], v[120:123], v[156:159], v[80:83]
    v_mfma_f32_16x16x32_bf16 v[116:119], v[136:139], v[156:159], v[116:119]
    s_waitcnt lgkmcnt(0)
    s_barrier
    s_cmp_lg_u32 s3, 0
    s_cbranch_scc1 LB_sk
    s_waitcnt vmcnt(0)
    v_cmp_eq_u32 vcc, 0, v222
    s_cbranch_vccnz LB_slow
LB_back:
    s_mov_b64 exec, 1
    buffer_store_dword v222, v220, s[52:55], s96 offen sc1
    s_mov_b64 exec, -1
LB_sk:
    v_mfma_f32_16x16x32_bf16 v[16:19], v[184:187], v[164:167], v[16:19]
    ds_read_b128 v[120:123], v4 offset:0
    v_mfma_f32_16x16x32_bf16 v[20:23], v[188:191], v[164:167], v[20:23]
    ds_read_b128 v[124:127], v4 offset:2048
    v_mfma_f32_16x16x32_bf16 v[52:55], v[196:199], v[164:167], v[52:55]
    ds_read_b128 v[128:131], v4 offset:4096
    v_mfma_f32_16x16x32_bf16 v[48:51], v[192:195], v[164:167], v[48:51]
    ds_read_b128 v[132:135], v4 offset:6144
    v_mfma_f32_16x16x32_bf16 v[56:59], v[192:195], v[168:171], v[56:59]
    ds_read_b128 v[136:139], v2 offset:0
    v_mfma_f32_16x16x32_bf16 v[60:63], v[196:199], v[168:171], v[60:63]
    ds_read_b64_tr_b16 v[140:141], v6 offset:0
    v_mfma_f32_16x16x32_bf16 v[28:31], v[188:191], v[168:171], v[28:31]
    ds_read_b64_tr_b16 v[142:143], v6 offset:512
    v_mfma_f32_16x16x32_bf16 v[24:27], v[184:187], v[168:171], v[24:27]
    ds_read_b64_tr_b16 v[144:145], v7 offset:0
    v_mfma_f32_16x16x32_bf16 v[32:35], v[184:187], v[172:175], v[32:35]
    ds_read_b64_tr_b16 v[146:147], v7 offset:512
    v_mfma_f32_16x16x32_bf16 v[36:39], v[188:191], v[172:175], v[36:39]
    ds_read_b64_tr_b16 v[148:149], v6 offset:1024
    v_mfma_f32_16x16x32_bf16 v[68:71], v[196:199], v[172:175], v[68:71]
    ds_read_b64_tr_b16 v[150:151], v6 offset:1536
    v_mfma_f32_16x16x32_bf16 v[64:67], v[192:195], v[172:175], v[64:67]
    ds_read_b64_tr_b16 v[152:153], v7 offset:1024
    v_mfma_f32_16x16x32_bf16 v[112:115], v[192:195], v[180:183], v[112:115]
    ds_read_b64_tr_b16 v[154:155], v7 offset:1536
    v_mfma_f32_16x16x32_bf16 v[72:75], v[192:195], v[176:179], v[72:75]
    ds_read_b64_tr_b16 v[156:157], v6 offset:2048
    v_mfma_f32_16x16x32_bf16 v[76:79], v[196:199], v[176:179], v[76:79]
    ds_read_b64_tr_b16 v[158:159], v6 offset:2560
    v_mfma_f32_16x16x32_bf16 v[44:47], v[188:191], v[176:179], v[44:47]
    ds_read_b64_tr_b16 v[160:161], v7 offset:2048
    v_mfma_f32_16x16x32_bf16 v[40:43], v[184:187], v[176:179], v[40:43]
    ds_read_b64_tr_b16 v[162:163], v7 offset:2560
    v_mfma_f32_16x16x32_bf16 v[104:107], v[176:179], v[200:203], v[104:107]
    v_mfma_f32_16x16x32_bf16 v[108:111], v[176:179], v[204:207], v[108:111]
    v_mfma_f32_16x16x32_bf16 v[100:103], v[172:175], v[204:207], v[100:103]
    v_mfma_f32_16x16x32_bf16 v[96:99], v[172:175], v[200:203], v[96:99]
    v_mfma_f32_16x16x32_bf16 v[88:91], v[168:171], v[200:203], v[88:91]
    v_mfma_f32_16x16x32_bf16 v[92:95], v[168:171], v[204:207], v[92:95]
    v_mfma_f32_16x16x32_bf16 v[84:87], v[164:167], v[204:207], v[84:87]
    v_mfma_f32_16x16x32_bf16 v[80:83], v[164:167], v[200:203], v[80:83]
    v_mfma_f32_16x16x32_bf16 v[116:119], v[180:183], v[200:203], v[116:119]
    s_waitcnt lgkmcnt(0)
    v_mfma_f32_16x16x32_bf16 v[16:19], v[140:143], v[120:123], v[16:19]
    ds_read_b128 v[164:167], v5 offset:0
    v_mfma_f32_16x16x32_bf16 v[20:23], v[144:147], v[120:123], v[20:23]
    ds_read_b128 v[168:171], v5 offset:2048
    v_mfma_f32_16x16x32_bf16 v[52:55], v[152:155], v[120:123], v[52:55]
    ds_read_b128 v[172:175], v5 offset:4096
    v_mfma_f32_16x16x32_bf16 v[48:51], v[148:151], v[120:123], v[48:51]
    ds_read_b128 v[176:179], v5 offset:6144
    v_mfma_f32_16x16x32_bf16 v[56:59], v[148:151], v[124:127], v[56:59]
    ds_read_b128 v[180:183], v3 offset:0
    v_mfma_f32_16x16x32_bf16 v[60:63], v[152:155], v[124:127], v[60:63]
    ds_read_b64_tr_b16 v[184:185], v6 offset:12288
    v_mfma_f32_16x16x32_bf16 v[28:31], v[144:147], v[124:127], v[28:31]
    ds_read_b64_tr_b16 v[186:187], v6 offset:12800
    v_mfma_f32_16x16x32_bf16 v[24:27], v[140:143], v[124:127], v[24:27]
    ds_read_b64_tr_b16 v[188:189], v7 offset:12288
    v_mfma_f32_16x16x32_bf16 v[32:35], v[140:143], v[128:131], v[32:35]
    ds_read_b64_tr_b16 v[190:191], v7 offset:12800
    v_mfma_f32_16x16x32_bf16 v[36:39], v[144:147], v[128:131], v[36:39]
    ds_read_b64_tr_b16 v[192:193], v6 offset:13312
    v_mfma_f32_16x16x32_bf16 v[68:71], v[152:155], v[128:131], v[68:71]
    ds_read_b64_tr_b16 v[194:195], v6 offset:13824
    v_mfma_f32_16x16x32_bf16 v[64:67], v[148:151], v[128:131], v[64:67]
    ds_read_b64_tr_b16 v[196:197], v7 offset:13312
    v_mfma_f32_16x16x32_bf16 v[112:115], v[148:151], v[136:139], v[112:115]
    ds_read_b64_tr_b16 v[198:199], v7 offset:13824
    v_mfma_f32_16x16x32_bf16 v[72:75], v[148:151], v[132:135], v[72:75]
    ds_read_b64_tr_b16 v[200:201], v6 offset:14336
    v_mfma_f32_16x16x32_bf16 v[76:79], v[152:155], v[132:135], v[76:79]
    ds_read_b64_tr_b16 v[202:203], v6 offset:14848
    v_mfma_f32_16x16x32_bf16 v[44:47], v[144:147], v[132:135], v[44:47]
    ds_read_b64_tr_b16 v[204:205], v7 offset:14336
    v_mfma_f32_16x16x32_bf16 v[40:43], v[140:143], v[132:135], v[40:43]
    ds_read_b64_tr_b16 v[206:207], v7 offset:14848
    v_mfma_f32_16x16x32_bf16 v[104:107], v[132:135], v[156:159], v[104:107]
    v_mfma_f32_16x16x32_bf16 v[108:111], v[132:135], v[160:163], v[108:111]
    v_mfma_f32_16x16x32_bf16 v[100:103], v[128:131], v[160:163], v[100:103]
    v_mfma_f32_16x16x32_bf16 v[96:99], v[128:131], v[156:159], v[96:99]
    v_mfma_f32_16x16x32_bf16 v[88:91], v[124:127], v[156:159], v[88:91]
    v_mfma_f32_16x16x32_bf16 v[92:95], v[124:127], v[160:163], v[92:95]
    v_mfma_f32_16x16x32_bf16 v[84:87], v[120:123], v[160:163], v[84:87]
    v_mfma_f32_16x16x32_bf16 v[80:83], v[120:123], v[156:159], v[80:83]
    v_mfma_f32_16x16x32_bf16 v[116:119], v[136:139], v[156:159], v[116:119]
    s_waitcnt lgkmcnt(0)
    s_barrier
    v_mfma_f32_16x16x32_bf16 v[16:19], v[184:187], v[164:167], v[16:19]
    ds_read_b128 v[120:123], v4 offset:18432
    v_mfma_f32_16x16x32_bf16 v[20:23], v[188:191], v[164:167], v[20:23]
    ds_read_b128 v[124:127], v4 offset:20480
    v_mfma_f32_16x16x32_bf16 v[52:55], v[196:199], v[164:167], v[52:55]
    ds_read_b128 v[128:131], v4 offset:22528
    v_mfma_f32_16x16x32_bf16 v[48:51], v[192:195], v[164:167], v[48:51]
    ds_read_b128 v[132:135], v4 offset:24576
    v_mfma_f32_16x16x32_bf16 v[56:59], v[192:195], v[168:171], v[56:59]
    ds_read_b128 v[136:139], v2 offset:18432
    v_mfma_f32_16x16x32_bf16 v[60:63], v[196:199], v[168:171], v[60:63]
    ds_read_b64_tr_b16 v[140:141], v6 offset:24576
    v_mfma_f32_16x16x32_bf16 v[28:31], v[188:191], v[168:171], v[28:31]
    ds_read_b64_tr_b16 v[142:143], v6 offset:25088
    v_mfma_f32_16x16x32_bf16 v[24:27], v[184:187], v[168:171], v[24:27]
    ds_read_b64_tr_b16 v[144:145], v7 offset:24576
    v_mfma_f32_16x16x32_bf16 v[32:35], v[184:187], v[172:175], v[32:35]
    ds_read_b64_tr_b16 v[146:147], v7 offset:25088
    v_mfma_f32_16x16x32_bf16 v[36:39], v[188:191], v[172:175], v[36:39]
    ds_read_b64_tr_b16 v[148:149], v6 offset:25600
    v_mfma_f32_16x16x32_bf16 v[68:71], v[196:199], v[172:175], v[68:71]
    ds_read_b64_tr_b16 v[150:151], v6 offset:26112
    v_mfma_f32_16x16x32_bf16 v[64:67], v[192:195], v[172:175], v[64:67]
    ds_read_b64_tr_b16 v[152:153], v7 offset:25600
    v_mfma_f32_16x16x32_bf16 v[112:115], v[192:195], v[180:183], v[112:115]
    ds_read_b64_tr_b16 v[154:155], v7 offset:26112
    v_mfma_f32_16x16x32_bf16 v[72:75], v[192:195], v[176:179], v[72:75]
    ds_read_b64_tr_b16 v[156:157], v6 offset:26624
    v_mfma_f32_16x16x32_bf16 v[76:79], v[196:199], v[176:179], v[76:79]
    ds_read_b64_tr_b16 v[158:159], v6 offset:27136
    v_mfma_f32_16x16x32_bf16 v[44:47], v[188:191], v[176:179], v[44:47]
    ds_read_b64_tr_b16 v[160:161], v7 offset:26624
    v_mfma_f32_16x16x32_bf16 v[40:43], v[184:187], v[176:179], v[40:43]
    ds_read_b64_tr_b16 v[162:163], v7 offset:27136
    v_mfma_f32_16x16x32_bf16 v[104:107], v[176:179], v[200:203], v[104:107]
    v_mfma_f32_16x16x32_bf16 v[108:111], v[176:179], v[204:207], v[108:111]
    v_mfma_f32_16x16x32_bf16 v[100:103], v[172:175], v[204:207], v[100:103]
    v_mfma_f32_16x16x32_bf16 v[96:99], v[172:175], v[200:203], v[96:99]
    v_mfma_f32_16x16x32_bf16 v[88:91], v[168:171], v[200:203], v[88:91]
    v_mfma_f32_16x16x32_bf16 v[92:95], v[168:171], v[204:207], v[92:95]
    v_mfma_f32_16x16x32_bf16 v[84:87], v[164:167], v[204:207], v[84:87]
    v_mfma_f32_16x16x32_bf16 v[80:83], v[164:167], v[200:203], v[80:83]
    v_mfma_f32_16x16x32_bf16 v[116:119], v[180:183], v[200:203], v[116:119]
    s_waitcnt lgkmcnt(0)
    v_mfma_f32_16x16x32_bf16 v[16:19], v[140:143], v[120:123], v[16:19]
    ds_read_b128 v[164:167], v5 offset:18432
    v_mfma_f32_16x16x32_bf16 v[20:23], v[144:147], v[120:123], v[20:23]
    ds_read_b128 v[168:171], v5 offset:20480
    v_mfma_f32_16x16x32_bf16 v[52:55], v[152:155], v[120:123], v[52:55]
    ds_read_b128 v[172:175], v5 offset:22528
    v_mfma_f32_16x16x32_bf16 v[48:51], v[148:151], v[120:123], v[48:51]
    ds_read_b128 v[176:179], v5 offset:24576
    v_mfma_f32_16x16x32_bf16 v[56:59], v[148:151], v[124:127], v[56:59]
    ds_read_b128 v[180:183], v3 offset:18432
    v_mfma_f32_16x16x32_bf16 v[60:63], v[152:155], v[124:127], v[60:63]
    ds_read_b64_tr_b16 v[184:185], v6 offset:36864
    v_mfma_f32_16x16x32_bf16 v[28:31], v[144:147], v[124:127], v[28:31]
    ds_read_b64_tr_b16 v[186:187], v6 offset:37376
    v_mfma_f32_16x16x32_bf16 v[24:27], v[140:143], v[124:127], v[24:27]
    ds_read_b64_tr_b16 v[188:189], v7 offset:36864
    v_mfma_f32_16x16x32_bf16 v[32:35], v[140:143], v[128:131], v[32:35]
    ds_read_b64_tr_b16 v[190:191], v7 offset:37376
    v_mfma_f32_16x16x32_bf16 v[36:39], v[144:147], v[128:131], v[36:39]
    ds_read_b64_tr_b16 v[192:193], v6 offset:37888
    v_mfma_f32_16x16x32_bf16 v[68:71], v[152:155], v[128:131], v[68:71]
    ds_read_b64_tr_b16 v[194:195], v6 offset:38400
    v_mfma_f32_16x16x32_bf16 v[64:67], v[148:151], v[128:131], v[64:67]
    ds_read_b64_tr_b16 v[196:197], v7 offset:37888
    v_mfma_f32_16x16x32_bf16 v[112:115], v[148:151], v[136:139], v[112:115]
    ds_read_b64_tr_b16 v[198:199], v7 offset:38400
    v_mfma_f32_16x16x32_bf16 v[72:75], v[148:151], v[132:135], v[72:75]
    ds_read_b64_tr_b16 v[200:201], v6 offset:38912
    v_mfma_f32_16x16x32_bf16 v[76:79], v[152:155], v[132:135], v[76:79]
    ds_read_b64_tr_b16 v[202:203], v6 offset:39424
    v_mfma_f32_16x16x32_bf16 v[44:47], v[144:147], v[132:135], v[44:47]
    ds_read_b64_tr_b16 v[204:205], v7 offset:38912
    v_mfma_f32_16x16x32_bf16 v[40:43], v[140:143], v[132:135], v[40:43]
    ds_read_b64_tr_b16 v[206:207], v7 offset:39424
    v_mfma_f32_16x16x32_bf16 v[104:107], v[132:135], v[156:159], v[104:107]
    v_mfma_f32_16x16x32_bf16 v[108:111], v[132:135], v[160:163], v[108:111]
    v_mfma_f32_16x16x32_bf16 v[100:103], v[128:131], v[160:163], v[100:103]
    v_mfma_f32_16x16x32_bf16 v[96:99], v[128:131], v[156:159], v[96:99]
    v_mfma_f32_16x16x32_bf16 v[88:91], v[124:127], v[156:159], v[88:91]
    v_mfma_f32_16x16x32_bf16 v[92:95], v[124:127], v[160:163], v[92:95]
    v_mfma_f32_16x16x32_bf16 v[84:87], v[120:123], v[160:163], v[84:87]
    v_mfma_f32_16x16x32_bf16 v[80:83], v[120:123], v[156:159], v[80:83]
    v_mfma_f32_16x16x32_bf16 v[116:119], v[136:139], v[156:159], v[116:119]
    s_waitcnt lgkmcnt(0)
    s_barrier
    v_mfma_f32_16x16x32_bf16 v[16:19], v[184:187], v[164:167], v[16:19]
    ds_read_b128 v[120:123], v4 offset:36864
    v_mfma_f32_16x16x32_bf16 v[20:23], v[188:191], v[164:167], v[20:23]
    ds_read_b128 v[124:127], v4 offset:38912
    v_mfma_f32_16x16x32_bf16 v[52:55], v[196:199], v[164:167], v[52:55]
    ds_read_b128 v[128:131], v4 offset:40960
    v_mfma_f32_16x16x32_bf16 v[48:51], v[192:195], v[164:167], v[48:51]
    ds_read_b128 v[132:135], v4 offset:43008
    v_mfma_f32_16x16x32_bf16 v[56:59], v[192:195], v[168:171], v[56:59]
    ds_read_b128 v[136:139], v2 offset:36864
    v_mfma_f32_16x16x32_bf16 v[60:63], v[196:199], v[168:171], v[60:63]
    ds_read_b64_tr_b16 v[140:141], v6 offset:49152
    v_mfma_f32_16x16x32_bf16 v[28:31], v[188:191], v[168:171], v[28:31]
    ds_read_b64_tr_b16 v[142:143], v6 offset:49664
    v_mfma_f32_16x16x32_bf16 v[24:27], v[184:187], v[168:171], v[24:27]
    ds_read_b64_tr_b16 v[144:145], v7 offset:49152
    v_mfma_f32_16x16x32_bf16 v[32:35], v[184:187], v[172:175], v[32:35]
    ds_read_b64_tr_b16 v[146:147], v7 offset:49664
    v_mfma_f32_16x16x32_bf16 v[36:39], v[188:191], v[172:175], v[36:39]
    ds_read_b64_tr_b16 v[148:149], v6 offset:50176
    v_mfma_f32_16x16x32_bf16 v[68:71], v[196:199], v[172:175], v[68:71]
    ds_read_b64_tr_b16 v[150:151], v6 offset:50688
    v_mfma_f32_16x16x32_bf16 v[64:67], v[192:195], v[172:175], v[64:67]
    ds_read_b64_tr_b16 v[152:153], v7 offset:50176
    v_mfma_f32_16x16x32_bf16 v[112:115], v[192:195], v[180:183], v[112:115]
    ds_read_b64_tr_b16 v[154:155], v7 offset:50688
    v_mfma_f32_16x16x32_bf16 v[72:75], v[192:195], v[176:179], v[72:75]
    ds_read_b64_tr_b16 v[156:157], v6 offset:51200
    v_mfma_f32_16x16x32_bf16 v[76:79], v[196:199], v[176:179], v[76:79]
    ds_read_b64_tr_b16 v[158:159], v6 offset:51712
    v_mfma_f32_16x16x32_bf16 v[44:47], v[188:191], v[176:179], v[44:47]
    ds_read_b64_tr_b16 v[160:161], v7 offset:51200
    v_mfma_f32_16x16x32_bf16 v[40:43], v[184:187], v[176:179], v[40:43]
    ds_read_b64_tr_b16 v[162:163], v7 offset:51712
    v_mfma_f32_16x16x32_bf16 v[104:107], v[176:179], v[200:203], v[104:107]
    v_mfma_f32_16x16x32_bf16 v[108:111], v[176:179], v[204:207], v[108:111]
    v_mfma_f32_16x16x32_bf16 v[100:103], v[172:175], v[204:207], v[100:103]
    v_mfma_f32_16x16x32_bf16 v[96:99], v[172:175], v[200:203], v[96:99]
    v_mfma_f32_16x16x32_bf16 v[88:91], v[168:171], v[200:203], v[88:91]
    v_mfma_f32_16x16x32_bf16 v[92:95], v[168:171], v[204:207], v[92:95]
    v_mfma_f32_16x16x32_bf16 v[84:87], v[164:167], v[204:207], v[84:87]
    v_mfma_f32_16x16x32_bf16 v[80:83], v[164:167], v[200:203], v[80:83]
    v_mfma_f32_16x16x32_bf16 v[116:119], v[180:183], v[200:203], v[116:119]
    s_waitcnt lgkmcnt(0)
    v_mfma_f32_16x16x32_bf16 v[16:19], v[140:143], v[120:123], v[16:19]
    ds_read_b128 v[164:167], v5 offset:36864
    v_mfma_f32_16x16x32_bf16 v[20:23], v[144:147], v[120:123], v[20:23]
    ds_read_b128 v[168:171], v5 offset:38912
    v_mfma_f32_16x16x32_bf16 v[52:55], v[152:155], v[120:123], v[52:55]
    ds_read_b128 v[172:175], v5 offset:40960
    v_mfma_f32_16x16x32_bf16 v[48:51], v[148:151], v[120:123], v[48:51]
    ds_read_b128 v[176:179], v5 offset:43008
    v_mfma_f32_16x16x32_bf16 v[56:59], v[148:151], v[124:127], v[56:59]
    ds_read_b128 v[180:183], v3 offset:36864
    v_mfma_f32_16x16x32_bf16 v[60:63], v[152:155], v[124:127], v[60:63]
    ds_read_b64_tr_b16 v[184:185], v6 offset:61440
    v_mfma_f32_16x16x32_bf16 v[28:31], v[144:147], v[124:127], v[28:31]
    ds_read_b64_tr_b16 v[186:187], v6 offset:61952
    v_mfma_f32_16x16x32_bf16 v[24:27], v[140:143], v[124:127], v[24:27]
    ds_read_b64_tr_b16 v[188:189], v7 offset:61440
    v_mfma_f32_16x16x32_bf16 v[32:35], v[140:143], v[128:131], v[32:35]
    ds_read_b64_tr_b16 v[190:191], v7 offset:61952
    v_mfma_f32_16x16x32_bf16 v[36:39], v[144:147], v[128:131], v[36:39]
    ds_read_b64_tr_b16 v[192:193], v6 offset:62464
    v_mfma_f32_16x16x32_bf16 v[68:71], v[152:155], v[128:131], v[68:71]
    ds_read_b64_tr_b16 v[194:195], v6 offset:62976
    v_mfma_f32_16x16x32_bf16 v[64:67], v[148:151], v[128:131], v[64:67]
    ds_read_b64_tr_b16 v[196:197], v7 offset:62464
    v_mfma_f32_16x16x32_bf16 v[112:115], v[148:151], v[136:139], v[112:115]
    ds_read_b64_tr_b16 v[198:199], v7 offset:62976
    v_mfma_f32_16x16x32_bf16 v[72:75], v[148:151], v[132:135], v[72:75]
    ds_read_b64_tr_b16 v[200:201], v6 offset:63488
    v_mfma_f32_16x16x32_bf16 v[76:79], v[152:155], v[132:135], v[76:79]
    ds_read_b64_tr_b16 v[202:203], v6 offset:64000
    v_mfma_f32_16x16x32_bf16 v[44:47], v[144:147], v[132:135], v[44:47]
    ds_read_b64_tr_b16 v[204:205], v7 offset:63488
    v_mfma_f32_16x16x32_bf16 v[40:43], v[140:143], v[132:135], v[40:43]
    ds_read_b64_tr_b16 v[206:207], v7 offset:64000
    v_mfma_f32_16x16x32_bf16 v[104:107], v[132:135], v[156:159], v[104:107]
    s_nop 0
    v_mfma_f32_16x16x32_bf16 v[108:111], v[132:135], v[160:163], v[108:111]
    s_nop 0
    v_mfma_f32_16x16x32_bf16 v[100:103], v[128:131], v[160:163], v[100:103]
    s_nop 0
    v_mfma_f32_16x16x32_bf16 v[96:99], v[128:131], v[156:159], v[96:99]
    s_nop 0
    v_mfma_f32_16x16x32_bf16 v[88:91], v[124:127], v[156:159], v[88:91]
    ds_read_b32 v223, v10 offset:24
    v_mfma_f32_16x16x32_bf16 v[92:95], v[124:127], v[160:163], v[92:95]
    v_mfma_f32_16x16x32_bf16 v[84:87], v[120:123], v[160:163], v[84:87]
    v_mfma_f32_16x16x32_bf16 v[80:83], v[120:123], v[156:159], v[80:83]
    v_mfma_f32_16x16x32_bf16 v[116:119], v[136:139], v[156:159], v[116:119]
    s_waitcnt lgkmcnt(0)
    v_cmp_gt_u32 vcc, 4, v223
    s_cbranch_vccnz LB_w15
LB_g15:
    v_mfma_f32_16x16x32_bf16 v[16:19], v[184:187], v[164:167], v[16:19]
    ds_read_b128 v[120:123], v4 offset:0
    v_mfma_f32_16x16x32_bf16 v[20:23], v[188:191], v[164:167], v[20:23]
    ds_read_b128 v[124:127], v4 offset:2048
    v_mfma_f32_16x16x32_bf16 v[52:55], v[196:199], v[164:167], v[52:55]
    ds_read_b128 v[128:131], v4 offset:4096
    v_mfma_f32_16x16x32_bf16 v[48:51], v[192:195], v[164:167], v[48:51]
    ds_read_b128 v[132:135], v4 offset:6144
    v_mfma_f32_16x16x32_bf16 v[56:59], v[192:195], v[168:171], v[56:59]
    ds_read_b128 v[136:139], v2 offset:0
    v_mfma_f32_16x16x32_bf16 v[60:63], v[196:199], v[168:171], v[60:63]
    ds_read_b64_tr_b16 v[140:141], v6 offset:0
    v_mfma_f32_16x16x32_bf16 v[28:31], v[188:191], v[168:171], v[28:31]
    ds_read_b64_tr_b16 v[142:143], v6 offset:512
    v_mfma_f32_16x16x32_bf16 v[24:27], v[184:187], v[168:171], v[24:27]
    ds_read_b64_tr_b16 v[144:145], v7 offset:0
    v_mfma_f32_16x16x32_bf16 v[32:35], v[184:187], v[172:175], v[32:35]
    ds_read_b64_tr_b16 v[146:147], v7 offset:512
    v_mfma_f32_16x16x32_bf16 v[36:39], v[188:191], v[172:175], v[36:39]
    ds_read_b64_tr_b16 v[148:149], v6 offset:1024
    v_mfma_f32_16x16x32_bf16 v[68:71], v[196:199], v[172:175], v[68:71]
    ds_read_b64_tr_b16 v[150:151], v6 offset:1536
    v_mfma_f32_16x16x32_bf16 v[64:67], v[192:195], v[172:175], v[64:67]
    ds_read_b64_tr_b16 v[152:153], v7 offset:1024
    v_mfma_f32_16x16x32_bf16 v[112:115], v[192:195], v[180:183], v[112:115]
    ds_read_b64_tr_b16 v[154:155], v7 offset:1536
    v_mfma_f32_16x16x32_bf16 v[72:75], v[192:195], v[176:179], v[72:75]
    ds_read_b64_tr_b16 v[156:157], v6 offset:2048
    v_mfma_f32_16x16x32_bf16 v[76:79], v[196:199], v[176:179], v[76:79]
    ds_read_b64_tr_b16 v[158:159], v6 offset:2560
    v_mfma_f32_16x16x32_bf16 v[44:47], v[188:191], v[176:179], v[44:47]
    ds_read_b64_tr_b16 v[160:161], v7 offset:2048
    v_mfma_f32_16x16x32_bf16 v[40:43], v[184:187], v[176:179], v[40:43]
    ds_read_b64_tr_b16 v[162:163], v7 offset:2560
    v_mfma_f32_16x16x32_bf16 v[104:107], v[176:179], v[200:203], v[104:107]
    v_mfma_f32_16x16x32_bf16 v[108:111], v[176:179], v[204:207], v[108:111]
    v_mfma_f32_16x16x32_bf16 v[100:103], v[172:175], v[204:207], v[100:103]
    v_mfma_f32_16x16x32_bf16 v[96:99], v[172:175], v[200:203], v[96:99]
    v_mfma_f32_16x16x32_bf16 v[88:91], v[168:171], v[200:203], v[88:91]
    v_mfma_f32_16x16x32_bf16 v[92:95], v[168:171], v[204:207], v[92:95]
    v_mfma_f32_16x16x32_bf16 v[84:87], v[164:167], v[204:207], v[84:87]
    v_mfma_f32_16x16x32_bf16 v[80:83], v[164:167], v[200:203], v[80:83]
    v_mfma_f32_16x16x32_bf16 v[116:119], v[180:183], v[200:203], v[116:119]
    s_waitcnt lgkmcnt(0)
    v_mfma_f32_16x16x32_bf16 v[16:19], v[140:143], v[120:123], v[16:19]
    ds_read_b128 v[164:167], v5 offset:0
    v_mfma_f32_16x16x32_bf16 v[20:23], v[144:147], v[120:123], v[20:23]
    ds_read_b128 v[168:171], v5 offset:2048
    v_mfma_f32_16x16x32_bf16 v[52:55], v[152:155], v[120:123], v[52:55]
    ds_read_b128 v[172:175], v5 offset:4096
    v_mfma_f32_16x16x32_bf16 v[48:51], v[148:151], v[120:123], v[48:51]
    ds_read_b128 v[176:179], v5 offset:6144
    v_mfma_f32_16x16x32_bf16 v[56:59], v[148:151], v[124:127], v[56:59]
    ds_read_b128 v[180:183], v3 offset:0
    v_mfma_f32_16x16x32_bf16 v[60:63], v[152:155], v[124:127], v[60:63]
    ds_read_b64_tr_b16 v[184:185], v6 offset:12288
    v_mfma_f32_16x16x32_bf16 v[28:31], v[144:147], v[124:127], v[28:31]
    ds_read_b64_tr_b16 v[186:187], v6 offset:12800
    v_mfma_f32_16x16x32_bf16 v[24:27], v[140:143], v[124:127], v[24:27]
    ds_read_b64_tr_b16 v[188:189], v7 offset:12288
    v_mfma_f32_16x16x32_bf16 v[32:35], v[140:143], v[128:131], v[32:35]
    ds_read_b64_tr_b16 v[190:191], v7 offset:12800
    v_mfma_f32_16x16x32_bf16 v[36:39], v[144:147], v[128:131], v[36:39]
    ds_read_b64_tr_b16 v[192:193], v6 offset:13312
    v_mfma_f32_16x16x32_bf16 v[68:71], v[152:155], v[128:131], v[68:71]
    ds_read_b64_tr_b16 v[194:195], v6 offset:13824
    v_mfma_f32_16x16x32_bf16 v[64:67], v[148:151], v[128:131], v[64:67]
    ds_read_b64_tr_b16 v[196:197], v7 offset:13312
    v_mfma_f32_16x16x32_bf16 v[112:115], v[148:151], v[136:139], v[112:115]
    ds_read_b64_tr_b16 v[198:199], v7 offset:13824
    v_mfma_f32_16x16x32_bf16 v[72:75], v[148:151], v[132:135], v[72:75]
    ds_read_b64_tr_b16 v[200:201], v6 offset:14336
    v_mfma_f32_16x16x32_bf16 v[76:79], v[152:155], v[132:135], v[76:79]
    ds_read_b64_tr_b16 v[202:203], v6 offset:14848
    v_mfma_f32_16x16x32_bf16 v[44:47], v[144:147], v[132:135], v[44:47]
    ds_read_b64_tr_b16 v[204:205], v7 offset:14336
    v_mfma_f32_16x16x32_bf16 v[40:43], v[140:143], v[132:135], v[40:43]
    ds_read_b64_tr_b16 v[206:207], v7 offset:14848
    v_mfma_f32_16x16x32_bf16 v[104:107], v[132:135], v[156:159], v[104:107]
    v_mfma_f32_16x16x32_bf16 v[108:111], v[132:135], v[160:163], v[108:111]
    v_mfma_f32_16x16x32_bf16 v[100:103], v[128:131], v[160:163], v[100:103]
    v_mfma_f32_16x16x32_bf16 v[96:99], v[128:131], v[156:159], v[96:99]
    v_mfma_f32_16x16x32_bf16 v[88:91], v[124:127], v[156:159], v[88:91]
    v_mfma_f32_16x16x32_bf16 v[92:95], v[124:127], v[160:163], v[92:95]
    v_mfma_f32_16x16x32_bf16 v[84:87], v[120:123], v[160:163], v[84:87]
    v_mfma_f32_16x16x32_bf16 v[80:83], v[120:123], v[156:159], v[80:83]
    v_mfma_f32_16x16x32_bf16 v[116:119], v[136:139], v[156:159], v[116:119]
    s_waitcnt lgkmcnt(0)
    v_mfma_f32_16x16x32_bf16 v[112:115], v[192:195], v[180:183], v[112:115]
    v_mfma_f32_16x16x32_bf16 v[116:119], v[180:183], v[200:203], v[116:119]
    v_mfma_f32_16x16x32_bf16 v[72:75], v[192:195], v[176:179], v[72:75]
    v_mfma_f32_16x16x32_bf16 v[76:79], v[196:199], v[176:179], v[76:79]
    v_mfma_f32_16x16x32_bf16 v[104:107], v[176:179], v[200:203], v[104:107]
    v_mfma_f32_16x16x32_bf16 v[108:111], v[176:179], v[204:207], v[108:111]
    v_mfma_f32_16x16x32_bf16 v[40:43], v[184:187], v[176:179], v[40:43]
    v_mfma_f32_16x16x32_bf16 v[44:47], v[188:191], v[176:179], v[44:47]
    v_mfma_f32_16x16x32_bf16 v[64:67], v[192:195], v[172:175], v[64:67]
    v_mfma_f32_16x16x32_bf16 v[68:71], v[196:199], v[172:175], v[68:71]
    v_cvt_pk_bf16_f32 v156, v112, v113
    v_cvt_pk_bf16_f32 v157, v114, v115
    v_mfma_f32_16x16x32_bf16 v[32:35], v[184:187], v[172:175], v[32:35]
    v_cvt_pk_bf16_f32 v158, v116, v117
    v_cvt_pk_bf16_f32 v159, v118, v119
    v_mfma_f32_16x16x32_bf16 v[36:39], v[188:191], v[172:175], v[36:39]
    v_cvt_pk_bf16_f32 v152, v72, v73
    v_cvt_pk_bf16_f32 v153, v74, v75
    v_mfma_f32_16x16x32_bf16 v[56:59], v[192:195], v[168:171], v[56:59]
    v_cvt_pk_bf16_f32 v154, v76, v77
    v_cvt_pk_bf16_f32 v155, v78, v79
    v_mfma_f32_16x16x32_bf16 v[60:63], v[196:199], v[168:171], v[60:63]
    v_cvt_pk_bf16_f32 v232, v104, v105
    v_cvt_pk_bf16_f32 v233, v106, v107
    v_mfma_f32_16x16x32_bf16 v[24:27], v[184:187], v[168:171], v[24:27]
    v_cvt_pk_bf16_f32 v242, v108, v109
    v_cvt_pk_bf16_f32 v243, v110, v111
    v_mfma_f32_16x16x32_bf16 v[28:31], v[188:191], v[168:171], v[28:31]
    ds_write_b64 v216, v[156:157]
    ds_write_b64 v216, v[158:159] offset:1024
    v_mfma_f32_16x16x32_bf16 v[48:51], v[192:195], v[164:167], v[48:51]
    ds_write_b64 v217, v[152:153] offset:0
    ds_write_b64 v217, v[232:233] offset:1024
    v_mfma_f32_16x16x32_bf16 v[52:55], v[196:199], v[164:167], v[52:55]
    ds_write_b64 v217, v[154:155] offset:512
    ds_write_b64 v217, v[242:243] offset:1536
    v_mfma_f32_16x16x32_bf16 v[16:19], v[184:187], v[164:167], v[16:19]
    v_cvt_pk_bf16_f32 v132, v40, v41
    v_cvt_pk_bf16_f32 v133, v42, v43
    v_mfma_f32_16x16x32_bf16 v[20:23], v[188:191], v[164:167], v[20:23]
    v_cvt_pk_bf16_f32 v134, v44, v45
    v_cvt_pk_bf16_f32 v135, v46, v47
    v_mfma_f32_16x16x32_bf16 v[96:99], v[172:175], v[200:203], v[96:99]
    v_cvt_pk_bf16_f32 v148, v64, v65
    v_cvt_pk_bf16_f32 v149, v66, v67
    v_mfma_f32_16x16x32_bf16 v[100:103], v[172:175], v[204:207], v[100:103]
    v_cvt_pk_bf16_f32 v150, v68, v69
    v_cvt_pk_bf16_f32 v151, v70, v71
    v_mfma_f32_16x16x32_bf16 v[88:91], v[168:171], v[200:203], v[88:91]
    v_cvt_pk_bf16_f32 v128, v32, v33
    v_cvt_pk_bf16_f32 v129, v34, v35
    v_mfma_f32_16x16x32_bf16 v[92:95], v[168:171], v[204:207], v[92:95]
    v_cvt_pk_bf16_f32 v130, v36, v37
    v_cvt_pk_bf16_f32 v131, v38, v39
    v_mfma_f32_16x16x32_bf16 v[80:83], v[164:167], v[200:203], v[80:83]
    v_cvt_pk_bf16_f32 v144, v56, v57
    v_cvt_pk_bf16_f32 v145, v58, v59
    v_mfma_f32_16x16x32_bf16 v[84:87], v[164:167], v[204:207], v[84:87]
    v_cvt_pk_bf16_f32 v146, v60, v61
    v_cvt_pk_bf16_f32 v147, v62, v63
    v_cvt_pk_bf16_f32 v124, v24, v25
    v_cvt_pk_bf16_f32 v125, v26, v27
    v_cvt_pk_bf16_f32 v126, v28, v29
    v_cvt_pk_bf16_f32 v127, v30, v31
    s_mov_b64 exec, 1
    ds_add_u32 v10, v11 offset:0
    s_mov_b64 exec, -1
    v_cvt_pk_bf16_f32 v140, v48, v49
    v_cvt_pk_bf16_f32 v141, v50, v51
    v_cvt_pk_bf16_f32 v142, v52, v53
    v_cvt_pk_bf16_f32 v143, v54, v55
    v_cvt_pk_bf16_f32 v120, v16, v17
    v_cvt_pk_bf16_f32 v121, v18, v19
    v_cvt_pk_bf16_f32 v122, v20, v21
    v_cvt_pk_bf16_f32 v123, v22, v23
    v_mfma_f32_16x16x32_bf16 v[44:47], v[152:155], v[132:135], 0
    v_cvt_pk_bf16_f32 v230, v96, v97
    v_cvt_pk_bf16_f32 v231, v98, v99
    v_mfma_f32_16x16x32_bf16 v[40:43], v[148:151], v[132:135], 0
    v_cvt_pk_bf16_f32 v240, v100, v101
    v_cvt_pk_bf16_f32 v241, v102, v103
    v_mfma_f32_16x16x32_bf16 v[36:39], v[148:151], v[128:131], 0
    v_cvt_pk_bf16_f32 v228, v88, v89
    v_cvt_pk_bf16_f32 v229, v90, v91
    v_mfma_f32_16x16x32_bf16 v[32:35], v[144:147], v[128:131], 0
    v_cvt_pk_bf16_f32 v238, v92, v93
    v_cvt_pk_bf16_f32 v239, v94, v95
    v_mfma_f32_16x16x32_bf16 v[28:31], v[144:147], v[124:127], 0
    v_cvt_pk_bf16_f32 v226, v80, v81
    v_cvt_pk_bf16_f32 v227, v82, v83
    v_mfma_f32_16x16x32_bf16 v[24:27], v[140:143], v[124:127], 0
    v_cvt_pk_bf16_f32 v236, v84, v85
    v_cvt_pk_bf16_f32 v237, v86, v87
    v_mfma_f32_16x16x32_bf16 v[20:23], v[140:143], v[120:123], 0
    s_branch LB_s1_in
LB_s1:
    s_sleep 1
LB_s1_in:
    ds_read_b32 v14, v10 offset:0
    ds_read_b64 v[136:137], v218
    ds_read_b64 v[138:139], v219
    ds_read_b64 v[224:225], v218 offset:1024
    ds_read_b64 v[234:235], v219 offset:1024
    s_waitcnt lgkmcnt(0)
    v_readfirstlane_b32 s78, v14
    s_nop 0
    s_cmp_ge_u32 s78, 4
    s_cbranch_scc0 LB_s1
    v_mfma_f32_16x16x32_bf16 v[16:19], v[136:139], v[120:123], v[212:215]
    v_cndmask_b32 v60, v44, v45, s[88:89]
    s_add_u32 m0, s34, 36864
    s_add_u32 s35, s44, 0
    buffer_load_dwordx4 v245, s[64:67], s35 offen  lds
    v_cndmask_b32 v61, v40, v41, s[88:89]
    v_cndmask_b32 v54, v61, v60, s[90:91]
    v_cndmask_b32 v60, v46, v47, s[88:89]
    v_cndmask_b32 v61, v42, v43, s[88:89]
    v_cndmask_b32 v55, v61, v60, s[92:93]
    v_max_f32 v59, v54, v55
    v_cndmask_b32 v60, v36, v37, s[88:89]
    v_cndmask_b32 v61, v32, v33, s[88:89]
    v_cndmask_b32 v52, v61, v60, s[90:91]
    v_cndmask_b32 v60, v38, v39, s[88:89]
    v_cndmask_b32 v61, v34, v35, s[88:89]
    v_cndmask_b32 v53, v61, v60, s[92:93]
    v_max_f32 v58, v52, v53
    v_cndmask_b32 v60, v28, v29, s[88:89]
    v_cndmask_b32 v61, v24, v25, s[88:89]
    v_cndmask_b32 v50, v61, v60, s[90:91]
    v_cndmask_b32 v60, v30, v31, s[88:89]
    v_cndmask_b32 v61, v26, v27, s[88:89]
    s_add_u32 m0, s34, 40960
    s_add_u32 s35, s44, 65536
    buffer_load_dwordx4 v245, s[64:67], s35 offen  lds
    v_cndmask_b32 v51, v61, v60, s[92:93]
    v_max_f32 v57, v50, v51
    v_cndmask_b32 v60, v20, v21, s[88:89]
    v_cndmask_b32 v61, v16, v17, s[88:89]
    v_cndmask_b32 v48, v61, v60, s[90:91]
    v_cndmask_b32 v60, v22, v23, s[88:89]
    v_cndmask_b32 v61, v18, v19, s[88:89]
    v_cndmask_b32 v49, v61, v60, s[92:93]
    v_max_f32 v56, v48, v49
    s_mov_b32 s80, 0x3e8293ee
    v_permlane32_swap_b32 v58, v59
    v_permlane32_swap_b32 v56, v57
    v_max_f32 v58, v58, v59
    v_max_f32 v56, v56, v57
    s_nop 1
    v_permlane16_swap_b32 v56, v58
    v_max_f32 v56, v56, v58
    v_mul_f32 v56, s80, v56
    v_mov_b32 v58, v56
    s_nop 1
    v_permlane16_swap_b32 v56, v58
    s_add_u32 m0, s34, 45056
    s_add_u32 s35, s44, 131072
    buffer_load_dwordx4 v245, s[64:67], s35 offen  lds
    v_mov_b32 v57, v56
    v_mov_b32 v59, v58
    s_nop 0
    v_permlane32_swap_b32 v56, v57
    v_permlane32_swap_b32 v58, v59
    v_fma_f32 v48, v48, s80, -v56
    v_fma_f32 v49, v49, s80, -v56
    v_fma_f32 v50, v50, s80, -v57
    v_fma_f32 v51, v51, s80, -v57
    v_fma_f32 v52, v52, s80, -v58
    v_fma_f32 v53, v53, s80, -v58
    v_fma_f32 v54, v54, s80, -v59
    v_fma_f32 v55, v55, s80, -v59
    v_exp_f32 v48, v48
    v_exp_f32 v49, v49
    v_exp_f32 v50, v50
    v_exp_f32 v51, v51
    v_exp_f32 v52, v52
    v_exp_f32 v53, v53
    s_add_u32 m0, s34, 49152
    s_add_u32 s35, s44, 196608
    buffer_load_dwordx4 v245, s[64:67], s35 offen  lds
    v_exp_f32 v54, v54
    v_exp_f32 v55, v55
    v_add_f32 v56, v48, v49
    v_add_f32 v57, v50, v51
    v_add_f32 v58, v52, v53
    v_add_f32 v59, v54, v55
    s_nop 1
    v_permlane32_swap_b32 v58, v59
    v_permlane32_swap_b32 v56, v57
    v_add_f32 v58, v58, v59
    v_add_f32 v56, v56, v57
    s_nop 1
    v_permlane16_swap_b32 v56, v58
    v_add_f32 v56, v56, v58
    v_rcp_f32 v56, v56
    s_nop 0
    v_mov_b32 v58, v56
    s_nop 1
    v_permlane16_swap_b32 v56, v58
    v_mov_b32 v57, v56
    v_mov_b32 v59, v58
    s_nop 0
    v_permlane32_swap_b32 v56, v57
    v_permlane32_swap_b32 v58, v59
    s_add_u32 m0, s34, 53248
    s_add_u32 s35, s45, 0
    buffer_load_dwordx4 v245, s[64:67], s35 offen  lds
    v_mul_f32 v48, v48, v56
    v_mul_f32 v49, v49, v56
    v_cvt_pk_bf16_f32 v48, v48, v49
    v_perm_b32 v64, v48, v48, v208
    v_perm_b32 v65, v48, v48, v209
    v_perm_b32 v66, v48, v48, v210
    v_perm_b32 v67, v48, v48, v211
    v_mul_f32 v50, v50, v57
    v_mul_f32 v51, v51, v57
    v_cvt_pk_bf16_f32 v50, v50, v51
    v_perm_b32 v68, v50, v50, v208
    v_perm_b32 v69, v50, v50, v209
    v_perm_b32 v70, v50, v50, v210
    v_perm_b32 v71, v50, v50, v211
    v_mfma_f32_16x16x32_bf16 v[16:19], v[224:227], v[64:67], 0
    v_mfma_f32_16x16x32_bf16 v[20:23], v[234:237], v[64:67], 0
    v_mul_f32 v52, v52, v58
    v_mul_f32 v53, v53, v58
    s_add_u32 m0, s34, 57344
    s_add_u32 s35, s45, 65536
    buffer_load_dwordx4 v245, s[64:67], s35 offen  lds
    v_cvt_pk_bf16_f32 v52, v52, v53
    v_perm_b32 v72, v52, v52, v208
    v_perm_b32 v73, v52, v52, v209
    v_perm_b32 v74, v52, v52, v210
    v_perm_b32 v75, v52, v52, v211
    v_mfma_f32_16x16x32_bf16 v[24:27], v[226:229], v[68:71], 0
    v_mfma_f32_16x16x32_bf16 v[28:31], v[236:239], v[68:71], 0
    v_mul_f32 v54, v54, v59
    v_mul_f32 v55, v55, v59
    v_cvt_pk_bf16_f32 v54, v54, v55
    v_perm_b32 v76, v54, v54, v208
    v_perm_b32 v77, v54, v54, v209
    v_perm_b32 v78, v54, v54, v210
    v_perm_b32 v79, v54, v54, v211
    v_mfma_f32_16x16x32_bf16 v[32:35], v[228:231], v[72:75], 0
    v_mfma_f32_16x16x32_bf16 v[36:39], v[238:241], v[72:75], 0
    v_mfma_f32_16x16x32_bf16 v[40:43], v[230:233], v[76:79], 0
    v_mfma_f32_16x16x32_bf16 v[44:47], v[240:243], v[76:79], 0
    v_cvt_pk_bf16_f32 v80, v16, v17
    v_cvt_pk_bf16_f32 v81, v18, v19
    v_cvt_pk_bf16_f32 v82, v20, v21
    v_cvt_pk_bf16_f32 v83, v22, v23
    s_add_u32 s95, s94, 0
    buffer_store_dwordx4 v[80:83], v12, s[52:55], s95 offen sc1
    v_cvt_pk_bf16_f32 v84, v24, v25
    v_cvt_pk_bf16_f32 v85, v26, v27
    v_cvt_pk_bf16_f32 v86, v28, v29
    v_cvt_pk_bf16_f32 v87, v30, v31
    s_add_u32 s95, s94, 32768
    buffer_store_dwordx4 v[84:87], v12, s[52:55], s95 offen sc1
    v_cvt_pk_bf16_f32 v88, v32, v33
    v_cvt_pk_bf16_f32 v89, v34, v35
    v_cvt_pk_bf16_f32 v90, v36, v37
    v_cvt_pk_bf16_f32 v91, v38, v39
    s_add_u32 s95, s94, 65536
    buffer_store_dwordx4 v[88:91], v12, s[52:55], s95 offen sc1
    v_cvt_pk_bf16_f32 v92, v40, v41
    v_cvt_pk_bf16_f32 v93, v42, v43
    v_cvt_pk_bf16_f32 v94, v44, v45
    v_cvt_pk_bf16_f32 v95, v46, v47
    s_add_u32 s95, s94, 98304
    buffer_store_dwordx4 v[92:95], v12, s[52:55], s95 offen sc1
    s_add_u32 m0, s34, 61440
    s_add_u32 s35, s45, 131072
    buffer_load_dwordx4 v245, s[64:67], s35 offen  lds
    v_xor_b32 v2, 0, v244
    v_xor_b32 v3, 32, v244
    v_xor_b32 v4, 64, v244
    v_xor_b32 v5, 96, v244
    s_add_u32 m0, s34, 65536
    s_add_u32 s35, s45, 196608
    buffer_load_dwordx4 v245, s[64:67], s35 offen  lds
    v_xor_b32 v6, 2048, v244
    v_xor_b32 v7, 2080, v244
    v_xor_b32 v8, 2112, v244
    v_xor_b32 v9, 2144, v244
    s_waitcnt vmcnt(6)
    s_mov_b64 exec, 1
    ds_add_u32 v10, v11 offset:8
    s_mov_b64 exec, -1
    s_add_u32 m0, s34, 69632
    s_add_u32 s35, s46, 0
    buffer_load_dwordx4 v245, s[64:67], s35 offen  lds
    v_add_u32 v224, 65536, v2
    v_add_u32 v225, 65536, v3
    s_add_u32 m0, s34, 73728
    s_add_u32 s35, s46, 65536
    buffer_load_dwordx4 v245, s[64:67], s35 offen  lds
    v_add_u32 v226, 65536, v4
    s_add_u32 m0, s34, 77824
    s_add_u32 s35, s46, 131072
    buffer_load_dwordx4 v245, s[64:67], s35 offen  lds
    v_add_u32 v227, 65536, v5
    v_add_u32 v228, 65536, v6
    s_add_u32 m0, s34, 81920
    s_add_u32 s35, s46, 196608
    buffer_load_dwordx4 v245, s[64:67], s35 offen  lds
    v_add_u32 v229, 65536, v7
    s_add_u32 m0, s34, 86016
    s_add_u32 s35, s47, 0
    buffer_load_dwordx4 v245, s[64:67], s35 offen  lds
    v_add_u32 v230, 65536, v8
    v_add_u32 v231, 65536, v9
    s_add_u32 m0, s34, 0
    s_add_u32 s35, s47, 65536
    buffer_load_dwordx4 v245, s[64:67], s35 offen  lds
    v_add_u32 v15, 32768, v12
    s_waitcnt vmcnt(8)
    s_mov_b64 exec, 1
    buffer_store_dword v11, v220, s[52:55], s97 offen sc1
    s_mov_b64 exec, -1
    s_branch LB_s2_in
LB_s2:
    s_sleep 1
LB_s2_in:
    ds_read_b32 v14, v10 offset:8
    s_waitcnt lgkmcnt(0)
    v_readfirstlane_b32 s78, v14
    s_nop 0
    s_cmp_ge_u32 s78, 8
    s_cbranch_scc0 LB_s2
    s_add_u32 m0, s34, 4096
    s_add_u32 s35, s47, 131072
    buffer_load_dwordx4 v245, s[64:67], s35 offen  lds
    ds_read_b64_tr_b16 v[48:49], v2 offset:36864
    ds_read_b64_tr_b16 v[50:51], v6 offset:36864
    s_add_u32 m0, s34, 8192
    s_add_u32 s35, s47, 196608
    buffer_load_dwordx4 v245, s[64:67], s35 offen  lds
    ds_read_b64_tr_b16 v[52:53], v3 offset:36864
    s_add_u32 m0, s34, 12288
    s_add_u32 s35, s48, 0
    buffer_load_dwordx4 v245, s[64:67], s35 offen  lds
    ds_read_b64_tr_b16 v[54:55], v7 offset:36864
    s_add_u32 m0, s34, 16384
    s_add_u32 s35, s48, 65536
    buffer_load_dwordx4 v245, s[64:67], s35 offen  lds
    ds_read_b64_tr_b16 v[56:57], v4 offset:36864
    ds_read_b64_tr_b16 v[58:59], v8 offset:36864
    s_add_u32 m0, s34, 20480
    s_add_u32 s35, s48, 131072
    buffer_load_dwordx4 v245, s[64:67], s35 offen  lds
    ds_read_b64_tr_b16 v[60:61], v5 offset:36864
    s_add_u32 m0, s34, 110592
    s_add_u32 s35, s48, 196608
    buffer_load_dwordx4 v245, s[64:67], s35 offen  lds
    ds_read_b64_tr_b16 v[62:63], v9 offset:36864
    s_add_u32 m0, s34, 114688
    s_add_u32 s35, s49, 0
    buffer_load_dwordx4 v245, s[64:67], s35 offen  lds
    ds_read_b64_tr_b16 v[64:65], v2 offset:40960
    ds_read_b64_tr_b16 v[66:67], v6 offset:40960
    s_add_u32 m0, s34, 118784
    s_add_u32 s35, s49, 65536
    buffer_load_dwordx4 v245, s[64:67], s35 offen  lds
    ds_read_b64_tr_b16 v[68:69], v3 offset:40960
    s_add_u32 m0, s34, 122880
    s_add_u32 s35, s49, 131072
    buffer_load_dwordx4 v245, s[64:67], s35 offen  lds
    ds_read_b64_tr_b16 v[70:71], v7 offset:40960
    s_add_u32 m0, s34, 24576
    s_add_u32 s35, s49, 196608
    buffer_load_dwordx4 v245, s[64:67], s35 offen  lds
    ds_read_b64_tr_b16 v[72:73], v4 offset:40960
    ds_read_b64_tr_b16 v[74:75], v8 offset:40960
    s_add_u32 m0, s34, 28672
    s_add_u32 s35, s50, 0
    buffer_load_dwordx4 v245, s[64:67], s35 offen  lds
    ds_read_b64_tr_b16 v[76:77], v5 offset:40960
    s_add_u32 m0, s34, 32768
    s_add_u32 s35, s50, 65536
    buffer_load_dwordx4 v245, s[64:67], s35 offen  lds
    ds_read_b64_tr_b16 v[78:79], v9 offset:40960
    s_waitcnt vmcnt(0)
    s_mov_b64 exec, 0xffffffff
    s_mov_b32 s79, 0
LB_po:
    buffer_load_dword v14, v247, s[52:55], s30 offen sc1
    s_add_u32 s79, s79, 1
    s_cmp_gt_u32 s79, 200000
    s_cbranch_scc1 LB_po_x
    s_waitcnt vmcnt(0)
    v_cmp_ne_u32 vcc, 1, v14
    s_cbranch_vccz LB_po_x
    s_mov_b64 exec, vcc
    s_sleep 8
    s_branch LB_po
LB_po_x:
    s_waitcnt vmcnt(0)
    s_mov_b64 exec, -1
    buffer_load_dwordx4 v[144:147], v12, s[52:55], s36 offen offset:0 sc1
    buffer_load_dwordx4 v[148:151], v15, s[52:55], s36 offen offset:0 sc1
    buffer_load_dwordx4 v[152:155], v12, s[52:55], s36 offen offset:1024 sc1
    buffer_load_dwordx4 v[156:159], v15, s[52:55], s36 offen offset:1024 sc1
    buffer_load_dwordx4 v[160:163], v12, s[52:55], s36 offen offset:2048 sc1
    buffer_load_dwordx4 v[164:167], v15, s[52:55], s36 offen offset:2048 sc1
    buffer_load_dwordx4 v[168:171], v12, s[52:55], s36 offen offset:3072 sc1
    buffer_load_dwordx4 v[172:175], v15, s[52:55], s36 offen offset:3072 sc1
    buffer_load_dwordx4 v[176:179], v12, s[52:55], s37 offen offset:0 sc1
    buffer_load_dwordx4 v[180:183], v15, s[52:55], s37 offen offset:0 sc1
    s_setprio 1
    s_mov_b64 exec, 1
    ds_add_u32 v10, v11 offset:16
    s_mov_b64 exec, -1
    s_branch LB_s4_in
LB_s4:
    s_sleep 1
LB_s4_in:
    ds_read_b32 v14, v10 offset:16
    s_waitcnt lgkmcnt(0)
    v_readfirstlane_b32 s78, v14
    s_nop 0
    s_cmp_ge_u32 s78, 4
    s_cbranch_scc0 LB_s4
    s_waitcnt vmcnt(8)
    v_mfma_f32_16x16x32_bf16 v[16:19], v[48:51], v[144:147], 0
    buffer_load_dwordx4 v[184:187], v12, s[52:55], s37 offen offset:1024 sc1
    buffer_load_dwordx4 v[188:191], v15, s[52:55], s37 offen offset:1024 sc1
    v_mfma_f32_16x16x32_bf16 v[20:23], v[52:55], v[144:147], 0
    ds_read_b64_tr_b16 v[80:81], v2 offset:45056
    v_mfma_f32_16x16x32_bf16 v[24:27], v[56:59], v[144:147], 0
    ds_read_b64_tr_b16 v[82:83], v6 offset:45056
    v_mfma_f32_16x16x32_bf16 v[28:31], v[60:63], v[144:147], 0
    ds_read_b64_tr_b16 v[84:85], v3 offset:45056
    v_mfma_f32_16x16x32_bf16 v[32:35], v[48:51], v[148:151], 0
    ds_read_b64_tr_b16 v[86:87], v7 offset:45056
    ds_read_b64_tr_b16 v[88:89], v4 offset:45056
    v_mfma_f32_16x16x32_bf16 v[36:39], v[52:55], v[148:151], 0
    ds_read_b64_tr_b16 v[90:91], v8 offset:45056
    v_mfma_f32_16x16x32_bf16 v[40:43], v[56:59], v[148:151], 0
    ds_read_b64_tr_b16 v[92:93], v5 offset:45056
    v_mfma_f32_16x16x32_bf16 v[44:47], v[60:63], v[148:151], 0
    ds_read_b64_tr_b16 v[94:95], v9 offset:45056
    s_waitcnt vmcnt(8)
    v_mfma_f32_16x16x32_bf16 v[16:19], v[64:67], v[152:155], v[16:19]
    buffer_load_dwordx4 v[144:147], v12, s[52:55], s37 offen offset:2048 sc1
    buffer_load_dwordx4 v[148:151], v15, s[52:55], s37 offen offset:2048 sc1
    v_mfma_f32_16x16x32_bf16 v[20:23], v[68:71], v[152:155], v[20:23]
    ds_read_b64_tr_b16 v[96:97], v2 offset:49152
    v_mfma_f32_16x16x32_bf16 v[24:27], v[72:75], v[152:155], v[24:27]
    ds_read_b64_tr_b16 v[98:99], v6 offset:49152
    v_mfma_f32_16x16x32_bf16 v[28:31], v[76:79], v[152:155], v[28:31]
    ds_read_b64_tr_b16 v[100:101], v3 offset:49152
    v_mfma_f32_16x16x32_bf16 v[32:35], v[64:67], v[156:159], v[32:35]
    ds_read_b64_tr_b16 v[102:103], v7 offset:49152
    ds_read_b64_tr_b16 v[104:105], v4 offset:49152
    v_mfma_f32_16x16x32_bf16 v[36:39], v[68:71], v[156:159], v[36:39]
    ds_read_b64_tr_b16 v[106:107], v8 offset:49152
    v_mfma_f32_16x16x32_bf16 v[40:43], v[72:75], v[156:159], v[40:43]
    ds_read_b64_tr_b16 v[108:109], v5 offset:49152
    v_mfma_f32_16x16x32_bf16 v[44:47], v[76:79], v[156:159], v[44:47]
    ds_read_b64_tr_b16 v[110:111], v9 offset:49152
    s_waitcnt vmcnt(8) lgkmcnt(8)
    v_mfma_f32_16x16x32_bf16 v[16:19], v[80:83], v[160:163], v[16:19]
    buffer_load_dwordx4 v[152:155], v12, s[52:55], s37 offen offset:3072 sc1
    buffer_load_dwordx4 v[156:159], v15, s[52:55], s37 offen offset:3072 sc1
    v_mfma_f32_16x16x32_bf16 v[20:23], v[84:87], v[160:163], v[20:23]
    ds_read_b64_tr_b16 v[112:113], v2 offset:53248
    v_mfma_f32_16x16x32_bf16 v[24:27], v[88:91], v[160:163], v[24:27]
    ds_read_b64_tr_b16 v[114:115], v6 offset:53248
    v_mfma_f32_16x16x32_bf16 v[28:31], v[92:95], v[160:163], v[28:31]
    ds_read_b64_tr_b16 v[116:117], v3 offset:53248
    v_mfma_f32_16x16x32_bf16 v[32:35], v[80:83], v[164:167], v[32:35]
    ds_read_b64_tr_b16 v[118:119], v7 offset:53248
    ds_read_b64_tr_b16 v[120:121], v4 offset:53248
    v_mfma_f32_16x16x32_bf16 v[36:39], v[84:87], v[164:167], v[36:39]
    ds_read_b64_tr_b16 v[122:123], v8 offset:53248
    v_mfma_f32_16x16x32_bf16 v[40:43], v[88:91], v[164:167], v[40:43]
    ds_read_b64_tr_b16 v[124:125], v5 offset:53248
    v_mfma_f32_16x16x32_bf16 v[44:47], v[92:95], v[164:167], v[44:47]
    ds_read_b64_tr_b16 v[126:127], v9 offset:53248
    s_waitcnt vmcnt(8) lgkmcnt(8)
    v_mfma_f32_16x16x32_bf16 v[16:19], v[96:99], v[168:171], v[16:19]
    buffer_load_dwordx4 v[160:163], v12, s[52:55], s38 offen offset:0 sc1
    buffer_load_dwordx4 v[164:167], v15, s[52:55], s38 offen offset:0 sc1
    v_mfma_f32_16x16x32_bf16 v[20:23], v[100:103], v[168:171], v[20:23]
    ds_read_b64_tr_b16 v[128:129], v2 offset:57344
    v_mfma_f32_16x16x32_bf16 v[24:27], v[104:107], v[168:171], v[24:27]
    ds_read_b64_tr_b16 v[130:131], v6 offset:57344
    v_mfma_f32_16x16x32_bf16 v[28:31], v[108:111], v[168:171], v[28:31]
    ds_read_b64_tr_b16 v[132:133], v3 offset:57344
    v_mfma_f32_16x16x32_bf16 v[32:35], v[96:99], v[172:175], v[32:35]
    ds_read_b64_tr_b16 v[134:135], v7 offset:57344
    ds_read_b64_tr_b16 v[136:137], v4 offset:57344
    v_mfma_f32_16x16x32_bf16 v[36:39], v[100:103], v[172:175], v[36:39]
    ds_read_b64_tr_b16 v[138:139], v8 offset:57344
    v_mfma_f32_16x16x32_bf16 v[40:43], v[104:107], v[172:175], v[40:43]
    ds_read_b64_tr_b16 v[140:141], v5 offset:57344
    v_mfma_f32_16x16x32_bf16 v[44:47], v[108:111], v[172:175], v[44:47]
    ds_read_b64_tr_b16 v[142:143], v9 offset:57344
    s_waitcnt vmcnt(8) lgkmcnt(8)
    v_mfma_f32_16x16x32_bf16 v[16:19], v[112:115], v[176:179], v[16:19]
    buffer_load_dwordx4 v[168:171], v12, s[52:55], s38 offen offset:1024 sc1
    buffer_load_dwordx4 v[172:175], v15, s[52:55], s38 offen offset:1024 sc1
    v_mfma_f32_16x16x32_bf16 v[20:23], v[116:119], v[176:179], v[20:23]
    ds_read_b64_tr_b16 v[48:49], v2 offset:61440
    v_mfma_f32_16x16x32_bf16 v[24:27], v[120:123], v[176:179], v[24:27]
    ds_read_b64_tr_b16 v[50:51], v6 offset:61440
    v_mfma_f32_16x16x32_bf16 v[28:31], v[124:127], v[176:179], v[28:31]
    ds_read_b64_tr_b16 v[52:53], v3 offset:61440
    v_mfma_f32_16x16x32_bf16 v[32:35], v[112:115], v[180:183], v[32:35]
    ds_read_b64_tr_b16 v[54:55], v7 offset:61440
    ds_read_b64_tr_b16 v[56:57], v4 offset:61440
    v_mfma_f32_16x16x32_bf16 v[36:39], v[116:119], v[180:183], v[36:39]
    ds_read_b64_tr_b16 v[58:59], v8 offset:61440
    v_mfma_f32_16x16x32_bf16 v[40:43], v[120:123], v[180:183], v[40:43]
    ds_read_b64_tr_b16 v[60:61], v5 offset:61440
    v_mfma_f32_16x16x32_bf16 v[44:47], v[124:127], v[180:183], v[44:47]
    ds_read_b64_tr_b16 v[62:63], v9 offset:61440
    s_waitcnt vmcnt(8) lgkmcnt(8)
    v_mfma_f32_16x16x32_bf16 v[16:19], v[128:131], v[184:187], v[16:19]
    buffer_load_dwordx4 v[176:179], v12, s[52:55], s38 offen offset:2048 sc1
    buffer_load_dwordx4 v[180:183], v15, s[52:55], s38 offen offset:2048 sc1
    v_mfma_f32_16x16x32_bf16 v[20:23], v[132:135], v[184:187], v[20:23]
    ds_read_b64_tr_b16 v[64:65], v224 offset:0
    v_mfma_f32_16x16x32_bf16 v[24:27], v[136:139], v[184:187], v[24:27]
    ds_read_b64_tr_b16 v[66:67], v228 offset:0
    v_mfma_f32_16x16x32_bf16 v[28:31], v[140:143], v[184:187], v[28:31]
    ds_read_b64_tr_b16 v[68:69], v225 offset:0
    v_mfma_f32_16x16x32_bf16 v[32:35], v[128:131], v[188:191], v[32:35]
    ds_read_b64_tr_b16 v[70:71], v229 offset:0
    ds_read_b64_tr_b16 v[72:73], v226 offset:0
    v_mfma_f32_16x16x32_bf16 v[36:39], v[132:135], v[188:191], v[36:39]
    ds_read_b64_tr_b16 v[74:75], v230 offset:0
    v_mfma_f32_16x16x32_bf16 v[40:43], v[136:139], v[188:191], v[40:43]
    ds_read_b64_tr_b16 v[76:77], v227 offset:0
    v_mfma_f32_16x16x32_bf16 v[44:47], v[140:143], v[188:191], v[44:47]
    ds_read_b64_tr_b16 v[78:79], v231 offset:0
    s_waitcnt vmcnt(8) lgkmcnt(8)
    v_mfma_f32_16x16x32_bf16 v[16:19], v[48:51], v[144:147], v[16:19]
    buffer_load_dwordx4 v[184:187], v12, s[52:55], s38 offen offset:3072 sc1
    buffer_load_dwordx4 v[188:191], v15, s[52:55], s38 offen offset:3072 sc1
    v_mfma_f32_16x16x32_bf16 v[20:23], v[52:55], v[144:147], v[20:23]
    ds_read_b64_tr_b16 v[80:81], v224 offset:4096
    v_mfma_f32_16x16x32_bf16 v[24:27], v[56:59], v[144:147], v[24:27]
    ds_read_b64_tr_b16 v[82:83], v228 offset:4096
    v_mfma_f32_16x16x32_bf16 v[28:31], v[60:63], v[144:147], v[28:31]
    ds_read_b64_tr_b16 v[84:85], v225 offset:4096
    v_mfma_f32_16x16x32_bf16 v[32:35], v[48:51], v[148:151], v[32:35]
    ds_read_b64_tr_b16 v[86:87], v229 offset:4096
    ds_read_b64_tr_b16 v[88:89], v226 offset:4096
    v_mfma_f32_16x16x32_bf16 v[36:39], v[52:55], v[148:151], v[36:39]
    ds_read_b64_tr_b16 v[90:91], v230 offset:4096
    v_mfma_f32_16x16x32_bf16 v[40:43], v[56:59], v[148:151], v[40:43]
    ds_read_b64_tr_b16 v[92:93], v227 offset:4096
    v_mfma_f32_16x16x32_bf16 v[44:47], v[60:63], v[148:151], v[44:47]
    ds_read_b64_tr_b16 v[94:95], v231 offset:4096
    s_waitcnt vmcnt(8) lgkmcnt(8)
    v_mfma_f32_16x16x32_bf16 v[16:19], v[64:67], v[152:155], v[16:19]
    buffer_load_dwordx4 v[144:147], v12, s[52:55], s39 offen offset:0 sc1
    buffer_load_dwordx4 v[148:151], v15, s[52:55], s39 offen offset:0 sc1
    v_mfma_f32_16x16x32_bf16 v[20:23], v[68:71], v[152:155], v[20:23]
    ds_read_b64_tr_b16 v[96:97], v224 offset:8192
    v_mfma_f32_16x16x32_bf16 v[24:27], v[72:75], v[152:155], v[24:27]
    ds_read_b64_tr_b16 v[98:99], v228 offset:8192
    v_mfma_f32_16x16x32_bf16 v[28:31], v[76:79], v[152:155], v[28:31]
    ds_read_b64_tr_b16 v[100:101], v225 offset:8192
    v_mfma_f32_16x16x32_bf16 v[32:35], v[64:67], v[156:159], v[32:35]
    ds_read_b64_tr_b16 v[102:103], v229 offset:8192
    ds_read_b64_tr_b16 v[104:105], v226 offset:8192
    v_mfma_f32_16x16x32_bf16 v[36:39], v[68:71], v[156:159], v[36:39]
    ds_read_b64_tr_b16 v[106:107], v230 offset:8192
    v_mfma_f32_16x16x32_bf16 v[40:43], v[72:75], v[156:159], v[40:43]
    ds_read_b64_tr_b16 v[108:109], v227 offset:8192
    v_mfma_f32_16x16x32_bf16 v[44:47], v[76:79], v[156:159], v[44:47]
    ds_read_b64_tr_b16 v[110:111], v231 offset:8192
    s_waitcnt vmcnt(8) lgkmcnt(8)
    v_mfma_f32_16x16x32_bf16 v[16:19], v[80:83], v[160:163], v[16:19]
    buffer_load_dwordx4 v[152:155], v12, s[52:55], s39 offen offset:1024 sc1
    buffer_load_dwordx4 v[156:159], v15, s[52:55], s39 offen offset:1024 sc1
    v_mfma_f32_16x16x32_bf16 v[20:23], v[84:87], v[160:163], v[20:23]
    ds_read_b64_tr_b16 v[112:113], v224 offset:12288
    v_mfma_f32_16x16x32_bf16 v[24:27], v[88:91], v[160:163], v[24:27]
    ds_read_b64_tr_b16 v[114:115], v228 offset:12288
    v_mfma_f32_16x16x32_bf16 v[28:31], v[92:95], v[160:163], v[28:31]
    ds_read_b64_tr_b16 v[116:117], v225 offset:12288
    v_mfma_f32_16x16x32_bf16 v[32:35], v[80:83], v[164:167], v[32:35]
    ds_read_b64_tr_b16 v[118:119], v229 offset:12288
    ds_read_b64_tr_b16 v[120:121], v226 offset:12288
    v_mfma_f32_16x16x32_bf16 v[36:39], v[84:87], v[164:167], v[36:39]
    ds_read_b64_tr_b16 v[122:123], v230 offset:12288
    v_mfma_f32_16x16x32_bf16 v[40:43], v[88:91], v[164:167], v[40:43]
    ds_read_b64_tr_b16 v[124:125], v227 offset:12288
    v_mfma_f32_16x16x32_bf16 v[44:47], v[92:95], v[164:167], v[44:47]
    ds_read_b64_tr_b16 v[126:127], v231 offset:12288
    s_waitcnt vmcnt(8) lgkmcnt(8)
    v_mfma_f32_16x16x32_bf16 v[16:19], v[96:99], v[168:171], v[16:19]
    buffer_load_dwordx4 v[160:163], v12, s[52:55], s39 offen offset:2048 sc1
    buffer_load_dwordx4 v[164:167], v15, s[52:55], s39 offen offset:2048 sc1
    v_mfma_f32_16x16x32_bf16 v[20:23], v[100:103], v[168:171], v[20:23]
    ds_read_b64_tr_b16 v[128:129], v224 offset:16384
    v_mfma_f32_16x16x32_bf16 v[24:27], v[104:107], v[168:171], v[24:27]
    ds_read_b64_tr_b16 v[130:131], v228 offset:16384
    v_mfma_f32_16x16x32_bf16 v[28:31], v[108:111], v[168:171], v[28:31]
    ds_read_b64_tr_b16 v[132:133], v225 offset:16384
    v_mfma_f32_16x16x32_bf16 v[32:35], v[96:99], v[172:175], v[32:35]
    ds_read_b64_tr_b16 v[134:135], v229 offset:16384
    ds_read_b64_tr_b16 v[136:137], v226 offset:16384
    v_mfma_f32_16x16x32_bf16 v[36:39], v[100:103], v[172:175], v[36:39]
    ds_read_b64_tr_b16 v[138:139], v230 offset:16384
    v_mfma_f32_16x16x32_bf16 v[40:43], v[104:107], v[172:175], v[40:43]
    ds_read_b64_tr_b16 v[140:141], v227 offset:16384
    v_mfma_f32_16x16x32_bf16 v[44:47], v[108:111], v[172:175], v[44:47]
    ds_read_b64_tr_b16 v[142:143], v231 offset:16384
    s_waitcnt vmcnt(8) lgkmcnt(8)
    v_mfma_f32_16x16x32_bf16 v[16:19], v[112:115], v[176:179], v[16:19]
    buffer_load_dwordx4 v[168:171], v12, s[52:55], s39 offen offset:3072 sc1
    buffer_load_dwordx4 v[172:175], v15, s[52:55], s39 offen offset:3072 sc1
    v_mfma_f32_16x16x32_bf16 v[20:23], v[116:119], v[176:179], v[20:23]
    ds_read_b64_tr_b16 v[48:49], v224 offset:20480
    v_mfma_f32_16x16x32_bf16 v[24:27], v[120:123], v[176:179], v[24:27]
    ds_read_b64_tr_b16 v[50:51], v228 offset:20480
    v_mfma_f32_16x16x32_bf16 v[28:31], v[124:127], v[176:179], v[28:31]
    ds_read_b64_tr_b16 v[52:53], v225 offset:20480
    v_mfma_f32_16x16x32_bf16 v[32:35], v[112:115], v[180:183], v[32:35]
    ds_read_b64_tr_b16 v[54:55], v229 offset:20480
    ds_read_b64_tr_b16 v[56:57], v226 offset:20480
    v_mfma_f32_16x16x32_bf16 v[36:39], v[116:119], v[180:183], v[36:39]
    ds_read_b64_tr_b16 v[58:59], v230 offset:20480
    v_mfma_f32_16x16x32_bf16 v[40:43], v[120:123], v[180:183], v[40:43]
    ds_read_b64_tr_b16 v[60:61], v227 offset:20480
    v_mfma_f32_16x16x32_bf16 v[44:47], v[124:127], v[180:183], v[44:47]
    ds_read_b64_tr_b16 v[62:63], v231 offset:20480
    s_waitcnt vmcnt(8) lgkmcnt(8)
    v_mfma_f32_16x16x32_bf16 v[16:19], v[128:131], v[184:187], v[16:19]
    buffer_load_dwordx4 v[176:179], v12, s[52:55], s40 offen offset:0 sc1
    buffer_load_dwordx4 v[180:183], v15, s[52:55], s40 offen offset:0 sc1
    v_mfma_f32_16x16x32_bf16 v[20:23], v[132:135], v[184:187], v[20:23]
    ds_read_b64_tr_b16 v[64:65], v2 offset:0
    v_mfma_f32_16x16x32_bf16 v[24:27], v[136:139], v[184:187], v[24:27]
    ds_read_b64_tr_b16 v[66:67], v6 offset:0
    v_mfma_f32_16x16x32_bf16 v[28:31], v[140:143], v[184:187], v[28:31]
    ds_read_b64_tr_b16 v[68:69], v3 offset:0
    v_mfma_f32_16x16x32_bf16 v[32:35], v[128:131], v[188:191], v[32:35]
    ds_read_b64_tr_b16 v[70:71], v7 offset:0
    ds_read_b64_tr_b16 v[72:73], v4 offset:0
    v_mfma_f32_16x16x32_bf16 v[36:39], v[132:135], v[188:191], v[36:39]
    ds_read_b64_tr_b16 v[74:75], v8 offset:0
    v_mfma_f32_16x16x32_bf16 v[40:43], v[136:139], v[188:191], v[40:43]
    ds_read_b64_tr_b16 v[76:77], v5 offset:0
    v_mfma_f32_16x16x32_bf16 v[44:47], v[140:143], v[188:191], v[44:47]
    ds_read_b64_tr_b16 v[78:79], v9 offset:0
    s_waitcnt vmcnt(8) lgkmcnt(8)
    v_mfma_f32_16x16x32_bf16 v[16:19], v[48:51], v[144:147], v[16:19]
    buffer_load_dwordx4 v[184:187], v12, s[52:55], s40 offen offset:1024 sc1
    buffer_load_dwordx4 v[188:191], v15, s[52:55], s40 offen offset:1024 sc1
    v_mfma_f32_16x16x32_bf16 v[20:23], v[52:55], v[144:147], v[20:23]
    ds_read_b64_tr_b16 v[80:81], v2 offset:4096
    v_mfma_f32_16x16x32_bf16 v[24:27], v[56:59], v[144:147], v[24:27]
    ds_read_b64_tr_b16 v[82:83], v6 offset:4096
    v_mfma_f32_16x16x32_bf16 v[28:31], v[60:63], v[144:147], v[28:31]
    ds_read_b64_tr_b16 v[84:85], v3 offset:4096
    v_mfma_f32_16x16x32_bf16 v[32:35], v[48:51], v[148:151], v[32:35]
    ds_read_b64_tr_b16 v[86:87], v7 offset:4096
    ds_read_b64_tr_b16 v[88:89], v4 offset:4096
    v_mfma_f32_16x16x32_bf16 v[36:39], v[52:55], v[148:151], v[36:39]
    ds_read_b64_tr_b16 v[90:91], v8 offset:4096
    v_mfma_f32_16x16x32_bf16 v[40:43], v[56:59], v[148:151], v[40:43]
    ds_read_b64_tr_b16 v[92:93], v5 offset:4096
    v_mfma_f32_16x16x32_bf16 v[44:47], v[60:63], v[148:151], v[44:47]
    ds_read_b64_tr_b16 v[94:95], v9 offset:4096
    s_waitcnt vmcnt(8) lgkmcnt(8)
    v_mfma_f32_16x16x32_bf16 v[16:19], v[64:67], v[152:155], v[16:19]
    buffer_load_dwordx4 v[144:147], v12, s[52:55], s40 offen offset:2048 sc1
    buffer_load_dwordx4 v[148:151], v15, s[52:55], s40 offen offset:2048 sc1
    v_mfma_f32_16x16x32_bf16 v[20:23], v[68:71], v[152:155], v[20:23]
    ds_read_b64_tr_b16 v[96:97], v2 offset:8192
    v_mfma_f32_16x16x32_bf16 v[24:27], v[72:75], v[152:155], v[24:27]
    ds_read_b64_tr_b16 v[98:99], v6 offset:8192
    v_mfma_f32_16x16x32_bf16 v[28:31], v[76:79], v[152:155], v[28:31]
    ds_read_b64_tr_b16 v[100:101], v3 offset:8192
    v_mfma_f32_16x16x32_bf16 v[32:35], v[64:67], v[156:159], v[32:35]
    ds_read_b64_tr_b16 v[102:103], v7 offset:8192
    ds_read_b64_tr_b16 v[104:105], v4 offset:8192
    v_mfma_f32_16x16x32_bf16 v[36:39], v[68:71], v[156:159], v[36:39]
    ds_read_b64_tr_b16 v[106:107], v8 offset:8192
    v_mfma_f32_16x16x32_bf16 v[40:43], v[72:75], v[156:159], v[40:43]
    ds_read_b64_tr_b16 v[108:109], v5 offset:8192
    v_mfma_f32_16x16x32_bf16 v[44:47], v[76:79], v[156:159], v[44:47]
    ds_read_b64_tr_b16 v[110:111], v9 offset:8192
    s_waitcnt vmcnt(8) lgkmcnt(8)
    v_mfma_f32_16x16x32_bf16 v[16:19], v[80:83], v[160:163], v[16:19]
    buffer_load_dwordx4 v[152:155], v12, s[52:55], s40 offen offset:3072 sc1
    buffer_load_dwordx4 v[156:159], v15, s[52:55], s40 offen offset:3072 sc1
    v_mfma_f32_16x16x32_bf16 v[20:23], v[84:87], v[160:163], v[20:23]
    ds_read_b64_tr_b16 v[112:113], v2 offset:12288
    v_mfma_f32_16x16x32_bf16 v[24:27], v[88:91], v[160:163], v[24:27]
    ds_read_b64_tr_b16 v[114:115], v6 offset:12288
    v_mfma_f32_16x16x32_bf16 v[28:31], v[92:95], v[160:163], v[28:31]
    ds_read_b64_tr_b16 v[116:117], v3 offset:12288
    v_mfma_f32_16x16x32_bf16 v[32:35], v[80:83], v[164:167], v[32:35]
    ds_read_b64_tr_b16 v[118:119], v7 offset:12288
    ds_read_b64_tr_b16 v[120:121], v4 offset:12288
    v_mfma_f32_16x16x32_bf16 v[36:39], v[84:87], v[164:167], v[36:39]
    ds_read_b64_tr_b16 v[122:123], v8 offset:12288
    v_mfma_f32_16x16x32_bf16 v[40:43], v[88:91], v[164:167], v[40:43]
    ds_read_b64_tr_b16 v[124:125], v5 offset:12288
    v_mfma_f32_16x16x32_bf16 v[44:47], v[92:95], v[164:167], v[44:47]
    ds_read_b64_tr_b16 v[126:127], v9 offset:12288
    s_waitcnt vmcnt(8) lgkmcnt(8)
    v_mfma_f32_16x16x32_bf16 v[16:19], v[96:99], v[168:171], v[16:19]
    buffer_load_dwordx4 v[160:163], v12, s[52:55], s41 offen offset:0 sc1
    buffer_load_dwordx4 v[164:167], v15, s[52:55], s41 offen offset:0 sc1
    v_mfma_f32_16x16x32_bf16 v[20:23], v[100:103], v[168:171], v[20:23]
    ds_read_b64_tr_b16 v[128:129], v2 offset:16384
    v_mfma_f32_16x16x32_bf16 v[24:27], v[104:107], v[168:171], v[24:27]
    ds_read_b64_tr_b16 v[130:131], v6 offset:16384
    v_mfma_f32_16x16x32_bf16 v[28:31], v[108:111], v[168:171], v[28:31]
    ds_read_b64_tr_b16 v[132:133], v3 offset:16384
    v_mfma_f32_16x16x32_bf16 v[32:35], v[96:99], v[172:175], v[32:35]
    ds_read_b64_tr_b16 v[134:135], v7 offset:16384
    ds_read_b64_tr_b16 v[136:137], v4 offset:16384
    v_mfma_f32_16x16x32_bf16 v[36:39], v[100:103], v[172:175], v[36:39]
    ds_read_b64_tr_b16 v[138:139], v8 offset:16384
    v_mfma_f32_16x16x32_bf16 v[40:43], v[104:107], v[172:175], v[40:43]
    ds_read_b64_tr_b16 v[140:141], v5 offset:16384
    v_mfma_f32_16x16x32_bf16 v[44:47], v[108:111], v[172:175], v[44:47]
    ds_read_b64_tr_b16 v[142:143], v9 offset:16384
    s_waitcnt vmcnt(8) lgkmcnt(8)
    v_mfma_f32_16x16x32_bf16 v[16:19], v[112:115], v[176:179], v[16:19]
    buffer_load_dwordx4 v[168:171], v12, s[52:55], s41 offen offset:1024 sc1
    buffer_load_dwordx4 v[172:175], v15, s[52:55], s41 offen offset:1024 sc1
    v_mfma_f32_16x16x32_bf16 v[20:23], v[116:119], v[176:179], v[20:23]
    ds_read_b64_tr_b16 v[48:49], v2 offset:20480
    v_mfma_f32_16x16x32_bf16 v[24:27], v[120:123], v[176:179], v[24:27]
    ds_read_b64_tr_b16 v[50:51], v6 offset:20480
    v_mfma_f32_16x16x32_bf16 v[28:31], v[124:127], v[176:179], v[28:31]
    ds_read_b64_tr_b16 v[52:53], v3 offset:20480
    v_mfma_f32_16x16x32_bf16 v[32:35], v[112:115], v[180:183], v[32:35]
    ds_read_b64_tr_b16 v[54:55], v7 offset:20480
    ds_read_b64_tr_b16 v[56:57], v4 offset:20480
    v_mfma_f32_16x16x32_bf16 v[36:39], v[116:119], v[180:183], v[36:39]
    ds_read_b64_tr_b16 v[58:59], v8 offset:20480
    v_mfma_f32_16x16x32_bf16 v[40:43], v[120:123], v[180:183], v[40:43]
    ds_read_b64_tr_b16 v[60:61], v5 offset:20480
    v_mfma_f32_16x16x32_bf16 v[44:47], v[124:127], v[180:183], v[44:47]
    ds_read_b64_tr_b16 v[62:63], v9 offset:20480
    s_waitcnt vmcnt(8) lgkmcnt(8)
    v_mfma_f32_16x16x32_bf16 v[16:19], v[128:131], v[184:187], v[16:19]
    buffer_load_dwordx4 v[176:179], v12, s[52:55], s41 offen offset:2048 sc1
    buffer_load_dwordx4 v[180:183], v15, s[52:55], s41 offen offset:2048 sc1
    v_mfma_f32_16x16x32_bf16 v[20:23], v[132:135], v[184:187], v[20:23]
    ds_read_b64_tr_b16 v[64:65], v224 offset:45056
    v_mfma_f32_16x16x32_bf16 v[24:27], v[136:139], v[184:187], v[24:27]
    ds_read_b64_tr_b16 v[66:67], v228 offset:45056
    v_mfma_f32_16x16x32_bf16 v[28:31], v[140:143], v[184:187], v[28:31]
    ds_read_b64_tr_b16 v[68:69], v225 offset:45056
    v_mfma_f32_16x16x32_bf16 v[32:35], v[128:131], v[188:191], v[32:35]
    ds_read_b64_tr_b16 v[70:71], v229 offset:45056
    ds_read_b64_tr_b16 v[72:73], v226 offset:45056
    v_mfma_f32_16x16x32_bf16 v[36:39], v[132:135], v[188:191], v[36:39]
    ds_read_b64_tr_b16 v[74:75], v230 offset:45056
    v_mfma_f32_16x16x32_bf16 v[40:43], v[136:139], v[188:191], v[40:43]
    ds_read_b64_tr_b16 v[76:77], v227 offset:45056
    v_mfma_f32_16x16x32_bf16 v[44:47], v[140:143], v[188:191], v[44:47]
    ds_read_b64_tr_b16 v[78:79], v231 offset:45056
    s_waitcnt vmcnt(8) lgkmcnt(8)
    v_mfma_f32_16x16x32_bf16 v[16:19], v[48:51], v[144:147], v[16:19]
    buffer_load_dwordx4 v[184:187], v12, s[52:55], s41 offen offset:3072 sc1
    buffer_load_dwordx4 v[188:191], v15, s[52:55], s41 offen offset:3072 sc1
    v_mfma_f32_16x16x32_bf16 v[20:23], v[52:55], v[144:147], v[20:23]
    ds_read_b64_tr_b16 v[80:81], v224 offset:49152
    v_mfma_f32_16x16x32_bf16 v[24:27], v[56:59], v[144:147], v[24:27]
    ds_read_b64_tr_b16 v[82:83], v228 offset:49152
    v_mfma_f32_16x16x32_bf16 v[28:31], v[60:63], v[144:147], v[28:31]
    ds_read_b64_tr_b16 v[84:85], v225 offset:49152
    v_mfma_f32_16x16x32_bf16 v[32:35], v[48:51], v[148:151], v[32:35]
    ds_read_b64_tr_b16 v[86:87], v229 offset:49152
    ds_read_b64_tr_b16 v[88:89], v226 offset:49152
    v_mfma_f32_16x16x32_bf16 v[36:39], v[52:55], v[148:151], v[36:39]
    ds_read_b64_tr_b16 v[90:91], v230 offset:49152
    v_mfma_f32_16x16x32_bf16 v[40:43], v[56:59], v[148:151], v[40:43]
    ds_read_b64_tr_b16 v[92:93], v227 offset:49152
    v_mfma_f32_16x16x32_bf16 v[44:47], v[60:63], v[148:151], v[44:47]
    ds_read_b64_tr_b16 v[94:95], v231 offset:49152
    s_waitcnt vmcnt(8) lgkmcnt(8)
    s_mov_b64 exec, 1
    ds_add_u32 v10, v11 offset:28
    s_mov_b64 exec, -1
    v_mfma_f32_16x16x32_bf16 v[16:19], v[64:67], v[152:155], v[16:19]
    buffer_load_dwordx4 v[144:147], v12, s[52:55], s42 offen offset:0 sc1
    buffer_load_dwordx4 v[148:151], v15, s[52:55], s42 offen offset:0 sc1
    v_mfma_f32_16x16x32_bf16 v[20:23], v[68:71], v[152:155], v[20:23]
    ds_read_b64_tr_b16 v[96:97], v224 offset:53248
    v_mfma_f32_16x16x32_bf16 v[24:27], v[72:75], v[152:155], v[24:27]
    ds_read_b64_tr_b16 v[98:99], v228 offset:53248
    v_mfma_f32_16x16x32_bf16 v[28:31], v[76:79], v[152:155], v[28:31]
    ds_read_b64_tr_b16 v[100:101], v225 offset:53248
    v_mfma_f32_16x16x32_bf16 v[32:35], v[64:67], v[156:159], v[32:35]
    ds_read_b64_tr_b16 v[102:103], v229 offset:53248
    ds_read_b64_tr_b16 v[104:105], v226 offset:53248
    v_mfma_f32_16x16x32_bf16 v[36:39], v[68:71], v[156:159], v[36:39]
    ds_read_b64_tr_b16 v[106:107], v230 offset:53248
    v_mfma_f32_16x16x32_bf16 v[40:43], v[72:75], v[156:159], v[40:43]
    ds_read_b64_tr_b16 v[108:109], v227 offset:53248
    v_mfma_f32_16x16x32_bf16 v[44:47], v[76:79], v[156:159], v[44:47]
    ds_read_b64_tr_b16 v[110:111], v231 offset:53248
    s_waitcnt vmcnt(8) lgkmcnt(9)
    v_mfma_f32_16x16x32_bf16 v[16:19], v[80:83], v[160:163], v[16:19]
    buffer_load_dwordx4 v[152:155], v12, s[52:55], s42 offen offset:1024 sc1
    buffer_load_dwordx4 v[156:159], v15, s[52:55], s42 offen offset:1024 sc1
    v_mfma_f32_16x16x32_bf16 v[20:23], v[84:87], v[160:163], v[20:23]
    ds_read_b64_tr_b16 v[112:113], v224 offset:57344
    v_mfma_f32_16x16x32_bf16 v[24:27], v[88:91], v[160:163], v[24:27]
    ds_read_b64_tr_b16 v[114:115], v228 offset:57344
    v_mfma_f32_16x16x32_bf16 v[28:31], v[92:95], v[160:163], v[28:31]
    ds_read_b64_tr_b16 v[116:117], v225 offset:57344
    v_mfma_f32_16x16x32_bf16 v[32:35], v[80:83], v[164:167], v[32:35]
    ds_read_b64_tr_b16 v[118:119], v229 offset:57344
    ds_read_b64_tr_b16 v[120:121], v226 offset:57344
    v_mfma_f32_16x16x32_bf16 v[36:39], v[84:87], v[164:167], v[36:39]
    ds_read_b64_tr_b16 v[122:123], v230 offset:57344
    v_mfma_f32_16x16x32_bf16 v[40:43], v[88:91], v[164:167], v[40:43]
    ds_read_b64_tr_b16 v[124:125], v227 offset:57344
    v_mfma_f32_16x16x32_bf16 v[44:47], v[92:95], v[164:167], v[44:47]
    ds_read_b64_tr_b16 v[126:127], v231 offset:57344
    s_waitcnt vmcnt(8) lgkmcnt(8)
    v_mfma_f32_16x16x32_bf16 v[16:19], v[96:99], v[168:171], v[16:19]
    buffer_load_dwordx4 v[160:163], v12, s[52:55], s42 offen offset:2048 sc1
    buffer_load_dwordx4 v[164:167], v15, s[52:55], s42 offen offset:2048 sc1
    v_mfma_f32_16x16x32_bf16 v[20:23], v[100:103], v[168:171], v[20:23]
    ds_read_b64_tr_b16 v[128:129], v2 offset:24576
    v_mfma_f32_16x16x32_bf16 v[24:27], v[104:107], v[168:171], v[24:27]
    ds_read_b64_tr_b16 v[130:131], v6 offset:24576
    v_mfma_f32_16x16x32_bf16 v[28:31], v[108:111], v[168:171], v[28:31]
    ds_read_b64_tr_b16 v[132:133], v3 offset:24576
    v_mfma_f32_16x16x32_bf16 v[32:35], v[96:99], v[172:175], v[32:35]
    ds_read_b64_tr_b16 v[134:135], v7 offset:24576
    ds_read_b64_tr_b16 v[136:137], v4 offset:24576
    v_mfma_f32_16x16x32_bf16 v[36:39], v[100:103], v[172:175], v[36:39]
    ds_read_b64_tr_b16 v[138:139], v8 offset:24576
    v_mfma_f32_16x16x32_bf16 v[40:43], v[104:107], v[172:175], v[40:43]
    ds_read_b64_tr_b16 v[140:141], v5 offset:24576
    v_mfma_f32_16x16x32_bf16 v[44:47], v[108:111], v[172:175], v[44:47]
    ds_read_b64_tr_b16 v[142:143], v9 offset:24576
    s_waitcnt vmcnt(8) lgkmcnt(8)
    v_mfma_f32_16x16x32_bf16 v[16:19], v[112:115], v[176:179], v[16:19]
    buffer_load_dwordx4 v[168:171], v12, s[52:55], s42 offen offset:3072 sc1
    buffer_load_dwordx4 v[172:175], v15, s[52:55], s42 offen offset:3072 sc1
    v_mfma_f32_16x16x32_bf16 v[20:23], v[116:119], v[176:179], v[20:23]
    ds_read_b64_tr_b16 v[48:49], v2 offset:28672
    v_mfma_f32_16x16x32_bf16 v[24:27], v[120:123], v[176:179], v[24:27]
    ds_read_b64_tr_b16 v[50:51], v6 offset:28672
    v_mfma_f32_16x16x32_bf16 v[28:31], v[124:127], v[176:179], v[28:31]
    ds_read_b64_tr_b16 v[52:53], v3 offset:28672
    v_mfma_f32_16x16x32_bf16 v[32:35], v[112:115], v[180:183], v[32:35]
    ds_read_b64_tr_b16 v[54:55], v7 offset:28672
    ds_read_b64_tr_b16 v[56:57], v4 offset:28672
    v_mfma_f32_16x16x32_bf16 v[36:39], v[116:119], v[180:183], v[36:39]
    ds_read_b64_tr_b16 v[58:59], v8 offset:28672
    v_mfma_f32_16x16x32_bf16 v[40:43], v[120:123], v[180:183], v[40:43]
    ds_read_b64_tr_b16 v[60:61], v5 offset:28672
    v_mfma_f32_16x16x32_bf16 v[44:47], v[124:127], v[180:183], v[44:47]
    ds_read_b64_tr_b16 v[62:63], v9 offset:28672
    s_waitcnt vmcnt(8) lgkmcnt(8)
    v_mfma_f32_16x16x32_bf16 v[16:19], v[128:131], v[184:187], v[16:19]
    buffer_load_dwordx4 v[176:179], v12, s[52:55], s43 offen offset:0 sc1
    buffer_load_dwordx4 v[180:183], v15, s[52:55], s43 offen offset:0 sc1
    v_mfma_f32_16x16x32_bf16 v[20:23], v[132:135], v[184:187], v[20:23]
    ds_read_b32 v223, v10 offset:32
    v_mfma_f32_16x16x32_bf16 v[24:27], v[136:139], v[184:187], v[24:27]
    ds_read_b64_tr_b16 v[64:65], v2 offset:32768
    ds_read_b64_tr_b16 v[66:67], v6 offset:32768
    v_mfma_f32_16x16x32_bf16 v[28:31], v[140:143], v[184:187], v[28:31]
    ds_read_b64_tr_b16 v[68:69], v3 offset:32768
    v_mfma_f32_16x16x32_bf16 v[32:35], v[128:131], v[188:191], v[32:35]
    ds_read_b64_tr_b16 v[70:71], v7 offset:32768
    v_mfma_f32_16x16x32_bf16 v[36:39], v[132:135], v[188:191], v[36:39]
    ds_read_b64_tr_b16 v[72:73], v4 offset:32768
    ds_read_b64_tr_b16 v[74:75], v8 offset:32768
    v_mfma_f32_16x16x32_bf16 v[40:43], v[136:139], v[188:191], v[40:43]
    ds_read_b64_tr_b16 v[76:77], v5 offset:32768
    v_mfma_f32_16x16x32_bf16 v[44:47], v[140:143], v[188:191], v[44:47]
    ds_read_b64_tr_b16 v[78:79], v9 offset:32768
    s_waitcnt vmcnt(8) lgkmcnt(9)
    s_waitcnt lgkmcnt(8)
    v_cmp_gt_u32 vcc, 4, v223
    s_cbranch_vccnz LB_w8
LB_g8:
    v_mfma_f32_16x16x32_bf16 v[16:19], v[48:51], v[144:147], v[16:19]
    buffer_load_dwordx4 v[184:187], v12, s[52:55], s43 offen offset:1024 sc1
    buffer_load_dwordx4 v[188:191], v15, s[52:55], s43 offen offset:1024 sc1
    v_add_u32 v2, 129024, v2
    v_mfma_f32_16x16x32_bf16 v[20:23], v[52:55], v[144:147], v[20:23]
    ds_read_b64_tr_b16 v[80:81], v2 offset:0
    v_add_u32 v6, 129024, v6
    v_mfma_f32_16x16x32_bf16 v[24:27], v[56:59], v[144:147], v[24:27]
    ds_read_b64_tr_b16 v[82:83], v6 offset:0
    v_add_u32 v3, 129024, v3
    v_mfma_f32_16x16x32_bf16 v[28:31], v[60:63], v[144:147], v[28:31]
    ds_read_b64_tr_b16 v[84:85], v3 offset:0
    v_add_u32 v7, 129024, v7
    v_mfma_f32_16x16x32_bf16 v[32:35], v[48:51], v[148:151], v[32:35]
    ds_read_b64_tr_b16 v[86:87], v7 offset:0
    v_add_u32 v4, 129024, v4
    ds_read_b64_tr_b16 v[88:89], v4 offset:0
    v_mfma_f32_16x16x32_bf16 v[36:39], v[52:55], v[148:151], v[36:39]
    v_add_u32 v8, 129024, v8
    ds_read_b64_tr_b16 v[90:91], v8 offset:0
    v_mfma_f32_16x16x32_bf16 v[40:43], v[56:59], v[148:151], v[40:43]
    v_add_u32 v5, 129024, v5
    ds_read_b64_tr_b16 v[92:93], v5 offset:0
    v_mfma_f32_16x16x32_bf16 v[44:47], v[60:63], v[148:151], v[44:47]
    v_add_u32 v9, 129024, v9
    ds_read_b64_tr_b16 v[94:95], v9 offset:0
    s_waitcnt vmcnt(8) lgkmcnt(8)
    v_mfma_f32_16x16x32_bf16 v[16:19], v[64:67], v[152:155], v[16:19]
    buffer_load_dwordx4 v[144:147], v12, s[52:55], s43 offen offset:2048 sc1
    buffer_load_dwordx4 v[148:151], v15, s[52:55], s43 offen offset:2048 sc1
    v_mfma_f32_16x16x32_bf16 v[20:23], v[68:71], v[152:155], v[20:23]
    ds_read_b64_tr_b16 v[96:97], v2 offset:4096
    v_mfma_f32_16x16x32_bf16 v[24:27], v[72:75], v[152:155], v[24:27]
    ds_read_b64_tr_b16 v[98:99], v6 offset:4096
    v_mfma_f32_16x16x32_bf16 v[28:31], v[76:79], v[152:155], v[28:31]
    ds_read_b64_tr_b16 v[100:101], v3 offset:4096
    v_mfma_f32_16x16x32_bf16 v[32:35], v[64:67], v[156:159], v[32:35]
    ds_read_b64_tr_b16 v[102:103], v7 offset:4096
    ds_read_b64_tr_b16 v[104:105], v4 offset:4096
    v_mfma_f32_16x16x32_bf16 v[36:39], v[68:71], v[156:159], v[36:39]
    ds_read_b64_tr_b16 v[106:107], v8 offset:4096
    v_mfma_f32_16x16x32_bf16 v[40:43], v[72:75], v[156:159], v[40:43]
    ds_read_b64_tr_b16 v[108:109], v5 offset:4096
    v_mfma_f32_16x16x32_bf16 v[44:47], v[76:79], v[156:159], v[44:47]
    ds_read_b64_tr_b16 v[110:111], v9 offset:4096
    s_waitcnt vmcnt(8) lgkmcnt(8)
    v_mfma_f32_16x16x32_bf16 v[16:19], v[80:83], v[160:163], v[16:19]
    buffer_load_dwordx4 v[152:155], v12, s[52:55], s43 offen offset:3072 sc1
    buffer_load_dwordx4 v[156:159], v15, s[52:55], s43 offen offset:3072 sc1
    v_mfma_f32_16x16x32_bf16 v[20:23], v[84:87], v[160:163], v[20:23]
    ds_read_b64_tr_b16 v[112:113], v2 offset:8192
    v_mfma_f32_16x16x32_bf16 v[24:27], v[88:91], v[160:163], v[24:27]
    ds_read_b64_tr_b16 v[114:115], v6 offset:8192
    v_mfma_f32_16x16x32_bf16 v[28:31], v[92:95], v[160:163], v[28:31]
    ds_read_b64_tr_b16 v[116:117], v3 offset:8192
    v_mfma_f32_16x16x32_bf16 v[32:35], v[80:83], v[164:167], v[32:35]
    ds_read_b64_tr_b16 v[118:119], v7 offset:8192
    ds_read_b64_tr_b16 v[120:121], v4 offset:8192
    v_mfma_f32_16x16x32_bf16 v[36:39], v[84:87], v[164:167], v[36:39]
    ds_read_b64_tr_b16 v[122:123], v8 offset:8192
    v_mfma_f32_16x16x32_bf16 v[40:43], v[88:91], v[164:167], v[40:43]
    ds_read_b64_tr_b16 v[124:125], v5 offset:8192
    v_mfma_f32_16x16x32_bf16 v[44:47], v[92:95], v[164:167], v[44:47]
    ds_read_b64_tr_b16 v[126:127], v9 offset:8192
    s_waitcnt vmcnt(8) lgkmcnt(8)
    v_mfma_f32_16x16x32_bf16 v[16:19], v[96:99], v[168:171], v[16:19]
    ds_read_b64_tr_b16 v[128:129], v2 offset:12288
    v_mfma_f32_16x16x32_bf16 v[20:23], v[100:103], v[168:171], v[20:23]
    ds_read_b64_tr_b16 v[130:131], v6 offset:12288
    v_mfma_f32_16x16x32_bf16 v[24:27], v[104:107], v[168:171], v[24:27]
    ds_read_b64_tr_b16 v[132:133], v3 offset:12288
    v_mfma_f32_16x16x32_bf16 v[28:31], v[108:111], v[168:171], v[28:31]
    ds_read_b64_tr_b16 v[134:135], v7 offset:12288
    v_mfma_f32_16x16x32_bf16 v[32:35], v[96:99], v[172:175], v[32:35]
    ds_read_b64_tr_b16 v[136:137], v4 offset:12288
    v_mfma_f32_16x16x32_bf16 v[36:39], v[100:103], v[172:175], v[36:39]
    ds_read_b64_tr_b16 v[138:139], v8 offset:12288
    v_mfma_f32_16x16x32_bf16 v[40:43], v[104:107], v[172:175], v[40:43]
    ds_read_b64_tr_b16 v[140:141], v5 offset:12288
    v_mfma_f32_16x16x32_bf16 v[44:47], v[108:111], v[172:175], v[44:47]
    ds_read_b64_tr_b16 v[142:143], v9 offset:12288
    s_waitcnt vmcnt(6) lgkmcnt(8)
    v_mfma_f32_16x16x32_bf16 v[16:19], v[112:115], v[176:179], v[16:19]
    ds_read_b64_tr_b16 v[48:49], v2 offset:16384
    v_mfma_f32_16x16x32_bf16 v[20:23], v[116:119], v[176:179], v[20:23]
    ds_read_b64_tr_b16 v[50:51], v6 offset:16384
    v_mfma_f32_16x16x32_bf16 v[24:27], v[120:123], v[176:179], v[24:27]
    ds_read_b64_tr_b16 v[52:53], v3 offset:16384
    v_mfma_f32_16x16x32_bf16 v[28:31], v[124:127], v[176:179], v[28:31]
    ds_read_b64_tr_b16 v[54:55], v7 offset:16384
    v_mfma_f32_16x16x32_bf16 v[32:35], v[112:115], v[180:183], v[32:35]
    ds_read_b64_tr_b16 v[56:57], v4 offset:16384
    v_mfma_f32_16x16x32_bf16 v[36:39], v[116:119], v[180:183], v[36:39]
    ds_read_b64_tr_b16 v[58:59], v8 offset:16384
    v_mfma_f32_16x16x32_bf16 v[40:43], v[120:123], v[180:183], v[40:43]
    ds_read_b64_tr_b16 v[60:61], v5 offset:16384
    v_mfma_f32_16x16x32_bf16 v[44:47], v[124:127], v[180:183], v[44:47]
    ds_read_b64_tr_b16 v[62:63], v9 offset:16384
    s_waitcnt vmcnt(4) lgkmcnt(8)
    v_mfma_f32_16x16x32_bf16 v[16:19], v[128:131], v[184:187], v[16:19]
    ds_read_b64_tr_b16 v[64:65], v2 offset:20480
    v_mfma_f32_16x16x32_bf16 v[20:23], v[132:135], v[184:187], v[20:23]
    ds_read_b64_tr_b16 v[66:67], v6 offset:20480
    v_mfma_f32_16x16x32_bf16 v[24:27], v[136:139], v[184:187], v[24:27]
    ds_read_b64_tr_b16 v[68:69], v3 offset:20480
    v_mfma_f32_16x16x32_bf16 v[28:31], v[140:143], v[184:187], v[28:31]
    ds_read_b64_tr_b16 v[70:71], v7 offset:20480
    v_mfma_f32_16x16x32_bf16 v[32:35], v[128:131], v[188:191], v[32:35]
    ds_read_b64_tr_b16 v[72:73], v4 offset:20480
    v_mfma_f32_16x16x32_bf16 v[36:39], v[132:135], v[188:191], v[36:39]
    ds_read_b64_tr_b16 v[74:75], v8 offset:20480
    v_mfma_f32_16x16x32_bf16 v[40:43], v[136:139], v[188:191], v[40:43]
    ds_read_b64_tr_b16 v[76:77], v5 offset:20480
    v_mfma_f32_16x16x32_bf16 v[44:47], v[140:143], v[188:191], v[44:47]
    ds_read_b64_tr_b16 v[78:79], v9 offset:20480
    s_waitcnt vmcnt(2) lgkmcnt(8)
    v_mfma_f32_16x16x32_bf16 v[16:19], v[48:51], v[144:147], v[16:19]
    ds_read_b32 v223, v10 offset:28
    v_mfma_f32_16x16x32_bf16 v[20:23], v[52:55], v[144:147], v[20:23]
    v_mfma_f32_16x16x32_bf16 v[24:27], v[56:59], v[144:147], v[24:27]
    v_mfma_f32_16x16x32_bf16 v[28:31], v[60:63], v[144:147], v[28:31]
    v_mfma_f32_16x16x32_bf16 v[32:35], v[48:51], v[148:151], v[32:35]
    v_mfma_f32_16x16x32_bf16 v[36:39], v[52:55], v[148:151], v[36:39]
    v_mfma_f32_16x16x32_bf16 v[40:43], v[56:59], v[148:151], v[40:43]
    v_mfma_f32_16x16x32_bf16 v[44:47], v[60:63], v[148:151], v[44:47]
    s_waitcnt vmcnt(0) lgkmcnt(1)
    v_mfma_f32_16x16x32_bf16 v[16:19], v[64:67], v[152:155], v[16:19]
    v_mfma_f32_16x16x32_bf16 v[20:23], v[68:71], v[152:155], v[20:23]
    v_mfma_f32_16x16x32_bf16 v[24:27], v[72:75], v[152:155], v[24:27]
    v_mfma_f32_16x16x32_bf16 v[28:31], v[76:79], v[152:155], v[28:31]
    v_mfma_f32_16x16x32_bf16 v[32:35], v[64:67], v[156:159], v[32:35]
    v_mfma_f32_16x16x32_bf16 v[36:39], v[68:71], v[156:159], v[36:39]
    v_mfma_f32_16x16x32_bf16 v[40:43], v[72:75], v[156:159], v[40:43]
    v_mfma_f32_16x16x32_bf16 v[44:47], v[76:79], v[156:159], v[44:47]
    s_waitcnt lgkmcnt(0)
    v_cmp_gt_u32 vcc, 4, v223
    s_cbranch_vccnz LB_w7
LB_g7:
    v_cvt_pk_bf16_f32 v96, v16, v17
    v_cvt_pk_bf16_f32 v97, v18, v19
    v_cvt_pk_bf16_f32 v98, v20, v21
    v_cvt_pk_bf16_f32 v99, v22, v23
    s_nop 0
    v_permlane16_swap_b32 v96, v98
    v_permlane16_swap_b32 v97, v99
    ds_write_b128 v248, v[96:99] offset:0
    v_cvt_pk_bf16_f32 v100, v24, v25
    v_cvt_pk_bf16_f32 v101, v26, v27
    v_cvt_pk_bf16_f32 v102, v28, v29
    v_cvt_pk_bf16_f32 v103, v30, v31
    s_nop 0
    v_permlane16_swap_b32 v100, v102
    v_permlane16_swap_b32 v101, v103
    ds_write_b128 v249, v[100:103] offset:0
    ds_read_b128 v[112:115], v250 offset:0
    ds_read_b128 v[116:119], v250 offset:1024
    v_cvt_pk_bf16_f32 v104, v32, v33
    v_cvt_pk_bf16_f32 v105, v34, v35
    v_cvt_pk_bf16_f32 v106, v36, v37
    v_cvt_pk_bf16_f32 v107, v38, v39
    s_nop 0
    v_permlane16_swap_b32 v104, v106
    v_permlane16_swap_b32 v105, v107
    ds_write_b128 v248, v[104:107] offset:2048
    v_cvt_pk_bf16_f32 v108, v40, v41
    v_cvt_pk_bf16_f32 v109, v42, v43
    v_cvt_pk_bf16_f32 v110, v44, v45
    v_cvt_pk_bf16_f32 v111, v46, v47
    s_nop 0
    v_permlane16_swap_b32 v108, v110
    v_permlane16_swap_b32 v109, v111
    ds_write_b128 v249, v[108:111] offset:2048
    ds_read_b128 v[120:123], v250 offset:2048
    ds_read_b128 v[124:127], v250 offset:3072
    s_mov_b32 s95, 0
    s_waitcnt lgkmcnt(5)
    buffer_store_dwordx4 v[112:115], v246, s[60:63], s95 offen nt
    s_mov_b32 s95, 32768
    s_waitcnt lgkmcnt(4)
    buffer_store_dwordx4 v[116:119], v246, s[60:63], s95 offen nt
    s_mov_b32 s95, 65536
    s_waitcnt lgkmcnt(1)
    buffer_store_dwordx4 v[120:123], v246, s[60:63], s95 offen nt
    s_mov_b32 s95, 98304
    s_waitcnt lgkmcnt(0)
    buffer_store_dwordx4 v[124:127], v246, s[60:63], s95 offen nt
    s_endpgm
LA_slow:
    s_mov_b32 s79, 0
LA_slow1:
    s_mov_b64 exec, vcc
    s_sleep 8
    buffer_load_dword v136, v33, s[68:71], 0 offen sc1
    buffer_load_dword v137, v34, s[52:55], 0 offen sc1
    s_add_u32 s79, s79, 1
    s_cmp_gt_u32 s79, 200000
    s_waitcnt vmcnt(0)
    s_cbranch_scc1 LA_back
    v_cmp_ne_u32 vcc, v136, v137
    v_cmp_gt_u32 s[80:81], s96, v136
    s_nop 0
    s_or_b64 vcc, vcc, s[80:81]
    s_cbranch_vccnz LA_slow1
    s_branch LA_back
LB_slow:
    s_mov_b32 s79, 0
LB_pt:
    buffer_load_dword v222, v220, s[68:71], s98 offen sc1
    s_add_u32 s79, s79, 1
    s_cmp_gt_u32 s79, 200000
    s_cbranch_scc1 LB_pt_x
    s_waitcnt vmcnt(0)
    v_cmp_gt_u32 vcc, 4096, v222
    s_cbranch_vccz LB_pt_x
    s_mov_b64 exec, vcc
    s_sleep 8
    s_branch LB_pt
LB_pt_x:
    s_waitcnt vmcnt(0)
    s_branch LB_back
LB_w15:
    s_branch LB_s6_in
LB_s6:
    s_sleep 1
LB_s6_in:
    ds_read_b32 v223, v10 offset:24
    s_waitcnt lgkmcnt(0)
    v_readfirstlane_b32 s78, v223
    s_nop 0
    s_cmp_ge_u32 s78, 4
    s_cbranch_scc0 LB_s6
    s_branch LB_g15
LB_w8:
    s_branch LB_s8_in
LB_s8:
    s_sleep 1
LB_s8_in:
    ds_read_b32 v223, v10 offset:32
    s_waitcnt lgkmcnt(0)
    v_readfirstlane_b32 s78, v223
    s_nop 0
    s_cmp_ge_u32 s78, 4
    s_cbranch_scc0 LB_s8
    s_branch LB_g8
LB_w7:
    s_branch LB_s7_in
LB_s7:
    s_sleep 1
LB_s7_in:
    ds_read_b32 v223, v10 offset:28
    s_waitcnt lgkmcnt(0)
    v_readfirstlane_b32 s78, v223
    s_nop 0
    s_cmp_ge_u32 s78, 4
    s_cbranch_scc0 LB_s7
    s_branch LB_g7
L_end:
    s_endpgm
.section .rodata,"a"
.p2align 6
.amdhsa_kernel concat_heads__ssm_conv_h3__sliding_local_dilated__prompt_kernel
  .amdhsa_next_free_vgpr 256
  .amdhsa_next_free_sgpr 102
  .amdhsa_accum_offset 256
  .amdhsa_group_segment_fixed_size 0
  .amdhsa_kernarg_size 96
  .amdhsa_user_sgpr_count 2
  .amdhsa_user_sgpr_kernarg_segment_ptr 1
  .amdhsa_system_sgpr_workgroup_id_x 1
.end_amdhsa_kernel
```

```asm
; @launch grid=(256,1,1) block=(512,1,1) lds=163840
.amdgcn_target "amdgcn-amd-amdhsa--gfx950"
.text
.globl concat_heads__ssm_conv_h3__sliding_local_dilated__prompt_kernel
.p2align 8
.type concat_heads__ssm_conv_h3__sliding_local_dilated__prompt_kernel,@function
concat_heads__ssm_conv_h3__sliding_local_dilated__prompt_kernel:
    s_cmp_ge_u32 s2, 256
    s_cbranch_scc1 L_end
    s_load_dwordx4 s[16:19], s[0:1], 48
    s_load_dwordx8 s[4:11], s[0:1], 0
    s_load_dwordx4 s[12:15], s[0:1], 32
    s_load_dwordx8 s[20:27], s[0:1], 64
    v_lshrrev_b32 v1, 6, v0
    v_and_b32 v0, 63, v0
    v_readfirstlane_b32 s3, v1
    s_nop 0
    s_cmp_lg_u32 s3, 4
    s_cbranch_scc1 L_nopf
    s_getpc_b64 s[80:81]
L_pc:
    s_bfe_u32 s78, s2, 0x40003
    v_lshl_add_u32 v1, v0, 4, s78
    v_lshlrev_b32 v1, 7, v1
    v_cmp_gt_u32 vcc, L_end-L_pc, v1
    s_nop 0
    s_and_saveexec_b64 s[82:83], vcc
    global_load_dword v222, v1, s[80:81]
    s_mov_b64 exec, -1
L_nopf:
    s_and_b32 s78, s2, 7
    s_lshr_b32 s79, s2, 3
    s_lshl_b32 s78, s78, 2
    s_lshr_b32 s78, 0x76325410, s78
    s_and_b32 s78, s78, 7
    s_and_b32 s80, s78, 1
    s_lshl_b32 s80, s80, 3
    s_lshr_b32 s81, s78, 1
    s_lshl_b32 s81, s81, 2
    s_and_b32 s72, s79, 7
    s_add_u32 s72, s72, s80
    s_lshr_b32 s73, s79, 3
    s_xor_b32 s73, s73, 3
    s_add_u32 s73, s73, s81
    s_and_b32 s76, s79, 3
    s_add_u32 s76, s76, s81
    s_lshr_b32 s77, s79, 2
    s_add_u32 s77, s77, s80
    s_lshr_b32 s74, s79, 4
    s_xor_b32 s78, s78, 0
    s_lshl_b32 s78, s78, 1
    s_add_u32 s74, s74, s78
    s_and_b32 s75, s79, 15
    s_cmp_ge_u32 s3, 4
    s_cbranch_scc1 L_B
    v_lshrrev_b32 v5, 3, v0
    v_and_b32 v6, 7, v0
    v_lshrrev_b32 v7, 4, v0
    s_lshl_b32 s79, s72, 7
    s_lshl_b32 s80, s3, 5
    s_add_u32 s81, s79, s80
    v_xor_b32 v8, v7, v6
    v_lshlrev_b32 v8, 4, v8
    v_add_u32 v240, s81, v5
    v_lshl_add_u32 v240, v240, 11, v8
    v_xor_b32 v241, 64, v240
    v_add_u32 v241, 15360, v241
    v_add_u32 v242, 30720, v240
    v_add_u32 v243, 30720, v241
    s_and_b32 s78, s3, 1
    s_lshl_b32 s78, s78, 2
    s_lshl_b32 s80, s3, 3
    v_and_b32 v8, 1, v7
    v_lshl_or_b32 v8, v8, 1, s78
    v_xor_b32 v8, v8, v6
    v_lshlrev_b32 v8, 4, v8
    v_add_u32 v244, s80, v5
    v_mul_u32_u24 v244, 6144, v244
    s_lshl_b32 s82, s73, 7
    v_add3_u32 v244, v244, v8, s82
    v_add_u32 v245, 1024, v244
    v_add_u32 v246, 2048, v244
    s_lshl_b32 s78, s3, 1
    s_lshl_b32 s80, s3, 2
    s_add_u32 s79, s79, s80
    s_sub_u32 s79, s79, 16
    v_add_u32 v8, s78, v7
    v_xor_b32 v8, v8, v6
    v_and_b32 v8, 7, v8
    v_lshlrev_b32 v8, 4, v8
    v_add_u32 v3, s79, v5
    v_lshl_add_u32 v3, v3, 11, v8
    s_lshl_b32 s86, s3, 10
    s_lshl_b32 s87, s3, 12
    s_add_u32 s87, s87, 75776
    s_lshl_b32 s88, s3, 9
    s_add_u32 s88, s88, 73728
    s_and_b32 s98, s73, 0
    s_and_b32 s78, s72, 8
    s_add_u32 s98, s98, s78
    s_add_u32 s101, s72, s73
    s_and_b32 s101, s101, 3
    s_mov_b32 s82, 0x65832401
    s_mov_b32 s83, 0xfedba9c7
    s_cmp_eq_u32 s101, 1
    s_cselect_b32 s82, 0x69432510, s82
    s_cselect_b32 s83, 0xfecbad87, s83
    s_cmp_eq_u32 s101, 2
    s_cselect_b32 s82, 0xa5436210, s82
    s_cselect_b32 s83, 0xfdcbe987, s83
    s_cmp_eq_u32 s101, 3
    s_cselect_b32 s82, 0x65472310, s82
    s_cselect_b32 s83, 0xedcfa98b, s83
    s_bfe_u32 s62, s72, 0x10002
    s_mul_i32 s78, s62, 12288
    s_mul_i32 s79, s3, 3072
    s_add_u32 s60, s79, s78
    s_sub_u32 s61, s79, s78
    s_mul_i32 s62, s62, 196608
    s_sub_u32 s63, 196608, s62
    s_mov_b32 s30, 0x400000
    s_mov_b32 s31, 0x20000
    s_mov_b32 s34, 0x600000
    s_mov_b32 s35, 0x20000
    s_waitcnt lgkmcnt(0)
    s_mov_b64 s[28:29], s[16:17]
    s_mov_b64 s[32:33], s[18:19]
    s_mov_b64 s[0:1], s[82:83]
    s_add_u32 s97, s98, s0
    s_lshr_b64 s[0:1], s[0:1], 4
    s_and_b32 s97, s97, 15
    s_lshr_b32 s99, s97, 3
    s_xor_b32 s97, s97, s99
    s_add_u32 m0, s87, 0
    s_lshl_b32 s97, s97, 7
    buffer_load_dwordx4 v240, s[28:31], s97 offen offset:0  lds
    buffer_load_dwordx4 v241, s[28:31], s97 offen offset:1024  lds
    buffer_load_dwordx4 v242, s[28:31], s97 offen offset:2048  lds
    buffer_load_dwordx4 v243, s[28:31], s97 offen offset:3072  lds
    s_add_u32 m0, s88, 0
    s_mov_b64 exec, 0xffffffff
    buffer_load_dwordx4 v3, s[28:31], s97 offen offset:0  lds
    s_mov_b64 exec, -1
    s_mul_i32 s16, s97, 3072
    s_add_u32 m0, s60, 0
    s_add_u32 s99, s16, s62
    buffer_load_dwordx4 v244, s[32:35], s99 offen offset:0  lds
    buffer_load_dwordx4 v245, s[32:35], s99 offen offset:1024  lds
    buffer_load_dwordx4 v246, s[32:35], s99 offen offset:2048  lds
    s_add_u32 m0, s61, 12288
    s_add_u32 s16, s16, s63
    buffer_load_dwordx4 v244, s[32:35], s16 offen offset:0  lds
    buffer_load_dwordx4 v245, s[32:35], s16 offen offset:1024  lds
    buffer_load_dwordx4 v246, s[32:35], s16 offen offset:2048  lds
    s_add_u32 s97, s98, s0
    s_lshr_b64 s[0:1], s[0:1], 4
    s_and_b32 s97, s97, 15
    s_lshr_b32 s99, s97, 3
    s_xor_b32 s97, s97, s99
    s_add_u32 m0, s87, 18432
    s_lshl_b32 s97, s97, 7
    buffer_load_dwordx4 v240, s[28:31], s97 offen offset:0  lds
    s_mov_b32 s36, s6
    s_mov_b32 s37, s7
    s_mov_b32 s38, 0x400000
    s_mov_b32 s39, 0x20000
    s_mov_b32 s40, s8
    s_mov_b32 s41, s9
    s_mov_b32 s42, 0x400000
    s_mov_b32 s43, 0x20000
    s_mov_b32 s44, s10
    s_mov_b32 s45, s11
    s_mov_b32 s46, 0x2000
    s_mov_b32 s47, 0x20000
    s_mov_b32 s52, s26
    s_mov_b32 s53, s27
    s_mov_b32 s54, 0x1000000
    s_mov_b32 s55, 0x20000
    v_lshlrev_b32 v15, 4, v0
    v_and_b32 v7, 7, v0
    s_lshl_b32 s79, s74, 7
    v_lshl_add_u32 v7, v7, 4, s79
    s_lshl_b32 s78, s75, 7
    s_lshl_b32 s80, s3, 3
    s_add_u32 s80, s80, s78
    v_lshrrev_b32 v5, 3, v0
    s_and_b32 s79, s3, 1
    v_xor_b32 v5, s79, v5
    v_add_u32 v5, s80, v5
    v_lshl_add_u32 v10, v5, 11, v7
    s_xor_b32 s80, s3, 1
    s_add_u32 s80, s78, s80
    s_sub_u32 s80, s80, 4
    s_lshl_b32 s80, s80, 11
    v_add_u32 v11, s80, v7
    v_bfe_u32 v5, v0, 3, 2
    v_lshrrev_b32 v6, 5, v0
    s_lshl_b32 s80, s3, 5
    v_lshlrev_b32 v8, 3, v5
    v_lshl_add_u32 v8, v6, 2, v8
    v_add_u32 v8, s80, v8
    v_and_b32 v35, 7, v0
    v_lshlrev_b32 v16, 4, v35
    v_lshl_add_u32 v16, v8, 7, v16
    v_add_u32 v232, 129024, v16
    v_and_b32 v231, 1, v5
    v_lshl_add_u32 v16, v231, 7, v232
    v_xor_b32 v233, v231, v6
    v_xor_b32 v233, 1, v233
    v_lshl_add_u32 v232, v233, 7, v232
    v_xor_b32 v231, 128, v16
    v_xor_b32 v233, 128, v232
    v_lshrrev_b32 v33, 2, v35
    v_lshlrev_b32 v35, 6, v35
    v_lshl_add_u32 v35, v33, 4, v35
    v_add_u32 v35, 162816, v35
    v_add_u32 v8, s78, v8
    v_lshl_add_u32 v9, v8, 11, v7
    v_lshl_add_u32 v13, v8, 12, v7
    v_bfe_u32 v8, v0, 2, 1
    v_lshlrev_b32 v8, 1, v8
    v_add_u32 v8, v8, v6
    v_lshlrev_b32 v8, 16, v8
    v_lshl_add_u32 v8, v5, 6, v8
    v_and_b32 v7, 3, v0
    v_lshl_add_u32 v8, v7, 4, v8
    s_add_u32 s78, s78, s80
    s_lshl_b32 s78, s78, 3
    s_lshl_b32 s79, s74, 18
    s_add_u32 s78, s78, s79
    v_add_u32 v12, s78, v8
    s_mov_b32 s48, s12
    s_mov_b32 s49, s13
    s_mov_b32 s50, 0x400000
    s_mov_b32 s51, 0x20000
    s_mov_b32 s56, s4
    s_mov_b32 s57, s5
    s_mov_b32 s58, 0x400000
    s_mov_b32 s59, 0x20000
    s_mov_b32 s64, s20
    s_mov_b32 s65, s21
    s_mov_b32 s66, 0x200000
    s_mov_b32 s67, 0x20000
    s_lshl_b32 s91, s74, 4
    s_add_u32 s91, s91, s75
    s_lshr_b32 s78, s91, 3
    s_lshl_b32 s78, s78, 5
    s_and_b32 s79, s91, 7
    s_add_u32 s78, s78, s79
    s_lshl_b32 s79, s3, 3
    s_add_u32 s90, s78, s79
    s_lshl_b32 s91, s91, 14
    s_mov_b32 s96, 4096
    s_lshl_b32 s78, s90, 12
    v_lshl_add_u32 v228, v0, 7, s78
    s_lshr_b32 s78, s2, 3
    s_lshl_b32 s78, s78, 2
    s_add_u32 s78, s78, s3
    s_lshl_b32 s78, s78, 14
    s_and_b32 s79, s77, 8
    s_lshl_b32 s79, s79, 7
    s_add_u32 s78, s78, s79
    v_and_b32 v5, 7, v0
    v_lshlrev_b32 v5, 7, v5
    v_lshrrev_b32 v8, 3, v0
    v_lshl_add_u32 v5, v8, 11, v5
    v_add_u32 v229, s78, v5
    s_and_b32 s78, s73, 7
    s_cmp_eq_u32 s78, 3
    s_cselect_b32 s78, 0x40000000, 0
    v_or_b32 v229, s78, v229
    buffer_load_dwordx4 v241, s[28:31], s97 offen offset:1024  lds
    buffer_load_dwordx4 v242, s[28:31], s97 offen offset:2048  lds
    buffer_load_dwordx4 v243, s[28:31], s97 offen offset:3072  lds
    s_add_u32 m0, s88, 18432
    s_mov_b64 exec, 0xffffffff
    buffer_load_dwordx4 v3, s[28:31], s97 offen offset:0  lds
    s_mov_b64 exec, -1
    s_mul_i32 s16, s97, 3072
    s_add_u32 m0, s60, 24576
    s_add_u32 s99, s16, s62
    buffer_load_dwordx4 v244, s[32:35], s99 offen offset:0  lds
    buffer_load_dwordx4 v245, s[32:35], s99 offen offset:1024  lds
    s_cmp_eq_u32 s101, 1
    s_cbranch_scc1 LA_c1
    s_cmp_eq_u32 s101, 2
    s_cbranch_scc1 LA_c2
    s_cmp_eq_u32 s101, 3
    s_cbranch_scc1 LA_c3
LA_c0:
    s_waitcnt vmcnt(7)
    s_barrier
    buffer_load_dwordx4 v246, s[32:35], s99 offen offset:2048  lds
    s_add_u32 m0, s61, 36864
    s_add_u32 s16, s16, s63
    buffer_load_dwordx4 v244, s[32:35], s16 offen offset:0  lds
    buffer_load_dwordx4 v245, s[32:35], s16 offen offset:1024  lds
    buffer_load_dwordx4 v246, s[32:35], s16 offen offset:2048  lds
    s_add_u32 s97, s98, s0
    s_lshr_b64 s[0:1], s[0:1], 4
    s_and_b32 s97, s97, 15
    s_lshr_b32 s99, s97, 3
    s_xor_b32 s97, s97, s99
    s_add_u32 m0, s87, 36864
    s_lshl_b32 s97, s97, 7
    buffer_load_dwordx4 v240, s[28:31], s97 offen offset:0  lds
    buffer_load_dwordx4 v241, s[28:31], s97 offen offset:1024  lds
    buffer_load_dwordx4 v242, s[28:31], s97 offen offset:2048  lds
    buffer_load_dwordx4 v243, s[28:31], s97 offen offset:3072  lds
    s_add_u32 m0, s88, 36864
    s_mov_b64 exec, 0xffffffff
    buffer_load_dwordx4 v3, s[28:31], s97 offen offset:0  lds
    s_mov_b64 exec, -1
    s_mul_i32 s16, s97, 3072
    s_add_u32 m0, s60, 49152
    s_add_u32 s99, s16, s62
    buffer_load_dwordx4 v244, s[32:35], s99 offen offset:0  lds
    buffer_load_dwordx4 v245, s[32:35], s99 offen offset:1024  lds
    buffer_load_dwordx4 v246, s[32:35], s99 offen offset:2048  lds
    s_add_u32 m0, s61, 61440
    s_add_u32 s16, s16, s63
    buffer_load_dwordx4 v244, s[32:35], s16 offen offset:0  lds
    buffer_load_dwordx4 v245, s[32:35], s16 offen offset:1024  lds
    buffer_load_dwordx4 v246, s[32:35], s16 offen offset:2048  lds
    s_waitcnt vmcnt(11)
    s_barrier
    s_add_u32 m0, s86, 129536
    s_mov_b32 s89, 0
    buffer_load_dwordx4 v10, s[36:39], s89 offen nt lds
    s_mov_b32 s68, s24
    s_mov_b32 s69, s25
    s_mov_b32 s70, 0x100
    s_mov_b32 s71, 0x20000
    s_add_u32 m0, s86, 145920
    s_mov_b32 s89, 0
    buffer_load_dwordx4 v10, s[40:43], s89 offen nt lds
    v_lshrrev_b32 v6, 5, v0
    v_and_b32 v7, 3, v0
    s_lshr_b32 s78, s90, 1
    s_lshl_b32 s78, s78, 2
    s_add_u32 m0, s86, 133632
    s_mov_b32 s89, 65536
    buffer_load_dwordx4 v10, s[36:39], s89 offen nt lds
    s_load_dword s92, s[14:15], s78
    s_mul_i32 s94, s3, 8320
    s_add_u32 s94, s94, 129024
    v_bfe_u32 v5, v0, 2, 2
    s_add_u32 m0, s86, 150016
    s_mov_b32 s89, 65536
    buffer_load_dwordx4 v10, s[40:43], s89 offen nt lds
    v_lshlrev_b32 v5, 1, v5
    v_lshl_add_u32 v5, v6, 3, v5
    v_bfe_u32 v8, v0, 4, 1
    s_add_u32 m0, s86, 137728
    s_mov_b32 s89, 131072
    buffer_load_dwordx4 v10, s[36:39], s89 offen nt lds
    v_add_u32 v5, v5, v8
    s_and_b32 s78, s3, 1
    s_lshl_b32 s78, s78, 1
    v_add_u32 v8, s78, v6
    s_add_u32 m0, s86, 154112
    s_mov_b32 s89, 131072
    buffer_load_dwordx4 v10, s[40:43], s89 offen nt lds
    v_xor_b32 v8, v8, v7
    v_lshlrev_b32 v8, 4, v8
    v_lshl_add_u32 v5, v5, 6, v8
    v_add_u32 v14, s86, v5
    s_add_u32 m0, s86, 141824
    s_mov_b32 s89, 196608
    buffer_load_dwordx4 v10, s[36:39], s89 offen nt lds
    v_mov_b32 v18, 162304
    v_mov_b32 v19, 1
    v_and_b32 v5, 3, v0
    s_lshl_b32 s78, s74, 4
    s_add_u32 m0, s86, 158208
    s_mov_b32 s89, 196608
    buffer_load_dwordx4 v10, s[40:43], s89 offen nt lds
    s_add_u32 s78, s78, s3
    v_lshl_add_u32 v6, v5, 2, s78
    s_lshr_b32 s78, s76, 3
    s_mov_b64 exec, 0xff
    s_lshl_b32 s82, s3, 7
    s_add_u32 m0, s82, 129024
    s_mov_b32 s89, 0
    buffer_load_dwordx4 v11, s[36:39], s89 offen nt lds
    s_lshl_b32 s83, s74, 9
    s_add_u32 s83, s83, s82
    s_and_b32 s89, s3, 2
    s_lshl_b32 s89, s89, 3
    s_add_u32 s82, s82, s89
    s_add_u32 m0, s82, 162816
    s_add_u32 s89, s83, 0
    buffer_load_dwordx4 v15, s[44:47], s89 offen  lds
    s_mov_b64 exec, -1
    s_lshl_b32 s79, s3, 1
    s_add_u32 s78, s78, s79
    s_xor_b32 s78, s78, 0
    s_lshl_b32 s78, s78, 5
    s_add_u32 s97, s98, s0
    s_lshr_b64 s[0:1], s[0:1], 4
    s_and_b32 s97, s97, 15
    s_lshr_b32 s99, s97, 3
    s_xor_b32 s97, s97, s99
    s_add_u32 m0, s87, 0
    s_lshl_b32 s97, s97, 7
    buffer_load_dwordx4 v240, s[28:31], s97 offen offset:0  lds
    s_and_b32 s79, s76, 7
    s_add_u32 s78, s78, s79
    v_lshl_add_u32 v7, v5, 3, s78
    v_and_b32 v8, 4, v0
    buffer_load_dwordx4 v241, s[28:31], s97 offen offset:1024  lds
    v_cmp_eq_u32 vcc, 0, v8
    s_nop 1
    v_cndmask_b32 v6, v7, v6, vcc
    v_and_b32 v33, 0xf0, v6
    v_lshlrev_b32 v34, 8, v6
    buffer_load_dwordx4 v242, s[28:31], s97 offen offset:2048  lds
    v_add_u32 v34, 12582912, v34
    v_and_b32 v5, 15, v0
    v_lshrrev_b32 v6, 4, v0
    buffer_load_dwordx4 v243, s[28:31], s97 offen offset:3072  lds
    v_add_u32 v7, 9, v5
    v_and_b32 v8, 1, v7
    v_mul_u32_u24 v8, 4160, v8
    v_lshrrev_b32 v7, 1, v7
    s_add_u32 m0, s88, 0
    s_mov_b64 exec, 0xffffffff
    buffer_load_dwordx4 v3, s[28:31], s97 offen offset:0  lds
    s_mov_b64 exec, -1
    v_lshl_add_u32 v8, v7, 2, v8
    v_lshlrev_b32 v7, 4, v6
    v_sub_u32 v8, v8, v7
    s_add_u32 s78, s94, 32
    s_mul_i32 s16, s97, 3072
    s_add_u32 m0, s60, 0
    s_add_u32 s99, s16, s62
    buffer_load_dwordx4 v244, s[32:35], s99 offen offset:0  lds
    v_add_u32 v21, s78, v8
    v_add_u32 v22, 1024, v21
    v_add_u32 v23, 2048, v21
    v_add_u32 v24, 3072, v21
    buffer_load_dwordx4 v245, s[32:35], s99 offen offset:1024  lds
    v_lshl_add_u32 v7, v5, 1, v6
    v_add_u32 v7, 30, v7
    v_and_b32 v8, 1, v7
    s_waitcnt vmcnt(17)
    s_barrier
    buffer_load_dwordx4 v246, s[32:35], s99 offen offset:2048  lds
    v_bfe_u32 v136, v7, 1, 2
    v_lshl_add_u32 v136, v8, 2, v136
    v_lshlrev_b32 v136, 6, v136
    v_lshrrev_b32 v7, 3, v7
    s_add_u32 m0, s61, 12288
    s_add_u32 s16, s16, s63
    buffer_load_dwordx4 v244, s[32:35], s16 offen offset:0  lds
    v_lshl_add_u32 v136, v7, 9, v136
    v_bitop3_b32 v8, v7, 3, s3 bitop3:0x6a
    v_lshl_add_u32 v25, v8, 4, v136
    v_add_u32 v25, 92160, v25
    buffer_load_dwordx4 v245, s[32:35], s16 offen offset:1024  lds
    v_subrev_u32 v7, 1, v7
    v_bitop3_b32 v8, v7, 3, s3 bitop3:0x6a
    v_lshl_add_u32 v27, v8, 4, v136
    v_add_u32 v27, 91648, v27
    buffer_load_dwordx4 v246, s[32:35], s16 offen offset:2048  lds
    v_subrev_u32 v7, 1, v7
    v_bitop3_b32 v8, v7, 3, s3 bitop3:0x6a
    v_lshl_add_u32 v29, v8, 4, v136
    v_add_u32 v29, 91136, v29
    s_add_u32 s97, s98, s0
    s_lshr_b64 s[0:1], s[0:1], 4
    s_and_b32 s97, s97, 15
    s_lshr_b32 s99, s97, 3
    s_xor_b32 s97, s97, s99
    s_add_u32 m0, s87, 18432
    s_lshl_b32 s97, s97, 7
    buffer_load_dwordx4 v240, s[28:31], s97 offen offset:0  lds
    v_subrev_u32 v7, 1, v7
    v_bitop3_b32 v8, v7, 3, s3 bitop3:0x6a
    v_lshl_add_u32 v31, v8, 4, v136
    v_add_u32 v31, 90624, v31
    buffer_load_dwordx4 v241, s[28:31], s97 offen offset:1024  lds
    v_lshl_add_u32 v7, v5, 1, v6
    v_add_u32 v7, 26, v7
    v_and_b32 v8, 1, v7
    v_bfe_u32 v136, v7, 1, 2
    buffer_load_dwordx4 v242, s[28:31], s97 offen offset:2048  lds
    v_lshl_add_u32 v136, v8, 2, v136
    v_lshlrev_b32 v136, 6, v136
    v_lshrrev_b32 v7, 3, v7
    v_lshl_add_u32 v136, v7, 9, v136
    buffer_load_dwordx4 v243, s[28:31], s97 offen offset:3072  lds
    v_bitop3_b32 v8, v7, 3, s3 bitop3:0x6a
    v_lshl_add_u32 v26, v8, 4, v136
    v_add_u32 v26, 92160, v26
    v_subrev_u32 v7, 1, v7
    s_add_u32 m0, s88, 18432
    s_mov_b64 exec, 0xffffffff
    buffer_load_dwordx4 v3, s[28:31], s97 offen offset:0  lds
    s_mov_b64 exec, -1
    v_bitop3_b32 v8, v7, 3, s3 bitop3:0x6a
    v_lshl_add_u32 v28, v8, 4, v136
    v_add_u32 v28, 91648, v28
    v_subrev_u32 v7, 1, v7
    s_mul_i32 s16, s97, 3072
    s_add_u32 m0, s60, 24576
    s_add_u32 s99, s16, s62
    buffer_load_dwordx4 v244, s[32:35], s99 offen offset:0  lds
    v_bitop3_b32 v8, v7, 3, s3 bitop3:0x6a
    v_lshl_add_u32 v30, v8, 4, v136
    v_add_u32 v30, 91136, v30
    v_subrev_u32 v7, 1, v7
    buffer_load_dwordx4 v245, s[32:35], s99 offen offset:1024  lds
    v_bitop3_b32 v8, v7, 3, s3 bitop3:0x6a
    v_lshl_add_u32 v32, v8, 4, v136
    v_add_u32 v32, 90624, v32
    v_lshrrev_b32 v7, 1, v6
    buffer_load_dwordx4 v246, s[32:35], s99 offen offset:2048  lds
    v_lshl_add_u32 v7, v5, 1, v7
    v_add_u32 v7, 32, v7
    v_and_b32 v8, 1, v7
    v_bfe_u32 v136, v7, 1, 2
    s_add_u32 m0, s61, 36864
    s_add_u32 s16, s16, s63
    buffer_load_dwordx4 v244, s[32:35], s16 offen offset:0  lds
    v_lshl_add_u32 v136, v8, 2, v136
    v_lshlrev_b32 v136, 6, v136
    v_lshrrev_b32 v7, 3, v7
    v_lshl_add_u32 v136, v7, 9, v136
    buffer_load_dwordx4 v245, s[32:35], s16 offen offset:1024  lds
    v_bitop3_b32 v8, v7, 3, s3 bitop3:0x6a
    v_lshl_add_u32 v20, v8, 4, v136
    v_add_u32 v20, 92160, v20
    v_and_b32 v8, 1, v6
    buffer_load_dwordx4 v246, s[32:35], s16 offen offset:2048  lds
    v_xor_b32 v8, 1, v8
    v_lshl_add_u32 v20, v8, 3, v20
    s_waitcnt lgkmcnt(0)
    s_and_b32 s78, s92, 0xffff0000
    s_waitcnt vmcnt(11)
    s_barrier
    s_add_u32 s97, s98, s0
    s_lshr_b64 s[0:1], s[0:1], 4
    s_and_b32 s97, s97, 15
    s_lshr_b32 s99, s97, 3
    s_xor_b32 s97, s97, s99
    s_add_u32 m0, s87, 36864
    s_lshl_b32 s97, s97, 7
    buffer_load_dwordx4 v240, s[28:31], s97 offen offset:0  lds
    ds_read_b128 v[84:87], v35 offset:0
    ds_read_b128 v[88:91], v35 offset:16
    buffer_load_dwordx4 v241, s[28:31], s97 offen offset:1024  lds
    ds_read_b128 v[92:95], v35 offset:32
    buffer_load_dwordx4 v242, s[28:31], s97 offen offset:2048  lds
    ds_read_b128 v[96:99], v35 offset:48
    ds_read_b128 v[40:43], v233 offset:0
    buffer_load_dwordx4 v243, s[28:31], s97 offen offset:3072  lds
    ds_read_b128 v[44:47], v232 offset:256
    s_add_u32 m0, s88, 36864
    s_mov_b64 exec, 0xffffffff
    buffer_load_dwordx4 v3, s[28:31], s97 offen offset:0  lds
    s_mov_b64 exec, -1
    ds_read_b128 v[48:51], v233 offset:256
    s_mul_i32 s16, s97, 3072
    s_add_u32 m0, s60, 49152
    s_add_u32 s99, s16, s62
    buffer_load_dwordx4 v244, s[32:35], s99 offen offset:0  lds
    ds_read_b128 v[52:55], v16 offset:512
    ds_read_b128 v[56:59], v231 offset:512
    buffer_load_dwordx4 v245, s[32:35], s99 offen offset:1024  lds
    ds_read_b128 v[60:63], v16 offset:768
    buffer_load_dwordx4 v246, s[32:35], s99 offen offset:2048  lds
    ds_read_b128 v[64:67], v231 offset:768
    s_add_u32 m0, s61, 61440
    s_add_u32 s16, s16, s63
    buffer_load_dwordx4 v244, s[32:35], s16 offen offset:0  lds
    ds_read_b128 v[68:71], v16 offset:16896
    ds_read_b128 v[72:75], v231 offset:16896
    buffer_load_dwordx4 v245, s[32:35], s16 offen offset:1024  lds
    ds_read_b128 v[76:79], v16 offset:17152
    buffer_load_dwordx4 v246, s[32:35], s16 offen offset:2048  lds
    ds_read_b128 v[80:83], v231 offset:17152
    s_waitcnt vmcnt(11)
    s_waitcnt lgkmcnt(0)
    s_barrier
    s_add_u32 s97, s98, s0
    s_lshr_b64 s[0:1], s[0:1], 4
    s_and_b32 s97, s97, 15
    s_lshr_b32 s99, s97, 3
    s_xor_b32 s97, s97, s99
    s_add_u32 m0, s87, 0
    s_lshl_b32 s97, s97, 7
    buffer_load_dwordx4 v240, s[28:31], s97 offen offset:0  lds
    v_lshlrev_b32 v116, 16, v40
    v_lshlrev_b32 v117, 16, v44
    v_lshlrev_b32 v118, 16, v48
    v_lshlrev_b32 v119, 16, v52
    v_lshlrev_b32 v120, 16, v56
    buffer_load_dwordx4 v241, s[28:31], s97 offen offset:1024  lds
    v_lshlrev_b32 v121, 16, v60
    v_lshlrev_b32 v122, 16, v64
    v_lshlrev_b32 v127, 16, v84
    v_and_b32 v128, 0xffff0000, v84
    v_lshlrev_b32 v129, 16, v85
    buffer_load_dwordx4 v242, s[28:31], s97 offen offset:2048  lds
    v_and_b32 v130, 0xffff0000, v85
    v_lshlrev_b32 v123, 16, v68
    v_lshlrev_b32 v124, 16, v72
    v_lshlrev_b32 v125, 16, v76
    v_lshlrev_b32 v126, 16, v80
    buffer_load_dwordx4 v243, s[28:31], s97 offen offset:3072  lds
    v_mul_f32 v131, v116, v130
    v_mul_f32 v132, v117, v130
    v_mul_f32 v133, v118, v130
    v_mul_f32 v134, v119, v130
    v_fmac_f32 v131, v117, v129
    s_add_u32 m0, s88, 0
    s_mov_b64 exec, 0xffffffff
    buffer_load_dwordx4 v3, s[28:31], s97 offen offset:0  lds
    s_mov_b64 exec, -1
    v_fmac_f32 v132, v118, v129
    v_fmac_f32 v133, v119, v129
    v_fmac_f32 v134, v120, v129
    v_fmac_f32 v131, v118, v128
    v_fmac_f32 v132, v119, v128
    s_mul_i32 s16, s97, 3072
    s_add_u32 m0, s60, 0
    s_add_u32 s99, s16, s62
    buffer_load_dwordx4 v244, s[32:35], s99 offen offset:0  lds
    v_fmac_f32 v133, v120, v128
    v_fmac_f32 v134, v121, v128
    v_fmac_f32 v131, v119, v127
    v_fmac_f32 v132, v120, v127
    v_fmac_f32 v133, v121, v127
    buffer_load_dwordx4 v245, s[32:35], s99 offen offset:1024  lds
    v_fmac_f32 v134, v122, v127
    v_mul_f32 v131, v131, v123
    v_mul_f32 v132, v132, v124
    v_mul_f32 v133, v133, v125
    v_mul_f32 v134, v134, v126
    buffer_load_dwordx4 v246, s[32:35], s99 offen offset:2048  lds
    v_cvt_pk_bf16_f32 v102, v134, v133
    v_cvt_pk_bf16_f32 v103, v132, v131
    v_lshlrev_b32 v116, 16, v42
    v_lshlrev_b32 v117, 16, v46
    v_lshlrev_b32 v118, 16, v50
    s_add_u32 m0, s61, 12288
    s_add_u32 s16, s16, s63
    buffer_load_dwordx4 v244, s[32:35], s16 offen offset:0  lds
    v_lshlrev_b32 v119, 16, v54
    v_lshlrev_b32 v120, 16, v58
    v_lshlrev_b32 v121, 16, v62
    v_lshlrev_b32 v122, 16, v66
    v_lshlrev_b32 v127, 16, v92
    buffer_load_dwordx4 v245, s[32:35], s16 offen offset:1024  lds
    v_and_b32 v128, 0xffff0000, v92
    v_lshlrev_b32 v129, 16, v93
    v_and_b32 v130, 0xffff0000, v93
    v_lshlrev_b32 v123, 16, v70
    v_lshlrev_b32 v124, 16, v74
    buffer_load_dwordx4 v246, s[32:35], s16 offen offset:2048  lds
    v_lshlrev_b32 v125, 16, v78
    v_lshlrev_b32 v126, 16, v82
    v_mul_f32 v131, v116, v130
    v_mul_f32 v132, v117, v130
    v_mul_f32 v133, v118, v130
    v_mul_f32 v134, v119, v130
    v_fmac_f32 v131, v117, v129
    v_fmac_f32 v132, v118, v129
    v_fmac_f32 v133, v119, v129
    v_fmac_f32 v134, v120, v129
    v_fmac_f32 v131, v118, v128
    v_fmac_f32 v132, v119, v128
    s_waitcnt vmcnt(11)
    s_barrier
    s_add_u32 s97, s98, s0
    s_lshr_b64 s[0:1], s[0:1], 4
    s_and_b32 s97, s97, 15
    s_lshr_b32 s99, s97, 3
    s_xor_b32 s97, s97, s99
    s_add_u32 m0, s87, 18432
    s_lshl_b32 s97, s97, 7
    buffer_load_dwordx4 v240, s[28:31], s97 offen offset:0  lds
    v_fmac_f32 v133, v120, v128
    v_fmac_f32 v134, v121, v128
    v_fmac_f32 v131, v119, v127
    v_fmac_f32 v132, v120, v127
    v_fmac_f32 v133, v121, v127
    buffer_load_dwordx4 v241, s[28:31], s97 offen offset:1024  lds
    v_fmac_f32 v134, v122, v127
    v_mul_f32 v131, v131, v123
    v_mul_f32 v132, v132, v124
    v_mul_f32 v133, v133, v125
    v_mul_f32 v134, v134, v126
    buffer_load_dwordx4 v242, s[28:31], s97 offen offset:2048  lds
    v_cvt_pk_bf16_f32 v100, v134, v133
    v_cvt_pk_bf16_f32 v101, v132, v131
    s_nop 0
    v_permlane32_swap_b32 v102, v100
    v_permlane32_swap_b32 v103, v101
    s_mov_b32 s89, 0
    buffer_store_dwordx4 v[100:103], v12, s[52:55], s89 offen sc1
    buffer_load_dwordx4 v243, s[28:31], s97 offen offset:3072  lds
    v_and_b32 v116, 0xffff0000, v40
    v_and_b32 v117, 0xffff0000, v44
    v_and_b32 v118, 0xffff0000, v48
    v_and_b32 v119, 0xffff0000, v52
    v_and_b32 v120, 0xffff0000, v56
    s_add_u32 m0, s88, 18432
    s_mov_b64 exec, 0xffffffff
    buffer_load_dwordx4 v3, s[28:31], s97 offen offset:0  lds
    s_mov_b64 exec, -1
    v_and_b32 v121, 0xffff0000, v60
    v_and_b32 v122, 0xffff0000, v64
    v_lshlrev_b32 v127, 16, v86
    v_and_b32 v128, 0xffff0000, v86
    v_lshlrev_b32 v129, 16, v87
    s_mul_i32 s16, s97, 3072
    s_add_u32 m0, s60, 24576
    s_add_u32 s99, s16, s62
    buffer_load_dwordx4 v244, s[32:35], s99 offen offset:0  lds
    v_and_b32 v130, 0xffff0000, v87
    v_and_b32 v123, 0xffff0000, v68
    v_and_b32 v124, 0xffff0000, v72
    v_and_b32 v125, 0xffff0000, v76
    v_and_b32 v126, 0xffff0000, v80
    buffer_load_dwordx4 v245, s[32:35], s99 offen offset:1024  lds
    v_mul_f32 v131, v116, v130
    v_mul_f32 v132, v117, v130
    v_mul_f32 v133, v118, v130
    v_mul_f32 v134, v119, v130
    v_fmac_f32 v131, v117, v129
    buffer_load_dwordx4 v246, s[32:35], s99 offen offset:2048  lds
    v_fmac_f32 v132, v118, v129
    v_fmac_f32 v133, v119, v129
    v_fmac_f32 v134, v120, v129
    v_fmac_f32 v131, v118, v128
    v_fmac_f32 v132, v119, v128
    s_add_u32 m0, s61, 36864
    s_add_u32 s16, s16, s63
    buffer_load_dwordx4 v244, s[32:35], s16 offen offset:0  lds
    v_fmac_f32 v133, v120, v128
    v_fmac_f32 v134, v121, v128
    v_fmac_f32 v131, v119, v127
    v_fmac_f32 v132, v120, v127
    v_fmac_f32 v133, v121, v127
    buffer_load_dwordx4 v245, s[32:35], s16 offen offset:1024  lds
    v_fmac_f32 v134, v122, v127
    v_mul_f32 v131, v131, v123
    v_mul_f32 v132, v132, v124
    v_mul_f32 v133, v133, v125
    v_mul_f32 v134, v134, v126
    buffer_load_dwordx4 v246, s[32:35], s16 offen offset:2048  lds
    v_cvt_pk_bf16_f32 v106, v134, v133
    v_cvt_pk_bf16_f32 v107, v132, v131
    v_and_b32 v116, 0xffff0000, v42
    v_and_b32 v117, 0xffff0000, v46
    v_and_b32 v118, 0xffff0000, v50
    v_and_b32 v119, 0xffff0000, v54
    v_and_b32 v120, 0xffff0000, v58
    v_and_b32 v121, 0xffff0000, v62
    v_and_b32 v122, 0xffff0000, v66
    v_lshlrev_b32 v127, 16, v94
    v_and_b32 v128, 0xffff0000, v94
    v_lshlrev_b32 v129, 16, v95
    s_waitcnt vmcnt(12)
    s_barrier
    buffer_load_dword v230, v229, s[64:67], 0 offen
    v_and_b32 v130, 0xffff0000, v95
    v_and_b32 v123, 0xffff0000, v70
    v_and_b32 v124, 0xffff0000, v74
    v_and_b32 v125, 0xffff0000, v78
    v_and_b32 v126, 0xffff0000, v82
    s_add_u32 s97, s98, s0
    s_lshr_b64 s[0:1], s[0:1], 4
    s_and_b32 s97, s97, 15
    s_lshr_b32 s99, s97, 3
    s_xor_b32 s97, s97, s99
    s_add_u32 m0, s87, 36864
    s_lshl_b32 s97, s97, 7
    buffer_load_dwordx4 v240, s[28:31], s97 offen offset:0  lds
    v_mul_f32 v131, v116, v130
    v_mul_f32 v132, v117, v130
    v_mul_f32 v133, v118, v130
    v_mul_f32 v134, v119, v130
    v_fmac_f32 v131, v117, v129
    buffer_load_dwordx4 v241, s[28:31], s97 offen offset:1024  lds
    v_fmac_f32 v132, v118, v129
    v_fmac_f32 v133, v119, v129
    v_fmac_f32 v134, v120, v129
    v_fmac_f32 v131, v118, v128
    v_fmac_f32 v132, v119, v128
    buffer_load_dwordx4 v242, s[28:31], s97 offen offset:2048  lds
    v_fmac_f32 v133, v120, v128
    v_fmac_f32 v134, v121, v128
    v_fmac_f32 v131, v119, v127
    v_fmac_f32 v132, v120, v127
    v_fmac_f32 v133, v121, v127
    buffer_load_dwordx4 v243, s[28:31], s97 offen offset:3072  lds
    v_fmac_f32 v134, v122, v127
    v_mul_f32 v131, v131, v123
    v_mul_f32 v132, v132, v124
    v_mul_f32 v133, v133, v125
    v_mul_f32 v134, v134, v126
    s_add_u32 m0, s88, 36864
    s_mov_b64 exec, 0xffffffff
    buffer_load_dwordx4 v3, s[28:31], s97 offen offset:0  lds
    s_mov_b64 exec, -1
    v_cvt_pk_bf16_f32 v104, v134, v133
    v_cvt_pk_bf16_f32 v105, v132, v131
    s_nop 0
    v_permlane32_swap_b32 v106, v104
    v_permlane32_swap_b32 v107, v105
    s_mov_b32 s89, 16384
    buffer_store_dwordx4 v[104:107], v12, s[52:55], s89 offen sc1
    s_mul_i32 s16, s97, 3072
    s_add_u32 m0, s60, 49152
    s_add_u32 s99, s16, s62
    buffer_load_dwordx4 v244, s[32:35], s99 offen offset:0  lds
    v_lshlrev_b32 v116, 16, v41
    v_lshlrev_b32 v117, 16, v45
    v_lshlrev_b32 v118, 16, v49
    v_lshlrev_b32 v119, 16, v53
    v_lshlrev_b32 v120, 16, v57
    buffer_load_dwordx4 v245, s[32:35], s99 offen offset:1024  lds
    v_lshlrev_b32 v121, 16, v61
    v_lshlrev_b32 v122, 16, v65
    v_lshlrev_b32 v127, 16, v88
    v_and_b32 v128, 0xffff0000, v88
    v_lshlrev_b32 v129, 16, v89
    buffer_load_dwordx4 v246, s[32:35], s99 offen offset:2048  lds
    v_and_b32 v130, 0xffff0000, v89
    v_lshlrev_b32 v123, 16, v69
    v_lshlrev_b32 v124, 16, v73
    v_lshlrev_b32 v125, 16, v77
    v_lshlrev_b32 v126, 16, v81
    s_add_u32 m0, s61, 61440
    s_add_u32 s16, s16, s63
    buffer_load_dwordx4 v244, s[32:35], s16 offen offset:0  lds
    v_mul_f32 v131, v116, v130
    v_mul_f32 v132, v117, v130
    v_mul_f32 v133, v118, v130
    v_mul_f32 v134, v119, v130
    v_fmac_f32 v131, v117, v129
    buffer_load_dwordx4 v245, s[32:35], s16 offen offset:1024  lds
    v_fmac_f32 v132, v118, v129
    v_fmac_f32 v133, v119, v129
    v_fmac_f32 v134, v120, v129
    v_fmac_f32 v131, v118, v128
    v_fmac_f32 v132, v119, v128
    buffer_load_dwordx4 v246, s[32:35], s16 offen offset:2048  lds
    v_fmac_f32 v133, v120, v128
    v_fmac_f32 v134, v121, v128
    v_fmac_f32 v131, v119, v127
    v_fmac_f32 v132, v120, v127
    v_fmac_f32 v133, v121, v127
    v_fmac_f32 v134, v122, v127
    v_mul_f32 v131, v131, v123
    s_waitcnt vmcnt(13)
    s_barrier
    s_add_u32 s97, s98, s0
    s_lshr_b64 s[0:1], s[0:1], 4
    s_and_b32 s97, s97, 15
    s_lshr_b32 s99, s97, 3
    s_xor_b32 s97, s97, s99
    s_add_u32 m0, s87, 0
    s_lshl_b32 s97, s97, 7
    buffer_load_dwordx4 v240, s[28:31], s97 offen offset:0  lds
    v_mul_f32 v132, v132, v124
    v_mul_f32 v133, v133, v125
    v_mul_f32 v134, v134, v126
    v_cvt_pk_bf16_f32 v110, v134, v133
    v_cvt_pk_bf16_f32 v111, v132, v131
    buffer_load_dwordx4 v241, s[28:31], s97 offen offset:1024  lds
    v_lshlrev_b32 v116, 16, v43
    v_lshlrev_b32 v117, 16, v47
    v_lshlrev_b32 v118, 16, v51
    v_lshlrev_b32 v119, 16, v55
    v_lshlrev_b32 v120, 16, v59
    buffer_load_dwordx4 v242, s[28:31], s97 offen offset:2048  lds
    v_lshlrev_b32 v121, 16, v63
    v_lshlrev_b32 v122, 16, v67
    v_lshlrev_b32 v127, 16, v96
    v_and_b32 v128, 0xffff0000, v96
    v_lshlrev_b32 v129, 16, v97
    buffer_load_dwordx4 v243, s[28:31], s97 offen offset:3072  lds
    v_and_b32 v130, 0xffff0000, v97
    v_lshlrev_b32 v123, 16, v71
    v_lshlrev_b32 v124, 16, v75
    v_lshlrev_b32 v125, 16, v79
    v_lshlrev_b32 v126, 16, v83
    s_add_u32 m0, s88, 0
    s_mov_b64 exec, 0xffffffff
    buffer_load_dwordx4 v3, s[28:31], s97 offen offset:0  lds
    s_mov_b64 exec, -1
    v_mul_f32 v131, v116, v130
    v_mul_f32 v132, v117, v130
    v_mul_f32 v133, v118, v130
    v_mul_f32 v134, v119, v130
    v_fmac_f32 v131, v117, v129
    s_mul_i32 s16, s97, 3072
    s_add_u32 m0, s60, 0
    s_add_u32 s99, s16, s62
    buffer_load_dwordx4 v244, s[32:35], s99 offen offset:0  lds
    v_fmac_f32 v132, v118, v129
    v_fmac_f32 v133, v119, v129
    v_fmac_f32 v134, v120, v129
    v_fmac_f32 v131, v118, v128
    v_fmac_f32 v132, v119, v128
    buffer_load_dwordx4 v245, s[32:35], s99 offen offset:1024  lds
    v_fmac_f32 v133, v120, v128
    v_fmac_f32 v134, v121, v128
    v_fmac_f32 v131, v119, v127
    v_fmac_f32 v132, v120, v127
    v_fmac_f32 v133, v121, v127
    buffer_load_dwordx4 v246, s[32:35], s99 offen offset:2048  lds
    v_fmac_f32 v134, v122, v127
    v_mul_f32 v131, v131, v123
    v_mul_f32 v132, v132, v124
    v_mul_f32 v133, v133, v125
    v_mul_f32 v134, v134, v126
    s_add_u32 m0, s61, 12288
    s_add_u32 s16, s16, s63
    buffer_load_dwordx4 v244, s[32:35], s16 offen offset:0  lds
    v_cvt_pk_bf16_f32 v108, v134, v133
    v_cvt_pk_bf16_f32 v109, v132, v131
    s_nop 0
    v_permlane32_swap_b32 v110, v108
    v_permlane32_swap_b32 v111, v109
    s_mov_b32 s89, 32768
    buffer_store_dwordx4 v[108:111], v12, s[52:55], s89 offen sc1
    buffer_load_dwordx4 v245, s[32:35], s16 offen offset:1024  lds
    v_and_b32 v116, 0xffff0000, v41
    v_and_b32 v117, 0xffff0000, v45
    v_and_b32 v118, 0xffff0000, v49
    v_and_b32 v119, 0xffff0000, v53
    v_and_b32 v120, 0xffff0000, v57
    buffer_load_dwordx4 v246, s[32:35], s16 offen offset:2048  lds
    v_and_b32 v121, 0xffff0000, v61
    v_and_b32 v122, 0xffff0000, v65
    v_lshlrev_b32 v127, 16, v90
    v_and_b32 v128, 0xffff0000, v90
    v_lshlrev_b32 v129, 16, v91
    v_and_b32 v130, 0xffff0000, v91
    v_and_b32 v123, 0xffff0000, v69
    v_and_b32 v124, 0xffff0000, v73
    v_and_b32 v125, 0xffff0000, v77
    v_and_b32 v126, 0xffff0000, v81
    v_mul_f32 v131, v116, v130
    v_mul_f32 v132, v117, v130
    s_waitcnt vmcnt(12)
    s_barrier
    s_add_u32 s97, s98, s0
    s_lshr_b64 s[0:1], s[0:1], 4
    s_and_b32 s97, s97, 15
    s_lshr_b32 s99, s97, 3
    s_xor_b32 s97, s97, s99
    s_add_u32 m0, s87, 18432
    s_lshl_b32 s97, s97, 7
    buffer_load_dwordx4 v240, s[28:31], s97 offen offset:0  lds
    v_mul_f32 v133, v118, v130
    v_mul_f32 v134, v119, v130
    v_fmac_f32 v131, v117, v129
    v_fmac_f32 v132, v118, v129
    v_fmac_f32 v133, v119, v129
    buffer_load_dwordx4 v241, s[28:31], s97 offen offset:1024  lds
    v_fmac_f32 v134, v120, v129
    v_fmac_f32 v131, v118, v128
    v_fmac_f32 v132, v119, v128
    v_fmac_f32 v133, v120, v128
    v_fmac_f32 v134, v121, v128
    buffer_load_dwordx4 v242, s[28:31], s97 offen offset:2048  lds
    v_fmac_f32 v131, v119, v127
    v_fmac_f32 v132, v120, v127
    v_fmac_f32 v133, v121, v127
    v_fmac_f32 v134, v122, v127
    v_mul_f32 v131, v131, v123
    buffer_load_dwordx4 v243, s[28:31], s97 offen offset:3072  lds
    v_mul_f32 v132, v132, v124
    v_mul_f32 v133, v133, v125
    v_mul_f32 v134, v134, v126
    v_cvt_pk_bf16_f32 v114, v134, v133
    v_cvt_pk_bf16_f32 v115, v132, v131
    s_add_u32 m0, s88, 18432
    s_mov_b64 exec, 0xffffffff
    buffer_load_dwordx4 v3, s[28:31], s97 offen offset:0  lds
    s_mov_b64 exec, -1
    v_and_b32 v116, 0xffff0000, v43
    v_and_b32 v117, 0xffff0000, v47
    v_and_b32 v118, 0xffff0000, v51
    v_and_b32 v119, 0xffff0000, v55
    v_and_b32 v120, 0xffff0000, v59
    s_mul_i32 s16, s97, 3072
    s_add_u32 m0, s60, 24576
    s_add_u32 s99, s16, s62
    buffer_load_dwordx4 v244, s[32:35], s99 offen offset:0  lds
    v_and_b32 v121, 0xffff0000, v63
    v_and_b32 v122, 0xffff0000, v67
    v_lshlrev_b32 v127, 16, v98
    v_and_b32 v128, 0xffff0000, v98
    v_lshlrev_b32 v129, 16, v99
    buffer_load_dwordx4 v245, s[32:35], s99 offen offset:1024  lds
    v_and_b32 v130, 0xffff0000, v99
    v_and_b32 v123, 0xffff0000, v71
    v_and_b32 v124, 0xffff0000, v75
    v_and_b32 v125, 0xffff0000, v79
    v_and_b32 v126, 0xffff0000, v83
    buffer_load_dwordx4 v246, s[32:35], s99 offen offset:2048  lds
    v_mul_f32 v131, v116, v130
    v_mul_f32 v132, v117, v130
    v_mul_f32 v133, v118, v130
    v_mul_f32 v134, v119, v130
    v_fmac_f32 v131, v117, v129
    s_add_u32 m0, s61, 36864
    s_add_u32 s16, s16, s63
    buffer_load_dwordx4 v244, s[32:35], s16 offen offset:0  lds
    v_fmac_f32 v132, v118, v129
    v_fmac_f32 v133, v119, v129
    v_fmac_f32 v134, v120, v129
    v_fmac_f32 v131, v118, v128
    v_fmac_f32 v132, v119, v128
    buffer_load_dwordx4 v245, s[32:35], s16 offen offset:1024  lds
    v_fmac_f32 v133, v120, v128
    v_fmac_f32 v134, v121, v128
    v_fmac_f32 v131, v119, v127
    v_fmac_f32 v132, v120, v127
    v_fmac_f32 v133, v121, v127
    buffer_load_dwordx4 v246, s[32:35], s16 offen offset:2048  lds
    v_fmac_f32 v134, v122, v127
    v_mul_f32 v131, v131, v123
    v_mul_f32 v132, v132, v124
    v_mul_f32 v133, v133, v125
    v_mul_f32 v134, v134, v126
    v_cvt_pk_bf16_f32 v112, v134, v133
    v_cvt_pk_bf16_f32 v113, v132, v131
    s_nop 0
    v_permlane32_swap_b32 v114, v112
    v_permlane32_swap_b32 v115, v113
    s_mov_b32 s89, 49152
    buffer_store_dwordx4 v[112:115], v12, s[52:55], s89 offen sc1
    s_waitcnt vmcnt(12)
    s_barrier
    s_add_u32 s97, s98, s0
    s_lshr_b64 s[0:1], s[0:1], 4
    s_and_b32 s97, s97, 15
    s_lshr_b32 s99, s97, 3
    s_xor_b32 s97, s97, s99
    s_add_u32 m0, s87, 36864
    s_lshl_b32 s97, s97, 7
    buffer_load_dwordx4 v240, s[28:31], s97 offen offset:0  lds
    s_lshl_b32 s92, s92, 16
    s_bitcmp1_b32 s90, 0
    s_cselect_b32 s92, s78, s92
    buffer_load_dwordx4 v241, s[28:31], s97 offen offset:1024  lds
    v_lshlrev_b32 v7, 3, v6
    v_sub_u32 v7, v7, v5
    buffer_load_dwordx4 v242, s[28:31], s97 offen offset:2048  lds
    v_subrev_u32 v7, 9, v7
    buffer_load_dwordx4 v243, s[28:31], s97 offen offset:3072  lds
    v_and_b32 v8, 1, v7
    v_xor_b32 v8, 1, v8
    s_add_u32 m0, s88, 36864
    s_mov_b64 exec, 0xffffffff
    buffer_load_dwordx4 v3, s[28:31], s97 offen offset:0  lds
    s_mov_b64 exec, -1
    v_lshlrev_b32 v8, 4, v8
    v_lshrrev_b32 v8, v8, s92
    s_mul_i32 s16, s97, 3072
    s_add_u32 m0, s60, 49152
    s_add_u32 s99, s16, s62
    buffer_load_dwordx4 v244, s[32:35], s99 offen offset:0  lds
    v_ashrrev_i32 v7, 1, v7
    buffer_load_dwordx4 v245, s[32:35], s99 offen offset:1024  lds
    v_cmp_eq_u32 vcc, 0, v7
    s_nop 1
    v_cndmask_b32 v236, 0, v8, vcc
    buffer_load_dwordx4 v246, s[32:35], s99 offen offset:2048  lds
    v_cmp_eq_u32 vcc, 1, v7
    s_nop 1
    v_cndmask_b32 v237, 0, v8, vcc
    s_add_u32 m0, s61, 61440
    s_add_u32 s16, s16, s63
    buffer_load_dwordx4 v244, s[32:35], s16 offen offset:0  lds
    v_cmp_eq_u32 vcc, 2, v7
    buffer_load_dwordx4 v245, s[32:35], s16 offen offset:1024  lds
    s_nop 0
    v_cndmask_b32 v238, 0, v8, vcc
    v_cmp_eq_u32 vcc, 3, v7
    buffer_load_dwordx4 v246, s[32:35], s16 offen offset:2048  lds
    s_nop 0
    v_cndmask_b32 v239, 0, v8, vcc
    s_waitcnt vmcnt(12)
    s_barrier
    s_add_u32 m0, s94, 32
    s_lshl_b32 s89, s90, 12
    buffer_load_dwordx4 v15, s[48:51], s89 offen offset:0 nt lds
    s_add_u32 m0, s94, 32
    s_lshl_b32 s89, s90, 12
    buffer_load_dwordx4 v15, s[48:51], s89 offen offset:1024 nt lds
    s_add_u32 m0, s94, 32
    s_lshl_b32 s89, s90, 12
    buffer_load_dwordx4 v15, s[48:51], s89 offen offset:2048 nt lds
    s_add_u32 m0, s94, 32
    s_lshl_b32 s89, s90, 12
    buffer_load_dwordx4 v15, s[48:51], s89 offen offset:3072 nt lds
    s_add_u32 s97, s98, s0
    s_lshr_b64 s[0:1], s[0:1], 4
    s_and_b32 s97, s97, 15
    s_lshr_b32 s99, s97, 3
    s_xor_b32 s97, s97, s99
    s_add_u32 m0, s87, 0
    s_lshl_b32 s97, s97, 7
    buffer_load_dwordx4 v240, s[28:31], s97 offen offset:0  lds
    buffer_load_dwordx4 v241, s[28:31], s97 offen offset:1024  lds
    buffer_load_dwordx4 v242, s[28:31], s97 offen offset:2048  lds
    buffer_load_dwordx4 v243, s[28:31], s97 offen offset:3072  lds
    s_add_u32 m0, s88, 0
    s_mov_b64 exec, 0xffffffff
    buffer_load_dwordx4 v3, s[28:31], s97 offen offset:0  lds
    s_mov_b64 exec, -1
    s_mul_i32 s16, s97, 3072
    s_add_u32 m0, s60, 0
    s_add_u32 s99, s16, s62
    buffer_load_dwordx4 v244, s[32:35], s99 offen offset:0  lds
    buffer_load_dwordx4 v245, s[32:35], s99 offen offset:1024  lds
    buffer_load_dwordx4 v246, s[32:35], s99 offen offset:2048  lds
    s_add_u32 m0, s61, 12288
    s_add_u32 s16, s16, s63
    buffer_load_dwordx4 v244, s[32:35], s16 offen offset:0  lds
    buffer_load_dwordx4 v245, s[32:35], s16 offen offset:1024  lds
    buffer_load_dwordx4 v246, s[32:35], s16 offen offset:2048  lds
    s_waitcnt vmcnt(15)
    s_barrier
    s_add_u32 s97, s98, s0
    s_lshr_b64 s[0:1], s[0:1], 4
    s_and_b32 s97, s97, 15
    s_lshr_b32 s99, s97, 3
    s_xor_b32 s97, s97, s99
    s_add_u32 m0, s87, 18432
    s_lshl_b32 s97, s97, 7
    buffer_load_dwordx4 v240, s[28:31], s97 offen offset:0  lds
    buffer_load_dwordx4 v241, s[28:31], s97 offen offset:1024  lds
    buffer_load_dwordx4 v242, s[28:31], s97 offen offset:2048  lds
    buffer_load_dwordx4 v243, s[28:31], s97 offen offset:3072  lds
    s_add_u32 m0, s88, 18432
    s_mov_b64 exec, 0xffffffff
    buffer_load_dwordx4 v3, s[28:31], s97 offen offset:0  lds
    s_mov_b64 exec, -1
    s_mul_i32 s16, s97, 3072
    s_add_u32 m0, s60, 24576
    s_add_u32 s99, s16, s62
    buffer_load_dwordx4 v244, s[32:35], s99 offen offset:0  lds
    buffer_load_dwordx4 v245, s[32:35], s99 offen offset:1024  lds
    buffer_load_dwordx4 v246, s[32:35], s99 offen offset:2048  lds
    s_add_u32 m0, s61, 36864
    s_add_u32 s16, s16, s63
    buffer_load_dwordx4 v244, s[32:35], s16 offen offset:0  lds
    buffer_load_dwordx4 v245, s[32:35], s16 offen offset:1024  lds
    buffer_load_dwordx4 v246, s[32:35], s16 offen offset:2048  lds
    s_waitcnt vmcnt(11)
    s_barrier
    s_add_u32 s97, s98, s0
    s_lshr_b64 s[0:1], s[0:1], 4
    s_and_b32 s97, s97, 15
    s_lshr_b32 s99, s97, 3
    s_xor_b32 s97, s97, s99
    s_add_u32 m0, s87, 36864
    s_lshl_b32 s97, s97, 7
    buffer_load_dwordx4 v240, s[28:31], s97 offen offset:0  lds
    v_add_u32 v5, s94, v15
    ds_read_b128 v[140:143], v5 offset:32
    ds_read_b32 v156, v5 offset:48
    ds_read_b128 v[144:147], v5 offset:1056
    buffer_load_dwordx4 v241, s[28:31], s97 offen offset:1024  lds
    ds_read_b32 v157, v5 offset:1072
    ds_read_b128 v[148:151], v5 offset:2080
    ds_read_b32 v158, v5 offset:2096
    ds_read_b128 v[152:155], v5 offset:3104
    buffer_load_dwordx4 v242, s[28:31], s97 offen offset:2048  lds
    ds_read_b32 v159, v5 offset:3120
    v_lshrrev_b32 v6, 3, v0
    v_mul_u32_u24 v6, 4160, v6
    buffer_load_dwordx4 v243, s[28:31], s97 offen offset:3072  lds
    v_and_b32 v7, 7, v0
    v_lshl_add_u32 v6, v7, 2, v6
    v_add_u32 v6, s94, v6
    v_mov_b32 v7, 0
    s_add_u32 m0, s88, 36864
    s_mov_b64 exec, 0xffffffff
    buffer_load_dwordx4 v3, s[28:31], s97 offen offset:0  lds
    s_mov_b64 exec, -1
    s_waitcnt lgkmcnt(0)
    v_readfirstlane_b32 s93, v140
    s_nop 0
    s_lshl_b32 s93, s93, 16
    s_nop 1
    v_writelane_b32 v7, s93, 15
    s_mul_i32 s16, s97, 3072
    s_add_u32 m0, s60, 49152
    s_add_u32 s99, s16, s62
    buffer_load_dwordx4 v244, s[32:35], s99 offen offset:0  lds
    v_alignbit_b32 v140, v141, v140, 16
    v_alignbit_b32 v141, v142, v141, 16
    v_alignbit_b32 v142, v143, v142, 16
    buffer_load_dwordx4 v245, s[32:35], s99 offen offset:1024  lds
    v_alignbit_b32 v143, v156, v143, 16
    v_alignbit_b32 v144, v145, v144, 16
    v_alignbit_b32 v145, v146, v145, 16
    v_alignbit_b32 v146, v147, v146, 16
    buffer_load_dwordx4 v246, s[32:35], s99 offen offset:2048  lds
    v_alignbit_b32 v147, v157, v147, 16
    v_alignbit_b32 v148, v149, v148, 16
    v_alignbit_b32 v149, v150, v149, 16
    v_alignbit_b32 v150, v151, v150, 16
    s_add_u32 m0, s61, 61440
    s_add_u32 s16, s16, s63
    buffer_load_dwordx4 v244, s[32:35], s16 offen offset:0  lds
    v_alignbit_b32 v151, v158, v151, 16
    v_alignbit_b32 v152, v153, v152, 16
    v_alignbit_b32 v153, v154, v153, 16
    buffer_load_dwordx4 v245, s[32:35], s16 offen offset:1024  lds
    v_alignbit_b32 v154, v155, v154, 16
    v_alignbit_b32 v155, v159, v155, 16
    v_lshlrev_b32 v8, 3, v0
    s_add_u32 s78, s88, 18432
    buffer_load_dwordx4 v246, s[32:35], s16 offen offset:2048  lds
    v_add_u32 v8, s78, v8
    v_mov_b32 v156, 0
    v_mov_b32 v157, 0
    s_waitcnt vmcnt(11)
    s_barrier
    s_add_u32 s97, s98, s0
    s_lshr_b64 s[0:1], s[0:1], 4
    s_and_b32 s97, s97, 15
    s_lshr_b32 s99, s97, 3
    s_xor_b32 s97, s97, s99
    s_add_u32 m0, s87, 0
    s_lshl_b32 s97, s97, 7
    buffer_load_dwordx4 v240, s[28:31], s97 offen offset:0  lds
    buffer_load_dwordx4 v241, s[28:31], s97 offen offset:1024  lds
    buffer_load_dwordx4 v242, s[28:31], s97 offen offset:2048  lds
    buffer_load_dwordx4 v243, s[28:31], s97 offen offset:3072  lds
    s_add_u32 m0, s88, 0
    s_mov_b64 exec, 0xffffffff
    buffer_load_dwordx4 v3, s[28:31], s97 offen offset:0  lds
    s_mov_b64 exec, -1
    s_mul_i32 s16, s97, 3072
    s_add_u32 m0, s60, 0
    s_add_u32 s99, s16, s62
    buffer_load_dwordx4 v244, s[32:35], s99 offen offset:0  lds
    buffer_load_dwordx4 v245, s[32:35], s99 offen offset:1024  lds
    buffer_load_dwordx4 v246, s[32:35], s99 offen offset:2048  lds
    s_add_u32 m0, s61, 12288
    s_add_u32 s16, s16, s63
    buffer_load_dwordx4 v244, s[32:35], s16 offen offset:0  lds
    buffer_load_dwordx4 v245, s[32:35], s16 offen offset:1024  lds
    buffer_load_dwordx4 v246, s[32:35], s16 offen offset:2048  lds
    s_mov_b64 exec, 0xff
    buffer_load_dword v136, v33, s[68:71], 0 offen sc1
    buffer_load_dword v137, v34, s[52:55], 0 offen sc1
    s_mov_b64 exec, -1
    s_waitcnt vmcnt(13)
    s_barrier
    s_waitcnt vmcnt(0)
    s_branch LA_j
LA_c1:
    s_waitcnt vmcnt(7)
    s_barrier
    buffer_load_dwordx4 v246, s[32:35], s99 offen offset:2048  lds
    s_add_u32 m0, s61, 36864
    s_add_u32 s16, s16, s63
    buffer_load_dwordx4 v244, s[32:35], s16 offen offset:0  lds
    buffer_load_dwordx4 v245, s[32:35], s16 offen offset:1024  lds
    buffer_load_dwordx4 v246, s[32:35], s16 offen offset:2048  lds
    s_add_u32 s97, s98, s0
    s_lshr_b64 s[0:1], s[0:1], 4
    s_and_b32 s97, s97, 15
    s_lshr_b32 s99, s97, 3
    s_xor_b32 s97, s97, s99
    s_add_u32 m0, s87, 36864
    s_lshl_b32 s97, s97, 7
    buffer_load_dwordx4 v240, s[28:31], s97 offen offset:0  lds
    buffer_load_dwordx4 v241, s[28:31], s97 offen offset:1024  lds
    buffer_load_dwordx4 v242, s[28:31], s97 offen offset:2048  lds
    buffer_load_dwordx4 v243, s[28:31], s97 offen offset:3072  lds
    s_add_u32 m0, s88, 36864
    s_mov_b64 exec, 0xffffffff
    buffer_load_dwordx4 v3, s[28:31], s97 offen offset:0  lds
    s_mov_b64 exec, -1
    s_mul_i32 s16, s97, 3072
    s_add_u32 m0, s60, 49152
    s_add_u32 s99, s16, s62
    buffer_load_dwordx4 v244, s[32:35], s99 offen offset:0  lds
    buffer_load_dwordx4 v245, s[32:35], s99 offen offset:1024  lds
    buffer_load_dwordx4 v246, s[32:35], s99 offen offset:2048  lds
    s_add_u32 m0, s61, 61440
    s_add_u32 s16, s16, s63
    buffer_load_dwordx4 v244, s[32:35], s16 offen offset:0  lds
    buffer_load_dwordx4 v245, s[32:35], s16 offen offset:1024  lds
    buffer_load_dwordx4 v246, s[32:35], s16 offen offset:2048  lds
    s_waitcnt vmcnt(11)
    s_barrier
    s_add_u32 s97, s98, s0
    s_lshr_b64 s[0:1], s[0:1], 4
    s_and_b32 s97, s97, 15
    s_lshr_b32 s99, s97, 3
    s_xor_b32 s97, s97, s99
    s_add_u32 m0, s87, 0
    s_lshl_b32 s97, s97, 7
    buffer_load_dwordx4 v240, s[28:31], s97 offen offset:0  lds
    s_mov_b32 s68, s24
    s_mov_b32 s69, s25
    s_mov_b32 s70, 0x100
    s_mov_b32 s71, 0x20000
    v_lshrrev_b32 v6, 5, v0
    buffer_load_dwordx4 v241, s[28:31], s97 offen offset:1024  lds
    v_and_b32 v7, 3, v0
    s_lshr_b32 s78, s90, 1
    s_lshl_b32 s78, s78, 2
    s_load_dword s92, s[14:15], s78
    s_mul_i32 s94, s3, 8320
    buffer_load_dwordx4 v242, s[28:31], s97 offen offset:2048  lds
    s_add_u32 s94, s94, 129024
    v_bfe_u32 v5, v0, 2, 2
    v_lshlrev_b32 v5, 1, v5
    v_lshl_add_u32 v5, v6, 3, v5
    v_bfe_u32 v8, v0, 4, 1
    buffer_load_dwordx4 v243, s[28:31], s97 offen offset:3072  lds
    v_add_u32 v5, v5, v8
    s_and_b32 s78, s3, 1
    s_lshl_b32 s78, s78, 1
    v_add_u32 v8, s78, v6
    v_xor_b32 v8, v8, v7
    s_add_u32 m0, s88, 0
    s_mov_b64 exec, 0xffffffff
    buffer_load_dwordx4 v3, s[28:31], s97 offen offset:0  lds
    s_mov_b64 exec, -1
    v_lshlrev_b32 v8, 4, v8
    v_lshl_add_u32 v5, v5, 6, v8
    v_add_u32 v14, s86, v5
    v_mov_b32 v18, 162304
    v_mov_b32 v19, 1
    s_mul_i32 s16, s97, 3072
    s_add_u32 m0, s60, 0
    s_add_u32 s99, s16, s62
    buffer_load_dwordx4 v244, s[32:35], s99 offen offset:0  lds
    v_and_b32 v5, 3, v0
    s_lshl_b32 s78, s74, 4
    s_add_u32 s78, s78, s3
    v_lshl_add_u32 v6, v5, 2, s78
    s_lshr_b32 s78, s76, 3
    buffer_load_dwordx4 v245, s[32:35], s99 offen offset:1024  lds
    s_lshl_b32 s79, s3, 1
    s_add_u32 s78, s78, s79
    s_xor_b32 s78, s78, 0
    s_lshl_b32 s78, s78, 5
    s_and_b32 s79, s76, 7
    buffer_load_dwordx4 v246, s[32:35], s99 offen offset:2048  lds
    s_add_u32 s78, s78, s79
    v_lshl_add_u32 v7, v5, 3, s78
    v_and_b32 v8, 4, v0
    v_cmp_eq_u32 vcc, 0, v8
    s_nop 1
    v_cndmask_b32 v6, v7, v6, vcc
    s_add_u32 m0, s61, 12288
    s_add_u32 s16, s16, s63
    buffer_load_dwordx4 v244, s[32:35], s16 offen offset:0  lds
    v_and_b32 v33, 0xf0, v6
    v_lshlrev_b32 v34, 8, v6
    v_add_u32 v34, 12582912, v34
    v_and_b32 v5, 15, v0
    v_lshrrev_b32 v6, 4, v0
    buffer_load_dwordx4 v245, s[32:35], s16 offen offset:1024  lds
    v_add_u32 v7, 9, v5
    v_and_b32 v8, 1, v7
    v_mul_u32_u24 v8, 4160, v8
    v_lshrrev_b32 v7, 1, v7
    v_lshl_add_u32 v8, v7, 2, v8
    buffer_load_dwordx4 v246, s[32:35], s16 offen offset:2048  lds
    v_lshlrev_b32 v7, 4, v6
    v_sub_u32 v8, v8, v7
    s_add_u32 s78, s94, 32
    v_add_u32 v21, s78, v8
    v_add_u32 v22, 1024, v21
    v_add_u32 v23, 2048, v21
    v_add_u32 v24, 3072, v21
    v_lshl_add_u32 v7, v5, 1, v6
    v_add_u32 v7, 30, v7
    v_and_b32 v8, 1, v7
    s_waitcnt vmcnt(11)
    s_barrier
    s_add_u32 m0, s86, 129536
    s_mov_b32 s89, 0
    buffer_load_dwordx4 v10, s[36:39], s89 offen nt lds
    v_bfe_u32 v136, v7, 1, 2
    v_lshl_add_u32 v136, v8, 2, v136
    v_lshlrev_b32 v136, 6, v136
    v_lshrrev_b32 v7, 3, v7
    s_add_u32 m0, s86, 145920
    s_mov_b32 s89, 0
    buffer_load_dwordx4 v10, s[40:43], s89 offen nt lds
    v_lshl_add_u32 v136, v7, 9, v136
    v_bitop3_b32 v8, v7, 3, s3 bitop3:0x6a
    v_lshl_add_u32 v25, v8, 4, v136
    v_add_u32 v25, 92160, v25
    s_add_u32 m0, s86, 133632
    s_mov_b32 s89, 65536
    buffer_load_dwordx4 v10, s[36:39], s89 offen nt lds
    v_subrev_u32 v7, 1, v7
    v_bitop3_b32 v8, v7, 3, s3 bitop3:0x6a
    v_lshl_add_u32 v27, v8, 4, v136
    v_add_u32 v27, 91648, v27
    s_add_u32 m0, s86, 150016
    s_mov_b32 s89, 65536
    buffer_load_dwordx4 v10, s[40:43], s89 offen nt lds
    v_subrev_u32 v7, 1, v7
    v_bitop3_b32 v8, v7, 3, s3 bitop3:0x6a
    v_lshl_add_u32 v29, v8, 4, v136
    s_add_u32 m0, s86, 137728
    s_mov_b32 s89, 131072
    buffer_load_dwordx4 v10, s[36:39], s89 offen nt lds
    v_add_u32 v29, 91136, v29
    v_subrev_u32 v7, 1, v7
    v_bitop3_b32 v8, v7, 3, s3 bitop3:0x6a
    v_lshl_add_u32 v31, v8, 4, v136
    s_add_u32 m0, s86, 154112
    s_mov_b32 s89, 131072
    buffer_load_dwordx4 v10, s[40:43], s89 offen nt lds
    v_add_u32 v31, 90624, v31
    v_lshl_add_u32 v7, v5, 1, v6
    v_add_u32 v7, 26, v7
    v_and_b32 v8, 1, v7
    s_add_u32 m0, s86, 141824
    s_mov_b32 s89, 196608
    buffer_load_dwordx4 v10, s[36:39], s89 offen nt lds
    v_bfe_u32 v136, v7, 1, 2
    v_lshl_add_u32 v136, v8, 2, v136
    v_lshlrev_b32 v136, 6, v136
    v_lshrrev_b32 v7, 3, v7
    s_add_u32 m0, s86, 158208
    s_mov_b32 s89, 196608
    buffer_load_dwordx4 v10, s[40:43], s89 offen nt lds
    v_lshl_add_u32 v136, v7, 9, v136
    v_bitop3_b32 v8, v7, 3, s3 bitop3:0x6a
    v_lshl_add_u32 v26, v8, 4, v136
    s_mov_b64 exec, 0xff
    s_lshl_b32 s82, s3, 7
    s_add_u32 m0, s82, 129024
    s_mov_b32 s89, 0
    buffer_load_dwordx4 v11, s[36:39], s89 offen nt lds
    s_lshl_b32 s83, s74, 9
    s_add_u32 s83, s83, s82
    s_and_b32 s89, s3, 2
    s_lshl_b32 s89, s89, 3
    s_add_u32 s82, s82, s89
    s_add_u32 m0, s82, 162816
    s_add_u32 s89, s83, 0
    buffer_load_dwordx4 v15, s[44:47], s89 offen  lds
    s_mov_b64 exec, -1
    v_add_u32 v26, 92160, v26
    v_subrev_u32 v7, 1, v7
    v_bitop3_b32 v8, v7, 3, s3 bitop3:0x6a
    v_lshl_add_u32 v28, v8, 4, v136
    s_add_u32 s97, s98, s0
    s_lshr_b64 s[0:1], s[0:1], 4
    s_and_b32 s97, s97, 15
    s_lshr_b32 s99, s97, 3
    s_xor_b32 s97, s97, s99
    s_add_u32 m0, s87, 18432
    s_lshl_b32 s97, s97, 7
    buffer_load_dwordx4 v240, s[28:31], s97 offen offset:0  lds
    v_add_u32 v28, 91648, v28
    v_subrev_u32 v7, 1, v7
    v_bitop3_b32 v8, v7, 3, s3 bitop3:0x6a
    v_lshl_add_u32 v30, v8, 4, v136
    buffer_load_dwordx4 v241, s[28:31], s97 offen offset:1024  lds
    v_add_u32 v30, 91136, v30
    v_subrev_u32 v7, 1, v7
    v_bitop3_b32 v8, v7, 3, s3 bitop3:0x6a
    v_lshl_add_u32 v32, v8, 4, v136
    buffer_load_dwordx4 v242, s[28:31], s97 offen offset:2048  lds
    v_add_u32 v32, 90624, v32
    v_lshrrev_b32 v7, 1, v6
    v_lshl_add_u32 v7, v5, 1, v7
    buffer_load_dwordx4 v243, s[28:31], s97 offen offset:3072  lds
    v_add_u32 v7, 32, v7
    v_and_b32 v8, 1, v7
    v_bfe_u32 v136, v7, 1, 2
    v_lshl_add_u32 v136, v8, 2, v136
    s_add_u32 m0, s88, 18432
    s_mov_b64 exec, 0xffffffff
    buffer_load_dwordx4 v3, s[28:31], s97 offen offset:0  lds
    s_mov_b64 exec, -1
    v_lshlrev_b32 v136, 6, v136
    v_lshrrev_b32 v7, 3, v7
    v_lshl_add_u32 v136, v7, 9, v136
    v_bitop3_b32 v8, v7, 3, s3 bitop3:0x6a
    s_mul_i32 s16, s97, 3072
    s_add_u32 m0, s60, 24576
    s_add_u32 s99, s16, s62
    buffer_load_dwordx4 v244, s[32:35], s99 offen offset:0  lds
    v_lshl_add_u32 v20, v8, 4, v136
    v_add_u32 v20, 92160, v20
    v_and_b32 v8, 1, v6
    v_xor_b32 v8, 1, v8
    buffer_load_dwordx4 v245, s[32:35], s99 offen offset:1024  lds
    v_lshl_add_u32 v20, v8, 3, v20
    s_waitcnt lgkmcnt(0)
    s_and_b32 s78, s92, 0xffff0000
    s_waitcnt vmcnt(17)
    s_barrier
    buffer_load_dwordx4 v246, s[32:35], s99 offen offset:2048  lds
    s_lshl_b32 s92, s92, 16
    s_bitcmp1_b32 s90, 0
    s_cselect_b32 s92, s78, s92
    s_add_u32 m0, s61, 36864
    s_add_u32 s16, s16, s63
    buffer_load_dwordx4 v244, s[32:35], s16 offen offset:0  lds
    v_lshlrev_b32 v7, 3, v6
    buffer_load_dwordx4 v245, s[32:35], s16 offen offset:1024  lds
    v_sub_u32 v7, v7, v5
    buffer_load_dwordx4 v246, s[32:35], s16 offen offset:2048  lds
    v_subrev_u32 v7, 9, v7
    s_add_u32 s97, s98, s0
    s_lshr_b64 s[0:1], s[0:1], 4
    s_and_b32 s97, s97, 15
    s_lshr_b32 s99, s97, 3
    s_xor_b32 s97, s97, s99
    s_add_u32 m0, s87, 36864
    s_lshl_b32 s97, s97, 7
    buffer_load_dwordx4 v240, s[28:31], s97 offen offset:0  lds
    v_and_b32 v8, 1, v7
    buffer_load_dwordx4 v241, s[28:31], s97 offen offset:1024  lds
    v_xor_b32 v8, 1, v8
    v_lshlrev_b32 v8, 4, v8
    buffer_load_dwordx4 v242, s[28:31], s97 offen offset:2048  lds
    v_lshrrev_b32 v8, v8, s92
    buffer_load_dwordx4 v243, s[28:31], s97 offen offset:3072  lds
    v_ashrrev_i32 v7, 1, v7
    s_add_u32 m0, s88, 36864
    s_mov_b64 exec, 0xffffffff
    buffer_load_dwordx4 v3, s[28:31], s97 offen offset:0  lds
    s_mov_b64 exec, -1
    v_cmp_eq_u32 vcc, 0, v7
    s_mul_i32 s16, s97, 3072
    s_add_u32 m0, s60, 49152
    s_add_u32 s99, s16, s62
    buffer_load_dwordx4 v244, s[32:35], s99 offen offset:0  lds
    v_cndmask_b32 v236, 0, v8, vcc
    buffer_load_dwordx4 v245, s[32:35], s99 offen offset:1024  lds
    v_cmp_eq_u32 vcc, 1, v7
    s_nop 1
    v_cndmask_b32 v237, 0, v8, vcc
    buffer_load_dwordx4 v246, s[32:35], s99 offen offset:2048  lds
    v_cmp_eq_u32 vcc, 2, v7
    s_add_u32 m0, s61, 61440
    s_add_u32 s16, s16, s63
    buffer_load_dwordx4 v244, s[32:35], s16 offen offset:0  lds
    v_cndmask_b32 v238, 0, v8, vcc
    buffer_load_dwordx4 v245, s[32:35], s16 offen offset:1024  lds
    v_cmp_eq_u32 vcc, 3, v7
    buffer_load_dwordx4 v246, s[32:35], s16 offen offset:2048  lds
    s_nop 0
    v_cndmask_b32 v239, 0, v8, vcc
    s_waitcnt vmcnt(11)
    s_barrier
    buffer_load_dword v230, v229, s[64:67], 0 offen
    ds_read_b128 v[84:87], v35 offset:0
    ds_read_b128 v[88:91], v35 offset:16
    s_add_u32 s97, s98, s0
    s_lshr_b64 s[0:1], s[0:1], 4
    s_and_b32 s97, s97, 15
    s_lshr_b32 s99, s97, 3
    s_xor_b32 s97, s97, s99
    s_add_u32 m0, s87, 0
    s_lshl_b32 s97, s97, 7
    buffer_load_dwordx4 v240, s[28:31], s97 offen offset:0  lds
    ds_read_b128 v[92:95], v35 offset:32
    buffer_load_dwordx4 v241, s[28:31], s97 offen offset:1024  lds
    ds_read_b128 v[96:99], v35 offset:48
    buffer_load_dwordx4 v242, s[28:31], s97 offen offset:2048  lds
    ds_read_b128 v[40:43], v233 offset:0
    buffer_load_dwordx4 v243, s[28:31], s97 offen offset:3072  lds
    ds_read_b128 v[44:47], v232 offset:256
    ds_read_b128 v[48:51], v233 offset:256
    s_add_u32 m0, s88, 0
    s_mov_b64 exec, 0xffffffff
    buffer_load_dwordx4 v3, s[28:31], s97 offen offset:0  lds
    s_mov_b64 exec, -1
    ds_read_b128 v[52:55], v16 offset:512
    s_mul_i32 s16, s97, 3072
    s_add_u32 m0, s60, 0
    s_add_u32 s99, s16, s62
    buffer_load_dwordx4 v244, s[32:35], s99 offen offset:0  lds
    ds_read_b128 v[56:59], v231 offset:512
    buffer_load_dwordx4 v245, s[32:35], s99 offen offset:1024  lds
    ds_read_b128 v[60:63], v16 offset:768
    buffer_load_dwordx4 v246, s[32:35], s99 offen offset:2048  lds
    ds_read_b128 v[64:67], v231 offset:768
    ds_read_b128 v[68:71], v16 offset:16896
    s_add_u32 m0, s61, 12288
    s_add_u32 s16, s16, s63
    buffer_load_dwordx4 v244, s[32:35], s16 offen offset:0  lds
    ds_read_b128 v[72:75], v231 offset:16896
    buffer_load_dwordx4 v245, s[32:35], s16 offen offset:1024  lds
    ds_read_b128 v[76:79], v16 offset:17152
    buffer_load_dwordx4 v246, s[32:35], s16 offen offset:2048  lds
    ds_read_b128 v[80:83], v231 offset:17152
    s_waitcnt vmcnt(12)
    s_waitcnt lgkmcnt(0)
    s_barrier
    s_add_u32 s97, s98, s0
    s_lshr_b64 s[0:1], s[0:1], 4
    s_and_b32 s97, s97, 15
    s_lshr_b32 s99, s97, 3
    s_xor_b32 s97, s97, s99
    s_add_u32 m0, s87, 18432
    s_lshl_b32 s97, s97, 7
    buffer_load_dwordx4 v240, s[28:31], s97 offen offset:0  lds
    v_lshlrev_b32 v116, 16, v40
    v_lshlrev_b32 v117, 16, v44
    v_lshlrev_b32 v118, 16, v48
    v_lshlrev_b32 v119, 16, v52
    v_lshlrev_b32 v120, 16, v56
    buffer_load_dwordx4 v241, s[28:31], s97 offen offset:1024  lds
    v_lshlrev_b32 v121, 16, v60
    v_lshlrev_b32 v122, 16, v64
    v_lshlrev_b32 v127, 16, v84
    v_and_b32 v128, 0xffff0000, v84
    v_lshlrev_b32 v129, 16, v85
    buffer_load_dwordx4 v242, s[28:31], s97 offen offset:2048  lds
    v_and_b32 v130, 0xffff0000, v85
    v_lshlrev_b32 v123, 16, v68
    v_lshlrev_b32 v124, 16, v72
    v_lshlrev_b32 v125, 16, v76
    v_lshlrev_b32 v126, 16, v80
    buffer_load_dwordx4 v243, s[28:31], s97 offen offset:3072  lds
    v_mul_f32 v131, v116, v130
    v_mul_f32 v132, v117, v130
    v_mul_f32 v133, v118, v130
    v_mul_f32 v134, v119, v130
    v_fmac_f32 v131, v117, v129
    s_add_u32 m0, s88, 18432
    s_mov_b64 exec, 0xffffffff
    buffer_load_dwordx4 v3, s[28:31], s97 offen offset:0  lds
    s_mov_b64 exec, -1
    v_fmac_f32 v132, v118, v129
    v_fmac_f32 v133, v119, v129
    v_fmac_f32 v134, v120, v129
    v_fmac_f32 v131, v118, v128
    v_fmac_f32 v132, v119, v128
    s_mul_i32 s16, s97, 3072
    s_add_u32 m0, s60, 24576
    s_add_u32 s99, s16, s62
    buffer_load_dwordx4 v244, s[32:35], s99 offen offset:0  lds
    v_fmac_f32 v133, v120, v128
    v_fmac_f32 v134, v121, v128
    v_fmac_f32 v131, v119, v127
    v_fmac_f32 v132, v120, v127
    v_fmac_f32 v133, v121, v127
    buffer_load_dwordx4 v245, s[32:35], s99 offen offset:1024  lds
    v_fmac_f32 v134, v122, v127
    v_mul_f32 v131, v131, v123
    v_mul_f32 v132, v132, v124
    v_mul_f32 v133, v133, v125
    v_mul_f32 v134, v134, v126
    buffer_load_dwordx4 v246, s[32:35], s99 offen offset:2048  lds
    v_cvt_pk_bf16_f32 v102, v134, v133
    v_cvt_pk_bf16_f32 v103, v132, v131
    v_lshlrev_b32 v116, 16, v42
    v_lshlrev_b32 v117, 16, v46
    v_lshlrev_b32 v118, 16, v50
    s_add_u32 m0, s61, 36864
    s_add_u32 s16, s16, s63
    buffer_load_dwordx4 v244, s[32:35], s16 offen offset:0  lds
    v_lshlrev_b32 v119, 16, v54
    v_lshlrev_b32 v120, 16, v58
    v_lshlrev_b32 v121, 16, v62
    v_lshlrev_b32 v122, 16, v66
    v_lshlrev_b32 v127, 16, v92
    buffer_load_dwordx4 v245, s[32:35], s16 offen offset:1024  lds
    v_and_b32 v128, 0xffff0000, v92
    v_lshlrev_b32 v129, 16, v93
    v_and_b32 v130, 0xffff0000, v93
    v_lshlrev_b32 v123, 16, v70
    v_lshlrev_b32 v124, 16, v74
    buffer_load_dwordx4 v246, s[32:35], s16 offen offset:2048  lds
    v_lshlrev_b32 v125, 16, v78
    v_lshlrev_b32 v126, 16, v82
    v_mul_f32 v131, v116, v130
    v_mul_f32 v132, v117, v130
    v_mul_f32 v133, v118, v130
    v_mul_f32 v134, v119, v130
    v_fmac_f32 v131, v117, v129
    v_fmac_f32 v132, v118, v129
    v_fmac_f32 v133, v119, v129
    v_fmac_f32 v134, v120, v129
    v_fmac_f32 v131, v118, v128
    v_fmac_f32 v132, v119, v128
    s_waitcnt vmcnt(11)
    s_barrier
    s_add_u32 s97, s98, s0
    s_lshr_b64 s[0:1], s[0:1], 4
    s_and_b32 s97, s97, 15
    s_lshr_b32 s99, s97, 3
    s_xor_b32 s97, s97, s99
    s_add_u32 m0, s87, 36864
    s_lshl_b32 s97, s97, 7
    buffer_load_dwordx4 v240, s[28:31], s97 offen offset:0  lds
    v_fmac_f32 v133, v120, v128
    v_fmac_f32 v134, v121, v128
    v_fmac_f32 v131, v119, v127
    v_fmac_f32 v132, v120, v127
    v_fmac_f32 v133, v121, v127
    buffer_load_dwordx4 v241, s[28:31], s97 offen offset:1024  lds
    v_fmac_f32 v134, v122, v127
    v_mul_f32 v131, v131, v123
    v_mul_f32 v132, v132, v124
    v_mul_f32 v133, v133, v125
    v_mul_f32 v134, v134, v126
    buffer_load_dwordx4 v242, s[28:31], s97 offen offset:2048  lds
    v_cvt_pk_bf16_f32 v100, v134, v133
    v_cvt_pk_bf16_f32 v101, v132, v131
    s_nop 0
    v_permlane32_swap_b32 v102, v100
    v_permlane32_swap_b32 v103, v101
    s_mov_b32 s89, 0
    buffer_store_dwordx4 v[100:103], v12, s[52:55], s89 offen sc1
    buffer_load_dwordx4 v243, s[28:31], s97 offen offset:3072  lds
    v_and_b32 v116, 0xffff0000, v40
    v_and_b32 v117, 0xffff0000, v44
    v_and_b32 v118, 0xffff0000, v48
    v_and_b32 v119, 0xffff0000, v52
    v_and_b32 v120, 0xffff0000, v56
    s_add_u32 m0, s88, 36864
    s_mov_b64 exec, 0xffffffff
    buffer_load_dwordx4 v3, s[28:31], s97 offen offset:0  lds
    s_mov_b64 exec, -1
    v_and_b32 v121, 0xffff0000, v60
    v_and_b32 v122, 0xffff0000, v64
    v_lshlrev_b32 v127, 16, v86
    v_and_b32 v128, 0xffff0000, v86
    v_lshlrev_b32 v129, 16, v87
    s_mul_i32 s16, s97, 3072
    s_add_u32 m0, s60, 49152
    s_add_u32 s99, s16, s62
    buffer_load_dwordx4 v244, s[32:35], s99 offen offset:0  lds
    v_and_b32 v130, 0xffff0000, v87
    v_and_b32 v123, 0xffff0000, v68
    v_and_b32 v124, 0xffff0000, v72
    v_and_b32 v125, 0xffff0000, v76
    v_and_b32 v126, 0xffff0000, v80
    buffer_load_dwordx4 v245, s[32:35], s99 offen offset:1024  lds
    v_mul_f32 v131, v116, v130
    v_mul_f32 v132, v117, v130
    v_mul_f32 v133, v118, v130
    v_mul_f32 v134, v119, v130
    v_fmac_f32 v131, v117, v129
    buffer_load_dwordx4 v246, s[32:35], s99 offen offset:2048  lds
    v_fmac_f32 v132, v118, v129
    v_fmac_f32 v133, v119, v129
    v_fmac_f32 v134, v120, v129
    v_fmac_f32 v131, v118, v128
    v_fmac_f32 v132, v119, v128
    s_add_u32 m0, s61, 61440
    s_add_u32 s16, s16, s63
    buffer_load_dwordx4 v244, s[32:35], s16 offen offset:0  lds
    v_fmac_f32 v133, v120, v128
    v_fmac_f32 v134, v121, v128
    v_fmac_f32 v131, v119, v127
    v_fmac_f32 v132, v120, v127
    v_fmac_f32 v133, v121, v127
    buffer_load_dwordx4 v245, s[32:35], s16 offen offset:1024  lds
    v_fmac_f32 v134, v122, v127
    v_mul_f32 v131, v131, v123
    v_mul_f32 v132, v132, v124
    v_mul_f32 v133, v133, v125
    v_mul_f32 v134, v134, v126
    buffer_load_dwordx4 v246, s[32:35], s16 offen offset:2048  lds
    v_cvt_pk_bf16_f32 v106, v134, v133
    v_cvt_pk_bf16_f32 v107, v132, v131
    v_and_b32 v116, 0xffff0000, v42
    v_and_b32 v117, 0xffff0000, v46
    v_and_b32 v118, 0xffff0000, v50
    v_and_b32 v119, 0xffff0000, v54
    v_and_b32 v120, 0xffff0000, v58
    v_and_b32 v121, 0xffff0000, v62
    v_and_b32 v122, 0xffff0000, v66
    v_lshlrev_b32 v127, 16, v94
    v_and_b32 v128, 0xffff0000, v94
    v_lshlrev_b32 v129, 16, v95
    s_waitcnt vmcnt(12)
    s_barrier
    s_add_u32 s97, s98, s0
    s_lshr_b64 s[0:1], s[0:1], 4
    s_and_b32 s97, s97, 15
    s_lshr_b32 s99, s97, 3
    s_xor_b32 s97, s97, s99
    s_add_u32 m0, s87, 0
    s_lshl_b32 s97, s97, 7
    buffer_load_dwordx4 v240, s[28:31], s97 offen offset:0  lds
    v_and_b32 v130, 0xffff0000, v95
    v_and_b32 v123, 0xffff0000, v70
    v_and_b32 v124, 0xffff0000, v74
    v_and_b32 v125, 0xffff0000, v78
    v_and_b32 v126, 0xffff0000, v82
    buffer_load_dwordx4 v241, s[28:31], s97 offen offset:1024  lds
    v_mul_f32 v131, v116, v130
    v_mul_f32 v132, v117, v130
    v_mul_f32 v133, v118, v130
    v_mul_f32 v134, v119, v130
    v_fmac_f32 v131, v117, v129
    buffer_load_dwordx4 v242, s[28:31], s97 offen offset:2048  lds
    v_fmac_f32 v132, v118, v129
    v_fmac_f32 v133, v119, v129
    v_fmac_f32 v134, v120, v129
    v_fmac_f32 v131, v118, v128
    v_fmac_f32 v132, v119, v128
    buffer_load_dwordx4 v243, s[28:31], s97 offen offset:3072  lds
    v_fmac_f32 v133, v120, v128
    v_fmac_f32 v134, v121, v128
    v_fmac_f32 v131, v119, v127
    v_fmac_f32 v132, v120, v127
    v_fmac_f32 v133, v121, v127
    s_add_u32 m0, s88, 0
    s_mov_b64 exec, 0xffffffff
    buffer_load_dwordx4 v3, s[28:31], s97 offen offset:0  lds
    s_mov_b64 exec, -1
    v_fmac_f32 v134, v122, v127
    v_mul_f32 v131, v131, v123
    v_mul_f32 v132, v132, v124
    v_mul_f32 v133, v133, v125
    v_mul_f32 v134, v134, v126
    s_mul_i32 s16, s97, 3072
    s_add_u32 m0, s60, 0
    s_add_u32 s99, s16, s62
    buffer_load_dwordx4 v244, s[32:35], s99 offen offset:0  lds
    v_cvt_pk_bf16_f32 v104, v134, v133
    v_cvt_pk_bf16_f32 v105, v132, v131
    s_nop 0
    v_permlane32_swap_b32 v106, v104
    v_permlane32_swap_b32 v107, v105
    s_mov_b32 s89, 16384
    buffer_store_dwordx4 v[104:107], v12, s[52:55], s89 offen sc1
    buffer_load_dwordx4 v245, s[32:35], s99 offen offset:1024  lds
    v_lshlrev_b32 v116, 16, v41
    v_lshlrev_b32 v117, 16, v45
    v_lshlrev_b32 v118, 16, v49
    v_lshlrev_b32 v119, 16, v53
    v_lshlrev_b32 v120, 16, v57
    buffer_load_dwordx4 v246, s[32:35], s99 offen offset:2048  lds
    v_lshlrev_b32 v121, 16, v61
    v_lshlrev_b32 v122, 16, v65
    v_lshlrev_b32 v127, 16, v88
    v_and_b32 v128, 0xffff0000, v88
    v_lshlrev_b32 v129, 16, v89
    s_add_u32 m0, s61, 12288
    s_add_u32 s16, s16, s63
    buffer_load_dwordx4 v244, s[32:35], s16 offen offset:0  lds
    v_and_b32 v130, 0xffff0000, v89
    v_lshlrev_b32 v123, 16, v69
    v_lshlrev_b32 v124, 16, v73
    v_lshlrev_b32 v125, 16, v77
    v_lshlrev_b32 v126, 16, v81
    buffer_load_dwordx4 v245, s[32:35], s16 offen offset:1024  lds
    v_mul_f32 v131, v116, v130
    v_mul_f32 v132, v117, v130
    v_mul_f32 v133, v118, v130
    v_mul_f32 v134, v119, v130
    v_fmac_f32 v131, v117, v129
    buffer_load_dwordx4 v246, s[32:35], s16 offen offset:2048  lds
    v_fmac_f32 v132, v118, v129
    v_fmac_f32 v133, v119, v129
    v_fmac_f32 v134, v120, v129
    v_fmac_f32 v131, v118, v128
    v_fmac_f32 v132, v119, v128
    v_fmac_f32 v133, v120, v128
    v_fmac_f32 v134, v121, v128
    v_fmac_f32 v131, v119, v127
    v_fmac_f32 v132, v120, v127
    v_fmac_f32 v133, v121, v127
    v_fmac_f32 v134, v122, v127
    v_mul_f32 v131, v131, v123
    s_waitcnt vmcnt(12)
    s_barrier
    s_add_u32 s97, s98, s0
    s_lshr_b64 s[0:1], s[0:1], 4
    s_and_b32 s97, s97, 15
    s_lshr_b32 s99, s97, 3
    s_xor_b32 s97, s97, s99
    s_add_u32 m0, s87, 18432
    s_lshl_b32 s97, s97, 7
    buffer_load_dwordx4 v240, s[28:31], s97 offen offset:0  lds
    v_mul_f32 v132, v132, v124
    v_mul_f32 v133, v133, v125
    v_mul_f32 v134, v134, v126
    v_cvt_pk_bf16_f32 v110, v134, v133
    v_cvt_pk_bf16_f32 v111, v132, v131
    buffer_load_dwordx4 v241, s[28:31], s97 offen offset:1024  lds
    v_lshlrev_b32 v116, 16, v43
    v_lshlrev_b32 v117, 16, v47
    v_lshlrev_b32 v118, 16, v51
    v_lshlrev_b32 v119, 16, v55
    v_lshlrev_b32 v120, 16, v59
    buffer_load_dwordx4 v242, s[28:31], s97 offen offset:2048  lds
    v_lshlrev_b32 v121, 16, v63
    v_lshlrev_b32 v122, 16, v67
    v_lshlrev_b32 v127, 16, v96
    v_and_b32 v128, 0xffff0000, v96
    v_lshlrev_b32 v129, 16, v97
    buffer_load_dwordx4 v243, s[28:31], s97 offen offset:3072  lds
    v_and_b32 v130, 0xffff0000, v97
    v_lshlrev_b32 v123, 16, v71
    v_lshlrev_b32 v124, 16, v75
    v_lshlrev_b32 v125, 16, v79
    v_lshlrev_b32 v126, 16, v83
    s_add_u32 m0, s88, 18432
    s_mov_b64 exec, 0xffffffff
    buffer_load_dwordx4 v3, s[28:31], s97 offen offset:0  lds
    s_mov_b64 exec, -1
    v_mul_f32 v131, v116, v130
    v_mul_f32 v132, v117, v130
    v_mul_f32 v133, v118, v130
    v_mul_f32 v134, v119, v130
    v_fmac_f32 v131, v117, v129
    s_mul_i32 s16, s97, 3072
    s_add_u32 m0, s60, 24576
    s_add_u32 s99, s16, s62
    buffer_load_dwordx4 v244, s[32:35], s99 offen offset:0  lds
    v_fmac_f32 v132, v118, v129
    v_fmac_f32 v133, v119, v129
    v_fmac_f32 v134, v120, v129
    v_fmac_f32 v131, v118, v128
    v_fmac_f32 v132, v119, v128
    buffer_load_dwordx4 v245, s[32:35], s99 offen offset:1024  lds
    v_fmac_f32 v133, v120, v128
    v_fmac_f32 v134, v121, v128
    v_fmac_f32 v131, v119, v127
    v_fmac_f32 v132, v120, v127
    v_fmac_f32 v133, v121, v127
    buffer_load_dwordx4 v246, s[32:35], s99 offen offset:2048  lds
    v_fmac_f32 v134, v122, v127
    v_mul_f32 v131, v131, v123
    v_mul_f32 v132, v132, v124
    v_mul_f32 v133, v133, v125
    v_mul_f32 v134, v134, v126
    s_add_u32 m0, s61, 36864
    s_add_u32 s16, s16, s63
    buffer_load_dwordx4 v244, s[32:35], s16 offen offset:0  lds
    v_cvt_pk_bf16_f32 v108, v134, v133
    v_cvt_pk_bf16_f32 v109, v132, v131
    s_nop 0
    v_permlane32_swap_b32 v110, v108
    v_permlane32_swap_b32 v111, v109
    s_mov_b32 s89, 32768
    buffer_store_dwordx4 v[108:111], v12, s[52:55], s89 offen sc1
    buffer_load_dwordx4 v245, s[32:35], s16 offen offset:1024  lds
    v_and_b32 v116, 0xffff0000, v41
    v_and_b32 v117, 0xffff0000, v45
    v_and_b32 v118, 0xffff0000, v49
    v_and_b32 v119, 0xffff0000, v53
    v_and_b32 v120, 0xffff0000, v57
    buffer_load_dwordx4 v246, s[32:35], s16 offen offset:2048  lds
    v_and_b32 v121, 0xffff0000, v61
    v_and_b32 v122, 0xffff0000, v65
    v_lshlrev_b32 v127, 16, v90
    v_and_b32 v128, 0xffff0000, v90
    v_lshlrev_b32 v129, 16, v91
    v_and_b32 v130, 0xffff0000, v91
    v_and_b32 v123, 0xffff0000, v69
    v_and_b32 v124, 0xffff0000, v73
    v_and_b32 v125, 0xffff0000, v77
    v_and_b32 v126, 0xffff0000, v81
    v_mul_f32 v131, v116, v130
    v_mul_f32 v132, v117, v130
    s_waitcnt vmcnt(12)
    s_barrier
    s_add_u32 s97, s98, s0
    s_lshr_b64 s[0:1], s[0:1], 4
    s_and_b32 s97, s97, 15
    s_lshr_b32 s99, s97, 3
    s_xor_b32 s97, s97, s99
    s_add_u32 m0, s87, 36864
    s_lshl_b32 s97, s97, 7
    buffer_load_dwordx4 v240, s[28:31], s97 offen offset:0  lds
    v_mul_f32 v133, v118, v130
    v_mul_f32 v134, v119, v130
    v_fmac_f32 v131, v117, v129
    v_fmac_f32 v132, v118, v129
    v_fmac_f32 v133, v119, v129
    buffer_load_dwordx4 v241, s[28:31], s97 offen offset:1024  lds
    v_fmac_f32 v134, v120, v129
    v_fmac_f32 v131, v118, v128
    v_fmac_f32 v132, v119, v128
    v_fmac_f32 v133, v120, v128
    v_fmac_f32 v134, v121, v128
    buffer_load_dwordx4 v242, s[28:31], s97 offen offset:2048  lds
    v_fmac_f32 v131, v119, v127
    v_fmac_f32 v132, v120, v127
    v_fmac_f32 v133, v121, v127
    v_fmac_f32 v134, v122, v127
    v_mul_f32 v131, v131, v123
    buffer_load_dwordx4 v243, s[28:31], s97 offen offset:3072  lds
    v_mul_f32 v132, v132, v124
    v_mul_f32 v133, v133, v125
    v_mul_f32 v134, v134, v126
    v_cvt_pk_bf16_f32 v114, v134, v133
    v_cvt_pk_bf16_f32 v115, v132, v131
    s_add_u32 m0, s88, 36864
    s_mov_b64 exec, 0xffffffff
    buffer_load_dwordx4 v3, s[28:31], s97 offen offset:0  lds
    s_mov_b64 exec, -1
    v_and_b32 v116, 0xffff0000, v43
    v_and_b32 v117, 0xffff0000, v47
    v_and_b32 v118, 0xffff0000, v51
    v_and_b32 v119, 0xffff0000, v55
    v_and_b32 v120, 0xffff0000, v59
    s_mul_i32 s16, s97, 3072
    s_add_u32 m0, s60, 49152
    s_add_u32 s99, s16, s62
    buffer_load_dwordx4 v244, s[32:35], s99 offen offset:0  lds
    v_and_b32 v121, 0xffff0000, v63
    v_and_b32 v122, 0xffff0000, v67
    v_lshlrev_b32 v127, 16, v98
    v_and_b32 v128, 0xffff0000, v98
    v_lshlrev_b32 v129, 16, v99
    buffer_load_dwordx4 v245, s[32:35], s99 offen offset:1024  lds
    v_and_b32 v130, 0xffff0000, v99
    v_and_b32 v123, 0xffff0000, v71
    v_and_b32 v124, 0xffff0000, v75
    v_and_b32 v125, 0xffff0000, v79
    v_and_b32 v126, 0xffff0000, v83
    buffer_load_dwordx4 v246, s[32:35], s99 offen offset:2048  lds
    v_mul_f32 v131, v116, v130
    v_mul_f32 v132, v117, v130
    v_mul_f32 v133, v118, v130
    v_mul_f32 v134, v119, v130
    v_fmac_f32 v131, v117, v129
    s_add_u32 m0, s61, 61440
    s_add_u32 s16, s16, s63
    buffer_load_dwordx4 v244, s[32:35], s16 offen offset:0  lds
    v_fmac_f32 v132, v118, v129
    v_fmac_f32 v133, v119, v129
    v_fmac_f32 v134, v120, v129
    v_fmac_f32 v131, v118, v128
    v_fmac_f32 v132, v119, v128
    buffer_load_dwordx4 v245, s[32:35], s16 offen offset:1024  lds
    v_fmac_f32 v133, v120, v128
    v_fmac_f32 v134, v121, v128
    v_fmac_f32 v131, v119, v127
    v_fmac_f32 v132, v120, v127
    v_fmac_f32 v133, v121, v127
    buffer_load_dwordx4 v246, s[32:35], s16 offen offset:2048  lds
    v_fmac_f32 v134, v122, v127
    v_mul_f32 v131, v131, v123
    v_mul_f32 v132, v132, v124
    v_mul_f32 v133, v133, v125
    v_mul_f32 v134, v134, v126
    v_cvt_pk_bf16_f32 v112, v134, v133
    v_cvt_pk_bf16_f32 v113, v132, v131
    s_nop 0
    v_permlane32_swap_b32 v114, v112
    v_permlane32_swap_b32 v115, v113
    s_mov_b32 s89, 49152
    buffer_store_dwordx4 v[112:115], v12, s[52:55], s89 offen sc1
    s_waitcnt vmcnt(12)
    s_barrier
    s_add_u32 m0, s94, 32
    s_lshl_b32 s89, s90, 12
    buffer_load_dwordx4 v15, s[48:51], s89 offen offset:0 nt lds
    s_add_u32 m0, s94, 32
    s_lshl_b32 s89, s90, 12
    buffer_load_dwordx4 v15, s[48:51], s89 offen offset:1024 nt lds
    s_add_u32 m0, s94, 32
    s_lshl_b32 s89, s90, 12
    buffer_load_dwordx4 v15, s[48:51], s89 offen offset:2048 nt lds
    s_add_u32 m0, s94, 32
    s_lshl_b32 s89, s90, 12
    buffer_load_dwordx4 v15, s[48:51], s89 offen offset:3072 nt lds
    s_add_u32 s97, s98, s0
    s_lshr_b64 s[0:1], s[0:1], 4
    s_and_b32 s97, s97, 15
    s_lshr_b32 s99, s97, 3
    s_xor_b32 s97, s97, s99
    s_add_u32 m0, s87, 0
    s_lshl_b32 s97, s97, 7
    buffer_load_dwordx4 v240, s[28:31], s97 offen offset:0  lds
    buffer_load_dwordx4 v241, s[28:31], s97 offen offset:1024  lds
    buffer_load_dwordx4 v242, s[28:31], s97 offen offset:2048  lds
    buffer_load_dwordx4 v243, s[28:31], s97 offen offset:3072  lds
    s_add_u32 m0, s88, 0
    s_mov_b64 exec, 0xffffffff
    buffer_load_dwordx4 v3, s[28:31], s97 offen offset:0  lds
    s_mov_b64 exec, -1
    s_mul_i32 s16, s97, 3072
    s_add_u32 m0, s60, 0
    s_add_u32 s99, s16, s62
    buffer_load_dwordx4 v244, s[32:35], s99 offen offset:0  lds
    buffer_load_dwordx4 v245, s[32:35], s99 offen offset:1024  lds
    buffer_load_dwordx4 v246, s[32:35], s99 offen offset:2048  lds
    s_add_u32 m0, s61, 12288
    s_add_u32 s16, s16, s63
    buffer_load_dwordx4 v244, s[32:35], s16 offen offset:0  lds
    buffer_load_dwordx4 v245, s[32:35], s16 offen offset:1024  lds
    buffer_load_dwordx4 v246, s[32:35], s16 offen offset:2048  lds
    s_waitcnt vmcnt(16)
    s_barrier
    s_add_u32 s97, s98, s0
    s_lshr_b64 s[0:1], s[0:1], 4
    s_and_b32 s97, s97, 15
    s_lshr_b32 s99, s97, 3
    s_xor_b32 s97, s97, s99
    s_add_u32 m0, s87, 18432
    s_lshl_b32 s97, s97, 7
    buffer_load_dwordx4 v240, s[28:31], s97 offen offset:0  lds
    buffer_load_dwordx4 v241, s[28:31], s97 offen offset:1024  lds
    buffer_load_dwordx4 v242, s[28:31], s97 offen offset:2048  lds
    buffer_load_dwordx4 v243, s[28:31], s97 offen offset:3072  lds
    s_add_u32 m0, s88, 18432
    s_mov_b64 exec, 0xffffffff
    buffer_load_dwordx4 v3, s[28:31], s97 offen offset:0  lds
    s_mov_b64 exec, -1
    s_mul_i32 s16, s97, 3072
    s_add_u32 m0, s60, 24576
    s_add_u32 s99, s16, s62
    buffer_load_dwordx4 v244, s[32:35], s99 offen offset:0  lds
    buffer_load_dwordx4 v245, s[32:35], s99 offen offset:1024  lds
    buffer_load_dwordx4 v246, s[32:35], s99 offen offset:2048  lds
    s_add_u32 m0, s61, 36864
    s_add_u32 s16, s16, s63
    buffer_load_dwordx4 v244, s[32:35], s16 offen offset:0  lds
    buffer_load_dwordx4 v245, s[32:35], s16 offen offset:1024  lds
    buffer_load_dwordx4 v246, s[32:35], s16 offen offset:2048  lds
    s_waitcnt vmcnt(11)
    s_barrier
    s_add_u32 s97, s98, s0
    s_lshr_b64 s[0:1], s[0:1], 4
    s_and_b32 s97, s97, 15
    s_lshr_b32 s99, s97, 3
    s_xor_b32 s97, s97, s99
    s_add_u32 m0, s87, 36864
    s_lshl_b32 s97, s97, 7
    buffer_load_dwordx4 v240, s[28:31], s97 offen offset:0  lds
    v_add_u32 v5, s94, v15
    ds_read_b128 v[140:143], v5 offset:32
    ds_read_b32 v156, v5 offset:48
    ds_read_b128 v[144:147], v5 offset:1056
    buffer_load_dwordx4 v241, s[28:31], s97 offen offset:1024  lds
    ds_read_b32 v157, v5 offset:1072
    ds_read_b128 v[148:151], v5 offset:2080
    ds_read_b32 v158, v5 offset:2096
    ds_read_b128 v[152:155], v5 offset:3104
    buffer_load_dwordx4 v242, s[28:31], s97 offen offset:2048  lds
    ds_read_b32 v159, v5 offset:3120
    v_lshrrev_b32 v6, 3, v0
    v_mul_u32_u24 v6, 4160, v6
    buffer_load_dwordx4 v243, s[28:31], s97 offen offset:3072  lds
    v_and_b32 v7, 7, v0
    v_lshl_add_u32 v6, v7, 2, v6
    v_add_u32 v6, s94, v6
    v_mov_b32 v7, 0
    s_add_u32 m0, s88, 36864
    s_mov_b64 exec, 0xffffffff
    buffer_load_dwordx4 v3, s[28:31], s97 offen offset:0  lds
    s_mov_b64 exec, -1
    s_waitcnt lgkmcnt(0)
    v_readfirstlane_b32 s93, v140
    s_nop 0
    s_lshl_b32 s93, s93, 16
    s_nop 1
    v_writelane_b32 v7, s93, 15
    s_mul_i32 s16, s97, 3072
    s_add_u32 m0, s60, 49152
    s_add_u32 s99, s16, s62
    buffer_load_dwordx4 v244, s[32:35], s99 offen offset:0  lds
    v_alignbit_b32 v140, v141, v140, 16
    v_alignbit_b32 v141, v142, v141, 16
    v_alignbit_b32 v142, v143, v142, 16
    buffer_load_dwordx4 v245, s[32:35], s99 offen offset:1024  lds
    v_alignbit_b32 v143, v156, v143, 16
    v_alignbit_b32 v144, v145, v144, 16
    v_alignbit_b32 v145, v146, v145, 16
    v_alignbit_b32 v146, v147, v146, 16
    buffer_load_dwordx4 v246, s[32:35], s99 offen offset:2048  lds
    v_alignbit_b32 v147, v157, v147, 16
    v_alignbit_b32 v148, v149, v148, 16
    v_alignbit_b32 v149, v150, v149, 16
    v_alignbit_b32 v150, v151, v150, 16
    s_add_u32 m0, s61, 61440
    s_add_u32 s16, s16, s63
    buffer_load_dwordx4 v244, s[32:35], s16 offen offset:0  lds
    v_alignbit_b32 v151, v158, v151, 16
    v_alignbit_b32 v152, v153, v152, 16
    v_alignbit_b32 v153, v154, v153, 16
    buffer_load_dwordx4 v245, s[32:35], s16 offen offset:1024  lds
    v_alignbit_b32 v154, v155, v154, 16
    v_alignbit_b32 v155, v159, v155, 16
    v_lshlrev_b32 v8, 3, v0
    s_add_u32 s78, s88, 18432
    buffer_load_dwordx4 v246, s[32:35], s16 offen offset:2048  lds
    v_add_u32 v8, s78, v8
    v_mov_b32 v156, 0
    v_mov_b32 v157, 0
    s_waitcnt vmcnt(11)
    s_barrier
    s_add_u32 s97, s98, s0
    s_lshr_b64 s[0:1], s[0:1], 4
    s_and_b32 s97, s97, 15
    s_lshr_b32 s99, s97, 3
    s_xor_b32 s97, s97, s99
    s_add_u32 m0, s87, 0
    s_lshl_b32 s97, s97, 7
    buffer_load_dwordx4 v240, s[28:31], s97 offen offset:0  lds
    buffer_load_dwordx4 v241, s[28:31], s97 offen offset:1024  lds
    buffer_load_dwordx4 v242, s[28:31], s97 offen offset:2048  lds
    buffer_load_dwordx4 v243, s[28:31], s97 offen offset:3072  lds
    s_add_u32 m0, s88, 0
    s_mov_b64 exec, 0xffffffff
    buffer_load_dwordx4 v3, s[28:31], s97 offen offset:0  lds
    s_mov_b64 exec, -1
    s_mul_i32 s16, s97, 3072
    s_add_u32 m0, s60, 0
    s_add_u32 s99, s16, s62
    buffer_load_dwordx4 v244, s[32:35], s99 offen offset:0  lds
    buffer_load_dwordx4 v245, s[32:35], s99 offen offset:1024  lds
    buffer_load_dwordx4 v246, s[32:35], s99 offen offset:2048  lds
    s_add_u32 m0, s61, 12288
    s_add_u32 s16, s16, s63
    buffer_load_dwordx4 v244, s[32:35], s16 offen offset:0  lds
    buffer_load_dwordx4 v245, s[32:35], s16 offen offset:1024  lds
    buffer_load_dwordx4 v246, s[32:35], s16 offen offset:2048  lds
    s_mov_b64 exec, 0xff
    buffer_load_dword v136, v33, s[68:71], 0 offen sc1
    buffer_load_dword v137, v34, s[52:55], 0 offen sc1
    s_mov_b64 exec, -1
    s_waitcnt vmcnt(13)
    s_barrier
    s_waitcnt vmcnt(0)
    s_branch LA_j
LA_c2:
    s_waitcnt vmcnt(7)
    s_barrier
    buffer_load_dwordx4 v246, s[32:35], s99 offen offset:2048  lds
    s_add_u32 m0, s61, 36864
    s_add_u32 s16, s16, s63
    buffer_load_dwordx4 v244, s[32:35], s16 offen offset:0  lds
    buffer_load_dwordx4 v245, s[32:35], s16 offen offset:1024  lds
    buffer_load_dwordx4 v246, s[32:35], s16 offen offset:2048  lds
    s_add_u32 s97, s98, s0
    s_lshr_b64 s[0:1], s[0:1], 4
    s_and_b32 s97, s97, 15
    s_lshr_b32 s99, s97, 3
    s_xor_b32 s97, s97, s99
    s_add_u32 m0, s87, 36864
    s_lshl_b32 s97, s97, 7
    buffer_load_dwordx4 v240, s[28:31], s97 offen offset:0  lds
    buffer_load_dwordx4 v241, s[28:31], s97 offen offset:1024  lds
    buffer_load_dwordx4 v242, s[28:31], s97 offen offset:2048  lds
    buffer_load_dwordx4 v243, s[28:31], s97 offen offset:3072  lds
    s_add_u32 m0, s88, 36864
    s_mov_b64 exec, 0xffffffff
    buffer_load_dwordx4 v3, s[28:31], s97 offen offset:0  lds
    s_mov_b64 exec, -1
    s_mul_i32 s16, s97, 3072
    s_add_u32 m0, s60, 49152
    s_add_u32 s99, s16, s62
    buffer_load_dwordx4 v244, s[32:35], s99 offen offset:0  lds
    buffer_load_dwordx4 v245, s[32:35], s99 offen offset:1024  lds
    buffer_load_dwordx4 v246, s[32:35], s99 offen offset:2048  lds
    s_add_u32 m0, s61, 61440
    s_add_u32 s16, s16, s63
    buffer_load_dwordx4 v244, s[32:35], s16 offen offset:0  lds
    buffer_load_dwordx4 v245, s[32:35], s16 offen offset:1024  lds
    buffer_load_dwordx4 v246, s[32:35], s16 offen offset:2048  lds
    s_waitcnt vmcnt(11)
    s_barrier
    s_add_u32 s97, s98, s0
    s_lshr_b64 s[0:1], s[0:1], 4
    s_and_b32 s97, s97, 15
    s_lshr_b32 s99, s97, 3
    s_xor_b32 s97, s97, s99
    s_add_u32 m0, s87, 0
    s_lshl_b32 s97, s97, 7
    buffer_load_dwordx4 v240, s[28:31], s97 offen offset:0  lds
    s_mov_b32 s68, s24
    s_mov_b32 s69, s25
    s_mov_b32 s70, 0x100
    s_mov_b32 s71, 0x20000
    v_lshrrev_b32 v6, 5, v0
    buffer_load_dwordx4 v241, s[28:31], s97 offen offset:1024  lds
    v_and_b32 v7, 3, v0
    s_lshr_b32 s78, s90, 1
    s_lshl_b32 s78, s78, 2
    s_load_dword s92, s[14:15], s78
    s_mul_i32 s94, s3, 8320
    buffer_load_dwordx4 v242, s[28:31], s97 offen offset:2048  lds
    s_add_u32 s94, s94, 129024
    v_bfe_u32 v5, v0, 2, 2
    v_lshlrev_b32 v5, 1, v5
    v_lshl_add_u32 v5, v6, 3, v5
    v_bfe_u32 v8, v0, 4, 1
    buffer_load_dwordx4 v243, s[28:31], s97 offen offset:3072  lds
    v_add_u32 v5, v5, v8
    s_and_b32 s78, s3, 1
    s_lshl_b32 s78, s78, 1
    v_add_u32 v8, s78, v6
    v_xor_b32 v8, v8, v7
    s_add_u32 m0, s88, 0
    s_mov_b64 exec, 0xffffffff
    buffer_load_dwordx4 v3, s[28:31], s97 offen offset:0  lds
    s_mov_b64 exec, -1
    v_lshlrev_b32 v8, 4, v8
    v_lshl_add_u32 v5, v5, 6, v8
    v_add_u32 v14, s86, v5
    v_mov_b32 v18, 162304
    v_mov_b32 v19, 1
    s_mul_i32 s16, s97, 3072
    s_add_u32 m0, s60, 0
    s_add_u32 s99, s16, s62
    buffer_load_dwordx4 v244, s[32:35], s99 offen offset:0  lds
    v_and_b32 v5, 3, v0
    s_lshl_b32 s78, s74, 4
    s_add_u32 s78, s78, s3
    v_lshl_add_u32 v6, v5, 2, s78
    s_lshr_b32 s78, s76, 3
    buffer_load_dwordx4 v245, s[32:35], s99 offen offset:1024  lds
    s_lshl_b32 s79, s3, 1
    s_add_u32 s78, s78, s79
    s_xor_b32 s78, s78, 0
    s_lshl_b32 s78, s78, 5
    s_and_b32 s79, s76, 7
    buffer_load_dwordx4 v246, s[32:35], s99 offen offset:2048  lds
    s_add_u32 s78, s78, s79
    v_lshl_add_u32 v7, v5, 3, s78
    v_and_b32 v8, 4, v0
    v_cmp_eq_u32 vcc, 0, v8
    s_nop 1
    v_cndmask_b32 v6, v7, v6, vcc
    s_add_u32 m0, s61, 12288
    s_add_u32 s16, s16, s63
    buffer_load_dwordx4 v244, s[32:35], s16 offen offset:0  lds
    v_and_b32 v33, 0xf0, v6
    v_lshlrev_b32 v34, 8, v6
    v_add_u32 v34, 12582912, v34
    v_and_b32 v5, 15, v0
    v_lshrrev_b32 v6, 4, v0
    buffer_load_dwordx4 v245, s[32:35], s16 offen offset:1024  lds
    v_add_u32 v7, 9, v5
    v_and_b32 v8, 1, v7
    v_mul_u32_u24 v8, 4160, v8
    v_lshrrev_b32 v7, 1, v7
    v_lshl_add_u32 v8, v7, 2, v8
    buffer_load_dwordx4 v246, s[32:35], s16 offen offset:2048  lds
    v_lshlrev_b32 v7, 4, v6
    v_sub_u32 v8, v8, v7
    s_add_u32 s78, s94, 32
    v_add_u32 v21, s78, v8
    v_add_u32 v22, 1024, v21
    v_add_u32 v23, 2048, v21
    v_add_u32 v24, 3072, v21
    v_lshl_add_u32 v7, v5, 1, v6
    v_add_u32 v7, 30, v7
    v_and_b32 v8, 1, v7
    s_waitcnt vmcnt(11)
    s_barrier
    s_add_u32 s97, s98, s0
    s_lshr_b64 s[0:1], s[0:1], 4
    s_and_b32 s97, s97, 15
    s_lshr_b32 s99, s97, 3
    s_xor_b32 s97, s97, s99
    s_add_u32 m0, s87, 18432
    s_lshl_b32 s97, s97, 7
    buffer_load_dwordx4 v240, s[28:31], s97 offen offset:0  lds
    v_bfe_u32 v136, v7, 1, 2
    v_lshl_add_u32 v136, v8, 2, v136
    v_lshlrev_b32 v136, 6, v136
    v_lshrrev_b32 v7, 3, v7
    v_lshl_add_u32 v136, v7, 9, v136
    buffer_load_dwordx4 v241, s[28:31], s97 offen offset:1024  lds
    v_bitop3_b32 v8, v7, 3, s3 bitop3:0x6a
    v_lshl_add_u32 v25, v8, 4, v136
    v_add_u32 v25, 92160, v25
    v_subrev_u32 v7, 1, v7
    v_bitop3_b32 v8, v7, 3, s3 bitop3:0x6a
    buffer_load_dwordx4 v242, s[28:31], s97 offen offset:2048  lds
    v_lshl_add_u32 v27, v8, 4, v136
    v_add_u32 v27, 91648, v27
    v_subrev_u32 v7, 1, v7
    v_bitop3_b32 v8, v7, 3, s3 bitop3:0x6a
    v_lshl_add_u32 v29, v8, 4, v136
    buffer_load_dwordx4 v243, s[28:31], s97 offen offset:3072  lds
    v_add_u32 v29, 91136, v29
    v_subrev_u32 v7, 1, v7
    v_bitop3_b32 v8, v7, 3, s3 bitop3:0x6a
    v_lshl_add_u32 v31, v8, 4, v136
    v_add_u32 v31, 90624, v31
    s_add_u32 m0, s88, 18432
    s_mov_b64 exec, 0xffffffff
    buffer_load_dwordx4 v3, s[28:31], s97 offen offset:0  lds
    s_mov_b64 exec, -1
    v_lshl_add_u32 v7, v5, 1, v6
    v_add_u32 v7, 26, v7
    v_and_b32 v8, 1, v7
    v_bfe_u32 v136, v7, 1, 2
    v_lshl_add_u32 v136, v8, 2, v136
    s_mul_i32 s16, s97, 3072
    s_add_u32 m0, s60, 24576
    s_add_u32 s99, s16, s62
    buffer_load_dwordx4 v244, s[32:35], s99 offen offset:0  lds
    v_lshlrev_b32 v136, 6, v136
    v_lshrrev_b32 v7, 3, v7
    v_lshl_add_u32 v136, v7, 9, v136
    v_bitop3_b32 v8, v7, 3, s3 bitop3:0x6a
    v_lshl_add_u32 v26, v8, 4, v136
    buffer_load_dwordx4 v245, s[32:35], s99 offen offset:1024  lds
    v_add_u32 v26, 92160, v26
    v_subrev_u32 v7, 1, v7
    v_bitop3_b32 v8, v7, 3, s3 bitop3:0x6a
    v_lshl_add_u32 v28, v8, 4, v136
    v_add_u32 v28, 91648, v28
    buffer_load_dwordx4 v246, s[32:35], s99 offen offset:2048  lds
    v_subrev_u32 v7, 1, v7
    v_bitop3_b32 v8, v7, 3, s3 bitop3:0x6a
    v_lshl_add_u32 v30, v8, 4, v136
    v_add_u32 v30, 91136, v30
    v_subrev_u32 v7, 1, v7
    s_add_u32 m0, s61, 36864
    s_add_u32 s16, s16, s63
    buffer_load_dwordx4 v244, s[32:35], s16 offen offset:0  lds
    v_bitop3_b32 v8, v7, 3, s3 bitop3:0x6a
    v_lshl_add_u32 v32, v8, 4, v136
    v_add_u32 v32, 90624, v32
    v_lshrrev_b32 v7, 1, v6
    v_lshl_add_u32 v7, v5, 1, v7
    buffer_load_dwordx4 v245, s[32:35], s16 offen offset:1024  lds
    v_add_u32 v7, 32, v7
    v_and_b32 v8, 1, v7
    v_bfe_u32 v136, v7, 1, 2
    v_lshl_add_u32 v136, v8, 2, v136
    v_lshlrev_b32 v136, 6, v136
    buffer_load_dwordx4 v246, s[32:35], s16 offen offset:2048  lds
    v_lshrrev_b32 v7, 3, v7
    v_lshl_add_u32 v136, v7, 9, v136
    v_bitop3_b32 v8, v7, 3, s3 bitop3:0x6a
    v_lshl_add_u32 v20, v8, 4, v136
    v_add_u32 v20, 92160, v20
    v_and_b32 v8, 1, v6
    v_xor_b32 v8, 1, v8
    v_lshl_add_u32 v20, v8, 3, v20
    s_waitcnt lgkmcnt(0)
    s_and_b32 s78, s92, 0xffff0000
    s_waitcnt vmcnt(11)
    s_barrier
    s_add_u32 m0, s86, 129536
    s_mov_b32 s89, 0
    buffer_load_dwordx4 v10, s[36:39], s89 offen nt lds
    s_lshl_b32 s92, s92, 16
    s_bitcmp1_b32 s90, 0
    s_cselect_b32 s92, s78, s92
    s_add_u32 m0, s86, 145920
    s_mov_b32 s89, 0
    buffer_load_dwordx4 v10, s[40:43], s89 offen nt lds
    v_lshlrev_b32 v7, 3, v6
    s_add_u32 m0, s86, 133632
    s_mov_b32 s89, 65536
    buffer_load_dwordx4 v10, s[36:39], s89 offen nt lds
    v_sub_u32 v7, v7, v5
    s_add_u32 m0, s86, 150016
    s_mov_b32 s89, 65536
    buffer_load_dwordx4 v10, s[40:43], s89 offen nt lds
    v_subrev_u32 v7, 9, v7
    s_add_u32 m0, s86, 137728
    s_mov_b32 s89, 131072
    buffer_load_dwordx4 v10, s[36:39], s89 offen nt lds
    v_and_b32 v8, 1, v7
    s_add_u32 m0, s86, 154112
    s_mov_b32 s89, 131072
    buffer_load_dwordx4 v10, s[40:43], s89 offen nt lds
    v_xor_b32 v8, 1, v8
    s_add_u32 m0, s86, 141824
    s_mov_b32 s89, 196608
    buffer_load_dwordx4 v10, s[36:39], s89 offen nt lds
    v_lshlrev_b32 v8, 4, v8
    s_add_u32 m0, s86, 158208
    s_mov_b32 s89, 196608
    buffer_load_dwordx4 v10, s[40:43], s89 offen nt lds
    v_lshrrev_b32 v8, v8, s92
    s_mov_b64 exec, 0xff
    s_lshl_b32 s82, s3, 7
    s_add_u32 m0, s82, 129024
    s_mov_b32 s89, 0
    buffer_load_dwordx4 v11, s[36:39], s89 offen nt lds
    s_lshl_b32 s83, s74, 9
    s_add_u32 s83, s83, s82
    s_and_b32 s89, s3, 2
    s_lshl_b32 s89, s89, 3
    s_add_u32 s82, s82, s89
    s_add_u32 m0, s82, 162816
    s_add_u32 s89, s83, 0
    buffer_load_dwordx4 v15, s[44:47], s89 offen  lds
    s_mov_b64 exec, -1
    v_ashrrev_i32 v7, 1, v7
    v_cmp_eq_u32 vcc, 0, v7
    s_add_u32 s97, s98, s0
    s_lshr_b64 s[0:1], s[0:1], 4
    s_and_b32 s97, s97, 15
    s_lshr_b32 s99, s97, 3
    s_xor_b32 s97, s97, s99
    s_add_u32 m0, s87, 36864
    s_lshl_b32 s97, s97, 7
    buffer_load_dwordx4 v240, s[28:31], s97 offen offset:0  lds
    v_cndmask_b32 v236, 0, v8, vcc
    buffer_load_dwordx4 v241, s[28:31], s97 offen offset:1024  lds
    v_cmp_eq_u32 vcc, 1, v7
    buffer_load_dwordx4 v242, s[28:31], s97 offen offset:2048  lds
    s_nop 0
    v_cndmask_b32 v237, 0, v8, vcc
    buffer_load_dwordx4 v243, s[28:31], s97 offen offset:3072  lds
    v_cmp_eq_u32 vcc, 2, v7
    s_add_u32 m0, s88, 36864
    s_mov_b64 exec, 0xffffffff
    buffer_load_dwordx4 v3, s[28:31], s97 offen offset:0  lds
    s_mov_b64 exec, -1
    v_cndmask_b32 v238, 0, v8, vcc
    s_mul_i32 s16, s97, 3072
    s_add_u32 m0, s60, 49152
    s_add_u32 s99, s16, s62
    buffer_load_dwordx4 v244, s[32:35], s99 offen offset:0  lds
    v_cmp_eq_u32 vcc, 3, v7
    buffer_load_dwordx4 v245, s[32:35], s99 offen offset:1024  lds
    s_nop 0
    v_cndmask_b32 v239, 0, v8, vcc
    s_waitcnt vmcnt(17)
    s_barrier
    buffer_load_dwordx4 v246, s[32:35], s99 offen offset:2048  lds
    s_add_u32 m0, s61, 61440
    s_add_u32 s16, s16, s63
    buffer_load_dwordx4 v244, s[32:35], s16 offen offset:0  lds
    buffer_load_dwordx4 v245, s[32:35], s16 offen offset:1024  lds
    buffer_load_dwordx4 v246, s[32:35], s16 offen offset:2048  lds
    s_add_u32 s97, s98, s0
    s_lshr_b64 s[0:1], s[0:1], 4
    s_and_b32 s97, s97, 15
    s_lshr_b32 s99, s97, 3
    s_xor_b32 s97, s97, s99
    s_add_u32 m0, s87, 0
    s_lshl_b32 s97, s97, 7
    buffer_load_dwordx4 v240, s[28:31], s97 offen offset:0  lds
    buffer_load_dwordx4 v241, s[28:31], s97 offen offset:1024  lds
    buffer_load_dwordx4 v242, s[28:31], s97 offen offset:2048  lds
    buffer_load_dwordx4 v243, s[28:31], s97 offen offset:3072  lds
    s_add_u32 m0, s88, 0
    s_mov_b64 exec, 0xffffffff
    buffer_load_dwordx4 v3, s[28:31], s97 offen offset:0  lds
    s_mov_b64 exec, -1
    s_mul_i32 s16, s97, 3072
    s_add_u32 m0, s60, 0
    s_add_u32 s99, s16, s62
    buffer_load_dwordx4 v244, s[32:35], s99 offen offset:0  lds
    buffer_load_dwordx4 v245, s[32:35], s99 offen offset:1024  lds
    buffer_load_dwordx4 v246, s[32:35], s99 offen offset:2048  lds
    s_add_u32 m0, s61, 12288
    s_add_u32 s16, s16, s63
    buffer_load_dwordx4 v244, s[32:35], s16 offen offset:0  lds
    buffer_load_dwordx4 v245, s[32:35], s16 offen offset:1024  lds
    buffer_load_dwordx4 v246, s[32:35], s16 offen offset:2048  lds
    s_waitcnt vmcnt(11)
    s_barrier
    buffer_load_dword v230, v229, s[64:67], 0 offen
    ds_read_b128 v[84:87], v35 offset:0
    ds_read_b128 v[88:91], v35 offset:16
    s_add_u32 s97, s98, s0
    s_lshr_b64 s[0:1], s[0:1], 4
    s_and_b32 s97, s97, 15
    s_lshr_b32 s99, s97, 3
    s_xor_b32 s97, s97, s99
    s_add_u32 m0, s87, 18432
    s_lshl_b32 s97, s97, 7
    buffer_load_dwordx4 v240, s[28:31], s97 offen offset:0  lds
    ds_read_b128 v[92:95], v35 offset:32
    buffer_load_dwordx4 v241, s[28:31], s97 offen offset:1024  lds
    ds_read_b128 v[96:99], v35 offset:48
    buffer_load_dwordx4 v242, s[28:31], s97 offen offset:2048  lds
    ds_read_b128 v[40:43], v233 offset:0
    buffer_load_dwordx4 v243, s[28:31], s97 offen offset:3072  lds
    ds_read_b128 v[44:47], v232 offset:256
    ds_read_b128 v[48:51], v233 offset:256
    s_add_u32 m0, s88, 18432
    s_mov_b64 exec, 0xffffffff
    buffer_load_dwordx4 v3, s[28:31], s97 offen offset:0  lds
    s_mov_b64 exec, -1
    ds_read_b128 v[52:55], v16 offset:512
    s_mul_i32 s16, s97, 3072
    s_add_u32 m0, s60, 24576
    s_add_u32 s99, s16, s62
    buffer_load_dwordx4 v244, s[32:35], s99 offen offset:0  lds
    ds_read_b128 v[56:59], v231 offset:512
    buffer_load_dwordx4 v245, s[32:35], s99 offen offset:1024  lds
    ds_read_b128 v[60:63], v16 offset:768
    buffer_load_dwordx4 v246, s[32:35], s99 offen offset:2048  lds
    ds_read_b128 v[64:67], v231 offset:768
    ds_read_b128 v[68:71], v16 offset:16896
    s_add_u32 m0, s61, 36864
    s_add_u32 s16, s16, s63
    buffer_load_dwordx4 v244, s[32:35], s16 offen offset:0  lds
    ds_read_b128 v[72:75], v231 offset:16896
    buffer_load_dwordx4 v245, s[32:35], s16 offen offset:1024  lds
    ds_read_b128 v[76:79], v16 offset:17152
    buffer_load_dwordx4 v246, s[32:35], s16 offen offset:2048  lds
    ds_read_b128 v[80:83], v231 offset:17152
    s_waitcnt vmcnt(12)
    s_waitcnt lgkmcnt(0)
    s_barrier
    s_add_u32 s97, s98, s0
    s_lshr_b64 s[0:1], s[0:1], 4
    s_and_b32 s97, s97, 15
    s_lshr_b32 s99, s97, 3
    s_xor_b32 s97, s97, s99
    s_add_u32 m0, s87, 36864
    s_lshl_b32 s97, s97, 7
    buffer_load_dwordx4 v240, s[28:31], s97 offen offset:0  lds
    v_lshlrev_b32 v116, 16, v40
    v_lshlrev_b32 v117, 16, v44
    v_lshlrev_b32 v118, 16, v48
    v_lshlrev_b32 v119, 16, v52
    v_lshlrev_b32 v120, 16, v56
    buffer_load_dwordx4 v241, s[28:31], s97 offen offset:1024  lds
    v_lshlrev_b32 v121, 16, v60
    v_lshlrev_b32 v122, 16, v64
    v_lshlrev_b32 v127, 16, v84
    v_and_b32 v128, 0xffff0000, v84
    v_lshlrev_b32 v129, 16, v85
    buffer_load_dwordx4 v242, s[28:31], s97 offen offset:2048  lds
    v_and_b32 v130, 0xffff0000, v85
    v_lshlrev_b32 v123, 16, v68
    v_lshlrev_b32 v124, 16, v72
    v_lshlrev_b32 v125, 16, v76
    v_lshlrev_b32 v126, 16, v80
    buffer_load_dwordx4 v243, s[28:31], s97 offen offset:3072  lds
    v_mul_f32 v131, v116, v130
    v_mul_f32 v132, v117, v130
    v_mul_f32 v133, v118, v130
    v_mul_f32 v134, v119, v130
    v_fmac_f32 v131, v117, v129
    s_add_u32 m0, s88, 36864
    s_mov_b64 exec, 0xffffffff
    buffer_load_dwordx4 v3, s[28:31], s97 offen offset:0  lds
    s_mov_b64 exec, -1
    v_fmac_f32 v132, v118, v129
    v_fmac_f32 v133, v119, v129
    v_fmac_f32 v134, v120, v129
    v_fmac_f32 v131, v118, v128
    v_fmac_f32 v132, v119, v128
    s_mul_i32 s16, s97, 3072
    s_add_u32 m0, s60, 49152
    s_add_u32 s99, s16, s62
    buffer_load_dwordx4 v244, s[32:35], s99 offen offset:0  lds
    v_fmac_f32 v133, v120, v128
    v_fmac_f32 v134, v121, v128
    v_fmac_f32 v131, v119, v127
    v_fmac_f32 v132, v120, v127
    v_fmac_f32 v133, v121, v127
    buffer_load_dwordx4 v245, s[32:35], s99 offen offset:1024  lds
    v_fmac_f32 v134, v122, v127
    v_mul_f32 v131, v131, v123
    v_mul_f32 v132, v132, v124
    v_mul_f32 v133, v133, v125
    v_mul_f32 v134, v134, v126
    buffer_load_dwordx4 v246, s[32:35], s99 offen offset:2048  lds
    v_cvt_pk_bf16_f32 v102, v134, v133
    v_cvt_pk_bf16_f32 v103, v132, v131
    v_lshlrev_b32 v116, 16, v42
    v_lshlrev_b32 v117, 16, v46
    v_lshlrev_b32 v118, 16, v50
    s_add_u32 m0, s61, 61440
    s_add_u32 s16, s16, s63
    buffer_load_dwordx4 v244, s[32:35], s16 offen offset:0  lds
    v_lshlrev_b32 v119, 16, v54
    v_lshlrev_b32 v120, 16, v58
    v_lshlrev_b32 v121, 16, v62
    v_lshlrev_b32 v122, 16, v66
    v_lshlrev_b32 v127, 16, v92
    buffer_load_dwordx4 v245, s[32:35], s16 offen offset:1024  lds
    v_and_b32 v128, 0xffff0000, v92
    v_lshlrev_b32 v129, 16, v93
    v_and_b32 v130, 0xffff0000, v93
    v_lshlrev_b32 v123, 16, v70
    v_lshlrev_b32 v124, 16, v74
    buffer_load_dwordx4 v246, s[32:35], s16 offen offset:2048  lds
    v_lshlrev_b32 v125, 16, v78
    v_lshlrev_b32 v126, 16, v82
    v_mul_f32 v131, v116, v130
    v_mul_f32 v132, v117, v130
    v_mul_f32 v133, v118, v130
    v_mul_f32 v134, v119, v130
    v_fmac_f32 v131, v117, v129
    v_fmac_f32 v132, v118, v129
    v_fmac_f32 v133, v119, v129
    v_fmac_f32 v134, v120, v129
    v_fmac_f32 v131, v118, v128
    v_fmac_f32 v132, v119, v128
    s_waitcnt vmcnt(11)
    s_barrier
    s_add_u32 s97, s98, s0
    s_lshr_b64 s[0:1], s[0:1], 4
    s_and_b32 s97, s97, 15
    s_lshr_b32 s99, s97, 3
    s_xor_b32 s97, s97, s99
    s_add_u32 m0, s87, 0
    s_lshl_b32 s97, s97, 7
    buffer_load_dwordx4 v240, s[28:31], s97 offen offset:0  lds
    v_fmac_f32 v133, v120, v128
    v_fmac_f32 v134, v121, v128
    v_fmac_f32 v131, v119, v127
    v_fmac_f32 v132, v120, v127
    v_fmac_f32 v133, v121, v127
    buffer_load_dwordx4 v241, s[28:31], s97 offen offset:1024  lds
    v_fmac_f32 v134, v122, v127
    v_mul_f32 v131, v131, v123
    v_mul_f32 v132, v132, v124
    v_mul_f32 v133, v133, v125
    v_mul_f32 v134, v134, v126
    buffer_load_dwordx4 v242, s[28:31], s97 offen offset:2048  lds
    v_cvt_pk_bf16_f32 v100, v134, v133
    v_cvt_pk_bf16_f32 v101, v132, v131
    s_nop 0
    v_permlane32_swap_b32 v102, v100
    v_permlane32_swap_b32 v103, v101
    s_mov_b32 s89, 0
    buffer_store_dwordx4 v[100:103], v12, s[52:55], s89 offen sc1
    buffer_load_dwordx4 v243, s[28:31], s97 offen offset:3072  lds
    v_and_b32 v116, 0xffff0000, v40
    v_and_b32 v117, 0xffff0000, v44
    v_and_b32 v118, 0xffff0000, v48
    v_and_b32 v119, 0xffff0000, v52
    v_and_b32 v120, 0xffff0000, v56
    s_add_u32 m0, s88, 0
    s_mov_b64 exec, 0xffffffff
    buffer_load_dwordx4 v3, s[28:31], s97 offen offset:0  lds
    s_mov_b64 exec, -1
    v_and_b32 v121, 0xffff0000, v60
    v_and_b32 v122, 0xffff0000, v64
    v_lshlrev_b32 v127, 16, v86
    v_and_b32 v128, 0xffff0000, v86
    v_lshlrev_b32 v129, 16, v87
    s_mul_i32 s16, s97, 3072
    s_add_u32 m0, s60, 0
    s_add_u32 s99, s16, s62
    buffer_load_dwordx4 v244, s[32:35], s99 offen offset:0  lds
    v_and_b32 v130, 0xffff0000, v87
    v_and_b32 v123, 0xffff0000, v68
    v_and_b32 v124, 0xffff0000, v72
    v_and_b32 v125, 0xffff0000, v76
    v_and_b32 v126, 0xffff0000, v80
    buffer_load_dwordx4 v245, s[32:35], s99 offen offset:1024  lds
    v_mul_f32 v131, v116, v130
    v_mul_f32 v132, v117, v130
    v_mul_f32 v133, v118, v130
    v_mul_f32 v134, v119, v130
    v_fmac_f32 v131, v117, v129
    buffer_load_dwordx4 v246, s[32:35], s99 offen offset:2048  lds
    v_fmac_f32 v132, v118, v129
    v_fmac_f32 v133, v119, v129
    v_fmac_f32 v134, v120, v129
    v_fmac_f32 v131, v118, v128
    v_fmac_f32 v132, v119, v128
    s_add_u32 m0, s61, 12288
    s_add_u32 s16, s16, s63
    buffer_load_dwordx4 v244, s[32:35], s16 offen offset:0  lds
    v_fmac_f32 v133, v120, v128
    v_fmac_f32 v134, v121, v128
    v_fmac_f32 v131, v119, v127
    v_fmac_f32 v132, v120, v127
    v_fmac_f32 v133, v121, v127
    buffer_load_dwordx4 v245, s[32:35], s16 offen offset:1024  lds
    v_fmac_f32 v134, v122, v127
    v_mul_f32 v131, v131, v123
    v_mul_f32 v132, v132, v124
    v_mul_f32 v133, v133, v125
    v_mul_f32 v134, v134, v126
    buffer_load_dwordx4 v246, s[32:35], s16 offen offset:2048  lds
    v_cvt_pk_bf16_f32 v106, v134, v133
    v_cvt_pk_bf16_f32 v107, v132, v131
    v_and_b32 v116, 0xffff0000, v42
    v_and_b32 v117, 0xffff0000, v46
    v_and_b32 v118, 0xffff0000, v50
    v_and_b32 v119, 0xffff0000, v54
    v_and_b32 v120, 0xffff0000, v58
    v_and_b32 v121, 0xffff0000, v62
    v_and_b32 v122, 0xffff0000, v66
    v_lshlrev_b32 v127, 16, v94
    v_and_b32 v128, 0xffff0000, v94
    v_lshlrev_b32 v129, 16, v95
    s_waitcnt vmcnt(12)
    s_barrier
    s_add_u32 s97, s98, s0
    s_lshr_b64 s[0:1], s[0:1], 4
    s_and_b32 s97, s97, 15
    s_lshr_b32 s99, s97, 3
    s_xor_b32 s97, s97, s99
    s_add_u32 m0, s87, 18432
    s_lshl_b32 s97, s97, 7
    buffer_load_dwordx4 v240, s[28:31], s97 offen offset:0  lds
    v_and_b32 v130, 0xffff0000, v95
    v_and_b32 v123, 0xffff0000, v70
    v_and_b32 v124, 0xffff0000, v74
    v_and_b32 v125, 0xffff0000, v78
    v_and_b32 v126, 0xffff0000, v82
    buffer_load_dwordx4 v241, s[28:31], s97 offen offset:1024  lds
    v_mul_f32 v131, v116, v130
    v_mul_f32 v132, v117, v130
    v_mul_f32 v133, v118, v130
    v_mul_f32 v134, v119, v130
    v_fmac_f32 v131, v117, v129
    buffer_load_dwordx4 v242, s[28:31], s97 offen offset:2048  lds
    v_fmac_f32 v132, v118, v129
    v_fmac_f32 v133, v119, v129
    v_fmac_f32 v134, v120, v129
    v_fmac_f32 v131, v118, v128
    v_fmac_f32 v132, v119, v128
    buffer_load_dwordx4 v243, s[28:31], s97 offen offset:3072  lds
    v_fmac_f32 v133, v120, v128
    v_fmac_f32 v134, v121, v128
    v_fmac_f32 v131, v119, v127
    v_fmac_f32 v132, v120, v127
    v_fmac_f32 v133, v121, v127
    s_add_u32 m0, s88, 18432
    s_mov_b64 exec, 0xffffffff
    buffer_load_dwordx4 v3, s[28:31], s97 offen offset:0  lds
    s_mov_b64 exec, -1
    v_fmac_f32 v134, v122, v127
    v_mul_f32 v131, v131, v123
    v_mul_f32 v132, v132, v124
    v_mul_f32 v133, v133, v125
    v_mul_f32 v134, v134, v126
    s_mul_i32 s16, s97, 3072
    s_add_u32 m0, s60, 24576
    s_add_u32 s99, s16, s62
    buffer_load_dwordx4 v244, s[32:35], s99 offen offset:0  lds
    v_cvt_pk_bf16_f32 v104, v134, v133
    v_cvt_pk_bf16_f32 v105, v132, v131
    s_nop 0
    v_permlane32_swap_b32 v106, v104
    v_permlane32_swap_b32 v107, v105
    s_mov_b32 s89, 16384
    buffer_store_dwordx4 v[104:107], v12, s[52:55], s89 offen sc1
    buffer_load_dwordx4 v245, s[32:35], s99 offen offset:1024  lds
    v_lshlrev_b32 v116, 16, v41
    v_lshlrev_b32 v117, 16, v45
    v_lshlrev_b32 v118, 16, v49
    v_lshlrev_b32 v119, 16, v53
    v_lshlrev_b32 v120, 16, v57
    buffer_load_dwordx4 v246, s[32:35], s99 offen offset:2048  lds
    v_lshlrev_b32 v121, 16, v61
    v_lshlrev_b32 v122, 16, v65
    v_lshlrev_b32 v127, 16, v88
    v_and_b32 v128, 0xffff0000, v88
    v_lshlrev_b32 v129, 16, v89
    s_add_u32 m0, s61, 36864
    s_add_u32 s16, s16, s63
    buffer_load_dwordx4 v244, s[32:35], s16 offen offset:0  lds
    v_and_b32 v130, 0xffff0000, v89
    v_lshlrev_b32 v123, 16, v69
    v_lshlrev_b32 v124, 16, v73
    v_lshlrev_b32 v125, 16, v77
    v_lshlrev_b32 v126, 16, v81
    buffer_load_dwordx4 v245, s[32:35], s16 offen offset:1024  lds
    v_mul_f32 v131, v116, v130
    v_mul_f32 v132, v117, v130
    v_mul_f32 v133, v118, v130
    v_mul_f32 v134, v119, v130
    v_fmac_f32 v131, v117, v129
    buffer_load_dwordx4 v246, s[32:35], s16 offen offset:2048  lds
    v_fmac_f32 v132, v118, v129
    v_fmac_f32 v133, v119, v129
    v_fmac_f32 v134, v120, v129
    v_fmac_f32 v131, v118, v128
    v_fmac_f32 v132, v119, v128
    v_fmac_f32 v133, v120, v128
    v_fmac_f32 v134, v121, v128
    v_fmac_f32 v131, v119, v127
    v_fmac_f32 v132, v120, v127
    v_fmac_f32 v133, v121, v127
    v_fmac_f32 v134, v122, v127
    v_mul_f32 v131, v131, v123
    s_waitcnt vmcnt(12)
    s_barrier
    s_add_u32 s97, s98, s0
    s_lshr_b64 s[0:1], s[0:1], 4
    s_and_b32 s97, s97, 15
    s_lshr_b32 s99, s97, 3
    s_xor_b32 s97, s97, s99
    s_add_u32 m0, s87, 36864
    s_lshl_b32 s97, s97, 7
    buffer_load_dwordx4 v240, s[28:31], s97 offen offset:0  lds
    v_mul_f32 v132, v132, v124
    v_mul_f32 v133, v133, v125
    v_mul_f32 v134, v134, v126
    v_cvt_pk_bf16_f32 v110, v134, v133
    v_cvt_pk_bf16_f32 v111, v132, v131
    buffer_load_dwordx4 v241, s[28:31], s97 offen offset:1024  lds
    v_lshlrev_b32 v116, 16, v43
    v_lshlrev_b32 v117, 16, v47
    v_lshlrev_b32 v118, 16, v51
    v_lshlrev_b32 v119, 16, v55
    v_lshlrev_b32 v120, 16, v59
    buffer_load_dwordx4 v242, s[28:31], s97 offen offset:2048  lds
    v_lshlrev_b32 v121, 16, v63
    v_lshlrev_b32 v122, 16, v67
    v_lshlrev_b32 v127, 16, v96
    v_and_b32 v128, 0xffff0000, v96
    v_lshlrev_b32 v129, 16, v97
    buffer_load_dwordx4 v243, s[28:31], s97 offen offset:3072  lds
    v_and_b32 v130, 0xffff0000, v97
    v_lshlrev_b32 v123, 16, v71
    v_lshlrev_b32 v124, 16, v75
    v_lshlrev_b32 v125, 16, v79
    v_lshlrev_b32 v126, 16, v83
    s_add_u32 m0, s88, 36864
    s_mov_b64 exec, 0xffffffff
    buffer_load_dwordx4 v3, s[28:31], s97 offen offset:0  lds
    s_mov_b64 exec, -1
    v_mul_f32 v131, v116, v130
    v_mul_f32 v132, v117, v130
    v_mul_f32 v133, v118, v130
    v_mul_f32 v134, v119, v130
    v_fmac_f32 v131, v117, v129
    s_mul_i32 s16, s97, 3072
    s_add_u32 m0, s60, 49152
    s_add_u32 s99, s16, s62
    buffer_load_dwordx4 v244, s[32:35], s99 offen offset:0  lds
    v_fmac_f32 v132, v118, v129
    v_fmac_f32 v133, v119, v129
    v_fmac_f32 v134, v120, v129
    v_fmac_f32 v131, v118, v128
    v_fmac_f32 v132, v119, v128
    buffer_load_dwordx4 v245, s[32:35], s99 offen offset:1024  lds
    v_fmac_f32 v133, v120, v128
    v_fmac_f32 v134, v121, v128
    v_fmac_f32 v131, v119, v127
    v_fmac_f32 v132, v120, v127
    v_fmac_f32 v133, v121, v127
    buffer_load_dwordx4 v246, s[32:35], s99 offen offset:2048  lds
    v_fmac_f32 v134, v122, v127
    v_mul_f32 v131, v131, v123
    v_mul_f32 v132, v132, v124
    v_mul_f32 v133, v133, v125
    v_mul_f32 v134, v134, v126
    s_add_u32 m0, s61, 61440
    s_add_u32 s16, s16, s63
    buffer_load_dwordx4 v244, s[32:35], s16 offen offset:0  lds
    v_cvt_pk_bf16_f32 v108, v134, v133
    v_cvt_pk_bf16_f32 v109, v132, v131
    s_nop 0
    v_permlane32_swap_b32 v110, v108
    v_permlane32_swap_b32 v111, v109
    s_mov_b32 s89, 32768
    buffer_store_dwordx4 v[108:111], v12, s[52:55], s89 offen sc1
    buffer_load_dwordx4 v245, s[32:35], s16 offen offset:1024  lds
    v_and_b32 v116, 0xffff0000, v41
    v_and_b32 v117, 0xffff0000, v45
    v_and_b32 v118, 0xffff0000, v49
    v_and_b32 v119, 0xffff0000, v53
    v_and_b32 v120, 0xffff0000, v57
    buffer_load_dwordx4 v246, s[32:35], s16 offen offset:2048  lds
    v_and_b32 v121, 0xffff0000, v61
    v_and_b32 v122, 0xffff0000, v65
    v_lshlrev_b32 v127, 16, v90
    v_and_b32 v128, 0xffff0000, v90
    v_lshlrev_b32 v129, 16, v91
    v_and_b32 v130, 0xffff0000, v91
    v_and_b32 v123, 0xffff0000, v69
    v_and_b32 v124, 0xffff0000, v73
    v_and_b32 v125, 0xffff0000, v77
    v_and_b32 v126, 0xffff0000, v81
    v_mul_f32 v131, v116, v130
    v_mul_f32 v132, v117, v130
    s_waitcnt vmcnt(12)
    s_barrier
    s_add_u32 s97, s98, s0
    s_lshr_b64 s[0:1], s[0:1], 4
    s_and_b32 s97, s97, 15
    s_lshr_b32 s99, s97, 3
    s_xor_b32 s97, s97, s99
    s_add_u32 m0, s87, 0
    s_lshl_b32 s97, s97, 7
    buffer_load_dwordx4 v240, s[28:31], s97 offen offset:0  lds
    v_mul_f32 v133, v118, v130
    v_mul_f32 v134, v119, v130
    v_fmac_f32 v131, v117, v129
    v_fmac_f32 v132, v118, v129
    v_fmac_f32 v133, v119, v129
    buffer_load_dwordx4 v241, s[28:31], s97 offen offset:1024  lds
    v_fmac_f32 v134, v120, v129
    v_fmac_f32 v131, v118, v128
    v_fmac_f32 v132, v119, v128
    v_fmac_f32 v133, v120, v128
    v_fmac_f32 v134, v121, v128
    buffer_load_dwordx4 v242, s[28:31], s97 offen offset:2048  lds
    v_fmac_f32 v131, v119, v127
    v_fmac_f32 v132, v120, v127
    v_fmac_f32 v133, v121, v127
    v_fmac_f32 v134, v122, v127
    v_mul_f32 v131, v131, v123
    buffer_load_dwordx4 v243, s[28:31], s97 offen offset:3072  lds
    v_mul_f32 v132, v132, v124
    v_mul_f32 v133, v133, v125
    v_mul_f32 v134, v134, v126
    v_cvt_pk_bf16_f32 v114, v134, v133
    v_cvt_pk_bf16_f32 v115, v132, v131
    s_add_u32 m0, s88, 0
    s_mov_b64 exec, 0xffffffff
    buffer_load_dwordx4 v3, s[28:31], s97 offen offset:0  lds
    s_mov_b64 exec, -1
    v_and_b32 v116, 0xffff0000, v43
    v_and_b32 v117, 0xffff0000, v47
    v_and_b32 v118, 0xffff0000, v51
    v_and_b32 v119, 0xffff0000, v55
    v_and_b32 v120, 0xffff0000, v59
    s_mul_i32 s16, s97, 3072
    s_add_u32 m0, s60, 0
    s_add_u32 s99, s16, s62
    buffer_load_dwordx4 v244, s[32:35], s99 offen offset:0  lds
    v_and_b32 v121, 0xffff0000, v63
    v_and_b32 v122, 0xffff0000, v67
    v_lshlrev_b32 v127, 16, v98
    v_and_b32 v128, 0xffff0000, v98
    v_lshlrev_b32 v129, 16, v99
    buffer_load_dwordx4 v245, s[32:35], s99 offen offset:1024  lds
    v_and_b32 v130, 0xffff0000, v99
    v_and_b32 v123, 0xffff0000, v71
    v_and_b32 v124, 0xffff0000, v75
    v_and_b32 v125, 0xffff0000, v79
    v_and_b32 v126, 0xffff0000, v83
    buffer_load_dwordx4 v246, s[32:35], s99 offen offset:2048  lds
    v_mul_f32 v131, v116, v130
    v_mul_f32 v132, v117, v130
    v_mul_f32 v133, v118, v130
    v_mul_f32 v134, v119, v130
    v_fmac_f32 v131, v117, v129
    s_add_u32 m0, s61, 12288
    s_add_u32 s16, s16, s63
    buffer_load_dwordx4 v244, s[32:35], s16 offen offset:0  lds
    v_fmac_f32 v132, v118, v129
    v_fmac_f32 v133, v119, v129
    v_fmac_f32 v134, v120, v129
    v_fmac_f32 v131, v118, v128
    v_fmac_f32 v132, v119, v128
    buffer_load_dwordx4 v245, s[32:35], s16 offen offset:1024  lds
    v_fmac_f32 v133, v120, v128
    v_fmac_f32 v134, v121, v128
    v_fmac_f32 v131, v119, v127
    v_fmac_f32 v132, v120, v127
    v_fmac_f32 v133, v121, v127
    buffer_load_dwordx4 v246, s[32:35], s16 offen offset:2048  lds
    v_fmac_f32 v134, v122, v127
    v_mul_f32 v131, v131, v123
    v_mul_f32 v132, v132, v124
    v_mul_f32 v133, v133, v125
    v_mul_f32 v134, v134, v126
    v_cvt_pk_bf16_f32 v112, v134, v133
    v_cvt_pk_bf16_f32 v113, v132, v131
    s_nop 0
    v_permlane32_swap_b32 v114, v112
    v_permlane32_swap_b32 v115, v113
    s_mov_b32 s89, 49152
    buffer_store_dwordx4 v[112:115], v12, s[52:55], s89 offen sc1
    s_waitcnt vmcnt(12)
    s_barrier
    s_add_u32 m0, s94, 32
    s_lshl_b32 s89, s90, 12
    buffer_load_dwordx4 v15, s[48:51], s89 offen offset:0 nt lds
    s_add_u32 m0, s94, 32
    s_lshl_b32 s89, s90, 12
    buffer_load_dwordx4 v15, s[48:51], s89 offen offset:1024 nt lds
    s_add_u32 m0, s94, 32
    s_lshl_b32 s89, s90, 12
    buffer_load_dwordx4 v15, s[48:51], s89 offen offset:2048 nt lds
    s_add_u32 m0, s94, 32
    s_lshl_b32 s89, s90, 12
    buffer_load_dwordx4 v15, s[48:51], s89 offen offset:3072 nt lds
    s_add_u32 s97, s98, s0
    s_lshr_b64 s[0:1], s[0:1], 4
    s_and_b32 s97, s97, 15
    s_lshr_b32 s99, s97, 3
    s_xor_b32 s97, s97, s99
    s_add_u32 m0, s87, 18432
    s_lshl_b32 s97, s97, 7
    buffer_load_dwordx4 v240, s[28:31], s97 offen offset:0  lds
    buffer_load_dwordx4 v241, s[28:31], s97 offen offset:1024  lds
    buffer_load_dwordx4 v242, s[28:31], s97 offen offset:2048  lds
    buffer_load_dwordx4 v243, s[28:31], s97 offen offset:3072  lds
    s_add_u32 m0, s88, 18432
    s_mov_b64 exec, 0xffffffff
    buffer_load_dwordx4 v3, s[28:31], s97 offen offset:0  lds
    s_mov_b64 exec, -1
    s_mul_i32 s16, s97, 3072
    s_add_u32 m0, s60, 24576
    s_add_u32 s99, s16, s62
    buffer_load_dwordx4 v244, s[32:35], s99 offen offset:0  lds
    buffer_load_dwordx4 v245, s[32:35], s99 offen offset:1024  lds
    buffer_load_dwordx4 v246, s[32:35], s99 offen offset:2048  lds
    s_add_u32 m0, s61, 36864
    s_add_u32 s16, s16, s63
    buffer_load_dwordx4 v244, s[32:35], s16 offen offset:0  lds
    buffer_load_dwordx4 v245, s[32:35], s16 offen offset:1024  lds
    buffer_load_dwordx4 v246, s[32:35], s16 offen offset:2048  lds
    s_waitcnt vmcnt(16)
    s_waitcnt vmcnt(15)
    s_barrier
    s_add_u32 s97, s98, s0
    s_lshr_b64 s[0:1], s[0:1], 4
    s_and_b32 s97, s97, 15
    s_lshr_b32 s99, s97, 3
    s_xor_b32 s97, s97, s99
    s_add_u32 m0, s87, 36864
    s_lshl_b32 s97, s97, 7
    buffer_load_dwordx4 v240, s[28:31], s97 offen offset:0  lds
    buffer_load_dwordx4 v241, s[28:31], s97 offen offset:1024  lds
    buffer_load_dwordx4 v242, s[28:31], s97 offen offset:2048  lds
    buffer_load_dwordx4 v243, s[28:31], s97 offen offset:3072  lds
    s_add_u32 m0, s88, 36864
    s_mov_b64 exec, 0xffffffff
    buffer_load_dwordx4 v3, s[28:31], s97 offen offset:0  lds
    s_mov_b64 exec, -1
    s_mul_i32 s16, s97, 3072
    s_add_u32 m0, s60, 49152
    s_add_u32 s99, s16, s62
    buffer_load_dwordx4 v244, s[32:35], s99 offen offset:0  lds
    buffer_load_dwordx4 v245, s[32:35], s99 offen offset:1024  lds
    buffer_load_dwordx4 v246, s[32:35], s99 offen offset:2048  lds
    s_add_u32 m0, s61, 61440
    s_add_u32 s16, s16, s63
    buffer_load_dwordx4 v244, s[32:35], s16 offen offset:0  lds
    buffer_load_dwordx4 v245, s[32:35], s16 offen offset:1024  lds
    buffer_load_dwordx4 v246, s[32:35], s16 offen offset:2048  lds
    s_waitcnt vmcnt(11)
    s_barrier
    s_add_u32 s97, s98, s0
    s_lshr_b64 s[0:1], s[0:1], 4
    s_and_b32 s97, s97, 15
    s_lshr_b32 s99, s97, 3
    s_xor_b32 s97, s97, s99
    s_add_u32 m0, s87, 0
    s_lshl_b32 s97, s97, 7
    buffer_load_dwordx4 v240, s[28:31], s97 offen offset:0  lds
    v_add_u32 v5, s94, v15
    ds_read_b128 v[140:143], v5 offset:32
    ds_read_b32 v156, v5 offset:48
    ds_read_b128 v[144:147], v5 offset:1056
    buffer_load_dwordx4 v241, s[28:31], s97 offen offset:1024  lds
    ds_read_b32 v157, v5 offset:1072
    ds_read_b128 v[148:151], v5 offset:2080
    ds_read_b32 v158, v5 offset:2096
    buffer_load_dwordx4 v242, s[28:31], s97 offen offset:2048  lds
    ds_read_b128 v[152:155], v5 offset:3104
    ds_read_b32 v159, v5 offset:3120
    v_lshrrev_b32 v6, 3, v0
    buffer_load_dwordx4 v243, s[28:31], s97 offen offset:3072  lds
    v_mul_u32_u24 v6, 4160, v6
    v_and_b32 v7, 7, v0
    v_lshl_add_u32 v6, v7, 2, v6
    v_add_u32 v6, s94, v6
    s_add_u32 m0, s88, 0
    s_mov_b64 exec, 0xffffffff
    buffer_load_dwordx4 v3, s[28:31], s97 offen offset:0  lds
    s_mov_b64 exec, -1
    v_mov_b32 v7, 0
    s_waitcnt lgkmcnt(0)
    v_readfirstlane_b32 s93, v140
    s_mul_i32 s16, s97, 3072
    s_add_u32 m0, s60, 0
    s_add_u32 s99, s16, s62
    buffer_load_dwordx4 v244, s[32:35], s99 offen offset:0  lds
    s_lshl_b32 s93, s93, 16
    v_writelane_b32 v7, s93, 15
    v_alignbit_b32 v140, v141, v140, 16
    buffer_load_dwordx4 v245, s[32:35], s99 offen offset:1024  lds
    v_alignbit_b32 v141, v142, v141, 16
    v_alignbit_b32 v142, v143, v142, 16
    v_alignbit_b32 v143, v156, v143, 16
    v_alignbit_b32 v144, v145, v144, 16
    buffer_load_dwordx4 v246, s[32:35], s99 offen offset:2048  lds
    v_alignbit_b32 v145, v146, v145, 16
    v_alignbit_b32 v146, v147, v146, 16
    v_alignbit_b32 v147, v157, v147, 16
    s_add_u32 m0, s61, 12288
    s_add_u32 s16, s16, s63
    buffer_load_dwordx4 v244, s[32:35], s16 offen offset:0  lds
    v_alignbit_b32 v148, v149, v148, 16
    v_alignbit_b32 v149, v150, v149, 16
    v_alignbit_b32 v150, v151, v150, 16
    buffer_load_dwordx4 v245, s[32:35], s16 offen offset:1024  lds
    v_alignbit_b32 v151, v158, v151, 16
    v_alignbit_b32 v152, v153, v152, 16
    v_alignbit_b32 v153, v154, v153, 16
    v_alignbit_b32 v154, v155, v154, 16
    buffer_load_dwordx4 v246, s[32:35], s16 offen offset:2048  lds
    v_alignbit_b32 v155, v159, v155, 16
    v_lshlrev_b32 v8, 3, v0
    s_add_u32 s78, s88, 18432
    s_mov_b64 exec, 0xff
    buffer_load_dword v136, v33, s[68:71], 0 offen sc1
    buffer_load_dword v137, v34, s[52:55], 0 offen sc1
    s_mov_b64 exec, -1
    v_add_u32 v8, s78, v8
    v_mov_b32 v156, 0
    v_mov_b32 v157, 0
    s_waitcnt vmcnt(13)
    s_barrier
    s_waitcnt vmcnt(0)
    s_branch LA_j
LA_c3:
    s_waitcnt vmcnt(7)
    s_barrier
    buffer_load_dwordx4 v246, s[32:35], s99 offen offset:2048  lds
    s_add_u32 m0, s61, 36864
    s_add_u32 s16, s16, s63
    buffer_load_dwordx4 v244, s[32:35], s16 offen offset:0  lds
    buffer_load_dwordx4 v245, s[32:35], s16 offen offset:1024  lds
    buffer_load_dwordx4 v246, s[32:35], s16 offen offset:2048  lds
    s_add_u32 s97, s98, s0
    s_lshr_b64 s[0:1], s[0:1], 4
    s_and_b32 s97, s97, 15
    s_lshr_b32 s99, s97, 3
    s_xor_b32 s97, s97, s99
    s_add_u32 m0, s87, 36864
    s_lshl_b32 s97, s97, 7
    buffer_load_dwordx4 v240, s[28:31], s97 offen offset:0  lds
    buffer_load_dwordx4 v241, s[28:31], s97 offen offset:1024  lds
    buffer_load_dwordx4 v242, s[28:31], s97 offen offset:2048  lds
    buffer_load_dwordx4 v243, s[28:31], s97 offen offset:3072  lds
    s_add_u32 m0, s88, 36864
    s_mov_b64 exec, 0xffffffff
    buffer_load_dwordx4 v3, s[28:31], s97 offen offset:0  lds
    s_mov_b64 exec, -1
    s_mul_i32 s16, s97, 3072
    s_add_u32 m0, s60, 49152
    s_add_u32 s99, s16, s62
    buffer_load_dwordx4 v244, s[32:35], s99 offen offset:0  lds
    buffer_load_dwordx4 v245, s[32:35], s99 offen offset:1024  lds
    buffer_load_dwordx4 v246, s[32:35], s99 offen offset:2048  lds
    s_add_u32 m0, s61, 61440
    s_add_u32 s16, s16, s63
    buffer_load_dwordx4 v244, s[32:35], s16 offen offset:0  lds
    buffer_load_dwordx4 v245, s[32:35], s16 offen offset:1024  lds
    buffer_load_dwordx4 v246, s[32:35], s16 offen offset:2048  lds
    s_waitcnt vmcnt(11)
    s_barrier
    buffer_load_dword v230, v229, s[64:67], 0 offen
    s_mov_b32 s68, s24
    s_mov_b32 s69, s25
    s_mov_b32 s70, 0x100
    s_mov_b32 s71, 0x20000
    v_lshrrev_b32 v6, 5, v0
    s_add_u32 s97, s98, s0
    s_lshr_b64 s[0:1], s[0:1], 4
    s_and_b32 s97, s97, 15
    s_lshr_b32 s99, s97, 3
    s_xor_b32 s97, s97, s99
    s_add_u32 m0, s87, 0
    s_lshl_b32 s97, s97, 7
    buffer_load_dwordx4 v240, s[28:31], s97 offen offset:0  lds
    v_and_b32 v7, 3, v0
    s_lshr_b32 s78, s90, 1
    s_lshl_b32 s78, s78, 2
    s_load_dword s92, s[14:15], s78
    s_mul_i32 s94, s3, 8320
    buffer_load_dwordx4 v241, s[28:31], s97 offen offset:1024  lds
    s_add_u32 s94, s94, 129024
    v_bfe_u32 v5, v0, 2, 2
    v_lshlrev_b32 v5, 1, v5
    v_lshl_add_u32 v5, v6, 3, v5
    v_bfe_u32 v8, v0, 4, 1
    buffer_load_dwordx4 v242, s[28:31], s97 offen offset:2048  lds
    v_add_u32 v5, v5, v8
    s_and_b32 s78, s3, 1
    s_lshl_b32 s78, s78, 1
    v_add_u32 v8, s78, v6
    v_xor_b32 v8, v8, v7
    buffer_load_dwordx4 v243, s[28:31], s97 offen offset:3072  lds
    v_lshlrev_b32 v8, 4, v8
    v_lshl_add_u32 v5, v5, 6, v8
    v_add_u32 v14, s86, v5
    v_mov_b32 v18, 162304
    v_mov_b32 v19, 1
    s_add_u32 m0, s88, 0
    s_mov_b64 exec, 0xffffffff
    buffer_load_dwordx4 v3, s[28:31], s97 offen offset:0  lds
    s_mov_b64 exec, -1
    v_and_b32 v5, 3, v0
    s_lshl_b32 s78, s74, 4
    s_add_u32 s78, s78, s3
    v_lshl_add_u32 v6, v5, 2, s78
    s_lshr_b32 s78, s76, 3
    s_mul_i32 s16, s97, 3072
    s_add_u32 m0, s60, 0
    s_add_u32 s99, s16, s62
    buffer_load_dwordx4 v244, s[32:35], s99 offen offset:0  lds
    s_lshl_b32 s79, s3, 1
    s_add_u32 s78, s78, s79
    s_xor_b32 s78, s78, 0
    s_lshl_b32 s78, s78, 5
    s_and_b32 s79, s76, 7
    buffer_load_dwordx4 v245, s[32:35], s99 offen offset:1024  lds
    s_add_u32 s78, s78, s79
    v_lshl_add_u32 v7, v5, 3, s78
    v_and_b32 v8, 4, v0
    v_cmp_eq_u32 vcc, 0, v8
    s_nop 1
    v_cndmask_b32 v6, v7, v6, vcc
    buffer_load_dwordx4 v246, s[32:35], s99 offen offset:2048  lds
    v_and_b32 v33, 0xf0, v6
    v_lshlrev_b32 v34, 8, v6
    v_add_u32 v34, 12582912, v34
    v_and_b32 v5, 15, v0
    v_lshrrev_b32 v6, 4, v0
    s_add_u32 m0, s61, 12288
    s_add_u32 s16, s16, s63
    buffer_load_dwordx4 v244, s[32:35], s16 offen offset:0  lds
    v_add_u32 v7, 9, v5
    v_and_b32 v8, 1, v7
    v_mul_u32_u24 v8, 4160, v8
    v_lshrrev_b32 v7, 1, v7
    v_lshl_add_u32 v8, v7, 2, v8
    buffer_load_dwordx4 v245, s[32:35], s16 offen offset:1024  lds
    v_lshlrev_b32 v7, 4, v6
    v_sub_u32 v8, v8, v7
    s_add_u32 s78, s94, 32
    v_add_u32 v21, s78, v8
    v_add_u32 v22, 1024, v21
    buffer_load_dwordx4 v246, s[32:35], s16 offen offset:2048  lds
    v_add_u32 v23, 2048, v21
    v_add_u32 v24, 3072, v21
    v_lshl_add_u32 v7, v5, 1, v6
    v_add_u32 v7, 30, v7
    v_and_b32 v8, 1, v7
    s_waitcnt vmcnt(12)
    s_barrier
    s_add_u32 s97, s98, s0
    s_lshr_b64 s[0:1], s[0:1], 4
    s_and_b32 s97, s97, 15
    s_lshr_b32 s99, s97, 3
    s_xor_b32 s97, s97, s99
    s_add_u32 m0, s87, 18432
    s_lshl_b32 s97, s97, 7
    buffer_load_dwordx4 v240, s[28:31], s97 offen offset:0  lds
    v_bfe_u32 v136, v7, 1, 2
    v_lshl_add_u32 v136, v8, 2, v136
    v_lshlrev_b32 v136, 6, v136
    v_lshrrev_b32 v7, 3, v7
    v_lshl_add_u32 v136, v7, 9, v136
    buffer_load_dwordx4 v241, s[28:31], s97 offen offset:1024  lds
    v_bitop3_b32 v8, v7, 3, s3 bitop3:0x6a
    v_lshl_add_u32 v25, v8, 4, v136
    v_add_u32 v25, 92160, v25
    v_subrev_u32 v7, 1, v7
    v_bitop3_b32 v8, v7, 3, s3 bitop3:0x6a
    buffer_load_dwordx4 v242, s[28:31], s97 offen offset:2048  lds
    v_lshl_add_u32 v27, v8, 4, v136
    v_add_u32 v27, 91648, v27
    v_subrev_u32 v7, 1, v7
    v_bitop3_b32 v8, v7, 3, s3 bitop3:0x6a
    v_lshl_add_u32 v29, v8, 4, v136
    buffer_load_dwordx4 v243, s[28:31], s97 offen offset:3072  lds
    v_add_u32 v29, 91136, v29
    v_subrev_u32 v7, 1, v7
    v_bitop3_b32 v8, v7, 3, s3 bitop3:0x6a
    v_lshl_add_u32 v31, v8, 4, v136
    v_add_u32 v31, 90624, v31
    s_add_u32 m0, s88, 18432
    s_mov_b64 exec, 0xffffffff
    buffer_load_dwordx4 v3, s[28:31], s97 offen offset:0  lds
    s_mov_b64 exec, -1
    v_lshl_add_u32 v7, v5, 1, v6
    v_add_u32 v7, 26, v7
    v_and_b32 v8, 1, v7
    v_bfe_u32 v136, v7, 1, 2
    v_lshl_add_u32 v136, v8, 2, v136
    s_mul_i32 s16, s97, 3072
    s_add_u32 m0, s60, 24576
    s_add_u32 s99, s16, s62
    buffer_load_dwordx4 v244, s[32:35], s99 offen offset:0  lds
    v_lshlrev_b32 v136, 6, v136
    v_lshrrev_b32 v7, 3, v7
    v_lshl_add_u32 v136, v7, 9, v136
    v_bitop3_b32 v8, v7, 3, s3 bitop3:0x6a
    v_lshl_add_u32 v26, v8, 4, v136
    buffer_load_dwordx4 v245, s[32:35], s99 offen offset:1024  lds
    v_add_u32 v26, 92160, v26
    v_subrev_u32 v7, 1, v7
    v_bitop3_b32 v8, v7, 3, s3 bitop3:0x6a
    v_lshl_add_u32 v28, v8, 4, v136
    v_add_u32 v28, 91648, v28
    buffer_load_dwordx4 v246, s[32:35], s99 offen offset:2048  lds
    v_subrev_u32 v7, 1, v7
    v_bitop3_b32 v8, v7, 3, s3 bitop3:0x6a
    v_lshl_add_u32 v30, v8, 4, v136
    v_add_u32 v30, 91136, v30
    v_subrev_u32 v7, 1, v7
    s_add_u32 m0, s61, 36864
    s_add_u32 s16, s16, s63
    buffer_load_dwordx4 v244, s[32:35], s16 offen offset:0  lds
    v_bitop3_b32 v8, v7, 3, s3 bitop3:0x6a
    v_lshl_add_u32 v32, v8, 4, v136
    v_add_u32 v32, 90624, v32
    v_lshrrev_b32 v7, 1, v6
    v_lshl_add_u32 v7, v5, 1, v7
    buffer_load_dwordx4 v245, s[32:35], s16 offen offset:1024  lds
    v_add_u32 v7, 32, v7
    v_and_b32 v8, 1, v7
    v_bfe_u32 v136, v7, 1, 2
    v_lshl_add_u32 v136, v8, 2, v136
    v_lshlrev_b32 v136, 6, v136
    buffer_load_dwordx4 v246, s[32:35], s16 offen offset:2048  lds
    v_lshrrev_b32 v7, 3, v7
    v_lshl_add_u32 v136, v7, 9, v136
    v_bitop3_b32 v8, v7, 3, s3 bitop3:0x6a
    v_lshl_add_u32 v20, v8, 4, v136
    v_add_u32 v20, 92160, v20
    v_and_b32 v8, 1, v6
    v_xor_b32 v8, 1, v8
    v_lshl_add_u32 v20, v8, 3, v20
    s_waitcnt lgkmcnt(0)
    s_and_b32 s78, s92, 0xffff0000
    s_waitcnt vmcnt(11)
    s_barrier
    s_add_u32 m0, s86, 129536
    s_mov_b32 s89, 0
    buffer_load_dwordx4 v10, s[36:39], s89 offen nt lds
    s_lshl_b32 s92, s92, 16
    s_bitcmp1_b32 s90, 0
    s_cselect_b32 s92, s78, s92
    s_add_u32 m0, s86, 145920
    s_mov_b32 s89, 0
    buffer_load_dwordx4 v10, s[40:43], s89 offen nt lds
    v_lshlrev_b32 v7, 3, v6
    s_add_u32 m0, s86, 133632
    s_mov_b32 s89, 65536
    buffer_load_dwordx4 v10, s[36:39], s89 offen nt lds
    v_sub_u32 v7, v7, v5
    s_add_u32 m0, s86, 150016
    s_mov_b32 s89, 65536
    buffer_load_dwordx4 v10, s[40:43], s89 offen nt lds
    v_subrev_u32 v7, 9, v7
    s_add_u32 m0, s86, 137728
    s_mov_b32 s89, 131072
    buffer_load_dwordx4 v10, s[36:39], s89 offen nt lds
    v_and_b32 v8, 1, v7
    s_add_u32 m0, s86, 154112
    s_mov_b32 s89, 131072
    buffer_load_dwordx4 v10, s[40:43], s89 offen nt lds
    v_xor_b32 v8, 1, v8
    s_add_u32 m0, s86, 141824
    s_mov_b32 s89, 196608
    buffer_load_dwordx4 v10, s[36:39], s89 offen nt lds
    v_lshlrev_b32 v8, 4, v8
    s_add_u32 m0, s86, 158208
    s_mov_b32 s89, 196608
    buffer_load_dwordx4 v10, s[40:43], s89 offen nt lds
    v_lshrrev_b32 v8, v8, s92
    s_mov_b64 exec, 0xff
    s_lshl_b32 s82, s3, 7
    s_add_u32 m0, s82, 129024
    s_mov_b32 s89, 0
    buffer_load_dwordx4 v11, s[36:39], s89 offen nt lds
    s_lshl_b32 s83, s74, 9
    s_add_u32 s83, s83, s82
    s_and_b32 s89, s3, 2
    s_lshl_b32 s89, s89, 3
    s_add_u32 s82, s82, s89
    s_add_u32 m0, s82, 162816
    s_add_u32 s89, s83, 0
    buffer_load_dwordx4 v15, s[44:47], s89 offen  lds
    s_mov_b64 exec, -1
    v_ashrrev_i32 v7, 1, v7
    v_cmp_eq_u32 vcc, 0, v7
    s_add_u32 s97, s98, s0
    s_lshr_b64 s[0:1], s[0:1], 4
    s_and_b32 s97, s97, 15
    s_lshr_b32 s99, s97, 3
    s_xor_b32 s97, s97, s99
    s_add_u32 m0, s87, 36864
    s_lshl_b32 s97, s97, 7
    buffer_load_dwordx4 v240, s[28:31], s97 offen offset:0  lds
    v_cndmask_b32 v236, 0, v8, vcc
    buffer_load_dwordx4 v241, s[28:31], s97 offen offset:1024  lds
    v_cmp_eq_u32 vcc, 1, v7
    buffer_load_dwordx4 v242, s[28:31], s97 offen offset:2048  lds
    s_nop 0
    v_cndmask_b32 v237, 0, v8, vcc
    buffer_load_dwordx4 v243, s[28:31], s97 offen offset:3072  lds
    v_cmp_eq_u32 vcc, 2, v7
    s_add_u32 m0, s88, 36864
    s_mov_b64 exec, 0xffffffff
    buffer_load_dwordx4 v3, s[28:31], s97 offen offset:0  lds
    s_mov_b64 exec, -1
    v_cndmask_b32 v238, 0, v8, vcc
    s_mul_i32 s16, s97, 3072
    s_add_u32 m0, s60, 49152
    s_add_u32 s99, s16, s62
    buffer_load_dwordx4 v244, s[32:35], s99 offen offset:0  lds
    v_cmp_eq_u32 vcc, 3, v7
    buffer_load_dwordx4 v245, s[32:35], s99 offen offset:1024  lds
    s_nop 0
    v_cndmask_b32 v239, 0, v8, vcc
    s_waitcnt vmcnt(17)
    s_barrier
    buffer_load_dwordx4 v246, s[32:35], s99 offen offset:2048  lds
    s_add_u32 m0, s61, 61440
    s_add_u32 s16, s16, s63
    buffer_load_dwordx4 v244, s[32:35], s16 offen offset:0  lds
    buffer_load_dwordx4 v245, s[32:35], s16 offen offset:1024  lds
    buffer_load_dwordx4 v246, s[32:35], s16 offen offset:2048  lds
    s_add_u32 s97, s98, s0
    s_lshr_b64 s[0:1], s[0:1], 4
    s_and_b32 s97, s97, 15
    s_lshr_b32 s99, s97, 3
    s_xor_b32 s97, s97, s99
    s_add_u32 m0, s87, 0
    s_lshl_b32 s97, s97, 7
    buffer_load_dwordx4 v240, s[28:31], s97 offen offset:0  lds
    buffer_load_dwordx4 v241, s[28:31], s97 offen offset:1024  lds
    buffer_load_dwordx4 v242, s[28:31], s97 offen offset:2048  lds
    buffer_load_dwordx4 v243, s[28:31], s97 offen offset:3072  lds
    s_add_u32 m0, s88, 0
    s_mov_b64 exec, 0xffffffff
    buffer_load_dwordx4 v3, s[28:31], s97 offen offset:0  lds
    s_mov_b64 exec, -1
    s_mul_i32 s16, s97, 3072
    s_add_u32 m0, s60, 0
    s_add_u32 s99, s16, s62
    buffer_load_dwordx4 v244, s[32:35], s99 offen offset:0  lds
    buffer_load_dwordx4 v245, s[32:35], s99 offen offset:1024  lds
    buffer_load_dwordx4 v246, s[32:35], s99 offen offset:2048  lds
    s_add_u32 m0, s61, 12288
    s_add_u32 s16, s16, s63
    buffer_load_dwordx4 v244, s[32:35], s16 offen offset:0  lds
    buffer_load_dwordx4 v245, s[32:35], s16 offen offset:1024  lds
    buffer_load_dwordx4 v246, s[32:35], s16 offen offset:2048  lds
    s_waitcnt vmcnt(11)
    s_barrier
    s_add_u32 s97, s98, s0
    s_lshr_b64 s[0:1], s[0:1], 4
    s_and_b32 s97, s97, 15
    s_lshr_b32 s99, s97, 3
    s_xor_b32 s97, s97, s99
    s_add_u32 m0, s87, 18432
    s_lshl_b32 s97, s97, 7
    buffer_load_dwordx4 v240, s[28:31], s97 offen offset:0  lds
    ds_read_b128 v[84:87], v35 offset:0
    ds_read_b128 v[88:91], v35 offset:16
    buffer_load_dwordx4 v241, s[28:31], s97 offen offset:1024  lds
    ds_read_b128 v[92:95], v35 offset:32
    buffer_load_dwordx4 v242, s[28:31], s97 offen offset:2048  lds
    ds_read_b128 v[96:99], v35 offset:48
    ds_read_b128 v[40:43], v233 offset:0
    buffer_load_dwordx4 v243, s[28:31], s97 offen offset:3072  lds
    ds_read_b128 v[44:47], v232 offset:256
    s_add_u32 m0, s88, 18432
    s_mov_b64 exec, 0xffffffff
    buffer_load_dwordx4 v3, s[28:31], s97 offen offset:0  lds
    s_mov_b64 exec, -1
    ds_read_b128 v[48:51], v233 offset:256
    s_mul_i32 s16, s97, 3072
    s_add_u32 m0, s60, 24576
    s_add_u32 s99, s16, s62
    buffer_load_dwordx4 v244, s[32:35], s99 offen offset:0  lds
    ds_read_b128 v[52:55], v16 offset:512
    ds_read_b128 v[56:59], v231 offset:512
    buffer_load_dwordx4 v245, s[32:35], s99 offen offset:1024  lds
    ds_read_b128 v[60:63], v16 offset:768
    buffer_load_dwordx4 v246, s[32:35], s99 offen offset:2048  lds
    ds_read_b128 v[64:67], v231 offset:768
    s_add_u32 m0, s61, 36864
    s_add_u32 s16, s16, s63
    buffer_load_dwordx4 v244, s[32:35], s16 offen offset:0  lds
    ds_read_b128 v[68:71], v16 offset:16896
    ds_read_b128 v[72:75], v231 offset:16896
    buffer_load_dwordx4 v245, s[32:35], s16 offen offset:1024  lds
    ds_read_b128 v[76:79], v16 offset:17152
    buffer_load_dwordx4 v246, s[32:35], s16 offen offset:2048  lds
    ds_read_b128 v[80:83], v231 offset:17152
    s_waitcnt vmcnt(11)
    s_waitcnt lgkmcnt(0)
    s_barrier
    s_add_u32 s97, s98, s0
    s_lshr_b64 s[0:1], s[0:1], 4
    s_and_b32 s97, s97, 15
    s_lshr_b32 s99, s97, 3
    s_xor_b32 s97, s97, s99
    s_add_u32 m0, s87, 36864
    s_lshl_b32 s97, s97, 7
    buffer_load_dwordx4 v240, s[28:31], s97 offen offset:0  lds
    v_lshlrev_b32 v116, 16, v40
    v_lshlrev_b32 v117, 16, v44
    v_lshlrev_b32 v118, 16, v48
    v_lshlrev_b32 v119, 16, v52
    v_lshlrev_b32 v120, 16, v56
    buffer_load_dwordx4 v241, s[28:31], s97 offen offset:1024  lds
    v_lshlrev_b32 v121, 16, v60
    v_lshlrev_b32 v122, 16, v64
    v_lshlrev_b32 v127, 16, v84
    v_and_b32 v128, 0xffff0000, v84
    v_lshlrev_b32 v129, 16, v85
    buffer_load_dwordx4 v242, s[28:31], s97 offen offset:2048  lds
    v_and_b32 v130, 0xffff0000, v85
    v_lshlrev_b32 v123, 16, v68
    v_lshlrev_b32 v124, 16, v72
    v_lshlrev_b32 v125, 16, v76
    v_lshlrev_b32 v126, 16, v80
    buffer_load_dwordx4 v243, s[28:31], s97 offen offset:3072  lds
    v_mul_f32 v131, v116, v130
    v_mul_f32 v132, v117, v130
    v_mul_f32 v133, v118, v130
    v_mul_f32 v134, v119, v130
    v_fmac_f32 v131, v117, v129
    s_add_u32 m0, s88, 36864
    s_mov_b64 exec, 0xffffffff
    buffer_load_dwordx4 v3, s[28:31], s97 offen offset:0  lds
    s_mov_b64 exec, -1
    v_fmac_f32 v132, v118, v129
    v_fmac_f32 v133, v119, v129
    v_fmac_f32 v134, v120, v129
    v_fmac_f32 v131, v118, v128
    v_fmac_f32 v132, v119, v128
    s_mul_i32 s16, s97, 3072
    s_add_u32 m0, s60, 49152
    s_add_u32 s99, s16, s62
    buffer_load_dwordx4 v244, s[32:35], s99 offen offset:0  lds
    v_fmac_f32 v133, v120, v128
    v_fmac_f32 v134, v121, v128
    v_fmac_f32 v131, v119, v127
    v_fmac_f32 v132, v120, v127
    v_fmac_f32 v133, v121, v127
    buffer_load_dwordx4 v245, s[32:35], s99 offen offset:1024  lds
    v_fmac_f32 v134, v122, v127
    v_mul_f32 v131, v131, v123
    v_mul_f32 v132, v132, v124
    v_mul_f32 v133, v133, v125
    v_mul_f32 v134, v134, v126
    buffer_load_dwordx4 v246, s[32:35], s99 offen offset:2048  lds
    v_cvt_pk_bf16_f32 v102, v134, v133
    v_cvt_pk_bf16_f32 v103, v132, v131
    v_lshlrev_b32 v116, 16, v42
    v_lshlrev_b32 v117, 16, v46
    v_lshlrev_b32 v118, 16, v50
    s_add_u32 m0, s61, 61440
    s_add_u32 s16, s16, s63
    buffer_load_dwordx4 v244, s[32:35], s16 offen offset:0  lds
    v_lshlrev_b32 v119, 16, v54
    v_lshlrev_b32 v120, 16, v58
    v_lshlrev_b32 v121, 16, v62
    v_lshlrev_b32 v122, 16, v66
    v_lshlrev_b32 v127, 16, v92
    buffer_load_dwordx4 v245, s[32:35], s16 offen offset:1024  lds
    v_and_b32 v128, 0xffff0000, v92
    v_lshlrev_b32 v129, 16, v93
    v_and_b32 v130, 0xffff0000, v93
    v_lshlrev_b32 v123, 16, v70
    v_lshlrev_b32 v124, 16, v74
    buffer_load_dwordx4 v246, s[32:35], s16 offen offset:2048  lds
    v_lshlrev_b32 v125, 16, v78
    v_lshlrev_b32 v126, 16, v82
    v_mul_f32 v131, v116, v130
    v_mul_f32 v132, v117, v130
    v_mul_f32 v133, v118, v130
    v_mul_f32 v134, v119, v130
    v_fmac_f32 v131, v117, v129
    v_fmac_f32 v132, v118, v129
    v_fmac_f32 v133, v119, v129
    v_fmac_f32 v134, v120, v129
    v_fmac_f32 v131, v118, v128
    v_fmac_f32 v132, v119, v128
    s_waitcnt vmcnt(11)
    s_barrier
    s_add_u32 s97, s98, s0
    s_lshr_b64 s[0:1], s[0:1], 4
    s_and_b32 s97, s97, 15
    s_lshr_b32 s99, s97, 3
    s_xor_b32 s97, s97, s99
    s_add_u32 m0, s87, 0
    s_lshl_b32 s97, s97, 7
    buffer_load_dwordx4 v240, s[28:31], s97 offen offset:0  lds
    v_fmac_f32 v133, v120, v128
    v_fmac_f32 v134, v121, v128
    v_fmac_f32 v131, v119, v127
    v_fmac_f32 v132, v120, v127
    v_fmac_f32 v133, v121, v127
    buffer_load_dwordx4 v241, s[28:31], s97 offen offset:1024  lds
    v_fmac_f32 v134, v122, v127
    v_mul_f32 v131, v131, v123
    v_mul_f32 v132, v132, v124
    v_mul_f32 v133, v133, v125
    v_mul_f32 v134, v134, v126
    buffer_load_dwordx4 v242, s[28:31], s97 offen offset:2048  lds
    v_cvt_pk_bf16_f32 v100, v134, v133
    v_cvt_pk_bf16_f32 v101, v132, v131
    s_nop 0
    v_permlane32_swap_b32 v102, v100
    v_permlane32_swap_b32 v103, v101
    s_mov_b32 s89, 0
    buffer_store_dwordx4 v[100:103], v12, s[52:55], s89 offen sc1
    buffer_load_dwordx4 v243, s[28:31], s97 offen offset:3072  lds
    v_and_b32 v116, 0xffff0000, v40
    v_and_b32 v117, 0xffff0000, v44
    v_and_b32 v118, 0xffff0000, v48
    v_and_b32 v119, 0xffff0000, v52
    v_and_b32 v120, 0xffff0000, v56
    s_add_u32 m0, s88, 0
    s_mov_b64 exec, 0xffffffff
    buffer_load_dwordx4 v3, s[28:31], s97 offen offset:0  lds
    s_mov_b64 exec, -1
    v_and_b32 v121, 0xffff0000, v60
    v_and_b32 v122, 0xffff0000, v64
    v_lshlrev_b32 v127, 16, v86
    v_and_b32 v128, 0xffff0000, v86
    v_lshlrev_b32 v129, 16, v87
    s_mul_i32 s16, s97, 3072
    s_add_u32 m0, s60, 0
    s_add_u32 s99, s16, s62
    buffer_load_dwordx4 v244, s[32:35], s99 offen offset:0  lds
    v_and_b32 v130, 0xffff0000, v87
    v_and_b32 v123, 0xffff0000, v68
    v_and_b32 v124, 0xffff0000, v72
    v_and_b32 v125, 0xffff0000, v76
    v_and_b32 v126, 0xffff0000, v80
    buffer_load_dwordx4 v245, s[32:35], s99 offen offset:1024  lds
    v_mul_f32 v131, v116, v130
    v_mul_f32 v132, v117, v130
    v_mul_f32 v133, v118, v130
    v_mul_f32 v134, v119, v130
    v_fmac_f32 v131, v117, v129
    buffer_load_dwordx4 v246, s[32:35], s99 offen offset:2048  lds
    v_fmac_f32 v132, v118, v129
    v_fmac_f32 v133, v119, v129
    v_fmac_f32 v134, v120, v129
    v_fmac_f32 v131, v118, v128
    v_fmac_f32 v132, v119, v128
    s_add_u32 m0, s61, 12288
    s_add_u32 s16, s16, s63
    buffer_load_dwordx4 v244, s[32:35], s16 offen offset:0  lds
    v_fmac_f32 v133, v120, v128
    v_fmac_f32 v134, v121, v128
    v_fmac_f32 v131, v119, v127
    v_fmac_f32 v132, v120, v127
    v_fmac_f32 v133, v121, v127
    buffer_load_dwordx4 v245, s[32:35], s16 offen offset:1024  lds
    v_fmac_f32 v134, v122, v127
    v_mul_f32 v131, v131, v123
    v_mul_f32 v132, v132, v124
    v_mul_f32 v133, v133, v125
    v_mul_f32 v134, v134, v126
    buffer_load_dwordx4 v246, s[32:35], s16 offen offset:2048  lds
    v_cvt_pk_bf16_f32 v106, v134, v133
    v_cvt_pk_bf16_f32 v107, v132, v131
    v_and_b32 v116, 0xffff0000, v42
    v_and_b32 v117, 0xffff0000, v46
    v_and_b32 v118, 0xffff0000, v50
    v_and_b32 v119, 0xffff0000, v54
    v_and_b32 v120, 0xffff0000, v58
    v_and_b32 v121, 0xffff0000, v62
    v_and_b32 v122, 0xffff0000, v66
    v_lshlrev_b32 v127, 16, v94
    v_and_b32 v128, 0xffff0000, v94
    v_lshlrev_b32 v129, 16, v95
    s_waitcnt vmcnt(12)
    s_barrier
    s_add_u32 s97, s98, s0
    s_lshr_b64 s[0:1], s[0:1], 4
    s_and_b32 s97, s97, 15
    s_lshr_b32 s99, s97, 3
    s_xor_b32 s97, s97, s99
    s_add_u32 m0, s87, 18432
    s_lshl_b32 s97, s97, 7
    buffer_load_dwordx4 v240, s[28:31], s97 offen offset:0  lds
    v_and_b32 v130, 0xffff0000, v95
    v_and_b32 v123, 0xffff0000, v70
    v_and_b32 v124, 0xffff0000, v74
    v_and_b32 v125, 0xffff0000, v78
    v_and_b32 v126, 0xffff0000, v82
    buffer_load_dwordx4 v241, s[28:31], s97 offen offset:1024  lds
    v_mul_f32 v131, v116, v130
    v_mul_f32 v132, v117, v130
    v_mul_f32 v133, v118, v130
    v_mul_f32 v134, v119, v130
    v_fmac_f32 v131, v117, v129
    buffer_load_dwordx4 v242, s[28:31], s97 offen offset:2048  lds
    v_fmac_f32 v132, v118, v129
    v_fmac_f32 v133, v119, v129
    v_fmac_f32 v134, v120, v129
    v_fmac_f32 v131, v118, v128
    v_fmac_f32 v132, v119, v128
    buffer_load_dwordx4 v243, s[28:31], s97 offen offset:3072  lds
    v_fmac_f32 v133, v120, v128
    v_fmac_f32 v134, v121, v128
    v_fmac_f32 v131, v119, v127
    v_fmac_f32 v132, v120, v127
    v_fmac_f32 v133, v121, v127
    s_add_u32 m0, s88, 18432
    s_mov_b64 exec, 0xffffffff
    buffer_load_dwordx4 v3, s[28:31], s97 offen offset:0  lds
    s_mov_b64 exec, -1
    v_fmac_f32 v134, v122, v127
    v_mul_f32 v131, v131, v123
    v_mul_f32 v132, v132, v124
    v_mul_f32 v133, v133, v125
    v_mul_f32 v134, v134, v126
    s_mul_i32 s16, s97, 3072
    s_add_u32 m0, s60, 24576
    s_add_u32 s99, s16, s62
    buffer_load_dwordx4 v244, s[32:35], s99 offen offset:0  lds
    v_cvt_pk_bf16_f32 v104, v134, v133
    v_cvt_pk_bf16_f32 v105, v132, v131
    s_nop 0
    v_permlane32_swap_b32 v106, v104
    v_permlane32_swap_b32 v107, v105
    s_mov_b32 s89, 16384
    buffer_store_dwordx4 v[104:107], v12, s[52:55], s89 offen sc1
    buffer_load_dwordx4 v245, s[32:35], s99 offen offset:1024  lds
    v_lshlrev_b32 v116, 16, v41
    v_lshlrev_b32 v117, 16, v45
    v_lshlrev_b32 v118, 16, v49
    v_lshlrev_b32 v119, 16, v53
    v_lshlrev_b32 v120, 16, v57
    buffer_load_dwordx4 v246, s[32:35], s99 offen offset:2048  lds
    v_lshlrev_b32 v121, 16, v61
    v_lshlrev_b32 v122, 16, v65
    v_lshlrev_b32 v127, 16, v88
    v_and_b32 v128, 0xffff0000, v88
    v_lshlrev_b32 v129, 16, v89
    s_add_u32 m0, s61, 36864
    s_add_u32 s16, s16, s63
    buffer_load_dwordx4 v244, s[32:35], s16 offen offset:0  lds
    v_and_b32 v130, 0xffff0000, v89
    v_lshlrev_b32 v123, 16, v69
    v_lshlrev_b32 v124, 16, v73
    v_lshlrev_b32 v125, 16, v77
    v_lshlrev_b32 v126, 16, v81
    buffer_load_dwordx4 v245, s[32:35], s16 offen offset:1024  lds
    v_mul_f32 v131, v116, v130
    v_mul_f32 v132, v117, v130
    v_mul_f32 v133, v118, v130
    v_mul_f32 v134, v119, v130
    v_fmac_f32 v131, v117, v129
    buffer_load_dwordx4 v246, s[32:35], s16 offen offset:2048  lds
    v_fmac_f32 v132, v118, v129
    v_fmac_f32 v133, v119, v129
    v_fmac_f32 v134, v120, v129
    v_fmac_f32 v131, v118, v128
    v_fmac_f32 v132, v119, v128
    v_fmac_f32 v133, v120, v128
    v_fmac_f32 v134, v121, v128
    v_fmac_f32 v131, v119, v127
    v_fmac_f32 v132, v120, v127
    v_fmac_f32 v133, v121, v127
    v_fmac_f32 v134, v122, v127
    v_mul_f32 v131, v131, v123
    s_waitcnt vmcnt(12)
    s_barrier
    s_add_u32 s97, s98, s0
    s_lshr_b64 s[0:1], s[0:1], 4
    s_and_b32 s97, s97, 15
    s_lshr_b32 s99, s97, 3
    s_xor_b32 s97, s97, s99
    s_add_u32 m0, s87, 36864
    s_lshl_b32 s97, s97, 7
    buffer_load_dwordx4 v240, s[28:31], s97 offen offset:0  lds
    v_mul_f32 v132, v132, v124
    v_mul_f32 v133, v133, v125
    v_mul_f32 v134, v134, v126
    v_cvt_pk_bf16_f32 v110, v134, v133
    v_cvt_pk_bf16_f32 v111, v132, v131
    buffer_load_dwordx4 v241, s[28:31], s97 offen offset:1024  lds
    v_lshlrev_b32 v116, 16, v43
    v_lshlrev_b32 v117, 16, v47
    v_lshlrev_b32 v118, 16, v51
    v_lshlrev_b32 v119, 16, v55
    v_lshlrev_b32 v120, 16, v59
    buffer_load_dwordx4 v242, s[28:31], s97 offen offset:2048  lds
    v_lshlrev_b32 v121, 16, v63
    v_lshlrev_b32 v122, 16, v67
    v_lshlrev_b32 v127, 16, v96
    v_and_b32 v128, 0xffff0000, v96
    v_lshlrev_b32 v129, 16, v97
    buffer_load_dwordx4 v243, s[28:31], s97 offen offset:3072  lds
    v_and_b32 v130, 0xffff0000, v97
    v_lshlrev_b32 v123, 16, v71
    v_lshlrev_b32 v124, 16, v75
    v_lshlrev_b32 v125, 16, v79
    v_lshlrev_b32 v126, 16, v83
    s_add_u32 m0, s88, 36864
    s_mov_b64 exec, 0xffffffff
    buffer_load_dwordx4 v3, s[28:31], s97 offen offset:0  lds
    s_mov_b64 exec, -1
    v_mul_f32 v131, v116, v130
    v_mul_f32 v132, v117, v130
    v_mul_f32 v133, v118, v130
    v_mul_f32 v134, v119, v130
    v_fmac_f32 v131, v117, v129
    s_mul_i32 s16, s97, 3072
    s_add_u32 m0, s60, 49152
    s_add_u32 s99, s16, s62
    buffer_load_dwordx4 v244, s[32:35], s99 offen offset:0  lds
    v_fmac_f32 v132, v118, v129
    v_fmac_f32 v133, v119, v129
    v_fmac_f32 v134, v120, v129
    v_fmac_f32 v131, v118, v128
    v_fmac_f32 v132, v119, v128
    buffer_load_dwordx4 v245, s[32:35], s99 offen offset:1024  lds
    v_fmac_f32 v133, v120, v128
    v_fmac_f32 v134, v121, v128
    v_fmac_f32 v131, v119, v127
    v_fmac_f32 v132, v120, v127
    v_fmac_f32 v133, v121, v127
    buffer_load_dwordx4 v246, s[32:35], s99 offen offset:2048  lds
    v_fmac_f32 v134, v122, v127
    v_mul_f32 v131, v131, v123
    v_mul_f32 v132, v132, v124
    v_mul_f32 v133, v133, v125
    v_mul_f32 v134, v134, v126
    s_add_u32 m0, s61, 61440
    s_add_u32 s16, s16, s63
    buffer_load_dwordx4 v244, s[32:35], s16 offen offset:0  lds
    v_cvt_pk_bf16_f32 v108, v134, v133
    v_cvt_pk_bf16_f32 v109, v132, v131
    s_nop 0
    v_permlane32_swap_b32 v110, v108
    v_permlane32_swap_b32 v111, v109
    s_mov_b32 s89, 32768
    buffer_store_dwordx4 v[108:111], v12, s[52:55], s89 offen sc1
    buffer_load_dwordx4 v245, s[32:35], s16 offen offset:1024  lds
    v_and_b32 v116, 0xffff0000, v41
    v_and_b32 v117, 0xffff0000, v45
    v_and_b32 v118, 0xffff0000, v49
    v_and_b32 v119, 0xffff0000, v53
    v_and_b32 v120, 0xffff0000, v57
    buffer_load_dwordx4 v246, s[32:35], s16 offen offset:2048  lds
    v_and_b32 v121, 0xffff0000, v61
    v_and_b32 v122, 0xffff0000, v65
    v_lshlrev_b32 v127, 16, v90
    v_and_b32 v128, 0xffff0000, v90
    v_lshlrev_b32 v129, 16, v91
    v_and_b32 v130, 0xffff0000, v91
    v_and_b32 v123, 0xffff0000, v69
    v_and_b32 v124, 0xffff0000, v73
    v_and_b32 v125, 0xffff0000, v77
    v_and_b32 v126, 0xffff0000, v81
    v_mul_f32 v131, v116, v130
    v_mul_f32 v132, v117, v130
    s_waitcnt vmcnt(12)
    s_barrier
    s_add_u32 s97, s98, s0
    s_lshr_b64 s[0:1], s[0:1], 4
    s_and_b32 s97, s97, 15
    s_lshr_b32 s99, s97, 3
    s_xor_b32 s97, s97, s99
    s_add_u32 m0, s87, 0
    s_lshl_b32 s97, s97, 7
    buffer_load_dwordx4 v240, s[28:31], s97 offen offset:0  lds
    v_mul_f32 v133, v118, v130
    v_mul_f32 v134, v119, v130
    v_fmac_f32 v131, v117, v129
    v_fmac_f32 v132, v118, v129
    v_fmac_f32 v133, v119, v129
    buffer_load_dwordx4 v241, s[28:31], s97 offen offset:1024  lds
    v_fmac_f32 v134, v120, v129
    v_fmac_f32 v131, v118, v128
    v_fmac_f32 v132, v119, v128
    v_fmac_f32 v133, v120, v128
    v_fmac_f32 v134, v121, v128
    buffer_load_dwordx4 v242, s[28:31], s97 offen offset:2048  lds
    v_fmac_f32 v131, v119, v127
    v_fmac_f32 v132, v120, v127
    v_fmac_f32 v133, v121, v127
    v_fmac_f32 v134, v122, v127
    v_mul_f32 v131, v131, v123
    buffer_load_dwordx4 v243, s[28:31], s97 offen offset:3072  lds
    v_mul_f32 v132, v132, v124
    v_mul_f32 v133, v133, v125
    v_mul_f32 v134, v134, v126
    v_cvt_pk_bf16_f32 v114, v134, v133
    v_cvt_pk_bf16_f32 v115, v132, v131
    s_add_u32 m0, s88, 0
    s_mov_b64 exec, 0xffffffff
    buffer_load_dwordx4 v3, s[28:31], s97 offen offset:0  lds
    s_mov_b64 exec, -1
    v_and_b32 v116, 0xffff0000, v43
    v_and_b32 v117, 0xffff0000, v47
    v_and_b32 v118, 0xffff0000, v51
    v_and_b32 v119, 0xffff0000, v55
    v_and_b32 v120, 0xffff0000, v59
    s_mul_i32 s16, s97, 3072
    s_add_u32 m0, s60, 0
    s_add_u32 s99, s16, s62
    buffer_load_dwordx4 v244, s[32:35], s99 offen offset:0  lds
    v_and_b32 v121, 0xffff0000, v63
    v_and_b32 v122, 0xffff0000, v67
    v_lshlrev_b32 v127, 16, v98
    v_and_b32 v128, 0xffff0000, v98
    v_lshlrev_b32 v129, 16, v99
    buffer_load_dwordx4 v245, s[32:35], s99 offen offset:1024  lds
    v_and_b32 v130, 0xffff0000, v99
    v_and_b32 v123, 0xffff0000, v71
    v_and_b32 v124, 0xffff0000, v75
    v_and_b32 v125, 0xffff0000, v79
    v_and_b32 v126, 0xffff0000, v83
    buffer_load_dwordx4 v246, s[32:35], s99 offen offset:2048  lds
    v_mul_f32 v131, v116, v130
    v_mul_f32 v132, v117, v130
    v_mul_f32 v133, v118, v130
    v_mul_f32 v134, v119, v130
    v_fmac_f32 v131, v117, v129
    s_add_u32 m0, s61, 12288
    s_add_u32 s16, s16, s63
    buffer_load_dwordx4 v244, s[32:35], s16 offen offset:0  lds
    v_fmac_f32 v132, v118, v129
    v_fmac_f32 v133, v119, v129
    v_fmac_f32 v134, v120, v129
    v_fmac_f32 v131, v118, v128
    v_fmac_f32 v132, v119, v128
    buffer_load_dwordx4 v245, s[32:35], s16 offen offset:1024  lds
    v_fmac_f32 v133, v120, v128
    v_fmac_f32 v134, v121, v128
    v_fmac_f32 v131, v119, v127
    v_fmac_f32 v132, v120, v127
    v_fmac_f32 v133, v121, v127
    buffer_load_dwordx4 v246, s[32:35], s16 offen offset:2048  lds
    v_fmac_f32 v134, v122, v127
    v_mul_f32 v131, v131, v123
    v_mul_f32 v132, v132, v124
    v_mul_f32 v133, v133, v125
    v_mul_f32 v134, v134, v126
    v_cvt_pk_bf16_f32 v112, v134, v133
    v_cvt_pk_bf16_f32 v113, v132, v131
    s_nop 0
    v_permlane32_swap_b32 v114, v112
    v_permlane32_swap_b32 v115, v113
    s_mov_b32 s89, 49152
    buffer_store_dwordx4 v[112:115], v12, s[52:55], s89 offen sc1
    s_waitcnt vmcnt(12)
    s_barrier
    s_add_u32 m0, s94, 32
    s_lshl_b32 s89, s90, 12
    buffer_load_dwordx4 v15, s[48:51], s89 offen offset:0 nt lds
    s_add_u32 m0, s94, 32
    s_lshl_b32 s89, s90, 12
    buffer_load_dwordx4 v15, s[48:51], s89 offen offset:1024 nt lds
    s_add_u32 m0, s94, 32
    s_lshl_b32 s89, s90, 12
    buffer_load_dwordx4 v15, s[48:51], s89 offen offset:2048 nt lds
    s_add_u32 m0, s94, 32
    s_lshl_b32 s89, s90, 12
    buffer_load_dwordx4 v15, s[48:51], s89 offen offset:3072 nt lds
    s_add_u32 s97, s98, s0
    s_lshr_b64 s[0:1], s[0:1], 4
    s_and_b32 s97, s97, 15
    s_lshr_b32 s99, s97, 3
    s_xor_b32 s97, s97, s99
    s_add_u32 m0, s87, 18432
    s_lshl_b32 s97, s97, 7
    buffer_load_dwordx4 v240, s[28:31], s97 offen offset:0  lds
    buffer_load_dwordx4 v241, s[28:31], s97 offen offset:1024  lds
    buffer_load_dwordx4 v242, s[28:31], s97 offen offset:2048  lds
    buffer_load_dwordx4 v243, s[28:31], s97 offen offset:3072  lds
    s_add_u32 m0, s88, 18432
    s_mov_b64 exec, 0xffffffff
    buffer_load_dwordx4 v3, s[28:31], s97 offen offset:0  lds
    s_mov_b64 exec, -1
    s_mul_i32 s16, s97, 3072
    s_add_u32 m0, s60, 24576
    s_add_u32 s99, s16, s62
    buffer_load_dwordx4 v244, s[32:35], s99 offen offset:0  lds
    buffer_load_dwordx4 v245, s[32:35], s99 offen offset:1024  lds
    buffer_load_dwordx4 v246, s[32:35], s99 offen offset:2048  lds
    s_add_u32 m0, s61, 36864
    s_add_u32 s16, s16, s63
    buffer_load_dwordx4 v244, s[32:35], s16 offen offset:0  lds
    buffer_load_dwordx4 v245, s[32:35], s16 offen offset:1024  lds
    buffer_load_dwordx4 v246, s[32:35], s16 offen offset:2048  lds
    s_waitcnt vmcnt(16)
    s_waitcnt vmcnt(15)
    s_barrier
    s_add_u32 s97, s98, s0
    s_lshr_b64 s[0:1], s[0:1], 4
    s_and_b32 s97, s97, 15
    s_lshr_b32 s99, s97, 3
    s_xor_b32 s97, s97, s99
    s_add_u32 m0, s87, 36864
    s_lshl_b32 s97, s97, 7
    buffer_load_dwordx4 v240, s[28:31], s97 offen offset:0  lds
    buffer_load_dwordx4 v241, s[28:31], s97 offen offset:1024  lds
    buffer_load_dwordx4 v242, s[28:31], s97 offen offset:2048  lds
    buffer_load_dwordx4 v243, s[28:31], s97 offen offset:3072  lds
    s_add_u32 m0, s88, 36864
    s_mov_b64 exec, 0xffffffff
    buffer_load_dwordx4 v3, s[28:31], s97 offen offset:0  lds
    s_mov_b64 exec, -1
    s_mul_i32 s16, s97, 3072
    s_add_u32 m0, s60, 49152
    s_add_u32 s99, s16, s62
    buffer_load_dwordx4 v244, s[32:35], s99 offen offset:0  lds
    buffer_load_dwordx4 v245, s[32:35], s99 offen offset:1024  lds
    buffer_load_dwordx4 v246, s[32:35], s99 offen offset:2048  lds
    s_add_u32 m0, s61, 61440
    s_add_u32 s16, s16, s63
    buffer_load_dwordx4 v244, s[32:35], s16 offen offset:0  lds
    buffer_load_dwordx4 v245, s[32:35], s16 offen offset:1024  lds
    buffer_load_dwordx4 v246, s[32:35], s16 offen offset:2048  lds
    s_waitcnt vmcnt(11)
    s_barrier
    s_add_u32 s97, s98, s0
    s_lshr_b64 s[0:1], s[0:1], 4
    s_and_b32 s97, s97, 15
    s_lshr_b32 s99, s97, 3
    s_xor_b32 s97, s97, s99
    s_add_u32 m0, s87, 0
    s_lshl_b32 s97, s97, 7
    buffer_load_dwordx4 v240, s[28:31], s97 offen offset:0  lds
    v_add_u32 v5, s94, v15
    ds_read_b128 v[140:143], v5 offset:32
    ds_read_b32 v156, v5 offset:48
    ds_read_b128 v[144:147], v5 offset:1056
    buffer_load_dwordx4 v241, s[28:31], s97 offen offset:1024  lds
    ds_read_b32 v157, v5 offset:1072
    ds_read_b128 v[148:151], v5 offset:2080
    ds_read_b32 v158, v5 offset:2096
    buffer_load_dwordx4 v242, s[28:31], s97 offen offset:2048  lds
    ds_read_b128 v[152:155], v5 offset:3104
    ds_read_b32 v159, v5 offset:3120
    v_lshrrev_b32 v6, 3, v0
    buffer_load_dwordx4 v243, s[28:31], s97 offen offset:3072  lds
    v_mul_u32_u24 v6, 4160, v6
    v_and_b32 v7, 7, v0
    v_lshl_add_u32 v6, v7, 2, v6
    v_add_u32 v6, s94, v6
    s_add_u32 m0, s88, 0
    s_mov_b64 exec, 0xffffffff
    buffer_load_dwordx4 v3, s[28:31], s97 offen offset:0  lds
    s_mov_b64 exec, -1
    v_mov_b32 v7, 0
    s_waitcnt lgkmcnt(0)
    v_readfirstlane_b32 s93, v140
    s_mul_i32 s16, s97, 3072
    s_add_u32 m0, s60, 0
    s_add_u32 s99, s16, s62
    buffer_load_dwordx4 v244, s[32:35], s99 offen offset:0  lds
    s_lshl_b32 s93, s93, 16
    v_writelane_b32 v7, s93, 15
    v_alignbit_b32 v140, v141, v140, 16
    buffer_load_dwordx4 v245, s[32:35], s99 offen offset:1024  lds
    v_alignbit_b32 v141, v142, v141, 16
    v_alignbit_b32 v142, v143, v142, 16
    v_alignbit_b32 v143, v156, v143, 16
    v_alignbit_b32 v144, v145, v144, 16
    buffer_load_dwordx4 v246, s[32:35], s99 offen offset:2048  lds
    v_alignbit_b32 v145, v146, v145, 16
    v_alignbit_b32 v146, v147, v146, 16
    v_alignbit_b32 v147, v157, v147, 16
    s_add_u32 m0, s61, 12288
    s_add_u32 s16, s16, s63
    buffer_load_dwordx4 v244, s[32:35], s16 offen offset:0  lds
    v_alignbit_b32 v148, v149, v148, 16
    v_alignbit_b32 v149, v150, v149, 16
    v_alignbit_b32 v150, v151, v150, 16
    buffer_load_dwordx4 v245, s[32:35], s16 offen offset:1024  lds
    v_alignbit_b32 v151, v158, v151, 16
    v_alignbit_b32 v152, v153, v152, 16
    v_alignbit_b32 v153, v154, v153, 16
    v_alignbit_b32 v154, v155, v154, 16
    buffer_load_dwordx4 v246, s[32:35], s16 offen offset:2048  lds
    v_alignbit_b32 v155, v159, v155, 16
    v_lshlrev_b32 v8, 3, v0
    s_add_u32 s78, s88, 18432
    s_mov_b64 exec, 0xff
    buffer_load_dword v136, v33, s[68:71], 0 offen sc1
    buffer_load_dword v137, v34, s[52:55], 0 offen sc1
    s_mov_b64 exec, -1
    v_add_u32 v8, s78, v8
    v_mov_b32 v156, 0
    v_mov_b32 v157, 0
    s_waitcnt vmcnt(13)
    s_barrier
    s_waitcnt vmcnt(0)
LA_j:
    s_mov_b64 exec, 1
    ds_add_u32 v18, v19 offset:24
    s_mov_b64 exec, -1
    s_mov_b64 exec, 0xff
    v_cmp_ne_u32 vcc, v136, v137
    v_cmp_gt_u32 s[80:81], s96, v136
    s_nop 0
    s_or_b64 vcc, vcc, s[80:81]
    s_cbranch_vccnz LA_slow
LA_back:
    s_mov_b64 exec, -1
    s_add_u32 m0, s86, 94208
    s_add_u32 s89, s91, 0
    buffer_load_dwordx4 v14, s[52:55], s89 offen sc1 lds
    s_add_u32 m0, s86, 98304
    s_add_u32 s89, s91, 4096
    buffer_load_dwordx4 v14, s[52:55], s89 offen sc1 lds
    s_add_u32 m0, s86, 102400
    s_add_u32 s89, s91, 8192
    buffer_load_dwordx4 v14, s[52:55], s89 offen sc1 lds
    s_add_u32 m0, s86, 106496
    s_add_u32 s89, s91, 12288
    buffer_load_dwordx4 v14, s[52:55], s89 offen sc1 lds
    s_mov_b64 exec, 0xffff
    ds_write_b32 v6, v7
    s_mov_b64 exec, -1
    ds_write_b128 v5, v[140:143] offset:4192
    ds_write_b128 v5, v[144:147] offset:5216
    ds_write_b128 v5, v[148:151] offset:6240
    ds_write_b128 v5, v[152:155] offset:7264
    ds_write_b64 v8, v[156:157]
    ds_read2_b32 v[68:69], v21 offset0:0 offset1:1
    ds_read2_b32 v[70:71], v21 offset0:2 offset1:3
    ds_read2_b32 v[72:73], v21 offset0:128 offset1:129
    ds_read2_b32 v[74:75], v21 offset0:130 offset1:131
    ds_read2_b32 v[76:77], v22 offset0:0 offset1:1
    ds_read2_b32 v[78:79], v22 offset0:2 offset1:3
    ds_read2_b32 v[80:81], v22 offset0:128 offset1:129
    ds_read2_b32 v[82:83], v22 offset0:130 offset1:131
    ds_read2_b32 v[84:85], v23 offset0:0 offset1:1
    ds_read2_b32 v[86:87], v23 offset0:2 offset1:3
    ds_read2_b32 v[88:89], v23 offset0:128 offset1:129
    ds_read2_b32 v[90:91], v23 offset0:130 offset1:131
    ds_read2_b32 v[92:93], v24 offset0:0 offset1:1
    ds_read2_b32 v[94:95], v24 offset0:2 offset1:3
    ds_read2_b32 v[96:97], v24 offset0:128 offset1:129
    ds_read2_b32 v[98:99], v24 offset0:130 offset1:131
    s_waitcnt vmcnt(0)
    s_mov_b64 exec, 1
    ds_add_u32 v18, v19 offset:20
    s_mov_b64 exec, -1
    buffer_load_dwordx4 v[212:215], v9, s[56:59], 0 offen offset:0 nt
    buffer_load_dwordx4 v[216:219], v9, s[56:59], 0 offen offset:2048 nt
    buffer_load_dwordx4 v[220:223], v9, s[56:59], s96 offen offset:0 nt
    buffer_load_dwordx4 v[224:227], v9, s[56:59], s96 offen offset:2048 nt
    s_branch LA_s5_in
LA_s5:
    s_sleep 1
LA_s5_in:
    ds_read_b32 v6, v18 offset:20
    s_waitcnt lgkmcnt(0)
    v_readfirstlane_b32 s78, v6
    s_nop 0
    s_cmp_ge_u32 s78, 4
    s_cbranch_scc0 LA_s5
    s_mov_b64 exec, 1
    ds_add_u32 v18, v19 offset:8
    s_mov_b64 exec, -1
    ds_read_b128 v[100:103], v25 offset:0
    ds_read_b128 v[104:107], v25 offset:2048
    ds_read_b128 v[108:111], v25 offset:4096
    ds_read_b128 v[112:115], v25 offset:6144
    ds_read_b128 v[116:119], v25 offset:8192
    ds_read_b128 v[120:123], v25 offset:10240
    ds_read_b128 v[124:127], v25 offset:12288
    ds_read_b128 v[128:131], v25 offset:14336
    s_setprio 2
    s_waitcnt lgkmcnt(7)
    v_mfma_f32_16x16x32_bf16 v[36:39], v[236:239], v[100:103], 0
    ds_read2_b32 v[132:133], v21 offset0:16 offset1:17
    s_waitcnt lgkmcnt(7)
    v_mfma_f32_16x16x32_bf16 v[40:43], v[236:239], v[104:107], 0
    ds_read2_b32 v[134:135], v21 offset0:18 offset1:19
    s_waitcnt lgkmcnt(7)
    v_mfma_f32_16x16x32_bf16 v[44:47], v[236:239], v[108:111], 0
    s_waitcnt lgkmcnt(6)
    v_mfma_f32_16x16x32_bf16 v[48:51], v[236:239], v[112:115], 0
    ds_read_b128 v[164:167], v26 offset:0
    s_waitcnt lgkmcnt(6)
    v_mfma_f32_16x16x32_bf16 v[52:55], v[236:239], v[116:119], 0
    s_waitcnt lgkmcnt(5)
    v_mfma_f32_16x16x32_bf16 v[56:59], v[236:239], v[120:123], 0
    ds_read_b128 v[168:171], v26 offset:2048
    s_waitcnt lgkmcnt(5)
    v_mfma_f32_16x16x32_bf16 v[60:63], v[236:239], v[124:127], 0
    ds_read_b128 v[172:175], v26 offset:4096
    s_waitcnt lgkmcnt(5)
    v_mfma_f32_16x16x32_bf16 v[64:67], v[236:239], v[128:131], 0
    v_mfma_f32_16x16x32_bf16 v[36:39], v[68:71], v[100:103], v[36:39]
    ds_read_b128 v[176:179], v26 offset:6144
    v_mfma_f32_16x16x32_bf16 v[40:43], v[68:71], v[104:107], v[40:43]
    v_mfma_f32_16x16x32_bf16 v[44:47], v[68:71], v[108:111], v[44:47]
    ds_read_b128 v[180:183], v26 offset:8192
    v_mfma_f32_16x16x32_bf16 v[48:51], v[68:71], v[112:115], v[48:51]
    ds_read_b128 v[184:187], v26 offset:10240
    v_mfma_f32_16x16x32_bf16 v[52:55], v[68:71], v[116:119], v[52:55]
    v_mfma_f32_16x16x32_bf16 v[56:59], v[68:71], v[120:123], v[56:59]
    ds_read_b128 v[188:191], v26 offset:12288
    v_mfma_f32_16x16x32_bf16 v[60:63], v[68:71], v[124:127], v[60:63]
    v_mfma_f32_16x16x32_bf16 v[64:67], v[68:71], v[128:131], v[64:67]
    ds_read_b128 v[192:195], v26 offset:14336
    v_mfma_f32_16x16x32_bf16 v[40:43], v[72:75], v[100:103], v[40:43]
    ds_read2_b32 v[136:137], v21 offset0:144 offset1:145
    v_mfma_f32_16x16x32_bf16 v[44:47], v[72:75], v[104:107], v[44:47]
    v_mfma_f32_16x16x32_bf16 v[48:51], v[72:75], v[108:111], v[48:51]
    ds_read2_b32 v[138:139], v21 offset0:146 offset1:147
    v_mfma_f32_16x16x32_bf16 v[52:55], v[72:75], v[112:115], v[52:55]
    v_mfma_f32_16x16x32_bf16 v[56:59], v[72:75], v[116:119], v[56:59]
    ds_read2_b32 v[140:141], v22 offset0:16 offset1:17
    v_mfma_f32_16x16x32_bf16 v[60:63], v[72:75], v[120:123], v[60:63]
    ds_read2_b32 v[142:143], v22 offset0:18 offset1:19
    v_mfma_f32_16x16x32_bf16 v[64:67], v[72:75], v[124:127], v[64:67]
    v_mfma_f32_16x16x32_bf16 v[44:47], v[76:79], v[100:103], v[44:47]
    ds_read2_b32 v[144:145], v22 offset0:144 offset1:145
    v_mfma_f32_16x16x32_bf16 v[48:51], v[76:79], v[104:107], v[48:51]
    v_mfma_f32_16x16x32_bf16 v[52:55], v[76:79], v[108:111], v[52:55]
    ds_read2_b32 v[146:147], v22 offset0:146 offset1:147
    v_mfma_f32_16x16x32_bf16 v[56:59], v[76:79], v[112:115], v[56:59]
    ds_read2_b32 v[148:149], v23 offset0:16 offset1:17
    v_mfma_f32_16x16x32_bf16 v[60:63], v[76:79], v[116:119], v[60:63]
    v_mfma_f32_16x16x32_bf16 v[64:67], v[76:79], v[120:123], v[64:67]
    ds_read2_b32 v[150:151], v23 offset0:18 offset1:19
    v_mfma_f32_16x16x32_bf16 v[48:51], v[80:83], v[100:103], v[48:51]
    v_mfma_f32_16x16x32_bf16 v[52:55], v[80:83], v[104:107], v[52:55]
    ds_read2_b32 v[152:153], v23 offset0:144 offset1:145
    v_mfma_f32_16x16x32_bf16 v[56:59], v[80:83], v[108:111], v[56:59]
    ds_read2_b32 v[154:155], v23 offset0:146 offset1:147
    v_mfma_f32_16x16x32_bf16 v[60:63], v[80:83], v[112:115], v[60:63]
    v_mfma_f32_16x16x32_bf16 v[64:67], v[80:83], v[116:119], v[64:67]
    ds_read2_b32 v[156:157], v24 offset0:16 offset1:17
    v_mfma_f32_16x16x32_bf16 v[52:55], v[84:87], v[100:103], v[52:55]
    v_mfma_f32_16x16x32_bf16 v[56:59], v[84:87], v[104:107], v[56:59]
    ds_read2_b32 v[158:159], v24 offset0:18 offset1:19
    v_mfma_f32_16x16x32_bf16 v[60:63], v[84:87], v[108:111], v[60:63]
    ds_read2_b32 v[160:161], v24 offset0:144 offset1:145
    v_mfma_f32_16x16x32_bf16 v[64:67], v[84:87], v[112:115], v[64:67]
    v_mfma_f32_16x16x32_bf16 v[56:59], v[88:91], v[100:103], v[56:59]
    ds_read2_b32 v[162:163], v24 offset0:146 offset1:147
    v_mfma_f32_16x16x32_bf16 v[60:63], v[88:91], v[104:107], v[60:63]
    v_mfma_f32_16x16x32_bf16 v[64:67], v[88:91], v[108:111], v[64:67]
    v_mfma_f32_16x16x32_bf16 v[60:63], v[92:95], v[100:103], v[60:63]
    v_mfma_f32_16x16x32_bf16 v[64:67], v[92:95], v[104:107], v[64:67]
    v_mfma_f32_16x16x32_bf16 v[64:67], v[96:99], v[100:103], v[64:67]
    s_waitcnt lgkmcnt(14)
    v_mfma_f32_16x16x32_bf16 v[36:39], v[132:135], v[164:167], v[36:39]
    ds_read2_b32 v[68:69], v21 offset0:32 offset1:33
    v_mfma_f32_16x16x32_bf16 v[40:43], v[132:135], v[168:171], v[40:43]
    ds_read2_b32 v[70:71], v21 offset0:34 offset1:35
    v_mfma_f32_16x16x32_bf16 v[44:47], v[132:135], v[172:175], v[44:47]
    ds_read_b128 v[100:103], v27 offset:0
    v_mfma_f32_16x16x32_bf16 v[48:51], v[132:135], v[176:179], v[48:51]
    v_mfma_f32_16x16x32_bf16 v[52:55], v[132:135], v[180:183], v[52:55]
    ds_read_b128 v[104:107], v27 offset:2048
    v_mfma_f32_16x16x32_bf16 v[56:59], v[132:135], v[184:187], v[56:59]
    ds_read_b128 v[108:111], v27 offset:4096
    v_mfma_f32_16x16x32_bf16 v[60:63], v[132:135], v[188:191], v[60:63]
    ds_read_b128 v[112:115], v27 offset:6144
    v_mfma_f32_16x16x32_bf16 v[64:67], v[132:135], v[192:195], v[64:67]
    s_waitcnt lgkmcnt(14)
    v_mfma_f32_16x16x32_bf16 v[40:43], v[136:139], v[164:167], v[40:43]
    ds_read_b128 v[116:119], v27 offset:8192
    v_mfma_f32_16x16x32_bf16 v[44:47], v[136:139], v[168:171], v[44:47]
    ds_read_b128 v[120:123], v27 offset:10240
    v_mfma_f32_16x16x32_bf16 v[48:51], v[136:139], v[172:175], v[48:51]
    ds_read_b128 v[124:127], v27 offset:12288
    v_mfma_f32_16x16x32_bf16 v[52:55], v[136:139], v[176:179], v[52:55]
    v_mfma_f32_16x16x32_bf16 v[56:59], v[136:139], v[180:183], v[56:59]
    ds_read_b128 v[128:131], v27 offset:14336
    v_mfma_f32_16x16x32_bf16 v[60:63], v[136:139], v[184:187], v[60:63]
    ds_read2_b32 v[72:73], v21 offset0:160 offset1:161
    v_mfma_f32_16x16x32_bf16 v[64:67], v[136:139], v[188:191], v[64:67]
    ds_read2_b32 v[74:75], v21 offset0:162 offset1:163
    v_mfma_f32_16x16x32_bf16 v[44:47], v[140:143], v[164:167], v[44:47]
    v_mfma_f32_16x16x32_bf16 v[48:51], v[140:143], v[168:171], v[48:51]
    ds_read2_b32 v[76:77], v22 offset0:32 offset1:33
    v_mfma_f32_16x16x32_bf16 v[52:55], v[140:143], v[172:175], v[52:55]
    ds_read2_b32 v[78:79], v22 offset0:34 offset1:35
    v_mfma_f32_16x16x32_bf16 v[56:59], v[140:143], v[176:179], v[56:59]
    ds_read2_b32 v[80:81], v22 offset0:160 offset1:161
    v_mfma_f32_16x16x32_bf16 v[60:63], v[140:143], v[180:183], v[60:63]
    v_mfma_f32_16x16x32_bf16 v[64:67], v[140:143], v[184:187], v[64:67]
    ds_read2_b32 v[82:83], v22 offset0:162 offset1:163
    v_mfma_f32_16x16x32_bf16 v[48:51], v[144:147], v[164:167], v[48:51]
    ds_read2_b32 v[84:85], v23 offset0:32 offset1:33
    v_mfma_f32_16x16x32_bf16 v[52:55], v[144:147], v[168:171], v[52:55]
    ds_read2_b32 v[86:87], v23 offset0:34 offset1:35
    v_mfma_f32_16x16x32_bf16 v[56:59], v[144:147], v[172:175], v[56:59]
    v_mfma_f32_16x16x32_bf16 v[60:63], v[144:147], v[176:179], v[60:63]
    ds_read2_b32 v[88:89], v23 offset0:160 offset1:161
    v_mfma_f32_16x16x32_bf16 v[64:67], v[144:147], v[180:183], v[64:67]
    ds_read2_b32 v[90:91], v23 offset0:162 offset1:163
    s_waitcnt lgkmcnt(14)
    v_mfma_f32_16x16x32_bf16 v[52:55], v[148:151], v[164:167], v[52:55]
    ds_read2_b32 v[92:93], v24 offset0:32 offset1:33
    v_mfma_f32_16x16x32_bf16 v[56:59], v[148:151], v[168:171], v[56:59]
    v_mfma_f32_16x16x32_bf16 v[60:63], v[148:151], v[172:175], v[60:63]
    ds_read2_b32 v[94:95], v24 offset0:34 offset1:35
    v_mfma_f32_16x16x32_bf16 v[64:67], v[148:151], v[176:179], v[64:67]
    ds_read2_b32 v[96:97], v24 offset0:160 offset1:161
    v_mfma_f32_16x16x32_bf16 v[56:59], v[152:155], v[164:167], v[56:59]
    ds_read2_b32 v[98:99], v24 offset0:162 offset1:163
    v_mfma_f32_16x16x32_bf16 v[60:63], v[152:155], v[168:171], v[60:63]
    v_mfma_f32_16x16x32_bf16 v[64:67], v[152:155], v[172:175], v[64:67]
    v_mfma_f32_16x16x32_bf16 v[60:63], v[156:159], v[164:167], v[60:63]
    v_mfma_f32_16x16x32_bf16 v[64:67], v[156:159], v[168:171], v[64:67]
    v_mfma_f32_16x16x32_bf16 v[64:67], v[160:163], v[164:167], v[64:67]
    v_mfma_f32_16x16x32_bf16 v[36:39], v[68:71], v[100:103], v[36:39]
    ds_read2_b32 v[132:133], v21 offset0:48 offset1:49
    v_mfma_f32_16x16x32_bf16 v[40:43], v[68:71], v[104:107], v[40:43]
    ds_read2_b32 v[134:135], v21 offset0:50 offset1:51
    v_mfma_f32_16x16x32_bf16 v[44:47], v[68:71], v[108:111], v[44:47]
    ds_read_b128 v[164:167], v28 offset:0
    v_mfma_f32_16x16x32_bf16 v[48:51], v[68:71], v[112:115], v[48:51]
    s_waitcnt lgkmcnt(14)
    v_mfma_f32_16x16x32_bf16 v[52:55], v[68:71], v[116:119], v[52:55]
    ds_read_b128 v[168:171], v28 offset:2048
    v_mfma_f32_16x16x32_bf16 v[56:59], v[68:71], v[120:123], v[56:59]
    ds_read_b128 v[172:175], v28 offset:4096
    v_mfma_f32_16x16x32_bf16 v[60:63], v[68:71], v[124:127], v[60:63]
    ds_read_b128 v[176:179], v28 offset:6144
    v_mfma_f32_16x16x32_bf16 v[64:67], v[68:71], v[128:131], v[64:67]
    v_mfma_f32_16x16x32_bf16 v[40:43], v[72:75], v[100:103], v[40:43]
    ds_read_b128 v[180:183], v28 offset:8192
    v_mfma_f32_16x16x32_bf16 v[44:47], v[72:75], v[104:107], v[44:47]
    ds_read_b128 v[184:187], v28 offset:10240
    v_mfma_f32_16x16x32_bf16 v[48:51], v[72:75], v[108:111], v[48:51]
    ds_read_b128 v[188:191], v28 offset:12288
    v_mfma_f32_16x16x32_bf16 v[52:55], v[72:75], v[112:115], v[52:55]
    v_mfma_f32_16x16x32_bf16 v[56:59], v[72:75], v[116:119], v[56:59]
    ds_read_b128 v[192:195], v28 offset:14336
    v_mfma_f32_16x16x32_bf16 v[60:63], v[72:75], v[120:123], v[60:63]
    ds_read2_b32 v[136:137], v21 offset0:176 offset1:177
    v_mfma_f32_16x16x32_bf16 v[64:67], v[72:75], v[124:127], v[64:67]
    ds_read2_b32 v[138:139], v21 offset0:178 offset1:179
    s_waitcnt lgkmcnt(14)
    v_mfma_f32_16x16x32_bf16 v[44:47], v[76:79], v[100:103], v[44:47]
    v_mfma_f32_16x16x32_bf16 v[48:51], v[76:79], v[104:107], v[48:51]
    ds_read2_b32 v[140:141], v22 offset0:48 offset1:49
    v_mfma_f32_16x16x32_bf16 v[52:55], v[76:79], v[108:111], v[52:55]
    ds_read2_b32 v[142:143], v22 offset0:50 offset1:51
    v_mfma_f32_16x16x32_bf16 v[56:59], v[76:79], v[112:115], v[56:59]
    ds_read2_b32 v[144:145], v22 offset0:176 offset1:177
    v_mfma_f32_16x16x32_bf16 v[60:63], v[76:79], v[116:119], v[60:63]
    v_mfma_f32_16x16x32_bf16 v[64:67], v[76:79], v[120:123], v[64:67]
    ds_read2_b32 v[146:147], v22 offset0:178 offset1:179
    v_mfma_f32_16x16x32_bf16 v[48:51], v[80:83], v[100:103], v[48:51]
    ds_read2_b32 v[148:149], v23 offset0:48 offset1:49
    v_mfma_f32_16x16x32_bf16 v[52:55], v[80:83], v[104:107], v[52:55]
    ds_read2_b32 v[150:151], v23 offset0:50 offset1:51
    v_mfma_f32_16x16x32_bf16 v[56:59], v[80:83], v[108:111], v[56:59]
    v_mfma_f32_16x16x32_bf16 v[60:63], v[80:83], v[112:115], v[60:63]
    ds_read2_b32 v[152:153], v23 offset0:176 offset1:177
    v_mfma_f32_16x16x32_bf16 v[64:67], v[80:83], v[116:119], v[64:67]
    ds_read2_b32 v[154:155], v23 offset0:178 offset1:179
    v_mfma_f32_16x16x32_bf16 v[52:55], v[84:87], v[100:103], v[52:55]
    ds_read2_b32 v[156:157], v24 offset0:48 offset1:49
    v_mfma_f32_16x16x32_bf16 v[56:59], v[84:87], v[104:107], v[56:59]
    v_mfma_f32_16x16x32_bf16 v[60:63], v[84:87], v[108:111], v[60:63]
    ds_read2_b32 v[158:159], v24 offset0:50 offset1:51
    v_mfma_f32_16x16x32_bf16 v[64:67], v[84:87], v[112:115], v[64:67]
    ds_read2_b32 v[160:161], v24 offset0:176 offset1:177
    v_mfma_f32_16x16x32_bf16 v[56:59], v[88:91], v[100:103], v[56:59]
    ds_read2_b32 v[162:163], v24 offset0:178 offset1:179
    v_mfma_f32_16x16x32_bf16 v[60:63], v[88:91], v[104:107], v[60:63]
    v_mfma_f32_16x16x32_bf16 v[64:67], v[88:91], v[108:111], v[64:67]
    v_mfma_f32_16x16x32_bf16 v[60:63], v[92:95], v[100:103], v[60:63]
    v_mfma_f32_16x16x32_bf16 v[64:67], v[92:95], v[104:107], v[64:67]
    s_waitcnt lgkmcnt(14)
    v_mfma_f32_16x16x32_bf16 v[64:67], v[96:99], v[100:103], v[64:67]
    v_mfma_f32_16x16x32_bf16 v[36:39], v[132:135], v[164:167], v[36:39]
    ds_read2_b32 v[68:69], v21 offset0:64 offset1:65
    s_and_b32 s78, s77, 7
    v_mfma_f32_16x16x32_bf16 v[40:43], v[132:135], v[168:171], v[40:43]
    ds_read2_b32 v[70:71], v21 offset0:66 offset1:67
    s_mov_b32 s97, 0x76543210
    v_mfma_f32_16x16x32_bf16 v[44:47], v[132:135], v[172:175], v[44:47]
    ds_read_b128 v[100:103], v29 offset:0
    v_mfma_f32_16x16x32_bf16 v[48:51], v[132:135], v[176:179], v[48:51]
    s_cmp_eq_u32 s78, 1
    v_mfma_f32_16x16x32_bf16 v[52:55], v[132:135], v[180:183], v[52:55]
    ds_read_b128 v[104:107], v29 offset:2048
    s_cselect_b32 s97, 0x76543201, s97
    v_mfma_f32_16x16x32_bf16 v[56:59], v[132:135], v[184:187], v[56:59]
    ds_read_b128 v[108:111], v29 offset:4096
    v_mfma_f32_16x16x32_bf16 v[60:63], v[132:135], v[188:191], v[60:63]
    ds_read_b128 v[112:115], v29 offset:6144
    s_cmp_eq_u32 s78, 2
    v_mfma_f32_16x16x32_bf16 v[64:67], v[132:135], v[192:195], v[64:67]
    s_cselect_b32 s97, 0x76543120, s97
    s_waitcnt lgkmcnt(14)
    v_mfma_f32_16x16x32_bf16 v[40:43], v[136:139], v[164:167], v[40:43]
    ds_read_b128 v[116:119], v29 offset:8192
    v_mfma_f32_16x16x32_bf16 v[44:47], v[136:139], v[168:171], v[44:47]
    ds_read_b128 v[120:123], v29 offset:10240
    s_cmp_eq_u32 s78, 3
    v_mfma_f32_16x16x32_bf16 v[48:51], v[136:139], v[172:175], v[48:51]
    ds_read_b128 v[124:127], v29 offset:12288
    s_cselect_b32 s97, 0x76542310, s97
    v_mfma_f32_16x16x32_bf16 v[52:55], v[136:139], v[176:179], v[52:55]
    v_mfma_f32_16x16x32_bf16 v[56:59], v[136:139], v[180:183], v[56:59]
    ds_read_b128 v[128:131], v29 offset:14336
    s_cmp_eq_u32 s78, 4
    v_mfma_f32_16x16x32_bf16 v[60:63], v[136:139], v[184:187], v[60:63]
    ds_read2_b32 v[72:73], v21 offset0:192 offset1:193
    v_mfma_f32_16x16x32_bf16 v[64:67], v[136:139], v[188:191], v[64:67]
    ds_read2_b32 v[74:75], v21 offset0:194 offset1:195
    s_cselect_b32 s97, 0x76534210, s97
    v_mfma_f32_16x16x32_bf16 v[44:47], v[140:143], v[164:167], v[44:47]
    s_cmp_eq_u32 s78, 5
    v_mfma_f32_16x16x32_bf16 v[48:51], v[140:143], v[168:171], v[48:51]
    ds_read2_b32 v[76:77], v22 offset0:64 offset1:65
    v_mfma_f32_16x16x32_bf16 v[52:55], v[140:143], v[172:175], v[52:55]
    ds_read2_b32 v[78:79], v22 offset0:66 offset1:67
    s_cselect_b32 s97, 0x76453210, s97
    v_mfma_f32_16x16x32_bf16 v[56:59], v[140:143], v[176:179], v[56:59]
    ds_read2_b32 v[80:81], v22 offset0:192 offset1:193
    s_cmp_eq_u32 s78, 6
    v_mfma_f32_16x16x32_bf16 v[60:63], v[140:143], v[180:183], v[60:63]
    v_mfma_f32_16x16x32_bf16 v[64:67], v[140:143], v[184:187], v[64:67]
    ds_read2_b32 v[82:83], v22 offset0:194 offset1:195
    s_cselect_b32 s97, 0x75643210, s97
    v_mfma_f32_16x16x32_bf16 v[48:51], v[144:147], v[164:167], v[48:51]
    ds_read2_b32 v[84:85], v23 offset0:64 offset1:65
    s_cmp_eq_u32 s78, 7
    v_mfma_f32_16x16x32_bf16 v[52:55], v[144:147], v[168:171], v[52:55]
    ds_read2_b32 v[86:87], v23 offset0:66 offset1:67
    v_mfma_f32_16x16x32_bf16 v[56:59], v[144:147], v[172:175], v[56:59]
    s_cselect_b32 s97, 0x67543210, s97
    v_mfma_f32_16x16x32_bf16 v[60:63], v[144:147], v[176:179], v[60:63]
    ds_read2_b32 v[88:89], v23 offset0:192 offset1:193
    v_mfma_f32_16x16x32_bf16 v[64:67], v[144:147], v[180:183], v[64:67]
    ds_read2_b32 v[90:91], v23 offset0:194 offset1:195
    s_and_b32 s78, s76, 3
    s_waitcnt lgkmcnt(14)
    v_mfma_f32_16x16x32_bf16 v[52:55], v[148:151], v[164:167], v[52:55]
    ds_read2_b32 v[92:93], v24 offset0:64 offset1:65
    s_mul_i32 s78, s78, 0x22222222
    v_mfma_f32_16x16x32_bf16 v[56:59], v[148:151], v[168:171], v[56:59]
    v_mfma_f32_16x16x32_bf16 v[60:63], v[148:151], v[172:175], v[60:63]
    ds_read2_b32 v[94:95], v24 offset0:66 offset1:67
    s_add_u32 s97, s97, s78
    v_mfma_f32_16x16x32_bf16 v[64:67], v[148:151], v[176:179], v[64:67]
    ds_read2_b32 v[96:97], v24 offset0:192 offset1:193
    s_bfe_u32 s99, s97, 0x3001c
    v_mfma_f32_16x16x32_bf16 v[56:59], v[152:155], v[164:167], v[56:59]
    ds_read2_b32 v[98:99], v24 offset0:194 offset1:195
    v_mfma_f32_16x16x32_bf16 v[60:63], v[152:155], v[168:171], v[60:63]
    s_lshl_b32 s99, s99, 18
    v_mfma_f32_16x16x32_bf16 v[64:67], v[152:155], v[172:175], v[64:67]
    s_bfe_u32 s97, s97, 0x30018
    v_mfma_f32_16x16x32_bf16 v[60:63], v[156:159], v[164:167], v[60:63]
    v_mfma_f32_16x16x32_bf16 v[64:67], v[156:159], v[168:171], v[64:67]
    s_lshl_b32 s97, s97, 18
    v_mfma_f32_16x16x32_bf16 v[64:67], v[160:163], v[164:167], v[64:67]
    v_mfma_f32_16x16x32_bf16 v[36:39], v[68:71], v[100:103], v[36:39]
    ds_read2_b32 v[132:133], v21 offset0:80 offset1:81
    v_lshrrev_b32 v5, 4, v0
    v_mfma_f32_16x16x32_bf16 v[40:43], v[68:71], v[104:107], v[40:43]
    ds_read2_b32 v[134:135], v21 offset0:82 offset1:83
    v_mfma_f32_16x16x32_bf16 v[44:47], v[68:71], v[108:111], v[44:47]
    ds_read_b128 v[164:167], v30 offset:0
    v_mfma_f32_16x16x32_bf16 v[48:51], v[68:71], v[112:115], v[48:51]
    v_lshlrev_b32 v5, 1, v5
    s_waitcnt lgkmcnt(14)
    v_mfma_f32_16x16x32_bf16 v[52:55], v[68:71], v[116:119], v[52:55]
    ds_read_b128 v[168:171], v30 offset:2048
    v_mfma_f32_16x16x32_bf16 v[56:59], v[68:71], v[120:123], v[56:59]
    ds_read_b128 v[172:175], v30 offset:4096
    v_mfma_f32_16x16x32_bf16 v[60:63], v[68:71], v[124:127], v[60:63]
    ds_read_b128 v[176:179], v30 offset:6144
    v_and_b32 v8, 7, v0
    v_mfma_f32_16x16x32_bf16 v[64:67], v[68:71], v[128:131], v[64:67]
    v_mfma_f32_16x16x32_bf16 v[40:43], v[72:75], v[100:103], v[40:43]
    ds_read_b128 v[180:183], v30 offset:8192
    v_mfma_f32_16x16x32_bf16 v[44:47], v[72:75], v[104:107], v[44:47]
    ds_read_b128 v[184:187], v30 offset:10240
    v_xor_b32 v5, v5, v8
    v_mfma_f32_16x16x32_bf16 v[48:51], v[72:75], v[108:111], v[48:51]
    ds_read_b128 v[188:191], v30 offset:12288
    v_mfma_f32_16x16x32_bf16 v[52:55], v[72:75], v[112:115], v[52:55]
    v_mfma_f32_16x16x32_bf16 v[56:59], v[72:75], v[116:119], v[56:59]
    ds_read_b128 v[192:195], v30 offset:14336
    v_mfma_f32_16x16x32_bf16 v[60:63], v[72:75], v[120:123], v[60:63]
    ds_read2_b32 v[136:137], v21 offset0:208 offset1:209
    v_lshlrev_b32 v5, 4, v5
    v_mfma_f32_16x16x32_bf16 v[64:67], v[72:75], v[124:127], v[64:67]
    ds_read2_b32 v[138:139], v21 offset0:210 offset1:211
    s_waitcnt lgkmcnt(14)
    v_mfma_f32_16x16x32_bf16 v[44:47], v[76:79], v[100:103], v[44:47]
    v_mfma_f32_16x16x32_bf16 v[48:51], v[76:79], v[104:107], v[48:51]
    ds_read2_b32 v[140:141], v22 offset0:80 offset1:81
    v_lshrrev_b32 v8, 3, v0
    v_mfma_f32_16x16x32_bf16 v[52:55], v[76:79], v[108:111], v[52:55]
    ds_read2_b32 v[142:143], v22 offset0:82 offset1:83
    v_mfma_f32_16x16x32_bf16 v[56:59], v[76:79], v[112:115], v[56:59]
    ds_read2_b32 v[144:145], v22 offset0:208 offset1:209
    v_mfma_f32_16x16x32_bf16 v[60:63], v[76:79], v[116:119], v[60:63]
    v_lshl_add_u32 v5, v8, 11, v5
    v_mfma_f32_16x16x32_bf16 v[64:67], v[76:79], v[120:123], v[64:67]
    ds_read2_b32 v[146:147], v22 offset0:210 offset1:211
    v_mfma_f32_16x16x32_bf16 v[48:51], v[80:83], v[100:103], v[48:51]
    ds_read2_b32 v[148:149], v23 offset0:80 offset1:81
    v_mfma_f32_16x16x32_bf16 v[52:55], v[80:83], v[104:107], v[52:55]
    ds_read2_b32 v[150:151], v23 offset0:82 offset1:83
    s_lshl_b32 s78, s77, 7
    v_mfma_f32_16x16x32_bf16 v[56:59], v[80:83], v[108:111], v[56:59]
    v_mfma_f32_16x16x32_bf16 v[60:63], v[80:83], v[112:115], v[60:63]
    ds_read2_b32 v[152:153], v23 offset0:208 offset1:209
    v_mfma_f32_16x16x32_bf16 v[64:67], v[80:83], v[116:119], v[64:67]
    ds_read2_b32 v[154:155], v23 offset0:210 offset1:211
    v_mfma_f32_16x16x32_bf16 v[52:55], v[84:87], v[100:103], v[52:55]
    ds_read2_b32 v[156:157], v24 offset0:80 offset1:81
    s_lshl_b32 s79, s3, 14
    v_mfma_f32_16x16x32_bf16 v[56:59], v[84:87], v[104:107], v[56:59]
    v_mfma_f32_16x16x32_bf16 v[60:63], v[84:87], v[108:111], v[60:63]
    ds_read2_b32 v[158:159], v24 offset0:82 offset1:83
    v_mfma_f32_16x16x32_bf16 v[64:67], v[84:87], v[112:115], v[64:67]
    ds_read2_b32 v[160:161], v24 offset0:208 offset1:209
    s_add_u32 s78, s78, s79
    v_mfma_f32_16x16x32_bf16 v[56:59], v[88:91], v[100:103], v[56:59]
    ds_read2_b32 v[162:163], v24 offset0:210 offset1:211
    v_mfma_f32_16x16x32_bf16 v[60:63], v[88:91], v[104:107], v[60:63]
    v_mfma_f32_16x16x32_bf16 v[64:67], v[88:91], v[108:111], v[64:67]
    v_add_u32 v17, s78, v5
    v_mfma_f32_16x16x32_bf16 v[60:63], v[92:95], v[100:103], v[60:63]
    v_mfma_f32_16x16x32_bf16 v[64:67], v[92:95], v[104:107], v[64:67]
    s_waitcnt lgkmcnt(14)
    v_mfma_f32_16x16x32_bf16 v[64:67], v[96:99], v[100:103], v[64:67]
    v_mfma_f32_16x16x32_bf16 v[36:39], v[132:135], v[164:167], v[36:39]
    ds_read2_b32 v[68:69], v21 offset0:96 offset1:97
    s_waitcnt vmcnt(3)
    v_lshlrev_b32 v196, 16, v212
    v_mfma_f32_16x16x32_bf16 v[40:43], v[132:135], v[168:171], v[40:43]
    ds_read2_b32 v[70:71], v21 offset0:98 offset1:99
    v_mfma_f32_16x16x32_bf16 v[44:47], v[132:135], v[172:175], v[44:47]
    ds_read_b128 v[100:103], v31 offset:0
    v_and_b32 v197, 0xffff0000, v212
    v_mfma_f32_16x16x32_bf16 v[48:51], v[132:135], v[176:179], v[48:51]
    v_mfma_f32_16x16x32_bf16 v[52:55], v[132:135], v[180:183], v[52:55]
    ds_read_b128 v[104:107], v31 offset:2048
    v_lshlrev_b32 v198, 16, v213
    v_mfma_f32_16x16x32_bf16 v[56:59], v[132:135], v[184:187], v[56:59]
    ds_read_b128 v[108:111], v31 offset:4096
    v_mfma_f32_16x16x32_bf16 v[60:63], v[132:135], v[188:191], v[60:63]
    ds_read_b128 v[112:115], v31 offset:6144
    v_and_b32 v199, 0xffff0000, v213
    v_mfma_f32_16x16x32_bf16 v[64:67], v[132:135], v[192:195], v[64:67]
    s_waitcnt lgkmcnt(14)
    v_mfma_f32_16x16x32_bf16 v[40:43], v[136:139], v[164:167], v[40:43]
    ds_read_b128 v[116:119], v31 offset:8192
    v_mfma_f32_16x16x32_bf16 v[44:47], v[136:139], v[168:171], v[44:47]
    ds_read_b128 v[120:123], v31 offset:10240
    v_lshlrev_b32 v200, 16, v214
    v_mfma_f32_16x16x32_bf16 v[48:51], v[136:139], v[172:175], v[48:51]
    ds_read_b128 v[124:127], v31 offset:12288
    v_mfma_f32_16x16x32_bf16 v[52:55], v[136:139], v[176:179], v[52:55]
    v_and_b32 v201, 0xffff0000, v214
    v_mfma_f32_16x16x32_bf16 v[56:59], v[136:139], v[180:183], v[56:59]
    ds_read_b128 v[128:131], v31 offset:14336
    v_mfma_f32_16x16x32_bf16 v[60:63], v[136:139], v[184:187], v[60:63]
    ds_read2_b32 v[72:73], v21 offset0:224 offset1:225
    v_lshlrev_b32 v202, 16, v215
    v_mfma_f32_16x16x32_bf16 v[64:67], v[136:139], v[188:191], v[64:67]
    ds_read2_b32 v[74:75], v21 offset0:226 offset1:227
    v_mfma_f32_16x16x32_bf16 v[44:47], v[140:143], v[164:167], v[44:47]
    v_and_b32 v203, 0xffff0000, v215
    v_mfma_f32_16x16x32_bf16 v[48:51], v[140:143], v[168:171], v[48:51]
    ds_read2_b32 v[76:77], v22 offset0:96 offset1:97
    v_mfma_f32_16x16x32_bf16 v[52:55], v[140:143], v[172:175], v[52:55]
    ds_read2_b32 v[78:79], v22 offset0:98 offset1:99
    v_mfma_f32_16x16x32_bf16 v[56:59], v[140:143], v[176:179], v[56:59]
    ds_read2_b32 v[80:81], v22 offset0:224 offset1:225
    s_waitcnt vmcnt(2)
    v_lshlrev_b32 v204, 16, v216
    v_mfma_f32_16x16x32_bf16 v[60:63], v[140:143], v[180:183], v[60:63]
    v_mfma_f32_16x16x32_bf16 v[64:67], v[140:143], v[184:187], v[64:67]
    ds_read2_b32 v[82:83], v22 offset0:226 offset1:227
    v_and_b32 v205, 0xffff0000, v216
    v_mfma_f32_16x16x32_bf16 v[48:51], v[144:147], v[164:167], v[48:51]
    ds_read2_b32 v[84:85], v23 offset0:96 offset1:97
    v_mfma_f32_16x16x32_bf16 v[52:55], v[144:147], v[168:171], v[52:55]
    ds_read2_b32 v[86:87], v23 offset0:98 offset1:99
    v_lshlrev_b32 v206, 16, v217
    v_mfma_f32_16x16x32_bf16 v[56:59], v[144:147], v[172:175], v[56:59]
    v_mfma_f32_16x16x32_bf16 v[60:63], v[144:147], v[176:179], v[60:63]
    ds_read2_b32 v[88:89], v23 offset0:224 offset1:225
    v_and_b32 v207, 0xffff0000, v217
    v_mfma_f32_16x16x32_bf16 v[64:67], v[144:147], v[180:183], v[64:67]
    ds_read2_b32 v[90:91], v23 offset0:226 offset1:227
    s_waitcnt lgkmcnt(14)
    v_mfma_f32_16x16x32_bf16 v[52:55], v[148:151], v[164:167], v[52:55]
    ds_read2_b32 v[92:93], v24 offset0:96 offset1:97
    v_mfma_f32_16x16x32_bf16 v[56:59], v[148:151], v[168:171], v[56:59]
    v_lshlrev_b32 v208, 16, v218
    v_mfma_f32_16x16x32_bf16 v[60:63], v[148:151], v[172:175], v[60:63]
    ds_read2_b32 v[94:95], v24 offset0:98 offset1:99
    v_mfma_f32_16x16x32_bf16 v[64:67], v[148:151], v[176:179], v[64:67]
    ds_read2_b32 v[96:97], v24 offset0:224 offset1:225
    v_and_b32 v209, 0xffff0000, v218
    v_mfma_f32_16x16x32_bf16 v[56:59], v[152:155], v[164:167], v[56:59]
    ds_read2_b32 v[98:99], v24 offset0:226 offset1:227
    v_mfma_f32_16x16x32_bf16 v[60:63], v[152:155], v[168:171], v[60:63]
    v_lshlrev_b32 v210, 16, v219
    v_mfma_f32_16x16x32_bf16 v[64:67], v[152:155], v[172:175], v[64:67]
    v_mfma_f32_16x16x32_bf16 v[60:63], v[156:159], v[164:167], v[60:63]
    v_and_b32 v211, 0xffff0000, v219
    v_mfma_f32_16x16x32_bf16 v[64:67], v[156:159], v[168:171], v[64:67]
    v_mfma_f32_16x16x32_bf16 v[64:67], v[160:163], v[164:167], v[64:67]
    v_mfma_f32_16x16x32_bf16 v[36:39], v[68:71], v[100:103], v[36:39]
    ds_read2_b32 v[132:133], v21 offset0:112 offset1:113
    s_waitcnt vmcnt(1)
    v_lshlrev_b32 v240, 16, v220
    v_mfma_f32_16x16x32_bf16 v[40:43], v[68:71], v[104:107], v[40:43]
    ds_read2_b32 v[134:135], v21 offset0:114 offset1:115
    v_mfma_f32_16x16x32_bf16 v[44:47], v[68:71], v[108:111], v[44:47]
    ds_read_b128 v[164:167], v32 offset:0
    v_and_b32 v241, 0xffff0000, v220
    v_mfma_f32_16x16x32_bf16 v[48:51], v[68:71], v[112:115], v[48:51]
    s_waitcnt lgkmcnt(14)
    v_mfma_f32_16x16x32_bf16 v[52:55], v[68:71], v[116:119], v[52:55]
    ds_read_b128 v[168:171], v32 offset:2048
    v_lshlrev_b32 v242, 16, v221
    v_mfma_f32_16x16x32_bf16 v[56:59], v[68:71], v[120:123], v[56:59]
    ds_read_b128 v[172:175], v32 offset:4096
    v_mfma_f32_16x16x32_bf16 v[60:63], v[68:71], v[124:127], v[60:63]
    ds_read_b128 v[176:179], v32 offset:6144
    v_and_b32 v243, 0xffff0000, v221
    v_mfma_f32_16x16x32_bf16 v[64:67], v[68:71], v[128:131], v[64:67]
    v_mfma_f32_16x16x32_bf16 v[40:43], v[72:75], v[100:103], v[40:43]
    ds_read_b128 v[180:183], v32 offset:8192
    v_mfma_f32_16x16x32_bf16 v[44:47], v[72:75], v[104:107], v[44:47]
    ds_read_b128 v[184:187], v32 offset:10240
    v_lshlrev_b32 v244, 16, v222
    v_mfma_f32_16x16x32_bf16 v[48:51], v[72:75], v[108:111], v[48:51]
    ds_read_b128 v[188:191], v32 offset:12288
    v_mfma_f32_16x16x32_bf16 v[52:55], v[72:75], v[112:115], v[52:55]
    v_and_b32 v245, 0xffff0000, v222
    v_mfma_f32_16x16x32_bf16 v[56:59], v[72:75], v[116:119], v[56:59]
    ds_read_b128 v[192:195], v32 offset:14336
    v_mfma_f32_16x16x32_bf16 v[60:63], v[72:75], v[120:123], v[60:63]
    ds_read2_b32 v[136:137], v21 offset0:240 offset1:241
    v_lshlrev_b32 v246, 16, v223
    v_mfma_f32_16x16x32_bf16 v[64:67], v[72:75], v[124:127], v[64:67]
    ds_read2_b32 v[138:139], v21 offset0:242 offset1:243
    s_waitcnt lgkmcnt(14)
    v_mfma_f32_16x16x32_bf16 v[44:47], v[76:79], v[100:103], v[44:47]
    v_and_b32 v247, 0xffff0000, v223
    v_mfma_f32_16x16x32_bf16 v[48:51], v[76:79], v[104:107], v[48:51]
    ds_read2_b32 v[140:141], v22 offset0:112 offset1:113
    v_mfma_f32_16x16x32_bf16 v[52:55], v[76:79], v[108:111], v[52:55]
    ds_read2_b32 v[142:143], v22 offset0:114 offset1:115
    v_mfma_f32_16x16x32_bf16 v[56:59], v[76:79], v[112:115], v[56:59]
    ds_read2_b32 v[144:145], v22 offset0:240 offset1:241
    s_waitcnt vmcnt(0)
    v_lshlrev_b32 v248, 16, v224
    v_mfma_f32_16x16x32_bf16 v[60:63], v[76:79], v[116:119], v[60:63]
    v_mfma_f32_16x16x32_bf16 v[64:67], v[76:79], v[120:123], v[64:67]
    ds_read2_b32 v[146:147], v22 offset0:242 offset1:243
    v_and_b32 v249, 0xffff0000, v224
    v_mfma_f32_16x16x32_bf16 v[48:51], v[80:83], v[100:103], v[48:51]
    ds_read2_b32 v[148:149], v23 offset0:112 offset1:113
    v_mfma_f32_16x16x32_bf16 v[52:55], v[80:83], v[104:107], v[52:55]
    ds_read2_b32 v[150:151], v23 offset0:114 offset1:115
    v_lshlrev_b32 v250, 16, v225
    v_mfma_f32_16x16x32_bf16 v[56:59], v[80:83], v[108:111], v[56:59]
    v_mfma_f32_16x16x32_bf16 v[60:63], v[80:83], v[112:115], v[60:63]
    ds_read2_b32 v[152:153], v23 offset0:240 offset1:241
    v_and_b32 v251, 0xffff0000, v225
    v_mfma_f32_16x16x32_bf16 v[64:67], v[80:83], v[116:119], v[64:67]
    ds_read2_b32 v[154:155], v23 offset0:242 offset1:243
    v_mfma_f32_16x16x32_bf16 v[52:55], v[84:87], v[100:103], v[52:55]
    ds_read2_b32 v[156:157], v24 offset0:112 offset1:113
    v_mfma_f32_16x16x32_bf16 v[56:59], v[84:87], v[104:107], v[56:59]
    v_lshlrev_b32 v252, 16, v226
    v_mfma_f32_16x16x32_bf16 v[60:63], v[84:87], v[108:111], v[60:63]
    ds_read2_b32 v[158:159], v24 offset0:114 offset1:115
    v_mfma_f32_16x16x32_bf16 v[64:67], v[84:87], v[112:115], v[64:67]
    ds_read2_b32 v[160:161], v24 offset0:240 offset1:241
    v_and_b32 v253, 0xffff0000, v226
    v_mfma_f32_16x16x32_bf16 v[56:59], v[88:91], v[100:103], v[56:59]
    ds_read2_b32 v[162:163], v24 offset0:242 offset1:243
    v_mfma_f32_16x16x32_bf16 v[60:63], v[88:91], v[104:107], v[60:63]
    v_lshlrev_b32 v254, 16, v227
    v_mfma_f32_16x16x32_bf16 v[64:67], v[88:91], v[108:111], v[64:67]
    v_mfma_f32_16x16x32_bf16 v[60:63], v[92:95], v[100:103], v[60:63]
    v_and_b32 v255, 0xffff0000, v227
    v_mfma_f32_16x16x32_bf16 v[64:67], v[92:95], v[104:107], v[64:67]
    s_waitcnt lgkmcnt(14)
    v_mfma_f32_16x16x32_bf16 v[64:67], v[96:99], v[100:103], v[64:67]
    v_mfma_f32_16x16x32_bf16 v[36:39], v[132:135], v[164:167], v[36:39]
    v_mfma_f32_16x16x32_bf16 v[40:43], v[132:135], v[168:171], v[40:43]
    v_mfma_f32_16x16x32_bf16 v[44:47], v[132:135], v[172:175], v[44:47]
    v_mfma_f32_16x16x32_bf16 v[48:51], v[132:135], v[176:179], v[48:51]
    v_mfma_f32_16x16x32_bf16 v[52:55], v[132:135], v[180:183], v[52:55]
    v_mfma_f32_16x16x32_bf16 v[56:59], v[132:135], v[184:187], v[56:59]
    v_mfma_f32_16x16x32_bf16 v[60:63], v[132:135], v[188:191], v[60:63]
    v_mfma_f32_16x16x32_bf16 v[64:67], v[132:135], v[192:195], v[64:67]
    s_waitcnt lgkmcnt(12)
    v_mfma_f32_16x16x32_bf16 v[40:43], v[136:139], v[164:167], v[40:43]
    v_cvt_pk_bf16_f32 v68, v39, v38
    v_cvt_pk_bf16_f32 v69, v37, v36
    v_mfma_f32_16x16x32_bf16 v[44:47], v[136:139], v[168:171], v[44:47]
    ds_write_b64 v20, v[68:69] offset:0
    v_mfma_f32_16x16x32_bf16 v[48:51], v[136:139], v[172:175], v[48:51]
    v_mfma_f32_16x16x32_bf16 v[52:55], v[136:139], v[176:179], v[52:55]
    v_mfma_f32_16x16x32_bf16 v[56:59], v[136:139], v[180:183], v[56:59]
    v_mfma_f32_16x16x32_bf16 v[60:63], v[136:139], v[184:187], v[60:63]
    v_mfma_f32_16x16x32_bf16 v[64:67], v[136:139], v[188:191], v[64:67]
    s_waitcnt lgkmcnt(11)
    v_mfma_f32_16x16x32_bf16 v[44:47], v[140:143], v[164:167], v[44:47]
    v_mfma_f32_16x16x32_bf16 v[48:51], v[140:143], v[168:171], v[48:51]
    v_cvt_pk_bf16_f32 v70, v43, v42
    v_cvt_pk_bf16_f32 v71, v41, v40
    v_mfma_f32_16x16x32_bf16 v[52:55], v[140:143], v[172:175], v[52:55]
    ds_write_b64 v20, v[70:71] offset:2048
    v_mfma_f32_16x16x32_bf16 v[56:59], v[140:143], v[176:179], v[56:59]
    v_mfma_f32_16x16x32_bf16 v[60:63], v[140:143], v[180:183], v[60:63]
    v_mfma_f32_16x16x32_bf16 v[64:67], v[140:143], v[184:187], v[64:67]
    s_waitcnt lgkmcnt(10)
    v_mfma_f32_16x16x32_bf16 v[48:51], v[144:147], v[164:167], v[48:51]
    v_mfma_f32_16x16x32_bf16 v[52:55], v[144:147], v[168:171], v[52:55]
    v_mfma_f32_16x16x32_bf16 v[56:59], v[144:147], v[172:175], v[56:59]
    v_cvt_pk_bf16_f32 v72, v47, v46
    v_cvt_pk_bf16_f32 v73, v45, v44
    v_mfma_f32_16x16x32_bf16 v[60:63], v[144:147], v[176:179], v[60:63]
    ds_write_b64 v20, v[72:73] offset:4096
    v_mfma_f32_16x16x32_bf16 v[64:67], v[144:147], v[180:183], v[64:67]
    s_waitcnt lgkmcnt(9)
    v_mfma_f32_16x16x32_bf16 v[52:55], v[148:151], v[164:167], v[52:55]
    v_mfma_f32_16x16x32_bf16 v[56:59], v[148:151], v[168:171], v[56:59]
    v_mfma_f32_16x16x32_bf16 v[60:63], v[148:151], v[172:175], v[60:63]
    v_mfma_f32_16x16x32_bf16 v[64:67], v[148:151], v[176:179], v[64:67]
    v_cvt_pk_bf16_f32 v74, v51, v50
    v_cvt_pk_bf16_f32 v75, v49, v48
    s_waitcnt lgkmcnt(7)
    v_mfma_f32_16x16x32_bf16 v[56:59], v[152:155], v[164:167], v[56:59]
    ds_write_b64 v20, v[74:75] offset:6144
    v_mfma_f32_16x16x32_bf16 v[60:63], v[152:155], v[168:171], v[60:63]
    v_mfma_f32_16x16x32_bf16 v[64:67], v[152:155], v[172:175], v[64:67]
    s_waitcnt lgkmcnt(6)
    v_mfma_f32_16x16x32_bf16 v[60:63], v[156:159], v[164:167], v[60:63]
    v_mfma_f32_16x16x32_bf16 v[64:67], v[156:159], v[168:171], v[64:67]
    v_cvt_pk_bf16_f32 v76, v55, v54
    v_cvt_pk_bf16_f32 v77, v53, v52
    s_waitcnt lgkmcnt(4)
    v_mfma_f32_16x16x32_bf16 v[64:67], v[160:163], v[164:167], v[64:67]
    ds_write_b64 v20, v[76:77] offset:8192
    v_cvt_pk_bf16_f32 v78, v59, v58
    v_cvt_pk_bf16_f32 v79, v57, v56
    ds_write_b64 v20, v[78:79] offset:10240
    v_cvt_pk_bf16_f32 v80, v63, v62
    v_cvt_pk_bf16_f32 v81, v61, v60
    ds_write_b64 v20, v[80:81] offset:12288
    s_nop 0
    v_cvt_pk_bf16_f32 v82, v67, v66
    v_cvt_pk_bf16_f32 v83, v65, v64
    ds_write_b64 v20, v[82:83] offset:14336
    s_mov_b64 exec, 1
    ds_add_u32 v18, v19 offset:12
    s_mov_b64 exec, -1
    s_add_u32 s80, s86, 94208
    v_add_u32 v5, s80, v15
    s_branch LA_s3_in
LA_s3:
    s_sleep 1
LA_s3_in:
    ds_read_b32 v6, v18 offset:12
    ds_read_b128 v[84:87], v5 offset:0
    ds_read_b128 v[88:91], v5 offset:4096
    ds_read_b128 v[92:95], v5 offset:8192
    ds_read_b128 v[96:99], v5 offset:12288
    s_waitcnt lgkmcnt(0)
    v_readfirstlane_b32 s78, v6
    s_nop 0
    s_cmp_ge_u32 s78, 4
    s_cbranch_scc0 LA_s3
    s_add_u32 s89, s91, 4194304
    buffer_store_dwordx4 v[84:87], v14, s[52:55], s89 offen sc1
    s_add_u32 s89, s91, 4198400
    buffer_store_dwordx4 v[88:91], v14, s[52:55], s89 offen sc1
    s_add_u32 s89, s91, 4202496
    buffer_store_dwordx4 v[92:95], v14, s[52:55], s89 offen sc1
    s_add_u32 s89, s91, 4206592
    buffer_store_dwordx4 v[96:99], v14, s[52:55], s89 offen sc1
    s_add_u32 m0, s86, 129024
    s_add_u32 s89, s97, 131072
    buffer_load_dwordx4 v17, s[64:67], s89 offen  lds
    s_add_u32 m0, s86, 133120
    s_add_u32 s89, s97, 196608
    buffer_load_dwordx4 v17, s[64:67], s89 offen  lds
    s_add_u32 m0, s86, 137216
    s_add_u32 s89, s99, 0
    buffer_load_dwordx4 v17, s[64:67], s89 offen  lds
    s_add_u32 m0, s86, 141312
    s_add_u32 s89, s99, 65536
    buffer_load_dwordx4 v17, s[64:67], s89 offen  lds
    s_add_u32 m0, s86, 145408
    s_add_u32 s89, s99, 131072
    buffer_load_dwordx4 v17, s[64:67], s89 offen  lds
    s_add_u32 m0, s86, 149504
    s_add_u32 s89, s99, 196608
    buffer_load_dwordx4 v17, s[64:67], s89 offen  lds
    s_setprio 0
    s_mov_b32 s60, s22
    s_mov_b32 s61, s23
    s_mov_b32 s62, 0x800000
    s_mov_b32 s63, 0x20000
    s_lshr_b32 s81, s91, 4
    s_lshl_b32 s82, s3, 8
    s_add_u32 s81, s81, s82
    s_add_u32 s81, s81, 12648448
    s_lshl_b32 s80, s74, 14
    s_and_b32 s82, s75, 3
    s_lshl_b32 s82, s82, 8
    s_add_u32 s80, s80, s82
    s_add_u32 s80, s80, 12648448
    v_mov_b32 v5, 0
    v_lshlrev_b32 v7, 10, v0
    s_waitcnt vmcnt(6)
    s_mov_b64 exec, 1
    buffer_store_dword v19, v5, s[52:55], s81 offen sc1
    s_mov_b64 exec, 0xffff
    s_waitcnt vmcnt(1)
    s_mov_b64 exec, 1
    ds_add_u32 v18, v19 offset:32
    s_mov_b64 exec, -1
    s_mov_b64 exec, 0xffff
    s_waitcnt vmcnt(0)
    s_branch LA_s7a_in
LA_s7a:
    s_sleep 1
LA_s7a_in:
    ds_read_b32 v6, v18 offset:28
    s_waitcnt lgkmcnt(0)
    v_readfirstlane_b32 s78, v6
    s_nop 0
    s_cmp_ge_u32 s78, 4
    s_cbranch_scc0 LA_s7a
    s_setprio 2
    s_mov_b32 s79, 0
LA_py:
    buffer_load_dword v6, v7, s[52:55], s80 offen sc1
    s_add_u32 s79, s79, 1
    s_cmp_gt_u32 s79, 200000
    s_cbranch_scc1 LA_py_x
    s_waitcnt vmcnt(0)
    v_cmp_ne_u32 vcc, 1, v6
    s_cbranch_vccz LA_py_x
    s_mov_b64 exec, vcc
    s_sleep 8
    s_branch LA_py
LA_py_x:
    s_waitcnt vmcnt(0)
    s_mov_b64 exec, -1
    s_mov_b32 s89, 4194304
    buffer_load_dwordx4 v[100:103], v12, s[52:55], s89 offen sc1
    s_mov_b32 s89, 4210688
    buffer_load_dwordx4 v[104:107], v12, s[52:55], s89 offen sc1
    s_mov_b32 s89, 4227072
    buffer_load_dwordx4 v[108:111], v12, s[52:55], s89 offen sc1
    s_mov_b32 s89, 4243456
    buffer_load_dwordx4 v[112:115], v12, s[52:55], s89 offen sc1
    s_waitcnt vmcnt(3)
    v_permlane32_swap_b32 v102, v100
    v_permlane32_swap_b32 v103, v101
    s_waitcnt vmcnt(2)
    v_permlane32_swap_b32 v106, v104
    v_permlane32_swap_b32 v107, v105
    s_waitcnt vmcnt(1)
    v_permlane32_swap_b32 v110, v108
    v_permlane32_swap_b32 v111, v109
    s_waitcnt vmcnt(0)
    v_permlane32_swap_b32 v114, v112
    v_permlane32_swap_b32 v115, v113
    v_and_b32 v68, 0xffff0000, v103
    v_and_b32 v69, 0xffff0000, v107
    v_and_b32 v70, 0xffff0000, v111
    v_and_b32 v71, 0xffff0000, v115
    v_and_b32 v72, 0xffff0000, v101
    v_and_b32 v73, 0xffff0000, v105
    v_and_b32 v74, 0xffff0000, v109
    v_and_b32 v75, 0xffff0000, v113
    v_mul_f32 v68, v68, v196
    v_mul_f32 v69, v69, v197
    v_mul_f32 v70, v70, v198
    v_mul_f32 v71, v71, v199
    v_mul_f32 v72, v72, v200
    v_mul_f32 v73, v73, v201
    v_mul_f32 v74, v74, v202
    v_mul_f32 v75, v75, v203
    v_cvt_pk_bf16_f32 v36, v68, v69
    v_cvt_pk_bf16_f32 v37, v70, v71
    v_cvt_pk_bf16_f32 v38, v72, v73
    v_cvt_pk_bf16_f32 v39, v74, v75
    s_mov_b32 s89, 0
    buffer_store_dwordx4 v[36:39], v13, s[60:63], s89 offen nt
    v_lshlrev_b32 v68, 16, v103
    v_lshlrev_b32 v69, 16, v107
    v_lshlrev_b32 v70, 16, v111
    v_lshlrev_b32 v71, 16, v115
    v_lshlrev_b32 v72, 16, v101
    v_lshlrev_b32 v73, 16, v105
    v_lshlrev_b32 v74, 16, v109
    v_lshlrev_b32 v75, 16, v113
    v_mul_f32 v68, v68, v204
    v_mul_f32 v69, v69, v205
    v_mul_f32 v70, v70, v206
    v_mul_f32 v71, v71, v207
    v_mul_f32 v72, v72, v208
    v_mul_f32 v73, v73, v209
    v_mul_f32 v74, v74, v210
    v_mul_f32 v75, v75, v211
    v_cvt_pk_bf16_f32 v40, v68, v69
    v_cvt_pk_bf16_f32 v41, v70, v71
    v_cvt_pk_bf16_f32 v42, v72, v73
    v_cvt_pk_bf16_f32 v43, v74, v75
    s_mov_b32 s89, 4096
    buffer_store_dwordx4 v[40:43], v13, s[60:63], s89 offen nt
    v_and_b32 v68, 0xffff0000, v102
    v_and_b32 v69, 0xffff0000, v106
    v_and_b32 v70, 0xffff0000, v110
    v_and_b32 v71, 0xffff0000, v114
    v_and_b32 v72, 0xffff0000, v100
    v_and_b32 v73, 0xffff0000, v104
    v_and_b32 v74, 0xffff0000, v108
    v_and_b32 v75, 0xffff0000, v112
    v_mul_f32 v68, v68, v240
    v_mul_f32 v69, v69, v241
    v_mul_f32 v70, v70, v242
    v_mul_f32 v71, v71, v243
    v_mul_f32 v72, v72, v244
    v_mul_f32 v73, v73, v245
    v_mul_f32 v74, v74, v246
    v_mul_f32 v75, v75, v247
    v_cvt_pk_bf16_f32 v44, v68, v69
    v_cvt_pk_bf16_f32 v45, v70, v71
    v_cvt_pk_bf16_f32 v46, v72, v73
    v_cvt_pk_bf16_f32 v47, v74, v75
    s_mov_b32 s89, 8192
    buffer_store_dwordx4 v[44:47], v13, s[60:63], s89 offen nt
    v_lshlrev_b32 v68, 16, v102
    v_lshlrev_b32 v69, 16, v106
    v_lshlrev_b32 v70, 16, v110
    v_lshlrev_b32 v71, 16, v114
    v_lshlrev_b32 v72, 16, v100
    v_lshlrev_b32 v73, 16, v104
    v_lshlrev_b32 v74, 16, v108
    v_lshlrev_b32 v75, 16, v112
    v_mul_f32 v68, v68, v248
    v_mul_f32 v69, v69, v249
    v_mul_f32 v70, v70, v250
    v_mul_f32 v71, v71, v251
    v_mul_f32 v72, v72, v252
    v_mul_f32 v73, v73, v253
    v_mul_f32 v74, v74, v254
    v_mul_f32 v75, v75, v255
    v_cvt_pk_bf16_f32 v48, v68, v69
    v_cvt_pk_bf16_f32 v49, v70, v71
    v_cvt_pk_bf16_f32 v50, v72, v73
    v_cvt_pk_bf16_f32 v51, v74, v75
    s_mov_b32 s89, 12288
    buffer_store_dwordx4 v[48:51], v13, s[60:63], s89 offen nt
    s_endpgm
L_B:
    s_setprio 3
    s_and_b32 s3, s3, 3
    s_lshr_b32 s86, s3, 1
    s_and_b32 s87, s3, 1
    v_mov_b32 v10, 162304
    v_mov_b32 v11, 1
    v_lshlrev_b32 v12, 4, v0
    v_lshl_add_u32 v13, v0, 2, v10
    v_mov_b32 v14, 0
    ds_write_b32 v13, v14
    s_lshl_b32 s78, s74, 4
    s_add_u32 s78, s78, s75
    s_lshl_b32 s96, s78, 8
    s_add_u32 s96, s96, 12582912
    s_lshl_b32 s78, s78, 2
    s_add_u32 s78, s78, s3
    s_lshl_b32 s78, s78, 8
    s_add_u32 s80, s78, 12648448
    s_lshl_b32 s81, s72, 1
    s_add_u32 s81, s81, s86
    s_lshl_b32 s97, s81, 4
    s_add_u32 s97, s97, s73
    s_lshl_b32 s97, s97, 8
    s_add_u32 s97, s97, 12910464
    v_mov_b32 v15, s80
    v_mov_b32 v223, s97
    v_cmp_gt_u32 vcc, 8, v0
    s_nop 1
    v_cndmask_b32 v15, v223, v15, vcc
    v_add_u32 v221, v15, v12
    s_lshl_b32 s78, s87, 2
    s_add_u32 s78, s78, 128
    s_add_u32 s97, s97, s78
    s_lshl_b32 s82, s73, 1
    s_add_u32 s82, s82, s87
    s_lshl_b32 s78, s81, 7
    s_add_u32 s78, s78, s82
    s_lshl_b32 s94, s78, 10
    s_add_u32 s94, s94, 8388608
    v_mov_b32 v212, 0
    v_mov_b32 v213, 0
    v_mov_b32 v214, 0
    v_mov_b32 v215, 0
    v_mov_b32 v220, 0
    s_waitcnt lgkmcnt(0)
    s_mov_b32 s52, s26
    s_mov_b32 s53, s27
    s_mov_b32 s54, 0x1000000
    s_mov_b32 s55, 0x20000
    s_mov_b32 s68, s24
    s_mov_b32 s69, s25
    s_mov_b32 s70, 0x100
    s_mov_b32 s71, 0x20000
    s_lshl_b32 s98, s74, 4
    s_or_b32 s78, s75, s3
    s_cmp_lg_u32 s78, 0
    s_cbranch_scc1 LB_notag
    s_mov_b64 exec, 0xffff
    v_lshlrev_b32 v15, 8, v0
    buffer_load_dword v223, v15, s[52:55], s96 offen sc1
    s_waitcnt vmcnt(0)
    v_lshrrev_b32 v223, v0, v223
    v_and_b32 v223, 1, v223
    v_cmp_eq_u32 vcc, 0, v223
    s_nop 1
    s_or_b32 s78, vcc_lo, 0x10000
    s_mov_b64 exec, 1
    v_mov_b32 v223, s78
    buffer_store_dword v223, v220, s[68:71], s98 offen sc1
LB_notag:
    s_lshl_b32 s78, s87, 3
    s_lshr_b32 exec_lo, 0xffff, s78
    s_mov_b32 exec_hi, 0
    buffer_store_dwordx4 v[212:215], v221, s[52:55], 0 offen sc1
    s_mov_b64 exec, -1
    v_and_b32 v13, 15, v0
    v_lshrrev_b32 v14, 4, v0
    v_lshrrev_b32 v15, 1, v13
    v_xor_b32 v15, v15, v14
    v_lshlrev_b32 v15, 4, v15
    v_lshl_add_u32 v15, v13, 7, v15
    v_add_u32 v2, 73728, v15
    v_xor_b32 v3, 64, v2
    s_lshl_b32 s78, s86, 13
    s_add_u32 s78, s78, 2048
    v_add_u32 v4, s78, v2
    v_add_u32 v5, s78, v3
    v_bfe_u32 v15, v0, 3, 2
    s_lshl_b32 s78, s87, 1
    s_add_u32 s78, s78, s86
    v_xor_b32 v15, s78, v15
    v_lshlrev_b32 v15, 5, v15
    v_and_b32 v223, 3, v0
    v_lshl_add_u32 v15, v223, 3, v15
    v_bfe_u32 v223, v0, 2, 2
    v_lshl_add_u32 v15, v223, 7, v15
    v_mul_u32_u24 v223, 3072, v14
    v_add_u32 v6, v223, v15
    v_xor_b32 v7, 32, v6
    s_mov_b32 s60, s22
    s_mov_b32 s61, s23
    s_mov_b32 s62, 0x800000
    s_mov_b32 s63, 0x20000
    v_and_b32 v15, 1, v13
    v_cmp_eq_u32 s[88:89], 1, v15
    v_lshl_add_u32 v15, v14, 2, v15
    v_cmp_le_u32 s[90:91], v15, v13
    v_add_u32 v15, 2, v15
    v_cmp_le_u32 s[92:93], v15, v13
    v_mov_b32 v212, 0x0c0c0c0c
    v_mov_b32 v15, 0xc0c0100
    v_mov_b32 v223, 0x1000c0c
    v_cndmask_b32 v15, v15, v223, s[88:89]
    v_cndmask_b32 v208, v15, v212, s[90:91]
    v_cndmask_b32 v210, v212, v15, s[90:91]
    v_mov_b32 v15, 0xc0c0302
    v_mov_b32 v223, 0x3020c0c
    v_cndmask_b32 v15, v15, v223, s[88:89]
    v_cndmask_b32 v209, v15, v212, s[92:93]
    v_cndmask_b32 v211, v212, v15, s[92:93]
    s_or_b32 s78, s72, s86
    s_cmp_eq_u32 s78, 0
    s_cselect_b32 s78, 0xf149f2ca, 0
    v_mov_b32 v212, s78
    v_mov_b32 v213, s78
    v_mov_b32 v214, s78
    v_mov_b32 v215, s78
    s_lshl_b32 s78, s87, 12
    s_add_u32 s78, s78, 24576
    s_lshl_b32 s79, s86, 9
    s_add_u32 s79, s79, s78
    v_lshlrev_b32 v15, 3, v0
    v_add_u32 v216, s79, v15
    s_lshl_b32 s80, s86, 11
    v_add_u32 v218, s80, v216
    v_xor_b32 v219, 512, v218
    s_add_u32 s78, s78, 2048
    s_cmp_eq_u32 s86, 0
    s_cselect_b32 s78, s78, 32768
    v_add_u32 v217, s78, v15
    v_bfe_u32 v14, v0, 3, 2
    v_lshlrev_b32 v14, 5, v14
    v_and_b32 v15, 3, v0
    v_lshl_add_u32 v14, v15, 3, v14
    v_lshrrev_b32 v15, 2, v0
    v_lshl_add_u32 v14, v15, 7, v14
    s_lshl_b32 s78, s86, 11
    v_add_u32 v244, s78, v14
    s_mov_b32 s64, s20
    s_mov_b32 s65, s21
    s_mov_b32 s66, 0x200000
    s_mov_b32 s67, 0x20000
    v_lshrrev_b32 v14, 4, v0
    v_lshlrev_b32 v14, 1, v14
    v_and_b32 v15, 7, v0
    v_xor_b32 v14, v14, v15
    v_lshlrev_b32 v14, 4, v14
    v_lshrrev_b32 v15, 3, v0
    v_lshl_add_u32 v14, v15, 11, v14
    s_lshl_b32 s78, s77, 7
    s_lshl_b32 s79, s3, 14
    s_add_u32 s78, s78, s79
    v_add_u32 v245, s78, v14
    v_and_b32 v14, 15, v0
    s_lshl_b32 s78, s76, 2
    s_add_u32 s78, s78, s3
    s_lshl_b32 s79, s78, 5
    v_add_u32 v14, s79, v14
    v_lshlrev_b32 v14, 12, v14
    v_bfe_u32 v15, v0, 4, 1
    v_lshl_add_u32 v14, v15, 5, v14
    v_lshrrev_b32 v15, 5, v0
    v_lshl_add_u32 v14, v15, 4, v14
    s_lshl_b32 s79, s77, 7
    s_add_u32 s79, s79, 2048
    v_add_u32 v246, s79, v14
    s_lshl_b32 s28, s78, 16
    s_add_u32 s28, s28, 8388608
    s_lshl_b32 s30, s76, 1
    s_add_u32 s30, s30, s86
    s_lshl_b32 s30, s30, 12
    s_add_u32 s30, s30, 12910592
    v_lshrrev_b32 v15, 1, v0
    v_lshlrev_b32 v15, 8, v15
    v_and_b32 v14, 1, v0
    v_lshl_add_u32 v247, v14, 2, v15
    s_and_b32 s78, s77, 7
    s_mov_b32 s79, 0x76543210
    s_cmp_eq_u32 s78, 1
    s_cselect_b32 s79, 0x76543201, s79
    s_cmp_eq_u32 s78, 2
    s_cselect_b32 s79, 0x76543120, s79
    s_cmp_eq_u32 s78, 3
    s_cselect_b32 s79, 0x76542310, s79
    s_cmp_eq_u32 s78, 4
    s_cselect_b32 s79, 0x76534210, s79
    s_cmp_eq_u32 s78, 5
    s_cselect_b32 s79, 0x76453210, s79
    s_cmp_eq_u32 s78, 6
    s_cselect_b32 s79, 0x75643210, s79
    s_cmp_eq_u32 s78, 7
    s_cselect_b32 s79, 0x67543210, s79
    s_and_b32 s78, s76, 3
    s_mul_i32 s78, s78, 0x22222222
    s_add_u32 s79, s79, s78
    s_bfe_u32 s78, s79, 0x30000
    s_lshl_b32 s44, s78, 18
    s_lshl_b32 s78, s78, 12
    s_add_u32 s36, s78, s28
    s_bfe_u32 s78, s79, 0x30004
    s_lshl_b32 s45, s78, 18
    s_lshl_b32 s78, s78, 12
    s_add_u32 s37, s78, s28
    s_bfe_u32 s78, s79, 0x30008
    s_lshl_b32 s46, s78, 18
    s_lshl_b32 s78, s78, 12
    s_add_u32 s38, s78, s28
    s_bfe_u32 s78, s79, 0x3000c
    s_lshl_b32 s47, s78, 18
    s_lshl_b32 s78, s78, 12
    s_add_u32 s39, s78, s28
    s_bfe_u32 s78, s79, 0x30010
    s_lshl_b32 s48, s78, 18
    s_lshl_b32 s78, s78, 12
    s_add_u32 s40, s78, s28
    s_bfe_u32 s78, s79, 0x30014
    s_lshl_b32 s49, s78, 18
    s_lshl_b32 s78, s78, 12
    s_add_u32 s41, s78, s28
    s_bfe_u32 s78, s79, 0x30018
    s_lshl_b32 s50, s78, 18
    s_lshl_b32 s78, s78, 12
    s_add_u32 s42, s78, s28
    s_bfe_u32 s78, s79, 0x3001c
    s_lshl_b32 s51, s78, 18
    s_lshl_b32 s78, s78, 12
    s_add_u32 s43, s78, s28
    s_lshl_b32 s34, s3, 10
    v_bfe_u32 v14, v0, 4, 1
    v_lshrrev_b32 v15, 5, v0
    v_lshl_add_u32 v14, v14, 1, v15
    v_and_b32 v15, 7, v0
    v_xor_b32 v14, v14, v15
    v_lshlrev_b32 v14, 4, v14
    v_and_b32 v223, 15, v0
    v_lshl_add_u32 v14, v223, 7, v14
    s_lshl_b32 s78, s3, 12
    v_add_u32 v248, s78, v14
    v_xor_b32 v249, 64, v248
    v_add_u32 v250, s78, v12
    v_lshrrev_b32 v14, 3, v0
    v_xor_b32 v15, v15, v14
    v_lshlrev_b32 v15, 4, v15
    v_lshl_add_u32 v14, v14, 12, v15
    s_lshl_b32 s78, s76, 2
    s_add_u32 s78, s78, s3
    s_lshl_b32 s78, s78, 17
    s_lshl_b32 s79, s77, 7
    s_add_u32 s78, s78, s79
    s_add_u32 s78, s78, 2048
    v_add_u32 v246, s78, v14
    s_waitcnt lgkmcnt(0)
    s_barrier
    ds_read_b128 v[120:123], v4 offset:0
    ds_read_b128 v[124:127], v4 offset:2048
    ds_read_b128 v[128:131], v4 offset:4096
    ds_read_b128 v[132:135], v4 offset:6144
    ds_read_b128 v[136:139], v2 offset:0
    ds_read_b64_tr_b16 v[140:141], v6 offset:0
    ds_read_b64_tr_b16 v[142:143], v6 offset:512
    ds_read_b64_tr_b16 v[144:145], v7 offset:0
    ds_read_b64_tr_b16 v[146:147], v7 offset:512
    ds_read_b64_tr_b16 v[148:149], v6 offset:1024
    ds_read_b64_tr_b16 v[150:151], v6 offset:1536
    ds_read_b64_tr_b16 v[152:153], v7 offset:1024
    ds_read_b64_tr_b16 v[154:155], v7 offset:1536
    ds_read_b64_tr_b16 v[156:157], v6 offset:2048
    ds_read_b64_tr_b16 v[158:159], v6 offset:2560
    ds_read_b64_tr_b16 v[160:161], v7 offset:2048
    ds_read_b64_tr_b16 v[162:163], v7 offset:2560
    s_waitcnt lgkmcnt(0)
    v_mfma_f32_16x16x32_bf16 v[16:19], v[140:143], v[120:123], 0
    ds_read_b128 v[164:167], v5 offset:0
    v_mfma_f32_16x16x32_bf16 v[20:23], v[144:147], v[120:123], 0
    ds_read_b128 v[168:171], v5 offset:2048
    v_mfma_f32_16x16x32_bf16 v[52:55], v[152:155], v[120:123], 0
    ds_read_b128 v[172:175], v5 offset:4096
    v_mfma_f32_16x16x32_bf16 v[48:51], v[148:151], v[120:123], 0
    ds_read_b128 v[176:179], v5 offset:6144
    v_mfma_f32_16x16x32_bf16 v[56:59], v[148:151], v[124:127], 0
    ds_read_b128 v[180:183], v3 offset:0
    v_mfma_f32_16x16x32_bf16 v[60:63], v[152:155], v[124:127], 0
    ds_read_b64_tr_b16 v[184:185], v6 offset:12288
    v_mfma_f32_16x16x32_bf16 v[28:31], v[144:147], v[124:127], 0
    ds_read_b64_tr_b16 v[186:187], v6 offset:12800
    v_mfma_f32_16x16x32_bf16 v[24:27], v[140:143], v[124:127], 0
    ds_read_b64_tr_b16 v[188:189], v7 offset:12288
    v_mfma_f32_16x16x32_bf16 v[32:35], v[140:143], v[128:131], 0
    ds_read_b64_tr_b16 v[190:191], v7 offset:12800
    v_mfma_f32_16x16x32_bf16 v[36:39], v[144:147], v[128:131], 0
    ds_read_b64_tr_b16 v[192:193], v6 offset:13312
    v_mfma_f32_16x16x32_bf16 v[68:71], v[152:155], v[128:131], 0
    ds_read_b64_tr_b16 v[194:195], v6 offset:13824
    v_mfma_f32_16x16x32_bf16 v[64:67], v[148:151], v[128:131], 0
    ds_read_b64_tr_b16 v[196:197], v7 offset:13312
    v_mfma_f32_16x16x32_bf16 v[112:115], v[148:151], v[136:139], 0
    ds_read_b64_tr_b16 v[198:199], v7 offset:13824
    v_mfma_f32_16x16x32_bf16 v[72:75], v[148:151], v[132:135], 0
    ds_read_b64_tr_b16 v[200:201], v6 offset:14336
    v_mfma_f32_16x16x32_bf16 v[76:79], v[152:155], v[132:135], 0
    ds_read_b64_tr_b16 v[202:203], v6 offset:14848
    v_mfma_f32_16x16x32_bf16 v[44:47], v[144:147], v[132:135], 0
    ds_read_b64_tr_b16 v[204:205], v7 offset:14336
    v_mfma_f32_16x16x32_bf16 v[40:43], v[140:143], v[132:135], 0
    ds_read_b64_tr_b16 v[206:207], v7 offset:14848
    v_mfma_f32_16x16x32_bf16 v[104:107], v[132:135], v[156:159], 0
    v_mfma_f32_16x16x32_bf16 v[108:111], v[132:135], v[160:163], 0
    v_mfma_f32_16x16x32_bf16 v[100:103], v[128:131], v[160:163], 0
    v_mfma_f32_16x16x32_bf16 v[96:99], v[128:131], v[156:159], 0
    v_mfma_f32_16x16x32_bf16 v[88:91], v[124:127], v[156:159], 0
    v_mfma_f32_16x16x32_bf16 v[92:95], v[124:127], v[160:163], 0
    v_mfma_f32_16x16x32_bf16 v[84:87], v[120:123], v[160:163], 0
    v_mfma_f32_16x16x32_bf16 v[80:83], v[120:123], v[156:159], 0
    v_mfma_f32_16x16x32_bf16 v[116:119], v[136:139], v[156:159], 0
    s_waitcnt vmcnt(0)
    s_waitcnt lgkmcnt(0)
    s_barrier
    v_mfma_f32_16x16x32_bf16 v[16:19], v[184:187], v[164:167], v[16:19]
    ds_read_b128 v[120:123], v4 offset:18432
    v_mfma_f32_16x16x32_bf16 v[20:23], v[188:191], v[164:167], v[20:23]
    ds_read_b128 v[124:127], v4 offset:20480
    v_mfma_f32_16x16x32_bf16 v[52:55], v[196:199], v[164:167], v[52:55]
    ds_read_b128 v[128:131], v4 offset:22528
    v_mfma_f32_16x16x32_bf16 v[48:51], v[192:195], v[164:167], v[48:51]
    ds_read_b128 v[132:135], v4 offset:24576
    v_mfma_f32_16x16x32_bf16 v[56:59], v[192:195], v[168:171], v[56:59]
    ds_read_b128 v[136:139], v2 offset:18432
    v_mfma_f32_16x16x32_bf16 v[60:63], v[196:199], v[168:171], v[60:63]
    ds_read_b64_tr_b16 v[140:141], v6 offset:24576
    v_mfma_f32_16x16x32_bf16 v[28:31], v[188:191], v[168:171], v[28:31]
    ds_read_b64_tr_b16 v[142:143], v6 offset:25088
    v_mfma_f32_16x16x32_bf16 v[24:27], v[184:187], v[168:171], v[24:27]
    ds_read_b64_tr_b16 v[144:145], v7 offset:24576
    v_mfma_f32_16x16x32_bf16 v[32:35], v[184:187], v[172:175], v[32:35]
    ds_read_b64_tr_b16 v[146:147], v7 offset:25088
    v_mfma_f32_16x16x32_bf16 v[36:39], v[188:191], v[172:175], v[36:39]
    ds_read_b64_tr_b16 v[148:149], v6 offset:25600
    v_mfma_f32_16x16x32_bf16 v[68:71], v[196:199], v[172:175], v[68:71]
    ds_read_b64_tr_b16 v[150:151], v6 offset:26112
    v_mfma_f32_16x16x32_bf16 v[64:67], v[192:195], v[172:175], v[64:67]
    ds_read_b64_tr_b16 v[152:153], v7 offset:25600
    v_mfma_f32_16x16x32_bf16 v[112:115], v[192:195], v[180:183], v[112:115]
    ds_read_b64_tr_b16 v[154:155], v7 offset:26112
    v_mfma_f32_16x16x32_bf16 v[72:75], v[192:195], v[176:179], v[72:75]
    ds_read_b64_tr_b16 v[156:157], v6 offset:26624
    v_mfma_f32_16x16x32_bf16 v[76:79], v[196:199], v[176:179], v[76:79]
    ds_read_b64_tr_b16 v[158:159], v6 offset:27136
    v_mfma_f32_16x16x32_bf16 v[44:47], v[188:191], v[176:179], v[44:47]
    ds_read_b64_tr_b16 v[160:161], v7 offset:26624
    v_mfma_f32_16x16x32_bf16 v[40:43], v[184:187], v[176:179], v[40:43]
    ds_read_b64_tr_b16 v[162:163], v7 offset:27136
    v_mfma_f32_16x16x32_bf16 v[104:107], v[176:179], v[200:203], v[104:107]
    v_mfma_f32_16x16x32_bf16 v[108:111], v[176:179], v[204:207], v[108:111]
    v_mfma_f32_16x16x32_bf16 v[100:103], v[172:175], v[204:207], v[100:103]
    v_mfma_f32_16x16x32_bf16 v[96:99], v[172:175], v[200:203], v[96:99]
    v_mfma_f32_16x16x32_bf16 v[88:91], v[168:171], v[200:203], v[88:91]
    v_mfma_f32_16x16x32_bf16 v[92:95], v[168:171], v[204:207], v[92:95]
    v_mfma_f32_16x16x32_bf16 v[84:87], v[164:167], v[204:207], v[84:87]
    v_mfma_f32_16x16x32_bf16 v[80:83], v[164:167], v[200:203], v[80:83]
    v_mfma_f32_16x16x32_bf16 v[116:119], v[180:183], v[200:203], v[116:119]
    s_waitcnt lgkmcnt(0)
    v_mfma_f32_16x16x32_bf16 v[16:19], v[140:143], v[120:123], v[16:19]
    ds_read_b128 v[164:167], v5 offset:18432
    v_mfma_f32_16x16x32_bf16 v[20:23], v[144:147], v[120:123], v[20:23]
    ds_read_b128 v[168:171], v5 offset:20480
    v_mfma_f32_16x16x32_bf16 v[52:55], v[152:155], v[120:123], v[52:55]
    ds_read_b128 v[172:175], v5 offset:22528
    v_mfma_f32_16x16x32_bf16 v[48:51], v[148:151], v[120:123], v[48:51]
    ds_read_b128 v[176:179], v5 offset:24576
    v_mfma_f32_16x16x32_bf16 v[56:59], v[148:151], v[124:127], v[56:59]
    ds_read_b128 v[180:183], v3 offset:18432
    v_mfma_f32_16x16x32_bf16 v[60:63], v[152:155], v[124:127], v[60:63]
    ds_read_b64_tr_b16 v[184:185], v6 offset:36864
    v_mfma_f32_16x16x32_bf16 v[28:31], v[144:147], v[124:127], v[28:31]
    ds_read_b64_tr_b16 v[186:187], v6 offset:37376
    v_mfma_f32_16x16x32_bf16 v[24:27], v[140:143], v[124:127], v[24:27]
    ds_read_b64_tr_b16 v[188:189], v7 offset:36864
    v_mfma_f32_16x16x32_bf16 v[32:35], v[140:143], v[128:131], v[32:35]
    ds_read_b64_tr_b16 v[190:191], v7 offset:37376
    v_mfma_f32_16x16x32_bf16 v[36:39], v[144:147], v[128:131], v[36:39]
    ds_read_b64_tr_b16 v[192:193], v6 offset:37888
    v_mfma_f32_16x16x32_bf16 v[68:71], v[152:155], v[128:131], v[68:71]
    ds_read_b64_tr_b16 v[194:195], v6 offset:38400
    v_mfma_f32_16x16x32_bf16 v[64:67], v[148:151], v[128:131], v[64:67]
    ds_read_b64_tr_b16 v[196:197], v7 offset:37888
    v_mfma_f32_16x16x32_bf16 v[112:115], v[148:151], v[136:139], v[112:115]
    ds_read_b64_tr_b16 v[198:199], v7 offset:38400
    v_mfma_f32_16x16x32_bf16 v[72:75], v[148:151], v[132:135], v[72:75]
    ds_read_b64_tr_b16 v[200:201], v6 offset:38912
    v_mfma_f32_16x16x32_bf16 v[76:79], v[152:155], v[132:135], v[76:79]
    ds_read_b64_tr_b16 v[202:203], v6 offset:39424
    v_mfma_f32_16x16x32_bf16 v[44:47], v[144:147], v[132:135], v[44:47]
    ds_read_b64_tr_b16 v[204:205], v7 offset:38912
    v_mfma_f32_16x16x32_bf16 v[40:43], v[140:143], v[132:135], v[40:43]
    ds_read_b64_tr_b16 v[206:207], v7 offset:39424
    v_mfma_f32_16x16x32_bf16 v[104:107], v[132:135], v[156:159], v[104:107]
    v_mfma_f32_16x16x32_bf16 v[108:111], v[132:135], v[160:163], v[108:111]
    v_mfma_f32_16x16x32_bf16 v[100:103], v[128:131], v[160:163], v[100:103]
    v_mfma_f32_16x16x32_bf16 v[96:99], v[128:131], v[156:159], v[96:99]
    v_mfma_f32_16x16x32_bf16 v[88:91], v[124:127], v[156:159], v[88:91]
    v_mfma_f32_16x16x32_bf16 v[92:95], v[124:127], v[160:163], v[92:95]
    v_mfma_f32_16x16x32_bf16 v[84:87], v[120:123], v[160:163], v[84:87]
    v_mfma_f32_16x16x32_bf16 v[80:83], v[120:123], v[156:159], v[80:83]
    v_mfma_f32_16x16x32_bf16 v[116:119], v[136:139], v[156:159], v[116:119]
    s_waitcnt lgkmcnt(0)
    s_barrier
    v_mfma_f32_16x16x32_bf16 v[16:19], v[184:187], v[164:167], v[16:19]
    ds_read_b128 v[120:123], v4 offset:36864
    v_mfma_f32_16x16x32_bf16 v[20:23], v[188:191], v[164:167], v[20:23]
    ds_read_b128 v[124:127], v4 offset:38912
    v_mfma_f32_16x16x32_bf16 v[52:55], v[196:199], v[164:167], v[52:55]
    ds_read_b128 v[128:131], v4 offset:40960
    v_mfma_f32_16x16x32_bf16 v[48:51], v[192:195], v[164:167], v[48:51]
    ds_read_b128 v[132:135], v4 offset:43008
    v_mfma_f32_16x16x32_bf16 v[56:59], v[192:195], v[168:171], v[56:59]
    ds_read_b128 v[136:139], v2 offset:36864
    v_mfma_f32_16x16x32_bf16 v[60:63], v[196:199], v[168:171], v[60:63]
    ds_read_b64_tr_b16 v[140:141], v6 offset:49152
    v_mfma_f32_16x16x32_bf16 v[28:31], v[188:191], v[168:171], v[28:31]
    ds_read_b64_tr_b16 v[142:143], v6 offset:49664
    v_mfma_f32_16x16x32_bf16 v[24:27], v[184:187], v[168:171], v[24:27]
    ds_read_b64_tr_b16 v[144:145], v7 offset:49152
    v_mfma_f32_16x16x32_bf16 v[32:35], v[184:187], v[172:175], v[32:35]
    ds_read_b64_tr_b16 v[146:147], v7 offset:49664
    v_mfma_f32_16x16x32_bf16 v[36:39], v[188:191], v[172:175], v[36:39]
    ds_read_b64_tr_b16 v[148:149], v6 offset:50176
    v_mfma_f32_16x16x32_bf16 v[68:71], v[196:199], v[172:175], v[68:71]
    ds_read_b64_tr_b16 v[150:151], v6 offset:50688
    v_mfma_f32_16x16x32_bf16 v[64:67], v[192:195], v[172:175], v[64:67]
    ds_read_b64_tr_b16 v[152:153], v7 offset:50176
    v_mfma_f32_16x16x32_bf16 v[112:115], v[192:195], v[180:183], v[112:115]
    ds_read_b64_tr_b16 v[154:155], v7 offset:50688
    v_mfma_f32_16x16x32_bf16 v[72:75], v[192:195], v[176:179], v[72:75]
    ds_read_b64_tr_b16 v[156:157], v6 offset:51200
    v_mfma_f32_16x16x32_bf16 v[76:79], v[196:199], v[176:179], v[76:79]
    ds_read_b64_tr_b16 v[158:159], v6 offset:51712
    v_mfma_f32_16x16x32_bf16 v[44:47], v[188:191], v[176:179], v[44:47]
    ds_read_b64_tr_b16 v[160:161], v7 offset:51200
    v_mfma_f32_16x16x32_bf16 v[40:43], v[184:187], v[176:179], v[40:43]
    ds_read_b64_tr_b16 v[162:163], v7 offset:51712
    v_mfma_f32_16x16x32_bf16 v[104:107], v[176:179], v[200:203], v[104:107]
    v_mfma_f32_16x16x32_bf16 v[108:111], v[176:179], v[204:207], v[108:111]
    v_mfma_f32_16x16x32_bf16 v[100:103], v[172:175], v[204:207], v[100:103]
    v_mfma_f32_16x16x32_bf16 v[96:99], v[172:175], v[200:203], v[96:99]
    v_mfma_f32_16x16x32_bf16 v[88:91], v[168:171], v[200:203], v[88:91]
    v_mfma_f32_16x16x32_bf16 v[92:95], v[168:171], v[204:207], v[92:95]
    v_mfma_f32_16x16x32_bf16 v[84:87], v[164:167], v[204:207], v[84:87]
    v_mfma_f32_16x16x32_bf16 v[80:83], v[164:167], v[200:203], v[80:83]
    v_mfma_f32_16x16x32_bf16 v[116:119], v[180:183], v[200:203], v[116:119]
    s_waitcnt lgkmcnt(0)
    v_mfma_f32_16x16x32_bf16 v[16:19], v[140:143], v[120:123], v[16:19]
    ds_read_b128 v[164:167], v5 offset:36864
    v_mfma_f32_16x16x32_bf16 v[20:23], v[144:147], v[120:123], v[20:23]
    ds_read_b128 v[168:171], v5 offset:38912
    v_mfma_f32_16x16x32_bf16 v[52:55], v[152:155], v[120:123], v[52:55]
    ds_read_b128 v[172:175], v5 offset:40960
    v_mfma_f32_16x16x32_bf16 v[48:51], v[148:151], v[120:123], v[48:51]
    ds_read_b128 v[176:179], v5 offset:43008
    v_mfma_f32_16x16x32_bf16 v[56:59], v[148:151], v[124:127], v[56:59]
    ds_read_b128 v[180:183], v3 offset:36864
    v_mfma_f32_16x16x32_bf16 v[60:63], v[152:155], v[124:127], v[60:63]
    ds_read_b64_tr_b16 v[184:185], v6 offset:61440
    v_mfma_f32_16x16x32_bf16 v[28:31], v[144:147], v[124:127], v[28:31]
    ds_read_b64_tr_b16 v[186:187], v6 offset:61952
    v_mfma_f32_16x16x32_bf16 v[24:27], v[140:143], v[124:127], v[24:27]
    ds_read_b64_tr_b16 v[188:189], v7 offset:61440
    v_mfma_f32_16x16x32_bf16 v[32:35], v[140:143], v[128:131], v[32:35]
    ds_read_b64_tr_b16 v[190:191], v7 offset:61952
    v_mfma_f32_16x16x32_bf16 v[36:39], v[144:147], v[128:131], v[36:39]
    ds_read_b64_tr_b16 v[192:193], v6 offset:62464
    v_mfma_f32_16x16x32_bf16 v[68:71], v[152:155], v[128:131], v[68:71]
    ds_read_b64_tr_b16 v[194:195], v6 offset:62976
    v_mfma_f32_16x16x32_bf16 v[64:67], v[148:151], v[128:131], v[64:67]
    ds_read_b64_tr_b16 v[196:197], v7 offset:62464
    v_mfma_f32_16x16x32_bf16 v[112:115], v[148:151], v[136:139], v[112:115]
    ds_read_b64_tr_b16 v[198:199], v7 offset:62976
    v_mfma_f32_16x16x32_bf16 v[72:75], v[148:151], v[132:135], v[72:75]
    ds_read_b64_tr_b16 v[200:201], v6 offset:63488
    v_mfma_f32_16x16x32_bf16 v[76:79], v[152:155], v[132:135], v[76:79]
    ds_read_b64_tr_b16 v[202:203], v6 offset:64000
    v_mfma_f32_16x16x32_bf16 v[44:47], v[144:147], v[132:135], v[44:47]
    ds_read_b64_tr_b16 v[204:205], v7 offset:63488
    v_mfma_f32_16x16x32_bf16 v[40:43], v[140:143], v[132:135], v[40:43]
    ds_read_b64_tr_b16 v[206:207], v7 offset:64000
    v_mfma_f32_16x16x32_bf16 v[104:107], v[132:135], v[156:159], v[104:107]
    v_mfma_f32_16x16x32_bf16 v[108:111], v[132:135], v[160:163], v[108:111]
    v_mfma_f32_16x16x32_bf16 v[100:103], v[128:131], v[160:163], v[100:103]
    v_mfma_f32_16x16x32_bf16 v[96:99], v[128:131], v[156:159], v[96:99]
    v_mfma_f32_16x16x32_bf16 v[88:91], v[124:127], v[156:159], v[88:91]
    v_mfma_f32_16x16x32_bf16 v[92:95], v[124:127], v[160:163], v[92:95]
    v_mfma_f32_16x16x32_bf16 v[84:87], v[120:123], v[160:163], v[84:87]
    v_mfma_f32_16x16x32_bf16 v[80:83], v[120:123], v[156:159], v[80:83]
    v_mfma_f32_16x16x32_bf16 v[116:119], v[136:139], v[156:159], v[116:119]
    s_waitcnt lgkmcnt(0)
    s_barrier
    v_mfma_f32_16x16x32_bf16 v[16:19], v[184:187], v[164:167], v[16:19]
    ds_read_b128 v[120:123], v4 offset:0
    v_mfma_f32_16x16x32_bf16 v[20:23], v[188:191], v[164:167], v[20:23]
    ds_read_b128 v[124:127], v4 offset:2048
    v_mfma_f32_16x16x32_bf16 v[52:55], v[196:199], v[164:167], v[52:55]
    ds_read_b128 v[128:131], v4 offset:4096
    v_mfma_f32_16x16x32_bf16 v[48:51], v[192:195], v[164:167], v[48:51]
    ds_read_b128 v[132:135], v4 offset:6144
    v_mfma_f32_16x16x32_bf16 v[56:59], v[192:195], v[168:171], v[56:59]
    ds_read_b128 v[136:139], v2 offset:0
    v_mfma_f32_16x16x32_bf16 v[60:63], v[196:199], v[168:171], v[60:63]
    ds_read_b64_tr_b16 v[140:141], v6 offset:0
    v_mfma_f32_16x16x32_bf16 v[28:31], v[188:191], v[168:171], v[28:31]
    ds_read_b64_tr_b16 v[142:143], v6 offset:512
    v_mfma_f32_16x16x32_bf16 v[24:27], v[184:187], v[168:171], v[24:27]
    ds_read_b64_tr_b16 v[144:145], v7 offset:0
    v_mfma_f32_16x16x32_bf16 v[32:35], v[184:187], v[172:175], v[32:35]
    ds_read_b64_tr_b16 v[146:147], v7 offset:512
    v_mfma_f32_16x16x32_bf16 v[36:39], v[188:191], v[172:175], v[36:39]
    ds_read_b64_tr_b16 v[148:149], v6 offset:1024
    v_mfma_f32_16x16x32_bf16 v[68:71], v[196:199], v[172:175], v[68:71]
    ds_read_b64_tr_b16 v[150:151], v6 offset:1536
    v_mfma_f32_16x16x32_bf16 v[64:67], v[192:195], v[172:175], v[64:67]
    ds_read_b64_tr_b16 v[152:153], v7 offset:1024
    v_mfma_f32_16x16x32_bf16 v[112:115], v[192:195], v[180:183], v[112:115]
    ds_read_b64_tr_b16 v[154:155], v7 offset:1536
    v_mfma_f32_16x16x32_bf16 v[72:75], v[192:195], v[176:179], v[72:75]
    ds_read_b64_tr_b16 v[156:157], v6 offset:2048
    v_mfma_f32_16x16x32_bf16 v[76:79], v[196:199], v[176:179], v[76:79]
    ds_read_b64_tr_b16 v[158:159], v6 offset:2560
    v_mfma_f32_16x16x32_bf16 v[44:47], v[188:191], v[176:179], v[44:47]
    ds_read_b64_tr_b16 v[160:161], v7 offset:2048
    v_mfma_f32_16x16x32_bf16 v[40:43], v[184:187], v[176:179], v[40:43]
    ds_read_b64_tr_b16 v[162:163], v7 offset:2560
    v_mfma_f32_16x16x32_bf16 v[104:107], v[176:179], v[200:203], v[104:107]
    v_mfma_f32_16x16x32_bf16 v[108:111], v[176:179], v[204:207], v[108:111]
    v_mfma_f32_16x16x32_bf16 v[100:103], v[172:175], v[204:207], v[100:103]
    v_mfma_f32_16x16x32_bf16 v[96:99], v[172:175], v[200:203], v[96:99]
    v_mfma_f32_16x16x32_bf16 v[88:91], v[168:171], v[200:203], v[88:91]
    v_mfma_f32_16x16x32_bf16 v[92:95], v[168:171], v[204:207], v[92:95]
    v_mfma_f32_16x16x32_bf16 v[84:87], v[164:167], v[204:207], v[84:87]
    v_mfma_f32_16x16x32_bf16 v[80:83], v[164:167], v[200:203], v[80:83]
    v_mfma_f32_16x16x32_bf16 v[116:119], v[180:183], v[200:203], v[116:119]
    s_waitcnt lgkmcnt(0)
    v_mfma_f32_16x16x32_bf16 v[16:19], v[140:143], v[120:123], v[16:19]
    ds_read_b128 v[164:167], v5 offset:0
    v_mfma_f32_16x16x32_bf16 v[20:23], v[144:147], v[120:123], v[20:23]
    ds_read_b128 v[168:171], v5 offset:2048
    v_mfma_f32_16x16x32_bf16 v[52:55], v[152:155], v[120:123], v[52:55]
    ds_read_b128 v[172:175], v5 offset:4096
    v_mfma_f32_16x16x32_bf16 v[48:51], v[148:151], v[120:123], v[48:51]
    ds_read_b128 v[176:179], v5 offset:6144
    v_mfma_f32_16x16x32_bf16 v[56:59], v[148:151], v[124:127], v[56:59]
    ds_read_b128 v[180:183], v3 offset:0
    v_mfma_f32_16x16x32_bf16 v[60:63], v[152:155], v[124:127], v[60:63]
    ds_read_b64_tr_b16 v[184:185], v6 offset:12288
    v_mfma_f32_16x16x32_bf16 v[28:31], v[144:147], v[124:127], v[28:31]
    ds_read_b64_tr_b16 v[186:187], v6 offset:12800
    v_mfma_f32_16x16x32_bf16 v[24:27], v[140:143], v[124:127], v[24:27]
    ds_read_b64_tr_b16 v[188:189], v7 offset:12288
    v_mfma_f32_16x16x32_bf16 v[32:35], v[140:143], v[128:131], v[32:35]
    ds_read_b64_tr_b16 v[190:191], v7 offset:12800
    v_mfma_f32_16x16x32_bf16 v[36:39], v[144:147], v[128:131], v[36:39]
    ds_read_b64_tr_b16 v[192:193], v6 offset:13312
    v_mfma_f32_16x16x32_bf16 v[68:71], v[152:155], v[128:131], v[68:71]
    ds_read_b64_tr_b16 v[194:195], v6 offset:13824
    v_mfma_f32_16x16x32_bf16 v[64:67], v[148:151], v[128:131], v[64:67]
    ds_read_b64_tr_b16 v[196:197], v7 offset:13312
    v_mfma_f32_16x16x32_bf16 v[112:115], v[148:151], v[136:139], v[112:115]
    ds_read_b64_tr_b16 v[198:199], v7 offset:13824
    v_mfma_f32_16x16x32_bf16 v[72:75], v[148:151], v[132:135], v[72:75]
    ds_read_b64_tr_b16 v[200:201], v6 offset:14336
    v_mfma_f32_16x16x32_bf16 v[76:79], v[152:155], v[132:135], v[76:79]
    ds_read_b64_tr_b16 v[202:203], v6 offset:14848
    v_mfma_f32_16x16x32_bf16 v[44:47], v[144:147], v[132:135], v[44:47]
    ds_read_b64_tr_b16 v[204:205], v7 offset:14336
    v_mfma_f32_16x16x32_bf16 v[40:43], v[140:143], v[132:135], v[40:43]
    ds_read_b64_tr_b16 v[206:207], v7 offset:14848
    v_mfma_f32_16x16x32_bf16 v[104:107], v[132:135], v[156:159], v[104:107]
    v_mfma_f32_16x16x32_bf16 v[108:111], v[132:135], v[160:163], v[108:111]
    v_mfma_f32_16x16x32_bf16 v[100:103], v[128:131], v[160:163], v[100:103]
    v_mfma_f32_16x16x32_bf16 v[96:99], v[128:131], v[156:159], v[96:99]
    v_mfma_f32_16x16x32_bf16 v[88:91], v[124:127], v[156:159], v[88:91]
    v_mfma_f32_16x16x32_bf16 v[92:95], v[124:127], v[160:163], v[92:95]
    v_mfma_f32_16x16x32_bf16 v[84:87], v[120:123], v[160:163], v[84:87]
    v_mfma_f32_16x16x32_bf16 v[80:83], v[120:123], v[156:159], v[80:83]
    v_mfma_f32_16x16x32_bf16 v[116:119], v[136:139], v[156:159], v[116:119]
    s_waitcnt lgkmcnt(0)
    s_barrier
    v_mfma_f32_16x16x32_bf16 v[16:19], v[184:187], v[164:167], v[16:19]
    ds_read_b128 v[120:123], v4 offset:18432
    v_mfma_f32_16x16x32_bf16 v[20:23], v[188:191], v[164:167], v[20:23]
    ds_read_b128 v[124:127], v4 offset:20480
    v_mfma_f32_16x16x32_bf16 v[52:55], v[196:199], v[164:167], v[52:55]
    ds_read_b128 v[128:131], v4 offset:22528
    v_mfma_f32_16x16x32_bf16 v[48:51], v[192:195], v[164:167], v[48:51]
    ds_read_b128 v[132:135], v4 offset:24576
    v_mfma_f32_16x16x32_bf16 v[56:59], v[192:195], v[168:171], v[56:59]
    ds_read_b128 v[136:139], v2 offset:18432
    v_mfma_f32_16x16x32_bf16 v[60:63], v[196:199], v[168:171], v[60:63]
    ds_read_b64_tr_b16 v[140:141], v6 offset:24576
    v_mfma_f32_16x16x32_bf16 v[28:31], v[188:191], v[168:171], v[28:31]
    ds_read_b64_tr_b16 v[142:143], v6 offset:25088
    v_mfma_f32_16x16x32_bf16 v[24:27], v[184:187], v[168:171], v[24:27]
    ds_read_b64_tr_b16 v[144:145], v7 offset:24576
    v_mfma_f32_16x16x32_bf16 v[32:35], v[184:187], v[172:175], v[32:35]
    ds_read_b64_tr_b16 v[146:147], v7 offset:25088
    v_mfma_f32_16x16x32_bf16 v[36:39], v[188:191], v[172:175], v[36:39]
    ds_read_b64_tr_b16 v[148:149], v6 offset:25600
    v_mfma_f32_16x16x32_bf16 v[68:71], v[196:199], v[172:175], v[68:71]
    ds_read_b64_tr_b16 v[150:151], v6 offset:26112
    v_mfma_f32_16x16x32_bf16 v[64:67], v[192:195], v[172:175], v[64:67]
    ds_read_b64_tr_b16 v[152:153], v7 offset:25600
    v_mfma_f32_16x16x32_bf16 v[112:115], v[192:195], v[180:183], v[112:115]
    ds_read_b64_tr_b16 v[154:155], v7 offset:26112
    v_mfma_f32_16x16x32_bf16 v[72:75], v[192:195], v[176:179], v[72:75]
    ds_read_b64_tr_b16 v[156:157], v6 offset:26624
    v_mfma_f32_16x16x32_bf16 v[76:79], v[196:199], v[176:179], v[76:79]
    ds_read_b64_tr_b16 v[158:159], v6 offset:27136
    v_mfma_f32_16x16x32_bf16 v[44:47], v[188:191], v[176:179], v[44:47]
    ds_read_b64_tr_b16 v[160:161], v7 offset:26624
    v_mfma_f32_16x16x32_bf16 v[40:43], v[184:187], v[176:179], v[40:43]
    ds_read_b64_tr_b16 v[162:163], v7 offset:27136
    v_mfma_f32_16x16x32_bf16 v[104:107], v[176:179], v[200:203], v[104:107]
    v_mfma_f32_16x16x32_bf16 v[108:111], v[176:179], v[204:207], v[108:111]
    v_mfma_f32_16x16x32_bf16 v[100:103], v[172:175], v[204:207], v[100:103]
    v_mfma_f32_16x16x32_bf16 v[96:99], v[172:175], v[200:203], v[96:99]
    v_mfma_f32_16x16x32_bf16 v[88:91], v[168:171], v[200:203], v[88:91]
    v_mfma_f32_16x16x32_bf16 v[92:95], v[168:171], v[204:207], v[92:95]
    v_mfma_f32_16x16x32_bf16 v[84:87], v[164:167], v[204:207], v[84:87]
    v_mfma_f32_16x16x32_bf16 v[80:83], v[164:167], v[200:203], v[80:83]
    v_mfma_f32_16x16x32_bf16 v[116:119], v[180:183], v[200:203], v[116:119]
    s_waitcnt lgkmcnt(0)
    v_mfma_f32_16x16x32_bf16 v[16:19], v[140:143], v[120:123], v[16:19]
    ds_read_b128 v[164:167], v5 offset:18432
    v_mfma_f32_16x16x32_bf16 v[20:23], v[144:147], v[120:123], v[20:23]
    ds_read_b128 v[168:171], v5 offset:20480
    v_mfma_f32_16x16x32_bf16 v[52:55], v[152:155], v[120:123], v[52:55]
    ds_read_b128 v[172:175], v5 offset:22528
    v_mfma_f32_16x16x32_bf16 v[48:51], v[148:151], v[120:123], v[48:51]
    ds_read_b128 v[176:179], v5 offset:24576
    v_mfma_f32_16x16x32_bf16 v[56:59], v[148:151], v[124:127], v[56:59]
    ds_read_b128 v[180:183], v3 offset:18432
    v_mfma_f32_16x16x32_bf16 v[60:63], v[152:155], v[124:127], v[60:63]
    ds_read_b64_tr_b16 v[184:185], v6 offset:36864
    v_mfma_f32_16x16x32_bf16 v[28:31], v[144:147], v[124:127], v[28:31]
    ds_read_b64_tr_b16 v[186:187], v6 offset:37376
    v_mfma_f32_16x16x32_bf16 v[24:27], v[140:143], v[124:127], v[24:27]
    ds_read_b64_tr_b16 v[188:189], v7 offset:36864
    v_mfma_f32_16x16x32_bf16 v[32:35], v[140:143], v[128:131], v[32:35]
    ds_read_b64_tr_b16 v[190:191], v7 offset:37376
    v_mfma_f32_16x16x32_bf16 v[36:39], v[144:147], v[128:131], v[36:39]
    ds_read_b64_tr_b16 v[192:193], v6 offset:37888
    v_mfma_f32_16x16x32_bf16 v[68:71], v[152:155], v[128:131], v[68:71]
    ds_read_b64_tr_b16 v[194:195], v6 offset:38400
    v_mfma_f32_16x16x32_bf16 v[64:67], v[148:151], v[128:131], v[64:67]
    ds_read_b64_tr_b16 v[196:197], v7 offset:37888
    v_mfma_f32_16x16x32_bf16 v[112:115], v[148:151], v[136:139], v[112:115]
    ds_read_b64_tr_b16 v[198:199], v7 offset:38400
    v_mfma_f32_16x16x32_bf16 v[72:75], v[148:151], v[132:135], v[72:75]
    ds_read_b64_tr_b16 v[200:201], v6 offset:38912
    v_mfma_f32_16x16x32_bf16 v[76:79], v[152:155], v[132:135], v[76:79]
    ds_read_b64_tr_b16 v[202:203], v6 offset:39424
    v_mfma_f32_16x16x32_bf16 v[44:47], v[144:147], v[132:135], v[44:47]
    ds_read_b64_tr_b16 v[204:205], v7 offset:38912
    v_mfma_f32_16x16x32_bf16 v[40:43], v[140:143], v[132:135], v[40:43]
    ds_read_b64_tr_b16 v[206:207], v7 offset:39424
    v_mfma_f32_16x16x32_bf16 v[104:107], v[132:135], v[156:159], v[104:107]
    v_mfma_f32_16x16x32_bf16 v[108:111], v[132:135], v[160:163], v[108:111]
    v_mfma_f32_16x16x32_bf16 v[100:103], v[128:131], v[160:163], v[100:103]
    v_mfma_f32_16x16x32_bf16 v[96:99], v[128:131], v[156:159], v[96:99]
    v_mfma_f32_16x16x32_bf16 v[88:91], v[124:127], v[156:159], v[88:91]
    v_mfma_f32_16x16x32_bf16 v[92:95], v[124:127], v[160:163], v[92:95]
    v_mfma_f32_16x16x32_bf16 v[84:87], v[120:123], v[160:163], v[84:87]
    v_mfma_f32_16x16x32_bf16 v[80:83], v[120:123], v[156:159], v[80:83]
    v_mfma_f32_16x16x32_bf16 v[116:119], v[136:139], v[156:159], v[116:119]
    s_waitcnt lgkmcnt(0)
    s_barrier
    v_mfma_f32_16x16x32_bf16 v[16:19], v[184:187], v[164:167], v[16:19]
    ds_read_b128 v[120:123], v4 offset:36864
    v_mfma_f32_16x16x32_bf16 v[20:23], v[188:191], v[164:167], v[20:23]
    ds_read_b128 v[124:127], v4 offset:38912
    v_mfma_f32_16x16x32_bf16 v[52:55], v[196:199], v[164:167], v[52:55]
    ds_read_b128 v[128:131], v4 offset:40960
    v_mfma_f32_16x16x32_bf16 v[48:51], v[192:195], v[164:167], v[48:51]
    ds_read_b128 v[132:135], v4 offset:43008
    v_mfma_f32_16x16x32_bf16 v[56:59], v[192:195], v[168:171], v[56:59]
    ds_read_b128 v[136:139], v2 offset:36864
    v_mfma_f32_16x16x32_bf16 v[60:63], v[196:199], v[168:171], v[60:63]
    ds_read_b64_tr_b16 v[140:141], v6 offset:49152
    v_mfma_f32_16x16x32_bf16 v[28:31], v[188:191], v[168:171], v[28:31]
    ds_read_b64_tr_b16 v[142:143], v6 offset:49664
    v_mfma_f32_16x16x32_bf16 v[24:27], v[184:187], v[168:171], v[24:27]
    ds_read_b64_tr_b16 v[144:145], v7 offset:49152
    v_mfma_f32_16x16x32_bf16 v[32:35], v[184:187], v[172:175], v[32:35]
    ds_read_b64_tr_b16 v[146:147], v7 offset:49664
    v_mfma_f32_16x16x32_bf16 v[36:39], v[188:191], v[172:175], v[36:39]
    ds_read_b64_tr_b16 v[148:149], v6 offset:50176
    v_mfma_f32_16x16x32_bf16 v[68:71], v[196:199], v[172:175], v[68:71]
    ds_read_b64_tr_b16 v[150:151], v6 offset:50688
    v_mfma_f32_16x16x32_bf16 v[64:67], v[192:195], v[172:175], v[64:67]
    ds_read_b64_tr_b16 v[152:153], v7 offset:50176
    v_mfma_f32_16x16x32_bf16 v[112:115], v[192:195], v[180:183], v[112:115]
    ds_read_b64_tr_b16 v[154:155], v7 offset:50688
    v_mfma_f32_16x16x32_bf16 v[72:75], v[192:195], v[176:179], v[72:75]
    ds_read_b64_tr_b16 v[156:157], v6 offset:51200
    v_mfma_f32_16x16x32_bf16 v[76:79], v[196:199], v[176:179], v[76:79]
    ds_read_b64_tr_b16 v[158:159], v6 offset:51712
    v_mfma_f32_16x16x32_bf16 v[44:47], v[188:191], v[176:179], v[44:47]
    ds_read_b64_tr_b16 v[160:161], v7 offset:51200
    v_mfma_f32_16x16x32_bf16 v[40:43], v[184:187], v[176:179], v[40:43]
    ds_read_b64_tr_b16 v[162:163], v7 offset:51712
    v_mfma_f32_16x16x32_bf16 v[104:107], v[176:179], v[200:203], v[104:107]
    v_mfma_f32_16x16x32_bf16 v[108:111], v[176:179], v[204:207], v[108:111]
    v_mfma_f32_16x16x32_bf16 v[100:103], v[172:175], v[204:207], v[100:103]
    v_mfma_f32_16x16x32_bf16 v[96:99], v[172:175], v[200:203], v[96:99]
    v_mfma_f32_16x16x32_bf16 v[88:91], v[168:171], v[200:203], v[88:91]
    v_mfma_f32_16x16x32_bf16 v[92:95], v[168:171], v[204:207], v[92:95]
    v_mfma_f32_16x16x32_bf16 v[84:87], v[164:167], v[204:207], v[84:87]
    v_mfma_f32_16x16x32_bf16 v[80:83], v[164:167], v[200:203], v[80:83]
    v_mfma_f32_16x16x32_bf16 v[116:119], v[180:183], v[200:203], v[116:119]
    s_waitcnt lgkmcnt(0)
    v_mfma_f32_16x16x32_bf16 v[16:19], v[140:143], v[120:123], v[16:19]
    ds_read_b128 v[164:167], v5 offset:36864
    v_mfma_f32_16x16x32_bf16 v[20:23], v[144:147], v[120:123], v[20:23]
    ds_read_b128 v[168:171], v5 offset:38912
    v_mfma_f32_16x16x32_bf16 v[52:55], v[152:155], v[120:123], v[52:55]
    ds_read_b128 v[172:175], v5 offset:40960
    v_mfma_f32_16x16x32_bf16 v[48:51], v[148:151], v[120:123], v[48:51]
    ds_read_b128 v[176:179], v5 offset:43008
    v_mfma_f32_16x16x32_bf16 v[56:59], v[148:151], v[124:127], v[56:59]
    ds_read_b128 v[180:183], v3 offset:36864
    v_mfma_f32_16x16x32_bf16 v[60:63], v[152:155], v[124:127], v[60:63]
    ds_read_b64_tr_b16 v[184:185], v6 offset:61440
    v_mfma_f32_16x16x32_bf16 v[28:31], v[144:147], v[124:127], v[28:31]
    ds_read_b64_tr_b16 v[186:187], v6 offset:61952
    v_mfma_f32_16x16x32_bf16 v[24:27], v[140:143], v[124:127], v[24:27]
    ds_read_b64_tr_b16 v[188:189], v7 offset:61440
    v_mfma_f32_16x16x32_bf16 v[32:35], v[140:143], v[128:131], v[32:35]
    ds_read_b64_tr_b16 v[190:191], v7 offset:61952
    v_mfma_f32_16x16x32_bf16 v[36:39], v[144:147], v[128:131], v[36:39]
    ds_read_b64_tr_b16 v[192:193], v6 offset:62464
    v_mfma_f32_16x16x32_bf16 v[68:71], v[152:155], v[128:131], v[68:71]
    ds_read_b64_tr_b16 v[194:195], v6 offset:62976
    v_mfma_f32_16x16x32_bf16 v[64:67], v[148:151], v[128:131], v[64:67]
    ds_read_b64_tr_b16 v[196:197], v7 offset:62464
    v_mfma_f32_16x16x32_bf16 v[112:115], v[148:151], v[136:139], v[112:115]
    ds_read_b64_tr_b16 v[198:199], v7 offset:62976
    v_mfma_f32_16x16x32_bf16 v[72:75], v[148:151], v[132:135], v[72:75]
    ds_read_b64_tr_b16 v[200:201], v6 offset:63488
    v_mfma_f32_16x16x32_bf16 v[76:79], v[152:155], v[132:135], v[76:79]
    ds_read_b64_tr_b16 v[202:203], v6 offset:64000
    v_mfma_f32_16x16x32_bf16 v[44:47], v[144:147], v[132:135], v[44:47]
    ds_read_b64_tr_b16 v[204:205], v7 offset:63488
    v_mfma_f32_16x16x32_bf16 v[40:43], v[140:143], v[132:135], v[40:43]
    ds_read_b64_tr_b16 v[206:207], v7 offset:64000
    v_mfma_f32_16x16x32_bf16 v[104:107], v[132:135], v[156:159], v[104:107]
    v_mfma_f32_16x16x32_bf16 v[108:111], v[132:135], v[160:163], v[108:111]
    v_mfma_f32_16x16x32_bf16 v[100:103], v[128:131], v[160:163], v[100:103]
    v_mfma_f32_16x16x32_bf16 v[96:99], v[128:131], v[156:159], v[96:99]
    v_mfma_f32_16x16x32_bf16 v[88:91], v[124:127], v[156:159], v[88:91]
    v_mfma_f32_16x16x32_bf16 v[92:95], v[124:127], v[160:163], v[92:95]
    v_mfma_f32_16x16x32_bf16 v[84:87], v[120:123], v[160:163], v[84:87]
    v_mfma_f32_16x16x32_bf16 v[80:83], v[120:123], v[156:159], v[80:83]
    v_mfma_f32_16x16x32_bf16 v[116:119], v[136:139], v[156:159], v[116:119]
    s_waitcnt lgkmcnt(0)
    s_barrier
    v_mfma_f32_16x16x32_bf16 v[16:19], v[184:187], v[164:167], v[16:19]
    ds_read_b128 v[120:123], v4 offset:0
    v_mfma_f32_16x16x32_bf16 v[20:23], v[188:191], v[164:167], v[20:23]
    ds_read_b128 v[124:127], v4 offset:2048
    v_mfma_f32_16x16x32_bf16 v[52:55], v[196:199], v[164:167], v[52:55]
    ds_read_b128 v[128:131], v4 offset:4096
    v_mfma_f32_16x16x32_bf16 v[48:51], v[192:195], v[164:167], v[48:51]
    ds_read_b128 v[132:135], v4 offset:6144
    v_mfma_f32_16x16x32_bf16 v[56:59], v[192:195], v[168:171], v[56:59]
    ds_read_b128 v[136:139], v2 offset:0
    v_mfma_f32_16x16x32_bf16 v[60:63], v[196:199], v[168:171], v[60:63]
    ds_read_b64_tr_b16 v[140:141], v6 offset:0
    v_mfma_f32_16x16x32_bf16 v[28:31], v[188:191], v[168:171], v[28:31]
    ds_read_b64_tr_b16 v[142:143], v6 offset:512
    v_mfma_f32_16x16x32_bf16 v[24:27], v[184:187], v[168:171], v[24:27]
    ds_read_b64_tr_b16 v[144:145], v7 offset:0
    v_mfma_f32_16x16x32_bf16 v[32:35], v[184:187], v[172:175], v[32:35]
    ds_read_b64_tr_b16 v[146:147], v7 offset:512
    v_mfma_f32_16x16x32_bf16 v[36:39], v[188:191], v[172:175], v[36:39]
    ds_read_b64_tr_b16 v[148:149], v6 offset:1024
    v_mfma_f32_16x16x32_bf16 v[68:71], v[196:199], v[172:175], v[68:71]
    ds_read_b64_tr_b16 v[150:151], v6 offset:1536
    v_mfma_f32_16x16x32_bf16 v[64:67], v[192:195], v[172:175], v[64:67]
    ds_read_b64_tr_b16 v[152:153], v7 offset:1024
    v_mfma_f32_16x16x32_bf16 v[112:115], v[192:195], v[180:183], v[112:115]
    ds_read_b64_tr_b16 v[154:155], v7 offset:1536
    v_mfma_f32_16x16x32_bf16 v[72:75], v[192:195], v[176:179], v[72:75]
    ds_read_b64_tr_b16 v[156:157], v6 offset:2048
    v_mfma_f32_16x16x32_bf16 v[76:79], v[196:199], v[176:179], v[76:79]
    ds_read_b64_tr_b16 v[158:159], v6 offset:2560
    v_mfma_f32_16x16x32_bf16 v[44:47], v[188:191], v[176:179], v[44:47]
    ds_read_b64_tr_b16 v[160:161], v7 offset:2048
    v_mfma_f32_16x16x32_bf16 v[40:43], v[184:187], v[176:179], v[40:43]
    ds_read_b64_tr_b16 v[162:163], v7 offset:2560
    v_mfma_f32_16x16x32_bf16 v[104:107], v[176:179], v[200:203], v[104:107]
    v_mfma_f32_16x16x32_bf16 v[108:111], v[176:179], v[204:207], v[108:111]
    v_mfma_f32_16x16x32_bf16 v[100:103], v[172:175], v[204:207], v[100:103]
    v_mfma_f32_16x16x32_bf16 v[96:99], v[172:175], v[200:203], v[96:99]
    v_mfma_f32_16x16x32_bf16 v[88:91], v[168:171], v[200:203], v[88:91]
    v_mfma_f32_16x16x32_bf16 v[92:95], v[168:171], v[204:207], v[92:95]
    v_mfma_f32_16x16x32_bf16 v[84:87], v[164:167], v[204:207], v[84:87]
    v_mfma_f32_16x16x32_bf16 v[80:83], v[164:167], v[200:203], v[80:83]
    v_mfma_f32_16x16x32_bf16 v[116:119], v[180:183], v[200:203], v[116:119]
    s_waitcnt lgkmcnt(0)
    v_mfma_f32_16x16x32_bf16 v[16:19], v[140:143], v[120:123], v[16:19]
    ds_read_b128 v[164:167], v5 offset:0
    v_mfma_f32_16x16x32_bf16 v[20:23], v[144:147], v[120:123], v[20:23]
    ds_read_b128 v[168:171], v5 offset:2048
    v_mfma_f32_16x16x32_bf16 v[52:55], v[152:155], v[120:123], v[52:55]
    ds_read_b128 v[172:175], v5 offset:4096
    v_mfma_f32_16x16x32_bf16 v[48:51], v[148:151], v[120:123], v[48:51]
    ds_read_b128 v[176:179], v5 offset:6144
    v_mfma_f32_16x16x32_bf16 v[56:59], v[148:151], v[124:127], v[56:59]
    ds_read_b128 v[180:183], v3 offset:0
    v_mfma_f32_16x16x32_bf16 v[60:63], v[152:155], v[124:127], v[60:63]
    ds_read_b64_tr_b16 v[184:185], v6 offset:12288
    v_mfma_f32_16x16x32_bf16 v[28:31], v[144:147], v[124:127], v[28:31]
    ds_read_b64_tr_b16 v[186:187], v6 offset:12800
    v_mfma_f32_16x16x32_bf16 v[24:27], v[140:143], v[124:127], v[24:27]
    ds_read_b64_tr_b16 v[188:189], v7 offset:12288
    v_mfma_f32_16x16x32_bf16 v[32:35], v[140:143], v[128:131], v[32:35]
    ds_read_b64_tr_b16 v[190:191], v7 offset:12800
    v_mfma_f32_16x16x32_bf16 v[36:39], v[144:147], v[128:131], v[36:39]
    ds_read_b64_tr_b16 v[192:193], v6 offset:13312
    v_mfma_f32_16x16x32_bf16 v[68:71], v[152:155], v[128:131], v[68:71]
    ds_read_b64_tr_b16 v[194:195], v6 offset:13824
    v_mfma_f32_16x16x32_bf16 v[64:67], v[148:151], v[128:131], v[64:67]
    ds_read_b64_tr_b16 v[196:197], v7 offset:13312
    v_mfma_f32_16x16x32_bf16 v[112:115], v[148:151], v[136:139], v[112:115]
    ds_read_b64_tr_b16 v[198:199], v7 offset:13824
    v_mfma_f32_16x16x32_bf16 v[72:75], v[148:151], v[132:135], v[72:75]
    ds_read_b64_tr_b16 v[200:201], v6 offset:14336
    v_mfma_f32_16x16x32_bf16 v[76:79], v[152:155], v[132:135], v[76:79]
    ds_read_b64_tr_b16 v[202:203], v6 offset:14848
    v_mfma_f32_16x16x32_bf16 v[44:47], v[144:147], v[132:135], v[44:47]
    ds_read_b64_tr_b16 v[204:205], v7 offset:14336
    v_mfma_f32_16x16x32_bf16 v[40:43], v[140:143], v[132:135], v[40:43]
    ds_read_b64_tr_b16 v[206:207], v7 offset:14848
    v_mfma_f32_16x16x32_bf16 v[104:107], v[132:135], v[156:159], v[104:107]
    v_mfma_f32_16x16x32_bf16 v[108:111], v[132:135], v[160:163], v[108:111]
    v_mfma_f32_16x16x32_bf16 v[100:103], v[128:131], v[160:163], v[100:103]
    v_mfma_f32_16x16x32_bf16 v[96:99], v[128:131], v[156:159], v[96:99]
    v_mfma_f32_16x16x32_bf16 v[88:91], v[124:127], v[156:159], v[88:91]
    v_mfma_f32_16x16x32_bf16 v[92:95], v[124:127], v[160:163], v[92:95]
    v_mfma_f32_16x16x32_bf16 v[84:87], v[120:123], v[160:163], v[84:87]
    v_mfma_f32_16x16x32_bf16 v[80:83], v[120:123], v[156:159], v[80:83]
    v_mfma_f32_16x16x32_bf16 v[116:119], v[136:139], v[156:159], v[116:119]
    s_waitcnt lgkmcnt(0)
    s_barrier
    v_mfma_f32_16x16x32_bf16 v[16:19], v[184:187], v[164:167], v[16:19]
    ds_read_b128 v[120:123], v4 offset:18432
    v_mfma_f32_16x16x32_bf16 v[20:23], v[188:191], v[164:167], v[20:23]
    ds_read_b128 v[124:127], v4 offset:20480
    v_mfma_f32_16x16x32_bf16 v[52:55], v[196:199], v[164:167], v[52:55]
    ds_read_b128 v[128:131], v4 offset:22528
    v_mfma_f32_16x16x32_bf16 v[48:51], v[192:195], v[164:167], v[48:51]
    ds_read_b128 v[132:135], v4 offset:24576
    v_mfma_f32_16x16x32_bf16 v[56:59], v[192:195], v[168:171], v[56:59]
    ds_read_b128 v[136:139], v2 offset:18432
    v_mfma_f32_16x16x32_bf16 v[60:63], v[196:199], v[168:171], v[60:63]
    ds_read_b64_tr_b16 v[140:141], v6 offset:24576
    v_mfma_f32_16x16x32_bf16 v[28:31], v[188:191], v[168:171], v[28:31]
    ds_read_b64_tr_b16 v[142:143], v6 offset:25088
    v_mfma_f32_16x16x32_bf16 v[24:27], v[184:187], v[168:171], v[24:27]
    ds_read_b64_tr_b16 v[144:145], v7 offset:24576
    v_mfma_f32_16x16x32_bf16 v[32:35], v[184:187], v[172:175], v[32:35]
    ds_read_b64_tr_b16 v[146:147], v7 offset:25088
    v_mfma_f32_16x16x32_bf16 v[36:39], v[188:191], v[172:175], v[36:39]
    ds_read_b64_tr_b16 v[148:149], v6 offset:25600
    v_mfma_f32_16x16x32_bf16 v[68:71], v[196:199], v[172:175], v[68:71]
    ds_read_b64_tr_b16 v[150:151], v6 offset:26112
    v_mfma_f32_16x16x32_bf16 v[64:67], v[192:195], v[172:175], v[64:67]
    ds_read_b64_tr_b16 v[152:153], v7 offset:25600
    v_mfma_f32_16x16x32_bf16 v[112:115], v[192:195], v[180:183], v[112:115]
    ds_read_b64_tr_b16 v[154:155], v7 offset:26112
    v_mfma_f32_16x16x32_bf16 v[72:75], v[192:195], v[176:179], v[72:75]
    ds_read_b64_tr_b16 v[156:157], v6 offset:26624
    v_mfma_f32_16x16x32_bf16 v[76:79], v[196:199], v[176:179], v[76:79]
    ds_read_b64_tr_b16 v[158:159], v6 offset:27136
    v_mfma_f32_16x16x32_bf16 v[44:47], v[188:191], v[176:179], v[44:47]
    ds_read_b64_tr_b16 v[160:161], v7 offset:26624
    v_mfma_f32_16x16x32_bf16 v[40:43], v[184:187], v[176:179], v[40:43]
    ds_read_b64_tr_b16 v[162:163], v7 offset:27136
    v_mfma_f32_16x16x32_bf16 v[104:107], v[176:179], v[200:203], v[104:107]
    v_mfma_f32_16x16x32_bf16 v[108:111], v[176:179], v[204:207], v[108:111]
    v_mfma_f32_16x16x32_bf16 v[100:103], v[172:175], v[204:207], v[100:103]
    v_mfma_f32_16x16x32_bf16 v[96:99], v[172:175], v[200:203], v[96:99]
    v_mfma_f32_16x16x32_bf16 v[88:91], v[168:171], v[200:203], v[88:91]
    v_mfma_f32_16x16x32_bf16 v[92:95], v[168:171], v[204:207], v[92:95]
    v_mfma_f32_16x16x32_bf16 v[84:87], v[164:167], v[204:207], v[84:87]
    v_mfma_f32_16x16x32_bf16 v[80:83], v[164:167], v[200:203], v[80:83]
    v_mfma_f32_16x16x32_bf16 v[116:119], v[180:183], v[200:203], v[116:119]
    s_waitcnt lgkmcnt(0)
    v_mfma_f32_16x16x32_bf16 v[16:19], v[140:143], v[120:123], v[16:19]
    ds_read_b128 v[164:167], v5 offset:18432
    v_mfma_f32_16x16x32_bf16 v[20:23], v[144:147], v[120:123], v[20:23]
    ds_read_b128 v[168:171], v5 offset:20480
    v_mfma_f32_16x16x32_bf16 v[52:55], v[152:155], v[120:123], v[52:55]
    ds_read_b128 v[172:175], v5 offset:22528
    v_mfma_f32_16x16x32_bf16 v[48:51], v[148:151], v[120:123], v[48:51]
    ds_read_b128 v[176:179], v5 offset:24576
    v_mfma_f32_16x16x32_bf16 v[56:59], v[148:151], v[124:127], v[56:59]
    ds_read_b128 v[180:183], v3 offset:18432
    v_mfma_f32_16x16x32_bf16 v[60:63], v[152:155], v[124:127], v[60:63]
    ds_read_b64_tr_b16 v[184:185], v6 offset:36864
    v_mfma_f32_16x16x32_bf16 v[28:31], v[144:147], v[124:127], v[28:31]
    ds_read_b64_tr_b16 v[186:187], v6 offset:37376
    v_mfma_f32_16x16x32_bf16 v[24:27], v[140:143], v[124:127], v[24:27]
    ds_read_b64_tr_b16 v[188:189], v7 offset:36864
    v_mfma_f32_16x16x32_bf16 v[32:35], v[140:143], v[128:131], v[32:35]
    ds_read_b64_tr_b16 v[190:191], v7 offset:37376
    v_mfma_f32_16x16x32_bf16 v[36:39], v[144:147], v[128:131], v[36:39]
    ds_read_b64_tr_b16 v[192:193], v6 offset:37888
    v_mfma_f32_16x16x32_bf16 v[68:71], v[152:155], v[128:131], v[68:71]
    ds_read_b64_tr_b16 v[194:195], v6 offset:38400
    v_mfma_f32_16x16x32_bf16 v[64:67], v[148:151], v[128:131], v[64:67]
    ds_read_b64_tr_b16 v[196:197], v7 offset:37888
    v_mfma_f32_16x16x32_bf16 v[112:115], v[148:151], v[136:139], v[112:115]
    ds_read_b64_tr_b16 v[198:199], v7 offset:38400
    v_mfma_f32_16x16x32_bf16 v[72:75], v[148:151], v[132:135], v[72:75]
    ds_read_b64_tr_b16 v[200:201], v6 offset:38912
    v_mfma_f32_16x16x32_bf16 v[76:79], v[152:155], v[132:135], v[76:79]
    ds_read_b64_tr_b16 v[202:203], v6 offset:39424
    v_mfma_f32_16x16x32_bf16 v[44:47], v[144:147], v[132:135], v[44:47]
    ds_read_b64_tr_b16 v[204:205], v7 offset:38912
    v_mfma_f32_16x16x32_bf16 v[40:43], v[140:143], v[132:135], v[40:43]
    ds_read_b64_tr_b16 v[206:207], v7 offset:39424
    v_mfma_f32_16x16x32_bf16 v[104:107], v[132:135], v[156:159], v[104:107]
    v_mfma_f32_16x16x32_bf16 v[108:111], v[132:135], v[160:163], v[108:111]
    v_mfma_f32_16x16x32_bf16 v[100:103], v[128:131], v[160:163], v[100:103]
    v_mfma_f32_16x16x32_bf16 v[96:99], v[128:131], v[156:159], v[96:99]
    v_mfma_f32_16x16x32_bf16 v[88:91], v[124:127], v[156:159], v[88:91]
    v_mfma_f32_16x16x32_bf16 v[92:95], v[124:127], v[160:163], v[92:95]
    v_mfma_f32_16x16x32_bf16 v[84:87], v[120:123], v[160:163], v[84:87]
    v_mfma_f32_16x16x32_bf16 v[80:83], v[120:123], v[156:159], v[80:83]
    v_mfma_f32_16x16x32_bf16 v[116:119], v[136:139], v[156:159], v[116:119]
    s_waitcnt lgkmcnt(0)
    s_barrier
    v_mfma_f32_16x16x32_bf16 v[16:19], v[184:187], v[164:167], v[16:19]
    ds_read_b128 v[120:123], v4 offset:36864
    v_mfma_f32_16x16x32_bf16 v[20:23], v[188:191], v[164:167], v[20:23]
    ds_read_b128 v[124:127], v4 offset:38912
    v_mfma_f32_16x16x32_bf16 v[52:55], v[196:199], v[164:167], v[52:55]
    ds_read_b128 v[128:131], v4 offset:40960
    v_mfma_f32_16x16x32_bf16 v[48:51], v[192:195], v[164:167], v[48:51]
    ds_read_b128 v[132:135], v4 offset:43008
    v_mfma_f32_16x16x32_bf16 v[56:59], v[192:195], v[168:171], v[56:59]
    ds_read_b128 v[136:139], v2 offset:36864
    v_mfma_f32_16x16x32_bf16 v[60:63], v[196:199], v[168:171], v[60:63]
    ds_read_b64_tr_b16 v[140:141], v6 offset:49152
    v_mfma_f32_16x16x32_bf16 v[28:31], v[188:191], v[168:171], v[28:31]
    ds_read_b64_tr_b16 v[142:143], v6 offset:49664
    v_mfma_f32_16x16x32_bf16 v[24:27], v[184:187], v[168:171], v[24:27]
    ds_read_b64_tr_b16 v[144:145], v7 offset:49152
    v_mfma_f32_16x16x32_bf16 v[32:35], v[184:187], v[172:175], v[32:35]
    ds_read_b64_tr_b16 v[146:147], v7 offset:49664
    v_mfma_f32_16x16x32_bf16 v[36:39], v[188:191], v[172:175], v[36:39]
    ds_read_b64_tr_b16 v[148:149], v6 offset:50176
    v_mfma_f32_16x16x32_bf16 v[68:71], v[196:199], v[172:175], v[68:71]
    ds_read_b64_tr_b16 v[150:151], v6 offset:50688
    v_mfma_f32_16x16x32_bf16 v[64:67], v[192:195], v[172:175], v[64:67]
    ds_read_b64_tr_b16 v[152:153], v7 offset:50176
    v_mfma_f32_16x16x32_bf16 v[112:115], v[192:195], v[180:183], v[112:115]
    ds_read_b64_tr_b16 v[154:155], v7 offset:50688
    v_mfma_f32_16x16x32_bf16 v[72:75], v[192:195], v[176:179], v[72:75]
    ds_read_b64_tr_b16 v[156:157], v6 offset:51200
    v_mfma_f32_16x16x32_bf16 v[76:79], v[196:199], v[176:179], v[76:79]
    ds_read_b64_tr_b16 v[158:159], v6 offset:51712
    v_mfma_f32_16x16x32_bf16 v[44:47], v[188:191], v[176:179], v[44:47]
    ds_read_b64_tr_b16 v[160:161], v7 offset:51200
    v_mfma_f32_16x16x32_bf16 v[40:43], v[184:187], v[176:179], v[40:43]
    ds_read_b64_tr_b16 v[162:163], v7 offset:51712
    v_mfma_f32_16x16x32_bf16 v[104:107], v[176:179], v[200:203], v[104:107]
    v_mfma_f32_16x16x32_bf16 v[108:111], v[176:179], v[204:207], v[108:111]
    v_mfma_f32_16x16x32_bf16 v[100:103], v[172:175], v[204:207], v[100:103]
    v_mfma_f32_16x16x32_bf16 v[96:99], v[172:175], v[200:203], v[96:99]
    v_mfma_f32_16x16x32_bf16 v[88:91], v[168:171], v[200:203], v[88:91]
    v_mfma_f32_16x16x32_bf16 v[92:95], v[168:171], v[204:207], v[92:95]
    v_mfma_f32_16x16x32_bf16 v[84:87], v[164:167], v[204:207], v[84:87]
    v_mfma_f32_16x16x32_bf16 v[80:83], v[164:167], v[200:203], v[80:83]
    v_mfma_f32_16x16x32_bf16 v[116:119], v[180:183], v[200:203], v[116:119]
    s_waitcnt lgkmcnt(0)
    v_mfma_f32_16x16x32_bf16 v[16:19], v[140:143], v[120:123], v[16:19]
    ds_read_b128 v[164:167], v5 offset:36864
    v_mfma_f32_16x16x32_bf16 v[20:23], v[144:147], v[120:123], v[20:23]
    ds_read_b128 v[168:171], v5 offset:38912
    v_mfma_f32_16x16x32_bf16 v[52:55], v[152:155], v[120:123], v[52:55]
    ds_read_b128 v[172:175], v5 offset:40960
    v_mfma_f32_16x16x32_bf16 v[48:51], v[148:151], v[120:123], v[48:51]
    ds_read_b128 v[176:179], v5 offset:43008
    v_mfma_f32_16x16x32_bf16 v[56:59], v[148:151], v[124:127], v[56:59]
    ds_read_b128 v[180:183], v3 offset:36864
    v_mfma_f32_16x16x32_bf16 v[60:63], v[152:155], v[124:127], v[60:63]
    ds_read_b64_tr_b16 v[184:185], v6 offset:61440
    v_mfma_f32_16x16x32_bf16 v[28:31], v[144:147], v[124:127], v[28:31]
    ds_read_b64_tr_b16 v[186:187], v6 offset:61952
    v_mfma_f32_16x16x32_bf16 v[24:27], v[140:143], v[124:127], v[24:27]
    ds_read_b64_tr_b16 v[188:189], v7 offset:61440
    v_mfma_f32_16x16x32_bf16 v[32:35], v[140:143], v[128:131], v[32:35]
    ds_read_b64_tr_b16 v[190:191], v7 offset:61952
    v_mfma_f32_16x16x32_bf16 v[36:39], v[144:147], v[128:131], v[36:39]
    ds_read_b64_tr_b16 v[192:193], v6 offset:62464
    v_mfma_f32_16x16x32_bf16 v[68:71], v[152:155], v[128:131], v[68:71]
    ds_read_b64_tr_b16 v[194:195], v6 offset:62976
    v_mfma_f32_16x16x32_bf16 v[64:67], v[148:151], v[128:131], v[64:67]
    ds_read_b64_tr_b16 v[196:197], v7 offset:62464
    v_mfma_f32_16x16x32_bf16 v[112:115], v[148:151], v[136:139], v[112:115]
    ds_read_b64_tr_b16 v[198:199], v7 offset:62976
    v_mfma_f32_16x16x32_bf16 v[72:75], v[148:151], v[132:135], v[72:75]
    ds_read_b64_tr_b16 v[200:201], v6 offset:63488
    v_mfma_f32_16x16x32_bf16 v[76:79], v[152:155], v[132:135], v[76:79]
    ds_read_b64_tr_b16 v[202:203], v6 offset:64000
    v_mfma_f32_16x16x32_bf16 v[44:47], v[144:147], v[132:135], v[44:47]
    ds_read_b64_tr_b16 v[204:205], v7 offset:63488
    v_mfma_f32_16x16x32_bf16 v[40:43], v[140:143], v[132:135], v[40:43]
    ds_read_b64_tr_b16 v[206:207], v7 offset:64000
    v_mfma_f32_16x16x32_bf16 v[104:107], v[132:135], v[156:159], v[104:107]
    v_mfma_f32_16x16x32_bf16 v[108:111], v[132:135], v[160:163], v[108:111]
    v_mfma_f32_16x16x32_bf16 v[100:103], v[128:131], v[160:163], v[100:103]
    v_mfma_f32_16x16x32_bf16 v[96:99], v[128:131], v[156:159], v[96:99]
    v_mfma_f32_16x16x32_bf16 v[88:91], v[124:127], v[156:159], v[88:91]
    v_mfma_f32_16x16x32_bf16 v[92:95], v[124:127], v[160:163], v[92:95]
    v_mfma_f32_16x16x32_bf16 v[84:87], v[120:123], v[160:163], v[84:87]
    v_mfma_f32_16x16x32_bf16 v[80:83], v[120:123], v[156:159], v[80:83]
    v_mfma_f32_16x16x32_bf16 v[116:119], v[136:139], v[156:159], v[116:119]
    s_waitcnt lgkmcnt(0)
    s_barrier
    v_mfma_f32_16x16x32_bf16 v[16:19], v[184:187], v[164:167], v[16:19]
    ds_read_b128 v[120:123], v4 offset:0
    v_mfma_f32_16x16x32_bf16 v[20:23], v[188:191], v[164:167], v[20:23]
    ds_read_b128 v[124:127], v4 offset:2048
    v_mfma_f32_16x16x32_bf16 v[52:55], v[196:199], v[164:167], v[52:55]
    ds_read_b128 v[128:131], v4 offset:4096
    v_mfma_f32_16x16x32_bf16 v[48:51], v[192:195], v[164:167], v[48:51]
    ds_read_b128 v[132:135], v4 offset:6144
    v_mfma_f32_16x16x32_bf16 v[56:59], v[192:195], v[168:171], v[56:59]
    ds_read_b128 v[136:139], v2 offset:0
    v_mfma_f32_16x16x32_bf16 v[60:63], v[196:199], v[168:171], v[60:63]
    ds_read_b64_tr_b16 v[140:141], v6 offset:0
    v_mfma_f32_16x16x32_bf16 v[28:31], v[188:191], v[168:171], v[28:31]
    ds_read_b64_tr_b16 v[142:143], v6 offset:512
    v_mfma_f32_16x16x32_bf16 v[24:27], v[184:187], v[168:171], v[24:27]
    ds_read_b64_tr_b16 v[144:145], v7 offset:0
    v_mfma_f32_16x16x32_bf16 v[32:35], v[184:187], v[172:175], v[32:35]
    ds_read_b64_tr_b16 v[146:147], v7 offset:512
    v_mfma_f32_16x16x32_bf16 v[36:39], v[188:191], v[172:175], v[36:39]
    ds_read_b64_tr_b16 v[148:149], v6 offset:1024
    v_mfma_f32_16x16x32_bf16 v[68:71], v[196:199], v[172:175], v[68:71]
    ds_read_b64_tr_b16 v[150:151], v6 offset:1536
    v_mfma_f32_16x16x32_bf16 v[64:67], v[192:195], v[172:175], v[64:67]
    ds_read_b64_tr_b16 v[152:153], v7 offset:1024
    v_mfma_f32_16x16x32_bf16 v[112:115], v[192:195], v[180:183], v[112:115]
    ds_read_b64_tr_b16 v[154:155], v7 offset:1536
    v_mfma_f32_16x16x32_bf16 v[72:75], v[192:195], v[176:179], v[72:75]
    ds_read_b64_tr_b16 v[156:157], v6 offset:2048
    v_mfma_f32_16x16x32_bf16 v[76:79], v[196:199], v[176:179], v[76:79]
    ds_read_b64_tr_b16 v[158:159], v6 offset:2560
    v_mfma_f32_16x16x32_bf16 v[44:47], v[188:191], v[176:179], v[44:47]
    ds_read_b64_tr_b16 v[160:161], v7 offset:2048
    v_mfma_f32_16x16x32_bf16 v[40:43], v[184:187], v[176:179], v[40:43]
    ds_read_b64_tr_b16 v[162:163], v7 offset:2560
    v_mfma_f32_16x16x32_bf16 v[104:107], v[176:179], v[200:203], v[104:107]
    v_mfma_f32_16x16x32_bf16 v[108:111], v[176:179], v[204:207], v[108:111]
    v_mfma_f32_16x16x32_bf16 v[100:103], v[172:175], v[204:207], v[100:103]
    v_mfma_f32_16x16x32_bf16 v[96:99], v[172:175], v[200:203], v[96:99]
    v_mfma_f32_16x16x32_bf16 v[88:91], v[168:171], v[200:203], v[88:91]
    v_mfma_f32_16x16x32_bf16 v[92:95], v[168:171], v[204:207], v[92:95]
    v_mfma_f32_16x16x32_bf16 v[84:87], v[164:167], v[204:207], v[84:87]
    v_mfma_f32_16x16x32_bf16 v[80:83], v[164:167], v[200:203], v[80:83]
    v_mfma_f32_16x16x32_bf16 v[116:119], v[180:183], v[200:203], v[116:119]
    s_waitcnt lgkmcnt(0)
    v_mfma_f32_16x16x32_bf16 v[16:19], v[140:143], v[120:123], v[16:19]
    ds_read_b128 v[164:167], v5 offset:0
    v_mfma_f32_16x16x32_bf16 v[20:23], v[144:147], v[120:123], v[20:23]
    ds_read_b128 v[168:171], v5 offset:2048
    v_mfma_f32_16x16x32_bf16 v[52:55], v[152:155], v[120:123], v[52:55]
    ds_read_b128 v[172:175], v5 offset:4096
    v_mfma_f32_16x16x32_bf16 v[48:51], v[148:151], v[120:123], v[48:51]
    ds_read_b128 v[176:179], v5 offset:6144
    v_mfma_f32_16x16x32_bf16 v[56:59], v[148:151], v[124:127], v[56:59]
    ds_read_b128 v[180:183], v3 offset:0
    v_mfma_f32_16x16x32_bf16 v[60:63], v[152:155], v[124:127], v[60:63]
    ds_read_b64_tr_b16 v[184:185], v6 offset:12288
    v_mfma_f32_16x16x32_bf16 v[28:31], v[144:147], v[124:127], v[28:31]
    ds_read_b64_tr_b16 v[186:187], v6 offset:12800
    v_mfma_f32_16x16x32_bf16 v[24:27], v[140:143], v[124:127], v[24:27]
    ds_read_b64_tr_b16 v[188:189], v7 offset:12288
    v_mfma_f32_16x16x32_bf16 v[32:35], v[140:143], v[128:131], v[32:35]
    ds_read_b64_tr_b16 v[190:191], v7 offset:12800
    v_mfma_f32_16x16x32_bf16 v[36:39], v[144:147], v[128:131], v[36:39]
    ds_read_b64_tr_b16 v[192:193], v6 offset:13312
    v_mfma_f32_16x16x32_bf16 v[68:71], v[152:155], v[128:131], v[68:71]
    ds_read_b64_tr_b16 v[194:195], v6 offset:13824
    v_mfma_f32_16x16x32_bf16 v[64:67], v[148:151], v[128:131], v[64:67]
    ds_read_b64_tr_b16 v[196:197], v7 offset:13312
    v_mfma_f32_16x16x32_bf16 v[112:115], v[148:151], v[136:139], v[112:115]
    ds_read_b64_tr_b16 v[198:199], v7 offset:13824
    v_mfma_f32_16x16x32_bf16 v[72:75], v[148:151], v[132:135], v[72:75]
    ds_read_b64_tr_b16 v[200:201], v6 offset:14336
    v_mfma_f32_16x16x32_bf16 v[76:79], v[152:155], v[132:135], v[76:79]
    ds_read_b64_tr_b16 v[202:203], v6 offset:14848
    v_mfma_f32_16x16x32_bf16 v[44:47], v[144:147], v[132:135], v[44:47]
    ds_read_b64_tr_b16 v[204:205], v7 offset:14336
    v_mfma_f32_16x16x32_bf16 v[40:43], v[140:143], v[132:135], v[40:43]
    ds_read_b64_tr_b16 v[206:207], v7 offset:14848
    v_mfma_f32_16x16x32_bf16 v[104:107], v[132:135], v[156:159], v[104:107]
    buffer_load_dword v222, v220, s[68:71], s98 offen sc1
    v_mfma_f32_16x16x32_bf16 v[108:111], v[132:135], v[160:163], v[108:111]
    v_mfma_f32_16x16x32_bf16 v[100:103], v[128:131], v[160:163], v[100:103]
    v_mfma_f32_16x16x32_bf16 v[96:99], v[128:131], v[156:159], v[96:99]
    v_mfma_f32_16x16x32_bf16 v[88:91], v[124:127], v[156:159], v[88:91]
    v_mfma_f32_16x16x32_bf16 v[92:95], v[124:127], v[160:163], v[92:95]
    v_mfma_f32_16x16x32_bf16 v[84:87], v[120:123], v[160:163], v[84:87]
    v_mfma_f32_16x16x32_bf16 v[80:83], v[120:123], v[156:159], v[80:83]
    v_mfma_f32_16x16x32_bf16 v[116:119], v[136:139], v[156:159], v[116:119]
    s_waitcnt lgkmcnt(0)
    s_barrier
    v_mfma_f32_16x16x32_bf16 v[16:19], v[184:187], v[164:167], v[16:19]
    ds_read_b128 v[120:123], v4 offset:18432
    v_mfma_f32_16x16x32_bf16 v[20:23], v[188:191], v[164:167], v[20:23]
    ds_read_b128 v[124:127], v4 offset:20480
    v_mfma_f32_16x16x32_bf16 v[52:55], v[196:199], v[164:167], v[52:55]
    ds_read_b128 v[128:131], v4 offset:22528
    v_mfma_f32_16x16x32_bf16 v[48:51], v[192:195], v[164:167], v[48:51]
    ds_read_b128 v[132:135], v4 offset:24576
    v_mfma_f32_16x16x32_bf16 v[56:59], v[192:195], v[168:171], v[56:59]
    ds_read_b128 v[136:139], v2 offset:18432
    v_mfma_f32_16x16x32_bf16 v[60:63], v[196:199], v[168:171], v[60:63]
    ds_read_b64_tr_b16 v[140:141], v6 offset:24576
    v_mfma_f32_16x16x32_bf16 v[28:31], v[188:191], v[168:171], v[28:31]
    ds_read_b64_tr_b16 v[142:143], v6 offset:25088
    v_mfma_f32_16x16x32_bf16 v[24:27], v[184:187], v[168:171], v[24:27]
    ds_read_b64_tr_b16 v[144:145], v7 offset:24576
    v_mfma_f32_16x16x32_bf16 v[32:35], v[184:187], v[172:175], v[32:35]
    ds_read_b64_tr_b16 v[146:147], v7 offset:25088
    v_mfma_f32_16x16x32_bf16 v[36:39], v[188:191], v[172:175], v[36:39]
    ds_read_b64_tr_b16 v[148:149], v6 offset:25600
    v_mfma_f32_16x16x32_bf16 v[68:71], v[196:199], v[172:175], v[68:71]
    ds_read_b64_tr_b16 v[150:151], v6 offset:26112
    v_mfma_f32_16x16x32_bf16 v[64:67], v[192:195], v[172:175], v[64:67]
    ds_read_b64_tr_b16 v[152:153], v7 offset:25600
    v_mfma_f32_16x16x32_bf16 v[112:115], v[192:195], v[180:183], v[112:115]
    ds_read_b64_tr_b16 v[154:155], v7 offset:26112
    v_mfma_f32_16x16x32_bf16 v[72:75], v[192:195], v[176:179], v[72:75]
    ds_read_b64_tr_b16 v[156:157], v6 offset:26624
    v_mfma_f32_16x16x32_bf16 v[76:79], v[196:199], v[176:179], v[76:79]
    ds_read_b64_tr_b16 v[158:159], v6 offset:27136
    v_mfma_f32_16x16x32_bf16 v[44:47], v[188:191], v[176:179], v[44:47]
    ds_read_b64_tr_b16 v[160:161], v7 offset:26624
    v_mfma_f32_16x16x32_bf16 v[40:43], v[184:187], v[176:179], v[40:43]
    ds_read_b64_tr_b16 v[162:163], v7 offset:27136
    v_mfma_f32_16x16x32_bf16 v[104:107], v[176:179], v[200:203], v[104:107]
    v_mfma_f32_16x16x32_bf16 v[108:111], v[176:179], v[204:207], v[108:111]
    v_mfma_f32_16x16x32_bf16 v[100:103], v[172:175], v[204:207], v[100:103]
    v_mfma_f32_16x16x32_bf16 v[96:99], v[172:175], v[200:203], v[96:99]
    v_mfma_f32_16x16x32_bf16 v[88:91], v[168:171], v[200:203], v[88:91]
    v_mfma_f32_16x16x32_bf16 v[92:95], v[168:171], v[204:207], v[92:95]
    v_mfma_f32_16x16x32_bf16 v[84:87], v[164:167], v[204:207], v[84:87]
    v_mfma_f32_16x16x32_bf16 v[80:83], v[164:167], v[200:203], v[80:83]
    v_mfma_f32_16x16x32_bf16 v[116:119], v[180:183], v[200:203], v[116:119]
    s_waitcnt lgkmcnt(0)
    v_mfma_f32_16x16x32_bf16 v[16:19], v[140:143], v[120:123], v[16:19]
    ds_read_b128 v[164:167], v5 offset:18432
    v_mfma_f32_16x16x32_bf16 v[20:23], v[144:147], v[120:123], v[20:23]
    ds_read_b128 v[168:171], v5 offset:20480
    v_mfma_f32_16x16x32_bf16 v[52:55], v[152:155], v[120:123], v[52:55]
    ds_read_b128 v[172:175], v5 offset:22528
    v_mfma_f32_16x16x32_bf16 v[48:51], v[148:151], v[120:123], v[48:51]
    ds_read_b128 v[176:179], v5 offset:24576
    v_mfma_f32_16x16x32_bf16 v[56:59], v[148:151], v[124:127], v[56:59]
    ds_read_b128 v[180:183], v3 offset:18432
    v_mfma_f32_16x16x32_bf16 v[60:63], v[152:155], v[124:127], v[60:63]
    ds_read_b64_tr_b16 v[184:185], v6 offset:36864
    v_mfma_f32_16x16x32_bf16 v[28:31], v[144:147], v[124:127], v[28:31]
    ds_read_b64_tr_b16 v[186:187], v6 offset:37376
    v_mfma_f32_16x16x32_bf16 v[24:27], v[140:143], v[124:127], v[24:27]
    ds_read_b64_tr_b16 v[188:189], v7 offset:36864
    v_mfma_f32_16x16x32_bf16 v[32:35], v[140:143], v[128:131], v[32:35]
    ds_read_b64_tr_b16 v[190:191], v7 offset:37376
    v_mfma_f32_16x16x32_bf16 v[36:39], v[144:147], v[128:131], v[36:39]
    ds_read_b64_tr_b16 v[192:193], v6 offset:37888
    v_mfma_f32_16x16x32_bf16 v[68:71], v[152:155], v[128:131], v[68:71]
    ds_read_b64_tr_b16 v[194:195], v6 offset:38400
    v_mfma_f32_16x16x32_bf16 v[64:67], v[148:151], v[128:131], v[64:67]
    ds_read_b64_tr_b16 v[196:197], v7 offset:37888
    v_mfma_f32_16x16x32_bf16 v[112:115], v[148:151], v[136:139], v[112:115]
    ds_read_b64_tr_b16 v[198:199], v7 offset:38400
    v_mfma_f32_16x16x32_bf16 v[72:75], v[148:151], v[132:135], v[72:75]
    ds_read_b64_tr_b16 v[200:201], v6 offset:38912
    v_mfma_f32_16x16x32_bf16 v[76:79], v[152:155], v[132:135], v[76:79]
    ds_read_b64_tr_b16 v[202:203], v6 offset:39424
    v_mfma_f32_16x16x32_bf16 v[44:47], v[144:147], v[132:135], v[44:47]
    ds_read_b64_tr_b16 v[204:205], v7 offset:38912
    v_mfma_f32_16x16x32_bf16 v[40:43], v[140:143], v[132:135], v[40:43]
    ds_read_b64_tr_b16 v[206:207], v7 offset:39424
    v_mfma_f32_16x16x32_bf16 v[104:107], v[132:135], v[156:159], v[104:107]
    v_mfma_f32_16x16x32_bf16 v[108:111], v[132:135], v[160:163], v[108:111]
    v_mfma_f32_16x16x32_bf16 v[100:103], v[128:131], v[160:163], v[100:103]
    v_mfma_f32_16x16x32_bf16 v[96:99], v[128:131], v[156:159], v[96:99]
    v_mfma_f32_16x16x32_bf16 v[88:91], v[124:127], v[156:159], v[88:91]
    v_mfma_f32_16x16x32_bf16 v[92:95], v[124:127], v[160:163], v[92:95]
    v_mfma_f32_16x16x32_bf16 v[84:87], v[120:123], v[160:163], v[84:87]
    v_mfma_f32_16x16x32_bf16 v[80:83], v[120:123], v[156:159], v[80:83]
    v_mfma_f32_16x16x32_bf16 v[116:119], v[136:139], v[156:159], v[116:119]
    s_waitcnt lgkmcnt(0)
    s_barrier
    v_mfma_f32_16x16x32_bf16 v[16:19], v[184:187], v[164:167], v[16:19]
    ds_read_b128 v[120:123], v4 offset:36864
    v_mfma_f32_16x16x32_bf16 v[20:23], v[188:191], v[164:167], v[20:23]
    ds_read_b128 v[124:127], v4 offset:38912
    v_mfma_f32_16x16x32_bf16 v[52:55], v[196:199], v[164:167], v[52:55]
    ds_read_b128 v[128:131], v4 offset:40960
    v_mfma_f32_16x16x32_bf16 v[48:51], v[192:195], v[164:167], v[48:51]
    ds_read_b128 v[132:135], v4 offset:43008
    v_mfma_f32_16x16x32_bf16 v[56:59], v[192:195], v[168:171], v[56:59]
    ds_read_b128 v[136:139], v2 offset:36864
    v_mfma_f32_16x16x32_bf16 v[60:63], v[196:199], v[168:171], v[60:63]
    ds_read_b64_tr_b16 v[140:141], v6 offset:49152
    v_mfma_f32_16x16x32_bf16 v[28:31], v[188:191], v[168:171], v[28:31]
    ds_read_b64_tr_b16 v[142:143], v6 offset:49664
    v_mfma_f32_16x16x32_bf16 v[24:27], v[184:187], v[168:171], v[24:27]
    ds_read_b64_tr_b16 v[144:145], v7 offset:49152
    v_mfma_f32_16x16x32_bf16 v[32:35], v[184:187], v[172:175], v[32:35]
    ds_read_b64_tr_b16 v[146:147], v7 offset:49664
    v_mfma_f32_16x16x32_bf16 v[36:39], v[188:191], v[172:175], v[36:39]
    ds_read_b64_tr_b16 v[148:149], v6 offset:50176
    v_mfma_f32_16x16x32_bf16 v[68:71], v[196:199], v[172:175], v[68:71]
    ds_read_b64_tr_b16 v[150:151], v6 offset:50688
    v_mfma_f32_16x16x32_bf16 v[64:67], v[192:195], v[172:175], v[64:67]
    ds_read_b64_tr_b16 v[152:153], v7 offset:50176
    v_mfma_f32_16x16x32_bf16 v[112:115], v[192:195], v[180:183], v[112:115]
    ds_read_b64_tr_b16 v[154:155], v7 offset:50688
    v_mfma_f32_16x16x32_bf16 v[72:75], v[192:195], v[176:179], v[72:75]
    ds_read_b64_tr_b16 v[156:157], v6 offset:51200
    v_mfma_f32_16x16x32_bf16 v[76:79], v[196:199], v[176:179], v[76:79]
    ds_read_b64_tr_b16 v[158:159], v6 offset:51712
    v_mfma_f32_16x16x32_bf16 v[44:47], v[188:191], v[176:179], v[44:47]
    ds_read_b64_tr_b16 v[160:161], v7 offset:51200
    v_mfma_f32_16x16x32_bf16 v[40:43], v[184:187], v[176:179], v[40:43]
    ds_read_b64_tr_b16 v[162:163], v7 offset:51712
    v_mfma_f32_16x16x32_bf16 v[104:107], v[176:179], v[200:203], v[104:107]
    v_mfma_f32_16x16x32_bf16 v[108:111], v[176:179], v[204:207], v[108:111]
    v_mfma_f32_16x16x32_bf16 v[100:103], v[172:175], v[204:207], v[100:103]
    v_mfma_f32_16x16x32_bf16 v[96:99], v[172:175], v[200:203], v[96:99]
    v_mfma_f32_16x16x32_bf16 v[88:91], v[168:171], v[200:203], v[88:91]
    v_mfma_f32_16x16x32_bf16 v[92:95], v[168:171], v[204:207], v[92:95]
    v_mfma_f32_16x16x32_bf16 v[84:87], v[164:167], v[204:207], v[84:87]
    v_mfma_f32_16x16x32_bf16 v[80:83], v[164:167], v[200:203], v[80:83]
    v_mfma_f32_16x16x32_bf16 v[116:119], v[180:183], v[200:203], v[116:119]
    s_waitcnt lgkmcnt(0)
    v_mfma_f32_16x16x32_bf16 v[16:19], v[140:143], v[120:123], v[16:19]
    ds_read_b128 v[164:167], v5 offset:36864
    v_mfma_f32_16x16x32_bf16 v[20:23], v[144:147], v[120:123], v[20:23]
    ds_read_b128 v[168:171], v5 offset:38912
    v_mfma_f32_16x16x32_bf16 v[52:55], v[152:155], v[120:123], v[52:55]
    ds_read_b128 v[172:175], v5 offset:40960
    v_mfma_f32_16x16x32_bf16 v[48:51], v[148:151], v[120:123], v[48:51]
    ds_read_b128 v[176:179], v5 offset:43008
    v_mfma_f32_16x16x32_bf16 v[56:59], v[148:151], v[124:127], v[56:59]
    ds_read_b128 v[180:183], v3 offset:36864
    v_mfma_f32_16x16x32_bf16 v[60:63], v[152:155], v[124:127], v[60:63]
    ds_read_b64_tr_b16 v[184:185], v6 offset:61440
    v_mfma_f32_16x16x32_bf16 v[28:31], v[144:147], v[124:127], v[28:31]
    ds_read_b64_tr_b16 v[186:187], v6 offset:61952
    v_mfma_f32_16x16x32_bf16 v[24:27], v[140:143], v[124:127], v[24:27]
    ds_read_b64_tr_b16 v[188:189], v7 offset:61440
    v_mfma_f32_16x16x32_bf16 v[32:35], v[140:143], v[128:131], v[32:35]
    ds_read_b64_tr_b16 v[190:191], v7 offset:61952
    v_mfma_f32_16x16x32_bf16 v[36:39], v[144:147], v[128:131], v[36:39]
    ds_read_b64_tr_b16 v[192:193], v6 offset:62464
    v_mfma_f32_16x16x32_bf16 v[68:71], v[152:155], v[128:131], v[68:71]
    ds_read_b64_tr_b16 v[194:195], v6 offset:62976
    v_mfma_f32_16x16x32_bf16 v[64:67], v[148:151], v[128:131], v[64:67]
    ds_read_b64_tr_b16 v[196:197], v7 offset:62464
    v_mfma_f32_16x16x32_bf16 v[112:115], v[148:151], v[136:139], v[112:115]
    ds_read_b64_tr_b16 v[198:199], v7 offset:62976
    v_mfma_f32_16x16x32_bf16 v[72:75], v[148:151], v[132:135], v[72:75]
    ds_read_b64_tr_b16 v[200:201], v6 offset:63488
    v_mfma_f32_16x16x32_bf16 v[76:79], v[152:155], v[132:135], v[76:79]
    ds_read_b64_tr_b16 v[202:203], v6 offset:64000
    v_mfma_f32_16x16x32_bf16 v[44:47], v[144:147], v[132:135], v[44:47]
    ds_read_b64_tr_b16 v[204:205], v7 offset:63488
    v_mfma_f32_16x16x32_bf16 v[40:43], v[140:143], v[132:135], v[40:43]
    ds_read_b64_tr_b16 v[206:207], v7 offset:64000
    v_mfma_f32_16x16x32_bf16 v[104:107], v[132:135], v[156:159], v[104:107]
    v_mfma_f32_16x16x32_bf16 v[108:111], v[132:135], v[160:163], v[108:111]
    v_mfma_f32_16x16x32_bf16 v[100:103], v[128:131], v[160:163], v[100:103]
    v_mfma_f32_16x16x32_bf16 v[96:99], v[128:131], v[156:159], v[96:99]
    v_mfma_f32_16x16x32_bf16 v[88:91], v[124:127], v[156:159], v[88:91]
    v_mfma_f32_16x16x32_bf16 v[92:95], v[124:127], v[160:163], v[92:95]
    v_mfma_f32_16x16x32_bf16 v[84:87], v[120:123], v[160:163], v[84:87]
    v_mfma_f32_16x16x32_bf16 v[80:83], v[120:123], v[156:159], v[80:83]
    v_mfma_f32_16x16x32_bf16 v[116:119], v[136:139], v[156:159], v[116:119]
    s_waitcnt lgkmcnt(0)
    s_barrier
    s_cmp_lg_u32 s3, 0
    s_cbranch_scc1 LB_sk
    s_waitcnt vmcnt(0)
    v_cmp_eq_u32 vcc, 0, v222
    s_cbranch_vccnz LB_slow
LB_back:
    s_mov_b64 exec, 1
    buffer_store_dword v222, v220, s[52:55], s96 offen sc1
    s_mov_b64 exec, -1
LB_sk:
    v_mfma_f32_16x16x32_bf16 v[16:19], v[184:187], v[164:167], v[16:19]
    ds_read_b128 v[120:123], v4 offset:0
    v_mfma_f32_16x16x32_bf16 v[20:23], v[188:191], v[164:167], v[20:23]
    ds_read_b128 v[124:127], v4 offset:2048
    v_mfma_f32_16x16x32_bf16 v[52:55], v[196:199], v[164:167], v[52:55]
    ds_read_b128 v[128:131], v4 offset:4096
    v_mfma_f32_16x16x32_bf16 v[48:51], v[192:195], v[164:167], v[48:51]
    ds_read_b128 v[132:135], v4 offset:6144
    v_mfma_f32_16x16x32_bf16 v[56:59], v[192:195], v[168:171], v[56:59]
    ds_read_b128 v[136:139], v2 offset:0
    v_mfma_f32_16x16x32_bf16 v[60:63], v[196:199], v[168:171], v[60:63]
    ds_read_b64_tr_b16 v[140:141], v6 offset:0
    v_mfma_f32_16x16x32_bf16 v[28:31], v[188:191], v[168:171], v[28:31]
    ds_read_b64_tr_b16 v[142:143], v6 offset:512
    v_mfma_f32_16x16x32_bf16 v[24:27], v[184:187], v[168:171], v[24:27]
    ds_read_b64_tr_b16 v[144:145], v7 offset:0
    v_mfma_f32_16x16x32_bf16 v[32:35], v[184:187], v[172:175], v[32:35]
    ds_read_b64_tr_b16 v[146:147], v7 offset:512
    v_mfma_f32_16x16x32_bf16 v[36:39], v[188:191], v[172:175], v[36:39]
    ds_read_b64_tr_b16 v[148:149], v6 offset:1024
    v_mfma_f32_16x16x32_bf16 v[68:71], v[196:199], v[172:175], v[68:71]
    ds_read_b64_tr_b16 v[150:151], v6 offset:1536
    v_mfma_f32_16x16x32_bf16 v[64:67], v[192:195], v[172:175], v[64:67]
    ds_read_b64_tr_b16 v[152:153], v7 offset:1024
    v_mfma_f32_16x16x32_bf16 v[112:115], v[192:195], v[180:183], v[112:115]
    ds_read_b64_tr_b16 v[154:155], v7 offset:1536
    v_mfma_f32_16x16x32_bf16 v[72:75], v[192:195], v[176:179], v[72:75]
    ds_read_b64_tr_b16 v[156:157], v6 offset:2048
    v_mfma_f32_16x16x32_bf16 v[76:79], v[196:199], v[176:179], v[76:79]
    ds_read_b64_tr_b16 v[158:159], v6 offset:2560
    v_mfma_f32_16x16x32_bf16 v[44:47], v[188:191], v[176:179], v[44:47]
    ds_read_b64_tr_b16 v[160:161], v7 offset:2048
    v_mfma_f32_16x16x32_bf16 v[40:43], v[184:187], v[176:179], v[40:43]
    ds_read_b64_tr_b16 v[162:163], v7 offset:2560
    v_mfma_f32_16x16x32_bf16 v[104:107], v[176:179], v[200:203], v[104:107]
    v_mfma_f32_16x16x32_bf16 v[108:111], v[176:179], v[204:207], v[108:111]
    v_mfma_f32_16x16x32_bf16 v[100:103], v[172:175], v[204:207], v[100:103]
    v_mfma_f32_16x16x32_bf16 v[96:99], v[172:175], v[200:203], v[96:99]
    v_mfma_f32_16x16x32_bf16 v[88:91], v[168:171], v[200:203], v[88:91]
    v_mfma_f32_16x16x32_bf16 v[92:95], v[168:171], v[204:207], v[92:95]
    v_mfma_f32_16x16x32_bf16 v[84:87], v[164:167], v[204:207], v[84:87]
    v_mfma_f32_16x16x32_bf16 v[80:83], v[164:167], v[200:203], v[80:83]
    v_mfma_f32_16x16x32_bf16 v[116:119], v[180:183], v[200:203], v[116:119]
    s_waitcnt lgkmcnt(0)
    v_mfma_f32_16x16x32_bf16 v[16:19], v[140:143], v[120:123], v[16:19]
    ds_read_b128 v[164:167], v5 offset:0
    v_mfma_f32_16x16x32_bf16 v[20:23], v[144:147], v[120:123], v[20:23]
    ds_read_b128 v[168:171], v5 offset:2048
    v_mfma_f32_16x16x32_bf16 v[52:55], v[152:155], v[120:123], v[52:55]
    ds_read_b128 v[172:175], v5 offset:4096
    v_mfma_f32_16x16x32_bf16 v[48:51], v[148:151], v[120:123], v[48:51]
    ds_read_b128 v[176:179], v5 offset:6144
    v_mfma_f32_16x16x32_bf16 v[56:59], v[148:151], v[124:127], v[56:59]
    ds_read_b128 v[180:183], v3 offset:0
    v_mfma_f32_16x16x32_bf16 v[60:63], v[152:155], v[124:127], v[60:63]
    ds_read_b64_tr_b16 v[184:185], v6 offset:12288
    v_mfma_f32_16x16x32_bf16 v[28:31], v[144:147], v[124:127], v[28:31]
    ds_read_b64_tr_b16 v[186:187], v6 offset:12800
    v_mfma_f32_16x16x32_bf16 v[24:27], v[140:143], v[124:127], v[24:27]
    ds_read_b64_tr_b16 v[188:189], v7 offset:12288
    v_mfma_f32_16x16x32_bf16 v[32:35], v[140:143], v[128:131], v[32:35]
    ds_read_b64_tr_b16 v[190:191], v7 offset:12800
    v_mfma_f32_16x16x32_bf16 v[36:39], v[144:147], v[128:131], v[36:39]
    ds_read_b64_tr_b16 v[192:193], v6 offset:13312
    v_mfma_f32_16x16x32_bf16 v[68:71], v[152:155], v[128:131], v[68:71]
    ds_read_b64_tr_b16 v[194:195], v6 offset:13824
    v_mfma_f32_16x16x32_bf16 v[64:67], v[148:151], v[128:131], v[64:67]
    ds_read_b64_tr_b16 v[196:197], v7 offset:13312
    v_mfma_f32_16x16x32_bf16 v[112:115], v[148:151], v[136:139], v[112:115]
    ds_read_b64_tr_b16 v[198:199], v7 offset:13824
    v_mfma_f32_16x16x32_bf16 v[72:75], v[148:151], v[132:135], v[72:75]
    ds_read_b64_tr_b16 v[200:201], v6 offset:14336
    v_mfma_f32_16x16x32_bf16 v[76:79], v[152:155], v[132:135], v[76:79]
    ds_read_b64_tr_b16 v[202:203], v6 offset:14848
    v_mfma_f32_16x16x32_bf16 v[44:47], v[144:147], v[132:135], v[44:47]
    ds_read_b64_tr_b16 v[204:205], v7 offset:14336
    v_mfma_f32_16x16x32_bf16 v[40:43], v[140:143], v[132:135], v[40:43]
    ds_read_b64_tr_b16 v[206:207], v7 offset:14848
    v_mfma_f32_16x16x32_bf16 v[104:107], v[132:135], v[156:159], v[104:107]
    v_mfma_f32_16x16x32_bf16 v[108:111], v[132:135], v[160:163], v[108:111]
    v_mfma_f32_16x16x32_bf16 v[100:103], v[128:131], v[160:163], v[100:103]
    v_mfma_f32_16x16x32_bf16 v[96:99], v[128:131], v[156:159], v[96:99]
    v_mfma_f32_16x16x32_bf16 v[88:91], v[124:127], v[156:159], v[88:91]
    v_mfma_f32_16x16x32_bf16 v[92:95], v[124:127], v[160:163], v[92:95]
    v_mfma_f32_16x16x32_bf16 v[84:87], v[120:123], v[160:163], v[84:87]
    v_mfma_f32_16x16x32_bf16 v[80:83], v[120:123], v[156:159], v[80:83]
    v_mfma_f32_16x16x32_bf16 v[116:119], v[136:139], v[156:159], v[116:119]
    s_waitcnt lgkmcnt(0)
    s_barrier
    v_mfma_f32_16x16x32_bf16 v[16:19], v[184:187], v[164:167], v[16:19]
    ds_read_b128 v[120:123], v4 offset:18432
    v_mfma_f32_16x16x32_bf16 v[20:23], v[188:191], v[164:167], v[20:23]
    ds_read_b128 v[124:127], v4 offset:20480
    v_mfma_f32_16x16x32_bf16 v[52:55], v[196:199], v[164:167], v[52:55]
    ds_read_b128 v[128:131], v4 offset:22528
    v_mfma_f32_16x16x32_bf16 v[48:51], v[192:195], v[164:167], v[48:51]
    ds_read_b128 v[132:135], v4 offset:24576
    v_mfma_f32_16x16x32_bf16 v[56:59], v[192:195], v[168:171], v[56:59]
    ds_read_b128 v[136:139], v2 offset:18432
    v_mfma_f32_16x16x32_bf16 v[60:63], v[196:199], v[168:171], v[60:63]
    ds_read_b64_tr_b16 v[140:141], v6 offset:24576
    v_mfma_f32_16x16x32_bf16 v[28:31], v[188:191], v[168:171], v[28:31]
    ds_read_b64_tr_b16 v[142:143], v6 offset:25088
    v_mfma_f32_16x16x32_bf16 v[24:27], v[184:187], v[168:171], v[24:27]
    ds_read_b64_tr_b16 v[144:145], v7 offset:24576
    v_mfma_f32_16x16x32_bf16 v[32:35], v[184:187], v[172:175], v[32:35]
    ds_read_b64_tr_b16 v[146:147], v7 offset:25088
    v_mfma_f32_16x16x32_bf16 v[36:39], v[188:191], v[172:175], v[36:39]
    ds_read_b64_tr_b16 v[148:149], v6 offset:25600
    v_mfma_f32_16x16x32_bf16 v[68:71], v[196:199], v[172:175], v[68:71]
    ds_read_b64_tr_b16 v[150:151], v6 offset:26112
    v_mfma_f32_16x16x32_bf16 v[64:67], v[192:195], v[172:175], v[64:67]
    ds_read_b64_tr_b16 v[152:153], v7 offset:25600
    v_mfma_f32_16x16x32_bf16 v[112:115], v[192:195], v[180:183], v[112:115]
    ds_read_b64_tr_b16 v[154:155], v7 offset:26112
    v_mfma_f32_16x16x32_bf16 v[72:75], v[192:195], v[176:179], v[72:75]
    ds_read_b64_tr_b16 v[156:157], v6 offset:26624
    v_mfma_f32_16x16x32_bf16 v[76:79], v[196:199], v[176:179], v[76:79]
    ds_read_b64_tr_b16 v[158:159], v6 offset:27136
    v_mfma_f32_16x16x32_bf16 v[44:47], v[188:191], v[176:179], v[44:47]
    ds_read_b64_tr_b16 v[160:161], v7 offset:26624
    v_mfma_f32_16x16x32_bf16 v[40:43], v[184:187], v[176:179], v[40:43]
    ds_read_b64_tr_b16 v[162:163], v7 offset:27136
    v_mfma_f32_16x16x32_bf16 v[104:107], v[176:179], v[200:203], v[104:107]
    v_mfma_f32_16x16x32_bf16 v[108:111], v[176:179], v[204:207], v[108:111]
    v_mfma_f32_16x16x32_bf16 v[100:103], v[172:175], v[204:207], v[100:103]
    v_mfma_f32_16x16x32_bf16 v[96:99], v[172:175], v[200:203], v[96:99]
    v_mfma_f32_16x16x32_bf16 v[88:91], v[168:171], v[200:203], v[88:91]
    v_mfma_f32_16x16x32_bf16 v[92:95], v[168:171], v[204:207], v[92:95]
    v_mfma_f32_16x16x32_bf16 v[84:87], v[164:167], v[204:207], v[84:87]
    v_mfma_f32_16x16x32_bf16 v[80:83], v[164:167], v[200:203], v[80:83]
    v_mfma_f32_16x16x32_bf16 v[116:119], v[180:183], v[200:203], v[116:119]
    s_waitcnt lgkmcnt(0)
    v_mfma_f32_16x16x32_bf16 v[16:19], v[140:143], v[120:123], v[16:19]
    ds_read_b128 v[164:167], v5 offset:18432
    v_mfma_f32_16x16x32_bf16 v[20:23], v[144:147], v[120:123], v[20:23]
    ds_read_b128 v[168:171], v5 offset:20480
    v_mfma_f32_16x16x32_bf16 v[52:55], v[152:155], v[120:123], v[52:55]
    ds_read_b128 v[172:175], v5 offset:22528
    v_mfma_f32_16x16x32_bf16 v[48:51], v[148:151], v[120:123], v[48:51]
    ds_read_b128 v[176:179], v5 offset:24576
    v_mfma_f32_16x16x32_bf16 v[56:59], v[148:151], v[124:127], v[56:59]
    ds_read_b128 v[180:183], v3 offset:18432
    v_mfma_f32_16x16x32_bf16 v[60:63], v[152:155], v[124:127], v[60:63]
    ds_read_b64_tr_b16 v[184:185], v6 offset:36864
    v_mfma_f32_16x16x32_bf16 v[28:31], v[144:147], v[124:127], v[28:31]
    ds_read_b64_tr_b16 v[186:187], v6 offset:37376
    v_mfma_f32_16x16x32_bf16 v[24:27], v[140:143], v[124:127], v[24:27]
    ds_read_b64_tr_b16 v[188:189], v7 offset:36864
    v_mfma_f32_16x16x32_bf16 v[32:35], v[140:143], v[128:131], v[32:35]
    ds_read_b64_tr_b16 v[190:191], v7 offset:37376
    v_mfma_f32_16x16x32_bf16 v[36:39], v[144:147], v[128:131], v[36:39]
    ds_read_b64_tr_b16 v[192:193], v6 offset:37888
    v_mfma_f32_16x16x32_bf16 v[68:71], v[152:155], v[128:131], v[68:71]
    ds_read_b64_tr_b16 v[194:195], v6 offset:38400
    v_mfma_f32_16x16x32_bf16 v[64:67], v[148:151], v[128:131], v[64:67]
    ds_read_b64_tr_b16 v[196:197], v7 offset:37888
    v_mfma_f32_16x16x32_bf16 v[112:115], v[148:151], v[136:139], v[112:115]
    ds_read_b64_tr_b16 v[198:199], v7 offset:38400
    v_mfma_f32_16x16x32_bf16 v[72:75], v[148:151], v[132:135], v[72:75]
    ds_read_b64_tr_b16 v[200:201], v6 offset:38912
    v_mfma_f32_16x16x32_bf16 v[76:79], v[152:155], v[132:135], v[76:79]
    ds_read_b64_tr_b16 v[202:203], v6 offset:39424
    v_mfma_f32_16x16x32_bf16 v[44:47], v[144:147], v[132:135], v[44:47]
    ds_read_b64_tr_b16 v[204:205], v7 offset:38912
    v_mfma_f32_16x16x32_bf16 v[40:43], v[140:143], v[132:135], v[40:43]
    ds_read_b64_tr_b16 v[206:207], v7 offset:39424
    v_mfma_f32_16x16x32_bf16 v[104:107], v[132:135], v[156:159], v[104:107]
    v_mfma_f32_16x16x32_bf16 v[108:111], v[132:135], v[160:163], v[108:111]
    v_mfma_f32_16x16x32_bf16 v[100:103], v[128:131], v[160:163], v[100:103]
    v_mfma_f32_16x16x32_bf16 v[96:99], v[128:131], v[156:159], v[96:99]
    v_mfma_f32_16x16x32_bf16 v[88:91], v[124:127], v[156:159], v[88:91]
    v_mfma_f32_16x16x32_bf16 v[92:95], v[124:127], v[160:163], v[92:95]
    v_mfma_f32_16x16x32_bf16 v[84:87], v[120:123], v[160:163], v[84:87]
    v_mfma_f32_16x16x32_bf16 v[80:83], v[120:123], v[156:159], v[80:83]
    v_mfma_f32_16x16x32_bf16 v[116:119], v[136:139], v[156:159], v[116:119]
    s_waitcnt lgkmcnt(0)
    s_barrier
    v_mfma_f32_16x16x32_bf16 v[16:19], v[184:187], v[164:167], v[16:19]
    ds_read_b128 v[120:123], v4 offset:36864
    v_mfma_f32_16x16x32_bf16 v[20:23], v[188:191], v[164:167], v[20:23]
    ds_read_b128 v[124:127], v4 offset:38912
    v_mfma_f32_16x16x32_bf16 v[52:55], v[196:199], v[164:167], v[52:55]
    ds_read_b128 v[128:131], v4 offset:40960
    v_mfma_f32_16x16x32_bf16 v[48:51], v[192:195], v[164:167], v[48:51]
    ds_read_b128 v[132:135], v4 offset:43008
    v_mfma_f32_16x16x32_bf16 v[56:59], v[192:195], v[168:171], v[56:59]
    ds_read_b128 v[136:139], v2 offset:36864
    v_mfma_f32_16x16x32_bf16 v[60:63], v[196:199], v[168:171], v[60:63]
    ds_read_b64_tr_b16 v[140:141], v6 offset:49152
    v_mfma_f32_16x16x32_bf16 v[28:31], v[188:191], v[168:171], v[28:31]
    ds_read_b64_tr_b16 v[142:143], v6 offset:49664
    v_mfma_f32_16x16x32_bf16 v[24:27], v[184:187], v[168:171], v[24:27]
    ds_read_b64_tr_b16 v[144:145], v7 offset:49152
    v_mfma_f32_16x16x32_bf16 v[32:35], v[184:187], v[172:175], v[32:35]
    ds_read_b64_tr_b16 v[146:147], v7 offset:49664
    v_mfma_f32_16x16x32_bf16 v[36:39], v[188:191], v[172:175], v[36:39]
    ds_read_b64_tr_b16 v[148:149], v6 offset:50176
    v_mfma_f32_16x16x32_bf16 v[68:71], v[196:199], v[172:175], v[68:71]
    ds_read_b64_tr_b16 v[150:151], v6 offset:50688
    v_mfma_f32_16x16x32_bf16 v[64:67], v[192:195], v[172:175], v[64:67]
    ds_read_b64_tr_b16 v[152:153], v7 offset:50176
    v_mfma_f32_16x16x32_bf16 v[112:115], v[192:195], v[180:183], v[112:115]
    ds_read_b64_tr_b16 v[154:155], v7 offset:50688
    v_mfma_f32_16x16x32_bf16 v[72:75], v[192:195], v[176:179], v[72:75]
    ds_read_b64_tr_b16 v[156:157], v6 offset:51200
    v_mfma_f32_16x16x32_bf16 v[76:79], v[196:199], v[176:179], v[76:79]
    ds_read_b64_tr_b16 v[158:159], v6 offset:51712
    v_mfma_f32_16x16x32_bf16 v[44:47], v[188:191], v[176:179], v[44:47]
    ds_read_b64_tr_b16 v[160:161], v7 offset:51200
    v_mfma_f32_16x16x32_bf16 v[40:43], v[184:187], v[176:179], v[40:43]
    ds_read_b64_tr_b16 v[162:163], v7 offset:51712
    v_mfma_f32_16x16x32_bf16 v[104:107], v[176:179], v[200:203], v[104:107]
    v_mfma_f32_16x16x32_bf16 v[108:111], v[176:179], v[204:207], v[108:111]
    v_mfma_f32_16x16x32_bf16 v[100:103], v[172:175], v[204:207], v[100:103]
    v_mfma_f32_16x16x32_bf16 v[96:99], v[172:175], v[200:203], v[96:99]
    v_mfma_f32_16x16x32_bf16 v[88:91], v[168:171], v[200:203], v[88:91]
    v_mfma_f32_16x16x32_bf16 v[92:95], v[168:171], v[204:207], v[92:95]
    v_mfma_f32_16x16x32_bf16 v[84:87], v[164:167], v[204:207], v[84:87]
    v_mfma_f32_16x16x32_bf16 v[80:83], v[164:167], v[200:203], v[80:83]
    v_mfma_f32_16x16x32_bf16 v[116:119], v[180:183], v[200:203], v[116:119]
    s_waitcnt lgkmcnt(0)
    v_mfma_f32_16x16x32_bf16 v[16:19], v[140:143], v[120:123], v[16:19]
    ds_read_b128 v[164:167], v5 offset:36864
    v_mfma_f32_16x16x32_bf16 v[20:23], v[144:147], v[120:123], v[20:23]
    ds_read_b128 v[168:171], v5 offset:38912
    v_mfma_f32_16x16x32_bf16 v[52:55], v[152:155], v[120:123], v[52:55]
    ds_read_b128 v[172:175], v5 offset:40960
    v_mfma_f32_16x16x32_bf16 v[48:51], v[148:151], v[120:123], v[48:51]
    ds_read_b128 v[176:179], v5 offset:43008
    v_mfma_f32_16x16x32_bf16 v[56:59], v[148:151], v[124:127], v[56:59]
    ds_read_b128 v[180:183], v3 offset:36864
    v_mfma_f32_16x16x32_bf16 v[60:63], v[152:155], v[124:127], v[60:63]
    ds_read_b64_tr_b16 v[184:185], v6 offset:61440
    v_mfma_f32_16x16x32_bf16 v[28:31], v[144:147], v[124:127], v[28:31]
    ds_read_b64_tr_b16 v[186:187], v6 offset:61952
    v_mfma_f32_16x16x32_bf16 v[24:27], v[140:143], v[124:127], v[24:27]
    ds_read_b64_tr_b16 v[188:189], v7 offset:61440
    v_mfma_f32_16x16x32_bf16 v[32:35], v[140:143], v[128:131], v[32:35]
    ds_read_b64_tr_b16 v[190:191], v7 offset:61952
    v_mfma_f32_16x16x32_bf16 v[36:39], v[144:147], v[128:131], v[36:39]
    ds_read_b64_tr_b16 v[192:193], v6 offset:62464
    v_mfma_f32_16x16x32_bf16 v[68:71], v[152:155], v[128:131], v[68:71]
    ds_read_b64_tr_b16 v[194:195], v6 offset:62976
    v_mfma_f32_16x16x32_bf16 v[64:67], v[148:151], v[128:131], v[64:67]
    ds_read_b64_tr_b16 v[196:197], v7 offset:62464
    v_mfma_f32_16x16x32_bf16 v[112:115], v[148:151], v[136:139], v[112:115]
    ds_read_b64_tr_b16 v[198:199], v7 offset:62976
    v_mfma_f32_16x16x32_bf16 v[72:75], v[148:151], v[132:135], v[72:75]
    ds_read_b64_tr_b16 v[200:201], v6 offset:63488
    v_mfma_f32_16x16x32_bf16 v[76:79], v[152:155], v[132:135], v[76:79]
    ds_read_b64_tr_b16 v[202:203], v6 offset:64000
    v_mfma_f32_16x16x32_bf16 v[44:47], v[144:147], v[132:135], v[44:47]
    ds_read_b64_tr_b16 v[204:205], v7 offset:63488
    v_mfma_f32_16x16x32_bf16 v[40:43], v[140:143], v[132:135], v[40:43]
    ds_read_b64_tr_b16 v[206:207], v7 offset:64000
    v_mfma_f32_16x16x32_bf16 v[104:107], v[132:135], v[156:159], v[104:107]
    s_nop 0
    v_mfma_f32_16x16x32_bf16 v[108:111], v[132:135], v[160:163], v[108:111]
    s_nop 0
    v_mfma_f32_16x16x32_bf16 v[100:103], v[128:131], v[160:163], v[100:103]
    s_nop 0
    v_mfma_f32_16x16x32_bf16 v[96:99], v[128:131], v[156:159], v[96:99]
    s_nop 0
    v_mfma_f32_16x16x32_bf16 v[88:91], v[124:127], v[156:159], v[88:91]
    ds_read_b32 v223, v10 offset:24
    v_mfma_f32_16x16x32_bf16 v[92:95], v[124:127], v[160:163], v[92:95]
    v_mfma_f32_16x16x32_bf16 v[84:87], v[120:123], v[160:163], v[84:87]
    v_mfma_f32_16x16x32_bf16 v[80:83], v[120:123], v[156:159], v[80:83]
    v_mfma_f32_16x16x32_bf16 v[116:119], v[136:139], v[156:159], v[116:119]
    s_waitcnt lgkmcnt(0)
    v_cmp_gt_u32 vcc, 4, v223
    s_cbranch_vccnz LB_w15
LB_g15:
    v_mfma_f32_16x16x32_bf16 v[16:19], v[184:187], v[164:167], v[16:19]
    ds_read_b128 v[120:123], v4 offset:0
    v_mfma_f32_16x16x32_bf16 v[20:23], v[188:191], v[164:167], v[20:23]
    ds_read_b128 v[124:127], v4 offset:2048
    v_mfma_f32_16x16x32_bf16 v[52:55], v[196:199], v[164:167], v[52:55]
    ds_read_b128 v[128:131], v4 offset:4096
    v_mfma_f32_16x16x32_bf16 v[48:51], v[192:195], v[164:167], v[48:51]
    ds_read_b128 v[132:135], v4 offset:6144
    v_mfma_f32_16x16x32_bf16 v[56:59], v[192:195], v[168:171], v[56:59]
    ds_read_b128 v[136:139], v2 offset:0
    v_mfma_f32_16x16x32_bf16 v[60:63], v[196:199], v[168:171], v[60:63]
    ds_read_b64_tr_b16 v[140:141], v6 offset:0
    v_mfma_f32_16x16x32_bf16 v[28:31], v[188:191], v[168:171], v[28:31]
    ds_read_b64_tr_b16 v[142:143], v6 offset:512
    v_mfma_f32_16x16x32_bf16 v[24:27], v[184:187], v[168:171], v[24:27]
    ds_read_b64_tr_b16 v[144:145], v7 offset:0
    v_mfma_f32_16x16x32_bf16 v[32:35], v[184:187], v[172:175], v[32:35]
    ds_read_b64_tr_b16 v[146:147], v7 offset:512
    v_mfma_f32_16x16x32_bf16 v[36:39], v[188:191], v[172:175], v[36:39]
    ds_read_b64_tr_b16 v[148:149], v6 offset:1024
    v_mfma_f32_16x16x32_bf16 v[68:71], v[196:199], v[172:175], v[68:71]
    ds_read_b64_tr_b16 v[150:151], v6 offset:1536
    v_mfma_f32_16x16x32_bf16 v[64:67], v[192:195], v[172:175], v[64:67]
    ds_read_b64_tr_b16 v[152:153], v7 offset:1024
    v_mfma_f32_16x16x32_bf16 v[112:115], v[192:195], v[180:183], v[112:115]
    ds_read_b64_tr_b16 v[154:155], v7 offset:1536
    v_mfma_f32_16x16x32_bf16 v[72:75], v[192:195], v[176:179], v[72:75]
    ds_read_b64_tr_b16 v[156:157], v6 offset:2048
    v_mfma_f32_16x16x32_bf16 v[76:79], v[196:199], v[176:179], v[76:79]
    ds_read_b64_tr_b16 v[158:159], v6 offset:2560
    v_mfma_f32_16x16x32_bf16 v[44:47], v[188:191], v[176:179], v[44:47]
    ds_read_b64_tr_b16 v[160:161], v7 offset:2048
    v_mfma_f32_16x16x32_bf16 v[40:43], v[184:187], v[176:179], v[40:43]
    ds_read_b64_tr_b16 v[162:163], v7 offset:2560
    v_mfma_f32_16x16x32_bf16 v[104:107], v[176:179], v[200:203], v[104:107]
    v_mfma_f32_16x16x32_bf16 v[108:111], v[176:179], v[204:207], v[108:111]
    v_mfma_f32_16x16x32_bf16 v[100:103], v[172:175], v[204:207], v[100:103]
    v_mfma_f32_16x16x32_bf16 v[96:99], v[172:175], v[200:203], v[96:99]
    v_mfma_f32_16x16x32_bf16 v[88:91], v[168:171], v[200:203], v[88:91]
    v_mfma_f32_16x16x32_bf16 v[92:95], v[168:171], v[204:207], v[92:95]
    v_mfma_f32_16x16x32_bf16 v[84:87], v[164:167], v[204:207], v[84:87]
    v_mfma_f32_16x16x32_bf16 v[80:83], v[164:167], v[200:203], v[80:83]
    v_mfma_f32_16x16x32_bf16 v[116:119], v[180:183], v[200:203], v[116:119]
    s_waitcnt lgkmcnt(0)
    v_mfma_f32_16x16x32_bf16 v[16:19], v[140:143], v[120:123], v[16:19]
    ds_read_b128 v[164:167], v5 offset:0
    v_mfma_f32_16x16x32_bf16 v[20:23], v[144:147], v[120:123], v[20:23]
    ds_read_b128 v[168:171], v5 offset:2048
    v_mfma_f32_16x16x32_bf16 v[52:55], v[152:155], v[120:123], v[52:55]
    ds_read_b128 v[172:175], v5 offset:4096
    v_mfma_f32_16x16x32_bf16 v[48:51], v[148:151], v[120:123], v[48:51]
    ds_read_b128 v[176:179], v5 offset:6144
    v_mfma_f32_16x16x32_bf16 v[56:59], v[148:151], v[124:127], v[56:59]
    ds_read_b128 v[180:183], v3 offset:0
    v_mfma_f32_16x16x32_bf16 v[60:63], v[152:155], v[124:127], v[60:63]
    ds_read_b64_tr_b16 v[184:185], v6 offset:12288
    v_mfma_f32_16x16x32_bf16 v[28:31], v[144:147], v[124:127], v[28:31]
    ds_read_b64_tr_b16 v[186:187], v6 offset:12800
    v_mfma_f32_16x16x32_bf16 v[24:27], v[140:143], v[124:127], v[24:27]
    ds_read_b64_tr_b16 v[188:189], v7 offset:12288
    v_mfma_f32_16x16x32_bf16 v[32:35], v[140:143], v[128:131], v[32:35]
    ds_read_b64_tr_b16 v[190:191], v7 offset:12800
    v_mfma_f32_16x16x32_bf16 v[36:39], v[144:147], v[128:131], v[36:39]
    ds_read_b64_tr_b16 v[192:193], v6 offset:13312
    v_mfma_f32_16x16x32_bf16 v[68:71], v[152:155], v[128:131], v[68:71]
    ds_read_b64_tr_b16 v[194:195], v6 offset:13824
    v_mfma_f32_16x16x32_bf16 v[64:67], v[148:151], v[128:131], v[64:67]
    ds_read_b64_tr_b16 v[196:197], v7 offset:13312
    v_mfma_f32_16x16x32_bf16 v[112:115], v[148:151], v[136:139], v[112:115]
    ds_read_b64_tr_b16 v[198:199], v7 offset:13824
    v_mfma_f32_16x16x32_bf16 v[72:75], v[148:151], v[132:135], v[72:75]
    ds_read_b64_tr_b16 v[200:201], v6 offset:14336
    v_mfma_f32_16x16x32_bf16 v[76:79], v[152:155], v[132:135], v[76:79]
    ds_read_b64_tr_b16 v[202:203], v6 offset:14848
    v_mfma_f32_16x16x32_bf16 v[44:47], v[144:147], v[132:135], v[44:47]
    ds_read_b64_tr_b16 v[204:205], v7 offset:14336
    v_mfma_f32_16x16x32_bf16 v[40:43], v[140:143], v[132:135], v[40:43]
    ds_read_b64_tr_b16 v[206:207], v7 offset:14848
    v_mfma_f32_16x16x32_bf16 v[104:107], v[132:135], v[156:159], v[104:107]
    v_mfma_f32_16x16x32_bf16 v[108:111], v[132:135], v[160:163], v[108:111]
    v_mfma_f32_16x16x32_bf16 v[100:103], v[128:131], v[160:163], v[100:103]
    v_mfma_f32_16x16x32_bf16 v[96:99], v[128:131], v[156:159], v[96:99]
    v_mfma_f32_16x16x32_bf16 v[88:91], v[124:127], v[156:159], v[88:91]
    v_mfma_f32_16x16x32_bf16 v[92:95], v[124:127], v[160:163], v[92:95]
    v_mfma_f32_16x16x32_bf16 v[84:87], v[120:123], v[160:163], v[84:87]
    v_mfma_f32_16x16x32_bf16 v[80:83], v[120:123], v[156:159], v[80:83]
    v_mfma_f32_16x16x32_bf16 v[116:119], v[136:139], v[156:159], v[116:119]
    s_waitcnt lgkmcnt(0)
    v_mfma_f32_16x16x32_bf16 v[112:115], v[192:195], v[180:183], v[112:115]
    v_mfma_f32_16x16x32_bf16 v[116:119], v[180:183], v[200:203], v[116:119]
    v_mfma_f32_16x16x32_bf16 v[72:75], v[192:195], v[176:179], v[72:75]
    v_mfma_f32_16x16x32_bf16 v[76:79], v[196:199], v[176:179], v[76:79]
    v_mfma_f32_16x16x32_bf16 v[104:107], v[176:179], v[200:203], v[104:107]
    v_mfma_f32_16x16x32_bf16 v[108:111], v[176:179], v[204:207], v[108:111]
    v_mfma_f32_16x16x32_bf16 v[40:43], v[184:187], v[176:179], v[40:43]
    v_mfma_f32_16x16x32_bf16 v[44:47], v[188:191], v[176:179], v[44:47]
    v_mfma_f32_16x16x32_bf16 v[64:67], v[192:195], v[172:175], v[64:67]
    v_mfma_f32_16x16x32_bf16 v[68:71], v[196:199], v[172:175], v[68:71]
    v_cvt_pk_bf16_f32 v156, v112, v113
    v_cvt_pk_bf16_f32 v157, v114, v115
    v_mfma_f32_16x16x32_bf16 v[32:35], v[184:187], v[172:175], v[32:35]
    v_cvt_pk_bf16_f32 v158, v116, v117
    v_cvt_pk_bf16_f32 v159, v118, v119
    v_mfma_f32_16x16x32_bf16 v[36:39], v[188:191], v[172:175], v[36:39]
    v_cvt_pk_bf16_f32 v152, v72, v73
    v_cvt_pk_bf16_f32 v153, v74, v75
    v_mfma_f32_16x16x32_bf16 v[56:59], v[192:195], v[168:171], v[56:59]
    v_cvt_pk_bf16_f32 v154, v76, v77
    v_cvt_pk_bf16_f32 v155, v78, v79
    v_mfma_f32_16x16x32_bf16 v[60:63], v[196:199], v[168:171], v[60:63]
    v_cvt_pk_bf16_f32 v232, v104, v105
    v_cvt_pk_bf16_f32 v233, v106, v107
    v_mfma_f32_16x16x32_bf16 v[24:27], v[184:187], v[168:171], v[24:27]
    v_cvt_pk_bf16_f32 v242, v108, v109
    v_cvt_pk_bf16_f32 v243, v110, v111
    v_mfma_f32_16x16x32_bf16 v[28:31], v[188:191], v[168:171], v[28:31]
    ds_write_b64 v216, v[156:157]
    ds_write_b64 v216, v[158:159] offset:1024
    v_mfma_f32_16x16x32_bf16 v[48:51], v[192:195], v[164:167], v[48:51]
    ds_write_b64 v217, v[152:153] offset:0
    ds_write_b64 v217, v[232:233] offset:1024
    v_mfma_f32_16x16x32_bf16 v[52:55], v[196:199], v[164:167], v[52:55]
    ds_write_b64 v217, v[154:155] offset:512
    ds_write_b64 v217, v[242:243] offset:1536
    v_mfma_f32_16x16x32_bf16 v[16:19], v[184:187], v[164:167], v[16:19]
    v_cvt_pk_bf16_f32 v132, v40, v41
    v_cvt_pk_bf16_f32 v133, v42, v43
    v_mfma_f32_16x16x32_bf16 v[20:23], v[188:191], v[164:167], v[20:23]
    v_cvt_pk_bf16_f32 v134, v44, v45
    v_cvt_pk_bf16_f32 v135, v46, v47
    v_mfma_f32_16x16x32_bf16 v[96:99], v[172:175], v[200:203], v[96:99]
    v_cvt_pk_bf16_f32 v148, v64, v65
    v_cvt_pk_bf16_f32 v149, v66, v67
    v_mfma_f32_16x16x32_bf16 v[100:103], v[172:175], v[204:207], v[100:103]
    v_cvt_pk_bf16_f32 v150, v68, v69
    v_cvt_pk_bf16_f32 v151, v70, v71
    v_mfma_f32_16x16x32_bf16 v[88:91], v[168:171], v[200:203], v[88:91]
    v_cvt_pk_bf16_f32 v128, v32, v33
    v_cvt_pk_bf16_f32 v129, v34, v35
    v_mfma_f32_16x16x32_bf16 v[92:95], v[168:171], v[204:207], v[92:95]
    v_cvt_pk_bf16_f32 v130, v36, v37
    v_cvt_pk_bf16_f32 v131, v38, v39
    v_mfma_f32_16x16x32_bf16 v[80:83], v[164:167], v[200:203], v[80:83]
    v_cvt_pk_bf16_f32 v144, v56, v57
    v_cvt_pk_bf16_f32 v145, v58, v59
    v_mfma_f32_16x16x32_bf16 v[84:87], v[164:167], v[204:207], v[84:87]
    v_cvt_pk_bf16_f32 v146, v60, v61
    v_cvt_pk_bf16_f32 v147, v62, v63
    v_cvt_pk_bf16_f32 v124, v24, v25
    v_cvt_pk_bf16_f32 v125, v26, v27
    v_cvt_pk_bf16_f32 v126, v28, v29
    v_cvt_pk_bf16_f32 v127, v30, v31
    s_mov_b64 exec, 1
    ds_add_u32 v10, v11 offset:0
    s_mov_b64 exec, -1
    v_cvt_pk_bf16_f32 v140, v48, v49
    v_cvt_pk_bf16_f32 v141, v50, v51
    v_cvt_pk_bf16_f32 v142, v52, v53
    v_cvt_pk_bf16_f32 v143, v54, v55
    v_cvt_pk_bf16_f32 v120, v16, v17
    v_cvt_pk_bf16_f32 v121, v18, v19
    v_cvt_pk_bf16_f32 v122, v20, v21
    v_cvt_pk_bf16_f32 v123, v22, v23
    v_mfma_f32_16x16x32_bf16 v[44:47], v[152:155], v[132:135], 0
    v_cvt_pk_bf16_f32 v230, v96, v97
    v_cvt_pk_bf16_f32 v231, v98, v99
    v_mfma_f32_16x16x32_bf16 v[40:43], v[148:151], v[132:135], 0
    v_cvt_pk_bf16_f32 v240, v100, v101
    v_cvt_pk_bf16_f32 v241, v102, v103
    v_mfma_f32_16x16x32_bf16 v[36:39], v[148:151], v[128:131], 0
    v_cvt_pk_bf16_f32 v228, v88, v89
    v_cvt_pk_bf16_f32 v229, v90, v91
    v_mfma_f32_16x16x32_bf16 v[32:35], v[144:147], v[128:131], 0
    v_cvt_pk_bf16_f32 v238, v92, v93
    v_cvt_pk_bf16_f32 v239, v94, v95
    v_mfma_f32_16x16x32_bf16 v[28:31], v[144:147], v[124:127], 0
    v_cvt_pk_bf16_f32 v226, v80, v81
    v_cvt_pk_bf16_f32 v227, v82, v83
    v_mfma_f32_16x16x32_bf16 v[24:27], v[140:143], v[124:127], 0
    v_cvt_pk_bf16_f32 v236, v84, v85
    v_cvt_pk_bf16_f32 v237, v86, v87
    v_mfma_f32_16x16x32_bf16 v[20:23], v[140:143], v[120:123], 0
    s_branch LB_s1_in
LB_s1:
    s_sleep 1
LB_s1_in:
    ds_read_b32 v14, v10 offset:0
    ds_read_b64 v[136:137], v218
    ds_read_b64 v[138:139], v219
    ds_read_b64 v[224:225], v218 offset:1024
    ds_read_b64 v[234:235], v219 offset:1024
    s_waitcnt lgkmcnt(0)
    v_readfirstlane_b32 s78, v14
    s_nop 0
    s_cmp_ge_u32 s78, 4
    s_cbranch_scc0 LB_s1
    v_mfma_f32_16x16x32_bf16 v[16:19], v[136:139], v[120:123], v[212:215]
    v_cndmask_b32 v60, v44, v45, s[88:89]
    s_add_u32 m0, s34, 36864
    s_add_u32 s35, s44, 0
    buffer_load_dwordx4 v245, s[64:67], s35 offen  lds
    v_cndmask_b32 v61, v40, v41, s[88:89]
    v_cndmask_b32 v54, v61, v60, s[90:91]
    v_cndmask_b32 v60, v46, v47, s[88:89]
    v_cndmask_b32 v61, v42, v43, s[88:89]
    v_cndmask_b32 v55, v61, v60, s[92:93]
    v_max_f32 v59, v54, v55
    v_cndmask_b32 v60, v36, v37, s[88:89]
    v_cndmask_b32 v61, v32, v33, s[88:89]
    v_cndmask_b32 v52, v61, v60, s[90:91]
    v_cndmask_b32 v60, v38, v39, s[88:89]
    v_cndmask_b32 v61, v34, v35, s[88:89]
    v_cndmask_b32 v53, v61, v60, s[92:93]
    v_max_f32 v58, v52, v53
    v_cndmask_b32 v60, v28, v29, s[88:89]
    v_cndmask_b32 v61, v24, v25, s[88:89]
    v_cndmask_b32 v50, v61, v60, s[90:91]
    v_cndmask_b32 v60, v30, v31, s[88:89]
    v_cndmask_b32 v61, v26, v27, s[88:89]
    s_add_u32 m0, s34, 40960
    s_add_u32 s35, s44, 65536
    buffer_load_dwordx4 v245, s[64:67], s35 offen  lds
    v_cndmask_b32 v51, v61, v60, s[92:93]
    v_max_f32 v57, v50, v51
    v_cndmask_b32 v60, v20, v21, s[88:89]
    v_cndmask_b32 v61, v16, v17, s[88:89]
    v_cndmask_b32 v48, v61, v60, s[90:91]
    v_cndmask_b32 v60, v22, v23, s[88:89]
    v_cndmask_b32 v61, v18, v19, s[88:89]
    v_cndmask_b32 v49, v61, v60, s[92:93]
    v_max_f32 v56, v48, v49
    s_mov_b32 s80, 0x3e8293ee
    v_permlane32_swap_b32 v58, v59
    v_permlane32_swap_b32 v56, v57
    v_max_f32 v58, v58, v59
    v_max_f32 v56, v56, v57
    s_nop 1
    v_permlane16_swap_b32 v56, v58
    v_max_f32 v56, v56, v58
    v_mul_f32 v56, s80, v56
    v_mov_b32 v58, v56
    s_nop 1
    v_permlane16_swap_b32 v56, v58
    s_add_u32 m0, s34, 45056
    s_add_u32 s35, s44, 131072
    buffer_load_dwordx4 v245, s[64:67], s35 offen  lds
    v_mov_b32 v57, v56
    v_mov_b32 v59, v58
    s_nop 0
    v_permlane32_swap_b32 v56, v57
    v_permlane32_swap_b32 v58, v59
    v_fma_f32 v48, v48, s80, -v56
    v_fma_f32 v49, v49, s80, -v56
    v_fma_f32 v50, v50, s80, -v57
    v_fma_f32 v51, v51, s80, -v57
    v_fma_f32 v52, v52, s80, -v58
    v_fma_f32 v53, v53, s80, -v58
    v_fma_f32 v54, v54, s80, -v59
    v_fma_f32 v55, v55, s80, -v59
    v_exp_f32 v48, v48
    v_exp_f32 v49, v49
    v_exp_f32 v50, v50
    v_exp_f32 v51, v51
    v_exp_f32 v52, v52
    v_exp_f32 v53, v53
    s_add_u32 m0, s34, 49152
    s_add_u32 s35, s44, 196608
    buffer_load_dwordx4 v245, s[64:67], s35 offen  lds
    v_exp_f32 v54, v54
    v_exp_f32 v55, v55
    v_add_f32 v56, v48, v49
    v_add_f32 v57, v50, v51
    v_add_f32 v58, v52, v53
    v_add_f32 v59, v54, v55
    s_nop 1
    v_permlane32_swap_b32 v58, v59
    v_permlane32_swap_b32 v56, v57
    v_add_f32 v58, v58, v59
    v_add_f32 v56, v56, v57
    s_nop 1
    v_permlane16_swap_b32 v56, v58
    v_add_f32 v56, v56, v58
    v_rcp_f32 v56, v56
    s_nop 0
    v_mov_b32 v58, v56
    s_nop 1
    v_permlane16_swap_b32 v56, v58
    v_mov_b32 v57, v56
    v_mov_b32 v59, v58
    s_nop 0
    v_permlane32_swap_b32 v56, v57
    v_permlane32_swap_b32 v58, v59
    s_add_u32 m0, s34, 53248
    s_add_u32 s35, s45, 0
    buffer_load_dwordx4 v245, s[64:67], s35 offen  lds
    v_mul_f32 v48, v48, v56
    v_mul_f32 v49, v49, v56
    v_cvt_pk_bf16_f32 v48, v48, v49
    v_perm_b32 v64, v48, v48, v208
    v_perm_b32 v65, v48, v48, v209
    v_perm_b32 v66, v48, v48, v210
    v_perm_b32 v67, v48, v48, v211
    v_mul_f32 v50, v50, v57
    v_mul_f32 v51, v51, v57
    v_cvt_pk_bf16_f32 v50, v50, v51
    v_perm_b32 v68, v50, v50, v208
    v_perm_b32 v69, v50, v50, v209
    v_perm_b32 v70, v50, v50, v210
    v_perm_b32 v71, v50, v50, v211
    v_mfma_f32_16x16x32_bf16 v[16:19], v[224:227], v[64:67], 0
    v_mfma_f32_16x16x32_bf16 v[20:23], v[234:237], v[64:67], 0
    v_mul_f32 v52, v52, v58
    v_mul_f32 v53, v53, v58
    s_add_u32 m0, s34, 57344
    s_add_u32 s35, s45, 65536
    buffer_load_dwordx4 v245, s[64:67], s35 offen  lds
    v_cvt_pk_bf16_f32 v52, v52, v53
    v_perm_b32 v72, v52, v52, v208
    v_perm_b32 v73, v52, v52, v209
    v_perm_b32 v74, v52, v52, v210
    v_perm_b32 v75, v52, v52, v211
    v_mfma_f32_16x16x32_bf16 v[24:27], v[226:229], v[68:71], 0
    v_mfma_f32_16x16x32_bf16 v[28:31], v[236:239], v[68:71], 0
    v_mul_f32 v54, v54, v59
    v_mul_f32 v55, v55, v59
    v_cvt_pk_bf16_f32 v54, v54, v55
    v_perm_b32 v76, v54, v54, v208
    v_perm_b32 v77, v54, v54, v209
    v_perm_b32 v78, v54, v54, v210
    v_perm_b32 v79, v54, v54, v211
    v_mfma_f32_16x16x32_bf16 v[32:35], v[228:231], v[72:75], 0
    v_mfma_f32_16x16x32_bf16 v[36:39], v[238:241], v[72:75], 0
    v_mfma_f32_16x16x32_bf16 v[40:43], v[230:233], v[76:79], 0
    v_mfma_f32_16x16x32_bf16 v[44:47], v[240:243], v[76:79], 0
    v_cvt_pk_bf16_f32 v80, v16, v17
    v_cvt_pk_bf16_f32 v81, v18, v19
    v_cvt_pk_bf16_f32 v82, v20, v21
    v_cvt_pk_bf16_f32 v83, v22, v23
    s_add_u32 s95, s94, 0
    buffer_store_dwordx4 v[80:83], v12, s[52:55], s95 offen sc1
    v_cvt_pk_bf16_f32 v84, v24, v25
    v_cvt_pk_bf16_f32 v85, v26, v27
    v_cvt_pk_bf16_f32 v86, v28, v29
    v_cvt_pk_bf16_f32 v87, v30, v31
    s_add_u32 s95, s94, 32768
    buffer_store_dwordx4 v[84:87], v12, s[52:55], s95 offen sc1
    v_cvt_pk_bf16_f32 v88, v32, v33
    v_cvt_pk_bf16_f32 v89, v34, v35
    v_cvt_pk_bf16_f32 v90, v36, v37
    v_cvt_pk_bf16_f32 v91, v38, v39
    s_add_u32 s95, s94, 65536
    buffer_store_dwordx4 v[88:91], v12, s[52:55], s95 offen sc1
    v_cvt_pk_bf16_f32 v92, v40, v41
    v_cvt_pk_bf16_f32 v93, v42, v43
    v_cvt_pk_bf16_f32 v94, v44, v45
    v_cvt_pk_bf16_f32 v95, v46, v47
    s_add_u32 s95, s94, 98304
    buffer_store_dwordx4 v[92:95], v12, s[52:55], s95 offen sc1
    s_add_u32 m0, s34, 61440
    s_add_u32 s35, s45, 131072
    buffer_load_dwordx4 v245, s[64:67], s35 offen  lds
    v_xor_b32 v2, 0, v244
    v_xor_b32 v3, 32, v244
    v_xor_b32 v4, 64, v244
    v_xor_b32 v5, 96, v244
    s_add_u32 m0, s34, 65536
    s_add_u32 s35, s45, 196608
    buffer_load_dwordx4 v245, s[64:67], s35 offen  lds
    v_xor_b32 v6, 2048, v244
    v_xor_b32 v7, 2080, v244
    v_xor_b32 v8, 2112, v244
    v_xor_b32 v9, 2144, v244
    s_waitcnt vmcnt(6)
    s_mov_b64 exec, 1
    ds_add_u32 v10, v11 offset:8
    s_mov_b64 exec, -1
    s_add_u32 m0, s34, 69632
    s_add_u32 s35, s46, 0
    buffer_load_dwordx4 v245, s[64:67], s35 offen  lds
    v_add_u32 v224, 65536, v2
    v_add_u32 v225, 65536, v3
    s_add_u32 m0, s34, 73728
    s_add_u32 s35, s46, 65536
    buffer_load_dwordx4 v245, s[64:67], s35 offen  lds
    v_add_u32 v226, 65536, v4
    s_add_u32 m0, s34, 77824
    s_add_u32 s35, s46, 131072
    buffer_load_dwordx4 v245, s[64:67], s35 offen  lds
    v_add_u32 v227, 65536, v5
    v_add_u32 v228, 65536, v6
    s_add_u32 m0, s34, 81920
    s_add_u32 s35, s46, 196608
    buffer_load_dwordx4 v245, s[64:67], s35 offen  lds
    v_add_u32 v229, 65536, v7
    s_add_u32 m0, s34, 86016
    s_add_u32 s35, s47, 0
    buffer_load_dwordx4 v245, s[64:67], s35 offen  lds
    v_add_u32 v230, 65536, v8
    v_add_u32 v231, 65536, v9
    s_add_u32 m0, s34, 0
    s_add_u32 s35, s47, 65536
    buffer_load_dwordx4 v245, s[64:67], s35 offen  lds
    v_add_u32 v15, 32768, v12
    s_waitcnt vmcnt(8)
    s_mov_b64 exec, 1
    buffer_store_dword v11, v220, s[52:55], s97 offen sc1
    s_mov_b64 exec, -1
    s_branch LB_s2_in
LB_s2:
    s_sleep 1
LB_s2_in:
    ds_read_b32 v14, v10 offset:8
    s_waitcnt lgkmcnt(0)
    v_readfirstlane_b32 s78, v14
    s_nop 0
    s_cmp_ge_u32 s78, 8
    s_cbranch_scc0 LB_s2
    s_add_u32 m0, s34, 4096
    s_add_u32 s35, s47, 131072
    buffer_load_dwordx4 v245, s[64:67], s35 offen  lds
    ds_read_b64_tr_b16 v[48:49], v2 offset:36864
    ds_read_b64_tr_b16 v[50:51], v6 offset:36864
    s_add_u32 m0, s34, 8192
    s_add_u32 s35, s47, 196608
    buffer_load_dwordx4 v245, s[64:67], s35 offen  lds
    ds_read_b64_tr_b16 v[52:53], v3 offset:36864
    s_add_u32 m0, s34, 12288
    s_add_u32 s35, s48, 0
    buffer_load_dwordx4 v245, s[64:67], s35 offen  lds
    ds_read_b64_tr_b16 v[54:55], v7 offset:36864
    s_add_u32 m0, s34, 16384
    s_add_u32 s35, s48, 65536
    buffer_load_dwordx4 v245, s[64:67], s35 offen  lds
    ds_read_b64_tr_b16 v[56:57], v4 offset:36864
    ds_read_b64_tr_b16 v[58:59], v8 offset:36864
    s_add_u32 m0, s34, 20480
    s_add_u32 s35, s48, 131072
    buffer_load_dwordx4 v245, s[64:67], s35 offen  lds
    ds_read_b64_tr_b16 v[60:61], v5 offset:36864
    s_add_u32 m0, s34, 110592
    s_add_u32 s35, s48, 196608
    buffer_load_dwordx4 v245, s[64:67], s35 offen  lds
    ds_read_b64_tr_b16 v[62:63], v9 offset:36864
    s_add_u32 m0, s34, 114688
    s_add_u32 s35, s49, 0
    buffer_load_dwordx4 v245, s[64:67], s35 offen  lds
    ds_read_b64_tr_b16 v[64:65], v2 offset:40960
    ds_read_b64_tr_b16 v[66:67], v6 offset:40960
    s_add_u32 m0, s34, 118784
    s_add_u32 s35, s49, 65536
    buffer_load_dwordx4 v245, s[64:67], s35 offen  lds
    ds_read_b64_tr_b16 v[68:69], v3 offset:40960
    s_add_u32 m0, s34, 122880
    s_add_u32 s35, s49, 131072
    buffer_load_dwordx4 v245, s[64:67], s35 offen  lds
    ds_read_b64_tr_b16 v[70:71], v7 offset:40960
    s_add_u32 m0, s34, 24576
    s_add_u32 s35, s49, 196608
    buffer_load_dwordx4 v245, s[64:67], s35 offen  lds
    ds_read_b64_tr_b16 v[72:73], v4 offset:40960
    ds_read_b64_tr_b16 v[74:75], v8 offset:40960
    s_add_u32 m0, s34, 28672
    s_add_u32 s35, s50, 0
    buffer_load_dwordx4 v245, s[64:67], s35 offen  lds
    ds_read_b64_tr_b16 v[76:77], v5 offset:40960
    s_add_u32 m0, s34, 32768
    s_add_u32 s35, s50, 65536
    buffer_load_dwordx4 v245, s[64:67], s35 offen  lds
    ds_read_b64_tr_b16 v[78:79], v9 offset:40960
    s_waitcnt vmcnt(0)
    s_mov_b64 exec, 0xffffffff
    s_mov_b32 s79, 0
LB_po:
    buffer_load_dword v14, v247, s[52:55], s30 offen sc1
    s_add_u32 s79, s79, 1
    s_cmp_gt_u32 s79, 200000
    s_cbranch_scc1 LB_po_x
    s_waitcnt vmcnt(0)
    v_cmp_ne_u32 vcc, 1, v14
    s_cbranch_vccz LB_po_x
    s_mov_b64 exec, vcc
    s_sleep 8
    s_branch LB_po
LB_po_x:
    s_waitcnt vmcnt(0)
    s_mov_b64 exec, -1
    buffer_load_dwordx4 v[144:147], v12, s[52:55], s36 offen offset:0 sc1
    buffer_load_dwordx4 v[148:151], v15, s[52:55], s36 offen offset:0 sc1
    buffer_load_dwordx4 v[152:155], v12, s[52:55], s36 offen offset:1024 sc1
    buffer_load_dwordx4 v[156:159], v15, s[52:55], s36 offen offset:1024 sc1
    buffer_load_dwordx4 v[160:163], v12, s[52:55], s36 offen offset:2048 sc1
    buffer_load_dwordx4 v[164:167], v15, s[52:55], s36 offen offset:2048 sc1
    buffer_load_dwordx4 v[168:171], v12, s[52:55], s36 offen offset:3072 sc1
    buffer_load_dwordx4 v[172:175], v15, s[52:55], s36 offen offset:3072 sc1
    buffer_load_dwordx4 v[176:179], v12, s[52:55], s37 offen offset:0 sc1
    buffer_load_dwordx4 v[180:183], v15, s[52:55], s37 offen offset:0 sc1
    s_setprio 1
    s_mov_b64 exec, 1
    ds_add_u32 v10, v11 offset:16
    s_mov_b64 exec, -1
    s_branch LB_s4_in
LB_s4:
    s_sleep 1
LB_s4_in:
    ds_read_b32 v14, v10 offset:16
    s_waitcnt lgkmcnt(0)
    v_readfirstlane_b32 s78, v14
    s_nop 0
    s_cmp_ge_u32 s78, 4
    s_cbranch_scc0 LB_s4
    s_waitcnt vmcnt(8)
    v_mfma_f32_16x16x32_bf16 v[16:19], v[48:51], v[144:147], 0
    buffer_load_dwordx4 v[184:187], v12, s[52:55], s37 offen offset:1024 sc1
    buffer_load_dwordx4 v[188:191], v15, s[52:55], s37 offen offset:1024 sc1
    v_mfma_f32_16x16x32_bf16 v[20:23], v[52:55], v[144:147], 0
    ds_read_b64_tr_b16 v[80:81], v2 offset:45056
    v_mfma_f32_16x16x32_bf16 v[24:27], v[56:59], v[144:147], 0
    ds_read_b64_tr_b16 v[82:83], v6 offset:45056
    v_mfma_f32_16x16x32_bf16 v[28:31], v[60:63], v[144:147], 0
    ds_read_b64_tr_b16 v[84:85], v3 offset:45056
    v_mfma_f32_16x16x32_bf16 v[32:35], v[48:51], v[148:151], 0
    ds_read_b64_tr_b16 v[86:87], v7 offset:45056
    ds_read_b64_tr_b16 v[88:89], v4 offset:45056
    v_mfma_f32_16x16x32_bf16 v[36:39], v[52:55], v[148:151], 0
    ds_read_b64_tr_b16 v[90:91], v8 offset:45056
    v_mfma_f32_16x16x32_bf16 v[40:43], v[56:59], v[148:151], 0
    ds_read_b64_tr_b16 v[92:93], v5 offset:45056
    v_mfma_f32_16x16x32_bf16 v[44:47], v[60:63], v[148:151], 0
    ds_read_b64_tr_b16 v[94:95], v9 offset:45056
    s_waitcnt vmcnt(8)
    v_mfma_f32_16x16x32_bf16 v[16:19], v[64:67], v[152:155], v[16:19]
    buffer_load_dwordx4 v[144:147], v12, s[52:55], s37 offen offset:2048 sc1
    buffer_load_dwordx4 v[148:151], v15, s[52:55], s37 offen offset:2048 sc1
    v_mfma_f32_16x16x32_bf16 v[20:23], v[68:71], v[152:155], v[20:23]
    ds_read_b64_tr_b16 v[96:97], v2 offset:49152
    v_mfma_f32_16x16x32_bf16 v[24:27], v[72:75], v[152:155], v[24:27]
    ds_read_b64_tr_b16 v[98:99], v6 offset:49152
    v_mfma_f32_16x16x32_bf16 v[28:31], v[76:79], v[152:155], v[28:31]
    ds_read_b64_tr_b16 v[100:101], v3 offset:49152
    v_mfma_f32_16x16x32_bf16 v[32:35], v[64:67], v[156:159], v[32:35]
    ds_read_b64_tr_b16 v[102:103], v7 offset:49152
    ds_read_b64_tr_b16 v[104:105], v4 offset:49152
    v_mfma_f32_16x16x32_bf16 v[36:39], v[68:71], v[156:159], v[36:39]
    ds_read_b64_tr_b16 v[106:107], v8 offset:49152
    v_mfma_f32_16x16x32_bf16 v[40:43], v[72:75], v[156:159], v[40:43]
    ds_read_b64_tr_b16 v[108:109], v5 offset:49152
    v_mfma_f32_16x16x32_bf16 v[44:47], v[76:79], v[156:159], v[44:47]
    ds_read_b64_tr_b16 v[110:111], v9 offset:49152
    s_waitcnt vmcnt(8) lgkmcnt(8)
    v_mfma_f32_16x16x32_bf16 v[16:19], v[80:83], v[160:163], v[16:19]
    buffer_load_dwordx4 v[152:155], v12, s[52:55], s37 offen offset:3072 sc1
    buffer_load_dwordx4 v[156:159], v15, s[52:55], s37 offen offset:3072 sc1
    v_mfma_f32_16x16x32_bf16 v[20:23], v[84:87], v[160:163], v[20:23]
    ds_read_b64_tr_b16 v[112:113], v2 offset:53248
    v_mfma_f32_16x16x32_bf16 v[24:27], v[88:91], v[160:163], v[24:27]
    ds_read_b64_tr_b16 v[114:115], v6 offset:53248
    v_mfma_f32_16x16x32_bf16 v[28:31], v[92:95], v[160:163], v[28:31]
    ds_read_b64_tr_b16 v[116:117], v3 offset:53248
    v_mfma_f32_16x16x32_bf16 v[32:35], v[80:83], v[164:167], v[32:35]
    ds_read_b64_tr_b16 v[118:119], v7 offset:53248
    ds_read_b64_tr_b16 v[120:121], v4 offset:53248
    v_mfma_f32_16x16x32_bf16 v[36:39], v[84:87], v[164:167], v[36:39]
    ds_read_b64_tr_b16 v[122:123], v8 offset:53248
    v_mfma_f32_16x16x32_bf16 v[40:43], v[88:91], v[164:167], v[40:43]
    ds_read_b64_tr_b16 v[124:125], v5 offset:53248
    v_mfma_f32_16x16x32_bf16 v[44:47], v[92:95], v[164:167], v[44:47]
    ds_read_b64_tr_b16 v[126:127], v9 offset:53248
    s_waitcnt vmcnt(8) lgkmcnt(8)
    v_mfma_f32_16x16x32_bf16 v[16:19], v[96:99], v[168:171], v[16:19]
    buffer_load_dwordx4 v[160:163], v12, s[52:55], s38 offen offset:0 sc1
    buffer_load_dwordx4 v[164:167], v15, s[52:55], s38 offen offset:0 sc1
    v_mfma_f32_16x16x32_bf16 v[20:23], v[100:103], v[168:171], v[20:23]
    ds_read_b64_tr_b16 v[128:129], v2 offset:57344
    v_mfma_f32_16x16x32_bf16 v[24:27], v[104:107], v[168:171], v[24:27]
    ds_read_b64_tr_b16 v[130:131], v6 offset:57344
    v_mfma_f32_16x16x32_bf16 v[28:31], v[108:111], v[168:171], v[28:31]
    ds_read_b64_tr_b16 v[132:133], v3 offset:57344
    v_mfma_f32_16x16x32_bf16 v[32:35], v[96:99], v[172:175], v[32:35]
    ds_read_b64_tr_b16 v[134:135], v7 offset:57344
    ds_read_b64_tr_b16 v[136:137], v4 offset:57344
    v_mfma_f32_16x16x32_bf16 v[36:39], v[100:103], v[172:175], v[36:39]
    ds_read_b64_tr_b16 v[138:139], v8 offset:57344
    v_mfma_f32_16x16x32_bf16 v[40:43], v[104:107], v[172:175], v[40:43]
    ds_read_b64_tr_b16 v[140:141], v5 offset:57344
    v_mfma_f32_16x16x32_bf16 v[44:47], v[108:111], v[172:175], v[44:47]
    ds_read_b64_tr_b16 v[142:143], v9 offset:57344
    s_waitcnt vmcnt(8) lgkmcnt(8)
    v_mfma_f32_16x16x32_bf16 v[16:19], v[112:115], v[176:179], v[16:19]
    buffer_load_dwordx4 v[168:171], v12, s[52:55], s38 offen offset:1024 sc1
    buffer_load_dwordx4 v[172:175], v15, s[52:55], s38 offen offset:1024 sc1
    v_mfma_f32_16x16x32_bf16 v[20:23], v[116:119], v[176:179], v[20:23]
    ds_read_b64_tr_b16 v[48:49], v2 offset:61440
    v_mfma_f32_16x16x32_bf16 v[24:27], v[120:123], v[176:179], v[24:27]
    ds_read_b64_tr_b16 v[50:51], v6 offset:61440
    v_mfma_f32_16x16x32_bf16 v[28:31], v[124:127], v[176:179], v[28:31]
    ds_read_b64_tr_b16 v[52:53], v3 offset:61440
    v_mfma_f32_16x16x32_bf16 v[32:35], v[112:115], v[180:183], v[32:35]
    ds_read_b64_tr_b16 v[54:55], v7 offset:61440
    ds_read_b64_tr_b16 v[56:57], v4 offset:61440
    v_mfma_f32_16x16x32_bf16 v[36:39], v[116:119], v[180:183], v[36:39]
    ds_read_b64_tr_b16 v[58:59], v8 offset:61440
    v_mfma_f32_16x16x32_bf16 v[40:43], v[120:123], v[180:183], v[40:43]
    ds_read_b64_tr_b16 v[60:61], v5 offset:61440
    v_mfma_f32_16x16x32_bf16 v[44:47], v[124:127], v[180:183], v[44:47]
    ds_read_b64_tr_b16 v[62:63], v9 offset:61440
    s_waitcnt vmcnt(8) lgkmcnt(8)
    v_mfma_f32_16x16x32_bf16 v[16:19], v[128:131], v[184:187], v[16:19]
    buffer_load_dwordx4 v[176:179], v12, s[52:55], s38 offen offset:2048 sc1
    buffer_load_dwordx4 v[180:183], v15, s[52:55], s38 offen offset:2048 sc1
    v_mfma_f32_16x16x32_bf16 v[20:23], v[132:135], v[184:187], v[20:23]
    ds_read_b64_tr_b16 v[64:65], v224 offset:0
    v_mfma_f32_16x16x32_bf16 v[24:27], v[136:139], v[184:187], v[24:27]
    ds_read_b64_tr_b16 v[66:67], v228 offset:0
    v_mfma_f32_16x16x32_bf16 v[28:31], v[140:143], v[184:187], v[28:31]
    ds_read_b64_tr_b16 v[68:69], v225 offset:0
    v_mfma_f32_16x16x32_bf16 v[32:35], v[128:131], v[188:191], v[32:35]
    ds_read_b64_tr_b16 v[70:71], v229 offset:0
    ds_read_b64_tr_b16 v[72:73], v226 offset:0
    v_mfma_f32_16x16x32_bf16 v[36:39], v[132:135], v[188:191], v[36:39]
    ds_read_b64_tr_b16 v[74:75], v230 offset:0
    v_mfma_f32_16x16x32_bf16 v[40:43], v[136:139], v[188:191], v[40:43]
    ds_read_b64_tr_b16 v[76:77], v227 offset:0
    v_mfma_f32_16x16x32_bf16 v[44:47], v[140:143], v[188:191], v[44:47]
    ds_read_b64_tr_b16 v[78:79], v231 offset:0
    s_waitcnt vmcnt(8) lgkmcnt(8)
    v_mfma_f32_16x16x32_bf16 v[16:19], v[48:51], v[144:147], v[16:19]
    buffer_load_dwordx4 v[184:187], v12, s[52:55], s38 offen offset:3072 sc1
    buffer_load_dwordx4 v[188:191], v15, s[52:55], s38 offen offset:3072 sc1
    v_mfma_f32_16x16x32_bf16 v[20:23], v[52:55], v[144:147], v[20:23]
    ds_read_b64_tr_b16 v[80:81], v224 offset:4096
    v_mfma_f32_16x16x32_bf16 v[24:27], v[56:59], v[144:147], v[24:27]
    ds_read_b64_tr_b16 v[82:83], v228 offset:4096
    v_mfma_f32_16x16x32_bf16 v[28:31], v[60:63], v[144:147], v[28:31]
    ds_read_b64_tr_b16 v[84:85], v225 offset:4096
    v_mfma_f32_16x16x32_bf16 v[32:35], v[48:51], v[148:151], v[32:35]
    ds_read_b64_tr_b16 v[86:87], v229 offset:4096
    ds_read_b64_tr_b16 v[88:89], v226 offset:4096
    v_mfma_f32_16x16x32_bf16 v[36:39], v[52:55], v[148:151], v[36:39]
    ds_read_b64_tr_b16 v[90:91], v230 offset:4096
    v_mfma_f32_16x16x32_bf16 v[40:43], v[56:59], v[148:151], v[40:43]
    ds_read_b64_tr_b16 v[92:93], v227 offset:4096
    v_mfma_f32_16x16x32_bf16 v[44:47], v[60:63], v[148:151], v[44:47]
    ds_read_b64_tr_b16 v[94:95], v231 offset:4096
    s_waitcnt vmcnt(8) lgkmcnt(8)
    v_mfma_f32_16x16x32_bf16 v[16:19], v[64:67], v[152:155], v[16:19]
    buffer_load_dwordx4 v[144:147], v12, s[52:55], s39 offen offset:0 sc1
    buffer_load_dwordx4 v[148:151], v15, s[52:55], s39 offen offset:0 sc1
    v_mfma_f32_16x16x32_bf16 v[20:23], v[68:71], v[152:155], v[20:23]
    ds_read_b64_tr_b16 v[96:97], v224 offset:8192
    v_mfma_f32_16x16x32_bf16 v[24:27], v[72:75], v[152:155], v[24:27]
    ds_read_b64_tr_b16 v[98:99], v228 offset:8192
    v_mfma_f32_16x16x32_bf16 v[28:31], v[76:79], v[152:155], v[28:31]
    ds_read_b64_tr_b16 v[100:101], v225 offset:8192
    v_mfma_f32_16x16x32_bf16 v[32:35], v[64:67], v[156:159], v[32:35]
    ds_read_b64_tr_b16 v[102:103], v229 offset:8192
    ds_read_b64_tr_b16 v[104:105], v226 offset:8192
    v_mfma_f32_16x16x32_bf16 v[36:39], v[68:71], v[156:159], v[36:39]
    ds_read_b64_tr_b16 v[106:107], v230 offset:8192
    v_mfma_f32_16x16x32_bf16 v[40:43], v[72:75], v[156:159], v[40:43]
    ds_read_b64_tr_b16 v[108:109], v227 offset:8192
    v_mfma_f32_16x16x32_bf16 v[44:47], v[76:79], v[156:159], v[44:47]
    ds_read_b64_tr_b16 v[110:111], v231 offset:8192
    s_waitcnt vmcnt(8) lgkmcnt(8)
    v_mfma_f32_16x16x32_bf16 v[16:19], v[80:83], v[160:163], v[16:19]
    buffer_load_dwordx4 v[152:155], v12, s[52:55], s39 offen offset:1024 sc1
    buffer_load_dwordx4 v[156:159], v15, s[52:55], s39 offen offset:1024 sc1
    v_mfma_f32_16x16x32_bf16 v[20:23], v[84:87], v[160:163], v[20:23]
    ds_read_b64_tr_b16 v[112:113], v224 offset:12288
    v_mfma_f32_16x16x32_bf16 v[24:27], v[88:91], v[160:163], v[24:27]
    ds_read_b64_tr_b16 v[114:115], v228 offset:12288
    v_mfma_f32_16x16x32_bf16 v[28:31], v[92:95], v[160:163], v[28:31]
    ds_read_b64_tr_b16 v[116:117], v225 offset:12288
    v_mfma_f32_16x16x32_bf16 v[32:35], v[80:83], v[164:167], v[32:35]
    ds_read_b64_tr_b16 v[118:119], v229 offset:12288
    ds_read_b64_tr_b16 v[120:121], v226 offset:12288
    v_mfma_f32_16x16x32_bf16 v[36:39], v[84:87], v[164:167], v[36:39]
    ds_read_b64_tr_b16 v[122:123], v230 offset:12288
    v_mfma_f32_16x16x32_bf16 v[40:43], v[88:91], v[164:167], v[40:43]
    ds_read_b64_tr_b16 v[124:125], v227 offset:12288
    v_mfma_f32_16x16x32_bf16 v[44:47], v[92:95], v[164:167], v[44:47]
    ds_read_b64_tr_b16 v[126:127], v231 offset:12288
    s_waitcnt vmcnt(8) lgkmcnt(8)
    v_mfma_f32_16x16x32_bf16 v[16:19], v[96:99], v[168:171], v[16:19]
    buffer_load_dwordx4 v[160:163], v12, s[52:55], s39 offen offset:2048 sc1
    buffer_load_dwordx4 v[164:167], v15, s[52:55], s39 offen offset:2048 sc1
    v_mfma_f32_16x16x32_bf16 v[20:23], v[100:103], v[168:171], v[20:23]
    ds_read_b64_tr_b16 v[128:129], v224 offset:16384
    v_mfma_f32_16x16x32_bf16 v[24:27], v[104:107], v[168:171], v[24:27]
    ds_read_b64_tr_b16 v[130:131], v228 offset:16384
    v_mfma_f32_16x16x32_bf16 v[28:31], v[108:111], v[168:171], v[28:31]
    ds_read_b64_tr_b16 v[132:133], v225 offset:16384
    v_mfma_f32_16x16x32_bf16 v[32:35], v[96:99], v[172:175], v[32:35]
    ds_read_b64_tr_b16 v[134:135], v229 offset:16384
    ds_read_b64_tr_b16 v[136:137], v226 offset:16384
    v_mfma_f32_16x16x32_bf16 v[36:39], v[100:103], v[172:175], v[36:39]
    ds_read_b64_tr_b16 v[138:139], v230 offset:16384
    v_mfma_f32_16x16x32_bf16 v[40:43], v[104:107], v[172:175], v[40:43]
    ds_read_b64_tr_b16 v[140:141], v227 offset:16384
    v_mfma_f32_16x16x32_bf16 v[44:47], v[108:111], v[172:175], v[44:47]
    ds_read_b64_tr_b16 v[142:143], v231 offset:16384
    s_waitcnt vmcnt(8) lgkmcnt(8)
    v_mfma_f32_16x16x32_bf16 v[16:19], v[112:115], v[176:179], v[16:19]
    buffer_load_dwordx4 v[168:171], v12, s[52:55], s39 offen offset:3072 sc1
    buffer_load_dwordx4 v[172:175], v15, s[52:55], s39 offen offset:3072 sc1
    v_mfma_f32_16x16x32_bf16 v[20:23], v[116:119], v[176:179], v[20:23]
    ds_read_b64_tr_b16 v[48:49], v224 offset:20480
    v_mfma_f32_16x16x32_bf16 v[24:27], v[120:123], v[176:179], v[24:27]
    ds_read_b64_tr_b16 v[50:51], v228 offset:20480
    v_mfma_f32_16x16x32_bf16 v[28:31], v[124:127], v[176:179], v[28:31]
    ds_read_b64_tr_b16 v[52:53], v225 offset:20480
    v_mfma_f32_16x16x32_bf16 v[32:35], v[112:115], v[180:183], v[32:35]
    ds_read_b64_tr_b16 v[54:55], v229 offset:20480
    ds_read_b64_tr_b16 v[56:57], v226 offset:20480
    v_mfma_f32_16x16x32_bf16 v[36:39], v[116:119], v[180:183], v[36:39]
    ds_read_b64_tr_b16 v[58:59], v230 offset:20480
    v_mfma_f32_16x16x32_bf16 v[40:43], v[120:123], v[180:183], v[40:43]
    ds_read_b64_tr_b16 v[60:61], v227 offset:20480
    v_mfma_f32_16x16x32_bf16 v[44:47], v[124:127], v[180:183], v[44:47]
    ds_read_b64_tr_b16 v[62:63], v231 offset:20480
    s_waitcnt vmcnt(8) lgkmcnt(8)
    v_mfma_f32_16x16x32_bf16 v[16:19], v[128:131], v[184:187], v[16:19]
    buffer_load_dwordx4 v[176:179], v12, s[52:55], s40 offen offset:0 sc1
    buffer_load_dwordx4 v[180:183], v15, s[52:55], s40 offen offset:0 sc1
    v_mfma_f32_16x16x32_bf16 v[20:23], v[132:135], v[184:187], v[20:23]
    ds_read_b64_tr_b16 v[64:65], v2 offset:0
    v_mfma_f32_16x16x32_bf16 v[24:27], v[136:139], v[184:187], v[24:27]
    ds_read_b64_tr_b16 v[66:67], v6 offset:0
    v_mfma_f32_16x16x32_bf16 v[28:31], v[140:143], v[184:187], v[28:31]
    ds_read_b64_tr_b16 v[68:69], v3 offset:0
    v_mfma_f32_16x16x32_bf16 v[32:35], v[128:131], v[188:191], v[32:35]
    ds_read_b64_tr_b16 v[70:71], v7 offset:0
    ds_read_b64_tr_b16 v[72:73], v4 offset:0
    v_mfma_f32_16x16x32_bf16 v[36:39], v[132:135], v[188:191], v[36:39]
    ds_read_b64_tr_b16 v[74:75], v8 offset:0
    v_mfma_f32_16x16x32_bf16 v[40:43], v[136:139], v[188:191], v[40:43]
    ds_read_b64_tr_b16 v[76:77], v5 offset:0
    v_mfma_f32_16x16x32_bf16 v[44:47], v[140:143], v[188:191], v[44:47]
    ds_read_b64_tr_b16 v[78:79], v9 offset:0
    s_waitcnt vmcnt(8) lgkmcnt(8)
    v_mfma_f32_16x16x32_bf16 v[16:19], v[48:51], v[144:147], v[16:19]
    buffer_load_dwordx4 v[184:187], v12, s[52:55], s40 offen offset:1024 sc1
    buffer_load_dwordx4 v[188:191], v15, s[52:55], s40 offen offset:1024 sc1
    v_mfma_f32_16x16x32_bf16 v[20:23], v[52:55], v[144:147], v[20:23]
    ds_read_b64_tr_b16 v[80:81], v2 offset:4096
    v_mfma_f32_16x16x32_bf16 v[24:27], v[56:59], v[144:147], v[24:27]
    ds_read_b64_tr_b16 v[82:83], v6 offset:4096
    v_mfma_f32_16x16x32_bf16 v[28:31], v[60:63], v[144:147], v[28:31]
    ds_read_b64_tr_b16 v[84:85], v3 offset:4096
    v_mfma_f32_16x16x32_bf16 v[32:35], v[48:51], v[148:151], v[32:35]
    ds_read_b64_tr_b16 v[86:87], v7 offset:4096
    ds_read_b64_tr_b16 v[88:89], v4 offset:4096
    v_mfma_f32_16x16x32_bf16 v[36:39], v[52:55], v[148:151], v[36:39]
    ds_read_b64_tr_b16 v[90:91], v8 offset:4096
    v_mfma_f32_16x16x32_bf16 v[40:43], v[56:59], v[148:151], v[40:43]
    ds_read_b64_tr_b16 v[92:93], v5 offset:4096
    v_mfma_f32_16x16x32_bf16 v[44:47], v[60:63], v[148:151], v[44:47]
    ds_read_b64_tr_b16 v[94:95], v9 offset:4096
    s_waitcnt vmcnt(8) lgkmcnt(8)
    v_mfma_f32_16x16x32_bf16 v[16:19], v[64:67], v[152:155], v[16:19]
    buffer_load_dwordx4 v[144:147], v12, s[52:55], s40 offen offset:2048 sc1
    buffer_load_dwordx4 v[148:151], v15, s[52:55], s40 offen offset:2048 sc1
    v_mfma_f32_16x16x32_bf16 v[20:23], v[68:71], v[152:155], v[20:23]
    ds_read_b64_tr_b16 v[96:97], v2 offset:8192
    v_mfma_f32_16x16x32_bf16 v[24:27], v[72:75], v[152:155], v[24:27]
    ds_read_b64_tr_b16 v[98:99], v6 offset:8192
    v_mfma_f32_16x16x32_bf16 v[28:31], v[76:79], v[152:155], v[28:31]
    ds_read_b64_tr_b16 v[100:101], v3 offset:8192
    v_mfma_f32_16x16x32_bf16 v[32:35], v[64:67], v[156:159], v[32:35]
    ds_read_b64_tr_b16 v[102:103], v7 offset:8192
    ds_read_b64_tr_b16 v[104:105], v4 offset:8192
    v_mfma_f32_16x16x32_bf16 v[36:39], v[68:71], v[156:159], v[36:39]
    ds_read_b64_tr_b16 v[106:107], v8 offset:8192
    v_mfma_f32_16x16x32_bf16 v[40:43], v[72:75], v[156:159], v[40:43]
    ds_read_b64_tr_b16 v[108:109], v5 offset:8192
    v_mfma_f32_16x16x32_bf16 v[44:47], v[76:79], v[156:159], v[44:47]
    ds_read_b64_tr_b16 v[110:111], v9 offset:8192
    s_waitcnt vmcnt(8) lgkmcnt(8)
    v_mfma_f32_16x16x32_bf16 v[16:19], v[80:83], v[160:163], v[16:19]
    buffer_load_dwordx4 v[152:155], v12, s[52:55], s40 offen offset:3072 sc1
    buffer_load_dwordx4 v[156:159], v15, s[52:55], s40 offen offset:3072 sc1
    v_mfma_f32_16x16x32_bf16 v[20:23], v[84:87], v[160:163], v[20:23]
    ds_read_b64_tr_b16 v[112:113], v2 offset:12288
    v_mfma_f32_16x16x32_bf16 v[24:27], v[88:91], v[160:163], v[24:27]
    ds_read_b64_tr_b16 v[114:115], v6 offset:12288
    v_mfma_f32_16x16x32_bf16 v[28:31], v[92:95], v[160:163], v[28:31]
    ds_read_b64_tr_b16 v[116:117], v3 offset:12288
    v_mfma_f32_16x16x32_bf16 v[32:35], v[80:83], v[164:167], v[32:35]
    ds_read_b64_tr_b16 v[118:119], v7 offset:12288
    ds_read_b64_tr_b16 v[120:121], v4 offset:12288
    v_mfma_f32_16x16x32_bf16 v[36:39], v[84:87], v[164:167], v[36:39]
    ds_read_b64_tr_b16 v[122:123], v8 offset:12288
    v_mfma_f32_16x16x32_bf16 v[40:43], v[88:91], v[164:167], v[40:43]
    ds_read_b64_tr_b16 v[124:125], v5 offset:12288
    v_mfma_f32_16x16x32_bf16 v[44:47], v[92:95], v[164:167], v[44:47]
    ds_read_b64_tr_b16 v[126:127], v9 offset:12288
    s_waitcnt vmcnt(8) lgkmcnt(8)
    v_mfma_f32_16x16x32_bf16 v[16:19], v[96:99], v[168:171], v[16:19]
    buffer_load_dwordx4 v[160:163], v12, s[52:55], s41 offen offset:0 sc1
    buffer_load_dwordx4 v[164:167], v15, s[52:55], s41 offen offset:0 sc1
    v_mfma_f32_16x16x32_bf16 v[20:23], v[100:103], v[168:171], v[20:23]
    ds_read_b64_tr_b16 v[128:129], v2 offset:16384
    v_mfma_f32_16x16x32_bf16 v[24:27], v[104:107], v[168:171], v[24:27]
    ds_read_b64_tr_b16 v[130:131], v6 offset:16384
    v_mfma_f32_16x16x32_bf16 v[28:31], v[108:111], v[168:171], v[28:31]
    ds_read_b64_tr_b16 v[132:133], v3 offset:16384
    v_mfma_f32_16x16x32_bf16 v[32:35], v[96:99], v[172:175], v[32:35]
    ds_read_b64_tr_b16 v[134:135], v7 offset:16384
    ds_read_b64_tr_b16 v[136:137], v4 offset:16384
    v_mfma_f32_16x16x32_bf16 v[36:39], v[100:103], v[172:175], v[36:39]
    ds_read_b64_tr_b16 v[138:139], v8 offset:16384
    v_mfma_f32_16x16x32_bf16 v[40:43], v[104:107], v[172:175], v[40:43]
    ds_read_b64_tr_b16 v[140:141], v5 offset:16384
    v_mfma_f32_16x16x32_bf16 v[44:47], v[108:111], v[172:175], v[44:47]
    ds_read_b64_tr_b16 v[142:143], v9 offset:16384
    s_waitcnt vmcnt(8) lgkmcnt(8)
    v_mfma_f32_16x16x32_bf16 v[16:19], v[112:115], v[176:179], v[16:19]
    buffer_load_dwordx4 v[168:171], v12, s[52:55], s41 offen offset:1024 sc1
    buffer_load_dwordx4 v[172:175], v15, s[52:55], s41 offen offset:1024 sc1
    v_mfma_f32_16x16x32_bf16 v[20:23], v[116:119], v[176:179], v[20:23]
    ds_read_b64_tr_b16 v[48:49], v2 offset:20480
    v_mfma_f32_16x16x32_bf16 v[24:27], v[120:123], v[176:179], v[24:27]
    ds_read_b64_tr_b16 v[50:51], v6 offset:20480
    v_mfma_f32_16x16x32_bf16 v[28:31], v[124:127], v[176:179], v[28:31]
    ds_read_b64_tr_b16 v[52:53], v3 offset:20480
    v_mfma_f32_16x16x32_bf16 v[32:35], v[112:115], v[180:183], v[32:35]
    ds_read_b64_tr_b16 v[54:55], v7 offset:20480
    ds_read_b64_tr_b16 v[56:57], v4 offset:20480
    v_mfma_f32_16x16x32_bf16 v[36:39], v[116:119], v[180:183], v[36:39]
    ds_read_b64_tr_b16 v[58:59], v8 offset:20480
    v_mfma_f32_16x16x32_bf16 v[40:43], v[120:123], v[180:183], v[40:43]
    ds_read_b64_tr_b16 v[60:61], v5 offset:20480
    v_mfma_f32_16x16x32_bf16 v[44:47], v[124:127], v[180:183], v[44:47]
    ds_read_b64_tr_b16 v[62:63], v9 offset:20480
    s_waitcnt vmcnt(8) lgkmcnt(8)
    v_mfma_f32_16x16x32_bf16 v[16:19], v[128:131], v[184:187], v[16:19]
    buffer_load_dwordx4 v[176:179], v12, s[52:55], s41 offen offset:2048 sc1
    buffer_load_dwordx4 v[180:183], v15, s[52:55], s41 offen offset:2048 sc1
    v_mfma_f32_16x16x32_bf16 v[20:23], v[132:135], v[184:187], v[20:23]
    ds_read_b64_tr_b16 v[64:65], v224 offset:45056
    v_mfma_f32_16x16x32_bf16 v[24:27], v[136:139], v[184:187], v[24:27]
    ds_read_b64_tr_b16 v[66:67], v228 offset:45056
    v_mfma_f32_16x16x32_bf16 v[28:31], v[140:143], v[184:187], v[28:31]
    ds_read_b64_tr_b16 v[68:69], v225 offset:45056
    v_mfma_f32_16x16x32_bf16 v[32:35], v[128:131], v[188:191], v[32:35]
    ds_read_b64_tr_b16 v[70:71], v229 offset:45056
    ds_read_b64_tr_b16 v[72:73], v226 offset:45056
    v_mfma_f32_16x16x32_bf16 v[36:39], v[132:135], v[188:191], v[36:39]
    ds_read_b64_tr_b16 v[74:75], v230 offset:45056
    v_mfma_f32_16x16x32_bf16 v[40:43], v[136:139], v[188:191], v[40:43]
    ds_read_b64_tr_b16 v[76:77], v227 offset:45056
    v_mfma_f32_16x16x32_bf16 v[44:47], v[140:143], v[188:191], v[44:47]
    ds_read_b64_tr_b16 v[78:79], v231 offset:45056
    s_waitcnt vmcnt(8) lgkmcnt(8)
    v_mfma_f32_16x16x32_bf16 v[16:19], v[48:51], v[144:147], v[16:19]
    buffer_load_dwordx4 v[184:187], v12, s[52:55], s41 offen offset:3072 sc1
    buffer_load_dwordx4 v[188:191], v15, s[52:55], s41 offen offset:3072 sc1
    v_mfma_f32_16x16x32_bf16 v[20:23], v[52:55], v[144:147], v[20:23]
    ds_read_b64_tr_b16 v[80:81], v224 offset:49152
    v_mfma_f32_16x16x32_bf16 v[24:27], v[56:59], v[144:147], v[24:27]
    ds_read_b64_tr_b16 v[82:83], v228 offset:49152
    v_mfma_f32_16x16x32_bf16 v[28:31], v[60:63], v[144:147], v[28:31]
    ds_read_b64_tr_b16 v[84:85], v225 offset:49152
    v_mfma_f32_16x16x32_bf16 v[32:35], v[48:51], v[148:151], v[32:35]
    ds_read_b64_tr_b16 v[86:87], v229 offset:49152
    ds_read_b64_tr_b16 v[88:89], v226 offset:49152
    v_mfma_f32_16x16x32_bf16 v[36:39], v[52:55], v[148:151], v[36:39]
    ds_read_b64_tr_b16 v[90:91], v230 offset:49152
    v_mfma_f32_16x16x32_bf16 v[40:43], v[56:59], v[148:151], v[40:43]
    ds_read_b64_tr_b16 v[92:93], v227 offset:49152
    v_mfma_f32_16x16x32_bf16 v[44:47], v[60:63], v[148:151], v[44:47]
    ds_read_b64_tr_b16 v[94:95], v231 offset:49152
    s_waitcnt vmcnt(8) lgkmcnt(8)
    s_mov_b64 exec, 1
    ds_add_u32 v10, v11 offset:28
    s_mov_b64 exec, -1
    v_mfma_f32_16x16x32_bf16 v[16:19], v[64:67], v[152:155], v[16:19]
    buffer_load_dwordx4 v[144:147], v12, s[52:55], s42 offen offset:0 sc1
    buffer_load_dwordx4 v[148:151], v15, s[52:55], s42 offen offset:0 sc1
    v_mfma_f32_16x16x32_bf16 v[20:23], v[68:71], v[152:155], v[20:23]
    ds_read_b64_tr_b16 v[96:97], v224 offset:53248
    v_mfma_f32_16x16x32_bf16 v[24:27], v[72:75], v[152:155], v[24:27]
    ds_read_b64_tr_b16 v[98:99], v228 offset:53248
    v_mfma_f32_16x16x32_bf16 v[28:31], v[76:79], v[152:155], v[28:31]
    ds_read_b64_tr_b16 v[100:101], v225 offset:53248
    v_mfma_f32_16x16x32_bf16 v[32:35], v[64:67], v[156:159], v[32:35]
    ds_read_b64_tr_b16 v[102:103], v229 offset:53248
    ds_read_b64_tr_b16 v[104:105], v226 offset:53248
    v_mfma_f32_16x16x32_bf16 v[36:39], v[68:71], v[156:159], v[36:39]
    ds_read_b64_tr_b16 v[106:107], v230 offset:53248
    v_mfma_f32_16x16x32_bf16 v[40:43], v[72:75], v[156:159], v[40:43]
    ds_read_b64_tr_b16 v[108:109], v227 offset:53248
    v_mfma_f32_16x16x32_bf16 v[44:47], v[76:79], v[156:159], v[44:47]
    ds_read_b64_tr_b16 v[110:111], v231 offset:53248
    s_waitcnt vmcnt(8) lgkmcnt(9)
    v_mfma_f32_16x16x32_bf16 v[16:19], v[80:83], v[160:163], v[16:19]
    buffer_load_dwordx4 v[152:155], v12, s[52:55], s42 offen offset:1024 sc1
    buffer_load_dwordx4 v[156:159], v15, s[52:55], s42 offen offset:1024 sc1
    v_mfma_f32_16x16x32_bf16 v[20:23], v[84:87], v[160:163], v[20:23]
    ds_read_b64_tr_b16 v[112:113], v224 offset:57344
    v_mfma_f32_16x16x32_bf16 v[24:27], v[88:91], v[160:163], v[24:27]
    ds_read_b64_tr_b16 v[114:115], v228 offset:57344
    v_mfma_f32_16x16x32_bf16 v[28:31], v[92:95], v[160:163], v[28:31]
    ds_read_b64_tr_b16 v[116:117], v225 offset:57344
    v_mfma_f32_16x16x32_bf16 v[32:35], v[80:83], v[164:167], v[32:35]
    ds_read_b64_tr_b16 v[118:119], v229 offset:57344
    ds_read_b64_tr_b16 v[120:121], v226 offset:57344
    v_mfma_f32_16x16x32_bf16 v[36:39], v[84:87], v[164:167], v[36:39]
    ds_read_b64_tr_b16 v[122:123], v230 offset:57344
    v_mfma_f32_16x16x32_bf16 v[40:43], v[88:91], v[164:167], v[40:43]
    ds_read_b64_tr_b16 v[124:125], v227 offset:57344
    v_mfma_f32_16x16x32_bf16 v[44:47], v[92:95], v[164:167], v[44:47]
    ds_read_b64_tr_b16 v[126:127], v231 offset:57344
    s_waitcnt vmcnt(8) lgkmcnt(8)
    v_mfma_f32_16x16x32_bf16 v[16:19], v[96:99], v[168:171], v[16:19]
    buffer_load_dwordx4 v[160:163], v12, s[52:55], s42 offen offset:2048 sc1
    buffer_load_dwordx4 v[164:167], v15, s[52:55], s42 offen offset:2048 sc1
    v_mfma_f32_16x16x32_bf16 v[20:23], v[100:103], v[168:171], v[20:23]
    ds_read_b64_tr_b16 v[128:129], v2 offset:24576
    v_mfma_f32_16x16x32_bf16 v[24:27], v[104:107], v[168:171], v[24:27]
    ds_read_b64_tr_b16 v[130:131], v6 offset:24576
    v_mfma_f32_16x16x32_bf16 v[28:31], v[108:111], v[168:171], v[28:31]
    ds_read_b64_tr_b16 v[132:133], v3 offset:24576
    v_mfma_f32_16x16x32_bf16 v[32:35], v[96:99], v[172:175], v[32:35]
    ds_read_b64_tr_b16 v[134:135], v7 offset:24576
    ds_read_b64_tr_b16 v[136:137], v4 offset:24576
    v_mfma_f32_16x16x32_bf16 v[36:39], v[100:103], v[172:175], v[36:39]
    ds_read_b64_tr_b16 v[138:139], v8 offset:24576
    v_mfma_f32_16x16x32_bf16 v[40:43], v[104:107], v[172:175], v[40:43]
    ds_read_b64_tr_b16 v[140:141], v5 offset:24576
    v_mfma_f32_16x16x32_bf16 v[44:47], v[108:111], v[172:175], v[44:47]
    ds_read_b64_tr_b16 v[142:143], v9 offset:24576
    s_waitcnt vmcnt(8) lgkmcnt(8)
    v_mfma_f32_16x16x32_bf16 v[16:19], v[112:115], v[176:179], v[16:19]
    buffer_load_dwordx4 v[168:171], v12, s[52:55], s42 offen offset:3072 sc1
    buffer_load_dwordx4 v[172:175], v15, s[52:55], s42 offen offset:3072 sc1
    v_mfma_f32_16x16x32_bf16 v[20:23], v[116:119], v[176:179], v[20:23]
    ds_read_b64_tr_b16 v[48:49], v2 offset:28672
    v_mfma_f32_16x16x32_bf16 v[24:27], v[120:123], v[176:179], v[24:27]
    ds_read_b64_tr_b16 v[50:51], v6 offset:28672
    v_mfma_f32_16x16x32_bf16 v[28:31], v[124:127], v[176:179], v[28:31]
    ds_read_b64_tr_b16 v[52:53], v3 offset:28672
    v_mfma_f32_16x16x32_bf16 v[32:35], v[112:115], v[180:183], v[32:35]
    ds_read_b64_tr_b16 v[54:55], v7 offset:28672
    ds_read_b64_tr_b16 v[56:57], v4 offset:28672
    v_mfma_f32_16x16x32_bf16 v[36:39], v[116:119], v[180:183], v[36:39]
    ds_read_b64_tr_b16 v[58:59], v8 offset:28672
    v_mfma_f32_16x16x32_bf16 v[40:43], v[120:123], v[180:183], v[40:43]
    ds_read_b64_tr_b16 v[60:61], v5 offset:28672
    v_mfma_f32_16x16x32_bf16 v[44:47], v[124:127], v[180:183], v[44:47]
    ds_read_b64_tr_b16 v[62:63], v9 offset:28672
    s_waitcnt vmcnt(8) lgkmcnt(8)
    v_mfma_f32_16x16x32_bf16 v[16:19], v[128:131], v[184:187], v[16:19]
    buffer_load_dwordx4 v[176:179], v12, s[52:55], s43 offen offset:0 sc1
    buffer_load_dwordx4 v[180:183], v15, s[52:55], s43 offen offset:0 sc1
    v_mfma_f32_16x16x32_bf16 v[20:23], v[132:135], v[184:187], v[20:23]
    ds_read_b32 v223, v10 offset:32
    v_mfma_f32_16x16x32_bf16 v[24:27], v[136:139], v[184:187], v[24:27]
    ds_read_b64_tr_b16 v[64:65], v2 offset:32768
    ds_read_b64_tr_b16 v[66:67], v6 offset:32768
    v_mfma_f32_16x16x32_bf16 v[28:31], v[140:143], v[184:187], v[28:31]
    ds_read_b64_tr_b16 v[68:69], v3 offset:32768
    v_mfma_f32_16x16x32_bf16 v[32:35], v[128:131], v[188:191], v[32:35]
    ds_read_b64_tr_b16 v[70:71], v7 offset:32768
    v_mfma_f32_16x16x32_bf16 v[36:39], v[132:135], v[188:191], v[36:39]
    ds_read_b64_tr_b16 v[72:73], v4 offset:32768
    ds_read_b64_tr_b16 v[74:75], v8 offset:32768
    v_mfma_f32_16x16x32_bf16 v[40:43], v[136:139], v[188:191], v[40:43]
    ds_read_b64_tr_b16 v[76:77], v5 offset:32768
    v_mfma_f32_16x16x32_bf16 v[44:47], v[140:143], v[188:191], v[44:47]
    ds_read_b64_tr_b16 v[78:79], v9 offset:32768
    s_waitcnt vmcnt(8) lgkmcnt(9)
    s_waitcnt lgkmcnt(8)
    v_cmp_gt_u32 vcc, 4, v223
    s_cbranch_vccnz LB_w8
LB_g8:
    v_mfma_f32_16x16x32_bf16 v[16:19], v[48:51], v[144:147], v[16:19]
    buffer_load_dwordx4 v[184:187], v12, s[52:55], s43 offen offset:1024 sc1
    buffer_load_dwordx4 v[188:191], v15, s[52:55], s43 offen offset:1024 sc1
    v_add_u32 v2, 129024, v2
    v_mfma_f32_16x16x32_bf16 v[20:23], v[52:55], v[144:147], v[20:23]
    ds_read_b64_tr_b16 v[80:81], v2 offset:0
    v_add_u32 v6, 129024, v6
    v_mfma_f32_16x16x32_bf16 v[24:27], v[56:59], v[144:147], v[24:27]
    ds_read_b64_tr_b16 v[82:83], v6 offset:0
    v_add_u32 v3, 129024, v3
    v_mfma_f32_16x16x32_bf16 v[28:31], v[60:63], v[144:147], v[28:31]
    ds_read_b64_tr_b16 v[84:85], v3 offset:0
    v_add_u32 v7, 129024, v7
    v_mfma_f32_16x16x32_bf16 v[32:35], v[48:51], v[148:151], v[32:35]
    ds_read_b64_tr_b16 v[86:87], v7 offset:0
    v_add_u32 v4, 129024, v4
    ds_read_b64_tr_b16 v[88:89], v4 offset:0
    v_mfma_f32_16x16x32_bf16 v[36:39], v[52:55], v[148:151], v[36:39]
    v_add_u32 v8, 129024, v8
    ds_read_b64_tr_b16 v[90:91], v8 offset:0
    v_mfma_f32_16x16x32_bf16 v[40:43], v[56:59], v[148:151], v[40:43]
    v_add_u32 v5, 129024, v5
    ds_read_b64_tr_b16 v[92:93], v5 offset:0
    v_mfma_f32_16x16x32_bf16 v[44:47], v[60:63], v[148:151], v[44:47]
    v_add_u32 v9, 129024, v9
    ds_read_b64_tr_b16 v[94:95], v9 offset:0
    s_waitcnt vmcnt(8) lgkmcnt(8)
    v_mfma_f32_16x16x32_bf16 v[16:19], v[64:67], v[152:155], v[16:19]
    buffer_load_dwordx4 v[144:147], v12, s[52:55], s43 offen offset:2048 sc1
    buffer_load_dwordx4 v[148:151], v15, s[52:55], s43 offen offset:2048 sc1
    v_mfma_f32_16x16x32_bf16 v[20:23], v[68:71], v[152:155], v[20:23]
    ds_read_b64_tr_b16 v[96:97], v2 offset:4096
    v_mfma_f32_16x16x32_bf16 v[24:27], v[72:75], v[152:155], v[24:27]
    ds_read_b64_tr_b16 v[98:99], v6 offset:4096
    v_mfma_f32_16x16x32_bf16 v[28:31], v[76:79], v[152:155], v[28:31]
    ds_read_b64_tr_b16 v[100:101], v3 offset:4096
    v_mfma_f32_16x16x32_bf16 v[32:35], v[64:67], v[156:159], v[32:35]
    ds_read_b64_tr_b16 v[102:103], v7 offset:4096
    ds_read_b64_tr_b16 v[104:105], v4 offset:4096
    v_mfma_f32_16x16x32_bf16 v[36:39], v[68:71], v[156:159], v[36:39]
    ds_read_b64_tr_b16 v[106:107], v8 offset:4096
    v_mfma_f32_16x16x32_bf16 v[40:43], v[72:75], v[156:159], v[40:43]
    ds_read_b64_tr_b16 v[108:109], v5 offset:4096
    v_mfma_f32_16x16x32_bf16 v[44:47], v[76:79], v[156:159], v[44:47]
    ds_read_b64_tr_b16 v[110:111], v9 offset:4096
    s_waitcnt vmcnt(8) lgkmcnt(8)
    v_mfma_f32_16x16x32_bf16 v[16:19], v[80:83], v[160:163], v[16:19]
    buffer_load_dwordx4 v[152:155], v12, s[52:55], s43 offen offset:3072 sc1
    buffer_load_dwordx4 v[156:159], v15, s[52:55], s43 offen offset:3072 sc1
    v_mfma_f32_16x16x32_bf16 v[20:23], v[84:87], v[160:163], v[20:23]
    ds_read_b64_tr_b16 v[112:113], v2 offset:8192
    v_mfma_f32_16x16x32_bf16 v[24:27], v[88:91], v[160:163], v[24:27]
    ds_read_b64_tr_b16 v[114:115], v6 offset:8192
    v_mfma_f32_16x16x32_bf16 v[28:31], v[92:95], v[160:163], v[28:31]
    ds_read_b64_tr_b16 v[116:117], v3 offset:8192
    v_mfma_f32_16x16x32_bf16 v[32:35], v[80:83], v[164:167], v[32:35]
    ds_read_b64_tr_b16 v[118:119], v7 offset:8192
    ds_read_b64_tr_b16 v[120:121], v4 offset:8192
    v_mfma_f32_16x16x32_bf16 v[36:39], v[84:87], v[164:167], v[36:39]
    ds_read_b64_tr_b16 v[122:123], v8 offset:8192
    v_mfma_f32_16x16x32_bf16 v[40:43], v[88:91], v[164:167], v[40:43]
    ds_read_b64_tr_b16 v[124:125], v5 offset:8192
    v_mfma_f32_16x16x32_bf16 v[44:47], v[92:95], v[164:167], v[44:47]
    ds_read_b64_tr_b16 v[126:127], v9 offset:8192
    s_waitcnt vmcnt(8) lgkmcnt(8)
    v_mfma_f32_16x16x32_bf16 v[16:19], v[96:99], v[168:171], v[16:19]
    ds_read_b64_tr_b16 v[128:129], v2 offset:12288
    v_mfma_f32_16x16x32_bf16 v[20:23], v[100:103], v[168:171], v[20:23]
    ds_read_b64_tr_b16 v[130:131], v6 offset:12288
    v_mfma_f32_16x16x32_bf16 v[24:27], v[104:107], v[168:171], v[24:27]
    ds_read_b64_tr_b16 v[132:133], v3 offset:12288
    v_mfma_f32_16x16x32_bf16 v[28:31], v[108:111], v[168:171], v[28:31]
    ds_read_b64_tr_b16 v[134:135], v7 offset:12288
    v_mfma_f32_16x16x32_bf16 v[32:35], v[96:99], v[172:175], v[32:35]
    ds_read_b64_tr_b16 v[136:137], v4 offset:12288
    v_mfma_f32_16x16x32_bf16 v[36:39], v[100:103], v[172:175], v[36:39]
    ds_read_b64_tr_b16 v[138:139], v8 offset:12288
    v_mfma_f32_16x16x32_bf16 v[40:43], v[104:107], v[172:175], v[40:43]
    ds_read_b64_tr_b16 v[140:141], v5 offset:12288
    v_mfma_f32_16x16x32_bf16 v[44:47], v[108:111], v[172:175], v[44:47]
    ds_read_b64_tr_b16 v[142:143], v9 offset:12288
    s_waitcnt vmcnt(6) lgkmcnt(8)
    v_mfma_f32_16x16x32_bf16 v[16:19], v[112:115], v[176:179], v[16:19]
    ds_read_b64_tr_b16 v[48:49], v2 offset:16384
    v_mfma_f32_16x16x32_bf16 v[20:23], v[116:119], v[176:179], v[20:23]
    ds_read_b64_tr_b16 v[50:51], v6 offset:16384
    v_mfma_f32_16x16x32_bf16 v[24:27], v[120:123], v[176:179], v[24:27]
    ds_read_b64_tr_b16 v[52:53], v3 offset:16384
    v_mfma_f32_16x16x32_bf16 v[28:31], v[124:127], v[176:179], v[28:31]
    ds_read_b64_tr_b16 v[54:55], v7 offset:16384
    v_mfma_f32_16x16x32_bf16 v[32:35], v[112:115], v[180:183], v[32:35]
    ds_read_b64_tr_b16 v[56:57], v4 offset:16384
    v_mfma_f32_16x16x32_bf16 v[36:39], v[116:119], v[180:183], v[36:39]
    ds_read_b64_tr_b16 v[58:59], v8 offset:16384
    v_mfma_f32_16x16x32_bf16 v[40:43], v[120:123], v[180:183], v[40:43]
    ds_read_b64_tr_b16 v[60:61], v5 offset:16384
    v_mfma_f32_16x16x32_bf16 v[44:47], v[124:127], v[180:183], v[44:47]
    ds_read_b64_tr_b16 v[62:63], v9 offset:16384
    s_waitcnt vmcnt(4) lgkmcnt(8)
    v_mfma_f32_16x16x32_bf16 v[16:19], v[128:131], v[184:187], v[16:19]
    ds_read_b64_tr_b16 v[64:65], v2 offset:20480
    v_mfma_f32_16x16x32_bf16 v[20:23], v[132:135], v[184:187], v[20:23]
    ds_read_b64_tr_b16 v[66:67], v6 offset:20480
    v_mfma_f32_16x16x32_bf16 v[24:27], v[136:139], v[184:187], v[24:27]
    ds_read_b64_tr_b16 v[68:69], v3 offset:20480
    v_mfma_f32_16x16x32_bf16 v[28:31], v[140:143], v[184:187], v[28:31]
    ds_read_b64_tr_b16 v[70:71], v7 offset:20480
    v_mfma_f32_16x16x32_bf16 v[32:35], v[128:131], v[188:191], v[32:35]
    ds_read_b64_tr_b16 v[72:73], v4 offset:20480
    v_mfma_f32_16x16x32_bf16 v[36:39], v[132:135], v[188:191], v[36:39]
    ds_read_b64_tr_b16 v[74:75], v8 offset:20480
    v_mfma_f32_16x16x32_bf16 v[40:43], v[136:139], v[188:191], v[40:43]
    ds_read_b64_tr_b16 v[76:77], v5 offset:20480
    v_mfma_f32_16x16x32_bf16 v[44:47], v[140:143], v[188:191], v[44:47]
    ds_read_b64_tr_b16 v[78:79], v9 offset:20480
    s_waitcnt vmcnt(2) lgkmcnt(8)
    v_mfma_f32_16x16x32_bf16 v[16:19], v[48:51], v[144:147], v[16:19]
    ds_read_b32 v223, v10 offset:28
    v_mfma_f32_16x16x32_bf16 v[20:23], v[52:55], v[144:147], v[20:23]
    v_mfma_f32_16x16x32_bf16 v[24:27], v[56:59], v[144:147], v[24:27]
    v_mfma_f32_16x16x32_bf16 v[28:31], v[60:63], v[144:147], v[28:31]
    v_mfma_f32_16x16x32_bf16 v[32:35], v[48:51], v[148:151], v[32:35]
    v_mfma_f32_16x16x32_bf16 v[36:39], v[52:55], v[148:151], v[36:39]
    v_mfma_f32_16x16x32_bf16 v[40:43], v[56:59], v[148:151], v[40:43]
    v_mfma_f32_16x16x32_bf16 v[44:47], v[60:63], v[148:151], v[44:47]
    s_waitcnt vmcnt(0) lgkmcnt(1)
    v_mfma_f32_16x16x32_bf16 v[16:19], v[64:67], v[152:155], v[16:19]
    v_mfma_f32_16x16x32_bf16 v[20:23], v[68:71], v[152:155], v[20:23]
    v_mfma_f32_16x16x32_bf16 v[24:27], v[72:75], v[152:155], v[24:27]
    v_mfma_f32_16x16x32_bf16 v[28:31], v[76:79], v[152:155], v[28:31]
    v_mfma_f32_16x16x32_bf16 v[32:35], v[64:67], v[156:159], v[32:35]
    v_mfma_f32_16x16x32_bf16 v[36:39], v[68:71], v[156:159], v[36:39]
    v_mfma_f32_16x16x32_bf16 v[40:43], v[72:75], v[156:159], v[40:43]
    v_mfma_f32_16x16x32_bf16 v[44:47], v[76:79], v[156:159], v[44:47]
    s_waitcnt lgkmcnt(0)
    v_cmp_gt_u32 vcc, 4, v223
    s_cbranch_vccnz LB_w7
LB_g7:
    v_cvt_pk_bf16_f32 v96, v16, v17
    v_cvt_pk_bf16_f32 v97, v18, v19
    v_cvt_pk_bf16_f32 v98, v20, v21
    v_cvt_pk_bf16_f32 v99, v22, v23
    s_nop 0
    v_permlane16_swap_b32 v96, v98
    v_permlane16_swap_b32 v97, v99
    ds_write_b128 v248, v[96:99] offset:0
    v_cvt_pk_bf16_f32 v100, v24, v25
    v_cvt_pk_bf16_f32 v101, v26, v27
    v_cvt_pk_bf16_f32 v102, v28, v29
    v_cvt_pk_bf16_f32 v103, v30, v31
    s_nop 0
    v_permlane16_swap_b32 v100, v102
    v_permlane16_swap_b32 v101, v103
    ds_write_b128 v249, v[100:103] offset:0
    ds_read_b128 v[112:115], v250 offset:0
    ds_read_b128 v[116:119], v250 offset:1024
    v_cvt_pk_bf16_f32 v104, v32, v33
    v_cvt_pk_bf16_f32 v105, v34, v35
    v_cvt_pk_bf16_f32 v106, v36, v37
    v_cvt_pk_bf16_f32 v107, v38, v39
    s_nop 0
    v_permlane16_swap_b32 v104, v106
    v_permlane16_swap_b32 v105, v107
    ds_write_b128 v248, v[104:107] offset:2048
    v_cvt_pk_bf16_f32 v108, v40, v41
    v_cvt_pk_bf16_f32 v109, v42, v43
    v_cvt_pk_bf16_f32 v110, v44, v45
    v_cvt_pk_bf16_f32 v111, v46, v47
    s_nop 0
    v_permlane16_swap_b32 v108, v110
    v_permlane16_swap_b32 v109, v111
    ds_write_b128 v249, v[108:111] offset:2048
    ds_read_b128 v[120:123], v250 offset:2048
    ds_read_b128 v[124:127], v250 offset:3072
    s_mov_b32 s95, 0
    s_waitcnt lgkmcnt(5)
    buffer_store_dwordx4 v[112:115], v246, s[60:63], s95 offen nt
    s_mov_b32 s95, 32768
    s_waitcnt lgkmcnt(4)
    buffer_store_dwordx4 v[116:119], v246, s[60:63], s95 offen nt
    s_mov_b32 s95, 65536
    s_waitcnt lgkmcnt(1)
    buffer_store_dwordx4 v[120:123], v246, s[60:63], s95 offen nt
    s_mov_b32 s95, 98304
    s_waitcnt lgkmcnt(0)
    buffer_store_dwordx4 v[124:127], v246, s[60:63], s95 offen nt
    s_endpgm
LA_slow:
    s_mov_b32 s79, 0
LA_slow1:
    s_mov_b64 exec, vcc
    s_sleep 8
    buffer_load_dword v136, v33, s[68:71], 0 offen sc1
    buffer_load_dword v137, v34, s[52:55], 0 offen sc1
    s_add_u32 s79, s79, 1
    s_cmp_gt_u32 s79, 200000
    s_waitcnt vmcnt(0)
    s_cbranch_scc1 LA_back
    v_cmp_ne_u32 vcc, v136, v137
    v_cmp_gt_u32 s[80:81], s96, v136
    s_nop 0
    s_or_b64 vcc, vcc, s[80:81]
    s_cbranch_vccnz LA_slow1
    s_branch LA_back
LB_slow:
    s_mov_b32 s79, 0
LB_pt:
    buffer_load_dword v222, v220, s[68:71], s98 offen sc1
    s_add_u32 s79, s79, 1
    s_cmp_gt_u32 s79, 200000
    s_cbranch_scc1 LB_pt_x
    s_waitcnt vmcnt(0)
    v_cmp_gt_u32 vcc, 4096, v222
    s_cbranch_vccz LB_pt_x
    s_mov_b64 exec, vcc
    s_sleep 8
    s_branch LB_pt
LB_pt_x:
    s_waitcnt vmcnt(0)
    s_branch LB_back
LB_w15:
    s_branch LB_s6_in
LB_s6:
    s_sleep 1
LB_s6_in:
    ds_read_b32 v223, v10 offset:24
    s_waitcnt lgkmcnt(0)
    v_readfirstlane_b32 s78, v223
    s_nop 0
    s_cmp_ge_u32 s78, 4
    s_cbranch_scc0 LB_s6
    s_branch LB_g15
LB_w8:
    s_branch LB_s8_in
LB_s8:
    s_sleep 1
LB_s8_in:
    ds_read_b32 v223, v10 offset:32
    s_waitcnt lgkmcnt(0)
    v_readfirstlane_b32 s78, v223
    s_nop 0
    s_cmp_ge_u32 s78, 4
    s_cbranch_scc0 LB_s8
    s_branch LB_g8
LB_w7:
    s_branch LB_s7_in
LB_s7:
    s_sleep 1
LB_s7_in:
    ds_read_b32 v223, v10 offset:28
    s_waitcnt lgkmcnt(0)
    v_readfirstlane_b32 s78, v223
    s_nop 0
    s_cmp_ge_u32 s78, 4
    s_cbranch_scc0 LB_s7
    s_branch LB_g7
L_end:
    s_endpgm
.section .rodata,"a"
.p2align 6
.amdhsa_kernel concat_heads__ssm_conv_h3__sliding_local_dilated__prompt_kernel
  .amdhsa_next_free_vgpr 256
  .amdhsa_next_free_sgpr 102
  .amdhsa_accum_offset 256
  .amdhsa_group_segment_fixed_size 0
  .amdhsa_kernarg_size 96
  .amdhsa_user_sgpr_count 2
  .amdhsa_user_sgpr_kernarg_segment_ptr 1
  .amdhsa_system_sgpr_workgroup_id_x 1
.end_amdhsa_kernel
```

```asm
; @launch grid=(256,1,1) block=(512,1,1) lds=163840
.amdgcn_target "amdgcn-amd-amdhsa--gfx950"
.text
.globl concat_heads__ssm_conv_h3__sliding_local_dilated__prompt_kernel
.p2align 8
.type concat_heads__ssm_conv_h3__sliding_local_dilated__prompt_kernel,@function
concat_heads__ssm_conv_h3__sliding_local_dilated__prompt_kernel:
    s_cmp_ge_u32 s2, 256
    s_cbranch_scc1 L_end
    s_load_dwordx4 s[16:19], s[0:1], 48
    s_load_dwordx8 s[4:11], s[0:1], 0
    s_load_dwordx4 s[12:15], s[0:1], 32
    s_load_dwordx8 s[20:27], s[0:1], 64
    v_lshrrev_b32 v1, 6, v0
    v_and_b32 v0, 63, v0
    v_readfirstlane_b32 s3, v1
    s_nop 0
    s_cmp_lg_u32 s3, 4
    s_cbranch_scc1 L_nopf
    s_getpc_b64 s[80:81]
L_pc:
    s_bfe_u32 s78, s2, 0x40003
    v_lshl_add_u32 v1, v0, 4, s78
    v_lshlrev_b32 v1, 7, v1
    v_cmp_gt_u32 vcc, L_end-L_pc, v1
    s_nop 0
    s_and_saveexec_b64 s[82:83], vcc
    global_load_dword v222, v1, s[80:81]
    s_mov_b64 exec, -1
L_nopf:
    s_and_b32 s78, s2, 7
    s_lshr_b32 s79, s2, 3
    s_lshl_b32 s78, s78, 2
    s_lshr_b32 s78, 0x76325410, s78
    s_and_b32 s78, s78, 7
    s_and_b32 s80, s78, 1
    s_lshl_b32 s80, s80, 3
    s_lshr_b32 s81, s78, 1
    s_lshl_b32 s81, s81, 2
    s_and_b32 s72, s79, 7
    s_add_u32 s72, s72, s80
    s_lshr_b32 s73, s79, 3
    s_xor_b32 s73, s73, 3
    s_add_u32 s73, s73, s81
    s_and_b32 s76, s79, 3
    s_add_u32 s76, s76, s81
    s_lshr_b32 s77, s79, 2
    s_add_u32 s77, s77, s80
    s_lshr_b32 s74, s79, 4
    s_xor_b32 s78, s78, 0
    s_lshl_b32 s78, s78, 1
    s_add_u32 s74, s74, s78
    s_and_b32 s75, s79, 15
    s_cmp_ge_u32 s3, 4
    s_cbranch_scc1 L_B
    v_lshrrev_b32 v5, 3, v0
    v_and_b32 v6, 7, v0
    v_lshrrev_b32 v7, 4, v0
    s_lshl_b32 s79, s72, 7
    s_lshl_b32 s80, s3, 5
    s_add_u32 s81, s79, s80
    v_xor_b32 v8, v7, v6
    v_lshlrev_b32 v8, 4, v8
    v_add_u32 v240, s81, v5
    v_lshl_add_u32 v240, v240, 11, v8
    v_xor_b32 v241, 64, v240
    v_add_u32 v241, 15360, v241
    v_add_u32 v242, 30720, v240
    v_add_u32 v243, 30720, v241
    s_and_b32 s78, s3, 1
    s_lshl_b32 s78, s78, 2
    s_lshl_b32 s80, s3, 3
    v_and_b32 v8, 1, v7
    v_lshl_or_b32 v8, v8, 1, s78
    v_xor_b32 v8, v8, v6
    v_lshlrev_b32 v8, 4, v8
    v_add_u32 v244, s80, v5
    v_mul_u32_u24 v244, 6144, v244
    s_lshl_b32 s82, s73, 7
    v_add3_u32 v244, v244, v8, s82
    v_add_u32 v245, 1024, v244
    v_add_u32 v246, 2048, v244
    s_lshl_b32 s78, s3, 1
    s_lshl_b32 s80, s3, 2
    s_add_u32 s79, s79, s80
    s_sub_u32 s79, s79, 16
    v_add_u32 v8, s78, v7
    v_xor_b32 v8, v8, v6
    v_and_b32 v8, 7, v8
    v_lshlrev_b32 v8, 4, v8
    v_add_u32 v3, s79, v5
    v_lshl_add_u32 v3, v3, 11, v8
    s_lshl_b32 s86, s3, 10
    s_lshl_b32 s87, s3, 12
    s_add_u32 s87, s87, 75776
    s_lshl_b32 s88, s3, 9
    s_add_u32 s88, s88, 73728
    s_and_b32 s98, s73, 0
    s_and_b32 s78, s72, 8
    s_add_u32 s98, s98, s78
    s_add_u32 s101, s72, s73
    s_and_b32 s101, s101, 3
    s_mov_b32 s82, 0x65832401
    s_mov_b32 s83, 0xfedba9c7
    s_cmp_eq_u32 s101, 1
    s_cselect_b32 s82, 0x69432510, s82
    s_cselect_b32 s83, 0xfecbad87, s83
    s_cmp_eq_u32 s101, 2
    s_cselect_b32 s82, 0xa5436201, s82
    s_cselect_b32 s83, 0xfdcbe987, s83
    s_cmp_eq_u32 s101, 3
    s_cselect_b32 s82, 0x65472310, s82
    s_cselect_b32 s83, 0xedcfa98b, s83
    s_bfe_u32 s62, s72, 0x10002
    s_mul_i32 s78, s62, 12288
    s_mul_i32 s79, s3, 3072
    s_add_u32 s60, s79, s78
    s_sub_u32 s61, s79, s78
    s_mul_i32 s62, s62, 196608
    s_sub_u32 s63, 196608, s62
    s_mov_b32 s30, 0x400000
    s_mov_b32 s31, 0x20000
    s_mov_b32 s34, 0x600000
    s_mov_b32 s35, 0x20000
    s_waitcnt lgkmcnt(0)
    s_mov_b64 s[28:29], s[16:17]
    s_mov_b64 s[32:33], s[18:19]
    s_mov_b64 s[0:1], s[82:83]
    s_add_u32 s97, s98, s0
    s_lshr_b64 s[0:1], s[0:1], 4
    s_and_b32 s97, s97, 15
    s_lshr_b32 s99, s97, 3
    s_xor_b32 s97, s97, s99
    s_add_u32 m0, s87, 0
    s_lshl_b32 s97, s97, 7
    buffer_load_dwordx4 v240, s[28:31], s97 offen offset:0  lds
    buffer_load_dwordx4 v241, s[28:31], s97 offen offset:1024  lds
    buffer_load_dwordx4 v242, s[28:31], s97 offen offset:2048  lds
    buffer_load_dwordx4 v243, s[28:31], s97 offen offset:3072  lds
    s_add_u32 m0, s88, 0
    s_mov_b64 exec, 0xffffffff
    buffer_load_dwordx4 v3, s[28:31], s97 offen offset:0  lds
    s_mov_b64 exec, -1
    s_mul_i32 s16, s97, 3072
    s_add_u32 m0, s60, 0
    s_add_u32 s99, s16, s62
    buffer_load_dwordx4 v244, s[32:35], s99 offen offset:0  lds
    buffer_load_dwordx4 v245, s[32:35], s99 offen offset:1024  lds
    buffer_load_dwordx4 v246, s[32:35], s99 offen offset:2048  lds
    s_add_u32 m0, s61, 12288
    s_add_u32 s16, s16, s63
    buffer_load_dwordx4 v244, s[32:35], s16 offen offset:0  lds
    buffer_load_dwordx4 v245, s[32:35], s16 offen offset:1024  lds
    buffer_load_dwordx4 v246, s[32:35], s16 offen offset:2048  lds
    s_add_u32 s97, s98, s0
    s_lshr_b64 s[0:1], s[0:1], 4
    s_and_b32 s97, s97, 15
    s_lshr_b32 s99, s97, 3
    s_xor_b32 s97, s97, s99
    s_add_u32 m0, s87, 18432
    s_lshl_b32 s97, s97, 7
    buffer_load_dwordx4 v240, s[28:31], s97 offen offset:0  lds
    s_mov_b32 s36, s6
    s_mov_b32 s37, s7
    s_mov_b32 s38, 0x400000
    s_mov_b32 s39, 0x20000
    s_mov_b32 s40, s8
    s_mov_b32 s41, s9
    s_mov_b32 s42, 0x400000
    s_mov_b32 s43, 0x20000
    s_mov_b32 s44, s10
    s_mov_b32 s45, s11
    s_mov_b32 s46, 0x2000
    s_mov_b32 s47, 0x20000
    s_mov_b32 s52, s26
    s_mov_b32 s53, s27
    s_mov_b32 s54, 0x1000000
    s_mov_b32 s55, 0x20000
    v_lshlrev_b32 v15, 4, v0
    v_and_b32 v7, 7, v0
    s_lshl_b32 s79, s74, 7
    v_lshl_add_u32 v7, v7, 4, s79
    s_lshl_b32 s78, s75, 7
    s_lshl_b32 s80, s3, 3
    s_add_u32 s80, s80, s78
    v_lshrrev_b32 v5, 3, v0
    s_and_b32 s79, s3, 1
    v_xor_b32 v5, s79, v5
    v_add_u32 v5, s80, v5
    v_lshl_add_u32 v10, v5, 11, v7
    s_xor_b32 s80, s3, 1
    s_add_u32 s80, s78, s80
    s_sub_u32 s80, s80, 4
    s_lshl_b32 s80, s80, 11
    v_add_u32 v11, s80, v7
    v_bfe_u32 v5, v0, 3, 2
    v_lshrrev_b32 v6, 5, v0
    s_lshl_b32 s80, s3, 5
    v_lshlrev_b32 v8, 3, v5
    v_lshl_add_u32 v8, v6, 2, v8
    v_add_u32 v8, s80, v8
    v_and_b32 v35, 7, v0
    v_lshlrev_b32 v16, 4, v35
    v_lshl_add_u32 v16, v8, 7, v16
    v_add_u32 v232, 129024, v16
    v_and_b32 v231, 1, v5
    v_lshl_add_u32 v16, v231, 7, v232
    v_xor_b32 v233, v231, v6
    v_xor_b32 v233, 1, v233
    v_lshl_add_u32 v232, v233, 7, v232
    v_xor_b32 v231, 128, v16
    v_xor_b32 v233, 128, v232
    v_lshrrev_b32 v33, 2, v35
    v_lshlrev_b32 v35, 6, v35
    v_lshl_add_u32 v35, v33, 4, v35
    v_add_u32 v35, 162816, v35
    v_add_u32 v8, s78, v8
    v_lshl_add_u32 v9, v8, 11, v7
    v_lshl_add_u32 v13, v8, 12, v7
    v_bfe_u32 v8, v0, 2, 1
    v_lshlrev_b32 v8, 1, v8
    v_add_u32 v8, v8, v6
    v_lshlrev_b32 v8, 16, v8
    v_lshl_add_u32 v8, v5, 6, v8
    v_and_b32 v7, 3, v0
    v_lshl_add_u32 v8, v7, 4, v8
    s_add_u32 s78, s78, s80
    s_lshl_b32 s78, s78, 3
    s_lshl_b32 s79, s74, 18
    s_add_u32 s78, s78, s79
    v_add_u32 v12, s78, v8
    s_mov_b32 s48, s12
    s_mov_b32 s49, s13
    s_mov_b32 s50, 0x400000
    s_mov_b32 s51, 0x20000
    s_mov_b32 s56, s4
    s_mov_b32 s57, s5
    s_mov_b32 s58, 0x400000
    s_mov_b32 s59, 0x20000
    s_mov_b32 s64, s20
    s_mov_b32 s65, s21
    s_mov_b32 s66, 0x200000
    s_mov_b32 s67, 0x20000
    s_lshl_b32 s91, s74, 4
    s_add_u32 s91, s91, s75
    s_lshr_b32 s78, s91, 3
    s_lshl_b32 s78, s78, 5
    s_and_b32 s79, s91, 7
    s_add_u32 s78, s78, s79
    s_lshl_b32 s79, s3, 3
    s_add_u32 s90, s78, s79
    s_lshl_b32 s91, s91, 14
    s_mov_b32 s96, 4096
    s_mul_i32 s94, s3, 8320
    s_add_u32 s94, s94, 129024
    s_lshl_b32 s78, s90, 12
    v_lshl_add_u32 v228, v0, 7, s78
    s_lshr_b32 s78, s2, 3
    s_lshl_b32 s78, s78, 2
    s_add_u32 s78, s78, s3
    s_lshl_b32 s78, s78, 14
    s_and_b32 s79, s77, 8
    s_lshl_b32 s79, s79, 7
    s_add_u32 s78, s78, s79
    v_and_b32 v5, 7, v0
    v_lshlrev_b32 v5, 7, v5
    v_lshrrev_b32 v8, 3, v0
    v_lshl_add_u32 v5, v8, 11, v5
    v_add_u32 v229, s78, v5
    s_and_b32 s78, s73, 7
    s_cmp_eq_u32 s78, 3
    s_cselect_b32 s78, 0x40000000, 0
    v_or_b32 v229, s78, v229
    buffer_load_dwordx4 v241, s[28:31], s97 offen offset:1024  lds
    buffer_load_dwordx4 v242, s[28:31], s97 offen offset:2048  lds
    buffer_load_dwordx4 v243, s[28:31], s97 offen offset:3072  lds
    s_add_u32 m0, s88, 18432
    s_mov_b64 exec, 0xffffffff
    buffer_load_dwordx4 v3, s[28:31], s97 offen offset:0  lds
    s_mov_b64 exec, -1
    s_mul_i32 s16, s97, 3072
    s_add_u32 m0, s60, 24576
    s_add_u32 s99, s16, s62
    buffer_load_dwordx4 v244, s[32:35], s99 offen offset:0  lds
    buffer_load_dwordx4 v245, s[32:35], s99 offen offset:1024  lds
    s_cmp_eq_u32 s101, 1
    s_cbranch_scc1 LA_c1
    s_cmp_eq_u32 s101, 2
    s_cbranch_scc1 LA_c2
    s_cmp_eq_u32 s101, 3
    s_cbranch_scc1 LA_c3
LA_c0:
    s_waitcnt vmcnt(7)
    s_barrier
    buffer_load_dwordx4 v246, s[32:35], s99 offen offset:2048  lds
    s_add_u32 m0, s61, 36864
    s_add_u32 s16, s16, s63
    buffer_load_dwordx4 v244, s[32:35], s16 offen offset:0  lds
    buffer_load_dwordx4 v245, s[32:35], s16 offen offset:1024  lds
    buffer_load_dwordx4 v246, s[32:35], s16 offen offset:2048  lds
    s_add_u32 s97, s98, s0
    s_lshr_b64 s[0:1], s[0:1], 4
    s_and_b32 s97, s97, 15
    s_lshr_b32 s99, s97, 3
    s_xor_b32 s97, s97, s99
    s_add_u32 m0, s87, 36864
    s_lshl_b32 s97, s97, 7
    buffer_load_dwordx4 v240, s[28:31], s97 offen offset:0  lds
    buffer_load_dwordx4 v241, s[28:31], s97 offen offset:1024  lds
    buffer_load_dwordx4 v242, s[28:31], s97 offen offset:2048  lds
    buffer_load_dwordx4 v243, s[28:31], s97 offen offset:3072  lds
    s_add_u32 m0, s88, 36864
    s_mov_b64 exec, 0xffffffff
    buffer_load_dwordx4 v3, s[28:31], s97 offen offset:0  lds
    s_mov_b64 exec, -1
    s_mul_i32 s16, s97, 3072
    s_add_u32 m0, s60, 49152
    s_add_u32 s99, s16, s62
    buffer_load_dwordx4 v244, s[32:35], s99 offen offset:0  lds
    buffer_load_dwordx4 v245, s[32:35], s99 offen offset:1024  lds
    buffer_load_dwordx4 v246, s[32:35], s99 offen offset:2048  lds
    s_add_u32 m0, s61, 61440
    s_add_u32 s16, s16, s63
    buffer_load_dwordx4 v244, s[32:35], s16 offen offset:0  lds
    buffer_load_dwordx4 v245, s[32:35], s16 offen offset:1024  lds
    buffer_load_dwordx4 v246, s[32:35], s16 offen offset:2048  lds
    s_waitcnt vmcnt(11)
    s_barrier
    s_add_u32 m0, s86, 129536
    s_mov_b32 s89, 0
    buffer_load_dwordx4 v10, s[36:39], s89 offen nt lds
    s_mov_b32 s68, s24
    s_mov_b32 s69, s25
    s_mov_b32 s70, 0x100
    s_mov_b32 s71, 0x20000
    s_add_u32 m0, s86, 145920
    s_mov_b32 s89, 0
    buffer_load_dwordx4 v10, s[40:43], s89 offen nt lds
    v_lshrrev_b32 v6, 5, v0
    v_and_b32 v7, 3, v0
    s_lshr_b32 s78, s90, 1
    s_lshl_b32 s78, s78, 2
    s_add_u32 m0, s86, 133632
    s_mov_b32 s89, 65536
    buffer_load_dwordx4 v10, s[36:39], s89 offen nt lds
    s_load_dword s92, s[14:15], s78
    v_bfe_u32 v5, v0, 2, 2
    v_lshlrev_b32 v5, 1, v5
    v_lshl_add_u32 v5, v6, 3, v5
    s_add_u32 m0, s86, 150016
    s_mov_b32 s89, 65536
    buffer_load_dwordx4 v10, s[40:43], s89 offen nt lds
    v_bfe_u32 v8, v0, 4, 1
    v_add_u32 v5, v5, v8
    s_and_b32 s78, s3, 1
    s_add_u32 m0, s86, 137728
    s_mov_b32 s89, 131072
    buffer_load_dwordx4 v10, s[36:39], s89 offen nt lds
    s_lshl_b32 s78, s78, 1
    v_add_u32 v8, s78, v6
    v_xor_b32 v8, v8, v7
    v_lshlrev_b32 v8, 4, v8
    s_add_u32 m0, s86, 154112
    s_mov_b32 s89, 131072
    buffer_load_dwordx4 v10, s[40:43], s89 offen nt lds
    v_lshl_add_u32 v5, v5, 6, v8
    v_add_u32 v14, s86, v5
    v_mov_b32 v18, 162304
    v_mov_b32 v19, 1
    s_add_u32 m0, s86, 141824
    s_mov_b32 s89, 196608
    buffer_load_dwordx4 v10, s[36:39], s89 offen nt lds
    v_and_b32 v5, 3, v0
    s_lshl_b32 s78, s74, 4
    s_add_u32 s78, s78, s3
    v_lshl_add_u32 v6, v5, 2, s78
    s_add_u32 m0, s86, 158208
    s_mov_b32 s89, 196608
    buffer_load_dwordx4 v10, s[40:43], s89 offen nt lds
    s_lshr_b32 s78, s76, 3
    s_lshl_b32 s79, s3, 1
    s_add_u32 s78, s78, s79
    s_mov_b64 exec, 0xff
    s_lshl_b32 s82, s3, 7
    s_add_u32 m0, s82, 129024
    s_mov_b32 s89, 0
    buffer_load_dwordx4 v11, s[36:39], s89 offen nt lds
    s_lshl_b32 s83, s74, 9
    s_add_u32 s83, s83, s82
    s_and_b32 s89, s3, 2
    s_lshl_b32 s89, s89, 3
    s_add_u32 s82, s82, s89
    s_add_u32 m0, s82, 162816
    s_add_u32 s89, s83, 0
    buffer_load_dwordx4 v15, s[44:47], s89 offen  lds
    s_mov_b64 exec, -1
    s_xor_b32 s78, s78, 0
    s_lshl_b32 s78, s78, 5
    s_and_b32 s79, s76, 7
    s_add_u32 s78, s78, s79
    s_add_u32 s97, s98, s0
    s_lshr_b64 s[0:1], s[0:1], 4
    s_and_b32 s97, s97, 15
    s_lshr_b32 s99, s97, 3
    s_xor_b32 s97, s97, s99
    s_add_u32 m0, s87, 0
    s_lshl_b32 s97, s97, 7
    buffer_load_dwordx4 v240, s[28:31], s97 offen offset:0  lds
    v_lshl_add_u32 v7, v5, 3, s78
    v_and_b32 v8, 4, v0
    v_cmp_eq_u32 vcc, 0, v8
    s_nop 1
    v_cndmask_b32 v6, v7, v6, vcc
    buffer_load_dwordx4 v241, s[28:31], s97 offen offset:1024  lds
    v_and_b32 v33, 0xf0, v6
    v_lshlrev_b32 v34, 8, v6
    v_add_u32 v34, 12582912, v34
    v_and_b32 v5, 15, v0
    buffer_load_dwordx4 v242, s[28:31], s97 offen offset:2048  lds
    v_lshrrev_b32 v6, 4, v0
    v_add_u32 v7, 9, v5
    v_and_b32 v8, 1, v7
    buffer_load_dwordx4 v243, s[28:31], s97 offen offset:3072  lds
    v_mul_u32_u24 v8, 4160, v8
    v_lshrrev_b32 v7, 1, v7
    v_lshl_add_u32 v8, v7, 2, v8
    v_lshlrev_b32 v7, 4, v6
    s_add_u32 m0, s88, 0
    s_mov_b64 exec, 0xffffffff
    buffer_load_dwordx4 v3, s[28:31], s97 offen offset:0  lds
    s_mov_b64 exec, -1
    v_sub_u32 v8, v8, v7
    s_add_u32 s78, s94, 32
    v_add_u32 v21, s78, v8
    v_add_u32 v22, 1024, v21
    s_mul_i32 s16, s97, 3072
    s_add_u32 m0, s60, 0
    s_add_u32 s99, s16, s62
    buffer_load_dwordx4 v244, s[32:35], s99 offen offset:0  lds
    v_add_u32 v23, 2048, v21
    v_add_u32 v24, 3072, v21
    v_lshl_add_u32 v7, v5, 1, v6
    v_add_u32 v7, 30, v7
    buffer_load_dwordx4 v245, s[32:35], s99 offen offset:1024  lds
    v_and_b32 v8, 1, v7
    v_bfe_u32 v136, v7, 1, 2
    v_lshl_add_u32 v136, v8, 2, v136
    s_waitcnt vmcnt(17)
    s_barrier
    buffer_load_dwordx4 v246, s[32:35], s99 offen offset:2048  lds
    v_lshlrev_b32 v136, 6, v136
    v_lshrrev_b32 v7, 3, v7
    v_lshl_add_u32 v136, v7, 9, v136
    v_bitop3_b32 v8, v7, 3, s3 bitop3:0x6a
    s_add_u32 m0, s61, 12288
    s_add_u32 s16, s16, s63
    buffer_load_dwordx4 v244, s[32:35], s16 offen offset:0  lds
    v_lshl_add_u32 v25, v8, 4, v136
    v_add_u32 v25, 92160, v25
    v_subrev_u32 v7, 1, v7
    v_bitop3_b32 v8, v7, 3, s3 bitop3:0x6a
    buffer_load_dwordx4 v245, s[32:35], s16 offen offset:1024  lds
    v_lshl_add_u32 v27, v8, 4, v136
    v_add_u32 v27, 91648, v27
    v_subrev_u32 v7, 1, v7
    v_bitop3_b32 v8, v7, 3, s3 bitop3:0x6a
    buffer_load_dwordx4 v246, s[32:35], s16 offen offset:2048  lds
    v_lshl_add_u32 v29, v8, 4, v136
    v_add_u32 v29, 91136, v29
    v_subrev_u32 v7, 1, v7
    v_bitop3_b32 v8, v7, 3, s3 bitop3:0x6a
    s_add_u32 s97, s98, s0
    s_lshr_b64 s[0:1], s[0:1], 4
    s_and_b32 s97, s97, 15
    s_lshr_b32 s99, s97, 3
    s_xor_b32 s97, s97, s99
    s_add_u32 m0, s87, 18432
    s_lshl_b32 s97, s97, 7
    buffer_load_dwordx4 v240, s[28:31], s97 offen offset:0  lds
    v_lshl_add_u32 v31, v8, 4, v136
    v_add_u32 v31, 90624, v31
    v_lshl_add_u32 v7, v5, 1, v6
    v_add_u32 v7, 26, v7
    buffer_load_dwordx4 v241, s[28:31], s97 offen offset:1024  lds
    v_and_b32 v8, 1, v7
    v_bfe_u32 v136, v7, 1, 2
    v_lshl_add_u32 v136, v8, 2, v136
    v_lshlrev_b32 v136, 6, v136
    buffer_load_dwordx4 v242, s[28:31], s97 offen offset:2048  lds
    v_lshrrev_b32 v7, 3, v7
    v_lshl_add_u32 v136, v7, 9, v136
    v_bitop3_b32 v8, v7, 3, s3 bitop3:0x6a
    v_lshl_add_u32 v26, v8, 4, v136
    buffer_load_dwordx4 v243, s[28:31], s97 offen offset:3072  lds
    v_add_u32 v26, 92160, v26
    v_subrev_u32 v7, 1, v7
    v_bitop3_b32 v8, v7, 3, s3 bitop3:0x6a
    v_lshl_add_u32 v28, v8, 4, v136
    s_add_u32 m0, s88, 18432
    s_mov_b64 exec, 0xffffffff
    buffer_load_dwordx4 v3, s[28:31], s97 offen offset:0  lds
    s_mov_b64 exec, -1
    v_add_u32 v28, 91648, v28
    v_subrev_u32 v7, 1, v7
    v_bitop3_b32 v8, v7, 3, s3 bitop3:0x6a
    v_lshl_add_u32 v30, v8, 4, v136
    s_mul_i32 s16, s97, 3072
    s_add_u32 m0, s60, 24576
    s_add_u32 s99, s16, s62
    buffer_load_dwordx4 v244, s[32:35], s99 offen offset:0  lds
    v_add_u32 v30, 91136, v30
    v_subrev_u32 v7, 1, v7
    v_bitop3_b32 v8, v7, 3, s3 bitop3:0x6a
    v_lshl_add_u32 v32, v8, 4, v136
    buffer_load_dwordx4 v245, s[32:35], s99 offen offset:1024  lds
    v_add_u32 v32, 90624, v32
    v_lshrrev_b32 v7, 1, v6
    v_lshl_add_u32 v7, v5, 1, v7
    v_add_u32 v7, 32, v7
    buffer_load_dwordx4 v246, s[32:35], s99 offen offset:2048  lds
    v_and_b32 v8, 1, v7
    v_bfe_u32 v136, v7, 1, 2
    v_lshl_add_u32 v136, v8, 2, v136
    v_lshlrev_b32 v136, 6, v136
    s_add_u32 m0, s61, 36864
    s_add_u32 s16, s16, s63
    buffer_load_dwordx4 v244, s[32:35], s16 offen offset:0  lds
    v_lshrrev_b32 v7, 3, v7
    v_lshl_add_u32 v136, v7, 9, v136
    v_bitop3_b32 v8, v7, 3, s3 bitop3:0x6a
    v_lshl_add_u32 v20, v8, 4, v136
    buffer_load_dwordx4 v245, s[32:35], s16 offen offset:1024  lds
    v_add_u32 v20, 92160, v20
    v_and_b32 v8, 1, v6
    v_xor_b32 v8, 1, v8
    v_lshl_add_u32 v20, v8, 3, v20
    buffer_load_dwordx4 v246, s[32:35], s16 offen offset:2048  lds
    s_waitcnt lgkmcnt(0)
    s_and_b32 s78, s92, 0xffff0000
    s_lshl_b32 s92, s92, 16
    s_bitcmp1_b32 s90, 0
    s_cselect_b32 s92, s78, s92
    s_waitcnt vmcnt(11)
    s_barrier
    s_add_u32 s97, s98, s0
    s_lshr_b64 s[0:1], s[0:1], 4
    s_and_b32 s97, s97, 15
    s_lshr_b32 s99, s97, 3
    s_xor_b32 s97, s97, s99
    s_add_u32 m0, s87, 36864
    s_lshl_b32 s97, s97, 7
    buffer_load_dwordx4 v240, s[28:31], s97 offen offset:0  lds
    ds_read_b128 v[84:87], v35 offset:0
    ds_read_b128 v[88:91], v35 offset:16
    buffer_load_dwordx4 v241, s[28:31], s97 offen offset:1024  lds
    ds_read_b128 v[92:95], v35 offset:32
    buffer_load_dwordx4 v242, s[28:31], s97 offen offset:2048  lds
    ds_read_b128 v[96:99], v35 offset:48
    ds_read_b128 v[40:43], v233 offset:0
    buffer_load_dwordx4 v243, s[28:31], s97 offen offset:3072  lds
    ds_read_b128 v[44:47], v232 offset:256
    s_add_u32 m0, s88, 36864
    s_mov_b64 exec, 0xffffffff
    buffer_load_dwordx4 v3, s[28:31], s97 offen offset:0  lds
    s_mov_b64 exec, -1
    ds_read_b128 v[48:51], v233 offset:256
    s_mul_i32 s16, s97, 3072
    s_add_u32 m0, s60, 49152
    s_add_u32 s99, s16, s62
    buffer_load_dwordx4 v244, s[32:35], s99 offen offset:0  lds
    ds_read_b128 v[52:55], v16 offset:512
    ds_read_b128 v[56:59], v231 offset:512
    buffer_load_dwordx4 v245, s[32:35], s99 offen offset:1024  lds
    ds_read_b128 v[60:63], v16 offset:768
    buffer_load_dwordx4 v246, s[32:35], s99 offen offset:2048  lds
    ds_read_b128 v[64:67], v231 offset:768
    s_add_u32 m0, s61, 61440
    s_add_u32 s16, s16, s63
    buffer_load_dwordx4 v244, s[32:35], s16 offen offset:0  lds
    ds_read_b128 v[68:71], v16 offset:16896
    ds_read_b128 v[72:75], v231 offset:16896
    buffer_load_dwordx4 v245, s[32:35], s16 offen offset:1024  lds
    ds_read_b128 v[76:79], v16 offset:17152
    buffer_load_dwordx4 v246, s[32:35], s16 offen offset:2048  lds
    ds_read_b128 v[80:83], v231 offset:17152
    s_waitcnt vmcnt(11)
    s_waitcnt lgkmcnt(0)
    s_barrier
    s_add_u32 s97, s98, s0
    s_lshr_b64 s[0:1], s[0:1], 4
    s_and_b32 s97, s97, 15
    s_lshr_b32 s99, s97, 3
    s_xor_b32 s97, s97, s99
    s_add_u32 m0, s87, 0
    s_lshl_b32 s97, s97, 7
    buffer_load_dwordx4 v240, s[28:31], s97 offen offset:0  lds
    v_lshlrev_b32 v116, 16, v40
    v_lshlrev_b32 v117, 16, v44
    v_lshlrev_b32 v118, 16, v48
    v_lshlrev_b32 v119, 16, v52
    v_lshlrev_b32 v120, 16, v56
    buffer_load_dwordx4 v241, s[28:31], s97 offen offset:1024  lds
    v_lshlrev_b32 v121, 16, v60
    v_lshlrev_b32 v122, 16, v64
    v_lshlrev_b32 v127, 16, v84
    v_and_b32 v128, 0xffff0000, v84
    v_lshlrev_b32 v129, 16, v85
    buffer_load_dwordx4 v242, s[28:31], s97 offen offset:2048  lds
    v_and_b32 v130, 0xffff0000, v85
    v_lshlrev_b32 v123, 16, v68
    v_lshlrev_b32 v124, 16, v72
    v_lshlrev_b32 v125, 16, v76
    v_lshlrev_b32 v126, 16, v80
    buffer_load_dwordx4 v243, s[28:31], s97 offen offset:3072  lds
    v_mul_f32 v131, v116, v130
    v_mul_f32 v132, v117, v130
    v_mul_f32 v133, v118, v130
    v_mul_f32 v134, v119, v130
    v_fmac_f32 v131, v117, v129
    s_add_u32 m0, s88, 0
    s_mov_b64 exec, 0xffffffff
    buffer_load_dwordx4 v3, s[28:31], s97 offen offset:0  lds
    s_mov_b64 exec, -1
    v_fmac_f32 v132, v118, v129
    v_fmac_f32 v133, v119, v129
    v_fmac_f32 v134, v120, v129
    v_fmac_f32 v131, v118, v128
    v_fmac_f32 v132, v119, v128
    s_mul_i32 s16, s97, 3072
    s_add_u32 m0, s60, 0
    s_add_u32 s99, s16, s62
    buffer_load_dwordx4 v244, s[32:35], s99 offen offset:0  lds
    v_fmac_f32 v133, v120, v128
    v_fmac_f32 v134, v121, v128
    v_fmac_f32 v131, v119, v127
    v_fmac_f32 v132, v120, v127
    v_fmac_f32 v133, v121, v127
    buffer_load_dwordx4 v245, s[32:35], s99 offen offset:1024  lds
    v_fmac_f32 v134, v122, v127
    v_mul_f32 v131, v131, v123
    v_mul_f32 v132, v132, v124
    v_mul_f32 v133, v133, v125
    v_mul_f32 v134, v134, v126
    buffer_load_dwordx4 v246, s[32:35], s99 offen offset:2048  lds
    v_cvt_pk_bf16_f32 v102, v134, v133
    v_cvt_pk_bf16_f32 v103, v132, v131
    v_lshlrev_b32 v116, 16, v42
    v_lshlrev_b32 v117, 16, v46
    v_lshlrev_b32 v118, 16, v50
    s_add_u32 m0, s61, 12288
    s_add_u32 s16, s16, s63
    buffer_load_dwordx4 v244, s[32:35], s16 offen offset:0  lds
    v_lshlrev_b32 v119, 16, v54
    v_lshlrev_b32 v120, 16, v58
    v_lshlrev_b32 v121, 16, v62
    v_lshlrev_b32 v122, 16, v66
    v_lshlrev_b32 v127, 16, v92
    buffer_load_dwordx4 v245, s[32:35], s16 offen offset:1024  lds
    v_and_b32 v128, 0xffff0000, v92
    v_lshlrev_b32 v129, 16, v93
    v_and_b32 v130, 0xffff0000, v93
    v_lshlrev_b32 v123, 16, v70
    v_lshlrev_b32 v124, 16, v74
    buffer_load_dwordx4 v246, s[32:35], s16 offen offset:2048  lds
    v_lshlrev_b32 v125, 16, v78
    v_lshlrev_b32 v126, 16, v82
    v_mul_f32 v131, v116, v130
    v_mul_f32 v132, v117, v130
    v_mul_f32 v133, v118, v130
    v_mul_f32 v134, v119, v130
    v_fmac_f32 v131, v117, v129
    v_fmac_f32 v132, v118, v129
    v_fmac_f32 v133, v119, v129
    v_fmac_f32 v134, v120, v129
    v_fmac_f32 v131, v118, v128
    v_fmac_f32 v132, v119, v128
    s_waitcnt vmcnt(11)
    s_barrier
    s_add_u32 s97, s98, s0
    s_lshr_b64 s[0:1], s[0:1], 4
    s_and_b32 s97, s97, 15
    s_lshr_b32 s99, s97, 3
    s_xor_b32 s97, s97, s99
    s_add_u32 m0, s87, 18432
    s_lshl_b32 s97, s97, 7
    buffer_load_dwordx4 v240, s[28:31], s97 offen offset:0  lds
    v_fmac_f32 v133, v120, v128
    v_fmac_f32 v134, v121, v128
    v_fmac_f32 v131, v119, v127
    v_fmac_f32 v132, v120, v127
    v_fmac_f32 v133, v121, v127
    buffer_load_dwordx4 v241, s[28:31], s97 offen offset:1024  lds
    v_fmac_f32 v134, v122, v127
    v_mul_f32 v131, v131, v123
    v_mul_f32 v132, v132, v124
    v_mul_f32 v133, v133, v125
    v_mul_f32 v134, v134, v126
    buffer_load_dwordx4 v242, s[28:31], s97 offen offset:2048  lds
    v_cvt_pk_bf16_f32 v100, v134, v133
    v_cvt_pk_bf16_f32 v101, v132, v131
    s_nop 0
    v_permlane32_swap_b32 v102, v100
    v_permlane32_swap_b32 v103, v101
    s_mov_b32 s89, 0
    buffer_store_dwordx4 v[100:103], v12, s[52:55], s89 offen sc1
    buffer_load_dwordx4 v243, s[28:31], s97 offen offset:3072  lds
    v_and_b32 v116, 0xffff0000, v40
    v_and_b32 v117, 0xffff0000, v44
    v_and_b32 v118, 0xffff0000, v48
    v_and_b32 v119, 0xffff0000, v52
    v_and_b32 v120, 0xffff0000, v56
    s_add_u32 m0, s88, 18432
    s_mov_b64 exec, 0xffffffff
    buffer_load_dwordx4 v3, s[28:31], s97 offen offset:0  lds
    s_mov_b64 exec, -1
    v_and_b32 v121, 0xffff0000, v60
    v_and_b32 v122, 0xffff0000, v64
    v_lshlrev_b32 v127, 16, v86
    v_and_b32 v128, 0xffff0000, v86
    v_lshlrev_b32 v129, 16, v87
    s_mul_i32 s16, s97, 3072
    s_add_u32 m0, s60, 24576
    s_add_u32 s99, s16, s62
    buffer_load_dwordx4 v244, s[32:35], s99 offen offset:0  lds
    v_and_b32 v130, 0xffff0000, v87
    v_and_b32 v123, 0xffff0000, v68
    v_and_b32 v124, 0xffff0000, v72
    v_and_b32 v125, 0xffff0000, v76
    v_and_b32 v126, 0xffff0000, v80
    buffer_load_dwordx4 v245, s[32:35], s99 offen offset:1024  lds
    v_mul_f32 v131, v116, v130
    v_mul_f32 v132, v117, v130
    v_mul_f32 v133, v118, v130
    v_mul_f32 v134, v119, v130
    v_fmac_f32 v131, v117, v129
    buffer_load_dwordx4 v246, s[32:35], s99 offen offset:2048  lds
    v_fmac_f32 v132, v118, v129
    v_fmac_f32 v133, v119, v129
    v_fmac_f32 v134, v120, v129
    v_fmac_f32 v131, v118, v128
    v_fmac_f32 v132, v119, v128
    s_add_u32 m0, s61, 36864
    s_add_u32 s16, s16, s63
    buffer_load_dwordx4 v244, s[32:35], s16 offen offset:0  lds
    v_fmac_f32 v133, v120, v128
    v_fmac_f32 v134, v121, v128
    v_fmac_f32 v131, v119, v127
    v_fmac_f32 v132, v120, v127
    v_fmac_f32 v133, v121, v127
    buffer_load_dwordx4 v245, s[32:35], s16 offen offset:1024  lds
    v_fmac_f32 v134, v122, v127
    v_mul_f32 v131, v131, v123
    v_mul_f32 v132, v132, v124
    v_mul_f32 v133, v133, v125
    v_mul_f32 v134, v134, v126
    buffer_load_dwordx4 v246, s[32:35], s16 offen offset:2048  lds
    v_cvt_pk_bf16_f32 v106, v134, v133
    v_cvt_pk_bf16_f32 v107, v132, v131
    v_and_b32 v116, 0xffff0000, v42
    v_and_b32 v117, 0xffff0000, v46
    v_and_b32 v118, 0xffff0000, v50
    v_and_b32 v119, 0xffff0000, v54
    v_and_b32 v120, 0xffff0000, v58
    v_and_b32 v121, 0xffff0000, v62
    v_and_b32 v122, 0xffff0000, v66
    v_lshlrev_b32 v127, 16, v94
    v_and_b32 v128, 0xffff0000, v94
    v_lshlrev_b32 v129, 16, v95
    s_waitcnt vmcnt(12)
    s_barrier
    buffer_load_dword v230, v229, s[64:67], 0 offen
    v_and_b32 v130, 0xffff0000, v95
    v_and_b32 v123, 0xffff0000, v70
    v_and_b32 v124, 0xffff0000, v74
    v_and_b32 v125, 0xffff0000, v78
    v_and_b32 v126, 0xffff0000, v82
    s_add_u32 s97, s98, s0
    s_lshr_b64 s[0:1], s[0:1], 4
    s_and_b32 s97, s97, 15
    s_lshr_b32 s99, s97, 3
    s_xor_b32 s97, s97, s99
    s_add_u32 m0, s87, 36864
    s_lshl_b32 s97, s97, 7
    buffer_load_dwordx4 v240, s[28:31], s97 offen offset:0  lds
    v_mul_f32 v131, v116, v130
    v_mul_f32 v132, v117, v130
    v_mul_f32 v133, v118, v130
    v_mul_f32 v134, v119, v130
    v_fmac_f32 v131, v117, v129
    buffer_load_dwordx4 v241, s[28:31], s97 offen offset:1024  lds
    v_fmac_f32 v132, v118, v129
    v_fmac_f32 v133, v119, v129
    v_fmac_f32 v134, v120, v129
    v_fmac_f32 v131, v118, v128
    v_fmac_f32 v132, v119, v128
    buffer_load_dwordx4 v242, s[28:31], s97 offen offset:2048  lds
    v_fmac_f32 v133, v120, v128
    v_fmac_f32 v134, v121, v128
    v_fmac_f32 v131, v119, v127
    v_fmac_f32 v132, v120, v127
    v_fmac_f32 v133, v121, v127
    buffer_load_dwordx4 v243, s[28:31], s97 offen offset:3072  lds
    v_fmac_f32 v134, v122, v127
    v_mul_f32 v131, v131, v123
    v_mul_f32 v132, v132, v124
    v_mul_f32 v133, v133, v125
    v_mul_f32 v134, v134, v126
    s_add_u32 m0, s88, 36864
    s_mov_b64 exec, 0xffffffff
    buffer_load_dwordx4 v3, s[28:31], s97 offen offset:0  lds
    s_mov_b64 exec, -1
    v_cvt_pk_bf16_f32 v104, v134, v133
    v_cvt_pk_bf16_f32 v105, v132, v131
    s_nop 0
    v_permlane32_swap_b32 v106, v104
    v_permlane32_swap_b32 v107, v105
    s_mov_b32 s89, 16384
    buffer_store_dwordx4 v[104:107], v12, s[52:55], s89 offen sc1
    s_mul_i32 s16, s97, 3072
    s_add_u32 m0, s60, 49152
    s_add_u32 s99, s16, s62
    buffer_load_dwordx4 v244, s[32:35], s99 offen offset:0  lds
    v_lshlrev_b32 v116, 16, v41
    v_lshlrev_b32 v117, 16, v45
    v_lshlrev_b32 v118, 16, v49
    v_lshlrev_b32 v119, 16, v53
    v_lshlrev_b32 v120, 16, v57
    buffer_load_dwordx4 v245, s[32:35], s99 offen offset:1024  lds
    v_lshlrev_b32 v121, 16, v61
    v_lshlrev_b32 v122, 16, v65
    v_lshlrev_b32 v127, 16, v88
    v_and_b32 v128, 0xffff0000, v88
    v_lshlrev_b32 v129, 16, v89
    buffer_load_dwordx4 v246, s[32:35], s99 offen offset:2048  lds
    v_and_b32 v130, 0xffff0000, v89
    v_lshlrev_b32 v123, 16, v69
    v_lshlrev_b32 v124, 16, v73
    v_lshlrev_b32 v125, 16, v77
    v_lshlrev_b32 v126, 16, v81
    s_add_u32 m0, s61, 61440
    s_add_u32 s16, s16, s63
    buffer_load_dwordx4 v244, s[32:35], s16 offen offset:0  lds
    v_mul_f32 v131, v116, v130
    v_mul_f32 v132, v117, v130
    v_mul_f32 v133, v118, v130
    v_mul_f32 v134, v119, v130
    v_fmac_f32 v131, v117, v129
    buffer_load_dwordx4 v245, s[32:35], s16 offen offset:1024  lds
    v_fmac_f32 v132, v118, v129
    v_fmac_f32 v133, v119, v129
    v_fmac_f32 v134, v120, v129
    v_fmac_f32 v131, v118, v128
    v_fmac_f32 v132, v119, v128
    buffer_load_dwordx4 v246, s[32:35], s16 offen offset:2048  lds
    v_fmac_f32 v133, v120, v128
    v_fmac_f32 v134, v121, v128
    v_fmac_f32 v131, v119, v127
    v_fmac_f32 v132, v120, v127
    v_fmac_f32 v133, v121, v127
    v_fmac_f32 v134, v122, v127
    v_mul_f32 v131, v131, v123
    s_waitcnt vmcnt(13)
    s_barrier
    s_add_u32 s97, s98, s0
    s_lshr_b64 s[0:1], s[0:1], 4
    s_and_b32 s97, s97, 15
    s_lshr_b32 s99, s97, 3
    s_xor_b32 s97, s97, s99
    s_add_u32 m0, s87, 0
    s_lshl_b32 s97, s97, 7
    buffer_load_dwordx4 v240, s[28:31], s97 offen offset:0  lds
    v_mul_f32 v132, v132, v124
    v_mul_f32 v133, v133, v125
    v_mul_f32 v134, v134, v126
    v_cvt_pk_bf16_f32 v110, v134, v133
    v_cvt_pk_bf16_f32 v111, v132, v131
    buffer_load_dwordx4 v241, s[28:31], s97 offen offset:1024  lds
    v_lshlrev_b32 v116, 16, v43
    v_lshlrev_b32 v117, 16, v47
    v_lshlrev_b32 v118, 16, v51
    v_lshlrev_b32 v119, 16, v55
    v_lshlrev_b32 v120, 16, v59
    buffer_load_dwordx4 v242, s[28:31], s97 offen offset:2048  lds
    v_lshlrev_b32 v121, 16, v63
    v_lshlrev_b32 v122, 16, v67
    v_lshlrev_b32 v127, 16, v96
    v_and_b32 v128, 0xffff0000, v96
    v_lshlrev_b32 v129, 16, v97
    buffer_load_dwordx4 v243, s[28:31], s97 offen offset:3072  lds
    v_and_b32 v130, 0xffff0000, v97
    v_lshlrev_b32 v123, 16, v71
    v_lshlrev_b32 v124, 16, v75
    v_lshlrev_b32 v125, 16, v79
    v_lshlrev_b32 v126, 16, v83
    s_add_u32 m0, s88, 0
    s_mov_b64 exec, 0xffffffff
    buffer_load_dwordx4 v3, s[28:31], s97 offen offset:0  lds
    s_mov_b64 exec, -1
    v_mul_f32 v131, v116, v130
    v_mul_f32 v132, v117, v130
    v_mul_f32 v133, v118, v130
    v_mul_f32 v134, v119, v130
    v_fmac_f32 v131, v117, v129
    s_mul_i32 s16, s97, 3072
    s_add_u32 m0, s60, 0
    s_add_u32 s99, s16, s62
    buffer_load_dwordx4 v244, s[32:35], s99 offen offset:0  lds
    v_fmac_f32 v132, v118, v129
    v_fmac_f32 v133, v119, v129
    v_fmac_f32 v134, v120, v129
    v_fmac_f32 v131, v118, v128
    v_fmac_f32 v132, v119, v128
    buffer_load_dwordx4 v245, s[32:35], s99 offen offset:1024  lds
    v_fmac_f32 v133, v120, v128
    v_fmac_f32 v134, v121, v128
    v_fmac_f32 v131, v119, v127
    v_fmac_f32 v132, v120, v127
    v_fmac_f32 v133, v121, v127
    buffer_load_dwordx4 v246, s[32:35], s99 offen offset:2048  lds
    v_fmac_f32 v134, v122, v127
    v_mul_f32 v131, v131, v123
    v_mul_f32 v132, v132, v124
    v_mul_f32 v133, v133, v125
    v_mul_f32 v134, v134, v126
    s_add_u32 m0, s61, 12288
    s_add_u32 s16, s16, s63
    buffer_load_dwordx4 v244, s[32:35], s16 offen offset:0  lds
    v_cvt_pk_bf16_f32 v108, v134, v133
    v_cvt_pk_bf16_f32 v109, v132, v131
    s_nop 0
    v_permlane32_swap_b32 v110, v108
    v_permlane32_swap_b32 v111, v109
    s_mov_b32 s89, 32768
    buffer_store_dwordx4 v[108:111], v12, s[52:55], s89 offen sc1
    buffer_load_dwordx4 v245, s[32:35], s16 offen offset:1024  lds
    v_and_b32 v116, 0xffff0000, v41
    v_and_b32 v117, 0xffff0000, v45
    v_and_b32 v118, 0xffff0000, v49
    v_and_b32 v119, 0xffff0000, v53
    v_and_b32 v120, 0xffff0000, v57
    buffer_load_dwordx4 v246, s[32:35], s16 offen offset:2048  lds
    v_and_b32 v121, 0xffff0000, v61
    v_and_b32 v122, 0xffff0000, v65
    v_lshlrev_b32 v127, 16, v90
    v_and_b32 v128, 0xffff0000, v90
    v_lshlrev_b32 v129, 16, v91
    v_and_b32 v130, 0xffff0000, v91
    v_and_b32 v123, 0xffff0000, v69
    v_and_b32 v124, 0xffff0000, v73
    v_and_b32 v125, 0xffff0000, v77
    v_and_b32 v126, 0xffff0000, v81
    v_mul_f32 v131, v116, v130
    v_mul_f32 v132, v117, v130
    s_waitcnt vmcnt(12)
    s_barrier
    s_add_u32 s97, s98, s0
    s_lshr_b64 s[0:1], s[0:1], 4
    s_and_b32 s97, s97, 15
    s_lshr_b32 s99, s97, 3
    s_xor_b32 s97, s97, s99
    s_add_u32 m0, s87, 18432
    s_lshl_b32 s97, s97, 7
    buffer_load_dwordx4 v240, s[28:31], s97 offen offset:0  lds
    v_mul_f32 v133, v118, v130
    v_mul_f32 v134, v119, v130
    v_fmac_f32 v131, v117, v129
    v_fmac_f32 v132, v118, v129
    v_fmac_f32 v133, v119, v129
    buffer_load_dwordx4 v241, s[28:31], s97 offen offset:1024  lds
    v_fmac_f32 v134, v120, v129
    v_fmac_f32 v131, v118, v128
    v_fmac_f32 v132, v119, v128
    v_fmac_f32 v133, v120, v128
    v_fmac_f32 v134, v121, v128
    buffer_load_dwordx4 v242, s[28:31], s97 offen offset:2048  lds
    v_fmac_f32 v131, v119, v127
    v_fmac_f32 v132, v120, v127
    v_fmac_f32 v133, v121, v127
    v_fmac_f32 v134, v122, v127
    v_mul_f32 v131, v131, v123
    buffer_load_dwordx4 v243, s[28:31], s97 offen offset:3072  lds
    v_mul_f32 v132, v132, v124
    v_mul_f32 v133, v133, v125
    v_mul_f32 v134, v134, v126
    v_cvt_pk_bf16_f32 v114, v134, v133
    v_cvt_pk_bf16_f32 v115, v132, v131
    s_add_u32 m0, s88, 18432
    s_mov_b64 exec, 0xffffffff
    buffer_load_dwordx4 v3, s[28:31], s97 offen offset:0  lds
    s_mov_b64 exec, -1
    v_and_b32 v116, 0xffff0000, v43
    v_and_b32 v117, 0xffff0000, v47
    v_and_b32 v118, 0xffff0000, v51
    v_and_b32 v119, 0xffff0000, v55
    v_and_b32 v120, 0xffff0000, v59
    s_mul_i32 s16, s97, 3072
    s_add_u32 m0, s60, 24576
    s_add_u32 s99, s16, s62
    buffer_load_dwordx4 v244, s[32:35], s99 offen offset:0  lds
    v_and_b32 v121, 0xffff0000, v63
    v_and_b32 v122, 0xffff0000, v67
    v_lshlrev_b32 v127, 16, v98
    v_and_b32 v128, 0xffff0000, v98
    v_lshlrev_b32 v129, 16, v99
    buffer_load_dwordx4 v245, s[32:35], s99 offen offset:1024  lds
    v_and_b32 v130, 0xffff0000, v99
    v_and_b32 v123, 0xffff0000, v71
    v_and_b32 v124, 0xffff0000, v75
    v_and_b32 v125, 0xffff0000, v79
    v_and_b32 v126, 0xffff0000, v83
    buffer_load_dwordx4 v246, s[32:35], s99 offen offset:2048  lds
    v_mul_f32 v131, v116, v130
    v_mul_f32 v132, v117, v130
    v_mul_f32 v133, v118, v130
    v_mul_f32 v134, v119, v130
    v_fmac_f32 v131, v117, v129
    s_add_u32 m0, s61, 36864
    s_add_u32 s16, s16, s63
    buffer_load_dwordx4 v244, s[32:35], s16 offen offset:0  lds
    v_fmac_f32 v132, v118, v129
    v_fmac_f32 v133, v119, v129
    v_fmac_f32 v134, v120, v129
    v_fmac_f32 v131, v118, v128
    v_fmac_f32 v132, v119, v128
    buffer_load_dwordx4 v245, s[32:35], s16 offen offset:1024  lds
    v_fmac_f32 v133, v120, v128
    v_fmac_f32 v134, v121, v128
    v_fmac_f32 v131, v119, v127
    v_fmac_f32 v132, v120, v127
    v_fmac_f32 v133, v121, v127
    buffer_load_dwordx4 v246, s[32:35], s16 offen offset:2048  lds
    v_fmac_f32 v134, v122, v127
    v_mul_f32 v131, v131, v123
    v_mul_f32 v132, v132, v124
    v_mul_f32 v133, v133, v125
    v_mul_f32 v134, v134, v126
    v_cvt_pk_bf16_f32 v112, v134, v133
    v_cvt_pk_bf16_f32 v113, v132, v131
    s_nop 0
    v_permlane32_swap_b32 v114, v112
    v_permlane32_swap_b32 v115, v113
    s_mov_b32 s89, 49152
    buffer_store_dwordx4 v[112:115], v12, s[52:55], s89 offen sc1
    s_waitcnt vmcnt(12)
    s_barrier
    s_add_u32 s97, s98, s0
    s_lshr_b64 s[0:1], s[0:1], 4
    s_and_b32 s97, s97, 15
    s_lshr_b32 s99, s97, 3
    s_xor_b32 s97, s97, s99
    s_add_u32 m0, s87, 36864
    s_lshl_b32 s97, s97, 7
    buffer_load_dwordx4 v240, s[28:31], s97 offen offset:0  lds
    v_lshlrev_b32 v7, 3, v6
    v_sub_u32 v7, v7, v5
    buffer_load_dwordx4 v241, s[28:31], s97 offen offset:1024  lds
    v_subrev_u32 v7, 9, v7
    buffer_load_dwordx4 v242, s[28:31], s97 offen offset:2048  lds
    v_and_b32 v8, 1, v7
    v_xor_b32 v8, 1, v8
    buffer_load_dwordx4 v243, s[28:31], s97 offen offset:3072  lds
    v_lshlrev_b32 v8, 4, v8
    s_add_u32 m0, s88, 36864
    s_mov_b64 exec, 0xffffffff
    buffer_load_dwordx4 v3, s[28:31], s97 offen offset:0  lds
    s_mov_b64 exec, -1
    v_lshrrev_b32 v8, v8, s92
    v_ashrrev_i32 v7, 1, v7
    s_mul_i32 s16, s97, 3072
    s_add_u32 m0, s60, 49152
    s_add_u32 s99, s16, s62
    buffer_load_dwordx4 v244, s[32:35], s99 offen offset:0  lds
    v_cmp_eq_u32 vcc, 0, v7
    buffer_load_dwordx4 v245, s[32:35], s99 offen offset:1024  lds
    s_nop 0
    v_cndmask_b32 v236, 0, v8, vcc
    v_cmp_eq_u32 vcc, 1, v7
    buffer_load_dwordx4 v246, s[32:35], s99 offen offset:2048  lds
    s_nop 0
    v_cndmask_b32 v237, 0, v8, vcc
    s_add_u32 m0, s61, 61440
    s_add_u32 s16, s16, s63
    buffer_load_dwordx4 v244, s[32:35], s16 offen offset:0  lds
    v_cmp_eq_u32 vcc, 2, v7
    s_nop 1
    v_cndmask_b32 v238, 0, v8, vcc
    buffer_load_dwordx4 v245, s[32:35], s16 offen offset:1024  lds
    v_cmp_eq_u32 vcc, 3, v7
    buffer_load_dwordx4 v246, s[32:35], s16 offen offset:2048  lds
    s_nop 0
    v_cndmask_b32 v239, 0, v8, vcc
    s_waitcnt vmcnt(12)
    s_barrier
    s_add_u32 m0, s94, 32
    s_lshl_b32 s89, s90, 12
    buffer_load_dwordx4 v15, s[48:51], s89 offen offset:0 nt lds
    s_add_u32 m0, s94, 32
    s_lshl_b32 s89, s90, 12
    buffer_load_dwordx4 v15, s[48:51], s89 offen offset:1024 nt lds
    s_add_u32 m0, s94, 32
    s_lshl_b32 s89, s90, 12
    buffer_load_dwordx4 v15, s[48:51], s89 offen offset:2048 nt lds
    s_add_u32 m0, s94, 32
    s_lshl_b32 s89, s90, 12
    buffer_load_dwordx4 v15, s[48:51], s89 offen offset:3072 nt lds
    s_add_u32 s97, s98, s0
    s_lshr_b64 s[0:1], s[0:1], 4
    s_and_b32 s97, s97, 15
    s_lshr_b32 s99, s97, 3
    s_xor_b32 s97, s97, s99
    s_add_u32 m0, s87, 0
    s_lshl_b32 s97, s97, 7
    buffer_load_dwordx4 v240, s[28:31], s97 offen offset:0  lds
    buffer_load_dwordx4 v241, s[28:31], s97 offen offset:1024  lds
    buffer_load_dwordx4 v242, s[28:31], s97 offen offset:2048  lds
    buffer_load_dwordx4 v243, s[28:31], s97 offen offset:3072  lds
    s_add_u32 m0, s88, 0
    s_mov_b64 exec, 0xffffffff
    buffer_load_dwordx4 v3, s[28:31], s97 offen offset:0  lds
    s_mov_b64 exec, -1
    s_mul_i32 s16, s97, 3072
    s_add_u32 m0, s60, 0
    s_add_u32 s99, s16, s62
    buffer_load_dwordx4 v244, s[32:35], s99 offen offset:0  lds
    buffer_load_dwordx4 v245, s[32:35], s99 offen offset:1024  lds
    buffer_load_dwordx4 v246, s[32:35], s99 offen offset:2048  lds
    s_add_u32 m0, s61, 12288
    s_add_u32 s16, s16, s63
    buffer_load_dwordx4 v244, s[32:35], s16 offen offset:0  lds
    buffer_load_dwordx4 v245, s[32:35], s16 offen offset:1024  lds
    buffer_load_dwordx4 v246, s[32:35], s16 offen offset:2048  lds
    s_waitcnt vmcnt(15)
    s_barrier
    s_add_u32 s97, s98, s0
    s_lshr_b64 s[0:1], s[0:1], 4
    s_and_b32 s97, s97, 15
    s_lshr_b32 s99, s97, 3
    s_xor_b32 s97, s97, s99
    s_add_u32 m0, s87, 18432
    s_lshl_b32 s97, s97, 7
    buffer_load_dwordx4 v240, s[28:31], s97 offen offset:0  lds
    buffer_load_dwordx4 v241, s[28:31], s97 offen offset:1024  lds
    buffer_load_dwordx4 v242, s[28:31], s97 offen offset:2048  lds
    buffer_load_dwordx4 v243, s[28:31], s97 offen offset:3072  lds
    s_add_u32 m0, s88, 18432
    s_mov_b64 exec, 0xffffffff
    buffer_load_dwordx4 v3, s[28:31], s97 offen offset:0  lds
    s_mov_b64 exec, -1
    s_mul_i32 s16, s97, 3072
    s_add_u32 m0, s60, 24576
    s_add_u32 s99, s16, s62
    buffer_load_dwordx4 v244, s[32:35], s99 offen offset:0  lds
    buffer_load_dwordx4 v245, s[32:35], s99 offen offset:1024  lds
    buffer_load_dwordx4 v246, s[32:35], s99 offen offset:2048  lds
    s_add_u32 m0, s61, 36864
    s_add_u32 s16, s16, s63
    buffer_load_dwordx4 v244, s[32:35], s16 offen offset:0  lds
    buffer_load_dwordx4 v245, s[32:35], s16 offen offset:1024  lds
    buffer_load_dwordx4 v246, s[32:35], s16 offen offset:2048  lds
    s_waitcnt vmcnt(11)
    s_barrier
    s_add_u32 s97, s98, s0
    s_lshr_b64 s[0:1], s[0:1], 4
    s_and_b32 s97, s97, 15
    s_lshr_b32 s99, s97, 3
    s_xor_b32 s97, s97, s99
    s_add_u32 m0, s87, 36864
    s_lshl_b32 s97, s97, 7
    buffer_load_dwordx4 v240, s[28:31], s97 offen offset:0  lds
    v_add_u32 v5, s94, v15
    ds_read_b128 v[140:143], v5 offset:32
    ds_read_b32 v156, v5 offset:48
    ds_read_b128 v[144:147], v5 offset:1056
    buffer_load_dwordx4 v241, s[28:31], s97 offen offset:1024  lds
    ds_read_b32 v157, v5 offset:1072
    ds_read_b128 v[148:151], v5 offset:2080
    ds_read_b32 v158, v5 offset:2096
    ds_read_b128 v[152:155], v5 offset:3104
    buffer_load_dwordx4 v242, s[28:31], s97 offen offset:2048  lds
    ds_read_b32 v159, v5 offset:3120
    v_lshrrev_b32 v6, 3, v0
    v_mul_u32_u24 v6, 4160, v6
    buffer_load_dwordx4 v243, s[28:31], s97 offen offset:3072  lds
    v_and_b32 v7, 7, v0
    v_lshl_add_u32 v6, v7, 2, v6
    v_add_u32 v6, s94, v6
    v_mov_b32 v7, 0
    s_add_u32 m0, s88, 36864
    s_mov_b64 exec, 0xffffffff
    buffer_load_dwordx4 v3, s[28:31], s97 offen offset:0  lds
    s_mov_b64 exec, -1
    s_waitcnt lgkmcnt(0)
    v_readfirstlane_b32 s93, v140
    s_nop 0
    s_lshl_b32 s93, s93, 16
    s_nop 1
    v_writelane_b32 v7, s93, 15
    s_mul_i32 s16, s97, 3072
    s_add_u32 m0, s60, 49152
    s_add_u32 s99, s16, s62
    buffer_load_dwordx4 v244, s[32:35], s99 offen offset:0  lds
    v_alignbit_b32 v140, v141, v140, 16
    v_alignbit_b32 v141, v142, v141, 16
    v_alignbit_b32 v142, v143, v142, 16
    buffer_load_dwordx4 v245, s[32:35], s99 offen offset:1024  lds
    v_alignbit_b32 v143, v156, v143, 16
    v_alignbit_b32 v144, v145, v144, 16
    v_alignbit_b32 v145, v146, v145, 16
    v_alignbit_b32 v146, v147, v146, 16
    buffer_load_dwordx4 v246, s[32:35], s99 offen offset:2048  lds
    v_alignbit_b32 v147, v157, v147, 16
    v_alignbit_b32 v148, v149, v148, 16
    v_alignbit_b32 v149, v150, v149, 16
    v_alignbit_b32 v150, v151, v150, 16
    s_add_u32 m0, s61, 61440
    s_add_u32 s16, s16, s63
    buffer_load_dwordx4 v244, s[32:35], s16 offen offset:0  lds
    v_alignbit_b32 v151, v158, v151, 16
    v_alignbit_b32 v152, v153, v152, 16
    v_alignbit_b32 v153, v154, v153, 16
    buffer_load_dwordx4 v245, s[32:35], s16 offen offset:1024  lds
    v_alignbit_b32 v154, v155, v154, 16
    v_alignbit_b32 v155, v159, v155, 16
    v_lshlrev_b32 v8, 3, v0
    s_add_u32 s78, s88, 18432
    buffer_load_dwordx4 v246, s[32:35], s16 offen offset:2048  lds
    v_add_u32 v8, s78, v8
    v_mov_b32 v156, 0
    v_mov_b32 v157, 0
    s_waitcnt vmcnt(11)
    s_barrier
    s_add_u32 s97, s98, s0
    s_lshr_b64 s[0:1], s[0:1], 4
    s_and_b32 s97, s97, 15
    s_lshr_b32 s99, s97, 3
    s_xor_b32 s97, s97, s99
    s_add_u32 m0, s87, 0
    s_lshl_b32 s97, s97, 7
    buffer_load_dwordx4 v240, s[28:31], s97 offen offset:0  lds
    buffer_load_dwordx4 v241, s[28:31], s97 offen offset:1024  lds
    buffer_load_dwordx4 v242, s[28:31], s97 offen offset:2048  lds
    buffer_load_dwordx4 v243, s[28:31], s97 offen offset:3072  lds
    s_add_u32 m0, s88, 0
    s_mov_b64 exec, 0xffffffff
    buffer_load_dwordx4 v3, s[28:31], s97 offen offset:0  lds
    s_mov_b64 exec, -1
    s_mul_i32 s16, s97, 3072
    s_add_u32 m0, s60, 0
    s_add_u32 s99, s16, s62
    buffer_load_dwordx4 v244, s[32:35], s99 offen offset:0  lds
    buffer_load_dwordx4 v245, s[32:35], s99 offen offset:1024  lds
    buffer_load_dwordx4 v246, s[32:35], s99 offen offset:2048  lds
    s_add_u32 m0, s61, 12288
    s_add_u32 s16, s16, s63
    buffer_load_dwordx4 v244, s[32:35], s16 offen offset:0  lds
    buffer_load_dwordx4 v245, s[32:35], s16 offen offset:1024  lds
    buffer_load_dwordx4 v246, s[32:35], s16 offen offset:2048  lds
    s_mov_b64 exec, 0xff
    buffer_load_dword v136, v33, s[68:71], 0 offen sc1
    buffer_load_dword v137, v34, s[52:55], 0 offen sc1
    s_mov_b64 exec, -1
    s_waitcnt vmcnt(13)
    s_barrier
    s_waitcnt vmcnt(0)
    s_branch LA_j
LA_c1:
    s_waitcnt vmcnt(7)
    s_barrier
    buffer_load_dwordx4 v246, s[32:35], s99 offen offset:2048  lds
    s_add_u32 m0, s61, 36864
    s_add_u32 s16, s16, s63
    buffer_load_dwordx4 v244, s[32:35], s16 offen offset:0  lds
    buffer_load_dwordx4 v245, s[32:35], s16 offen offset:1024  lds
    buffer_load_dwordx4 v246, s[32:35], s16 offen offset:2048  lds
    s_add_u32 s97, s98, s0
    s_lshr_b64 s[0:1], s[0:1], 4
    s_and_b32 s97, s97, 15
    s_lshr_b32 s99, s97, 3
    s_xor_b32 s97, s97, s99
    s_add_u32 m0, s87, 36864
    s_lshl_b32 s97, s97, 7
    buffer_load_dwordx4 v240, s[28:31], s97 offen offset:0  lds
    buffer_load_dwordx4 v241, s[28:31], s97 offen offset:1024  lds
    buffer_load_dwordx4 v242, s[28:31], s97 offen offset:2048  lds
    buffer_load_dwordx4 v243, s[28:31], s97 offen offset:3072  lds
    s_add_u32 m0, s88, 36864
    s_mov_b64 exec, 0xffffffff
    buffer_load_dwordx4 v3, s[28:31], s97 offen offset:0  lds
    s_mov_b64 exec, -1
    s_mul_i32 s16, s97, 3072
    s_add_u32 m0, s60, 49152
    s_add_u32 s99, s16, s62
    buffer_load_dwordx4 v244, s[32:35], s99 offen offset:0  lds
    buffer_load_dwordx4 v245, s[32:35], s99 offen offset:1024  lds
    buffer_load_dwordx4 v246, s[32:35], s99 offen offset:2048  lds
    s_add_u32 m0, s61, 61440
    s_add_u32 s16, s16, s63
    buffer_load_dwordx4 v244, s[32:35], s16 offen offset:0  lds
    buffer_load_dwordx4 v245, s[32:35], s16 offen offset:1024  lds
    buffer_load_dwordx4 v246, s[32:35], s16 offen offset:2048  lds
    s_waitcnt vmcnt(11)
    s_barrier
    s_add_u32 s97, s98, s0
    s_lshr_b64 s[0:1], s[0:1], 4
    s_and_b32 s97, s97, 15
    s_lshr_b32 s99, s97, 3
    s_xor_b32 s97, s97, s99
    s_add_u32 m0, s87, 0
    s_lshl_b32 s97, s97, 7
    buffer_load_dwordx4 v240, s[28:31], s97 offen offset:0  lds
    s_mov_b32 s68, s24
    s_mov_b32 s69, s25
    s_mov_b32 s70, 0x100
    s_mov_b32 s71, 0x20000
    v_lshrrev_b32 v6, 5, v0
    buffer_load_dwordx4 v241, s[28:31], s97 offen offset:1024  lds
    v_and_b32 v7, 3, v0
    s_lshr_b32 s78, s90, 1
    s_lshl_b32 s78, s78, 2
    s_load_dword s92, s[14:15], s78
    v_bfe_u32 v5, v0, 2, 2
    buffer_load_dwordx4 v242, s[28:31], s97 offen offset:2048  lds
    v_lshlrev_b32 v5, 1, v5
    v_lshl_add_u32 v5, v6, 3, v5
    v_bfe_u32 v8, v0, 4, 1
    v_add_u32 v5, v5, v8
    s_and_b32 s78, s3, 1
    buffer_load_dwordx4 v243, s[28:31], s97 offen offset:3072  lds
    s_lshl_b32 s78, s78, 1
    v_add_u32 v8, s78, v6
    v_xor_b32 v8, v8, v7
    v_lshlrev_b32 v8, 4, v8
    v_lshl_add_u32 v5, v5, 6, v8
    s_add_u32 m0, s88, 0
    s_mov_b64 exec, 0xffffffff
    buffer_load_dwordx4 v3, s[28:31], s97 offen offset:0  lds
    s_mov_b64 exec, -1
    v_add_u32 v14, s86, v5
    v_mov_b32 v18, 162304
    v_mov_b32 v19, 1
    v_and_b32 v5, 3, v0
    s_lshl_b32 s78, s74, 4
    s_mul_i32 s16, s97, 3072
    s_add_u32 m0, s60, 0
    s_add_u32 s99, s16, s62
    buffer_load_dwordx4 v244, s[32:35], s99 offen offset:0  lds
    s_add_u32 s78, s78, s3
    v_lshl_add_u32 v6, v5, 2, s78
    s_lshr_b32 s78, s76, 3
    s_lshl_b32 s79, s3, 1
    s_add_u32 s78, s78, s79
    buffer_load_dwordx4 v245, s[32:35], s99 offen offset:1024  lds
    s_xor_b32 s78, s78, 0
    s_lshl_b32 s78, s78, 5
    s_and_b32 s79, s76, 7
    s_add_u32 s78, s78, s79
    v_lshl_add_u32 v7, v5, 3, s78
    buffer_load_dwordx4 v246, s[32:35], s99 offen offset:2048  lds
    v_and_b32 v8, 4, v0
    v_cmp_eq_u32 vcc, 0, v8
    s_nop 1
    v_cndmask_b32 v6, v7, v6, vcc
    v_and_b32 v33, 0xf0, v6
    v_lshlrev_b32 v34, 8, v6
    s_add_u32 m0, s61, 12288
    s_add_u32 s16, s16, s63
    buffer_load_dwordx4 v244, s[32:35], s16 offen offset:0  lds
    v_add_u32 v34, 12582912, v34
    v_and_b32 v5, 15, v0
    v_lshrrev_b32 v6, 4, v0
    v_add_u32 v7, 9, v5
    v_and_b32 v8, 1, v7
    buffer_load_dwordx4 v245, s[32:35], s16 offen offset:1024  lds
    v_mul_u32_u24 v8, 4160, v8
    v_lshrrev_b32 v7, 1, v7
    v_lshl_add_u32 v8, v7, 2, v8
    v_lshlrev_b32 v7, 4, v6
    v_sub_u32 v8, v8, v7
    buffer_load_dwordx4 v246, s[32:35], s16 offen offset:2048  lds
    s_add_u32 s78, s94, 32
    v_add_u32 v21, s78, v8
    v_add_u32 v22, 1024, v21
    v_add_u32 v23, 2048, v21
    v_add_u32 v24, 3072, v21
    v_lshl_add_u32 v7, v5, 1, v6
    v_add_u32 v7, 30, v7
    v_and_b32 v8, 1, v7
    v_bfe_u32 v136, v7, 1, 2
    v_lshl_add_u32 v136, v8, 2, v136
    s_waitcnt vmcnt(11)
    s_barrier
    s_add_u32 m0, s86, 129536
    s_mov_b32 s89, 0
    buffer_load_dwordx4 v10, s[36:39], s89 offen nt lds
    v_lshlrev_b32 v136, 6, v136
    v_lshrrev_b32 v7, 3, v7
    v_lshl_add_u32 v136, v7, 9, v136
    v_bitop3_b32 v8, v7, 3, s3 bitop3:0x6a
    s_add_u32 m0, s86, 145920
    s_mov_b32 s89, 0
    buffer_load_dwordx4 v10, s[40:43], s89 offen nt lds
    v_lshl_add_u32 v25, v8, 4, v136
    v_add_u32 v25, 92160, v25
    v_subrev_u32 v7, 1, v7
    v_bitop3_b32 v8, v7, 3, s3 bitop3:0x6a
    s_add_u32 m0, s86, 133632
    s_mov_b32 s89, 65536
    buffer_load_dwordx4 v10, s[36:39], s89 offen nt lds
    v_lshl_add_u32 v27, v8, 4, v136
    v_add_u32 v27, 91648, v27
    v_subrev_u32 v7, 1, v7
    v_bitop3_b32 v8, v7, 3, s3 bitop3:0x6a
    s_add_u32 m0, s86, 150016
    s_mov_b32 s89, 65536
    buffer_load_dwordx4 v10, s[40:43], s89 offen nt lds
    v_lshl_add_u32 v29, v8, 4, v136
    v_add_u32 v29, 91136, v29
    v_subrev_u32 v7, 1, v7
    s_add_u32 m0, s86, 137728
    s_mov_b32 s89, 131072
    buffer_load_dwordx4 v10, s[36:39], s89 offen nt lds
    v_bitop3_b32 v8, v7, 3, s3 bitop3:0x6a
    v_lshl_add_u32 v31, v8, 4, v136
    v_add_u32 v31, 90624, v31
    v_lshl_add_u32 v7, v5, 1, v6
    s_add_u32 m0, s86, 154112
    s_mov_b32 s89, 131072
    buffer_load_dwordx4 v10, s[40:43], s89 offen nt lds
    v_add_u32 v7, 26, v7
    v_and_b32 v8, 1, v7
    v_bfe_u32 v136, v7, 1, 2
    v_lshl_add_u32 v136, v8, 2, v136
    s_add_u32 m0, s86, 141824
    s_mov_b32 s89, 196608
    buffer_load_dwordx4 v10, s[36:39], s89 offen nt lds
    v_lshlrev_b32 v136, 6, v136
    v_lshrrev_b32 v7, 3, v7
    v_lshl_add_u32 v136, v7, 9, v136
    v_bitop3_b32 v8, v7, 3, s3 bitop3:0x6a
    s_add_u32 m0, s86, 158208
    s_mov_b32 s89, 196608
    buffer_load_dwordx4 v10, s[40:43], s89 offen nt lds
    v_lshl_add_u32 v26, v8, 4, v136
    v_add_u32 v26, 92160, v26
    v_subrev_u32 v7, 1, v7
    s_mov_b64 exec, 0xff
    s_lshl_b32 s82, s3, 7
    s_add_u32 m0, s82, 129024
    s_mov_b32 s89, 0
    buffer_load_dwordx4 v11, s[36:39], s89 offen nt lds
    s_lshl_b32 s83, s74, 9
    s_add_u32 s83, s83, s82
    s_and_b32 s89, s3, 2
    s_lshl_b32 s89, s89, 3
    s_add_u32 s82, s82, s89
    s_add_u32 m0, s82, 162816
    s_add_u32 s89, s83, 0
    buffer_load_dwordx4 v15, s[44:47], s89 offen  lds
    s_mov_b64 exec, -1
    v_bitop3_b32 v8, v7, 3, s3 bitop3:0x6a
    v_lshl_add_u32 v28, v8, 4, v136
    v_add_u32 v28, 91648, v28
    v_subrev_u32 v7, 1, v7
    s_add_u32 s97, s98, s0
    s_lshr_b64 s[0:1], s[0:1], 4
    s_and_b32 s97, s97, 15
    s_lshr_b32 s99, s97, 3
    s_xor_b32 s97, s97, s99
    s_add_u32 m0, s87, 18432
    s_lshl_b32 s97, s97, 7
    buffer_load_dwordx4 v240, s[28:31], s97 offen offset:0  lds
    v_bitop3_b32 v8, v7, 3, s3 bitop3:0x6a
    v_lshl_add_u32 v30, v8, 4, v136
    v_add_u32 v30, 91136, v30
    v_subrev_u32 v7, 1, v7
    buffer_load_dwordx4 v241, s[28:31], s97 offen offset:1024  lds
    v_bitop3_b32 v8, v7, 3, s3 bitop3:0x6a
    v_lshl_add_u32 v32, v8, 4, v136
    v_add_u32 v32, 90624, v32
    v_lshrrev_b32 v7, 1, v6
    buffer_load_dwordx4 v242, s[28:31], s97 offen offset:2048  lds
    v_lshl_add_u32 v7, v5, 1, v7
    v_add_u32 v7, 32, v7
    v_and_b32 v8, 1, v7
    buffer_load_dwordx4 v243, s[28:31], s97 offen offset:3072  lds
    v_bfe_u32 v136, v7, 1, 2
    v_lshl_add_u32 v136, v8, 2, v136
    v_lshlrev_b32 v136, 6, v136
    v_lshrrev_b32 v7, 3, v7
    s_add_u32 m0, s88, 18432
    s_mov_b64 exec, 0xffffffff
    buffer_load_dwordx4 v3, s[28:31], s97 offen offset:0  lds
    s_mov_b64 exec, -1
    v_lshl_add_u32 v136, v7, 9, v136
    v_bitop3_b32 v8, v7, 3, s3 bitop3:0x6a
    v_lshl_add_u32 v20, v8, 4, v136
    v_add_u32 v20, 92160, v20
    s_mul_i32 s16, s97, 3072
    s_add_u32 m0, s60, 24576
    s_add_u32 s99, s16, s62
    buffer_load_dwordx4 v244, s[32:35], s99 offen offset:0  lds
    v_and_b32 v8, 1, v6
    v_xor_b32 v8, 1, v8
    v_lshl_add_u32 v20, v8, 3, v20
    s_waitcnt lgkmcnt(0)
    buffer_load_dwordx4 v245, s[32:35], s99 offen offset:1024  lds
    s_and_b32 s78, s92, 0xffff0000
    s_lshl_b32 s92, s92, 16
    s_bitcmp1_b32 s90, 0
    s_cselect_b32 s92, s78, s92
    s_waitcnt vmcnt(17)
    s_barrier
    buffer_load_dwordx4 v246, s[32:35], s99 offen offset:2048  lds
    v_lshlrev_b32 v7, 3, v6
    v_sub_u32 v7, v7, v5
    s_add_u32 m0, s61, 36864
    s_add_u32 s16, s16, s63
    buffer_load_dwordx4 v244, s[32:35], s16 offen offset:0  lds
    v_subrev_u32 v7, 9, v7
    buffer_load_dwordx4 v245, s[32:35], s16 offen offset:1024  lds
    v_and_b32 v8, 1, v7
    buffer_load_dwordx4 v246, s[32:35], s16 offen offset:2048  lds
    v_xor_b32 v8, 1, v8
    s_add_u32 s97, s98, s0
    s_lshr_b64 s[0:1], s[0:1], 4
    s_and_b32 s97, s97, 15
    s_lshr_b32 s99, s97, 3
    s_xor_b32 s97, s97, s99
    s_add_u32 m0, s87, 36864
    s_lshl_b32 s97, s97, 7
    buffer_load_dwordx4 v240, s[28:31], s97 offen offset:0  lds
    v_lshlrev_b32 v8, 4, v8
    buffer_load_dwordx4 v241, s[28:31], s97 offen offset:1024  lds
    v_lshrrev_b32 v8, v8, s92
    buffer_load_dwordx4 v242, s[28:31], s97 offen offset:2048  lds
    v_ashrrev_i32 v7, 1, v7
    buffer_load_dwordx4 v243, s[28:31], s97 offen offset:3072  lds
    v_cmp_eq_u32 vcc, 0, v7
    s_add_u32 m0, s88, 36864
    s_mov_b64 exec, 0xffffffff
    buffer_load_dwordx4 v3, s[28:31], s97 offen offset:0  lds
    s_mov_b64 exec, -1
    v_cndmask_b32 v236, 0, v8, vcc
    s_mul_i32 s16, s97, 3072
    s_add_u32 m0, s60, 49152
    s_add_u32 s99, s16, s62
    buffer_load_dwordx4 v244, s[32:35], s99 offen offset:0  lds
    v_cmp_eq_u32 vcc, 1, v7
    buffer_load_dwordx4 v245, s[32:35], s99 offen offset:1024  lds
    s_nop 0
    v_cndmask_b32 v237, 0, v8, vcc
    buffer_load_dwordx4 v246, s[32:35], s99 offen offset:2048  lds
    v_cmp_eq_u32 vcc, 2, v7
    s_add_u32 m0, s61, 61440
    s_add_u32 s16, s16, s63
    buffer_load_dwordx4 v244, s[32:35], s16 offen offset:0  lds
    v_cndmask_b32 v238, 0, v8, vcc
    buffer_load_dwordx4 v245, s[32:35], s16 offen offset:1024  lds
    v_cmp_eq_u32 vcc, 3, v7
    buffer_load_dwordx4 v246, s[32:35], s16 offen offset:2048  lds
    s_nop 0
    v_cndmask_b32 v239, 0, v8, vcc
    s_waitcnt vmcnt(11)
    s_barrier
    buffer_load_dword v230, v229, s[64:67], 0 offen
    ds_read_b128 v[84:87], v35 offset:0
    ds_read_b128 v[88:91], v35 offset:16
    s_add_u32 s97, s98, s0
    s_lshr_b64 s[0:1], s[0:1], 4
    s_and_b32 s97, s97, 15
    s_lshr_b32 s99, s97, 3
    s_xor_b32 s97, s97, s99
    s_add_u32 m0, s87, 0
    s_lshl_b32 s97, s97, 7
    buffer_load_dwordx4 v240, s[28:31], s97 offen offset:0  lds
    ds_read_b128 v[92:95], v35 offset:32
    buffer_load_dwordx4 v241, s[28:31], s97 offen offset:1024  lds
    ds_read_b128 v[96:99], v35 offset:48
    buffer_load_dwordx4 v242, s[28:31], s97 offen offset:2048  lds
    ds_read_b128 v[40:43], v233 offset:0
    buffer_load_dwordx4 v243, s[28:31], s97 offen offset:3072  lds
    ds_read_b128 v[44:47], v232 offset:256
    ds_read_b128 v[48:51], v233 offset:256
    s_add_u32 m0, s88, 0
    s_mov_b64 exec, 0xffffffff
    buffer_load_dwordx4 v3, s[28:31], s97 offen offset:0  lds
    s_mov_b64 exec, -1
    ds_read_b128 v[52:55], v16 offset:512
    s_mul_i32 s16, s97, 3072
    s_add_u32 m0, s60, 0
    s_add_u32 s99, s16, s62
    buffer_load_dwordx4 v244, s[32:35], s99 offen offset:0  lds
    ds_read_b128 v[56:59], v231 offset:512
    buffer_load_dwordx4 v245, s[32:35], s99 offen offset:1024  lds
    ds_read_b128 v[60:63], v16 offset:768
    buffer_load_dwordx4 v246, s[32:35], s99 offen offset:2048  lds
    ds_read_b128 v[64:67], v231 offset:768
    ds_read_b128 v[68:71], v16 offset:16896
    s_add_u32 m0, s61, 12288
    s_add_u32 s16, s16, s63
    buffer_load_dwordx4 v244, s[32:35], s16 offen offset:0  lds
    ds_read_b128 v[72:75], v231 offset:16896
    buffer_load_dwordx4 v245, s[32:35], s16 offen offset:1024  lds
    ds_read_b128 v[76:79], v16 offset:17152
    buffer_load_dwordx4 v246, s[32:35], s16 offen offset:2048  lds
    ds_read_b128 v[80:83], v231 offset:17152
    s_waitcnt vmcnt(12)
    s_waitcnt lgkmcnt(0)
    s_barrier
    s_add_u32 s97, s98, s0
    s_lshr_b64 s[0:1], s[0:1], 4
    s_and_b32 s97, s97, 15
    s_lshr_b32 s99, s97, 3
    s_xor_b32 s97, s97, s99
    s_add_u32 m0, s87, 18432
    s_lshl_b32 s97, s97, 7
    buffer_load_dwordx4 v240, s[28:31], s97 offen offset:0  lds
    v_lshlrev_b32 v116, 16, v40
    v_lshlrev_b32 v117, 16, v44
    v_lshlrev_b32 v118, 16, v48
    v_lshlrev_b32 v119, 16, v52
    v_lshlrev_b32 v120, 16, v56
    buffer_load_dwordx4 v241, s[28:31], s97 offen offset:1024  lds
    v_lshlrev_b32 v121, 16, v60
    v_lshlrev_b32 v122, 16, v64
    v_lshlrev_b32 v127, 16, v84
    v_and_b32 v128, 0xffff0000, v84
    v_lshlrev_b32 v129, 16, v85
    buffer_load_dwordx4 v242, s[28:31], s97 offen offset:2048  lds
    v_and_b32 v130, 0xffff0000, v85
    v_lshlrev_b32 v123, 16, v68
    v_lshlrev_b32 v124, 16, v72
    v_lshlrev_b32 v125, 16, v76
    v_lshlrev_b32 v126, 16, v80
    buffer_load_dwordx4 v243, s[28:31], s97 offen offset:3072  lds
    v_mul_f32 v131, v116, v130
    v_mul_f32 v132, v117, v130
    v_mul_f32 v133, v118, v130
    v_mul_f32 v134, v119, v130
    v_fmac_f32 v131, v117, v129
    s_add_u32 m0, s88, 18432
    s_mov_b64 exec, 0xffffffff
    buffer_load_dwordx4 v3, s[28:31], s97 offen offset:0  lds
    s_mov_b64 exec, -1
    v_fmac_f32 v132, v118, v129
    v_fmac_f32 v133, v119, v129
    v_fmac_f32 v134, v120, v129
    v_fmac_f32 v131, v118, v128
    v_fmac_f32 v132, v119, v128
    s_mul_i32 s16, s97, 3072
    s_add_u32 m0, s60, 24576
    s_add_u32 s99, s16, s62
    buffer_load_dwordx4 v244, s[32:35], s99 offen offset:0  lds
    v_fmac_f32 v133, v120, v128
    v_fmac_f32 v134, v121, v128
    v_fmac_f32 v131, v119, v127
    v_fmac_f32 v132, v120, v127
    v_fmac_f32 v133, v121, v127
    buffer_load_dwordx4 v245, s[32:35], s99 offen offset:1024  lds
    v_fmac_f32 v134, v122, v127
    v_mul_f32 v131, v131, v123
    v_mul_f32 v132, v132, v124
    v_mul_f32 v133, v133, v125
    v_mul_f32 v134, v134, v126
    buffer_load_dwordx4 v246, s[32:35], s99 offen offset:2048  lds
    v_cvt_pk_bf16_f32 v102, v134, v133
    v_cvt_pk_bf16_f32 v103, v132, v131
    v_lshlrev_b32 v116, 16, v42
    v_lshlrev_b32 v117, 16, v46
    v_lshlrev_b32 v118, 16, v50
    s_add_u32 m0, s61, 36864
    s_add_u32 s16, s16, s63
    buffer_load_dwordx4 v244, s[32:35], s16 offen offset:0  lds
    v_lshlrev_b32 v119, 16, v54
    v_lshlrev_b32 v120, 16, v58
    v_lshlrev_b32 v121, 16, v62
    v_lshlrev_b32 v122, 16, v66
    v_lshlrev_b32 v127, 16, v92
    buffer_load_dwordx4 v245, s[32:35], s16 offen offset:1024  lds
    v_and_b32 v128, 0xffff0000, v92
    v_lshlrev_b32 v129, 16, v93
    v_and_b32 v130, 0xffff0000, v93
    v_lshlrev_b32 v123, 16, v70
    v_lshlrev_b32 v124, 16, v74
    buffer_load_dwordx4 v246, s[32:35], s16 offen offset:2048  lds
    v_lshlrev_b32 v125, 16, v78
    v_lshlrev_b32 v126, 16, v82
    v_mul_f32 v131, v116, v130
    v_mul_f32 v132, v117, v130
    v_mul_f32 v133, v118, v130
    v_mul_f32 v134, v119, v130
    v_fmac_f32 v131, v117, v129
    v_fmac_f32 v132, v118, v129
    v_fmac_f32 v133, v119, v129
    v_fmac_f32 v134, v120, v129
    v_fmac_f32 v131, v118, v128
    v_fmac_f32 v132, v119, v128
    s_waitcnt vmcnt(11)
    s_barrier
    s_add_u32 s97, s98, s0
    s_lshr_b64 s[0:1], s[0:1], 4
    s_and_b32 s97, s97, 15
    s_lshr_b32 s99, s97, 3
    s_xor_b32 s97, s97, s99
    s_add_u32 m0, s87, 36864
    s_lshl_b32 s97, s97, 7
    buffer_load_dwordx4 v240, s[28:31], s97 offen offset:0  lds
    v_fmac_f32 v133, v120, v128
    v_fmac_f32 v134, v121, v128
    v_fmac_f32 v131, v119, v127
    v_fmac_f32 v132, v120, v127
    v_fmac_f32 v133, v121, v127
    buffer_load_dwordx4 v241, s[28:31], s97 offen offset:1024  lds
    v_fmac_f32 v134, v122, v127
    v_mul_f32 v131, v131, v123
    v_mul_f32 v132, v132, v124
    v_mul_f32 v133, v133, v125
    v_mul_f32 v134, v134, v126
    buffer_load_dwordx4 v242, s[28:31], s97 offen offset:2048  lds
    v_cvt_pk_bf16_f32 v100, v134, v133
    v_cvt_pk_bf16_f32 v101, v132, v131
    s_nop 0
    v_permlane32_swap_b32 v102, v100
    v_permlane32_swap_b32 v103, v101
    s_mov_b32 s89, 0
    buffer_store_dwordx4 v[100:103], v12, s[52:55], s89 offen sc1
    buffer_load_dwordx4 v243, s[28:31], s97 offen offset:3072  lds
    v_and_b32 v116, 0xffff0000, v40
    v_and_b32 v117, 0xffff0000, v44
    v_and_b32 v118, 0xffff0000, v48
    v_and_b32 v119, 0xffff0000, v52
    v_and_b32 v120, 0xffff0000, v56
    s_add_u32 m0, s88, 36864
    s_mov_b64 exec, 0xffffffff
    buffer_load_dwordx4 v3, s[28:31], s97 offen offset:0  lds
    s_mov_b64 exec, -1
    v_and_b32 v121, 0xffff0000, v60
    v_and_b32 v122, 0xffff0000, v64
    v_lshlrev_b32 v127, 16, v86
    v_and_b32 v128, 0xffff0000, v86
    v_lshlrev_b32 v129, 16, v87
    s_mul_i32 s16, s97, 3072
    s_add_u32 m0, s60, 49152
    s_add_u32 s99, s16, s62
    buffer_load_dwordx4 v244, s[32:35], s99 offen offset:0  lds
    v_and_b32 v130, 0xffff0000, v87
    v_and_b32 v123, 0xffff0000, v68
    v_and_b32 v124, 0xffff0000, v72
    v_and_b32 v125, 0xffff0000, v76
    v_and_b32 v126, 0xffff0000, v80
    buffer_load_dwordx4 v245, s[32:35], s99 offen offset:1024  lds
    v_mul_f32 v131, v116, v130
    v_mul_f32 v132, v117, v130
    v_mul_f32 v133, v118, v130
    v_mul_f32 v134, v119, v130
    v_fmac_f32 v131, v117, v129
    buffer_load_dwordx4 v246, s[32:35], s99 offen offset:2048  lds
    v_fmac_f32 v132, v118, v129
    v_fmac_f32 v133, v119, v129
    v_fmac_f32 v134, v120, v129
    v_fmac_f32 v131, v118, v128
    v_fmac_f32 v132, v119, v128
    s_add_u32 m0, s61, 61440
    s_add_u32 s16, s16, s63
    buffer_load_dwordx4 v244, s[32:35], s16 offen offset:0  lds
    v_fmac_f32 v133, v120, v128
    v_fmac_f32 v134, v121, v128
    v_fmac_f32 v131, v119, v127
    v_fmac_f32 v132, v120, v127
    v_fmac_f32 v133, v121, v127
    buffer_load_dwordx4 v245, s[32:35], s16 offen offset:1024  lds
    v_fmac_f32 v134, v122, v127
    v_mul_f32 v131, v131, v123
    v_mul_f32 v132, v132, v124
    v_mul_f32 v133, v133, v125
    v_mul_f32 v134, v134, v126
    buffer_load_dwordx4 v246, s[32:35], s16 offen offset:2048  lds
    v_cvt_pk_bf16_f32 v106, v134, v133
    v_cvt_pk_bf16_f32 v107, v132, v131
    v_and_b32 v116, 0xffff0000, v42
    v_and_b32 v117, 0xffff0000, v46
    v_and_b32 v118, 0xffff0000, v50
    v_and_b32 v119, 0xffff0000, v54
    v_and_b32 v120, 0xffff0000, v58
    v_and_b32 v121, 0xffff0000, v62
    v_and_b32 v122, 0xffff0000, v66
    v_lshlrev_b32 v127, 16, v94
    v_and_b32 v128, 0xffff0000, v94
    v_lshlrev_b32 v129, 16, v95
    s_waitcnt vmcnt(12)
    s_barrier
    s_add_u32 s97, s98, s0
    s_lshr_b64 s[0:1], s[0:1], 4
    s_and_b32 s97, s97, 15
    s_lshr_b32 s99, s97, 3
    s_xor_b32 s97, s97, s99
    s_add_u32 m0, s87, 0
    s_lshl_b32 s97, s97, 7
    buffer_load_dwordx4 v240, s[28:31], s97 offen offset:0  lds
    v_and_b32 v130, 0xffff0000, v95
    v_and_b32 v123, 0xffff0000, v70
    v_and_b32 v124, 0xffff0000, v74
    v_and_b32 v125, 0xffff0000, v78
    v_and_b32 v126, 0xffff0000, v82
    buffer_load_dwordx4 v241, s[28:31], s97 offen offset:1024  lds
    v_mul_f32 v131, v116, v130
    v_mul_f32 v132, v117, v130
    v_mul_f32 v133, v118, v130
    v_mul_f32 v134, v119, v130
    v_fmac_f32 v131, v117, v129
    buffer_load_dwordx4 v242, s[28:31], s97 offen offset:2048  lds
    v_fmac_f32 v132, v118, v129
    v_fmac_f32 v133, v119, v129
    v_fmac_f32 v134, v120, v129
    v_fmac_f32 v131, v118, v128
    v_fmac_f32 v132, v119, v128
    buffer_load_dwordx4 v243, s[28:31], s97 offen offset:3072  lds
    v_fmac_f32 v133, v120, v128
    v_fmac_f32 v134, v121, v128
    v_fmac_f32 v131, v119, v127
    v_fmac_f32 v132, v120, v127
    v_fmac_f32 v133, v121, v127
    s_add_u32 m0, s88, 0
    s_mov_b64 exec, 0xffffffff
    buffer_load_dwordx4 v3, s[28:31], s97 offen offset:0  lds
    s_mov_b64 exec, -1
    v_fmac_f32 v134, v122, v127
    v_mul_f32 v131, v131, v123
    v_mul_f32 v132, v132, v124
    v_mul_f32 v133, v133, v125
    v_mul_f32 v134, v134, v126
    s_mul_i32 s16, s97, 3072
    s_add_u32 m0, s60, 0
    s_add_u32 s99, s16, s62
    buffer_load_dwordx4 v244, s[32:35], s99 offen offset:0  lds
    v_cvt_pk_bf16_f32 v104, v134, v133
    v_cvt_pk_bf16_f32 v105, v132, v131
    s_nop 0
    v_permlane32_swap_b32 v106, v104
    v_permlane32_swap_b32 v107, v105
    s_mov_b32 s89, 16384
    buffer_store_dwordx4 v[104:107], v12, s[52:55], s89 offen sc1
    buffer_load_dwordx4 v245, s[32:35], s99 offen offset:1024  lds
    v_lshlrev_b32 v116, 16, v41
    v_lshlrev_b32 v117, 16, v45
    v_lshlrev_b32 v118, 16, v49
    v_lshlrev_b32 v119, 16, v53
    v_lshlrev_b32 v120, 16, v57
    buffer_load_dwordx4 v246, s[32:35], s99 offen offset:2048  lds
    v_lshlrev_b32 v121, 16, v61
    v_lshlrev_b32 v122, 16, v65
    v_lshlrev_b32 v127, 16, v88
    v_and_b32 v128, 0xffff0000, v88
    v_lshlrev_b32 v129, 16, v89
    s_add_u32 m0, s61, 12288
    s_add_u32 s16, s16, s63
    buffer_load_dwordx4 v244, s[32:35], s16 offen offset:0  lds
    v_and_b32 v130, 0xffff0000, v89
    v_lshlrev_b32 v123, 16, v69
    v_lshlrev_b32 v124, 16, v73
    v_lshlrev_b32 v125, 16, v77
    v_lshlrev_b32 v126, 16, v81
    buffer_load_dwordx4 v245, s[32:35], s16 offen offset:1024  lds
    v_mul_f32 v131, v116, v130
    v_mul_f32 v132, v117, v130
    v_mul_f32 v133, v118, v130
    v_mul_f32 v134, v119, v130
    v_fmac_f32 v131, v117, v129
    buffer_load_dwordx4 v246, s[32:35], s16 offen offset:2048  lds
    v_fmac_f32 v132, v118, v129
    v_fmac_f32 v133, v119, v129
    v_fmac_f32 v134, v120, v129
    v_fmac_f32 v131, v118, v128
    v_fmac_f32 v132, v119, v128
    v_fmac_f32 v133, v120, v128
    v_fmac_f32 v134, v121, v128
    v_fmac_f32 v131, v119, v127
    v_fmac_f32 v132, v120, v127
    v_fmac_f32 v133, v121, v127
    v_fmac_f32 v134, v122, v127
    v_mul_f32 v131, v131, v123
    s_waitcnt vmcnt(12)
    s_barrier
    s_add_u32 s97, s98, s0
    s_lshr_b64 s[0:1], s[0:1], 4
    s_and_b32 s97, s97, 15
    s_lshr_b32 s99, s97, 3
    s_xor_b32 s97, s97, s99
    s_add_u32 m0, s87, 18432
    s_lshl_b32 s97, s97, 7
    buffer_load_dwordx4 v240, s[28:31], s97 offen offset:0  lds
    v_mul_f32 v132, v132, v124
    v_mul_f32 v133, v133, v125
    v_mul_f32 v134, v134, v126
    v_cvt_pk_bf16_f32 v110, v134, v133
    v_cvt_pk_bf16_f32 v111, v132, v131
    buffer_load_dwordx4 v241, s[28:31], s97 offen offset:1024  lds
    v_lshlrev_b32 v116, 16, v43
    v_lshlrev_b32 v117, 16, v47
    v_lshlrev_b32 v118, 16, v51
    v_lshlrev_b32 v119, 16, v55
    v_lshlrev_b32 v120, 16, v59
    buffer_load_dwordx4 v242, s[28:31], s97 offen offset:2048  lds
    v_lshlrev_b32 v121, 16, v63
    v_lshlrev_b32 v122, 16, v67
    v_lshlrev_b32 v127, 16, v96
    v_and_b32 v128, 0xffff0000, v96
    v_lshlrev_b32 v129, 16, v97
    buffer_load_dwordx4 v243, s[28:31], s97 offen offset:3072  lds
    v_and_b32 v130, 0xffff0000, v97
    v_lshlrev_b32 v123, 16, v71
    v_lshlrev_b32 v124, 16, v75
    v_lshlrev_b32 v125, 16, v79
    v_lshlrev_b32 v126, 16, v83
    s_add_u32 m0, s88, 18432
    s_mov_b64 exec, 0xffffffff
    buffer_load_dwordx4 v3, s[28:31], s97 offen offset:0  lds
    s_mov_b64 exec, -1
    v_mul_f32 v131, v116, v130
    v_mul_f32 v132, v117, v130
    v_mul_f32 v133, v118, v130
    v_mul_f32 v134, v119, v130
    v_fmac_f32 v131, v117, v129
    s_mul_i32 s16, s97, 3072
    s_add_u32 m0, s60, 24576
    s_add_u32 s99, s16, s62
    buffer_load_dwordx4 v244, s[32:35], s99 offen offset:0  lds
    v_fmac_f32 v132, v118, v129
    v_fmac_f32 v133, v119, v129
    v_fmac_f32 v134, v120, v129
    v_fmac_f32 v131, v118, v128
    v_fmac_f32 v132, v119, v128
    buffer_load_dwordx4 v245, s[32:35], s99 offen offset:1024  lds
    v_fmac_f32 v133, v120, v128
    v_fmac_f32 v134, v121, v128
    v_fmac_f32 v131, v119, v127
    v_fmac_f32 v132, v120, v127
    v_fmac_f32 v133, v121, v127
    buffer_load_dwordx4 v246, s[32:35], s99 offen offset:2048  lds
    v_fmac_f32 v134, v122, v127
    v_mul_f32 v131, v131, v123
    v_mul_f32 v132, v132, v124
    v_mul_f32 v133, v133, v125
    v_mul_f32 v134, v134, v126
    s_add_u32 m0, s61, 36864
    s_add_u32 s16, s16, s63
    buffer_load_dwordx4 v244, s[32:35], s16 offen offset:0  lds
    v_cvt_pk_bf16_f32 v108, v134, v133
    v_cvt_pk_bf16_f32 v109, v132, v131
    s_nop 0
    v_permlane32_swap_b32 v110, v108
    v_permlane32_swap_b32 v111, v109
    s_mov_b32 s89, 32768
    buffer_store_dwordx4 v[108:111], v12, s[52:55], s89 offen sc1
    buffer_load_dwordx4 v245, s[32:35], s16 offen offset:1024  lds
    v_and_b32 v116, 0xffff0000, v41
    v_and_b32 v117, 0xffff0000, v45
    v_and_b32 v118, 0xffff0000, v49
    v_and_b32 v119, 0xffff0000, v53
    v_and_b32 v120, 0xffff0000, v57
    buffer_load_dwordx4 v246, s[32:35], s16 offen offset:2048  lds
    v_and_b32 v121, 0xffff0000, v61
    v_and_b32 v122, 0xffff0000, v65
    v_lshlrev_b32 v127, 16, v90
    v_and_b32 v128, 0xffff0000, v90
    v_lshlrev_b32 v129, 16, v91
    v_and_b32 v130, 0xffff0000, v91
    v_and_b32 v123, 0xffff0000, v69
    v_and_b32 v124, 0xffff0000, v73
    v_and_b32 v125, 0xffff0000, v77
    v_and_b32 v126, 0xffff0000, v81
    v_mul_f32 v131, v116, v130
    v_mul_f32 v132, v117, v130
    s_waitcnt vmcnt(12)
    s_barrier
    s_add_u32 s97, s98, s0
    s_lshr_b64 s[0:1], s[0:1], 4
    s_and_b32 s97, s97, 15
    s_lshr_b32 s99, s97, 3
    s_xor_b32 s97, s97, s99
    s_add_u32 m0, s87, 36864
    s_lshl_b32 s97, s97, 7
    buffer_load_dwordx4 v240, s[28:31], s97 offen offset:0  lds
    v_mul_f32 v133, v118, v130
    v_mul_f32 v134, v119, v130
    v_fmac_f32 v131, v117, v129
    v_fmac_f32 v132, v118, v129
    v_fmac_f32 v133, v119, v129
    buffer_load_dwordx4 v241, s[28:31], s97 offen offset:1024  lds
    v_fmac_f32 v134, v120, v129
    v_fmac_f32 v131, v118, v128
    v_fmac_f32 v132, v119, v128
    v_fmac_f32 v133, v120, v128
    v_fmac_f32 v134, v121, v128
    buffer_load_dwordx4 v242, s[28:31], s97 offen offset:2048  lds
    v_fmac_f32 v131, v119, v127
    v_fmac_f32 v132, v120, v127
    v_fmac_f32 v133, v121, v127
    v_fmac_f32 v134, v122, v127
    v_mul_f32 v131, v131, v123
    buffer_load_dwordx4 v243, s[28:31], s97 offen offset:3072  lds
    v_mul_f32 v132, v132, v124
    v_mul_f32 v133, v133, v125
    v_mul_f32 v134, v134, v126
    v_cvt_pk_bf16_f32 v114, v134, v133
    v_cvt_pk_bf16_f32 v115, v132, v131
    s_add_u32 m0, s88, 36864
    s_mov_b64 exec, 0xffffffff
    buffer_load_dwordx4 v3, s[28:31], s97 offen offset:0  lds
    s_mov_b64 exec, -1
    v_and_b32 v116, 0xffff0000, v43
    v_and_b32 v117, 0xffff0000, v47
    v_and_b32 v118, 0xffff0000, v51
    v_and_b32 v119, 0xffff0000, v55
    v_and_b32 v120, 0xffff0000, v59
    s_mul_i32 s16, s97, 3072
    s_add_u32 m0, s60, 49152
    s_add_u32 s99, s16, s62
    buffer_load_dwordx4 v244, s[32:35], s99 offen offset:0  lds
    v_and_b32 v121, 0xffff0000, v63
    v_and_b32 v122, 0xffff0000, v67
    v_lshlrev_b32 v127, 16, v98
    v_and_b32 v128, 0xffff0000, v98
    v_lshlrev_b32 v129, 16, v99
    buffer_load_dwordx4 v245, s[32:35], s99 offen offset:1024  lds
    v_and_b32 v130, 0xffff0000, v99
    v_and_b32 v123, 0xffff0000, v71
    v_and_b32 v124, 0xffff0000, v75
    v_and_b32 v125, 0xffff0000, v79
    v_and_b32 v126, 0xffff0000, v83
    buffer_load_dwordx4 v246, s[32:35], s99 offen offset:2048  lds
    v_mul_f32 v131, v116, v130
    v_mul_f32 v132, v117, v130
    v_mul_f32 v133, v118, v130
    v_mul_f32 v134, v119, v130
    v_fmac_f32 v131, v117, v129
    s_add_u32 m0, s61, 61440
    s_add_u32 s16, s16, s63
    buffer_load_dwordx4 v244, s[32:35], s16 offen offset:0  lds
    v_fmac_f32 v132, v118, v129
    v_fmac_f32 v133, v119, v129
    v_fmac_f32 v134, v120, v129
    v_fmac_f32 v131, v118, v128
    v_fmac_f32 v132, v119, v128
    buffer_load_dwordx4 v245, s[32:35], s16 offen offset:1024  lds
    v_fmac_f32 v133, v120, v128
    v_fmac_f32 v134, v121, v128
    v_fmac_f32 v131, v119, v127
    v_fmac_f32 v132, v120, v127
    v_fmac_f32 v133, v121, v127
    buffer_load_dwordx4 v246, s[32:35], s16 offen offset:2048  lds
    v_fmac_f32 v134, v122, v127
    v_mul_f32 v131, v131, v123
    v_mul_f32 v132, v132, v124
    v_mul_f32 v133, v133, v125
    v_mul_f32 v134, v134, v126
    v_cvt_pk_bf16_f32 v112, v134, v133
    v_cvt_pk_bf16_f32 v113, v132, v131
    s_nop 0
    v_permlane32_swap_b32 v114, v112
    v_permlane32_swap_b32 v115, v113
    s_mov_b32 s89, 49152
    buffer_store_dwordx4 v[112:115], v12, s[52:55], s89 offen sc1
    s_waitcnt vmcnt(12)
    s_barrier
    s_add_u32 m0, s94, 32
    s_lshl_b32 s89, s90, 12
    buffer_load_dwordx4 v15, s[48:51], s89 offen offset:0 nt lds
    s_add_u32 m0, s94, 32
    s_lshl_b32 s89, s90, 12
    buffer_load_dwordx4 v15, s[48:51], s89 offen offset:1024 nt lds
    s_add_u32 m0, s94, 32
    s_lshl_b32 s89, s90, 12
    buffer_load_dwordx4 v15, s[48:51], s89 offen offset:2048 nt lds
    s_add_u32 m0, s94, 32
    s_lshl_b32 s89, s90, 12
    buffer_load_dwordx4 v15, s[48:51], s89 offen offset:3072 nt lds
    s_add_u32 s97, s98, s0
    s_lshr_b64 s[0:1], s[0:1], 4
    s_and_b32 s97, s97, 15
    s_lshr_b32 s99, s97, 3
    s_xor_b32 s97, s97, s99
    s_add_u32 m0, s87, 0
    s_lshl_b32 s97, s97, 7
    buffer_load_dwordx4 v240, s[28:31], s97 offen offset:0  lds
    buffer_load_dwordx4 v241, s[28:31], s97 offen offset:1024  lds
    buffer_load_dwordx4 v242, s[28:31], s97 offen offset:2048  lds
    buffer_load_dwordx4 v243, s[28:31], s97 offen offset:3072  lds
    s_add_u32 m0, s88, 0
    s_mov_b64 exec, 0xffffffff
    buffer_load_dwordx4 v3, s[28:31], s97 offen offset:0  lds
    s_mov_b64 exec, -1
    s_mul_i32 s16, s97, 3072
    s_add_u32 m0, s60, 0
    s_add_u32 s99, s16, s62
    buffer_load_dwordx4 v244, s[32:35], s99 offen offset:0  lds
    buffer_load_dwordx4 v245, s[32:35], s99 offen offset:1024  lds
    buffer_load_dwordx4 v246, s[32:35], s99 offen offset:2048  lds
    s_add_u32 m0, s61, 12288
    s_add_u32 s16, s16, s63
    buffer_load_dwordx4 v244, s[32:35], s16 offen offset:0  lds
    buffer_load_dwordx4 v245, s[32:35], s16 offen offset:1024  lds
    buffer_load_dwordx4 v246, s[32:35], s16 offen offset:2048  lds
    s_waitcnt vmcnt(16)
    s_barrier
    s_add_u32 s97, s98, s0
    s_lshr_b64 s[0:1], s[0:1], 4
    s_and_b32 s97, s97, 15
    s_lshr_b32 s99, s97, 3
    s_xor_b32 s97, s97, s99
    s_add_u32 m0, s87, 18432
    s_lshl_b32 s97, s97, 7
    buffer_load_dwordx4 v240, s[28:31], s97 offen offset:0  lds
    buffer_load_dwordx4 v241, s[28:31], s97 offen offset:1024  lds
    buffer_load_dwordx4 v242, s[28:31], s97 offen offset:2048  lds
    buffer_load_dwordx4 v243, s[28:31], s97 offen offset:3072  lds
    s_add_u32 m0, s88, 18432
    s_mov_b64 exec, 0xffffffff
    buffer_load_dwordx4 v3, s[28:31], s97 offen offset:0  lds
    s_mov_b64 exec, -1
    s_mul_i32 s16, s97, 3072
    s_add_u32 m0, s60, 24576
    s_add_u32 s99, s16, s62
    buffer_load_dwordx4 v244, s[32:35], s99 offen offset:0  lds
    buffer_load_dwordx4 v245, s[32:35], s99 offen offset:1024  lds
    buffer_load_dwordx4 v246, s[32:35], s99 offen offset:2048  lds
    s_add_u32 m0, s61, 36864
    s_add_u32 s16, s16, s63
    buffer_load_dwordx4 v244, s[32:35], s16 offen offset:0  lds
    buffer_load_dwordx4 v245, s[32:35], s16 offen offset:1024  lds
    buffer_load_dwordx4 v246, s[32:35], s16 offen offset:2048  lds
    s_waitcnt vmcnt(11)
    s_barrier
    s_add_u32 s97, s98, s0
    s_lshr_b64 s[0:1], s[0:1], 4
    s_and_b32 s97, s97, 15
    s_lshr_b32 s99, s97, 3
    s_xor_b32 s97, s97, s99
    s_add_u32 m0, s87, 36864
    s_lshl_b32 s97, s97, 7
    buffer_load_dwordx4 v240, s[28:31], s97 offen offset:0  lds
    v_add_u32 v5, s94, v15
    ds_read_b128 v[140:143], v5 offset:32
    ds_read_b32 v156, v5 offset:48
    ds_read_b128 v[144:147], v5 offset:1056
    buffer_load_dwordx4 v241, s[28:31], s97 offen offset:1024  lds
    ds_read_b32 v157, v5 offset:1072
    ds_read_b128 v[148:151], v5 offset:2080
    ds_read_b32 v158, v5 offset:2096
    ds_read_b128 v[152:155], v5 offset:3104
    buffer_load_dwordx4 v242, s[28:31], s97 offen offset:2048  lds
    ds_read_b32 v159, v5 offset:3120
    v_lshrrev_b32 v6, 3, v0
    v_mul_u32_u24 v6, 4160, v6
    buffer_load_dwordx4 v243, s[28:31], s97 offen offset:3072  lds
    v_and_b32 v7, 7, v0
    v_lshl_add_u32 v6, v7, 2, v6
    v_add_u32 v6, s94, v6
    v_mov_b32 v7, 0
    s_add_u32 m0, s88, 36864
    s_mov_b64 exec, 0xffffffff
    buffer_load_dwordx4 v3, s[28:31], s97 offen offset:0  lds
    s_mov_b64 exec, -1
    s_waitcnt lgkmcnt(0)
    v_readfirstlane_b32 s93, v140
    s_nop 0
    s_lshl_b32 s93, s93, 16
    s_nop 1
    v_writelane_b32 v7, s93, 15
    s_mul_i32 s16, s97, 3072
    s_add_u32 m0, s60, 49152
    s_add_u32 s99, s16, s62
    buffer_load_dwordx4 v244, s[32:35], s99 offen offset:0  lds
    v_alignbit_b32 v140, v141, v140, 16
    v_alignbit_b32 v141, v142, v141, 16
    v_alignbit_b32 v142, v143, v142, 16
    buffer_load_dwordx4 v245, s[32:35], s99 offen offset:1024  lds
    v_alignbit_b32 v143, v156, v143, 16
    v_alignbit_b32 v144, v145, v144, 16
    v_alignbit_b32 v145, v146, v145, 16
    v_alignbit_b32 v146, v147, v146, 16
    buffer_load_dwordx4 v246, s[32:35], s99 offen offset:2048  lds
    v_alignbit_b32 v147, v157, v147, 16
    v_alignbit_b32 v148, v149, v148, 16
    v_alignbit_b32 v149, v150, v149, 16
    v_alignbit_b32 v150, v151, v150, 16
    s_add_u32 m0, s61, 61440
    s_add_u32 s16, s16, s63
    buffer_load_dwordx4 v244, s[32:35], s16 offen offset:0  lds
    v_alignbit_b32 v151, v158, v151, 16
    v_alignbit_b32 v152, v153, v152, 16
    v_alignbit_b32 v153, v154, v153, 16
    buffer_load_dwordx4 v245, s[32:35], s16 offen offset:1024  lds
    v_alignbit_b32 v154, v155, v154, 16
    v_alignbit_b32 v155, v159, v155, 16
    v_lshlrev_b32 v8, 3, v0
    s_add_u32 s78, s88, 18432
    buffer_load_dwordx4 v246, s[32:35], s16 offen offset:2048  lds
    v_add_u32 v8, s78, v8
    v_mov_b32 v156, 0
    v_mov_b32 v157, 0
    s_waitcnt vmcnt(11)
    s_barrier
    s_add_u32 s97, s98, s0
    s_lshr_b64 s[0:1], s[0:1], 4
    s_and_b32 s97, s97, 15
    s_lshr_b32 s99, s97, 3
    s_xor_b32 s97, s97, s99
    s_add_u32 m0, s87, 0
    s_lshl_b32 s97, s97, 7
    buffer_load_dwordx4 v240, s[28:31], s97 offen offset:0  lds
    buffer_load_dwordx4 v241, s[28:31], s97 offen offset:1024  lds
    buffer_load_dwordx4 v242, s[28:31], s97 offen offset:2048  lds
    buffer_load_dwordx4 v243, s[28:31], s97 offen offset:3072  lds
    s_add_u32 m0, s88, 0
    s_mov_b64 exec, 0xffffffff
    buffer_load_dwordx4 v3, s[28:31], s97 offen offset:0  lds
    s_mov_b64 exec, -1
    s_mul_i32 s16, s97, 3072
    s_add_u32 m0, s60, 0
    s_add_u32 s99, s16, s62
    buffer_load_dwordx4 v244, s[32:35], s99 offen offset:0  lds
    buffer_load_dwordx4 v245, s[32:35], s99 offen offset:1024  lds
    buffer_load_dwordx4 v246, s[32:35], s99 offen offset:2048  lds
    s_add_u32 m0, s61, 12288
    s_add_u32 s16, s16, s63
    buffer_load_dwordx4 v244, s[32:35], s16 offen offset:0  lds
    buffer_load_dwordx4 v245, s[32:35], s16 offen offset:1024  lds
    buffer_load_dwordx4 v246, s[32:35], s16 offen offset:2048  lds
    s_mov_b64 exec, 0xff
    buffer_load_dword v136, v33, s[68:71], 0 offen sc1
    buffer_load_dword v137, v34, s[52:55], 0 offen sc1
    s_mov_b64 exec, -1
    s_waitcnt vmcnt(13)
    s_barrier
    s_waitcnt vmcnt(0)
    s_branch LA_j
LA_c2:
    s_waitcnt vmcnt(7)
    s_barrier
    buffer_load_dwordx4 v246, s[32:35], s99 offen offset:2048  lds
    s_add_u32 m0, s61, 36864
    s_add_u32 s16, s16, s63
    buffer_load_dwordx4 v244, s[32:35], s16 offen offset:0  lds
    buffer_load_dwordx4 v245, s[32:35], s16 offen offset:1024  lds
    buffer_load_dwordx4 v246, s[32:35], s16 offen offset:2048  lds
    s_add_u32 s97, s98, s0
    s_lshr_b64 s[0:1], s[0:1], 4
    s_and_b32 s97, s97, 15
    s_lshr_b32 s99, s97, 3
    s_xor_b32 s97, s97, s99
    s_add_u32 m0, s87, 36864
    s_lshl_b32 s97, s97, 7
    buffer_load_dwordx4 v240, s[28:31], s97 offen offset:0  lds
    buffer_load_dwordx4 v241, s[28:31], s97 offen offset:1024  lds
    buffer_load_dwordx4 v242, s[28:31], s97 offen offset:2048  lds
    buffer_load_dwordx4 v243, s[28:31], s97 offen offset:3072  lds
    s_add_u32 m0, s88, 36864
    s_mov_b64 exec, 0xffffffff
    buffer_load_dwordx4 v3, s[28:31], s97 offen offset:0  lds
    s_mov_b64 exec, -1
    s_mul_i32 s16, s97, 3072
    s_add_u32 m0, s60, 49152
    s_add_u32 s99, s16, s62
    buffer_load_dwordx4 v244, s[32:35], s99 offen offset:0  lds
    buffer_load_dwordx4 v245, s[32:35], s99 offen offset:1024  lds
    buffer_load_dwordx4 v246, s[32:35], s99 offen offset:2048  lds
    s_add_u32 m0, s61, 61440
    s_add_u32 s16, s16, s63
    buffer_load_dwordx4 v244, s[32:35], s16 offen offset:0  lds
    buffer_load_dwordx4 v245, s[32:35], s16 offen offset:1024  lds
    buffer_load_dwordx4 v246, s[32:35], s16 offen offset:2048  lds
    s_waitcnt vmcnt(11)
    s_barrier
    s_add_u32 s97, s98, s0
    s_lshr_b64 s[0:1], s[0:1], 4
    s_and_b32 s97, s97, 15
    s_lshr_b32 s99, s97, 3
    s_xor_b32 s97, s97, s99
    s_add_u32 m0, s87, 0
    s_lshl_b32 s97, s97, 7
    buffer_load_dwordx4 v240, s[28:31], s97 offen offset:0  lds
    s_mov_b32 s68, s24
    s_mov_b32 s69, s25
    s_mov_b32 s70, 0x100
    s_mov_b32 s71, 0x20000
    v_lshrrev_b32 v6, 5, v0
    buffer_load_dwordx4 v241, s[28:31], s97 offen offset:1024  lds
    v_and_b32 v7, 3, v0
    s_lshr_b32 s78, s90, 1
    s_lshl_b32 s78, s78, 2
    s_load_dword s92, s[14:15], s78
    v_bfe_u32 v5, v0, 2, 2
    buffer_load_dwordx4 v242, s[28:31], s97 offen offset:2048  lds
    v_lshlrev_b32 v5, 1, v5
    v_lshl_add_u32 v5, v6, 3, v5
    v_bfe_u32 v8, v0, 4, 1
    v_add_u32 v5, v5, v8
    s_and_b32 s78, s3, 1
    buffer_load_dwordx4 v243, s[28:31], s97 offen offset:3072  lds
    s_lshl_b32 s78, s78, 1
    v_add_u32 v8, s78, v6
    v_xor_b32 v8, v8, v7
    v_lshlrev_b32 v8, 4, v8
    v_lshl_add_u32 v5, v5, 6, v8
    s_add_u32 m0, s88, 0
    s_mov_b64 exec, 0xffffffff
    buffer_load_dwordx4 v3, s[28:31], s97 offen offset:0  lds
    s_mov_b64 exec, -1
    v_add_u32 v14, s86, v5
    v_mov_b32 v18, 162304
    v_mov_b32 v19, 1
    v_and_b32 v5, 3, v0
    s_lshl_b32 s78, s74, 4
    s_mul_i32 s16, s97, 3072
    s_add_u32 m0, s60, 0
    s_add_u32 s99, s16, s62
    buffer_load_dwordx4 v244, s[32:35], s99 offen offset:0  lds
    s_add_u32 s78, s78, s3
    v_lshl_add_u32 v6, v5, 2, s78
    s_lshr_b32 s78, s76, 3
    s_lshl_b32 s79, s3, 1
    s_add_u32 s78, s78, s79
    buffer_load_dwordx4 v245, s[32:35], s99 offen offset:1024  lds
    s_xor_b32 s78, s78, 0
    s_lshl_b32 s78, s78, 5
    s_and_b32 s79, s76, 7
    s_add_u32 s78, s78, s79
    v_lshl_add_u32 v7, v5, 3, s78
    buffer_load_dwordx4 v246, s[32:35], s99 offen offset:2048  lds
    v_and_b32 v8, 4, v0
    v_cmp_eq_u32 vcc, 0, v8
    s_nop 1
    v_cndmask_b32 v6, v7, v6, vcc
    v_and_b32 v33, 0xf0, v6
    v_lshlrev_b32 v34, 8, v6
    s_add_u32 m0, s61, 12288
    s_add_u32 s16, s16, s63
    buffer_load_dwordx4 v244, s[32:35], s16 offen offset:0  lds
    v_add_u32 v34, 12582912, v34
    v_and_b32 v5, 15, v0
    v_lshrrev_b32 v6, 4, v0
    v_add_u32 v7, 9, v5
    v_and_b32 v8, 1, v7
    buffer_load_dwordx4 v245, s[32:35], s16 offen offset:1024  lds
    v_mul_u32_u24 v8, 4160, v8
    v_lshrrev_b32 v7, 1, v7
    v_lshl_add_u32 v8, v7, 2, v8
    v_lshlrev_b32 v7, 4, v6
    v_sub_u32 v8, v8, v7
    buffer_load_dwordx4 v246, s[32:35], s16 offen offset:2048  lds
    s_add_u32 s78, s94, 32
    v_add_u32 v21, s78, v8
    v_add_u32 v22, 1024, v21
    v_add_u32 v23, 2048, v21
    v_add_u32 v24, 3072, v21
    v_lshl_add_u32 v7, v5, 1, v6
    v_add_u32 v7, 30, v7
    v_and_b32 v8, 1, v7
    v_bfe_u32 v136, v7, 1, 2
    v_lshl_add_u32 v136, v8, 2, v136
    s_waitcnt vmcnt(11)
    s_barrier
    s_add_u32 s97, s98, s0
    s_lshr_b64 s[0:1], s[0:1], 4
    s_and_b32 s97, s97, 15
    s_lshr_b32 s99, s97, 3
    s_xor_b32 s97, s97, s99
    s_add_u32 m0, s87, 18432
    s_lshl_b32 s97, s97, 7
    buffer_load_dwordx4 v240, s[28:31], s97 offen offset:0  lds
    v_lshlrev_b32 v136, 6, v136
    v_lshrrev_b32 v7, 3, v7
    v_lshl_add_u32 v136, v7, 9, v136
    v_bitop3_b32 v8, v7, 3, s3 bitop3:0x6a
    v_lshl_add_u32 v25, v8, 4, v136
    buffer_load_dwordx4 v241, s[28:31], s97 offen offset:1024  lds
    v_add_u32 v25, 92160, v25
    v_subrev_u32 v7, 1, v7
    v_bitop3_b32 v8, v7, 3, s3 bitop3:0x6a
    v_lshl_add_u32 v27, v8, 4, v136
    v_add_u32 v27, 91648, v27
    buffer_load_dwordx4 v242, s[28:31], s97 offen offset:2048  lds
    v_subrev_u32 v7, 1, v7
    v_bitop3_b32 v8, v7, 3, s3 bitop3:0x6a
    v_lshl_add_u32 v29, v8, 4, v136
    v_add_u32 v29, 91136, v29
    v_subrev_u32 v7, 1, v7
    buffer_load_dwordx4 v243, s[28:31], s97 offen offset:3072  lds
    v_bitop3_b32 v8, v7, 3, s3 bitop3:0x6a
    v_lshl_add_u32 v31, v8, 4, v136
    v_add_u32 v31, 90624, v31
    v_lshl_add_u32 v7, v5, 1, v6
    v_add_u32 v7, 26, v7
    s_add_u32 m0, s88, 18432
    s_mov_b64 exec, 0xffffffff
    buffer_load_dwordx4 v3, s[28:31], s97 offen offset:0  lds
    s_mov_b64 exec, -1
    v_and_b32 v8, 1, v7
    v_bfe_u32 v136, v7, 1, 2
    v_lshl_add_u32 v136, v8, 2, v136
    v_lshlrev_b32 v136, 6, v136
    v_lshrrev_b32 v7, 3, v7
    s_mul_i32 s16, s97, 3072
    s_add_u32 m0, s60, 24576
    s_add_u32 s99, s16, s62
    buffer_load_dwordx4 v244, s[32:35], s99 offen offset:0  lds
    v_lshl_add_u32 v136, v7, 9, v136
    v_bitop3_b32 v8, v7, 3, s3 bitop3:0x6a
    v_lshl_add_u32 v26, v8, 4, v136
    v_add_u32 v26, 92160, v26
    v_subrev_u32 v7, 1, v7
    buffer_load_dwordx4 v245, s[32:35], s99 offen offset:1024  lds
    v_bitop3_b32 v8, v7, 3, s3 bitop3:0x6a
    v_lshl_add_u32 v28, v8, 4, v136
    v_add_u32 v28, 91648, v28
    v_subrev_u32 v7, 1, v7
    v_bitop3_b32 v8, v7, 3, s3 bitop3:0x6a
    buffer_load_dwordx4 v246, s[32:35], s99 offen offset:2048  lds
    v_lshl_add_u32 v30, v8, 4, v136
    v_add_u32 v30, 91136, v30
    v_subrev_u32 v7, 1, v7
    v_bitop3_b32 v8, v7, 3, s3 bitop3:0x6a
    v_lshl_add_u32 v32, v8, 4, v136
    s_add_u32 m0, s61, 36864
    s_add_u32 s16, s16, s63
    buffer_load_dwordx4 v244, s[32:35], s16 offen offset:0  lds
    v_add_u32 v32, 90624, v32
    v_lshrrev_b32 v7, 1, v6
    v_lshl_add_u32 v7, v5, 1, v7
    v_add_u32 v7, 32, v7
    v_and_b32 v8, 1, v7
    buffer_load_dwordx4 v245, s[32:35], s16 offen offset:1024  lds
    v_bfe_u32 v136, v7, 1, 2
    v_lshl_add_u32 v136, v8, 2, v136
    v_lshlrev_b32 v136, 6, v136
    v_lshrrev_b32 v7, 3, v7
    v_lshl_add_u32 v136, v7, 9, v136
    buffer_load_dwordx4 v246, s[32:35], s16 offen offset:2048  lds
    v_bitop3_b32 v8, v7, 3, s3 bitop3:0x6a
    v_lshl_add_u32 v20, v8, 4, v136
    v_add_u32 v20, 92160, v20
    v_and_b32 v8, 1, v6
    v_xor_b32 v8, 1, v8
    v_lshl_add_u32 v20, v8, 3, v20
    s_waitcnt lgkmcnt(0)
    s_and_b32 s78, s92, 0xffff0000
    s_lshl_b32 s92, s92, 16
    s_bitcmp1_b32 s90, 0
    s_cselect_b32 s92, s78, s92
    s_waitcnt vmcnt(11)
    s_barrier
    s_add_u32 m0, s86, 129536
    s_mov_b32 s89, 0
    buffer_load_dwordx4 v10, s[36:39], s89 offen nt lds
    v_lshlrev_b32 v7, 3, v6
    s_add_u32 m0, s86, 145920
    s_mov_b32 s89, 0
    buffer_load_dwordx4 v10, s[40:43], s89 offen nt lds
    v_sub_u32 v7, v7, v5
    s_add_u32 m0, s86, 133632
    s_mov_b32 s89, 65536
    buffer_load_dwordx4 v10, s[36:39], s89 offen nt lds
    v_subrev_u32 v7, 9, v7
    s_add_u32 m0, s86, 150016
    s_mov_b32 s89, 65536
    buffer_load_dwordx4 v10, s[40:43], s89 offen nt lds
    v_and_b32 v8, 1, v7
    s_add_u32 m0, s86, 137728
    s_mov_b32 s89, 131072
    buffer_load_dwordx4 v10, s[36:39], s89 offen nt lds
    v_xor_b32 v8, 1, v8
    s_add_u32 m0, s86, 154112
    s_mov_b32 s89, 131072
    buffer_load_dwordx4 v10, s[40:43], s89 offen nt lds
    v_lshlrev_b32 v8, 4, v8
    s_add_u32 m0, s86, 141824
    s_mov_b32 s89, 196608
    buffer_load_dwordx4 v10, s[36:39], s89 offen nt lds
    v_lshrrev_b32 v8, v8, s92
    s_add_u32 m0, s86, 158208
    s_mov_b32 s89, 196608
    buffer_load_dwordx4 v10, s[40:43], s89 offen nt lds
    v_ashrrev_i32 v7, 1, v7
    s_mov_b64 exec, 0xff
    s_lshl_b32 s82, s3, 7
    s_add_u32 m0, s82, 129024
    s_mov_b32 s89, 0
    buffer_load_dwordx4 v11, s[36:39], s89 offen nt lds
    s_lshl_b32 s83, s74, 9
    s_add_u32 s83, s83, s82
    s_and_b32 s89, s3, 2
    s_lshl_b32 s89, s89, 3
    s_add_u32 s82, s82, s89
    s_add_u32 m0, s82, 162816
    s_add_u32 s89, s83, 0
    buffer_load_dwordx4 v15, s[44:47], s89 offen  lds
    s_mov_b64 exec, -1
    v_cmp_eq_u32 vcc, 0, v7
    s_add_u32 s97, s98, s0
    s_lshr_b64 s[0:1], s[0:1], 4
    s_and_b32 s97, s97, 15
    s_lshr_b32 s99, s97, 3
    s_xor_b32 s97, s97, s99
    s_add_u32 m0, s87, 36864
    s_lshl_b32 s97, s97, 7
    buffer_load_dwordx4 v240, s[28:31], s97 offen offset:0  lds
    v_cndmask_b32 v236, 0, v8, vcc
    buffer_load_dwordx4 v241, s[28:31], s97 offen offset:1024  lds
    v_cmp_eq_u32 vcc, 1, v7
    buffer_load_dwordx4 v242, s[28:31], s97 offen offset:2048  lds
    s_nop 0
    v_cndmask_b32 v237, 0, v8, vcc
    buffer_load_dwordx4 v243, s[28:31], s97 offen offset:3072  lds
    v_cmp_eq_u32 vcc, 2, v7
    s_add_u32 m0, s88, 36864
    s_mov_b64 exec, 0xffffffff
    buffer_load_dwordx4 v3, s[28:31], s97 offen offset:0  lds
    s_mov_b64 exec, -1
    v_cndmask_b32 v238, 0, v8, vcc
    s_mul_i32 s16, s97, 3072
    s_add_u32 m0, s60, 49152
    s_add_u32 s99, s16, s62
    buffer_load_dwordx4 v244, s[32:35], s99 offen offset:0  lds
    v_cmp_eq_u32 vcc, 3, v7
    buffer_load_dwordx4 v245, s[32:35], s99 offen offset:1024  lds
    s_nop 0
    v_cndmask_b32 v239, 0, v8, vcc
    s_waitcnt vmcnt(17)
    s_barrier
    buffer_load_dwordx4 v246, s[32:35], s99 offen offset:2048  lds
    s_add_u32 m0, s61, 61440
    s_add_u32 s16, s16, s63
    buffer_load_dwordx4 v244, s[32:35], s16 offen offset:0  lds
    buffer_load_dwordx4 v245, s[32:35], s16 offen offset:1024  lds
    buffer_load_dwordx4 v246, s[32:35], s16 offen offset:2048  lds
    s_add_u32 s97, s98, s0
    s_lshr_b64 s[0:1], s[0:1], 4
    s_and_b32 s97, s97, 15
    s_lshr_b32 s99, s97, 3
    s_xor_b32 s97, s97, s99
    s_add_u32 m0, s87, 0
    s_lshl_b32 s97, s97, 7
    buffer_load_dwordx4 v240, s[28:31], s97 offen offset:0  lds
    buffer_load_dwordx4 v241, s[28:31], s97 offen offset:1024  lds
    buffer_load_dwordx4 v242, s[28:31], s97 offen offset:2048  lds
    buffer_load_dwordx4 v243, s[28:31], s97 offen offset:3072  lds
    s_add_u32 m0, s88, 0
    s_mov_b64 exec, 0xffffffff
    buffer_load_dwordx4 v3, s[28:31], s97 offen offset:0  lds
    s_mov_b64 exec, -1
    s_mul_i32 s16, s97, 3072
    s_add_u32 m0, s60, 0
    s_add_u32 s99, s16, s62
    buffer_load_dwordx4 v244, s[32:35], s99 offen offset:0  lds
    buffer_load_dwordx4 v245, s[32:35], s99 offen offset:1024  lds
    buffer_load_dwordx4 v246, s[32:35], s99 offen offset:2048  lds
    s_add_u32 m0, s61, 12288
    s_add_u32 s16, s16, s63
    buffer_load_dwordx4 v244, s[32:35], s16 offen offset:0  lds
    buffer_load_dwordx4 v245, s[32:35], s16 offen offset:1024  lds
    buffer_load_dwordx4 v246, s[32:35], s16 offen offset:2048  lds
    s_waitcnt vmcnt(11)
    s_barrier
    buffer_load_dword v230, v229, s[64:67], 0 offen
    ds_read_b128 v[84:87], v35 offset:0
    ds_read_b128 v[88:91], v35 offset:16
    s_add_u32 s97, s98, s0
    s_lshr_b64 s[0:1], s[0:1], 4
    s_and_b32 s97, s97, 15
    s_lshr_b32 s99, s97, 3
    s_xor_b32 s97, s97, s99
    s_add_u32 m0, s87, 18432
    s_lshl_b32 s97, s97, 7
    buffer_load_dwordx4 v240, s[28:31], s97 offen offset:0  lds
    ds_read_b128 v[92:95], v35 offset:32
    buffer_load_dwordx4 v241, s[28:31], s97 offen offset:1024  lds
    ds_read_b128 v[96:99], v35 offset:48
    buffer_load_dwordx4 v242, s[28:31], s97 offen offset:2048  lds
    ds_read_b128 v[40:43], v233 offset:0
    buffer_load_dwordx4 v243, s[28:31], s97 offen offset:3072  lds
    ds_read_b128 v[44:47], v232 offset:256
    ds_read_b128 v[48:51], v233 offset:256
    s_add_u32 m0, s88, 18432
    s_mov_b64 exec, 0xffffffff
    buffer_load_dwordx4 v3, s[28:31], s97 offen offset:0  lds
    s_mov_b64 exec, -1
    ds_read_b128 v[52:55], v16 offset:512
    s_mul_i32 s16, s97, 3072
    s_add_u32 m0, s60, 24576
    s_add_u32 s99, s16, s62
    buffer_load_dwordx4 v244, s[32:35], s99 offen offset:0  lds
    ds_read_b128 v[56:59], v231 offset:512
    buffer_load_dwordx4 v245, s[32:35], s99 offen offset:1024  lds
    ds_read_b128 v[60:63], v16 offset:768
    buffer_load_dwordx4 v246, s[32:35], s99 offen offset:2048  lds
    ds_read_b128 v[64:67], v231 offset:768
    ds_read_b128 v[68:71], v16 offset:16896
    s_add_u32 m0, s61, 36864
    s_add_u32 s16, s16, s63
    buffer_load_dwordx4 v244, s[32:35], s16 offen offset:0  lds
    ds_read_b128 v[72:75], v231 offset:16896
    buffer_load_dwordx4 v245, s[32:35], s16 offen offset:1024  lds
    ds_read_b128 v[76:79], v16 offset:17152
    buffer_load_dwordx4 v246, s[32:35], s16 offen offset:2048  lds
    ds_read_b128 v[80:83], v231 offset:17152
    s_waitcnt vmcnt(12)
    s_waitcnt lgkmcnt(0)
    s_barrier
    s_add_u32 s97, s98, s0
    s_lshr_b64 s[0:1], s[0:1], 4
    s_and_b32 s97, s97, 15
    s_lshr_b32 s99, s97, 3
    s_xor_b32 s97, s97, s99
    s_add_u32 m0, s87, 36864
    s_lshl_b32 s97, s97, 7
    buffer_load_dwordx4 v240, s[28:31], s97 offen offset:0  lds
    v_lshlrev_b32 v116, 16, v40
    v_lshlrev_b32 v117, 16, v44
    v_lshlrev_b32 v118, 16, v48
    v_lshlrev_b32 v119, 16, v52
    v_lshlrev_b32 v120, 16, v56
    buffer_load_dwordx4 v241, s[28:31], s97 offen offset:1024  lds
    v_lshlrev_b32 v121, 16, v60
    v_lshlrev_b32 v122, 16, v64
    v_lshlrev_b32 v127, 16, v84
    v_and_b32 v128, 0xffff0000, v84
    v_lshlrev_b32 v129, 16, v85
    buffer_load_dwordx4 v242, s[28:31], s97 offen offset:2048  lds
    v_and_b32 v130, 0xffff0000, v85
    v_lshlrev_b32 v123, 16, v68
    v_lshlrev_b32 v124, 16, v72
    v_lshlrev_b32 v125, 16, v76
    v_lshlrev_b32 v126, 16, v80
    buffer_load_dwordx4 v243, s[28:31], s97 offen offset:3072  lds
    v_mul_f32 v131, v116, v130
    v_mul_f32 v132, v117, v130
    v_mul_f32 v133, v118, v130
    v_mul_f32 v134, v119, v130
    v_fmac_f32 v131, v117, v129
    s_add_u32 m0, s88, 36864
    s_mov_b64 exec, 0xffffffff
    buffer_load_dwordx4 v3, s[28:31], s97 offen offset:0  lds
    s_mov_b64 exec, -1
    v_fmac_f32 v132, v118, v129
    v_fmac_f32 v133, v119, v129
    v_fmac_f32 v134, v120, v129
    v_fmac_f32 v131, v118, v128
    v_fmac_f32 v132, v119, v128
    s_mul_i32 s16, s97, 3072
    s_add_u32 m0, s60, 49152
    s_add_u32 s99, s16, s62
    buffer_load_dwordx4 v244, s[32:35], s99 offen offset:0  lds
    v_fmac_f32 v133, v120, v128
    v_fmac_f32 v134, v121, v128
    v_fmac_f32 v131, v119, v127
    v_fmac_f32 v132, v120, v127
    v_fmac_f32 v133, v121, v127
    buffer_load_dwordx4 v245, s[32:35], s99 offen offset:1024  lds
    v_fmac_f32 v134, v122, v127
    v_mul_f32 v131, v131, v123
    v_mul_f32 v132, v132, v124
    v_mul_f32 v133, v133, v125
    v_mul_f32 v134, v134, v126
    buffer_load_dwordx4 v246, s[32:35], s99 offen offset:2048  lds
    v_cvt_pk_bf16_f32 v102, v134, v133
    v_cvt_pk_bf16_f32 v103, v132, v131
    v_lshlrev_b32 v116, 16, v42
    v_lshlrev_b32 v117, 16, v46
    v_lshlrev_b32 v118, 16, v50
    s_add_u32 m0, s61, 61440
    s_add_u32 s16, s16, s63
    buffer_load_dwordx4 v244, s[32:35], s16 offen offset:0  lds
    v_lshlrev_b32 v119, 16, v54
    v_lshlrev_b32 v120, 16, v58
    v_lshlrev_b32 v121, 16, v62
    v_lshlrev_b32 v122, 16, v66
    v_lshlrev_b32 v127, 16, v92
    buffer_load_dwordx4 v245, s[32:35], s16 offen offset:1024  lds
    v_and_b32 v128, 0xffff0000, v92
    v_lshlrev_b32 v129, 16, v93
    v_and_b32 v130, 0xffff0000, v93
    v_lshlrev_b32 v123, 16, v70
    v_lshlrev_b32 v124, 16, v74
    buffer_load_dwordx4 v246, s[32:35], s16 offen offset:2048  lds
    v_lshlrev_b32 v125, 16, v78
    v_lshlrev_b32 v126, 16, v82
    v_mul_f32 v131, v116, v130
    v_mul_f32 v132, v117, v130
    v_mul_f32 v133, v118, v130
    v_mul_f32 v134, v119, v130
    v_fmac_f32 v131, v117, v129
    v_fmac_f32 v132, v118, v129
    v_fmac_f32 v133, v119, v129
    v_fmac_f32 v134, v120, v129
    v_fmac_f32 v131, v118, v128
    v_fmac_f32 v132, v119, v128
    s_waitcnt vmcnt(11)
    s_barrier
    s_add_u32 s97, s98, s0
    s_lshr_b64 s[0:1], s[0:1], 4
    s_and_b32 s97, s97, 15
    s_lshr_b32 s99, s97, 3
    s_xor_b32 s97, s97, s99
    s_add_u32 m0, s87, 0
    s_lshl_b32 s97, s97, 7
    buffer_load_dwordx4 v240, s[28:31], s97 offen offset:0  lds
    v_fmac_f32 v133, v120, v128
    v_fmac_f32 v134, v121, v128
    v_fmac_f32 v131, v119, v127
    v_fmac_f32 v132, v120, v127
    v_fmac_f32 v133, v121, v127
    buffer_load_dwordx4 v241, s[28:31], s97 offen offset:1024  lds
    v_fmac_f32 v134, v122, v127
    v_mul_f32 v131, v131, v123
    v_mul_f32 v132, v132, v124
    v_mul_f32 v133, v133, v125
    v_mul_f32 v134, v134, v126
    buffer_load_dwordx4 v242, s[28:31], s97 offen offset:2048  lds
    v_cvt_pk_bf16_f32 v100, v134, v133
    v_cvt_pk_bf16_f32 v101, v132, v131
    s_nop 0
    v_permlane32_swap_b32 v102, v100
    v_permlane32_swap_b32 v103, v101
    s_mov_b32 s89, 0
    buffer_store_dwordx4 v[100:103], v12, s[52:55], s89 offen sc1
    buffer_load_dwordx4 v243, s[28:31], s97 offen offset:3072  lds
    v_and_b32 v116, 0xffff0000, v40
    v_and_b32 v117, 0xffff0000, v44
    v_and_b32 v118, 0xffff0000, v48
    v_and_b32 v119, 0xffff0000, v52
    v_and_b32 v120, 0xffff0000, v56
    s_add_u32 m0, s88, 0
    s_mov_b64 exec, 0xffffffff
    buffer_load_dwordx4 v3, s[28:31], s97 offen offset:0  lds
    s_mov_b64 exec, -1
    v_and_b32 v121, 0xffff0000, v60
    v_and_b32 v122, 0xffff0000, v64
    v_lshlrev_b32 v127, 16, v86
    v_and_b32 v128, 0xffff0000, v86
    v_lshlrev_b32 v129, 16, v87
    s_mul_i32 s16, s97, 3072
    s_add_u32 m0, s60, 0
    s_add_u32 s99, s16, s62
    buffer_load_dwordx4 v244, s[32:35], s99 offen offset:0  lds
    v_and_b32 v130, 0xffff0000, v87
    v_and_b32 v123, 0xffff0000, v68
    v_and_b32 v124, 0xffff0000, v72
    v_and_b32 v125, 0xffff0000, v76
    v_and_b32 v126, 0xffff0000, v80
    buffer_load_dwordx4 v245, s[32:35], s99 offen offset:1024  lds
    v_mul_f32 v131, v116, v130
    v_mul_f32 v132, v117, v130
    v_mul_f32 v133, v118, v130
    v_mul_f32 v134, v119, v130
    v_fmac_f32 v131, v117, v129
    buffer_load_dwordx4 v246, s[32:35], s99 offen offset:2048  lds
    v_fmac_f32 v132, v118, v129
    v_fmac_f32 v133, v119, v129
    v_fmac_f32 v134, v120, v129
    v_fmac_f32 v131, v118, v128
    v_fmac_f32 v132, v119, v128
    s_add_u32 m0, s61, 12288
    s_add_u32 s16, s16, s63
    buffer_load_dwordx4 v244, s[32:35], s16 offen offset:0  lds
    v_fmac_f32 v133, v120, v128
    v_fmac_f32 v134, v121, v128
    v_fmac_f32 v131, v119, v127
    v_fmac_f32 v132, v120, v127
    v_fmac_f32 v133, v121, v127
    buffer_load_dwordx4 v245, s[32:35], s16 offen offset:1024  lds
    v_fmac_f32 v134, v122, v127
    v_mul_f32 v131, v131, v123
    v_mul_f32 v132, v132, v124
    v_mul_f32 v133, v133, v125
    v_mul_f32 v134, v134, v126
    buffer_load_dwordx4 v246, s[32:35], s16 offen offset:2048  lds
    v_cvt_pk_bf16_f32 v106, v134, v133
    v_cvt_pk_bf16_f32 v107, v132, v131
    v_and_b32 v116, 0xffff0000, v42
    v_and_b32 v117, 0xffff0000, v46
    v_and_b32 v118, 0xffff0000, v50
    v_and_b32 v119, 0xffff0000, v54
    v_and_b32 v120, 0xffff0000, v58
    v_and_b32 v121, 0xffff0000, v62
    v_and_b32 v122, 0xffff0000, v66
    v_lshlrev_b32 v127, 16, v94
    v_and_b32 v128, 0xffff0000, v94
    v_lshlrev_b32 v129, 16, v95
    s_waitcnt vmcnt(12)
    s_barrier
    s_add_u32 s97, s98, s0
    s_lshr_b64 s[0:1], s[0:1], 4
    s_and_b32 s97, s97, 15
    s_lshr_b32 s99, s97, 3
    s_xor_b32 s97, s97, s99
    s_add_u32 m0, s87, 18432
    s_lshl_b32 s97, s97, 7
    buffer_load_dwordx4 v240, s[28:31], s97 offen offset:0  lds
    v_and_b32 v130, 0xffff0000, v95
    v_and_b32 v123, 0xffff0000, v70
    v_and_b32 v124, 0xffff0000, v74
    v_and_b32 v125, 0xffff0000, v78
    v_and_b32 v126, 0xffff0000, v82
    buffer_load_dwordx4 v241, s[28:31], s97 offen offset:1024  lds
    v_mul_f32 v131, v116, v130
    v_mul_f32 v132, v117, v130
    v_mul_f32 v133, v118, v130
    v_mul_f32 v134, v119, v130
    v_fmac_f32 v131, v117, v129
    buffer_load_dwordx4 v242, s[28:31], s97 offen offset:2048  lds
    v_fmac_f32 v132, v118, v129
    v_fmac_f32 v133, v119, v129
    v_fmac_f32 v134, v120, v129
    v_fmac_f32 v131, v118, v128
    v_fmac_f32 v132, v119, v128
    buffer_load_dwordx4 v243, s[28:31], s97 offen offset:3072  lds
    v_fmac_f32 v133, v120, v128
    v_fmac_f32 v134, v121, v128
    v_fmac_f32 v131, v119, v127
    v_fmac_f32 v132, v120, v127
    v_fmac_f32 v133, v121, v127
    s_add_u32 m0, s88, 18432
    s_mov_b64 exec, 0xffffffff
    buffer_load_dwordx4 v3, s[28:31], s97 offen offset:0  lds
    s_mov_b64 exec, -1
    v_fmac_f32 v134, v122, v127
    v_mul_f32 v131, v131, v123
    v_mul_f32 v132, v132, v124
    v_mul_f32 v133, v133, v125
    v_mul_f32 v134, v134, v126
    s_mul_i32 s16, s97, 3072
    s_add_u32 m0, s60, 24576
    s_add_u32 s99, s16, s62
    buffer_load_dwordx4 v244, s[32:35], s99 offen offset:0  lds
    v_cvt_pk_bf16_f32 v104, v134, v133
    v_cvt_pk_bf16_f32 v105, v132, v131
    s_nop 0
    v_permlane32_swap_b32 v106, v104
    v_permlane32_swap_b32 v107, v105
    s_mov_b32 s89, 16384
    buffer_store_dwordx4 v[104:107], v12, s[52:55], s89 offen sc1
    buffer_load_dwordx4 v245, s[32:35], s99 offen offset:1024  lds
    v_lshlrev_b32 v116, 16, v41
    v_lshlrev_b32 v117, 16, v45
    v_lshlrev_b32 v118, 16, v49
    v_lshlrev_b32 v119, 16, v53
    v_lshlrev_b32 v120, 16, v57
    buffer_load_dwordx4 v246, s[32:35], s99 offen offset:2048  lds
    v_lshlrev_b32 v121, 16, v61
    v_lshlrev_b32 v122, 16, v65
    v_lshlrev_b32 v127, 16, v88
    v_and_b32 v128, 0xffff0000, v88
    v_lshlrev_b32 v129, 16, v89
    s_add_u32 m0, s61, 36864
    s_add_u32 s16, s16, s63
    buffer_load_dwordx4 v244, s[32:35], s16 offen offset:0  lds
    v_and_b32 v130, 0xffff0000, v89
    v_lshlrev_b32 v123, 16, v69
    v_lshlrev_b32 v124, 16, v73
    v_lshlrev_b32 v125, 16, v77
    v_lshlrev_b32 v126, 16, v81
    buffer_load_dwordx4 v245, s[32:35], s16 offen offset:1024  lds
    v_mul_f32 v131, v116, v130
    v_mul_f32 v132, v117, v130
    v_mul_f32 v133, v118, v130
    v_mul_f32 v134, v119, v130
    v_fmac_f32 v131, v117, v129
    buffer_load_dwordx4 v246, s[32:35], s16 offen offset:2048  lds
    v_fmac_f32 v132, v118, v129
    v_fmac_f32 v133, v119, v129
    v_fmac_f32 v134, v120, v129
    v_fmac_f32 v131, v118, v128
    v_fmac_f32 v132, v119, v128
    v_fmac_f32 v133, v120, v128
    v_fmac_f32 v134, v121, v128
    v_fmac_f32 v131, v119, v127
    v_fmac_f32 v132, v120, v127
    v_fmac_f32 v133, v121, v127
    v_fmac_f32 v134, v122, v127
    v_mul_f32 v131, v131, v123
    s_waitcnt vmcnt(12)
    s_barrier
    s_add_u32 s97, s98, s0
    s_lshr_b64 s[0:1], s[0:1], 4
    s_and_b32 s97, s97, 15
    s_lshr_b32 s99, s97, 3
    s_xor_b32 s97, s97, s99
    s_add_u32 m0, s87, 36864
    s_lshl_b32 s97, s97, 7
    buffer_load_dwordx4 v240, s[28:31], s97 offen offset:0  lds
    v_mul_f32 v132, v132, v124
    v_mul_f32 v133, v133, v125
    v_mul_f32 v134, v134, v126
    v_cvt_pk_bf16_f32 v110, v134, v133
    v_cvt_pk_bf16_f32 v111, v132, v131
    buffer_load_dwordx4 v241, s[28:31], s97 offen offset:1024  lds
    v_lshlrev_b32 v116, 16, v43
    v_lshlrev_b32 v117, 16, v47
    v_lshlrev_b32 v118, 16, v51
    v_lshlrev_b32 v119, 16, v55
    v_lshlrev_b32 v120, 16, v59
    buffer_load_dwordx4 v242, s[28:31], s97 offen offset:2048  lds
    v_lshlrev_b32 v121, 16, v63
    v_lshlrev_b32 v122, 16, v67
    v_lshlrev_b32 v127, 16, v96
    v_and_b32 v128, 0xffff0000, v96
    v_lshlrev_b32 v129, 16, v97
    buffer_load_dwordx4 v243, s[28:31], s97 offen offset:3072  lds
    v_and_b32 v130, 0xffff0000, v97
    v_lshlrev_b32 v123, 16, v71
    v_lshlrev_b32 v124, 16, v75
    v_lshlrev_b32 v125, 16, v79
    v_lshlrev_b32 v126, 16, v83
    s_add_u32 m0, s88, 36864
    s_mov_b64 exec, 0xffffffff
    buffer_load_dwordx4 v3, s[28:31], s97 offen offset:0  lds
    s_mov_b64 exec, -1
    v_mul_f32 v131, v116, v130
    v_mul_f32 v132, v117, v130
    v_mul_f32 v133, v118, v130
    v_mul_f32 v134, v119, v130
    v_fmac_f32 v131, v117, v129
    s_mul_i32 s16, s97, 3072
    s_add_u32 m0, s60, 49152
    s_add_u32 s99, s16, s62
    buffer_load_dwordx4 v244, s[32:35], s99 offen offset:0  lds
    v_fmac_f32 v132, v118, v129
    v_fmac_f32 v133, v119, v129
    v_fmac_f32 v134, v120, v129
    v_fmac_f32 v131, v118, v128
    v_fmac_f32 v132, v119, v128
    buffer_load_dwordx4 v245, s[32:35], s99 offen offset:1024  lds
    v_fmac_f32 v133, v120, v128
    v_fmac_f32 v134, v121, v128
    v_fmac_f32 v131, v119, v127
    v_fmac_f32 v132, v120, v127
    v_fmac_f32 v133, v121, v127
    buffer_load_dwordx4 v246, s[32:35], s99 offen offset:2048  lds
    v_fmac_f32 v134, v122, v127
    v_mul_f32 v131, v131, v123
    v_mul_f32 v132, v132, v124
    v_mul_f32 v133, v133, v125
    v_mul_f32 v134, v134, v126
    s_add_u32 m0, s61, 61440
    s_add_u32 s16, s16, s63
    buffer_load_dwordx4 v244, s[32:35], s16 offen offset:0  lds
    v_cvt_pk_bf16_f32 v108, v134, v133
    v_cvt_pk_bf16_f32 v109, v132, v131
    s_nop 0
    v_permlane32_swap_b32 v110, v108
    v_permlane32_swap_b32 v111, v109
    s_mov_b32 s89, 32768
    buffer_store_dwordx4 v[108:111], v12, s[52:55], s89 offen sc1
    buffer_load_dwordx4 v245, s[32:35], s16 offen offset:1024  lds
    v_and_b32 v116, 0xffff0000, v41
    v_and_b32 v117, 0xffff0000, v45
    v_and_b32 v118, 0xffff0000, v49
    v_and_b32 v119, 0xffff0000, v53
    v_and_b32 v120, 0xffff0000, v57
    buffer_load_dwordx4 v246, s[32:35], s16 offen offset:2048  lds
    v_and_b32 v121, 0xffff0000, v61
    v_and_b32 v122, 0xffff0000, v65
    v_lshlrev_b32 v127, 16, v90
    v_and_b32 v128, 0xffff0000, v90
    v_lshlrev_b32 v129, 16, v91
    v_and_b32 v130, 0xffff0000, v91
    v_and_b32 v123, 0xffff0000, v69
    v_and_b32 v124, 0xffff0000, v73
    v_and_b32 v125, 0xffff0000, v77
    v_and_b32 v126, 0xffff0000, v81
    v_mul_f32 v131, v116, v130
    v_mul_f32 v132, v117, v130
    s_waitcnt vmcnt(12)
    s_barrier
    s_add_u32 s97, s98, s0
    s_lshr_b64 s[0:1], s[0:1], 4
    s_and_b32 s97, s97, 15
    s_lshr_b32 s99, s97, 3
    s_xor_b32 s97, s97, s99
    s_add_u32 m0, s87, 0
    s_lshl_b32 s97, s97, 7
    buffer_load_dwordx4 v240, s[28:31], s97 offen offset:0  lds
    v_mul_f32 v133, v118, v130
    v_mul_f32 v134, v119, v130
    v_fmac_f32 v131, v117, v129
    v_fmac_f32 v132, v118, v129
    v_fmac_f32 v133, v119, v129
    buffer_load_dwordx4 v241, s[28:31], s97 offen offset:1024  lds
    v_fmac_f32 v134, v120, v129
    v_fmac_f32 v131, v118, v128
    v_fmac_f32 v132, v119, v128
    v_fmac_f32 v133, v120, v128
    v_fmac_f32 v134, v121, v128
    buffer_load_dwordx4 v242, s[28:31], s97 offen offset:2048  lds
    v_fmac_f32 v131, v119, v127
    v_fmac_f32 v132, v120, v127
    v_fmac_f32 v133, v121, v127
    v_fmac_f32 v134, v122, v127
    v_mul_f32 v131, v131, v123
    buffer_load_dwordx4 v243, s[28:31], s97 offen offset:3072  lds
    v_mul_f32 v132, v132, v124
    v_mul_f32 v133, v133, v125
    v_mul_f32 v134, v134, v126
    v_cvt_pk_bf16_f32 v114, v134, v133
    v_cvt_pk_bf16_f32 v115, v132, v131
    s_add_u32 m0, s88, 0
    s_mov_b64 exec, 0xffffffff
    buffer_load_dwordx4 v3, s[28:31], s97 offen offset:0  lds
    s_mov_b64 exec, -1
    v_and_b32 v116, 0xffff0000, v43
    v_and_b32 v117, 0xffff0000, v47
    v_and_b32 v118, 0xffff0000, v51
    v_and_b32 v119, 0xffff0000, v55
    v_and_b32 v120, 0xffff0000, v59
    s_mul_i32 s16, s97, 3072
    s_add_u32 m0, s60, 0
    s_add_u32 s99, s16, s62
    buffer_load_dwordx4 v244, s[32:35], s99 offen offset:0  lds
    v_and_b32 v121, 0xffff0000, v63
    v_and_b32 v122, 0xffff0000, v67
    v_lshlrev_b32 v127, 16, v98
    v_and_b32 v128, 0xffff0000, v98
    v_lshlrev_b32 v129, 16, v99
    buffer_load_dwordx4 v245, s[32:35], s99 offen offset:1024  lds
    v_and_b32 v130, 0xffff0000, v99
    v_and_b32 v123, 0xffff0000, v71
    v_and_b32 v124, 0xffff0000, v75
    v_and_b32 v125, 0xffff0000, v79
    v_and_b32 v126, 0xffff0000, v83
    buffer_load_dwordx4 v246, s[32:35], s99 offen offset:2048  lds
    v_mul_f32 v131, v116, v130
    v_mul_f32 v132, v117, v130
    v_mul_f32 v133, v118, v130
    v_mul_f32 v134, v119, v130
    v_fmac_f32 v131, v117, v129
    s_add_u32 m0, s61, 12288
    s_add_u32 s16, s16, s63
    buffer_load_dwordx4 v244, s[32:35], s16 offen offset:0  lds
    v_fmac_f32 v132, v118, v129
    v_fmac_f32 v133, v119, v129
    v_fmac_f32 v134, v120, v129
    v_fmac_f32 v131, v118, v128
    v_fmac_f32 v132, v119, v128
    buffer_load_dwordx4 v245, s[32:35], s16 offen offset:1024  lds
    v_fmac_f32 v133, v120, v128
    v_fmac_f32 v134, v121, v128
    v_fmac_f32 v131, v119, v127
    v_fmac_f32 v132, v120, v127
    v_fmac_f32 v133, v121, v127
    buffer_load_dwordx4 v246, s[32:35], s16 offen offset:2048  lds
    v_fmac_f32 v134, v122, v127
    v_mul_f32 v131, v131, v123
    v_mul_f32 v132, v132, v124
    v_mul_f32 v133, v133, v125
    v_mul_f32 v134, v134, v126
    v_cvt_pk_bf16_f32 v112, v134, v133
    v_cvt_pk_bf16_f32 v113, v132, v131
    s_nop 0
    v_permlane32_swap_b32 v114, v112
    v_permlane32_swap_b32 v115, v113
    s_mov_b32 s89, 49152
    buffer_store_dwordx4 v[112:115], v12, s[52:55], s89 offen sc1
    s_waitcnt vmcnt(12)
    s_barrier
    s_add_u32 m0, s94, 32
    s_lshl_b32 s89, s90, 12
    buffer_load_dwordx4 v15, s[48:51], s89 offen offset:0 nt lds
    s_add_u32 m0, s94, 32
    s_lshl_b32 s89, s90, 12
    buffer_load_dwordx4 v15, s[48:51], s89 offen offset:1024 nt lds
    s_add_u32 m0, s94, 32
    s_lshl_b32 s89, s90, 12
    buffer_load_dwordx4 v15, s[48:51], s89 offen offset:2048 nt lds
    s_add_u32 m0, s94, 32
    s_lshl_b32 s89, s90, 12
    buffer_load_dwordx4 v15, s[48:51], s89 offen offset:3072 nt lds
    s_add_u32 s97, s98, s0
    s_lshr_b64 s[0:1], s[0:1], 4
    s_and_b32 s97, s97, 15
    s_lshr_b32 s99, s97, 3
    s_xor_b32 s97, s97, s99
    s_add_u32 m0, s87, 18432
    s_lshl_b32 s97, s97, 7
    buffer_load_dwordx4 v240, s[28:31], s97 offen offset:0  lds
    buffer_load_dwordx4 v241, s[28:31], s97 offen offset:1024  lds
    buffer_load_dwordx4 v242, s[28:31], s97 offen offset:2048  lds
    buffer_load_dwordx4 v243, s[28:31], s97 offen offset:3072  lds
    s_add_u32 m0, s88, 18432
    s_mov_b64 exec, 0xffffffff
    buffer_load_dwordx4 v3, s[28:31], s97 offen offset:0  lds
    s_mov_b64 exec, -1
    s_mul_i32 s16, s97, 3072
    s_add_u32 m0, s60, 24576
    s_add_u32 s99, s16, s62
    buffer_load_dwordx4 v244, s[32:35], s99 offen offset:0  lds
    buffer_load_dwordx4 v245, s[32:35], s99 offen offset:1024  lds
    buffer_load_dwordx4 v246, s[32:35], s99 offen offset:2048  lds
    s_add_u32 m0, s61, 36864
    s_add_u32 s16, s16, s63
    buffer_load_dwordx4 v244, s[32:35], s16 offen offset:0  lds
    buffer_load_dwordx4 v245, s[32:35], s16 offen offset:1024  lds
    buffer_load_dwordx4 v246, s[32:35], s16 offen offset:2048  lds
    s_waitcnt vmcnt(16)
    s_waitcnt vmcnt(15)
    s_barrier
    s_add_u32 s97, s98, s0
    s_lshr_b64 s[0:1], s[0:1], 4
    s_and_b32 s97, s97, 15
    s_lshr_b32 s99, s97, 3
    s_xor_b32 s97, s97, s99
    s_add_u32 m0, s87, 36864
    s_lshl_b32 s97, s97, 7
    buffer_load_dwordx4 v240, s[28:31], s97 offen offset:0  lds
    buffer_load_dwordx4 v241, s[28:31], s97 offen offset:1024  lds
    buffer_load_dwordx4 v242, s[28:31], s97 offen offset:2048  lds
    buffer_load_dwordx4 v243, s[28:31], s97 offen offset:3072  lds
    s_add_u32 m0, s88, 36864
    s_mov_b64 exec, 0xffffffff
    buffer_load_dwordx4 v3, s[28:31], s97 offen offset:0  lds
    s_mov_b64 exec, -1
    s_mul_i32 s16, s97, 3072
    s_add_u32 m0, s60, 49152
    s_add_u32 s99, s16, s62
    buffer_load_dwordx4 v244, s[32:35], s99 offen offset:0  lds
    buffer_load_dwordx4 v245, s[32:35], s99 offen offset:1024  lds
    buffer_load_dwordx4 v246, s[32:35], s99 offen offset:2048  lds
    s_add_u32 m0, s61, 61440
    s_add_u32 s16, s16, s63
    buffer_load_dwordx4 v244, s[32:35], s16 offen offset:0  lds
    buffer_load_dwordx4 v245, s[32:35], s16 offen offset:1024  lds
    buffer_load_dwordx4 v246, s[32:35], s16 offen offset:2048  lds
    s_waitcnt vmcnt(11)
    s_barrier
    s_add_u32 s97, s98, s0
    s_lshr_b64 s[0:1], s[0:1], 4
    s_and_b32 s97, s97, 15
    s_lshr_b32 s99, s97, 3
    s_xor_b32 s97, s97, s99
    s_add_u32 m0, s87, 0
    s_lshl_b32 s97, s97, 7
    buffer_load_dwordx4 v240, s[28:31], s97 offen offset:0  lds
    v_add_u32 v5, s94, v15
    ds_read_b128 v[140:143], v5 offset:32
    ds_read_b32 v156, v5 offset:48
    ds_read_b128 v[144:147], v5 offset:1056
    buffer_load_dwordx4 v241, s[28:31], s97 offen offset:1024  lds
    ds_read_b32 v157, v5 offset:1072
    ds_read_b128 v[148:151], v5 offset:2080
    ds_read_b32 v158, v5 offset:2096
    buffer_load_dwordx4 v242, s[28:31], s97 offen offset:2048  lds
    ds_read_b128 v[152:155], v5 offset:3104
    ds_read_b32 v159, v5 offset:3120
    v_lshrrev_b32 v6, 3, v0
    buffer_load_dwordx4 v243, s[28:31], s97 offen offset:3072  lds
    v_mul_u32_u24 v6, 4160, v6
    v_and_b32 v7, 7, v0
    v_lshl_add_u32 v6, v7, 2, v6
    v_add_u32 v6, s94, v6
    s_add_u32 m0, s88, 0
    s_mov_b64 exec, 0xffffffff
    buffer_load_dwordx4 v3, s[28:31], s97 offen offset:0  lds
    s_mov_b64 exec, -1
    v_mov_b32 v7, 0
    s_waitcnt lgkmcnt(0)
    v_readfirstlane_b32 s93, v140
    s_mul_i32 s16, s97, 3072
    s_add_u32 m0, s60, 0
    s_add_u32 s99, s16, s62
    buffer_load_dwordx4 v244, s[32:35], s99 offen offset:0  lds
    s_lshl_b32 s93, s93, 16
    v_writelane_b32 v7, s93, 15
    v_alignbit_b32 v140, v141, v140, 16
    buffer_load_dwordx4 v245, s[32:35], s99 offen offset:1024  lds
    v_alignbit_b32 v141, v142, v141, 16
    v_alignbit_b32 v142, v143, v142, 16
    v_alignbit_b32 v143, v156, v143, 16
    v_alignbit_b32 v144, v145, v144, 16
    buffer_load_dwordx4 v246, s[32:35], s99 offen offset:2048  lds
    v_alignbit_b32 v145, v146, v145, 16
    v_alignbit_b32 v146, v147, v146, 16
    v_alignbit_b32 v147, v157, v147, 16
    s_add_u32 m0, s61, 12288
    s_add_u32 s16, s16, s63
    buffer_load_dwordx4 v244, s[32:35], s16 offen offset:0  lds
    v_alignbit_b32 v148, v149, v148, 16
    v_alignbit_b32 v149, v150, v149, 16
    v_alignbit_b32 v150, v151, v150, 16
    buffer_load_dwordx4 v245, s[32:35], s16 offen offset:1024  lds
    v_alignbit_b32 v151, v158, v151, 16
    v_alignbit_b32 v152, v153, v152, 16
    v_alignbit_b32 v153, v154, v153, 16
    v_alignbit_b32 v154, v155, v154, 16
    buffer_load_dwordx4 v246, s[32:35], s16 offen offset:2048  lds
    v_alignbit_b32 v155, v159, v155, 16
    v_lshlrev_b32 v8, 3, v0
    s_add_u32 s78, s88, 18432
    s_mov_b64 exec, 0xff
    buffer_load_dword v136, v33, s[68:71], 0 offen sc1
    buffer_load_dword v137, v34, s[52:55], 0 offen sc1
    s_mov_b64 exec, -1
    v_add_u32 v8, s78, v8
    v_mov_b32 v156, 0
    v_mov_b32 v157, 0
    s_waitcnt vmcnt(13)
    s_barrier
    s_waitcnt vmcnt(0)
    s_branch LA_j
LA_c3:
    s_waitcnt vmcnt(7)
    s_barrier
    buffer_load_dwordx4 v246, s[32:35], s99 offen offset:2048  lds
    s_add_u32 m0, s61, 36864
    s_add_u32 s16, s16, s63
    buffer_load_dwordx4 v244, s[32:35], s16 offen offset:0  lds
    buffer_load_dwordx4 v245, s[32:35], s16 offen offset:1024  lds
    buffer_load_dwordx4 v246, s[32:35], s16 offen offset:2048  lds
    s_add_u32 s97, s98, s0
    s_lshr_b64 s[0:1], s[0:1], 4
    s_and_b32 s97, s97, 15
    s_lshr_b32 s99, s97, 3
    s_xor_b32 s97, s97, s99
    s_add_u32 m0, s87, 36864
    s_lshl_b32 s97, s97, 7
    buffer_load_dwordx4 v240, s[28:31], s97 offen offset:0  lds
    buffer_load_dwordx4 v241, s[28:31], s97 offen offset:1024  lds
    buffer_load_dwordx4 v242, s[28:31], s97 offen offset:2048  lds
    buffer_load_dwordx4 v243, s[28:31], s97 offen offset:3072  lds
    s_add_u32 m0, s88, 36864
    s_mov_b64 exec, 0xffffffff
    buffer_load_dwordx4 v3, s[28:31], s97 offen offset:0  lds
    s_mov_b64 exec, -1
    s_mul_i32 s16, s97, 3072
    s_add_u32 m0, s60, 49152
    s_add_u32 s99, s16, s62
    buffer_load_dwordx4 v244, s[32:35], s99 offen offset:0  lds
    buffer_load_dwordx4 v245, s[32:35], s99 offen offset:1024  lds
    buffer_load_dwordx4 v246, s[32:35], s99 offen offset:2048  lds
    s_add_u32 m0, s61, 61440
    s_add_u32 s16, s16, s63
    buffer_load_dwordx4 v244, s[32:35], s16 offen offset:0  lds
    buffer_load_dwordx4 v245, s[32:35], s16 offen offset:1024  lds
    buffer_load_dwordx4 v246, s[32:35], s16 offen offset:2048  lds
    s_waitcnt vmcnt(11)
    s_barrier
    buffer_load_dword v230, v229, s[64:67], 0 offen
    s_mov_b32 s68, s24
    s_mov_b32 s69, s25
    s_mov_b32 s70, 0x100
    s_mov_b32 s71, 0x20000
    v_lshrrev_b32 v6, 5, v0
    s_add_u32 s97, s98, s0
    s_lshr_b64 s[0:1], s[0:1], 4
    s_and_b32 s97, s97, 15
    s_lshr_b32 s99, s97, 3
    s_xor_b32 s97, s97, s99
    s_add_u32 m0, s87, 0
    s_lshl_b32 s97, s97, 7
    buffer_load_dwordx4 v240, s[28:31], s97 offen offset:0  lds
    v_and_b32 v7, 3, v0
    s_lshr_b32 s78, s90, 1
    s_lshl_b32 s78, s78, 2
    s_load_dword s92, s[14:15], s78
    v_bfe_u32 v5, v0, 2, 2
    buffer_load_dwordx4 v241, s[28:31], s97 offen offset:1024  lds
    v_lshlrev_b32 v5, 1, v5
    v_lshl_add_u32 v5, v6, 3, v5
    v_bfe_u32 v8, v0, 4, 1
    v_add_u32 v5, v5, v8
    s_and_b32 s78, s3, 1
    buffer_load_dwordx4 v242, s[28:31], s97 offen offset:2048  lds
    s_lshl_b32 s78, s78, 1
    v_add_u32 v8, s78, v6
    v_xor_b32 v8, v8, v7
    v_lshlrev_b32 v8, 4, v8
    v_lshl_add_u32 v5, v5, 6, v8
    buffer_load_dwordx4 v243, s[28:31], s97 offen offset:3072  lds
    v_add_u32 v14, s86, v5
    v_mov_b32 v18, 162304
    v_mov_b32 v19, 1
    v_and_b32 v5, 3, v0
    s_lshl_b32 s78, s74, 4
    s_add_u32 m0, s88, 0
    s_mov_b64 exec, 0xffffffff
    buffer_load_dwordx4 v3, s[28:31], s97 offen offset:0  lds
    s_mov_b64 exec, -1
    s_add_u32 s78, s78, s3
    v_lshl_add_u32 v6, v5, 2, s78
    s_lshr_b32 s78, s76, 3
    s_lshl_b32 s79, s3, 1
    s_add_u32 s78, s78, s79
    s_mul_i32 s16, s97, 3072
    s_add_u32 m0, s60, 0
    s_add_u32 s99, s16, s62
    buffer_load_dwordx4 v244, s[32:35], s99 offen offset:0  lds
    s_xor_b32 s78, s78, 0
    s_lshl_b32 s78, s78, 5
    s_and_b32 s79, s76, 7
    s_add_u32 s78, s78, s79
    v_lshl_add_u32 v7, v5, 3, s78
    buffer_load_dwordx4 v245, s[32:35], s99 offen offset:1024  lds
    v_and_b32 v8, 4, v0
    v_cmp_eq_u32 vcc, 0, v8
    s_nop 1
    v_cndmask_b32 v6, v7, v6, vcc
    v_and_b32 v33, 0xf0, v6
    v_lshlrev_b32 v34, 8, v6
    buffer_load_dwordx4 v246, s[32:35], s99 offen offset:2048  lds
    v_add_u32 v34, 12582912, v34
    v_and_b32 v5, 15, v0
    v_lshrrev_b32 v6, 4, v0
    v_add_u32 v7, 9, v5
    v_and_b32 v8, 1, v7
    s_add_u32 m0, s61, 12288
    s_add_u32 s16, s16, s63
    buffer_load_dwordx4 v244, s[32:35], s16 offen offset:0  lds
    v_mul_u32_u24 v8, 4160, v8
    v_lshrrev_b32 v7, 1, v7
    v_lshl_add_u32 v8, v7, 2, v8
    v_lshlrev_b32 v7, 4, v6
    v_sub_u32 v8, v8, v7
    buffer_load_dwordx4 v245, s[32:35], s16 offen offset:1024  lds
    s_add_u32 s78, s94, 32
    v_add_u32 v21, s78, v8
    v_add_u32 v22, 1024, v21
    v_add_u32 v23, 2048, v21
    v_add_u32 v24, 3072, v21
    buffer_load_dwordx4 v246, s[32:35], s16 offen offset:2048  lds
    v_lshl_add_u32 v7, v5, 1, v6
    v_add_u32 v7, 30, v7
    v_and_b32 v8, 1, v7
    v_bfe_u32 v136, v7, 1, 2
    v_lshl_add_u32 v136, v8, 2, v136
    s_waitcnt vmcnt(12)
    s_barrier
    s_add_u32 s97, s98, s0
    s_lshr_b64 s[0:1], s[0:1], 4
    s_and_b32 s97, s97, 15
    s_lshr_b32 s99, s97, 3
    s_xor_b32 s97, s97, s99
    s_add_u32 m0, s87, 18432
    s_lshl_b32 s97, s97, 7
    buffer_load_dwordx4 v240, s[28:31], s97 offen offset:0  lds
    v_lshlrev_b32 v136, 6, v136
    v_lshrrev_b32 v7, 3, v7
    v_lshl_add_u32 v136, v7, 9, v136
    v_bitop3_b32 v8, v7, 3, s3 bitop3:0x6a
    v_lshl_add_u32 v25, v8, 4, v136
    buffer_load_dwordx4 v241, s[28:31], s97 offen offset:1024  lds
    v_add_u32 v25, 92160, v25
    v_subrev_u32 v7, 1, v7
    v_bitop3_b32 v8, v7, 3, s3 bitop3:0x6a
    v_lshl_add_u32 v27, v8, 4, v136
    v_add_u32 v27, 91648, v27
    buffer_load_dwordx4 v242, s[28:31], s97 offen offset:2048  lds
    v_subrev_u32 v7, 1, v7
    v_bitop3_b32 v8, v7, 3, s3 bitop3:0x6a
    v_lshl_add_u32 v29, v8, 4, v136
    v_add_u32 v29, 91136, v29
    v_subrev_u32 v7, 1, v7
    buffer_load_dwordx4 v243, s[28:31], s97 offen offset:3072  lds
    v_bitop3_b32 v8, v7, 3, s3 bitop3:0x6a
    v_lshl_add_u32 v31, v8, 4, v136
    v_add_u32 v31, 90624, v31
    v_lshl_add_u32 v7, v5, 1, v6
    v_add_u32 v7, 26, v7
    s_add_u32 m0, s88, 18432
    s_mov_b64 exec, 0xffffffff
    buffer_load_dwordx4 v3, s[28:31], s97 offen offset:0  lds
    s_mov_b64 exec, -1
    v_and_b32 v8, 1, v7
    v_bfe_u32 v136, v7, 1, 2
    v_lshl_add_u32 v136, v8, 2, v136
    v_lshlrev_b32 v136, 6, v136
    v_lshrrev_b32 v7, 3, v7
    s_mul_i32 s16, s97, 3072
    s_add_u32 m0, s60, 24576
    s_add_u32 s99, s16, s62
    buffer_load_dwordx4 v244, s[32:35], s99 offen offset:0  lds
    v_lshl_add_u32 v136, v7, 9, v136
    v_bitop3_b32 v8, v7, 3, s3 bitop3:0x6a
    v_lshl_add_u32 v26, v8, 4, v136
    v_add_u32 v26, 92160, v26
    v_subrev_u32 v7, 1, v7
    buffer_load_dwordx4 v245, s[32:35], s99 offen offset:1024  lds
    v_bitop3_b32 v8, v7, 3, s3 bitop3:0x6a
    v_lshl_add_u32 v28, v8, 4, v136
    v_add_u32 v28, 91648, v28
    v_subrev_u32 v7, 1, v7
    v_bitop3_b32 v8, v7, 3, s3 bitop3:0x6a
    buffer_load_dwordx4 v246, s[32:35], s99 offen offset:2048  lds
    v_lshl_add_u32 v30, v8, 4, v136
    v_add_u32 v30, 91136, v30
    v_subrev_u32 v7, 1, v7
    v_bitop3_b32 v8, v7, 3, s3 bitop3:0x6a
    v_lshl_add_u32 v32, v8, 4, v136
    s_add_u32 m0, s61, 36864
    s_add_u32 s16, s16, s63
    buffer_load_dwordx4 v244, s[32:35], s16 offen offset:0  lds
    v_add_u32 v32, 90624, v32
    v_lshrrev_b32 v7, 1, v6
    v_lshl_add_u32 v7, v5, 1, v7
    v_add_u32 v7, 32, v7
    v_and_b32 v8, 1, v7
    buffer_load_dwordx4 v245, s[32:35], s16 offen offset:1024  lds
    v_bfe_u32 v136, v7, 1, 2
    v_lshl_add_u32 v136, v8, 2, v136
    v_lshlrev_b32 v136, 6, v136
    v_lshrrev_b32 v7, 3, v7
    v_lshl_add_u32 v136, v7, 9, v136
    buffer_load_dwordx4 v246, s[32:35], s16 offen offset:2048  lds
    v_bitop3_b32 v8, v7, 3, s3 bitop3:0x6a
    v_lshl_add_u32 v20, v8, 4, v136
    v_add_u32 v20, 92160, v20
    v_and_b32 v8, 1, v6
    v_xor_b32 v8, 1, v8
    v_lshl_add_u32 v20, v8, 3, v20
    s_waitcnt lgkmcnt(0)
    s_and_b32 s78, s92, 0xffff0000
    s_lshl_b32 s92, s92, 16
    s_bitcmp1_b32 s90, 0
    s_cselect_b32 s92, s78, s92
    s_waitcnt vmcnt(11)
    s_barrier
    s_add_u32 m0, s86, 129536
    s_mov_b32 s89, 0
    buffer_load_dwordx4 v10, s[36:39], s89 offen nt lds
    v_lshlrev_b32 v7, 3, v6
    s_add_u32 m0, s86, 145920
    s_mov_b32 s89, 0
    buffer_load_dwordx4 v10, s[40:43], s89 offen nt lds
    v_sub_u32 v7, v7, v5
    s_add_u32 m0, s86, 133632
    s_mov_b32 s89, 65536
    buffer_load_dwordx4 v10, s[36:39], s89 offen nt lds
    v_subrev_u32 v7, 9, v7
    s_add_u32 m0, s86, 150016
    s_mov_b32 s89, 65536
    buffer_load_dwordx4 v10, s[40:43], s89 offen nt lds
    v_and_b32 v8, 1, v7
    s_add_u32 m0, s86, 137728
    s_mov_b32 s89, 131072
    buffer_load_dwordx4 v10, s[36:39], s89 offen nt lds
    v_xor_b32 v8, 1, v8
    s_add_u32 m0, s86, 154112
    s_mov_b32 s89, 131072
    buffer_load_dwordx4 v10, s[40:43], s89 offen nt lds
    v_lshlrev_b32 v8, 4, v8
    s_add_u32 m0, s86, 141824
    s_mov_b32 s89, 196608
    buffer_load_dwordx4 v10, s[36:39], s89 offen nt lds
    v_lshrrev_b32 v8, v8, s92
    s_add_u32 m0, s86, 158208
    s_mov_b32 s89, 196608
    buffer_load_dwordx4 v10, s[40:43], s89 offen nt lds
    v_ashrrev_i32 v7, 1, v7
    s_mov_b64 exec, 0xff
    s_lshl_b32 s82, s3, 7
    s_add_u32 m0, s82, 129024
    s_mov_b32 s89, 0
    buffer_load_dwordx4 v11, s[36:39], s89 offen nt lds
    s_lshl_b32 s83, s74, 9
    s_add_u32 s83, s83, s82
    s_and_b32 s89, s3, 2
    s_lshl_b32 s89, s89, 3
    s_add_u32 s82, s82, s89
    s_add_u32 m0, s82, 162816
    s_add_u32 s89, s83, 0
    buffer_load_dwordx4 v15, s[44:47], s89 offen  lds
    s_mov_b64 exec, -1
    v_cmp_eq_u32 vcc, 0, v7
    s_add_u32 s97, s98, s0
    s_lshr_b64 s[0:1], s[0:1], 4
    s_and_b32 s97, s97, 15
    s_lshr_b32 s99, s97, 3
    s_xor_b32 s97, s97, s99
    s_add_u32 m0, s87, 36864
    s_lshl_b32 s97, s97, 7
    buffer_load_dwordx4 v240, s[28:31], s97 offen offset:0  lds
    v_cndmask_b32 v236, 0, v8, vcc
    buffer_load_dwordx4 v241, s[28:31], s97 offen offset:1024  lds
    v_cmp_eq_u32 vcc, 1, v7
    buffer_load_dwordx4 v242, s[28:31], s97 offen offset:2048  lds
    s_nop 0
    v_cndmask_b32 v237, 0, v8, vcc
    buffer_load_dwordx4 v243, s[28:31], s97 offen offset:3072  lds
    v_cmp_eq_u32 vcc, 2, v7
    s_add_u32 m0, s88, 36864
    s_mov_b64 exec, 0xffffffff
    buffer_load_dwordx4 v3, s[28:31], s97 offen offset:0  lds
    s_mov_b64 exec, -1
    v_cndmask_b32 v238, 0, v8, vcc
    s_mul_i32 s16, s97, 3072
    s_add_u32 m0, s60, 49152
    s_add_u32 s99, s16, s62
    buffer_load_dwordx4 v244, s[32:35], s99 offen offset:0  lds
    v_cmp_eq_u32 vcc, 3, v7
    buffer_load_dwordx4 v245, s[32:35], s99 offen offset:1024  lds
    s_nop 0
    v_cndmask_b32 v239, 0, v8, vcc
    s_waitcnt vmcnt(17)
    s_barrier
    buffer_load_dwordx4 v246, s[32:35], s99 offen offset:2048  lds
    s_add_u32 m0, s61, 61440
    s_add_u32 s16, s16, s63
    buffer_load_dwordx4 v244, s[32:35], s16 offen offset:0  lds
    buffer_load_dwordx4 v245, s[32:35], s16 offen offset:1024  lds
    buffer_load_dwordx4 v246, s[32:35], s16 offen offset:2048  lds
    s_add_u32 s97, s98, s0
    s_lshr_b64 s[0:1], s[0:1], 4
    s_and_b32 s97, s97, 15
    s_lshr_b32 s99, s97, 3
    s_xor_b32 s97, s97, s99
    s_add_u32 m0, s87, 0
    s_lshl_b32 s97, s97, 7
    buffer_load_dwordx4 v240, s[28:31], s97 offen offset:0  lds
    buffer_load_dwordx4 v241, s[28:31], s97 offen offset:1024  lds
    buffer_load_dwordx4 v242, s[28:31], s97 offen offset:2048  lds
    buffer_load_dwordx4 v243, s[28:31], s97 offen offset:3072  lds
    s_add_u32 m0, s88, 0
    s_mov_b64 exec, 0xffffffff
    buffer_load_dwordx4 v3, s[28:31], s97 offen offset:0  lds
    s_mov_b64 exec, -1
    s_mul_i32 s16, s97, 3072
    s_add_u32 m0, s60, 0
    s_add_u32 s99, s16, s62
    buffer_load_dwordx4 v244, s[32:35], s99 offen offset:0  lds
    buffer_load_dwordx4 v245, s[32:35], s99 offen offset:1024  lds
    buffer_load_dwordx4 v246, s[32:35], s99 offen offset:2048  lds
    s_add_u32 m0, s61, 12288
    s_add_u32 s16, s16, s63
    buffer_load_dwordx4 v244, s[32:35], s16 offen offset:0  lds
    buffer_load_dwordx4 v245, s[32:35], s16 offen offset:1024  lds
    buffer_load_dwordx4 v246, s[32:35], s16 offen offset:2048  lds
    s_waitcnt vmcnt(11)
    s_barrier
    s_add_u32 s97, s98, s0
    s_lshr_b64 s[0:1], s[0:1], 4
    s_and_b32 s97, s97, 15
    s_lshr_b32 s99, s97, 3
    s_xor_b32 s97, s97, s99
    s_add_u32 m0, s87, 18432
    s_lshl_b32 s97, s97, 7
    buffer_load_dwordx4 v240, s[28:31], s97 offen offset:0  lds
    ds_read_b128 v[84:87], v35 offset:0
    ds_read_b128 v[88:91], v35 offset:16
    buffer_load_dwordx4 v241, s[28:31], s97 offen offset:1024  lds
    ds_read_b128 v[92:95], v35 offset:32
    buffer_load_dwordx4 v242, s[28:31], s97 offen offset:2048  lds
    ds_read_b128 v[96:99], v35 offset:48
    ds_read_b128 v[40:43], v233 offset:0
    buffer_load_dwordx4 v243, s[28:31], s97 offen offset:3072  lds
    ds_read_b128 v[44:47], v232 offset:256
    s_add_u32 m0, s88, 18432
    s_mov_b64 exec, 0xffffffff
    buffer_load_dwordx4 v3, s[28:31], s97 offen offset:0  lds
    s_mov_b64 exec, -1
    ds_read_b128 v[48:51], v233 offset:256
    s_mul_i32 s16, s97, 3072
    s_add_u32 m0, s60, 24576
    s_add_u32 s99, s16, s62
    buffer_load_dwordx4 v244, s[32:35], s99 offen offset:0  lds
    ds_read_b128 v[52:55], v16 offset:512
    ds_read_b128 v[56:59], v231 offset:512
    buffer_load_dwordx4 v245, s[32:35], s99 offen offset:1024  lds
    ds_read_b128 v[60:63], v16 offset:768
    buffer_load_dwordx4 v246, s[32:35], s99 offen offset:2048  lds
    ds_read_b128 v[64:67], v231 offset:768
    s_add_u32 m0, s61, 36864
    s_add_u32 s16, s16, s63
    buffer_load_dwordx4 v244, s[32:35], s16 offen offset:0  lds
    ds_read_b128 v[68:71], v16 offset:16896
    ds_read_b128 v[72:75], v231 offset:16896
    buffer_load_dwordx4 v245, s[32:35], s16 offen offset:1024  lds
    ds_read_b128 v[76:79], v16 offset:17152
    buffer_load_dwordx4 v246, s[32:35], s16 offen offset:2048  lds
    ds_read_b128 v[80:83], v231 offset:17152
    s_waitcnt vmcnt(11)
    s_waitcnt lgkmcnt(0)
    s_barrier
    s_add_u32 s97, s98, s0
    s_lshr_b64 s[0:1], s[0:1], 4
    s_and_b32 s97, s97, 15
    s_lshr_b32 s99, s97, 3
    s_xor_b32 s97, s97, s99
    s_add_u32 m0, s87, 36864
    s_lshl_b32 s97, s97, 7
    buffer_load_dwordx4 v240, s[28:31], s97 offen offset:0  lds
    v_lshlrev_b32 v116, 16, v40
    v_lshlrev_b32 v117, 16, v44
    v_lshlrev_b32 v118, 16, v48
    v_lshlrev_b32 v119, 16, v52
    v_lshlrev_b32 v120, 16, v56
    buffer_load_dwordx4 v241, s[28:31], s97 offen offset:1024  lds
    v_lshlrev_b32 v121, 16, v60
    v_lshlrev_b32 v122, 16, v64
    v_lshlrev_b32 v127, 16, v84
    v_and_b32 v128, 0xffff0000, v84
    v_lshlrev_b32 v129, 16, v85
    buffer_load_dwordx4 v242, s[28:31], s97 offen offset:2048  lds
    v_and_b32 v130, 0xffff0000, v85
    v_lshlrev_b32 v123, 16, v68
    v_lshlrev_b32 v124, 16, v72
    v_lshlrev_b32 v125, 16, v76
    v_lshlrev_b32 v126, 16, v80
    buffer_load_dwordx4 v243, s[28:31], s97 offen offset:3072  lds
    v_mul_f32 v131, v116, v130
    v_mul_f32 v132, v117, v130
    v_mul_f32 v133, v118, v130
    v_mul_f32 v134, v119, v130
    v_fmac_f32 v131, v117, v129
    s_add_u32 m0, s88, 36864
    s_mov_b64 exec, 0xffffffff
    buffer_load_dwordx4 v3, s[28:31], s97 offen offset:0  lds
    s_mov_b64 exec, -1
    v_fmac_f32 v132, v118, v129
    v_fmac_f32 v133, v119, v129
    v_fmac_f32 v134, v120, v129
    v_fmac_f32 v131, v118, v128
    v_fmac_f32 v132, v119, v128
    s_mul_i32 s16, s97, 3072
    s_add_u32 m0, s60, 49152
    s_add_u32 s99, s16, s62
    buffer_load_dwordx4 v244, s[32:35], s99 offen offset:0  lds
    v_fmac_f32 v133, v120, v128
    v_fmac_f32 v134, v121, v128
    v_fmac_f32 v131, v119, v127
    v_fmac_f32 v132, v120, v127
    v_fmac_f32 v133, v121, v127
    buffer_load_dwordx4 v245, s[32:35], s99 offen offset:1024  lds
    v_fmac_f32 v134, v122, v127
    v_mul_f32 v131, v131, v123
    v_mul_f32 v132, v132, v124
    v_mul_f32 v133, v133, v125
    v_mul_f32 v134, v134, v126
    buffer_load_dwordx4 v246, s[32:35], s99 offen offset:2048  lds
    v_cvt_pk_bf16_f32 v102, v134, v133
    v_cvt_pk_bf16_f32 v103, v132, v131
    v_lshlrev_b32 v116, 16, v42
    v_lshlrev_b32 v117, 16, v46
    v_lshlrev_b32 v118, 16, v50
    s_add_u32 m0, s61, 61440
    s_add_u32 s16, s16, s63
    buffer_load_dwordx4 v244, s[32:35], s16 offen offset:0  lds
    v_lshlrev_b32 v119, 16, v54
    v_lshlrev_b32 v120, 16, v58
    v_lshlrev_b32 v121, 16, v62
    v_lshlrev_b32 v122, 16, v66
    v_lshlrev_b32 v127, 16, v92
    buffer_load_dwordx4 v245, s[32:35], s16 offen offset:1024  lds
    v_and_b32 v128, 0xffff0000, v92
    v_lshlrev_b32 v129, 16, v93
    v_and_b32 v130, 0xffff0000, v93
    v_lshlrev_b32 v123, 16, v70
    v_lshlrev_b32 v124, 16, v74
    buffer_load_dwordx4 v246, s[32:35], s16 offen offset:2048  lds
    v_lshlrev_b32 v125, 16, v78
    v_lshlrev_b32 v126, 16, v82
    v_mul_f32 v131, v116, v130
    v_mul_f32 v132, v117, v130
    v_mul_f32 v133, v118, v130
    v_mul_f32 v134, v119, v130
    v_fmac_f32 v131, v117, v129
    v_fmac_f32 v132, v118, v129
    v_fmac_f32 v133, v119, v129
    v_fmac_f32 v134, v120, v129
    v_fmac_f32 v131, v118, v128
    v_fmac_f32 v132, v119, v128
    s_waitcnt vmcnt(11)
    s_barrier
    s_add_u32 s97, s98, s0
    s_lshr_b64 s[0:1], s[0:1], 4
    s_and_b32 s97, s97, 15
    s_lshr_b32 s99, s97, 3
    s_xor_b32 s97, s97, s99
    s_add_u32 m0, s87, 0
    s_lshl_b32 s97, s97, 7
    buffer_load_dwordx4 v240, s[28:31], s97 offen offset:0  lds
    v_fmac_f32 v133, v120, v128
    v_fmac_f32 v134, v121, v128
    v_fmac_f32 v131, v119, v127
    v_fmac_f32 v132, v120, v127
    v_fmac_f32 v133, v121, v127
    buffer_load_dwordx4 v241, s[28:31], s97 offen offset:1024  lds
    v_fmac_f32 v134, v122, v127
    v_mul_f32 v131, v131, v123
    v_mul_f32 v132, v132, v124
    v_mul_f32 v133, v133, v125
    v_mul_f32 v134, v134, v126
    buffer_load_dwordx4 v242, s[28:31], s97 offen offset:2048  lds
    v_cvt_pk_bf16_f32 v100, v134, v133
    v_cvt_pk_bf16_f32 v101, v132, v131
    s_nop 0
    v_permlane32_swap_b32 v102, v100
    v_permlane32_swap_b32 v103, v101
    s_mov_b32 s89, 0
    buffer_store_dwordx4 v[100:103], v12, s[52:55], s89 offen sc1
    buffer_load_dwordx4 v243, s[28:31], s97 offen offset:3072  lds
    v_and_b32 v116, 0xffff0000, v40
    v_and_b32 v117, 0xffff0000, v44
    v_and_b32 v118, 0xffff0000, v48
    v_and_b32 v119, 0xffff0000, v52
    v_and_b32 v120, 0xffff0000, v56
    s_add_u32 m0, s88, 0
    s_mov_b64 exec, 0xffffffff
    buffer_load_dwordx4 v3, s[28:31], s97 offen offset:0  lds
    s_mov_b64 exec, -1
    v_and_b32 v121, 0xffff0000, v60
    v_and_b32 v122, 0xffff0000, v64
    v_lshlrev_b32 v127, 16, v86
    v_and_b32 v128, 0xffff0000, v86
    v_lshlrev_b32 v129, 16, v87
    s_mul_i32 s16, s97, 3072
    s_add_u32 m0, s60, 0
    s_add_u32 s99, s16, s62
    buffer_load_dwordx4 v244, s[32:35], s99 offen offset:0  lds
    v_and_b32 v130, 0xffff0000, v87
    v_and_b32 v123, 0xffff0000, v68
    v_and_b32 v124, 0xffff0000, v72
    v_and_b32 v125, 0xffff0000, v76
    v_and_b32 v126, 0xffff0000, v80
    buffer_load_dwordx4 v245, s[32:35], s99 offen offset:1024  lds
    v_mul_f32 v131, v116, v130
    v_mul_f32 v132, v117, v130
    v_mul_f32 v133, v118, v130
    v_mul_f32 v134, v119, v130
    v_fmac_f32 v131, v117, v129
    buffer_load_dwordx4 v246, s[32:35], s99 offen offset:2048  lds
    v_fmac_f32 v132, v118, v129
    v_fmac_f32 v133, v119, v129
    v_fmac_f32 v134, v120, v129
    v_fmac_f32 v131, v118, v128
    v_fmac_f32 v132, v119, v128
    s_add_u32 m0, s61, 12288
    s_add_u32 s16, s16, s63
    buffer_load_dwordx4 v244, s[32:35], s16 offen offset:0  lds
    v_fmac_f32 v133, v120, v128
    v_fmac_f32 v134, v121, v128
    v_fmac_f32 v131, v119, v127
    v_fmac_f32 v132, v120, v127
    v_fmac_f32 v133, v121, v127
    buffer_load_dwordx4 v245, s[32:35], s16 offen offset:1024  lds
    v_fmac_f32 v134, v122, v127
    v_mul_f32 v131, v131, v123
    v_mul_f32 v132, v132, v124
    v_mul_f32 v133, v133, v125
    v_mul_f32 v134, v134, v126
    buffer_load_dwordx4 v246, s[32:35], s16 offen offset:2048  lds
    v_cvt_pk_bf16_f32 v106, v134, v133
    v_cvt_pk_bf16_f32 v107, v132, v131
    v_and_b32 v116, 0xffff0000, v42
    v_and_b32 v117, 0xffff0000, v46
    v_and_b32 v118, 0xffff0000, v50
    v_and_b32 v119, 0xffff0000, v54
    v_and_b32 v120, 0xffff0000, v58
    v_and_b32 v121, 0xffff0000, v62
    v_and_b32 v122, 0xffff0000, v66
    v_lshlrev_b32 v127, 16, v94
    v_and_b32 v128, 0xffff0000, v94
    v_lshlrev_b32 v129, 16, v95
    s_waitcnt vmcnt(12)
    s_barrier
    s_add_u32 s97, s98, s0
    s_lshr_b64 s[0:1], s[0:1], 4
    s_and_b32 s97, s97, 15
    s_lshr_b32 s99, s97, 3
    s_xor_b32 s97, s97, s99
    s_add_u32 m0, s87, 18432
    s_lshl_b32 s97, s97, 7
    buffer_load_dwordx4 v240, s[28:31], s97 offen offset:0  lds
    v_and_b32 v130, 0xffff0000, v95
    v_and_b32 v123, 0xffff0000, v70
    v_and_b32 v124, 0xffff0000, v74
    v_and_b32 v125, 0xffff0000, v78
    v_and_b32 v126, 0xffff0000, v82
    buffer_load_dwordx4 v241, s[28:31], s97 offen offset:1024  lds
    v_mul_f32 v131, v116, v130
    v_mul_f32 v132, v117, v130
    v_mul_f32 v133, v118, v130
    v_mul_f32 v134, v119, v130
    v_fmac_f32 v131, v117, v129
    buffer_load_dwordx4 v242, s[28:31], s97 offen offset:2048  lds
    v_fmac_f32 v132, v118, v129
    v_fmac_f32 v133, v119, v129
    v_fmac_f32 v134, v120, v129
    v_fmac_f32 v131, v118, v128
    v_fmac_f32 v132, v119, v128
    buffer_load_dwordx4 v243, s[28:31], s97 offen offset:3072  lds
    v_fmac_f32 v133, v120, v128
    v_fmac_f32 v134, v121, v128
    v_fmac_f32 v131, v119, v127
    v_fmac_f32 v132, v120, v127
    v_fmac_f32 v133, v121, v127
    s_add_u32 m0, s88, 18432
    s_mov_b64 exec, 0xffffffff
    buffer_load_dwordx4 v3, s[28:31], s97 offen offset:0  lds
    s_mov_b64 exec, -1
    v_fmac_f32 v134, v122, v127
    v_mul_f32 v131, v131, v123
    v_mul_f32 v132, v132, v124
    v_mul_f32 v133, v133, v125
    v_mul_f32 v134, v134, v126
    s_mul_i32 s16, s97, 3072
    s_add_u32 m0, s60, 24576
    s_add_u32 s99, s16, s62
    buffer_load_dwordx4 v244, s[32:35], s99 offen offset:0  lds
    v_cvt_pk_bf16_f32 v104, v134, v133
    v_cvt_pk_bf16_f32 v105, v132, v131
    s_nop 0
    v_permlane32_swap_b32 v106, v104
    v_permlane32_swap_b32 v107, v105
    s_mov_b32 s89, 16384
    buffer_store_dwordx4 v[104:107], v12, s[52:55], s89 offen sc1
    buffer_load_dwordx4 v245, s[32:35], s99 offen offset:1024  lds
    v_lshlrev_b32 v116, 16, v41
    v_lshlrev_b32 v117, 16, v45
    v_lshlrev_b32 v118, 16, v49
    v_lshlrev_b32 v119, 16, v53
    v_lshlrev_b32 v120, 16, v57
    buffer_load_dwordx4 v246, s[32:35], s99 offen offset:2048  lds
    v_lshlrev_b32 v121, 16, v61
    v_lshlrev_b32 v122, 16, v65
    v_lshlrev_b32 v127, 16, v88
    v_and_b32 v128, 0xffff0000, v88
    v_lshlrev_b32 v129, 16, v89
    s_add_u32 m0, s61, 36864
    s_add_u32 s16, s16, s63
    buffer_load_dwordx4 v244, s[32:35], s16 offen offset:0  lds
    v_and_b32 v130, 0xffff0000, v89
    v_lshlrev_b32 v123, 16, v69
    v_lshlrev_b32 v124, 16, v73
    v_lshlrev_b32 v125, 16, v77
    v_lshlrev_b32 v126, 16, v81
    buffer_load_dwordx4 v245, s[32:35], s16 offen offset:1024  lds
    v_mul_f32 v131, v116, v130
    v_mul_f32 v132, v117, v130
    v_mul_f32 v133, v118, v130
    v_mul_f32 v134, v119, v130
    v_fmac_f32 v131, v117, v129
    buffer_load_dwordx4 v246, s[32:35], s16 offen offset:2048  lds
    v_fmac_f32 v132, v118, v129
    v_fmac_f32 v133, v119, v129
    v_fmac_f32 v134, v120, v129
    v_fmac_f32 v131, v118, v128
    v_fmac_f32 v132, v119, v128
    v_fmac_f32 v133, v120, v128
    v_fmac_f32 v134, v121, v128
    v_fmac_f32 v131, v119, v127
    v_fmac_f32 v132, v120, v127
    v_fmac_f32 v133, v121, v127
    v_fmac_f32 v134, v122, v127
    v_mul_f32 v131, v131, v123
    s_waitcnt vmcnt(12)
    s_barrier
    s_add_u32 s97, s98, s0
    s_lshr_b64 s[0:1], s[0:1], 4
    s_and_b32 s97, s97, 15
    s_lshr_b32 s99, s97, 3
    s_xor_b32 s97, s97, s99
    s_add_u32 m0, s87, 36864
    s_lshl_b32 s97, s97, 7
    buffer_load_dwordx4 v240, s[28:31], s97 offen offset:0  lds
    v_mul_f32 v132, v132, v124
    v_mul_f32 v133, v133, v125
    v_mul_f32 v134, v134, v126
    v_cvt_pk_bf16_f32 v110, v134, v133
    v_cvt_pk_bf16_f32 v111, v132, v131
    buffer_load_dwordx4 v241, s[28:31], s97 offen offset:1024  lds
    v_lshlrev_b32 v116, 16, v43
    v_lshlrev_b32 v117, 16, v47
    v_lshlrev_b32 v118, 16, v51
    v_lshlrev_b32 v119, 16, v55
    v_lshlrev_b32 v120, 16, v59
    buffer_load_dwordx4 v242, s[28:31], s97 offen offset:2048  lds
    v_lshlrev_b32 v121, 16, v63
    v_lshlrev_b32 v122, 16, v67
    v_lshlrev_b32 v127, 16, v96
    v_and_b32 v128, 0xffff0000, v96
    v_lshlrev_b32 v129, 16, v97
    buffer_load_dwordx4 v243, s[28:31], s97 offen offset:3072  lds
    v_and_b32 v130, 0xffff0000, v97
    v_lshlrev_b32 v123, 16, v71
    v_lshlrev_b32 v124, 16, v75
    v_lshlrev_b32 v125, 16, v79
    v_lshlrev_b32 v126, 16, v83
    s_add_u32 m0, s88, 36864
    s_mov_b64 exec, 0xffffffff
    buffer_load_dwordx4 v3, s[28:31], s97 offen offset:0  lds
    s_mov_b64 exec, -1
    v_mul_f32 v131, v116, v130
    v_mul_f32 v132, v117, v130
    v_mul_f32 v133, v118, v130
    v_mul_f32 v134, v119, v130
    v_fmac_f32 v131, v117, v129
    s_mul_i32 s16, s97, 3072
    s_add_u32 m0, s60, 49152
    s_add_u32 s99, s16, s62
    buffer_load_dwordx4 v244, s[32:35], s99 offen offset:0  lds
    v_fmac_f32 v132, v118, v129
    v_fmac_f32 v133, v119, v129
    v_fmac_f32 v134, v120, v129
    v_fmac_f32 v131, v118, v128
    v_fmac_f32 v132, v119, v128
    buffer_load_dwordx4 v245, s[32:35], s99 offen offset:1024  lds
    v_fmac_f32 v133, v120, v128
    v_fmac_f32 v134, v121, v128
    v_fmac_f32 v131, v119, v127
    v_fmac_f32 v132, v120, v127
    v_fmac_f32 v133, v121, v127
    buffer_load_dwordx4 v246, s[32:35], s99 offen offset:2048  lds
    v_fmac_f32 v134, v122, v127
    v_mul_f32 v131, v131, v123
    v_mul_f32 v132, v132, v124
    v_mul_f32 v133, v133, v125
    v_mul_f32 v134, v134, v126
    s_add_u32 m0, s61, 61440
    s_add_u32 s16, s16, s63
    buffer_load_dwordx4 v244, s[32:35], s16 offen offset:0  lds
    v_cvt_pk_bf16_f32 v108, v134, v133
    v_cvt_pk_bf16_f32 v109, v132, v131
    s_nop 0
    v_permlane32_swap_b32 v110, v108
    v_permlane32_swap_b32 v111, v109
    s_mov_b32 s89, 32768
    buffer_store_dwordx4 v[108:111], v12, s[52:55], s89 offen sc1
    buffer_load_dwordx4 v245, s[32:35], s16 offen offset:1024  lds
    v_and_b32 v116, 0xffff0000, v41
    v_and_b32 v117, 0xffff0000, v45
    v_and_b32 v118, 0xffff0000, v49
    v_and_b32 v119, 0xffff0000, v53
    v_and_b32 v120, 0xffff0000, v57
    buffer_load_dwordx4 v246, s[32:35], s16 offen offset:2048  lds
    v_and_b32 v121, 0xffff0000, v61
    v_and_b32 v122, 0xffff0000, v65
    v_lshlrev_b32 v127, 16, v90
    v_and_b32 v128, 0xffff0000, v90
    v_lshlrev_b32 v129, 16, v91
    v_and_b32 v130, 0xffff0000, v91
    v_and_b32 v123, 0xffff0000, v69
    v_and_b32 v124, 0xffff0000, v73
    v_and_b32 v125, 0xffff0000, v77
    v_and_b32 v126, 0xffff0000, v81
    v_mul_f32 v131, v116, v130
    v_mul_f32 v132, v117, v130
    s_waitcnt vmcnt(12)
    s_barrier
    s_add_u32 s97, s98, s0
    s_lshr_b64 s[0:1], s[0:1], 4
    s_and_b32 s97, s97, 15
    s_lshr_b32 s99, s97, 3
    s_xor_b32 s97, s97, s99
    s_add_u32 m0, s87, 0
    s_lshl_b32 s97, s97, 7
    buffer_load_dwordx4 v240, s[28:31], s97 offen offset:0  lds
    v_mul_f32 v133, v118, v130
    v_mul_f32 v134, v119, v130
    v_fmac_f32 v131, v117, v129
    v_fmac_f32 v132, v118, v129
    v_fmac_f32 v133, v119, v129
    buffer_load_dwordx4 v241, s[28:31], s97 offen offset:1024  lds
    v_fmac_f32 v134, v120, v129
    v_fmac_f32 v131, v118, v128
    v_fmac_f32 v132, v119, v128
    v_fmac_f32 v133, v120, v128
    v_fmac_f32 v134, v121, v128
    buffer_load_dwordx4 v242, s[28:31], s97 offen offset:2048  lds
    v_fmac_f32 v131, v119, v127
    v_fmac_f32 v132, v120, v127
    v_fmac_f32 v133, v121, v127
    v_fmac_f32 v134, v122, v127
    v_mul_f32 v131, v131, v123
    buffer_load_dwordx4 v243, s[28:31], s97 offen offset:3072  lds
    v_mul_f32 v132, v132, v124
    v_mul_f32 v133, v133, v125
    v_mul_f32 v134, v134, v126
    v_cvt_pk_bf16_f32 v114, v134, v133
    v_cvt_pk_bf16_f32 v115, v132, v131
    s_add_u32 m0, s88, 0
    s_mov_b64 exec, 0xffffffff
    buffer_load_dwordx4 v3, s[28:31], s97 offen offset:0  lds
    s_mov_b64 exec, -1
    v_and_b32 v116, 0xffff0000, v43
    v_and_b32 v117, 0xffff0000, v47
    v_and_b32 v118, 0xffff0000, v51
    v_and_b32 v119, 0xffff0000, v55
    v_and_b32 v120, 0xffff0000, v59
    s_mul_i32 s16, s97, 3072
    s_add_u32 m0, s60, 0
    s_add_u32 s99, s16, s62
    buffer_load_dwordx4 v244, s[32:35], s99 offen offset:0  lds
    v_and_b32 v121, 0xffff0000, v63
    v_and_b32 v122, 0xffff0000, v67
    v_lshlrev_b32 v127, 16, v98
    v_and_b32 v128, 0xffff0000, v98
    v_lshlrev_b32 v129, 16, v99
    buffer_load_dwordx4 v245, s[32:35], s99 offen offset:1024  lds
    v_and_b32 v130, 0xffff0000, v99
    v_and_b32 v123, 0xffff0000, v71
    v_and_b32 v124, 0xffff0000, v75
    v_and_b32 v125, 0xffff0000, v79
    v_and_b32 v126, 0xffff0000, v83
    buffer_load_dwordx4 v246, s[32:35], s99 offen offset:2048  lds
    v_mul_f32 v131, v116, v130
    v_mul_f32 v132, v117, v130
    v_mul_f32 v133, v118, v130
    v_mul_f32 v134, v119, v130
    v_fmac_f32 v131, v117, v129
    s_add_u32 m0, s61, 12288
    s_add_u32 s16, s16, s63
    buffer_load_dwordx4 v244, s[32:35], s16 offen offset:0  lds
    v_fmac_f32 v132, v118, v129
    v_fmac_f32 v133, v119, v129
    v_fmac_f32 v134, v120, v129
    v_fmac_f32 v131, v118, v128
    v_fmac_f32 v132, v119, v128
    buffer_load_dwordx4 v245, s[32:35], s16 offen offset:1024  lds
    v_fmac_f32 v133, v120, v128
    v_fmac_f32 v134, v121, v128
    v_fmac_f32 v131, v119, v127
    v_fmac_f32 v132, v120, v127
    v_fmac_f32 v133, v121, v127
    buffer_load_dwordx4 v246, s[32:35], s16 offen offset:2048  lds
    v_fmac_f32 v134, v122, v127
    v_mul_f32 v131, v131, v123
    v_mul_f32 v132, v132, v124
    v_mul_f32 v133, v133, v125
    v_mul_f32 v134, v134, v126
    v_cvt_pk_bf16_f32 v112, v134, v133
    v_cvt_pk_bf16_f32 v113, v132, v131
    s_nop 0
    v_permlane32_swap_b32 v114, v112
    v_permlane32_swap_b32 v115, v113
    s_mov_b32 s89, 49152
    buffer_store_dwordx4 v[112:115], v12, s[52:55], s89 offen sc1
    s_waitcnt vmcnt(12)
    s_barrier
    s_add_u32 m0, s94, 32
    s_lshl_b32 s89, s90, 12
    buffer_load_dwordx4 v15, s[48:51], s89 offen offset:0 nt lds
    s_add_u32 m0, s94, 32
    s_lshl_b32 s89, s90, 12
    buffer_load_dwordx4 v15, s[48:51], s89 offen offset:1024 nt lds
    s_add_u32 m0, s94, 32
    s_lshl_b32 s89, s90, 12
    buffer_load_dwordx4 v15, s[48:51], s89 offen offset:2048 nt lds
    s_add_u32 m0, s94, 32
    s_lshl_b32 s89, s90, 12
    buffer_load_dwordx4 v15, s[48:51], s89 offen offset:3072 nt lds
    s_add_u32 s97, s98, s0
    s_lshr_b64 s[0:1], s[0:1], 4
    s_and_b32 s97, s97, 15
    s_lshr_b32 s99, s97, 3
    s_xor_b32 s97, s97, s99
    s_add_u32 m0, s87, 18432
    s_lshl_b32 s97, s97, 7
    buffer_load_dwordx4 v240, s[28:31], s97 offen offset:0  lds
    buffer_load_dwordx4 v241, s[28:31], s97 offen offset:1024  lds
    buffer_load_dwordx4 v242, s[28:31], s97 offen offset:2048  lds
    buffer_load_dwordx4 v243, s[28:31], s97 offen offset:3072  lds
    s_add_u32 m0, s88, 18432
    s_mov_b64 exec, 0xffffffff
    buffer_load_dwordx4 v3, s[28:31], s97 offen offset:0  lds
    s_mov_b64 exec, -1
    s_mul_i32 s16, s97, 3072
    s_add_u32 m0, s60, 24576
    s_add_u32 s99, s16, s62
    buffer_load_dwordx4 v244, s[32:35], s99 offen offset:0  lds
    buffer_load_dwordx4 v245, s[32:35], s99 offen offset:1024  lds
    buffer_load_dwordx4 v246, s[32:35], s99 offen offset:2048  lds
    s_add_u32 m0, s61, 36864
    s_add_u32 s16, s16, s63
    buffer_load_dwordx4 v244, s[32:35], s16 offen offset:0  lds
    buffer_load_dwordx4 v245, s[32:35], s16 offen offset:1024  lds
    buffer_load_dwordx4 v246, s[32:35], s16 offen offset:2048  lds
    s_waitcnt vmcnt(16)
    s_waitcnt vmcnt(15)
    s_barrier
    s_add_u32 s97, s98, s0
    s_lshr_b64 s[0:1], s[0:1], 4
    s_and_b32 s97, s97, 15
    s_lshr_b32 s99, s97, 3
    s_xor_b32 s97, s97, s99
    s_add_u32 m0, s87, 36864
    s_lshl_b32 s97, s97, 7
    buffer_load_dwordx4 v240, s[28:31], s97 offen offset:0  lds
    buffer_load_dwordx4 v241, s[28:31], s97 offen offset:1024  lds
    buffer_load_dwordx4 v242, s[28:31], s97 offen offset:2048  lds
    buffer_load_dwordx4 v243, s[28:31], s97 offen offset:3072  lds
    s_add_u32 m0, s88, 36864
    s_mov_b64 exec, 0xffffffff
    buffer_load_dwordx4 v3, s[28:31], s97 offen offset:0  lds
    s_mov_b64 exec, -1
    s_mul_i32 s16, s97, 3072
    s_add_u32 m0, s60, 49152
    s_add_u32 s99, s16, s62
    buffer_load_dwordx4 v244, s[32:35], s99 offen offset:0  lds
    buffer_load_dwordx4 v245, s[32:35], s99 offen offset:1024  lds
    buffer_load_dwordx4 v246, s[32:35], s99 offen offset:2048  lds
    s_add_u32 m0, s61, 61440
    s_add_u32 s16, s16, s63
    buffer_load_dwordx4 v244, s[32:35], s16 offen offset:0  lds
    buffer_load_dwordx4 v245, s[32:35], s16 offen offset:1024  lds
    buffer_load_dwordx4 v246, s[32:35], s16 offen offset:2048  lds
    s_waitcnt vmcnt(11)
    s_barrier
    s_add_u32 s97, s98, s0
    s_lshr_b64 s[0:1], s[0:1], 4
    s_and_b32 s97, s97, 15
    s_lshr_b32 s99, s97, 3
    s_xor_b32 s97, s97, s99
    s_add_u32 m0, s87, 0
    s_lshl_b32 s97, s97, 7
    buffer_load_dwordx4 v240, s[28:31], s97 offen offset:0  lds
    v_add_u32 v5, s94, v15
    ds_read_b128 v[140:143], v5 offset:32
    ds_read_b32 v156, v5 offset:48
    ds_read_b128 v[144:147], v5 offset:1056
    buffer_load_dwordx4 v241, s[28:31], s97 offen offset:1024  lds
    ds_read_b32 v157, v5 offset:1072
    ds_read_b128 v[148:151], v5 offset:2080
    ds_read_b32 v158, v5 offset:2096
    buffer_load_dwordx4 v242, s[28:31], s97 offen offset:2048  lds
    ds_read_b128 v[152:155], v5 offset:3104
    ds_read_b32 v159, v5 offset:3120
    v_lshrrev_b32 v6, 3, v0
    buffer_load_dwordx4 v243, s[28:31], s97 offen offset:3072  lds
    v_mul_u32_u24 v6, 4160, v6
    v_and_b32 v7, 7, v0
    v_lshl_add_u32 v6, v7, 2, v6
    v_add_u32 v6, s94, v6
    s_add_u32 m0, s88, 0
    s_mov_b64 exec, 0xffffffff
    buffer_load_dwordx4 v3, s[28:31], s97 offen offset:0  lds
    s_mov_b64 exec, -1
    v_mov_b32 v7, 0
    s_waitcnt lgkmcnt(0)
    v_readfirstlane_b32 s93, v140
    s_mul_i32 s16, s97, 3072
    s_add_u32 m0, s60, 0
    s_add_u32 s99, s16, s62
    buffer_load_dwordx4 v244, s[32:35], s99 offen offset:0  lds
    s_lshl_b32 s93, s93, 16
    v_writelane_b32 v7, s93, 15
    v_alignbit_b32 v140, v141, v140, 16
    buffer_load_dwordx4 v245, s[32:35], s99 offen offset:1024  lds
    v_alignbit_b32 v141, v142, v141, 16
    v_alignbit_b32 v142, v143, v142, 16
    v_alignbit_b32 v143, v156, v143, 16
    v_alignbit_b32 v144, v145, v144, 16
    buffer_load_dwordx4 v246, s[32:35], s99 offen offset:2048  lds
    v_alignbit_b32 v145, v146, v145, 16
    v_alignbit_b32 v146, v147, v146, 16
    v_alignbit_b32 v147, v157, v147, 16
    s_add_u32 m0, s61, 12288
    s_add_u32 s16, s16, s63
    buffer_load_dwordx4 v244, s[32:35], s16 offen offset:0  lds
    v_alignbit_b32 v148, v149, v148, 16
    v_alignbit_b32 v149, v150, v149, 16
    v_alignbit_b32 v150, v151, v150, 16
    buffer_load_dwordx4 v245, s[32:35], s16 offen offset:1024  lds
    v_alignbit_b32 v151, v158, v151, 16
    v_alignbit_b32 v152, v153, v152, 16
    v_alignbit_b32 v153, v154, v153, 16
    v_alignbit_b32 v154, v155, v154, 16
    buffer_load_dwordx4 v246, s[32:35], s16 offen offset:2048  lds
    v_alignbit_b32 v155, v159, v155, 16
    v_lshlrev_b32 v8, 3, v0
    s_add_u32 s78, s88, 18432
    s_mov_b64 exec, 0xff
    buffer_load_dword v136, v33, s[68:71], 0 offen sc1
    buffer_load_dword v137, v34, s[52:55], 0 offen sc1
    s_mov_b64 exec, -1
    v_add_u32 v8, s78, v8
    v_mov_b32 v156, 0
    v_mov_b32 v157, 0
    s_waitcnt vmcnt(13)
    s_barrier
    s_waitcnt vmcnt(0)
LA_j:
    s_mov_b64 exec, 1
    ds_add_u32 v18, v19 offset:24
    s_mov_b64 exec, -1
    s_mov_b64 exec, 0xff
    v_cmp_ne_u32 vcc, v136, v137
    v_cmp_gt_u32 s[80:81], s96, v136
    s_nop 0
    s_or_b64 vcc, vcc, s[80:81]
    s_cbranch_vccnz LA_slow
LA_back:
    s_mov_b64 exec, -1
    s_add_u32 m0, s86, 94208
    s_add_u32 s89, s91, 0
    buffer_load_dwordx4 v14, s[52:55], s89 offen sc1 lds
    s_add_u32 m0, s86, 98304
    s_add_u32 s89, s91, 4096
    buffer_load_dwordx4 v14, s[52:55], s89 offen sc1 lds
    s_add_u32 m0, s86, 102400
    s_add_u32 s89, s91, 8192
    buffer_load_dwordx4 v14, s[52:55], s89 offen sc1 lds
    s_add_u32 m0, s86, 106496
    s_add_u32 s89, s91, 12288
    buffer_load_dwordx4 v14, s[52:55], s89 offen sc1 lds
    s_mov_b64 exec, 0xffff
    ds_write_b32 v6, v7
    s_mov_b64 exec, -1
    ds_write_b128 v5, v[140:143] offset:4192
    ds_write_b128 v5, v[144:147] offset:5216
    ds_write_b128 v5, v[148:151] offset:6240
    ds_write_b128 v5, v[152:155] offset:7264
    ds_write_b64 v8, v[156:157]
    ds_read2_b32 v[68:69], v21 offset0:0 offset1:1
    ds_read2_b32 v[70:71], v21 offset0:2 offset1:3
    ds_read2_b32 v[72:73], v21 offset0:128 offset1:129
    ds_read2_b32 v[74:75], v21 offset0:130 offset1:131
    ds_read2_b32 v[76:77], v22 offset0:0 offset1:1
    ds_read2_b32 v[78:79], v22 offset0:2 offset1:3
    ds_read2_b32 v[80:81], v22 offset0:128 offset1:129
    ds_read2_b32 v[82:83], v22 offset0:130 offset1:131
    ds_read2_b32 v[84:85], v23 offset0:0 offset1:1
    ds_read2_b32 v[86:87], v23 offset0:2 offset1:3
    ds_read2_b32 v[88:89], v23 offset0:128 offset1:129
    ds_read2_b32 v[90:91], v23 offset0:130 offset1:131
    ds_read2_b32 v[92:93], v24 offset0:0 offset1:1
    ds_read2_b32 v[94:95], v24 offset0:2 offset1:3
    ds_read2_b32 v[96:97], v24 offset0:128 offset1:129
    ds_read2_b32 v[98:99], v24 offset0:130 offset1:131
    s_waitcnt vmcnt(0)
    s_mov_b64 exec, 1
    ds_add_u32 v18, v19 offset:20
    s_mov_b64 exec, -1
    buffer_load_dwordx4 v[212:215], v9, s[56:59], 0 offen offset:0 nt
    buffer_load_dwordx4 v[216:219], v9, s[56:59], 0 offen offset:2048 nt
    buffer_load_dwordx4 v[220:223], v9, s[56:59], s96 offen offset:0 nt
    buffer_load_dwordx4 v[224:227], v9, s[56:59], s96 offen offset:2048 nt
    s_branch LA_s5_in
LA_s5:
    s_sleep 1
LA_s5_in:
    ds_read_b32 v6, v18 offset:20
    s_waitcnt lgkmcnt(0)
    v_readfirstlane_b32 s78, v6
    s_nop 0
    s_cmp_ge_u32 s78, 4
    s_cbranch_scc0 LA_s5
    s_mov_b64 exec, 1
    ds_add_u32 v18, v19 offset:8
    s_mov_b64 exec, -1
    ds_read_b128 v[100:103], v25 offset:0
    ds_read_b128 v[104:107], v25 offset:2048
    ds_read_b128 v[108:111], v25 offset:4096
    ds_read_b128 v[112:115], v25 offset:6144
    ds_read_b128 v[116:119], v25 offset:8192
    ds_read_b128 v[120:123], v25 offset:10240
    ds_read_b128 v[124:127], v25 offset:12288
    ds_read_b128 v[128:131], v25 offset:14336
    s_setprio 2
    s_waitcnt lgkmcnt(7)
    v_mfma_f32_16x16x32_bf16 v[36:39], v[236:239], v[100:103], 0
    ds_read2_b32 v[132:133], v21 offset0:16 offset1:17
    s_waitcnt lgkmcnt(7)
    v_mfma_f32_16x16x32_bf16 v[40:43], v[236:239], v[104:107], 0
    ds_read2_b32 v[134:135], v21 offset0:18 offset1:19
    s_waitcnt lgkmcnt(7)
    v_mfma_f32_16x16x32_bf16 v[44:47], v[236:239], v[108:111], 0
    s_waitcnt lgkmcnt(6)
    v_mfma_f32_16x16x32_bf16 v[48:51], v[236:239], v[112:115], 0
    ds_read_b128 v[164:167], v26 offset:0
    s_waitcnt lgkmcnt(6)
    v_mfma_f32_16x16x32_bf16 v[52:55], v[236:239], v[116:119], 0
    s_waitcnt lgkmcnt(5)
    v_mfma_f32_16x16x32_bf16 v[56:59], v[236:239], v[120:123], 0
    ds_read_b128 v[168:171], v26 offset:2048
    s_waitcnt lgkmcnt(5)
    v_mfma_f32_16x16x32_bf16 v[60:63], v[236:239], v[124:127], 0
    ds_read_b128 v[172:175], v26 offset:4096
    s_waitcnt lgkmcnt(5)
    v_mfma_f32_16x16x32_bf16 v[64:67], v[236:239], v[128:131], 0
    v_mfma_f32_16x16x32_bf16 v[36:39], v[68:71], v[100:103], v[36:39]
    ds_read_b128 v[176:179], v26 offset:6144
    v_mfma_f32_16x16x32_bf16 v[40:43], v[68:71], v[104:107], v[40:43]
    v_mfma_f32_16x16x32_bf16 v[44:47], v[68:71], v[108:111], v[44:47]
    ds_read_b128 v[180:183], v26 offset:8192
    v_mfma_f32_16x16x32_bf16 v[48:51], v[68:71], v[112:115], v[48:51]
    ds_read_b128 v[184:187], v26 offset:10240
    v_mfma_f32_16x16x32_bf16 v[52:55], v[68:71], v[116:119], v[52:55]
    v_mfma_f32_16x16x32_bf16 v[56:59], v[68:71], v[120:123], v[56:59]
    ds_read_b128 v[188:191], v26 offset:12288
    v_mfma_f32_16x16x32_bf16 v[60:63], v[68:71], v[124:127], v[60:63]
    v_mfma_f32_16x16x32_bf16 v[64:67], v[68:71], v[128:131], v[64:67]
    ds_read_b128 v[192:195], v26 offset:14336
    v_mfma_f32_16x16x32_bf16 v[40:43], v[72:75], v[100:103], v[40:43]
    ds_read2_b32 v[136:137], v21 offset0:144 offset1:145
    v_mfma_f32_16x16x32_bf16 v[44:47], v[72:75], v[104:107], v[44:47]
    v_mfma_f32_16x16x32_bf16 v[48:51], v[72:75], v[108:111], v[48:51]
    ds_read2_b32 v[138:139], v21 offset0:146 offset1:147
    v_mfma_f32_16x16x32_bf16 v[52:55], v[72:75], v[112:115], v[52:55]
    v_mfma_f32_16x16x32_bf16 v[56:59], v[72:75], v[116:119], v[56:59]
    ds_read2_b32 v[140:141], v22 offset0:16 offset1:17
    v_mfma_f32_16x16x32_bf16 v[60:63], v[72:75], v[120:123], v[60:63]
    ds_read2_b32 v[142:143], v22 offset0:18 offset1:19
    v_mfma_f32_16x16x32_bf16 v[64:67], v[72:75], v[124:127], v[64:67]
    v_mfma_f32_16x16x32_bf16 v[44:47], v[76:79], v[100:103], v[44:47]
    ds_read2_b32 v[144:145], v22 offset0:144 offset1:145
    v_mfma_f32_16x16x32_bf16 v[48:51], v[76:79], v[104:107], v[48:51]
    v_mfma_f32_16x16x32_bf16 v[52:55], v[76:79], v[108:111], v[52:55]
    ds_read2_b32 v[146:147], v22 offset0:146 offset1:147
    v_mfma_f32_16x16x32_bf16 v[56:59], v[76:79], v[112:115], v[56:59]
    ds_read2_b32 v[148:149], v23 offset0:16 offset1:17
    v_mfma_f32_16x16x32_bf16 v[60:63], v[76:79], v[116:119], v[60:63]
    v_mfma_f32_16x16x32_bf16 v[64:67], v[76:79], v[120:123], v[64:67]
    ds_read2_b32 v[150:151], v23 offset0:18 offset1:19
    v_mfma_f32_16x16x32_bf16 v[48:51], v[80:83], v[100:103], v[48:51]
    v_mfma_f32_16x16x32_bf16 v[52:55], v[80:83], v[104:107], v[52:55]
    ds_read2_b32 v[152:153], v23 offset0:144 offset1:145
    v_mfma_f32_16x16x32_bf16 v[56:59], v[80:83], v[108:111], v[56:59]
    ds_read2_b32 v[154:155], v23 offset0:146 offset1:147
    v_mfma_f32_16x16x32_bf16 v[60:63], v[80:83], v[112:115], v[60:63]
    v_mfma_f32_16x16x32_bf16 v[64:67], v[80:83], v[116:119], v[64:67]
    ds_read2_b32 v[156:157], v24 offset0:16 offset1:17
    v_mfma_f32_16x16x32_bf16 v[52:55], v[84:87], v[100:103], v[52:55]
    v_mfma_f32_16x16x32_bf16 v[56:59], v[84:87], v[104:107], v[56:59]
    ds_read2_b32 v[158:159], v24 offset0:18 offset1:19
    v_mfma_f32_16x16x32_bf16 v[60:63], v[84:87], v[108:111], v[60:63]
    ds_read2_b32 v[160:161], v24 offset0:144 offset1:145
    v_mfma_f32_16x16x32_bf16 v[64:67], v[84:87], v[112:115], v[64:67]
    v_mfma_f32_16x16x32_bf16 v[56:59], v[88:91], v[100:103], v[56:59]
    ds_read2_b32 v[162:163], v24 offset0:146 offset1:147
    v_mfma_f32_16x16x32_bf16 v[60:63], v[88:91], v[104:107], v[60:63]
    v_mfma_f32_16x16x32_bf16 v[64:67], v[88:91], v[108:111], v[64:67]
    v_mfma_f32_16x16x32_bf16 v[60:63], v[92:95], v[100:103], v[60:63]
    v_mfma_f32_16x16x32_bf16 v[64:67], v[92:95], v[104:107], v[64:67]
    v_mfma_f32_16x16x32_bf16 v[64:67], v[96:99], v[100:103], v[64:67]
    s_waitcnt lgkmcnt(14)
    v_mfma_f32_16x16x32_bf16 v[36:39], v[132:135], v[164:167], v[36:39]
    ds_read2_b32 v[68:69], v21 offset0:32 offset1:33
    v_mfma_f32_16x16x32_bf16 v[40:43], v[132:135], v[168:171], v[40:43]
    ds_read2_b32 v[70:71], v21 offset0:34 offset1:35
    v_mfma_f32_16x16x32_bf16 v[44:47], v[132:135], v[172:175], v[44:47]
    ds_read_b128 v[100:103], v27 offset:0
    v_mfma_f32_16x16x32_bf16 v[48:51], v[132:135], v[176:179], v[48:51]
    v_mfma_f32_16x16x32_bf16 v[52:55], v[132:135], v[180:183], v[52:55]
    ds_read_b128 v[104:107], v27 offset:2048
    v_mfma_f32_16x16x32_bf16 v[56:59], v[132:135], v[184:187], v[56:59]
    ds_read_b128 v[108:111], v27 offset:4096
    v_mfma_f32_16x16x32_bf16 v[60:63], v[132:135], v[188:191], v[60:63]
    ds_read_b128 v[112:115], v27 offset:6144
    v_mfma_f32_16x16x32_bf16 v[64:67], v[132:135], v[192:195], v[64:67]
    s_waitcnt lgkmcnt(14)
    v_mfma_f32_16x16x32_bf16 v[40:43], v[136:139], v[164:167], v[40:43]
    ds_read_b128 v[116:119], v27 offset:8192
    v_mfma_f32_16x16x32_bf16 v[44:47], v[136:139], v[168:171], v[44:47]
    ds_read_b128 v[120:123], v27 offset:10240
    v_mfma_f32_16x16x32_bf16 v[48:51], v[136:139], v[172:175], v[48:51]
    ds_read_b128 v[124:127], v27 offset:12288
    v_mfma_f32_16x16x32_bf16 v[52:55], v[136:139], v[176:179], v[52:55]
    v_mfma_f32_16x16x32_bf16 v[56:59], v[136:139], v[180:183], v[56:59]
    ds_read_b128 v[128:131], v27 offset:14336
    v_mfma_f32_16x16x32_bf16 v[60:63], v[136:139], v[184:187], v[60:63]
    ds_read2_b32 v[72:73], v21 offset0:160 offset1:161
    v_mfma_f32_16x16x32_bf16 v[64:67], v[136:139], v[188:191], v[64:67]
    ds_read2_b32 v[74:75], v21 offset0:162 offset1:163
    v_mfma_f32_16x16x32_bf16 v[44:47], v[140:143], v[164:167], v[44:47]
    v_mfma_f32_16x16x32_bf16 v[48:51], v[140:143], v[168:171], v[48:51]
    ds_read2_b32 v[76:77], v22 offset0:32 offset1:33
    v_mfma_f32_16x16x32_bf16 v[52:55], v[140:143], v[172:175], v[52:55]
    ds_read2_b32 v[78:79], v22 offset0:34 offset1:35
    v_mfma_f32_16x16x32_bf16 v[56:59], v[140:143], v[176:179], v[56:59]
    ds_read2_b32 v[80:81], v22 offset0:160 offset1:161
    v_mfma_f32_16x16x32_bf16 v[60:63], v[140:143], v[180:183], v[60:63]
    v_mfma_f32_16x16x32_bf16 v[64:67], v[140:143], v[184:187], v[64:67]
    ds_read2_b32 v[82:83], v22 offset0:162 offset1:163
    v_mfma_f32_16x16x32_bf16 v[48:51], v[144:147], v[164:167], v[48:51]
    ds_read2_b32 v[84:85], v23 offset0:32 offset1:33
    v_mfma_f32_16x16x32_bf16 v[52:55], v[144:147], v[168:171], v[52:55]
    ds_read2_b32 v[86:87], v23 offset0:34 offset1:35
    v_mfma_f32_16x16x32_bf16 v[56:59], v[144:147], v[172:175], v[56:59]
    v_mfma_f32_16x16x32_bf16 v[60:63], v[144:147], v[176:179], v[60:63]
    ds_read2_b32 v[88:89], v23 offset0:160 offset1:161
    v_mfma_f32_16x16x32_bf16 v[64:67], v[144:147], v[180:183], v[64:67]
    ds_read2_b32 v[90:91], v23 offset0:162 offset1:163
    s_waitcnt lgkmcnt(14)
    v_mfma_f32_16x16x32_bf16 v[52:55], v[148:151], v[164:167], v[52:55]
    ds_read2_b32 v[92:93], v24 offset0:32 offset1:33
    v_mfma_f32_16x16x32_bf16 v[56:59], v[148:151], v[168:171], v[56:59]
    v_mfma_f32_16x16x32_bf16 v[60:63], v[148:151], v[172:175], v[60:63]
    ds_read2_b32 v[94:95], v24 offset0:34 offset1:35
    v_mfma_f32_16x16x32_bf16 v[64:67], v[148:151], v[176:179], v[64:67]
    ds_read2_b32 v[96:97], v24 offset0:160 offset1:161
    v_mfma_f32_16x16x32_bf16 v[56:59], v[152:155], v[164:167], v[56:59]
    ds_read2_b32 v[98:99], v24 offset0:162 offset1:163
    v_mfma_f32_16x16x32_bf16 v[60:63], v[152:155], v[168:171], v[60:63]
    v_mfma_f32_16x16x32_bf16 v[64:67], v[152:155], v[172:175], v[64:67]
    v_mfma_f32_16x16x32_bf16 v[60:63], v[156:159], v[164:167], v[60:63]
    v_mfma_f32_16x16x32_bf16 v[64:67], v[156:159], v[168:171], v[64:67]
    v_mfma_f32_16x16x32_bf16 v[64:67], v[160:163], v[164:167], v[64:67]
    v_mfma_f32_16x16x32_bf16 v[36:39], v[68:71], v[100:103], v[36:39]
    ds_read2_b32 v[132:133], v21 offset0:48 offset1:49
    v_mfma_f32_16x16x32_bf16 v[40:43], v[68:71], v[104:107], v[40:43]
    ds_read2_b32 v[134:135], v21 offset0:50 offset1:51
    v_mfma_f32_16x16x32_bf16 v[44:47], v[68:71], v[108:111], v[44:47]
    ds_read_b128 v[164:167], v28 offset:0
    v_mfma_f32_16x16x32_bf16 v[48:51], v[68:71], v[112:115], v[48:51]
    s_waitcnt lgkmcnt(14)
    v_mfma_f32_16x16x32_bf16 v[52:55], v[68:71], v[116:119], v[52:55]
    ds_read_b128 v[168:171], v28 offset:2048
    v_mfma_f32_16x16x32_bf16 v[56:59], v[68:71], v[120:123], v[56:59]
    ds_read_b128 v[172:175], v28 offset:4096
    v_mfma_f32_16x16x32_bf16 v[60:63], v[68:71], v[124:127], v[60:63]
    ds_read_b128 v[176:179], v28 offset:6144
    v_mfma_f32_16x16x32_bf16 v[64:67], v[68:71], v[128:131], v[64:67]
    v_mfma_f32_16x16x32_bf16 v[40:43], v[72:75], v[100:103], v[40:43]
    ds_read_b128 v[180:183], v28 offset:8192
    v_mfma_f32_16x16x32_bf16 v[44:47], v[72:75], v[104:107], v[44:47]
    ds_read_b128 v[184:187], v28 offset:10240
    v_mfma_f32_16x16x32_bf16 v[48:51], v[72:75], v[108:111], v[48:51]
    ds_read_b128 v[188:191], v28 offset:12288
    v_mfma_f32_16x16x32_bf16 v[52:55], v[72:75], v[112:115], v[52:55]
    v_mfma_f32_16x16x32_bf16 v[56:59], v[72:75], v[116:119], v[56:59]
    ds_read_b128 v[192:195], v28 offset:14336
    v_mfma_f32_16x16x32_bf16 v[60:63], v[72:75], v[120:123], v[60:63]
    ds_read2_b32 v[136:137], v21 offset0:176 offset1:177
    v_mfma_f32_16x16x32_bf16 v[64:67], v[72:75], v[124:127], v[64:67]
    ds_read2_b32 v[138:139], v21 offset0:178 offset1:179
    s_waitcnt lgkmcnt(14)
    v_mfma_f32_16x16x32_bf16 v[44:47], v[76:79], v[100:103], v[44:47]
    v_mfma_f32_16x16x32_bf16 v[48:51], v[76:79], v[104:107], v[48:51]
    ds_read2_b32 v[140:141], v22 offset0:48 offset1:49
    v_mfma_f32_16x16x32_bf16 v[52:55], v[76:79], v[108:111], v[52:55]
    ds_read2_b32 v[142:143], v22 offset0:50 offset1:51
    v_mfma_f32_16x16x32_bf16 v[56:59], v[76:79], v[112:115], v[56:59]
    ds_read2_b32 v[144:145], v22 offset0:176 offset1:177
    v_mfma_f32_16x16x32_bf16 v[60:63], v[76:79], v[116:119], v[60:63]
    v_mfma_f32_16x16x32_bf16 v[64:67], v[76:79], v[120:123], v[64:67]
    ds_read2_b32 v[146:147], v22 offset0:178 offset1:179
    v_mfma_f32_16x16x32_bf16 v[48:51], v[80:83], v[100:103], v[48:51]
    ds_read2_b32 v[148:149], v23 offset0:48 offset1:49
    v_mfma_f32_16x16x32_bf16 v[52:55], v[80:83], v[104:107], v[52:55]
    ds_read2_b32 v[150:151], v23 offset0:50 offset1:51
    v_mfma_f32_16x16x32_bf16 v[56:59], v[80:83], v[108:111], v[56:59]
    v_mfma_f32_16x16x32_bf16 v[60:63], v[80:83], v[112:115], v[60:63]
    ds_read2_b32 v[152:153], v23 offset0:176 offset1:177
    v_mfma_f32_16x16x32_bf16 v[64:67], v[80:83], v[116:119], v[64:67]
    ds_read2_b32 v[154:155], v23 offset0:178 offset1:179
    v_mfma_f32_16x16x32_bf16 v[52:55], v[84:87], v[100:103], v[52:55]
    ds_read2_b32 v[156:157], v24 offset0:48 offset1:49
    v_mfma_f32_16x16x32_bf16 v[56:59], v[84:87], v[104:107], v[56:59]
    v_mfma_f32_16x16x32_bf16 v[60:63], v[84:87], v[108:111], v[60:63]
    ds_read2_b32 v[158:159], v24 offset0:50 offset1:51
    v_mfma_f32_16x16x32_bf16 v[64:67], v[84:87], v[112:115], v[64:67]
    ds_read2_b32 v[160:161], v24 offset0:176 offset1:177
    v_mfma_f32_16x16x32_bf16 v[56:59], v[88:91], v[100:103], v[56:59]
    ds_read2_b32 v[162:163], v24 offset0:178 offset1:179
    v_mfma_f32_16x16x32_bf16 v[60:63], v[88:91], v[104:107], v[60:63]
    v_mfma_f32_16x16x32_bf16 v[64:67], v[88:91], v[108:111], v[64:67]
    v_mfma_f32_16x16x32_bf16 v[60:63], v[92:95], v[100:103], v[60:63]
    v_mfma_f32_16x16x32_bf16 v[64:67], v[92:95], v[104:107], v[64:67]
    s_waitcnt lgkmcnt(14)
    v_mfma_f32_16x16x32_bf16 v[64:67], v[96:99], v[100:103], v[64:67]
    v_mfma_f32_16x16x32_bf16 v[36:39], v[132:135], v[164:167], v[36:39]
    ds_read2_b32 v[68:69], v21 offset0:64 offset1:65
    s_and_b32 s78, s77, 7
    v_mfma_f32_16x16x32_bf16 v[40:43], v[132:135], v[168:171], v[40:43]
    ds_read2_b32 v[70:71], v21 offset0:66 offset1:67
    s_mov_b32 s97, 0x76543210
    v_mfma_f32_16x16x32_bf16 v[44:47], v[132:135], v[172:175], v[44:47]
    ds_read_b128 v[100:103], v29 offset:0
    v_mfma_f32_16x16x32_bf16 v[48:51], v[132:135], v[176:179], v[48:51]
    s_cmp_eq_u32 s78, 1
    v_mfma_f32_16x16x32_bf16 v[52:55], v[132:135], v[180:183], v[52:55]
    ds_read_b128 v[104:107], v29 offset:2048
    s_cselect_b32 s97, 0x76543201, s97
    v_mfma_f32_16x16x32_bf16 v[56:59], v[132:135], v[184:187], v[56:59]
    ds_read_b128 v[108:111], v29 offset:4096
    v_mfma_f32_16x16x32_bf16 v[60:63], v[132:135], v[188:191], v[60:63]
    ds_read_b128 v[112:115], v29 offset:6144
    s_cmp_eq_u32 s78, 2
    v_mfma_f32_16x16x32_bf16 v[64:67], v[132:135], v[192:195], v[64:67]
    s_cselect_b32 s97, 0x76543120, s97
    s_waitcnt lgkmcnt(14)
    v_mfma_f32_16x16x32_bf16 v[40:43], v[136:139], v[164:167], v[40:43]
    ds_read_b128 v[116:119], v29 offset:8192
    v_mfma_f32_16x16x32_bf16 v[44:47], v[136:139], v[168:171], v[44:47]
    ds_read_b128 v[120:123], v29 offset:10240
    s_cmp_eq_u32 s78, 3
    v_mfma_f32_16x16x32_bf16 v[48:51], v[136:139], v[172:175], v[48:51]
    ds_read_b128 v[124:127], v29 offset:12288
    s_cselect_b32 s97, 0x76542310, s97
    v_mfma_f32_16x16x32_bf16 v[52:55], v[136:139], v[176:179], v[52:55]
    v_mfma_f32_16x16x32_bf16 v[56:59], v[136:139], v[180:183], v[56:59]
    ds_read_b128 v[128:131], v29 offset:14336
    s_cmp_eq_u32 s78, 4
    v_mfma_f32_16x16x32_bf16 v[60:63], v[136:139], v[184:187], v[60:63]
    ds_read2_b32 v[72:73], v21 offset0:192 offset1:193
    v_mfma_f32_16x16x32_bf16 v[64:67], v[136:139], v[188:191], v[64:67]
    ds_read2_b32 v[74:75], v21 offset0:194 offset1:195
    s_cselect_b32 s97, 0x76534210, s97
    v_mfma_f32_16x16x32_bf16 v[44:47], v[140:143], v[164:167], v[44:47]
    s_cmp_eq_u32 s78, 5
    v_mfma_f32_16x16x32_bf16 v[48:51], v[140:143], v[168:171], v[48:51]
    ds_read2_b32 v[76:77], v22 offset0:64 offset1:65
    v_mfma_f32_16x16x32_bf16 v[52:55], v[140:143], v[172:175], v[52:55]
    ds_read2_b32 v[78:79], v22 offset0:66 offset1:67
    s_cselect_b32 s97, 0x76453210, s97
    v_mfma_f32_16x16x32_bf16 v[56:59], v[140:143], v[176:179], v[56:59]
    ds_read2_b32 v[80:81], v22 offset0:192 offset1:193
    s_cmp_eq_u32 s78, 6
    v_mfma_f32_16x16x32_bf16 v[60:63], v[140:143], v[180:183], v[60:63]
    v_mfma_f32_16x16x32_bf16 v[64:67], v[140:143], v[184:187], v[64:67]
    ds_read2_b32 v[82:83], v22 offset0:194 offset1:195
    s_cselect_b32 s97, 0x75643210, s97
    v_mfma_f32_16x16x32_bf16 v[48:51], v[144:147], v[164:167], v[48:51]
    ds_read2_b32 v[84:85], v23 offset0:64 offset1:65
    s_cmp_eq_u32 s78, 7
    v_mfma_f32_16x16x32_bf16 v[52:55], v[144:147], v[168:171], v[52:55]
    ds_read2_b32 v[86:87], v23 offset0:66 offset1:67
    v_mfma_f32_16x16x32_bf16 v[56:59], v[144:147], v[172:175], v[56:59]
    s_cselect_b32 s97, 0x67543210, s97
    v_mfma_f32_16x16x32_bf16 v[60:63], v[144:147], v[176:179], v[60:63]
    ds_read2_b32 v[88:89], v23 offset0:192 offset1:193
    v_mfma_f32_16x16x32_bf16 v[64:67], v[144:147], v[180:183], v[64:67]
    ds_read2_b32 v[90:91], v23 offset0:194 offset1:195
    s_and_b32 s78, s76, 3
    s_waitcnt lgkmcnt(14)
    v_mfma_f32_16x16x32_bf16 v[52:55], v[148:151], v[164:167], v[52:55]
    ds_read2_b32 v[92:93], v24 offset0:64 offset1:65
    s_mul_i32 s78, s78, 0x22222222
    v_mfma_f32_16x16x32_bf16 v[56:59], v[148:151], v[168:171], v[56:59]
    v_mfma_f32_16x16x32_bf16 v[60:63], v[148:151], v[172:175], v[60:63]
    ds_read2_b32 v[94:95], v24 offset0:66 offset1:67
    s_add_u32 s97, s97, s78
    v_mfma_f32_16x16x32_bf16 v[64:67], v[148:151], v[176:179], v[64:67]
    ds_read2_b32 v[96:97], v24 offset0:192 offset1:193
    s_bfe_u32 s99, s97, 0x3001c
    v_mfma_f32_16x16x32_bf16 v[56:59], v[152:155], v[164:167], v[56:59]
    ds_read2_b32 v[98:99], v24 offset0:194 offset1:195
    v_mfma_f32_16x16x32_bf16 v[60:63], v[152:155], v[168:171], v[60:63]
    s_lshl_b32 s99, s99, 18
    v_mfma_f32_16x16x32_bf16 v[64:67], v[152:155], v[172:175], v[64:67]
    s_bfe_u32 s97, s97, 0x30018
    v_mfma_f32_16x16x32_bf16 v[60:63], v[156:159], v[164:167], v[60:63]
    v_mfma_f32_16x16x32_bf16 v[64:67], v[156:159], v[168:171], v[64:67]
    s_lshl_b32 s97, s97, 18
    v_mfma_f32_16x16x32_bf16 v[64:67], v[160:163], v[164:167], v[64:67]
    v_mfma_f32_16x16x32_bf16 v[36:39], v[68:71], v[100:103], v[36:39]
    ds_read2_b32 v[132:133], v21 offset0:80 offset1:81
    v_lshrrev_b32 v5, 4, v0
    v_mfma_f32_16x16x32_bf16 v[40:43], v[68:71], v[104:107], v[40:43]
    ds_read2_b32 v[134:135], v21 offset0:82 offset1:83
    v_mfma_f32_16x16x32_bf16 v[44:47], v[68:71], v[108:111], v[44:47]
    ds_read_b128 v[164:167], v30 offset:0
    v_mfma_f32_16x16x32_bf16 v[48:51], v[68:71], v[112:115], v[48:51]
    v_lshlrev_b32 v5, 1, v5
    s_waitcnt lgkmcnt(14)
    v_mfma_f32_16x16x32_bf16 v[52:55], v[68:71], v[116:119], v[52:55]
    ds_read_b128 v[168:171], v30 offset:2048
    v_mfma_f32_16x16x32_bf16 v[56:59], v[68:71], v[120:123], v[56:59]
    ds_read_b128 v[172:175], v30 offset:4096
    v_mfma_f32_16x16x32_bf16 v[60:63], v[68:71], v[124:127], v[60:63]
    ds_read_b128 v[176:179], v30 offset:6144
    v_and_b32 v8, 7, v0
    v_mfma_f32_16x16x32_bf16 v[64:67], v[68:71], v[128:131], v[64:67]
    v_mfma_f32_16x16x32_bf16 v[40:43], v[72:75], v[100:103], v[40:43]
    ds_read_b128 v[180:183], v30 offset:8192
    v_mfma_f32_16x16x32_bf16 v[44:47], v[72:75], v[104:107], v[44:47]
    ds_read_b128 v[184:187], v30 offset:10240
    v_xor_b32 v5, v5, v8
    v_mfma_f32_16x16x32_bf16 v[48:51], v[72:75], v[108:111], v[48:51]
    ds_read_b128 v[188:191], v30 offset:12288
    v_mfma_f32_16x16x32_bf16 v[52:55], v[72:75], v[112:115], v[52:55]
    v_mfma_f32_16x16x32_bf16 v[56:59], v[72:75], v[116:119], v[56:59]
    ds_read_b128 v[192:195], v30 offset:14336
    v_mfma_f32_16x16x32_bf16 v[60:63], v[72:75], v[120:123], v[60:63]
    ds_read2_b32 v[136:137], v21 offset0:208 offset1:209
    v_lshlrev_b32 v5, 4, v5
    v_mfma_f32_16x16x32_bf16 v[64:67], v[72:75], v[124:127], v[64:67]
    ds_read2_b32 v[138:139], v21 offset0:210 offset1:211
    s_waitcnt lgkmcnt(14)
    v_mfma_f32_16x16x32_bf16 v[44:47], v[76:79], v[100:103], v[44:47]
    v_mfma_f32_16x16x32_bf16 v[48:51], v[76:79], v[104:107], v[48:51]
    ds_read2_b32 v[140:141], v22 offset0:80 offset1:81
    v_lshrrev_b32 v8, 3, v0
    v_mfma_f32_16x16x32_bf16 v[52:55], v[76:79], v[108:111], v[52:55]
    ds_read2_b32 v[142:143], v22 offset0:82 offset1:83
    v_mfma_f32_16x16x32_bf16 v[56:59], v[76:79], v[112:115], v[56:59]
    ds_read2_b32 v[144:145], v22 offset0:208 offset1:209
    v_mfma_f32_16x16x32_bf16 v[60:63], v[76:79], v[116:119], v[60:63]
    v_lshl_add_u32 v5, v8, 11, v5
    v_mfma_f32_16x16x32_bf16 v[64:67], v[76:79], v[120:123], v[64:67]
    ds_read2_b32 v[146:147], v22 offset0:210 offset1:211
    v_mfma_f32_16x16x32_bf16 v[48:51], v[80:83], v[100:103], v[48:51]
    ds_read2_b32 v[148:149], v23 offset0:80 offset1:81
    v_mfma_f32_16x16x32_bf16 v[52:55], v[80:83], v[104:107], v[52:55]
    ds_read2_b32 v[150:151], v23 offset0:82 offset1:83
    s_lshl_b32 s78, s77, 7
    v_mfma_f32_16x16x32_bf16 v[56:59], v[80:83], v[108:111], v[56:59]
    v_mfma_f32_16x16x32_bf16 v[60:63], v[80:83], v[112:115], v[60:63]
    ds_read2_b32 v[152:153], v23 offset0:208 offset1:209
    v_mfma_f32_16x16x32_bf16 v[64:67], v[80:83], v[116:119], v[64:67]
    ds_read2_b32 v[154:155], v23 offset0:210 offset1:211
    v_mfma_f32_16x16x32_bf16 v[52:55], v[84:87], v[100:103], v[52:55]
    ds_read2_b32 v[156:157], v24 offset0:80 offset1:81
    s_lshl_b32 s79, s3, 14
    v_mfma_f32_16x16x32_bf16 v[56:59], v[84:87], v[104:107], v[56:59]
    v_mfma_f32_16x16x32_bf16 v[60:63], v[84:87], v[108:111], v[60:63]
    ds_read2_b32 v[158:159], v24 offset0:82 offset1:83
    v_mfma_f32_16x16x32_bf16 v[64:67], v[84:87], v[112:115], v[64:67]
    ds_read2_b32 v[160:161], v24 offset0:208 offset1:209
    s_add_u32 s78, s78, s79
    v_mfma_f32_16x16x32_bf16 v[56:59], v[88:91], v[100:103], v[56:59]
    ds_read2_b32 v[162:163], v24 offset0:210 offset1:211
    v_mfma_f32_16x16x32_bf16 v[60:63], v[88:91], v[104:107], v[60:63]
    v_mfma_f32_16x16x32_bf16 v[64:67], v[88:91], v[108:111], v[64:67]
    v_add_u32 v17, s78, v5
    v_mfma_f32_16x16x32_bf16 v[60:63], v[92:95], v[100:103], v[60:63]
    v_mfma_f32_16x16x32_bf16 v[64:67], v[92:95], v[104:107], v[64:67]
    s_waitcnt lgkmcnt(14)
    v_mfma_f32_16x16x32_bf16 v[64:67], v[96:99], v[100:103], v[64:67]
    v_mfma_f32_16x16x32_bf16 v[36:39], v[132:135], v[164:167], v[36:39]
    ds_read2_b32 v[68:69], v21 offset0:96 offset1:97
    s_waitcnt vmcnt(3)
    v_lshlrev_b32 v196, 16, v212
    v_mfma_f32_16x16x32_bf16 v[40:43], v[132:135], v[168:171], v[40:43]
    ds_read2_b32 v[70:71], v21 offset0:98 offset1:99
    v_mfma_f32_16x16x32_bf16 v[44:47], v[132:135], v[172:175], v[44:47]
    ds_read_b128 v[100:103], v31 offset:0
    v_and_b32 v197, 0xffff0000, v212
    v_mfma_f32_16x16x32_bf16 v[48:51], v[132:135], v[176:179], v[48:51]
    v_mfma_f32_16x16x32_bf16 v[52:55], v[132:135], v[180:183], v[52:55]
    ds_read_b128 v[104:107], v31 offset:2048
    v_lshlrev_b32 v198, 16, v213
    v_mfma_f32_16x16x32_bf16 v[56:59], v[132:135], v[184:187], v[56:59]
    ds_read_b128 v[108:111], v31 offset:4096
    v_mfma_f32_16x16x32_bf16 v[60:63], v[132:135], v[188:191], v[60:63]
    ds_read_b128 v[112:115], v31 offset:6144
    v_and_b32 v199, 0xffff0000, v213
    v_mfma_f32_16x16x32_bf16 v[64:67], v[132:135], v[192:195], v[64:67]
    s_waitcnt lgkmcnt(14)
    v_mfma_f32_16x16x32_bf16 v[40:43], v[136:139], v[164:167], v[40:43]
    ds_read_b128 v[116:119], v31 offset:8192
    v_mfma_f32_16x16x32_bf16 v[44:47], v[136:139], v[168:171], v[44:47]
    ds_read_b128 v[120:123], v31 offset:10240
    v_lshlrev_b32 v200, 16, v214
    v_mfma_f32_16x16x32_bf16 v[48:51], v[136:139], v[172:175], v[48:51]
    ds_read_b128 v[124:127], v31 offset:12288
    v_mfma_f32_16x16x32_bf16 v[52:55], v[136:139], v[176:179], v[52:55]
    v_and_b32 v201, 0xffff0000, v214
    v_mfma_f32_16x16x32_bf16 v[56:59], v[136:139], v[180:183], v[56:59]
    ds_read_b128 v[128:131], v31 offset:14336
    v_mfma_f32_16x16x32_bf16 v[60:63], v[136:139], v[184:187], v[60:63]
    ds_read2_b32 v[72:73], v21 offset0:224 offset1:225
    v_lshlrev_b32 v202, 16, v215
    v_mfma_f32_16x16x32_bf16 v[64:67], v[136:139], v[188:191], v[64:67]
    ds_read2_b32 v[74:75], v21 offset0:226 offset1:227
    v_mfma_f32_16x16x32_bf16 v[44:47], v[140:143], v[164:167], v[44:47]
    v_and_b32 v203, 0xffff0000, v215
    v_mfma_f32_16x16x32_bf16 v[48:51], v[140:143], v[168:171], v[48:51]
    ds_read2_b32 v[76:77], v22 offset0:96 offset1:97
    v_mfma_f32_16x16x32_bf16 v[52:55], v[140:143], v[172:175], v[52:55]
    ds_read2_b32 v[78:79], v22 offset0:98 offset1:99
    v_mfma_f32_16x16x32_bf16 v[56:59], v[140:143], v[176:179], v[56:59]
    ds_read2_b32 v[80:81], v22 offset0:224 offset1:225
    s_waitcnt vmcnt(2)
    v_lshlrev_b32 v204, 16, v216
    v_mfma_f32_16x16x32_bf16 v[60:63], v[140:143], v[180:183], v[60:63]
    v_mfma_f32_16x16x32_bf16 v[64:67], v[140:143], v[184:187], v[64:67]
    ds_read2_b32 v[82:83], v22 offset0:226 offset1:227
    v_and_b32 v205, 0xffff0000, v216
    v_mfma_f32_16x16x32_bf16 v[48:51], v[144:147], v[164:167], v[48:51]
    ds_read2_b32 v[84:85], v23 offset0:96 offset1:97
    v_mfma_f32_16x16x32_bf16 v[52:55], v[144:147], v[168:171], v[52:55]
    ds_read2_b32 v[86:87], v23 offset0:98 offset1:99
    v_lshlrev_b32 v206, 16, v217
    v_mfma_f32_16x16x32_bf16 v[56:59], v[144:147], v[172:175], v[56:59]
    v_mfma_f32_16x16x32_bf16 v[60:63], v[144:147], v[176:179], v[60:63]
    ds_read2_b32 v[88:89], v23 offset0:224 offset1:225
    v_and_b32 v207, 0xffff0000, v217
    v_mfma_f32_16x16x32_bf16 v[64:67], v[144:147], v[180:183], v[64:67]
    ds_read2_b32 v[90:91], v23 offset0:226 offset1:227
    s_waitcnt lgkmcnt(14)
    v_mfma_f32_16x16x32_bf16 v[52:55], v[148:151], v[164:167], v[52:55]
    ds_read2_b32 v[92:93], v24 offset0:96 offset1:97
    v_mfma_f32_16x16x32_bf16 v[56:59], v[148:151], v[168:171], v[56:59]
    v_lshlrev_b32 v208, 16, v218
    v_mfma_f32_16x16x32_bf16 v[60:63], v[148:151], v[172:175], v[60:63]
    ds_read2_b32 v[94:95], v24 offset0:98 offset1:99
    v_mfma_f32_16x16x32_bf16 v[64:67], v[148:151], v[176:179], v[64:67]
    ds_read2_b32 v[96:97], v24 offset0:224 offset1:225
    v_and_b32 v209, 0xffff0000, v218
    v_mfma_f32_16x16x32_bf16 v[56:59], v[152:155], v[164:167], v[56:59]
    ds_read2_b32 v[98:99], v24 offset0:226 offset1:227
    v_mfma_f32_16x16x32_bf16 v[60:63], v[152:155], v[168:171], v[60:63]
    v_lshlrev_b32 v210, 16, v219
    v_mfma_f32_16x16x32_bf16 v[64:67], v[152:155], v[172:175], v[64:67]
    v_mfma_f32_16x16x32_bf16 v[60:63], v[156:159], v[164:167], v[60:63]
    v_and_b32 v211, 0xffff0000, v219
    v_mfma_f32_16x16x32_bf16 v[64:67], v[156:159], v[168:171], v[64:67]
    v_mfma_f32_16x16x32_bf16 v[64:67], v[160:163], v[164:167], v[64:67]
    v_mfma_f32_16x16x32_bf16 v[36:39], v[68:71], v[100:103], v[36:39]
    ds_read2_b32 v[132:133], v21 offset0:112 offset1:113
    s_waitcnt vmcnt(1)
    v_lshlrev_b32 v240, 16, v220
    v_mfma_f32_16x16x32_bf16 v[40:43], v[68:71], v[104:107], v[40:43]
    ds_read2_b32 v[134:135], v21 offset0:114 offset1:115
    v_mfma_f32_16x16x32_bf16 v[44:47], v[68:71], v[108:111], v[44:47]
    ds_read_b128 v[164:167], v32 offset:0
    v_and_b32 v241, 0xffff0000, v220
    v_mfma_f32_16x16x32_bf16 v[48:51], v[68:71], v[112:115], v[48:51]
    s_waitcnt lgkmcnt(14)
    v_mfma_f32_16x16x32_bf16 v[52:55], v[68:71], v[116:119], v[52:55]
    ds_read_b128 v[168:171], v32 offset:2048
    v_lshlrev_b32 v242, 16, v221
    v_mfma_f32_16x16x32_bf16 v[56:59], v[68:71], v[120:123], v[56:59]
    ds_read_b128 v[172:175], v32 offset:4096
    v_mfma_f32_16x16x32_bf16 v[60:63], v[68:71], v[124:127], v[60:63]
    ds_read_b128 v[176:179], v32 offset:6144
    v_and_b32 v243, 0xffff0000, v221
    v_mfma_f32_16x16x32_bf16 v[64:67], v[68:71], v[128:131], v[64:67]
    v_mfma_f32_16x16x32_bf16 v[40:43], v[72:75], v[100:103], v[40:43]
    ds_read_b128 v[180:183], v32 offset:8192
    v_mfma_f32_16x16x32_bf16 v[44:47], v[72:75], v[104:107], v[44:47]
    ds_read_b128 v[184:187], v32 offset:10240
    v_lshlrev_b32 v244, 16, v222
    v_mfma_f32_16x16x32_bf16 v[48:51], v[72:75], v[108:111], v[48:51]
    ds_read_b128 v[188:191], v32 offset:12288
    v_mfma_f32_16x16x32_bf16 v[52:55], v[72:75], v[112:115], v[52:55]
    v_and_b32 v245, 0xffff0000, v222
    v_mfma_f32_16x16x32_bf16 v[56:59], v[72:75], v[116:119], v[56:59]
    ds_read_b128 v[192:195], v32 offset:14336
    v_mfma_f32_16x16x32_bf16 v[60:63], v[72:75], v[120:123], v[60:63]
    ds_read2_b32 v[136:137], v21 offset0:240 offset1:241
    v_lshlrev_b32 v246, 16, v223
    v_mfma_f32_16x16x32_bf16 v[64:67], v[72:75], v[124:127], v[64:67]
    ds_read2_b32 v[138:139], v21 offset0:242 offset1:243
    s_waitcnt lgkmcnt(14)
    v_mfma_f32_16x16x32_bf16 v[44:47], v[76:79], v[100:103], v[44:47]
    v_and_b32 v247, 0xffff0000, v223
    v_mfma_f32_16x16x32_bf16 v[48:51], v[76:79], v[104:107], v[48:51]
    ds_read2_b32 v[140:141], v22 offset0:112 offset1:113
    v_mfma_f32_16x16x32_bf16 v[52:55], v[76:79], v[108:111], v[52:55]
    ds_read2_b32 v[142:143], v22 offset0:114 offset1:115
    v_mfma_f32_16x16x32_bf16 v[56:59], v[76:79], v[112:115], v[56:59]
    ds_read2_b32 v[144:145], v22 offset0:240 offset1:241
    s_waitcnt vmcnt(0)
    v_lshlrev_b32 v248, 16, v224
    v_mfma_f32_16x16x32_bf16 v[60:63], v[76:79], v[116:119], v[60:63]
    v_mfma_f32_16x16x32_bf16 v[64:67], v[76:79], v[120:123], v[64:67]
    ds_read2_b32 v[146:147], v22 offset0:242 offset1:243
    v_and_b32 v249, 0xffff0000, v224
    v_mfma_f32_16x16x32_bf16 v[48:51], v[80:83], v[100:103], v[48:51]
    ds_read2_b32 v[148:149], v23 offset0:112 offset1:113
    v_mfma_f32_16x16x32_bf16 v[52:55], v[80:83], v[104:107], v[52:55]
    ds_read2_b32 v[150:151], v23 offset0:114 offset1:115
    v_lshlrev_b32 v250, 16, v225
    v_mfma_f32_16x16x32_bf16 v[56:59], v[80:83], v[108:111], v[56:59]
    v_mfma_f32_16x16x32_bf16 v[60:63], v[80:83], v[112:115], v[60:63]
    ds_read2_b32 v[152:153], v23 offset0:240 offset1:241
    v_and_b32 v251, 0xffff0000, v225
    v_mfma_f32_16x16x32_bf16 v[64:67], v[80:83], v[116:119], v[64:67]
    ds_read2_b32 v[154:155], v23 offset0:242 offset1:243
    v_mfma_f32_16x16x32_bf16 v[52:55], v[84:87], v[100:103], v[52:55]
    ds_read2_b32 v[156:157], v24 offset0:112 offset1:113
    v_mfma_f32_16x16x32_bf16 v[56:59], v[84:87], v[104:107], v[56:59]
    v_lshlrev_b32 v252, 16, v226
    v_mfma_f32_16x16x32_bf16 v[60:63], v[84:87], v[108:111], v[60:63]
    ds_read2_b32 v[158:159], v24 offset0:114 offset1:115
    v_mfma_f32_16x16x32_bf16 v[64:67], v[84:87], v[112:115], v[64:67]
    ds_read2_b32 v[160:161], v24 offset0:240 offset1:241
    v_and_b32 v253, 0xffff0000, v226
    v_mfma_f32_16x16x32_bf16 v[56:59], v[88:91], v[100:103], v[56:59]
    ds_read2_b32 v[162:163], v24 offset0:242 offset1:243
    v_mfma_f32_16x16x32_bf16 v[60:63], v[88:91], v[104:107], v[60:63]
    v_lshlrev_b32 v254, 16, v227
    v_mfma_f32_16x16x32_bf16 v[64:67], v[88:91], v[108:111], v[64:67]
    v_mfma_f32_16x16x32_bf16 v[60:63], v[92:95], v[100:103], v[60:63]
    v_and_b32 v255, 0xffff0000, v227
    v_mfma_f32_16x16x32_bf16 v[64:67], v[92:95], v[104:107], v[64:67]
    s_waitcnt lgkmcnt(14)
    v_mfma_f32_16x16x32_bf16 v[64:67], v[96:99], v[100:103], v[64:67]
    v_mfma_f32_16x16x32_bf16 v[36:39], v[132:135], v[164:167], v[36:39]
    v_mfma_f32_16x16x32_bf16 v[40:43], v[132:135], v[168:171], v[40:43]
    v_mfma_f32_16x16x32_bf16 v[44:47], v[132:135], v[172:175], v[44:47]
    v_mfma_f32_16x16x32_bf16 v[48:51], v[132:135], v[176:179], v[48:51]
    v_mfma_f32_16x16x32_bf16 v[52:55], v[132:135], v[180:183], v[52:55]
    v_mfma_f32_16x16x32_bf16 v[56:59], v[132:135], v[184:187], v[56:59]
    v_mfma_f32_16x16x32_bf16 v[60:63], v[132:135], v[188:191], v[60:63]
    v_mfma_f32_16x16x32_bf16 v[64:67], v[132:135], v[192:195], v[64:67]
    s_waitcnt lgkmcnt(12)
    v_mfma_f32_16x16x32_bf16 v[40:43], v[136:139], v[164:167], v[40:43]
    v_cvt_pk_bf16_f32 v68, v39, v38
    v_cvt_pk_bf16_f32 v69, v37, v36
    v_mfma_f32_16x16x32_bf16 v[44:47], v[136:139], v[168:171], v[44:47]
    ds_write_b64 v20, v[68:69] offset:0
    v_mfma_f32_16x16x32_bf16 v[48:51], v[136:139], v[172:175], v[48:51]
    v_mfma_f32_16x16x32_bf16 v[52:55], v[136:139], v[176:179], v[52:55]
    v_mfma_f32_16x16x32_bf16 v[56:59], v[136:139], v[180:183], v[56:59]
    v_mfma_f32_16x16x32_bf16 v[60:63], v[136:139], v[184:187], v[60:63]
    v_mfma_f32_16x16x32_bf16 v[64:67], v[136:139], v[188:191], v[64:67]
    s_waitcnt lgkmcnt(11)
    v_mfma_f32_16x16x32_bf16 v[44:47], v[140:143], v[164:167], v[44:47]
    v_mfma_f32_16x16x32_bf16 v[48:51], v[140:143], v[168:171], v[48:51]
    v_cvt_pk_bf16_f32 v70, v43, v42
    v_cvt_pk_bf16_f32 v71, v41, v40
    v_mfma_f32_16x16x32_bf16 v[52:55], v[140:143], v[172:175], v[52:55]
    ds_write_b64 v20, v[70:71] offset:2048
    v_mfma_f32_16x16x32_bf16 v[56:59], v[140:143], v[176:179], v[56:59]
    v_mfma_f32_16x16x32_bf16 v[60:63], v[140:143], v[180:183], v[60:63]
    v_mfma_f32_16x16x32_bf16 v[64:67], v[140:143], v[184:187], v[64:67]
    s_waitcnt lgkmcnt(10)
    v_mfma_f32_16x16x32_bf16 v[48:51], v[144:147], v[164:167], v[48:51]
    v_mfma_f32_16x16x32_bf16 v[52:55], v[144:147], v[168:171], v[52:55]
    v_mfma_f32_16x16x32_bf16 v[56:59], v[144:147], v[172:175], v[56:59]
    v_cvt_pk_bf16_f32 v72, v47, v46
    v_cvt_pk_bf16_f32 v73, v45, v44
    v_mfma_f32_16x16x32_bf16 v[60:63], v[144:147], v[176:179], v[60:63]
    ds_write_b64 v20, v[72:73] offset:4096
    v_mfma_f32_16x16x32_bf16 v[64:67], v[144:147], v[180:183], v[64:67]
    s_waitcnt lgkmcnt(9)
    v_mfma_f32_16x16x32_bf16 v[52:55], v[148:151], v[164:167], v[52:55]
    v_mfma_f32_16x16x32_bf16 v[56:59], v[148:151], v[168:171], v[56:59]
    v_mfma_f32_16x16x32_bf16 v[60:63], v[148:151], v[172:175], v[60:63]
    v_mfma_f32_16x16x32_bf16 v[64:67], v[148:151], v[176:179], v[64:67]
    v_cvt_pk_bf16_f32 v74, v51, v50
    v_cvt_pk_bf16_f32 v75, v49, v48
    s_waitcnt lgkmcnt(7)
    v_mfma_f32_16x16x32_bf16 v[56:59], v[152:155], v[164:167], v[56:59]
    ds_write_b64 v20, v[74:75] offset:6144
    v_mfma_f32_16x16x32_bf16 v[60:63], v[152:155], v[168:171], v[60:63]
    v_mfma_f32_16x16x32_bf16 v[64:67], v[152:155], v[172:175], v[64:67]
    s_waitcnt lgkmcnt(6)
    v_mfma_f32_16x16x32_bf16 v[60:63], v[156:159], v[164:167], v[60:63]
    v_mfma_f32_16x16x32_bf16 v[64:67], v[156:159], v[168:171], v[64:67]
    v_cvt_pk_bf16_f32 v76, v55, v54
    v_cvt_pk_bf16_f32 v77, v53, v52
    s_waitcnt lgkmcnt(4)
    v_mfma_f32_16x16x32_bf16 v[64:67], v[160:163], v[164:167], v[64:67]
    ds_write_b64 v20, v[76:77] offset:8192
    v_cvt_pk_bf16_f32 v78, v59, v58
    v_cvt_pk_bf16_f32 v79, v57, v56
    ds_write_b64 v20, v[78:79] offset:10240
    v_cvt_pk_bf16_f32 v80, v63, v62
    v_cvt_pk_bf16_f32 v81, v61, v60
    ds_write_b64 v20, v[80:81] offset:12288
    s_nop 0
    v_cvt_pk_bf16_f32 v82, v67, v66
    v_cvt_pk_bf16_f32 v83, v65, v64
    ds_write_b64 v20, v[82:83] offset:14336
    s_mov_b64 exec, 1
    ds_add_u32 v18, v19 offset:12
    s_mov_b64 exec, -1
    s_add_u32 s80, s86, 94208
    v_add_u32 v5, s80, v15
    s_branch LA_s3_in
LA_s3:
    s_sleep 1
LA_s3_in:
    ds_read_b32 v6, v18 offset:12
    ds_read_b128 v[84:87], v5 offset:0
    ds_read_b128 v[88:91], v5 offset:4096
    ds_read_b128 v[92:95], v5 offset:8192
    ds_read_b128 v[96:99], v5 offset:12288
    s_waitcnt lgkmcnt(0)
    v_readfirstlane_b32 s78, v6
    s_nop 0
    s_cmp_ge_u32 s78, 4
    s_cbranch_scc0 LA_s3
    s_add_u32 s89, s91, 4194304
    buffer_store_dwordx4 v[84:87], v14, s[52:55], s89 offen sc1
    s_add_u32 s89, s91, 4198400
    buffer_store_dwordx4 v[88:91], v14, s[52:55], s89 offen sc1
    s_add_u32 s89, s91, 4202496
    buffer_store_dwordx4 v[92:95], v14, s[52:55], s89 offen sc1
    s_add_u32 s89, s91, 4206592
    buffer_store_dwordx4 v[96:99], v14, s[52:55], s89 offen sc1
    s_add_u32 m0, s86, 129024
    s_add_u32 s89, s97, 131072
    buffer_load_dwordx4 v17, s[64:67], s89 offen  lds
    s_add_u32 m0, s86, 133120
    s_add_u32 s89, s97, 196608
    buffer_load_dwordx4 v17, s[64:67], s89 offen  lds
    s_add_u32 m0, s86, 137216
    s_add_u32 s89, s99, 0
    buffer_load_dwordx4 v17, s[64:67], s89 offen  lds
    s_add_u32 m0, s86, 141312
    s_add_u32 s89, s99, 65536
    buffer_load_dwordx4 v17, s[64:67], s89 offen  lds
    s_add_u32 m0, s86, 145408
    s_add_u32 s89, s99, 131072
    buffer_load_dwordx4 v17, s[64:67], s89 offen  lds
    s_add_u32 m0, s86, 149504
    s_add_u32 s89, s99, 196608
    buffer_load_dwordx4 v17, s[64:67], s89 offen  lds
    s_setprio 0
    s_mov_b32 s60, s22
    s_mov_b32 s61, s23
    s_mov_b32 s62, 0x800000
    s_mov_b32 s63, 0x20000
    s_lshr_b32 s81, s91, 4
    s_lshl_b32 s82, s3, 8
    s_add_u32 s81, s81, s82
    s_add_u32 s81, s81, 12648448
    s_lshl_b32 s80, s74, 14
    s_and_b32 s82, s75, 3
    s_lshl_b32 s82, s82, 8
    s_add_u32 s80, s80, s82
    s_add_u32 s80, s80, 12648448
    v_mov_b32 v5, 0
    v_lshlrev_b32 v7, 10, v0
    s_waitcnt vmcnt(6)
    s_mov_b64 exec, 1
    buffer_store_dword v19, v5, s[52:55], s81 offen sc1
    s_mov_b64 exec, 0xffff
    s_waitcnt vmcnt(1)
    s_mov_b64 exec, 1
    ds_add_u32 v18, v19 offset:32
    s_mov_b64 exec, -1
    s_mov_b64 exec, 0xffff
    s_waitcnt vmcnt(0)
    s_branch LA_s7a_in
LA_s7a:
    s_sleep 1
LA_s7a_in:
    ds_read_b32 v6, v18 offset:28
    s_waitcnt lgkmcnt(0)
    v_readfirstlane_b32 s78, v6
    s_nop 0
    s_cmp_ge_u32 s78, 4
    s_cbranch_scc0 LA_s7a
    s_setprio 2
    s_mov_b32 s79, 0
LA_py:
    buffer_load_dword v6, v7, s[52:55], s80 offen sc1
    s_add_u32 s79, s79, 1
    s_cmp_gt_u32 s79, 200000
    s_cbranch_scc1 LA_py_x
    s_waitcnt vmcnt(0)
    v_cmp_ne_u32 vcc, 1, v6
    s_cbranch_vccz LA_py_x
    s_mov_b64 exec, vcc
    s_sleep 8
    s_branch LA_py
LA_py_x:
    s_waitcnt vmcnt(0)
    s_mov_b64 exec, -1
    s_mov_b32 s89, 4194304
    buffer_load_dwordx4 v[100:103], v12, s[52:55], s89 offen sc1
    s_mov_b32 s89, 4210688
    buffer_load_dwordx4 v[104:107], v12, s[52:55], s89 offen sc1
    s_mov_b32 s89, 4227072
    buffer_load_dwordx4 v[108:111], v12, s[52:55], s89 offen sc1
    s_mov_b32 s89, 4243456
    buffer_load_dwordx4 v[112:115], v12, s[52:55], s89 offen sc1
    s_waitcnt vmcnt(3)
    v_permlane32_swap_b32 v102, v100
    v_permlane32_swap_b32 v103, v101
    s_waitcnt vmcnt(2)
    v_permlane32_swap_b32 v106, v104
    v_permlane32_swap_b32 v107, v105
    s_waitcnt vmcnt(1)
    v_permlane32_swap_b32 v110, v108
    v_permlane32_swap_b32 v111, v109
    s_waitcnt vmcnt(0)
    v_permlane32_swap_b32 v114, v112
    v_permlane32_swap_b32 v115, v113
    v_and_b32 v68, 0xffff0000, v103
    v_and_b32 v69, 0xffff0000, v107
    v_and_b32 v70, 0xffff0000, v111
    v_and_b32 v71, 0xffff0000, v115
    v_and_b32 v72, 0xffff0000, v101
    v_and_b32 v73, 0xffff0000, v105
    v_and_b32 v74, 0xffff0000, v109
    v_and_b32 v75, 0xffff0000, v113
    v_mul_f32 v68, v68, v196
    v_mul_f32 v69, v69, v197
    v_mul_f32 v70, v70, v198
    v_mul_f32 v71, v71, v199
    v_mul_f32 v72, v72, v200
    v_mul_f32 v73, v73, v201
    v_mul_f32 v74, v74, v202
    v_mul_f32 v75, v75, v203
    v_cvt_pk_bf16_f32 v36, v68, v69
    v_cvt_pk_bf16_f32 v37, v70, v71
    v_cvt_pk_bf16_f32 v38, v72, v73
    v_cvt_pk_bf16_f32 v39, v74, v75
    s_mov_b32 s89, 0
    buffer_store_dwordx4 v[36:39], v13, s[60:63], s89 offen nt
    v_lshlrev_b32 v68, 16, v103
    v_lshlrev_b32 v69, 16, v107
    v_lshlrev_b32 v70, 16, v111
    v_lshlrev_b32 v71, 16, v115
    v_lshlrev_b32 v72, 16, v101
    v_lshlrev_b32 v73, 16, v105
    v_lshlrev_b32 v74, 16, v109
    v_lshlrev_b32 v75, 16, v113
    v_mul_f32 v68, v68, v204
    v_mul_f32 v69, v69, v205
    v_mul_f32 v70, v70, v206
    v_mul_f32 v71, v71, v207
    v_mul_f32 v72, v72, v208
    v_mul_f32 v73, v73, v209
    v_mul_f32 v74, v74, v210
    v_mul_f32 v75, v75, v211
    v_cvt_pk_bf16_f32 v40, v68, v69
    v_cvt_pk_bf16_f32 v41, v70, v71
    v_cvt_pk_bf16_f32 v42, v72, v73
    v_cvt_pk_bf16_f32 v43, v74, v75
    s_mov_b32 s89, 4096
    buffer_store_dwordx4 v[40:43], v13, s[60:63], s89 offen nt
    v_and_b32 v68, 0xffff0000, v102
    v_and_b32 v69, 0xffff0000, v106
    v_and_b32 v70, 0xffff0000, v110
    v_and_b32 v71, 0xffff0000, v114
    v_and_b32 v72, 0xffff0000, v100
    v_and_b32 v73, 0xffff0000, v104
    v_and_b32 v74, 0xffff0000, v108
    v_and_b32 v75, 0xffff0000, v112
    v_mul_f32 v68, v68, v240
    v_mul_f32 v69, v69, v241
    v_mul_f32 v70, v70, v242
    v_mul_f32 v71, v71, v243
    v_mul_f32 v72, v72, v244
    v_mul_f32 v73, v73, v245
    v_mul_f32 v74, v74, v246
    v_mul_f32 v75, v75, v247
    v_cvt_pk_bf16_f32 v44, v68, v69
    v_cvt_pk_bf16_f32 v45, v70, v71
    v_cvt_pk_bf16_f32 v46, v72, v73
    v_cvt_pk_bf16_f32 v47, v74, v75
    s_mov_b32 s89, 8192
    buffer_store_dwordx4 v[44:47], v13, s[60:63], s89 offen nt
    v_lshlrev_b32 v68, 16, v102
    v_lshlrev_b32 v69, 16, v106
    v_lshlrev_b32 v70, 16, v110
    v_lshlrev_b32 v71, 16, v114
    v_lshlrev_b32 v72, 16, v100
    v_lshlrev_b32 v73, 16, v104
    v_lshlrev_b32 v74, 16, v108
    v_lshlrev_b32 v75, 16, v112
    v_mul_f32 v68, v68, v248
    v_mul_f32 v69, v69, v249
    v_mul_f32 v70, v70, v250
    v_mul_f32 v71, v71, v251
    v_mul_f32 v72, v72, v252
    v_mul_f32 v73, v73, v253
    v_mul_f32 v74, v74, v254
    v_mul_f32 v75, v75, v255
    v_cvt_pk_bf16_f32 v48, v68, v69
    v_cvt_pk_bf16_f32 v49, v70, v71
    v_cvt_pk_bf16_f32 v50, v72, v73
    v_cvt_pk_bf16_f32 v51, v74, v75
    s_mov_b32 s89, 12288
    buffer_store_dwordx4 v[48:51], v13, s[60:63], s89 offen nt
    s_endpgm
L_B:
    s_setprio 3
    s_and_b32 s3, s3, 3
    s_lshr_b32 s86, s3, 1
    s_and_b32 s87, s3, 1
    v_mov_b32 v10, 162304
    v_mov_b32 v11, 1
    v_lshlrev_b32 v12, 4, v0
    v_lshl_add_u32 v13, v0, 2, v10
    v_mov_b32 v14, 0
    ds_write_b32 v13, v14
    s_lshl_b32 s78, s74, 4
    s_add_u32 s78, s78, s75
    s_lshl_b32 s96, s78, 8
    s_add_u32 s96, s96, 12582912
    s_lshl_b32 s78, s78, 2
    s_add_u32 s78, s78, s3
    s_lshl_b32 s78, s78, 8
    s_add_u32 s80, s78, 12648448
    s_lshl_b32 s81, s72, 1
    s_add_u32 s81, s81, s86
    s_lshl_b32 s97, s81, 4
    s_add_u32 s97, s97, s73
    s_lshl_b32 s97, s97, 8
    s_add_u32 s97, s97, 12910464
    v_mov_b32 v15, s80
    v_mov_b32 v223, s97
    v_cmp_gt_u32 vcc, 8, v0
    s_nop 1
    v_cndmask_b32 v15, v223, v15, vcc
    v_add_u32 v221, v15, v12
    s_lshl_b32 s78, s87, 2
    s_add_u32 s78, s78, 128
    s_add_u32 s97, s97, s78
    s_lshl_b32 s82, s73, 1
    s_add_u32 s82, s82, s87
    s_lshl_b32 s78, s81, 7
    s_add_u32 s78, s78, s82
    s_lshl_b32 s94, s78, 10
    s_add_u32 s94, s94, 8388608
    v_mov_b32 v212, 0
    v_mov_b32 v213, 0
    v_mov_b32 v214, 0
    v_mov_b32 v215, 0
    v_mov_b32 v220, 0
    s_waitcnt lgkmcnt(0)
    s_mov_b32 s52, s26
    s_mov_b32 s53, s27
    s_mov_b32 s54, 0x1000000
    s_mov_b32 s55, 0x20000
    s_mov_b32 s68, s24
    s_mov_b32 s69, s25
    s_mov_b32 s70, 0x100
    s_mov_b32 s71, 0x20000
    s_lshl_b32 s98, s74, 4
    s_or_b32 s78, s75, s3
    s_cmp_lg_u32 s78, 0
    s_cbranch_scc1 LB_notag
    s_mov_b64 exec, 0xffff
    v_lshlrev_b32 v15, 8, v0
    buffer_load_dword v223, v15, s[52:55], s96 offen sc1
    s_waitcnt vmcnt(0)
    v_lshrrev_b32 v223, v0, v223
    v_and_b32 v223, 1, v223
    v_cmp_eq_u32 vcc, 0, v223
    s_nop 1
    s_or_b32 s78, vcc_lo, 0x10000
    s_mov_b64 exec, 1
    v_mov_b32 v223, s78
    buffer_store_dword v223, v220, s[68:71], s98 offen sc1
LB_notag:
    s_lshl_b32 s78, s87, 3
    s_lshr_b32 exec_lo, 0xffff, s78
    s_mov_b32 exec_hi, 0
    buffer_store_dwordx4 v[212:215], v221, s[52:55], 0 offen sc1
    s_mov_b64 exec, -1
    v_and_b32 v13, 15, v0
    v_lshrrev_b32 v14, 4, v0
    v_lshrrev_b32 v15, 1, v13
    v_xor_b32 v15, v15, v14
    v_lshlrev_b32 v15, 4, v15
    v_lshl_add_u32 v15, v13, 7, v15
    v_add_u32 v2, 73728, v15
    v_xor_b32 v3, 64, v2
    s_lshl_b32 s78, s86, 13
    s_add_u32 s78, s78, 2048
    v_add_u32 v4, s78, v2
    v_add_u32 v5, s78, v3
    v_bfe_u32 v15, v0, 3, 2
    s_lshl_b32 s78, s87, 1
    s_add_u32 s78, s78, s86
    v_xor_b32 v15, s78, v15
    v_lshlrev_b32 v15, 5, v15
    v_and_b32 v223, 3, v0
    v_lshl_add_u32 v15, v223, 3, v15
    v_bfe_u32 v223, v0, 2, 2
    v_lshl_add_u32 v15, v223, 7, v15
    v_mul_u32_u24 v223, 3072, v14
    v_add_u32 v6, v223, v15
    v_xor_b32 v7, 32, v6
    s_mov_b32 s60, s22
    s_mov_b32 s61, s23
    s_mov_b32 s62, 0x800000
    s_mov_b32 s63, 0x20000
    v_and_b32 v15, 1, v13
    v_cmp_eq_u32 s[88:89], 1, v15
    v_lshl_add_u32 v15, v14, 2, v15
    v_cmp_le_u32 s[90:91], v15, v13
    v_add_u32 v15, 2, v15
    v_cmp_le_u32 s[92:93], v15, v13
    v_mov_b32 v212, 0x0c0c0c0c
    v_mov_b32 v15, 0xc0c0100
    v_mov_b32 v223, 0x1000c0c
    v_cndmask_b32 v15, v15, v223, s[88:89]
    v_cndmask_b32 v208, v15, v212, s[90:91]
    v_cndmask_b32 v210, v212, v15, s[90:91]
    v_mov_b32 v15, 0xc0c0302
    v_mov_b32 v223, 0x3020c0c
    v_cndmask_b32 v15, v15, v223, s[88:89]
    v_cndmask_b32 v209, v15, v212, s[92:93]
    v_cndmask_b32 v211, v212, v15, s[92:93]
    s_or_b32 s78, s72, s86
    s_cmp_eq_u32 s78, 0
    s_cselect_b32 s78, 0xf149f2ca, 0
    v_mov_b32 v212, s78
    v_mov_b32 v213, s78
    v_mov_b32 v214, s78
    v_mov_b32 v215, s78
    s_lshl_b32 s78, s87, 12
    s_add_u32 s78, s78, 24576
    s_lshl_b32 s79, s86, 9
    s_add_u32 s79, s79, s78
    v_lshlrev_b32 v15, 3, v0
    v_add_u32 v216, s79, v15
    s_lshl_b32 s80, s86, 11
    v_add_u32 v218, s80, v216
    v_xor_b32 v219, 512, v218
    s_add_u32 s78, s78, 2048
    s_cmp_eq_u32 s86, 0
    s_cselect_b32 s78, s78, 32768
    v_add_u32 v217, s78, v15
    v_bfe_u32 v14, v0, 3, 2
    v_lshlrev_b32 v14, 5, v14
    v_and_b32 v15, 3, v0
    v_lshl_add_u32 v14, v15, 3, v14
    v_lshrrev_b32 v15, 2, v0
    v_lshl_add_u32 v14, v15, 7, v14
    s_lshl_b32 s78, s86, 11
    v_add_u32 v244, s78, v14
    s_mov_b32 s64, s20
    s_mov_b32 s65, s21
    s_mov_b32 s66, 0x200000
    s_mov_b32 s67, 0x20000
    v_lshrrev_b32 v14, 4, v0
    v_lshlrev_b32 v14, 1, v14
    v_and_b32 v15, 7, v0
    v_xor_b32 v14, v14, v15
    v_lshlrev_b32 v14, 4, v14
    v_lshrrev_b32 v15, 3, v0
    v_lshl_add_u32 v14, v15, 11, v14
    s_lshl_b32 s78, s77, 7
    s_lshl_b32 s79, s3, 14
    s_add_u32 s78, s78, s79
    v_add_u32 v245, s78, v14
    v_and_b32 v14, 15, v0
    s_lshl_b32 s78, s76, 2
    s_add_u32 s78, s78, s3
    s_lshl_b32 s79, s78, 5
    v_add_u32 v14, s79, v14
    v_lshlrev_b32 v14, 12, v14
    v_bfe_u32 v15, v0, 4, 1
    v_lshl_add_u32 v14, v15, 5, v14
    v_lshrrev_b32 v15, 5, v0
    v_lshl_add_u32 v14, v15, 4, v14
    s_lshl_b32 s79, s77, 7
    s_add_u32 s79, s79, 2048
    v_add_u32 v246, s79, v14
    s_lshl_b32 s28, s78, 16
    s_add_u32 s28, s28, 8388608
    s_lshl_b32 s30, s76, 1
    s_add_u32 s30, s30, s86
    s_lshl_b32 s30, s30, 12
    s_add_u32 s30, s30, 12910592
    v_lshrrev_b32 v15, 1, v0
    v_lshlrev_b32 v15, 8, v15
    v_and_b32 v14, 1, v0
    v_lshl_add_u32 v247, v14, 2, v15
    s_and_b32 s78, s77, 7
    s_mov_b32 s79, 0x76543210
    s_cmp_eq_u32 s78, 1
    s_cselect_b32 s79, 0x76543201, s79
    s_cmp_eq_u32 s78, 2
    s_cselect_b32 s79, 0x76543120, s79
    s_cmp_eq_u32 s78, 3
    s_cselect_b32 s79, 0x76542310, s79
    s_cmp_eq_u32 s78, 4
    s_cselect_b32 s79, 0x76534210, s79
    s_cmp_eq_u32 s78, 5
    s_cselect_b32 s79, 0x76453210, s79
    s_cmp_eq_u32 s78, 6
    s_cselect_b32 s79, 0x75643210, s79
    s_cmp_eq_u32 s78, 7
    s_cselect_b32 s79, 0x67543210, s79
    s_and_b32 s78, s76, 3
    s_mul_i32 s78, s78, 0x22222222
    s_add_u32 s79, s79, s78
    s_bfe_u32 s78, s79, 0x30000
    s_lshl_b32 s44, s78, 18
    s_lshl_b32 s78, s78, 12
    s_add_u32 s36, s78, s28
    s_bfe_u32 s78, s79, 0x30004
    s_lshl_b32 s45, s78, 18
    s_lshl_b32 s78, s78, 12
    s_add_u32 s37, s78, s28
    s_bfe_u32 s78, s79, 0x30008
    s_lshl_b32 s46, s78, 18
    s_lshl_b32 s78, s78, 12
    s_add_u32 s38, s78, s28
    s_bfe_u32 s78, s79, 0x3000c
    s_lshl_b32 s47, s78, 18
    s_lshl_b32 s78, s78, 12
    s_add_u32 s39, s78, s28
    s_bfe_u32 s78, s79, 0x30010
    s_lshl_b32 s48, s78, 18
    s_lshl_b32 s78, s78, 12
    s_add_u32 s40, s78, s28
    s_bfe_u32 s78, s79, 0x30014
    s_lshl_b32 s49, s78, 18
    s_lshl_b32 s78, s78, 12
    s_add_u32 s41, s78, s28
    s_bfe_u32 s78, s79, 0x30018
    s_lshl_b32 s50, s78, 18
    s_lshl_b32 s78, s78, 12
    s_add_u32 s42, s78, s28
    s_bfe_u32 s78, s79, 0x3001c
    s_lshl_b32 s51, s78, 18
    s_lshl_b32 s78, s78, 12
    s_add_u32 s43, s78, s28
    s_lshl_b32 s34, s3, 10
    v_bfe_u32 v14, v0, 4, 1
    v_lshrrev_b32 v15, 5, v0
    v_lshl_add_u32 v14, v14, 1, v15
    v_and_b32 v15, 7, v0
    v_xor_b32 v14, v14, v15
    v_lshlrev_b32 v14, 4, v14
    v_and_b32 v223, 15, v0
    v_lshl_add_u32 v14, v223, 7, v14
    s_lshl_b32 s78, s3, 12
    v_add_u32 v248, s78, v14
    v_xor_b32 v249, 64, v248
    v_add_u32 v250, s78, v12
    v_lshrrev_b32 v14, 3, v0
    v_xor_b32 v15, v15, v14
    v_lshlrev_b32 v15, 4, v15
    v_lshl_add_u32 v14, v14, 12, v15
    s_lshl_b32 s78, s76, 2
    s_add_u32 s78, s78, s3
    s_lshl_b32 s78, s78, 17
    s_lshl_b32 s79, s77, 7
    s_add_u32 s78, s78, s79
    s_add_u32 s78, s78, 2048
    v_add_u32 v246, s78, v14
    s_waitcnt lgkmcnt(0)
    s_barrier
    ds_read_b128 v[120:123], v4 offset:0
    ds_read_b128 v[124:127], v4 offset:2048
    ds_read_b128 v[128:131], v4 offset:4096
    ds_read_b128 v[132:135], v4 offset:6144
    ds_read_b128 v[136:139], v2 offset:0
    ds_read_b64_tr_b16 v[140:141], v6 offset:0
    ds_read_b64_tr_b16 v[142:143], v6 offset:512
    ds_read_b64_tr_b16 v[144:145], v7 offset:0
    ds_read_b64_tr_b16 v[146:147], v7 offset:512
    ds_read_b64_tr_b16 v[148:149], v6 offset:1024
    ds_read_b64_tr_b16 v[150:151], v6 offset:1536
    ds_read_b64_tr_b16 v[152:153], v7 offset:1024
    ds_read_b64_tr_b16 v[154:155], v7 offset:1536
    ds_read_b64_tr_b16 v[156:157], v6 offset:2048
    ds_read_b64_tr_b16 v[158:159], v6 offset:2560
    ds_read_b64_tr_b16 v[160:161], v7 offset:2048
    ds_read_b64_tr_b16 v[162:163], v7 offset:2560
    s_waitcnt lgkmcnt(0)
    v_mfma_f32_16x16x32_bf16 v[16:19], v[140:143], v[120:123], 0
    ds_read_b128 v[164:167], v5 offset:0
    v_mfma_f32_16x16x32_bf16 v[20:23], v[144:147], v[120:123], 0
    ds_read_b128 v[168:171], v5 offset:2048
    v_mfma_f32_16x16x32_bf16 v[52:55], v[152:155], v[120:123], 0
    ds_read_b128 v[172:175], v5 offset:4096
    v_mfma_f32_16x16x32_bf16 v[48:51], v[148:151], v[120:123], 0
    ds_read_b128 v[176:179], v5 offset:6144
    v_mfma_f32_16x16x32_bf16 v[56:59], v[148:151], v[124:127], 0
    ds_read_b128 v[180:183], v3 offset:0
    v_mfma_f32_16x16x32_bf16 v[60:63], v[152:155], v[124:127], 0
    ds_read_b64_tr_b16 v[184:185], v6 offset:12288
    v_mfma_f32_16x16x32_bf16 v[28:31], v[144:147], v[124:127], 0
    ds_read_b64_tr_b16 v[186:187], v6 offset:12800
    v_mfma_f32_16x16x32_bf16 v[24:27], v[140:143], v[124:127], 0
    ds_read_b64_tr_b16 v[188:189], v7 offset:12288
    v_mfma_f32_16x16x32_bf16 v[32:35], v[140:143], v[128:131], 0
    ds_read_b64_tr_b16 v[190:191], v7 offset:12800
    v_mfma_f32_16x16x32_bf16 v[36:39], v[144:147], v[128:131], 0
    ds_read_b64_tr_b16 v[192:193], v6 offset:13312
    v_mfma_f32_16x16x32_bf16 v[68:71], v[152:155], v[128:131], 0
    ds_read_b64_tr_b16 v[194:195], v6 offset:13824
    v_mfma_f32_16x16x32_bf16 v[64:67], v[148:151], v[128:131], 0
    ds_read_b64_tr_b16 v[196:197], v7 offset:13312
    v_mfma_f32_16x16x32_bf16 v[112:115], v[148:151], v[136:139], 0
    ds_read_b64_tr_b16 v[198:199], v7 offset:13824
    v_mfma_f32_16x16x32_bf16 v[72:75], v[148:151], v[132:135], 0
    ds_read_b64_tr_b16 v[200:201], v6 offset:14336
    v_mfma_f32_16x16x32_bf16 v[76:79], v[152:155], v[132:135], 0
    ds_read_b64_tr_b16 v[202:203], v6 offset:14848
    v_mfma_f32_16x16x32_bf16 v[44:47], v[144:147], v[132:135], 0
    ds_read_b64_tr_b16 v[204:205], v7 offset:14336
    v_mfma_f32_16x16x32_bf16 v[40:43], v[140:143], v[132:135], 0
    ds_read_b64_tr_b16 v[206:207], v7 offset:14848
    v_mfma_f32_16x16x32_bf16 v[104:107], v[132:135], v[156:159], 0
    v_mfma_f32_16x16x32_bf16 v[108:111], v[132:135], v[160:163], 0
    v_mfma_f32_16x16x32_bf16 v[100:103], v[128:131], v[160:163], 0
    v_mfma_f32_16x16x32_bf16 v[96:99], v[128:131], v[156:159], 0
    v_mfma_f32_16x16x32_bf16 v[88:91], v[124:127], v[156:159], 0
    v_mfma_f32_16x16x32_bf16 v[92:95], v[124:127], v[160:163], 0
    v_mfma_f32_16x16x32_bf16 v[84:87], v[120:123], v[160:163], 0
    v_mfma_f32_16x16x32_bf16 v[80:83], v[120:123], v[156:159], 0
    v_mfma_f32_16x16x32_bf16 v[116:119], v[136:139], v[156:159], 0
    s_waitcnt vmcnt(0)
    s_waitcnt lgkmcnt(0)
    s_barrier
    v_mfma_f32_16x16x32_bf16 v[16:19], v[184:187], v[164:167], v[16:19]
    ds_read_b128 v[120:123], v4 offset:18432
    v_mfma_f32_16x16x32_bf16 v[20:23], v[188:191], v[164:167], v[20:23]
    ds_read_b128 v[124:127], v4 offset:20480
    v_mfma_f32_16x16x32_bf16 v[52:55], v[196:199], v[164:167], v[52:55]
    ds_read_b128 v[128:131], v4 offset:22528
    v_mfma_f32_16x16x32_bf16 v[48:51], v[192:195], v[164:167], v[48:51]
    ds_read_b128 v[132:135], v4 offset:24576
    v_mfma_f32_16x16x32_bf16 v[56:59], v[192:195], v[168:171], v[56:59]
    ds_read_b128 v[136:139], v2 offset:18432
    v_mfma_f32_16x16x32_bf16 v[60:63], v[196:199], v[168:171], v[60:63]
    ds_read_b64_tr_b16 v[140:141], v6 offset:24576
    v_mfma_f32_16x16x32_bf16 v[28:31], v[188:191], v[168:171], v[28:31]
    ds_read_b64_tr_b16 v[142:143], v6 offset:25088
    v_mfma_f32_16x16x32_bf16 v[24:27], v[184:187], v[168:171], v[24:27]
    ds_read_b64_tr_b16 v[144:145], v7 offset:24576
    v_mfma_f32_16x16x32_bf16 v[32:35], v[184:187], v[172:175], v[32:35]
    ds_read_b64_tr_b16 v[146:147], v7 offset:25088
    v_mfma_f32_16x16x32_bf16 v[36:39], v[188:191], v[172:175], v[36:39]
    ds_read_b64_tr_b16 v[148:149], v6 offset:25600
    v_mfma_f32_16x16x32_bf16 v[68:71], v[196:199], v[172:175], v[68:71]
    ds_read_b64_tr_b16 v[150:151], v6 offset:26112
    v_mfma_f32_16x16x32_bf16 v[64:67], v[192:195], v[172:175], v[64:67]
    ds_read_b64_tr_b16 v[152:153], v7 offset:25600
    v_mfma_f32_16x16x32_bf16 v[112:115], v[192:195], v[180:183], v[112:115]
    ds_read_b64_tr_b16 v[154:155], v7 offset:26112
    v_mfma_f32_16x16x32_bf16 v[72:75], v[192:195], v[176:179], v[72:75]
    ds_read_b64_tr_b16 v[156:157], v6 offset:26624
    v_mfma_f32_16x16x32_bf16 v[76:79], v[196:199], v[176:179], v[76:79]
    ds_read_b64_tr_b16 v[158:159], v6 offset:27136
    v_mfma_f32_16x16x32_bf16 v[44:47], v[188:191], v[176:179], v[44:47]
    ds_read_b64_tr_b16 v[160:161], v7 offset:26624
    v_mfma_f32_16x16x32_bf16 v[40:43], v[184:187], v[176:179], v[40:43]
    ds_read_b64_tr_b16 v[162:163], v7 offset:27136
    v_mfma_f32_16x16x32_bf16 v[104:107], v[176:179], v[200:203], v[104:107]
    v_mfma_f32_16x16x32_bf16 v[108:111], v[176:179], v[204:207], v[108:111]
    v_mfma_f32_16x16x32_bf16 v[100:103], v[172:175], v[204:207], v[100:103]
    v_mfma_f32_16x16x32_bf16 v[96:99], v[172:175], v[200:203], v[96:99]
    v_mfma_f32_16x16x32_bf16 v[88:91], v[168:171], v[200:203], v[88:91]
    v_mfma_f32_16x16x32_bf16 v[92:95], v[168:171], v[204:207], v[92:95]
    v_mfma_f32_16x16x32_bf16 v[84:87], v[164:167], v[204:207], v[84:87]
    v_mfma_f32_16x16x32_bf16 v[80:83], v[164:167], v[200:203], v[80:83]
    v_mfma_f32_16x16x32_bf16 v[116:119], v[180:183], v[200:203], v[116:119]
    s_waitcnt lgkmcnt(0)
    v_mfma_f32_16x16x32_bf16 v[16:19], v[140:143], v[120:123], v[16:19]
    ds_read_b128 v[164:167], v5 offset:18432
    v_mfma_f32_16x16x32_bf16 v[20:23], v[144:147], v[120:123], v[20:23]
    ds_read_b128 v[168:171], v5 offset:20480
    v_mfma_f32_16x16x32_bf16 v[52:55], v[152:155], v[120:123], v[52:55]
    ds_read_b128 v[172:175], v5 offset:22528
    v_mfma_f32_16x16x32_bf16 v[48:51], v[148:151], v[120:123], v[48:51]
    ds_read_b128 v[176:179], v5 offset:24576
    v_mfma_f32_16x16x32_bf16 v[56:59], v[148:151], v[124:127], v[56:59]
    ds_read_b128 v[180:183], v3 offset:18432
    v_mfma_f32_16x16x32_bf16 v[60:63], v[152:155], v[124:127], v[60:63]
    ds_read_b64_tr_b16 v[184:185], v6 offset:36864
    v_mfma_f32_16x16x32_bf16 v[28:31], v[144:147], v[124:127], v[28:31]
    ds_read_b64_tr_b16 v[186:187], v6 offset:37376
    v_mfma_f32_16x16x32_bf16 v[24:27], v[140:143], v[124:127], v[24:27]
    ds_read_b64_tr_b16 v[188:189], v7 offset:36864
    v_mfma_f32_16x16x32_bf16 v[32:35], v[140:143], v[128:131], v[32:35]
    ds_read_b64_tr_b16 v[190:191], v7 offset:37376
    v_mfma_f32_16x16x32_bf16 v[36:39], v[144:147], v[128:131], v[36:39]
    ds_read_b64_tr_b16 v[192:193], v6 offset:37888
    v_mfma_f32_16x16x32_bf16 v[68:71], v[152:155], v[128:131], v[68:71]
    ds_read_b64_tr_b16 v[194:195], v6 offset:38400
    v_mfma_f32_16x16x32_bf16 v[64:67], v[148:151], v[128:131], v[64:67]
    ds_read_b64_tr_b16 v[196:197], v7 offset:37888
    v_mfma_f32_16x16x32_bf16 v[112:115], v[148:151], v[136:139], v[112:115]
    ds_read_b64_tr_b16 v[198:199], v7 offset:38400
    v_mfma_f32_16x16x32_bf16 v[72:75], v[148:151], v[132:135], v[72:75]
    ds_read_b64_tr_b16 v[200:201], v6 offset:38912
    v_mfma_f32_16x16x32_bf16 v[76:79], v[152:155], v[132:135], v[76:79]
    ds_read_b64_tr_b16 v[202:203], v6 offset:39424
    v_mfma_f32_16x16x32_bf16 v[44:47], v[144:147], v[132:135], v[44:47]
    ds_read_b64_tr_b16 v[204:205], v7 offset:38912
    v_mfma_f32_16x16x32_bf16 v[40:43], v[140:143], v[132:135], v[40:43]
    ds_read_b64_tr_b16 v[206:207], v7 offset:39424
    v_mfma_f32_16x16x32_bf16 v[104:107], v[132:135], v[156:159], v[104:107]
    v_mfma_f32_16x16x32_bf16 v[108:111], v[132:135], v[160:163], v[108:111]
    v_mfma_f32_16x16x32_bf16 v[100:103], v[128:131], v[160:163], v[100:103]
    v_mfma_f32_16x16x32_bf16 v[96:99], v[128:131], v[156:159], v[96:99]
    v_mfma_f32_16x16x32_bf16 v[88:91], v[124:127], v[156:159], v[88:91]
    v_mfma_f32_16x16x32_bf16 v[92:95], v[124:127], v[160:163], v[92:95]
    v_mfma_f32_16x16x32_bf16 v[84:87], v[120:123], v[160:163], v[84:87]
    v_mfma_f32_16x16x32_bf16 v[80:83], v[120:123], v[156:159], v[80:83]
    v_mfma_f32_16x16x32_bf16 v[116:119], v[136:139], v[156:159], v[116:119]
    s_waitcnt lgkmcnt(0)
    s_barrier
    v_mfma_f32_16x16x32_bf16 v[16:19], v[184:187], v[164:167], v[16:19]
    ds_read_b128 v[120:123], v4 offset:36864
    v_mfma_f32_16x16x32_bf16 v[20:23], v[188:191], v[164:167], v[20:23]
    ds_read_b128 v[124:127], v4 offset:38912
    v_mfma_f32_16x16x32_bf16 v[52:55], v[196:199], v[164:167], v[52:55]
    ds_read_b128 v[128:131], v4 offset:40960
    v_mfma_f32_16x16x32_bf16 v[48:51], v[192:195], v[164:167], v[48:51]
    ds_read_b128 v[132:135], v4 offset:43008
    v_mfma_f32_16x16x32_bf16 v[56:59], v[192:195], v[168:171], v[56:59]
    ds_read_b128 v[136:139], v2 offset:36864
    v_mfma_f32_16x16x32_bf16 v[60:63], v[196:199], v[168:171], v[60:63]
    ds_read_b64_tr_b16 v[140:141], v6 offset:49152
    v_mfma_f32_16x16x32_bf16 v[28:31], v[188:191], v[168:171], v[28:31]
    ds_read_b64_tr_b16 v[142:143], v6 offset:49664
    v_mfma_f32_16x16x32_bf16 v[24:27], v[184:187], v[168:171], v[24:27]
    ds_read_b64_tr_b16 v[144:145], v7 offset:49152
    v_mfma_f32_16x16x32_bf16 v[32:35], v[184:187], v[172:175], v[32:35]
    ds_read_b64_tr_b16 v[146:147], v7 offset:49664
    v_mfma_f32_16x16x32_bf16 v[36:39], v[188:191], v[172:175], v[36:39]
    ds_read_b64_tr_b16 v[148:149], v6 offset:50176
    v_mfma_f32_16x16x32_bf16 v[68:71], v[196:199], v[172:175], v[68:71]
    ds_read_b64_tr_b16 v[150:151], v6 offset:50688
    v_mfma_f32_16x16x32_bf16 v[64:67], v[192:195], v[172:175], v[64:67]
    ds_read_b64_tr_b16 v[152:153], v7 offset:50176
    v_mfma_f32_16x16x32_bf16 v[112:115], v[192:195], v[180:183], v[112:115]
    ds_read_b64_tr_b16 v[154:155], v7 offset:50688
    v_mfma_f32_16x16x32_bf16 v[72:75], v[192:195], v[176:179], v[72:75]
    ds_read_b64_tr_b16 v[156:157], v6 offset:51200
    v_mfma_f32_16x16x32_bf16 v[76:79], v[196:199], v[176:179], v[76:79]
    ds_read_b64_tr_b16 v[158:159], v6 offset:51712
    v_mfma_f32_16x16x32_bf16 v[44:47], v[188:191], v[176:179], v[44:47]
    ds_read_b64_tr_b16 v[160:161], v7 offset:51200
    v_mfma_f32_16x16x32_bf16 v[40:43], v[184:187], v[176:179], v[40:43]
    ds_read_b64_tr_b16 v[162:163], v7 offset:51712
    v_mfma_f32_16x16x32_bf16 v[104:107], v[176:179], v[200:203], v[104:107]
    v_mfma_f32_16x16x32_bf16 v[108:111], v[176:179], v[204:207], v[108:111]
    v_mfma_f32_16x16x32_bf16 v[100:103], v[172:175], v[204:207], v[100:103]
    v_mfma_f32_16x16x32_bf16 v[96:99], v[172:175], v[200:203], v[96:99]
    v_mfma_f32_16x16x32_bf16 v[88:91], v[168:171], v[200:203], v[88:91]
    v_mfma_f32_16x16x32_bf16 v[92:95], v[168:171], v[204:207], v[92:95]
    v_mfma_f32_16x16x32_bf16 v[84:87], v[164:167], v[204:207], v[84:87]
    v_mfma_f32_16x16x32_bf16 v[80:83], v[164:167], v[200:203], v[80:83]
    v_mfma_f32_16x16x32_bf16 v[116:119], v[180:183], v[200:203], v[116:119]
    s_waitcnt lgkmcnt(0)
    v_mfma_f32_16x16x32_bf16 v[16:19], v[140:143], v[120:123], v[16:19]
    ds_read_b128 v[164:167], v5 offset:36864
    v_mfma_f32_16x16x32_bf16 v[20:23], v[144:147], v[120:123], v[20:23]
    ds_read_b128 v[168:171], v5 offset:38912
    v_mfma_f32_16x16x32_bf16 v[52:55], v[152:155], v[120:123], v[52:55]
    ds_read_b128 v[172:175], v5 offset:40960
    v_mfma_f32_16x16x32_bf16 v[48:51], v[148:151], v[120:123], v[48:51]
    ds_read_b128 v[176:179], v5 offset:43008
    v_mfma_f32_16x16x32_bf16 v[56:59], v[148:151], v[124:127], v[56:59]
    ds_read_b128 v[180:183], v3 offset:36864
    v_mfma_f32_16x16x32_bf16 v[60:63], v[152:155], v[124:127], v[60:63]
    ds_read_b64_tr_b16 v[184:185], v6 offset:61440
    v_mfma_f32_16x16x32_bf16 v[28:31], v[144:147], v[124:127], v[28:31]
    ds_read_b64_tr_b16 v[186:187], v6 offset:61952
    v_mfma_f32_16x16x32_bf16 v[24:27], v[140:143], v[124:127], v[24:27]
    ds_read_b64_tr_b16 v[188:189], v7 offset:61440
    v_mfma_f32_16x16x32_bf16 v[32:35], v[140:143], v[128:131], v[32:35]
    ds_read_b64_tr_b16 v[190:191], v7 offset:61952
    v_mfma_f32_16x16x32_bf16 v[36:39], v[144:147], v[128:131], v[36:39]
    ds_read_b64_tr_b16 v[192:193], v6 offset:62464
    v_mfma_f32_16x16x32_bf16 v[68:71], v[152:155], v[128:131], v[68:71]
    ds_read_b64_tr_b16 v[194:195], v6 offset:62976
    v_mfma_f32_16x16x32_bf16 v[64:67], v[148:151], v[128:131], v[64:67]
    ds_read_b64_tr_b16 v[196:197], v7 offset:62464
    v_mfma_f32_16x16x32_bf16 v[112:115], v[148:151], v[136:139], v[112:115]
    ds_read_b64_tr_b16 v[198:199], v7 offset:62976
    v_mfma_f32_16x16x32_bf16 v[72:75], v[148:151], v[132:135], v[72:75]
    ds_read_b64_tr_b16 v[200:201], v6 offset:63488
    v_mfma_f32_16x16x32_bf16 v[76:79], v[152:155], v[132:135], v[76:79]
    ds_read_b64_tr_b16 v[202:203], v6 offset:64000
    v_mfma_f32_16x16x32_bf16 v[44:47], v[144:147], v[132:135], v[44:47]
    ds_read_b64_tr_b16 v[204:205], v7 offset:63488
    v_mfma_f32_16x16x32_bf16 v[40:43], v[140:143], v[132:135], v[40:43]
    ds_read_b64_tr_b16 v[206:207], v7 offset:64000
    v_mfma_f32_16x16x32_bf16 v[104:107], v[132:135], v[156:159], v[104:107]
    v_mfma_f32_16x16x32_bf16 v[108:111], v[132:135], v[160:163], v[108:111]
    v_mfma_f32_16x16x32_bf16 v[100:103], v[128:131], v[160:163], v[100:103]
    v_mfma_f32_16x16x32_bf16 v[96:99], v[128:131], v[156:159], v[96:99]
    v_mfma_f32_16x16x32_bf16 v[88:91], v[124:127], v[156:159], v[88:91]
    v_mfma_f32_16x16x32_bf16 v[92:95], v[124:127], v[160:163], v[92:95]
    v_mfma_f32_16x16x32_bf16 v[84:87], v[120:123], v[160:163], v[84:87]
    v_mfma_f32_16x16x32_bf16 v[80:83], v[120:123], v[156:159], v[80:83]
    v_mfma_f32_16x16x32_bf16 v[116:119], v[136:139], v[156:159], v[116:119]
    s_waitcnt lgkmcnt(0)
    s_barrier
    v_mfma_f32_16x16x32_bf16 v[16:19], v[184:187], v[164:167], v[16:19]
    ds_read_b128 v[120:123], v4 offset:0
    v_mfma_f32_16x16x32_bf16 v[20:23], v[188:191], v[164:167], v[20:23]
    ds_read_b128 v[124:127], v4 offset:2048
    v_mfma_f32_16x16x32_bf16 v[52:55], v[196:199], v[164:167], v[52:55]
    ds_read_b128 v[128:131], v4 offset:4096
    v_mfma_f32_16x16x32_bf16 v[48:51], v[192:195], v[164:167], v[48:51]
    ds_read_b128 v[132:135], v4 offset:6144
    v_mfma_f32_16x16x32_bf16 v[56:59], v[192:195], v[168:171], v[56:59]
    ds_read_b128 v[136:139], v2 offset:0
    v_mfma_f32_16x16x32_bf16 v[60:63], v[196:199], v[168:171], v[60:63]
    ds_read_b64_tr_b16 v[140:141], v6 offset:0
    v_mfma_f32_16x16x32_bf16 v[28:31], v[188:191], v[168:171], v[28:31]
    ds_read_b64_tr_b16 v[142:143], v6 offset:512
    v_mfma_f32_16x16x32_bf16 v[24:27], v[184:187], v[168:171], v[24:27]
    ds_read_b64_tr_b16 v[144:145], v7 offset:0
    v_mfma_f32_16x16x32_bf16 v[32:35], v[184:187], v[172:175], v[32:35]
    ds_read_b64_tr_b16 v[146:147], v7 offset:512
    v_mfma_f32_16x16x32_bf16 v[36:39], v[188:191], v[172:175], v[36:39]
    ds_read_b64_tr_b16 v[148:149], v6 offset:1024
    v_mfma_f32_16x16x32_bf16 v[68:71], v[196:199], v[172:175], v[68:71]
    ds_read_b64_tr_b16 v[150:151], v6 offset:1536
    v_mfma_f32_16x16x32_bf16 v[64:67], v[192:195], v[172:175], v[64:67]
    ds_read_b64_tr_b16 v[152:153], v7 offset:1024
    v_mfma_f32_16x16x32_bf16 v[112:115], v[192:195], v[180:183], v[112:115]
    ds_read_b64_tr_b16 v[154:155], v7 offset:1536
    v_mfma_f32_16x16x32_bf16 v[72:75], v[192:195], v[176:179], v[72:75]
    ds_read_b64_tr_b16 v[156:157], v6 offset:2048
    v_mfma_f32_16x16x32_bf16 v[76:79], v[196:199], v[176:179], v[76:79]
    ds_read_b64_tr_b16 v[158:159], v6 offset:2560
    v_mfma_f32_16x16x32_bf16 v[44:47], v[188:191], v[176:179], v[44:47]
    ds_read_b64_tr_b16 v[160:161], v7 offset:2048
    v_mfma_f32_16x16x32_bf16 v[40:43], v[184:187], v[176:179], v[40:43]
    ds_read_b64_tr_b16 v[162:163], v7 offset:2560
    v_mfma_f32_16x16x32_bf16 v[104:107], v[176:179], v[200:203], v[104:107]
    v_mfma_f32_16x16x32_bf16 v[108:111], v[176:179], v[204:207], v[108:111]
    v_mfma_f32_16x16x32_bf16 v[100:103], v[172:175], v[204:207], v[100:103]
    v_mfma_f32_16x16x32_bf16 v[96:99], v[172:175], v[200:203], v[96:99]
    v_mfma_f32_16x16x32_bf16 v[88:91], v[168:171], v[200:203], v[88:91]
    v_mfma_f32_16x16x32_bf16 v[92:95], v[168:171], v[204:207], v[92:95]
    v_mfma_f32_16x16x32_bf16 v[84:87], v[164:167], v[204:207], v[84:87]
    v_mfma_f32_16x16x32_bf16 v[80:83], v[164:167], v[200:203], v[80:83]
    v_mfma_f32_16x16x32_bf16 v[116:119], v[180:183], v[200:203], v[116:119]
    s_waitcnt lgkmcnt(0)
    v_mfma_f32_16x16x32_bf16 v[16:19], v[140:143], v[120:123], v[16:19]
    ds_read_b128 v[164:167], v5 offset:0
    v_mfma_f32_16x16x32_bf16 v[20:23], v[144:147], v[120:123], v[20:23]
    ds_read_b128 v[168:171], v5 offset:2048
    v_mfma_f32_16x16x32_bf16 v[52:55], v[152:155], v[120:123], v[52:55]
    ds_read_b128 v[172:175], v5 offset:4096
    v_mfma_f32_16x16x32_bf16 v[48:51], v[148:151], v[120:123], v[48:51]
    ds_read_b128 v[176:179], v5 offset:6144
    v_mfma_f32_16x16x32_bf16 v[56:59], v[148:151], v[124:127], v[56:59]
    ds_read_b128 v[180:183], v3 offset:0
    v_mfma_f32_16x16x32_bf16 v[60:63], v[152:155], v[124:127], v[60:63]
    ds_read_b64_tr_b16 v[184:185], v6 offset:12288
    v_mfma_f32_16x16x32_bf16 v[28:31], v[144:147], v[124:127], v[28:31]
    ds_read_b64_tr_b16 v[186:187], v6 offset:12800
    v_mfma_f32_16x16x32_bf16 v[24:27], v[140:143], v[124:127], v[24:27]
    ds_read_b64_tr_b16 v[188:189], v7 offset:12288
    v_mfma_f32_16x16x32_bf16 v[32:35], v[140:143], v[128:131], v[32:35]
    ds_read_b64_tr_b16 v[190:191], v7 offset:12800
    v_mfma_f32_16x16x32_bf16 v[36:39], v[144:147], v[128:131], v[36:39]
    ds_read_b64_tr_b16 v[192:193], v6 offset:13312
    v_mfma_f32_16x16x32_bf16 v[68:71], v[152:155], v[128:131], v[68:71]
    ds_read_b64_tr_b16 v[194:195], v6 offset:13824
    v_mfma_f32_16x16x32_bf16 v[64:67], v[148:151], v[128:131], v[64:67]
    ds_read_b64_tr_b16 v[196:197], v7 offset:13312
    v_mfma_f32_16x16x32_bf16 v[112:115], v[148:151], v[136:139], v[112:115]
    ds_read_b64_tr_b16 v[198:199], v7 offset:13824
    v_mfma_f32_16x16x32_bf16 v[72:75], v[148:151], v[132:135], v[72:75]
    ds_read_b64_tr_b16 v[200:201], v6 offset:14336
    v_mfma_f32_16x16x32_bf16 v[76:79], v[152:155], v[132:135], v[76:79]
    ds_read_b64_tr_b16 v[202:203], v6 offset:14848
    v_mfma_f32_16x16x32_bf16 v[44:47], v[144:147], v[132:135], v[44:47]
    ds_read_b64_tr_b16 v[204:205], v7 offset:14336
    v_mfma_f32_16x16x32_bf16 v[40:43], v[140:143], v[132:135], v[40:43]
    ds_read_b64_tr_b16 v[206:207], v7 offset:14848
    v_mfma_f32_16x16x32_bf16 v[104:107], v[132:135], v[156:159], v[104:107]
    v_mfma_f32_16x16x32_bf16 v[108:111], v[132:135], v[160:163], v[108:111]
    v_mfma_f32_16x16x32_bf16 v[100:103], v[128:131], v[160:163], v[100:103]
    v_mfma_f32_16x16x32_bf16 v[96:99], v[128:131], v[156:159], v[96:99]
    v_mfma_f32_16x16x32_bf16 v[88:91], v[124:127], v[156:159], v[88:91]
    v_mfma_f32_16x16x32_bf16 v[92:95], v[124:127], v[160:163], v[92:95]
    v_mfma_f32_16x16x32_bf16 v[84:87], v[120:123], v[160:163], v[84:87]
    v_mfma_f32_16x16x32_bf16 v[80:83], v[120:123], v[156:159], v[80:83]
    v_mfma_f32_16x16x32_bf16 v[116:119], v[136:139], v[156:159], v[116:119]
    s_waitcnt lgkmcnt(0)
    s_barrier
    v_mfma_f32_16x16x32_bf16 v[16:19], v[184:187], v[164:167], v[16:19]
    ds_read_b128 v[120:123], v4 offset:18432
    v_mfma_f32_16x16x32_bf16 v[20:23], v[188:191], v[164:167], v[20:23]
    ds_read_b128 v[124:127], v4 offset:20480
    v_mfma_f32_16x16x32_bf16 v[52:55], v[196:199], v[164:167], v[52:55]
    ds_read_b128 v[128:131], v4 offset:22528
    v_mfma_f32_16x16x32_bf16 v[48:51], v[192:195], v[164:167], v[48:51]
    ds_read_b128 v[132:135], v4 offset:24576
    v_mfma_f32_16x16x32_bf16 v[56:59], v[192:195], v[168:171], v[56:59]
    ds_read_b128 v[136:139], v2 offset:18432
    v_mfma_f32_16x16x32_bf16 v[60:63], v[196:199], v[168:171], v[60:63]
    ds_read_b64_tr_b16 v[140:141], v6 offset:24576
    v_mfma_f32_16x16x32_bf16 v[28:31], v[188:191], v[168:171], v[28:31]
    ds_read_b64_tr_b16 v[142:143], v6 offset:25088
    v_mfma_f32_16x16x32_bf16 v[24:27], v[184:187], v[168:171], v[24:27]
    ds_read_b64_tr_b16 v[144:145], v7 offset:24576
    v_mfma_f32_16x16x32_bf16 v[32:35], v[184:187], v[172:175], v[32:35]
    ds_read_b64_tr_b16 v[146:147], v7 offset:25088
    v_mfma_f32_16x16x32_bf16 v[36:39], v[188:191], v[172:175], v[36:39]
    ds_read_b64_tr_b16 v[148:149], v6 offset:25600
    v_mfma_f32_16x16x32_bf16 v[68:71], v[196:199], v[172:175], v[68:71]
    ds_read_b64_tr_b16 v[150:151], v6 offset:26112
    v_mfma_f32_16x16x32_bf16 v[64:67], v[192:195], v[172:175], v[64:67]
    ds_read_b64_tr_b16 v[152:153], v7 offset:25600
    v_mfma_f32_16x16x32_bf16 v[112:115], v[192:195], v[180:183], v[112:115]
    ds_read_b64_tr_b16 v[154:155], v7 offset:26112
    v_mfma_f32_16x16x32_bf16 v[72:75], v[192:195], v[176:179], v[72:75]
    ds_read_b64_tr_b16 v[156:157], v6 offset:26624
    v_mfma_f32_16x16x32_bf16 v[76:79], v[196:199], v[176:179], v[76:79]
    ds_read_b64_tr_b16 v[158:159], v6 offset:27136
    v_mfma_f32_16x16x32_bf16 v[44:47], v[188:191], v[176:179], v[44:47]
    ds_read_b64_tr_b16 v[160:161], v7 offset:26624
    v_mfma_f32_16x16x32_bf16 v[40:43], v[184:187], v[176:179], v[40:43]
    ds_read_b64_tr_b16 v[162:163], v7 offset:27136
    v_mfma_f32_16x16x32_bf16 v[104:107], v[176:179], v[200:203], v[104:107]
    v_mfma_f32_16x16x32_bf16 v[108:111], v[176:179], v[204:207], v[108:111]
    v_mfma_f32_16x16x32_bf16 v[100:103], v[172:175], v[204:207], v[100:103]
    v_mfma_f32_16x16x32_bf16 v[96:99], v[172:175], v[200:203], v[96:99]
    v_mfma_f32_16x16x32_bf16 v[88:91], v[168:171], v[200:203], v[88:91]
    v_mfma_f32_16x16x32_bf16 v[92:95], v[168:171], v[204:207], v[92:95]
    v_mfma_f32_16x16x32_bf16 v[84:87], v[164:167], v[204:207], v[84:87]
    v_mfma_f32_16x16x32_bf16 v[80:83], v[164:167], v[200:203], v[80:83]
    v_mfma_f32_16x16x32_bf16 v[116:119], v[180:183], v[200:203], v[116:119]
    s_waitcnt lgkmcnt(0)
    v_mfma_f32_16x16x32_bf16 v[16:19], v[140:143], v[120:123], v[16:19]
    ds_read_b128 v[164:167], v5 offset:18432
    v_mfma_f32_16x16x32_bf16 v[20:23], v[144:147], v[120:123], v[20:23]
    ds_read_b128 v[168:171], v5 offset:20480
    v_mfma_f32_16x16x32_bf16 v[52:55], v[152:155], v[120:123], v[52:55]
    ds_read_b128 v[172:175], v5 offset:22528
    v_mfma_f32_16x16x32_bf16 v[48:51], v[148:151], v[120:123], v[48:51]
    ds_read_b128 v[176:179], v5 offset:24576
    v_mfma_f32_16x16x32_bf16 v[56:59], v[148:151], v[124:127], v[56:59]
    ds_read_b128 v[180:183], v3 offset:18432
    v_mfma_f32_16x16x32_bf16 v[60:63], v[152:155], v[124:127], v[60:63]
    ds_read_b64_tr_b16 v[184:185], v6 offset:36864
    v_mfma_f32_16x16x32_bf16 v[28:31], v[144:147], v[124:127], v[28:31]
    ds_read_b64_tr_b16 v[186:187], v6 offset:37376
    v_mfma_f32_16x16x32_bf16 v[24:27], v[140:143], v[124:127], v[24:27]
    ds_read_b64_tr_b16 v[188:189], v7 offset:36864
    v_mfma_f32_16x16x32_bf16 v[32:35], v[140:143], v[128:131], v[32:35]
    ds_read_b64_tr_b16 v[190:191], v7 offset:37376
    v_mfma_f32_16x16x32_bf16 v[36:39], v[144:147], v[128:131], v[36:39]
    ds_read_b64_tr_b16 v[192:193], v6 offset:37888
    v_mfma_f32_16x16x32_bf16 v[68:71], v[152:155], v[128:131], v[68:71]
    ds_read_b64_tr_b16 v[194:195], v6 offset:38400
    v_mfma_f32_16x16x32_bf16 v[64:67], v[148:151], v[128:131], v[64:67]
    ds_read_b64_tr_b16 v[196:197], v7 offset:37888
    v_mfma_f32_16x16x32_bf16 v[112:115], v[148:151], v[136:139], v[112:115]
    ds_read_b64_tr_b16 v[198:199], v7 offset:38400
    v_mfma_f32_16x16x32_bf16 v[72:75], v[148:151], v[132:135], v[72:75]
    ds_read_b64_tr_b16 v[200:201], v6 offset:38912
    v_mfma_f32_16x16x32_bf16 v[76:79], v[152:155], v[132:135], v[76:79]
    ds_read_b64_tr_b16 v[202:203], v6 offset:39424
    v_mfma_f32_16x16x32_bf16 v[44:47], v[144:147], v[132:135], v[44:47]
    ds_read_b64_tr_b16 v[204:205], v7 offset:38912
    v_mfma_f32_16x16x32_bf16 v[40:43], v[140:143], v[132:135], v[40:43]
    ds_read_b64_tr_b16 v[206:207], v7 offset:39424
    v_mfma_f32_16x16x32_bf16 v[104:107], v[132:135], v[156:159], v[104:107]
    v_mfma_f32_16x16x32_bf16 v[108:111], v[132:135], v[160:163], v[108:111]
    v_mfma_f32_16x16x32_bf16 v[100:103], v[128:131], v[160:163], v[100:103]
    v_mfma_f32_16x16x32_bf16 v[96:99], v[128:131], v[156:159], v[96:99]
    v_mfma_f32_16x16x32_bf16 v[88:91], v[124:127], v[156:159], v[88:91]
    v_mfma_f32_16x16x32_bf16 v[92:95], v[124:127], v[160:163], v[92:95]
    v_mfma_f32_16x16x32_bf16 v[84:87], v[120:123], v[160:163], v[84:87]
    v_mfma_f32_16x16x32_bf16 v[80:83], v[120:123], v[156:159], v[80:83]
    v_mfma_f32_16x16x32_bf16 v[116:119], v[136:139], v[156:159], v[116:119]
    s_waitcnt lgkmcnt(0)
    s_barrier
    v_mfma_f32_16x16x32_bf16 v[16:19], v[184:187], v[164:167], v[16:19]
    ds_read_b128 v[120:123], v4 offset:36864
    v_mfma_f32_16x16x32_bf16 v[20:23], v[188:191], v[164:167], v[20:23]
    ds_read_b128 v[124:127], v4 offset:38912
    v_mfma_f32_16x16x32_bf16 v[52:55], v[196:199], v[164:167], v[52:55]
    ds_read_b128 v[128:131], v4 offset:40960
    v_mfma_f32_16x16x32_bf16 v[48:51], v[192:195], v[164:167], v[48:51]
    ds_read_b128 v[132:135], v4 offset:43008
    v_mfma_f32_16x16x32_bf16 v[56:59], v[192:195], v[168:171], v[56:59]
    ds_read_b128 v[136:139], v2 offset:36864
    v_mfma_f32_16x16x32_bf16 v[60:63], v[196:199], v[168:171], v[60:63]
    ds_read_b64_tr_b16 v[140:141], v6 offset:49152
    v_mfma_f32_16x16x32_bf16 v[28:31], v[188:191], v[168:171], v[28:31]
    ds_read_b64_tr_b16 v[142:143], v6 offset:49664
    v_mfma_f32_16x16x32_bf16 v[24:27], v[184:187], v[168:171], v[24:27]
    ds_read_b64_tr_b16 v[144:145], v7 offset:49152
    v_mfma_f32_16x16x32_bf16 v[32:35], v[184:187], v[172:175], v[32:35]
    ds_read_b64_tr_b16 v[146:147], v7 offset:49664
    v_mfma_f32_16x16x32_bf16 v[36:39], v[188:191], v[172:175], v[36:39]
    ds_read_b64_tr_b16 v[148:149], v6 offset:50176
    v_mfma_f32_16x16x32_bf16 v[68:71], v[196:199], v[172:175], v[68:71]
    ds_read_b64_tr_b16 v[150:151], v6 offset:50688
    v_mfma_f32_16x16x32_bf16 v[64:67], v[192:195], v[172:175], v[64:67]
    ds_read_b64_tr_b16 v[152:153], v7 offset:50176
    v_mfma_f32_16x16x32_bf16 v[112:115], v[192:195], v[180:183], v[112:115]
    ds_read_b64_tr_b16 v[154:155], v7 offset:50688
    v_mfma_f32_16x16x32_bf16 v[72:75], v[192:195], v[176:179], v[72:75]
    ds_read_b64_tr_b16 v[156:157], v6 offset:51200
    v_mfma_f32_16x16x32_bf16 v[76:79], v[196:199], v[176:179], v[76:79]
    ds_read_b64_tr_b16 v[158:159], v6 offset:51712
    v_mfma_f32_16x16x32_bf16 v[44:47], v[188:191], v[176:179], v[44:47]
    ds_read_b64_tr_b16 v[160:161], v7 offset:51200
    v_mfma_f32_16x16x32_bf16 v[40:43], v[184:187], v[176:179], v[40:43]
    ds_read_b64_tr_b16 v[162:163], v7 offset:51712
    v_mfma_f32_16x16x32_bf16 v[104:107], v[176:179], v[200:203], v[104:107]
    v_mfma_f32_16x16x32_bf16 v[108:111], v[176:179], v[204:207], v[108:111]
    v_mfma_f32_16x16x32_bf16 v[100:103], v[172:175], v[204:207], v[100:103]
    v_mfma_f32_16x16x32_bf16 v[96:99], v[172:175], v[200:203], v[96:99]
    v_mfma_f32_16x16x32_bf16 v[88:91], v[168:171], v[200:203], v[88:91]
    v_mfma_f32_16x16x32_bf16 v[92:95], v[168:171], v[204:207], v[92:95]
    v_mfma_f32_16x16x32_bf16 v[84:87], v[164:167], v[204:207], v[84:87]
    v_mfma_f32_16x16x32_bf16 v[80:83], v[164:167], v[200:203], v[80:83]
    v_mfma_f32_16x16x32_bf16 v[116:119], v[180:183], v[200:203], v[116:119]
    s_waitcnt lgkmcnt(0)
    v_mfma_f32_16x16x32_bf16 v[16:19], v[140:143], v[120:123], v[16:19]
    ds_read_b128 v[164:167], v5 offset:36864
    v_mfma_f32_16x16x32_bf16 v[20:23], v[144:147], v[120:123], v[20:23]
    ds_read_b128 v[168:171], v5 offset:38912
    v_mfma_f32_16x16x32_bf16 v[52:55], v[152:155], v[120:123], v[52:55]
    ds_read_b128 v[172:175], v5 offset:40960
    v_mfma_f32_16x16x32_bf16 v[48:51], v[148:151], v[120:123], v[48:51]
    ds_read_b128 v[176:179], v5 offset:43008
    v_mfma_f32_16x16x32_bf16 v[56:59], v[148:151], v[124:127], v[56:59]
    ds_read_b128 v[180:183], v3 offset:36864
    v_mfma_f32_16x16x32_bf16 v[60:63], v[152:155], v[124:127], v[60:63]
    ds_read_b64_tr_b16 v[184:185], v6 offset:61440
    v_mfma_f32_16x16x32_bf16 v[28:31], v[144:147], v[124:127], v[28:31]
    ds_read_b64_tr_b16 v[186:187], v6 offset:61952
    v_mfma_f32_16x16x32_bf16 v[24:27], v[140:143], v[124:127], v[24:27]
    ds_read_b64_tr_b16 v[188:189], v7 offset:61440
    v_mfma_f32_16x16x32_bf16 v[32:35], v[140:143], v[128:131], v[32:35]
    ds_read_b64_tr_b16 v[190:191], v7 offset:61952
    v_mfma_f32_16x16x32_bf16 v[36:39], v[144:147], v[128:131], v[36:39]
    ds_read_b64_tr_b16 v[192:193], v6 offset:62464
    v_mfma_f32_16x16x32_bf16 v[68:71], v[152:155], v[128:131], v[68:71]
    ds_read_b64_tr_b16 v[194:195], v6 offset:62976
    v_mfma_f32_16x16x32_bf16 v[64:67], v[148:151], v[128:131], v[64:67]
    ds_read_b64_tr_b16 v[196:197], v7 offset:62464
    v_mfma_f32_16x16x32_bf16 v[112:115], v[148:151], v[136:139], v[112:115]
    ds_read_b64_tr_b16 v[198:199], v7 offset:62976
    v_mfma_f32_16x16x32_bf16 v[72:75], v[148:151], v[132:135], v[72:75]
    ds_read_b64_tr_b16 v[200:201], v6 offset:63488
    v_mfma_f32_16x16x32_bf16 v[76:79], v[152:155], v[132:135], v[76:79]
    ds_read_b64_tr_b16 v[202:203], v6 offset:64000
    v_mfma_f32_16x16x32_bf16 v[44:47], v[144:147], v[132:135], v[44:47]
    ds_read_b64_tr_b16 v[204:205], v7 offset:63488
    v_mfma_f32_16x16x32_bf16 v[40:43], v[140:143], v[132:135], v[40:43]
    ds_read_b64_tr_b16 v[206:207], v7 offset:64000
    v_mfma_f32_16x16x32_bf16 v[104:107], v[132:135], v[156:159], v[104:107]
    v_mfma_f32_16x16x32_bf16 v[108:111], v[132:135], v[160:163], v[108:111]
    v_mfma_f32_16x16x32_bf16 v[100:103], v[128:131], v[160:163], v[100:103]
    v_mfma_f32_16x16x32_bf16 v[96:99], v[128:131], v[156:159], v[96:99]
    v_mfma_f32_16x16x32_bf16 v[88:91], v[124:127], v[156:159], v[88:91]
    v_mfma_f32_16x16x32_bf16 v[92:95], v[124:127], v[160:163], v[92:95]
    v_mfma_f32_16x16x32_bf16 v[84:87], v[120:123], v[160:163], v[84:87]
    v_mfma_f32_16x16x32_bf16 v[80:83], v[120:123], v[156:159], v[80:83]
    v_mfma_f32_16x16x32_bf16 v[116:119], v[136:139], v[156:159], v[116:119]
    s_waitcnt lgkmcnt(0)
    s_barrier
    v_mfma_f32_16x16x32_bf16 v[16:19], v[184:187], v[164:167], v[16:19]
    ds_read_b128 v[120:123], v4 offset:0
    v_mfma_f32_16x16x32_bf16 v[20:23], v[188:191], v[164:167], v[20:23]
    ds_read_b128 v[124:127], v4 offset:2048
    v_mfma_f32_16x16x32_bf16 v[52:55], v[196:199], v[164:167], v[52:55]
    ds_read_b128 v[128:131], v4 offset:4096
    v_mfma_f32_16x16x32_bf16 v[48:51], v[192:195], v[164:167], v[48:51]
    ds_read_b128 v[132:135], v4 offset:6144
    v_mfma_f32_16x16x32_bf16 v[56:59], v[192:195], v[168:171], v[56:59]
    ds_read_b128 v[136:139], v2 offset:0
    v_mfma_f32_16x16x32_bf16 v[60:63], v[196:199], v[168:171], v[60:63]
    ds_read_b64_tr_b16 v[140:141], v6 offset:0
    v_mfma_f32_16x16x32_bf16 v[28:31], v[188:191], v[168:171], v[28:31]
    ds_read_b64_tr_b16 v[142:143], v6 offset:512
    v_mfma_f32_16x16x32_bf16 v[24:27], v[184:187], v[168:171], v[24:27]
    ds_read_b64_tr_b16 v[144:145], v7 offset:0
    v_mfma_f32_16x16x32_bf16 v[32:35], v[184:187], v[172:175], v[32:35]
    ds_read_b64_tr_b16 v[146:147], v7 offset:512
    v_mfma_f32_16x16x32_bf16 v[36:39], v[188:191], v[172:175], v[36:39]
    ds_read_b64_tr_b16 v[148:149], v6 offset:1024
    v_mfma_f32_16x16x32_bf16 v[68:71], v[196:199], v[172:175], v[68:71]
    ds_read_b64_tr_b16 v[150:151], v6 offset:1536
    v_mfma_f32_16x16x32_bf16 v[64:67], v[192:195], v[172:175], v[64:67]
    ds_read_b64_tr_b16 v[152:153], v7 offset:1024
    v_mfma_f32_16x16x32_bf16 v[112:115], v[192:195], v[180:183], v[112:115]
    ds_read_b64_tr_b16 v[154:155], v7 offset:1536
    v_mfma_f32_16x16x32_bf16 v[72:75], v[192:195], v[176:179], v[72:75]
    ds_read_b64_tr_b16 v[156:157], v6 offset:2048
    v_mfma_f32_16x16x32_bf16 v[76:79], v[196:199], v[176:179], v[76:79]
    ds_read_b64_tr_b16 v[158:159], v6 offset:2560
    v_mfma_f32_16x16x32_bf16 v[44:47], v[188:191], v[176:179], v[44:47]
    ds_read_b64_tr_b16 v[160:161], v7 offset:2048
    v_mfma_f32_16x16x32_bf16 v[40:43], v[184:187], v[176:179], v[40:43]
    ds_read_b64_tr_b16 v[162:163], v7 offset:2560
    v_mfma_f32_16x16x32_bf16 v[104:107], v[176:179], v[200:203], v[104:107]
    v_mfma_f32_16x16x32_bf16 v[108:111], v[176:179], v[204:207], v[108:111]
    v_mfma_f32_16x16x32_bf16 v[100:103], v[172:175], v[204:207], v[100:103]
    v_mfma_f32_16x16x32_bf16 v[96:99], v[172:175], v[200:203], v[96:99]
    v_mfma_f32_16x16x32_bf16 v[88:91], v[168:171], v[200:203], v[88:91]
    v_mfma_f32_16x16x32_bf16 v[92:95], v[168:171], v[204:207], v[92:95]
    v_mfma_f32_16x16x32_bf16 v[84:87], v[164:167], v[204:207], v[84:87]
    v_mfma_f32_16x16x32_bf16 v[80:83], v[164:167], v[200:203], v[80:83]
    v_mfma_f32_16x16x32_bf16 v[116:119], v[180:183], v[200:203], v[116:119]
    s_waitcnt lgkmcnt(0)
    v_mfma_f32_16x16x32_bf16 v[16:19], v[140:143], v[120:123], v[16:19]
    ds_read_b128 v[164:167], v5 offset:0
    v_mfma_f32_16x16x32_bf16 v[20:23], v[144:147], v[120:123], v[20:23]
    ds_read_b128 v[168:171], v5 offset:2048
    v_mfma_f32_16x16x32_bf16 v[52:55], v[152:155], v[120:123], v[52:55]
    ds_read_b128 v[172:175], v5 offset:4096
    v_mfma_f32_16x16x32_bf16 v[48:51], v[148:151], v[120:123], v[48:51]
    ds_read_b128 v[176:179], v5 offset:6144
    v_mfma_f32_16x16x32_bf16 v[56:59], v[148:151], v[124:127], v[56:59]
    ds_read_b128 v[180:183], v3 offset:0
    v_mfma_f32_16x16x32_bf16 v[60:63], v[152:155], v[124:127], v[60:63]
    ds_read_b64_tr_b16 v[184:185], v6 offset:12288
    v_mfma_f32_16x16x32_bf16 v[28:31], v[144:147], v[124:127], v[28:31]
    ds_read_b64_tr_b16 v[186:187], v6 offset:12800
    v_mfma_f32_16x16x32_bf16 v[24:27], v[140:143], v[124:127], v[24:27]
    ds_read_b64_tr_b16 v[188:189], v7 offset:12288
    v_mfma_f32_16x16x32_bf16 v[32:35], v[140:143], v[128:131], v[32:35]
    ds_read_b64_tr_b16 v[190:191], v7 offset:12800
    v_mfma_f32_16x16x32_bf16 v[36:39], v[144:147], v[128:131], v[36:39]
    ds_read_b64_tr_b16 v[192:193], v6 offset:13312
    v_mfma_f32_16x16x32_bf16 v[68:71], v[152:155], v[128:131], v[68:71]
    ds_read_b64_tr_b16 v[194:195], v6 offset:13824
    v_mfma_f32_16x16x32_bf16 v[64:67], v[148:151], v[128:131], v[64:67]
    ds_read_b64_tr_b16 v[196:197], v7 offset:13312
    v_mfma_f32_16x16x32_bf16 v[112:115], v[148:151], v[136:139], v[112:115]
    ds_read_b64_tr_b16 v[198:199], v7 offset:13824
    v_mfma_f32_16x16x32_bf16 v[72:75], v[148:151], v[132:135], v[72:75]
    ds_read_b64_tr_b16 v[200:201], v6 offset:14336
    v_mfma_f32_16x16x32_bf16 v[76:79], v[152:155], v[132:135], v[76:79]
    ds_read_b64_tr_b16 v[202:203], v6 offset:14848
    v_mfma_f32_16x16x32_bf16 v[44:47], v[144:147], v[132:135], v[44:47]
    ds_read_b64_tr_b16 v[204:205], v7 offset:14336
    v_mfma_f32_16x16x32_bf16 v[40:43], v[140:143], v[132:135], v[40:43]
    ds_read_b64_tr_b16 v[206:207], v7 offset:14848
    v_mfma_f32_16x16x32_bf16 v[104:107], v[132:135], v[156:159], v[104:107]
    v_mfma_f32_16x16x32_bf16 v[108:111], v[132:135], v[160:163], v[108:111]
    v_mfma_f32_16x16x32_bf16 v[100:103], v[128:131], v[160:163], v[100:103]
    v_mfma_f32_16x16x32_bf16 v[96:99], v[128:131], v[156:159], v[96:99]
    v_mfma_f32_16x16x32_bf16 v[88:91], v[124:127], v[156:159], v[88:91]
    v_mfma_f32_16x16x32_bf16 v[92:95], v[124:127], v[160:163], v[92:95]
    v_mfma_f32_16x16x32_bf16 v[84:87], v[120:123], v[160:163], v[84:87]
    v_mfma_f32_16x16x32_bf16 v[80:83], v[120:123], v[156:159], v[80:83]
    v_mfma_f32_16x16x32_bf16 v[116:119], v[136:139], v[156:159], v[116:119]
    s_waitcnt lgkmcnt(0)
    s_barrier
    v_mfma_f32_16x16x32_bf16 v[16:19], v[184:187], v[164:167], v[16:19]
    ds_read_b128 v[120:123], v4 offset:18432
    v_mfma_f32_16x16x32_bf16 v[20:23], v[188:191], v[164:167], v[20:23]
    ds_read_b128 v[124:127], v4 offset:20480
    v_mfma_f32_16x16x32_bf16 v[52:55], v[196:199], v[164:167], v[52:55]
    ds_read_b128 v[128:131], v4 offset:22528
    v_mfma_f32_16x16x32_bf16 v[48:51], v[192:195], v[164:167], v[48:51]
    ds_read_b128 v[132:135], v4 offset:24576
    v_mfma_f32_16x16x32_bf16 v[56:59], v[192:195], v[168:171], v[56:59]
    ds_read_b128 v[136:139], v2 offset:18432
    v_mfma_f32_16x16x32_bf16 v[60:63], v[196:199], v[168:171], v[60:63]
    ds_read_b64_tr_b16 v[140:141], v6 offset:24576
    v_mfma_f32_16x16x32_bf16 v[28:31], v[188:191], v[168:171], v[28:31]
    ds_read_b64_tr_b16 v[142:143], v6 offset:25088
    v_mfma_f32_16x16x32_bf16 v[24:27], v[184:187], v[168:171], v[24:27]
    ds_read_b64_tr_b16 v[144:145], v7 offset:24576
    v_mfma_f32_16x16x32_bf16 v[32:35], v[184:187], v[172:175], v[32:35]
    ds_read_b64_tr_b16 v[146:147], v7 offset:25088
    v_mfma_f32_16x16x32_bf16 v[36:39], v[188:191], v[172:175], v[36:39]
    ds_read_b64_tr_b16 v[148:149], v6 offset:25600
    v_mfma_f32_16x16x32_bf16 v[68:71], v[196:199], v[172:175], v[68:71]
    ds_read_b64_tr_b16 v[150:151], v6 offset:26112
    v_mfma_f32_16x16x32_bf16 v[64:67], v[192:195], v[172:175], v[64:67]
    ds_read_b64_tr_b16 v[152:153], v7 offset:25600
    v_mfma_f32_16x16x32_bf16 v[112:115], v[192:195], v[180:183], v[112:115]
    ds_read_b64_tr_b16 v[154:155], v7 offset:26112
    v_mfma_f32_16x16x32_bf16 v[72:75], v[192:195], v[176:179], v[72:75]
    ds_read_b64_tr_b16 v[156:157], v6 offset:26624
    v_mfma_f32_16x16x32_bf16 v[76:79], v[196:199], v[176:179], v[76:79]
    ds_read_b64_tr_b16 v[158:159], v6 offset:27136
    v_mfma_f32_16x16x32_bf16 v[44:47], v[188:191], v[176:179], v[44:47]
    ds_read_b64_tr_b16 v[160:161], v7 offset:26624
    v_mfma_f32_16x16x32_bf16 v[40:43], v[184:187], v[176:179], v[40:43]
    ds_read_b64_tr_b16 v[162:163], v7 offset:27136
    v_mfma_f32_16x16x32_bf16 v[104:107], v[176:179], v[200:203], v[104:107]
    v_mfma_f32_16x16x32_bf16 v[108:111], v[176:179], v[204:207], v[108:111]
    v_mfma_f32_16x16x32_bf16 v[100:103], v[172:175], v[204:207], v[100:103]
    v_mfma_f32_16x16x32_bf16 v[96:99], v[172:175], v[200:203], v[96:99]
    v_mfma_f32_16x16x32_bf16 v[88:91], v[168:171], v[200:203], v[88:91]
    v_mfma_f32_16x16x32_bf16 v[92:95], v[168:171], v[204:207], v[92:95]
    v_mfma_f32_16x16x32_bf16 v[84:87], v[164:167], v[204:207], v[84:87]
    v_mfma_f32_16x16x32_bf16 v[80:83], v[164:167], v[200:203], v[80:83]
    v_mfma_f32_16x16x32_bf16 v[116:119], v[180:183], v[200:203], v[116:119]
    s_waitcnt lgkmcnt(0)
    v_mfma_f32_16x16x32_bf16 v[16:19], v[140:143], v[120:123], v[16:19]
    ds_read_b128 v[164:167], v5 offset:18432
    v_mfma_f32_16x16x32_bf16 v[20:23], v[144:147], v[120:123], v[20:23]
    ds_read_b128 v[168:171], v5 offset:20480
    v_mfma_f32_16x16x32_bf16 v[52:55], v[152:155], v[120:123], v[52:55]
    ds_read_b128 v[172:175], v5 offset:22528
    v_mfma_f32_16x16x32_bf16 v[48:51], v[148:151], v[120:123], v[48:51]
    ds_read_b128 v[176:179], v5 offset:24576
    v_mfma_f32_16x16x32_bf16 v[56:59], v[148:151], v[124:127], v[56:59]
    ds_read_b128 v[180:183], v3 offset:18432
    v_mfma_f32_16x16x32_bf16 v[60:63], v[152:155], v[124:127], v[60:63]
    ds_read_b64_tr_b16 v[184:185], v6 offset:36864
    v_mfma_f32_16x16x32_bf16 v[28:31], v[144:147], v[124:127], v[28:31]
    ds_read_b64_tr_b16 v[186:187], v6 offset:37376
    v_mfma_f32_16x16x32_bf16 v[24:27], v[140:143], v[124:127], v[24:27]
    ds_read_b64_tr_b16 v[188:189], v7 offset:36864
    v_mfma_f32_16x16x32_bf16 v[32:35], v[140:143], v[128:131], v[32:35]
    ds_read_b64_tr_b16 v[190:191], v7 offset:37376
    v_mfma_f32_16x16x32_bf16 v[36:39], v[144:147], v[128:131], v[36:39]
    ds_read_b64_tr_b16 v[192:193], v6 offset:37888
    v_mfma_f32_16x16x32_bf16 v[68:71], v[152:155], v[128:131], v[68:71]
    ds_read_b64_tr_b16 v[194:195], v6 offset:38400
    v_mfma_f32_16x16x32_bf16 v[64:67], v[148:151], v[128:131], v[64:67]
    ds_read_b64_tr_b16 v[196:197], v7 offset:37888
    v_mfma_f32_16x16x32_bf16 v[112:115], v[148:151], v[136:139], v[112:115]
    ds_read_b64_tr_b16 v[198:199], v7 offset:38400
    v_mfma_f32_16x16x32_bf16 v[72:75], v[148:151], v[132:135], v[72:75]
    ds_read_b64_tr_b16 v[200:201], v6 offset:38912
    v_mfma_f32_16x16x32_bf16 v[76:79], v[152:155], v[132:135], v[76:79]
    ds_read_b64_tr_b16 v[202:203], v6 offset:39424
    v_mfma_f32_16x16x32_bf16 v[44:47], v[144:147], v[132:135], v[44:47]
    ds_read_b64_tr_b16 v[204:205], v7 offset:38912
    v_mfma_f32_16x16x32_bf16 v[40:43], v[140:143], v[132:135], v[40:43]
    ds_read_b64_tr_b16 v[206:207], v7 offset:39424
    v_mfma_f32_16x16x32_bf16 v[104:107], v[132:135], v[156:159], v[104:107]
    v_mfma_f32_16x16x32_bf16 v[108:111], v[132:135], v[160:163], v[108:111]
    v_mfma_f32_16x16x32_bf16 v[100:103], v[128:131], v[160:163], v[100:103]
    v_mfma_f32_16x16x32_bf16 v[96:99], v[128:131], v[156:159], v[96:99]
    v_mfma_f32_16x16x32_bf16 v[88:91], v[124:127], v[156:159], v[88:91]
    v_mfma_f32_16x16x32_bf16 v[92:95], v[124:127], v[160:163], v[92:95]
    v_mfma_f32_16x16x32_bf16 v[84:87], v[120:123], v[160:163], v[84:87]
    v_mfma_f32_16x16x32_bf16 v[80:83], v[120:123], v[156:159], v[80:83]
    v_mfma_f32_16x16x32_bf16 v[116:119], v[136:139], v[156:159], v[116:119]
    s_waitcnt lgkmcnt(0)
    s_barrier
    v_mfma_f32_16x16x32_bf16 v[16:19], v[184:187], v[164:167], v[16:19]
    ds_read_b128 v[120:123], v4 offset:36864
    v_mfma_f32_16x16x32_bf16 v[20:23], v[188:191], v[164:167], v[20:23]
    ds_read_b128 v[124:127], v4 offset:38912
    v_mfma_f32_16x16x32_bf16 v[52:55], v[196:199], v[164:167], v[52:55]
    ds_read_b128 v[128:131], v4 offset:40960
    v_mfma_f32_16x16x32_bf16 v[48:51], v[192:195], v[164:167], v[48:51]
    ds_read_b128 v[132:135], v4 offset:43008
    v_mfma_f32_16x16x32_bf16 v[56:59], v[192:195], v[168:171], v[56:59]
    ds_read_b128 v[136:139], v2 offset:36864
    v_mfma_f32_16x16x32_bf16 v[60:63], v[196:199], v[168:171], v[60:63]
    ds_read_b64_tr_b16 v[140:141], v6 offset:49152
    v_mfma_f32_16x16x32_bf16 v[28:31], v[188:191], v[168:171], v[28:31]
    ds_read_b64_tr_b16 v[142:143], v6 offset:49664
    v_mfma_f32_16x16x32_bf16 v[24:27], v[184:187], v[168:171], v[24:27]
    ds_read_b64_tr_b16 v[144:145], v7 offset:49152
    v_mfma_f32_16x16x32_bf16 v[32:35], v[184:187], v[172:175], v[32:35]
    ds_read_b64_tr_b16 v[146:147], v7 offset:49664
    v_mfma_f32_16x16x32_bf16 v[36:39], v[188:191], v[172:175], v[36:39]
    ds_read_b64_tr_b16 v[148:149], v6 offset:50176
    v_mfma_f32_16x16x32_bf16 v[68:71], v[196:199], v[172:175], v[68:71]
    ds_read_b64_tr_b16 v[150:151], v6 offset:50688
    v_mfma_f32_16x16x32_bf16 v[64:67], v[192:195], v[172:175], v[64:67]
    ds_read_b64_tr_b16 v[152:153], v7 offset:50176
    v_mfma_f32_16x16x32_bf16 v[112:115], v[192:195], v[180:183], v[112:115]
    ds_read_b64_tr_b16 v[154:155], v7 offset:50688
    v_mfma_f32_16x16x32_bf16 v[72:75], v[192:195], v[176:179], v[72:75]
    ds_read_b64_tr_b16 v[156:157], v6 offset:51200
    v_mfma_f32_16x16x32_bf16 v[76:79], v[196:199], v[176:179], v[76:79]
    ds_read_b64_tr_b16 v[158:159], v6 offset:51712
    v_mfma_f32_16x16x32_bf16 v[44:47], v[188:191], v[176:179], v[44:47]
    ds_read_b64_tr_b16 v[160:161], v7 offset:51200
    v_mfma_f32_16x16x32_bf16 v[40:43], v[184:187], v[176:179], v[40:43]
    ds_read_b64_tr_b16 v[162:163], v7 offset:51712
    v_mfma_f32_16x16x32_bf16 v[104:107], v[176:179], v[200:203], v[104:107]
    v_mfma_f32_16x16x32_bf16 v[108:111], v[176:179], v[204:207], v[108:111]
    v_mfma_f32_16x16x32_bf16 v[100:103], v[172:175], v[204:207], v[100:103]
    v_mfma_f32_16x16x32_bf16 v[96:99], v[172:175], v[200:203], v[96:99]
    v_mfma_f32_16x16x32_bf16 v[88:91], v[168:171], v[200:203], v[88:91]
    v_mfma_f32_16x16x32_bf16 v[92:95], v[168:171], v[204:207], v[92:95]
    v_mfma_f32_16x16x32_bf16 v[84:87], v[164:167], v[204:207], v[84:87]
    v_mfma_f32_16x16x32_bf16 v[80:83], v[164:167], v[200:203], v[80:83]
    v_mfma_f32_16x16x32_bf16 v[116:119], v[180:183], v[200:203], v[116:119]
    s_waitcnt lgkmcnt(0)
    v_mfma_f32_16x16x32_bf16 v[16:19], v[140:143], v[120:123], v[16:19]
    ds_read_b128 v[164:167], v5 offset:36864
    v_mfma_f32_16x16x32_bf16 v[20:23], v[144:147], v[120:123], v[20:23]
    ds_read_b128 v[168:171], v5 offset:38912
    v_mfma_f32_16x16x32_bf16 v[52:55], v[152:155], v[120:123], v[52:55]
    ds_read_b128 v[172:175], v5 offset:40960
    v_mfma_f32_16x16x32_bf16 v[48:51], v[148:151], v[120:123], v[48:51]
    ds_read_b128 v[176:179], v5 offset:43008
    v_mfma_f32_16x16x32_bf16 v[56:59], v[148:151], v[124:127], v[56:59]
    ds_read_b128 v[180:183], v3 offset:36864
    v_mfma_f32_16x16x32_bf16 v[60:63], v[152:155], v[124:127], v[60:63]
    ds_read_b64_tr_b16 v[184:185], v6 offset:61440
    v_mfma_f32_16x16x32_bf16 v[28:31], v[144:147], v[124:127], v[28:31]
    ds_read_b64_tr_b16 v[186:187], v6 offset:61952
    v_mfma_f32_16x16x32_bf16 v[24:27], v[140:143], v[124:127], v[24:27]
    ds_read_b64_tr_b16 v[188:189], v7 offset:61440
    v_mfma_f32_16x16x32_bf16 v[32:35], v[140:143], v[128:131], v[32:35]
    ds_read_b64_tr_b16 v[190:191], v7 offset:61952
    v_mfma_f32_16x16x32_bf16 v[36:39], v[144:147], v[128:131], v[36:39]
    ds_read_b64_tr_b16 v[192:193], v6 offset:62464
    v_mfma_f32_16x16x32_bf16 v[68:71], v[152:155], v[128:131], v[68:71]
    ds_read_b64_tr_b16 v[194:195], v6 offset:62976
    v_mfma_f32_16x16x32_bf16 v[64:67], v[148:151], v[128:131], v[64:67]
    ds_read_b64_tr_b16 v[196:197], v7 offset:62464
    v_mfma_f32_16x16x32_bf16 v[112:115], v[148:151], v[136:139], v[112:115]
    ds_read_b64_tr_b16 v[198:199], v7 offset:62976
    v_mfma_f32_16x16x32_bf16 v[72:75], v[148:151], v[132:135], v[72:75]
    ds_read_b64_tr_b16 v[200:201], v6 offset:63488
    v_mfma_f32_16x16x32_bf16 v[76:79], v[152:155], v[132:135], v[76:79]
    ds_read_b64_tr_b16 v[202:203], v6 offset:64000
    v_mfma_f32_16x16x32_bf16 v[44:47], v[144:147], v[132:135], v[44:47]
    ds_read_b64_tr_b16 v[204:205], v7 offset:63488
    v_mfma_f32_16x16x32_bf16 v[40:43], v[140:143], v[132:135], v[40:43]
    ds_read_b64_tr_b16 v[206:207], v7 offset:64000
    v_mfma_f32_16x16x32_bf16 v[104:107], v[132:135], v[156:159], v[104:107]
    v_mfma_f32_16x16x32_bf16 v[108:111], v[132:135], v[160:163], v[108:111]
    v_mfma_f32_16x16x32_bf16 v[100:103], v[128:131], v[160:163], v[100:103]
    v_mfma_f32_16x16x32_bf16 v[96:99], v[128:131], v[156:159], v[96:99]
    v_mfma_f32_16x16x32_bf16 v[88:91], v[124:127], v[156:159], v[88:91]
    v_mfma_f32_16x16x32_bf16 v[92:95], v[124:127], v[160:163], v[92:95]
    v_mfma_f32_16x16x32_bf16 v[84:87], v[120:123], v[160:163], v[84:87]
    v_mfma_f32_16x16x32_bf16 v[80:83], v[120:123], v[156:159], v[80:83]
    v_mfma_f32_16x16x32_bf16 v[116:119], v[136:139], v[156:159], v[116:119]
    s_waitcnt lgkmcnt(0)
    s_barrier
    v_mfma_f32_16x16x32_bf16 v[16:19], v[184:187], v[164:167], v[16:19]
    ds_read_b128 v[120:123], v4 offset:0
    v_mfma_f32_16x16x32_bf16 v[20:23], v[188:191], v[164:167], v[20:23]
    ds_read_b128 v[124:127], v4 offset:2048
    v_mfma_f32_16x16x32_bf16 v[52:55], v[196:199], v[164:167], v[52:55]
    ds_read_b128 v[128:131], v4 offset:4096
    v_mfma_f32_16x16x32_bf16 v[48:51], v[192:195], v[164:167], v[48:51]
    ds_read_b128 v[132:135], v4 offset:6144
    v_mfma_f32_16x16x32_bf16 v[56:59], v[192:195], v[168:171], v[56:59]
    ds_read_b128 v[136:139], v2 offset:0
    v_mfma_f32_16x16x32_bf16 v[60:63], v[196:199], v[168:171], v[60:63]
    ds_read_b64_tr_b16 v[140:141], v6 offset:0
    v_mfma_f32_16x16x32_bf16 v[28:31], v[188:191], v[168:171], v[28:31]
    ds_read_b64_tr_b16 v[142:143], v6 offset:512
    v_mfma_f32_16x16x32_bf16 v[24:27], v[184:187], v[168:171], v[24:27]
    ds_read_b64_tr_b16 v[144:145], v7 offset:0
    v_mfma_f32_16x16x32_bf16 v[32:35], v[184:187], v[172:175], v[32:35]
    ds_read_b64_tr_b16 v[146:147], v7 offset:512
    v_mfma_f32_16x16x32_bf16 v[36:39], v[188:191], v[172:175], v[36:39]
    ds_read_b64_tr_b16 v[148:149], v6 offset:1024
    v_mfma_f32_16x16x32_bf16 v[68:71], v[196:199], v[172:175], v[68:71]
    ds_read_b64_tr_b16 v[150:151], v6 offset:1536
    v_mfma_f32_16x16x32_bf16 v[64:67], v[192:195], v[172:175], v[64:67]
    ds_read_b64_tr_b16 v[152:153], v7 offset:1024
    v_mfma_f32_16x16x32_bf16 v[112:115], v[192:195], v[180:183], v[112:115]
    ds_read_b64_tr_b16 v[154:155], v7 offset:1536
    v_mfma_f32_16x16x32_bf16 v[72:75], v[192:195], v[176:179], v[72:75]
    ds_read_b64_tr_b16 v[156:157], v6 offset:2048
    v_mfma_f32_16x16x32_bf16 v[76:79], v[196:199], v[176:179], v[76:79]
    ds_read_b64_tr_b16 v[158:159], v6 offset:2560
    v_mfma_f32_16x16x32_bf16 v[44:47], v[188:191], v[176:179], v[44:47]
    ds_read_b64_tr_b16 v[160:161], v7 offset:2048
    v_mfma_f32_16x16x32_bf16 v[40:43], v[184:187], v[176:179], v[40:43]
    ds_read_b64_tr_b16 v[162:163], v7 offset:2560
    v_mfma_f32_16x16x32_bf16 v[104:107], v[176:179], v[200:203], v[104:107]
    v_mfma_f32_16x16x32_bf16 v[108:111], v[176:179], v[204:207], v[108:111]
    v_mfma_f32_16x16x32_bf16 v[100:103], v[172:175], v[204:207], v[100:103]
    v_mfma_f32_16x16x32_bf16 v[96:99], v[172:175], v[200:203], v[96:99]
    v_mfma_f32_16x16x32_bf16 v[88:91], v[168:171], v[200:203], v[88:91]
    v_mfma_f32_16x16x32_bf16 v[92:95], v[168:171], v[204:207], v[92:95]
    v_mfma_f32_16x16x32_bf16 v[84:87], v[164:167], v[204:207], v[84:87]
    v_mfma_f32_16x16x32_bf16 v[80:83], v[164:167], v[200:203], v[80:83]
    v_mfma_f32_16x16x32_bf16 v[116:119], v[180:183], v[200:203], v[116:119]
    s_waitcnt lgkmcnt(0)
    v_mfma_f32_16x16x32_bf16 v[16:19], v[140:143], v[120:123], v[16:19]
    ds_read_b128 v[164:167], v5 offset:0
    v_mfma_f32_16x16x32_bf16 v[20:23], v[144:147], v[120:123], v[20:23]
    ds_read_b128 v[168:171], v5 offset:2048
    v_mfma_f32_16x16x32_bf16 v[52:55], v[152:155], v[120:123], v[52:55]
    ds_read_b128 v[172:175], v5 offset:4096
    v_mfma_f32_16x16x32_bf16 v[48:51], v[148:151], v[120:123], v[48:51]
    ds_read_b128 v[176:179], v5 offset:6144
    v_mfma_f32_16x16x32_bf16 v[56:59], v[148:151], v[124:127], v[56:59]
    ds_read_b128 v[180:183], v3 offset:0
    v_mfma_f32_16x16x32_bf16 v[60:63], v[152:155], v[124:127], v[60:63]
    ds_read_b64_tr_b16 v[184:185], v6 offset:12288
    v_mfma_f32_16x16x32_bf16 v[28:31], v[144:147], v[124:127], v[28:31]
    ds_read_b64_tr_b16 v[186:187], v6 offset:12800
    v_mfma_f32_16x16x32_bf16 v[24:27], v[140:143], v[124:127], v[24:27]
    ds_read_b64_tr_b16 v[188:189], v7 offset:12288
    v_mfma_f32_16x16x32_bf16 v[32:35], v[140:143], v[128:131], v[32:35]
    ds_read_b64_tr_b16 v[190:191], v7 offset:12800
    v_mfma_f32_16x16x32_bf16 v[36:39], v[144:147], v[128:131], v[36:39]
    ds_read_b64_tr_b16 v[192:193], v6 offset:13312
    v_mfma_f32_16x16x32_bf16 v[68:71], v[152:155], v[128:131], v[68:71]
    ds_read_b64_tr_b16 v[194:195], v6 offset:13824
    v_mfma_f32_16x16x32_bf16 v[64:67], v[148:151], v[128:131], v[64:67]
    ds_read_b64_tr_b16 v[196:197], v7 offset:13312
    v_mfma_f32_16x16x32_bf16 v[112:115], v[148:151], v[136:139], v[112:115]
    ds_read_b64_tr_b16 v[198:199], v7 offset:13824
    v_mfma_f32_16x16x32_bf16 v[72:75], v[148:151], v[132:135], v[72:75]
    ds_read_b64_tr_b16 v[200:201], v6 offset:14336
    v_mfma_f32_16x16x32_bf16 v[76:79], v[152:155], v[132:135], v[76:79]
    ds_read_b64_tr_b16 v[202:203], v6 offset:14848
    v_mfma_f32_16x16x32_bf16 v[44:47], v[144:147], v[132:135], v[44:47]
    ds_read_b64_tr_b16 v[204:205], v7 offset:14336
    v_mfma_f32_16x16x32_bf16 v[40:43], v[140:143], v[132:135], v[40:43]
    ds_read_b64_tr_b16 v[206:207], v7 offset:14848
    v_mfma_f32_16x16x32_bf16 v[104:107], v[132:135], v[156:159], v[104:107]
    buffer_load_dword v222, v220, s[68:71], s98 offen sc1
    v_mfma_f32_16x16x32_bf16 v[108:111], v[132:135], v[160:163], v[108:111]
    v_mfma_f32_16x16x32_bf16 v[100:103], v[128:131], v[160:163], v[100:103]
    v_mfma_f32_16x16x32_bf16 v[96:99], v[128:131], v[156:159], v[96:99]
    v_mfma_f32_16x16x32_bf16 v[88:91], v[124:127], v[156:159], v[88:91]
    v_mfma_f32_16x16x32_bf16 v[92:95], v[124:127], v[160:163], v[92:95]
    v_mfma_f32_16x16x32_bf16 v[84:87], v[120:123], v[160:163], v[84:87]
    v_mfma_f32_16x16x32_bf16 v[80:83], v[120:123], v[156:159], v[80:83]
    v_mfma_f32_16x16x32_bf16 v[116:119], v[136:139], v[156:159], v[116:119]
    s_waitcnt lgkmcnt(0)
    s_barrier
    v_mfma_f32_16x16x32_bf16 v[16:19], v[184:187], v[164:167], v[16:19]
    ds_read_b128 v[120:123], v4 offset:18432
    v_mfma_f32_16x16x32_bf16 v[20:23], v[188:191], v[164:167], v[20:23]
    ds_read_b128 v[124:127], v4 offset:20480
    v_mfma_f32_16x16x32_bf16 v[52:55], v[196:199], v[164:167], v[52:55]
    ds_read_b128 v[128:131], v4 offset:22528
    v_mfma_f32_16x16x32_bf16 v[48:51], v[192:195], v[164:167], v[48:51]
    ds_read_b128 v[132:135], v4 offset:24576
    v_mfma_f32_16x16x32_bf16 v[56:59], v[192:195], v[168:171], v[56:59]
    ds_read_b128 v[136:139], v2 offset:18432
    v_mfma_f32_16x16x32_bf16 v[60:63], v[196:199], v[168:171], v[60:63]
    ds_read_b64_tr_b16 v[140:141], v6 offset:24576
    v_mfma_f32_16x16x32_bf16 v[28:31], v[188:191], v[168:171], v[28:31]
    ds_read_b64_tr_b16 v[142:143], v6 offset:25088
    v_mfma_f32_16x16x32_bf16 v[24:27], v[184:187], v[168:171], v[24:27]
    ds_read_b64_tr_b16 v[144:145], v7 offset:24576
    v_mfma_f32_16x16x32_bf16 v[32:35], v[184:187], v[172:175], v[32:35]
    ds_read_b64_tr_b16 v[146:147], v7 offset:25088
    v_mfma_f32_16x16x32_bf16 v[36:39], v[188:191], v[172:175], v[36:39]
    ds_read_b64_tr_b16 v[148:149], v6 offset:25600
    v_mfma_f32_16x16x32_bf16 v[68:71], v[196:199], v[172:175], v[68:71]
    ds_read_b64_tr_b16 v[150:151], v6 offset:26112
    v_mfma_f32_16x16x32_bf16 v[64:67], v[192:195], v[172:175], v[64:67]
    ds_read_b64_tr_b16 v[152:153], v7 offset:25600
    v_mfma_f32_16x16x32_bf16 v[112:115], v[192:195], v[180:183], v[112:115]
    ds_read_b64_tr_b16 v[154:155], v7 offset:26112
    v_mfma_f32_16x16x32_bf16 v[72:75], v[192:195], v[176:179], v[72:75]
    ds_read_b64_tr_b16 v[156:157], v6 offset:26624
    v_mfma_f32_16x16x32_bf16 v[76:79], v[196:199], v[176:179], v[76:79]
    ds_read_b64_tr_b16 v[158:159], v6 offset:27136
    v_mfma_f32_16x16x32_bf16 v[44:47], v[188:191], v[176:179], v[44:47]
    ds_read_b64_tr_b16 v[160:161], v7 offset:26624
    v_mfma_f32_16x16x32_bf16 v[40:43], v[184:187], v[176:179], v[40:43]
    ds_read_b64_tr_b16 v[162:163], v7 offset:27136
    v_mfma_f32_16x16x32_bf16 v[104:107], v[176:179], v[200:203], v[104:107]
    v_mfma_f32_16x16x32_bf16 v[108:111], v[176:179], v[204:207], v[108:111]
    v_mfma_f32_16x16x32_bf16 v[100:103], v[172:175], v[204:207], v[100:103]
    v_mfma_f32_16x16x32_bf16 v[96:99], v[172:175], v[200:203], v[96:99]
    v_mfma_f32_16x16x32_bf16 v[88:91], v[168:171], v[200:203], v[88:91]
    v_mfma_f32_16x16x32_bf16 v[92:95], v[168:171], v[204:207], v[92:95]
    v_mfma_f32_16x16x32_bf16 v[84:87], v[164:167], v[204:207], v[84:87]
    v_mfma_f32_16x16x32_bf16 v[80:83], v[164:167], v[200:203], v[80:83]
    v_mfma_f32_16x16x32_bf16 v[116:119], v[180:183], v[200:203], v[116:119]
    s_waitcnt lgkmcnt(0)
    v_mfma_f32_16x16x32_bf16 v[16:19], v[140:143], v[120:123], v[16:19]
    ds_read_b128 v[164:167], v5 offset:18432
    v_mfma_f32_16x16x32_bf16 v[20:23], v[144:147], v[120:123], v[20:23]
    ds_read_b128 v[168:171], v5 offset:20480
    v_mfma_f32_16x16x32_bf16 v[52:55], v[152:155], v[120:123], v[52:55]
    ds_read_b128 v[172:175], v5 offset:22528
    v_mfma_f32_16x16x32_bf16 v[48:51], v[148:151], v[120:123], v[48:51]
    ds_read_b128 v[176:179], v5 offset:24576
    v_mfma_f32_16x16x32_bf16 v[56:59], v[148:151], v[124:127], v[56:59]
    ds_read_b128 v[180:183], v3 offset:18432
    v_mfma_f32_16x16x32_bf16 v[60:63], v[152:155], v[124:127], v[60:63]
    ds_read_b64_tr_b16 v[184:185], v6 offset:36864
    v_mfma_f32_16x16x32_bf16 v[28:31], v[144:147], v[124:127], v[28:31]
    ds_read_b64_tr_b16 v[186:187], v6 offset:37376
    v_mfma_f32_16x16x32_bf16 v[24:27], v[140:143], v[124:127], v[24:27]
    ds_read_b64_tr_b16 v[188:189], v7 offset:36864
    v_mfma_f32_16x16x32_bf16 v[32:35], v[140:143], v[128:131], v[32:35]
    ds_read_b64_tr_b16 v[190:191], v7 offset:37376
    v_mfma_f32_16x16x32_bf16 v[36:39], v[144:147], v[128:131], v[36:39]
    ds_read_b64_tr_b16 v[192:193], v6 offset:37888
    v_mfma_f32_16x16x32_bf16 v[68:71], v[152:155], v[128:131], v[68:71]
    ds_read_b64_tr_b16 v[194:195], v6 offset:38400
    v_mfma_f32_16x16x32_bf16 v[64:67], v[148:151], v[128:131], v[64:67]
    ds_read_b64_tr_b16 v[196:197], v7 offset:37888
    v_mfma_f32_16x16x32_bf16 v[112:115], v[148:151], v[136:139], v[112:115]
    ds_read_b64_tr_b16 v[198:199], v7 offset:38400
    v_mfma_f32_16x16x32_bf16 v[72:75], v[148:151], v[132:135], v[72:75]
    ds_read_b64_tr_b16 v[200:201], v6 offset:38912
    v_mfma_f32_16x16x32_bf16 v[76:79], v[152:155], v[132:135], v[76:79]
    ds_read_b64_tr_b16 v[202:203], v6 offset:39424
    v_mfma_f32_16x16x32_bf16 v[44:47], v[144:147], v[132:135], v[44:47]
    ds_read_b64_tr_b16 v[204:205], v7 offset:38912
    v_mfma_f32_16x16x32_bf16 v[40:43], v[140:143], v[132:135], v[40:43]
    ds_read_b64_tr_b16 v[206:207], v7 offset:39424
    v_mfma_f32_16x16x32_bf16 v[104:107], v[132:135], v[156:159], v[104:107]
    v_mfma_f32_16x16x32_bf16 v[108:111], v[132:135], v[160:163], v[108:111]
    v_mfma_f32_16x16x32_bf16 v[100:103], v[128:131], v[160:163], v[100:103]
    v_mfma_f32_16x16x32_bf16 v[96:99], v[128:131], v[156:159], v[96:99]
    v_mfma_f32_16x16x32_bf16 v[88:91], v[124:127], v[156:159], v[88:91]
    v_mfma_f32_16x16x32_bf16 v[92:95], v[124:127], v[160:163], v[92:95]
    v_mfma_f32_16x16x32_bf16 v[84:87], v[120:123], v[160:163], v[84:87]
    v_mfma_f32_16x16x32_bf16 v[80:83], v[120:123], v[156:159], v[80:83]
    v_mfma_f32_16x16x32_bf16 v[116:119], v[136:139], v[156:159], v[116:119]
    s_waitcnt lgkmcnt(0)
    s_barrier
    v_mfma_f32_16x16x32_bf16 v[16:19], v[184:187], v[164:167], v[16:19]
    ds_read_b128 v[120:123], v4 offset:36864
    v_mfma_f32_16x16x32_bf16 v[20:23], v[188:191], v[164:167], v[20:23]
    ds_read_b128 v[124:127], v4 offset:38912
    v_mfma_f32_16x16x32_bf16 v[52:55], v[196:199], v[164:167], v[52:55]
    ds_read_b128 v[128:131], v4 offset:40960
    v_mfma_f32_16x16x32_bf16 v[48:51], v[192:195], v[164:167], v[48:51]
    ds_read_b128 v[132:135], v4 offset:43008
    v_mfma_f32_16x16x32_bf16 v[56:59], v[192:195], v[168:171], v[56:59]
    ds_read_b128 v[136:139], v2 offset:36864
    v_mfma_f32_16x16x32_bf16 v[60:63], v[196:199], v[168:171], v[60:63]
    ds_read_b64_tr_b16 v[140:141], v6 offset:49152
    v_mfma_f32_16x16x32_bf16 v[28:31], v[188:191], v[168:171], v[28:31]
    ds_read_b64_tr_b16 v[142:143], v6 offset:49664
    v_mfma_f32_16x16x32_bf16 v[24:27], v[184:187], v[168:171], v[24:27]
    ds_read_b64_tr_b16 v[144:145], v7 offset:49152
    v_mfma_f32_16x16x32_bf16 v[32:35], v[184:187], v[172:175], v[32:35]
    ds_read_b64_tr_b16 v[146:147], v7 offset:49664
    v_mfma_f32_16x16x32_bf16 v[36:39], v[188:191], v[172:175], v[36:39]
    ds_read_b64_tr_b16 v[148:149], v6 offset:50176
    v_mfma_f32_16x16x32_bf16 v[68:71], v[196:199], v[172:175], v[68:71]
    ds_read_b64_tr_b16 v[150:151], v6 offset:50688
    v_mfma_f32_16x16x32_bf16 v[64:67], v[192:195], v[172:175], v[64:67]
    ds_read_b64_tr_b16 v[152:153], v7 offset:50176
    v_mfma_f32_16x16x32_bf16 v[112:115], v[192:195], v[180:183], v[112:115]
    ds_read_b64_tr_b16 v[154:155], v7 offset:50688
    v_mfma_f32_16x16x32_bf16 v[72:75], v[192:195], v[176:179], v[72:75]
    ds_read_b64_tr_b16 v[156:157], v6 offset:51200
    v_mfma_f32_16x16x32_bf16 v[76:79], v[196:199], v[176:179], v[76:79]
    ds_read_b64_tr_b16 v[158:159], v6 offset:51712
    v_mfma_f32_16x16x32_bf16 v[44:47], v[188:191], v[176:179], v[44:47]
    ds_read_b64_tr_b16 v[160:161], v7 offset:51200
    v_mfma_f32_16x16x32_bf16 v[40:43], v[184:187], v[176:179], v[40:43]
    ds_read_b64_tr_b16 v[162:163], v7 offset:51712
    v_mfma_f32_16x16x32_bf16 v[104:107], v[176:179], v[200:203], v[104:107]
    v_mfma_f32_16x16x32_bf16 v[108:111], v[176:179], v[204:207], v[108:111]
    v_mfma_f32_16x16x32_bf16 v[100:103], v[172:175], v[204:207], v[100:103]
    v_mfma_f32_16x16x32_bf16 v[96:99], v[172:175], v[200:203], v[96:99]
    v_mfma_f32_16x16x32_bf16 v[88:91], v[168:171], v[200:203], v[88:91]
    v_mfma_f32_16x16x32_bf16 v[92:95], v[168:171], v[204:207], v[92:95]
    v_mfma_f32_16x16x32_bf16 v[84:87], v[164:167], v[204:207], v[84:87]
    v_mfma_f32_16x16x32_bf16 v[80:83], v[164:167], v[200:203], v[80:83]
    v_mfma_f32_16x16x32_bf16 v[116:119], v[180:183], v[200:203], v[116:119]
    s_waitcnt lgkmcnt(0)
    v_mfma_f32_16x16x32_bf16 v[16:19], v[140:143], v[120:123], v[16:19]
    ds_read_b128 v[164:167], v5 offset:36864
    v_mfma_f32_16x16x32_bf16 v[20:23], v[144:147], v[120:123], v[20:23]
    ds_read_b128 v[168:171], v5 offset:38912
    v_mfma_f32_16x16x32_bf16 v[52:55], v[152:155], v[120:123], v[52:55]
    ds_read_b128 v[172:175], v5 offset:40960
    v_mfma_f32_16x16x32_bf16 v[48:51], v[148:151], v[120:123], v[48:51]
    ds_read_b128 v[176:179], v5 offset:43008
    v_mfma_f32_16x16x32_bf16 v[56:59], v[148:151], v[124:127], v[56:59]
    ds_read_b128 v[180:183], v3 offset:36864
    v_mfma_f32_16x16x32_bf16 v[60:63], v[152:155], v[124:127], v[60:63]
    ds_read_b64_tr_b16 v[184:185], v6 offset:61440
    v_mfma_f32_16x16x32_bf16 v[28:31], v[144:147], v[124:127], v[28:31]
    ds_read_b64_tr_b16 v[186:187], v6 offset:61952
    v_mfma_f32_16x16x32_bf16 v[24:27], v[140:143], v[124:127], v[24:27]
    ds_read_b64_tr_b16 v[188:189], v7 offset:61440
    v_mfma_f32_16x16x32_bf16 v[32:35], v[140:143], v[128:131], v[32:35]
    ds_read_b64_tr_b16 v[190:191], v7 offset:61952
    v_mfma_f32_16x16x32_bf16 v[36:39], v[144:147], v[128:131], v[36:39]
    ds_read_b64_tr_b16 v[192:193], v6 offset:62464
    v_mfma_f32_16x16x32_bf16 v[68:71], v[152:155], v[128:131], v[68:71]
    ds_read_b64_tr_b16 v[194:195], v6 offset:62976
    v_mfma_f32_16x16x32_bf16 v[64:67], v[148:151], v[128:131], v[64:67]
    ds_read_b64_tr_b16 v[196:197], v7 offset:62464
    v_mfma_f32_16x16x32_bf16 v[112:115], v[148:151], v[136:139], v[112:115]
    ds_read_b64_tr_b16 v[198:199], v7 offset:62976
    v_mfma_f32_16x16x32_bf16 v[72:75], v[148:151], v[132:135], v[72:75]
    ds_read_b64_tr_b16 v[200:201], v6 offset:63488
    v_mfma_f32_16x16x32_bf16 v[76:79], v[152:155], v[132:135], v[76:79]
    ds_read_b64_tr_b16 v[202:203], v6 offset:64000
    v_mfma_f32_16x16x32_bf16 v[44:47], v[144:147], v[132:135], v[44:47]
    ds_read_b64_tr_b16 v[204:205], v7 offset:63488
    v_mfma_f32_16x16x32_bf16 v[40:43], v[140:143], v[132:135], v[40:43]
    ds_read_b64_tr_b16 v[206:207], v7 offset:64000
    v_mfma_f32_16x16x32_bf16 v[104:107], v[132:135], v[156:159], v[104:107]
    v_mfma_f32_16x16x32_bf16 v[108:111], v[132:135], v[160:163], v[108:111]
    v_mfma_f32_16x16x32_bf16 v[100:103], v[128:131], v[160:163], v[100:103]
    v_mfma_f32_16x16x32_bf16 v[96:99], v[128:131], v[156:159], v[96:99]
    v_mfma_f32_16x16x32_bf16 v[88:91], v[124:127], v[156:159], v[88:91]
    v_mfma_f32_16x16x32_bf16 v[92:95], v[124:127], v[160:163], v[92:95]
    v_mfma_f32_16x16x32_bf16 v[84:87], v[120:123], v[160:163], v[84:87]
    v_mfma_f32_16x16x32_bf16 v[80:83], v[120:123], v[156:159], v[80:83]
    v_mfma_f32_16x16x32_bf16 v[116:119], v[136:139], v[156:159], v[116:119]
    s_waitcnt lgkmcnt(0)
    s_barrier
    s_cmp_lg_u32 s3, 0
    s_cbranch_scc1 LB_sk
    s_waitcnt vmcnt(0)
    v_cmp_eq_u32 vcc, 0, v222
    s_cbranch_vccnz LB_slow
LB_back:
    s_mov_b64 exec, 1
    buffer_store_dword v222, v220, s[52:55], s96 offen sc1
    s_mov_b64 exec, -1
LB_sk:
    v_mfma_f32_16x16x32_bf16 v[16:19], v[184:187], v[164:167], v[16:19]
    ds_read_b128 v[120:123], v4 offset:0
    v_mfma_f32_16x16x32_bf16 v[20:23], v[188:191], v[164:167], v[20:23]
    ds_read_b128 v[124:127], v4 offset:2048
    v_mfma_f32_16x16x32_bf16 v[52:55], v[196:199], v[164:167], v[52:55]
    ds_read_b128 v[128:131], v4 offset:4096
    v_mfma_f32_16x16x32_bf16 v[48:51], v[192:195], v[164:167], v[48:51]
    ds_read_b128 v[132:135], v4 offset:6144
    v_mfma_f32_16x16x32_bf16 v[56:59], v[192:195], v[168:171], v[56:59]
    ds_read_b128 v[136:139], v2 offset:0
    v_mfma_f32_16x16x32_bf16 v[60:63], v[196:199], v[168:171], v[60:63]
    ds_read_b64_tr_b16 v[140:141], v6 offset:0
    v_mfma_f32_16x16x32_bf16 v[28:31], v[188:191], v[168:171], v[28:31]
    ds_read_b64_tr_b16 v[142:143], v6 offset:512
    v_mfma_f32_16x16x32_bf16 v[24:27], v[184:187], v[168:171], v[24:27]
    ds_read_b64_tr_b16 v[144:145], v7 offset:0
    v_mfma_f32_16x16x32_bf16 v[32:35], v[184:187], v[172:175], v[32:35]
    ds_read_b64_tr_b16 v[146:147], v7 offset:512
    v_mfma_f32_16x16x32_bf16 v[36:39], v[188:191], v[172:175], v[36:39]
    ds_read_b64_tr_b16 v[148:149], v6 offset:1024
    v_mfma_f32_16x16x32_bf16 v[68:71], v[196:199], v[172:175], v[68:71]
    ds_read_b64_tr_b16 v[150:151], v6 offset:1536
    v_mfma_f32_16x16x32_bf16 v[64:67], v[192:195], v[172:175], v[64:67]
    ds_read_b64_tr_b16 v[152:153], v7 offset:1024
    v_mfma_f32_16x16x32_bf16 v[112:115], v[192:195], v[180:183], v[112:115]
    ds_read_b64_tr_b16 v[154:155], v7 offset:1536
    v_mfma_f32_16x16x32_bf16 v[72:75], v[192:195], v[176:179], v[72:75]
    ds_read_b64_tr_b16 v[156:157], v6 offset:2048
    v_mfma_f32_16x16x32_bf16 v[76:79], v[196:199], v[176:179], v[76:79]
    ds_read_b64_tr_b16 v[158:159], v6 offset:2560
    v_mfma_f32_16x16x32_bf16 v[44:47], v[188:191], v[176:179], v[44:47]
    ds_read_b64_tr_b16 v[160:161], v7 offset:2048
    v_mfma_f32_16x16x32_bf16 v[40:43], v[184:187], v[176:179], v[40:43]
    ds_read_b64_tr_b16 v[162:163], v7 offset:2560
    v_mfma_f32_16x16x32_bf16 v[104:107], v[176:179], v[200:203], v[104:107]
    v_mfma_f32_16x16x32_bf16 v[108:111], v[176:179], v[204:207], v[108:111]
    v_mfma_f32_16x16x32_bf16 v[100:103], v[172:175], v[204:207], v[100:103]
    v_mfma_f32_16x16x32_bf16 v[96:99], v[172:175], v[200:203], v[96:99]
    v_mfma_f32_16x16x32_bf16 v[88:91], v[168:171], v[200:203], v[88:91]
    v_mfma_f32_16x16x32_bf16 v[92:95], v[168:171], v[204:207], v[92:95]
    v_mfma_f32_16x16x32_bf16 v[84:87], v[164:167], v[204:207], v[84:87]
    v_mfma_f32_16x16x32_bf16 v[80:83], v[164:167], v[200:203], v[80:83]
    v_mfma_f32_16x16x32_bf16 v[116:119], v[180:183], v[200:203], v[116:119]
    s_waitcnt lgkmcnt(0)
    v_mfma_f32_16x16x32_bf16 v[16:19], v[140:143], v[120:123], v[16:19]
    ds_read_b128 v[164:167], v5 offset:0
    v_mfma_f32_16x16x32_bf16 v[20:23], v[144:147], v[120:123], v[20:23]
    ds_read_b128 v[168:171], v5 offset:2048
    v_mfma_f32_16x16x32_bf16 v[52:55], v[152:155], v[120:123], v[52:55]
    ds_read_b128 v[172:175], v5 offset:4096
    v_mfma_f32_16x16x32_bf16 v[48:51], v[148:151], v[120:123], v[48:51]
    ds_read_b128 v[176:179], v5 offset:6144
    v_mfma_f32_16x16x32_bf16 v[56:59], v[148:151], v[124:127], v[56:59]
    ds_read_b128 v[180:183], v3 offset:0
    v_mfma_f32_16x16x32_bf16 v[60:63], v[152:155], v[124:127], v[60:63]
    ds_read_b64_tr_b16 v[184:185], v6 offset:12288
    v_mfma_f32_16x16x32_bf16 v[28:31], v[144:147], v[124:127], v[28:31]
    ds_read_b64_tr_b16 v[186:187], v6 offset:12800
    v_mfma_f32_16x16x32_bf16 v[24:27], v[140:143], v[124:127], v[24:27]
    ds_read_b64_tr_b16 v[188:189], v7 offset:12288
    v_mfma_f32_16x16x32_bf16 v[32:35], v[140:143], v[128:131], v[32:35]
    ds_read_b64_tr_b16 v[190:191], v7 offset:12800
    v_mfma_f32_16x16x32_bf16 v[36:39], v[144:147], v[128:131], v[36:39]
    ds_read_b64_tr_b16 v[192:193], v6 offset:13312
    v_mfma_f32_16x16x32_bf16 v[68:71], v[152:155], v[128:131], v[68:71]
    ds_read_b64_tr_b16 v[194:195], v6 offset:13824
    v_mfma_f32_16x16x32_bf16 v[64:67], v[148:151], v[128:131], v[64:67]
    ds_read_b64_tr_b16 v[196:197], v7 offset:13312
    v_mfma_f32_16x16x32_bf16 v[112:115], v[148:151], v[136:139], v[112:115]
    ds_read_b64_tr_b16 v[198:199], v7 offset:13824
    v_mfma_f32_16x16x32_bf16 v[72:75], v[148:151], v[132:135], v[72:75]
    ds_read_b64_tr_b16 v[200:201], v6 offset:14336
    v_mfma_f32_16x16x32_bf16 v[76:79], v[152:155], v[132:135], v[76:79]
    ds_read_b64_tr_b16 v[202:203], v6 offset:14848
    v_mfma_f32_16x16x32_bf16 v[44:47], v[144:147], v[132:135], v[44:47]
    ds_read_b64_tr_b16 v[204:205], v7 offset:14336
    v_mfma_f32_16x16x32_bf16 v[40:43], v[140:143], v[132:135], v[40:43]
    ds_read_b64_tr_b16 v[206:207], v7 offset:14848
    v_mfma_f32_16x16x32_bf16 v[104:107], v[132:135], v[156:159], v[104:107]
    v_mfma_f32_16x16x32_bf16 v[108:111], v[132:135], v[160:163], v[108:111]
    v_mfma_f32_16x16x32_bf16 v[100:103], v[128:131], v[160:163], v[100:103]
    v_mfma_f32_16x16x32_bf16 v[96:99], v[128:131], v[156:159], v[96:99]
    v_mfma_f32_16x16x32_bf16 v[88:91], v[124:127], v[156:159], v[88:91]
    v_mfma_f32_16x16x32_bf16 v[92:95], v[124:127], v[160:163], v[92:95]
    v_mfma_f32_16x16x32_bf16 v[84:87], v[120:123], v[160:163], v[84:87]
    v_mfma_f32_16x16x32_bf16 v[80:83], v[120:123], v[156:159], v[80:83]
    v_mfma_f32_16x16x32_bf16 v[116:119], v[136:139], v[156:159], v[116:119]
    s_waitcnt lgkmcnt(0)
    s_barrier
    v_mfma_f32_16x16x32_bf16 v[16:19], v[184:187], v[164:167], v[16:19]
    ds_read_b128 v[120:123], v4 offset:18432
    v_mfma_f32_16x16x32_bf16 v[20:23], v[188:191], v[164:167], v[20:23]
    ds_read_b128 v[124:127], v4 offset:20480
    v_mfma_f32_16x16x32_bf16 v[52:55], v[196:199], v[164:167], v[52:55]
    ds_read_b128 v[128:131], v4 offset:22528
    v_mfma_f32_16x16x32_bf16 v[48:51], v[192:195], v[164:167], v[48:51]
    ds_read_b128 v[132:135], v4 offset:24576
    v_mfma_f32_16x16x32_bf16 v[56:59], v[192:195], v[168:171], v[56:59]
    ds_read_b128 v[136:139], v2 offset:18432
    v_mfma_f32_16x16x32_bf16 v[60:63], v[196:199], v[168:171], v[60:63]
    ds_read_b64_tr_b16 v[140:141], v6 offset:24576
    v_mfma_f32_16x16x32_bf16 v[28:31], v[188:191], v[168:171], v[28:31]
    ds_read_b64_tr_b16 v[142:143], v6 offset:25088
    v_mfma_f32_16x16x32_bf16 v[24:27], v[184:187], v[168:171], v[24:27]
    ds_read_b64_tr_b16 v[144:145], v7 offset:24576
    v_mfma_f32_16x16x32_bf16 v[32:35], v[184:187], v[172:175], v[32:35]
    ds_read_b64_tr_b16 v[146:147], v7 offset:25088
    v_mfma_f32_16x16x32_bf16 v[36:39], v[188:191], v[172:175], v[36:39]
    ds_read_b64_tr_b16 v[148:149], v6 offset:25600
    v_mfma_f32_16x16x32_bf16 v[68:71], v[196:199], v[172:175], v[68:71]
    ds_read_b64_tr_b16 v[150:151], v6 offset:26112
    v_mfma_f32_16x16x32_bf16 v[64:67], v[192:195], v[172:175], v[64:67]
    ds_read_b64_tr_b16 v[152:153], v7 offset:25600
    v_mfma_f32_16x16x32_bf16 v[112:115], v[192:195], v[180:183], v[112:115]
    ds_read_b64_tr_b16 v[154:155], v7 offset:26112
    v_mfma_f32_16x16x32_bf16 v[72:75], v[192:195], v[176:179], v[72:75]
    ds_read_b64_tr_b16 v[156:157], v6 offset:26624
    v_mfma_f32_16x16x32_bf16 v[76:79], v[196:199], v[176:179], v[76:79]
    ds_read_b64_tr_b16 v[158:159], v6 offset:27136
    v_mfma_f32_16x16x32_bf16 v[44:47], v[188:191], v[176:179], v[44:47]
    ds_read_b64_tr_b16 v[160:161], v7 offset:26624
    v_mfma_f32_16x16x32_bf16 v[40:43], v[184:187], v[176:179], v[40:43]
    ds_read_b64_tr_b16 v[162:163], v7 offset:27136
    v_mfma_f32_16x16x32_bf16 v[104:107], v[176:179], v[200:203], v[104:107]
    v_mfma_f32_16x16x32_bf16 v[108:111], v[176:179], v[204:207], v[108:111]
    v_mfma_f32_16x16x32_bf16 v[100:103], v[172:175], v[204:207], v[100:103]
    v_mfma_f32_16x16x32_bf16 v[96:99], v[172:175], v[200:203], v[96:99]
    v_mfma_f32_16x16x32_bf16 v[88:91], v[168:171], v[200:203], v[88:91]
    v_mfma_f32_16x16x32_bf16 v[92:95], v[168:171], v[204:207], v[92:95]
    v_mfma_f32_16x16x32_bf16 v[84:87], v[164:167], v[204:207], v[84:87]
    v_mfma_f32_16x16x32_bf16 v[80:83], v[164:167], v[200:203], v[80:83]
    v_mfma_f32_16x16x32_bf16 v[116:119], v[180:183], v[200:203], v[116:119]
    s_waitcnt lgkmcnt(0)
    v_mfma_f32_16x16x32_bf16 v[16:19], v[140:143], v[120:123], v[16:19]
    ds_read_b128 v[164:167], v5 offset:18432
    v_mfma_f32_16x16x32_bf16 v[20:23], v[144:147], v[120:123], v[20:23]
    ds_read_b128 v[168:171], v5 offset:20480
    v_mfma_f32_16x16x32_bf16 v[52:55], v[152:155], v[120:123], v[52:55]
    ds_read_b128 v[172:175], v5 offset:22528
    v_mfma_f32_16x16x32_bf16 v[48:51], v[148:151], v[120:123], v[48:51]
    ds_read_b128 v[176:179], v5 offset:24576
    v_mfma_f32_16x16x32_bf16 v[56:59], v[148:151], v[124:127], v[56:59]
    ds_read_b128 v[180:183], v3 offset:18432
    v_mfma_f32_16x16x32_bf16 v[60:63], v[152:155], v[124:127], v[60:63]
    ds_read_b64_tr_b16 v[184:185], v6 offset:36864
    v_mfma_f32_16x16x32_bf16 v[28:31], v[144:147], v[124:127], v[28:31]
    ds_read_b64_tr_b16 v[186:187], v6 offset:37376
    v_mfma_f32_16x16x32_bf16 v[24:27], v[140:143], v[124:127], v[24:27]
    ds_read_b64_tr_b16 v[188:189], v7 offset:36864
    v_mfma_f32_16x16x32_bf16 v[32:35], v[140:143], v[128:131], v[32:35]
    ds_read_b64_tr_b16 v[190:191], v7 offset:37376
    v_mfma_f32_16x16x32_bf16 v[36:39], v[144:147], v[128:131], v[36:39]
    ds_read_b64_tr_b16 v[192:193], v6 offset:37888
    v_mfma_f32_16x16x32_bf16 v[68:71], v[152:155], v[128:131], v[68:71]
    ds_read_b64_tr_b16 v[194:195], v6 offset:38400
    v_mfma_f32_16x16x32_bf16 v[64:67], v[148:151], v[128:131], v[64:67]
    ds_read_b64_tr_b16 v[196:197], v7 offset:37888
    v_mfma_f32_16x16x32_bf16 v[112:115], v[148:151], v[136:139], v[112:115]
    ds_read_b64_tr_b16 v[198:199], v7 offset:38400
    v_mfma_f32_16x16x32_bf16 v[72:75], v[148:151], v[132:135], v[72:75]
    ds_read_b64_tr_b16 v[200:201], v6 offset:38912
    v_mfma_f32_16x16x32_bf16 v[76:79], v[152:155], v[132:135], v[76:79]
    ds_read_b64_tr_b16 v[202:203], v6 offset:39424
    v_mfma_f32_16x16x32_bf16 v[44:47], v[144:147], v[132:135], v[44:47]
    ds_read_b64_tr_b16 v[204:205], v7 offset:38912
    v_mfma_f32_16x16x32_bf16 v[40:43], v[140:143], v[132:135], v[40:43]
    ds_read_b64_tr_b16 v[206:207], v7 offset:39424
    v_mfma_f32_16x16x32_bf16 v[104:107], v[132:135], v[156:159], v[104:107]
    v_mfma_f32_16x16x32_bf16 v[108:111], v[132:135], v[160:163], v[108:111]
    v_mfma_f32_16x16x32_bf16 v[100:103], v[128:131], v[160:163], v[100:103]
    v_mfma_f32_16x16x32_bf16 v[96:99], v[128:131], v[156:159], v[96:99]
    v_mfma_f32_16x16x32_bf16 v[88:91], v[124:127], v[156:159], v[88:91]
    v_mfma_f32_16x16x32_bf16 v[92:95], v[124:127], v[160:163], v[92:95]
    v_mfma_f32_16x16x32_bf16 v[84:87], v[120:123], v[160:163], v[84:87]
    v_mfma_f32_16x16x32_bf16 v[80:83], v[120:123], v[156:159], v[80:83]
    v_mfma_f32_16x16x32_bf16 v[116:119], v[136:139], v[156:159], v[116:119]
    s_waitcnt lgkmcnt(0)
    s_barrier
    v_mfma_f32_16x16x32_bf16 v[16:19], v[184:187], v[164:167], v[16:19]
    ds_read_b128 v[120:123], v4 offset:36864
    v_mfma_f32_16x16x32_bf16 v[20:23], v[188:191], v[164:167], v[20:23]
    ds_read_b128 v[124:127], v4 offset:38912
    v_mfma_f32_16x16x32_bf16 v[52:55], v[196:199], v[164:167], v[52:55]
    ds_read_b128 v[128:131], v4 offset:40960
    v_mfma_f32_16x16x32_bf16 v[48:51], v[192:195], v[164:167], v[48:51]
    ds_read_b128 v[132:135], v4 offset:43008
    v_mfma_f32_16x16x32_bf16 v[56:59], v[192:195], v[168:171], v[56:59]
    ds_read_b128 v[136:139], v2 offset:36864
    v_mfma_f32_16x16x32_bf16 v[60:63], v[196:199], v[168:171], v[60:63]
    ds_read_b64_tr_b16 v[140:141], v6 offset:49152
    v_mfma_f32_16x16x32_bf16 v[28:31], v[188:191], v[168:171], v[28:31]
    ds_read_b64_tr_b16 v[142:143], v6 offset:49664
    v_mfma_f32_16x16x32_bf16 v[24:27], v[184:187], v[168:171], v[24:27]
    ds_read_b64_tr_b16 v[144:145], v7 offset:49152
    v_mfma_f32_16x16x32_bf16 v[32:35], v[184:187], v[172:175], v[32:35]
    ds_read_b64_tr_b16 v[146:147], v7 offset:49664
    v_mfma_f32_16x16x32_bf16 v[36:39], v[188:191], v[172:175], v[36:39]
    ds_read_b64_tr_b16 v[148:149], v6 offset:50176
    v_mfma_f32_16x16x32_bf16 v[68:71], v[196:199], v[172:175], v[68:71]
    ds_read_b64_tr_b16 v[150:151], v6 offset:50688
    v_mfma_f32_16x16x32_bf16 v[64:67], v[192:195], v[172:175], v[64:67]
    ds_read_b64_tr_b16 v[152:153], v7 offset:50176
    v_mfma_f32_16x16x32_bf16 v[112:115], v[192:195], v[180:183], v[112:115]
    ds_read_b64_tr_b16 v[154:155], v7 offset:50688
    v_mfma_f32_16x16x32_bf16 v[72:75], v[192:195], v[176:179], v[72:75]
    ds_read_b64_tr_b16 v[156:157], v6 offset:51200
    v_mfma_f32_16x16x32_bf16 v[76:79], v[196:199], v[176:179], v[76:79]
    ds_read_b64_tr_b16 v[158:159], v6 offset:51712
    v_mfma_f32_16x16x32_bf16 v[44:47], v[188:191], v[176:179], v[44:47]
    ds_read_b64_tr_b16 v[160:161], v7 offset:51200
    v_mfma_f32_16x16x32_bf16 v[40:43], v[184:187], v[176:179], v[40:43]
    ds_read_b64_tr_b16 v[162:163], v7 offset:51712
    v_mfma_f32_16x16x32_bf16 v[104:107], v[176:179], v[200:203], v[104:107]
    v_mfma_f32_16x16x32_bf16 v[108:111], v[176:179], v[204:207], v[108:111]
    v_mfma_f32_16x16x32_bf16 v[100:103], v[172:175], v[204:207], v[100:103]
    v_mfma_f32_16x16x32_bf16 v[96:99], v[172:175], v[200:203], v[96:99]
    v_mfma_f32_16x16x32_bf16 v[88:91], v[168:171], v[200:203], v[88:91]
    v_mfma_f32_16x16x32_bf16 v[92:95], v[168:171], v[204:207], v[92:95]
    v_mfma_f32_16x16x32_bf16 v[84:87], v[164:167], v[204:207], v[84:87]
    v_mfma_f32_16x16x32_bf16 v[80:83], v[164:167], v[200:203], v[80:83]
    v_mfma_f32_16x16x32_bf16 v[116:119], v[180:183], v[200:203], v[116:119]
    s_waitcnt lgkmcnt(0)
    v_mfma_f32_16x16x32_bf16 v[16:19], v[140:143], v[120:123], v[16:19]
    ds_read_b128 v[164:167], v5 offset:36864
    v_mfma_f32_16x16x32_bf16 v[20:23], v[144:147], v[120:123], v[20:23]
    ds_read_b128 v[168:171], v5 offset:38912
    v_mfma_f32_16x16x32_bf16 v[52:55], v[152:155], v[120:123], v[52:55]
    ds_read_b128 v[172:175], v5 offset:40960
    v_mfma_f32_16x16x32_bf16 v[48:51], v[148:151], v[120:123], v[48:51]
    ds_read_b128 v[176:179], v5 offset:43008
    v_mfma_f32_16x16x32_bf16 v[56:59], v[148:151], v[124:127], v[56:59]
    ds_read_b128 v[180:183], v3 offset:36864
    v_mfma_f32_16x16x32_bf16 v[60:63], v[152:155], v[124:127], v[60:63]
    ds_read_b64_tr_b16 v[184:185], v6 offset:61440
    v_mfma_f32_16x16x32_bf16 v[28:31], v[144:147], v[124:127], v[28:31]
    ds_read_b64_tr_b16 v[186:187], v6 offset:61952
    v_mfma_f32_16x16x32_bf16 v[24:27], v[140:143], v[124:127], v[24:27]
    ds_read_b64_tr_b16 v[188:189], v7 offset:61440
    v_mfma_f32_16x16x32_bf16 v[32:35], v[140:143], v[128:131], v[32:35]
    ds_read_b64_tr_b16 v[190:191], v7 offset:61952
    v_mfma_f32_16x16x32_bf16 v[36:39], v[144:147], v[128:131], v[36:39]
    ds_read_b64_tr_b16 v[192:193], v6 offset:62464
    v_mfma_f32_16x16x32_bf16 v[68:71], v[152:155], v[128:131], v[68:71]
    ds_read_b64_tr_b16 v[194:195], v6 offset:62976
    v_mfma_f32_16x16x32_bf16 v[64:67], v[148:151], v[128:131], v[64:67]
    ds_read_b64_tr_b16 v[196:197], v7 offset:62464
    v_mfma_f32_16x16x32_bf16 v[112:115], v[148:151], v[136:139], v[112:115]
    ds_read_b64_tr_b16 v[198:199], v7 offset:62976
    v_mfma_f32_16x16x32_bf16 v[72:75], v[148:151], v[132:135], v[72:75]
    ds_read_b64_tr_b16 v[200:201], v6 offset:63488
    v_mfma_f32_16x16x32_bf16 v[76:79], v[152:155], v[132:135], v[76:79]
    ds_read_b64_tr_b16 v[202:203], v6 offset:64000
    v_mfma_f32_16x16x32_bf16 v[44:47], v[144:147], v[132:135], v[44:47]
    ds_read_b64_tr_b16 v[204:205], v7 offset:63488
    v_mfma_f32_16x16x32_bf16 v[40:43], v[140:143], v[132:135], v[40:43]
    ds_read_b64_tr_b16 v[206:207], v7 offset:64000
    v_mfma_f32_16x16x32_bf16 v[104:107], v[132:135], v[156:159], v[104:107]
    s_nop 0
    v_mfma_f32_16x16x32_bf16 v[108:111], v[132:135], v[160:163], v[108:111]
    s_nop 0
    v_mfma_f32_16x16x32_bf16 v[100:103], v[128:131], v[160:163], v[100:103]
    s_nop 0
    v_mfma_f32_16x16x32_bf16 v[96:99], v[128:131], v[156:159], v[96:99]
    s_nop 0
    v_mfma_f32_16x16x32_bf16 v[88:91], v[124:127], v[156:159], v[88:91]
    ds_read_b32 v223, v10 offset:24
    v_mfma_f32_16x16x32_bf16 v[92:95], v[124:127], v[160:163], v[92:95]
    v_mfma_f32_16x16x32_bf16 v[84:87], v[120:123], v[160:163], v[84:87]
    v_mfma_f32_16x16x32_bf16 v[80:83], v[120:123], v[156:159], v[80:83]
    v_mfma_f32_16x16x32_bf16 v[116:119], v[136:139], v[156:159], v[116:119]
    s_waitcnt lgkmcnt(0)
    v_cmp_gt_u32 vcc, 4, v223
    s_cbranch_vccnz LB_w15
LB_g15:
    v_mfma_f32_16x16x32_bf16 v[16:19], v[184:187], v[164:167], v[16:19]
    ds_read_b128 v[120:123], v4 offset:0
    v_mfma_f32_16x16x32_bf16 v[20:23], v[188:191], v[164:167], v[20:23]
    ds_read_b128 v[124:127], v4 offset:2048
    v_mfma_f32_16x16x32_bf16 v[52:55], v[196:199], v[164:167], v[52:55]
    ds_read_b128 v[128:131], v4 offset:4096
    v_mfma_f32_16x16x32_bf16 v[48:51], v[192:195], v[164:167], v[48:51]
    ds_read_b128 v[132:135], v4 offset:6144
    v_mfma_f32_16x16x32_bf16 v[56:59], v[192:195], v[168:171], v[56:59]
    ds_read_b128 v[136:139], v2 offset:0
    v_mfma_f32_16x16x32_bf16 v[60:63], v[196:199], v[168:171], v[60:63]
    ds_read_b64_tr_b16 v[140:141], v6 offset:0
    v_mfma_f32_16x16x32_bf16 v[28:31], v[188:191], v[168:171], v[28:31]
    ds_read_b64_tr_b16 v[142:143], v6 offset:512
    v_mfma_f32_16x16x32_bf16 v[24:27], v[184:187], v[168:171], v[24:27]
    ds_read_b64_tr_b16 v[144:145], v7 offset:0
    v_mfma_f32_16x16x32_bf16 v[32:35], v[184:187], v[172:175], v[32:35]
    ds_read_b64_tr_b16 v[146:147], v7 offset:512
    v_mfma_f32_16x16x32_bf16 v[36:39], v[188:191], v[172:175], v[36:39]
    ds_read_b64_tr_b16 v[148:149], v6 offset:1024
    v_mfma_f32_16x16x32_bf16 v[68:71], v[196:199], v[172:175], v[68:71]
    ds_read_b64_tr_b16 v[150:151], v6 offset:1536
    v_mfma_f32_16x16x32_bf16 v[64:67], v[192:195], v[172:175], v[64:67]
    ds_read_b64_tr_b16 v[152:153], v7 offset:1024
    v_mfma_f32_16x16x32_bf16 v[112:115], v[192:195], v[180:183], v[112:115]
    ds_read_b64_tr_b16 v[154:155], v7 offset:1536
    v_mfma_f32_16x16x32_bf16 v[72:75], v[192:195], v[176:179], v[72:75]
    ds_read_b64_tr_b16 v[156:157], v6 offset:2048
    v_mfma_f32_16x16x32_bf16 v[76:79], v[196:199], v[176:179], v[76:79]
    ds_read_b64_tr_b16 v[158:159], v6 offset:2560
    v_mfma_f32_16x16x32_bf16 v[44:47], v[188:191], v[176:179], v[44:47]
    ds_read_b64_tr_b16 v[160:161], v7 offset:2048
    v_mfma_f32_16x16x32_bf16 v[40:43], v[184:187], v[176:179], v[40:43]
    ds_read_b64_tr_b16 v[162:163], v7 offset:2560
    v_mfma_f32_16x16x32_bf16 v[104:107], v[176:179], v[200:203], v[104:107]
    v_mfma_f32_16x16x32_bf16 v[108:111], v[176:179], v[204:207], v[108:111]
    v_mfma_f32_16x16x32_bf16 v[100:103], v[172:175], v[204:207], v[100:103]
    v_mfma_f32_16x16x32_bf16 v[96:99], v[172:175], v[200:203], v[96:99]
    v_mfma_f32_16x16x32_bf16 v[88:91], v[168:171], v[200:203], v[88:91]
    v_mfma_f32_16x16x32_bf16 v[92:95], v[168:171], v[204:207], v[92:95]
    v_mfma_f32_16x16x32_bf16 v[84:87], v[164:167], v[204:207], v[84:87]
    v_mfma_f32_16x16x32_bf16 v[80:83], v[164:167], v[200:203], v[80:83]
    v_mfma_f32_16x16x32_bf16 v[116:119], v[180:183], v[200:203], v[116:119]
    s_waitcnt lgkmcnt(0)
    v_mfma_f32_16x16x32_bf16 v[16:19], v[140:143], v[120:123], v[16:19]
    ds_read_b128 v[164:167], v5 offset:0
    v_mfma_f32_16x16x32_bf16 v[20:23], v[144:147], v[120:123], v[20:23]
    ds_read_b128 v[168:171], v5 offset:2048
    v_mfma_f32_16x16x32_bf16 v[52:55], v[152:155], v[120:123], v[52:55]
    ds_read_b128 v[172:175], v5 offset:4096
    v_mfma_f32_16x16x32_bf16 v[48:51], v[148:151], v[120:123], v[48:51]
    ds_read_b128 v[176:179], v5 offset:6144
    v_mfma_f32_16x16x32_bf16 v[56:59], v[148:151], v[124:127], v[56:59]
    ds_read_b128 v[180:183], v3 offset:0
    v_mfma_f32_16x16x32_bf16 v[60:63], v[152:155], v[124:127], v[60:63]
    ds_read_b64_tr_b16 v[184:185], v6 offset:12288
    v_mfma_f32_16x16x32_bf16 v[28:31], v[144:147], v[124:127], v[28:31]
    ds_read_b64_tr_b16 v[186:187], v6 offset:12800
    v_mfma_f32_16x16x32_bf16 v[24:27], v[140:143], v[124:127], v[24:27]
    ds_read_b64_tr_b16 v[188:189], v7 offset:12288
    v_mfma_f32_16x16x32_bf16 v[32:35], v[140:143], v[128:131], v[32:35]
    ds_read_b64_tr_b16 v[190:191], v7 offset:12800
    v_mfma_f32_16x16x32_bf16 v[36:39], v[144:147], v[128:131], v[36:39]
    ds_read_b64_tr_b16 v[192:193], v6 offset:13312
    v_mfma_f32_16x16x32_bf16 v[68:71], v[152:155], v[128:131], v[68:71]
    ds_read_b64_tr_b16 v[194:195], v6 offset:13824
    v_mfma_f32_16x16x32_bf16 v[64:67], v[148:151], v[128:131], v[64:67]
    ds_read_b64_tr_b16 v[196:197], v7 offset:13312
    v_mfma_f32_16x16x32_bf16 v[112:115], v[148:151], v[136:139], v[112:115]
    ds_read_b64_tr_b16 v[198:199], v7 offset:13824
    v_mfma_f32_16x16x32_bf16 v[72:75], v[148:151], v[132:135], v[72:75]
    ds_read_b64_tr_b16 v[200:201], v6 offset:14336
    v_mfma_f32_16x16x32_bf16 v[76:79], v[152:155], v[132:135], v[76:79]
    ds_read_b64_tr_b16 v[202:203], v6 offset:14848
    v_mfma_f32_16x16x32_bf16 v[44:47], v[144:147], v[132:135], v[44:47]
    ds_read_b64_tr_b16 v[204:205], v7 offset:14336
    v_mfma_f32_16x16x32_bf16 v[40:43], v[140:143], v[132:135], v[40:43]
    ds_read_b64_tr_b16 v[206:207], v7 offset:14848
    v_mfma_f32_16x16x32_bf16 v[104:107], v[132:135], v[156:159], v[104:107]
    v_mfma_f32_16x16x32_bf16 v[108:111], v[132:135], v[160:163], v[108:111]
    v_mfma_f32_16x16x32_bf16 v[100:103], v[128:131], v[160:163], v[100:103]
    v_mfma_f32_16x16x32_bf16 v[96:99], v[128:131], v[156:159], v[96:99]
    v_mfma_f32_16x16x32_bf16 v[88:91], v[124:127], v[156:159], v[88:91]
    v_mfma_f32_16x16x32_bf16 v[92:95], v[124:127], v[160:163], v[92:95]
    v_mfma_f32_16x16x32_bf16 v[84:87], v[120:123], v[160:163], v[84:87]
    v_mfma_f32_16x16x32_bf16 v[80:83], v[120:123], v[156:159], v[80:83]
    v_mfma_f32_16x16x32_bf16 v[116:119], v[136:139], v[156:159], v[116:119]
    s_waitcnt lgkmcnt(0)
    v_mfma_f32_16x16x32_bf16 v[112:115], v[192:195], v[180:183], v[112:115]
    v_mfma_f32_16x16x32_bf16 v[116:119], v[180:183], v[200:203], v[116:119]
    v_mfma_f32_16x16x32_bf16 v[72:75], v[192:195], v[176:179], v[72:75]
    v_mfma_f32_16x16x32_bf16 v[76:79], v[196:199], v[176:179], v[76:79]
    v_mfma_f32_16x16x32_bf16 v[104:107], v[176:179], v[200:203], v[104:107]
    v_mfma_f32_16x16x32_bf16 v[108:111], v[176:179], v[204:207], v[108:111]
    v_mfma_f32_16x16x32_bf16 v[40:43], v[184:187], v[176:179], v[40:43]
    v_mfma_f32_16x16x32_bf16 v[44:47], v[188:191], v[176:179], v[44:47]
    v_mfma_f32_16x16x32_bf16 v[64:67], v[192:195], v[172:175], v[64:67]
    v_mfma_f32_16x16x32_bf16 v[68:71], v[196:199], v[172:175], v[68:71]
    v_cvt_pk_bf16_f32 v156, v112, v113
    v_cvt_pk_bf16_f32 v157, v114, v115
    v_mfma_f32_16x16x32_bf16 v[32:35], v[184:187], v[172:175], v[32:35]
    v_cvt_pk_bf16_f32 v158, v116, v117
    v_cvt_pk_bf16_f32 v159, v118, v119
    v_mfma_f32_16x16x32_bf16 v[36:39], v[188:191], v[172:175], v[36:39]
    v_cvt_pk_bf16_f32 v152, v72, v73
    v_cvt_pk_bf16_f32 v153, v74, v75
    v_mfma_f32_16x16x32_bf16 v[56:59], v[192:195], v[168:171], v[56:59]
    v_cvt_pk_bf16_f32 v154, v76, v77
    v_cvt_pk_bf16_f32 v155, v78, v79
    v_mfma_f32_16x16x32_bf16 v[60:63], v[196:199], v[168:171], v[60:63]
    v_cvt_pk_bf16_f32 v232, v104, v105
    v_cvt_pk_bf16_f32 v233, v106, v107
    v_mfma_f32_16x16x32_bf16 v[24:27], v[184:187], v[168:171], v[24:27]
    v_cvt_pk_bf16_f32 v242, v108, v109
    v_cvt_pk_bf16_f32 v243, v110, v111
    v_mfma_f32_16x16x32_bf16 v[28:31], v[188:191], v[168:171], v[28:31]
    ds_write_b64 v216, v[156:157]
    ds_write_b64 v216, v[158:159] offset:1024
    v_mfma_f32_16x16x32_bf16 v[48:51], v[192:195], v[164:167], v[48:51]
    ds_write_b64 v217, v[152:153] offset:0
    ds_write_b64 v217, v[232:233] offset:1024
    v_mfma_f32_16x16x32_bf16 v[52:55], v[196:199], v[164:167], v[52:55]
    ds_write_b64 v217, v[154:155] offset:512
    ds_write_b64 v217, v[242:243] offset:1536
    v_mfma_f32_16x16x32_bf16 v[16:19], v[184:187], v[164:167], v[16:19]
    v_cvt_pk_bf16_f32 v132, v40, v41
    v_cvt_pk_bf16_f32 v133, v42, v43
    v_mfma_f32_16x16x32_bf16 v[20:23], v[188:191], v[164:167], v[20:23]
    v_cvt_pk_bf16_f32 v134, v44, v45
    v_cvt_pk_bf16_f32 v135, v46, v47
    v_mfma_f32_16x16x32_bf16 v[96:99], v[172:175], v[200:203], v[96:99]
    v_cvt_pk_bf16_f32 v148, v64, v65
    v_cvt_pk_bf16_f32 v149, v66, v67
    v_mfma_f32_16x16x32_bf16 v[100:103], v[172:175], v[204:207], v[100:103]
    v_cvt_pk_bf16_f32 v150, v68, v69
    v_cvt_pk_bf16_f32 v151, v70, v71
    v_mfma_f32_16x16x32_bf16 v[88:91], v[168:171], v[200:203], v[88:91]
    v_cvt_pk_bf16_f32 v128, v32, v33
    v_cvt_pk_bf16_f32 v129, v34, v35
    v_mfma_f32_16x16x32_bf16 v[92:95], v[168:171], v[204:207], v[92:95]
    v_cvt_pk_bf16_f32 v130, v36, v37
    v_cvt_pk_bf16_f32 v131, v38, v39
    v_mfma_f32_16x16x32_bf16 v[80:83], v[164:167], v[200:203], v[80:83]
    v_cvt_pk_bf16_f32 v144, v56, v57
    v_cvt_pk_bf16_f32 v145, v58, v59
    v_mfma_f32_16x16x32_bf16 v[84:87], v[164:167], v[204:207], v[84:87]
    v_cvt_pk_bf16_f32 v146, v60, v61
    v_cvt_pk_bf16_f32 v147, v62, v63
    v_cvt_pk_bf16_f32 v124, v24, v25
    v_cvt_pk_bf16_f32 v125, v26, v27
    v_cvt_pk_bf16_f32 v126, v28, v29
    v_cvt_pk_bf16_f32 v127, v30, v31
    s_mov_b64 exec, 1
    ds_add_u32 v10, v11 offset:0
    s_mov_b64 exec, -1
    v_cvt_pk_bf16_f32 v140, v48, v49
    v_cvt_pk_bf16_f32 v141, v50, v51
    v_cvt_pk_bf16_f32 v142, v52, v53
    v_cvt_pk_bf16_f32 v143, v54, v55
    v_cvt_pk_bf16_f32 v120, v16, v17
    v_cvt_pk_bf16_f32 v121, v18, v19
    v_cvt_pk_bf16_f32 v122, v20, v21
    v_cvt_pk_bf16_f32 v123, v22, v23
    v_mfma_f32_16x16x32_bf16 v[44:47], v[152:155], v[132:135], 0
    v_cvt_pk_bf16_f32 v230, v96, v97
    v_cvt_pk_bf16_f32 v231, v98, v99
    v_mfma_f32_16x16x32_bf16 v[40:43], v[148:151], v[132:135], 0
    v_cvt_pk_bf16_f32 v240, v100, v101
    v_cvt_pk_bf16_f32 v241, v102, v103
    v_mfma_f32_16x16x32_bf16 v[36:39], v[148:151], v[128:131], 0
    v_cvt_pk_bf16_f32 v228, v88, v89
    v_cvt_pk_bf16_f32 v229, v90, v91
    v_mfma_f32_16x16x32_bf16 v[32:35], v[144:147], v[128:131], 0
    v_cvt_pk_bf16_f32 v238, v92, v93
    v_cvt_pk_bf16_f32 v239, v94, v95
    v_mfma_f32_16x16x32_bf16 v[28:31], v[144:147], v[124:127], 0
    v_cvt_pk_bf16_f32 v226, v80, v81
    v_cvt_pk_bf16_f32 v227, v82, v83
    v_mfma_f32_16x16x32_bf16 v[24:27], v[140:143], v[124:127], 0
    v_cvt_pk_bf16_f32 v236, v84, v85
    v_cvt_pk_bf16_f32 v237, v86, v87
    v_mfma_f32_16x16x32_bf16 v[20:23], v[140:143], v[120:123], 0
    s_branch LB_s1_in
LB_s1:
    s_sleep 1
LB_s1_in:
    ds_read_b32 v14, v10 offset:0
    ds_read_b64 v[136:137], v218
    ds_read_b64 v[138:139], v219
    ds_read_b64 v[224:225], v218 offset:1024
    ds_read_b64 v[234:235], v219 offset:1024
    s_waitcnt lgkmcnt(0)
    v_readfirstlane_b32 s78, v14
    s_nop 0
    s_cmp_ge_u32 s78, 4
    s_cbranch_scc0 LB_s1
    v_mfma_f32_16x16x32_bf16 v[16:19], v[136:139], v[120:123], v[212:215]
    v_cndmask_b32 v60, v44, v45, s[88:89]
    s_add_u32 m0, s34, 36864
    s_add_u32 s35, s44, 0
    buffer_load_dwordx4 v245, s[64:67], s35 offen  lds
    v_cndmask_b32 v61, v40, v41, s[88:89]
    v_cndmask_b32 v54, v61, v60, s[90:91]
    v_cndmask_b32 v60, v46, v47, s[88:89]
    v_cndmask_b32 v61, v42, v43, s[88:89]
    v_cndmask_b32 v55, v61, v60, s[92:93]
    v_max_f32 v59, v54, v55
    v_cndmask_b32 v60, v36, v37, s[88:89]
    v_cndmask_b32 v61, v32, v33, s[88:89]
    v_cndmask_b32 v52, v61, v60, s[90:91]
    v_cndmask_b32 v60, v38, v39, s[88:89]
    v_cndmask_b32 v61, v34, v35, s[88:89]
    v_cndmask_b32 v53, v61, v60, s[92:93]
    v_max_f32 v58, v52, v53
    v_cndmask_b32 v60, v28, v29, s[88:89]
    v_cndmask_b32 v61, v24, v25, s[88:89]
    v_cndmask_b32 v50, v61, v60, s[90:91]
    v_cndmask_b32 v60, v30, v31, s[88:89]
    v_cndmask_b32 v61, v26, v27, s[88:89]
    s_add_u32 m0, s34, 40960
    s_add_u32 s35, s44, 65536
    buffer_load_dwordx4 v245, s[64:67], s35 offen  lds
    v_cndmask_b32 v51, v61, v60, s[92:93]
    v_max_f32 v57, v50, v51
    v_cndmask_b32 v60, v20, v21, s[88:89]
    v_cndmask_b32 v61, v16, v17, s[88:89]
    v_cndmask_b32 v48, v61, v60, s[90:91]
    v_cndmask_b32 v60, v22, v23, s[88:89]
    v_cndmask_b32 v61, v18, v19, s[88:89]
    v_cndmask_b32 v49, v61, v60, s[92:93]
    v_max_f32 v56, v48, v49
    s_mov_b32 s80, 0x3e8293ee
    v_permlane32_swap_b32 v58, v59
    v_permlane32_swap_b32 v56, v57
    v_max_f32 v58, v58, v59
    v_max_f32 v56, v56, v57
    s_nop 1
    v_permlane16_swap_b32 v56, v58
    v_max_f32 v56, v56, v58
    v_mul_f32 v56, s80, v56
    v_mov_b32 v58, v56
    s_nop 1
    v_permlane16_swap_b32 v56, v58
    s_add_u32 m0, s34, 45056
    s_add_u32 s35, s44, 131072
    buffer_load_dwordx4 v245, s[64:67], s35 offen  lds
    v_mov_b32 v57, v56
    v_mov_b32 v59, v58
    s_nop 0
    v_permlane32_swap_b32 v56, v57
    v_permlane32_swap_b32 v58, v59
    v_fma_f32 v48, v48, s80, -v56
    v_fma_f32 v49, v49, s80, -v56
    v_fma_f32 v50, v50, s80, -v57
    v_fma_f32 v51, v51, s80, -v57
    v_fma_f32 v52, v52, s80, -v58
    v_fma_f32 v53, v53, s80, -v58
    v_fma_f32 v54, v54, s80, -v59
    v_fma_f32 v55, v55, s80, -v59
    v_exp_f32 v48, v48
    v_exp_f32 v49, v49
    v_exp_f32 v50, v50
    v_exp_f32 v51, v51
    v_exp_f32 v52, v52
    v_exp_f32 v53, v53
    s_add_u32 m0, s34, 49152
    s_add_u32 s35, s44, 196608
    buffer_load_dwordx4 v245, s[64:67], s35 offen  lds
    v_exp_f32 v54, v54
    v_exp_f32 v55, v55
    v_add_f32 v56, v48, v49
    v_add_f32 v57, v50, v51
    v_add_f32 v58, v52, v53
    v_add_f32 v59, v54, v55
    s_nop 1
    v_permlane32_swap_b32 v58, v59
    v_permlane32_swap_b32 v56, v57
    v_add_f32 v58, v58, v59
    v_add_f32 v56, v56, v57
    s_nop 1
    v_permlane16_swap_b32 v56, v58
    v_add_f32 v56, v56, v58
    v_rcp_f32 v56, v56
    s_nop 0
    v_mov_b32 v58, v56
    s_nop 1
    v_permlane16_swap_b32 v56, v58
    v_mov_b32 v57, v56
    v_mov_b32 v59, v58
    s_nop 0
    v_permlane32_swap_b32 v56, v57
    v_permlane32_swap_b32 v58, v59
    s_add_u32 m0, s34, 53248
    s_add_u32 s35, s45, 0
    buffer_load_dwordx4 v245, s[64:67], s35 offen  lds
    v_mul_f32 v48, v48, v56
    v_mul_f32 v49, v49, v56
    v_cvt_pk_bf16_f32 v48, v48, v49
    v_perm_b32 v64, v48, v48, v208
    v_perm_b32 v65, v48, v48, v209
    v_perm_b32 v66, v48, v48, v210
    v_perm_b32 v67, v48, v48, v211
    v_mul_f32 v50, v50, v57
    v_mul_f32 v51, v51, v57
    v_cvt_pk_bf16_f32 v50, v50, v51
    v_perm_b32 v68, v50, v50, v208
    v_perm_b32 v69, v50, v50, v209
    v_perm_b32 v70, v50, v50, v210
    v_perm_b32 v71, v50, v50, v211
    v_mfma_f32_16x16x32_bf16 v[16:19], v[224:227], v[64:67], 0
    v_mfma_f32_16x16x32_bf16 v[20:23], v[234:237], v[64:67], 0
    v_mul_f32 v52, v52, v58
    v_mul_f32 v53, v53, v58
    s_add_u32 m0, s34, 57344
    s_add_u32 s35, s45, 65536
    buffer_load_dwordx4 v245, s[64:67], s35 offen  lds
    v_cvt_pk_bf16_f32 v52, v52, v53
    v_perm_b32 v72, v52, v52, v208
    v_perm_b32 v73, v52, v52, v209
    v_perm_b32 v74, v52, v52, v210
    v_perm_b32 v75, v52, v52, v211
    v_mfma_f32_16x16x32_bf16 v[24:27], v[226:229], v[68:71], 0
    v_mfma_f32_16x16x32_bf16 v[28:31], v[236:239], v[68:71], 0
    v_mul_f32 v54, v54, v59
    v_mul_f32 v55, v55, v59
    v_cvt_pk_bf16_f32 v54, v54, v55
    v_perm_b32 v76, v54, v54, v208
    v_perm_b32 v77, v54, v54, v209
    v_perm_b32 v78, v54, v54, v210
    v_perm_b32 v79, v54, v54, v211
    v_mfma_f32_16x16x32_bf16 v[32:35], v[228:231], v[72:75], 0
    v_mfma_f32_16x16x32_bf16 v[36:39], v[238:241], v[72:75], 0
    v_mfma_f32_16x16x32_bf16 v[40:43], v[230:233], v[76:79], 0
    v_mfma_f32_16x16x32_bf16 v[44:47], v[240:243], v[76:79], 0
    v_cvt_pk_bf16_f32 v80, v16, v17
    v_cvt_pk_bf16_f32 v81, v18, v19
    v_cvt_pk_bf16_f32 v82, v20, v21
    v_cvt_pk_bf16_f32 v83, v22, v23
    s_add_u32 s95, s94, 0
    buffer_store_dwordx4 v[80:83], v12, s[52:55], s95 offen sc1
    v_cvt_pk_bf16_f32 v84, v24, v25
    v_cvt_pk_bf16_f32 v85, v26, v27
    v_cvt_pk_bf16_f32 v86, v28, v29
    v_cvt_pk_bf16_f32 v87, v30, v31
    s_add_u32 s95, s94, 32768
    buffer_store_dwordx4 v[84:87], v12, s[52:55], s95 offen sc1
    v_cvt_pk_bf16_f32 v88, v32, v33
    v_cvt_pk_bf16_f32 v89, v34, v35
    v_cvt_pk_bf16_f32 v90, v36, v37
    v_cvt_pk_bf16_f32 v91, v38, v39
    s_add_u32 s95, s94, 65536
    buffer_store_dwordx4 v[88:91], v12, s[52:55], s95 offen sc1
    v_cvt_pk_bf16_f32 v92, v40, v41
    v_cvt_pk_bf16_f32 v93, v42, v43
    v_cvt_pk_bf16_f32 v94, v44, v45
    v_cvt_pk_bf16_f32 v95, v46, v47
    s_add_u32 s95, s94, 98304
    buffer_store_dwordx4 v[92:95], v12, s[52:55], s95 offen sc1
    s_add_u32 m0, s34, 61440
    s_add_u32 s35, s45, 131072
    buffer_load_dwordx4 v245, s[64:67], s35 offen  lds
    v_xor_b32 v2, 0, v244
    v_xor_b32 v3, 32, v244
    v_xor_b32 v4, 64, v244
    v_xor_b32 v5, 96, v244
    s_add_u32 m0, s34, 65536
    s_add_u32 s35, s45, 196608
    buffer_load_dwordx4 v245, s[64:67], s35 offen  lds
    v_xor_b32 v6, 2048, v244
    v_xor_b32 v7, 2080, v244
    v_xor_b32 v8, 2112, v244
    v_xor_b32 v9, 2144, v244
    s_waitcnt vmcnt(6)
    s_mov_b64 exec, 1
    ds_add_u32 v10, v11 offset:8
    s_mov_b64 exec, -1
    s_add_u32 m0, s34, 69632
    s_add_u32 s35, s46, 0
    buffer_load_dwordx4 v245, s[64:67], s35 offen  lds
    v_add_u32 v224, 65536, v2
    v_add_u32 v225, 65536, v3
    s_add_u32 m0, s34, 73728
    s_add_u32 s35, s46, 65536
    buffer_load_dwordx4 v245, s[64:67], s35 offen  lds
    v_add_u32 v226, 65536, v4
    s_add_u32 m0, s34, 77824
    s_add_u32 s35, s46, 131072
    buffer_load_dwordx4 v245, s[64:67], s35 offen  lds
    v_add_u32 v227, 65536, v5
    v_add_u32 v228, 65536, v6
    s_add_u32 m0, s34, 81920
    s_add_u32 s35, s46, 196608
    buffer_load_dwordx4 v245, s[64:67], s35 offen  lds
    v_add_u32 v229, 65536, v7
    s_add_u32 m0, s34, 86016
    s_add_u32 s35, s47, 0
    buffer_load_dwordx4 v245, s[64:67], s35 offen  lds
    v_add_u32 v230, 65536, v8
    v_add_u32 v231, 65536, v9
    s_add_u32 m0, s34, 0
    s_add_u32 s35, s47, 65536
    buffer_load_dwordx4 v245, s[64:67], s35 offen  lds
    v_add_u32 v15, 32768, v12
    s_waitcnt vmcnt(8)
    s_mov_b64 exec, 1
    buffer_store_dword v11, v220, s[52:55], s97 offen sc1
    s_mov_b64 exec, -1
    s_branch LB_s2_in
LB_s2:
    s_sleep 1
LB_s2_in:
    ds_read_b32 v14, v10 offset:8
    s_waitcnt lgkmcnt(0)
    v_readfirstlane_b32 s78, v14
    s_nop 0
    s_cmp_ge_u32 s78, 8
    s_cbranch_scc0 LB_s2
    s_add_u32 m0, s34, 4096
    s_add_u32 s35, s47, 131072
    buffer_load_dwordx4 v245, s[64:67], s35 offen  lds
    ds_read_b64_tr_b16 v[48:49], v2 offset:36864
    ds_read_b64_tr_b16 v[50:51], v6 offset:36864
    s_add_u32 m0, s34, 8192
    s_add_u32 s35, s47, 196608
    buffer_load_dwordx4 v245, s[64:67], s35 offen  lds
    ds_read_b64_tr_b16 v[52:53], v3 offset:36864
    s_add_u32 m0, s34, 12288
    s_add_u32 s35, s48, 0
    buffer_load_dwordx4 v245, s[64:67], s35 offen  lds
    ds_read_b64_tr_b16 v[54:55], v7 offset:36864
    s_add_u32 m0, s34, 16384
    s_add_u32 s35, s48, 65536
    buffer_load_dwordx4 v245, s[64:67], s35 offen  lds
    ds_read_b64_tr_b16 v[56:57], v4 offset:36864
    ds_read_b64_tr_b16 v[58:59], v8 offset:36864
    s_add_u32 m0, s34, 20480
    s_add_u32 s35, s48, 131072
    buffer_load_dwordx4 v245, s[64:67], s35 offen  lds
    ds_read_b64_tr_b16 v[60:61], v5 offset:36864
    s_add_u32 m0, s34, 110592
    s_add_u32 s35, s48, 196608
    buffer_load_dwordx4 v245, s[64:67], s35 offen  lds
    ds_read_b64_tr_b16 v[62:63], v9 offset:36864
    s_add_u32 m0, s34, 114688
    s_add_u32 s35, s49, 0
    buffer_load_dwordx4 v245, s[64:67], s35 offen  lds
    ds_read_b64_tr_b16 v[64:65], v2 offset:40960
    ds_read_b64_tr_b16 v[66:67], v6 offset:40960
    s_add_u32 m0, s34, 118784
    s_add_u32 s35, s49, 65536
    buffer_load_dwordx4 v245, s[64:67], s35 offen  lds
    ds_read_b64_tr_b16 v[68:69], v3 offset:40960
    s_add_u32 m0, s34, 122880
    s_add_u32 s35, s49, 131072
    buffer_load_dwordx4 v245, s[64:67], s35 offen  lds
    ds_read_b64_tr_b16 v[70:71], v7 offset:40960
    s_add_u32 m0, s34, 24576
    s_add_u32 s35, s49, 196608
    buffer_load_dwordx4 v245, s[64:67], s35 offen  lds
    ds_read_b64_tr_b16 v[72:73], v4 offset:40960
    ds_read_b64_tr_b16 v[74:75], v8 offset:40960
    s_add_u32 m0, s34, 28672
    s_add_u32 s35, s50, 0
    buffer_load_dwordx4 v245, s[64:67], s35 offen  lds
    ds_read_b64_tr_b16 v[76:77], v5 offset:40960
    s_add_u32 m0, s34, 32768
    s_add_u32 s35, s50, 65536
    buffer_load_dwordx4 v245, s[64:67], s35 offen  lds
    ds_read_b64_tr_b16 v[78:79], v9 offset:40960
    s_waitcnt vmcnt(0)
    s_mov_b64 exec, 0xffffffff
    s_mov_b32 s79, 0
LB_po:
    buffer_load_dword v14, v247, s[52:55], s30 offen sc1
    s_add_u32 s79, s79, 1
    s_cmp_gt_u32 s79, 200000
    s_cbranch_scc1 LB_po_x
    s_waitcnt vmcnt(0)
    v_cmp_ne_u32 vcc, 1, v14
    s_cbranch_vccz LB_po_x
    s_mov_b64 exec, vcc
    s_sleep 8
    s_branch LB_po
LB_po_x:
    s_waitcnt vmcnt(0)
    s_mov_b64 exec, -1
    buffer_load_dwordx4 v[96:99], v12, s[52:55], s36 offen offset:0 sc1
    buffer_load_dwordx4 v[100:103], v15, s[52:55], s36 offen offset:0 sc1
    buffer_load_dwordx4 v[104:107], v12, s[52:55], s36 offen offset:1024 sc1
    buffer_load_dwordx4 v[108:111], v15, s[52:55], s36 offen offset:1024 sc1
    buffer_load_dwordx4 v[112:115], v12, s[52:55], s36 offen offset:2048 sc1
    buffer_load_dwordx4 v[116:119], v15, s[52:55], s36 offen offset:2048 sc1
    buffer_load_dwordx4 v[120:123], v12, s[52:55], s36 offen offset:3072 sc1
    buffer_load_dwordx4 v[124:127], v15, s[52:55], s36 offen offset:3072 sc1
    buffer_load_dwordx4 v[128:131], v12, s[52:55], s37 offen offset:0 sc1
    buffer_load_dwordx4 v[132:135], v15, s[52:55], s37 offen offset:0 sc1
    s_setprio 1
    s_mov_b64 exec, 1
    ds_add_u32 v10, v11 offset:16
    s_mov_b64 exec, -1
    s_branch LB_s4_in
LB_s4:
    s_sleep 1
LB_s4_in:
    ds_read_b32 v14, v10 offset:16
    s_waitcnt lgkmcnt(0)
    v_readfirstlane_b32 s78, v14
    s_nop 0
    s_cmp_ge_u32 s78, 4
    s_cbranch_scc0 LB_s4
    s_waitcnt vmcnt(8)
    v_mfma_f32_16x16x32_bf16 v[16:19], v[48:51], v[96:99], 0
    buffer_load_dwordx4 v[136:139], v12, s[52:55], s37 offen offset:1024 sc1
    buffer_load_dwordx4 v[140:143], v15, s[52:55], s37 offen offset:1024 sc1
    v_mfma_f32_16x16x32_bf16 v[20:23], v[52:55], v[96:99], 0
    ds_read_b64_tr_b16 v[80:81], v2 offset:45056
    v_mfma_f32_16x16x32_bf16 v[24:27], v[56:59], v[96:99], 0
    ds_read_b64_tr_b16 v[82:83], v6 offset:45056
    v_mfma_f32_16x16x32_bf16 v[28:31], v[60:63], v[96:99], 0
    ds_read_b64_tr_b16 v[84:85], v3 offset:45056
    v_mfma_f32_16x16x32_bf16 v[32:35], v[48:51], v[100:103], 0
    ds_read_b64_tr_b16 v[86:87], v7 offset:45056
    ds_read_b64_tr_b16 v[88:89], v4 offset:45056
    v_mfma_f32_16x16x32_bf16 v[36:39], v[52:55], v[100:103], 0
    ds_read_b64_tr_b16 v[90:91], v8 offset:45056
    v_mfma_f32_16x16x32_bf16 v[40:43], v[56:59], v[100:103], 0
    ds_read_b64_tr_b16 v[92:93], v5 offset:45056
    v_mfma_f32_16x16x32_bf16 v[44:47], v[60:63], v[100:103], 0
    ds_read_b64_tr_b16 v[94:95], v9 offset:45056
    s_waitcnt vmcnt(8)
    v_mfma_f32_16x16x32_bf16 v[16:19], v[64:67], v[104:107], v[16:19]
    buffer_load_dwordx4 v[96:99], v12, s[52:55], s37 offen offset:2048 sc1
    buffer_load_dwordx4 v[100:103], v15, s[52:55], s37 offen offset:2048 sc1
    v_mfma_f32_16x16x32_bf16 v[20:23], v[68:71], v[104:107], v[20:23]
    ds_read_b64_tr_b16 v[48:49], v2 offset:49152
    v_mfma_f32_16x16x32_bf16 v[24:27], v[72:75], v[104:107], v[24:27]
    ds_read_b64_tr_b16 v[50:51], v6 offset:49152
    v_mfma_f32_16x16x32_bf16 v[28:31], v[76:79], v[104:107], v[28:31]
    ds_read_b64_tr_b16 v[52:53], v3 offset:49152
    v_mfma_f32_16x16x32_bf16 v[32:35], v[64:67], v[108:111], v[32:35]
    ds_read_b64_tr_b16 v[54:55], v7 offset:49152
    ds_read_b64_tr_b16 v[56:57], v4 offset:49152
    v_mfma_f32_16x16x32_bf16 v[36:39], v[68:71], v[108:111], v[36:39]
    ds_read_b64_tr_b16 v[58:59], v8 offset:49152
    v_mfma_f32_16x16x32_bf16 v[40:43], v[72:75], v[108:111], v[40:43]
    ds_read_b64_tr_b16 v[60:61], v5 offset:49152
    v_mfma_f32_16x16x32_bf16 v[44:47], v[76:79], v[108:111], v[44:47]
    ds_read_b64_tr_b16 v[62:63], v9 offset:49152
    s_waitcnt vmcnt(8) lgkmcnt(8)
    v_mfma_f32_16x16x32_bf16 v[16:19], v[80:83], v[112:115], v[16:19]
    buffer_load_dwordx4 v[104:107], v12, s[52:55], s37 offen offset:3072 sc1
    buffer_load_dwordx4 v[108:111], v15, s[52:55], s37 offen offset:3072 sc1
    v_mfma_f32_16x16x32_bf16 v[20:23], v[84:87], v[112:115], v[20:23]
    ds_read_b64_tr_b16 v[64:65], v2 offset:53248
    v_mfma_f32_16x16x32_bf16 v[24:27], v[88:91], v[112:115], v[24:27]
    ds_read_b64_tr_b16 v[66:67], v6 offset:53248
    v_mfma_f32_16x16x32_bf16 v[28:31], v[92:95], v[112:115], v[28:31]
    ds_read_b64_tr_b16 v[68:69], v3 offset:53248
    v_mfma_f32_16x16x32_bf16 v[32:35], v[80:83], v[116:119], v[32:35]
    ds_read_b64_tr_b16 v[70:71], v7 offset:53248
    ds_read_b64_tr_b16 v[72:73], v4 offset:53248
    v_mfma_f32_16x16x32_bf16 v[36:39], v[84:87], v[116:119], v[36:39]
    ds_read_b64_tr_b16 v[74:75], v8 offset:53248
    v_mfma_f32_16x16x32_bf16 v[40:43], v[88:91], v[116:119], v[40:43]
    ds_read_b64_tr_b16 v[76:77], v5 offset:53248
    v_mfma_f32_16x16x32_bf16 v[44:47], v[92:95], v[116:119], v[44:47]
    ds_read_b64_tr_b16 v[78:79], v9 offset:53248
    s_waitcnt vmcnt(8) lgkmcnt(8)
    v_mfma_f32_16x16x32_bf16 v[16:19], v[48:51], v[120:123], v[16:19]
    buffer_load_dwordx4 v[112:115], v12, s[52:55], s38 offen offset:0 sc1
    buffer_load_dwordx4 v[116:119], v15, s[52:55], s38 offen offset:0 sc1
    v_mfma_f32_16x16x32_bf16 v[20:23], v[52:55], v[120:123], v[20:23]
    ds_read_b64_tr_b16 v[80:81], v2 offset:57344
    v_mfma_f32_16x16x32_bf16 v[24:27], v[56:59], v[120:123], v[24:27]
    ds_read_b64_tr_b16 v[82:83], v6 offset:57344
    v_mfma_f32_16x16x32_bf16 v[28:31], v[60:63], v[120:123], v[28:31]
    ds_read_b64_tr_b16 v[84:85], v3 offset:57344
    v_mfma_f32_16x16x32_bf16 v[32:35], v[48:51], v[124:127], v[32:35]
    ds_read_b64_tr_b16 v[86:87], v7 offset:57344
    ds_read_b64_tr_b16 v[88:89], v4 offset:57344
    v_mfma_f32_16x16x32_bf16 v[36:39], v[52:55], v[124:127], v[36:39]
    ds_read_b64_tr_b16 v[90:91], v8 offset:57344
    v_mfma_f32_16x16x32_bf16 v[40:43], v[56:59], v[124:127], v[40:43]
    ds_read_b64_tr_b16 v[92:93], v5 offset:57344
    v_mfma_f32_16x16x32_bf16 v[44:47], v[60:63], v[124:127], v[44:47]
    ds_read_b64_tr_b16 v[94:95], v9 offset:57344
    s_waitcnt vmcnt(8) lgkmcnt(8)
    v_mfma_f32_16x16x32_bf16 v[16:19], v[64:67], v[128:131], v[16:19]
    buffer_load_dwordx4 v[120:123], v12, s[52:55], s38 offen offset:1024 sc1
    buffer_load_dwordx4 v[124:127], v15, s[52:55], s38 offen offset:1024 sc1
    v_mfma_f32_16x16x32_bf16 v[20:23], v[68:71], v[128:131], v[20:23]
    ds_read_b64_tr_b16 v[48:49], v2 offset:61440
    v_mfma_f32_16x16x32_bf16 v[24:27], v[72:75], v[128:131], v[24:27]
    ds_read_b64_tr_b16 v[50:51], v6 offset:61440
    v_mfma_f32_16x16x32_bf16 v[28:31], v[76:79], v[128:131], v[28:31]
    ds_read_b64_tr_b16 v[52:53], v3 offset:61440
    v_mfma_f32_16x16x32_bf16 v[32:35], v[64:67], v[132:135], v[32:35]
    ds_read_b64_tr_b16 v[54:55], v7 offset:61440
    ds_read_b64_tr_b16 v[56:57], v4 offset:61440
    v_mfma_f32_16x16x32_bf16 v[36:39], v[68:71], v[132:135], v[36:39]
    ds_read_b64_tr_b16 v[58:59], v8 offset:61440
    v_mfma_f32_16x16x32_bf16 v[40:43], v[72:75], v[132:135], v[40:43]
    ds_read_b64_tr_b16 v[60:61], v5 offset:61440
    v_mfma_f32_16x16x32_bf16 v[44:47], v[76:79], v[132:135], v[44:47]
    ds_read_b64_tr_b16 v[62:63], v9 offset:61440
    s_waitcnt vmcnt(8) lgkmcnt(8)
    v_mfma_f32_16x16x32_bf16 v[16:19], v[80:83], v[136:139], v[16:19]
    buffer_load_dwordx4 v[128:131], v12, s[52:55], s38 offen offset:2048 sc1
    buffer_load_dwordx4 v[132:135], v15, s[52:55], s38 offen offset:2048 sc1
    v_mfma_f32_16x16x32_bf16 v[20:23], v[84:87], v[136:139], v[20:23]
    ds_read_b64_tr_b16 v[64:65], v224 offset:0
    v_mfma_f32_16x16x32_bf16 v[24:27], v[88:91], v[136:139], v[24:27]
    ds_read_b64_tr_b16 v[66:67], v228 offset:0
    v_mfma_f32_16x16x32_bf16 v[28:31], v[92:95], v[136:139], v[28:31]
    ds_read_b64_tr_b16 v[68:69], v225 offset:0
    v_mfma_f32_16x16x32_bf16 v[32:35], v[80:83], v[140:143], v[32:35]
    ds_read_b64_tr_b16 v[70:71], v229 offset:0
    ds_read_b64_tr_b16 v[72:73], v226 offset:0
    v_mfma_f32_16x16x32_bf16 v[36:39], v[84:87], v[140:143], v[36:39]
    ds_read_b64_tr_b16 v[74:75], v230 offset:0
    v_mfma_f32_16x16x32_bf16 v[40:43], v[88:91], v[140:143], v[40:43]
    ds_read_b64_tr_b16 v[76:77], v227 offset:0
    v_mfma_f32_16x16x32_bf16 v[44:47], v[92:95], v[140:143], v[44:47]
    ds_read_b64_tr_b16 v[78:79], v231 offset:0
    s_waitcnt vmcnt(8) lgkmcnt(8)
    v_mfma_f32_16x16x32_bf16 v[16:19], v[48:51], v[96:99], v[16:19]
    buffer_load_dwordx4 v[136:139], v12, s[52:55], s38 offen offset:3072 sc1
    buffer_load_dwordx4 v[140:143], v15, s[52:55], s38 offen offset:3072 sc1
    v_mfma_f32_16x16x32_bf16 v[20:23], v[52:55], v[96:99], v[20:23]
    ds_read_b64_tr_b16 v[80:81], v224 offset:4096
    v_mfma_f32_16x16x32_bf16 v[24:27], v[56:59], v[96:99], v[24:27]
    ds_read_b64_tr_b16 v[82:83], v228 offset:4096
    v_mfma_f32_16x16x32_bf16 v[28:31], v[60:63], v[96:99], v[28:31]
    ds_read_b64_tr_b16 v[84:85], v225 offset:4096
    v_mfma_f32_16x16x32_bf16 v[32:35], v[48:51], v[100:103], v[32:35]
    ds_read_b64_tr_b16 v[86:87], v229 offset:4096
    ds_read_b64_tr_b16 v[88:89], v226 offset:4096
    v_mfma_f32_16x16x32_bf16 v[36:39], v[52:55], v[100:103], v[36:39]
    ds_read_b64_tr_b16 v[90:91], v230 offset:4096
    v_mfma_f32_16x16x32_bf16 v[40:43], v[56:59], v[100:103], v[40:43]
    ds_read_b64_tr_b16 v[92:93], v227 offset:4096
    v_mfma_f32_16x16x32_bf16 v[44:47], v[60:63], v[100:103], v[44:47]
    ds_read_b64_tr_b16 v[94:95], v231 offset:4096
    s_waitcnt vmcnt(8) lgkmcnt(8)
    v_mfma_f32_16x16x32_bf16 v[16:19], v[64:67], v[104:107], v[16:19]
    buffer_load_dwordx4 v[96:99], v12, s[52:55], s39 offen offset:0 sc1
    buffer_load_dwordx4 v[100:103], v15, s[52:55], s39 offen offset:0 sc1
    v_mfma_f32_16x16x32_bf16 v[20:23], v[68:71], v[104:107], v[20:23]
    ds_read_b64_tr_b16 v[48:49], v224 offset:8192
    v_mfma_f32_16x16x32_bf16 v[24:27], v[72:75], v[104:107], v[24:27]
    ds_read_b64_tr_b16 v[50:51], v228 offset:8192
    v_mfma_f32_16x16x32_bf16 v[28:31], v[76:79], v[104:107], v[28:31]
    ds_read_b64_tr_b16 v[52:53], v225 offset:8192
    v_mfma_f32_16x16x32_bf16 v[32:35], v[64:67], v[108:111], v[32:35]
    ds_read_b64_tr_b16 v[54:55], v229 offset:8192
    ds_read_b64_tr_b16 v[56:57], v226 offset:8192
    v_mfma_f32_16x16x32_bf16 v[36:39], v[68:71], v[108:111], v[36:39]
    ds_read_b64_tr_b16 v[58:59], v230 offset:8192
    v_mfma_f32_16x16x32_bf16 v[40:43], v[72:75], v[108:111], v[40:43]
    ds_read_b64_tr_b16 v[60:61], v227 offset:8192
    v_mfma_f32_16x16x32_bf16 v[44:47], v[76:79], v[108:111], v[44:47]
    ds_read_b64_tr_b16 v[62:63], v231 offset:8192
    s_waitcnt vmcnt(8) lgkmcnt(8)
    v_mfma_f32_16x16x32_bf16 v[16:19], v[80:83], v[112:115], v[16:19]
    buffer_load_dwordx4 v[104:107], v12, s[52:55], s39 offen offset:1024 sc1
    buffer_load_dwordx4 v[108:111], v15, s[52:55], s39 offen offset:1024 sc1
    v_mfma_f32_16x16x32_bf16 v[20:23], v[84:87], v[112:115], v[20:23]
    ds_read_b64_tr_b16 v[64:65], v224 offset:12288
    v_mfma_f32_16x16x32_bf16 v[24:27], v[88:91], v[112:115], v[24:27]
    ds_read_b64_tr_b16 v[66:67], v228 offset:12288
    v_mfma_f32_16x16x32_bf16 v[28:31], v[92:95], v[112:115], v[28:31]
    ds_read_b64_tr_b16 v[68:69], v225 offset:12288
    v_mfma_f32_16x16x32_bf16 v[32:35], v[80:83], v[116:119], v[32:35]
    ds_read_b64_tr_b16 v[70:71], v229 offset:12288
    ds_read_b64_tr_b16 v[72:73], v226 offset:12288
    v_mfma_f32_16x16x32_bf16 v[36:39], v[84:87], v[116:119], v[36:39]
    ds_read_b64_tr_b16 v[74:75], v230 offset:12288
    v_mfma_f32_16x16x32_bf16 v[40:43], v[88:91], v[116:119], v[40:43]
    ds_read_b64_tr_b16 v[76:77], v227 offset:12288
    v_mfma_f32_16x16x32_bf16 v[44:47], v[92:95], v[116:119], v[44:47]
    ds_read_b64_tr_b16 v[78:79], v231 offset:12288
    s_waitcnt vmcnt(8) lgkmcnt(8)
    v_mfma_f32_16x16x32_bf16 v[16:19], v[48:51], v[120:123], v[16:19]
    buffer_load_dwordx4 v[112:115], v12, s[52:55], s39 offen offset:2048 sc1
    buffer_load_dwordx4 v[116:119], v15, s[52:55], s39 offen offset:2048 sc1
    v_mfma_f32_16x16x32_bf16 v[20:23], v[52:55], v[120:123], v[20:23]
    ds_read_b64_tr_b16 v[80:81], v224 offset:16384
    v_mfma_f32_16x16x32_bf16 v[24:27], v[56:59], v[120:123], v[24:27]
    ds_read_b64_tr_b16 v[82:83], v228 offset:16384
    v_mfma_f32_16x16x32_bf16 v[28:31], v[60:63], v[120:123], v[28:31]
    ds_read_b64_tr_b16 v[84:85], v225 offset:16384
    v_mfma_f32_16x16x32_bf16 v[32:35], v[48:51], v[124:127], v[32:35]
    ds_read_b64_tr_b16 v[86:87], v229 offset:16384
    ds_read_b64_tr_b16 v[88:89], v226 offset:16384
    v_mfma_f32_16x16x32_bf16 v[36:39], v[52:55], v[124:127], v[36:39]
    ds_read_b64_tr_b16 v[90:91], v230 offset:16384
    v_mfma_f32_16x16x32_bf16 v[40:43], v[56:59], v[124:127], v[40:43]
    ds_read_b64_tr_b16 v[92:93], v227 offset:16384
    v_mfma_f32_16x16x32_bf16 v[44:47], v[60:63], v[124:127], v[44:47]
    ds_read_b64_tr_b16 v[94:95], v231 offset:16384
    s_waitcnt vmcnt(8) lgkmcnt(8)
    v_mfma_f32_16x16x32_bf16 v[16:19], v[64:67], v[128:131], v[16:19]
    buffer_load_dwordx4 v[120:123], v12, s[52:55], s39 offen offset:3072 sc1
    buffer_load_dwordx4 v[124:127], v15, s[52:55], s39 offen offset:3072 sc1
    v_mfma_f32_16x16x32_bf16 v[20:23], v[68:71], v[128:131], v[20:23]
    ds_read_b64_tr_b16 v[48:49], v224 offset:20480
    v_mfma_f32_16x16x32_bf16 v[24:27], v[72:75], v[128:131], v[24:27]
    ds_read_b64_tr_b16 v[50:51], v228 offset:20480
    v_mfma_f32_16x16x32_bf16 v[28:31], v[76:79], v[128:131], v[28:31]
    ds_read_b64_tr_b16 v[52:53], v225 offset:20480
    v_mfma_f32_16x16x32_bf16 v[32:35], v[64:67], v[132:135], v[32:35]
    ds_read_b64_tr_b16 v[54:55], v229 offset:20480
    ds_read_b64_tr_b16 v[56:57], v226 offset:20480
    v_mfma_f32_16x16x32_bf16 v[36:39], v[68:71], v[132:135], v[36:39]
    ds_read_b64_tr_b16 v[58:59], v230 offset:20480
    v_mfma_f32_16x16x32_bf16 v[40:43], v[72:75], v[132:135], v[40:43]
    ds_read_b64_tr_b16 v[60:61], v227 offset:20480
    v_mfma_f32_16x16x32_bf16 v[44:47], v[76:79], v[132:135], v[44:47]
    ds_read_b64_tr_b16 v[62:63], v231 offset:20480
    s_waitcnt vmcnt(8) lgkmcnt(8)
    v_mfma_f32_16x16x32_bf16 v[16:19], v[80:83], v[136:139], v[16:19]
    buffer_load_dwordx4 v[128:131], v12, s[52:55], s40 offen offset:0 sc1
    buffer_load_dwordx4 v[132:135], v15, s[52:55], s40 offen offset:0 sc1
    v_mfma_f32_16x16x32_bf16 v[20:23], v[84:87], v[136:139], v[20:23]
    ds_read_b64_tr_b16 v[64:65], v2 offset:0
    v_mfma_f32_16x16x32_bf16 v[24:27], v[88:91], v[136:139], v[24:27]
    ds_read_b64_tr_b16 v[66:67], v6 offset:0
    v_mfma_f32_16x16x32_bf16 v[28:31], v[92:95], v[136:139], v[28:31]
    ds_read_b64_tr_b16 v[68:69], v3 offset:0
    v_mfma_f32_16x16x32_bf16 v[32:35], v[80:83], v[140:143], v[32:35]
    ds_read_b64_tr_b16 v[70:71], v7 offset:0
    ds_read_b64_tr_b16 v[72:73], v4 offset:0
    v_mfma_f32_16x16x32_bf16 v[36:39], v[84:87], v[140:143], v[36:39]
    ds_read_b64_tr_b16 v[74:75], v8 offset:0
    v_mfma_f32_16x16x32_bf16 v[40:43], v[88:91], v[140:143], v[40:43]
    ds_read_b64_tr_b16 v[76:77], v5 offset:0
    v_mfma_f32_16x16x32_bf16 v[44:47], v[92:95], v[140:143], v[44:47]
    ds_read_b64_tr_b16 v[78:79], v9 offset:0
    s_waitcnt vmcnt(8) lgkmcnt(8)
    v_mfma_f32_16x16x32_bf16 v[16:19], v[48:51], v[96:99], v[16:19]
    buffer_load_dwordx4 v[136:139], v12, s[52:55], s40 offen offset:1024 sc1
    buffer_load_dwordx4 v[140:143], v15, s[52:55], s40 offen offset:1024 sc1
    v_mfma_f32_16x16x32_bf16 v[20:23], v[52:55], v[96:99], v[20:23]
    ds_read_b64_tr_b16 v[80:81], v2 offset:4096
    v_mfma_f32_16x16x32_bf16 v[24:27], v[56:59], v[96:99], v[24:27]
    ds_read_b64_tr_b16 v[82:83], v6 offset:4096
    v_mfma_f32_16x16x32_bf16 v[28:31], v[60:63], v[96:99], v[28:31]
    ds_read_b64_tr_b16 v[84:85], v3 offset:4096
    v_mfma_f32_16x16x32_bf16 v[32:35], v[48:51], v[100:103], v[32:35]
    ds_read_b64_tr_b16 v[86:87], v7 offset:4096
    ds_read_b64_tr_b16 v[88:89], v4 offset:4096
    v_mfma_f32_16x16x32_bf16 v[36:39], v[52:55], v[100:103], v[36:39]
    ds_read_b64_tr_b16 v[90:91], v8 offset:4096
    v_mfma_f32_16x16x32_bf16 v[40:43], v[56:59], v[100:103], v[40:43]
    ds_read_b64_tr_b16 v[92:93], v5 offset:4096
    v_mfma_f32_16x16x32_bf16 v[44:47], v[60:63], v[100:103], v[44:47]
    ds_read_b64_tr_b16 v[94:95], v9 offset:4096
    s_waitcnt vmcnt(8) lgkmcnt(8)
    v_mfma_f32_16x16x32_bf16 v[16:19], v[64:67], v[104:107], v[16:19]
    buffer_load_dwordx4 v[96:99], v12, s[52:55], s40 offen offset:2048 sc1
    buffer_load_dwordx4 v[100:103], v15, s[52:55], s40 offen offset:2048 sc1
    v_mfma_f32_16x16x32_bf16 v[20:23], v[68:71], v[104:107], v[20:23]
    ds_read_b64_tr_b16 v[48:49], v2 offset:8192
    v_mfma_f32_16x16x32_bf16 v[24:27], v[72:75], v[104:107], v[24:27]
    ds_read_b64_tr_b16 v[50:51], v6 offset:8192
    v_mfma_f32_16x16x32_bf16 v[28:31], v[76:79], v[104:107], v[28:31]
    ds_read_b64_tr_b16 v[52:53], v3 offset:8192
    v_mfma_f32_16x16x32_bf16 v[32:35], v[64:67], v[108:111], v[32:35]
    ds_read_b64_tr_b16 v[54:55], v7 offset:8192
    ds_read_b64_tr_b16 v[56:57], v4 offset:8192
    v_mfma_f32_16x16x32_bf16 v[36:39], v[68:71], v[108:111], v[36:39]
    ds_read_b64_tr_b16 v[58:59], v8 offset:8192
    v_mfma_f32_16x16x32_bf16 v[40:43], v[72:75], v[108:111], v[40:43]
    ds_read_b64_tr_b16 v[60:61], v5 offset:8192
    v_mfma_f32_16x16x32_bf16 v[44:47], v[76:79], v[108:111], v[44:47]
    ds_read_b64_tr_b16 v[62:63], v9 offset:8192
    s_waitcnt vmcnt(8) lgkmcnt(8)
    v_mfma_f32_16x16x32_bf16 v[16:19], v[80:83], v[112:115], v[16:19]
    buffer_load_dwordx4 v[104:107], v12, s[52:55], s40 offen offset:3072 sc1
    buffer_load_dwordx4 v[108:111], v15, s[52:55], s40 offen offset:3072 sc1
    v_mfma_f32_16x16x32_bf16 v[20:23], v[84:87], v[112:115], v[20:23]
    ds_read_b64_tr_b16 v[64:65], v2 offset:12288
    v_mfma_f32_16x16x32_bf16 v[24:27], v[88:91], v[112:115], v[24:27]
    ds_read_b64_tr_b16 v[66:67], v6 offset:12288
    v_mfma_f32_16x16x32_bf16 v[28:31], v[92:95], v[112:115], v[28:31]
    ds_read_b64_tr_b16 v[68:69], v3 offset:12288
    v_mfma_f32_16x16x32_bf16 v[32:35], v[80:83], v[116:119], v[32:35]
    ds_read_b64_tr_b16 v[70:71], v7 offset:12288
    ds_read_b64_tr_b16 v[72:73], v4 offset:12288
    v_mfma_f32_16x16x32_bf16 v[36:39], v[84:87], v[116:119], v[36:39]
    ds_read_b64_tr_b16 v[74:75], v8 offset:12288
    v_mfma_f32_16x16x32_bf16 v[40:43], v[88:91], v[116:119], v[40:43]
    ds_read_b64_tr_b16 v[76:77], v5 offset:12288
    v_mfma_f32_16x16x32_bf16 v[44:47], v[92:95], v[116:119], v[44:47]
    ds_read_b64_tr_b16 v[78:79], v9 offset:12288
    s_waitcnt vmcnt(8) lgkmcnt(8)
    v_mfma_f32_16x16x32_bf16 v[16:19], v[48:51], v[120:123], v[16:19]
    buffer_load_dwordx4 v[112:115], v12, s[52:55], s41 offen offset:0 sc1
    buffer_load_dwordx4 v[116:119], v15, s[52:55], s41 offen offset:0 sc1
    v_mfma_f32_16x16x32_bf16 v[20:23], v[52:55], v[120:123], v[20:23]
    ds_read_b64_tr_b16 v[80:81], v2 offset:16384
    v_mfma_f32_16x16x32_bf16 v[24:27], v[56:59], v[120:123], v[24:27]
    ds_read_b64_tr_b16 v[82:83], v6 offset:16384
    v_mfma_f32_16x16x32_bf16 v[28:31], v[60:63], v[120:123], v[28:31]
    ds_read_b64_tr_b16 v[84:85], v3 offset:16384
    v_mfma_f32_16x16x32_bf16 v[32:35], v[48:51], v[124:127], v[32:35]
    ds_read_b64_tr_b16 v[86:87], v7 offset:16384
    ds_read_b64_tr_b16 v[88:89], v4 offset:16384
    v_mfma_f32_16x16x32_bf16 v[36:39], v[52:55], v[124:127], v[36:39]
    ds_read_b64_tr_b16 v[90:91], v8 offset:16384
    v_mfma_f32_16x16x32_bf16 v[40:43], v[56:59], v[124:127], v[40:43]
    ds_read_b64_tr_b16 v[92:93], v5 offset:16384
    v_mfma_f32_16x16x32_bf16 v[44:47], v[60:63], v[124:127], v[44:47]
    ds_read_b64_tr_b16 v[94:95], v9 offset:16384
    s_waitcnt vmcnt(8) lgkmcnt(8)
    v_mfma_f32_16x16x32_bf16 v[16:19], v[64:67], v[128:131], v[16:19]
    buffer_load_dwordx4 v[120:123], v12, s[52:55], s41 offen offset:1024 sc1
    buffer_load_dwordx4 v[124:127], v15, s[52:55], s41 offen offset:1024 sc1
    v_mfma_f32_16x16x32_bf16 v[20:23], v[68:71], v[128:131], v[20:23]
    ds_read_b64_tr_b16 v[48:49], v2 offset:20480
    v_mfma_f32_16x16x32_bf16 v[24:27], v[72:75], v[128:131], v[24:27]
    ds_read_b64_tr_b16 v[50:51], v6 offset:20480
    v_mfma_f32_16x16x32_bf16 v[28:31], v[76:79], v[128:131], v[28:31]
    ds_read_b64_tr_b16 v[52:53], v3 offset:20480
    v_mfma_f32_16x16x32_bf16 v[32:35], v[64:67], v[132:135], v[32:35]
    ds_read_b64_tr_b16 v[54:55], v7 offset:20480
    ds_read_b64_tr_b16 v[56:57], v4 offset:20480
    v_mfma_f32_16x16x32_bf16 v[36:39], v[68:71], v[132:135], v[36:39]
    ds_read_b64_tr_b16 v[58:59], v8 offset:20480
    v_mfma_f32_16x16x32_bf16 v[40:43], v[72:75], v[132:135], v[40:43]
    ds_read_b64_tr_b16 v[60:61], v5 offset:20480
    v_mfma_f32_16x16x32_bf16 v[44:47], v[76:79], v[132:135], v[44:47]
    ds_read_b64_tr_b16 v[62:63], v9 offset:20480
    s_waitcnt vmcnt(8) lgkmcnt(8)
    v_mfma_f32_16x16x32_bf16 v[16:19], v[80:83], v[136:139], v[16:19]
    buffer_load_dwordx4 v[128:131], v12, s[52:55], s41 offen offset:2048 sc1
    buffer_load_dwordx4 v[132:135], v15, s[52:55], s41 offen offset:2048 sc1
    v_mfma_f32_16x16x32_bf16 v[20:23], v[84:87], v[136:139], v[20:23]
    ds_read_b64_tr_b16 v[64:65], v224 offset:45056
    v_mfma_f32_16x16x32_bf16 v[24:27], v[88:91], v[136:139], v[24:27]
    ds_read_b64_tr_b16 v[66:67], v228 offset:45056
    v_mfma_f32_16x16x32_bf16 v[28:31], v[92:95], v[136:139], v[28:31]
    ds_read_b64_tr_b16 v[68:69], v225 offset:45056
    v_mfma_f32_16x16x32_bf16 v[32:35], v[80:83], v[140:143], v[32:35]
    ds_read_b64_tr_b16 v[70:71], v229 offset:45056
    ds_read_b64_tr_b16 v[72:73], v226 offset:45056
    v_mfma_f32_16x16x32_bf16 v[36:39], v[84:87], v[140:143], v[36:39]
    ds_read_b64_tr_b16 v[74:75], v230 offset:45056
    v_mfma_f32_16x16x32_bf16 v[40:43], v[88:91], v[140:143], v[40:43]
    ds_read_b64_tr_b16 v[76:77], v227 offset:45056
    v_mfma_f32_16x16x32_bf16 v[44:47], v[92:95], v[140:143], v[44:47]
    ds_read_b64_tr_b16 v[78:79], v231 offset:45056
    s_waitcnt vmcnt(8) lgkmcnt(8)
    v_mfma_f32_16x16x32_bf16 v[16:19], v[48:51], v[96:99], v[16:19]
    buffer_load_dwordx4 v[136:139], v12, s[52:55], s41 offen offset:3072 sc1
    buffer_load_dwordx4 v[140:143], v15, s[52:55], s41 offen offset:3072 sc1
    v_mfma_f32_16x16x32_bf16 v[20:23], v[52:55], v[96:99], v[20:23]
    ds_read_b64_tr_b16 v[80:81], v224 offset:49152
    v_mfma_f32_16x16x32_bf16 v[24:27], v[56:59], v[96:99], v[24:27]
    ds_read_b64_tr_b16 v[82:83], v228 offset:49152
    v_mfma_f32_16x16x32_bf16 v[28:31], v[60:63], v[96:99], v[28:31]
    ds_read_b64_tr_b16 v[84:85], v225 offset:49152
    v_mfma_f32_16x16x32_bf16 v[32:35], v[48:51], v[100:103], v[32:35]
    ds_read_b64_tr_b16 v[86:87], v229 offset:49152
    ds_read_b64_tr_b16 v[88:89], v226 offset:49152
    v_mfma_f32_16x16x32_bf16 v[36:39], v[52:55], v[100:103], v[36:39]
    ds_read_b64_tr_b16 v[90:91], v230 offset:49152
    v_mfma_f32_16x16x32_bf16 v[40:43], v[56:59], v[100:103], v[40:43]
    ds_read_b64_tr_b16 v[92:93], v227 offset:49152
    v_mfma_f32_16x16x32_bf16 v[44:47], v[60:63], v[100:103], v[44:47]
    ds_read_b64_tr_b16 v[94:95], v231 offset:49152
    s_waitcnt vmcnt(8) lgkmcnt(8)
    s_mov_b64 exec, 1
    ds_add_u32 v10, v11 offset:28
    s_mov_b64 exec, -1
    v_mfma_f32_16x16x32_bf16 v[16:19], v[64:67], v[104:107], v[16:19]
    buffer_load_dwordx4 v[96:99], v12, s[52:55], s42 offen offset:0 sc1
    buffer_load_dwordx4 v[100:103], v15, s[52:55], s42 offen offset:0 sc1
    v_mfma_f32_16x16x32_bf16 v[20:23], v[68:71], v[104:107], v[20:23]
    ds_read_b64_tr_b16 v[48:49], v224 offset:53248
    v_mfma_f32_16x16x32_bf16 v[24:27], v[72:75], v[104:107], v[24:27]
    ds_read_b64_tr_b16 v[50:51], v228 offset:53248
    v_mfma_f32_16x16x32_bf16 v[28:31], v[76:79], v[104:107], v[28:31]
    ds_read_b64_tr_b16 v[52:53], v225 offset:53248
    v_mfma_f32_16x16x32_bf16 v[32:35], v[64:67], v[108:111], v[32:35]
    ds_read_b64_tr_b16 v[54:55], v229 offset:53248
    ds_read_b64_tr_b16 v[56:57], v226 offset:53248
    v_mfma_f32_16x16x32_bf16 v[36:39], v[68:71], v[108:111], v[36:39]
    ds_read_b64_tr_b16 v[58:59], v230 offset:53248
    v_mfma_f32_16x16x32_bf16 v[40:43], v[72:75], v[108:111], v[40:43]
    ds_read_b64_tr_b16 v[60:61], v227 offset:53248
    v_mfma_f32_16x16x32_bf16 v[44:47], v[76:79], v[108:111], v[44:47]
    ds_read_b64_tr_b16 v[62:63], v231 offset:53248
    s_waitcnt vmcnt(8) lgkmcnt(9)
    v_mfma_f32_16x16x32_bf16 v[16:19], v[80:83], v[112:115], v[16:19]
    buffer_load_dwordx4 v[104:107], v12, s[52:55], s42 offen offset:1024 sc1
    buffer_load_dwordx4 v[108:111], v15, s[52:55], s42 offen offset:1024 sc1
    v_mfma_f32_16x16x32_bf16 v[20:23], v[84:87], v[112:115], v[20:23]
    ds_read_b64_tr_b16 v[64:65], v224 offset:57344
    v_mfma_f32_16x16x32_bf16 v[24:27], v[88:91], v[112:115], v[24:27]
    ds_read_b64_tr_b16 v[66:67], v228 offset:57344
    v_mfma_f32_16x16x32_bf16 v[28:31], v[92:95], v[112:115], v[28:31]
    ds_read_b64_tr_b16 v[68:69], v225 offset:57344
    v_mfma_f32_16x16x32_bf16 v[32:35], v[80:83], v[116:119], v[32:35]
    ds_read_b64_tr_b16 v[70:71], v229 offset:57344
    ds_read_b64_tr_b16 v[72:73], v226 offset:57344
    v_mfma_f32_16x16x32_bf16 v[36:39], v[84:87], v[116:119], v[36:39]
    ds_read_b64_tr_b16 v[74:75], v230 offset:57344
    v_mfma_f32_16x16x32_bf16 v[40:43], v[88:91], v[116:119], v[40:43]
    ds_read_b64_tr_b16 v[76:77], v227 offset:57344
    v_mfma_f32_16x16x32_bf16 v[44:47], v[92:95], v[116:119], v[44:47]
    ds_read_b64_tr_b16 v[78:79], v231 offset:57344
    s_waitcnt vmcnt(8) lgkmcnt(8)
    v_mfma_f32_16x16x32_bf16 v[16:19], v[48:51], v[120:123], v[16:19]
    buffer_load_dwordx4 v[112:115], v12, s[52:55], s42 offen offset:2048 sc1
    buffer_load_dwordx4 v[116:119], v15, s[52:55], s42 offen offset:2048 sc1
    v_mfma_f32_16x16x32_bf16 v[20:23], v[52:55], v[120:123], v[20:23]
    ds_read_b64_tr_b16 v[80:81], v2 offset:24576
    v_mfma_f32_16x16x32_bf16 v[24:27], v[56:59], v[120:123], v[24:27]
    ds_read_b64_tr_b16 v[82:83], v6 offset:24576
    v_mfma_f32_16x16x32_bf16 v[28:31], v[60:63], v[120:123], v[28:31]
    ds_read_b64_tr_b16 v[84:85], v3 offset:24576
    v_mfma_f32_16x16x32_bf16 v[32:35], v[48:51], v[124:127], v[32:35]
    ds_read_b64_tr_b16 v[86:87], v7 offset:24576
    ds_read_b64_tr_b16 v[88:89], v4 offset:24576
    v_mfma_f32_16x16x32_bf16 v[36:39], v[52:55], v[124:127], v[36:39]
    ds_read_b64_tr_b16 v[90:91], v8 offset:24576
    v_mfma_f32_16x16x32_bf16 v[40:43], v[56:59], v[124:127], v[40:43]
    ds_read_b64_tr_b16 v[92:93], v5 offset:24576
    v_mfma_f32_16x16x32_bf16 v[44:47], v[60:63], v[124:127], v[44:47]
    ds_read_b64_tr_b16 v[94:95], v9 offset:24576
    s_waitcnt vmcnt(8) lgkmcnt(8)
    v_mfma_f32_16x16x32_bf16 v[16:19], v[64:67], v[128:131], v[16:19]
    buffer_load_dwordx4 v[120:123], v12, s[52:55], s42 offen offset:3072 sc1
    buffer_load_dwordx4 v[124:127], v15, s[52:55], s42 offen offset:3072 sc1
    v_mfma_f32_16x16x32_bf16 v[20:23], v[68:71], v[128:131], v[20:23]
    ds_read_b64_tr_b16 v[48:49], v2 offset:28672
    v_mfma_f32_16x16x32_bf16 v[24:27], v[72:75], v[128:131], v[24:27]
    ds_read_b64_tr_b16 v[50:51], v6 offset:28672
    v_mfma_f32_16x16x32_bf16 v[28:31], v[76:79], v[128:131], v[28:31]
    ds_read_b64_tr_b16 v[52:53], v3 offset:28672
    v_mfma_f32_16x16x32_bf16 v[32:35], v[64:67], v[132:135], v[32:35]
    ds_read_b64_tr_b16 v[54:55], v7 offset:28672
    ds_read_b64_tr_b16 v[56:57], v4 offset:28672
    v_mfma_f32_16x16x32_bf16 v[36:39], v[68:71], v[132:135], v[36:39]
    ds_read_b64_tr_b16 v[58:59], v8 offset:28672
    v_mfma_f32_16x16x32_bf16 v[40:43], v[72:75], v[132:135], v[40:43]
    ds_read_b64_tr_b16 v[60:61], v5 offset:28672
    v_mfma_f32_16x16x32_bf16 v[44:47], v[76:79], v[132:135], v[44:47]
    ds_read_b64_tr_b16 v[62:63], v9 offset:28672
    s_waitcnt vmcnt(8) lgkmcnt(8)
    v_mfma_f32_16x16x32_bf16 v[16:19], v[80:83], v[136:139], v[16:19]
    buffer_load_dwordx4 v[128:131], v12, s[52:55], s43 offen offset:0 sc1
    buffer_load_dwordx4 v[132:135], v15, s[52:55], s43 offen offset:0 sc1
    v_mfma_f32_16x16x32_bf16 v[20:23], v[84:87], v[136:139], v[20:23]
    ds_read_b32 v223, v10 offset:32
    v_mfma_f32_16x16x32_bf16 v[24:27], v[88:91], v[136:139], v[24:27]
    ds_read_b64_tr_b16 v[64:65], v2 offset:32768
    ds_read_b64_tr_b16 v[66:67], v6 offset:32768
    v_mfma_f32_16x16x32_bf16 v[28:31], v[92:95], v[136:139], v[28:31]
    ds_read_b64_tr_b16 v[68:69], v3 offset:32768
    v_mfma_f32_16x16x32_bf16 v[32:35], v[80:83], v[140:143], v[32:35]
    ds_read_b64_tr_b16 v[70:71], v7 offset:32768
    v_mfma_f32_16x16x32_bf16 v[36:39], v[84:87], v[140:143], v[36:39]
    ds_read_b64_tr_b16 v[72:73], v4 offset:32768
    ds_read_b64_tr_b16 v[74:75], v8 offset:32768
    v_mfma_f32_16x16x32_bf16 v[40:43], v[88:91], v[140:143], v[40:43]
    ds_read_b64_tr_b16 v[76:77], v5 offset:32768
    v_mfma_f32_16x16x32_bf16 v[44:47], v[92:95], v[140:143], v[44:47]
    ds_read_b64_tr_b16 v[78:79], v9 offset:32768
    s_waitcnt vmcnt(8) lgkmcnt(9)
    s_waitcnt lgkmcnt(8)
    v_cmp_gt_u32 vcc, 4, v223
    s_cbranch_vccnz LB_w8
LB_g8:
    v_mfma_f32_16x16x32_bf16 v[16:19], v[48:51], v[96:99], v[16:19]
    buffer_load_dwordx4 v[136:139], v12, s[52:55], s43 offen offset:1024 sc1
    buffer_load_dwordx4 v[140:143], v15, s[52:55], s43 offen offset:1024 sc1
    v_add_u32 v2, 129024, v2
    v_mfma_f32_16x16x32_bf16 v[20:23], v[52:55], v[96:99], v[20:23]
    ds_read_b64_tr_b16 v[80:81], v2 offset:0
    v_add_u32 v6, 129024, v6
    v_mfma_f32_16x16x32_bf16 v[24:27], v[56:59], v[96:99], v[24:27]
    ds_read_b64_tr_b16 v[82:83], v6 offset:0
    v_add_u32 v3, 129024, v3
    v_mfma_f32_16x16x32_bf16 v[28:31], v[60:63], v[96:99], v[28:31]
    ds_read_b64_tr_b16 v[84:85], v3 offset:0
    v_add_u32 v7, 129024, v7
    v_mfma_f32_16x16x32_bf16 v[32:35], v[48:51], v[100:103], v[32:35]
    ds_read_b64_tr_b16 v[86:87], v7 offset:0
    v_add_u32 v4, 129024, v4
    ds_read_b64_tr_b16 v[88:89], v4 offset:0
    v_mfma_f32_16x16x32_bf16 v[36:39], v[52:55], v[100:103], v[36:39]
    v_add_u32 v8, 129024, v8
    ds_read_b64_tr_b16 v[90:91], v8 offset:0
    v_mfma_f32_16x16x32_bf16 v[40:43], v[56:59], v[100:103], v[40:43]
    v_add_u32 v5, 129024, v5
    ds_read_b64_tr_b16 v[92:93], v5 offset:0
    v_mfma_f32_16x16x32_bf16 v[44:47], v[60:63], v[100:103], v[44:47]
    v_add_u32 v9, 129024, v9
    ds_read_b64_tr_b16 v[94:95], v9 offset:0
    s_waitcnt vmcnt(8) lgkmcnt(8)
    v_mfma_f32_16x16x32_bf16 v[16:19], v[64:67], v[104:107], v[16:19]
    buffer_load_dwordx4 v[96:99], v12, s[52:55], s43 offen offset:2048 sc1
    buffer_load_dwordx4 v[100:103], v15, s[52:55], s43 offen offset:2048 sc1
    v_mfma_f32_16x16x32_bf16 v[20:23], v[68:71], v[104:107], v[20:23]
    ds_read_b64_tr_b16 v[48:49], v2 offset:4096
    v_mfma_f32_16x16x32_bf16 v[24:27], v[72:75], v[104:107], v[24:27]
    ds_read_b64_tr_b16 v[50:51], v6 offset:4096
    v_mfma_f32_16x16x32_bf16 v[28:31], v[76:79], v[104:107], v[28:31]
    ds_read_b64_tr_b16 v[52:53], v3 offset:4096
    v_mfma_f32_16x16x32_bf16 v[32:35], v[64:67], v[108:111], v[32:35]
    ds_read_b64_tr_b16 v[54:55], v7 offset:4096
    ds_read_b64_tr_b16 v[56:57], v4 offset:4096
    v_mfma_f32_16x16x32_bf16 v[36:39], v[68:71], v[108:111], v[36:39]
    ds_read_b64_tr_b16 v[58:59], v8 offset:4096
    v_mfma_f32_16x16x32_bf16 v[40:43], v[72:75], v[108:111], v[40:43]
    ds_read_b64_tr_b16 v[60:61], v5 offset:4096
    v_mfma_f32_16x16x32_bf16 v[44:47], v[76:79], v[108:111], v[44:47]
    ds_read_b64_tr_b16 v[62:63], v9 offset:4096
    s_waitcnt vmcnt(8) lgkmcnt(8)
    v_mfma_f32_16x16x32_bf16 v[16:19], v[80:83], v[112:115], v[16:19]
    buffer_load_dwordx4 v[104:107], v12, s[52:55], s43 offen offset:3072 sc1
    buffer_load_dwordx4 v[108:111], v15, s[52:55], s43 offen offset:3072 sc1
    v_mfma_f32_16x16x32_bf16 v[20:23], v[84:87], v[112:115], v[20:23]
    ds_read_b64_tr_b16 v[64:65], v2 offset:8192
    v_mfma_f32_16x16x32_bf16 v[24:27], v[88:91], v[112:115], v[24:27]
    ds_read_b64_tr_b16 v[66:67], v6 offset:8192
    v_mfma_f32_16x16x32_bf16 v[28:31], v[92:95], v[112:115], v[28:31]
    ds_read_b64_tr_b16 v[68:69], v3 offset:8192
    v_mfma_f32_16x16x32_bf16 v[32:35], v[80:83], v[116:119], v[32:35]
    ds_read_b64_tr_b16 v[70:71], v7 offset:8192
    ds_read_b64_tr_b16 v[72:73], v4 offset:8192
    v_mfma_f32_16x16x32_bf16 v[36:39], v[84:87], v[116:119], v[36:39]
    ds_read_b64_tr_b16 v[74:75], v8 offset:8192
    v_mfma_f32_16x16x32_bf16 v[40:43], v[88:91], v[116:119], v[40:43]
    ds_read_b64_tr_b16 v[76:77], v5 offset:8192
    v_mfma_f32_16x16x32_bf16 v[44:47], v[92:95], v[116:119], v[44:47]
    ds_read_b64_tr_b16 v[78:79], v9 offset:8192
    s_waitcnt vmcnt(8) lgkmcnt(8)
    v_mfma_f32_16x16x32_bf16 v[16:19], v[48:51], v[120:123], v[16:19]
    ds_read_b64_tr_b16 v[80:81], v2 offset:12288
    v_mfma_f32_16x16x32_bf16 v[20:23], v[52:55], v[120:123], v[20:23]
    ds_read_b64_tr_b16 v[82:83], v6 offset:12288
    v_mfma_f32_16x16x32_bf16 v[24:27], v[56:59], v[120:123], v[24:27]
    ds_read_b64_tr_b16 v[84:85], v3 offset:12288
    v_mfma_f32_16x16x32_bf16 v[28:31], v[60:63], v[120:123], v[28:31]
    ds_read_b64_tr_b16 v[86:87], v7 offset:12288
    v_mfma_f32_16x16x32_bf16 v[32:35], v[48:51], v[124:127], v[32:35]
    ds_read_b64_tr_b16 v[88:89], v4 offset:12288
    v_mfma_f32_16x16x32_bf16 v[36:39], v[52:55], v[124:127], v[36:39]
    ds_read_b64_tr_b16 v[90:91], v8 offset:12288
    v_mfma_f32_16x16x32_bf16 v[40:43], v[56:59], v[124:127], v[40:43]
    ds_read_b64_tr_b16 v[92:93], v5 offset:12288
    v_mfma_f32_16x16x32_bf16 v[44:47], v[60:63], v[124:127], v[44:47]
    ds_read_b64_tr_b16 v[94:95], v9 offset:12288
    s_waitcnt vmcnt(6) lgkmcnt(8)
    v_mfma_f32_16x16x32_bf16 v[16:19], v[64:67], v[128:131], v[16:19]
    ds_read_b64_tr_b16 v[48:49], v2 offset:16384
    v_mfma_f32_16x16x32_bf16 v[20:23], v[68:71], v[128:131], v[20:23]
    ds_read_b64_tr_b16 v[50:51], v6 offset:16384
    v_mfma_f32_16x16x32_bf16 v[24:27], v[72:75], v[128:131], v[24:27]
    ds_read_b64_tr_b16 v[52:53], v3 offset:16384
    v_mfma_f32_16x16x32_bf16 v[28:31], v[76:79], v[128:131], v[28:31]
    ds_read_b64_tr_b16 v[54:55], v7 offset:16384
    v_mfma_f32_16x16x32_bf16 v[32:35], v[64:67], v[132:135], v[32:35]
    ds_read_b64_tr_b16 v[56:57], v4 offset:16384
    v_mfma_f32_16x16x32_bf16 v[36:39], v[68:71], v[132:135], v[36:39]
    ds_read_b64_tr_b16 v[58:59], v8 offset:16384
    v_mfma_f32_16x16x32_bf16 v[40:43], v[72:75], v[132:135], v[40:43]
    ds_read_b64_tr_b16 v[60:61], v5 offset:16384
    v_mfma_f32_16x16x32_bf16 v[44:47], v[76:79], v[132:135], v[44:47]
    ds_read_b64_tr_b16 v[62:63], v9 offset:16384
    s_waitcnt vmcnt(4) lgkmcnt(8)
    v_mfma_f32_16x16x32_bf16 v[16:19], v[80:83], v[136:139], v[16:19]
    ds_read_b64_tr_b16 v[64:65], v2 offset:20480
    v_mfma_f32_16x16x32_bf16 v[20:23], v[84:87], v[136:139], v[20:23]
    ds_read_b64_tr_b16 v[66:67], v6 offset:20480
    v_mfma_f32_16x16x32_bf16 v[24:27], v[88:91], v[136:139], v[24:27]
    ds_read_b64_tr_b16 v[68:69], v3 offset:20480
    v_mfma_f32_16x16x32_bf16 v[28:31], v[92:95], v[136:139], v[28:31]
    ds_read_b64_tr_b16 v[70:71], v7 offset:20480
    v_mfma_f32_16x16x32_bf16 v[32:35], v[80:83], v[140:143], v[32:35]
    ds_read_b64_tr_b16 v[72:73], v4 offset:20480
    v_mfma_f32_16x16x32_bf16 v[36:39], v[84:87], v[140:143], v[36:39]
    ds_read_b64_tr_b16 v[74:75], v8 offset:20480
    v_mfma_f32_16x16x32_bf16 v[40:43], v[88:91], v[140:143], v[40:43]
    ds_read_b64_tr_b16 v[76:77], v5 offset:20480
    v_mfma_f32_16x16x32_bf16 v[44:47], v[92:95], v[140:143], v[44:47]
    ds_read_b64_tr_b16 v[78:79], v9 offset:20480
    s_waitcnt vmcnt(2) lgkmcnt(8)
    v_mfma_f32_16x16x32_bf16 v[16:19], v[48:51], v[96:99], v[16:19]
    ds_read_b32 v223, v10 offset:28
    v_mfma_f32_16x16x32_bf16 v[20:23], v[52:55], v[96:99], v[20:23]
    v_mfma_f32_16x16x32_bf16 v[24:27], v[56:59], v[96:99], v[24:27]
    v_mfma_f32_16x16x32_bf16 v[28:31], v[60:63], v[96:99], v[28:31]
    v_mfma_f32_16x16x32_bf16 v[32:35], v[48:51], v[100:103], v[32:35]
    v_mfma_f32_16x16x32_bf16 v[36:39], v[52:55], v[100:103], v[36:39]
    v_mfma_f32_16x16x32_bf16 v[40:43], v[56:59], v[100:103], v[40:43]
    v_mfma_f32_16x16x32_bf16 v[44:47], v[60:63], v[100:103], v[44:47]
    s_waitcnt vmcnt(0) lgkmcnt(1)
    v_mfma_f32_16x16x32_bf16 v[16:19], v[64:67], v[104:107], v[16:19]
    v_mfma_f32_16x16x32_bf16 v[20:23], v[68:71], v[104:107], v[20:23]
    v_mfma_f32_16x16x32_bf16 v[24:27], v[72:75], v[104:107], v[24:27]
    v_mfma_f32_16x16x32_bf16 v[28:31], v[76:79], v[104:107], v[28:31]
    v_mfma_f32_16x16x32_bf16 v[32:35], v[64:67], v[108:111], v[32:35]
    v_mfma_f32_16x16x32_bf16 v[36:39], v[68:71], v[108:111], v[36:39]
    v_mfma_f32_16x16x32_bf16 v[40:43], v[72:75], v[108:111], v[40:43]
    v_mfma_f32_16x16x32_bf16 v[44:47], v[76:79], v[108:111], v[44:47]
    s_waitcnt lgkmcnt(0)
    v_cmp_gt_u32 vcc, 4, v223
    s_cbranch_vccnz LB_w7
LB_g7:
    v_cvt_pk_bf16_f32 v176, v16, v17
    v_cvt_pk_bf16_f32 v177, v18, v19
    v_cvt_pk_bf16_f32 v178, v20, v21
    v_cvt_pk_bf16_f32 v179, v22, v23
    s_nop 0
    v_permlane16_swap_b32 v176, v178
    v_permlane16_swap_b32 v177, v179
    ds_write_b128 v248, v[176:179] offset:0
    v_cvt_pk_bf16_f32 v180, v24, v25
    v_cvt_pk_bf16_f32 v181, v26, v27
    v_cvt_pk_bf16_f32 v182, v28, v29
    v_cvt_pk_bf16_f32 v183, v30, v31
    s_nop 0
    v_permlane16_swap_b32 v180, v182
    v_permlane16_swap_b32 v181, v183
    ds_write_b128 v249, v[180:183] offset:0
    ds_read_b128 v[192:195], v250 offset:0
    ds_read_b128 v[196:199], v250 offset:1024
    v_cvt_pk_bf16_f32 v184, v32, v33
    v_cvt_pk_bf16_f32 v185, v34, v35
    v_cvt_pk_bf16_f32 v186, v36, v37
    v_cvt_pk_bf16_f32 v187, v38, v39
    s_nop 0
    v_permlane16_swap_b32 v184, v186
    v_permlane16_swap_b32 v185, v187
    ds_write_b128 v248, v[184:187] offset:2048
    v_cvt_pk_bf16_f32 v188, v40, v41
    v_cvt_pk_bf16_f32 v189, v42, v43
    v_cvt_pk_bf16_f32 v190, v44, v45
    v_cvt_pk_bf16_f32 v191, v46, v47
    s_nop 0
    v_permlane16_swap_b32 v188, v190
    v_permlane16_swap_b32 v189, v191
    ds_write_b128 v249, v[188:191] offset:2048
    ds_read_b128 v[200:203], v250 offset:2048
    ds_read_b128 v[204:207], v250 offset:3072
    s_mov_b32 s95, 0
    s_waitcnt lgkmcnt(5)
    buffer_store_dwordx4 v[192:195], v246, s[60:63], s95 offen nt
    s_mov_b32 s95, 32768
    s_waitcnt lgkmcnt(4)
    buffer_store_dwordx4 v[196:199], v246, s[60:63], s95 offen nt
    s_mov_b32 s95, 65536
    s_waitcnt lgkmcnt(1)
    buffer_store_dwordx4 v[200:203], v246, s[60:63], s95 offen nt
    s_mov_b32 s95, 98304
    s_waitcnt lgkmcnt(0)
    buffer_store_dwordx4 v[204:207], v246, s[60:63], s95 offen nt
    s_endpgm
LA_slow:
    s_mov_b32 s79, 0
LA_slow1:
    s_mov_b64 exec, vcc
    s_sleep 8
    buffer_load_dword v136, v33, s[68:71], 0 offen sc1
    buffer_load_dword v137, v34, s[52:55], 0 offen sc1
    s_add_u32 s79, s79, 1
    s_cmp_gt_u32 s79, 200000
    s_waitcnt vmcnt(0)
    s_cbranch_scc1 LA_back
    v_cmp_ne_u32 vcc, v136, v137
    v_cmp_gt_u32 s[80:81], s96, v136
    s_nop 0
    s_or_b64 vcc, vcc, s[80:81]
    s_cbranch_vccnz LA_slow1
    s_branch LA_back
LB_slow:
    s_mov_b32 s79, 0
LB_pt:
    buffer_load_dword v222, v220, s[68:71], s98 offen sc1
    s_add_u32 s79, s79, 1
    s_cmp_gt_u32 s79, 200000
    s_cbranch_scc1 LB_pt_x
    s_waitcnt vmcnt(0)
    v_cmp_gt_u32 vcc, 4096, v222
    s_cbranch_vccz LB_pt_x
    s_mov_b64 exec, vcc
    s_sleep 8
    s_branch LB_pt
LB_pt_x:
    s_waitcnt vmcnt(0)
    s_branch LB_back
LB_w15:
    s_branch LB_s6_in
LB_s6:
    s_sleep 1
LB_s6_in:
    ds_read_b32 v223, v10 offset:24
    s_waitcnt lgkmcnt(0)
    v_readfirstlane_b32 s78, v223
    s_nop 0
    s_cmp_ge_u32 s78, 4
    s_cbranch_scc0 LB_s6
    s_branch LB_g15
LB_w8:
    s_branch LB_s8_in
LB_s8:
    s_sleep 1
LB_s8_in:
    ds_read_b32 v223, v10 offset:32
    s_waitcnt lgkmcnt(0)
    v_readfirstlane_b32 s78, v223
    s_nop 0
    s_cmp_ge_u32 s78, 4
    s_cbranch_scc0 LB_s8
    s_branch LB_g8
LB_w7:
    s_branch LB_s7_in
LB_s7:
    s_sleep 1
LB_s7_in:
    ds_read_b32 v223, v10 offset:28
    s_waitcnt lgkmcnt(0)
    v_readfirstlane_b32 s78, v223
    s_nop 0
    s_cmp_ge_u32 s78, 4
    s_cbranch_scc0 LB_s7
    s_branch LB_g7
L_end:
    s_endpgm
.section .rodata,"a"
.p2align 6
.amdhsa_kernel concat_heads__ssm_conv_h3__sliding_local_dilated__prompt_kernel
  .amdhsa_next_free_vgpr 256
  .amdhsa_next_free_sgpr 102
  .amdhsa_accum_offset 256
  .amdhsa_group_segment_fixed_size 0
  .amdhsa_kernarg_size 96
  .amdhsa_user_sgpr_count 2
  .amdhsa_user_sgpr_kernarg_segment_ptr 1
  .amdhsa_system_sgpr_workgroup_id_x 1
.end_amdhsa_kernel
```

```asm
; @launch grid=(256,1,1) block=(512,1,1) lds=163840
.amdgcn_target "amdgcn-amd-amdhsa--gfx950"
.text
.globl concat_heads__ssm_conv_h3__sliding_local_dilated__prompt_kernel
.p2align 8
.type concat_heads__ssm_conv_h3__sliding_local_dilated__prompt_kernel,@function
concat_heads__ssm_conv_h3__sliding_local_dilated__prompt_kernel:
    s_cmp_ge_u32 s2, 256
    s_cbranch_scc1 L_end
    s_load_dwordx4 s[16:19], s[0:1], 48
    s_load_dwordx8 s[4:11], s[0:1], 0
    s_load_dwordx4 s[12:15], s[0:1], 32
    s_load_dwordx8 s[20:27], s[0:1], 64
    v_lshrrev_b32 v1, 6, v0
    v_and_b32 v0, 63, v0
    v_readfirstlane_b32 s3, v1
    s_nop 0
    s_cmp_lg_u32 s3, 4
    s_cbranch_scc1 L_nopf
    s_getpc_b64 s[80:81]
L_pc:
    s_bfe_u32 s78, s2, 0x40003
    v_lshl_add_u32 v1, v0, 4, s78
    v_lshlrev_b32 v1, 7, v1
    v_cmp_gt_u32 vcc, L_end-L_pc, v1
    s_nop 0
    s_and_saveexec_b64 s[82:83], vcc
    global_load_dword v222, v1, s[80:81]
    s_mov_b64 exec, -1
L_nopf:
    s_and_b32 s78, s2, 7
    s_lshr_b32 s79, s2, 3
    s_lshl_b32 s78, s78, 2
    s_lshr_b32 s78, 0x76325410, s78
    s_and_b32 s78, s78, 7
    s_and_b32 s80, s78, 1
    s_lshl_b32 s80, s80, 3
    s_lshr_b32 s81, s78, 1
    s_lshl_b32 s81, s81, 2
    s_and_b32 s72, s79, 7
    s_add_u32 s72, s72, s80
    s_lshr_b32 s73, s79, 3
    s_xor_b32 s73, s73, 3
    s_add_u32 s73, s73, s81
    s_and_b32 s76, s79, 3
    s_add_u32 s76, s76, s81
    s_lshr_b32 s77, s79, 2
    s_add_u32 s77, s77, s80
    s_lshr_b32 s74, s79, 4
    s_xor_b32 s78, s78, 0
    s_lshl_b32 s78, s78, 1
    s_add_u32 s74, s74, s78
    s_and_b32 s75, s79, 15
    s_cmp_ge_u32 s3, 4
    s_cbranch_scc1 L_B
    v_lshrrev_b32 v5, 3, v0
    v_and_b32 v6, 7, v0
    v_lshrrev_b32 v7, 4, v0
    s_lshl_b32 s79, s72, 7
    s_lshl_b32 s80, s3, 5
    s_add_u32 s81, s79, s80
    v_xor_b32 v8, v7, v6
    v_lshlrev_b32 v8, 4, v8
    v_add_u32 v240, s81, v5
    v_lshl_add_u32 v240, v240, 11, v8
    v_xor_b32 v241, 64, v240
    v_add_u32 v241, 15360, v241
    v_add_u32 v242, 30720, v240
    v_add_u32 v243, 30720, v241
    s_and_b32 s78, s3, 1
    s_lshl_b32 s78, s78, 2
    s_lshl_b32 s80, s3, 3
    v_and_b32 v8, 1, v7
    v_lshl_or_b32 v8, v8, 1, s78
    v_xor_b32 v8, v8, v6
    v_lshlrev_b32 v8, 4, v8
    v_add_u32 v244, s80, v5
    v_mul_u32_u24 v244, 6144, v244
    s_lshl_b32 s82, s73, 7
    v_add3_u32 v244, v244, v8, s82
    v_add_u32 v245, 1024, v244
    v_add_u32 v246, 2048, v244
    s_lshl_b32 s78, s3, 1
    s_lshl_b32 s80, s3, 2
    s_add_u32 s79, s79, s80
    s_sub_u32 s79, s79, 16
    v_add_u32 v8, s78, v7
    v_xor_b32 v8, v8, v6
    v_and_b32 v8, 7, v8
    v_lshlrev_b32 v8, 4, v8
    v_add_u32 v3, s79, v5
    v_lshl_add_u32 v3, v3, 11, v8
    s_lshl_b32 s86, s3, 10
    s_lshl_b32 s87, s3, 12
    s_add_u32 s87, s87, 75776
    s_lshl_b32 s88, s3, 9
    s_add_u32 s88, s88, 73728
    s_and_b32 s98, s73, 0
    s_and_b32 s78, s72, 8
    s_add_u32 s98, s98, s78
    s_add_u32 s101, s72, s73
    s_and_b32 s101, s101, 3
    s_mov_b32 s82, 0x65832401
    s_mov_b32 s83, 0xfedba9c7
    s_cmp_eq_u32 s101, 1
    s_cselect_b32 s82, 0x69432510, s82
    s_cselect_b32 s83, 0xfecbad87, s83
    s_cmp_eq_u32 s101, 2
    s_cselect_b32 s82, 0xa5436201, s82
    s_cselect_b32 s83, 0xfdcbe987, s83
    s_cmp_eq_u32 s101, 3
    s_cselect_b32 s82, 0x65472310, s82
    s_cselect_b32 s83, 0xedcfa98b, s83
    s_bfe_u32 s62, s72, 0x10002
    s_mul_i32 s78, s62, 12288
    s_mul_i32 s79, s3, 3072
    s_add_u32 s60, s79, s78
    s_sub_u32 s61, s79, s78
    s_mul_i32 s62, s62, 196608
    s_sub_u32 s63, 196608, s62
    s_mov_b32 s30, 0x400000
    s_mov_b32 s31, 0x20000
    s_mov_b32 s34, 0x600000
    s_mov_b32 s35, 0x20000
    s_waitcnt lgkmcnt(0)
    s_mov_b64 s[28:29], s[16:17]
    s_mov_b64 s[32:33], s[18:19]
    s_mov_b64 s[0:1], s[82:83]
    s_add_u32 s97, s98, s0
    s_lshr_b64 s[0:1], s[0:1], 4
    s_and_b32 s97, s97, 15
    s_lshr_b32 s99, s97, 3
    s_xor_b32 s97, s97, s99
    s_add_u32 m0, s87, 0
    s_lshl_b32 s97, s97, 7
    buffer_load_dwordx4 v240, s[28:31], s97 offen offset:0  lds
    buffer_load_dwordx4 v241, s[28:31], s97 offen offset:1024  lds
    buffer_load_dwordx4 v242, s[28:31], s97 offen offset:2048  lds
    buffer_load_dwordx4 v243, s[28:31], s97 offen offset:3072  lds
    s_add_u32 m0, s88, 0
    s_mov_b64 exec, 0xffffffff
    buffer_load_dwordx4 v3, s[28:31], s97 offen offset:0  lds
    s_mov_b64 exec, -1
    s_mul_i32 s16, s97, 3072
    s_add_u32 m0, s60, 0
    s_add_u32 s99, s16, s62
    buffer_load_dwordx4 v244, s[32:35], s99 offen offset:0  lds
    buffer_load_dwordx4 v245, s[32:35], s99 offen offset:1024  lds
    buffer_load_dwordx4 v246, s[32:35], s99 offen offset:2048  lds
    s_add_u32 m0, s61, 12288
    s_add_u32 s16, s16, s63
    buffer_load_dwordx4 v244, s[32:35], s16 offen offset:0  lds
    buffer_load_dwordx4 v245, s[32:35], s16 offen offset:1024  lds
    buffer_load_dwordx4 v246, s[32:35], s16 offen offset:2048  lds
    s_add_u32 s97, s98, s0
    s_lshr_b64 s[0:1], s[0:1], 4
    s_and_b32 s97, s97, 15
    s_lshr_b32 s99, s97, 3
    s_xor_b32 s97, s97, s99
    s_add_u32 m0, s87, 18432
    s_lshl_b32 s97, s97, 7
    buffer_load_dwordx4 v240, s[28:31], s97 offen offset:0  lds
    s_mov_b32 s36, s6
    s_mov_b32 s37, s7
    s_mov_b32 s38, 0x400000
    s_mov_b32 s39, 0x20000
    s_mov_b32 s40, s8
    s_mov_b32 s41, s9
    s_mov_b32 s42, 0x400000
    s_mov_b32 s43, 0x20000
    s_mov_b32 s44, s10
    s_mov_b32 s45, s11
    s_mov_b32 s46, 0x2000
    s_mov_b32 s47, 0x20000
    s_mov_b32 s52, s26
    s_mov_b32 s53, s27
    s_mov_b32 s54, 0x1000000
    s_mov_b32 s55, 0x20000
    v_lshlrev_b32 v15, 4, v0
    v_and_b32 v7, 7, v0
    s_lshl_b32 s79, s74, 7
    v_lshl_add_u32 v7, v7, 4, s79
    s_lshl_b32 s78, s75, 7
    s_lshl_b32 s80, s3, 3
    s_add_u32 s80, s80, s78
    v_lshrrev_b32 v5, 3, v0
    s_and_b32 s79, s3, 1
    v_xor_b32 v5, s79, v5
    v_add_u32 v5, s80, v5
    v_lshl_add_u32 v10, v5, 11, v7
    s_xor_b32 s80, s3, 1
    s_add_u32 s80, s78, s80
    s_sub_u32 s80, s80, 4
    s_lshl_b32 s80, s80, 11
    v_add_u32 v11, s80, v7
    v_bfe_u32 v5, v0, 3, 2
    v_lshrrev_b32 v6, 5, v0
    s_lshl_b32 s80, s3, 5
    v_lshlrev_b32 v8, 3, v5
    v_lshl_add_u32 v8, v6, 2, v8
    v_add_u32 v8, s80, v8
    v_and_b32 v35, 7, v0
    v_lshlrev_b32 v16, 4, v35
    v_lshl_add_u32 v16, v8, 7, v16
    v_add_u32 v232, 129024, v16
    v_and_b32 v231, 1, v5
    v_lshl_add_u32 v16, v231, 7, v232
    v_xor_b32 v233, v231, v6
    v_xor_b32 v233, 1, v233
    v_lshl_add_u32 v232, v233, 7, v232
    v_xor_b32 v231, 128, v16
    v_xor_b32 v233, 128, v232
    v_lshrrev_b32 v33, 2, v35
    v_lshlrev_b32 v35, 6, v35
    v_lshl_add_u32 v35, v33, 4, v35
    v_add_u32 v35, 162816, v35
    v_add_u32 v8, s78, v8
    v_lshl_add_u32 v9, v8, 11, v7
    v_lshl_add_u32 v13, v8, 12, v7
    v_bfe_u32 v8, v0, 2, 1
    v_lshlrev_b32 v8, 1, v8
    v_add_u32 v8, v8, v6
    v_lshlrev_b32 v8, 16, v8
    v_lshl_add_u32 v8, v5, 6, v8
    v_and_b32 v7, 3, v0
    v_lshl_add_u32 v8, v7, 4, v8
    s_add_u32 s78, s78, s80
    s_lshl_b32 s78, s78, 3
    s_lshl_b32 s79, s74, 18
    s_add_u32 s78, s78, s79
    v_add_u32 v12, s78, v8
    s_mov_b32 s48, s12
    s_mov_b32 s49, s13
    s_mov_b32 s50, 0x400000
    s_mov_b32 s51, 0x20000
    s_mov_b32 s56, s4
    s_mov_b32 s57, s5
    s_mov_b32 s58, 0x400000
    s_mov_b32 s59, 0x20000
    s_mov_b32 s64, s20
    s_mov_b32 s65, s21
    s_mov_b32 s66, 0x200000
    s_mov_b32 s67, 0x20000
    s_lshl_b32 s91, s74, 4
    s_add_u32 s91, s91, s75
    s_lshr_b32 s78, s91, 3
    s_lshl_b32 s78, s78, 5
    s_and_b32 s79, s91, 7
    s_add_u32 s78, s78, s79
    s_lshl_b32 s79, s3, 3
    s_add_u32 s90, s78, s79
    s_lshl_b32 s91, s91, 14
    s_mov_b32 s96, 4096
    s_mul_i32 s94, s3, 8320
    s_add_u32 s94, s94, 129024
    s_lshl_b32 s78, s90, 12
    v_lshl_add_u32 v228, v0, 7, s78
    s_lshr_b32 s78, s2, 3
    s_lshl_b32 s78, s78, 2
    s_add_u32 s78, s78, s3
    s_lshl_b32 s78, s78, 14
    s_and_b32 s79, s77, 8
    s_lshl_b32 s79, s79, 7
    s_add_u32 s78, s78, s79
    v_and_b32 v5, 7, v0
    v_lshlrev_b32 v5, 7, v5
    v_lshrrev_b32 v8, 3, v0
    v_lshl_add_u32 v5, v8, 11, v5
    v_add_u32 v229, s78, v5
    s_and_b32 s78, s73, 7
    s_cmp_eq_u32 s78, 3
    s_cselect_b32 s78, 0x40000000, 0
    v_or_b32 v229, s78, v229
    s_mov_b32 s68, s24
    s_mov_b32 s69, s25
    s_mov_b32 s70, 0x100
    s_mov_b32 s71, 0x20000
    v_lshrrev_b32 v6, 5, v0
    v_and_b32 v7, 3, v0
    s_lshr_b32 s78, s90, 1
    s_lshl_b32 s78, s78, 2
    s_load_dword s92, s[14:15], s78
    v_bfe_u32 v5, v0, 2, 2
    v_lshlrev_b32 v5, 1, v5
    v_lshl_add_u32 v5, v6, 3, v5
    v_bfe_u32 v8, v0, 4, 1
    v_add_u32 v5, v5, v8
    s_and_b32 s78, s3, 1
    s_lshl_b32 s78, s78, 1
    v_add_u32 v8, s78, v6
    v_xor_b32 v8, v8, v7
    v_lshlrev_b32 v8, 4, v8
    v_lshl_add_u32 v5, v5, 6, v8
    v_add_u32 v14, s86, v5
    v_mov_b32 v18, 162304
    v_mov_b32 v19, 1
    v_and_b32 v5, 3, v0
    s_lshl_b32 s78, s74, 4
    s_add_u32 s78, s78, s3
    v_lshl_add_u32 v6, v5, 2, s78
    s_lshr_b32 s78, s76, 3
    s_lshl_b32 s79, s3, 1
    s_add_u32 s78, s78, s79
    s_xor_b32 s78, s78, 0
    s_lshl_b32 s78, s78, 5
    s_and_b32 s79, s76, 7
    s_add_u32 s78, s78, s79
    v_lshl_add_u32 v7, v5, 3, s78
    v_and_b32 v8, 4, v0
    v_cmp_eq_u32 vcc, 0, v8
    s_nop 1
    v_cndmask_b32 v6, v7, v6, vcc
    v_and_b32 v33, 0xf0, v6
    v_lshlrev_b32 v34, 8, v6
    v_add_u32 v34, 12582912, v34
    v_and_b32 v5, 15, v0
    v_lshrrev_b32 v6, 4, v0
    v_add_u32 v7, 9, v5
    v_and_b32 v8, 1, v7
    v_mul_u32_u24 v8, 4160, v8
    v_lshrrev_b32 v7, 1, v7
    v_lshl_add_u32 v8, v7, 2, v8
    v_lshlrev_b32 v7, 4, v6
    v_sub_u32 v8, v8, v7
    s_add_u32 s78, s94, 32
    v_add_u32 v21, s78, v8
    v_add_u32 v22, 1024, v21
    v_add_u32 v23, 2048, v21
    v_add_u32 v24, 3072, v21
    v_lshl_add_u32 v7, v5, 1, v6
    v_add_u32 v7, 30, v7
    v_and_b32 v8, 1, v7
    v_bfe_u32 v136, v7, 1, 2
    v_lshl_add_u32 v136, v8, 2, v136
    v_lshlrev_b32 v136, 6, v136
    v_lshrrev_b32 v7, 3, v7
    v_lshl_add_u32 v136, v7, 9, v136
    v_bitop3_b32 v8, v7, 3, s3 bitop3:0x6a
    v_lshl_add_u32 v25, v8, 4, v136
    v_add_u32 v25, 92160, v25
    v_subrev_u32 v7, 1, v7
    v_bitop3_b32 v8, v7, 3, s3 bitop3:0x6a
    v_lshl_add_u32 v27, v8, 4, v136
    v_add_u32 v27, 91648, v27
    v_subrev_u32 v7, 1, v7
    v_bitop3_b32 v8, v7, 3, s3 bitop3:0x6a
    v_lshl_add_u32 v29, v8, 4, v136
    v_add_u32 v29, 91136, v29
    v_subrev_u32 v7, 1, v7
    v_bitop3_b32 v8, v7, 3, s3 bitop3:0x6a
    v_lshl_add_u32 v31, v8, 4, v136
    v_add_u32 v31, 90624, v31
    v_lshl_add_u32 v7, v5, 1, v6
    v_add_u32 v7, 26, v7
    v_and_b32 v8, 1, v7
    v_bfe_u32 v136, v7, 1, 2
    v_lshl_add_u32 v136, v8, 2, v136
    v_lshlrev_b32 v136, 6, v136
    v_lshrrev_b32 v7, 3, v7
    v_lshl_add_u32 v136, v7, 9, v136
    v_bitop3_b32 v8, v7, 3, s3 bitop3:0x6a
    v_lshl_add_u32 v26, v8, 4, v136
    v_add_u32 v26, 92160, v26
    v_subrev_u32 v7, 1, v7
    v_bitop3_b32 v8, v7, 3, s3 bitop3:0x6a
    v_lshl_add_u32 v28, v8, 4, v136
    v_add_u32 v28, 91648, v28
    v_subrev_u32 v7, 1, v7
    v_bitop3_b32 v8, v7, 3, s3 bitop3:0x6a
    v_lshl_add_u32 v30, v8, 4, v136
    v_add_u32 v30, 91136, v30
    v_subrev_u32 v7, 1, v7
    v_bitop3_b32 v8, v7, 3, s3 bitop3:0x6a
    v_lshl_add_u32 v32, v8, 4, v136
    v_add_u32 v32, 90624, v32
    v_lshrrev_b32 v7, 1, v6
    v_lshl_add_u32 v7, v5, 1, v7
    v_add_u32 v7, 32, v7
    v_and_b32 v8, 1, v7
    v_bfe_u32 v136, v7, 1, 2
    v_lshl_add_u32 v136, v8, 2, v136
    v_lshlrev_b32 v136, 6, v136
    v_lshrrev_b32 v7, 3, v7
    v_lshl_add_u32 v136, v7, 9, v136
    v_bitop3_b32 v8, v7, 3, s3 bitop3:0x6a
    v_lshl_add_u32 v20, v8, 4, v136
    v_add_u32 v20, 92160, v20
    v_and_b32 v8, 1, v6
    v_xor_b32 v8, 1, v8
    v_lshl_add_u32 v20, v8, 3, v20
    s_waitcnt lgkmcnt(0)
    s_and_b32 s78, s92, 0xffff0000
    s_lshl_b32 s92, s92, 16
    s_bitcmp1_b32 s90, 0
    s_cselect_b32 s92, s78, s92
    v_lshlrev_b32 v7, 3, v6
    v_sub_u32 v7, v7, v5
    v_subrev_u32 v7, 9, v7
    v_and_b32 v8, 1, v7
    v_xor_b32 v8, 1, v8
    v_lshlrev_b32 v8, 4, v8
    v_lshrrev_b32 v8, v8, s92
    v_ashrrev_i32 v7, 1, v7
    v_cmp_eq_u32 vcc, 0, v7
    s_nop 1
    v_cndmask_b32 v236, 0, v8, vcc
    v_cmp_eq_u32 vcc, 1, v7
    s_nop 1
    v_cndmask_b32 v237, 0, v8, vcc
    v_cmp_eq_u32 vcc, 2, v7
    s_nop 1
    v_cndmask_b32 v238, 0, v8, vcc
    v_cmp_eq_u32 vcc, 3, v7
    s_nop 1
    v_cndmask_b32 v239, 0, v8, vcc
    buffer_load_dwordx4 v241, s[28:31], s97 offen offset:1024  lds
    buffer_load_dwordx4 v242, s[28:31], s97 offen offset:2048  lds
    buffer_load_dwordx4 v243, s[28:31], s97 offen offset:3072  lds
    s_add_u32 m0, s88, 18432
    s_mov_b64 exec, 0xffffffff
    buffer_load_dwordx4 v3, s[28:31], s97 offen offset:0  lds
    s_mov_b64 exec, -1
    s_mul_i32 s16, s97, 3072
    s_add_u32 m0, s60, 24576
    s_add_u32 s99, s16, s62
    buffer_load_dwordx4 v244, s[32:35], s99 offen offset:0  lds
    buffer_load_dwordx4 v245, s[32:35], s99 offen offset:1024  lds
    s_cmp_eq_u32 s101, 1
    s_cbranch_scc1 LA_c1
    s_cmp_eq_u32 s101, 2
    s_cbranch_scc1 LA_c2
    s_cmp_eq_u32 s101, 3
    s_cbranch_scc1 LA_c3
LA_c0:
    s_waitcnt vmcnt(7)
    s_barrier
    buffer_load_dwordx4 v246, s[32:35], s99 offen offset:2048  lds
    s_add_u32 m0, s61, 36864
    s_add_u32 s16, s16, s63
    buffer_load_dwordx4 v244, s[32:35], s16 offen offset:0  lds
    buffer_load_dwordx4 v245, s[32:35], s16 offen offset:1024  lds
    buffer_load_dwordx4 v246, s[32:35], s16 offen offset:2048  lds
    s_add_u32 s97, s98, s0
    s_lshr_b64 s[0:1], s[0:1], 4
    s_and_b32 s97, s97, 15
    s_lshr_b32 s99, s97, 3
    s_xor_b32 s97, s97, s99
    s_add_u32 m0, s87, 36864
    s_lshl_b32 s97, s97, 7
    buffer_load_dwordx4 v240, s[28:31], s97 offen offset:0  lds
    buffer_load_dwordx4 v241, s[28:31], s97 offen offset:1024  lds
    buffer_load_dwordx4 v242, s[28:31], s97 offen offset:2048  lds
    buffer_load_dwordx4 v243, s[28:31], s97 offen offset:3072  lds
    s_add_u32 m0, s88, 36864
    s_mov_b64 exec, 0xffffffff
    buffer_load_dwordx4 v3, s[28:31], s97 offen offset:0  lds
    s_mov_b64 exec, -1
    s_mul_i32 s16, s97, 3072
    s_add_u32 m0, s60, 49152
    s_add_u32 s99, s16, s62
    buffer_load_dwordx4 v244, s[32:35], s99 offen offset:0  lds
    buffer_load_dwordx4 v245, s[32:35], s99 offen offset:1024  lds
    buffer_load_dwordx4 v246, s[32:35], s99 offen offset:2048  lds
    s_add_u32 m0, s61, 61440
    s_add_u32 s16, s16, s63
    buffer_load_dwordx4 v244, s[32:35], s16 offen offset:0  lds
    buffer_load_dwordx4 v245, s[32:35], s16 offen offset:1024  lds
    buffer_load_dwordx4 v246, s[32:35], s16 offen offset:2048  lds
    s_waitcnt vmcnt(11)
    s_barrier
    s_add_u32 m0, s86, 129536
    s_mov_b32 s89, 0
    buffer_load_dwordx4 v10, s[36:39], s89 offen nt lds
    s_add_u32 m0, s86, 145920
    s_mov_b32 s89, 0
    buffer_load_dwordx4 v10, s[40:43], s89 offen nt lds
    s_add_u32 m0, s86, 133632
    s_mov_b32 s89, 65536
    buffer_load_dwordx4 v10, s[36:39], s89 offen nt lds
    s_add_u32 m0, s86, 150016
    s_mov_b32 s89, 65536
    buffer_load_dwordx4 v10, s[40:43], s89 offen nt lds
    s_add_u32 m0, s86, 137728
    s_mov_b32 s89, 131072
    buffer_load_dwordx4 v10, s[36:39], s89 offen nt lds
    s_add_u32 m0, s86, 154112
    s_mov_b32 s89, 131072
    buffer_load_dwordx4 v10, s[40:43], s89 offen nt lds
    s_add_u32 m0, s86, 141824
    s_mov_b32 s89, 196608
    buffer_load_dwordx4 v10, s[36:39], s89 offen nt lds
    s_add_u32 m0, s86, 158208
    s_mov_b32 s89, 196608
    buffer_load_dwordx4 v10, s[40:43], s89 offen nt lds
    s_mov_b64 exec, 0xff
    s_lshl_b32 s82, s3, 7
    s_add_u32 m0, s82, 129024
    s_mov_b32 s89, 0
    buffer_load_dwordx4 v11, s[36:39], s89 offen nt lds
    s_lshl_b32 s83, s74, 9
    s_add_u32 s83, s83, s82
    s_and_b32 s89, s3, 2
    s_lshl_b32 s89, s89, 3
    s_add_u32 s82, s82, s89
    s_add_u32 m0, s82, 162816
    s_add_u32 s89, s83, 0
    buffer_load_dwordx4 v15, s[44:47], s89 offen  lds
    s_mov_b64 exec, -1
    s_add_u32 s97, s98, s0
    s_lshr_b64 s[0:1], s[0:1], 4
    s_and_b32 s97, s97, 15
    s_lshr_b32 s99, s97, 3
    s_xor_b32 s97, s97, s99
    s_add_u32 m0, s87, 0
    s_lshl_b32 s97, s97, 7
    buffer_load_dwordx4 v240, s[28:31], s97 offen offset:0  lds
    buffer_load_dwordx4 v241, s[28:31], s97 offen offset:1024  lds
    buffer_load_dwordx4 v242, s[28:31], s97 offen offset:2048  lds
    buffer_load_dwordx4 v243, s[28:31], s97 offen offset:3072  lds
    s_add_u32 m0, s88, 0
    s_mov_b64 exec, 0xffffffff
    buffer_load_dwordx4 v3, s[28:31], s97 offen offset:0  lds
    s_mov_b64 exec, -1
    s_mul_i32 s16, s97, 3072
    s_add_u32 m0, s60, 0
    s_add_u32 s99, s16, s62
    buffer_load_dwordx4 v244, s[32:35], s99 offen offset:0  lds
    buffer_load_dwordx4 v245, s[32:35], s99 offen offset:1024  lds
    s_waitcnt vmcnt(17)
    s_barrier
    buffer_load_dwordx4 v246, s[32:35], s99 offen offset:2048  lds
    s_add_u32 m0, s61, 12288
    s_add_u32 s16, s16, s63
    buffer_load_dwordx4 v244, s[32:35], s16 offen offset:0  lds
    buffer_load_dwordx4 v245, s[32:35], s16 offen offset:1024  lds
    buffer_load_dwordx4 v246, s[32:35], s16 offen offset:2048  lds
    s_add_u32 s97, s98, s0
    s_lshr_b64 s[0:1], s[0:1], 4
    s_and_b32 s97, s97, 15
    s_lshr_b32 s99, s97, 3
    s_xor_b32 s97, s97, s99
    s_add_u32 m0, s87, 18432
    s_lshl_b32 s97, s97, 7
    buffer_load_dwordx4 v240, s[28:31], s97 offen offset:0  lds
    buffer_load_dwordx4 v241, s[28:31], s97 offen offset:1024  lds
    buffer_load_dwordx4 v242, s[28:31], s97 offen offset:2048  lds
    buffer_load_dwordx4 v243, s[28:31], s97 offen offset:3072  lds
    s_add_u32 m0, s88, 18432
    s_mov_b64 exec, 0xffffffff
    buffer_load_dwordx4 v3, s[28:31], s97 offen offset:0  lds
    s_mov_b64 exec, -1
    s_mul_i32 s16, s97, 3072
    s_add_u32 m0, s60, 24576
    s_add_u32 s99, s16, s62
    buffer_load_dwordx4 v244, s[32:35], s99 offen offset:0  lds
    buffer_load_dwordx4 v245, s[32:35], s99 offen offset:1024  lds
    buffer_load_dwordx4 v246, s[32:35], s99 offen offset:2048  lds
    s_add_u32 m0, s61, 36864
    s_add_u32 s16, s16, s63
    buffer_load_dwordx4 v244, s[32:35], s16 offen offset:0  lds
    buffer_load_dwordx4 v245, s[32:35], s16 offen offset:1024  lds
    buffer_load_dwordx4 v246, s[32:35], s16 offen offset:2048  lds
    s_waitcnt vmcnt(11)
    s_barrier
    s_add_u32 s97, s98, s0
    s_lshr_b64 s[0:1], s[0:1], 4
    s_and_b32 s97, s97, 15
    s_lshr_b32 s99, s97, 3
    s_xor_b32 s97, s97, s99
    s_add_u32 m0, s87, 36864
    s_lshl_b32 s97, s97, 7
    buffer_load_dwordx4 v240, s[28:31], s97 offen offset:0  lds
    ds_read_b128 v[84:87], v35 offset:0
    ds_read_b128 v[88:91], v35 offset:16
    buffer_load_dwordx4 v241, s[28:31], s97 offen offset:1024  lds
    ds_read_b128 v[92:95], v35 offset:32
    buffer_load_dwordx4 v242, s[28:31], s97 offen offset:2048  lds
    ds_read_b128 v[96:99], v35 offset:48
    ds_read_b128 v[40:43], v233 offset:0
    buffer_load_dwordx4 v243, s[28:31], s97 offen offset:3072  lds
    ds_read_b128 v[44:47], v232 offset:256
    s_add_u32 m0, s88, 36864
    s_mov_b64 exec, 0xffffffff
    buffer_load_dwordx4 v3, s[28:31], s97 offen offset:0  lds
    s_mov_b64 exec, -1
    ds_read_b128 v[48:51], v233 offset:256
    s_mul_i32 s16, s97, 3072
    s_add_u32 m0, s60, 49152
    s_add_u32 s99, s16, s62
    buffer_load_dwordx4 v244, s[32:35], s99 offen offset:0  lds
    ds_read_b128 v[52:55], v16 offset:512
    ds_read_b128 v[56:59], v231 offset:512
    buffer_load_dwordx4 v245, s[32:35], s99 offen offset:1024  lds
    ds_read_b128 v[60:63], v16 offset:768
    buffer_load_dwordx4 v246, s[32:35], s99 offen offset:2048  lds
    ds_read_b128 v[64:67], v231 offset:768
    s_add_u32 m0, s61, 61440
    s_add_u32 s16, s16, s63
    buffer_load_dwordx4 v244, s[32:35], s16 offen offset:0  lds
    ds_read_b128 v[68:71], v16 offset:16896
    ds_read_b128 v[72:75], v231 offset:16896
    buffer_load_dwordx4 v245, s[32:35], s16 offen offset:1024  lds
    ds_read_b128 v[76:79], v16 offset:17152
    buffer_load_dwordx4 v246, s[32:35], s16 offen offset:2048  lds
    ds_read_b128 v[80:83], v231 offset:17152
    s_waitcnt vmcnt(11)
    s_waitcnt lgkmcnt(0)
    s_barrier
    s_add_u32 s97, s98, s0
    s_lshr_b64 s[0:1], s[0:1], 4
    s_and_b32 s97, s97, 15
    s_lshr_b32 s99, s97, 3
    s_xor_b32 s97, s97, s99
    s_add_u32 m0, s87, 0
    s_lshl_b32 s97, s97, 7
    buffer_load_dwordx4 v240, s[28:31], s97 offen offset:0  lds
    v_lshlrev_b32 v116, 16, v40
    v_lshlrev_b32 v117, 16, v44
    v_lshlrev_b32 v118, 16, v48
    v_lshlrev_b32 v119, 16, v52
    v_lshlrev_b32 v120, 16, v56
    buffer_load_dwordx4 v241, s[28:31], s97 offen offset:1024  lds
    v_lshlrev_b32 v121, 16, v60
    v_lshlrev_b32 v122, 16, v64
    v_lshlrev_b32 v127, 16, v84
    v_and_b32 v128, 0xffff0000, v84
    v_lshlrev_b32 v129, 16, v85
    buffer_load_dwordx4 v242, s[28:31], s97 offen offset:2048  lds
    v_and_b32 v130, 0xffff0000, v85
    v_lshlrev_b32 v123, 16, v68
    v_lshlrev_b32 v124, 16, v72
    v_lshlrev_b32 v125, 16, v76
    v_lshlrev_b32 v126, 16, v80
    buffer_load_dwordx4 v243, s[28:31], s97 offen offset:3072  lds
    v_mul_f32 v131, v116, v130
    v_mul_f32 v132, v117, v130
    v_mul_f32 v133, v118, v130
    v_mul_f32 v134, v119, v130
    v_fmac_f32 v131, v117, v129
    s_add_u32 m0, s88, 0
    s_mov_b64 exec, 0xffffffff
    buffer_load_dwordx4 v3, s[28:31], s97 offen offset:0  lds
    s_mov_b64 exec, -1
    v_fmac_f32 v132, v118, v129
    v_fmac_f32 v133, v119, v129
    v_fmac_f32 v134, v120, v129
    v_fmac_f32 v131, v118, v128
    v_fmac_f32 v132, v119, v128
    s_mul_i32 s16, s97, 3072
    s_add_u32 m0, s60, 0
    s_add_u32 s99, s16, s62
    buffer_load_dwordx4 v244, s[32:35], s99 offen offset:0  lds
    v_fmac_f32 v133, v120, v128
    v_fmac_f32 v134, v121, v128
    v_fmac_f32 v131, v119, v127
    v_fmac_f32 v132, v120, v127
    v_fmac_f32 v133, v121, v127
    buffer_load_dwordx4 v245, s[32:35], s99 offen offset:1024  lds
    v_fmac_f32 v134, v122, v127
    v_mul_f32 v131, v131, v123
    v_mul_f32 v132, v132, v124
    v_mul_f32 v133, v133, v125
    v_mul_f32 v134, v134, v126
    buffer_load_dwordx4 v246, s[32:35], s99 offen offset:2048  lds
    v_cvt_pk_bf16_f32 v102, v134, v133
    v_cvt_pk_bf16_f32 v103, v132, v131
    v_lshlrev_b32 v116, 16, v42
    v_lshlrev_b32 v117, 16, v46
    v_lshlrev_b32 v118, 16, v50
    s_add_u32 m0, s61, 12288
    s_add_u32 s16, s16, s63
    buffer_load_dwordx4 v244, s[32:35], s16 offen offset:0  lds
    v_lshlrev_b32 v119, 16, v54
    v_lshlrev_b32 v120, 16, v58
    v_lshlrev_b32 v121, 16, v62
    v_lshlrev_b32 v122, 16, v66
    v_lshlrev_b32 v127, 16, v92
    buffer_load_dwordx4 v245, s[32:35], s16 offen offset:1024  lds
    v_and_b32 v128, 0xffff0000, v92
    v_lshlrev_b32 v129, 16, v93
    v_and_b32 v130, 0xffff0000, v93
    v_lshlrev_b32 v123, 16, v70
    v_lshlrev_b32 v124, 16, v74
    buffer_load_dwordx4 v246, s[32:35], s16 offen offset:2048  lds
    v_lshlrev_b32 v125, 16, v78
    v_lshlrev_b32 v126, 16, v82
    v_mul_f32 v131, v116, v130
    v_mul_f32 v132, v117, v130
    v_mul_f32 v133, v118, v130
    v_mul_f32 v134, v119, v130
    v_fmac_f32 v131, v117, v129
    v_fmac_f32 v132, v118, v129
    v_fmac_f32 v133, v119, v129
    v_fmac_f32 v134, v120, v129
    v_fmac_f32 v131, v118, v128
    v_fmac_f32 v132, v119, v128
    s_waitcnt vmcnt(11)
    s_barrier
    s_add_u32 s97, s98, s0
    s_lshr_b64 s[0:1], s[0:1], 4
    s_and_b32 s97, s97, 15
    s_lshr_b32 s99, s97, 3
    s_xor_b32 s97, s97, s99
    s_add_u32 m0, s87, 18432
    s_lshl_b32 s97, s97, 7
    buffer_load_dwordx4 v240, s[28:31], s97 offen offset:0  lds
    v_fmac_f32 v133, v120, v128
    v_fmac_f32 v134, v121, v128
    v_fmac_f32 v131, v119, v127
    v_fmac_f32 v132, v120, v127
    v_fmac_f32 v133, v121, v127
    buffer_load_dwordx4 v241, s[28:31], s97 offen offset:1024  lds
    v_fmac_f32 v134, v122, v127
    v_mul_f32 v131, v131, v123
    v_mul_f32 v132, v132, v124
    v_mul_f32 v133, v133, v125
    v_mul_f32 v134, v134, v126
    buffer_load_dwordx4 v242, s[28:31], s97 offen offset:2048  lds
    v_cvt_pk_bf16_f32 v100, v134, v133
    v_cvt_pk_bf16_f32 v101, v132, v131
    s_nop 0
    v_permlane32_swap_b32 v102, v100
    v_permlane32_swap_b32 v103, v101
    s_mov_b32 s89, 0
    buffer_store_dwordx4 v[100:103], v12, s[52:55], s89 offen sc1
    buffer_load_dwordx4 v243, s[28:31], s97 offen offset:3072  lds
    v_and_b32 v116, 0xffff0000, v40
    v_and_b32 v117, 0xffff0000, v44
    v_and_b32 v118, 0xffff0000, v48
    v_and_b32 v119, 0xffff0000, v52
    v_and_b32 v120, 0xffff0000, v56
    s_add_u32 m0, s88, 18432
    s_mov_b64 exec, 0xffffffff
    buffer_load_dwordx4 v3, s[28:31], s97 offen offset:0  lds
    s_mov_b64 exec, -1
    v_and_b32 v121, 0xffff0000, v60
    v_and_b32 v122, 0xffff0000, v64
    v_lshlrev_b32 v127, 16, v86
    v_and_b32 v128, 0xffff0000, v86
    v_lshlrev_b32 v129, 16, v87
    s_mul_i32 s16, s97, 3072
    s_add_u32 m0, s60, 24576
    s_add_u32 s99, s16, s62
    buffer_load_dwordx4 v244, s[32:35], s99 offen offset:0  lds
    v_and_b32 v130, 0xffff0000, v87
    v_and_b32 v123, 0xffff0000, v68
    v_and_b32 v124, 0xffff0000, v72
    v_and_b32 v125, 0xffff0000, v76
    v_and_b32 v126, 0xffff0000, v80
    buffer_load_dwordx4 v245, s[32:35], s99 offen offset:1024  lds
    v_mul_f32 v131, v116, v130
    v_mul_f32 v132, v117, v130
    v_mul_f32 v133, v118, v130
    v_mul_f32 v134, v119, v130
    v_fmac_f32 v131, v117, v129
    buffer_load_dwordx4 v246, s[32:35], s99 offen offset:2048  lds
    v_fmac_f32 v132, v118, v129
    v_fmac_f32 v133, v119, v129
    v_fmac_f32 v134, v120, v129
    v_fmac_f32 v131, v118, v128
    v_fmac_f32 v132, v119, v128
    s_add_u32 m0, s61, 36864
    s_add_u32 s16, s16, s63
    buffer_load_dwordx4 v244, s[32:35], s16 offen offset:0  lds
    v_fmac_f32 v133, v120, v128
    v_fmac_f32 v134, v121, v128
    v_fmac_f32 v131, v119, v127
    v_fmac_f32 v132, v120, v127
    v_fmac_f32 v133, v121, v127
    buffer_load_dwordx4 v245, s[32:35], s16 offen offset:1024  lds
    v_fmac_f32 v134, v122, v127
    v_mul_f32 v131, v131, v123
    v_mul_f32 v132, v132, v124
    v_mul_f32 v133, v133, v125
    v_mul_f32 v134, v134, v126
    buffer_load_dwordx4 v246, s[32:35], s16 offen offset:2048  lds
    v_cvt_pk_bf16_f32 v106, v134, v133
    v_cvt_pk_bf16_f32 v107, v132, v131
    v_and_b32 v116, 0xffff0000, v42
    v_and_b32 v117, 0xffff0000, v46
    v_and_b32 v118, 0xffff0000, v50
    v_and_b32 v119, 0xffff0000, v54
    v_and_b32 v120, 0xffff0000, v58
    v_and_b32 v121, 0xffff0000, v62
    v_and_b32 v122, 0xffff0000, v66
    v_lshlrev_b32 v127, 16, v94
    v_and_b32 v128, 0xffff0000, v94
    v_lshlrev_b32 v129, 16, v95
    s_waitcnt vmcnt(12)
    s_barrier
    buffer_load_dword v230, v229, s[64:67], 0 offen
    v_and_b32 v130, 0xffff0000, v95
    v_and_b32 v123, 0xffff0000, v70
    v_and_b32 v124, 0xffff0000, v74
    v_and_b32 v125, 0xffff0000, v78
    v_and_b32 v126, 0xffff0000, v82
    s_add_u32 s97, s98, s0
    s_lshr_b64 s[0:1], s[0:1], 4
    s_and_b32 s97, s97, 15
    s_lshr_b32 s99, s97, 3
    s_xor_b32 s97, s97, s99
    s_add_u32 m0, s87, 36864
    s_lshl_b32 s97, s97, 7
    buffer_load_dwordx4 v240, s[28:31], s97 offen offset:0  lds
    v_mul_f32 v131, v116, v130
    v_mul_f32 v132, v117, v130
    v_mul_f32 v133, v118, v130
    v_mul_f32 v134, v119, v130
    v_fmac_f32 v131, v117, v129
    buffer_load_dwordx4 v241, s[28:31], s97 offen offset:1024  lds
    v_fmac_f32 v132, v118, v129
    v_fmac_f32 v133, v119, v129
    v_fmac_f32 v134, v120, v129
    v_fmac_f32 v131, v118, v128
    v_fmac_f32 v132, v119, v128
    buffer_load_dwordx4 v242, s[28:31], s97 offen offset:2048  lds
    v_fmac_f32 v133, v120, v128
    v_fmac_f32 v134, v121, v128
    v_fmac_f32 v131, v119, v127
    v_fmac_f32 v132, v120, v127
    v_fmac_f32 v133, v121, v127
    buffer_load_dwordx4 v243, s[28:31], s97 offen offset:3072  lds
    v_fmac_f32 v134, v122, v127
    v_mul_f32 v131, v131, v123
    v_mul_f32 v132, v132, v124
    v_mul_f32 v133, v133, v125
    v_mul_f32 v134, v134, v126
    s_add_u32 m0, s88, 36864
    s_mov_b64 exec, 0xffffffff
    buffer_load_dwordx4 v3, s[28:31], s97 offen offset:0  lds
    s_mov_b64 exec, -1
    v_cvt_pk_bf16_f32 v104, v134, v133
    v_cvt_pk_bf16_f32 v105, v132, v131
    s_nop 0
    v_permlane32_swap_b32 v106, v104
    v_permlane32_swap_b32 v107, v105
    s_mov_b32 s89, 16384
    buffer_store_dwordx4 v[104:107], v12, s[52:55], s89 offen sc1
    s_mul_i32 s16, s97, 3072
    s_add_u32 m0, s60, 49152
    s_add_u32 s99, s16, s62
    buffer_load_dwordx4 v244, s[32:35], s99 offen offset:0  lds
    v_lshlrev_b32 v116, 16, v41
    v_lshlrev_b32 v117, 16, v45
    v_lshlrev_b32 v118, 16, v49
    v_lshlrev_b32 v119, 16, v53
    v_lshlrev_b32 v120, 16, v57
    buffer_load_dwordx4 v245, s[32:35], s99 offen offset:1024  lds
    v_lshlrev_b32 v121, 16, v61
    v_lshlrev_b32 v122, 16, v65
    v_lshlrev_b32 v127, 16, v88
    v_and_b32 v128, 0xffff0000, v88
    v_lshlrev_b32 v129, 16, v89
    buffer_load_dwordx4 v246, s[32:35], s99 offen offset:2048  lds
    v_and_b32 v130, 0xffff0000, v89
    v_lshlrev_b32 v123, 16, v69
    v_lshlrev_b32 v124, 16, v73
    v_lshlrev_b32 v125, 16, v77
    v_lshlrev_b32 v126, 16, v81
    s_add_u32 m0, s61, 61440
    s_add_u32 s16, s16, s63
    buffer_load_dwordx4 v244, s[32:35], s16 offen offset:0  lds
    v_mul_f32 v131, v116, v130
    v_mul_f32 v132, v117, v130
    v_mul_f32 v133, v118, v130
    v_mul_f32 v134, v119, v130
    v_fmac_f32 v131, v117, v129
    buffer_load_dwordx4 v245, s[32:35], s16 offen offset:1024  lds
    v_fmac_f32 v132, v118, v129
    v_fmac_f32 v133, v119, v129
    v_fmac_f32 v134, v120, v129
    v_fmac_f32 v131, v118, v128
    v_fmac_f32 v132, v119, v128
    buffer_load_dwordx4 v246, s[32:35], s16 offen offset:2048  lds
    v_fmac_f32 v133, v120, v128
    v_fmac_f32 v134, v121, v128
    v_fmac_f32 v131, v119, v127
    v_fmac_f32 v132, v120, v127
    v_fmac_f32 v133, v121, v127
    v_fmac_f32 v134, v122, v127
    v_mul_f32 v131, v131, v123
    s_waitcnt vmcnt(13)
    s_barrier
    s_add_u32 s97, s98, s0
    s_lshr_b64 s[0:1], s[0:1], 4
    s_and_b32 s97, s97, 15
    s_lshr_b32 s99, s97, 3
    s_xor_b32 s97, s97, s99
    s_add_u32 m0, s87, 0
    s_lshl_b32 s97, s97, 7
    buffer_load_dwordx4 v240, s[28:31], s97 offen offset:0  lds
    v_mul_f32 v132, v132, v124
    v_mul_f32 v133, v133, v125
    v_mul_f32 v134, v134, v126
    v_cvt_pk_bf16_f32 v110, v134, v133
    v_cvt_pk_bf16_f32 v111, v132, v131
    buffer_load_dwordx4 v241, s[28:31], s97 offen offset:1024  lds
    v_lshlrev_b32 v116, 16, v43
    v_lshlrev_b32 v117, 16, v47
    v_lshlrev_b32 v118, 16, v51
    v_lshlrev_b32 v119, 16, v55
    v_lshlrev_b32 v120, 16, v59
    buffer_load_dwordx4 v242, s[28:31], s97 offen offset:2048  lds
    v_lshlrev_b32 v121, 16, v63
    v_lshlrev_b32 v122, 16, v67
    v_lshlrev_b32 v127, 16, v96
    v_and_b32 v128, 0xffff0000, v96
    v_lshlrev_b32 v129, 16, v97
    buffer_load_dwordx4 v243, s[28:31], s97 offen offset:3072  lds
    v_and_b32 v130, 0xffff0000, v97
    v_lshlrev_b32 v123, 16, v71
    v_lshlrev_b32 v124, 16, v75
    v_lshlrev_b32 v125, 16, v79
    v_lshlrev_b32 v126, 16, v83
    s_add_u32 m0, s88, 0
    s_mov_b64 exec, 0xffffffff
    buffer_load_dwordx4 v3, s[28:31], s97 offen offset:0  lds
    s_mov_b64 exec, -1
    v_mul_f32 v131, v116, v130
    v_mul_f32 v132, v117, v130
    v_mul_f32 v133, v118, v130
    v_mul_f32 v134, v119, v130
    v_fmac_f32 v131, v117, v129
    s_mul_i32 s16, s97, 3072
    s_add_u32 m0, s60, 0
    s_add_u32 s99, s16, s62
    buffer_load_dwordx4 v244, s[32:35], s99 offen offset:0  lds
    v_fmac_f32 v132, v118, v129
    v_fmac_f32 v133, v119, v129
    v_fmac_f32 v134, v120, v129
    v_fmac_f32 v131, v118, v128
    v_fmac_f32 v132, v119, v128
    buffer_load_dwordx4 v245, s[32:35], s99 offen offset:1024  lds
    v_fmac_f32 v133, v120, v128
    v_fmac_f32 v134, v121, v128
    v_fmac_f32 v131, v119, v127
    v_fmac_f32 v132, v120, v127
    v_fmac_f32 v133, v121, v127
    buffer_load_dwordx4 v246, s[32:35], s99 offen offset:2048  lds
    v_fmac_f32 v134, v122, v127
    v_mul_f32 v131, v131, v123
    v_mul_f32 v132, v132, v124
    v_mul_f32 v133, v133, v125
    v_mul_f32 v134, v134, v126
    s_add_u32 m0, s61, 12288
    s_add_u32 s16, s16, s63
    buffer_load_dwordx4 v244, s[32:35], s16 offen offset:0  lds
    v_cvt_pk_bf16_f32 v108, v134, v133
    v_cvt_pk_bf16_f32 v109, v132, v131
    s_nop 0
    v_permlane32_swap_b32 v110, v108
    v_permlane32_swap_b32 v111, v109
    s_mov_b32 s89, 32768
    buffer_store_dwordx4 v[108:111], v12, s[52:55], s89 offen sc1
    buffer_load_dwordx4 v245, s[32:35], s16 offen offset:1024  lds
    v_and_b32 v116, 0xffff0000, v41
    v_and_b32 v117, 0xffff0000, v45
    v_and_b32 v118, 0xffff0000, v49
    v_and_b32 v119, 0xffff0000, v53
    v_and_b32 v120, 0xffff0000, v57
    buffer_load_dwordx4 v246, s[32:35], s16 offen offset:2048  lds
    v_and_b32 v121, 0xffff0000, v61
    v_and_b32 v122, 0xffff0000, v65
    v_lshlrev_b32 v127, 16, v90
    v_and_b32 v128, 0xffff0000, v90
    v_lshlrev_b32 v129, 16, v91
    v_and_b32 v130, 0xffff0000, v91
    v_and_b32 v123, 0xffff0000, v69
    v_and_b32 v124, 0xffff0000, v73
    v_and_b32 v125, 0xffff0000, v77
    v_and_b32 v126, 0xffff0000, v81
    v_mul_f32 v131, v116, v130
    v_mul_f32 v132, v117, v130
    s_waitcnt vmcnt(12)
    s_barrier
    s_add_u32 s97, s98, s0
    s_lshr_b64 s[0:1], s[0:1], 4
    s_and_b32 s97, s97, 15
    s_lshr_b32 s99, s97, 3
    s_xor_b32 s97, s97, s99
    s_add_u32 m0, s87, 18432
    s_lshl_b32 s97, s97, 7
    buffer_load_dwordx4 v240, s[28:31], s97 offen offset:0  lds
    v_mul_f32 v133, v118, v130
    v_mul_f32 v134, v119, v130
    v_fmac_f32 v131, v117, v129
    v_fmac_f32 v132, v118, v129
    v_fmac_f32 v133, v119, v129
    buffer_load_dwordx4 v241, s[28:31], s97 offen offset:1024  lds
    v_fmac_f32 v134, v120, v129
    v_fmac_f32 v131, v118, v128
    v_fmac_f32 v132, v119, v128
    v_fmac_f32 v133, v120, v128
    v_fmac_f32 v134, v121, v128
    buffer_load_dwordx4 v242, s[28:31], s97 offen offset:2048  lds
    v_fmac_f32 v131, v119, v127
    v_fmac_f32 v132, v120, v127
    v_fmac_f32 v133, v121, v127
    v_fmac_f32 v134, v122, v127
    v_mul_f32 v131, v131, v123
    buffer_load_dwordx4 v243, s[28:31], s97 offen offset:3072  lds
    v_mul_f32 v132, v132, v124
    v_mul_f32 v133, v133, v125
    v_mul_f32 v134, v134, v126
    v_cvt_pk_bf16_f32 v114, v134, v133
    v_cvt_pk_bf16_f32 v115, v132, v131
    s_add_u32 m0, s88, 18432
    s_mov_b64 exec, 0xffffffff
    buffer_load_dwordx4 v3, s[28:31], s97 offen offset:0  lds
    s_mov_b64 exec, -1
    v_and_b32 v116, 0xffff0000, v43
    v_and_b32 v117, 0xffff0000, v47
    v_and_b32 v118, 0xffff0000, v51
    v_and_b32 v119, 0xffff0000, v55
    v_and_b32 v120, 0xffff0000, v59
    s_mul_i32 s16, s97, 3072
    s_add_u32 m0, s60, 24576
    s_add_u32 s99, s16, s62
    buffer_load_dwordx4 v244, s[32:35], s99 offen offset:0  lds
    v_and_b32 v121, 0xffff0000, v63
    v_and_b32 v122, 0xffff0000, v67
    v_lshlrev_b32 v127, 16, v98
    v_and_b32 v128, 0xffff0000, v98
    v_lshlrev_b32 v129, 16, v99
    buffer_load_dwordx4 v245, s[32:35], s99 offen offset:1024  lds
    v_and_b32 v130, 0xffff0000, v99
    v_and_b32 v123, 0xffff0000, v71
    v_and_b32 v124, 0xffff0000, v75
    v_and_b32 v125, 0xffff0000, v79
    v_and_b32 v126, 0xffff0000, v83
    buffer_load_dwordx4 v246, s[32:35], s99 offen offset:2048  lds
    v_mul_f32 v131, v116, v130
    v_mul_f32 v132, v117, v130
    v_mul_f32 v133, v118, v130
    v_mul_f32 v134, v119, v130
    v_fmac_f32 v131, v117, v129
    s_add_u32 m0, s61, 36864
    s_add_u32 s16, s16, s63
    buffer_load_dwordx4 v244, s[32:35], s16 offen offset:0  lds
    v_fmac_f32 v132, v118, v129
    v_fmac_f32 v133, v119, v129
    v_fmac_f32 v134, v120, v129
    v_fmac_f32 v131, v118, v128
    v_fmac_f32 v132, v119, v128
    buffer_load_dwordx4 v245, s[32:35], s16 offen offset:1024  lds
    v_fmac_f32 v133, v120, v128
    v_fmac_f32 v134, v121, v128
    v_fmac_f32 v131, v119, v127
    v_fmac_f32 v132, v120, v127
    v_fmac_f32 v133, v121, v127
    buffer_load_dwordx4 v246, s[32:35], s16 offen offset:2048  lds
    v_fmac_f32 v134, v122, v127
    v_mul_f32 v131, v131, v123
    v_mul_f32 v132, v132, v124
    v_mul_f32 v133, v133, v125
    v_mul_f32 v134, v134, v126
    v_cvt_pk_bf16_f32 v112, v134, v133
    v_cvt_pk_bf16_f32 v113, v132, v131
    s_nop 0
    v_permlane32_swap_b32 v114, v112
    v_permlane32_swap_b32 v115, v113
    s_mov_b32 s89, 49152
    buffer_store_dwordx4 v[112:115], v12, s[52:55], s89 offen sc1
    s_waitcnt vmcnt(12)
    s_barrier
    s_add_u32 s97, s98, s0
    s_lshr_b64 s[0:1], s[0:1], 4
    s_and_b32 s97, s97, 15
    s_lshr_b32 s99, s97, 3
    s_xor_b32 s97, s97, s99
    s_add_u32 m0, s87, 36864
    s_lshl_b32 s97, s97, 7
    buffer_load_dwordx4 v240, s[28:31], s97 offen offset:0  lds
    buffer_load_dwordx4 v241, s[28:31], s97 offen offset:1024  lds
    buffer_load_dwordx4 v242, s[28:31], s97 offen offset:2048  lds
    buffer_load_dwordx4 v243, s[28:31], s97 offen offset:3072  lds
    s_add_u32 m0, s88, 36864
    s_mov_b64 exec, 0xffffffff
    buffer_load_dwordx4 v3, s[28:31], s97 offen offset:0  lds
    s_mov_b64 exec, -1
    s_mul_i32 s16, s97, 3072
    s_add_u32 m0, s60, 49152
    s_add_u32 s99, s16, s62
    buffer_load_dwordx4 v244, s[32:35], s99 offen offset:0  lds
    buffer_load_dwordx4 v245, s[32:35], s99 offen offset:1024  lds
    buffer_load_dwordx4 v246, s[32:35], s99 offen offset:2048  lds
    s_add_u32 m0, s61, 61440
    s_add_u32 s16, s16, s63
    buffer_load_dwordx4 v244, s[32:35], s16 offen offset:0  lds
    buffer_load_dwordx4 v245, s[32:35], s16 offen offset:1024  lds
    buffer_load_dwordx4 v246, s[32:35], s16 offen offset:2048  lds
    s_waitcnt vmcnt(12)
    s_barrier
    s_add_u32 m0, s94, 32
    s_lshl_b32 s89, s90, 12
    buffer_load_dwordx4 v15, s[48:51], s89 offen offset:0 nt lds
    s_add_u32 m0, s94, 32
    s_lshl_b32 s89, s90, 12
    buffer_load_dwordx4 v15, s[48:51], s89 offen offset:1024 nt lds
    s_add_u32 m0, s94, 32
    s_lshl_b32 s89, s90, 12
    buffer_load_dwordx4 v15, s[48:51], s89 offen offset:2048 nt lds
    s_add_u32 m0, s94, 32
    s_lshl_b32 s89, s90, 12
    buffer_load_dwordx4 v15, s[48:51], s89 offen offset:3072 nt lds
    s_add_u32 s97, s98, s0
    s_lshr_b64 s[0:1], s[0:1], 4
    s_and_b32 s97, s97, 15
    s_lshr_b32 s99, s97, 3
    s_xor_b32 s97, s97, s99
    s_add_u32 m0, s87, 0
    s_lshl_b32 s97, s97, 7
    buffer_load_dwordx4 v240, s[28:31], s97 offen offset:0  lds
    buffer_load_dwordx4 v241, s[28:31], s97 offen offset:1024  lds
    buffer_load_dwordx4 v242, s[28:31], s97 offen offset:2048  lds
    buffer_load_dwordx4 v243, s[28:31], s97 offen offset:3072  lds
    s_add_u32 m0, s88, 0
    s_mov_b64 exec, 0xffffffff
    buffer_load_dwordx4 v3, s[28:31], s97 offen offset:0  lds
    s_mov_b64 exec, -1
    s_mul_i32 s16, s97, 3072
    s_add_u32 m0, s60, 0
    s_add_u32 s99, s16, s62
    buffer_load_dwordx4 v244, s[32:35], s99 offen offset:0  lds
    buffer_load_dwordx4 v245, s[32:35], s99 offen offset:1024  lds
    buffer_load_dwordx4 v246, s[32:35], s99 offen offset:2048  lds
    s_add_u32 m0, s61, 12288
    s_add_u32 s16, s16, s63
    buffer_load_dwordx4 v244, s[32:35], s16 offen offset:0  lds
    buffer_load_dwordx4 v245, s[32:35], s16 offen offset:1024  lds
    buffer_load_dwordx4 v246, s[32:35], s16 offen offset:2048  lds
    s_waitcnt vmcnt(15)
    s_barrier
    s_add_u32 s97, s98, s0
    s_lshr_b64 s[0:1], s[0:1], 4
    s_and_b32 s97, s97, 15
    s_lshr_b32 s99, s97, 3
    s_xor_b32 s97, s97, s99
    s_add_u32 m0, s87, 18432
    s_lshl_b32 s97, s97, 7
    buffer_load_dwordx4 v240, s[28:31], s97 offen offset:0  lds
    buffer_load_dwordx4 v241, s[28:31], s97 offen offset:1024  lds
    buffer_load_dwordx4 v242, s[28:31], s97 offen offset:2048  lds
    buffer_load_dwordx4 v243, s[28:31], s97 offen offset:3072  lds
    s_add_u32 m0, s88, 18432
    s_mov_b64 exec, 0xffffffff
    buffer_load_dwordx4 v3, s[28:31], s97 offen offset:0  lds
    s_mov_b64 exec, -1
    s_mul_i32 s16, s97, 3072
    s_add_u32 m0, s60, 24576
    s_add_u32 s99, s16, s62
    buffer_load_dwordx4 v244, s[32:35], s99 offen offset:0  lds
    buffer_load_dwordx4 v245, s[32:35], s99 offen offset:1024  lds
    buffer_load_dwordx4 v246, s[32:35], s99 offen offset:2048  lds
    s_add_u32 m0, s61, 36864
    s_add_u32 s16, s16, s63
    buffer_load_dwordx4 v244, s[32:35], s16 offen offset:0  lds
    buffer_load_dwordx4 v245, s[32:35], s16 offen offset:1024  lds
    buffer_load_dwordx4 v246, s[32:35], s16 offen offset:2048  lds
    s_waitcnt vmcnt(11)
    s_barrier
    s_add_u32 s97, s98, s0
    s_lshr_b64 s[0:1], s[0:1], 4
    s_and_b32 s97, s97, 15
    s_lshr_b32 s99, s97, 3
    s_xor_b32 s97, s97, s99
    s_add_u32 m0, s87, 36864
    s_lshl_b32 s97, s97, 7
    buffer_load_dwordx4 v240, s[28:31], s97 offen offset:0  lds
    v_add_u32 v5, s94, v15
    ds_read_b128 v[140:143], v5 offset:32
    ds_read_b32 v156, v5 offset:48
    ds_read_b128 v[144:147], v5 offset:1056
    buffer_load_dwordx4 v241, s[28:31], s97 offen offset:1024  lds
    ds_read_b32 v157, v5 offset:1072
    ds_read_b128 v[148:151], v5 offset:2080
    ds_read_b32 v158, v5 offset:2096
    ds_read_b128 v[152:155], v5 offset:3104
    buffer_load_dwordx4 v242, s[28:31], s97 offen offset:2048  lds
    ds_read_b32 v159, v5 offset:3120
    v_lshrrev_b32 v6, 3, v0
    v_mul_u32_u24 v6, 4160, v6
    buffer_load_dwordx4 v243, s[28:31], s97 offen offset:3072  lds
    v_and_b32 v7, 7, v0
    v_lshl_add_u32 v6, v7, 2, v6
    v_add_u32 v6, s94, v6
    v_mov_b32 v7, 0
    s_add_u32 m0, s88, 36864
    s_mov_b64 exec, 0xffffffff
    buffer_load_dwordx4 v3, s[28:31], s97 offen offset:0  lds
    s_mov_b64 exec, -1
    s_waitcnt lgkmcnt(0)
    v_readfirstlane_b32 s93, v140
    s_nop 0
    s_lshl_b32 s93, s93, 16
    s_nop 1
    v_writelane_b32 v7, s93, 15
    s_mul_i32 s16, s97, 3072
    s_add_u32 m0, s60, 49152
    s_add_u32 s99, s16, s62
    buffer_load_dwordx4 v244, s[32:35], s99 offen offset:0  lds
    v_alignbit_b32 v140, v141, v140, 16
    v_alignbit_b32 v141, v142, v141, 16
    v_alignbit_b32 v142, v143, v142, 16
    buffer_load_dwordx4 v245, s[32:35], s99 offen offset:1024  lds
    v_alignbit_b32 v143, v156, v143, 16
    v_alignbit_b32 v144, v145, v144, 16
    v_alignbit_b32 v145, v146, v145, 16
    v_alignbit_b32 v146, v147, v146, 16
    buffer_load_dwordx4 v246, s[32:35], s99 offen offset:2048  lds
    v_alignbit_b32 v147, v157, v147, 16
    v_alignbit_b32 v148, v149, v148, 16
    v_alignbit_b32 v149, v150, v149, 16
    v_alignbit_b32 v150, v151, v150, 16
    s_add_u32 m0, s61, 61440
    s_add_u32 s16, s16, s63
    buffer_load_dwordx4 v244, s[32:35], s16 offen offset:0  lds
    v_alignbit_b32 v151, v158, v151, 16
    v_alignbit_b32 v152, v153, v152, 16
    v_alignbit_b32 v153, v154, v153, 16
    buffer_load_dwordx4 v245, s[32:35], s16 offen offset:1024  lds
    v_alignbit_b32 v154, v155, v154, 16
    v_alignbit_b32 v155, v159, v155, 16
    v_lshlrev_b32 v8, 3, v0
    s_add_u32 s78, s88, 18432
    buffer_load_dwordx4 v246, s[32:35], s16 offen offset:2048  lds
    v_add_u32 v8, s78, v8
    v_mov_b32 v156, 0
    v_mov_b32 v157, 0
    s_waitcnt vmcnt(11)
    s_barrier
    s_add_u32 s97, s98, s0
    s_lshr_b64 s[0:1], s[0:1], 4
    s_and_b32 s97, s97, 15
    s_lshr_b32 s99, s97, 3
    s_xor_b32 s97, s97, s99
    s_add_u32 m0, s87, 0
    s_lshl_b32 s97, s97, 7
    buffer_load_dwordx4 v240, s[28:31], s97 offen offset:0  lds
    buffer_load_dwordx4 v241, s[28:31], s97 offen offset:1024  lds
    buffer_load_dwordx4 v242, s[28:31], s97 offen offset:2048  lds
    buffer_load_dwordx4 v243, s[28:31], s97 offen offset:3072  lds
    s_add_u32 m0, s88, 0
    s_mov_b64 exec, 0xffffffff
    buffer_load_dwordx4 v3, s[28:31], s97 offen offset:0  lds
    s_mov_b64 exec, -1
    s_mul_i32 s16, s97, 3072
    s_add_u32 m0, s60, 0
    s_add_u32 s99, s16, s62
    buffer_load_dwordx4 v244, s[32:35], s99 offen offset:0  lds
    buffer_load_dwordx4 v245, s[32:35], s99 offen offset:1024  lds
    buffer_load_dwordx4 v246, s[32:35], s99 offen offset:2048  lds
    s_add_u32 m0, s61, 12288
    s_add_u32 s16, s16, s63
    buffer_load_dwordx4 v244, s[32:35], s16 offen offset:0  lds
    buffer_load_dwordx4 v245, s[32:35], s16 offen offset:1024  lds
    buffer_load_dwordx4 v246, s[32:35], s16 offen offset:2048  lds
    s_mov_b64 exec, 0xff
    buffer_load_dword v136, v33, s[68:71], 0 offen sc1
    buffer_load_dword v137, v34, s[52:55], 0 offen sc1
    s_mov_b64 exec, -1
    s_waitcnt vmcnt(13)
    s_barrier
    s_waitcnt vmcnt(0)
    s_branch LA_j
LA_c1:
    s_waitcnt vmcnt(7)
    s_barrier
    buffer_load_dwordx4 v246, s[32:35], s99 offen offset:2048  lds
    s_add_u32 m0, s61, 36864
    s_add_u32 s16, s16, s63
    buffer_load_dwordx4 v244, s[32:35], s16 offen offset:0  lds
    buffer_load_dwordx4 v245, s[32:35], s16 offen offset:1024  lds
    buffer_load_dwordx4 v246, s[32:35], s16 offen offset:2048  lds
    s_add_u32 s97, s98, s0
    s_lshr_b64 s[0:1], s[0:1], 4
    s_and_b32 s97, s97, 15
    s_lshr_b32 s99, s97, 3
    s_xor_b32 s97, s97, s99
    s_add_u32 m0, s87, 36864
    s_lshl_b32 s97, s97, 7
    buffer_load_dwordx4 v240, s[28:31], s97 offen offset:0  lds
    buffer_load_dwordx4 v241, s[28:31], s97 offen offset:1024  lds
    buffer_load_dwordx4 v242, s[28:31], s97 offen offset:2048  lds
    buffer_load_dwordx4 v243, s[28:31], s97 offen offset:3072  lds
    s_add_u32 m0, s88, 36864
    s_mov_b64 exec, 0xffffffff
    buffer_load_dwordx4 v3, s[28:31], s97 offen offset:0  lds
    s_mov_b64 exec, -1
    s_mul_i32 s16, s97, 3072
    s_add_u32 m0, s60, 49152
    s_add_u32 s99, s16, s62
    buffer_load_dwordx4 v244, s[32:35], s99 offen offset:0  lds
    buffer_load_dwordx4 v245, s[32:35], s99 offen offset:1024  lds
    buffer_load_dwordx4 v246, s[32:35], s99 offen offset:2048  lds
    s_add_u32 m0, s61, 61440
    s_add_u32 s16, s16, s63
    buffer_load_dwordx4 v244, s[32:35], s16 offen offset:0  lds
    buffer_load_dwordx4 v245, s[32:35], s16 offen offset:1024  lds
    buffer_load_dwordx4 v246, s[32:35], s16 offen offset:2048  lds
    s_waitcnt vmcnt(11)
    s_barrier
    s_add_u32 s97, s98, s0
    s_lshr_b64 s[0:1], s[0:1], 4
    s_and_b32 s97, s97, 15
    s_lshr_b32 s99, s97, 3
    s_xor_b32 s97, s97, s99
    s_add_u32 m0, s87, 0
    s_lshl_b32 s97, s97, 7
    buffer_load_dwordx4 v240, s[28:31], s97 offen offset:0  lds
    buffer_load_dwordx4 v241, s[28:31], s97 offen offset:1024  lds
    buffer_load_dwordx4 v242, s[28:31], s97 offen offset:2048  lds
    buffer_load_dwordx4 v243, s[28:31], s97 offen offset:3072  lds
    s_add_u32 m0, s88, 0
    s_mov_b64 exec, 0xffffffff
    buffer_load_dwordx4 v3, s[28:31], s97 offen offset:0  lds
    s_mov_b64 exec, -1
    s_mul_i32 s16, s97, 3072
    s_add_u32 m0, s60, 0
    s_add_u32 s99, s16, s62
    buffer_load_dwordx4 v244, s[32:35], s99 offen offset:0  lds
    buffer_load_dwordx4 v245, s[32:35], s99 offen offset:1024  lds
    buffer_load_dwordx4 v246, s[32:35], s99 offen offset:2048  lds
    s_add_u32 m0, s61, 12288
    s_add_u32 s16, s16, s63
    buffer_load_dwordx4 v244, s[32:35], s16 offen offset:0  lds
    buffer_load_dwordx4 v245, s[32:35], s16 offen offset:1024  lds
    buffer_load_dwordx4 v246, s[32:35], s16 offen offset:2048  lds
    s_waitcnt vmcnt(11)
    s_barrier
    s_add_u32 m0, s86, 129536
    s_mov_b32 s89, 0
    buffer_load_dwordx4 v10, s[36:39], s89 offen nt lds
    s_add_u32 m0, s86, 145920
    s_mov_b32 s89, 0
    buffer_load_dwordx4 v10, s[40:43], s89 offen nt lds
    s_add_u32 m0, s86, 133632
    s_mov_b32 s89, 65536
    buffer_load_dwordx4 v10, s[36:39], s89 offen nt lds
    s_add_u32 m0, s86, 150016
    s_mov_b32 s89, 65536
    buffer_load_dwordx4 v10, s[40:43], s89 offen nt lds
    s_add_u32 m0, s86, 137728
    s_mov_b32 s89, 131072
    buffer_load_dwordx4 v10, s[36:39], s89 offen nt lds
    s_add_u32 m0, s86, 154112
    s_mov_b32 s89, 131072
    buffer_load_dwordx4 v10, s[40:43], s89 offen nt lds
    s_add_u32 m0, s86, 141824
    s_mov_b32 s89, 196608
    buffer_load_dwordx4 v10, s[36:39], s89 offen nt lds
    s_add_u32 m0, s86, 158208
    s_mov_b32 s89, 196608
    buffer_load_dwordx4 v10, s[40:43], s89 offen nt lds
    s_mov_b64 exec, 0xff
    s_lshl_b32 s82, s3, 7
    s_add_u32 m0, s82, 129024
    s_mov_b32 s89, 0
    buffer_load_dwordx4 v11, s[36:39], s89 offen nt lds
    s_lshl_b32 s83, s74, 9
    s_add_u32 s83, s83, s82
    s_and_b32 s89, s3, 2
    s_lshl_b32 s89, s89, 3
    s_add_u32 s82, s82, s89
    s_add_u32 m0, s82, 162816
    s_add_u32 s89, s83, 0
    buffer_load_dwordx4 v15, s[44:47], s89 offen  lds
    s_mov_b64 exec, -1
    s_add_u32 s97, s98, s0
    s_lshr_b64 s[0:1], s[0:1], 4
    s_and_b32 s97, s97, 15
    s_lshr_b32 s99, s97, 3
    s_xor_b32 s97, s97, s99
    s_add_u32 m0, s87, 18432
    s_lshl_b32 s97, s97, 7
    buffer_load_dwordx4 v240, s[28:31], s97 offen offset:0  lds
    buffer_load_dwordx4 v241, s[28:31], s97 offen offset:1024  lds
    buffer_load_dwordx4 v242, s[28:31], s97 offen offset:2048  lds
    buffer_load_dwordx4 v243, s[28:31], s97 offen offset:3072  lds
    s_add_u32 m0, s88, 18432
    s_mov_b64 exec, 0xffffffff
    buffer_load_dwordx4 v3, s[28:31], s97 offen offset:0  lds
    s_mov_b64 exec, -1
    s_mul_i32 s16, s97, 3072
    s_add_u32 m0, s60, 24576
    s_add_u32 s99, s16, s62
    buffer_load_dwordx4 v244, s[32:35], s99 offen offset:0  lds
    buffer_load_dwordx4 v245, s[32:35], s99 offen offset:1024  lds
    s_waitcnt vmcnt(17)
    s_barrier
    buffer_load_dwordx4 v246, s[32:35], s99 offen offset:2048  lds
    s_add_u32 m0, s61, 36864
    s_add_u32 s16, s16, s63
    buffer_load_dwordx4 v244, s[32:35], s16 offen offset:0  lds
    buffer_load_dwordx4 v245, s[32:35], s16 offen offset:1024  lds
    buffer_load_dwordx4 v246, s[32:35], s16 offen offset:2048  lds
    s_add_u32 s97, s98, s0
    s_lshr_b64 s[0:1], s[0:1], 4
    s_and_b32 s97, s97, 15
    s_lshr_b32 s99, s97, 3
    s_xor_b32 s97, s97, s99
    s_add_u32 m0, s87, 36864
    s_lshl_b32 s97, s97, 7
    buffer_load_dwordx4 v240, s[28:31], s97 offen offset:0  lds
    buffer_load_dwordx4 v241, s[28:31], s97 offen offset:1024  lds
    buffer_load_dwordx4 v242, s[28:31], s97 offen offset:2048  lds
    buffer_load_dwordx4 v243, s[28:31], s97 offen offset:3072  lds
    s_add_u32 m0, s88, 36864
    s_mov_b64 exec, 0xffffffff
    buffer_load_dwordx4 v3, s[28:31], s97 offen offset:0  lds
    s_mov_b64 exec, -1
    s_mul_i32 s16, s97, 3072
    s_add_u32 m0, s60, 49152
    s_add_u32 s99, s16, s62
    buffer_load_dwordx4 v244, s[32:35], s99 offen offset:0  lds
    buffer_load_dwordx4 v245, s[32:35], s99 offen offset:1024  lds
    buffer_load_dwordx4 v246, s[32:35], s99 offen offset:2048  lds
    s_add_u32 m0, s61, 61440
    s_add_u32 s16, s16, s63
    buffer_load_dwordx4 v244, s[32:35], s16 offen offset:0  lds
    buffer_load_dwordx4 v245, s[32:35], s16 offen offset:1024  lds
    buffer_load_dwordx4 v246, s[32:35], s16 offen offset:2048  lds
    s_waitcnt vmcnt(11)
    s_barrier
    buffer_load_dword v230, v229, s[64:67], 0 offen
    ds_read_b128 v[84:87], v35 offset:0
    ds_read_b128 v[88:91], v35 offset:16
    s_add_u32 s97, s98, s0
    s_lshr_b64 s[0:1], s[0:1], 4
    s_and_b32 s97, s97, 15
    s_lshr_b32 s99, s97, 3
    s_xor_b32 s97, s97, s99
    s_add_u32 m0, s87, 0
    s_lshl_b32 s97, s97, 7
    buffer_load_dwordx4 v240, s[28:31], s97 offen offset:0  lds
    ds_read_b128 v[92:95], v35 offset:32
    buffer_load_dwordx4 v241, s[28:31], s97 offen offset:1024  lds
    ds_read_b128 v[96:99], v35 offset:48
    buffer_load_dwordx4 v242, s[28:31], s97 offen offset:2048  lds
    ds_read_b128 v[40:43], v233 offset:0
    buffer_load_dwordx4 v243, s[28:31], s97 offen offset:3072  lds
    ds_read_b128 v[44:47], v232 offset:256
    ds_read_b128 v[48:51], v233 offset:256
    s_add_u32 m0, s88, 0
    s_mov_b64 exec, 0xffffffff
    buffer_load_dwordx4 v3, s[28:31], s97 offen offset:0  lds
    s_mov_b64 exec, -1
    ds_read_b128 v[52:55], v16 offset:512
    s_mul_i32 s16, s97, 3072
    s_add_u32 m0, s60, 0
    s_add_u32 s99, s16, s62
    buffer_load_dwordx4 v244, s[32:35], s99 offen offset:0  lds
    ds_read_b128 v[56:59], v231 offset:512
    buffer_load_dwordx4 v245, s[32:35], s99 offen offset:1024  lds
    ds_read_b128 v[60:63], v16 offset:768
    buffer_load_dwordx4 v246, s[32:35], s99 offen offset:2048  lds
    ds_read_b128 v[64:67], v231 offset:768
    ds_read_b128 v[68:71], v16 offset:16896
    s_add_u32 m0, s61, 12288
    s_add_u32 s16, s16, s63
    buffer_load_dwordx4 v244, s[32:35], s16 offen offset:0  lds
    ds_read_b128 v[72:75], v231 offset:16896
    buffer_load_dwordx4 v245, s[32:35], s16 offen offset:1024  lds
    ds_read_b128 v[76:79], v16 offset:17152
    buffer_load_dwordx4 v246, s[32:35], s16 offen offset:2048  lds
    ds_read_b128 v[80:83], v231 offset:17152
    s_waitcnt vmcnt(12)
    s_waitcnt lgkmcnt(0)
    s_barrier
    s_add_u32 s97, s98, s0
    s_lshr_b64 s[0:1], s[0:1], 4
    s_and_b32 s97, s97, 15
    s_lshr_b32 s99, s97, 3
    s_xor_b32 s97, s97, s99
    s_add_u32 m0, s87, 18432
    s_lshl_b32 s97, s97, 7
    buffer_load_dwordx4 v240, s[28:31], s97 offen offset:0  lds
    v_lshlrev_b32 v116, 16, v40
    v_lshlrev_b32 v117, 16, v44
    v_lshlrev_b32 v118, 16, v48
    v_lshlrev_b32 v119, 16, v52
    v_lshlrev_b32 v120, 16, v56
    buffer_load_dwordx4 v241, s[28:31], s97 offen offset:1024  lds
    v_lshlrev_b32 v121, 16, v60
    v_lshlrev_b32 v122, 16, v64
    v_lshlrev_b32 v127, 16, v84
    v_and_b32 v128, 0xffff0000, v84
    v_lshlrev_b32 v129, 16, v85
    buffer_load_dwordx4 v242, s[28:31], s97 offen offset:2048  lds
    v_and_b32 v130, 0xffff0000, v85
    v_lshlrev_b32 v123, 16, v68
    v_lshlrev_b32 v124, 16, v72
    v_lshlrev_b32 v125, 16, v76
    v_lshlrev_b32 v126, 16, v80
    buffer_load_dwordx4 v243, s[28:31], s97 offen offset:3072  lds
    v_mul_f32 v131, v116, v130
    v_mul_f32 v132, v117, v130
    v_mul_f32 v133, v118, v130
    v_mul_f32 v134, v119, v130
    v_fmac_f32 v131, v117, v129
    s_add_u32 m0, s88, 18432
    s_mov_b64 exec, 0xffffffff
    buffer_load_dwordx4 v3, s[28:31], s97 offen offset:0  lds
    s_mov_b64 exec, -1
    v_fmac_f32 v132, v118, v129
    v_fmac_f32 v133, v119, v129
    v_fmac_f32 v134, v120, v129
    v_fmac_f32 v131, v118, v128
    v_fmac_f32 v132, v119, v128
    s_mul_i32 s16, s97, 3072
    s_add_u32 m0, s60, 24576
    s_add_u32 s99, s16, s62
    buffer_load_dwordx4 v244, s[32:35], s99 offen offset:0  lds
    v_fmac_f32 v133, v120, v128
    v_fmac_f32 v134, v121, v128
    v_fmac_f32 v131, v119, v127
    v_fmac_f32 v132, v120, v127
    v_fmac_f32 v133, v121, v127
    buffer_load_dwordx4 v245, s[32:35], s99 offen offset:1024  lds
    v_fmac_f32 v134, v122, v127
    v_mul_f32 v131, v131, v123
    v_mul_f32 v132, v132, v124
    v_mul_f32 v133, v133, v125
    v_mul_f32 v134, v134, v126
    buffer_load_dwordx4 v246, s[32:35], s99 offen offset:2048  lds
    v_cvt_pk_bf16_f32 v102, v134, v133
    v_cvt_pk_bf16_f32 v103, v132, v131
    v_lshlrev_b32 v116, 16, v42
    v_lshlrev_b32 v117, 16, v46
    v_lshlrev_b32 v118, 16, v50
    s_add_u32 m0, s61, 36864
    s_add_u32 s16, s16, s63
    buffer_load_dwordx4 v244, s[32:35], s16 offen offset:0  lds
    v_lshlrev_b32 v119, 16, v54
    v_lshlrev_b32 v120, 16, v58
    v_lshlrev_b32 v121, 16, v62
    v_lshlrev_b32 v122, 16, v66
    v_lshlrev_b32 v127, 16, v92
    buffer_load_dwordx4 v245, s[32:35], s16 offen offset:1024  lds
    v_and_b32 v128, 0xffff0000, v92
    v_lshlrev_b32 v129, 16, v93
    v_and_b32 v130, 0xffff0000, v93
    v_lshlrev_b32 v123, 16, v70
    v_lshlrev_b32 v124, 16, v74
    buffer_load_dwordx4 v246, s[32:35], s16 offen offset:2048  lds
    v_lshlrev_b32 v125, 16, v78
    v_lshlrev_b32 v126, 16, v82
    v_mul_f32 v131, v116, v130
    v_mul_f32 v132, v117, v130
    v_mul_f32 v133, v118, v130
    v_mul_f32 v134, v119, v130
    v_fmac_f32 v131, v117, v129
    v_fmac_f32 v132, v118, v129
    v_fmac_f32 v133, v119, v129
    v_fmac_f32 v134, v120, v129
    v_fmac_f32 v131, v118, v128
    v_fmac_f32 v132, v119, v128
    s_waitcnt vmcnt(11)
    s_barrier
    s_add_u32 s97, s98, s0
    s_lshr_b64 s[0:1], s[0:1], 4
    s_and_b32 s97, s97, 15
    s_lshr_b32 s99, s97, 3
    s_xor_b32 s97, s97, s99
    s_add_u32 m0, s87, 36864
    s_lshl_b32 s97, s97, 7
    buffer_load_dwordx4 v240, s[28:31], s97 offen offset:0  lds
    v_fmac_f32 v133, v120, v128
    v_fmac_f32 v134, v121, v128
    v_fmac_f32 v131, v119, v127
    v_fmac_f32 v132, v120, v127
    v_fmac_f32 v133, v121, v127
    buffer_load_dwordx4 v241, s[28:31], s97 offen offset:1024  lds
    v_fmac_f32 v134, v122, v127
    v_mul_f32 v131, v131, v123
    v_mul_f32 v132, v132, v124
    v_mul_f32 v133, v133, v125
    v_mul_f32 v134, v134, v126
    buffer_load_dwordx4 v242, s[28:31], s97 offen offset:2048  lds
    v_cvt_pk_bf16_f32 v100, v134, v133
    v_cvt_pk_bf16_f32 v101, v132, v131
    s_nop 0
    v_permlane32_swap_b32 v102, v100
    v_permlane32_swap_b32 v103, v101
    s_mov_b32 s89, 0
    buffer_store_dwordx4 v[100:103], v12, s[52:55], s89 offen sc1
    buffer_load_dwordx4 v243, s[28:31], s97 offen offset:3072  lds
    v_and_b32 v116, 0xffff0000, v40
    v_and_b32 v117, 0xffff0000, v44
    v_and_b32 v118, 0xffff0000, v48
    v_and_b32 v119, 0xffff0000, v52
    v_and_b32 v120, 0xffff0000, v56
    s_add_u32 m0, s88, 36864
    s_mov_b64 exec, 0xffffffff
    buffer_load_dwordx4 v3, s[28:31], s97 offen offset:0  lds
    s_mov_b64 exec, -1
    v_and_b32 v121, 0xffff0000, v60
    v_and_b32 v122, 0xffff0000, v64
    v_lshlrev_b32 v127, 16, v86
    v_and_b32 v128, 0xffff0000, v86
    v_lshlrev_b32 v129, 16, v87
    s_mul_i32 s16, s97, 3072
    s_add_u32 m0, s60, 49152
    s_add_u32 s99, s16, s62
    buffer_load_dwordx4 v244, s[32:35], s99 offen offset:0  lds
    v_and_b32 v130, 0xffff0000, v87
    v_and_b32 v123, 0xffff0000, v68
    v_and_b32 v124, 0xffff0000, v72
    v_and_b32 v125, 0xffff0000, v76
    v_and_b32 v126, 0xffff0000, v80
    buffer_load_dwordx4 v245, s[32:35], s99 offen offset:1024  lds
    v_mul_f32 v131, v116, v130
    v_mul_f32 v132, v117, v130
    v_mul_f32 v133, v118, v130
    v_mul_f32 v134, v119, v130
    v_fmac_f32 v131, v117, v129
    buffer_load_dwordx4 v246, s[32:35], s99 offen offset:2048  lds
    v_fmac_f32 v132, v118, v129
    v_fmac_f32 v133, v119, v129
    v_fmac_f32 v134, v120, v129
    v_fmac_f32 v131, v118, v128
    v_fmac_f32 v132, v119, v128
    s_add_u32 m0, s61, 61440
    s_add_u32 s16, s16, s63
    buffer_load_dwordx4 v244, s[32:35], s16 offen offset:0  lds
    v_fmac_f32 v133, v120, v128
    v_fmac_f32 v134, v121, v128
    v_fmac_f32 v131, v119, v127
    v_fmac_f32 v132, v120, v127
    v_fmac_f32 v133, v121, v127
    buffer_load_dwordx4 v245, s[32:35], s16 offen offset:1024  lds
    v_fmac_f32 v134, v122, v127
    v_mul_f32 v131, v131, v123
    v_mul_f32 v132, v132, v124
    v_mul_f32 v133, v133, v125
    v_mul_f32 v134, v134, v126
    buffer_load_dwordx4 v246, s[32:35], s16 offen offset:2048  lds
    v_cvt_pk_bf16_f32 v106, v134, v133
    v_cvt_pk_bf16_f32 v107, v132, v131
    v_and_b32 v116, 0xffff0000, v42
    v_and_b32 v117, 0xffff0000, v46
    v_and_b32 v118, 0xffff0000, v50
    v_and_b32 v119, 0xffff0000, v54
    v_and_b32 v120, 0xffff0000, v58
    v_and_b32 v121, 0xffff0000, v62
    v_and_b32 v122, 0xffff0000, v66
    v_lshlrev_b32 v127, 16, v94
    v_and_b32 v128, 0xffff0000, v94
    v_lshlrev_b32 v129, 16, v95
    s_waitcnt vmcnt(12)
    s_barrier
    s_add_u32 s97, s98, s0
    s_lshr_b64 s[0:1], s[0:1], 4
    s_and_b32 s97, s97, 15
    s_lshr_b32 s99, s97, 3
    s_xor_b32 s97, s97, s99
    s_add_u32 m0, s87, 0
    s_lshl_b32 s97, s97, 7
    buffer_load_dwordx4 v240, s[28:31], s97 offen offset:0  lds
    v_and_b32 v130, 0xffff0000, v95
    v_and_b32 v123, 0xffff0000, v70
    v_and_b32 v124, 0xffff0000, v74
    v_and_b32 v125, 0xffff0000, v78
    v_and_b32 v126, 0xffff0000, v82
    buffer_load_dwordx4 v241, s[28:31], s97 offen offset:1024  lds
    v_mul_f32 v131, v116, v130
    v_mul_f32 v132, v117, v130
    v_mul_f32 v133, v118, v130
    v_mul_f32 v134, v119, v130
    v_fmac_f32 v131, v117, v129
    buffer_load_dwordx4 v242, s[28:31], s97 offen offset:2048  lds
    v_fmac_f32 v132, v118, v129
    v_fmac_f32 v133, v119, v129
    v_fmac_f32 v134, v120, v129
    v_fmac_f32 v131, v118, v128
    v_fmac_f32 v132, v119, v128
    buffer_load_dwordx4 v243, s[28:31], s97 offen offset:3072  lds
    v_fmac_f32 v133, v120, v128
    v_fmac_f32 v134, v121, v128
    v_fmac_f32 v131, v119, v127
    v_fmac_f32 v132, v120, v127
    v_fmac_f32 v133, v121, v127
    s_add_u32 m0, s88, 0
    s_mov_b64 exec, 0xffffffff
    buffer_load_dwordx4 v3, s[28:31], s97 offen offset:0  lds
    s_mov_b64 exec, -1
    v_fmac_f32 v134, v122, v127
    v_mul_f32 v131, v131, v123
    v_mul_f32 v132, v132, v124
    v_mul_f32 v133, v133, v125
    v_mul_f32 v134, v134, v126
    s_mul_i32 s16, s97, 3072
    s_add_u32 m0, s60, 0
    s_add_u32 s99, s16, s62
    buffer_load_dwordx4 v244, s[32:35], s99 offen offset:0  lds
    v_cvt_pk_bf16_f32 v104, v134, v133
    v_cvt_pk_bf16_f32 v105, v132, v131
    s_nop 0
    v_permlane32_swap_b32 v106, v104
    v_permlane32_swap_b32 v107, v105
    s_mov_b32 s89, 16384
    buffer_store_dwordx4 v[104:107], v12, s[52:55], s89 offen sc1
    buffer_load_dwordx4 v245, s[32:35], s99 offen offset:1024  lds
    v_lshlrev_b32 v116, 16, v41
    v_lshlrev_b32 v117, 16, v45
    v_lshlrev_b32 v118, 16, v49
    v_lshlrev_b32 v119, 16, v53
    v_lshlrev_b32 v120, 16, v57
    buffer_load_dwordx4 v246, s[32:35], s99 offen offset:2048  lds
    v_lshlrev_b32 v121, 16, v61
    v_lshlrev_b32 v122, 16, v65
    v_lshlrev_b32 v127, 16, v88
    v_and_b32 v128, 0xffff0000, v88
    v_lshlrev_b32 v129, 16, v89
    s_add_u32 m0, s61, 12288
    s_add_u32 s16, s16, s63
    buffer_load_dwordx4 v244, s[32:35], s16 offen offset:0  lds
    v_and_b32 v130, 0xffff0000, v89
    v_lshlrev_b32 v123, 16, v69
    v_lshlrev_b32 v124, 16, v73
    v_lshlrev_b32 v125, 16, v77
    v_lshlrev_b32 v126, 16, v81
    buffer_load_dwordx4 v245, s[32:35], s16 offen offset:1024  lds
    v_mul_f32 v131, v116, v130
    v_mul_f32 v132, v117, v130
    v_mul_f32 v133, v118, v130
    v_mul_f32 v134, v119, v130
    v_fmac_f32 v131, v117, v129
    buffer_load_dwordx4 v246, s[32:35], s16 offen offset:2048  lds
    v_fmac_f32 v132, v118, v129
    v_fmac_f32 v133, v119, v129
    v_fmac_f32 v134, v120, v129
    v_fmac_f32 v131, v118, v128
    v_fmac_f32 v132, v119, v128
    v_fmac_f32 v133, v120, v128
    v_fmac_f32 v134, v121, v128
    v_fmac_f32 v131, v119, v127
    v_fmac_f32 v132, v120, v127
    v_fmac_f32 v133, v121, v127
    v_fmac_f32 v134, v122, v127
    v_mul_f32 v131, v131, v123
    s_waitcnt vmcnt(12)
    s_barrier
    s_add_u32 s97, s98, s0
    s_lshr_b64 s[0:1], s[0:1], 4
    s_and_b32 s97, s97, 15
    s_lshr_b32 s99, s97, 3
    s_xor_b32 s97, s97, s99
    s_add_u32 m0, s87, 18432
    s_lshl_b32 s97, s97, 7
    buffer_load_dwordx4 v240, s[28:31], s97 offen offset:0  lds
    v_mul_f32 v132, v132, v124
    v_mul_f32 v133, v133, v125
    v_mul_f32 v134, v134, v126
    v_cvt_pk_bf16_f32 v110, v134, v133
    v_cvt_pk_bf16_f32 v111, v132, v131
    buffer_load_dwordx4 v241, s[28:31], s97 offen offset:1024  lds
    v_lshlrev_b32 v116, 16, v43
    v_lshlrev_b32 v117, 16, v47
    v_lshlrev_b32 v118, 16, v51
    v_lshlrev_b32 v119, 16, v55
    v_lshlrev_b32 v120, 16, v59
    buffer_load_dwordx4 v242, s[28:31], s97 offen offset:2048  lds
    v_lshlrev_b32 v121, 16, v63
    v_lshlrev_b32 v122, 16, v67
    v_lshlrev_b32 v127, 16, v96
    v_and_b32 v128, 0xffff0000, v96
    v_lshlrev_b32 v129, 16, v97
    buffer_load_dwordx4 v243, s[28:31], s97 offen offset:3072  lds
    v_and_b32 v130, 0xffff0000, v97
    v_lshlrev_b32 v123, 16, v71
    v_lshlrev_b32 v124, 16, v75
    v_lshlrev_b32 v125, 16, v79
    v_lshlrev_b32 v126, 16, v83
    s_add_u32 m0, s88, 18432
    s_mov_b64 exec, 0xffffffff
    buffer_load_dwordx4 v3, s[28:31], s97 offen offset:0  lds
    s_mov_b64 exec, -1
    v_mul_f32 v131, v116, v130
    v_mul_f32 v132, v117, v130
    v_mul_f32 v133, v118, v130
    v_mul_f32 v134, v119, v130
    v_fmac_f32 v131, v117, v129
    s_mul_i32 s16, s97, 3072
    s_add_u32 m0, s60, 24576
    s_add_u32 s99, s16, s62
    buffer_load_dwordx4 v244, s[32:35], s99 offen offset:0  lds
    v_fmac_f32 v132, v118, v129
    v_fmac_f32 v133, v119, v129
    v_fmac_f32 v134, v120, v129
    v_fmac_f32 v131, v118, v128
    v_fmac_f32 v132, v119, v128
    buffer_load_dwordx4 v245, s[32:35], s99 offen offset:1024  lds
    v_fmac_f32 v133, v120, v128
    v_fmac_f32 v134, v121, v128
    v_fmac_f32 v131, v119, v127
    v_fmac_f32 v132, v120, v127
    v_fmac_f32 v133, v121, v127
    buffer_load_dwordx4 v246, s[32:35], s99 offen offset:2048  lds
    v_fmac_f32 v134, v122, v127
    v_mul_f32 v131, v131, v123
    v_mul_f32 v132, v132, v124
    v_mul_f32 v133, v133, v125
    v_mul_f32 v134, v134, v126
    s_add_u32 m0, s61, 36864
    s_add_u32 s16, s16, s63
    buffer_load_dwordx4 v244, s[32:35], s16 offen offset:0  lds
    v_cvt_pk_bf16_f32 v108, v134, v133
    v_cvt_pk_bf16_f32 v109, v132, v131
    s_nop 0
    v_permlane32_swap_b32 v110, v108
    v_permlane32_swap_b32 v111, v109
    s_mov_b32 s89, 32768
    buffer_store_dwordx4 v[108:111], v12, s[52:55], s89 offen sc1
    buffer_load_dwordx4 v245, s[32:35], s16 offen offset:1024  lds
    v_and_b32 v116, 0xffff0000, v41
    v_and_b32 v117, 0xffff0000, v45
    v_and_b32 v118, 0xffff0000, v49
    v_and_b32 v119, 0xffff0000, v53
    v_and_b32 v120, 0xffff0000, v57
    buffer_load_dwordx4 v246, s[32:35], s16 offen offset:2048  lds
    v_and_b32 v121, 0xffff0000, v61
    v_and_b32 v122, 0xffff0000, v65
    v_lshlrev_b32 v127, 16, v90
    v_and_b32 v128, 0xffff0000, v90
    v_lshlrev_b32 v129, 16, v91
    v_and_b32 v130, 0xffff0000, v91
    v_and_b32 v123, 0xffff0000, v69
    v_and_b32 v124, 0xffff0000, v73
    v_and_b32 v125, 0xffff0000, v77
    v_and_b32 v126, 0xffff0000, v81
    v_mul_f32 v131, v116, v130
    v_mul_f32 v132, v117, v130
    s_waitcnt vmcnt(12)
    s_barrier
    s_add_u32 s97, s98, s0
    s_lshr_b64 s[0:1], s[0:1], 4
    s_and_b32 s97, s97, 15
    s_lshr_b32 s99, s97, 3
    s_xor_b32 s97, s97, s99
    s_add_u32 m0, s87, 36864
    s_lshl_b32 s97, s97, 7
    buffer_load_dwordx4 v240, s[28:31], s97 offen offset:0  lds
    v_mul_f32 v133, v118, v130
    v_mul_f32 v134, v119, v130
    v_fmac_f32 v131, v117, v129
    v_fmac_f32 v132, v118, v129
    v_fmac_f32 v133, v119, v129
    buffer_load_dwordx4 v241, s[28:31], s97 offen offset:1024  lds
    v_fmac_f32 v134, v120, v129
    v_fmac_f32 v131, v118, v128
    v_fmac_f32 v132, v119, v128
    v_fmac_f32 v133, v120, v128
    v_fmac_f32 v134, v121, v128
    buffer_load_dwordx4 v242, s[28:31], s97 offen offset:2048  lds
    v_fmac_f32 v131, v119, v127
    v_fmac_f32 v132, v120, v127
    v_fmac_f32 v133, v121, v127
    v_fmac_f32 v134, v122, v127
    v_mul_f32 v131, v131, v123
    buffer_load_dwordx4 v243, s[28:31], s97 offen offset:3072  lds
    v_mul_f32 v132, v132, v124
    v_mul_f32 v133, v133, v125
    v_mul_f32 v134, v134, v126
    v_cvt_pk_bf16_f32 v114, v134, v133
    v_cvt_pk_bf16_f32 v115, v132, v131
    s_add_u32 m0, s88, 36864
    s_mov_b64 exec, 0xffffffff
    buffer_load_dwordx4 v3, s[28:31], s97 offen offset:0  lds
    s_mov_b64 exec, -1
    v_and_b32 v116, 0xffff0000, v43
    v_and_b32 v117, 0xffff0000, v47
    v_and_b32 v118, 0xffff0000, v51
    v_and_b32 v119, 0xffff0000, v55
    v_and_b32 v120, 0xffff0000, v59
    s_mul_i32 s16, s97, 3072
    s_add_u32 m0, s60, 49152
    s_add_u32 s99, s16, s62
    buffer_load_dwordx4 v244, s[32:35], s99 offen offset:0  lds
    v_and_b32 v121, 0xffff0000, v63
    v_and_b32 v122, 0xffff0000, v67
    v_lshlrev_b32 v127, 16, v98
    v_and_b32 v128, 0xffff0000, v98
    v_lshlrev_b32 v129, 16, v99
    buffer_load_dwordx4 v245, s[32:35], s99 offen offset:1024  lds
    v_and_b32 v130, 0xffff0000, v99
    v_and_b32 v123, 0xffff0000, v71
    v_and_b32 v124, 0xffff0000, v75
    v_and_b32 v125, 0xffff0000, v79
    v_and_b32 v126, 0xffff0000, v83
    buffer_load_dwordx4 v246, s[32:35], s99 offen offset:2048  lds
    v_mul_f32 v131, v116, v130
    v_mul_f32 v132, v117, v130
    v_mul_f32 v133, v118, v130
    v_mul_f32 v134, v119, v130
    v_fmac_f32 v131, v117, v129
    s_add_u32 m0, s61, 61440
    s_add_u32 s16, s16, s63
    buffer_load_dwordx4 v244, s[32:35], s16 offen offset:0  lds
    v_fmac_f32 v132, v118, v129
    v_fmac_f32 v133, v119, v129
    v_fmac_f32 v134, v120, v129
    v_fmac_f32 v131, v118, v128
    v_fmac_f32 v132, v119, v128
    buffer_load_dwordx4 v245, s[32:35], s16 offen offset:1024  lds
    v_fmac_f32 v133, v120, v128
    v_fmac_f32 v134, v121, v128
    v_fmac_f32 v131, v119, v127
    v_fmac_f32 v132, v120, v127
    v_fmac_f32 v133, v121, v127
    buffer_load_dwordx4 v246, s[32:35], s16 offen offset:2048  lds
    v_fmac_f32 v134, v122, v127
    v_mul_f32 v131, v131, v123
    v_mul_f32 v132, v132, v124
    v_mul_f32 v133, v133, v125
    v_mul_f32 v134, v134, v126
    v_cvt_pk_bf16_f32 v112, v134, v133
    v_cvt_pk_bf16_f32 v113, v132, v131
    s_nop 0
    v_permlane32_swap_b32 v114, v112
    v_permlane32_swap_b32 v115, v113
    s_mov_b32 s89, 49152
    buffer_store_dwordx4 v[112:115], v12, s[52:55], s89 offen sc1
    s_waitcnt vmcnt(12)
    s_barrier
    s_add_u32 m0, s94, 32
    s_lshl_b32 s89, s90, 12
    buffer_load_dwordx4 v15, s[48:51], s89 offen offset:0 nt lds
    s_add_u32 m0, s94, 32
    s_lshl_b32 s89, s90, 12
    buffer_load_dwordx4 v15, s[48:51], s89 offen offset:1024 nt lds
    s_add_u32 m0, s94, 32
    s_lshl_b32 s89, s90, 12
    buffer_load_dwordx4 v15, s[48:51], s89 offen offset:2048 nt lds
    s_add_u32 m0, s94, 32
    s_lshl_b32 s89, s90, 12
    buffer_load_dwordx4 v15, s[48:51], s89 offen offset:3072 nt lds
    s_add_u32 s97, s98, s0
    s_lshr_b64 s[0:1], s[0:1], 4
    s_and_b32 s97, s97, 15
    s_lshr_b32 s99, s97, 3
    s_xor_b32 s97, s97, s99
    s_add_u32 m0, s87, 0
    s_lshl_b32 s97, s97, 7
    buffer_load_dwordx4 v240, s[28:31], s97 offen offset:0  lds
    buffer_load_dwordx4 v241, s[28:31], s97 offen offset:1024  lds
    buffer_load_dwordx4 v242, s[28:31], s97 offen offset:2048  lds
    buffer_load_dwordx4 v243, s[28:31], s97 offen offset:3072  lds
    s_add_u32 m0, s88, 0
    s_mov_b64 exec, 0xffffffff
    buffer_load_dwordx4 v3, s[28:31], s97 offen offset:0  lds
    s_mov_b64 exec, -1
    s_mul_i32 s16, s97, 3072
    s_add_u32 m0, s60, 0
    s_add_u32 s99, s16, s62
    buffer_load_dwordx4 v244, s[32:35], s99 offen offset:0  lds
    buffer_load_dwordx4 v245, s[32:35], s99 offen offset:1024  lds
    buffer_load_dwordx4 v246, s[32:35], s99 offen offset:2048  lds
    s_add_u32 m0, s61, 12288
    s_add_u32 s16, s16, s63
    buffer_load_dwordx4 v244, s[32:35], s16 offen offset:0  lds
    buffer_load_dwordx4 v245, s[32:35], s16 offen offset:1024  lds
    buffer_load_dwordx4 v246, s[32:35], s16 offen offset:2048  lds
    s_waitcnt vmcnt(16)
    s_barrier
    s_add_u32 s97, s98, s0
    s_lshr_b64 s[0:1], s[0:1], 4
    s_and_b32 s97, s97, 15
    s_lshr_b32 s99, s97, 3
    s_xor_b32 s97, s97, s99
    s_add_u32 m0, s87, 18432
    s_lshl_b32 s97, s97, 7
    buffer_load_dwordx4 v240, s[28:31], s97 offen offset:0  lds
    buffer_load_dwordx4 v241, s[28:31], s97 offen offset:1024  lds
    buffer_load_dwordx4 v242, s[28:31], s97 offen offset:2048  lds
    buffer_load_dwordx4 v243, s[28:31], s97 offen offset:3072  lds
    s_add_u32 m0, s88, 18432
    s_mov_b64 exec, 0xffffffff
    buffer_load_dwordx4 v3, s[28:31], s97 offen offset:0  lds
    s_mov_b64 exec, -1
    s_mul_i32 s16, s97, 3072
    s_add_u32 m0, s60, 24576
    s_add_u32 s99, s16, s62
    buffer_load_dwordx4 v244, s[32:35], s99 offen offset:0  lds
    buffer_load_dwordx4 v245, s[32:35], s99 offen offset:1024  lds
    buffer_load_dwordx4 v246, s[32:35], s99 offen offset:2048  lds
    s_add_u32 m0, s61, 36864
    s_add_u32 s16, s16, s63
    buffer_load_dwordx4 v244, s[32:35], s16 offen offset:0  lds
    buffer_load_dwordx4 v245, s[32:35], s16 offen offset:1024  lds
    buffer_load_dwordx4 v246, s[32:35], s16 offen offset:2048  lds
    s_waitcnt vmcnt(11)
    s_barrier
    s_add_u32 s97, s98, s0
    s_lshr_b64 s[0:1], s[0:1], 4
    s_and_b32 s97, s97, 15
    s_lshr_b32 s99, s97, 3
    s_xor_b32 s97, s97, s99
    s_add_u32 m0, s87, 36864
    s_lshl_b32 s97, s97, 7
    buffer_load_dwordx4 v240, s[28:31], s97 offen offset:0  lds
    v_add_u32 v5, s94, v15
    ds_read_b128 v[140:143], v5 offset:32
    ds_read_b32 v156, v5 offset:48
    ds_read_b128 v[144:147], v5 offset:1056
    buffer_load_dwordx4 v241, s[28:31], s97 offen offset:1024  lds
    ds_read_b32 v157, v5 offset:1072
    ds_read_b128 v[148:151], v5 offset:2080
    ds_read_b32 v158, v5 offset:2096
    ds_read_b128 v[152:155], v5 offset:3104
    buffer_load_dwordx4 v242, s[28:31], s97 offen offset:2048  lds
    ds_read_b32 v159, v5 offset:3120
    v_lshrrev_b32 v6, 3, v0
    v_mul_u32_u24 v6, 4160, v6
    buffer_load_dwordx4 v243, s[28:31], s97 offen offset:3072  lds
    v_and_b32 v7, 7, v0
    v_lshl_add_u32 v6, v7, 2, v6
    v_add_u32 v6, s94, v6
    v_mov_b32 v7, 0
    s_add_u32 m0, s88, 36864
    s_mov_b64 exec, 0xffffffff
    buffer_load_dwordx4 v3, s[28:31], s97 offen offset:0  lds
    s_mov_b64 exec, -1
    s_waitcnt lgkmcnt(0)
    v_readfirstlane_b32 s93, v140
    s_nop 0
    s_lshl_b32 s93, s93, 16
    s_nop 1
    v_writelane_b32 v7, s93, 15
    s_mul_i32 s16, s97, 3072
    s_add_u32 m0, s60, 49152
    s_add_u32 s99, s16, s62
    buffer_load_dwordx4 v244, s[32:35], s99 offen offset:0  lds
    v_alignbit_b32 v140, v141, v140, 16
    v_alignbit_b32 v141, v142, v141, 16
    v_alignbit_b32 v142, v143, v142, 16
    buffer_load_dwordx4 v245, s[32:35], s99 offen offset:1024  lds
    v_alignbit_b32 v143, v156, v143, 16
    v_alignbit_b32 v144, v145, v144, 16
    v_alignbit_b32 v145, v146, v145, 16
    v_alignbit_b32 v146, v147, v146, 16
    buffer_load_dwordx4 v246, s[32:35], s99 offen offset:2048  lds
    v_alignbit_b32 v147, v157, v147, 16
    v_alignbit_b32 v148, v149, v148, 16
    v_alignbit_b32 v149, v150, v149, 16
    v_alignbit_b32 v150, v151, v150, 16
    s_add_u32 m0, s61, 61440
    s_add_u32 s16, s16, s63
    buffer_load_dwordx4 v244, s[32:35], s16 offen offset:0  lds
    v_alignbit_b32 v151, v158, v151, 16
    v_alignbit_b32 v152, v153, v152, 16
    v_alignbit_b32 v153, v154, v153, 16
    buffer_load_dwordx4 v245, s[32:35], s16 offen offset:1024  lds
    v_alignbit_b32 v154, v155, v154, 16
    v_alignbit_b32 v155, v159, v155, 16
    v_lshlrev_b32 v8, 3, v0
    s_add_u32 s78, s88, 18432
    buffer_load_dwordx4 v246, s[32:35], s16 offen offset:2048  lds
    v_add_u32 v8, s78, v8
    v_mov_b32 v156, 0
    v_mov_b32 v157, 0
    s_waitcnt vmcnt(11)
    s_barrier
    s_add_u32 s97, s98, s0
    s_lshr_b64 s[0:1], s[0:1], 4
    s_and_b32 s97, s97, 15
    s_lshr_b32 s99, s97, 3
    s_xor_b32 s97, s97, s99
    s_add_u32 m0, s87, 0
    s_lshl_b32 s97, s97, 7
    buffer_load_dwordx4 v240, s[28:31], s97 offen offset:0  lds
    buffer_load_dwordx4 v241, s[28:31], s97 offen offset:1024  lds
    buffer_load_dwordx4 v242, s[28:31], s97 offen offset:2048  lds
    buffer_load_dwordx4 v243, s[28:31], s97 offen offset:3072  lds
    s_add_u32 m0, s88, 0
    s_mov_b64 exec, 0xffffffff
    buffer_load_dwordx4 v3, s[28:31], s97 offen offset:0  lds
    s_mov_b64 exec, -1
    s_mul_i32 s16, s97, 3072
    s_add_u32 m0, s60, 0
    s_add_u32 s99, s16, s62
    buffer_load_dwordx4 v244, s[32:35], s99 offen offset:0  lds
    buffer_load_dwordx4 v245, s[32:35], s99 offen offset:1024  lds
    buffer_load_dwordx4 v246, s[32:35], s99 offen offset:2048  lds
    s_add_u32 m0, s61, 12288
    s_add_u32 s16, s16, s63
    buffer_load_dwordx4 v244, s[32:35], s16 offen offset:0  lds
    buffer_load_dwordx4 v245, s[32:35], s16 offen offset:1024  lds
    buffer_load_dwordx4 v246, s[32:35], s16 offen offset:2048  lds
    s_mov_b64 exec, 0xff
    buffer_load_dword v136, v33, s[68:71], 0 offen sc1
    buffer_load_dword v137, v34, s[52:55], 0 offen sc1
    s_mov_b64 exec, -1
    s_waitcnt vmcnt(13)
    s_barrier
    s_waitcnt vmcnt(0)
    s_branch LA_j
LA_c2:
    s_waitcnt vmcnt(7)
    s_barrier
    buffer_load_dwordx4 v246, s[32:35], s99 offen offset:2048  lds
    s_add_u32 m0, s61, 36864
    s_add_u32 s16, s16, s63
    buffer_load_dwordx4 v244, s[32:35], s16 offen offset:0  lds
    buffer_load_dwordx4 v245, s[32:35], s16 offen offset:1024  lds
    buffer_load_dwordx4 v246, s[32:35], s16 offen offset:2048  lds
    s_add_u32 s97, s98, s0
    s_lshr_b64 s[0:1], s[0:1], 4
    s_and_b32 s97, s97, 15
    s_lshr_b32 s99, s97, 3
    s_xor_b32 s97, s97, s99
    s_add_u32 m0, s87, 36864
    s_lshl_b32 s97, s97, 7
    buffer_load_dwordx4 v240, s[28:31], s97 offen offset:0  lds
    buffer_load_dwordx4 v241, s[28:31], s97 offen offset:1024  lds
    buffer_load_dwordx4 v242, s[28:31], s97 offen offset:2048  lds
    buffer_load_dwordx4 v243, s[28:31], s97 offen offset:3072  lds
    s_add_u32 m0, s88, 36864
    s_mov_b64 exec, 0xffffffff
    buffer_load_dwordx4 v3, s[28:31], s97 offen offset:0  lds
    s_mov_b64 exec, -1
    s_mul_i32 s16, s97, 3072
    s_add_u32 m0, s60, 49152
    s_add_u32 s99, s16, s62
    buffer_load_dwordx4 v244, s[32:35], s99 offen offset:0  lds
    buffer_load_dwordx4 v245, s[32:35], s99 offen offset:1024  lds
    buffer_load_dwordx4 v246, s[32:35], s99 offen offset:2048  lds
    s_add_u32 m0, s61, 61440
    s_add_u32 s16, s16, s63
    buffer_load_dwordx4 v244, s[32:35], s16 offen offset:0  lds
    buffer_load_dwordx4 v245, s[32:35], s16 offen offset:1024  lds
    buffer_load_dwordx4 v246, s[32:35], s16 offen offset:2048  lds
    s_waitcnt vmcnt(11)
    s_barrier
    s_add_u32 s97, s98, s0
    s_lshr_b64 s[0:1], s[0:1], 4
    s_and_b32 s97, s97, 15
    s_lshr_b32 s99, s97, 3
    s_xor_b32 s97, s97, s99
    s_add_u32 m0, s87, 0
    s_lshl_b32 s97, s97, 7
    buffer_load_dwordx4 v240, s[28:31], s97 offen offset:0  lds
    buffer_load_dwordx4 v241, s[28:31], s97 offen offset:1024  lds
    buffer_load_dwordx4 v242, s[28:31], s97 offen offset:2048  lds
    buffer_load_dwordx4 v243, s[28:31], s97 offen offset:3072  lds
    s_add_u32 m0, s88, 0
    s_mov_b64 exec, 0xffffffff
    buffer_load_dwordx4 v3, s[28:31], s97 offen offset:0  lds
    s_mov_b64 exec, -1
    s_mul_i32 s16, s97, 3072
    s_add_u32 m0, s60, 0
    s_add_u32 s99, s16, s62
    buffer_load_dwordx4 v244, s[32:35], s99 offen offset:0  lds
    buffer_load_dwordx4 v245, s[32:35], s99 offen offset:1024  lds
    buffer_load_dwordx4 v246, s[32:35], s99 offen offset:2048  lds
    s_add_u32 m0, s61, 12288
    s_add_u32 s16, s16, s63
    buffer_load_dwordx4 v244, s[32:35], s16 offen offset:0  lds
    buffer_load_dwordx4 v245, s[32:35], s16 offen offset:1024  lds
    buffer_load_dwordx4 v246, s[32:35], s16 offen offset:2048  lds
    s_waitcnt vmcnt(11)
    s_barrier
    s_add_u32 s97, s98, s0
    s_lshr_b64 s[0:1], s[0:1], 4
    s_and_b32 s97, s97, 15
    s_lshr_b32 s99, s97, 3
    s_xor_b32 s97, s97, s99
    s_add_u32 m0, s87, 18432
    s_lshl_b32 s97, s97, 7
    buffer_load_dwordx4 v240, s[28:31], s97 offen offset:0  lds
    buffer_load_dwordx4 v241, s[28:31], s97 offen offset:1024  lds
    buffer_load_dwordx4 v242, s[28:31], s97 offen offset:2048  lds
    buffer_load_dwordx4 v243, s[28:31], s97 offen offset:3072  lds
    s_add_u32 m0, s88, 18432
    s_mov_b64 exec, 0xffffffff
    buffer_load_dwordx4 v3, s[28:31], s97 offen offset:0  lds
    s_mov_b64 exec, -1
    s_mul_i32 s16, s97, 3072
    s_add_u32 m0, s60, 24576
    s_add_u32 s99, s16, s62
    buffer_load_dwordx4 v244, s[32:35], s99 offen offset:0  lds
    buffer_load_dwordx4 v245, s[32:35], s99 offen offset:1024  lds
    buffer_load_dwordx4 v246, s[32:35], s99 offen offset:2048  lds
    s_add_u32 m0, s61, 36864
    s_add_u32 s16, s16, s63
    buffer_load_dwordx4 v244, s[32:35], s16 offen offset:0  lds
    buffer_load_dwordx4 v245, s[32:35], s16 offen offset:1024  lds
    buffer_load_dwordx4 v246, s[32:35], s16 offen offset:2048  lds
    s_waitcnt vmcnt(11)
    s_barrier
    s_add_u32 m0, s86, 129536
    s_mov_b32 s89, 0
    buffer_load_dwordx4 v10, s[36:39], s89 offen nt lds
    s_add_u32 m0, s86, 145920
    s_mov_b32 s89, 0
    buffer_load_dwordx4 v10, s[40:43], s89 offen nt lds
    s_add_u32 m0, s86, 133632
    s_mov_b32 s89, 65536
    buffer_load_dwordx4 v10, s[36:39], s89 offen nt lds
    s_add_u32 m0, s86, 150016
    s_mov_b32 s89, 65536
    buffer_load_dwordx4 v10, s[40:43], s89 offen nt lds
    s_add_u32 m0, s86, 137728
    s_mov_b32 s89, 131072
    buffer_load_dwordx4 v10, s[36:39], s89 offen nt lds
    s_add_u32 m0, s86, 154112
    s_mov_b32 s89, 131072
    buffer_load_dwordx4 v10, s[40:43], s89 offen nt lds
    s_add_u32 m0, s86, 141824
    s_mov_b32 s89, 196608
    buffer_load_dwordx4 v10, s[36:39], s89 offen nt lds
    s_add_u32 m0, s86, 158208
    s_mov_b32 s89, 196608
    buffer_load_dwordx4 v10, s[40:43], s89 offen nt lds
    s_mov_b64 exec, 0xff
    s_lshl_b32 s82, s3, 7
    s_add_u32 m0, s82, 129024
    s_mov_b32 s89, 0
    buffer_load_dwordx4 v11, s[36:39], s89 offen nt lds
    s_lshl_b32 s83, s74, 9
    s_add_u32 s83, s83, s82
    s_and_b32 s89, s3, 2
    s_lshl_b32 s89, s89, 3
    s_add_u32 s82, s82, s89
    s_add_u32 m0, s82, 162816
    s_add_u32 s89, s83, 0
    buffer_load_dwordx4 v15, s[44:47], s89 offen  lds
    s_mov_b64 exec, -1
    s_add_u32 s97, s98, s0
    s_lshr_b64 s[0:1], s[0:1], 4
    s_and_b32 s97, s97, 15
    s_lshr_b32 s99, s97, 3
    s_xor_b32 s97, s97, s99
    s_add_u32 m0, s87, 36864
    s_lshl_b32 s97, s97, 7
    buffer_load_dwordx4 v240, s[28:31], s97 offen offset:0  lds
    buffer_load_dwordx4 v241, s[28:31], s97 offen offset:1024  lds
    buffer_load_dwordx4 v242, s[28:31], s97 offen offset:2048  lds
    buffer_load_dwordx4 v243, s[28:31], s97 offen offset:3072  lds
    s_add_u32 m0, s88, 36864
    s_mov_b64 exec, 0xffffffff
    buffer_load_dwordx4 v3, s[28:31], s97 offen offset:0  lds
    s_mov_b64 exec, -1
    s_mul_i32 s16, s97, 3072
    s_add_u32 m0, s60, 49152
    s_add_u32 s99, s16, s62
    buffer_load_dwordx4 v244, s[32:35], s99 offen offset:0  lds
    buffer_load_dwordx4 v245, s[32:35], s99 offen offset:1024  lds
    s_waitcnt vmcnt(17)
    s_barrier
    buffer_load_dwordx4 v246, s[32:35], s99 offen offset:2048  lds
    s_add_u32 m0, s61, 61440
    s_add_u32 s16, s16, s63
    buffer_load_dwordx4 v244, s[32:35], s16 offen offset:0  lds
    buffer_load_dwordx4 v245, s[32:35], s16 offen offset:1024  lds
    buffer_load_dwordx4 v246, s[32:35], s16 offen offset:2048  lds
    s_add_u32 s97, s98, s0
    s_lshr_b64 s[0:1], s[0:1], 4
    s_and_b32 s97, s97, 15
    s_lshr_b32 s99, s97, 3
    s_xor_b32 s97, s97, s99
    s_add_u32 m0, s87, 0
    s_lshl_b32 s97, s97, 7
    buffer_load_dwordx4 v240, s[28:31], s97 offen offset:0  lds
    buffer_load_dwordx4 v241, s[28:31], s97 offen offset:1024  lds
    buffer_load_dwordx4 v242, s[28:31], s97 offen offset:2048  lds
    buffer_load_dwordx4 v243, s[28:31], s97 offen offset:3072  lds
    s_add_u32 m0, s88, 0
    s_mov_b64 exec, 0xffffffff
    buffer_load_dwordx4 v3, s[28:31], s97 offen offset:0  lds
    s_mov_b64 exec, -1
    s_mul_i32 s16, s97, 3072
    s_add_u32 m0, s60, 0
    s_add_u32 s99, s16, s62
    buffer_load_dwordx4 v244, s[32:35], s99 offen offset:0  lds
    buffer_load_dwordx4 v245, s[32:35], s99 offen offset:1024  lds
    buffer_load_dwordx4 v246, s[32:35], s99 offen offset:2048  lds
    s_add_u32 m0, s61, 12288
    s_add_u32 s16, s16, s63
    buffer_load_dwordx4 v244, s[32:35], s16 offen offset:0  lds
    buffer_load_dwordx4 v245, s[32:35], s16 offen offset:1024  lds
    buffer_load_dwordx4 v246, s[32:35], s16 offen offset:2048  lds
    s_waitcnt vmcnt(11)
    s_barrier
    buffer_load_dword v230, v229, s[64:67], 0 offen
    ds_read_b128 v[84:87], v35 offset:0
    ds_read_b128 v[88:91], v35 offset:16
    s_add_u32 s97, s98, s0
    s_lshr_b64 s[0:1], s[0:1], 4
    s_and_b32 s97, s97, 15
    s_lshr_b32 s99, s97, 3
    s_xor_b32 s97, s97, s99
    s_add_u32 m0, s87, 18432
    s_lshl_b32 s97, s97, 7
    buffer_load_dwordx4 v240, s[28:31], s97 offen offset:0  lds
    ds_read_b128 v[92:95], v35 offset:32
    buffer_load_dwordx4 v241, s[28:31], s97 offen offset:1024  lds
    ds_read_b128 v[96:99], v35 offset:48
    buffer_load_dwordx4 v242, s[28:31], s97 offen offset:2048  lds
    ds_read_b128 v[40:43], v233 offset:0
    buffer_load_dwordx4 v243, s[28:31], s97 offen offset:3072  lds
    ds_read_b128 v[44:47], v232 offset:256
    ds_read_b128 v[48:51], v233 offset:256
    s_add_u32 m0, s88, 18432
    s_mov_b64 exec, 0xffffffff
    buffer_load_dwordx4 v3, s[28:31], s97 offen offset:0  lds
    s_mov_b64 exec, -1
    ds_read_b128 v[52:55], v16 offset:512
    s_mul_i32 s16, s97, 3072
    s_add_u32 m0, s60, 24576
    s_add_u32 s99, s16, s62
    buffer_load_dwordx4 v244, s[32:35], s99 offen offset:0  lds
    ds_read_b128 v[56:59], v231 offset:512
    buffer_load_dwordx4 v245, s[32:35], s99 offen offset:1024  lds
    ds_read_b128 v[60:63], v16 offset:768
    buffer_load_dwordx4 v246, s[32:35], s99 offen offset:2048  lds
    ds_read_b128 v[64:67], v231 offset:768
    ds_read_b128 v[68:71], v16 offset:16896
    s_add_u32 m0, s61, 36864
    s_add_u32 s16, s16, s63
    buffer_load_dwordx4 v244, s[32:35], s16 offen offset:0  lds
    ds_read_b128 v[72:75], v231 offset:16896
    buffer_load_dwordx4 v245, s[32:35], s16 offen offset:1024  lds
    ds_read_b128 v[76:79], v16 offset:17152
    buffer_load_dwordx4 v246, s[32:35], s16 offen offset:2048  lds
    ds_read_b128 v[80:83], v231 offset:17152
    s_waitcnt vmcnt(12)
    s_waitcnt lgkmcnt(0)
    s_barrier
    s_add_u32 s97, s98, s0
    s_lshr_b64 s[0:1], s[0:1], 4
    s_and_b32 s97, s97, 15
    s_lshr_b32 s99, s97, 3
    s_xor_b32 s97, s97, s99
    s_add_u32 m0, s87, 36864
    s_lshl_b32 s97, s97, 7
    buffer_load_dwordx4 v240, s[28:31], s97 offen offset:0  lds
    v_lshlrev_b32 v116, 16, v40
    v_lshlrev_b32 v117, 16, v44
    v_lshlrev_b32 v118, 16, v48
    v_lshlrev_b32 v119, 16, v52
    v_lshlrev_b32 v120, 16, v56
    buffer_load_dwordx4 v241, s[28:31], s97 offen offset:1024  lds
    v_lshlrev_b32 v121, 16, v60
    v_lshlrev_b32 v122, 16, v64
    v_lshlrev_b32 v127, 16, v84
    v_and_b32 v128, 0xffff0000, v84
    v_lshlrev_b32 v129, 16, v85
    buffer_load_dwordx4 v242, s[28:31], s97 offen offset:2048  lds
    v_and_b32 v130, 0xffff0000, v85
    v_lshlrev_b32 v123, 16, v68
    v_lshlrev_b32 v124, 16, v72
    v_lshlrev_b32 v125, 16, v76
    v_lshlrev_b32 v126, 16, v80
    buffer_load_dwordx4 v243, s[28:31], s97 offen offset:3072  lds
    v_mul_f32 v131, v116, v130
    v_mul_f32 v132, v117, v130
    v_mul_f32 v133, v118, v130
    v_mul_f32 v134, v119, v130
    v_fmac_f32 v131, v117, v129
    s_add_u32 m0, s88, 36864
    s_mov_b64 exec, 0xffffffff
    buffer_load_dwordx4 v3, s[28:31], s97 offen offset:0  lds
    s_mov_b64 exec, -1
    v_fmac_f32 v132, v118, v129
    v_fmac_f32 v133, v119, v129
    v_fmac_f32 v134, v120, v129
    v_fmac_f32 v131, v118, v128
    v_fmac_f32 v132, v119, v128
    s_mul_i32 s16, s97, 3072
    s_add_u32 m0, s60, 49152
    s_add_u32 s99, s16, s62
    buffer_load_dwordx4 v244, s[32:35], s99 offen offset:0  lds
    v_fmac_f32 v133, v120, v128
    v_fmac_f32 v134, v121, v128
    v_fmac_f32 v131, v119, v127
    v_fmac_f32 v132, v120, v127
    v_fmac_f32 v133, v121, v127
    buffer_load_dwordx4 v245, s[32:35], s99 offen offset:1024  lds
    v_fmac_f32 v134, v122, v127
    v_mul_f32 v131, v131, v123
    v_mul_f32 v132, v132, v124
    v_mul_f32 v133, v133, v125
    v_mul_f32 v134, v134, v126
    buffer_load_dwordx4 v246, s[32:35], s99 offen offset:2048  lds
    v_cvt_pk_bf16_f32 v102, v134, v133
    v_cvt_pk_bf16_f32 v103, v132, v131
    v_lshlrev_b32 v116, 16, v42
    v_lshlrev_b32 v117, 16, v46
    v_lshlrev_b32 v118, 16, v50
    s_add_u32 m0, s61, 61440
    s_add_u32 s16, s16, s63
    buffer_load_dwordx4 v244, s[32:35], s16 offen offset:0  lds
    v_lshlrev_b32 v119, 16, v54
    v_lshlrev_b32 v120, 16, v58
    v_lshlrev_b32 v121, 16, v62
    v_lshlrev_b32 v122, 16, v66
    v_lshlrev_b32 v127, 16, v92
    buffer_load_dwordx4 v245, s[32:35], s16 offen offset:1024  lds
    v_and_b32 v128, 0xffff0000, v92
    v_lshlrev_b32 v129, 16, v93
    v_and_b32 v130, 0xffff0000, v93
    v_lshlrev_b32 v123, 16, v70
    v_lshlrev_b32 v124, 16, v74
    buffer_load_dwordx4 v246, s[32:35], s16 offen offset:2048  lds
    v_lshlrev_b32 v125, 16, v78
    v_lshlrev_b32 v126, 16, v82
    v_mul_f32 v131, v116, v130
    v_mul_f32 v132, v117, v130
    v_mul_f32 v133, v118, v130
    v_mul_f32 v134, v119, v130
    v_fmac_f32 v131, v117, v129
    v_fmac_f32 v132, v118, v129
    v_fmac_f32 v133, v119, v129
    v_fmac_f32 v134, v120, v129
    v_fmac_f32 v131, v118, v128
    v_fmac_f32 v132, v119, v128
    s_waitcnt vmcnt(11)
    s_barrier
    s_add_u32 s97, s98, s0
    s_lshr_b64 s[0:1], s[0:1], 4
    s_and_b32 s97, s97, 15
    s_lshr_b32 s99, s97, 3
    s_xor_b32 s97, s97, s99
    s_add_u32 m0, s87, 0
    s_lshl_b32 s97, s97, 7
    buffer_load_dwordx4 v240, s[28:31], s97 offen offset:0  lds
    v_fmac_f32 v133, v120, v128
    v_fmac_f32 v134, v121, v128
    v_fmac_f32 v131, v119, v127
    v_fmac_f32 v132, v120, v127
    v_fmac_f32 v133, v121, v127
    buffer_load_dwordx4 v241, s[28:31], s97 offen offset:1024  lds
    v_fmac_f32 v134, v122, v127
    v_mul_f32 v131, v131, v123
    v_mul_f32 v132, v132, v124
    v_mul_f32 v133, v133, v125
    v_mul_f32 v134, v134, v126
    buffer_load_dwordx4 v242, s[28:31], s97 offen offset:2048  lds
    v_cvt_pk_bf16_f32 v100, v134, v133
    v_cvt_pk_bf16_f32 v101, v132, v131
    s_nop 0
    v_permlane32_swap_b32 v102, v100
    v_permlane32_swap_b32 v103, v101
    s_mov_b32 s89, 0
    buffer_store_dwordx4 v[100:103], v12, s[52:55], s89 offen sc1
    buffer_load_dwordx4 v243, s[28:31], s97 offen offset:3072  lds
    v_and_b32 v116, 0xffff0000, v40
    v_and_b32 v117, 0xffff0000, v44
    v_and_b32 v118, 0xffff0000, v48
    v_and_b32 v119, 0xffff0000, v52
    v_and_b32 v120, 0xffff0000, v56
    s_add_u32 m0, s88, 0
    s_mov_b64 exec, 0xffffffff
    buffer_load_dwordx4 v3, s[28:31], s97 offen offset:0  lds
    s_mov_b64 exec, -1
    v_and_b32 v121, 0xffff0000, v60
    v_and_b32 v122, 0xffff0000, v64
    v_lshlrev_b32 v127, 16, v86
    v_and_b32 v128, 0xffff0000, v86
    v_lshlrev_b32 v129, 16, v87
    s_mul_i32 s16, s97, 3072
    s_add_u32 m0, s60, 0
    s_add_u32 s99, s16, s62
    buffer_load_dwordx4 v244, s[32:35], s99 offen offset:0  lds
    v_and_b32 v130, 0xffff0000, v87
    v_and_b32 v123, 0xffff0000, v68
    v_and_b32 v124, 0xffff0000, v72
    v_and_b32 v125, 0xffff0000, v76
    v_and_b32 v126, 0xffff0000, v80
    buffer_load_dwordx4 v245, s[32:35], s99 offen offset:1024  lds
    v_mul_f32 v131, v116, v130
    v_mul_f32 v132, v117, v130
    v_mul_f32 v133, v118, v130
    v_mul_f32 v134, v119, v130
    v_fmac_f32 v131, v117, v129
    buffer_load_dwordx4 v246, s[32:35], s99 offen offset:2048  lds
    v_fmac_f32 v132, v118, v129
    v_fmac_f32 v133, v119, v129
    v_fmac_f32 v134, v120, v129
    v_fmac_f32 v131, v118, v128
    v_fmac_f32 v132, v119, v128
    s_add_u32 m0, s61, 12288
    s_add_u32 s16, s16, s63
    buffer_load_dwordx4 v244, s[32:35], s16 offen offset:0  lds
    v_fmac_f32 v133, v120, v128
    v_fmac_f32 v134, v121, v128
    v_fmac_f32 v131, v119, v127
    v_fmac_f32 v132, v120, v127
    v_fmac_f32 v133, v121, v127
    buffer_load_dwordx4 v245, s[32:35], s16 offen offset:1024  lds
    v_fmac_f32 v134, v122, v127
    v_mul_f32 v131, v131, v123
    v_mul_f32 v132, v132, v124
    v_mul_f32 v133, v133, v125
    v_mul_f32 v134, v134, v126
    buffer_load_dwordx4 v246, s[32:35], s16 offen offset:2048  lds
    v_cvt_pk_bf16_f32 v106, v134, v133
    v_cvt_pk_bf16_f32 v107, v132, v131
    v_and_b32 v116, 0xffff0000, v42
    v_and_b32 v117, 0xffff0000, v46
    v_and_b32 v118, 0xffff0000, v50
    v_and_b32 v119, 0xffff0000, v54
    v_and_b32 v120, 0xffff0000, v58
    v_and_b32 v121, 0xffff0000, v62
    v_and_b32 v122, 0xffff0000, v66
    v_lshlrev_b32 v127, 16, v94
    v_and_b32 v128, 0xffff0000, v94
    v_lshlrev_b32 v129, 16, v95
    s_waitcnt vmcnt(12)
    s_barrier
    s_add_u32 s97, s98, s0
    s_lshr_b64 s[0:1], s[0:1], 4
    s_and_b32 s97, s97, 15
    s_lshr_b32 s99, s97, 3
    s_xor_b32 s97, s97, s99
    s_add_u32 m0, s87, 18432
    s_lshl_b32 s97, s97, 7
    buffer_load_dwordx4 v240, s[28:31], s97 offen offset:0  lds
    v_and_b32 v130, 0xffff0000, v95
    v_and_b32 v123, 0xffff0000, v70
    v_and_b32 v124, 0xffff0000, v74
    v_and_b32 v125, 0xffff0000, v78
    v_and_b32 v126, 0xffff0000, v82
    buffer_load_dwordx4 v241, s[28:31], s97 offen offset:1024  lds
    v_mul_f32 v131, v116, v130
    v_mul_f32 v132, v117, v130
    v_mul_f32 v133, v118, v130
    v_mul_f32 v134, v119, v130
    v_fmac_f32 v131, v117, v129
    buffer_load_dwordx4 v242, s[28:31], s97 offen offset:2048  lds
    v_fmac_f32 v132, v118, v129
    v_fmac_f32 v133, v119, v129
    v_fmac_f32 v134, v120, v129
    v_fmac_f32 v131, v118, v128
    v_fmac_f32 v132, v119, v128
    buffer_load_dwordx4 v243, s[28:31], s97 offen offset:3072  lds
    v_fmac_f32 v133, v120, v128
    v_fmac_f32 v134, v121, v128
    v_fmac_f32 v131, v119, v127
    v_fmac_f32 v132, v120, v127
    v_fmac_f32 v133, v121, v127
    s_add_u32 m0, s88, 18432
    s_mov_b64 exec, 0xffffffff
    buffer_load_dwordx4 v3, s[28:31], s97 offen offset:0  lds
    s_mov_b64 exec, -1
    v_fmac_f32 v134, v122, v127
    v_mul_f32 v131, v131, v123
    v_mul_f32 v132, v132, v124
    v_mul_f32 v133, v133, v125
    v_mul_f32 v134, v134, v126
    s_mul_i32 s16, s97, 3072
    s_add_u32 m0, s60, 24576
    s_add_u32 s99, s16, s62
    buffer_load_dwordx4 v244, s[32:35], s99 offen offset:0  lds
    v_cvt_pk_bf16_f32 v104, v134, v133
    v_cvt_pk_bf16_f32 v105, v132, v131
    s_nop 0
    v_permlane32_swap_b32 v106, v104
    v_permlane32_swap_b32 v107, v105
    s_mov_b32 s89, 16384
    buffer_store_dwordx4 v[104:107], v12, s[52:55], s89 offen sc1
    buffer_load_dwordx4 v245, s[32:35], s99 offen offset:1024  lds
    v_lshlrev_b32 v116, 16, v41
    v_lshlrev_b32 v117, 16, v45
    v_lshlrev_b32 v118, 16, v49
    v_lshlrev_b32 v119, 16, v53
    v_lshlrev_b32 v120, 16, v57
    buffer_load_dwordx4 v246, s[32:35], s99 offen offset:2048  lds
    v_lshlrev_b32 v121, 16, v61
    v_lshlrev_b32 v122, 16, v65
    v_lshlrev_b32 v127, 16, v88
    v_and_b32 v128, 0xffff0000, v88
    v_lshlrev_b32 v129, 16, v89
    s_add_u32 m0, s61, 36864
    s_add_u32 s16, s16, s63
    buffer_load_dwordx4 v244, s[32:35], s16 offen offset:0  lds
    v_and_b32 v130, 0xffff0000, v89
    v_lshlrev_b32 v123, 16, v69
    v_lshlrev_b32 v124, 16, v73
    v_lshlrev_b32 v125, 16, v77
    v_lshlrev_b32 v126, 16, v81
    buffer_load_dwordx4 v245, s[32:35], s16 offen offset:1024  lds
    v_mul_f32 v131, v116, v130
    v_mul_f32 v132, v117, v130
    v_mul_f32 v133, v118, v130
    v_mul_f32 v134, v119, v130
    v_fmac_f32 v131, v117, v129
    buffer_load_dwordx4 v246, s[32:35], s16 offen offset:2048  lds
    v_fmac_f32 v132, v118, v129
    v_fmac_f32 v133, v119, v129
    v_fmac_f32 v134, v120, v129
    v_fmac_f32 v131, v118, v128
    v_fmac_f32 v132, v119, v128
    v_fmac_f32 v133, v120, v128
    v_fmac_f32 v134, v121, v128
    v_fmac_f32 v131, v119, v127
    v_fmac_f32 v132, v120, v127
    v_fmac_f32 v133, v121, v127
    v_fmac_f32 v134, v122, v127
    v_mul_f32 v131, v131, v123
    s_waitcnt vmcnt(12)
    s_barrier
    s_add_u32 s97, s98, s0
    s_lshr_b64 s[0:1], s[0:1], 4
    s_and_b32 s97, s97, 15
    s_lshr_b32 s99, s97, 3
    s_xor_b32 s97, s97, s99
    s_add_u32 m0, s87, 36864
    s_lshl_b32 s97, s97, 7
    buffer_load_dwordx4 v240, s[28:31], s97 offen offset:0  lds
    v_mul_f32 v132, v132, v124
    v_mul_f32 v133, v133, v125
    v_mul_f32 v134, v134, v126
    v_cvt_pk_bf16_f32 v110, v134, v133
    v_cvt_pk_bf16_f32 v111, v132, v131
    buffer_load_dwordx4 v241, s[28:31], s97 offen offset:1024  lds
    v_lshlrev_b32 v116, 16, v43
    v_lshlrev_b32 v117, 16, v47
    v_lshlrev_b32 v118, 16, v51
    v_lshlrev_b32 v119, 16, v55
    v_lshlrev_b32 v120, 16, v59
    buffer_load_dwordx4 v242, s[28:31], s97 offen offset:2048  lds
    v_lshlrev_b32 v121, 16, v63
    v_lshlrev_b32 v122, 16, v67
    v_lshlrev_b32 v127, 16, v96
    v_and_b32 v128, 0xffff0000, v96
    v_lshlrev_b32 v129, 16, v97
    buffer_load_dwordx4 v243, s[28:31], s97 offen offset:3072  lds
    v_and_b32 v130, 0xffff0000, v97
    v_lshlrev_b32 v123, 16, v71
    v_lshlrev_b32 v124, 16, v75
    v_lshlrev_b32 v125, 16, v79
    v_lshlrev_b32 v126, 16, v83
    s_add_u32 m0, s88, 36864
    s_mov_b64 exec, 0xffffffff
    buffer_load_dwordx4 v3, s[28:31], s97 offen offset:0  lds
    s_mov_b64 exec, -1
    v_mul_f32 v131, v116, v130
    v_mul_f32 v132, v117, v130
    v_mul_f32 v133, v118, v130
    v_mul_f32 v134, v119, v130
    v_fmac_f32 v131, v117, v129
    s_mul_i32 s16, s97, 3072
    s_add_u32 m0, s60, 49152
    s_add_u32 s99, s16, s62
    buffer_load_dwordx4 v244, s[32:35], s99 offen offset:0  lds
    v_fmac_f32 v132, v118, v129
    v_fmac_f32 v133, v119, v129
    v_fmac_f32 v134, v120, v129
    v_fmac_f32 v131, v118, v128
    v_fmac_f32 v132, v119, v128
    buffer_load_dwordx4 v245, s[32:35], s99 offen offset:1024  lds
    v_fmac_f32 v133, v120, v128
    v_fmac_f32 v134, v121, v128
    v_fmac_f32 v131, v119, v127
    v_fmac_f32 v132, v120, v127
    v_fmac_f32 v133, v121, v127
    buffer_load_dwordx4 v246, s[32:35], s99 offen offset:2048  lds
    v_fmac_f32 v134, v122, v127
    v_mul_f32 v131, v131, v123
    v_mul_f32 v132, v132, v124
    v_mul_f32 v133, v133, v125
    v_mul_f32 v134, v134, v126
    s_add_u32 m0, s61, 61440
    s_add_u32 s16, s16, s63
    buffer_load_dwordx4 v244, s[32:35], s16 offen offset:0  lds
    v_cvt_pk_bf16_f32 v108, v134, v133
    v_cvt_pk_bf16_f32 v109, v132, v131
    s_nop 0
    v_permlane32_swap_b32 v110, v108
    v_permlane32_swap_b32 v111, v109
    s_mov_b32 s89, 32768
    buffer_store_dwordx4 v[108:111], v12, s[52:55], s89 offen sc1
    buffer_load_dwordx4 v245, s[32:35], s16 offen offset:1024  lds
    v_and_b32 v116, 0xffff0000, v41
    v_and_b32 v117, 0xffff0000, v45
    v_and_b32 v118, 0xffff0000, v49
    v_and_b32 v119, 0xffff0000, v53
    v_and_b32 v120, 0xffff0000, v57
    buffer_load_dwordx4 v246, s[32:35], s16 offen offset:2048  lds
    v_and_b32 v121, 0xffff0000, v61
    v_and_b32 v122, 0xffff0000, v65
    v_lshlrev_b32 v127, 16, v90
    v_and_b32 v128, 0xffff0000, v90
    v_lshlrev_b32 v129, 16, v91
    v_and_b32 v130, 0xffff0000, v91
    v_and_b32 v123, 0xffff0000, v69
    v_and_b32 v124, 0xffff0000, v73
    v_and_b32 v125, 0xffff0000, v77
    v_and_b32 v126, 0xffff0000, v81
    v_mul_f32 v131, v116, v130
    v_mul_f32 v132, v117, v130
    s_waitcnt vmcnt(12)
    s_barrier
    s_add_u32 s97, s98, s0
    s_lshr_b64 s[0:1], s[0:1], 4
    s_and_b32 s97, s97, 15
    s_lshr_b32 s99, s97, 3
    s_xor_b32 s97, s97, s99
    s_add_u32 m0, s87, 0
    s_lshl_b32 s97, s97, 7
    buffer_load_dwordx4 v240, s[28:31], s97 offen offset:0  lds
    v_mul_f32 v133, v118, v130
    v_mul_f32 v134, v119, v130
    v_fmac_f32 v131, v117, v129
    v_fmac_f32 v132, v118, v129
    v_fmac_f32 v133, v119, v129
    buffer_load_dwordx4 v241, s[28:31], s97 offen offset:1024  lds
    v_fmac_f32 v134, v120, v129
    v_fmac_f32 v131, v118, v128
    v_fmac_f32 v132, v119, v128
    v_fmac_f32 v133, v120, v128
    v_fmac_f32 v134, v121, v128
    buffer_load_dwordx4 v242, s[28:31], s97 offen offset:2048  lds
    v_fmac_f32 v131, v119, v127
    v_fmac_f32 v132, v120, v127
    v_fmac_f32 v133, v121, v127
    v_fmac_f32 v134, v122, v127
    v_mul_f32 v131, v131, v123
    buffer_load_dwordx4 v243, s[28:31], s97 offen offset:3072  lds
    v_mul_f32 v132, v132, v124
    v_mul_f32 v133, v133, v125
    v_mul_f32 v134, v134, v126
    v_cvt_pk_bf16_f32 v114, v134, v133
    v_cvt_pk_bf16_f32 v115, v132, v131
    s_add_u32 m0, s88, 0
    s_mov_b64 exec, 0xffffffff
    buffer_load_dwordx4 v3, s[28:31], s97 offen offset:0  lds
    s_mov_b64 exec, -1
    v_and_b32 v116, 0xffff0000, v43
    v_and_b32 v117, 0xffff0000, v47
    v_and_b32 v118, 0xffff0000, v51
    v_and_b32 v119, 0xffff0000, v55
    v_and_b32 v120, 0xffff0000, v59
    s_mul_i32 s16, s97, 3072
    s_add_u32 m0, s60, 0
    s_add_u32 s99, s16, s62
    buffer_load_dwordx4 v244, s[32:35], s99 offen offset:0  lds
    v_and_b32 v121, 0xffff0000, v63
    v_and_b32 v122, 0xffff0000, v67
    v_lshlrev_b32 v127, 16, v98
    v_and_b32 v128, 0xffff0000, v98
    v_lshlrev_b32 v129, 16, v99
    buffer_load_dwordx4 v245, s[32:35], s99 offen offset:1024  lds
    v_and_b32 v130, 0xffff0000, v99
    v_and_b32 v123, 0xffff0000, v71
    v_and_b32 v124, 0xffff0000, v75
    v_and_b32 v125, 0xffff0000, v79
    v_and_b32 v126, 0xffff0000, v83
    buffer_load_dwordx4 v246, s[32:35], s99 offen offset:2048  lds
    v_mul_f32 v131, v116, v130
    v_mul_f32 v132, v117, v130
    v_mul_f32 v133, v118, v130
    v_mul_f32 v134, v119, v130
    v_fmac_f32 v131, v117, v129
    s_add_u32 m0, s61, 12288
    s_add_u32 s16, s16, s63
    buffer_load_dwordx4 v244, s[32:35], s16 offen offset:0  lds
    v_fmac_f32 v132, v118, v129
    v_fmac_f32 v133, v119, v129
    v_fmac_f32 v134, v120, v129
    v_fmac_f32 v131, v118, v128
    v_fmac_f32 v132, v119, v128
    buffer_load_dwordx4 v245, s[32:35], s16 offen offset:1024  lds
    v_fmac_f32 v133, v120, v128
    v_fmac_f32 v134, v121, v128
    v_fmac_f32 v131, v119, v127
    v_fmac_f32 v132, v120, v127
    v_fmac_f32 v133, v121, v127
    buffer_load_dwordx4 v246, s[32:35], s16 offen offset:2048  lds
    v_fmac_f32 v134, v122, v127
    v_mul_f32 v131, v131, v123
    v_mul_f32 v132, v132, v124
    v_mul_f32 v133, v133, v125
    v_mul_f32 v134, v134, v126
    v_cvt_pk_bf16_f32 v112, v134, v133
    v_cvt_pk_bf16_f32 v113, v132, v131
    s_nop 0
    v_permlane32_swap_b32 v114, v112
    v_permlane32_swap_b32 v115, v113
    s_mov_b32 s89, 49152
    buffer_store_dwordx4 v[112:115], v12, s[52:55], s89 offen sc1
    s_waitcnt vmcnt(12)
    s_barrier
    s_add_u32 m0, s94, 32
    s_lshl_b32 s89, s90, 12
    buffer_load_dwordx4 v15, s[48:51], s89 offen offset:0 nt lds
    s_add_u32 m0, s94, 32
    s_lshl_b32 s89, s90, 12
    buffer_load_dwordx4 v15, s[48:51], s89 offen offset:1024 nt lds
    s_add_u32 m0, s94, 32
    s_lshl_b32 s89, s90, 12
    buffer_load_dwordx4 v15, s[48:51], s89 offen offset:2048 nt lds
    s_add_u32 m0, s94, 32
    s_lshl_b32 s89, s90, 12
    buffer_load_dwordx4 v15, s[48:51], s89 offen offset:3072 nt lds
    s_add_u32 s97, s98, s0
    s_lshr_b64 s[0:1], s[0:1], 4
    s_and_b32 s97, s97, 15
    s_lshr_b32 s99, s97, 3
    s_xor_b32 s97, s97, s99
    s_add_u32 m0, s87, 18432
    s_lshl_b32 s97, s97, 7
    buffer_load_dwordx4 v240, s[28:31], s97 offen offset:0  lds
    buffer_load_dwordx4 v241, s[28:31], s97 offen offset:1024  lds
    buffer_load_dwordx4 v242, s[28:31], s97 offen offset:2048  lds
    buffer_load_dwordx4 v243, s[28:31], s97 offen offset:3072  lds
    s_add_u32 m0, s88, 18432
    s_mov_b64 exec, 0xffffffff
    buffer_load_dwordx4 v3, s[28:31], s97 offen offset:0  lds
    s_mov_b64 exec, -1
    s_mul_i32 s16, s97, 3072
    s_add_u32 m0, s60, 24576
    s_add_u32 s99, s16, s62
    buffer_load_dwordx4 v244, s[32:35], s99 offen offset:0  lds
    buffer_load_dwordx4 v245, s[32:35], s99 offen offset:1024  lds
    buffer_load_dwordx4 v246, s[32:35], s99 offen offset:2048  lds
    s_add_u32 m0, s61, 36864
    s_add_u32 s16, s16, s63
    buffer_load_dwordx4 v244, s[32:35], s16 offen offset:0  lds
    buffer_load_dwordx4 v245, s[32:35], s16 offen offset:1024  lds
    buffer_load_dwordx4 v246, s[32:35], s16 offen offset:2048  lds
    s_waitcnt vmcnt(16)
    s_waitcnt vmcnt(15)
    s_barrier
    s_add_u32 s97, s98, s0
    s_lshr_b64 s[0:1], s[0:1], 4
    s_and_b32 s97, s97, 15
    s_lshr_b32 s99, s97, 3
    s_xor_b32 s97, s97, s99
    s_add_u32 m0, s87, 36864
    s_lshl_b32 s97, s97, 7
    buffer_load_dwordx4 v240, s[28:31], s97 offen offset:0  lds
    buffer_load_dwordx4 v241, s[28:31], s97 offen offset:1024  lds
    buffer_load_dwordx4 v242, s[28:31], s97 offen offset:2048  lds
    buffer_load_dwordx4 v243, s[28:31], s97 offen offset:3072  lds
    s_add_u32 m0, s88, 36864
    s_mov_b64 exec, 0xffffffff
    buffer_load_dwordx4 v3, s[28:31], s97 offen offset:0  lds
    s_mov_b64 exec, -1
    s_mul_i32 s16, s97, 3072
    s_add_u32 m0, s60, 49152
    s_add_u32 s99, s16, s62
    buffer_load_dwordx4 v244, s[32:35], s99 offen offset:0  lds
    buffer_load_dwordx4 v245, s[32:35], s99 offen offset:1024  lds
    buffer_load_dwordx4 v246, s[32:35], s99 offen offset:2048  lds
    s_add_u32 m0, s61, 61440
    s_add_u32 s16, s16, s63
    buffer_load_dwordx4 v244, s[32:35], s16 offen offset:0  lds
    buffer_load_dwordx4 v245, s[32:35], s16 offen offset:1024  lds
    buffer_load_dwordx4 v246, s[32:35], s16 offen offset:2048  lds
    s_waitcnt vmcnt(11)
    s_barrier
    s_add_u32 s97, s98, s0
    s_lshr_b64 s[0:1], s[0:1], 4
    s_and_b32 s97, s97, 15
    s_lshr_b32 s99, s97, 3
    s_xor_b32 s97, s97, s99
    s_add_u32 m0, s87, 0
    s_lshl_b32 s97, s97, 7
    buffer_load_dwordx4 v240, s[28:31], s97 offen offset:0  lds
    v_add_u32 v5, s94, v15
    ds_read_b128 v[140:143], v5 offset:32
    ds_read_b32 v156, v5 offset:48
    ds_read_b128 v[144:147], v5 offset:1056
    buffer_load_dwordx4 v241, s[28:31], s97 offen offset:1024  lds
    ds_read_b32 v157, v5 offset:1072
    ds_read_b128 v[148:151], v5 offset:2080
    ds_read_b32 v158, v5 offset:2096
    buffer_load_dwordx4 v242, s[28:31], s97 offen offset:2048  lds
    ds_read_b128 v[152:155], v5 offset:3104
    ds_read_b32 v159, v5 offset:3120
    v_lshrrev_b32 v6, 3, v0
    buffer_load_dwordx4 v243, s[28:31], s97 offen offset:3072  lds
    v_mul_u32_u24 v6, 4160, v6
    v_and_b32 v7, 7, v0
    v_lshl_add_u32 v6, v7, 2, v6
    v_add_u32 v6, s94, v6
    s_add_u32 m0, s88, 0
    s_mov_b64 exec, 0xffffffff
    buffer_load_dwordx4 v3, s[28:31], s97 offen offset:0  lds
    s_mov_b64 exec, -1
    v_mov_b32 v7, 0
    s_waitcnt lgkmcnt(0)
    v_readfirstlane_b32 s93, v140
    s_mul_i32 s16, s97, 3072
    s_add_u32 m0, s60, 0
    s_add_u32 s99, s16, s62
    buffer_load_dwordx4 v244, s[32:35], s99 offen offset:0  lds
    s_lshl_b32 s93, s93, 16
    v_writelane_b32 v7, s93, 15
    v_alignbit_b32 v140, v141, v140, 16
    buffer_load_dwordx4 v245, s[32:35], s99 offen offset:1024  lds
    v_alignbit_b32 v141, v142, v141, 16
    v_alignbit_b32 v142, v143, v142, 16
    v_alignbit_b32 v143, v156, v143, 16
    v_alignbit_b32 v144, v145, v144, 16
    buffer_load_dwordx4 v246, s[32:35], s99 offen offset:2048  lds
    v_alignbit_b32 v145, v146, v145, 16
    v_alignbit_b32 v146, v147, v146, 16
    v_alignbit_b32 v147, v157, v147, 16
    s_add_u32 m0, s61, 12288
    s_add_u32 s16, s16, s63
    buffer_load_dwordx4 v244, s[32:35], s16 offen offset:0  lds
    v_alignbit_b32 v148, v149, v148, 16
    v_alignbit_b32 v149, v150, v149, 16
    v_alignbit_b32 v150, v151, v150, 16
    buffer_load_dwordx4 v245, s[32:35], s16 offen offset:1024  lds
    v_alignbit_b32 v151, v158, v151, 16
    v_alignbit_b32 v152, v153, v152, 16
    v_alignbit_b32 v153, v154, v153, 16
    v_alignbit_b32 v154, v155, v154, 16
    buffer_load_dwordx4 v246, s[32:35], s16 offen offset:2048  lds
    v_alignbit_b32 v155, v159, v155, 16
    v_lshlrev_b32 v8, 3, v0
    s_add_u32 s78, s88, 18432
    s_mov_b64 exec, 0xff
    buffer_load_dword v136, v33, s[68:71], 0 offen sc1
    buffer_load_dword v137, v34, s[52:55], 0 offen sc1
    s_mov_b64 exec, -1
    v_add_u32 v8, s78, v8
    v_mov_b32 v156, 0
    v_mov_b32 v157, 0
    s_waitcnt vmcnt(13)
    s_barrier
    s_waitcnt vmcnt(0)
    s_branch LA_j
LA_c3:
    s_waitcnt vmcnt(7)
    s_barrier
    buffer_load_dwordx4 v246, s[32:35], s99 offen offset:2048  lds
    s_add_u32 m0, s61, 36864
    s_add_u32 s16, s16, s63
    buffer_load_dwordx4 v244, s[32:35], s16 offen offset:0  lds
    buffer_load_dwordx4 v245, s[32:35], s16 offen offset:1024  lds
    buffer_load_dwordx4 v246, s[32:35], s16 offen offset:2048  lds
    s_add_u32 s97, s98, s0
    s_lshr_b64 s[0:1], s[0:1], 4
    s_and_b32 s97, s97, 15
    s_lshr_b32 s99, s97, 3
    s_xor_b32 s97, s97, s99
    s_add_u32 m0, s87, 36864
    s_lshl_b32 s97, s97, 7
    buffer_load_dwordx4 v240, s[28:31], s97 offen offset:0  lds
    buffer_load_dwordx4 v241, s[28:31], s97 offen offset:1024  lds
    buffer_load_dwordx4 v242, s[28:31], s97 offen offset:2048  lds
    buffer_load_dwordx4 v243, s[28:31], s97 offen offset:3072  lds
    s_add_u32 m0, s88, 36864
    s_mov_b64 exec, 0xffffffff
    buffer_load_dwordx4 v3, s[28:31], s97 offen offset:0  lds
    s_mov_b64 exec, -1
    s_mul_i32 s16, s97, 3072
    s_add_u32 m0, s60, 49152
    s_add_u32 s99, s16, s62
    buffer_load_dwordx4 v244, s[32:35], s99 offen offset:0  lds
    buffer_load_dwordx4 v245, s[32:35], s99 offen offset:1024  lds
    buffer_load_dwordx4 v246, s[32:35], s99 offen offset:2048  lds
    s_add_u32 m0, s61, 61440
    s_add_u32 s16, s16, s63
    buffer_load_dwordx4 v244, s[32:35], s16 offen offset:0  lds
    buffer_load_dwordx4 v245, s[32:35], s16 offen offset:1024  lds
    buffer_load_dwordx4 v246, s[32:35], s16 offen offset:2048  lds
    s_waitcnt vmcnt(11)
    s_barrier
    buffer_load_dword v230, v229, s[64:67], 0 offen
    s_add_u32 s97, s98, s0
    s_lshr_b64 s[0:1], s[0:1], 4
    s_and_b32 s97, s97, 15
    s_lshr_b32 s99, s97, 3
    s_xor_b32 s97, s97, s99
    s_add_u32 m0, s87, 0
    s_lshl_b32 s97, s97, 7
    buffer_load_dwordx4 v240, s[28:31], s97 offen offset:0  lds
    buffer_load_dwordx4 v241, s[28:31], s97 offen offset:1024  lds
    buffer_load_dwordx4 v242, s[28:31], s97 offen offset:2048  lds
    buffer_load_dwordx4 v243, s[28:31], s97 offen offset:3072  lds
    s_add_u32 m0, s88, 0
    s_mov_b64 exec, 0xffffffff
    buffer_load_dwordx4 v3, s[28:31], s97 offen offset:0  lds
    s_mov_b64 exec, -1
    s_mul_i32 s16, s97, 3072
    s_add_u32 m0, s60, 0
    s_add_u32 s99, s16, s62
    buffer_load_dwordx4 v244, s[32:35], s99 offen offset:0  lds
    buffer_load_dwordx4 v245, s[32:35], s99 offen offset:1024  lds
    buffer_load_dwordx4 v246, s[32:35], s99 offen offset:2048  lds
    s_add_u32 m0, s61, 12288
    s_add_u32 s16, s16, s63
    buffer_load_dwordx4 v244, s[32:35], s16 offen offset:0  lds
    buffer_load_dwordx4 v245, s[32:35], s16 offen offset:1024  lds
    buffer_load_dwordx4 v246, s[32:35], s16 offen offset:2048  lds
    s_waitcnt vmcnt(12)
    s_barrier
    s_add_u32 s97, s98, s0
    s_lshr_b64 s[0:1], s[0:1], 4
    s_and_b32 s97, s97, 15
    s_lshr_b32 s99, s97, 3
    s_xor_b32 s97, s97, s99
    s_add_u32 m0, s87, 18432
    s_lshl_b32 s97, s97, 7
    buffer_load_dwordx4 v240, s[28:31], s97 offen offset:0  lds
    buffer_load_dwordx4 v241, s[28:31], s97 offen offset:1024  lds
    buffer_load_dwordx4 v242, s[28:31], s97 offen offset:2048  lds
    buffer_load_dwordx4 v243, s[28:31], s97 offen offset:3072  lds
    s_add_u32 m0, s88, 18432
    s_mov_b64 exec, 0xffffffff
    buffer_load_dwordx4 v3, s[28:31], s97 offen offset:0  lds
    s_mov_b64 exec, -1
    s_mul_i32 s16, s97, 3072
    s_add_u32 m0, s60, 24576
    s_add_u32 s99, s16, s62
    buffer_load_dwordx4 v244, s[32:35], s99 offen offset:0  lds
    buffer_load_dwordx4 v245, s[32:35], s99 offen offset:1024  lds
    buffer_load_dwordx4 v246, s[32:35], s99 offen offset:2048  lds
    s_add_u32 m0, s61, 36864
    s_add_u32 s16, s16, s63
    buffer_load_dwordx4 v244, s[32:35], s16 offen offset:0  lds
    buffer_load_dwordx4 v245, s[32:35], s16 offen offset:1024  lds
    buffer_load_dwordx4 v246, s[32:35], s16 offen offset:2048  lds
    s_waitcnt vmcnt(11)
    s_barrier
    s_add_u32 m0, s86, 129536
    s_mov_b32 s89, 0
    buffer_load_dwordx4 v10, s[36:39], s89 offen nt lds
    s_add_u32 m0, s86, 145920
    s_mov_b32 s89, 0
    buffer_load_dwordx4 v10, s[40:43], s89 offen nt lds
    s_add_u32 m0, s86, 133632
    s_mov_b32 s89, 65536
    buffer_load_dwordx4 v10, s[36:39], s89 offen nt lds
    s_add_u32 m0, s86, 150016
    s_mov_b32 s89, 65536
    buffer_load_dwordx4 v10, s[40:43], s89 offen nt lds
    s_add_u32 m0, s86, 137728
    s_mov_b32 s89, 131072
    buffer_load_dwordx4 v10, s[36:39], s89 offen nt lds
    s_add_u32 m0, s86, 154112
    s_mov_b32 s89, 131072
    buffer_load_dwordx4 v10, s[40:43], s89 offen nt lds
    s_add_u32 m0, s86, 141824
    s_mov_b32 s89, 196608
    buffer_load_dwordx4 v10, s[36:39], s89 offen nt lds
    s_add_u32 m0, s86, 158208
    s_mov_b32 s89, 196608
    buffer_load_dwordx4 v10, s[40:43], s89 offen nt lds
    s_mov_b64 exec, 0xff
    s_lshl_b32 s82, s3, 7
    s_add_u32 m0, s82, 129024
    s_mov_b32 s89, 0
    buffer_load_dwordx4 v11, s[36:39], s89 offen nt lds
    s_lshl_b32 s83, s74, 9
    s_add_u32 s83, s83, s82
    s_and_b32 s89, s3, 2
    s_lshl_b32 s89, s89, 3
    s_add_u32 s82, s82, s89
    s_add_u32 m0, s82, 162816
    s_add_u32 s89, s83, 0
    buffer_load_dwordx4 v15, s[44:47], s89 offen  lds
    s_mov_b64 exec, -1
    s_add_u32 s97, s98, s0
    s_lshr_b64 s[0:1], s[0:1], 4
    s_and_b32 s97, s97, 15
    s_lshr_b32 s99, s97, 3
    s_xor_b32 s97, s97, s99
    s_add_u32 m0, s87, 36864
    s_lshl_b32 s97, s97, 7
    buffer_load_dwordx4 v240, s[28:31], s97 offen offset:0  lds
    buffer_load_dwordx4 v241, s[28:31], s97 offen offset:1024  lds
    buffer_load_dwordx4 v242, s[28:31], s97 offen offset:2048  lds
    buffer_load_dwordx4 v243, s[28:31], s97 offen offset:3072  lds
    s_add_u32 m0, s88, 36864
    s_mov_b64 exec, 0xffffffff
    buffer_load_dwordx4 v3, s[28:31], s97 offen offset:0  lds
    s_mov_b64 exec, -1
    s_mul_i32 s16, s97, 3072
    s_add_u32 m0, s60, 49152
    s_add_u32 s99, s16, s62
    buffer_load_dwordx4 v244, s[32:35], s99 offen offset:0  lds
    buffer_load_dwordx4 v245, s[32:35], s99 offen offset:1024  lds
    s_waitcnt vmcnt(17)
    s_barrier
    buffer_load_dwordx4 v246, s[32:35], s99 offen offset:2048  lds
    s_add_u32 m0, s61, 61440
    s_add_u32 s16, s16, s63
    buffer_load_dwordx4 v244, s[32:35], s16 offen offset:0  lds
    buffer_load_dwordx4 v245, s[32:35], s16 offen offset:1024  lds
    buffer_load_dwordx4 v246, s[32:35], s16 offen offset:2048  lds
    s_add_u32 s97, s98, s0
    s_lshr_b64 s[0:1], s[0:1], 4
    s_and_b32 s97, s97, 15
    s_lshr_b32 s99, s97, 3
    s_xor_b32 s97, s97, s99
    s_add_u32 m0, s87, 0
    s_lshl_b32 s97, s97, 7
    buffer_load_dwordx4 v240, s[28:31], s97 offen offset:0  lds
    buffer_load_dwordx4 v241, s[28:31], s97 offen offset:1024  lds
    buffer_load_dwordx4 v242, s[28:31], s97 offen offset:2048  lds
    buffer_load_dwordx4 v243, s[28:31], s97 offen offset:3072  lds
    s_add_u32 m0, s88, 0
    s_mov_b64 exec, 0xffffffff
    buffer_load_dwordx4 v3, s[28:31], s97 offen offset:0  lds
    s_mov_b64 exec, -1
    s_mul_i32 s16, s97, 3072
    s_add_u32 m0, s60, 0
    s_add_u32 s99, s16, s62
    buffer_load_dwordx4 v244, s[32:35], s99 offen offset:0  lds
    buffer_load_dwordx4 v245, s[32:35], s99 offen offset:1024  lds
    buffer_load_dwordx4 v246, s[32:35], s99 offen offset:2048  lds
    s_add_u32 m0, s61, 12288
    s_add_u32 s16, s16, s63
    buffer_load_dwordx4 v244, s[32:35], s16 offen offset:0  lds
    buffer_load_dwordx4 v245, s[32:35], s16 offen offset:1024  lds
    buffer_load_dwordx4 v246, s[32:35], s16 offen offset:2048  lds
    s_waitcnt vmcnt(11)
    s_barrier
    s_add_u32 s97, s98, s0
    s_lshr_b64 s[0:1], s[0:1], 4
    s_and_b32 s97, s97, 15
    s_lshr_b32 s99, s97, 3
    s_xor_b32 s97, s97, s99
    s_add_u32 m0, s87, 18432
    s_lshl_b32 s97, s97, 7
    buffer_load_dwordx4 v240, s[28:31], s97 offen offset:0  lds
    ds_read_b128 v[84:87], v35 offset:0
    ds_read_b128 v[88:91], v35 offset:16
    buffer_load_dwordx4 v241, s[28:31], s97 offen offset:1024  lds
    ds_read_b128 v[92:95], v35 offset:32
    buffer_load_dwordx4 v242, s[28:31], s97 offen offset:2048  lds
    ds_read_b128 v[96:99], v35 offset:48
    ds_read_b128 v[40:43], v233 offset:0
    buffer_load_dwordx4 v243, s[28:31], s97 offen offset:3072  lds
    ds_read_b128 v[44:47], v232 offset:256
    s_add_u32 m0, s88, 18432
    s_mov_b64 exec, 0xffffffff
    buffer_load_dwordx4 v3, s[28:31], s97 offen offset:0  lds
    s_mov_b64 exec, -1
    ds_read_b128 v[48:51], v233 offset:256
    s_mul_i32 s16, s97, 3072
    s_add_u32 m0, s60, 24576
    s_add_u32 s99, s16, s62
    buffer_load_dwordx4 v244, s[32:35], s99 offen offset:0  lds
    ds_read_b128 v[52:55], v16 offset:512
    ds_read_b128 v[56:59], v231 offset:512
    buffer_load_dwordx4 v245, s[32:35], s99 offen offset:1024  lds
    ds_read_b128 v[60:63], v16 offset:768
    buffer_load_dwordx4 v246, s[32:35], s99 offen offset:2048  lds
    ds_read_b128 v[64:67], v231 offset:768
    s_add_u32 m0, s61, 36864
    s_add_u32 s16, s16, s63
    buffer_load_dwordx4 v244, s[32:35], s16 offen offset:0  lds
    ds_read_b128 v[68:71], v16 offset:16896
    ds_read_b128 v[72:75], v231 offset:16896
    buffer_load_dwordx4 v245, s[32:35], s16 offen offset:1024  lds
    ds_read_b128 v[76:79], v16 offset:17152
    buffer_load_dwordx4 v246, s[32:35], s16 offen offset:2048  lds
    ds_read_b128 v[80:83], v231 offset:17152
    s_waitcnt vmcnt(11)
    s_waitcnt lgkmcnt(0)
    s_barrier
    s_add_u32 s97, s98, s0
    s_lshr_b64 s[0:1], s[0:1], 4
    s_and_b32 s97, s97, 15
    s_lshr_b32 s99, s97, 3
    s_xor_b32 s97, s97, s99
    s_add_u32 m0, s87, 36864
    s_lshl_b32 s97, s97, 7
    buffer_load_dwordx4 v240, s[28:31], s97 offen offset:0  lds
    v_lshlrev_b32 v116, 16, v40
    v_lshlrev_b32 v117, 16, v44
    v_lshlrev_b32 v118, 16, v48
    v_lshlrev_b32 v119, 16, v52
    v_lshlrev_b32 v120, 16, v56
    buffer_load_dwordx4 v241, s[28:31], s97 offen offset:1024  lds
    v_lshlrev_b32 v121, 16, v60
    v_lshlrev_b32 v122, 16, v64
    v_lshlrev_b32 v127, 16, v84
    v_and_b32 v128, 0xffff0000, v84
    v_lshlrev_b32 v129, 16, v85
    buffer_load_dwordx4 v242, s[28:31], s97 offen offset:2048  lds
    v_and_b32 v130, 0xffff0000, v85
    v_lshlrev_b32 v123, 16, v68
    v_lshlrev_b32 v124, 16, v72
    v_lshlrev_b32 v125, 16, v76
    v_lshlrev_b32 v126, 16, v80
    buffer_load_dwordx4 v243, s[28:31], s97 offen offset:3072  lds
    v_mul_f32 v131, v116, v130
    v_mul_f32 v132, v117, v130
    v_mul_f32 v133, v118, v130
    v_mul_f32 v134, v119, v130
    v_fmac_f32 v131, v117, v129
    s_add_u32 m0, s88, 36864
    s_mov_b64 exec, 0xffffffff
    buffer_load_dwordx4 v3, s[28:31], s97 offen offset:0  lds
    s_mov_b64 exec, -1
    v_fmac_f32 v132, v118, v129
    v_fmac_f32 v133, v119, v129
    v_fmac_f32 v134, v120, v129
    v_fmac_f32 v131, v118, v128
    v_fmac_f32 v132, v119, v128
    s_mul_i32 s16, s97, 3072
    s_add_u32 m0, s60, 49152
    s_add_u32 s99, s16, s62
    buffer_load_dwordx4 v244, s[32:35], s99 offen offset:0  lds
    v_fmac_f32 v133, v120, v128
    v_fmac_f32 v134, v121, v128
    v_fmac_f32 v131, v119, v127
    v_fmac_f32 v132, v120, v127
    v_fmac_f32 v133, v121, v127
    buffer_load_dwordx4 v245, s[32:35], s99 offen offset:1024  lds
    v_fmac_f32 v134, v122, v127
    v_mul_f32 v131, v131, v123
    v_mul_f32 v132, v132, v124
    v_mul_f32 v133, v133, v125
    v_mul_f32 v134, v134, v126
    buffer_load_dwordx4 v246, s[32:35], s99 offen offset:2048  lds
    v_cvt_pk_bf16_f32 v102, v134, v133
    v_cvt_pk_bf16_f32 v103, v132, v131
    v_lshlrev_b32 v116, 16, v42
    v_lshlrev_b32 v117, 16, v46
    v_lshlrev_b32 v118, 16, v50
    s_add_u32 m0, s61, 61440
    s_add_u32 s16, s16, s63
    buffer_load_dwordx4 v244, s[32:35], s16 offen offset:0  lds
    v_lshlrev_b32 v119, 16, v54
    v_lshlrev_b32 v120, 16, v58
    v_lshlrev_b32 v121, 16, v62
    v_lshlrev_b32 v122, 16, v66
    v_lshlrev_b32 v127, 16, v92
    buffer_load_dwordx4 v245, s[32:35], s16 offen offset:1024  lds
    v_and_b32 v128, 0xffff0000, v92
    v_lshlrev_b32 v129, 16, v93
    v_and_b32 v130, 0xffff0000, v93
    v_lshlrev_b32 v123, 16, v70
    v_lshlrev_b32 v124, 16, v74
    buffer_load_dwordx4 v246, s[32:35], s16 offen offset:2048  lds
    v_lshlrev_b32 v125, 16, v78
    v_lshlrev_b32 v126, 16, v82
    v_mul_f32 v131, v116, v130
    v_mul_f32 v132, v117, v130
    v_mul_f32 v133, v118, v130
    v_mul_f32 v134, v119, v130
    v_fmac_f32 v131, v117, v129
    v_fmac_f32 v132, v118, v129
    v_fmac_f32 v133, v119, v129
    v_fmac_f32 v134, v120, v129
    v_fmac_f32 v131, v118, v128
    v_fmac_f32 v132, v119, v128
    s_waitcnt vmcnt(11)
    s_barrier
    s_add_u32 s97, s98, s0
    s_lshr_b64 s[0:1], s[0:1], 4
    s_and_b32 s97, s97, 15
    s_lshr_b32 s99, s97, 3
    s_xor_b32 s97, s97, s99
    s_add_u32 m0, s87, 0
    s_lshl_b32 s97, s97, 7
    buffer_load_dwordx4 v240, s[28:31], s97 offen offset:0  lds
    v_fmac_f32 v133, v120, v128
    v_fmac_f32 v134, v121, v128
    v_fmac_f32 v131, v119, v127
    v_fmac_f32 v132, v120, v127
    v_fmac_f32 v133, v121, v127
    buffer_load_dwordx4 v241, s[28:31], s97 offen offset:1024  lds
    v_fmac_f32 v134, v122, v127
    v_mul_f32 v131, v131, v123
    v_mul_f32 v132, v132, v124
    v_mul_f32 v133, v133, v125
    v_mul_f32 v134, v134, v126
    buffer_load_dwordx4 v242, s[28:31], s97 offen offset:2048  lds
    v_cvt_pk_bf16_f32 v100, v134, v133
    v_cvt_pk_bf16_f32 v101, v132, v131
    s_nop 0
    v_permlane32_swap_b32 v102, v100
    v_permlane32_swap_b32 v103, v101
    s_mov_b32 s89, 0
    buffer_store_dwordx4 v[100:103], v12, s[52:55], s89 offen sc1
    buffer_load_dwordx4 v243, s[28:31], s97 offen offset:3072  lds
    v_and_b32 v116, 0xffff0000, v40
    v_and_b32 v117, 0xffff0000, v44
    v_and_b32 v118, 0xffff0000, v48
    v_and_b32 v119, 0xffff0000, v52
    v_and_b32 v120, 0xffff0000, v56
    s_add_u32 m0, s88, 0
    s_mov_b64 exec, 0xffffffff
    buffer_load_dwordx4 v3, s[28:31], s97 offen offset:0  lds
    s_mov_b64 exec, -1
    v_and_b32 v121, 0xffff0000, v60
    v_and_b32 v122, 0xffff0000, v64
    v_lshlrev_b32 v127, 16, v86
    v_and_b32 v128, 0xffff0000, v86
    v_lshlrev_b32 v129, 16, v87
    s_mul_i32 s16, s97, 3072
    s_add_u32 m0, s60, 0
    s_add_u32 s99, s16, s62
    buffer_load_dwordx4 v244, s[32:35], s99 offen offset:0  lds
    v_and_b32 v130, 0xffff0000, v87
    v_and_b32 v123, 0xffff0000, v68
    v_and_b32 v124, 0xffff0000, v72
    v_and_b32 v125, 0xffff0000, v76
    v_and_b32 v126, 0xffff0000, v80
    buffer_load_dwordx4 v245, s[32:35], s99 offen offset:1024  lds
    v_mul_f32 v131, v116, v130
    v_mul_f32 v132, v117, v130
    v_mul_f32 v133, v118, v130
    v_mul_f32 v134, v119, v130
    v_fmac_f32 v131, v117, v129
    buffer_load_dwordx4 v246, s[32:35], s99 offen offset:2048  lds
    v_fmac_f32 v132, v118, v129
    v_fmac_f32 v133, v119, v129
    v_fmac_f32 v134, v120, v129
    v_fmac_f32 v131, v118, v128
    v_fmac_f32 v132, v119, v128
    s_add_u32 m0, s61, 12288
    s_add_u32 s16, s16, s63
    buffer_load_dwordx4 v244, s[32:35], s16 offen offset:0  lds
    v_fmac_f32 v133, v120, v128
    v_fmac_f32 v134, v121, v128
    v_fmac_f32 v131, v119, v127
    v_fmac_f32 v132, v120, v127
    v_fmac_f32 v133, v121, v127
    buffer_load_dwordx4 v245, s[32:35], s16 offen offset:1024  lds
    v_fmac_f32 v134, v122, v127
    v_mul_f32 v131, v131, v123
    v_mul_f32 v132, v132, v124
    v_mul_f32 v133, v133, v125
    v_mul_f32 v134, v134, v126
    buffer_load_dwordx4 v246, s[32:35], s16 offen offset:2048  lds
    v_cvt_pk_bf16_f32 v106, v134, v133
    v_cvt_pk_bf16_f32 v107, v132, v131
    v_and_b32 v116, 0xffff0000, v42
    v_and_b32 v117, 0xffff0000, v46
    v_and_b32 v118, 0xffff0000, v50
    v_and_b32 v119, 0xffff0000, v54
    v_and_b32 v120, 0xffff0000, v58
    v_and_b32 v121, 0xffff0000, v62
    v_and_b32 v122, 0xffff0000, v66
    v_lshlrev_b32 v127, 16, v94
    v_and_b32 v128, 0xffff0000, v94
    v_lshlrev_b32 v129, 16, v95
    s_waitcnt vmcnt(12)
    s_barrier
    s_add_u32 s97, s98, s0
    s_lshr_b64 s[0:1], s[0:1], 4
    s_and_b32 s97, s97, 15
    s_lshr_b32 s99, s97, 3
    s_xor_b32 s97, s97, s99
    s_add_u32 m0, s87, 18432
    s_lshl_b32 s97, s97, 7
    buffer_load_dwordx4 v240, s[28:31], s97 offen offset:0  lds
    v_and_b32 v130, 0xffff0000, v95
    v_and_b32 v123, 0xffff0000, v70
    v_and_b32 v124, 0xffff0000, v74
    v_and_b32 v125, 0xffff0000, v78
    v_and_b32 v126, 0xffff0000, v82
    buffer_load_dwordx4 v241, s[28:31], s97 offen offset:1024  lds
    v_mul_f32 v131, v116, v130
    v_mul_f32 v132, v117, v130
    v_mul_f32 v133, v118, v130
    v_mul_f32 v134, v119, v130
    v_fmac_f32 v131, v117, v129
    buffer_load_dwordx4 v242, s[28:31], s97 offen offset:2048  lds
    v_fmac_f32 v132, v118, v129
    v_fmac_f32 v133, v119, v129
    v_fmac_f32 v134, v120, v129
    v_fmac_f32 v131, v118, v128
    v_fmac_f32 v132, v119, v128
    buffer_load_dwordx4 v243, s[28:31], s97 offen offset:3072  lds
    v_fmac_f32 v133, v120, v128
    v_fmac_f32 v134, v121, v128
    v_fmac_f32 v131, v119, v127
    v_fmac_f32 v132, v120, v127
    v_fmac_f32 v133, v121, v127
    s_add_u32 m0, s88, 18432
    s_mov_b64 exec, 0xffffffff
    buffer_load_dwordx4 v3, s[28:31], s97 offen offset:0  lds
    s_mov_b64 exec, -1
    v_fmac_f32 v134, v122, v127
    v_mul_f32 v131, v131, v123
    v_mul_f32 v132, v132, v124
    v_mul_f32 v133, v133, v125
    v_mul_f32 v134, v134, v126
    s_mul_i32 s16, s97, 3072
    s_add_u32 m0, s60, 24576
    s_add_u32 s99, s16, s62
    buffer_load_dwordx4 v244, s[32:35], s99 offen offset:0  lds
    v_cvt_pk_bf16_f32 v104, v134, v133
    v_cvt_pk_bf16_f32 v105, v132, v131
    s_nop 0
    v_permlane32_swap_b32 v106, v104
    v_permlane32_swap_b32 v107, v105
    s_mov_b32 s89, 16384
    buffer_store_dwordx4 v[104:107], v12, s[52:55], s89 offen sc1
    buffer_load_dwordx4 v245, s[32:35], s99 offen offset:1024  lds
    v_lshlrev_b32 v116, 16, v41
    v_lshlrev_b32 v117, 16, v45
    v_lshlrev_b32 v118, 16, v49
    v_lshlrev_b32 v119, 16, v53
    v_lshlrev_b32 v120, 16, v57
    buffer_load_dwordx4 v246, s[32:35], s99 offen offset:2048  lds
    v_lshlrev_b32 v121, 16, v61
    v_lshlrev_b32 v122, 16, v65
    v_lshlrev_b32 v127, 16, v88
    v_and_b32 v128, 0xffff0000, v88
    v_lshlrev_b32 v129, 16, v89
    s_add_u32 m0, s61, 36864
    s_add_u32 s16, s16, s63
    buffer_load_dwordx4 v244, s[32:35], s16 offen offset:0  lds
    v_and_b32 v130, 0xffff0000, v89
    v_lshlrev_b32 v123, 16, v69
    v_lshlrev_b32 v124, 16, v73
    v_lshlrev_b32 v125, 16, v77
    v_lshlrev_b32 v126, 16, v81
    buffer_load_dwordx4 v245, s[32:35], s16 offen offset:1024  lds
    v_mul_f32 v131, v116, v130
    v_mul_f32 v132, v117, v130
    v_mul_f32 v133, v118, v130
    v_mul_f32 v134, v119, v130
    v_fmac_f32 v131, v117, v129
    buffer_load_dwordx4 v246, s[32:35], s16 offen offset:2048  lds
    v_fmac_f32 v132, v118, v129
    v_fmac_f32 v133, v119, v129
    v_fmac_f32 v134, v120, v129
    v_fmac_f32 v131, v118, v128
    v_fmac_f32 v132, v119, v128
    v_fmac_f32 v133, v120, v128
    v_fmac_f32 v134, v121, v128
    v_fmac_f32 v131, v119, v127
    v_fmac_f32 v132, v120, v127
    v_fmac_f32 v133, v121, v127
    v_fmac_f32 v134, v122, v127
    v_mul_f32 v131, v131, v123
    s_waitcnt vmcnt(12)
    s_barrier
    s_add_u32 s97, s98, s0
    s_lshr_b64 s[0:1], s[0:1], 4
    s_and_b32 s97, s97, 15
    s_lshr_b32 s99, s97, 3
    s_xor_b32 s97, s97, s99
    s_add_u32 m0, s87, 36864
    s_lshl_b32 s97, s97, 7
    buffer_load_dwordx4 v240, s[28:31], s97 offen offset:0  lds
    v_mul_f32 v132, v132, v124
    v_mul_f32 v133, v133, v125
    v_mul_f32 v134, v134, v126
    v_cvt_pk_bf16_f32 v110, v134, v133
    v_cvt_pk_bf16_f32 v111, v132, v131
    buffer_load_dwordx4 v241, s[28:31], s97 offen offset:1024  lds
    v_lshlrev_b32 v116, 16, v43
    v_lshlrev_b32 v117, 16, v47
    v_lshlrev_b32 v118, 16, v51
    v_lshlrev_b32 v119, 16, v55
    v_lshlrev_b32 v120, 16, v59
    buffer_load_dwordx4 v242, s[28:31], s97 offen offset:2048  lds
    v_lshlrev_b32 v121, 16, v63
    v_lshlrev_b32 v122, 16, v67
    v_lshlrev_b32 v127, 16, v96
    v_and_b32 v128, 0xffff0000, v96
    v_lshlrev_b32 v129, 16, v97
    buffer_load_dwordx4 v243, s[28:31], s97 offen offset:3072  lds
    v_and_b32 v130, 0xffff0000, v97
    v_lshlrev_b32 v123, 16, v71
    v_lshlrev_b32 v124, 16, v75
    v_lshlrev_b32 v125, 16, v79
    v_lshlrev_b32 v126, 16, v83
    s_add_u32 m0, s88, 36864
    s_mov_b64 exec, 0xffffffff
    buffer_load_dwordx4 v3, s[28:31], s97 offen offset:0  lds
    s_mov_b64 exec, -1
    v_mul_f32 v131, v116, v130
    v_mul_f32 v132, v117, v130
    v_mul_f32 v133, v118, v130
    v_mul_f32 v134, v119, v130
    v_fmac_f32 v131, v117, v129
    s_mul_i32 s16, s97, 3072
    s_add_u32 m0, s60, 49152
    s_add_u32 s99, s16, s62
    buffer_load_dwordx4 v244, s[32:35], s99 offen offset:0  lds
    v_fmac_f32 v132, v118, v129
    v_fmac_f32 v133, v119, v129
    v_fmac_f32 v134, v120, v129
    v_fmac_f32 v131, v118, v128
    v_fmac_f32 v132, v119, v128
    buffer_load_dwordx4 v245, s[32:35], s99 offen offset:1024  lds
    v_fmac_f32 v133, v120, v128
    v_fmac_f32 v134, v121, v128
    v_fmac_f32 v131, v119, v127
    v_fmac_f32 v132, v120, v127
    v_fmac_f32 v133, v121, v127
    buffer_load_dwordx4 v246, s[32:35], s99 offen offset:2048  lds
    v_fmac_f32 v134, v122, v127
    v_mul_f32 v131, v131, v123
    v_mul_f32 v132, v132, v124
    v_mul_f32 v133, v133, v125
    v_mul_f32 v134, v134, v126
    s_add_u32 m0, s61, 61440
    s_add_u32 s16, s16, s63
    buffer_load_dwordx4 v244, s[32:35], s16 offen offset:0  lds
    v_cvt_pk_bf16_f32 v108, v134, v133
    v_cvt_pk_bf16_f32 v109, v132, v131
    s_nop 0
    v_permlane32_swap_b32 v110, v108
    v_permlane32_swap_b32 v111, v109
    s_mov_b32 s89, 32768
    buffer_store_dwordx4 v[108:111], v12, s[52:55], s89 offen sc1
    buffer_load_dwordx4 v245, s[32:35], s16 offen offset:1024  lds
    v_and_b32 v116, 0xffff0000, v41
    v_and_b32 v117, 0xffff0000, v45
    v_and_b32 v118, 0xffff0000, v49
    v_and_b32 v119, 0xffff0000, v53
    v_and_b32 v120, 0xffff0000, v57
    buffer_load_dwordx4 v246, s[32:35], s16 offen offset:2048  lds
    v_and_b32 v121, 0xffff0000, v61
    v_and_b32 v122, 0xffff0000, v65
    v_lshlrev_b32 v127, 16, v90
    v_and_b32 v128, 0xffff0000, v90
    v_lshlrev_b32 v129, 16, v91
    v_and_b32 v130, 0xffff0000, v91
    v_and_b32 v123, 0xffff0000, v69
    v_and_b32 v124, 0xffff0000, v73
    v_and_b32 v125, 0xffff0000, v77
    v_and_b32 v126, 0xffff0000, v81
    v_mul_f32 v131, v116, v130
    v_mul_f32 v132, v117, v130
    s_waitcnt vmcnt(12)
    s_barrier
    s_add_u32 s97, s98, s0
    s_lshr_b64 s[0:1], s[0:1], 4
    s_and_b32 s97, s97, 15
    s_lshr_b32 s99, s97, 3
    s_xor_b32 s97, s97, s99
    s_add_u32 m0, s87, 0
    s_lshl_b32 s97, s97, 7
    buffer_load_dwordx4 v240, s[28:31], s97 offen offset:0  lds
    v_mul_f32 v133, v118, v130
    v_mul_f32 v134, v119, v130
    v_fmac_f32 v131, v117, v129
    v_fmac_f32 v132, v118, v129
    v_fmac_f32 v133, v119, v129
    buffer_load_dwordx4 v241, s[28:31], s97 offen offset:1024  lds
    v_fmac_f32 v134, v120, v129
    v_fmac_f32 v131, v118, v128
    v_fmac_f32 v132, v119, v128
    v_fmac_f32 v133, v120, v128
    v_fmac_f32 v134, v121, v128
    buffer_load_dwordx4 v242, s[28:31], s97 offen offset:2048  lds
    v_fmac_f32 v131, v119, v127
    v_fmac_f32 v132, v120, v127
    v_fmac_f32 v133, v121, v127
    v_fmac_f32 v134, v122, v127
    v_mul_f32 v131, v131, v123
    buffer_load_dwordx4 v243, s[28:31], s97 offen offset:3072  lds
    v_mul_f32 v132, v132, v124
    v_mul_f32 v133, v133, v125
    v_mul_f32 v134, v134, v126
    v_cvt_pk_bf16_f32 v114, v134, v133
    v_cvt_pk_bf16_f32 v115, v132, v131
    s_add_u32 m0, s88, 0
    s_mov_b64 exec, 0xffffffff
    buffer_load_dwordx4 v3, s[28:31], s97 offen offset:0  lds
    s_mov_b64 exec, -1
    v_and_b32 v116, 0xffff0000, v43
    v_and_b32 v117, 0xffff0000, v47
    v_and_b32 v118, 0xffff0000, v51
    v_and_b32 v119, 0xffff0000, v55
    v_and_b32 v120, 0xffff0000, v59
    s_mul_i32 s16, s97, 3072
    s_add_u32 m0, s60, 0
    s_add_u32 s99, s16, s62
    buffer_load_dwordx4 v244, s[32:35], s99 offen offset:0  lds
    v_and_b32 v121, 0xffff0000, v63
    v_and_b32 v122, 0xffff0000, v67
    v_lshlrev_b32 v127, 16, v98
    v_and_b32 v128, 0xffff0000, v98
    v_lshlrev_b32 v129, 16, v99
    buffer_load_dwordx4 v245, s[32:35], s99 offen offset:1024  lds
    v_and_b32 v130, 0xffff0000, v99
    v_and_b32 v123, 0xffff0000, v71
    v_and_b32 v124, 0xffff0000, v75
    v_and_b32 v125, 0xffff0000, v79
    v_and_b32 v126, 0xffff0000, v83
    buffer_load_dwordx4 v246, s[32:35], s99 offen offset:2048  lds
    v_mul_f32 v131, v116, v130
    v_mul_f32 v132, v117, v130
    v_mul_f32 v133, v118, v130
    v_mul_f32 v134, v119, v130
    v_fmac_f32 v131, v117, v129
    s_add_u32 m0, s61, 12288
    s_add_u32 s16, s16, s63
    buffer_load_dwordx4 v244, s[32:35], s16 offen offset:0  lds
    v_fmac_f32 v132, v118, v129
    v_fmac_f32 v133, v119, v129
    v_fmac_f32 v134, v120, v129
    v_fmac_f32 v131, v118, v128
    v_fmac_f32 v132, v119, v128
    buffer_load_dwordx4 v245, s[32:35], s16 offen offset:1024  lds
    v_fmac_f32 v133, v120, v128
    v_fmac_f32 v134, v121, v128
    v_fmac_f32 v131, v119, v127
    v_fmac_f32 v132, v120, v127
    v_fmac_f32 v133, v121, v127
    buffer_load_dwordx4 v246, s[32:35], s16 offen offset:2048  lds
    v_fmac_f32 v134, v122, v127
    v_mul_f32 v131, v131, v123
    v_mul_f32 v132, v132, v124
    v_mul_f32 v133, v133, v125
    v_mul_f32 v134, v134, v126
    v_cvt_pk_bf16_f32 v112, v134, v133
    v_cvt_pk_bf16_f32 v113, v132, v131
    s_nop 0
    v_permlane32_swap_b32 v114, v112
    v_permlane32_swap_b32 v115, v113
    s_mov_b32 s89, 49152
    buffer_store_dwordx4 v[112:115], v12, s[52:55], s89 offen sc1
    s_waitcnt vmcnt(12)
    s_barrier
    s_add_u32 m0, s94, 32
    s_lshl_b32 s89, s90, 12
    buffer_load_dwordx4 v15, s[48:51], s89 offen offset:0 nt lds
    s_add_u32 m0, s94, 32
    s_lshl_b32 s89, s90, 12
    buffer_load_dwordx4 v15, s[48:51], s89 offen offset:1024 nt lds
    s_add_u32 m0, s94, 32
    s_lshl_b32 s89, s90, 12
    buffer_load_dwordx4 v15, s[48:51], s89 offen offset:2048 nt lds
    s_add_u32 m0, s94, 32
    s_lshl_b32 s89, s90, 12
    buffer_load_dwordx4 v15, s[48:51], s89 offen offset:3072 nt lds
    s_add_u32 s97, s98, s0
    s_lshr_b64 s[0:1], s[0:1], 4
    s_and_b32 s97, s97, 15
    s_lshr_b32 s99, s97, 3
    s_xor_b32 s97, s97, s99
    s_add_u32 m0, s87, 18432
    s_lshl_b32 s97, s97, 7
    buffer_load_dwordx4 v240, s[28:31], s97 offen offset:0  lds
    buffer_load_dwordx4 v241, s[28:31], s97 offen offset:1024  lds
    buffer_load_dwordx4 v242, s[28:31], s97 offen offset:2048  lds
    buffer_load_dwordx4 v243, s[28:31], s97 offen offset:3072  lds
    s_add_u32 m0, s88, 18432
    s_mov_b64 exec, 0xffffffff
    buffer_load_dwordx4 v3, s[28:31], s97 offen offset:0  lds
    s_mov_b64 exec, -1
    s_mul_i32 s16, s97, 3072
    s_add_u32 m0, s60, 24576
    s_add_u32 s99, s16, s62
    buffer_load_dwordx4 v244, s[32:35], s99 offen offset:0  lds
    buffer_load_dwordx4 v245, s[32:35], s99 offen offset:1024  lds
    buffer_load_dwordx4 v246, s[32:35], s99 offen offset:2048  lds
    s_add_u32 m0, s61, 36864
    s_add_u32 s16, s16, s63
    buffer_load_dwordx4 v244, s[32:35], s16 offen offset:0  lds
    buffer_load_dwordx4 v245, s[32:35], s16 offen offset:1024  lds
    buffer_load_dwordx4 v246, s[32:35], s16 offen offset:2048  lds
    s_waitcnt vmcnt(16)
    s_waitcnt vmcnt(15)
    s_barrier
    s_add_u32 s97, s98, s0
    s_lshr_b64 s[0:1], s[0:1], 4
    s_and_b32 s97, s97, 15
    s_lshr_b32 s99, s97, 3
    s_xor_b32 s97, s97, s99
    s_add_u32 m0, s87, 36864
    s_lshl_b32 s97, s97, 7
    buffer_load_dwordx4 v240, s[28:31], s97 offen offset:0  lds
    buffer_load_dwordx4 v241, s[28:31], s97 offen offset:1024  lds
    buffer_load_dwordx4 v242, s[28:31], s97 offen offset:2048  lds
    buffer_load_dwordx4 v243, s[28:31], s97 offen offset:3072  lds
    s_add_u32 m0, s88, 36864
    s_mov_b64 exec, 0xffffffff
    buffer_load_dwordx4 v3, s[28:31], s97 offen offset:0  lds
    s_mov_b64 exec, -1
    s_mul_i32 s16, s97, 3072
    s_add_u32 m0, s60, 49152
    s_add_u32 s99, s16, s62
    buffer_load_dwordx4 v244, s[32:35], s99 offen offset:0  lds
    buffer_load_dwordx4 v245, s[32:35], s99 offen offset:1024  lds
    buffer_load_dwordx4 v246, s[32:35], s99 offen offset:2048  lds
    s_add_u32 m0, s61, 61440
    s_add_u32 s16, s16, s63
    buffer_load_dwordx4 v244, s[32:35], s16 offen offset:0  lds
    buffer_load_dwordx4 v245, s[32:35], s16 offen offset:1024  lds
    buffer_load_dwordx4 v246, s[32:35], s16 offen offset:2048  lds
    s_waitcnt vmcnt(11)
    s_barrier
    s_add_u32 s97, s98, s0
    s_lshr_b64 s[0:1], s[0:1], 4
    s_and_b32 s97, s97, 15
    s_lshr_b32 s99, s97, 3
    s_xor_b32 s97, s97, s99
    s_add_u32 m0, s87, 0
    s_lshl_b32 s97, s97, 7
    buffer_load_dwordx4 v240, s[28:31], s97 offen offset:0  lds
    v_add_u32 v5, s94, v15
    ds_read_b128 v[140:143], v5 offset:32
    ds_read_b32 v156, v5 offset:48
    ds_read_b128 v[144:147], v5 offset:1056
    buffer_load_dwordx4 v241, s[28:31], s97 offen offset:1024  lds
    ds_read_b32 v157, v5 offset:1072
    ds_read_b128 v[148:151], v5 offset:2080
    ds_read_b32 v158, v5 offset:2096
    buffer_load_dwordx4 v242, s[28:31], s97 offen offset:2048  lds
    ds_read_b128 v[152:155], v5 offset:3104
    ds_read_b32 v159, v5 offset:3120
    v_lshrrev_b32 v6, 3, v0
    buffer_load_dwordx4 v243, s[28:31], s97 offen offset:3072  lds
    v_mul_u32_u24 v6, 4160, v6
    v_and_b32 v7, 7, v0
    v_lshl_add_u32 v6, v7, 2, v6
    v_add_u32 v6, s94, v6
    s_add_u32 m0, s88, 0
    s_mov_b64 exec, 0xffffffff
    buffer_load_dwordx4 v3, s[28:31], s97 offen offset:0  lds
    s_mov_b64 exec, -1
    v_mov_b32 v7, 0
    s_waitcnt lgkmcnt(0)
    v_readfirstlane_b32 s93, v140
    s_mul_i32 s16, s97, 3072
    s_add_u32 m0, s60, 0
    s_add_u32 s99, s16, s62
    buffer_load_dwordx4 v244, s[32:35], s99 offen offset:0  lds
    s_lshl_b32 s93, s93, 16
    v_writelane_b32 v7, s93, 15
    v_alignbit_b32 v140, v141, v140, 16
    buffer_load_dwordx4 v245, s[32:35], s99 offen offset:1024  lds
    v_alignbit_b32 v141, v142, v141, 16
    v_alignbit_b32 v142, v143, v142, 16
    v_alignbit_b32 v143, v156, v143, 16
    v_alignbit_b32 v144, v145, v144, 16
    buffer_load_dwordx4 v246, s[32:35], s99 offen offset:2048  lds
    v_alignbit_b32 v145, v146, v145, 16
    v_alignbit_b32 v146, v147, v146, 16
    v_alignbit_b32 v147, v157, v147, 16
    s_add_u32 m0, s61, 12288
    s_add_u32 s16, s16, s63
    buffer_load_dwordx4 v244, s[32:35], s16 offen offset:0  lds
    v_alignbit_b32 v148, v149, v148, 16
    v_alignbit_b32 v149, v150, v149, 16
    v_alignbit_b32 v150, v151, v150, 16
    buffer_load_dwordx4 v245, s[32:35], s16 offen offset:1024  lds
    v_alignbit_b32 v151, v158, v151, 16
    v_alignbit_b32 v152, v153, v152, 16
    v_alignbit_b32 v153, v154, v153, 16
    v_alignbit_b32 v154, v155, v154, 16
    buffer_load_dwordx4 v246, s[32:35], s16 offen offset:2048  lds
    v_alignbit_b32 v155, v159, v155, 16
    v_lshlrev_b32 v8, 3, v0
    s_add_u32 s78, s88, 18432
    s_mov_b64 exec, 0xff
    buffer_load_dword v136, v33, s[68:71], 0 offen sc1
    buffer_load_dword v137, v34, s[52:55], 0 offen sc1
    s_mov_b64 exec, -1
    v_add_u32 v8, s78, v8
    v_mov_b32 v156, 0
    v_mov_b32 v157, 0
    s_waitcnt vmcnt(13)
    s_barrier
    s_waitcnt vmcnt(0)
LA_j:
    s_mov_b64 exec, 1
    ds_add_u32 v18, v19 offset:24
    s_mov_b64 exec, -1
    s_mov_b64 exec, 0xff
    v_cmp_ne_u32 vcc, v136, v137
    v_cmp_gt_u32 s[80:81], s96, v136
    s_nop 0
    s_or_b64 vcc, vcc, s[80:81]
    s_cbranch_vccnz LA_slow
LA_back:
    s_mov_b64 exec, -1
    s_add_u32 m0, s86, 94208
    s_add_u32 s89, s91, 0
    buffer_load_dwordx4 v14, s[52:55], s89 offen sc1 lds
    s_add_u32 m0, s86, 98304
    s_add_u32 s89, s91, 4096
    buffer_load_dwordx4 v14, s[52:55], s89 offen sc1 lds
    s_add_u32 m0, s86, 102400
    s_add_u32 s89, s91, 8192
    buffer_load_dwordx4 v14, s[52:55], s89 offen sc1 lds
    s_add_u32 m0, s86, 106496
    s_add_u32 s89, s91, 12288
    buffer_load_dwordx4 v14, s[52:55], s89 offen sc1 lds
    s_mov_b64 exec, 0xffff
    ds_write_b32 v6, v7
    s_mov_b64 exec, -1
    ds_write_b128 v5, v[140:143] offset:4192
    ds_write_b128 v5, v[144:147] offset:5216
    ds_write_b128 v5, v[148:151] offset:6240
    ds_write_b128 v5, v[152:155] offset:7264
    ds_write_b64 v8, v[156:157]
    ds_read2_b32 v[68:69], v21 offset0:0 offset1:1
    ds_read2_b32 v[70:71], v21 offset0:2 offset1:3
    ds_read2_b32 v[72:73], v21 offset0:128 offset1:129
    ds_read2_b32 v[74:75], v21 offset0:130 offset1:131
    ds_read2_b32 v[76:77], v22 offset0:0 offset1:1
    ds_read2_b32 v[78:79], v22 offset0:2 offset1:3
    ds_read2_b32 v[80:81], v22 offset0:128 offset1:129
    ds_read2_b32 v[82:83], v22 offset0:130 offset1:131
    ds_read2_b32 v[84:85], v23 offset0:0 offset1:1
    ds_read2_b32 v[86:87], v23 offset0:2 offset1:3
    ds_read2_b32 v[88:89], v23 offset0:128 offset1:129
    ds_read2_b32 v[90:91], v23 offset0:130 offset1:131
    ds_read2_b32 v[92:93], v24 offset0:0 offset1:1
    ds_read2_b32 v[94:95], v24 offset0:2 offset1:3
    ds_read2_b32 v[96:97], v24 offset0:128 offset1:129
    ds_read2_b32 v[98:99], v24 offset0:130 offset1:131
    s_waitcnt vmcnt(0)
    s_mov_b64 exec, 1
    ds_add_u32 v18, v19 offset:20
    s_mov_b64 exec, -1
    buffer_load_dwordx4 v[212:215], v9, s[56:59], 0 offen offset:0 nt
    buffer_load_dwordx4 v[216:219], v9, s[56:59], 0 offen offset:2048 nt
    buffer_load_dwordx4 v[220:223], v9, s[56:59], s96 offen offset:0 nt
    buffer_load_dwordx4 v[224:227], v9, s[56:59], s96 offen offset:2048 nt
    s_branch LA_s5_in
LA_s5:
    s_sleep 1
LA_s5_in:
    ds_read_b32 v6, v18 offset:20
    s_waitcnt lgkmcnt(0)
    v_readfirstlane_b32 s78, v6
    s_nop 0
    s_cmp_ge_u32 s78, 4
    s_cbranch_scc0 LA_s5
    s_mov_b64 exec, 1
    ds_add_u32 v18, v19 offset:8
    s_mov_b64 exec, -1
    ds_read_b128 v[100:103], v25 offset:0
    ds_read_b128 v[104:107], v25 offset:2048
    ds_read_b128 v[108:111], v25 offset:4096
    ds_read_b128 v[112:115], v25 offset:6144
    ds_read_b128 v[116:119], v25 offset:8192
    ds_read_b128 v[120:123], v25 offset:10240
    ds_read_b128 v[124:127], v25 offset:12288
    ds_read_b128 v[128:131], v25 offset:14336
    s_setprio 2
    s_waitcnt lgkmcnt(7)
    v_mfma_f32_16x16x32_bf16 v[36:39], v[236:239], v[100:103], 0
    ds_read2_b32 v[132:133], v21 offset0:16 offset1:17
    s_waitcnt lgkmcnt(7)
    v_mfma_f32_16x16x32_bf16 v[40:43], v[236:239], v[104:107], 0
    ds_read2_b32 v[134:135], v21 offset0:18 offset1:19
    s_waitcnt lgkmcnt(7)
    v_mfma_f32_16x16x32_bf16 v[44:47], v[236:239], v[108:111], 0
    s_waitcnt lgkmcnt(6)
    v_mfma_f32_16x16x32_bf16 v[48:51], v[236:239], v[112:115], 0
    ds_read_b128 v[164:167], v26 offset:0
    s_waitcnt lgkmcnt(6)
    v_mfma_f32_16x16x32_bf16 v[52:55], v[236:239], v[116:119], 0
    s_waitcnt lgkmcnt(5)
    v_mfma_f32_16x16x32_bf16 v[56:59], v[236:239], v[120:123], 0
    ds_read_b128 v[168:171], v26 offset:2048
    s_waitcnt lgkmcnt(5)
    v_mfma_f32_16x16x32_bf16 v[60:63], v[236:239], v[124:127], 0
    ds_read_b128 v[172:175], v26 offset:4096
    s_waitcnt lgkmcnt(5)
    v_mfma_f32_16x16x32_bf16 v[64:67], v[236:239], v[128:131], 0
    v_mfma_f32_16x16x32_bf16 v[36:39], v[68:71], v[100:103], v[36:39]
    ds_read_b128 v[176:179], v26 offset:6144
    v_mfma_f32_16x16x32_bf16 v[40:43], v[68:71], v[104:107], v[40:43]
    v_mfma_f32_16x16x32_bf16 v[44:47], v[68:71], v[108:111], v[44:47]
    ds_read_b128 v[180:183], v26 offset:8192
    v_mfma_f32_16x16x32_bf16 v[48:51], v[68:71], v[112:115], v[48:51]
    ds_read_b128 v[184:187], v26 offset:10240
    v_mfma_f32_16x16x32_bf16 v[52:55], v[68:71], v[116:119], v[52:55]
    v_mfma_f32_16x16x32_bf16 v[56:59], v[68:71], v[120:123], v[56:59]
    ds_read_b128 v[188:191], v26 offset:12288
    v_mfma_f32_16x16x32_bf16 v[60:63], v[68:71], v[124:127], v[60:63]
    v_mfma_f32_16x16x32_bf16 v[64:67], v[68:71], v[128:131], v[64:67]
    ds_read_b128 v[192:195], v26 offset:14336
    v_mfma_f32_16x16x32_bf16 v[40:43], v[72:75], v[100:103], v[40:43]
    ds_read2_b32 v[136:137], v21 offset0:144 offset1:145
    v_mfma_f32_16x16x32_bf16 v[44:47], v[72:75], v[104:107], v[44:47]
    v_mfma_f32_16x16x32_bf16 v[48:51], v[72:75], v[108:111], v[48:51]
    ds_read2_b32 v[138:139], v21 offset0:146 offset1:147
    v_mfma_f32_16x16x32_bf16 v[52:55], v[72:75], v[112:115], v[52:55]
    v_mfma_f32_16x16x32_bf16 v[56:59], v[72:75], v[116:119], v[56:59]
    ds_read2_b32 v[140:141], v22 offset0:16 offset1:17
    v_mfma_f32_16x16x32_bf16 v[60:63], v[72:75], v[120:123], v[60:63]
    ds_read2_b32 v[142:143], v22 offset0:18 offset1:19
    v_mfma_f32_16x16x32_bf16 v[64:67], v[72:75], v[124:127], v[64:67]
    v_mfma_f32_16x16x32_bf16 v[44:47], v[76:79], v[100:103], v[44:47]
    ds_read2_b32 v[144:145], v22 offset0:144 offset1:145
    v_mfma_f32_16x16x32_bf16 v[48:51], v[76:79], v[104:107], v[48:51]
    v_mfma_f32_16x16x32_bf16 v[52:55], v[76:79], v[108:111], v[52:55]
    ds_read2_b32 v[146:147], v22 offset0:146 offset1:147
    v_mfma_f32_16x16x32_bf16 v[56:59], v[76:79], v[112:115], v[56:59]
    ds_read2_b32 v[148:149], v23 offset0:16 offset1:17
    v_mfma_f32_16x16x32_bf16 v[60:63], v[76:79], v[116:119], v[60:63]
    v_mfma_f32_16x16x32_bf16 v[64:67], v[76:79], v[120:123], v[64:67]
    ds_read2_b32 v[150:151], v23 offset0:18 offset1:19
    v_mfma_f32_16x16x32_bf16 v[48:51], v[80:83], v[100:103], v[48:51]
    v_mfma_f32_16x16x32_bf16 v[52:55], v[80:83], v[104:107], v[52:55]
    ds_read2_b32 v[152:153], v23 offset0:144 offset1:145
    v_mfma_f32_16x16x32_bf16 v[56:59], v[80:83], v[108:111], v[56:59]
    ds_read2_b32 v[154:155], v23 offset0:146 offset1:147
    v_mfma_f32_16x16x32_bf16 v[60:63], v[80:83], v[112:115], v[60:63]
    v_mfma_f32_16x16x32_bf16 v[64:67], v[80:83], v[116:119], v[64:67]
    ds_read2_b32 v[156:157], v24 offset0:16 offset1:17
    v_mfma_f32_16x16x32_bf16 v[52:55], v[84:87], v[100:103], v[52:55]
    v_mfma_f32_16x16x32_bf16 v[56:59], v[84:87], v[104:107], v[56:59]
    ds_read2_b32 v[158:159], v24 offset0:18 offset1:19
    v_mfma_f32_16x16x32_bf16 v[60:63], v[84:87], v[108:111], v[60:63]
    ds_read2_b32 v[160:161], v24 offset0:144 offset1:145
    v_mfma_f32_16x16x32_bf16 v[64:67], v[84:87], v[112:115], v[64:67]
    v_mfma_f32_16x16x32_bf16 v[56:59], v[88:91], v[100:103], v[56:59]
    ds_read2_b32 v[162:163], v24 offset0:146 offset1:147
    v_mfma_f32_16x16x32_bf16 v[60:63], v[88:91], v[104:107], v[60:63]
    v_mfma_f32_16x16x32_bf16 v[64:67], v[88:91], v[108:111], v[64:67]
    v_mfma_f32_16x16x32_bf16 v[60:63], v[92:95], v[100:103], v[60:63]
    v_mfma_f32_16x16x32_bf16 v[64:67], v[92:95], v[104:107], v[64:67]
    v_mfma_f32_16x16x32_bf16 v[64:67], v[96:99], v[100:103], v[64:67]
    s_waitcnt lgkmcnt(14)
    v_mfma_f32_16x16x32_bf16 v[36:39], v[132:135], v[164:167], v[36:39]
    ds_read2_b32 v[68:69], v21 offset0:32 offset1:33
    v_mfma_f32_16x16x32_bf16 v[40:43], v[132:135], v[168:171], v[40:43]
    ds_read2_b32 v[70:71], v21 offset0:34 offset1:35
    v_mfma_f32_16x16x32_bf16 v[44:47], v[132:135], v[172:175], v[44:47]
    ds_read_b128 v[100:103], v27 offset:0
    v_mfma_f32_16x16x32_bf16 v[48:51], v[132:135], v[176:179], v[48:51]
    v_mfma_f32_16x16x32_bf16 v[52:55], v[132:135], v[180:183], v[52:55]
    ds_read_b128 v[104:107], v27 offset:2048
    v_mfma_f32_16x16x32_bf16 v[56:59], v[132:135], v[184:187], v[56:59]
    ds_read_b128 v[108:111], v27 offset:4096
    v_mfma_f32_16x16x32_bf16 v[60:63], v[132:135], v[188:191], v[60:63]
    ds_read_b128 v[112:115], v27 offset:6144
    v_mfma_f32_16x16x32_bf16 v[64:67], v[132:135], v[192:195], v[64:67]
    s_waitcnt lgkmcnt(14)
    v_mfma_f32_16x16x32_bf16 v[40:43], v[136:139], v[164:167], v[40:43]
    ds_read_b128 v[116:119], v27 offset:8192
    v_mfma_f32_16x16x32_bf16 v[44:47], v[136:139], v[168:171], v[44:47]
    ds_read_b128 v[120:123], v27 offset:10240
    v_mfma_f32_16x16x32_bf16 v[48:51], v[136:139], v[172:175], v[48:51]
    ds_read_b128 v[124:127], v27 offset:12288
    v_mfma_f32_16x16x32_bf16 v[52:55], v[136:139], v[176:179], v[52:55]
    v_mfma_f32_16x16x32_bf16 v[56:59], v[136:139], v[180:183], v[56:59]
    ds_read_b128 v[128:131], v27 offset:14336
    v_mfma_f32_16x16x32_bf16 v[60:63], v[136:139], v[184:187], v[60:63]
    ds_read2_b32 v[72:73], v21 offset0:160 offset1:161
    v_mfma_f32_16x16x32_bf16 v[64:67], v[136:139], v[188:191], v[64:67]
    ds_read2_b32 v[74:75], v21 offset0:162 offset1:163
    v_mfma_f32_16x16x32_bf16 v[44:47], v[140:143], v[164:167], v[44:47]
    v_mfma_f32_16x16x32_bf16 v[48:51], v[140:143], v[168:171], v[48:51]
    ds_read2_b32 v[76:77], v22 offset0:32 offset1:33
    v_mfma_f32_16x16x32_bf16 v[52:55], v[140:143], v[172:175], v[52:55]
    ds_read2_b32 v[78:79], v22 offset0:34 offset1:35
    v_mfma_f32_16x16x32_bf16 v[56:59], v[140:143], v[176:179], v[56:59]
    ds_read2_b32 v[80:81], v22 offset0:160 offset1:161
    v_mfma_f32_16x16x32_bf16 v[60:63], v[140:143], v[180:183], v[60:63]
    v_mfma_f32_16x16x32_bf16 v[64:67], v[140:143], v[184:187], v[64:67]
    ds_read2_b32 v[82:83], v22 offset0:162 offset1:163
    v_mfma_f32_16x16x32_bf16 v[48:51], v[144:147], v[164:167], v[48:51]
    ds_read2_b32 v[84:85], v23 offset0:32 offset1:33
    v_mfma_f32_16x16x32_bf16 v[52:55], v[144:147], v[168:171], v[52:55]
    ds_read2_b32 v[86:87], v23 offset0:34 offset1:35
    v_mfma_f32_16x16x32_bf16 v[56:59], v[144:147], v[172:175], v[56:59]
    v_mfma_f32_16x16x32_bf16 v[60:63], v[144:147], v[176:179], v[60:63]
    ds_read2_b32 v[88:89], v23 offset0:160 offset1:161
    v_mfma_f32_16x16x32_bf16 v[64:67], v[144:147], v[180:183], v[64:67]
    ds_read2_b32 v[90:91], v23 offset0:162 offset1:163
    s_waitcnt lgkmcnt(14)
    v_mfma_f32_16x16x32_bf16 v[52:55], v[148:151], v[164:167], v[52:55]
    ds_read2_b32 v[92:93], v24 offset0:32 offset1:33
    v_mfma_f32_16x16x32_bf16 v[56:59], v[148:151], v[168:171], v[56:59]
    v_mfma_f32_16x16x32_bf16 v[60:63], v[148:151], v[172:175], v[60:63]
    ds_read2_b32 v[94:95], v24 offset0:34 offset1:35
    v_mfma_f32_16x16x32_bf16 v[64:67], v[148:151], v[176:179], v[64:67]
    ds_read2_b32 v[96:97], v24 offset0:160 offset1:161
    v_mfma_f32_16x16x32_bf16 v[56:59], v[152:155], v[164:167], v[56:59]
    ds_read2_b32 v[98:99], v24 offset0:162 offset1:163
    v_mfma_f32_16x16x32_bf16 v[60:63], v[152:155], v[168:171], v[60:63]
    v_mfma_f32_16x16x32_bf16 v[64:67], v[152:155], v[172:175], v[64:67]
    v_mfma_f32_16x16x32_bf16 v[60:63], v[156:159], v[164:167], v[60:63]
    v_mfma_f32_16x16x32_bf16 v[64:67], v[156:159], v[168:171], v[64:67]
    v_mfma_f32_16x16x32_bf16 v[64:67], v[160:163], v[164:167], v[64:67]
    v_mfma_f32_16x16x32_bf16 v[36:39], v[68:71], v[100:103], v[36:39]
    ds_read2_b32 v[132:133], v21 offset0:48 offset1:49
    v_mfma_f32_16x16x32_bf16 v[40:43], v[68:71], v[104:107], v[40:43]
    ds_read2_b32 v[134:135], v21 offset0:50 offset1:51
    v_mfma_f32_16x16x32_bf16 v[44:47], v[68:71], v[108:111], v[44:47]
    ds_read_b128 v[164:167], v28 offset:0
    v_mfma_f32_16x16x32_bf16 v[48:51], v[68:71], v[112:115], v[48:51]
    s_waitcnt lgkmcnt(14)
    v_mfma_f32_16x16x32_bf16 v[52:55], v[68:71], v[116:119], v[52:55]
    ds_read_b128 v[168:171], v28 offset:2048
    v_mfma_f32_16x16x32_bf16 v[56:59], v[68:71], v[120:123], v[56:59]
    ds_read_b128 v[172:175], v28 offset:4096
    v_mfma_f32_16x16x32_bf16 v[60:63], v[68:71], v[124:127], v[60:63]
    ds_read_b128 v[176:179], v28 offset:6144
    v_mfma_f32_16x16x32_bf16 v[64:67], v[68:71], v[128:131], v[64:67]
    v_mfma_f32_16x16x32_bf16 v[40:43], v[72:75], v[100:103], v[40:43]
    ds_read_b128 v[180:183], v28 offset:8192
    v_mfma_f32_16x16x32_bf16 v[44:47], v[72:75], v[104:107], v[44:47]
    ds_read_b128 v[184:187], v28 offset:10240
    v_mfma_f32_16x16x32_bf16 v[48:51], v[72:75], v[108:111], v[48:51]
    ds_read_b128 v[188:191], v28 offset:12288
    v_mfma_f32_16x16x32_bf16 v[52:55], v[72:75], v[112:115], v[52:55]
    v_mfma_f32_16x16x32_bf16 v[56:59], v[72:75], v[116:119], v[56:59]
    ds_read_b128 v[192:195], v28 offset:14336
    v_mfma_f32_16x16x32_bf16 v[60:63], v[72:75], v[120:123], v[60:63]
    ds_read2_b32 v[136:137], v21 offset0:176 offset1:177
    v_mfma_f32_16x16x32_bf16 v[64:67], v[72:75], v[124:127], v[64:67]
    ds_read2_b32 v[138:139], v21 offset0:178 offset1:179
    s_waitcnt lgkmcnt(14)
    v_mfma_f32_16x16x32_bf16 v[44:47], v[76:79], v[100:103], v[44:47]
    v_mfma_f32_16x16x32_bf16 v[48:51], v[76:79], v[104:107], v[48:51]
    ds_read2_b32 v[140:141], v22 offset0:48 offset1:49
    v_mfma_f32_16x16x32_bf16 v[52:55], v[76:79], v[108:111], v[52:55]
    ds_read2_b32 v[142:143], v22 offset0:50 offset1:51
    v_mfma_f32_16x16x32_bf16 v[56:59], v[76:79], v[112:115], v[56:59]
    ds_read2_b32 v[144:145], v22 offset0:176 offset1:177
    v_mfma_f32_16x16x32_bf16 v[60:63], v[76:79], v[116:119], v[60:63]
    v_mfma_f32_16x16x32_bf16 v[64:67], v[76:79], v[120:123], v[64:67]
    ds_read2_b32 v[146:147], v22 offset0:178 offset1:179
    v_mfma_f32_16x16x32_bf16 v[48:51], v[80:83], v[100:103], v[48:51]
    ds_read2_b32 v[148:149], v23 offset0:48 offset1:49
    v_mfma_f32_16x16x32_bf16 v[52:55], v[80:83], v[104:107], v[52:55]
    ds_read2_b32 v[150:151], v23 offset0:50 offset1:51
    v_mfma_f32_16x16x32_bf16 v[56:59], v[80:83], v[108:111], v[56:59]
    v_mfma_f32_16x16x32_bf16 v[60:63], v[80:83], v[112:115], v[60:63]
    ds_read2_b32 v[152:153], v23 offset0:176 offset1:177
    v_mfma_f32_16x16x32_bf16 v[64:67], v[80:83], v[116:119], v[64:67]
    ds_read2_b32 v[154:155], v23 offset0:178 offset1:179
    v_mfma_f32_16x16x32_bf16 v[52:55], v[84:87], v[100:103], v[52:55]
    ds_read2_b32 v[156:157], v24 offset0:48 offset1:49
    v_mfma_f32_16x16x32_bf16 v[56:59], v[84:87], v[104:107], v[56:59]
    v_mfma_f32_16x16x32_bf16 v[60:63], v[84:87], v[108:111], v[60:63]
    ds_read2_b32 v[158:159], v24 offset0:50 offset1:51
    v_mfma_f32_16x16x32_bf16 v[64:67], v[84:87], v[112:115], v[64:67]
    ds_read2_b32 v[160:161], v24 offset0:176 offset1:177
    v_mfma_f32_16x16x32_bf16 v[56:59], v[88:91], v[100:103], v[56:59]
    ds_read2_b32 v[162:163], v24 offset0:178 offset1:179
    v_mfma_f32_16x16x32_bf16 v[60:63], v[88:91], v[104:107], v[60:63]
    v_mfma_f32_16x16x32_bf16 v[64:67], v[88:91], v[108:111], v[64:67]
    v_mfma_f32_16x16x32_bf16 v[60:63], v[92:95], v[100:103], v[60:63]
    v_mfma_f32_16x16x32_bf16 v[64:67], v[92:95], v[104:107], v[64:67]
    s_waitcnt lgkmcnt(14)
    v_mfma_f32_16x16x32_bf16 v[64:67], v[96:99], v[100:103], v[64:67]
    v_mfma_f32_16x16x32_bf16 v[36:39], v[132:135], v[164:167], v[36:39]
    ds_read2_b32 v[68:69], v21 offset0:64 offset1:65
    s_and_b32 s78, s77, 7
    v_mfma_f32_16x16x32_bf16 v[40:43], v[132:135], v[168:171], v[40:43]
    ds_read2_b32 v[70:71], v21 offset0:66 offset1:67
    s_mov_b32 s97, 0x76543210
    v_mfma_f32_16x16x32_bf16 v[44:47], v[132:135], v[172:175], v[44:47]
    ds_read_b128 v[100:103], v29 offset:0
    v_mfma_f32_16x16x32_bf16 v[48:51], v[132:135], v[176:179], v[48:51]
    s_cmp_eq_u32 s78, 1
    v_mfma_f32_16x16x32_bf16 v[52:55], v[132:135], v[180:183], v[52:55]
    ds_read_b128 v[104:107], v29 offset:2048
    s_cselect_b32 s97, 0x76543201, s97
    v_mfma_f32_16x16x32_bf16 v[56:59], v[132:135], v[184:187], v[56:59]
    ds_read_b128 v[108:111], v29 offset:4096
    v_mfma_f32_16x16x32_bf16 v[60:63], v[132:135], v[188:191], v[60:63]
    ds_read_b128 v[112:115], v29 offset:6144
    s_cmp_eq_u32 s78, 2
    v_mfma_f32_16x16x32_bf16 v[64:67], v[132:135], v[192:195], v[64:67]
    s_cselect_b32 s97, 0x76543120, s97
    s_waitcnt lgkmcnt(14)
    v_mfma_f32_16x16x32_bf16 v[40:43], v[136:139], v[164:167], v[40:43]
    ds_read_b128 v[116:119], v29 offset:8192
    v_mfma_f32_16x16x32_bf16 v[44:47], v[136:139], v[168:171], v[44:47]
    ds_read_b128 v[120:123], v29 offset:10240
    s_cmp_eq_u32 s78, 3
    v_mfma_f32_16x16x32_bf16 v[48:51], v[136:139], v[172:175], v[48:51]
    ds_read_b128 v[124:127], v29 offset:12288
    s_cselect_b32 s97, 0x76542310, s97
    v_mfma_f32_16x16x32_bf16 v[52:55], v[136:139], v[176:179], v[52:55]
    v_mfma_f32_16x16x32_bf16 v[56:59], v[136:139], v[180:183], v[56:59]
    ds_read_b128 v[128:131], v29 offset:14336
    s_cmp_eq_u32 s78, 4
    v_mfma_f32_16x16x32_bf16 v[60:63], v[136:139], v[184:187], v[60:63]
    ds_read2_b32 v[72:73], v21 offset0:192 offset1:193
    v_mfma_f32_16x16x32_bf16 v[64:67], v[136:139], v[188:191], v[64:67]
    ds_read2_b32 v[74:75], v21 offset0:194 offset1:195
    s_cselect_b32 s97, 0x76534210, s97
    v_mfma_f32_16x16x32_bf16 v[44:47], v[140:143], v[164:167], v[44:47]
    s_cmp_eq_u32 s78, 5
    v_mfma_f32_16x16x32_bf16 v[48:51], v[140:143], v[168:171], v[48:51]
    ds_read2_b32 v[76:77], v22 offset0:64 offset1:65
    v_mfma_f32_16x16x32_bf16 v[52:55], v[140:143], v[172:175], v[52:55]
    ds_read2_b32 v[78:79], v22 offset0:66 offset1:67
    s_cselect_b32 s97, 0x76453210, s97
    v_mfma_f32_16x16x32_bf16 v[56:59], v[140:143], v[176:179], v[56:59]
    ds_read2_b32 v[80:81], v22 offset0:192 offset1:193
    s_cmp_eq_u32 s78, 6
    v_mfma_f32_16x16x32_bf16 v[60:63], v[140:143], v[180:183], v[60:63]
    v_mfma_f32_16x16x32_bf16 v[64:67], v[140:143], v[184:187], v[64:67]
    ds_read2_b32 v[82:83], v22 offset0:194 offset1:195
    s_cselect_b32 s97, 0x75643210, s97
    v_mfma_f32_16x16x32_bf16 v[48:51], v[144:147], v[164:167], v[48:51]
    ds_read2_b32 v[84:85], v23 offset0:64 offset1:65
    s_cmp_eq_u32 s78, 7
    v_mfma_f32_16x16x32_bf16 v[52:55], v[144:147], v[168:171], v[52:55]
    ds_read2_b32 v[86:87], v23 offset0:66 offset1:67
    v_mfma_f32_16x16x32_bf16 v[56:59], v[144:147], v[172:175], v[56:59]
    s_cselect_b32 s97, 0x67543210, s97
    v_mfma_f32_16x16x32_bf16 v[60:63], v[144:147], v[176:179], v[60:63]
    ds_read2_b32 v[88:89], v23 offset0:192 offset1:193
    v_mfma_f32_16x16x32_bf16 v[64:67], v[144:147], v[180:183], v[64:67]
    ds_read2_b32 v[90:91], v23 offset0:194 offset1:195
    s_and_b32 s78, s76, 3
    s_waitcnt lgkmcnt(14)
    v_mfma_f32_16x16x32_bf16 v[52:55], v[148:151], v[164:167], v[52:55]
    ds_read2_b32 v[92:93], v24 offset0:64 offset1:65
    s_mul_i32 s78, s78, 0x22222222
    v_mfma_f32_16x16x32_bf16 v[56:59], v[148:151], v[168:171], v[56:59]
    v_mfma_f32_16x16x32_bf16 v[60:63], v[148:151], v[172:175], v[60:63]
    ds_read2_b32 v[94:95], v24 offset0:66 offset1:67
    s_add_u32 s97, s97, s78
    v_mfma_f32_16x16x32_bf16 v[64:67], v[148:151], v[176:179], v[64:67]
    ds_read2_b32 v[96:97], v24 offset0:192 offset1:193
    s_bfe_u32 s99, s97, 0x3001c
    v_mfma_f32_16x16x32_bf16 v[56:59], v[152:155], v[164:167], v[56:59]
    ds_read2_b32 v[98:99], v24 offset0:194 offset1:195
    v_mfma_f32_16x16x32_bf16 v[60:63], v[152:155], v[168:171], v[60:63]
    s_lshl_b32 s99, s99, 18
    v_mfma_f32_16x16x32_bf16 v[64:67], v[152:155], v[172:175], v[64:67]
    s_bfe_u32 s97, s97, 0x30018
    v_mfma_f32_16x16x32_bf16 v[60:63], v[156:159], v[164:167], v[60:63]
    v_mfma_f32_16x16x32_bf16 v[64:67], v[156:159], v[168:171], v[64:67]
    s_lshl_b32 s97, s97, 18
    v_mfma_f32_16x16x32_bf16 v[64:67], v[160:163], v[164:167], v[64:67]
    v_mfma_f32_16x16x32_bf16 v[36:39], v[68:71], v[100:103], v[36:39]
    ds_read2_b32 v[132:133], v21 offset0:80 offset1:81
    v_lshrrev_b32 v5, 4, v0
    v_mfma_f32_16x16x32_bf16 v[40:43], v[68:71], v[104:107], v[40:43]
    ds_read2_b32 v[134:135], v21 offset0:82 offset1:83
    v_mfma_f32_16x16x32_bf16 v[44:47], v[68:71], v[108:111], v[44:47]
    ds_read_b128 v[164:167], v30 offset:0
    v_mfma_f32_16x16x32_bf16 v[48:51], v[68:71], v[112:115], v[48:51]
    v_lshlrev_b32 v5, 1, v5
    s_waitcnt lgkmcnt(14)
    v_mfma_f32_16x16x32_bf16 v[52:55], v[68:71], v[116:119], v[52:55]
    ds_read_b128 v[168:171], v30 offset:2048
    v_mfma_f32_16x16x32_bf16 v[56:59], v[68:71], v[120:123], v[56:59]
    ds_read_b128 v[172:175], v30 offset:4096
    v_mfma_f32_16x16x32_bf16 v[60:63], v[68:71], v[124:127], v[60:63]
    ds_read_b128 v[176:179], v30 offset:6144
    v_and_b32 v8, 7, v0
    v_mfma_f32_16x16x32_bf16 v[64:67], v[68:71], v[128:131], v[64:67]
    v_mfma_f32_16x16x32_bf16 v[40:43], v[72:75], v[100:103], v[40:43]
    ds_read_b128 v[180:183], v30 offset:8192
    v_mfma_f32_16x16x32_bf16 v[44:47], v[72:75], v[104:107], v[44:47]
    ds_read_b128 v[184:187], v30 offset:10240
    v_xor_b32 v5, v5, v8
    v_mfma_f32_16x16x32_bf16 v[48:51], v[72:75], v[108:111], v[48:51]
    ds_read_b128 v[188:191], v30 offset:12288
    v_mfma_f32_16x16x32_bf16 v[52:55], v[72:75], v[112:115], v[52:55]
    v_mfma_f32_16x16x32_bf16 v[56:59], v[72:75], v[116:119], v[56:59]
    ds_read_b128 v[192:195], v30 offset:14336
    v_mfma_f32_16x16x32_bf16 v[60:63], v[72:75], v[120:123], v[60:63]
    ds_read2_b32 v[136:137], v21 offset0:208 offset1:209
    v_lshlrev_b32 v5, 4, v5
    v_mfma_f32_16x16x32_bf16 v[64:67], v[72:75], v[124:127], v[64:67]
    ds_read2_b32 v[138:139], v21 offset0:210 offset1:211
    s_waitcnt lgkmcnt(14)
    v_mfma_f32_16x16x32_bf16 v[44:47], v[76:79], v[100:103], v[44:47]
    v_mfma_f32_16x16x32_bf16 v[48:51], v[76:79], v[104:107], v[48:51]
    ds_read2_b32 v[140:141], v22 offset0:80 offset1:81
    v_lshrrev_b32 v8, 3, v0
    v_mfma_f32_16x16x32_bf16 v[52:55], v[76:79], v[108:111], v[52:55]
    ds_read2_b32 v[142:143], v22 offset0:82 offset1:83
    v_mfma_f32_16x16x32_bf16 v[56:59], v[76:79], v[112:115], v[56:59]
    ds_read2_b32 v[144:145], v22 offset0:208 offset1:209
    v_mfma_f32_16x16x32_bf16 v[60:63], v[76:79], v[116:119], v[60:63]
    v_lshl_add_u32 v5, v8, 11, v5
    v_mfma_f32_16x16x32_bf16 v[64:67], v[76:79], v[120:123], v[64:67]
    ds_read2_b32 v[146:147], v22 offset0:210 offset1:211
    v_mfma_f32_16x16x32_bf16 v[48:51], v[80:83], v[100:103], v[48:51]
    ds_read2_b32 v[148:149], v23 offset0:80 offset1:81
    v_mfma_f32_16x16x32_bf16 v[52:55], v[80:83], v[104:107], v[52:55]
    ds_read2_b32 v[150:151], v23 offset0:82 offset1:83
    s_lshl_b32 s78, s77, 7
    v_mfma_f32_16x16x32_bf16 v[56:59], v[80:83], v[108:111], v[56:59]
    v_mfma_f32_16x16x32_bf16 v[60:63], v[80:83], v[112:115], v[60:63]
    ds_read2_b32 v[152:153], v23 offset0:208 offset1:209
    v_mfma_f32_16x16x32_bf16 v[64:67], v[80:83], v[116:119], v[64:67]
    ds_read2_b32 v[154:155], v23 offset0:210 offset1:211
    v_mfma_f32_16x16x32_bf16 v[52:55], v[84:87], v[100:103], v[52:55]
    ds_read2_b32 v[156:157], v24 offset0:80 offset1:81
    s_lshl_b32 s79, s3, 14
    v_mfma_f32_16x16x32_bf16 v[56:59], v[84:87], v[104:107], v[56:59]
    v_mfma_f32_16x16x32_bf16 v[60:63], v[84:87], v[108:111], v[60:63]
    ds_read2_b32 v[158:159], v24 offset0:82 offset1:83
    v_mfma_f32_16x16x32_bf16 v[64:67], v[84:87], v[112:115], v[64:67]
    ds_read2_b32 v[160:161], v24 offset0:208 offset1:209
    s_add_u32 s78, s78, s79
    v_mfma_f32_16x16x32_bf16 v[56:59], v[88:91], v[100:103], v[56:59]
    ds_read2_b32 v[162:163], v24 offset0:210 offset1:211
    v_mfma_f32_16x16x32_bf16 v[60:63], v[88:91], v[104:107], v[60:63]
    v_mfma_f32_16x16x32_bf16 v[64:67], v[88:91], v[108:111], v[64:67]
    v_add_u32 v17, s78, v5
    v_mfma_f32_16x16x32_bf16 v[60:63], v[92:95], v[100:103], v[60:63]
    v_mfma_f32_16x16x32_bf16 v[64:67], v[92:95], v[104:107], v[64:67]
    s_waitcnt lgkmcnt(14)
    v_mfma_f32_16x16x32_bf16 v[64:67], v[96:99], v[100:103], v[64:67]
    v_mfma_f32_16x16x32_bf16 v[36:39], v[132:135], v[164:167], v[36:39]
    ds_read2_b32 v[68:69], v21 offset0:96 offset1:97
    s_waitcnt vmcnt(3)
    v_lshlrev_b32 v196, 16, v212
    v_mfma_f32_16x16x32_bf16 v[40:43], v[132:135], v[168:171], v[40:43]
    ds_read2_b32 v[70:71], v21 offset0:98 offset1:99
    v_mfma_f32_16x16x32_bf16 v[44:47], v[132:135], v[172:175], v[44:47]
    ds_read_b128 v[100:103], v31 offset:0
    v_and_b32 v197, 0xffff0000, v212
    v_mfma_f32_16x16x32_bf16 v[48:51], v[132:135], v[176:179], v[48:51]
    v_mfma_f32_16x16x32_bf16 v[52:55], v[132:135], v[180:183], v[52:55]
    ds_read_b128 v[104:107], v31 offset:2048
    v_lshlrev_b32 v198, 16, v213
    v_mfma_f32_16x16x32_bf16 v[56:59], v[132:135], v[184:187], v[56:59]
    ds_read_b128 v[108:111], v31 offset:4096
    v_mfma_f32_16x16x32_bf16 v[60:63], v[132:135], v[188:191], v[60:63]
    ds_read_b128 v[112:115], v31 offset:6144
    v_and_b32 v199, 0xffff0000, v213
    v_mfma_f32_16x16x32_bf16 v[64:67], v[132:135], v[192:195], v[64:67]
    s_waitcnt lgkmcnt(14)
    v_mfma_f32_16x16x32_bf16 v[40:43], v[136:139], v[164:167], v[40:43]
    ds_read_b128 v[116:119], v31 offset:8192
    v_mfma_f32_16x16x32_bf16 v[44:47], v[136:139], v[168:171], v[44:47]
    ds_read_b128 v[120:123], v31 offset:10240
    v_lshlrev_b32 v200, 16, v214
    v_mfma_f32_16x16x32_bf16 v[48:51], v[136:139], v[172:175], v[48:51]
    ds_read_b128 v[124:127], v31 offset:12288
    v_mfma_f32_16x16x32_bf16 v[52:55], v[136:139], v[176:179], v[52:55]
    v_and_b32 v201, 0xffff0000, v214
    v_mfma_f32_16x16x32_bf16 v[56:59], v[136:139], v[180:183], v[56:59]
    ds_read_b128 v[128:131], v31 offset:14336
    v_mfma_f32_16x16x32_bf16 v[60:63], v[136:139], v[184:187], v[60:63]
    ds_read2_b32 v[72:73], v21 offset0:224 offset1:225
    v_lshlrev_b32 v202, 16, v215
    v_mfma_f32_16x16x32_bf16 v[64:67], v[136:139], v[188:191], v[64:67]
    ds_read2_b32 v[74:75], v21 offset0:226 offset1:227
    v_mfma_f32_16x16x32_bf16 v[44:47], v[140:143], v[164:167], v[44:47]
    v_and_b32 v203, 0xffff0000, v215
    v_mfma_f32_16x16x32_bf16 v[48:51], v[140:143], v[168:171], v[48:51]
    ds_read2_b32 v[76:77], v22 offset0:96 offset1:97
    v_mfma_f32_16x16x32_bf16 v[52:55], v[140:143], v[172:175], v[52:55]
    ds_read2_b32 v[78:79], v22 offset0:98 offset1:99
    v_mfma_f32_16x16x32_bf16 v[56:59], v[140:143], v[176:179], v[56:59]
    ds_read2_b32 v[80:81], v22 offset0:224 offset1:225
    s_waitcnt vmcnt(2)
    v_lshlrev_b32 v204, 16, v216
    v_mfma_f32_16x16x32_bf16 v[60:63], v[140:143], v[180:183], v[60:63]
    v_mfma_f32_16x16x32_bf16 v[64:67], v[140:143], v[184:187], v[64:67]
    ds_read2_b32 v[82:83], v22 offset0:226 offset1:227
    v_and_b32 v205, 0xffff0000, v216
    v_mfma_f32_16x16x32_bf16 v[48:51], v[144:147], v[164:167], v[48:51]
    ds_read2_b32 v[84:85], v23 offset0:96 offset1:97
    v_mfma_f32_16x16x32_bf16 v[52:55], v[144:147], v[168:171], v[52:55]
    ds_read2_b32 v[86:87], v23 offset0:98 offset1:99
    v_lshlrev_b32 v206, 16, v217
    v_mfma_f32_16x16x32_bf16 v[56:59], v[144:147], v[172:175], v[56:59]
    v_mfma_f32_16x16x32_bf16 v[60:63], v[144:147], v[176:179], v[60:63]
    ds_read2_b32 v[88:89], v23 offset0:224 offset1:225
    v_and_b32 v207, 0xffff0000, v217
    v_mfma_f32_16x16x32_bf16 v[64:67], v[144:147], v[180:183], v[64:67]
    ds_read2_b32 v[90:91], v23 offset0:226 offset1:227
    s_waitcnt lgkmcnt(14)
    v_mfma_f32_16x16x32_bf16 v[52:55], v[148:151], v[164:167], v[52:55]
    ds_read2_b32 v[92:93], v24 offset0:96 offset1:97
    v_mfma_f32_16x16x32_bf16 v[56:59], v[148:151], v[168:171], v[56:59]
    v_lshlrev_b32 v208, 16, v218
    v_mfma_f32_16x16x32_bf16 v[60:63], v[148:151], v[172:175], v[60:63]
    ds_read2_b32 v[94:95], v24 offset0:98 offset1:99
    v_mfma_f32_16x16x32_bf16 v[64:67], v[148:151], v[176:179], v[64:67]
    ds_read2_b32 v[96:97], v24 offset0:224 offset1:225
    v_and_b32 v209, 0xffff0000, v218
    v_mfma_f32_16x16x32_bf16 v[56:59], v[152:155], v[164:167], v[56:59]
    ds_read2_b32 v[98:99], v24 offset0:226 offset1:227
    v_mfma_f32_16x16x32_bf16 v[60:63], v[152:155], v[168:171], v[60:63]
    v_lshlrev_b32 v210, 16, v219
    v_mfma_f32_16x16x32_bf16 v[64:67], v[152:155], v[172:175], v[64:67]
    v_mfma_f32_16x16x32_bf16 v[60:63], v[156:159], v[164:167], v[60:63]
    v_and_b32 v211, 0xffff0000, v219
    v_mfma_f32_16x16x32_bf16 v[64:67], v[156:159], v[168:171], v[64:67]
    v_mfma_f32_16x16x32_bf16 v[64:67], v[160:163], v[164:167], v[64:67]
    v_mfma_f32_16x16x32_bf16 v[36:39], v[68:71], v[100:103], v[36:39]
    ds_read2_b32 v[132:133], v21 offset0:112 offset1:113
    s_waitcnt vmcnt(1)
    v_lshlrev_b32 v240, 16, v220
    v_mfma_f32_16x16x32_bf16 v[40:43], v[68:71], v[104:107], v[40:43]
    ds_read2_b32 v[134:135], v21 offset0:114 offset1:115
    v_mfma_f32_16x16x32_bf16 v[44:47], v[68:71], v[108:111], v[44:47]
    ds_read_b128 v[164:167], v32 offset:0
    v_and_b32 v241, 0xffff0000, v220
    v_mfma_f32_16x16x32_bf16 v[48:51], v[68:71], v[112:115], v[48:51]
    s_waitcnt lgkmcnt(14)
    v_mfma_f32_16x16x32_bf16 v[52:55], v[68:71], v[116:119], v[52:55]
    ds_read_b128 v[168:171], v32 offset:2048
    v_lshlrev_b32 v242, 16, v221
    v_mfma_f32_16x16x32_bf16 v[56:59], v[68:71], v[120:123], v[56:59]
    ds_read_b128 v[172:175], v32 offset:4096
    v_mfma_f32_16x16x32_bf16 v[60:63], v[68:71], v[124:127], v[60:63]
    ds_read_b128 v[176:179], v32 offset:6144
    v_and_b32 v243, 0xffff0000, v221
    v_mfma_f32_16x16x32_bf16 v[64:67], v[68:71], v[128:131], v[64:67]
    v_mfma_f32_16x16x32_bf16 v[40:43], v[72:75], v[100:103], v[40:43]
    ds_read_b128 v[180:183], v32 offset:8192
    v_mfma_f32_16x16x32_bf16 v[44:47], v[72:75], v[104:107], v[44:47]
    ds_read_b128 v[184:187], v32 offset:10240
    v_lshlrev_b32 v244, 16, v222
    v_mfma_f32_16x16x32_bf16 v[48:51], v[72:75], v[108:111], v[48:51]
    ds_read_b128 v[188:191], v32 offset:12288
    v_mfma_f32_16x16x32_bf16 v[52:55], v[72:75], v[112:115], v[52:55]
    v_and_b32 v245, 0xffff0000, v222
    v_mfma_f32_16x16x32_bf16 v[56:59], v[72:75], v[116:119], v[56:59]
    ds_read_b128 v[192:195], v32 offset:14336
    v_mfma_f32_16x16x32_bf16 v[60:63], v[72:75], v[120:123], v[60:63]
    ds_read2_b32 v[136:137], v21 offset0:240 offset1:241
    v_lshlrev_b32 v246, 16, v223
    v_mfma_f32_16x16x32_bf16 v[64:67], v[72:75], v[124:127], v[64:67]
    ds_read2_b32 v[138:139], v21 offset0:242 offset1:243
    s_waitcnt lgkmcnt(14)
    v_mfma_f32_16x16x32_bf16 v[44:47], v[76:79], v[100:103], v[44:47]
    v_and_b32 v247, 0xffff0000, v223
    v_mfma_f32_16x16x32_bf16 v[48:51], v[76:79], v[104:107], v[48:51]
    ds_read2_b32 v[140:141], v22 offset0:112 offset1:113
    v_mfma_f32_16x16x32_bf16 v[52:55], v[76:79], v[108:111], v[52:55]
    ds_read2_b32 v[142:143], v22 offset0:114 offset1:115
    v_mfma_f32_16x16x32_bf16 v[56:59], v[76:79], v[112:115], v[56:59]
    ds_read2_b32 v[144:145], v22 offset0:240 offset1:241
    s_waitcnt vmcnt(0)
    v_lshlrev_b32 v248, 16, v224
    v_mfma_f32_16x16x32_bf16 v[60:63], v[76:79], v[116:119], v[60:63]
    v_mfma_f32_16x16x32_bf16 v[64:67], v[76:79], v[120:123], v[64:67]
    ds_read2_b32 v[146:147], v22 offset0:242 offset1:243
    v_and_b32 v249, 0xffff0000, v224
    v_mfma_f32_16x16x32_bf16 v[48:51], v[80:83], v[100:103], v[48:51]
    ds_read2_b32 v[148:149], v23 offset0:112 offset1:113
    v_mfma_f32_16x16x32_bf16 v[52:55], v[80:83], v[104:107], v[52:55]
    ds_read2_b32 v[150:151], v23 offset0:114 offset1:115
    v_lshlrev_b32 v250, 16, v225
    v_mfma_f32_16x16x32_bf16 v[56:59], v[80:83], v[108:111], v[56:59]
    v_mfma_f32_16x16x32_bf16 v[60:63], v[80:83], v[112:115], v[60:63]
    ds_read2_b32 v[152:153], v23 offset0:240 offset1:241
    v_and_b32 v251, 0xffff0000, v225
    v_mfma_f32_16x16x32_bf16 v[64:67], v[80:83], v[116:119], v[64:67]
    ds_read2_b32 v[154:155], v23 offset0:242 offset1:243
    v_mfma_f32_16x16x32_bf16 v[52:55], v[84:87], v[100:103], v[52:55]
    ds_read2_b32 v[156:157], v24 offset0:112 offset1:113
    v_mfma_f32_16x16x32_bf16 v[56:59], v[84:87], v[104:107], v[56:59]
    v_lshlrev_b32 v252, 16, v226
    v_mfma_f32_16x16x32_bf16 v[60:63], v[84:87], v[108:111], v[60:63]
    ds_read2_b32 v[158:159], v24 offset0:114 offset1:115
    v_mfma_f32_16x16x32_bf16 v[64:67], v[84:87], v[112:115], v[64:67]
    ds_read2_b32 v[160:161], v24 offset0:240 offset1:241
    v_and_b32 v253, 0xffff0000, v226
    v_mfma_f32_16x16x32_bf16 v[56:59], v[88:91], v[100:103], v[56:59]
    ds_read2_b32 v[162:163], v24 offset0:242 offset1:243
    v_mfma_f32_16x16x32_bf16 v[60:63], v[88:91], v[104:107], v[60:63]
    v_lshlrev_b32 v254, 16, v227
    v_mfma_f32_16x16x32_bf16 v[64:67], v[88:91], v[108:111], v[64:67]
    v_mfma_f32_16x16x32_bf16 v[60:63], v[92:95], v[100:103], v[60:63]
    v_and_b32 v255, 0xffff0000, v227
    v_mfma_f32_16x16x32_bf16 v[64:67], v[92:95], v[104:107], v[64:67]
    s_waitcnt lgkmcnt(14)
    v_mfma_f32_16x16x32_bf16 v[64:67], v[96:99], v[100:103], v[64:67]
    v_mfma_f32_16x16x32_bf16 v[36:39], v[132:135], v[164:167], v[36:39]
    v_mfma_f32_16x16x32_bf16 v[40:43], v[132:135], v[168:171], v[40:43]
    v_mfma_f32_16x16x32_bf16 v[44:47], v[132:135], v[172:175], v[44:47]
    v_mfma_f32_16x16x32_bf16 v[48:51], v[132:135], v[176:179], v[48:51]
    v_mfma_f32_16x16x32_bf16 v[52:55], v[132:135], v[180:183], v[52:55]
    v_mfma_f32_16x16x32_bf16 v[56:59], v[132:135], v[184:187], v[56:59]
    v_mfma_f32_16x16x32_bf16 v[60:63], v[132:135], v[188:191], v[60:63]
    v_mfma_f32_16x16x32_bf16 v[64:67], v[132:135], v[192:195], v[64:67]
    s_waitcnt lgkmcnt(12)
    v_mfma_f32_16x16x32_bf16 v[40:43], v[136:139], v[164:167], v[40:43]
    v_cvt_pk_bf16_f32 v68, v39, v38
    v_cvt_pk_bf16_f32 v69, v37, v36
    v_mfma_f32_16x16x32_bf16 v[44:47], v[136:139], v[168:171], v[44:47]
    ds_write_b64 v20, v[68:69] offset:0
    v_mfma_f32_16x16x32_bf16 v[48:51], v[136:139], v[172:175], v[48:51]
    v_mfma_f32_16x16x32_bf16 v[52:55], v[136:139], v[176:179], v[52:55]
    v_mfma_f32_16x16x32_bf16 v[56:59], v[136:139], v[180:183], v[56:59]
    v_mfma_f32_16x16x32_bf16 v[60:63], v[136:139], v[184:187], v[60:63]
    v_mfma_f32_16x16x32_bf16 v[64:67], v[136:139], v[188:191], v[64:67]
    s_waitcnt lgkmcnt(11)
    v_mfma_f32_16x16x32_bf16 v[44:47], v[140:143], v[164:167], v[44:47]
    v_mfma_f32_16x16x32_bf16 v[48:51], v[140:143], v[168:171], v[48:51]
    v_cvt_pk_bf16_f32 v70, v43, v42
    v_cvt_pk_bf16_f32 v71, v41, v40
    v_mfma_f32_16x16x32_bf16 v[52:55], v[140:143], v[172:175], v[52:55]
    ds_write_b64 v20, v[70:71] offset:2048
    v_mfma_f32_16x16x32_bf16 v[56:59], v[140:143], v[176:179], v[56:59]
    v_mfma_f32_16x16x32_bf16 v[60:63], v[140:143], v[180:183], v[60:63]
    v_mfma_f32_16x16x32_bf16 v[64:67], v[140:143], v[184:187], v[64:67]
    s_waitcnt lgkmcnt(10)
    v_mfma_f32_16x16x32_bf16 v[48:51], v[144:147], v[164:167], v[48:51]
    v_mfma_f32_16x16x32_bf16 v[52:55], v[144:147], v[168:171], v[52:55]
    v_mfma_f32_16x16x32_bf16 v[56:59], v[144:147], v[172:175], v[56:59]
    v_cvt_pk_bf16_f32 v72, v47, v46
    v_cvt_pk_bf16_f32 v73, v45, v44
    v_mfma_f32_16x16x32_bf16 v[60:63], v[144:147], v[176:179], v[60:63]
    ds_write_b64 v20, v[72:73] offset:4096
    v_mfma_f32_16x16x32_bf16 v[64:67], v[144:147], v[180:183], v[64:67]
    s_waitcnt lgkmcnt(9)
    v_mfma_f32_16x16x32_bf16 v[52:55], v[148:151], v[164:167], v[52:55]
    v_mfma_f32_16x16x32_bf16 v[56:59], v[148:151], v[168:171], v[56:59]
    v_mfma_f32_16x16x32_bf16 v[60:63], v[148:151], v[172:175], v[60:63]
    v_mfma_f32_16x16x32_bf16 v[64:67], v[148:151], v[176:179], v[64:67]
    v_cvt_pk_bf16_f32 v74, v51, v50
    v_cvt_pk_bf16_f32 v75, v49, v48
    s_waitcnt lgkmcnt(7)
    v_mfma_f32_16x16x32_bf16 v[56:59], v[152:155], v[164:167], v[56:59]
    ds_write_b64 v20, v[74:75] offset:6144
    v_mfma_f32_16x16x32_bf16 v[60:63], v[152:155], v[168:171], v[60:63]
    v_mfma_f32_16x16x32_bf16 v[64:67], v[152:155], v[172:175], v[64:67]
    s_waitcnt lgkmcnt(6)
    v_mfma_f32_16x16x32_bf16 v[60:63], v[156:159], v[164:167], v[60:63]
    v_mfma_f32_16x16x32_bf16 v[64:67], v[156:159], v[168:171], v[64:67]
    v_cvt_pk_bf16_f32 v76, v55, v54
    v_cvt_pk_bf16_f32 v77, v53, v52
    s_waitcnt lgkmcnt(4)
    v_mfma_f32_16x16x32_bf16 v[64:67], v[160:163], v[164:167], v[64:67]
    ds_write_b64 v20, v[76:77] offset:8192
    v_cvt_pk_bf16_f32 v78, v59, v58
    v_cvt_pk_bf16_f32 v79, v57, v56
    ds_write_b64 v20, v[78:79] offset:10240
    v_cvt_pk_bf16_f32 v80, v63, v62
    v_cvt_pk_bf16_f32 v81, v61, v60
    ds_write_b64 v20, v[80:81] offset:12288
    s_nop 0
    v_cvt_pk_bf16_f32 v82, v67, v66
    v_cvt_pk_bf16_f32 v83, v65, v64
    ds_write_b64 v20, v[82:83] offset:14336
    s_mov_b64 exec, 1
    ds_add_u32 v18, v19 offset:12
    s_mov_b64 exec, -1
    s_add_u32 s80, s86, 94208
    v_add_u32 v5, s80, v15
    s_branch LA_s3_in
LA_s3:
    s_sleep 1
LA_s3_in:
    ds_read_b32 v6, v18 offset:12
    ds_read_b128 v[84:87], v5 offset:0
    ds_read_b128 v[88:91], v5 offset:4096
    ds_read_b128 v[92:95], v5 offset:8192
    ds_read_b128 v[96:99], v5 offset:12288
    s_waitcnt lgkmcnt(0)
    v_readfirstlane_b32 s78, v6
    s_nop 0
    s_cmp_ge_u32 s78, 4
    s_cbranch_scc0 LA_s3
    s_add_u32 s89, s91, 4194304
    buffer_store_dwordx4 v[84:87], v14, s[52:55], s89 offen sc1
    s_add_u32 s89, s91, 4198400
    buffer_store_dwordx4 v[88:91], v14, s[52:55], s89 offen sc1
    s_add_u32 s89, s91, 4202496
    buffer_store_dwordx4 v[92:95], v14, s[52:55], s89 offen sc1
    s_add_u32 s89, s91, 4206592
    buffer_store_dwordx4 v[96:99], v14, s[52:55], s89 offen sc1
    s_add_u32 m0, s86, 129024
    s_add_u32 s89, s97, 131072
    buffer_load_dwordx4 v17, s[64:67], s89 offen  lds
    s_add_u32 m0, s86, 133120
    s_add_u32 s89, s97, 196608
    buffer_load_dwordx4 v17, s[64:67], s89 offen  lds
    s_add_u32 m0, s86, 137216
    s_add_u32 s89, s99, 0
    buffer_load_dwordx4 v17, s[64:67], s89 offen  lds
    s_add_u32 m0, s86, 141312
    s_add_u32 s89, s99, 65536
    buffer_load_dwordx4 v17, s[64:67], s89 offen  lds
    s_add_u32 m0, s86, 145408
    s_add_u32 s89, s99, 131072
    buffer_load_dwordx4 v17, s[64:67], s89 offen  lds
    s_add_u32 m0, s86, 149504
    s_add_u32 s89, s99, 196608
    buffer_load_dwordx4 v17, s[64:67], s89 offen  lds
    s_setprio 0
    s_mov_b32 s60, s22
    s_mov_b32 s61, s23
    s_mov_b32 s62, 0x800000
    s_mov_b32 s63, 0x20000
    s_lshr_b32 s81, s91, 4
    s_lshl_b32 s82, s3, 8
    s_add_u32 s81, s81, s82
    s_add_u32 s81, s81, 12648448
    s_lshl_b32 s80, s74, 14
    s_and_b32 s82, s75, 3
    s_lshl_b32 s82, s82, 8
    s_add_u32 s80, s80, s82
    s_add_u32 s80, s80, 12648448
    v_mov_b32 v5, 0
    v_lshlrev_b32 v7, 10, v0
    s_waitcnt vmcnt(6)
    s_mov_b64 exec, 1
    buffer_store_dword v19, v5, s[52:55], s81 offen sc1
    s_mov_b64 exec, 0xffff
    s_waitcnt vmcnt(1)
    s_mov_b64 exec, 1
    ds_add_u32 v18, v19 offset:32
    s_mov_b64 exec, -1
    s_mov_b64 exec, 0xffff
    s_waitcnt vmcnt(0)
    s_branch LA_s7a_in
LA_s7a:
    s_sleep 1
LA_s7a_in:
    ds_read_b32 v6, v18 offset:28
    s_waitcnt lgkmcnt(0)
    v_readfirstlane_b32 s78, v6
    s_nop 0
    s_cmp_ge_u32 s78, 4
    s_cbranch_scc0 LA_s7a
    s_setprio 2
    s_mov_b32 s79, 0
LA_py:
    buffer_load_dword v6, v7, s[52:55], s80 offen sc1
    s_add_u32 s79, s79, 1
    s_cmp_gt_u32 s79, 200000
    s_cbranch_scc1 LA_py_x
    s_waitcnt vmcnt(0)
    v_cmp_ne_u32 vcc, 1, v6
    s_cbranch_vccz LA_py_x
    s_mov_b64 exec, vcc
    s_sleep 8
    s_branch LA_py
LA_py_x:
    s_waitcnt vmcnt(0)
    s_mov_b64 exec, -1
    s_mov_b32 s89, 4194304
    buffer_load_dwordx4 v[100:103], v12, s[52:55], s89 offen sc1
    s_mov_b32 s89, 4210688
    buffer_load_dwordx4 v[104:107], v12, s[52:55], s89 offen sc1
    s_mov_b32 s89, 4227072
    buffer_load_dwordx4 v[108:111], v12, s[52:55], s89 offen sc1
    s_mov_b32 s89, 4243456
    buffer_load_dwordx4 v[112:115], v12, s[52:55], s89 offen sc1
    s_waitcnt vmcnt(3)
    v_permlane32_swap_b32 v102, v100
    v_permlane32_swap_b32 v103, v101
    s_waitcnt vmcnt(2)
    v_permlane32_swap_b32 v106, v104
    v_permlane32_swap_b32 v107, v105
    s_waitcnt vmcnt(1)
    v_permlane32_swap_b32 v110, v108
    v_permlane32_swap_b32 v111, v109
    s_waitcnt vmcnt(0)
    v_permlane32_swap_b32 v114, v112
    v_permlane32_swap_b32 v115, v113
    v_and_b32 v68, 0xffff0000, v103
    v_and_b32 v69, 0xffff0000, v107
    v_and_b32 v70, 0xffff0000, v111
    v_and_b32 v71, 0xffff0000, v115
    v_and_b32 v72, 0xffff0000, v101
    v_and_b32 v73, 0xffff0000, v105
    v_and_b32 v74, 0xffff0000, v109
    v_and_b32 v75, 0xffff0000, v113
    v_mul_f32 v68, v68, v196
    v_mul_f32 v69, v69, v197
    v_mul_f32 v70, v70, v198
    v_mul_f32 v71, v71, v199
    v_mul_f32 v72, v72, v200
    v_mul_f32 v73, v73, v201
    v_mul_f32 v74, v74, v202
    v_mul_f32 v75, v75, v203
    v_cvt_pk_bf16_f32 v36, v68, v69
    v_cvt_pk_bf16_f32 v37, v70, v71
    v_cvt_pk_bf16_f32 v38, v72, v73
    v_cvt_pk_bf16_f32 v39, v74, v75
    s_mov_b32 s89, 0
    buffer_store_dwordx4 v[36:39], v13, s[60:63], s89 offen nt
    v_lshlrev_b32 v68, 16, v103
    v_lshlrev_b32 v69, 16, v107
    v_lshlrev_b32 v70, 16, v111
    v_lshlrev_b32 v71, 16, v115
    v_lshlrev_b32 v72, 16, v101
    v_lshlrev_b32 v73, 16, v105
    v_lshlrev_b32 v74, 16, v109
    v_lshlrev_b32 v75, 16, v113
    v_mul_f32 v68, v68, v204
    v_mul_f32 v69, v69, v205
    v_mul_f32 v70, v70, v206
    v_mul_f32 v71, v71, v207
    v_mul_f32 v72, v72, v208
    v_mul_f32 v73, v73, v209
    v_mul_f32 v74, v74, v210
    v_mul_f32 v75, v75, v211
    v_cvt_pk_bf16_f32 v40, v68, v69
    v_cvt_pk_bf16_f32 v41, v70, v71
    v_cvt_pk_bf16_f32 v42, v72, v73
    v_cvt_pk_bf16_f32 v43, v74, v75
    s_mov_b32 s89, 4096
    buffer_store_dwordx4 v[40:43], v13, s[60:63], s89 offen nt
    v_and_b32 v68, 0xffff0000, v102
    v_and_b32 v69, 0xffff0000, v106
    v_and_b32 v70, 0xffff0000, v110
    v_and_b32 v71, 0xffff0000, v114
    v_and_b32 v72, 0xffff0000, v100
    v_and_b32 v73, 0xffff0000, v104
    v_and_b32 v74, 0xffff0000, v108
    v_and_b32 v75, 0xffff0000, v112
    v_mul_f32 v68, v68, v240
    v_mul_f32 v69, v69, v241
    v_mul_f32 v70, v70, v242
    v_mul_f32 v71, v71, v243
    v_mul_f32 v72, v72, v244
    v_mul_f32 v73, v73, v245
    v_mul_f32 v74, v74, v246
    v_mul_f32 v75, v75, v247
    v_cvt_pk_bf16_f32 v44, v68, v69
    v_cvt_pk_bf16_f32 v45, v70, v71
    v_cvt_pk_bf16_f32 v46, v72, v73
    v_cvt_pk_bf16_f32 v47, v74, v75
    s_mov_b32 s89, 8192
    buffer_store_dwordx4 v[44:47], v13, s[60:63], s89 offen nt
    v_lshlrev_b32 v68, 16, v102
    v_lshlrev_b32 v69, 16, v106
    v_lshlrev_b32 v70, 16, v110
    v_lshlrev_b32 v71, 16, v114
    v_lshlrev_b32 v72, 16, v100
    v_lshlrev_b32 v73, 16, v104
    v_lshlrev_b32 v74, 16, v108
    v_lshlrev_b32 v75, 16, v112
    v_mul_f32 v68, v68, v248
    v_mul_f32 v69, v69, v249
    v_mul_f32 v70, v70, v250
    v_mul_f32 v71, v71, v251
    v_mul_f32 v72, v72, v252
    v_mul_f32 v73, v73, v253
    v_mul_f32 v74, v74, v254
    v_mul_f32 v75, v75, v255
    v_cvt_pk_bf16_f32 v48, v68, v69
    v_cvt_pk_bf16_f32 v49, v70, v71
    v_cvt_pk_bf16_f32 v50, v72, v73
    v_cvt_pk_bf16_f32 v51, v74, v75
    s_mov_b32 s89, 12288
    buffer_store_dwordx4 v[48:51], v13, s[60:63], s89 offen nt
    s_endpgm
L_B:
    s_setprio 3
    s_and_b32 s3, s3, 3
    s_lshr_b32 s86, s3, 1
    s_and_b32 s87, s3, 1
    v_mov_b32 v10, 162304
    v_mov_b32 v11, 1
    v_lshlrev_b32 v12, 4, v0
    v_lshl_add_u32 v13, v0, 2, v10
    v_mov_b32 v14, 0
    ds_write_b32 v13, v14
    s_lshl_b32 s78, s74, 4
    s_add_u32 s78, s78, s75
    s_lshl_b32 s96, s78, 8
    s_add_u32 s96, s96, 12582912
    s_lshl_b32 s78, s78, 2
    s_add_u32 s78, s78, s3
    s_lshl_b32 s78, s78, 8
    s_add_u32 s80, s78, 12648448
    s_lshl_b32 s81, s72, 1
    s_add_u32 s81, s81, s86
    s_lshl_b32 s97, s81, 4
    s_add_u32 s97, s97, s73
    s_lshl_b32 s97, s97, 8
    s_add_u32 s97, s97, 12910464
    v_mov_b32 v15, s80
    v_mov_b32 v223, s97
    v_cmp_gt_u32 vcc, 8, v0
    s_nop 1
    v_cndmask_b32 v15, v223, v15, vcc
    v_add_u32 v221, v15, v12
    s_lshl_b32 s78, s87, 2
    s_add_u32 s78, s78, 128
    s_add_u32 s97, s97, s78
    s_lshl_b32 s82, s73, 1
    s_add_u32 s82, s82, s87
    s_lshl_b32 s78, s81, 7
    s_add_u32 s78, s78, s82
    s_lshl_b32 s94, s78, 10
    s_add_u32 s94, s94, 8388608
    v_mov_b32 v212, 0
    v_mov_b32 v213, 0
    v_mov_b32 v214, 0
    v_mov_b32 v215, 0
    v_mov_b32 v220, 0
    s_waitcnt lgkmcnt(0)
    s_mov_b32 s52, s26
    s_mov_b32 s53, s27
    s_mov_b32 s54, 0x1000000
    s_mov_b32 s55, 0x20000
    s_mov_b32 s68, s24
    s_mov_b32 s69, s25
    s_mov_b32 s70, 0x100
    s_mov_b32 s71, 0x20000
    s_lshl_b32 s98, s74, 4
    s_or_b32 s78, s75, s3
    s_cmp_lg_u32 s78, 0
    s_cbranch_scc1 LB_notag
    s_mov_b64 exec, 0xffff
    v_lshlrev_b32 v15, 8, v0
    buffer_load_dword v223, v15, s[52:55], s96 offen sc1
    s_waitcnt vmcnt(0)
    v_lshrrev_b32 v223, v0, v223
    v_and_b32 v223, 1, v223
    v_cmp_eq_u32 vcc, 0, v223
    s_nop 1
    s_or_b32 s78, vcc_lo, 0x10000
    s_mov_b64 exec, 1
    v_mov_b32 v223, s78
    buffer_store_dword v223, v220, s[68:71], s98 offen sc1
LB_notag:
    s_lshl_b32 s78, s87, 3
    s_lshr_b32 exec_lo, 0xffff, s78
    s_mov_b32 exec_hi, 0
    buffer_store_dwordx4 v[212:215], v221, s[52:55], 0 offen sc1
    s_mov_b64 exec, -1
    v_and_b32 v13, 15, v0
    v_lshrrev_b32 v14, 4, v0
    v_lshrrev_b32 v15, 1, v13
    v_xor_b32 v15, v15, v14
    v_lshlrev_b32 v15, 4, v15
    v_lshl_add_u32 v15, v13, 7, v15
    v_add_u32 v2, 73728, v15
    v_xor_b32 v3, 64, v2
    s_lshl_b32 s78, s86, 13
    s_add_u32 s78, s78, 2048
    v_add_u32 v4, s78, v2
    v_add_u32 v5, s78, v3
    v_bfe_u32 v15, v0, 3, 2
    s_lshl_b32 s78, s87, 1
    s_add_u32 s78, s78, s86
    v_xor_b32 v15, s78, v15
    v_lshlrev_b32 v15, 5, v15
    v_and_b32 v223, 3, v0
    v_lshl_add_u32 v15, v223, 3, v15
    v_bfe_u32 v223, v0, 2, 2
    v_lshl_add_u32 v15, v223, 7, v15
    v_mul_u32_u24 v223, 3072, v14
    v_add_u32 v6, v223, v15
    v_xor_b32 v7, 32, v6
    s_mov_b32 s60, s22
    s_mov_b32 s61, s23
    s_mov_b32 s62, 0x800000
    s_mov_b32 s63, 0x20000
    v_and_b32 v15, 1, v13
    v_cmp_eq_u32 s[88:89], 1, v15
    v_lshl_add_u32 v15, v14, 2, v15
    v_cmp_le_u32 s[90:91], v15, v13
    v_add_u32 v15, 2, v15
    v_cmp_le_u32 s[92:93], v15, v13
    v_mov_b32 v212, 0x0c0c0c0c
    v_mov_b32 v15, 0xc0c0100
    v_mov_b32 v223, 0x1000c0c
    v_cndmask_b32 v15, v15, v223, s[88:89]
    v_cndmask_b32 v208, v15, v212, s[90:91]
    v_cndmask_b32 v210, v212, v15, s[90:91]
    v_mov_b32 v15, 0xc0c0302
    v_mov_b32 v223, 0x3020c0c
    v_cndmask_b32 v15, v15, v223, s[88:89]
    v_cndmask_b32 v209, v15, v212, s[92:93]
    v_cndmask_b32 v211, v212, v15, s[92:93]
    s_or_b32 s78, s72, s86
    s_cmp_eq_u32 s78, 0
    s_cselect_b32 s78, 0xf149f2ca, 0
    v_mov_b32 v212, s78
    v_mov_b32 v213, s78
    v_mov_b32 v214, s78
    v_mov_b32 v215, s78
    s_lshl_b32 s78, s87, 12
    s_add_u32 s78, s78, 24576
    s_lshl_b32 s79, s86, 9
    s_add_u32 s79, s79, s78
    v_lshlrev_b32 v15, 3, v0
    v_add_u32 v216, s79, v15
    s_lshl_b32 s80, s86, 11
    v_add_u32 v218, s80, v216
    v_xor_b32 v219, 512, v218
    s_add_u32 s78, s78, 2048
    s_cmp_eq_u32 s86, 0
    s_cselect_b32 s78, s78, 32768
    v_add_u32 v217, s78, v15
    v_bfe_u32 v14, v0, 3, 2
    v_lshlrev_b32 v14, 5, v14
    v_and_b32 v15, 3, v0
    v_lshl_add_u32 v14, v15, 3, v14
    v_lshrrev_b32 v15, 2, v0
    v_lshl_add_u32 v14, v15, 7, v14
    s_lshl_b32 s78, s86, 11
    v_add_u32 v244, s78, v14
    s_mov_b32 s64, s20
    s_mov_b32 s65, s21
    s_mov_b32 s66, 0x200000
    s_mov_b32 s67, 0x20000
    v_lshrrev_b32 v14, 4, v0
    v_lshlrev_b32 v14, 1, v14
    v_and_b32 v15, 7, v0
    v_xor_b32 v14, v14, v15
    v_lshlrev_b32 v14, 4, v14
    v_lshrrev_b32 v15, 3, v0
    v_lshl_add_u32 v14, v15, 11, v14
    s_lshl_b32 s78, s77, 7
    s_lshl_b32 s79, s3, 14
    s_add_u32 s78, s78, s79
    v_add_u32 v245, s78, v14
    v_and_b32 v14, 15, v0
    s_lshl_b32 s78, s76, 2
    s_add_u32 s78, s78, s3
    s_lshl_b32 s79, s78, 5
    v_add_u32 v14, s79, v14
    v_lshlrev_b32 v14, 12, v14
    v_bfe_u32 v15, v0, 4, 1
    v_lshl_add_u32 v14, v15, 5, v14
    v_lshrrev_b32 v15, 5, v0
    v_lshl_add_u32 v14, v15, 4, v14
    s_lshl_b32 s79, s77, 7
    s_add_u32 s79, s79, 2048
    v_add_u32 v246, s79, v14
    s_lshl_b32 s28, s78, 16
    s_add_u32 s28, s28, 8388608
    s_lshl_b32 s30, s76, 1
    s_add_u32 s30, s30, s86
    s_lshl_b32 s30, s30, 12
    s_add_u32 s30, s30, 12910592
    v_lshrrev_b32 v15, 1, v0
    v_lshlrev_b32 v15, 8, v15
    v_and_b32 v14, 1, v0
    v_lshl_add_u32 v247, v14, 2, v15
    s_and_b32 s78, s77, 7
    s_mov_b32 s79, 0x76543210
    s_cmp_eq_u32 s78, 1
    s_cselect_b32 s79, 0x76543201, s79
    s_cmp_eq_u32 s78, 2
    s_cselect_b32 s79, 0x76543120, s79
    s_cmp_eq_u32 s78, 3
    s_cselect_b32 s79, 0x76542310, s79
    s_cmp_eq_u32 s78, 4
    s_cselect_b32 s79, 0x76534210, s79
    s_cmp_eq_u32 s78, 5
    s_cselect_b32 s79, 0x76453210, s79
    s_cmp_eq_u32 s78, 6
    s_cselect_b32 s79, 0x75643210, s79
    s_cmp_eq_u32 s78, 7
    s_cselect_b32 s79, 0x67543210, s79
    s_and_b32 s78, s76, 3
    s_mul_i32 s78, s78, 0x22222222
    s_add_u32 s79, s79, s78
    s_bfe_u32 s78, s79, 0x30000
    s_lshl_b32 s44, s78, 18
    s_lshl_b32 s78, s78, 12
    s_add_u32 s36, s78, s28
    s_bfe_u32 s78, s79, 0x30004
    s_lshl_b32 s45, s78, 18
    s_lshl_b32 s78, s78, 12
    s_add_u32 s37, s78, s28
    s_bfe_u32 s78, s79, 0x30008
    s_lshl_b32 s46, s78, 18
    s_lshl_b32 s78, s78, 12
    s_add_u32 s38, s78, s28
    s_bfe_u32 s78, s79, 0x3000c
    s_lshl_b32 s47, s78, 18
    s_lshl_b32 s78, s78, 12
    s_add_u32 s39, s78, s28
    s_bfe_u32 s78, s79, 0x30010
    s_lshl_b32 s48, s78, 18
    s_lshl_b32 s78, s78, 12
    s_add_u32 s40, s78, s28
    s_bfe_u32 s78, s79, 0x30014
    s_lshl_b32 s49, s78, 18
    s_lshl_b32 s78, s78, 12
    s_add_u32 s41, s78, s28
    s_bfe_u32 s78, s79, 0x30018
    s_lshl_b32 s50, s78, 18
    s_lshl_b32 s78, s78, 12
    s_add_u32 s42, s78, s28
    s_bfe_u32 s78, s79, 0x3001c
    s_lshl_b32 s51, s78, 18
    s_lshl_b32 s78, s78, 12
    s_add_u32 s43, s78, s28
    s_lshl_b32 s34, s3, 10
    v_bfe_u32 v14, v0, 4, 1
    v_lshrrev_b32 v15, 5, v0
    v_lshl_add_u32 v14, v14, 1, v15
    v_and_b32 v15, 7, v0
    v_xor_b32 v14, v14, v15
    v_lshlrev_b32 v14, 4, v14
    v_and_b32 v223, 15, v0
    v_lshl_add_u32 v14, v223, 7, v14
    s_lshl_b32 s78, s3, 12
    v_add_u32 v248, s78, v14
    v_xor_b32 v249, 64, v248
    v_add_u32 v250, s78, v12
    v_lshrrev_b32 v14, 3, v0
    v_xor_b32 v15, v15, v14
    v_lshlrev_b32 v15, 4, v15
    v_lshl_add_u32 v14, v14, 12, v15
    s_lshl_b32 s78, s76, 2
    s_add_u32 s78, s78, s3
    s_lshl_b32 s78, s78, 17
    s_lshl_b32 s79, s77, 7
    s_add_u32 s78, s78, s79
    s_add_u32 s78, s78, 2048
    v_add_u32 v246, s78, v14
    s_waitcnt lgkmcnt(0)
    s_barrier
    ds_read_b128 v[120:123], v4 offset:0
    ds_read_b128 v[124:127], v4 offset:2048
    ds_read_b128 v[128:131], v4 offset:4096
    ds_read_b128 v[132:135], v4 offset:6144
    ds_read_b128 v[136:139], v2 offset:0
    ds_read_b64_tr_b16 v[140:141], v6 offset:0
    ds_read_b64_tr_b16 v[142:143], v6 offset:512
    ds_read_b64_tr_b16 v[144:145], v7 offset:0
    ds_read_b64_tr_b16 v[146:147], v7 offset:512
    ds_read_b64_tr_b16 v[148:149], v6 offset:1024
    ds_read_b64_tr_b16 v[150:151], v6 offset:1536
    ds_read_b64_tr_b16 v[152:153], v7 offset:1024
    ds_read_b64_tr_b16 v[154:155], v7 offset:1536
    ds_read_b64_tr_b16 v[156:157], v6 offset:2048
    ds_read_b64_tr_b16 v[158:159], v6 offset:2560
    ds_read_b64_tr_b16 v[160:161], v7 offset:2048
    ds_read_b64_tr_b16 v[162:163], v7 offset:2560
    s_waitcnt lgkmcnt(0)
    v_mfma_f32_16x16x32_bf16 v[16:19], v[140:143], v[120:123], 0
    ds_read_b128 v[164:167], v5 offset:0
    v_mfma_f32_16x16x32_bf16 v[20:23], v[144:147], v[120:123], 0
    ds_read_b128 v[168:171], v5 offset:2048
    v_mfma_f32_16x16x32_bf16 v[52:55], v[152:155], v[120:123], 0
    ds_read_b128 v[172:175], v5 offset:4096
    v_mfma_f32_16x16x32_bf16 v[48:51], v[148:151], v[120:123], 0
    ds_read_b128 v[176:179], v5 offset:6144
    v_mfma_f32_16x16x32_bf16 v[56:59], v[148:151], v[124:127], 0
    ds_read_b128 v[180:183], v3 offset:0
    v_mfma_f32_16x16x32_bf16 v[60:63], v[152:155], v[124:127], 0
    ds_read_b64_tr_b16 v[184:185], v6 offset:12288
    v_mfma_f32_16x16x32_bf16 v[28:31], v[144:147], v[124:127], 0
    ds_read_b64_tr_b16 v[186:187], v6 offset:12800
    v_mfma_f32_16x16x32_bf16 v[24:27], v[140:143], v[124:127], 0
    ds_read_b64_tr_b16 v[188:189], v7 offset:12288
    v_mfma_f32_16x16x32_bf16 v[32:35], v[140:143], v[128:131], 0
    ds_read_b64_tr_b16 v[190:191], v7 offset:12800
    v_mfma_f32_16x16x32_bf16 v[36:39], v[144:147], v[128:131], 0
    ds_read_b64_tr_b16 v[192:193], v6 offset:13312
    v_mfma_f32_16x16x32_bf16 v[68:71], v[152:155], v[128:131], 0
    ds_read_b64_tr_b16 v[194:195], v6 offset:13824
    v_mfma_f32_16x16x32_bf16 v[64:67], v[148:151], v[128:131], 0
    ds_read_b64_tr_b16 v[196:197], v7 offset:13312
    v_mfma_f32_16x16x32_bf16 v[112:115], v[148:151], v[136:139], 0
    ds_read_b64_tr_b16 v[198:199], v7 offset:13824
    v_mfma_f32_16x16x32_bf16 v[72:75], v[148:151], v[132:135], 0
    ds_read_b64_tr_b16 v[200:201], v6 offset:14336
    v_mfma_f32_16x16x32_bf16 v[76:79], v[152:155], v[132:135], 0
    ds_read_b64_tr_b16 v[202:203], v6 offset:14848
    v_mfma_f32_16x16x32_bf16 v[44:47], v[144:147], v[132:135], 0
    ds_read_b64_tr_b16 v[204:205], v7 offset:14336
    v_mfma_f32_16x16x32_bf16 v[40:43], v[140:143], v[132:135], 0
    ds_read_b64_tr_b16 v[206:207], v7 offset:14848
    v_mfma_f32_16x16x32_bf16 v[104:107], v[132:135], v[156:159], 0
    v_mfma_f32_16x16x32_bf16 v[108:111], v[132:135], v[160:163], 0
    v_mfma_f32_16x16x32_bf16 v[100:103], v[128:131], v[160:163], 0
    v_mfma_f32_16x16x32_bf16 v[96:99], v[128:131], v[156:159], 0
    v_mfma_f32_16x16x32_bf16 v[88:91], v[124:127], v[156:159], 0
    v_mfma_f32_16x16x32_bf16 v[92:95], v[124:127], v[160:163], 0
    v_mfma_f32_16x16x32_bf16 v[84:87], v[120:123], v[160:163], 0
    v_mfma_f32_16x16x32_bf16 v[80:83], v[120:123], v[156:159], 0
    v_mfma_f32_16x16x32_bf16 v[116:119], v[136:139], v[156:159], 0
    s_waitcnt vmcnt(0)
    s_waitcnt lgkmcnt(0)
    s_barrier
    v_mfma_f32_16x16x32_bf16 v[16:19], v[184:187], v[164:167], v[16:19]
    ds_read_b128 v[120:123], v4 offset:18432
    v_mfma_f32_16x16x32_bf16 v[20:23], v[188:191], v[164:167], v[20:23]
    ds_read_b128 v[124:127], v4 offset:20480
    v_mfma_f32_16x16x32_bf16 v[52:55], v[196:199], v[164:167], v[52:55]
    ds_read_b128 v[128:131], v4 offset:22528
    v_mfma_f32_16x16x32_bf16 v[48:51], v[192:195], v[164:167], v[48:51]
    ds_read_b128 v[132:135], v4 offset:24576
    v_mfma_f32_16x16x32_bf16 v[56:59], v[192:195], v[168:171], v[56:59]
    ds_read_b128 v[136:139], v2 offset:18432
    v_mfma_f32_16x16x32_bf16 v[60:63], v[196:199], v[168:171], v[60:63]
    ds_read_b64_tr_b16 v[140:141], v6 offset:24576
    v_mfma_f32_16x16x32_bf16 v[28:31], v[188:191], v[168:171], v[28:31]
    ds_read_b64_tr_b16 v[142:143], v6 offset:25088
    v_mfma_f32_16x16x32_bf16 v[24:27], v[184:187], v[168:171], v[24:27]
    ds_read_b64_tr_b16 v[144:145], v7 offset:24576
    v_mfma_f32_16x16x32_bf16 v[32:35], v[184:187], v[172:175], v[32:35]
    ds_read_b64_tr_b16 v[146:147], v7 offset:25088
    v_mfma_f32_16x16x32_bf16 v[36:39], v[188:191], v[172:175], v[36:39]
    ds_read_b64_tr_b16 v[148:149], v6 offset:25600
    v_mfma_f32_16x16x32_bf16 v[68:71], v[196:199], v[172:175], v[68:71]
    ds_read_b64_tr_b16 v[150:151], v6 offset:26112
    v_mfma_f32_16x16x32_bf16 v[64:67], v[192:195], v[172:175], v[64:67]
    ds_read_b64_tr_b16 v[152:153], v7 offset:25600
    v_mfma_f32_16x16x32_bf16 v[112:115], v[192:195], v[180:183], v[112:115]
    ds_read_b64_tr_b16 v[154:155], v7 offset:26112
    v_mfma_f32_16x16x32_bf16 v[72:75], v[192:195], v[176:179], v[72:75]
    ds_read_b64_tr_b16 v[156:157], v6 offset:26624
    v_mfma_f32_16x16x32_bf16 v[76:79], v[196:199], v[176:179], v[76:79]
    ds_read_b64_tr_b16 v[158:159], v6 offset:27136
    v_mfma_f32_16x16x32_bf16 v[44:47], v[188:191], v[176:179], v[44:47]
    ds_read_b64_tr_b16 v[160:161], v7 offset:26624
    v_mfma_f32_16x16x32_bf16 v[40:43], v[184:187], v[176:179], v[40:43]
    ds_read_b64_tr_b16 v[162:163], v7 offset:27136
    v_mfma_f32_16x16x32_bf16 v[104:107], v[176:179], v[200:203], v[104:107]
    v_mfma_f32_16x16x32_bf16 v[108:111], v[176:179], v[204:207], v[108:111]
    v_mfma_f32_16x16x32_bf16 v[100:103], v[172:175], v[204:207], v[100:103]
    v_mfma_f32_16x16x32_bf16 v[96:99], v[172:175], v[200:203], v[96:99]
    v_mfma_f32_16x16x32_bf16 v[88:91], v[168:171], v[200:203], v[88:91]
    v_mfma_f32_16x16x32_bf16 v[92:95], v[168:171], v[204:207], v[92:95]
    v_mfma_f32_16x16x32_bf16 v[84:87], v[164:167], v[204:207], v[84:87]
    v_mfma_f32_16x16x32_bf16 v[80:83], v[164:167], v[200:203], v[80:83]
    v_mfma_f32_16x16x32_bf16 v[116:119], v[180:183], v[200:203], v[116:119]
    s_waitcnt lgkmcnt(0)
    v_mfma_f32_16x16x32_bf16 v[16:19], v[140:143], v[120:123], v[16:19]
    ds_read_b128 v[164:167], v5 offset:18432
    v_mfma_f32_16x16x32_bf16 v[20:23], v[144:147], v[120:123], v[20:23]
    ds_read_b128 v[168:171], v5 offset:20480
    v_mfma_f32_16x16x32_bf16 v[52:55], v[152:155], v[120:123], v[52:55]
    ds_read_b128 v[172:175], v5 offset:22528
    v_mfma_f32_16x16x32_bf16 v[48:51], v[148:151], v[120:123], v[48:51]
    ds_read_b128 v[176:179], v5 offset:24576
    v_mfma_f32_16x16x32_bf16 v[56:59], v[148:151], v[124:127], v[56:59]
    ds_read_b128 v[180:183], v3 offset:18432
    v_mfma_f32_16x16x32_bf16 v[60:63], v[152:155], v[124:127], v[60:63]
    ds_read_b64_tr_b16 v[184:185], v6 offset:36864
    v_mfma_f32_16x16x32_bf16 v[28:31], v[144:147], v[124:127], v[28:31]
    ds_read_b64_tr_b16 v[186:187], v6 offset:37376
    v_mfma_f32_16x16x32_bf16 v[24:27], v[140:143], v[124:127], v[24:27]
    ds_read_b64_tr_b16 v[188:189], v7 offset:36864
    v_mfma_f32_16x16x32_bf16 v[32:35], v[140:143], v[128:131], v[32:35]
    ds_read_b64_tr_b16 v[190:191], v7 offset:37376
    v_mfma_f32_16x16x32_bf16 v[36:39], v[144:147], v[128:131], v[36:39]
    ds_read_b64_tr_b16 v[192:193], v6 offset:37888
    v_mfma_f32_16x16x32_bf16 v[68:71], v[152:155], v[128:131], v[68:71]
    ds_read_b64_tr_b16 v[194:195], v6 offset:38400
    v_mfma_f32_16x16x32_bf16 v[64:67], v[148:151], v[128:131], v[64:67]
    ds_read_b64_tr_b16 v[196:197], v7 offset:37888
    v_mfma_f32_16x16x32_bf16 v[112:115], v[148:151], v[136:139], v[112:115]
    ds_read_b64_tr_b16 v[198:199], v7 offset:38400
    v_mfma_f32_16x16x32_bf16 v[72:75], v[148:151], v[132:135], v[72:75]
    ds_read_b64_tr_b16 v[200:201], v6 offset:38912
    v_mfma_f32_16x16x32_bf16 v[76:79], v[152:155], v[132:135], v[76:79]
    ds_read_b64_tr_b16 v[202:203], v6 offset:39424
    v_mfma_f32_16x16x32_bf16 v[44:47], v[144:147], v[132:135], v[44:47]
    ds_read_b64_tr_b16 v[204:205], v7 offset:38912
    v_mfma_f32_16x16x32_bf16 v[40:43], v[140:143], v[132:135], v[40:43]
    ds_read_b64_tr_b16 v[206:207], v7 offset:39424
    v_mfma_f32_16x16x32_bf16 v[104:107], v[132:135], v[156:159], v[104:107]
    v_mfma_f32_16x16x32_bf16 v[108:111], v[132:135], v[160:163], v[108:111]
    v_mfma_f32_16x16x32_bf16 v[100:103], v[128:131], v[160:163], v[100:103]
    v_mfma_f32_16x16x32_bf16 v[96:99], v[128:131], v[156:159], v[96:99]
    v_mfma_f32_16x16x32_bf16 v[88:91], v[124:127], v[156:159], v[88:91]
    v_mfma_f32_16x16x32_bf16 v[92:95], v[124:127], v[160:163], v[92:95]
    v_mfma_f32_16x16x32_bf16 v[84:87], v[120:123], v[160:163], v[84:87]
    v_mfma_f32_16x16x32_bf16 v[80:83], v[120:123], v[156:159], v[80:83]
    v_mfma_f32_16x16x32_bf16 v[116:119], v[136:139], v[156:159], v[116:119]
    s_waitcnt lgkmcnt(0)
    s_barrier
    v_mfma_f32_16x16x32_bf16 v[16:19], v[184:187], v[164:167], v[16:19]
    ds_read_b128 v[120:123], v4 offset:36864
    v_mfma_f32_16x16x32_bf16 v[20:23], v[188:191], v[164:167], v[20:23]
    ds_read_b128 v[124:127], v4 offset:38912
    v_mfma_f32_16x16x32_bf16 v[52:55], v[196:199], v[164:167], v[52:55]
    ds_read_b128 v[128:131], v4 offset:40960
    v_mfma_f32_16x16x32_bf16 v[48:51], v[192:195], v[164:167], v[48:51]
    ds_read_b128 v[132:135], v4 offset:43008
    v_mfma_f32_16x16x32_bf16 v[56:59], v[192:195], v[168:171], v[56:59]
    ds_read_b128 v[136:139], v2 offset:36864
    v_mfma_f32_16x16x32_bf16 v[60:63], v[196:199], v[168:171], v[60:63]
    ds_read_b64_tr_b16 v[140:141], v6 offset:49152
    v_mfma_f32_16x16x32_bf16 v[28:31], v[188:191], v[168:171], v[28:31]
    ds_read_b64_tr_b16 v[142:143], v6 offset:49664
    v_mfma_f32_16x16x32_bf16 v[24:27], v[184:187], v[168:171], v[24:27]
    ds_read_b64_tr_b16 v[144:145], v7 offset:49152
    v_mfma_f32_16x16x32_bf16 v[32:35], v[184:187], v[172:175], v[32:35]
    ds_read_b64_tr_b16 v[146:147], v7 offset:49664
    v_mfma_f32_16x16x32_bf16 v[36:39], v[188:191], v[172:175], v[36:39]
    ds_read_b64_tr_b16 v[148:149], v6 offset:50176
    v_mfma_f32_16x16x32_bf16 v[68:71], v[196:199], v[172:175], v[68:71]
    ds_read_b64_tr_b16 v[150:151], v6 offset:50688
    v_mfma_f32_16x16x32_bf16 v[64:67], v[192:195], v[172:175], v[64:67]
    ds_read_b64_tr_b16 v[152:153], v7 offset:50176
    v_mfma_f32_16x16x32_bf16 v[112:115], v[192:195], v[180:183], v[112:115]
    ds_read_b64_tr_b16 v[154:155], v7 offset:50688
    v_mfma_f32_16x16x32_bf16 v[72:75], v[192:195], v[176:179], v[72:75]
    ds_read_b64_tr_b16 v[156:157], v6 offset:51200
    v_mfma_f32_16x16x32_bf16 v[76:79], v[196:199], v[176:179], v[76:79]
    ds_read_b64_tr_b16 v[158:159], v6 offset:51712
    v_mfma_f32_16x16x32_bf16 v[44:47], v[188:191], v[176:179], v[44:47]
    ds_read_b64_tr_b16 v[160:161], v7 offset:51200
    v_mfma_f32_16x16x32_bf16 v[40:43], v[184:187], v[176:179], v[40:43]
    ds_read_b64_tr_b16 v[162:163], v7 offset:51712
    v_mfma_f32_16x16x32_bf16 v[104:107], v[176:179], v[200:203], v[104:107]
    v_mfma_f32_16x16x32_bf16 v[108:111], v[176:179], v[204:207], v[108:111]
    v_mfma_f32_16x16x32_bf16 v[100:103], v[172:175], v[204:207], v[100:103]
    v_mfma_f32_16x16x32_bf16 v[96:99], v[172:175], v[200:203], v[96:99]
    v_mfma_f32_16x16x32_bf16 v[88:91], v[168:171], v[200:203], v[88:91]
    v_mfma_f32_16x16x32_bf16 v[92:95], v[168:171], v[204:207], v[92:95]
    v_mfma_f32_16x16x32_bf16 v[84:87], v[164:167], v[204:207], v[84:87]
    v_mfma_f32_16x16x32_bf16 v[80:83], v[164:167], v[200:203], v[80:83]
    v_mfma_f32_16x16x32_bf16 v[116:119], v[180:183], v[200:203], v[116:119]
    s_waitcnt lgkmcnt(0)
    v_mfma_f32_16x16x32_bf16 v[16:19], v[140:143], v[120:123], v[16:19]
    ds_read_b128 v[164:167], v5 offset:36864
    v_mfma_f32_16x16x32_bf16 v[20:23], v[144:147], v[120:123], v[20:23]
    ds_read_b128 v[168:171], v5 offset:38912
    v_mfma_f32_16x16x32_bf16 v[52:55], v[152:155], v[120:123], v[52:55]
    ds_read_b128 v[172:175], v5 offset:40960
    v_mfma_f32_16x16x32_bf16 v[48:51], v[148:151], v[120:123], v[48:51]
    ds_read_b128 v[176:179], v5 offset:43008
    v_mfma_f32_16x16x32_bf16 v[56:59], v[148:151], v[124:127], v[56:59]
    ds_read_b128 v[180:183], v3 offset:36864
    v_mfma_f32_16x16x32_bf16 v[60:63], v[152:155], v[124:127], v[60:63]
    ds_read_b64_tr_b16 v[184:185], v6 offset:61440
    v_mfma_f32_16x16x32_bf16 v[28:31], v[144:147], v[124:127], v[28:31]
    ds_read_b64_tr_b16 v[186:187], v6 offset:61952
    v_mfma_f32_16x16x32_bf16 v[24:27], v[140:143], v[124:127], v[24:27]
    ds_read_b64_tr_b16 v[188:189], v7 offset:61440
    v_mfma_f32_16x16x32_bf16 v[32:35], v[140:143], v[128:131], v[32:35]
    ds_read_b64_tr_b16 v[190:191], v7 offset:61952
    v_mfma_f32_16x16x32_bf16 v[36:39], v[144:147], v[128:131], v[36:39]
    ds_read_b64_tr_b16 v[192:193], v6 offset:62464
    v_mfma_f32_16x16x32_bf16 v[68:71], v[152:155], v[128:131], v[68:71]
    ds_read_b64_tr_b16 v[194:195], v6 offset:62976
    v_mfma_f32_16x16x32_bf16 v[64:67], v[148:151], v[128:131], v[64:67]
    ds_read_b64_tr_b16 v[196:197], v7 offset:62464
    v_mfma_f32_16x16x32_bf16 v[112:115], v[148:151], v[136:139], v[112:115]
    ds_read_b64_tr_b16 v[198:199], v7 offset:62976
    v_mfma_f32_16x16x32_bf16 v[72:75], v[148:151], v[132:135], v[72:75]
    ds_read_b64_tr_b16 v[200:201], v6 offset:63488
    v_mfma_f32_16x16x32_bf16 v[76:79], v[152:155], v[132:135], v[76:79]
    ds_read_b64_tr_b16 v[202:203], v6 offset:64000
    v_mfma_f32_16x16x32_bf16 v[44:47], v[144:147], v[132:135], v[44:47]
    ds_read_b64_tr_b16 v[204:205], v7 offset:63488
    v_mfma_f32_16x16x32_bf16 v[40:43], v[140:143], v[132:135], v[40:43]
    ds_read_b64_tr_b16 v[206:207], v7 offset:64000
    v_mfma_f32_16x16x32_bf16 v[104:107], v[132:135], v[156:159], v[104:107]
    v_mfma_f32_16x16x32_bf16 v[108:111], v[132:135], v[160:163], v[108:111]
    v_mfma_f32_16x16x32_bf16 v[100:103], v[128:131], v[160:163], v[100:103]
    v_mfma_f32_16x16x32_bf16 v[96:99], v[128:131], v[156:159], v[96:99]
    v_mfma_f32_16x16x32_bf16 v[88:91], v[124:127], v[156:159], v[88:91]
    v_mfma_f32_16x16x32_bf16 v[92:95], v[124:127], v[160:163], v[92:95]
    v_mfma_f32_16x16x32_bf16 v[84:87], v[120:123], v[160:163], v[84:87]
    v_mfma_f32_16x16x32_bf16 v[80:83], v[120:123], v[156:159], v[80:83]
    v_mfma_f32_16x16x32_bf16 v[116:119], v[136:139], v[156:159], v[116:119]
    s_waitcnt lgkmcnt(0)
    s_barrier
    v_mfma_f32_16x16x32_bf16 v[16:19], v[184:187], v[164:167], v[16:19]
    ds_read_b128 v[120:123], v4 offset:0
    v_mfma_f32_16x16x32_bf16 v[20:23], v[188:191], v[164:167], v[20:23]
    ds_read_b128 v[124:127], v4 offset:2048
    v_mfma_f32_16x16x32_bf16 v[52:55], v[196:199], v[164:167], v[52:55]
    ds_read_b128 v[128:131], v4 offset:4096
    v_mfma_f32_16x16x32_bf16 v[48:51], v[192:195], v[164:167], v[48:51]
    ds_read_b128 v[132:135], v4 offset:6144
    v_mfma_f32_16x16x32_bf16 v[56:59], v[192:195], v[168:171], v[56:59]
    ds_read_b128 v[136:139], v2 offset:0
    v_mfma_f32_16x16x32_bf16 v[60:63], v[196:199], v[168:171], v[60:63]
    ds_read_b64_tr_b16 v[140:141], v6 offset:0
    v_mfma_f32_16x16x32_bf16 v[28:31], v[188:191], v[168:171], v[28:31]
    ds_read_b64_tr_b16 v[142:143], v6 offset:512
    v_mfma_f32_16x16x32_bf16 v[24:27], v[184:187], v[168:171], v[24:27]
    ds_read_b64_tr_b16 v[144:145], v7 offset:0
    v_mfma_f32_16x16x32_bf16 v[32:35], v[184:187], v[172:175], v[32:35]
    ds_read_b64_tr_b16 v[146:147], v7 offset:512
    v_mfma_f32_16x16x32_bf16 v[36:39], v[188:191], v[172:175], v[36:39]
    ds_read_b64_tr_b16 v[148:149], v6 offset:1024
    v_mfma_f32_16x16x32_bf16 v[68:71], v[196:199], v[172:175], v[68:71]
    ds_read_b64_tr_b16 v[150:151], v6 offset:1536
    v_mfma_f32_16x16x32_bf16 v[64:67], v[192:195], v[172:175], v[64:67]
    ds_read_b64_tr_b16 v[152:153], v7 offset:1024
    v_mfma_f32_16x16x32_bf16 v[112:115], v[192:195], v[180:183], v[112:115]
    ds_read_b64_tr_b16 v[154:155], v7 offset:1536
    v_mfma_f32_16x16x32_bf16 v[72:75], v[192:195], v[176:179], v[72:75]
    ds_read_b64_tr_b16 v[156:157], v6 offset:2048
    v_mfma_f32_16x16x32_bf16 v[76:79], v[196:199], v[176:179], v[76:79]
    ds_read_b64_tr_b16 v[158:159], v6 offset:2560
    v_mfma_f32_16x16x32_bf16 v[44:47], v[188:191], v[176:179], v[44:47]
    ds_read_b64_tr_b16 v[160:161], v7 offset:2048
    v_mfma_f32_16x16x32_bf16 v[40:43], v[184:187], v[176:179], v[40:43]
    ds_read_b64_tr_b16 v[162:163], v7 offset:2560
    v_mfma_f32_16x16x32_bf16 v[104:107], v[176:179], v[200:203], v[104:107]
    v_mfma_f32_16x16x32_bf16 v[108:111], v[176:179], v[204:207], v[108:111]
    v_mfma_f32_16x16x32_bf16 v[100:103], v[172:175], v[204:207], v[100:103]
    v_mfma_f32_16x16x32_bf16 v[96:99], v[172:175], v[200:203], v[96:99]
    v_mfma_f32_16x16x32_bf16 v[88:91], v[168:171], v[200:203], v[88:91]
    v_mfma_f32_16x16x32_bf16 v[92:95], v[168:171], v[204:207], v[92:95]
    v_mfma_f32_16x16x32_bf16 v[84:87], v[164:167], v[204:207], v[84:87]
    v_mfma_f32_16x16x32_bf16 v[80:83], v[164:167], v[200:203], v[80:83]
    v_mfma_f32_16x16x32_bf16 v[116:119], v[180:183], v[200:203], v[116:119]
    s_waitcnt lgkmcnt(0)
    v_mfma_f32_16x16x32_bf16 v[16:19], v[140:143], v[120:123], v[16:19]
    ds_read_b128 v[164:167], v5 offset:0
    v_mfma_f32_16x16x32_bf16 v[20:23], v[144:147], v[120:123], v[20:23]
    ds_read_b128 v[168:171], v5 offset:2048
    v_mfma_f32_16x16x32_bf16 v[52:55], v[152:155], v[120:123], v[52:55]
    ds_read_b128 v[172:175], v5 offset:4096
    v_mfma_f32_16x16x32_bf16 v[48:51], v[148:151], v[120:123], v[48:51]
    ds_read_b128 v[176:179], v5 offset:6144
    v_mfma_f32_16x16x32_bf16 v[56:59], v[148:151], v[124:127], v[56:59]
    ds_read_b128 v[180:183], v3 offset:0
    v_mfma_f32_16x16x32_bf16 v[60:63], v[152:155], v[124:127], v[60:63]
    ds_read_b64_tr_b16 v[184:185], v6 offset:12288
    v_mfma_f32_16x16x32_bf16 v[28:31], v[144:147], v[124:127], v[28:31]
    ds_read_b64_tr_b16 v[186:187], v6 offset:12800
    v_mfma_f32_16x16x32_bf16 v[24:27], v[140:143], v[124:127], v[24:27]
    ds_read_b64_tr_b16 v[188:189], v7 offset:12288
    v_mfma_f32_16x16x32_bf16 v[32:35], v[140:143], v[128:131], v[32:35]
    ds_read_b64_tr_b16 v[190:191], v7 offset:12800
    v_mfma_f32_16x16x32_bf16 v[36:39], v[144:147], v[128:131], v[36:39]
    ds_read_b64_tr_b16 v[192:193], v6 offset:13312
    v_mfma_f32_16x16x32_bf16 v[68:71], v[152:155], v[128:131], v[68:71]
    ds_read_b64_tr_b16 v[194:195], v6 offset:13824
    v_mfma_f32_16x16x32_bf16 v[64:67], v[148:151], v[128:131], v[64:67]
    ds_read_b64_tr_b16 v[196:197], v7 offset:13312
    v_mfma_f32_16x16x32_bf16 v[112:115], v[148:151], v[136:139], v[112:115]
    ds_read_b64_tr_b16 v[198:199], v7 offset:13824
    v_mfma_f32_16x16x32_bf16 v[72:75], v[148:151], v[132:135], v[72:75]
    ds_read_b64_tr_b16 v[200:201], v6 offset:14336
    v_mfma_f32_16x16x32_bf16 v[76:79], v[152:155], v[132:135], v[76:79]
    ds_read_b64_tr_b16 v[202:203], v6 offset:14848
    v_mfma_f32_16x16x32_bf16 v[44:47], v[144:147], v[132:135], v[44:47]
    ds_read_b64_tr_b16 v[204:205], v7 offset:14336
    v_mfma_f32_16x16x32_bf16 v[40:43], v[140:143], v[132:135], v[40:43]
    ds_read_b64_tr_b16 v[206:207], v7 offset:14848
    v_mfma_f32_16x16x32_bf16 v[104:107], v[132:135], v[156:159], v[104:107]
    v_mfma_f32_16x16x32_bf16 v[108:111], v[132:135], v[160:163], v[108:111]
    v_mfma_f32_16x16x32_bf16 v[100:103], v[128:131], v[160:163], v[100:103]
    v_mfma_f32_16x16x32_bf16 v[96:99], v[128:131], v[156:159], v[96:99]
    v_mfma_f32_16x16x32_bf16 v[88:91], v[124:127], v[156:159], v[88:91]
    v_mfma_f32_16x16x32_bf16 v[92:95], v[124:127], v[160:163], v[92:95]
    v_mfma_f32_16x16x32_bf16 v[84:87], v[120:123], v[160:163], v[84:87]
    v_mfma_f32_16x16x32_bf16 v[80:83], v[120:123], v[156:159], v[80:83]
    v_mfma_f32_16x16x32_bf16 v[116:119], v[136:139], v[156:159], v[116:119]
    s_waitcnt lgkmcnt(0)
    s_barrier
    v_mfma_f32_16x16x32_bf16 v[16:19], v[184:187], v[164:167], v[16:19]
    ds_read_b128 v[120:123], v4 offset:18432
    v_mfma_f32_16x16x32_bf16 v[20:23], v[188:191], v[164:167], v[20:23]
    ds_read_b128 v[124:127], v4 offset:20480
    v_mfma_f32_16x16x32_bf16 v[52:55], v[196:199], v[164:167], v[52:55]
    ds_read_b128 v[128:131], v4 offset:22528
    v_mfma_f32_16x16x32_bf16 v[48:51], v[192:195], v[164:167], v[48:51]
    ds_read_b128 v[132:135], v4 offset:24576
    v_mfma_f32_16x16x32_bf16 v[56:59], v[192:195], v[168:171], v[56:59]
    ds_read_b128 v[136:139], v2 offset:18432
    v_mfma_f32_16x16x32_bf16 v[60:63], v[196:199], v[168:171], v[60:63]
    ds_read_b64_tr_b16 v[140:141], v6 offset:24576
    v_mfma_f32_16x16x32_bf16 v[28:31], v[188:191], v[168:171], v[28:31]
    ds_read_b64_tr_b16 v[142:143], v6 offset:25088
    v_mfma_f32_16x16x32_bf16 v[24:27], v[184:187], v[168:171], v[24:27]
    ds_read_b64_tr_b16 v[144:145], v7 offset:24576
    v_mfma_f32_16x16x32_bf16 v[32:35], v[184:187], v[172:175], v[32:35]
    ds_read_b64_tr_b16 v[146:147], v7 offset:25088
    v_mfma_f32_16x16x32_bf16 v[36:39], v[188:191], v[172:175], v[36:39]
    ds_read_b64_tr_b16 v[148:149], v6 offset:25600
    v_mfma_f32_16x16x32_bf16 v[68:71], v[196:199], v[172:175], v[68:71]
    ds_read_b64_tr_b16 v[150:151], v6 offset:26112
    v_mfma_f32_16x16x32_bf16 v[64:67], v[192:195], v[172:175], v[64:67]
    ds_read_b64_tr_b16 v[152:153], v7 offset:25600
    v_mfma_f32_16x16x32_bf16 v[112:115], v[192:195], v[180:183], v[112:115]
    ds_read_b64_tr_b16 v[154:155], v7 offset:26112
    v_mfma_f32_16x16x32_bf16 v[72:75], v[192:195], v[176:179], v[72:75]
    ds_read_b64_tr_b16 v[156:157], v6 offset:26624
    v_mfma_f32_16x16x32_bf16 v[76:79], v[196:199], v[176:179], v[76:79]
    ds_read_b64_tr_b16 v[158:159], v6 offset:27136
    v_mfma_f32_16x16x32_bf16 v[44:47], v[188:191], v[176:179], v[44:47]
    ds_read_b64_tr_b16 v[160:161], v7 offset:26624
    v_mfma_f32_16x16x32_bf16 v[40:43], v[184:187], v[176:179], v[40:43]
    ds_read_b64_tr_b16 v[162:163], v7 offset:27136
    v_mfma_f32_16x16x32_bf16 v[104:107], v[176:179], v[200:203], v[104:107]
    v_mfma_f32_16x16x32_bf16 v[108:111], v[176:179], v[204:207], v[108:111]
    v_mfma_f32_16x16x32_bf16 v[100:103], v[172:175], v[204:207], v[100:103]
    v_mfma_f32_16x16x32_bf16 v[96:99], v[172:175], v[200:203], v[96:99]
    v_mfma_f32_16x16x32_bf16 v[88:91], v[168:171], v[200:203], v[88:91]
    v_mfma_f32_16x16x32_bf16 v[92:95], v[168:171], v[204:207], v[92:95]
    v_mfma_f32_16x16x32_bf16 v[84:87], v[164:167], v[204:207], v[84:87]
    v_mfma_f32_16x16x32_bf16 v[80:83], v[164:167], v[200:203], v[80:83]
    v_mfma_f32_16x16x32_bf16 v[116:119], v[180:183], v[200:203], v[116:119]
    s_waitcnt lgkmcnt(0)
    v_mfma_f32_16x16x32_bf16 v[16:19], v[140:143], v[120:123], v[16:19]
    ds_read_b128 v[164:167], v5 offset:18432
    v_mfma_f32_16x16x32_bf16 v[20:23], v[144:147], v[120:123], v[20:23]
    ds_read_b128 v[168:171], v5 offset:20480
    v_mfma_f32_16x16x32_bf16 v[52:55], v[152:155], v[120:123], v[52:55]
    ds_read_b128 v[172:175], v5 offset:22528
    v_mfma_f32_16x16x32_bf16 v[48:51], v[148:151], v[120:123], v[48:51]
    ds_read_b128 v[176:179], v5 offset:24576
    v_mfma_f32_16x16x32_bf16 v[56:59], v[148:151], v[124:127], v[56:59]
    ds_read_b128 v[180:183], v3 offset:18432
    v_mfma_f32_16x16x32_bf16 v[60:63], v[152:155], v[124:127], v[60:63]
    ds_read_b64_tr_b16 v[184:185], v6 offset:36864
    v_mfma_f32_16x16x32_bf16 v[28:31], v[144:147], v[124:127], v[28:31]
    ds_read_b64_tr_b16 v[186:187], v6 offset:37376
    v_mfma_f32_16x16x32_bf16 v[24:27], v[140:143], v[124:127], v[24:27]
    ds_read_b64_tr_b16 v[188:189], v7 offset:36864
    v_mfma_f32_16x16x32_bf16 v[32:35], v[140:143], v[128:131], v[32:35]
    ds_read_b64_tr_b16 v[190:191], v7 offset:37376
    v_mfma_f32_16x16x32_bf16 v[36:39], v[144:147], v[128:131], v[36:39]
    ds_read_b64_tr_b16 v[192:193], v6 offset:37888
    v_mfma_f32_16x16x32_bf16 v[68:71], v[152:155], v[128:131], v[68:71]
    ds_read_b64_tr_b16 v[194:195], v6 offset:38400
    v_mfma_f32_16x16x32_bf16 v[64:67], v[148:151], v[128:131], v[64:67]
    ds_read_b64_tr_b16 v[196:197], v7 offset:37888
    v_mfma_f32_16x16x32_bf16 v[112:115], v[148:151], v[136:139], v[112:115]
    ds_read_b64_tr_b16 v[198:199], v7 offset:38400
    v_mfma_f32_16x16x32_bf16 v[72:75], v[148:151], v[132:135], v[72:75]
    ds_read_b64_tr_b16 v[200:201], v6 offset:38912
    v_mfma_f32_16x16x32_bf16 v[76:79], v[152:155], v[132:135], v[76:79]
    ds_read_b64_tr_b16 v[202:203], v6 offset:39424
    v_mfma_f32_16x16x32_bf16 v[44:47], v[144:147], v[132:135], v[44:47]
    ds_read_b64_tr_b16 v[204:205], v7 offset:38912
    v_mfma_f32_16x16x32_bf16 v[40:43], v[140:143], v[132:135], v[40:43]
    ds_read_b64_tr_b16 v[206:207], v7 offset:39424
    v_mfma_f32_16x16x32_bf16 v[104:107], v[132:135], v[156:159], v[104:107]
    v_mfma_f32_16x16x32_bf16 v[108:111], v[132:135], v[160:163], v[108:111]
    v_mfma_f32_16x16x32_bf16 v[100:103], v[128:131], v[160:163], v[100:103]
    v_mfma_f32_16x16x32_bf16 v[96:99], v[128:131], v[156:159], v[96:99]
    v_mfma_f32_16x16x32_bf16 v[88:91], v[124:127], v[156:159], v[88:91]
    v_mfma_f32_16x16x32_bf16 v[92:95], v[124:127], v[160:163], v[92:95]
    v_mfma_f32_16x16x32_bf16 v[84:87], v[120:123], v[160:163], v[84:87]
    v_mfma_f32_16x16x32_bf16 v[80:83], v[120:123], v[156:159], v[80:83]
    v_mfma_f32_16x16x32_bf16 v[116:119], v[136:139], v[156:159], v[116:119]
    s_waitcnt lgkmcnt(0)
    s_barrier
    v_mfma_f32_16x16x32_bf16 v[16:19], v[184:187], v[164:167], v[16:19]
    ds_read_b128 v[120:123], v4 offset:36864
    v_mfma_f32_16x16x32_bf16 v[20:23], v[188:191], v[164:167], v[20:23]
    ds_read_b128 v[124:127], v4 offset:38912
    v_mfma_f32_16x16x32_bf16 v[52:55], v[196:199], v[164:167], v[52:55]
    ds_read_b128 v[128:131], v4 offset:40960
    v_mfma_f32_16x16x32_bf16 v[48:51], v[192:195], v[164:167], v[48:51]
    ds_read_b128 v[132:135], v4 offset:43008
    v_mfma_f32_16x16x32_bf16 v[56:59], v[192:195], v[168:171], v[56:59]
    ds_read_b128 v[136:139], v2 offset:36864
    v_mfma_f32_16x16x32_bf16 v[60:63], v[196:199], v[168:171], v[60:63]
    ds_read_b64_tr_b16 v[140:141], v6 offset:49152
    v_mfma_f32_16x16x32_bf16 v[28:31], v[188:191], v[168:171], v[28:31]
    ds_read_b64_tr_b16 v[142:143], v6 offset:49664
    v_mfma_f32_16x16x32_bf16 v[24:27], v[184:187], v[168:171], v[24:27]
    ds_read_b64_tr_b16 v[144:145], v7 offset:49152
    v_mfma_f32_16x16x32_bf16 v[32:35], v[184:187], v[172:175], v[32:35]
    ds_read_b64_tr_b16 v[146:147], v7 offset:49664
    v_mfma_f32_16x16x32_bf16 v[36:39], v[188:191], v[172:175], v[36:39]
    ds_read_b64_tr_b16 v[148:149], v6 offset:50176
    v_mfma_f32_16x16x32_bf16 v[68:71], v[196:199], v[172:175], v[68:71]
    ds_read_b64_tr_b16 v[150:151], v6 offset:50688
    v_mfma_f32_16x16x32_bf16 v[64:67], v[192:195], v[172:175], v[64:67]
    ds_read_b64_tr_b16 v[152:153], v7 offset:50176
    v_mfma_f32_16x16x32_bf16 v[112:115], v[192:195], v[180:183], v[112:115]
    ds_read_b64_tr_b16 v[154:155], v7 offset:50688
    v_mfma_f32_16x16x32_bf16 v[72:75], v[192:195], v[176:179], v[72:75]
    ds_read_b64_tr_b16 v[156:157], v6 offset:51200
    v_mfma_f32_16x16x32_bf16 v[76:79], v[196:199], v[176:179], v[76:79]
    ds_read_b64_tr_b16 v[158:159], v6 offset:51712
    v_mfma_f32_16x16x32_bf16 v[44:47], v[188:191], v[176:179], v[44:47]
    ds_read_b64_tr_b16 v[160:161], v7 offset:51200
    v_mfma_f32_16x16x32_bf16 v[40:43], v[184:187], v[176:179], v[40:43]
    ds_read_b64_tr_b16 v[162:163], v7 offset:51712
    v_mfma_f32_16x16x32_bf16 v[104:107], v[176:179], v[200:203], v[104:107]
    v_mfma_f32_16x16x32_bf16 v[108:111], v[176:179], v[204:207], v[108:111]
    v_mfma_f32_16x16x32_bf16 v[100:103], v[172:175], v[204:207], v[100:103]
    v_mfma_f32_16x16x32_bf16 v[96:99], v[172:175], v[200:203], v[96:99]
    v_mfma_f32_16x16x32_bf16 v[88:91], v[168:171], v[200:203], v[88:91]
    v_mfma_f32_16x16x32_bf16 v[92:95], v[168:171], v[204:207], v[92:95]
    v_mfma_f32_16x16x32_bf16 v[84:87], v[164:167], v[204:207], v[84:87]
    v_mfma_f32_16x16x32_bf16 v[80:83], v[164:167], v[200:203], v[80:83]
    v_mfma_f32_16x16x32_bf16 v[116:119], v[180:183], v[200:203], v[116:119]
    s_waitcnt lgkmcnt(0)
    v_mfma_f32_16x16x32_bf16 v[16:19], v[140:143], v[120:123], v[16:19]
    ds_read_b128 v[164:167], v5 offset:36864
    v_mfma_f32_16x16x32_bf16 v[20:23], v[144:147], v[120:123], v[20:23]
    ds_read_b128 v[168:171], v5 offset:38912
    v_mfma_f32_16x16x32_bf16 v[52:55], v[152:155], v[120:123], v[52:55]
    ds_read_b128 v[172:175], v5 offset:40960
    v_mfma_f32_16x16x32_bf16 v[48:51], v[148:151], v[120:123], v[48:51]
    ds_read_b128 v[176:179], v5 offset:43008
    v_mfma_f32_16x16x32_bf16 v[56:59], v[148:151], v[124:127], v[56:59]
    ds_read_b128 v[180:183], v3 offset:36864
    v_mfma_f32_16x16x32_bf16 v[60:63], v[152:155], v[124:127], v[60:63]
    ds_read_b64_tr_b16 v[184:185], v6 offset:61440
    v_mfma_f32_16x16x32_bf16 v[28:31], v[144:147], v[124:127], v[28:31]
    ds_read_b64_tr_b16 v[186:187], v6 offset:61952
    v_mfma_f32_16x16x32_bf16 v[24:27], v[140:143], v[124:127], v[24:27]
    ds_read_b64_tr_b16 v[188:189], v7 offset:61440
    v_mfma_f32_16x16x32_bf16 v[32:35], v[140:143], v[128:131], v[32:35]
    ds_read_b64_tr_b16 v[190:191], v7 offset:61952
    v_mfma_f32_16x16x32_bf16 v[36:39], v[144:147], v[128:131], v[36:39]
    ds_read_b64_tr_b16 v[192:193], v6 offset:62464
    v_mfma_f32_16x16x32_bf16 v[68:71], v[152:155], v[128:131], v[68:71]
    ds_read_b64_tr_b16 v[194:195], v6 offset:62976
    v_mfma_f32_16x16x32_bf16 v[64:67], v[148:151], v[128:131], v[64:67]
    ds_read_b64_tr_b16 v[196:197], v7 offset:62464
    v_mfma_f32_16x16x32_bf16 v[112:115], v[148:151], v[136:139], v[112:115]
    ds_read_b64_tr_b16 v[198:199], v7 offset:62976
    v_mfma_f32_16x16x32_bf16 v[72:75], v[148:151], v[132:135], v[72:75]
    ds_read_b64_tr_b16 v[200:201], v6 offset:63488
    v_mfma_f32_16x16x32_bf16 v[76:79], v[152:155], v[132:135], v[76:79]
    ds_read_b64_tr_b16 v[202:203], v6 offset:64000
    v_mfma_f32_16x16x32_bf16 v[44:47], v[144:147], v[132:135], v[44:47]
    ds_read_b64_tr_b16 v[204:205], v7 offset:63488
    v_mfma_f32_16x16x32_bf16 v[40:43], v[140:143], v[132:135], v[40:43]
    ds_read_b64_tr_b16 v[206:207], v7 offset:64000
    v_mfma_f32_16x16x32_bf16 v[104:107], v[132:135], v[156:159], v[104:107]
    v_mfma_f32_16x16x32_bf16 v[108:111], v[132:135], v[160:163], v[108:111]
    v_mfma_f32_16x16x32_bf16 v[100:103], v[128:131], v[160:163], v[100:103]
    v_mfma_f32_16x16x32_bf16 v[96:99], v[128:131], v[156:159], v[96:99]
    v_mfma_f32_16x16x32_bf16 v[88:91], v[124:127], v[156:159], v[88:91]
    v_mfma_f32_16x16x32_bf16 v[92:95], v[124:127], v[160:163], v[92:95]
    v_mfma_f32_16x16x32_bf16 v[84:87], v[120:123], v[160:163], v[84:87]
    v_mfma_f32_16x16x32_bf16 v[80:83], v[120:123], v[156:159], v[80:83]
    v_mfma_f32_16x16x32_bf16 v[116:119], v[136:139], v[156:159], v[116:119]
    s_waitcnt lgkmcnt(0)
    s_barrier
    v_mfma_f32_16x16x32_bf16 v[16:19], v[184:187], v[164:167], v[16:19]
    ds_read_b128 v[120:123], v4 offset:0
    v_mfma_f32_16x16x32_bf16 v[20:23], v[188:191], v[164:167], v[20:23]
    ds_read_b128 v[124:127], v4 offset:2048
    v_mfma_f32_16x16x32_bf16 v[52:55], v[196:199], v[164:167], v[52:55]
    ds_read_b128 v[128:131], v4 offset:4096
    v_mfma_f32_16x16x32_bf16 v[48:51], v[192:195], v[164:167], v[48:51]
    ds_read_b128 v[132:135], v4 offset:6144
    v_mfma_f32_16x16x32_bf16 v[56:59], v[192:195], v[168:171], v[56:59]
    ds_read_b128 v[136:139], v2 offset:0
    v_mfma_f32_16x16x32_bf16 v[60:63], v[196:199], v[168:171], v[60:63]
    ds_read_b64_tr_b16 v[140:141], v6 offset:0
    v_mfma_f32_16x16x32_bf16 v[28:31], v[188:191], v[168:171], v[28:31]
    ds_read_b64_tr_b16 v[142:143], v6 offset:512
    v_mfma_f32_16x16x32_bf16 v[24:27], v[184:187], v[168:171], v[24:27]
    ds_read_b64_tr_b16 v[144:145], v7 offset:0
    v_mfma_f32_16x16x32_bf16 v[32:35], v[184:187], v[172:175], v[32:35]
    ds_read_b64_tr_b16 v[146:147], v7 offset:512
    v_mfma_f32_16x16x32_bf16 v[36:39], v[188:191], v[172:175], v[36:39]
    ds_read_b64_tr_b16 v[148:149], v6 offset:1024
    v_mfma_f32_16x16x32_bf16 v[68:71], v[196:199], v[172:175], v[68:71]
    ds_read_b64_tr_b16 v[150:151], v6 offset:1536
    v_mfma_f32_16x16x32_bf16 v[64:67], v[192:195], v[172:175], v[64:67]
    ds_read_b64_tr_b16 v[152:153], v7 offset:1024
    v_mfma_f32_16x16x32_bf16 v[112:115], v[192:195], v[180:183], v[112:115]
    ds_read_b64_tr_b16 v[154:155], v7 offset:1536
    v_mfma_f32_16x16x32_bf16 v[72:75], v[192:195], v[176:179], v[72:75]
    ds_read_b64_tr_b16 v[156:157], v6 offset:2048
    v_mfma_f32_16x16x32_bf16 v[76:79], v[196:199], v[176:179], v[76:79]
    ds_read_b64_tr_b16 v[158:159], v6 offset:2560
    v_mfma_f32_16x16x32_bf16 v[44:47], v[188:191], v[176:179], v[44:47]
    ds_read_b64_tr_b16 v[160:161], v7 offset:2048
    v_mfma_f32_16x16x32_bf16 v[40:43], v[184:187], v[176:179], v[40:43]
    ds_read_b64_tr_b16 v[162:163], v7 offset:2560
    v_mfma_f32_16x16x32_bf16 v[104:107], v[176:179], v[200:203], v[104:107]
    v_mfma_f32_16x16x32_bf16 v[108:111], v[176:179], v[204:207], v[108:111]
    v_mfma_f32_16x16x32_bf16 v[100:103], v[172:175], v[204:207], v[100:103]
    v_mfma_f32_16x16x32_bf16 v[96:99], v[172:175], v[200:203], v[96:99]
    v_mfma_f32_16x16x32_bf16 v[88:91], v[168:171], v[200:203], v[88:91]
    v_mfma_f32_16x16x32_bf16 v[92:95], v[168:171], v[204:207], v[92:95]
    v_mfma_f32_16x16x32_bf16 v[84:87], v[164:167], v[204:207], v[84:87]
    v_mfma_f32_16x16x32_bf16 v[80:83], v[164:167], v[200:203], v[80:83]
    v_mfma_f32_16x16x32_bf16 v[116:119], v[180:183], v[200:203], v[116:119]
    s_waitcnt lgkmcnt(0)
    v_mfma_f32_16x16x32_bf16 v[16:19], v[140:143], v[120:123], v[16:19]
    ds_read_b128 v[164:167], v5 offset:0
    v_mfma_f32_16x16x32_bf16 v[20:23], v[144:147], v[120:123], v[20:23]
    ds_read_b128 v[168:171], v5 offset:2048
    v_mfma_f32_16x16x32_bf16 v[52:55], v[152:155], v[120:123], v[52:55]
    ds_read_b128 v[172:175], v5 offset:4096
    v_mfma_f32_16x16x32_bf16 v[48:51], v[148:151], v[120:123], v[48:51]
    ds_read_b128 v[176:179], v5 offset:6144
    v_mfma_f32_16x16x32_bf16 v[56:59], v[148:151], v[124:127], v[56:59]
    ds_read_b128 v[180:183], v3 offset:0
    v_mfma_f32_16x16x32_bf16 v[60:63], v[152:155], v[124:127], v[60:63]
    ds_read_b64_tr_b16 v[184:185], v6 offset:12288
    v_mfma_f32_16x16x32_bf16 v[28:31], v[144:147], v[124:127], v[28:31]
    ds_read_b64_tr_b16 v[186:187], v6 offset:12800
    v_mfma_f32_16x16x32_bf16 v[24:27], v[140:143], v[124:127], v[24:27]
    ds_read_b64_tr_b16 v[188:189], v7 offset:12288
    v_mfma_f32_16x16x32_bf16 v[32:35], v[140:143], v[128:131], v[32:35]
    ds_read_b64_tr_b16 v[190:191], v7 offset:12800
    v_mfma_f32_16x16x32_bf16 v[36:39], v[144:147], v[128:131], v[36:39]
    ds_read_b64_tr_b16 v[192:193], v6 offset:13312
    v_mfma_f32_16x16x32_bf16 v[68:71], v[152:155], v[128:131], v[68:71]
    ds_read_b64_tr_b16 v[194:195], v6 offset:13824
    v_mfma_f32_16x16x32_bf16 v[64:67], v[148:151], v[128:131], v[64:67]
    ds_read_b64_tr_b16 v[196:197], v7 offset:13312
    v_mfma_f32_16x16x32_bf16 v[112:115], v[148:151], v[136:139], v[112:115]
    ds_read_b64_tr_b16 v[198:199], v7 offset:13824
    v_mfma_f32_16x16x32_bf16 v[72:75], v[148:151], v[132:135], v[72:75]
    ds_read_b64_tr_b16 v[200:201], v6 offset:14336
    v_mfma_f32_16x16x32_bf16 v[76:79], v[152:155], v[132:135], v[76:79]
    ds_read_b64_tr_b16 v[202:203], v6 offset:14848
    v_mfma_f32_16x16x32_bf16 v[44:47], v[144:147], v[132:135], v[44:47]
    ds_read_b64_tr_b16 v[204:205], v7 offset:14336
    v_mfma_f32_16x16x32_bf16 v[40:43], v[140:143], v[132:135], v[40:43]
    ds_read_b64_tr_b16 v[206:207], v7 offset:14848
    v_mfma_f32_16x16x32_bf16 v[104:107], v[132:135], v[156:159], v[104:107]
    v_mfma_f32_16x16x32_bf16 v[108:111], v[132:135], v[160:163], v[108:111]
    v_mfma_f32_16x16x32_bf16 v[100:103], v[128:131], v[160:163], v[100:103]
    v_mfma_f32_16x16x32_bf16 v[96:99], v[128:131], v[156:159], v[96:99]
    v_mfma_f32_16x16x32_bf16 v[88:91], v[124:127], v[156:159], v[88:91]
    v_mfma_f32_16x16x32_bf16 v[92:95], v[124:127], v[160:163], v[92:95]
    v_mfma_f32_16x16x32_bf16 v[84:87], v[120:123], v[160:163], v[84:87]
    v_mfma_f32_16x16x32_bf16 v[80:83], v[120:123], v[156:159], v[80:83]
    v_mfma_f32_16x16x32_bf16 v[116:119], v[136:139], v[156:159], v[116:119]
    s_waitcnt lgkmcnt(0)
    s_barrier
    v_mfma_f32_16x16x32_bf16 v[16:19], v[184:187], v[164:167], v[16:19]
    ds_read_b128 v[120:123], v4 offset:18432
    v_mfma_f32_16x16x32_bf16 v[20:23], v[188:191], v[164:167], v[20:23]
    ds_read_b128 v[124:127], v4 offset:20480
    v_mfma_f32_16x16x32_bf16 v[52:55], v[196:199], v[164:167], v[52:55]
    ds_read_b128 v[128:131], v4 offset:22528
    v_mfma_f32_16x16x32_bf16 v[48:51], v[192:195], v[164:167], v[48:51]
    ds_read_b128 v[132:135], v4 offset:24576
    v_mfma_f32_16x16x32_bf16 v[56:59], v[192:195], v[168:171], v[56:59]
    ds_read_b128 v[136:139], v2 offset:18432
    v_mfma_f32_16x16x32_bf16 v[60:63], v[196:199], v[168:171], v[60:63]
    ds_read_b64_tr_b16 v[140:141], v6 offset:24576
    v_mfma_f32_16x16x32_bf16 v[28:31], v[188:191], v[168:171], v[28:31]
    ds_read_b64_tr_b16 v[142:143], v6 offset:25088
    v_mfma_f32_16x16x32_bf16 v[24:27], v[184:187], v[168:171], v[24:27]
    ds_read_b64_tr_b16 v[144:145], v7 offset:24576
    v_mfma_f32_16x16x32_bf16 v[32:35], v[184:187], v[172:175], v[32:35]
    ds_read_b64_tr_b16 v[146:147], v7 offset:25088
    v_mfma_f32_16x16x32_bf16 v[36:39], v[188:191], v[172:175], v[36:39]
    ds_read_b64_tr_b16 v[148:149], v6 offset:25600
    v_mfma_f32_16x16x32_bf16 v[68:71], v[196:199], v[172:175], v[68:71]
    ds_read_b64_tr_b16 v[150:151], v6 offset:26112
    v_mfma_f32_16x16x32_bf16 v[64:67], v[192:195], v[172:175], v[64:67]
    ds_read_b64_tr_b16 v[152:153], v7 offset:25600
    v_mfma_f32_16x16x32_bf16 v[112:115], v[192:195], v[180:183], v[112:115]
    ds_read_b64_tr_b16 v[154:155], v7 offset:26112
    v_mfma_f32_16x16x32_bf16 v[72:75], v[192:195], v[176:179], v[72:75]
    ds_read_b64_tr_b16 v[156:157], v6 offset:26624
    v_mfma_f32_16x16x32_bf16 v[76:79], v[196:199], v[176:179], v[76:79]
    ds_read_b64_tr_b16 v[158:159], v6 offset:27136
    v_mfma_f32_16x16x32_bf16 v[44:47], v[188:191], v[176:179], v[44:47]
    ds_read_b64_tr_b16 v[160:161], v7 offset:26624
    v_mfma_f32_16x16x32_bf16 v[40:43], v[184:187], v[176:179], v[40:43]
    ds_read_b64_tr_b16 v[162:163], v7 offset:27136
    v_mfma_f32_16x16x32_bf16 v[104:107], v[176:179], v[200:203], v[104:107]
    v_mfma_f32_16x16x32_bf16 v[108:111], v[176:179], v[204:207], v[108:111]
    v_mfma_f32_16x16x32_bf16 v[100:103], v[172:175], v[204:207], v[100:103]
    v_mfma_f32_16x16x32_bf16 v[96:99], v[172:175], v[200:203], v[96:99]
    v_mfma_f32_16x16x32_bf16 v[88:91], v[168:171], v[200:203], v[88:91]
    v_mfma_f32_16x16x32_bf16 v[92:95], v[168:171], v[204:207], v[92:95]
    v_mfma_f32_16x16x32_bf16 v[84:87], v[164:167], v[204:207], v[84:87]
    v_mfma_f32_16x16x32_bf16 v[80:83], v[164:167], v[200:203], v[80:83]
    v_mfma_f32_16x16x32_bf16 v[116:119], v[180:183], v[200:203], v[116:119]
    s_waitcnt lgkmcnt(0)
    v_mfma_f32_16x16x32_bf16 v[16:19], v[140:143], v[120:123], v[16:19]
    ds_read_b128 v[164:167], v5 offset:18432
    v_mfma_f32_16x16x32_bf16 v[20:23], v[144:147], v[120:123], v[20:23]
    ds_read_b128 v[168:171], v5 offset:20480
    v_mfma_f32_16x16x32_bf16 v[52:55], v[152:155], v[120:123], v[52:55]
    ds_read_b128 v[172:175], v5 offset:22528
    v_mfma_f32_16x16x32_bf16 v[48:51], v[148:151], v[120:123], v[48:51]
    ds_read_b128 v[176:179], v5 offset:24576
    v_mfma_f32_16x16x32_bf16 v[56:59], v[148:151], v[124:127], v[56:59]
    ds_read_b128 v[180:183], v3 offset:18432
    v_mfma_f32_16x16x32_bf16 v[60:63], v[152:155], v[124:127], v[60:63]
    ds_read_b64_tr_b16 v[184:185], v6 offset:36864
    v_mfma_f32_16x16x32_bf16 v[28:31], v[144:147], v[124:127], v[28:31]
    ds_read_b64_tr_b16 v[186:187], v6 offset:37376
    v_mfma_f32_16x16x32_bf16 v[24:27], v[140:143], v[124:127], v[24:27]
    ds_read_b64_tr_b16 v[188:189], v7 offset:36864
    v_mfma_f32_16x16x32_bf16 v[32:35], v[140:143], v[128:131], v[32:35]
    ds_read_b64_tr_b16 v[190:191], v7 offset:37376
    v_mfma_f32_16x16x32_bf16 v[36:39], v[144:147], v[128:131], v[36:39]
    ds_read_b64_tr_b16 v[192:193], v6 offset:37888
    v_mfma_f32_16x16x32_bf16 v[68:71], v[152:155], v[128:131], v[68:71]
    ds_read_b64_tr_b16 v[194:195], v6 offset:38400
    v_mfma_f32_16x16x32_bf16 v[64:67], v[148:151], v[128:131], v[64:67]
    ds_read_b64_tr_b16 v[196:197], v7 offset:37888
    v_mfma_f32_16x16x32_bf16 v[112:115], v[148:151], v[136:139], v[112:115]
    ds_read_b64_tr_b16 v[198:199], v7 offset:38400
    v_mfma_f32_16x16x32_bf16 v[72:75], v[148:151], v[132:135], v[72:75]
    ds_read_b64_tr_b16 v[200:201], v6 offset:38912
    v_mfma_f32_16x16x32_bf16 v[76:79], v[152:155], v[132:135], v[76:79]
    ds_read_b64_tr_b16 v[202:203], v6 offset:39424
    v_mfma_f32_16x16x32_bf16 v[44:47], v[144:147], v[132:135], v[44:47]
    ds_read_b64_tr_b16 v[204:205], v7 offset:38912
    v_mfma_f32_16x16x32_bf16 v[40:43], v[140:143], v[132:135], v[40:43]
    ds_read_b64_tr_b16 v[206:207], v7 offset:39424
    v_mfma_f32_16x16x32_bf16 v[104:107], v[132:135], v[156:159], v[104:107]
    v_mfma_f32_16x16x32_bf16 v[108:111], v[132:135], v[160:163], v[108:111]
    v_mfma_f32_16x16x32_bf16 v[100:103], v[128:131], v[160:163], v[100:103]
    v_mfma_f32_16x16x32_bf16 v[96:99], v[128:131], v[156:159], v[96:99]
    v_mfma_f32_16x16x32_bf16 v[88:91], v[124:127], v[156:159], v[88:91]
    v_mfma_f32_16x16x32_bf16 v[92:95], v[124:127], v[160:163], v[92:95]
    v_mfma_f32_16x16x32_bf16 v[84:87], v[120:123], v[160:163], v[84:87]
    v_mfma_f32_16x16x32_bf16 v[80:83], v[120:123], v[156:159], v[80:83]
    v_mfma_f32_16x16x32_bf16 v[116:119], v[136:139], v[156:159], v[116:119]
    s_waitcnt lgkmcnt(0)
    s_barrier
    v_mfma_f32_16x16x32_bf16 v[16:19], v[184:187], v[164:167], v[16:19]
    ds_read_b128 v[120:123], v4 offset:36864
    v_mfma_f32_16x16x32_bf16 v[20:23], v[188:191], v[164:167], v[20:23]
    ds_read_b128 v[124:127], v4 offset:38912
    v_mfma_f32_16x16x32_bf16 v[52:55], v[196:199], v[164:167], v[52:55]
    ds_read_b128 v[128:131], v4 offset:40960
    v_mfma_f32_16x16x32_bf16 v[48:51], v[192:195], v[164:167], v[48:51]
    ds_read_b128 v[132:135], v4 offset:43008
    v_mfma_f32_16x16x32_bf16 v[56:59], v[192:195], v[168:171], v[56:59]
    ds_read_b128 v[136:139], v2 offset:36864
    v_mfma_f32_16x16x32_bf16 v[60:63], v[196:199], v[168:171], v[60:63]
    ds_read_b64_tr_b16 v[140:141], v6 offset:49152
    v_mfma_f32_16x16x32_bf16 v[28:31], v[188:191], v[168:171], v[28:31]
    ds_read_b64_tr_b16 v[142:143], v6 offset:49664
    v_mfma_f32_16x16x32_bf16 v[24:27], v[184:187], v[168:171], v[24:27]
    ds_read_b64_tr_b16 v[144:145], v7 offset:49152
    v_mfma_f32_16x16x32_bf16 v[32:35], v[184:187], v[172:175], v[32:35]
    ds_read_b64_tr_b16 v[146:147], v7 offset:49664
    v_mfma_f32_16x16x32_bf16 v[36:39], v[188:191], v[172:175], v[36:39]
    ds_read_b64_tr_b16 v[148:149], v6 offset:50176
    v_mfma_f32_16x16x32_bf16 v[68:71], v[196:199], v[172:175], v[68:71]
    ds_read_b64_tr_b16 v[150:151], v6 offset:50688
    v_mfma_f32_16x16x32_bf16 v[64:67], v[192:195], v[172:175], v[64:67]
    ds_read_b64_tr_b16 v[152:153], v7 offset:50176
    v_mfma_f32_16x16x32_bf16 v[112:115], v[192:195], v[180:183], v[112:115]
    ds_read_b64_tr_b16 v[154:155], v7 offset:50688
    v_mfma_f32_16x16x32_bf16 v[72:75], v[192:195], v[176:179], v[72:75]
    ds_read_b64_tr_b16 v[156:157], v6 offset:51200
    v_mfma_f32_16x16x32_bf16 v[76:79], v[196:199], v[176:179], v[76:79]
    ds_read_b64_tr_b16 v[158:159], v6 offset:51712
    v_mfma_f32_16x16x32_bf16 v[44:47], v[188:191], v[176:179], v[44:47]
    ds_read_b64_tr_b16 v[160:161], v7 offset:51200
    v_mfma_f32_16x16x32_bf16 v[40:43], v[184:187], v[176:179], v[40:43]
    ds_read_b64_tr_b16 v[162:163], v7 offset:51712
    v_mfma_f32_16x16x32_bf16 v[104:107], v[176:179], v[200:203], v[104:107]
    v_mfma_f32_16x16x32_bf16 v[108:111], v[176:179], v[204:207], v[108:111]
    v_mfma_f32_16x16x32_bf16 v[100:103], v[172:175], v[204:207], v[100:103]
    v_mfma_f32_16x16x32_bf16 v[96:99], v[172:175], v[200:203], v[96:99]
    v_mfma_f32_16x16x32_bf16 v[88:91], v[168:171], v[200:203], v[88:91]
    v_mfma_f32_16x16x32_bf16 v[92:95], v[168:171], v[204:207], v[92:95]
    v_mfma_f32_16x16x32_bf16 v[84:87], v[164:167], v[204:207], v[84:87]
    v_mfma_f32_16x16x32_bf16 v[80:83], v[164:167], v[200:203], v[80:83]
    v_mfma_f32_16x16x32_bf16 v[116:119], v[180:183], v[200:203], v[116:119]
    s_waitcnt lgkmcnt(0)
    v_mfma_f32_16x16x32_bf16 v[16:19], v[140:143], v[120:123], v[16:19]
    ds_read_b128 v[164:167], v5 offset:36864
    v_mfma_f32_16x16x32_bf16 v[20:23], v[144:147], v[120:123], v[20:23]
    ds_read_b128 v[168:171], v5 offset:38912
    v_mfma_f32_16x16x32_bf16 v[52:55], v[152:155], v[120:123], v[52:55]
    ds_read_b128 v[172:175], v5 offset:40960
    v_mfma_f32_16x16x32_bf16 v[48:51], v[148:151], v[120:123], v[48:51]
    ds_read_b128 v[176:179], v5 offset:43008
    v_mfma_f32_16x16x32_bf16 v[56:59], v[148:151], v[124:127], v[56:59]
    ds_read_b128 v[180:183], v3 offset:36864
    v_mfma_f32_16x16x32_bf16 v[60:63], v[152:155], v[124:127], v[60:63]
    ds_read_b64_tr_b16 v[184:185], v6 offset:61440
    v_mfma_f32_16x16x32_bf16 v[28:31], v[144:147], v[124:127], v[28:31]
    ds_read_b64_tr_b16 v[186:187], v6 offset:61952
    v_mfma_f32_16x16x32_bf16 v[24:27], v[140:143], v[124:127], v[24:27]
    ds_read_b64_tr_b16 v[188:189], v7 offset:61440
    v_mfma_f32_16x16x32_bf16 v[32:35], v[140:143], v[128:131], v[32:35]
    ds_read_b64_tr_b16 v[190:191], v7 offset:61952
    v_mfma_f32_16x16x32_bf16 v[36:39], v[144:147], v[128:131], v[36:39]
    ds_read_b64_tr_b16 v[192:193], v6 offset:62464
    v_mfma_f32_16x16x32_bf16 v[68:71], v[152:155], v[128:131], v[68:71]
    ds_read_b64_tr_b16 v[194:195], v6 offset:62976
    v_mfma_f32_16x16x32_bf16 v[64:67], v[148:151], v[128:131], v[64:67]
    ds_read_b64_tr_b16 v[196:197], v7 offset:62464
    v_mfma_f32_16x16x32_bf16 v[112:115], v[148:151], v[136:139], v[112:115]
    ds_read_b64_tr_b16 v[198:199], v7 offset:62976
    v_mfma_f32_16x16x32_bf16 v[72:75], v[148:151], v[132:135], v[72:75]
    ds_read_b64_tr_b16 v[200:201], v6 offset:63488
    v_mfma_f32_16x16x32_bf16 v[76:79], v[152:155], v[132:135], v[76:79]
    ds_read_b64_tr_b16 v[202:203], v6 offset:64000
    v_mfma_f32_16x16x32_bf16 v[44:47], v[144:147], v[132:135], v[44:47]
    ds_read_b64_tr_b16 v[204:205], v7 offset:63488
    v_mfma_f32_16x16x32_bf16 v[40:43], v[140:143], v[132:135], v[40:43]
    ds_read_b64_tr_b16 v[206:207], v7 offset:64000
    v_mfma_f32_16x16x32_bf16 v[104:107], v[132:135], v[156:159], v[104:107]
    v_mfma_f32_16x16x32_bf16 v[108:111], v[132:135], v[160:163], v[108:111]
    v_mfma_f32_16x16x32_bf16 v[100:103], v[128:131], v[160:163], v[100:103]
    v_mfma_f32_16x16x32_bf16 v[96:99], v[128:131], v[156:159], v[96:99]
    v_mfma_f32_16x16x32_bf16 v[88:91], v[124:127], v[156:159], v[88:91]
    v_mfma_f32_16x16x32_bf16 v[92:95], v[124:127], v[160:163], v[92:95]
    v_mfma_f32_16x16x32_bf16 v[84:87], v[120:123], v[160:163], v[84:87]
    v_mfma_f32_16x16x32_bf16 v[80:83], v[120:123], v[156:159], v[80:83]
    v_mfma_f32_16x16x32_bf16 v[116:119], v[136:139], v[156:159], v[116:119]
    s_waitcnt lgkmcnt(0)
    s_barrier
    v_mfma_f32_16x16x32_bf16 v[16:19], v[184:187], v[164:167], v[16:19]
    ds_read_b128 v[120:123], v4 offset:0
    v_mfma_f32_16x16x32_bf16 v[20:23], v[188:191], v[164:167], v[20:23]
    ds_read_b128 v[124:127], v4 offset:2048
    v_mfma_f32_16x16x32_bf16 v[52:55], v[196:199], v[164:167], v[52:55]
    ds_read_b128 v[128:131], v4 offset:4096
    v_mfma_f32_16x16x32_bf16 v[48:51], v[192:195], v[164:167], v[48:51]
    ds_read_b128 v[132:135], v4 offset:6144
    v_mfma_f32_16x16x32_bf16 v[56:59], v[192:195], v[168:171], v[56:59]
    ds_read_b128 v[136:139], v2 offset:0
    v_mfma_f32_16x16x32_bf16 v[60:63], v[196:199], v[168:171], v[60:63]
    ds_read_b64_tr_b16 v[140:141], v6 offset:0
    v_mfma_f32_16x16x32_bf16 v[28:31], v[188:191], v[168:171], v[28:31]
    ds_read_b64_tr_b16 v[142:143], v6 offset:512
    v_mfma_f32_16x16x32_bf16 v[24:27], v[184:187], v[168:171], v[24:27]
    ds_read_b64_tr_b16 v[144:145], v7 offset:0
    v_mfma_f32_16x16x32_bf16 v[32:35], v[184:187], v[172:175], v[32:35]
    ds_read_b64_tr_b16 v[146:147], v7 offset:512
    v_mfma_f32_16x16x32_bf16 v[36:39], v[188:191], v[172:175], v[36:39]
    ds_read_b64_tr_b16 v[148:149], v6 offset:1024
    v_mfma_f32_16x16x32_bf16 v[68:71], v[196:199], v[172:175], v[68:71]
    ds_read_b64_tr_b16 v[150:151], v6 offset:1536
    v_mfma_f32_16x16x32_bf16 v[64:67], v[192:195], v[172:175], v[64:67]
    ds_read_b64_tr_b16 v[152:153], v7 offset:1024
    v_mfma_f32_16x16x32_bf16 v[112:115], v[192:195], v[180:183], v[112:115]
    ds_read_b64_tr_b16 v[154:155], v7 offset:1536
    v_mfma_f32_16x16x32_bf16 v[72:75], v[192:195], v[176:179], v[72:75]
    ds_read_b64_tr_b16 v[156:157], v6 offset:2048
    v_mfma_f32_16x16x32_bf16 v[76:79], v[196:199], v[176:179], v[76:79]
    ds_read_b64_tr_b16 v[158:159], v6 offset:2560
    v_mfma_f32_16x16x32_bf16 v[44:47], v[188:191], v[176:179], v[44:47]
    ds_read_b64_tr_b16 v[160:161], v7 offset:2048
    v_mfma_f32_16x16x32_bf16 v[40:43], v[184:187], v[176:179], v[40:43]
    ds_read_b64_tr_b16 v[162:163], v7 offset:2560
    v_mfma_f32_16x16x32_bf16 v[104:107], v[176:179], v[200:203], v[104:107]
    v_mfma_f32_16x16x32_bf16 v[108:111], v[176:179], v[204:207], v[108:111]
    v_mfma_f32_16x16x32_bf16 v[100:103], v[172:175], v[204:207], v[100:103]
    v_mfma_f32_16x16x32_bf16 v[96:99], v[172:175], v[200:203], v[96:99]
    v_mfma_f32_16x16x32_bf16 v[88:91], v[168:171], v[200:203], v[88:91]
    v_mfma_f32_16x16x32_bf16 v[92:95], v[168:171], v[204:207], v[92:95]
    v_mfma_f32_16x16x32_bf16 v[84:87], v[164:167], v[204:207], v[84:87]
    v_mfma_f32_16x16x32_bf16 v[80:83], v[164:167], v[200:203], v[80:83]
    v_mfma_f32_16x16x32_bf16 v[116:119], v[180:183], v[200:203], v[116:119]
    s_waitcnt lgkmcnt(0)
    v_mfma_f32_16x16x32_bf16 v[16:19], v[140:143], v[120:123], v[16:19]
    ds_read_b128 v[164:167], v5 offset:0
    v_mfma_f32_16x16x32_bf16 v[20:23], v[144:147], v[120:123], v[20:23]
    ds_read_b128 v[168:171], v5 offset:2048
    v_mfma_f32_16x16x32_bf16 v[52:55], v[152:155], v[120:123], v[52:55]
    ds_read_b128 v[172:175], v5 offset:4096
    v_mfma_f32_16x16x32_bf16 v[48:51], v[148:151], v[120:123], v[48:51]
    ds_read_b128 v[176:179], v5 offset:6144
    v_mfma_f32_16x16x32_bf16 v[56:59], v[148:151], v[124:127], v[56:59]
    ds_read_b128 v[180:183], v3 offset:0
    v_mfma_f32_16x16x32_bf16 v[60:63], v[152:155], v[124:127], v[60:63]
    ds_read_b64_tr_b16 v[184:185], v6 offset:12288
    v_mfma_f32_16x16x32_bf16 v[28:31], v[144:147], v[124:127], v[28:31]
    ds_read_b64_tr_b16 v[186:187], v6 offset:12800
    v_mfma_f32_16x16x32_bf16 v[24:27], v[140:143], v[124:127], v[24:27]
    ds_read_b64_tr_b16 v[188:189], v7 offset:12288
    v_mfma_f32_16x16x32_bf16 v[32:35], v[140:143], v[128:131], v[32:35]
    ds_read_b64_tr_b16 v[190:191], v7 offset:12800
    v_mfma_f32_16x16x32_bf16 v[36:39], v[144:147], v[128:131], v[36:39]
    ds_read_b64_tr_b16 v[192:193], v6 offset:13312
    v_mfma_f32_16x16x32_bf16 v[68:71], v[152:155], v[128:131], v[68:71]
    ds_read_b64_tr_b16 v[194:195], v6 offset:13824
    v_mfma_f32_16x16x32_bf16 v[64:67], v[148:151], v[128:131], v[64:67]
    ds_read_b64_tr_b16 v[196:197], v7 offset:13312
    v_mfma_f32_16x16x32_bf16 v[112:115], v[148:151], v[136:139], v[112:115]
    ds_read_b64_tr_b16 v[198:199], v7 offset:13824
    v_mfma_f32_16x16x32_bf16 v[72:75], v[148:151], v[132:135], v[72:75]
    ds_read_b64_tr_b16 v[200:201], v6 offset:14336
    v_mfma_f32_16x16x32_bf16 v[76:79], v[152:155], v[132:135], v[76:79]
    ds_read_b64_tr_b16 v[202:203], v6 offset:14848
    v_mfma_f32_16x16x32_bf16 v[44:47], v[144:147], v[132:135], v[44:47]
    ds_read_b64_tr_b16 v[204:205], v7 offset:14336
    v_mfma_f32_16x16x32_bf16 v[40:43], v[140:143], v[132:135], v[40:43]
    ds_read_b64_tr_b16 v[206:207], v7 offset:14848
    v_mfma_f32_16x16x32_bf16 v[104:107], v[132:135], v[156:159], v[104:107]
    buffer_load_dword v222, v220, s[68:71], s98 offen sc1
    v_mfma_f32_16x16x32_bf16 v[108:111], v[132:135], v[160:163], v[108:111]
    v_mfma_f32_16x16x32_bf16 v[100:103], v[128:131], v[160:163], v[100:103]
    v_mfma_f32_16x16x32_bf16 v[96:99], v[128:131], v[156:159], v[96:99]
    v_mfma_f32_16x16x32_bf16 v[88:91], v[124:127], v[156:159], v[88:91]
    v_mfma_f32_16x16x32_bf16 v[92:95], v[124:127], v[160:163], v[92:95]
    v_mfma_f32_16x16x32_bf16 v[84:87], v[120:123], v[160:163], v[84:87]
    v_mfma_f32_16x16x32_bf16 v[80:83], v[120:123], v[156:159], v[80:83]
    v_mfma_f32_16x16x32_bf16 v[116:119], v[136:139], v[156:159], v[116:119]
    s_waitcnt lgkmcnt(0)
    s_barrier
    v_mfma_f32_16x16x32_bf16 v[16:19], v[184:187], v[164:167], v[16:19]
    ds_read_b128 v[120:123], v4 offset:18432
    v_mfma_f32_16x16x32_bf16 v[20:23], v[188:191], v[164:167], v[20:23]
    ds_read_b128 v[124:127], v4 offset:20480
    v_mfma_f32_16x16x32_bf16 v[52:55], v[196:199], v[164:167], v[52:55]
    ds_read_b128 v[128:131], v4 offset:22528
    v_mfma_f32_16x16x32_bf16 v[48:51], v[192:195], v[164:167], v[48:51]
    ds_read_b128 v[132:135], v4 offset:24576
    v_mfma_f32_16x16x32_bf16 v[56:59], v[192:195], v[168:171], v[56:59]
    ds_read_b128 v[136:139], v2 offset:18432
    v_mfma_f32_16x16x32_bf16 v[60:63], v[196:199], v[168:171], v[60:63]
    ds_read_b64_tr_b16 v[140:141], v6 offset:24576
    v_mfma_f32_16x16x32_bf16 v[28:31], v[188:191], v[168:171], v[28:31]
    ds_read_b64_tr_b16 v[142:143], v6 offset:25088
    v_mfma_f32_16x16x32_bf16 v[24:27], v[184:187], v[168:171], v[24:27]
    ds_read_b64_tr_b16 v[144:145], v7 offset:24576
    v_mfma_f32_16x16x32_bf16 v[32:35], v[184:187], v[172:175], v[32:35]
    ds_read_b64_tr_b16 v[146:147], v7 offset:25088
    v_mfma_f32_16x16x32_bf16 v[36:39], v[188:191], v[172:175], v[36:39]
    ds_read_b64_tr_b16 v[148:149], v6 offset:25600
    v_mfma_f32_16x16x32_bf16 v[68:71], v[196:199], v[172:175], v[68:71]
    ds_read_b64_tr_b16 v[150:151], v6 offset:26112
    v_mfma_f32_16x16x32_bf16 v[64:67], v[192:195], v[172:175], v[64:67]
    ds_read_b64_tr_b16 v[152:153], v7 offset:25600
    v_mfma_f32_16x16x32_bf16 v[112:115], v[192:195], v[180:183], v[112:115]
    ds_read_b64_tr_b16 v[154:155], v7 offset:26112
    v_mfma_f32_16x16x32_bf16 v[72:75], v[192:195], v[176:179], v[72:75]
    ds_read_b64_tr_b16 v[156:157], v6 offset:26624
    v_mfma_f32_16x16x32_bf16 v[76:79], v[196:199], v[176:179], v[76:79]
    ds_read_b64_tr_b16 v[158:159], v6 offset:27136
    v_mfma_f32_16x16x32_bf16 v[44:47], v[188:191], v[176:179], v[44:47]
    ds_read_b64_tr_b16 v[160:161], v7 offset:26624
    v_mfma_f32_16x16x32_bf16 v[40:43], v[184:187], v[176:179], v[40:43]
    ds_read_b64_tr_b16 v[162:163], v7 offset:27136
    v_mfma_f32_16x16x32_bf16 v[104:107], v[176:179], v[200:203], v[104:107]
    v_mfma_f32_16x16x32_bf16 v[108:111], v[176:179], v[204:207], v[108:111]
    v_mfma_f32_16x16x32_bf16 v[100:103], v[172:175], v[204:207], v[100:103]
    v_mfma_f32_16x16x32_bf16 v[96:99], v[172:175], v[200:203], v[96:99]
    v_mfma_f32_16x16x32_bf16 v[88:91], v[168:171], v[200:203], v[88:91]
    v_mfma_f32_16x16x32_bf16 v[92:95], v[168:171], v[204:207], v[92:95]
    v_mfma_f32_16x16x32_bf16 v[84:87], v[164:167], v[204:207], v[84:87]
    v_mfma_f32_16x16x32_bf16 v[80:83], v[164:167], v[200:203], v[80:83]
    v_mfma_f32_16x16x32_bf16 v[116:119], v[180:183], v[200:203], v[116:119]
    s_waitcnt lgkmcnt(0)
    v_mfma_f32_16x16x32_bf16 v[16:19], v[140:143], v[120:123], v[16:19]
    ds_read_b128 v[164:167], v5 offset:18432
    v_mfma_f32_16x16x32_bf16 v[20:23], v[144:147], v[120:123], v[20:23]
    ds_read_b128 v[168:171], v5 offset:20480
    v_mfma_f32_16x16x32_bf16 v[52:55], v[152:155], v[120:123], v[52:55]
    ds_read_b128 v[172:175], v5 offset:22528
    v_mfma_f32_16x16x32_bf16 v[48:51], v[148:151], v[120:123], v[48:51]
    ds_read_b128 v[176:179], v5 offset:24576
    v_mfma_f32_16x16x32_bf16 v[56:59], v[148:151], v[124:127], v[56:59]
    ds_read_b128 v[180:183], v3 offset:18432
    v_mfma_f32_16x16x32_bf16 v[60:63], v[152:155], v[124:127], v[60:63]
    ds_read_b64_tr_b16 v[184:185], v6 offset:36864
    v_mfma_f32_16x16x32_bf16 v[28:31], v[144:147], v[124:127], v[28:31]
    ds_read_b64_tr_b16 v[186:187], v6 offset:37376
    v_mfma_f32_16x16x32_bf16 v[24:27], v[140:143], v[124:127], v[24:27]
    ds_read_b64_tr_b16 v[188:189], v7 offset:36864
    v_mfma_f32_16x16x32_bf16 v[32:35], v[140:143], v[128:131], v[32:35]
    ds_read_b64_tr_b16 v[190:191], v7 offset:37376
    v_mfma_f32_16x16x32_bf16 v[36:39], v[144:147], v[128:131], v[36:39]
    ds_read_b64_tr_b16 v[192:193], v6 offset:37888
    v_mfma_f32_16x16x32_bf16 v[68:71], v[152:155], v[128:131], v[68:71]
    ds_read_b64_tr_b16 v[194:195], v6 offset:38400
    v_mfma_f32_16x16x32_bf16 v[64:67], v[148:151], v[128:131], v[64:67]
    ds_read_b64_tr_b16 v[196:197], v7 offset:37888
    v_mfma_f32_16x16x32_bf16 v[112:115], v[148:151], v[136:139], v[112:115]
    ds_read_b64_tr_b16 v[198:199], v7 offset:38400
    v_mfma_f32_16x16x32_bf16 v[72:75], v[148:151], v[132:135], v[72:75]
    ds_read_b64_tr_b16 v[200:201], v6 offset:38912
    v_mfma_f32_16x16x32_bf16 v[76:79], v[152:155], v[132:135], v[76:79]
    ds_read_b64_tr_b16 v[202:203], v6 offset:39424
    v_mfma_f32_16x16x32_bf16 v[44:47], v[144:147], v[132:135], v[44:47]
    ds_read_b64_tr_b16 v[204:205], v7 offset:38912
    v_mfma_f32_16x16x32_bf16 v[40:43], v[140:143], v[132:135], v[40:43]
    ds_read_b64_tr_b16 v[206:207], v7 offset:39424
    v_mfma_f32_16x16x32_bf16 v[104:107], v[132:135], v[156:159], v[104:107]
    v_mfma_f32_16x16x32_bf16 v[108:111], v[132:135], v[160:163], v[108:111]
    v_mfma_f32_16x16x32_bf16 v[100:103], v[128:131], v[160:163], v[100:103]
    v_mfma_f32_16x16x32_bf16 v[96:99], v[128:131], v[156:159], v[96:99]
    v_mfma_f32_16x16x32_bf16 v[88:91], v[124:127], v[156:159], v[88:91]
    v_mfma_f32_16x16x32_bf16 v[92:95], v[124:127], v[160:163], v[92:95]
    v_mfma_f32_16x16x32_bf16 v[84:87], v[120:123], v[160:163], v[84:87]
    v_mfma_f32_16x16x32_bf16 v[80:83], v[120:123], v[156:159], v[80:83]
    v_mfma_f32_16x16x32_bf16 v[116:119], v[136:139], v[156:159], v[116:119]
    s_waitcnt lgkmcnt(0)
    s_barrier
    v_mfma_f32_16x16x32_bf16 v[16:19], v[184:187], v[164:167], v[16:19]
    ds_read_b128 v[120:123], v4 offset:36864
    v_mfma_f32_16x16x32_bf16 v[20:23], v[188:191], v[164:167], v[20:23]
    ds_read_b128 v[124:127], v4 offset:38912
    v_mfma_f32_16x16x32_bf16 v[52:55], v[196:199], v[164:167], v[52:55]
    ds_read_b128 v[128:131], v4 offset:40960
    v_mfma_f32_16x16x32_bf16 v[48:51], v[192:195], v[164:167], v[48:51]
    ds_read_b128 v[132:135], v4 offset:43008
    v_mfma_f32_16x16x32_bf16 v[56:59], v[192:195], v[168:171], v[56:59]
    ds_read_b128 v[136:139], v2 offset:36864
    v_mfma_f32_16x16x32_bf16 v[60:63], v[196:199], v[168:171], v[60:63]
    ds_read_b64_tr_b16 v[140:141], v6 offset:49152
    v_mfma_f32_16x16x32_bf16 v[28:31], v[188:191], v[168:171], v[28:31]
    ds_read_b64_tr_b16 v[142:143], v6 offset:49664
    v_mfma_f32_16x16x32_bf16 v[24:27], v[184:187], v[168:171], v[24:27]
    ds_read_b64_tr_b16 v[144:145], v7 offset:49152
    v_mfma_f32_16x16x32_bf16 v[32:35], v[184:187], v[172:175], v[32:35]
    ds_read_b64_tr_b16 v[146:147], v7 offset:49664
    v_mfma_f32_16x16x32_bf16 v[36:39], v[188:191], v[172:175], v[36:39]
    ds_read_b64_tr_b16 v[148:149], v6 offset:50176
    v_mfma_f32_16x16x32_bf16 v[68:71], v[196:199], v[172:175], v[68:71]
    ds_read_b64_tr_b16 v[150:151], v6 offset:50688
    v_mfma_f32_16x16x32_bf16 v[64:67], v[192:195], v[172:175], v[64:67]
    ds_read_b64_tr_b16 v[152:153], v7 offset:50176
    v_mfma_f32_16x16x32_bf16 v[112:115], v[192:195], v[180:183], v[112:115]
    ds_read_b64_tr_b16 v[154:155], v7 offset:50688
    v_mfma_f32_16x16x32_bf16 v[72:75], v[192:195], v[176:179], v[72:75]
    ds_read_b64_tr_b16 v[156:157], v6 offset:51200
    v_mfma_f32_16x16x32_bf16 v[76:79], v[196:199], v[176:179], v[76:79]
    ds_read_b64_tr_b16 v[158:159], v6 offset:51712
    v_mfma_f32_16x16x32_bf16 v[44:47], v[188:191], v[176:179], v[44:47]
    ds_read_b64_tr_b16 v[160:161], v7 offset:51200
    v_mfma_f32_16x16x32_bf16 v[40:43], v[184:187], v[176:179], v[40:43]
    ds_read_b64_tr_b16 v[162:163], v7 offset:51712
    v_mfma_f32_16x16x32_bf16 v[104:107], v[176:179], v[200:203], v[104:107]
    v_mfma_f32_16x16x32_bf16 v[108:111], v[176:179], v[204:207], v[108:111]
    v_mfma_f32_16x16x32_bf16 v[100:103], v[172:175], v[204:207], v[100:103]
    v_mfma_f32_16x16x32_bf16 v[96:99], v[172:175], v[200:203], v[96:99]
    v_mfma_f32_16x16x32_bf16 v[88:91], v[168:171], v[200:203], v[88:91]
    v_mfma_f32_16x16x32_bf16 v[92:95], v[168:171], v[204:207], v[92:95]
    v_mfma_f32_16x16x32_bf16 v[84:87], v[164:167], v[204:207], v[84:87]
    v_mfma_f32_16x16x32_bf16 v[80:83], v[164:167], v[200:203], v[80:83]
    v_mfma_f32_16x16x32_bf16 v[116:119], v[180:183], v[200:203], v[116:119]
    s_waitcnt lgkmcnt(0)
    v_mfma_f32_16x16x32_bf16 v[16:19], v[140:143], v[120:123], v[16:19]
    ds_read_b128 v[164:167], v5 offset:36864
    v_mfma_f32_16x16x32_bf16 v[20:23], v[144:147], v[120:123], v[20:23]
    ds_read_b128 v[168:171], v5 offset:38912
    v_mfma_f32_16x16x32_bf16 v[52:55], v[152:155], v[120:123], v[52:55]
    ds_read_b128 v[172:175], v5 offset:40960
    v_mfma_f32_16x16x32_bf16 v[48:51], v[148:151], v[120:123], v[48:51]
    ds_read_b128 v[176:179], v5 offset:43008
    v_mfma_f32_16x16x32_bf16 v[56:59], v[148:151], v[124:127], v[56:59]
    ds_read_b128 v[180:183], v3 offset:36864
    v_mfma_f32_16x16x32_bf16 v[60:63], v[152:155], v[124:127], v[60:63]
    ds_read_b64_tr_b16 v[184:185], v6 offset:61440
    v_mfma_f32_16x16x32_bf16 v[28:31], v[144:147], v[124:127], v[28:31]
    ds_read_b64_tr_b16 v[186:187], v6 offset:61952
    v_mfma_f32_16x16x32_bf16 v[24:27], v[140:143], v[124:127], v[24:27]
    ds_read_b64_tr_b16 v[188:189], v7 offset:61440
    v_mfma_f32_16x16x32_bf16 v[32:35], v[140:143], v[128:131], v[32:35]
    ds_read_b64_tr_b16 v[190:191], v7 offset:61952
    v_mfma_f32_16x16x32_bf16 v[36:39], v[144:147], v[128:131], v[36:39]
    ds_read_b64_tr_b16 v[192:193], v6 offset:62464
    v_mfma_f32_16x16x32_bf16 v[68:71], v[152:155], v[128:131], v[68:71]
    ds_read_b64_tr_b16 v[194:195], v6 offset:62976
    v_mfma_f32_16x16x32_bf16 v[64:67], v[148:151], v[128:131], v[64:67]
    ds_read_b64_tr_b16 v[196:197], v7 offset:62464
    v_mfma_f32_16x16x32_bf16 v[112:115], v[148:151], v[136:139], v[112:115]
    ds_read_b64_tr_b16 v[198:199], v7 offset:62976
    v_mfma_f32_16x16x32_bf16 v[72:75], v[148:151], v[132:135], v[72:75]
    ds_read_b64_tr_b16 v[200:201], v6 offset:63488
    v_mfma_f32_16x16x32_bf16 v[76:79], v[152:155], v[132:135], v[76:79]
    ds_read_b64_tr_b16 v[202:203], v6 offset:64000
    v_mfma_f32_16x16x32_bf16 v[44:47], v[144:147], v[132:135], v[44:47]
    ds_read_b64_tr_b16 v[204:205], v7 offset:63488
    v_mfma_f32_16x16x32_bf16 v[40:43], v[140:143], v[132:135], v[40:43]
    ds_read_b64_tr_b16 v[206:207], v7 offset:64000
    v_mfma_f32_16x16x32_bf16 v[104:107], v[132:135], v[156:159], v[104:107]
    v_mfma_f32_16x16x32_bf16 v[108:111], v[132:135], v[160:163], v[108:111]
    v_mfma_f32_16x16x32_bf16 v[100:103], v[128:131], v[160:163], v[100:103]
    v_mfma_f32_16x16x32_bf16 v[96:99], v[128:131], v[156:159], v[96:99]
    v_mfma_f32_16x16x32_bf16 v[88:91], v[124:127], v[156:159], v[88:91]
    v_mfma_f32_16x16x32_bf16 v[92:95], v[124:127], v[160:163], v[92:95]
    v_mfma_f32_16x16x32_bf16 v[84:87], v[120:123], v[160:163], v[84:87]
    v_mfma_f32_16x16x32_bf16 v[80:83], v[120:123], v[156:159], v[80:83]
    v_mfma_f32_16x16x32_bf16 v[116:119], v[136:139], v[156:159], v[116:119]
    s_waitcnt lgkmcnt(0)
    s_barrier
    s_cmp_lg_u32 s3, 0
    s_cbranch_scc1 LB_sk
    s_waitcnt vmcnt(0)
    v_cmp_eq_u32 vcc, 0, v222
    s_cbranch_vccnz LB_slow
LB_back:
    s_mov_b64 exec, 1
    buffer_store_dword v222, v220, s[52:55], s96 offen sc1
    s_mov_b64 exec, -1
LB_sk:
    v_mfma_f32_16x16x32_bf16 v[16:19], v[184:187], v[164:167], v[16:19]
    ds_read_b128 v[120:123], v4 offset:0
    v_mfma_f32_16x16x32_bf16 v[20:23], v[188:191], v[164:167], v[20:23]
    ds_read_b128 v[124:127], v4 offset:2048
    v_mfma_f32_16x16x32_bf16 v[52:55], v[196:199], v[164:167], v[52:55]
    ds_read_b128 v[128:131], v4 offset:4096
    v_mfma_f32_16x16x32_bf16 v[48:51], v[192:195], v[164:167], v[48:51]
    ds_read_b128 v[132:135], v4 offset:6144
    v_mfma_f32_16x16x32_bf16 v[56:59], v[192:195], v[168:171], v[56:59]
    ds_read_b128 v[136:139], v2 offset:0
    v_mfma_f32_16x16x32_bf16 v[60:63], v[196:199], v[168:171], v[60:63]
    ds_read_b64_tr_b16 v[140:141], v6 offset:0
    v_mfma_f32_16x16x32_bf16 v[28:31], v[188:191], v[168:171], v[28:31]
    ds_read_b64_tr_b16 v[142:143], v6 offset:512
    v_mfma_f32_16x16x32_bf16 v[24:27], v[184:187], v[168:171], v[24:27]
    ds_read_b64_tr_b16 v[144:145], v7 offset:0
    v_mfma_f32_16x16x32_bf16 v[32:35], v[184:187], v[172:175], v[32:35]
    ds_read_b64_tr_b16 v[146:147], v7 offset:512
    v_mfma_f32_16x16x32_bf16 v[36:39], v[188:191], v[172:175], v[36:39]
    ds_read_b64_tr_b16 v[148:149], v6 offset:1024
    v_mfma_f32_16x16x32_bf16 v[68:71], v[196:199], v[172:175], v[68:71]
    ds_read_b64_tr_b16 v[150:151], v6 offset:1536
    v_mfma_f32_16x16x32_bf16 v[64:67], v[192:195], v[172:175], v[64:67]
    ds_read_b64_tr_b16 v[152:153], v7 offset:1024
    v_mfma_f32_16x16x32_bf16 v[112:115], v[192:195], v[180:183], v[112:115]
    ds_read_b64_tr_b16 v[154:155], v7 offset:1536
    v_mfma_f32_16x16x32_bf16 v[72:75], v[192:195], v[176:179], v[72:75]
    ds_read_b64_tr_b16 v[156:157], v6 offset:2048
    v_mfma_f32_16x16x32_bf16 v[76:79], v[196:199], v[176:179], v[76:79]
    ds_read_b64_tr_b16 v[158:159], v6 offset:2560
    v_mfma_f32_16x16x32_bf16 v[44:47], v[188:191], v[176:179], v[44:47]
    ds_read_b64_tr_b16 v[160:161], v7 offset:2048
    v_mfma_f32_16x16x32_bf16 v[40:43], v[184:187], v[176:179], v[40:43]
    ds_read_b64_tr_b16 v[162:163], v7 offset:2560
    v_mfma_f32_16x16x32_bf16 v[104:107], v[176:179], v[200:203], v[104:107]
    v_mfma_f32_16x16x32_bf16 v[108:111], v[176:179], v[204:207], v[108:111]
    v_mfma_f32_16x16x32_bf16 v[100:103], v[172:175], v[204:207], v[100:103]
    v_mfma_f32_16x16x32_bf16 v[96:99], v[172:175], v[200:203], v[96:99]
    v_mfma_f32_16x16x32_bf16 v[88:91], v[168:171], v[200:203], v[88:91]
    v_mfma_f32_16x16x32_bf16 v[92:95], v[168:171], v[204:207], v[92:95]
    v_mfma_f32_16x16x32_bf16 v[84:87], v[164:167], v[204:207], v[84:87]
    v_mfma_f32_16x16x32_bf16 v[80:83], v[164:167], v[200:203], v[80:83]
    v_mfma_f32_16x16x32_bf16 v[116:119], v[180:183], v[200:203], v[116:119]
    s_waitcnt lgkmcnt(0)
    v_mfma_f32_16x16x32_bf16 v[16:19], v[140:143], v[120:123], v[16:19]
    ds_read_b128 v[164:167], v5 offset:0
    v_mfma_f32_16x16x32_bf16 v[20:23], v[144:147], v[120:123], v[20:23]
    ds_read_b128 v[168:171], v5 offset:2048
    v_mfma_f32_16x16x32_bf16 v[52:55], v[152:155], v[120:123], v[52:55]
    ds_read_b128 v[172:175], v5 offset:4096
    v_mfma_f32_16x16x32_bf16 v[48:51], v[148:151], v[120:123], v[48:51]
    ds_read_b128 v[176:179], v5 offset:6144
    v_mfma_f32_16x16x32_bf16 v[56:59], v[148:151], v[124:127], v[56:59]
    ds_read_b128 v[180:183], v3 offset:0
    v_mfma_f32_16x16x32_bf16 v[60:63], v[152:155], v[124:127], v[60:63]
    ds_read_b64_tr_b16 v[184:185], v6 offset:12288
    v_mfma_f32_16x16x32_bf16 v[28:31], v[144:147], v[124:127], v[28:31]
    ds_read_b64_tr_b16 v[186:187], v6 offset:12800
    v_mfma_f32_16x16x32_bf16 v[24:27], v[140:143], v[124:127], v[24:27]
    ds_read_b64_tr_b16 v[188:189], v7 offset:12288
    v_mfma_f32_16x16x32_bf16 v[32:35], v[140:143], v[128:131], v[32:35]
    ds_read_b64_tr_b16 v[190:191], v7 offset:12800
    v_mfma_f32_16x16x32_bf16 v[36:39], v[144:147], v[128:131], v[36:39]
    ds_read_b64_tr_b16 v[192:193], v6 offset:13312
    v_mfma_f32_16x16x32_bf16 v[68:71], v[152:155], v[128:131], v[68:71]
    ds_read_b64_tr_b16 v[194:195], v6 offset:13824
    v_mfma_f32_16x16x32_bf16 v[64:67], v[148:151], v[128:131], v[64:67]
    ds_read_b64_tr_b16 v[196:197], v7 offset:13312
    v_mfma_f32_16x16x32_bf16 v[112:115], v[148:151], v[136:139], v[112:115]
    ds_read_b64_tr_b16 v[198:199], v7 offset:13824
    v_mfma_f32_16x16x32_bf16 v[72:75], v[148:151], v[132:135], v[72:75]
    ds_read_b64_tr_b16 v[200:201], v6 offset:14336
    v_mfma_f32_16x16x32_bf16 v[76:79], v[152:155], v[132:135], v[76:79]
    ds_read_b64_tr_b16 v[202:203], v6 offset:14848
    v_mfma_f32_16x16x32_bf16 v[44:47], v[144:147], v[132:135], v[44:47]
    ds_read_b64_tr_b16 v[204:205], v7 offset:14336
    v_mfma_f32_16x16x32_bf16 v[40:43], v[140:143], v[132:135], v[40:43]
    ds_read_b64_tr_b16 v[206:207], v7 offset:14848
    v_mfma_f32_16x16x32_bf16 v[104:107], v[132:135], v[156:159], v[104:107]
    v_mfma_f32_16x16x32_bf16 v[108:111], v[132:135], v[160:163], v[108:111]
    v_mfma_f32_16x16x32_bf16 v[100:103], v[128:131], v[160:163], v[100:103]
    v_mfma_f32_16x16x32_bf16 v[96:99], v[128:131], v[156:159], v[96:99]
    v_mfma_f32_16x16x32_bf16 v[88:91], v[124:127], v[156:159], v[88:91]
    v_mfma_f32_16x16x32_bf16 v[92:95], v[124:127], v[160:163], v[92:95]
    v_mfma_f32_16x16x32_bf16 v[84:87], v[120:123], v[160:163], v[84:87]
    v_mfma_f32_16x16x32_bf16 v[80:83], v[120:123], v[156:159], v[80:83]
    v_mfma_f32_16x16x32_bf16 v[116:119], v[136:139], v[156:159], v[116:119]
    s_waitcnt lgkmcnt(0)
    s_barrier
    v_mfma_f32_16x16x32_bf16 v[16:19], v[184:187], v[164:167], v[16:19]
    ds_read_b128 v[120:123], v4 offset:18432
    v_mfma_f32_16x16x32_bf16 v[20:23], v[188:191], v[164:167], v[20:23]
    ds_read_b128 v[124:127], v4 offset:20480
    v_mfma_f32_16x16x32_bf16 v[52:55], v[196:199], v[164:167], v[52:55]
    ds_read_b128 v[128:131], v4 offset:22528
    v_mfma_f32_16x16x32_bf16 v[48:51], v[192:195], v[164:167], v[48:51]
    ds_read_b128 v[132:135], v4 offset:24576
    v_mfma_f32_16x16x32_bf16 v[56:59], v[192:195], v[168:171], v[56:59]
    ds_read_b128 v[136:139], v2 offset:18432
    v_mfma_f32_16x16x32_bf16 v[60:63], v[196:199], v[168:171], v[60:63]
    ds_read_b64_tr_b16 v[140:141], v6 offset:24576
    v_mfma_f32_16x16x32_bf16 v[28:31], v[188:191], v[168:171], v[28:31]
    ds_read_b64_tr_b16 v[142:143], v6 offset:25088
    v_mfma_f32_16x16x32_bf16 v[24:27], v[184:187], v[168:171], v[24:27]
    ds_read_b64_tr_b16 v[144:145], v7 offset:24576
    v_mfma_f32_16x16x32_bf16 v[32:35], v[184:187], v[172:175], v[32:35]
    ds_read_b64_tr_b16 v[146:147], v7 offset:25088
    v_mfma_f32_16x16x32_bf16 v[36:39], v[188:191], v[172:175], v[36:39]
    ds_read_b64_tr_b16 v[148:149], v6 offset:25600
    v_mfma_f32_16x16x32_bf16 v[68:71], v[196:199], v[172:175], v[68:71]
    ds_read_b64_tr_b16 v[150:151], v6 offset:26112
    v_mfma_f32_16x16x32_bf16 v[64:67], v[192:195], v[172:175], v[64:67]
    ds_read_b64_tr_b16 v[152:153], v7 offset:25600
    v_mfma_f32_16x16x32_bf16 v[112:115], v[192:195], v[180:183], v[112:115]
    ds_read_b64_tr_b16 v[154:155], v7 offset:26112
    v_mfma_f32_16x16x32_bf16 v[72:75], v[192:195], v[176:179], v[72:75]
    ds_read_b64_tr_b16 v[156:157], v6 offset:26624
    v_mfma_f32_16x16x32_bf16 v[76:79], v[196:199], v[176:179], v[76:79]
    ds_read_b64_tr_b16 v[158:159], v6 offset:27136
    v_mfma_f32_16x16x32_bf16 v[44:47], v[188:191], v[176:179], v[44:47]
    ds_read_b64_tr_b16 v[160:161], v7 offset:26624
    v_mfma_f32_16x16x32_bf16 v[40:43], v[184:187], v[176:179], v[40:43]
    ds_read_b64_tr_b16 v[162:163], v7 offset:27136
    v_mfma_f32_16x16x32_bf16 v[104:107], v[176:179], v[200:203], v[104:107]
    v_mfma_f32_16x16x32_bf16 v[108:111], v[176:179], v[204:207], v[108:111]
    v_mfma_f32_16x16x32_bf16 v[100:103], v[172:175], v[204:207], v[100:103]
    v_mfma_f32_16x16x32_bf16 v[96:99], v[172:175], v[200:203], v[96:99]
    v_mfma_f32_16x16x32_bf16 v[88:91], v[168:171], v[200:203], v[88:91]
    v_mfma_f32_16x16x32_bf16 v[92:95], v[168:171], v[204:207], v[92:95]
    v_mfma_f32_16x16x32_bf16 v[84:87], v[164:167], v[204:207], v[84:87]
    v_mfma_f32_16x16x32_bf16 v[80:83], v[164:167], v[200:203], v[80:83]
    v_mfma_f32_16x16x32_bf16 v[116:119], v[180:183], v[200:203], v[116:119]
    s_waitcnt lgkmcnt(0)
    v_mfma_f32_16x16x32_bf16 v[16:19], v[140:143], v[120:123], v[16:19]
    ds_read_b128 v[164:167], v5 offset:18432
    v_mfma_f32_16x16x32_bf16 v[20:23], v[144:147], v[120:123], v[20:23]
    ds_read_b128 v[168:171], v5 offset:20480
    v_mfma_f32_16x16x32_bf16 v[52:55], v[152:155], v[120:123], v[52:55]
    ds_read_b128 v[172:175], v5 offset:22528
    v_mfma_f32_16x16x32_bf16 v[48:51], v[148:151], v[120:123], v[48:51]
    ds_read_b128 v[176:179], v5 offset:24576
    v_mfma_f32_16x16x32_bf16 v[56:59], v[148:151], v[124:127], v[56:59]
    ds_read_b128 v[180:183], v3 offset:18432
    v_mfma_f32_16x16x32_bf16 v[60:63], v[152:155], v[124:127], v[60:63]
    ds_read_b64_tr_b16 v[184:185], v6 offset:36864
    v_mfma_f32_16x16x32_bf16 v[28:31], v[144:147], v[124:127], v[28:31]
    ds_read_b64_tr_b16 v[186:187], v6 offset:37376
    v_mfma_f32_16x16x32_bf16 v[24:27], v[140:143], v[124:127], v[24:27]
    ds_read_b64_tr_b16 v[188:189], v7 offset:36864
    v_mfma_f32_16x16x32_bf16 v[32:35], v[140:143], v[128:131], v[32:35]
    ds_read_b64_tr_b16 v[190:191], v7 offset:37376
    v_mfma_f32_16x16x32_bf16 v[36:39], v[144:147], v[128:131], v[36:39]
    ds_read_b64_tr_b16 v[192:193], v6 offset:37888
    v_mfma_f32_16x16x32_bf16 v[68:71], v[152:155], v[128:131], v[68:71]
    ds_read_b64_tr_b16 v[194:195], v6 offset:38400
    v_mfma_f32_16x16x32_bf16 v[64:67], v[148:151], v[128:131], v[64:67]
    ds_read_b64_tr_b16 v[196:197], v7 offset:37888
    v_mfma_f32_16x16x32_bf16 v[112:115], v[148:151], v[136:139], v[112:115]
    ds_read_b64_tr_b16 v[198:199], v7 offset:38400
    v_mfma_f32_16x16x32_bf16 v[72:75], v[148:151], v[132:135], v[72:75]
    ds_read_b64_tr_b16 v[200:201], v6 offset:38912
    v_mfma_f32_16x16x32_bf16 v[76:79], v[152:155], v[132:135], v[76:79]
    ds_read_b64_tr_b16 v[202:203], v6 offset:39424
    v_mfma_f32_16x16x32_bf16 v[44:47], v[144:147], v[132:135], v[44:47]
    ds_read_b64_tr_b16 v[204:205], v7 offset:38912
    v_mfma_f32_16x16x32_bf16 v[40:43], v[140:143], v[132:135], v[40:43]
    ds_read_b64_tr_b16 v[206:207], v7 offset:39424
    v_mfma_f32_16x16x32_bf16 v[104:107], v[132:135], v[156:159], v[104:107]
    v_mfma_f32_16x16x32_bf16 v[108:111], v[132:135], v[160:163], v[108:111]
    v_mfma_f32_16x16x32_bf16 v[100:103], v[128:131], v[160:163], v[100:103]
    v_mfma_f32_16x16x32_bf16 v[96:99], v[128:131], v[156:159], v[96:99]
    v_mfma_f32_16x16x32_bf16 v[88:91], v[124:127], v[156:159], v[88:91]
    v_mfma_f32_16x16x32_bf16 v[92:95], v[124:127], v[160:163], v[92:95]
    v_mfma_f32_16x16x32_bf16 v[84:87], v[120:123], v[160:163], v[84:87]
    v_mfma_f32_16x16x32_bf16 v[80:83], v[120:123], v[156:159], v[80:83]
    v_mfma_f32_16x16x32_bf16 v[116:119], v[136:139], v[156:159], v[116:119]
    s_waitcnt lgkmcnt(0)
    s_barrier
    v_mfma_f32_16x16x32_bf16 v[16:19], v[184:187], v[164:167], v[16:19]
    ds_read_b128 v[120:123], v4 offset:36864
    v_mfma_f32_16x16x32_bf16 v[20:23], v[188:191], v[164:167], v[20:23]
    ds_read_b128 v[124:127], v4 offset:38912
    v_mfma_f32_16x16x32_bf16 v[52:55], v[196:199], v[164:167], v[52:55]
    ds_read_b128 v[128:131], v4 offset:40960
    v_mfma_f32_16x16x32_bf16 v[48:51], v[192:195], v[164:167], v[48:51]
    ds_read_b128 v[132:135], v4 offset:43008
    v_mfma_f32_16x16x32_bf16 v[56:59], v[192:195], v[168:171], v[56:59]
    ds_read_b128 v[136:139], v2 offset:36864
    v_mfma_f32_16x16x32_bf16 v[60:63], v[196:199], v[168:171], v[60:63]
    ds_read_b64_tr_b16 v[140:141], v6 offset:49152
    v_mfma_f32_16x16x32_bf16 v[28:31], v[188:191], v[168:171], v[28:31]
    ds_read_b64_tr_b16 v[142:143], v6 offset:49664
    v_mfma_f32_16x16x32_bf16 v[24:27], v[184:187], v[168:171], v[24:27]
    ds_read_b64_tr_b16 v[144:145], v7 offset:49152
    v_mfma_f32_16x16x32_bf16 v[32:35], v[184:187], v[172:175], v[32:35]
    ds_read_b64_tr_b16 v[146:147], v7 offset:49664
    v_mfma_f32_16x16x32_bf16 v[36:39], v[188:191], v[172:175], v[36:39]
    ds_read_b64_tr_b16 v[148:149], v6 offset:50176
    v_mfma_f32_16x16x32_bf16 v[68:71], v[196:199], v[172:175], v[68:71]
    ds_read_b64_tr_b16 v[150:151], v6 offset:50688
    v_mfma_f32_16x16x32_bf16 v[64:67], v[192:195], v[172:175], v[64:67]
    ds_read_b64_tr_b16 v[152:153], v7 offset:50176
    v_mfma_f32_16x16x32_bf16 v[112:115], v[192:195], v[180:183], v[112:115]
    ds_read_b64_tr_b16 v[154:155], v7 offset:50688
    v_mfma_f32_16x16x32_bf16 v[72:75], v[192:195], v[176:179], v[72:75]
    ds_read_b64_tr_b16 v[156:157], v6 offset:51200
    v_mfma_f32_16x16x32_bf16 v[76:79], v[196:199], v[176:179], v[76:79]
    ds_read_b64_tr_b16 v[158:159], v6 offset:51712
    v_mfma_f32_16x16x32_bf16 v[44:47], v[188:191], v[176:179], v[44:47]
    ds_read_b64_tr_b16 v[160:161], v7 offset:51200
    v_mfma_f32_16x16x32_bf16 v[40:43], v[184:187], v[176:179], v[40:43]
    ds_read_b64_tr_b16 v[162:163], v7 offset:51712
    v_mfma_f32_16x16x32_bf16 v[104:107], v[176:179], v[200:203], v[104:107]
    v_mfma_f32_16x16x32_bf16 v[108:111], v[176:179], v[204:207], v[108:111]
    v_mfma_f32_16x16x32_bf16 v[100:103], v[172:175], v[204:207], v[100:103]
    v_mfma_f32_16x16x32_bf16 v[96:99], v[172:175], v[200:203], v[96:99]
    v_mfma_f32_16x16x32_bf16 v[88:91], v[168:171], v[200:203], v[88:91]
    v_mfma_f32_16x16x32_bf16 v[92:95], v[168:171], v[204:207], v[92:95]
    v_mfma_f32_16x16x32_bf16 v[84:87], v[164:167], v[204:207], v[84:87]
    v_mfma_f32_16x16x32_bf16 v[80:83], v[164:167], v[200:203], v[80:83]
    v_mfma_f32_16x16x32_bf16 v[116:119], v[180:183], v[200:203], v[116:119]
    s_waitcnt lgkmcnt(0)
    v_mfma_f32_16x16x32_bf16 v[16:19], v[140:143], v[120:123], v[16:19]
    ds_read_b128 v[164:167], v5 offset:36864
    v_mfma_f32_16x16x32_bf16 v[20:23], v[144:147], v[120:123], v[20:23]
    ds_read_b128 v[168:171], v5 offset:38912
    v_mfma_f32_16x16x32_bf16 v[52:55], v[152:155], v[120:123], v[52:55]
    ds_read_b128 v[172:175], v5 offset:40960
    v_mfma_f32_16x16x32_bf16 v[48:51], v[148:151], v[120:123], v[48:51]
    ds_read_b128 v[176:179], v5 offset:43008
    v_mfma_f32_16x16x32_bf16 v[56:59], v[148:151], v[124:127], v[56:59]
    ds_read_b128 v[180:183], v3 offset:36864
    v_mfma_f32_16x16x32_bf16 v[60:63], v[152:155], v[124:127], v[60:63]
    ds_read_b64_tr_b16 v[184:185], v6 offset:61440
    v_mfma_f32_16x16x32_bf16 v[28:31], v[144:147], v[124:127], v[28:31]
    ds_read_b64_tr_b16 v[186:187], v6 offset:61952
    v_mfma_f32_16x16x32_bf16 v[24:27], v[140:143], v[124:127], v[24:27]
    ds_read_b64_tr_b16 v[188:189], v7 offset:61440
    v_mfma_f32_16x16x32_bf16 v[32:35], v[140:143], v[128:131], v[32:35]
    ds_read_b64_tr_b16 v[190:191], v7 offset:61952
    v_mfma_f32_16x16x32_bf16 v[36:39], v[144:147], v[128:131], v[36:39]
    ds_read_b64_tr_b16 v[192:193], v6 offset:62464
    v_mfma_f32_16x16x32_bf16 v[68:71], v[152:155], v[128:131], v[68:71]
    ds_read_b64_tr_b16 v[194:195], v6 offset:62976
    v_mfma_f32_16x16x32_bf16 v[64:67], v[148:151], v[128:131], v[64:67]
    ds_read_b64_tr_b16 v[196:197], v7 offset:62464
    v_mfma_f32_16x16x32_bf16 v[112:115], v[148:151], v[136:139], v[112:115]
    ds_read_b64_tr_b16 v[198:199], v7 offset:62976
    v_mfma_f32_16x16x32_bf16 v[72:75], v[148:151], v[132:135], v[72:75]
    ds_read_b64_tr_b16 v[200:201], v6 offset:63488
    v_mfma_f32_16x16x32_bf16 v[76:79], v[152:155], v[132:135], v[76:79]
    ds_read_b64_tr_b16 v[202:203], v6 offset:64000
    v_mfma_f32_16x16x32_bf16 v[44:47], v[144:147], v[132:135], v[44:47]
    ds_read_b64_tr_b16 v[204:205], v7 offset:63488
    v_mfma_f32_16x16x32_bf16 v[40:43], v[140:143], v[132:135], v[40:43]
    ds_read_b64_tr_b16 v[206:207], v7 offset:64000
    v_mfma_f32_16x16x32_bf16 v[104:107], v[132:135], v[156:159], v[104:107]
    s_nop 0
    v_mfma_f32_16x16x32_bf16 v[108:111], v[132:135], v[160:163], v[108:111]
    s_nop 0
    v_mfma_f32_16x16x32_bf16 v[100:103], v[128:131], v[160:163], v[100:103]
    s_nop 0
    v_mfma_f32_16x16x32_bf16 v[96:99], v[128:131], v[156:159], v[96:99]
    s_nop 0
    v_mfma_f32_16x16x32_bf16 v[88:91], v[124:127], v[156:159], v[88:91]
    ds_read_b32 v223, v10 offset:24
    v_mfma_f32_16x16x32_bf16 v[92:95], v[124:127], v[160:163], v[92:95]
    v_mfma_f32_16x16x32_bf16 v[84:87], v[120:123], v[160:163], v[84:87]
    v_mfma_f32_16x16x32_bf16 v[80:83], v[120:123], v[156:159], v[80:83]
    v_mfma_f32_16x16x32_bf16 v[116:119], v[136:139], v[156:159], v[116:119]
    s_waitcnt lgkmcnt(0)
    v_cmp_gt_u32 vcc, 4, v223
    s_cbranch_vccnz LB_w15
LB_g15:
    v_mfma_f32_16x16x32_bf16 v[16:19], v[184:187], v[164:167], v[16:19]
    ds_read_b128 v[120:123], v4 offset:0
    v_mfma_f32_16x16x32_bf16 v[20:23], v[188:191], v[164:167], v[20:23]
    ds_read_b128 v[124:127], v4 offset:2048
    v_mfma_f32_16x16x32_bf16 v[52:55], v[196:199], v[164:167], v[52:55]
    ds_read_b128 v[128:131], v4 offset:4096
    v_mfma_f32_16x16x32_bf16 v[48:51], v[192:195], v[164:167], v[48:51]
    ds_read_b128 v[132:135], v4 offset:6144
    v_mfma_f32_16x16x32_bf16 v[56:59], v[192:195], v[168:171], v[56:59]
    ds_read_b128 v[136:139], v2 offset:0
    v_mfma_f32_16x16x32_bf16 v[60:63], v[196:199], v[168:171], v[60:63]
    ds_read_b64_tr_b16 v[140:141], v6 offset:0
    v_mfma_f32_16x16x32_bf16 v[28:31], v[188:191], v[168:171], v[28:31]
    ds_read_b64_tr_b16 v[142:143], v6 offset:512
    v_mfma_f32_16x16x32_bf16 v[24:27], v[184:187], v[168:171], v[24:27]
    ds_read_b64_tr_b16 v[144:145], v7 offset:0
    v_mfma_f32_16x16x32_bf16 v[32:35], v[184:187], v[172:175], v[32:35]
    ds_read_b64_tr_b16 v[146:147], v7 offset:512
    v_mfma_f32_16x16x32_bf16 v[36:39], v[188:191], v[172:175], v[36:39]
    ds_read_b64_tr_b16 v[148:149], v6 offset:1024
    v_mfma_f32_16x16x32_bf16 v[68:71], v[196:199], v[172:175], v[68:71]
    ds_read_b64_tr_b16 v[150:151], v6 offset:1536
    v_mfma_f32_16x16x32_bf16 v[64:67], v[192:195], v[172:175], v[64:67]
    ds_read_b64_tr_b16 v[152:153], v7 offset:1024
    v_mfma_f32_16x16x32_bf16 v[112:115], v[192:195], v[180:183], v[112:115]
    ds_read_b64_tr_b16 v[154:155], v7 offset:1536
    v_mfma_f32_16x16x32_bf16 v[72:75], v[192:195], v[176:179], v[72:75]
    ds_read_b64_tr_b16 v[156:157], v6 offset:2048
    v_mfma_f32_16x16x32_bf16 v[76:79], v[196:199], v[176:179], v[76:79]
    ds_read_b64_tr_b16 v[158:159], v6 offset:2560
    v_mfma_f32_16x16x32_bf16 v[44:47], v[188:191], v[176:179], v[44:47]
    ds_read_b64_tr_b16 v[160:161], v7 offset:2048
    v_mfma_f32_16x16x32_bf16 v[40:43], v[184:187], v[176:179], v[40:43]
    ds_read_b64_tr_b16 v[162:163], v7 offset:2560
    v_mfma_f32_16x16x32_bf16 v[104:107], v[176:179], v[200:203], v[104:107]
    v_mfma_f32_16x16x32_bf16 v[108:111], v[176:179], v[204:207], v[108:111]
    v_mfma_f32_16x16x32_bf16 v[100:103], v[172:175], v[204:207], v[100:103]
    v_mfma_f32_16x16x32_bf16 v[96:99], v[172:175], v[200:203], v[96:99]
    v_mfma_f32_16x16x32_bf16 v[88:91], v[168:171], v[200:203], v[88:91]
    v_mfma_f32_16x16x32_bf16 v[92:95], v[168:171], v[204:207], v[92:95]
    v_mfma_f32_16x16x32_bf16 v[84:87], v[164:167], v[204:207], v[84:87]
    v_mfma_f32_16x16x32_bf16 v[80:83], v[164:167], v[200:203], v[80:83]
    v_mfma_f32_16x16x32_bf16 v[116:119], v[180:183], v[200:203], v[116:119]
    s_waitcnt lgkmcnt(0)
    v_mfma_f32_16x16x32_bf16 v[16:19], v[140:143], v[120:123], v[16:19]
    ds_read_b128 v[164:167], v5 offset:0
    v_mfma_f32_16x16x32_bf16 v[20:23], v[144:147], v[120:123], v[20:23]
    ds_read_b128 v[168:171], v5 offset:2048
    v_mfma_f32_16x16x32_bf16 v[52:55], v[152:155], v[120:123], v[52:55]
    ds_read_b128 v[172:175], v5 offset:4096
    v_mfma_f32_16x16x32_bf16 v[48:51], v[148:151], v[120:123], v[48:51]
    ds_read_b128 v[176:179], v5 offset:6144
    v_mfma_f32_16x16x32_bf16 v[56:59], v[148:151], v[124:127], v[56:59]
    ds_read_b128 v[180:183], v3 offset:0
    v_mfma_f32_16x16x32_bf16 v[60:63], v[152:155], v[124:127], v[60:63]
    ds_read_b64_tr_b16 v[184:185], v6 offset:12288
    v_mfma_f32_16x16x32_bf16 v[28:31], v[144:147], v[124:127], v[28:31]
    ds_read_b64_tr_b16 v[186:187], v6 offset:12800
    v_mfma_f32_16x16x32_bf16 v[24:27], v[140:143], v[124:127], v[24:27]
    ds_read_b64_tr_b16 v[188:189], v7 offset:12288
    v_mfma_f32_16x16x32_bf16 v[32:35], v[140:143], v[128:131], v[32:35]
    ds_read_b64_tr_b16 v[190:191], v7 offset:12800
    v_mfma_f32_16x16x32_bf16 v[36:39], v[144:147], v[128:131], v[36:39]
    ds_read_b64_tr_b16 v[192:193], v6 offset:13312
    v_mfma_f32_16x16x32_bf16 v[68:71], v[152:155], v[128:131], v[68:71]
    ds_read_b64_tr_b16 v[194:195], v6 offset:13824
    v_mfma_f32_16x16x32_bf16 v[64:67], v[148:151], v[128:131], v[64:67]
    ds_read_b64_tr_b16 v[196:197], v7 offset:13312
    v_mfma_f32_16x16x32_bf16 v[112:115], v[148:151], v[136:139], v[112:115]
    ds_read_b64_tr_b16 v[198:199], v7 offset:13824
    v_mfma_f32_16x16x32_bf16 v[72:75], v[148:151], v[132:135], v[72:75]
    ds_read_b64_tr_b16 v[200:201], v6 offset:14336
    v_mfma_f32_16x16x32_bf16 v[76:79], v[152:155], v[132:135], v[76:79]
    ds_read_b64_tr_b16 v[202:203], v6 offset:14848
    v_mfma_f32_16x16x32_bf16 v[44:47], v[144:147], v[132:135], v[44:47]
    ds_read_b64_tr_b16 v[204:205], v7 offset:14336
    v_mfma_f32_16x16x32_bf16 v[40:43], v[140:143], v[132:135], v[40:43]
    ds_read_b64_tr_b16 v[206:207], v7 offset:14848
    v_mfma_f32_16x16x32_bf16 v[104:107], v[132:135], v[156:159], v[104:107]
    v_mfma_f32_16x16x32_bf16 v[108:111], v[132:135], v[160:163], v[108:111]
    v_mfma_f32_16x16x32_bf16 v[100:103], v[128:131], v[160:163], v[100:103]
    v_mfma_f32_16x16x32_bf16 v[96:99], v[128:131], v[156:159], v[96:99]
    v_mfma_f32_16x16x32_bf16 v[88:91], v[124:127], v[156:159], v[88:91]
    v_mfma_f32_16x16x32_bf16 v[92:95], v[124:127], v[160:163], v[92:95]
    v_mfma_f32_16x16x32_bf16 v[84:87], v[120:123], v[160:163], v[84:87]
    v_mfma_f32_16x16x32_bf16 v[80:83], v[120:123], v[156:159], v[80:83]
    v_mfma_f32_16x16x32_bf16 v[116:119], v[136:139], v[156:159], v[116:119]
    s_waitcnt lgkmcnt(0)
    v_mfma_f32_16x16x32_bf16 v[112:115], v[192:195], v[180:183], v[112:115]
    v_mfma_f32_16x16x32_bf16 v[116:119], v[180:183], v[200:203], v[116:119]
    v_mfma_f32_16x16x32_bf16 v[72:75], v[192:195], v[176:179], v[72:75]
    v_mfma_f32_16x16x32_bf16 v[76:79], v[196:199], v[176:179], v[76:79]
    v_mfma_f32_16x16x32_bf16 v[104:107], v[176:179], v[200:203], v[104:107]
    v_mfma_f32_16x16x32_bf16 v[108:111], v[176:179], v[204:207], v[108:111]
    v_mfma_f32_16x16x32_bf16 v[40:43], v[184:187], v[176:179], v[40:43]
    v_mfma_f32_16x16x32_bf16 v[44:47], v[188:191], v[176:179], v[44:47]
    v_mfma_f32_16x16x32_bf16 v[64:67], v[192:195], v[172:175], v[64:67]
    v_mfma_f32_16x16x32_bf16 v[68:71], v[196:199], v[172:175], v[68:71]
    v_cvt_pk_bf16_f32 v156, v112, v113
    v_cvt_pk_bf16_f32 v157, v114, v115
    v_mfma_f32_16x16x32_bf16 v[32:35], v[184:187], v[172:175], v[32:35]
    v_cvt_pk_bf16_f32 v158, v116, v117
    v_cvt_pk_bf16_f32 v159, v118, v119
    v_mfma_f32_16x16x32_bf16 v[36:39], v[188:191], v[172:175], v[36:39]
    v_cvt_pk_bf16_f32 v152, v72, v73
    v_cvt_pk_bf16_f32 v153, v74, v75
    v_mfma_f32_16x16x32_bf16 v[56:59], v[192:195], v[168:171], v[56:59]
    v_cvt_pk_bf16_f32 v154, v76, v77
    v_cvt_pk_bf16_f32 v155, v78, v79
    v_mfma_f32_16x16x32_bf16 v[60:63], v[196:199], v[168:171], v[60:63]
    v_cvt_pk_bf16_f32 v232, v104, v105
    v_cvt_pk_bf16_f32 v233, v106, v107
    v_mfma_f32_16x16x32_bf16 v[24:27], v[184:187], v[168:171], v[24:27]
    v_cvt_pk_bf16_f32 v242, v108, v109
    v_cvt_pk_bf16_f32 v243, v110, v111
    v_mfma_f32_16x16x32_bf16 v[28:31], v[188:191], v[168:171], v[28:31]
    ds_write_b64 v216, v[156:157]
    ds_write_b64 v216, v[158:159] offset:1024
    v_mfma_f32_16x16x32_bf16 v[48:51], v[192:195], v[164:167], v[48:51]
    ds_write_b64 v217, v[152:153] offset:0
    ds_write_b64 v217, v[232:233] offset:1024
    v_mfma_f32_16x16x32_bf16 v[52:55], v[196:199], v[164:167], v[52:55]
    ds_write_b64 v217, v[154:155] offset:512
    ds_write_b64 v217, v[242:243] offset:1536
    v_mfma_f32_16x16x32_bf16 v[16:19], v[184:187], v[164:167], v[16:19]
    v_cvt_pk_bf16_f32 v132, v40, v41
    v_cvt_pk_bf16_f32 v133, v42, v43
    v_mfma_f32_16x16x32_bf16 v[20:23], v[188:191], v[164:167], v[20:23]
    v_cvt_pk_bf16_f32 v134, v44, v45
    v_cvt_pk_bf16_f32 v135, v46, v47
    v_mfma_f32_16x16x32_bf16 v[96:99], v[172:175], v[200:203], v[96:99]
    v_cvt_pk_bf16_f32 v148, v64, v65
    v_cvt_pk_bf16_f32 v149, v66, v67
    v_mfma_f32_16x16x32_bf16 v[100:103], v[172:175], v[204:207], v[100:103]
    v_cvt_pk_bf16_f32 v150, v68, v69
    v_cvt_pk_bf16_f32 v151, v70, v71
    v_mfma_f32_16x16x32_bf16 v[88:91], v[168:171], v[200:203], v[88:91]
    v_cvt_pk_bf16_f32 v128, v32, v33
    v_cvt_pk_bf16_f32 v129, v34, v35
    v_mfma_f32_16x16x32_bf16 v[92:95], v[168:171], v[204:207], v[92:95]
    v_cvt_pk_bf16_f32 v130, v36, v37
    v_cvt_pk_bf16_f32 v131, v38, v39
    v_mfma_f32_16x16x32_bf16 v[80:83], v[164:167], v[200:203], v[80:83]
    v_cvt_pk_bf16_f32 v144, v56, v57
    v_cvt_pk_bf16_f32 v145, v58, v59
    v_mfma_f32_16x16x32_bf16 v[84:87], v[164:167], v[204:207], v[84:87]
    v_cvt_pk_bf16_f32 v146, v60, v61
    v_cvt_pk_bf16_f32 v147, v62, v63
    v_cvt_pk_bf16_f32 v124, v24, v25
    v_cvt_pk_bf16_f32 v125, v26, v27
    v_cvt_pk_bf16_f32 v126, v28, v29
    v_cvt_pk_bf16_f32 v127, v30, v31
    s_mov_b64 exec, 1
    ds_add_u32 v10, v11 offset:0
    s_mov_b64 exec, -1
    v_cvt_pk_bf16_f32 v140, v48, v49
    v_cvt_pk_bf16_f32 v141, v50, v51
    v_cvt_pk_bf16_f32 v142, v52, v53
    v_cvt_pk_bf16_f32 v143, v54, v55
    v_cvt_pk_bf16_f32 v120, v16, v17
    v_cvt_pk_bf16_f32 v121, v18, v19
    v_cvt_pk_bf16_f32 v122, v20, v21
    v_cvt_pk_bf16_f32 v123, v22, v23
    v_mfma_f32_16x16x32_bf16 v[44:47], v[152:155], v[132:135], 0
    v_cvt_pk_bf16_f32 v230, v96, v97
    v_cvt_pk_bf16_f32 v231, v98, v99
    v_mfma_f32_16x16x32_bf16 v[40:43], v[148:151], v[132:135], 0
    v_cvt_pk_bf16_f32 v240, v100, v101
    v_cvt_pk_bf16_f32 v241, v102, v103
    v_mfma_f32_16x16x32_bf16 v[36:39], v[148:151], v[128:131], 0
    v_cvt_pk_bf16_f32 v228, v88, v89
    v_cvt_pk_bf16_f32 v229, v90, v91
    v_mfma_f32_16x16x32_bf16 v[32:35], v[144:147], v[128:131], 0
    v_cvt_pk_bf16_f32 v238, v92, v93
    v_cvt_pk_bf16_f32 v239, v94, v95
    v_mfma_f32_16x16x32_bf16 v[28:31], v[144:147], v[124:127], 0
    v_cvt_pk_bf16_f32 v226, v80, v81
    v_cvt_pk_bf16_f32 v227, v82, v83
    v_mfma_f32_16x16x32_bf16 v[24:27], v[140:143], v[124:127], 0
    v_cvt_pk_bf16_f32 v236, v84, v85
    v_cvt_pk_bf16_f32 v237, v86, v87
    v_mfma_f32_16x16x32_bf16 v[20:23], v[140:143], v[120:123], 0
    s_branch LB_s1_in
LB_s1:
    s_sleep 1
LB_s1_in:
    ds_read_b32 v14, v10 offset:0
    ds_read_b64 v[136:137], v218
    ds_read_b64 v[138:139], v219
    ds_read_b64 v[224:225], v218 offset:1024
    ds_read_b64 v[234:235], v219 offset:1024
    s_waitcnt lgkmcnt(0)
    v_readfirstlane_b32 s78, v14
    s_nop 0
    s_cmp_ge_u32 s78, 4
    s_cbranch_scc0 LB_s1
    v_mfma_f32_16x16x32_bf16 v[16:19], v[136:139], v[120:123], v[212:215]
    v_cndmask_b32 v60, v44, v45, s[88:89]
    s_add_u32 m0, s34, 36864
    s_add_u32 s35, s44, 0
    buffer_load_dwordx4 v245, s[64:67], s35 offen  lds
    v_cndmask_b32 v61, v40, v41, s[88:89]
    v_cndmask_b32 v54, v61, v60, s[90:91]
    v_cndmask_b32 v60, v46, v47, s[88:89]
    v_cndmask_b32 v61, v42, v43, s[88:89]
    v_cndmask_b32 v55, v61, v60, s[92:93]
    v_max_f32 v59, v54, v55
    v_cndmask_b32 v60, v36, v37, s[88:89]
    v_cndmask_b32 v61, v32, v33, s[88:89]
    v_cndmask_b32 v52, v61, v60, s[90:91]
    v_cndmask_b32 v60, v38, v39, s[88:89]
    v_cndmask_b32 v61, v34, v35, s[88:89]
    v_cndmask_b32 v53, v61, v60, s[92:93]
    v_max_f32 v58, v52, v53
    v_cndmask_b32 v60, v28, v29, s[88:89]
    v_cndmask_b32 v61, v24, v25, s[88:89]
    v_cndmask_b32 v50, v61, v60, s[90:91]
    v_cndmask_b32 v60, v30, v31, s[88:89]
    v_cndmask_b32 v61, v26, v27, s[88:89]
    s_add_u32 m0, s34, 40960
    s_add_u32 s35, s44, 65536
    buffer_load_dwordx4 v245, s[64:67], s35 offen  lds
    v_cndmask_b32 v51, v61, v60, s[92:93]
    v_max_f32 v57, v50, v51
    v_cndmask_b32 v60, v20, v21, s[88:89]
    v_cndmask_b32 v61, v16, v17, s[88:89]
    v_cndmask_b32 v48, v61, v60, s[90:91]
    v_cndmask_b32 v60, v22, v23, s[88:89]
    v_cndmask_b32 v61, v18, v19, s[88:89]
    v_cndmask_b32 v49, v61, v60, s[92:93]
    v_max_f32 v56, v48, v49
    s_mov_b32 s80, 0x3e8293ee
    v_permlane32_swap_b32 v58, v59
    v_permlane32_swap_b32 v56, v57
    v_max_f32 v58, v58, v59
    v_max_f32 v56, v56, v57
    s_nop 1
    v_permlane16_swap_b32 v56, v58
    v_max_f32 v56, v56, v58
    v_mul_f32 v56, s80, v56
    v_mov_b32 v58, v56
    s_nop 1
    v_permlane16_swap_b32 v56, v58
    s_add_u32 m0, s34, 45056
    s_add_u32 s35, s44, 131072
    buffer_load_dwordx4 v245, s[64:67], s35 offen  lds
    v_mov_b32 v57, v56
    v_mov_b32 v59, v58
    s_nop 0
    v_permlane32_swap_b32 v56, v57
    v_permlane32_swap_b32 v58, v59
    v_fma_f32 v48, v48, s80, -v56
    v_fma_f32 v49, v49, s80, -v56
    v_fma_f32 v50, v50, s80, -v57
    v_fma_f32 v51, v51, s80, -v57
    v_fma_f32 v52, v52, s80, -v58
    v_fma_f32 v53, v53, s80, -v58
    v_fma_f32 v54, v54, s80, -v59
    v_fma_f32 v55, v55, s80, -v59
    v_exp_f32 v48, v48
    v_exp_f32 v49, v49
    v_exp_f32 v50, v50
    v_exp_f32 v51, v51
    v_exp_f32 v52, v52
    v_exp_f32 v53, v53
    s_add_u32 m0, s34, 49152
    s_add_u32 s35, s44, 196608
    buffer_load_dwordx4 v245, s[64:67], s35 offen  lds
    v_exp_f32 v54, v54
    v_exp_f32 v55, v55
    v_add_f32 v56, v48, v49
    v_add_f32 v57, v50, v51
    v_add_f32 v58, v52, v53
    v_add_f32 v59, v54, v55
    s_nop 1
    v_permlane32_swap_b32 v58, v59
    v_permlane32_swap_b32 v56, v57
    v_add_f32 v58, v58, v59
    v_add_f32 v56, v56, v57
    s_nop 1
    v_permlane16_swap_b32 v56, v58
    v_add_f32 v56, v56, v58
    v_rcp_f32 v56, v56
    s_nop 0
    v_mov_b32 v58, v56
    s_nop 1
    v_permlane16_swap_b32 v56, v58
    v_mov_b32 v57, v56
    v_mov_b32 v59, v58
    s_nop 0
    v_permlane32_swap_b32 v56, v57
    v_permlane32_swap_b32 v58, v59
    s_add_u32 m0, s34, 53248
    s_add_u32 s35, s45, 0
    buffer_load_dwordx4 v245, s[64:67], s35 offen  lds
    v_mul_f32 v48, v48, v56
    v_mul_f32 v49, v49, v56
    v_cvt_pk_bf16_f32 v48, v48, v49
    v_perm_b32 v64, v48, v48, v208
    v_perm_b32 v65, v48, v48, v209
    v_perm_b32 v66, v48, v48, v210
    v_perm_b32 v67, v48, v48, v211
    v_mul_f32 v50, v50, v57
    v_mul_f32 v51, v51, v57
    v_cvt_pk_bf16_f32 v50, v50, v51
    v_perm_b32 v68, v50, v50, v208
    v_perm_b32 v69, v50, v50, v209
    v_perm_b32 v70, v50, v50, v210
    v_perm_b32 v71, v50, v50, v211
    v_mfma_f32_16x16x32_bf16 v[16:19], v[224:227], v[64:67], 0
    v_mfma_f32_16x16x32_bf16 v[20:23], v[234:237], v[64:67], 0
    v_mul_f32 v52, v52, v58
    v_mul_f32 v53, v53, v58
    s_add_u32 m0, s34, 57344
    s_add_u32 s35, s45, 65536
    buffer_load_dwordx4 v245, s[64:67], s35 offen  lds
    v_cvt_pk_bf16_f32 v52, v52, v53
    v_perm_b32 v72, v52, v52, v208
    v_perm_b32 v73, v52, v52, v209
    v_perm_b32 v74, v52, v52, v210
    v_perm_b32 v75, v52, v52, v211
    v_mfma_f32_16x16x32_bf16 v[24:27], v[226:229], v[68:71], 0
    v_mfma_f32_16x16x32_bf16 v[28:31], v[236:239], v[68:71], 0
    v_mul_f32 v54, v54, v59
    v_mul_f32 v55, v55, v59
    v_cvt_pk_bf16_f32 v54, v54, v55
    v_perm_b32 v76, v54, v54, v208
    v_perm_b32 v77, v54, v54, v209
    v_perm_b32 v78, v54, v54, v210
    v_perm_b32 v79, v54, v54, v211
    v_mfma_f32_16x16x32_bf16 v[32:35], v[228:231], v[72:75], 0
    v_mfma_f32_16x16x32_bf16 v[36:39], v[238:241], v[72:75], 0
    v_mfma_f32_16x16x32_bf16 v[40:43], v[230:233], v[76:79], 0
    v_mfma_f32_16x16x32_bf16 v[44:47], v[240:243], v[76:79], 0
    v_cvt_pk_bf16_f32 v80, v16, v17
    v_cvt_pk_bf16_f32 v81, v18, v19
    v_cvt_pk_bf16_f32 v82, v20, v21
    v_cvt_pk_bf16_f32 v83, v22, v23
    s_add_u32 s95, s94, 0
    buffer_store_dwordx4 v[80:83], v12, s[52:55], s95 offen sc1
    v_cvt_pk_bf16_f32 v84, v24, v25
    v_cvt_pk_bf16_f32 v85, v26, v27
    v_cvt_pk_bf16_f32 v86, v28, v29
    v_cvt_pk_bf16_f32 v87, v30, v31
    s_add_u32 s95, s94, 32768
    buffer_store_dwordx4 v[84:87], v12, s[52:55], s95 offen sc1
    v_cvt_pk_bf16_f32 v88, v32, v33
    v_cvt_pk_bf16_f32 v89, v34, v35
    v_cvt_pk_bf16_f32 v90, v36, v37
    v_cvt_pk_bf16_f32 v91, v38, v39
    s_add_u32 s95, s94, 65536
    buffer_store_dwordx4 v[88:91], v12, s[52:55], s95 offen sc1
    v_cvt_pk_bf16_f32 v92, v40, v41
    v_cvt_pk_bf16_f32 v93, v42, v43
    v_cvt_pk_bf16_f32 v94, v44, v45
    v_cvt_pk_bf16_f32 v95, v46, v47
    s_add_u32 s95, s94, 98304
    buffer_store_dwordx4 v[92:95], v12, s[52:55], s95 offen sc1
    s_add_u32 m0, s34, 61440
    s_add_u32 s35, s45, 131072
    buffer_load_dwordx4 v245, s[64:67], s35 offen  lds
    v_xor_b32 v2, 0, v244
    v_xor_b32 v3, 32, v244
    v_xor_b32 v4, 64, v244
    v_xor_b32 v5, 96, v244
    s_add_u32 m0, s34, 65536
    s_add_u32 s35, s45, 196608
    buffer_load_dwordx4 v245, s[64:67], s35 offen  lds
    v_xor_b32 v6, 2048, v244
    v_xor_b32 v7, 2080, v244
    v_xor_b32 v8, 2112, v244
    v_xor_b32 v9, 2144, v244
    s_waitcnt vmcnt(6)
    s_mov_b64 exec, 1
    ds_add_u32 v10, v11 offset:8
    s_mov_b64 exec, -1
    s_add_u32 m0, s34, 69632
    s_add_u32 s35, s46, 0
    buffer_load_dwordx4 v245, s[64:67], s35 offen  lds
    v_add_u32 v224, 65536, v2
    v_add_u32 v225, 65536, v3
    s_add_u32 m0, s34, 73728
    s_add_u32 s35, s46, 65536
    buffer_load_dwordx4 v245, s[64:67], s35 offen  lds
    v_add_u32 v226, 65536, v4
    s_add_u32 m0, s34, 77824
    s_add_u32 s35, s46, 131072
    buffer_load_dwordx4 v245, s[64:67], s35 offen  lds
    v_add_u32 v227, 65536, v5
    v_add_u32 v228, 65536, v6
    s_add_u32 m0, s34, 81920
    s_add_u32 s35, s46, 196608
    buffer_load_dwordx4 v245, s[64:67], s35 offen  lds
    v_add_u32 v229, 65536, v7
    s_add_u32 m0, s34, 86016
    s_add_u32 s35, s47, 0
    buffer_load_dwordx4 v245, s[64:67], s35 offen  lds
    v_add_u32 v230, 65536, v8
    v_add_u32 v231, 65536, v9
    s_add_u32 m0, s34, 0
    s_add_u32 s35, s47, 65536
    buffer_load_dwordx4 v245, s[64:67], s35 offen  lds
    v_add_u32 v15, 32768, v12
    s_waitcnt vmcnt(8)
    s_mov_b64 exec, 1
    buffer_store_dword v11, v220, s[52:55], s97 offen sc1
    s_mov_b64 exec, -1
    s_branch LB_s2_in
LB_s2:
    s_sleep 1
LB_s2_in:
    ds_read_b32 v14, v10 offset:8
    s_waitcnt lgkmcnt(0)
    v_readfirstlane_b32 s78, v14
    s_nop 0
    s_cmp_ge_u32 s78, 8
    s_cbranch_scc0 LB_s2
    s_add_u32 m0, s34, 4096
    s_add_u32 s35, s47, 131072
    buffer_load_dwordx4 v245, s[64:67], s35 offen  lds
    ds_read_b64_tr_b16 v[48:49], v2 offset:36864
    ds_read_b64_tr_b16 v[50:51], v6 offset:36864
    s_add_u32 m0, s34, 8192
    s_add_u32 s35, s47, 196608
    buffer_load_dwordx4 v245, s[64:67], s35 offen  lds
    ds_read_b64_tr_b16 v[52:53], v3 offset:36864
    s_add_u32 m0, s34, 12288
    s_add_u32 s35, s48, 0
    buffer_load_dwordx4 v245, s[64:67], s35 offen  lds
    ds_read_b64_tr_b16 v[54:55], v7 offset:36864
    s_add_u32 m0, s34, 16384
    s_add_u32 s35, s48, 65536
    buffer_load_dwordx4 v245, s[64:67], s35 offen  lds
    ds_read_b64_tr_b16 v[56:57], v4 offset:36864
    ds_read_b64_tr_b16 v[58:59], v8 offset:36864
    s_add_u32 m0, s34, 20480
    s_add_u32 s35, s48, 131072
    buffer_load_dwordx4 v245, s[64:67], s35 offen  lds
    ds_read_b64_tr_b16 v[60:61], v5 offset:36864
    s_add_u32 m0, s34, 110592
    s_add_u32 s35, s48, 196608
    buffer_load_dwordx4 v245, s[64:67], s35 offen  lds
    ds_read_b64_tr_b16 v[62:63], v9 offset:36864
    s_add_u32 m0, s34, 114688
    s_add_u32 s35, s49, 0
    buffer_load_dwordx4 v245, s[64:67], s35 offen  lds
    ds_read_b64_tr_b16 v[64:65], v2 offset:40960
    ds_read_b64_tr_b16 v[66:67], v6 offset:40960
    s_add_u32 m0, s34, 118784
    s_add_u32 s35, s49, 65536
    buffer_load_dwordx4 v245, s[64:67], s35 offen  lds
    ds_read_b64_tr_b16 v[68:69], v3 offset:40960
    s_add_u32 m0, s34, 122880
    s_add_u32 s35, s49, 131072
    buffer_load_dwordx4 v245, s[64:67], s35 offen  lds
    ds_read_b64_tr_b16 v[70:71], v7 offset:40960
    s_add_u32 m0, s34, 24576
    s_add_u32 s35, s49, 196608
    buffer_load_dwordx4 v245, s[64:67], s35 offen  lds
    ds_read_b64_tr_b16 v[72:73], v4 offset:40960
    ds_read_b64_tr_b16 v[74:75], v8 offset:40960
    s_add_u32 m0, s34, 28672
    s_add_u32 s35, s50, 0
    buffer_load_dwordx4 v245, s[64:67], s35 offen  lds
    ds_read_b64_tr_b16 v[76:77], v5 offset:40960
    s_add_u32 m0, s34, 32768
    s_add_u32 s35, s50, 65536
    buffer_load_dwordx4 v245, s[64:67], s35 offen  lds
    ds_read_b64_tr_b16 v[78:79], v9 offset:40960
    s_waitcnt vmcnt(0)
    s_mov_b64 exec, 1
    ds_add_u32 v10, v11 offset:16
    s_mov_b64 exec, -1
    s_mov_b64 exec, 0xffffffff
    s_mov_b32 s79, 0
LB_po:
    buffer_load_dword v14, v247, s[52:55], s30 offen sc1
    s_add_u32 s79, s79, 1
    s_cmp_gt_u32 s79, 200000
    s_cbranch_scc1 LB_po_x
    s_waitcnt vmcnt(0)
    v_cmp_ne_u32 vcc, 1, v14
    s_cbranch_vccz LB_po_x
    s_mov_b64 exec, vcc
    s_sleep 4
    s_branch LB_po
LB_po_x:
    s_waitcnt vmcnt(0)
    s_mov_b64 exec, -1
    ds_read_b32 v222, v10 offset:16
    buffer_load_dwordx4 v[96:99], v12, s[52:55], s36 offen offset:0 sc1
    buffer_load_dwordx4 v[100:103], v15, s[52:55], s36 offen offset:0 sc1
    buffer_load_dwordx4 v[104:107], v12, s[52:55], s36 offen offset:1024 sc1
    buffer_load_dwordx4 v[108:111], v15, s[52:55], s36 offen offset:1024 sc1
    buffer_load_dwordx4 v[112:115], v12, s[52:55], s36 offen offset:2048 sc1
    buffer_load_dwordx4 v[116:119], v15, s[52:55], s36 offen offset:2048 sc1
    buffer_load_dwordx4 v[120:123], v12, s[52:55], s36 offen offset:3072 sc1
    buffer_load_dwordx4 v[124:127], v15, s[52:55], s36 offen offset:3072 sc1
    buffer_load_dwordx4 v[128:131], v12, s[52:55], s37 offen offset:0 sc1
    buffer_load_dwordx4 v[132:135], v15, s[52:55], s37 offen offset:0 sc1
    s_setprio 1
    s_waitcnt lgkmcnt(0)
    v_cmp_gt_u32 vcc, 4, v222
    s_cbranch_vccnz LB_w4
LB_g4:
    s_waitcnt vmcnt(8)
    v_mfma_f32_16x16x32_bf16 v[16:19], v[48:51], v[96:99], 0
    buffer_load_dwordx4 v[136:139], v12, s[52:55], s37 offen offset:1024 sc1
    buffer_load_dwordx4 v[140:143], v15, s[52:55], s37 offen offset:1024 sc1
    v_mfma_f32_16x16x32_bf16 v[20:23], v[52:55], v[96:99], 0
    ds_read_b64_tr_b16 v[80:81], v2 offset:45056
    v_mfma_f32_16x16x32_bf16 v[24:27], v[56:59], v[96:99], 0
    ds_read_b64_tr_b16 v[82:83], v6 offset:45056
    v_mfma_f32_16x16x32_bf16 v[28:31], v[60:63], v[96:99], 0
    ds_read_b64_tr_b16 v[84:85], v3 offset:45056
    v_mfma_f32_16x16x32_bf16 v[32:35], v[48:51], v[100:103], 0
    ds_read_b64_tr_b16 v[86:87], v7 offset:45056
    ds_read_b64_tr_b16 v[88:89], v4 offset:45056
    v_mfma_f32_16x16x32_bf16 v[36:39], v[52:55], v[100:103], 0
    ds_read_b64_tr_b16 v[90:91], v8 offset:45056
    v_mfma_f32_16x16x32_bf16 v[40:43], v[56:59], v[100:103], 0
    ds_read_b64_tr_b16 v[92:93], v5 offset:45056
    v_mfma_f32_16x16x32_bf16 v[44:47], v[60:63], v[100:103], 0
    ds_read_b64_tr_b16 v[94:95], v9 offset:45056
    s_waitcnt vmcnt(8)
    v_mfma_f32_16x16x32_bf16 v[16:19], v[64:67], v[104:107], v[16:19]
    buffer_load_dwordx4 v[96:99], v12, s[52:55], s37 offen offset:2048 sc1
    buffer_load_dwordx4 v[100:103], v15, s[52:55], s37 offen offset:2048 sc1
    v_mfma_f32_16x16x32_bf16 v[20:23], v[68:71], v[104:107], v[20:23]
    ds_read_b64_tr_b16 v[48:49], v2 offset:49152
    v_mfma_f32_16x16x32_bf16 v[24:27], v[72:75], v[104:107], v[24:27]
    ds_read_b64_tr_b16 v[50:51], v6 offset:49152
    v_mfma_f32_16x16x32_bf16 v[28:31], v[76:79], v[104:107], v[28:31]
    ds_read_b64_tr_b16 v[52:53], v3 offset:49152
    v_mfma_f32_16x16x32_bf16 v[32:35], v[64:67], v[108:111], v[32:35]
    ds_read_b64_tr_b16 v[54:55], v7 offset:49152
    ds_read_b64_tr_b16 v[56:57], v4 offset:49152
    v_mfma_f32_16x16x32_bf16 v[36:39], v[68:71], v[108:111], v[36:39]
    ds_read_b64_tr_b16 v[58:59], v8 offset:49152
    v_mfma_f32_16x16x32_bf16 v[40:43], v[72:75], v[108:111], v[40:43]
    ds_read_b64_tr_b16 v[60:61], v5 offset:49152
    v_mfma_f32_16x16x32_bf16 v[44:47], v[76:79], v[108:111], v[44:47]
    ds_read_b64_tr_b16 v[62:63], v9 offset:49152
    s_waitcnt vmcnt(8) lgkmcnt(8)
    v_mfma_f32_16x16x32_bf16 v[16:19], v[80:83], v[112:115], v[16:19]
    buffer_load_dwordx4 v[104:107], v12, s[52:55], s37 offen offset:3072 sc1
    buffer_load_dwordx4 v[108:111], v15, s[52:55], s37 offen offset:3072 sc1
    v_mfma_f32_16x16x32_bf16 v[20:23], v[84:87], v[112:115], v[20:23]
    ds_read_b64_tr_b16 v[64:65], v2 offset:53248
    v_mfma_f32_16x16x32_bf16 v[24:27], v[88:91], v[112:115], v[24:27]
    ds_read_b64_tr_b16 v[66:67], v6 offset:53248
    v_mfma_f32_16x16x32_bf16 v[28:31], v[92:95], v[112:115], v[28:31]
    ds_read_b64_tr_b16 v[68:69], v3 offset:53248
    v_mfma_f32_16x16x32_bf16 v[32:35], v[80:83], v[116:119], v[32:35]
    ds_read_b64_tr_b16 v[70:71], v7 offset:53248
    ds_read_b64_tr_b16 v[72:73], v4 offset:53248
    v_mfma_f32_16x16x32_bf16 v[36:39], v[84:87], v[116:119], v[36:39]
    ds_read_b64_tr_b16 v[74:75], v8 offset:53248
    v_mfma_f32_16x16x32_bf16 v[40:43], v[88:91], v[116:119], v[40:43]
    ds_read_b64_tr_b16 v[76:77], v5 offset:53248
    v_mfma_f32_16x16x32_bf16 v[44:47], v[92:95], v[116:119], v[44:47]
    ds_read_b64_tr_b16 v[78:79], v9 offset:53248
    s_waitcnt vmcnt(8) lgkmcnt(8)
    v_mfma_f32_16x16x32_bf16 v[16:19], v[48:51], v[120:123], v[16:19]
    buffer_load_dwordx4 v[112:115], v12, s[52:55], s38 offen offset:0 sc1
    buffer_load_dwordx4 v[116:119], v15, s[52:55], s38 offen offset:0 sc1
    v_mfma_f32_16x16x32_bf16 v[20:23], v[52:55], v[120:123], v[20:23]
    ds_read_b64_tr_b16 v[80:81], v2 offset:57344
    v_mfma_f32_16x16x32_bf16 v[24:27], v[56:59], v[120:123], v[24:27]
    ds_read_b64_tr_b16 v[82:83], v6 offset:57344
    v_mfma_f32_16x16x32_bf16 v[28:31], v[60:63], v[120:123], v[28:31]
    ds_read_b64_tr_b16 v[84:85], v3 offset:57344
    v_mfma_f32_16x16x32_bf16 v[32:35], v[48:51], v[124:127], v[32:35]
    ds_read_b64_tr_b16 v[86:87], v7 offset:57344
    ds_read_b64_tr_b16 v[88:89], v4 offset:57344
    v_mfma_f32_16x16x32_bf16 v[36:39], v[52:55], v[124:127], v[36:39]
    ds_read_b64_tr_b16 v[90:91], v8 offset:57344
    v_mfma_f32_16x16x32_bf16 v[40:43], v[56:59], v[124:127], v[40:43]
    ds_read_b64_tr_b16 v[92:93], v5 offset:57344
    v_mfma_f32_16x16x32_bf16 v[44:47], v[60:63], v[124:127], v[44:47]
    ds_read_b64_tr_b16 v[94:95], v9 offset:57344
    s_waitcnt vmcnt(8) lgkmcnt(8)
    v_mfma_f32_16x16x32_bf16 v[16:19], v[64:67], v[128:131], v[16:19]
    buffer_load_dwordx4 v[120:123], v12, s[52:55], s38 offen offset:1024 sc1
    buffer_load_dwordx4 v[124:127], v15, s[52:55], s38 offen offset:1024 sc1
    v_mfma_f32_16x16x32_bf16 v[20:23], v[68:71], v[128:131], v[20:23]
    ds_read_b64_tr_b16 v[48:49], v2 offset:61440
    v_mfma_f32_16x16x32_bf16 v[24:27], v[72:75], v[128:131], v[24:27]
    ds_read_b64_tr_b16 v[50:51], v6 offset:61440
    v_mfma_f32_16x16x32_bf16 v[28:31], v[76:79], v[128:131], v[28:31]
    ds_read_b64_tr_b16 v[52:53], v3 offset:61440
    v_mfma_f32_16x16x32_bf16 v[32:35], v[64:67], v[132:135], v[32:35]
    ds_read_b64_tr_b16 v[54:55], v7 offset:61440
    ds_read_b64_tr_b16 v[56:57], v4 offset:61440
    v_mfma_f32_16x16x32_bf16 v[36:39], v[68:71], v[132:135], v[36:39]
    ds_read_b64_tr_b16 v[58:59], v8 offset:61440
    v_mfma_f32_16x16x32_bf16 v[40:43], v[72:75], v[132:135], v[40:43]
    ds_read_b64_tr_b16 v[60:61], v5 offset:61440
    v_mfma_f32_16x16x32_bf16 v[44:47], v[76:79], v[132:135], v[44:47]
    ds_read_b64_tr_b16 v[62:63], v9 offset:61440
    s_waitcnt vmcnt(8) lgkmcnt(8)
    v_mfma_f32_16x16x32_bf16 v[16:19], v[80:83], v[136:139], v[16:19]
    buffer_load_dwordx4 v[128:131], v12, s[52:55], s38 offen offset:2048 sc1
    buffer_load_dwordx4 v[132:135], v15, s[52:55], s38 offen offset:2048 sc1
    v_mfma_f32_16x16x32_bf16 v[20:23], v[84:87], v[136:139], v[20:23]
    ds_read_b64_tr_b16 v[64:65], v224 offset:0
    v_mfma_f32_16x16x32_bf16 v[24:27], v[88:91], v[136:139], v[24:27]
    ds_read_b64_tr_b16 v[66:67], v228 offset:0
    v_mfma_f32_16x16x32_bf16 v[28:31], v[92:95], v[136:139], v[28:31]
    ds_read_b64_tr_b16 v[68:69], v225 offset:0
    v_mfma_f32_16x16x32_bf16 v[32:35], v[80:83], v[140:143], v[32:35]
    ds_read_b64_tr_b16 v[70:71], v229 offset:0
    ds_read_b64_tr_b16 v[72:73], v226 offset:0
    v_mfma_f32_16x16x32_bf16 v[36:39], v[84:87], v[140:143], v[36:39]
    ds_read_b64_tr_b16 v[74:75], v230 offset:0
    v_mfma_f32_16x16x32_bf16 v[40:43], v[88:91], v[140:143], v[40:43]
    ds_read_b64_tr_b16 v[76:77], v227 offset:0
    v_mfma_f32_16x16x32_bf16 v[44:47], v[92:95], v[140:143], v[44:47]
    ds_read_b64_tr_b16 v[78:79], v231 offset:0
    s_waitcnt vmcnt(8) lgkmcnt(8)
    v_mfma_f32_16x16x32_bf16 v[16:19], v[48:51], v[96:99], v[16:19]
    buffer_load_dwordx4 v[136:139], v12, s[52:55], s38 offen offset:3072 sc1
    buffer_load_dwordx4 v[140:143], v15, s[52:55], s38 offen offset:3072 sc1
    v_mfma_f32_16x16x32_bf16 v[20:23], v[52:55], v[96:99], v[20:23]
    ds_read_b64_tr_b16 v[80:81], v224 offset:4096
    v_mfma_f32_16x16x32_bf16 v[24:27], v[56:59], v[96:99], v[24:27]
    ds_read_b64_tr_b16 v[82:83], v228 offset:4096
    v_mfma_f32_16x16x32_bf16 v[28:31], v[60:63], v[96:99], v[28:31]
    ds_read_b64_tr_b16 v[84:85], v225 offset:4096
    v_mfma_f32_16x16x32_bf16 v[32:35], v[48:51], v[100:103], v[32:35]
    ds_read_b64_tr_b16 v[86:87], v229 offset:4096
    ds_read_b64_tr_b16 v[88:89], v226 offset:4096
    v_mfma_f32_16x16x32_bf16 v[36:39], v[52:55], v[100:103], v[36:39]
    ds_read_b64_tr_b16 v[90:91], v230 offset:4096
    v_mfma_f32_16x16x32_bf16 v[40:43], v[56:59], v[100:103], v[40:43]
    ds_read_b64_tr_b16 v[92:93], v227 offset:4096
    v_mfma_f32_16x16x32_bf16 v[44:47], v[60:63], v[100:103], v[44:47]
    ds_read_b64_tr_b16 v[94:95], v231 offset:4096
    s_waitcnt vmcnt(8) lgkmcnt(8)
    v_mfma_f32_16x16x32_bf16 v[16:19], v[64:67], v[104:107], v[16:19]
    buffer_load_dwordx4 v[96:99], v12, s[52:55], s39 offen offset:0 sc1
    buffer_load_dwordx4 v[100:103], v15, s[52:55], s39 offen offset:0 sc1
    v_mfma_f32_16x16x32_bf16 v[20:23], v[68:71], v[104:107], v[20:23]
    ds_read_b64_tr_b16 v[48:49], v224 offset:8192
    v_mfma_f32_16x16x32_bf16 v[24:27], v[72:75], v[104:107], v[24:27]
    ds_read_b64_tr_b16 v[50:51], v228 offset:8192
    v_mfma_f32_16x16x32_bf16 v[28:31], v[76:79], v[104:107], v[28:31]
    ds_read_b64_tr_b16 v[52:53], v225 offset:8192
    v_mfma_f32_16x16x32_bf16 v[32:35], v[64:67], v[108:111], v[32:35]
    ds_read_b64_tr_b16 v[54:55], v229 offset:8192
    ds_read_b64_tr_b16 v[56:57], v226 offset:8192
    v_mfma_f32_16x16x32_bf16 v[36:39], v[68:71], v[108:111], v[36:39]
    ds_read_b64_tr_b16 v[58:59], v230 offset:8192
    v_mfma_f32_16x16x32_bf16 v[40:43], v[72:75], v[108:111], v[40:43]
    ds_read_b64_tr_b16 v[60:61], v227 offset:8192
    v_mfma_f32_16x16x32_bf16 v[44:47], v[76:79], v[108:111], v[44:47]
    ds_read_b64_tr_b16 v[62:63], v231 offset:8192
    s_waitcnt vmcnt(8) lgkmcnt(8)
    v_mfma_f32_16x16x32_bf16 v[16:19], v[80:83], v[112:115], v[16:19]
    buffer_load_dwordx4 v[104:107], v12, s[52:55], s39 offen offset:1024 sc1
    buffer_load_dwordx4 v[108:111], v15, s[52:55], s39 offen offset:1024 sc1
    v_mfma_f32_16x16x32_bf16 v[20:23], v[84:87], v[112:115], v[20:23]
    ds_read_b64_tr_b16 v[64:65], v224 offset:12288
    v_mfma_f32_16x16x32_bf16 v[24:27], v[88:91], v[112:115], v[24:27]
    ds_read_b64_tr_b16 v[66:67], v228 offset:12288
    v_mfma_f32_16x16x32_bf16 v[28:31], v[92:95], v[112:115], v[28:31]
    ds_read_b64_tr_b16 v[68:69], v225 offset:12288
    v_mfma_f32_16x16x32_bf16 v[32:35], v[80:83], v[116:119], v[32:35]
    ds_read_b64_tr_b16 v[70:71], v229 offset:12288
    ds_read_b64_tr_b16 v[72:73], v226 offset:12288
    v_mfma_f32_16x16x32_bf16 v[36:39], v[84:87], v[116:119], v[36:39]
    ds_read_b64_tr_b16 v[74:75], v230 offset:12288
    v_mfma_f32_16x16x32_bf16 v[40:43], v[88:91], v[116:119], v[40:43]
    ds_read_b64_tr_b16 v[76:77], v227 offset:12288
    v_mfma_f32_16x16x32_bf16 v[44:47], v[92:95], v[116:119], v[44:47]
    ds_read_b64_tr_b16 v[78:79], v231 offset:12288
    s_waitcnt vmcnt(8) lgkmcnt(8)
    v_mfma_f32_16x16x32_bf16 v[16:19], v[48:51], v[120:123], v[16:19]
    buffer_load_dwordx4 v[112:115], v12, s[52:55], s39 offen offset:2048 sc1
    buffer_load_dwordx4 v[116:119], v15, s[52:55], s39 offen offset:2048 sc1
    v_mfma_f32_16x16x32_bf16 v[20:23], v[52:55], v[120:123], v[20:23]
    ds_read_b64_tr_b16 v[80:81], v224 offset:16384
    v_mfma_f32_16x16x32_bf16 v[24:27], v[56:59], v[120:123], v[24:27]
    ds_read_b64_tr_b16 v[82:83], v228 offset:16384
    v_mfma_f32_16x16x32_bf16 v[28:31], v[60:63], v[120:123], v[28:31]
    ds_read_b64_tr_b16 v[84:85], v225 offset:16384
    v_mfma_f32_16x16x32_bf16 v[32:35], v[48:51], v[124:127], v[32:35]
    ds_read_b64_tr_b16 v[86:87], v229 offset:16384
    ds_read_b64_tr_b16 v[88:89], v226 offset:16384
    v_mfma_f32_16x16x32_bf16 v[36:39], v[52:55], v[124:127], v[36:39]
    ds_read_b64_tr_b16 v[90:91], v230 offset:16384
    v_mfma_f32_16x16x32_bf16 v[40:43], v[56:59], v[124:127], v[40:43]
    ds_read_b64_tr_b16 v[92:93], v227 offset:16384
    v_mfma_f32_16x16x32_bf16 v[44:47], v[60:63], v[124:127], v[44:47]
    ds_read_b64_tr_b16 v[94:95], v231 offset:16384
    s_waitcnt vmcnt(8) lgkmcnt(8)
    v_mfma_f32_16x16x32_bf16 v[16:19], v[64:67], v[128:131], v[16:19]
    buffer_load_dwordx4 v[120:123], v12, s[52:55], s39 offen offset:3072 sc1
    buffer_load_dwordx4 v[124:127], v15, s[52:55], s39 offen offset:3072 sc1
    v_mfma_f32_16x16x32_bf16 v[20:23], v[68:71], v[128:131], v[20:23]
    ds_read_b64_tr_b16 v[48:49], v224 offset:20480
    v_mfma_f32_16x16x32_bf16 v[24:27], v[72:75], v[128:131], v[24:27]
    ds_read_b64_tr_b16 v[50:51], v228 offset:20480
    v_mfma_f32_16x16x32_bf16 v[28:31], v[76:79], v[128:131], v[28:31]
    ds_read_b64_tr_b16 v[52:53], v225 offset:20480
    v_mfma_f32_16x16x32_bf16 v[32:35], v[64:67], v[132:135], v[32:35]
    ds_read_b64_tr_b16 v[54:55], v229 offset:20480
    ds_read_b64_tr_b16 v[56:57], v226 offset:20480
    v_mfma_f32_16x16x32_bf16 v[36:39], v[68:71], v[132:135], v[36:39]
    ds_read_b64_tr_b16 v[58:59], v230 offset:20480
    v_mfma_f32_16x16x32_bf16 v[40:43], v[72:75], v[132:135], v[40:43]
    ds_read_b64_tr_b16 v[60:61], v227 offset:20480
    v_mfma_f32_16x16x32_bf16 v[44:47], v[76:79], v[132:135], v[44:47]
    ds_read_b64_tr_b16 v[62:63], v231 offset:20480
    s_waitcnt vmcnt(8) lgkmcnt(8)
    v_mfma_f32_16x16x32_bf16 v[16:19], v[80:83], v[136:139], v[16:19]
    buffer_load_dwordx4 v[128:131], v12, s[52:55], s40 offen offset:0 sc1
    buffer_load_dwordx4 v[132:135], v15, s[52:55], s40 offen offset:0 sc1
    v_mfma_f32_16x16x32_bf16 v[20:23], v[84:87], v[136:139], v[20:23]
    ds_read_b64_tr_b16 v[64:65], v2 offset:0
    v_mfma_f32_16x16x32_bf16 v[24:27], v[88:91], v[136:139], v[24:27]
    ds_read_b64_tr_b16 v[66:67], v6 offset:0
    v_mfma_f32_16x16x32_bf16 v[28:31], v[92:95], v[136:139], v[28:31]
    ds_read_b64_tr_b16 v[68:69], v3 offset:0
    v_mfma_f32_16x16x32_bf16 v[32:35], v[80:83], v[140:143], v[32:35]
    ds_read_b64_tr_b16 v[70:71], v7 offset:0
    ds_read_b64_tr_b16 v[72:73], v4 offset:0
    v_mfma_f32_16x16x32_bf16 v[36:39], v[84:87], v[140:143], v[36:39]
    ds_read_b64_tr_b16 v[74:75], v8 offset:0
    v_mfma_f32_16x16x32_bf16 v[40:43], v[88:91], v[140:143], v[40:43]
    ds_read_b64_tr_b16 v[76:77], v5 offset:0
    v_mfma_f32_16x16x32_bf16 v[44:47], v[92:95], v[140:143], v[44:47]
    ds_read_b64_tr_b16 v[78:79], v9 offset:0
    s_waitcnt vmcnt(8) lgkmcnt(8)
    v_mfma_f32_16x16x32_bf16 v[16:19], v[48:51], v[96:99], v[16:19]
    buffer_load_dwordx4 v[136:139], v12, s[52:55], s40 offen offset:1024 sc1
    buffer_load_dwordx4 v[140:143], v15, s[52:55], s40 offen offset:1024 sc1
    v_mfma_f32_16x16x32_bf16 v[20:23], v[52:55], v[96:99], v[20:23]
    ds_read_b64_tr_b16 v[80:81], v2 offset:4096
    v_mfma_f32_16x16x32_bf16 v[24:27], v[56:59], v[96:99], v[24:27]
    ds_read_b64_tr_b16 v[82:83], v6 offset:4096
    v_mfma_f32_16x16x32_bf16 v[28:31], v[60:63], v[96:99], v[28:31]
    ds_read_b64_tr_b16 v[84:85], v3 offset:4096
    v_mfma_f32_16x16x32_bf16 v[32:35], v[48:51], v[100:103], v[32:35]
    ds_read_b64_tr_b16 v[86:87], v7 offset:4096
    ds_read_b64_tr_b16 v[88:89], v4 offset:4096
    v_mfma_f32_16x16x32_bf16 v[36:39], v[52:55], v[100:103], v[36:39]
    ds_read_b64_tr_b16 v[90:91], v8 offset:4096
    v_mfma_f32_16x16x32_bf16 v[40:43], v[56:59], v[100:103], v[40:43]
    ds_read_b64_tr_b16 v[92:93], v5 offset:4096
    v_mfma_f32_16x16x32_bf16 v[44:47], v[60:63], v[100:103], v[44:47]
    ds_read_b64_tr_b16 v[94:95], v9 offset:4096
    s_waitcnt vmcnt(8) lgkmcnt(8)
    v_mfma_f32_16x16x32_bf16 v[16:19], v[64:67], v[104:107], v[16:19]
    buffer_load_dwordx4 v[96:99], v12, s[52:55], s40 offen offset:2048 sc1
    buffer_load_dwordx4 v[100:103], v15, s[52:55], s40 offen offset:2048 sc1
    v_mfma_f32_16x16x32_bf16 v[20:23], v[68:71], v[104:107], v[20:23]
    ds_read_b64_tr_b16 v[48:49], v2 offset:8192
    v_mfma_f32_16x16x32_bf16 v[24:27], v[72:75], v[104:107], v[24:27]
    ds_read_b64_tr_b16 v[50:51], v6 offset:8192
    v_mfma_f32_16x16x32_bf16 v[28:31], v[76:79], v[104:107], v[28:31]
    ds_read_b64_tr_b16 v[52:53], v3 offset:8192
    v_mfma_f32_16x16x32_bf16 v[32:35], v[64:67], v[108:111], v[32:35]
    ds_read_b64_tr_b16 v[54:55], v7 offset:8192
    ds_read_b64_tr_b16 v[56:57], v4 offset:8192
    v_mfma_f32_16x16x32_bf16 v[36:39], v[68:71], v[108:111], v[36:39]
    ds_read_b64_tr_b16 v[58:59], v8 offset:8192
    v_mfma_f32_16x16x32_bf16 v[40:43], v[72:75], v[108:111], v[40:43]
    ds_read_b64_tr_b16 v[60:61], v5 offset:8192
    v_mfma_f32_16x16x32_bf16 v[44:47], v[76:79], v[108:111], v[44:47]
    ds_read_b64_tr_b16 v[62:63], v9 offset:8192
    s_waitcnt vmcnt(8) lgkmcnt(8)
    v_mfma_f32_16x16x32_bf16 v[16:19], v[80:83], v[112:115], v[16:19]
    buffer_load_dwordx4 v[104:107], v12, s[52:55], s40 offen offset:3072 sc1
    buffer_load_dwordx4 v[108:111], v15, s[52:55], s40 offen offset:3072 sc1
    v_mfma_f32_16x16x32_bf16 v[20:23], v[84:87], v[112:115], v[20:23]
    ds_read_b64_tr_b16 v[64:65], v2 offset:12288
    v_mfma_f32_16x16x32_bf16 v[24:27], v[88:91], v[112:115], v[24:27]
    ds_read_b64_tr_b16 v[66:67], v6 offset:12288
    v_mfma_f32_16x16x32_bf16 v[28:31], v[92:95], v[112:115], v[28:31]
    ds_read_b64_tr_b16 v[68:69], v3 offset:12288
    v_mfma_f32_16x16x32_bf16 v[32:35], v[80:83], v[116:119], v[32:35]
    ds_read_b64_tr_b16 v[70:71], v7 offset:12288
    ds_read_b64_tr_b16 v[72:73], v4 offset:12288
    v_mfma_f32_16x16x32_bf16 v[36:39], v[84:87], v[116:119], v[36:39]
    ds_read_b64_tr_b16 v[74:75], v8 offset:12288
    v_mfma_f32_16x16x32_bf16 v[40:43], v[88:91], v[116:119], v[40:43]
    ds_read_b64_tr_b16 v[76:77], v5 offset:12288
    v_mfma_f32_16x16x32_bf16 v[44:47], v[92:95], v[116:119], v[44:47]
    ds_read_b64_tr_b16 v[78:79], v9 offset:12288
    s_waitcnt vmcnt(8) lgkmcnt(8)
    v_mfma_f32_16x16x32_bf16 v[16:19], v[48:51], v[120:123], v[16:19]
    buffer_load_dwordx4 v[112:115], v12, s[52:55], s41 offen offset:0 sc1
    buffer_load_dwordx4 v[116:119], v15, s[52:55], s41 offen offset:0 sc1
    v_mfma_f32_16x16x32_bf16 v[20:23], v[52:55], v[120:123], v[20:23]
    ds_read_b64_tr_b16 v[80:81], v2 offset:16384
    v_mfma_f32_16x16x32_bf16 v[24:27], v[56:59], v[120:123], v[24:27]
    ds_read_b64_tr_b16 v[82:83], v6 offset:16384
    v_mfma_f32_16x16x32_bf16 v[28:31], v[60:63], v[120:123], v[28:31]
    ds_read_b64_tr_b16 v[84:85], v3 offset:16384
    v_mfma_f32_16x16x32_bf16 v[32:35], v[48:51], v[124:127], v[32:35]
    ds_read_b64_tr_b16 v[86:87], v7 offset:16384
    ds_read_b64_tr_b16 v[88:89], v4 offset:16384
    v_mfma_f32_16x16x32_bf16 v[36:39], v[52:55], v[124:127], v[36:39]
    ds_read_b64_tr_b16 v[90:91], v8 offset:16384
    v_mfma_f32_16x16x32_bf16 v[40:43], v[56:59], v[124:127], v[40:43]
    ds_read_b64_tr_b16 v[92:93], v5 offset:16384
    v_mfma_f32_16x16x32_bf16 v[44:47], v[60:63], v[124:127], v[44:47]
    ds_read_b64_tr_b16 v[94:95], v9 offset:16384
    s_waitcnt vmcnt(8) lgkmcnt(8)
    v_mfma_f32_16x16x32_bf16 v[16:19], v[64:67], v[128:131], v[16:19]
    buffer_load_dwordx4 v[120:123], v12, s[52:55], s41 offen offset:1024 sc1
    buffer_load_dwordx4 v[124:127], v15, s[52:55], s41 offen offset:1024 sc1
    v_mfma_f32_16x16x32_bf16 v[20:23], v[68:71], v[128:131], v[20:23]
    ds_read_b64_tr_b16 v[48:49], v2 offset:20480
    v_mfma_f32_16x16x32_bf16 v[24:27], v[72:75], v[128:131], v[24:27]
    ds_read_b64_tr_b16 v[50:51], v6 offset:20480
    v_mfma_f32_16x16x32_bf16 v[28:31], v[76:79], v[128:131], v[28:31]
    ds_read_b64_tr_b16 v[52:53], v3 offset:20480
    v_mfma_f32_16x16x32_bf16 v[32:35], v[64:67], v[132:135], v[32:35]
    ds_read_b64_tr_b16 v[54:55], v7 offset:20480
    ds_read_b64_tr_b16 v[56:57], v4 offset:20480
    v_mfma_f32_16x16x32_bf16 v[36:39], v[68:71], v[132:135], v[36:39]
    ds_read_b64_tr_b16 v[58:59], v8 offset:20480
    v_mfma_f32_16x16x32_bf16 v[40:43], v[72:75], v[132:135], v[40:43]
    ds_read_b64_tr_b16 v[60:61], v5 offset:20480
    v_mfma_f32_16x16x32_bf16 v[44:47], v[76:79], v[132:135], v[44:47]
    ds_read_b64_tr_b16 v[62:63], v9 offset:20480
    s_waitcnt vmcnt(8) lgkmcnt(8)
    s_mov_b64 exec, 1
    ds_add_u32 v10, v11 offset:28
    s_mov_b64 exec, -1
    v_mfma_f32_16x16x32_bf16 v[16:19], v[80:83], v[136:139], v[16:19]
    buffer_load_dwordx4 v[128:131], v12, s[52:55], s41 offen offset:2048 sc1
    buffer_load_dwordx4 v[132:135], v15, s[52:55], s41 offen offset:2048 sc1
    v_mfma_f32_16x16x32_bf16 v[20:23], v[84:87], v[136:139], v[20:23]
    ds_read_b64_tr_b16 v[64:65], v224 offset:45056
    v_mfma_f32_16x16x32_bf16 v[24:27], v[88:91], v[136:139], v[24:27]
    ds_read_b64_tr_b16 v[66:67], v228 offset:45056
    v_mfma_f32_16x16x32_bf16 v[28:31], v[92:95], v[136:139], v[28:31]
    ds_read_b64_tr_b16 v[68:69], v225 offset:45056
    v_mfma_f32_16x16x32_bf16 v[32:35], v[80:83], v[140:143], v[32:35]
    ds_read_b64_tr_b16 v[70:71], v229 offset:45056
    ds_read_b64_tr_b16 v[72:73], v226 offset:45056
    v_mfma_f32_16x16x32_bf16 v[36:39], v[84:87], v[140:143], v[36:39]
    ds_read_b64_tr_b16 v[74:75], v230 offset:45056
    v_mfma_f32_16x16x32_bf16 v[40:43], v[88:91], v[140:143], v[40:43]
    ds_read_b64_tr_b16 v[76:77], v227 offset:45056
    v_mfma_f32_16x16x32_bf16 v[44:47], v[92:95], v[140:143], v[44:47]
    ds_read_b64_tr_b16 v[78:79], v231 offset:45056
    s_waitcnt vmcnt(8) lgkmcnt(9)
    v_mfma_f32_16x16x32_bf16 v[16:19], v[48:51], v[96:99], v[16:19]
    buffer_load_dwordx4 v[136:139], v12, s[52:55], s41 offen offset:3072 sc1
    buffer_load_dwordx4 v[140:143], v15, s[52:55], s41 offen offset:3072 sc1
    v_mfma_f32_16x16x32_bf16 v[20:23], v[52:55], v[96:99], v[20:23]
    ds_read_b64_tr_b16 v[80:81], v224 offset:49152
    v_mfma_f32_16x16x32_bf16 v[24:27], v[56:59], v[96:99], v[24:27]
    ds_read_b64_tr_b16 v[82:83], v228 offset:49152
    v_mfma_f32_16x16x32_bf16 v[28:31], v[60:63], v[96:99], v[28:31]
    ds_read_b64_tr_b16 v[84:85], v225 offset:49152
    v_mfma_f32_16x16x32_bf16 v[32:35], v[48:51], v[100:103], v[32:35]
    ds_read_b64_tr_b16 v[86:87], v229 offset:49152
    ds_read_b64_tr_b16 v[88:89], v226 offset:49152
    v_mfma_f32_16x16x32_bf16 v[36:39], v[52:55], v[100:103], v[36:39]
    ds_read_b64_tr_b16 v[90:91], v230 offset:49152
    v_mfma_f32_16x16x32_bf16 v[40:43], v[56:59], v[100:103], v[40:43]
    ds_read_b64_tr_b16 v[92:93], v227 offset:49152
    v_mfma_f32_16x16x32_bf16 v[44:47], v[60:63], v[100:103], v[44:47]
    ds_read_b64_tr_b16 v[94:95], v231 offset:49152
    s_waitcnt vmcnt(8) lgkmcnt(8)
    v_mfma_f32_16x16x32_bf16 v[16:19], v[64:67], v[104:107], v[16:19]
    buffer_load_dwordx4 v[96:99], v12, s[52:55], s42 offen offset:0 sc1
    buffer_load_dwordx4 v[100:103], v15, s[52:55], s42 offen offset:0 sc1
    v_mfma_f32_16x16x32_bf16 v[20:23], v[68:71], v[104:107], v[20:23]
    ds_read_b64_tr_b16 v[48:49], v224 offset:53248
    v_mfma_f32_16x16x32_bf16 v[24:27], v[72:75], v[104:107], v[24:27]
    ds_read_b64_tr_b16 v[50:51], v228 offset:53248
    v_mfma_f32_16x16x32_bf16 v[28:31], v[76:79], v[104:107], v[28:31]
    ds_read_b64_tr_b16 v[52:53], v225 offset:53248
    v_mfma_f32_16x16x32_bf16 v[32:35], v[64:67], v[108:111], v[32:35]
    ds_read_b64_tr_b16 v[54:55], v229 offset:53248
    ds_read_b64_tr_b16 v[56:57], v226 offset:53248
    v_mfma_f32_16x16x32_bf16 v[36:39], v[68:71], v[108:111], v[36:39]
    ds_read_b64_tr_b16 v[58:59], v230 offset:53248
    v_mfma_f32_16x16x32_bf16 v[40:43], v[72:75], v[108:111], v[40:43]
    ds_read_b64_tr_b16 v[60:61], v227 offset:53248
    v_mfma_f32_16x16x32_bf16 v[44:47], v[76:79], v[108:111], v[44:47]
    ds_read_b64_tr_b16 v[62:63], v231 offset:53248
    s_waitcnt vmcnt(8) lgkmcnt(8)
    v_mfma_f32_16x16x32_bf16 v[16:19], v[80:83], v[112:115], v[16:19]
    buffer_load_dwordx4 v[104:107], v12, s[52:55], s42 offen offset:1024 sc1
    buffer_load_dwordx4 v[108:111], v15, s[52:55], s42 offen offset:1024 sc1
    v_mfma_f32_16x16x32_bf16 v[20:23], v[84:87], v[112:115], v[20:23]
    ds_read_b64_tr_b16 v[64:65], v224 offset:57344
    v_mfma_f32_16x16x32_bf16 v[24:27], v[88:91], v[112:115], v[24:27]
    ds_read_b64_tr_b16 v[66:67], v228 offset:57344
    v_mfma_f32_16x16x32_bf16 v[28:31], v[92:95], v[112:115], v[28:31]
    ds_read_b64_tr_b16 v[68:69], v225 offset:57344
    v_mfma_f32_16x16x32_bf16 v[32:35], v[80:83], v[116:119], v[32:35]
    ds_read_b64_tr_b16 v[70:71], v229 offset:57344
    ds_read_b64_tr_b16 v[72:73], v226 offset:57344
    v_mfma_f32_16x16x32_bf16 v[36:39], v[84:87], v[116:119], v[36:39]
    ds_read_b64_tr_b16 v[74:75], v230 offset:57344
    v_mfma_f32_16x16x32_bf16 v[40:43], v[88:91], v[116:119], v[40:43]
    ds_read_b64_tr_b16 v[76:77], v227 offset:57344
    v_mfma_f32_16x16x32_bf16 v[44:47], v[92:95], v[116:119], v[44:47]
    ds_read_b64_tr_b16 v[78:79], v231 offset:57344
    s_waitcnt vmcnt(8) lgkmcnt(8)
    v_mfma_f32_16x16x32_bf16 v[16:19], v[48:51], v[120:123], v[16:19]
    buffer_load_dwordx4 v[112:115], v12, s[52:55], s42 offen offset:2048 sc1
    buffer_load_dwordx4 v[116:119], v15, s[52:55], s42 offen offset:2048 sc1
    v_mfma_f32_16x16x32_bf16 v[20:23], v[52:55], v[120:123], v[20:23]
    ds_read_b64_tr_b16 v[80:81], v2 offset:24576
    v_mfma_f32_16x16x32_bf16 v[24:27], v[56:59], v[120:123], v[24:27]
    ds_read_b64_tr_b16 v[82:83], v6 offset:24576
    v_mfma_f32_16x16x32_bf16 v[28:31], v[60:63], v[120:123], v[28:31]
    ds_read_b64_tr_b16 v[84:85], v3 offset:24576
    v_mfma_f32_16x16x32_bf16 v[32:35], v[48:51], v[124:127], v[32:35]
    ds_read_b64_tr_b16 v[86:87], v7 offset:24576
    ds_read_b64_tr_b16 v[88:89], v4 offset:24576
    v_mfma_f32_16x16x32_bf16 v[36:39], v[52:55], v[124:127], v[36:39]
    ds_read_b64_tr_b16 v[90:91], v8 offset:24576
    v_mfma_f32_16x16x32_bf16 v[40:43], v[56:59], v[124:127], v[40:43]
    ds_read_b64_tr_b16 v[92:93], v5 offset:24576
    v_mfma_f32_16x16x32_bf16 v[44:47], v[60:63], v[124:127], v[44:47]
    ds_read_b64_tr_b16 v[94:95], v9 offset:24576
    s_waitcnt vmcnt(8) lgkmcnt(8)
    v_mfma_f32_16x16x32_bf16 v[16:19], v[64:67], v[128:131], v[16:19]
    buffer_load_dwordx4 v[120:123], v12, s[52:55], s42 offen offset:3072 sc1
    buffer_load_dwordx4 v[124:127], v15, s[52:55], s42 offen offset:3072 sc1
    v_mfma_f32_16x16x32_bf16 v[20:23], v[68:71], v[128:131], v[20:23]
    ds_read_b64_tr_b16 v[48:49], v2 offset:28672
    v_mfma_f32_16x16x32_bf16 v[24:27], v[72:75], v[128:131], v[24:27]
    ds_read_b64_tr_b16 v[50:51], v6 offset:28672
    v_mfma_f32_16x16x32_bf16 v[28:31], v[76:79], v[128:131], v[28:31]
    ds_read_b64_tr_b16 v[52:53], v3 offset:28672
    v_mfma_f32_16x16x32_bf16 v[32:35], v[64:67], v[132:135], v[32:35]
    ds_read_b64_tr_b16 v[54:55], v7 offset:28672
    ds_read_b64_tr_b16 v[56:57], v4 offset:28672
    v_mfma_f32_16x16x32_bf16 v[36:39], v[68:71], v[132:135], v[36:39]
    ds_read_b64_tr_b16 v[58:59], v8 offset:28672
    v_mfma_f32_16x16x32_bf16 v[40:43], v[72:75], v[132:135], v[40:43]
    ds_read_b64_tr_b16 v[60:61], v5 offset:28672
    v_mfma_f32_16x16x32_bf16 v[44:47], v[76:79], v[132:135], v[44:47]
    ds_read_b64_tr_b16 v[62:63], v9 offset:28672
    s_waitcnt vmcnt(8) lgkmcnt(8)
    v_mfma_f32_16x16x32_bf16 v[16:19], v[80:83], v[136:139], v[16:19]
    buffer_load_dwordx4 v[128:131], v12, s[52:55], s43 offen offset:0 sc1
    buffer_load_dwordx4 v[132:135], v15, s[52:55], s43 offen offset:0 sc1
    v_mfma_f32_16x16x32_bf16 v[20:23], v[84:87], v[136:139], v[20:23]
    ds_read_b32 v223, v10 offset:32
    v_mfma_f32_16x16x32_bf16 v[24:27], v[88:91], v[136:139], v[24:27]
    ds_read_b64_tr_b16 v[64:65], v2 offset:32768
    ds_read_b64_tr_b16 v[66:67], v6 offset:32768
    v_mfma_f32_16x16x32_bf16 v[28:31], v[92:95], v[136:139], v[28:31]
    ds_read_b64_tr_b16 v[68:69], v3 offset:32768
    v_mfma_f32_16x16x32_bf16 v[32:35], v[80:83], v[140:143], v[32:35]
    ds_read_b64_tr_b16 v[70:71], v7 offset:32768
    v_mfma_f32_16x16x32_bf16 v[36:39], v[84:87], v[140:143], v[36:39]
    ds_read_b64_tr_b16 v[72:73], v4 offset:32768
    ds_read_b64_tr_b16 v[74:75], v8 offset:32768
    v_mfma_f32_16x16x32_bf16 v[40:43], v[88:91], v[140:143], v[40:43]
    ds_read_b64_tr_b16 v[76:77], v5 offset:32768
    v_mfma_f32_16x16x32_bf16 v[44:47], v[92:95], v[140:143], v[44:47]
    ds_read_b64_tr_b16 v[78:79], v9 offset:32768
    s_waitcnt vmcnt(8) lgkmcnt(9)
    s_waitcnt lgkmcnt(8)
    v_cmp_gt_u32 vcc, 4, v223
    s_cbranch_vccnz LB_w8
LB_g8:
    v_mfma_f32_16x16x32_bf16 v[16:19], v[48:51], v[96:99], v[16:19]
    buffer_load_dwordx4 v[136:139], v12, s[52:55], s43 offen offset:1024 sc1
    buffer_load_dwordx4 v[140:143], v15, s[52:55], s43 offen offset:1024 sc1
    v_add_u32 v2, 129024, v2
    v_mfma_f32_16x16x32_bf16 v[20:23], v[52:55], v[96:99], v[20:23]
    ds_read_b64_tr_b16 v[80:81], v2 offset:0
    v_add_u32 v6, 129024, v6
    v_mfma_f32_16x16x32_bf16 v[24:27], v[56:59], v[96:99], v[24:27]
    ds_read_b64_tr_b16 v[82:83], v6 offset:0
    v_add_u32 v3, 129024, v3
    v_mfma_f32_16x16x32_bf16 v[28:31], v[60:63], v[96:99], v[28:31]
    ds_read_b64_tr_b16 v[84:85], v3 offset:0
    v_add_u32 v7, 129024, v7
    v_mfma_f32_16x16x32_bf16 v[32:35], v[48:51], v[100:103], v[32:35]
    ds_read_b64_tr_b16 v[86:87], v7 offset:0
    v_add_u32 v4, 129024, v4
    ds_read_b64_tr_b16 v[88:89], v4 offset:0
    v_mfma_f32_16x16x32_bf16 v[36:39], v[52:55], v[100:103], v[36:39]
    v_add_u32 v8, 129024, v8
    ds_read_b64_tr_b16 v[90:91], v8 offset:0
    v_mfma_f32_16x16x32_bf16 v[40:43], v[56:59], v[100:103], v[40:43]
    v_add_u32 v5, 129024, v5
    ds_read_b64_tr_b16 v[92:93], v5 offset:0
    v_mfma_f32_16x16x32_bf16 v[44:47], v[60:63], v[100:103], v[44:47]
    v_add_u32 v9, 129024, v9
    ds_read_b64_tr_b16 v[94:95], v9 offset:0
    s_waitcnt vmcnt(8) lgkmcnt(8)
    v_mfma_f32_16x16x32_bf16 v[16:19], v[64:67], v[104:107], v[16:19]
    buffer_load_dwordx4 v[96:99], v12, s[52:55], s43 offen offset:2048 sc1
    buffer_load_dwordx4 v[100:103], v15, s[52:55], s43 offen offset:2048 sc1
    v_mfma_f32_16x16x32_bf16 v[20:23], v[68:71], v[104:107], v[20:23]
    ds_read_b64_tr_b16 v[48:49], v2 offset:4096
    v_mfma_f32_16x16x32_bf16 v[24:27], v[72:75], v[104:107], v[24:27]
    ds_read_b64_tr_b16 v[50:51], v6 offset:4096
    v_mfma_f32_16x16x32_bf16 v[28:31], v[76:79], v[104:107], v[28:31]
    ds_read_b64_tr_b16 v[52:53], v3 offset:4096
    v_mfma_f32_16x16x32_bf16 v[32:35], v[64:67], v[108:111], v[32:35]
    ds_read_b64_tr_b16 v[54:55], v7 offset:4096
    ds_read_b64_tr_b16 v[56:57], v4 offset:4096
    v_mfma_f32_16x16x32_bf16 v[36:39], v[68:71], v[108:111], v[36:39]
    ds_read_b64_tr_b16 v[58:59], v8 offset:4096
    v_mfma_f32_16x16x32_bf16 v[40:43], v[72:75], v[108:111], v[40:43]
    ds_read_b64_tr_b16 v[60:61], v5 offset:4096
    v_mfma_f32_16x16x32_bf16 v[44:47], v[76:79], v[108:111], v[44:47]
    ds_read_b64_tr_b16 v[62:63], v9 offset:4096
    s_waitcnt vmcnt(8) lgkmcnt(8)
    v_mfma_f32_16x16x32_bf16 v[16:19], v[80:83], v[112:115], v[16:19]
    buffer_load_dwordx4 v[104:107], v12, s[52:55], s43 offen offset:3072 sc1
    buffer_load_dwordx4 v[108:111], v15, s[52:55], s43 offen offset:3072 sc1
    v_mfma_f32_16x16x32_bf16 v[20:23], v[84:87], v[112:115], v[20:23]
    ds_read_b64_tr_b16 v[64:65], v2 offset:8192
    v_mfma_f32_16x16x32_bf16 v[24:27], v[88:91], v[112:115], v[24:27]
    ds_read_b64_tr_b16 v[66:67], v6 offset:8192
    v_mfma_f32_16x16x32_bf16 v[28:31], v[92:95], v[112:115], v[28:31]
    ds_read_b64_tr_b16 v[68:69], v3 offset:8192
    v_mfma_f32_16x16x32_bf16 v[32:35], v[80:83], v[116:119], v[32:35]
    ds_read_b64_tr_b16 v[70:71], v7 offset:8192
    ds_read_b64_tr_b16 v[72:73], v4 offset:8192
    v_mfma_f32_16x16x32_bf16 v[36:39], v[84:87], v[116:119], v[36:39]
    ds_read_b64_tr_b16 v[74:75], v8 offset:8192
    v_mfma_f32_16x16x32_bf16 v[40:43], v[88:91], v[116:119], v[40:43]
    ds_read_b64_tr_b16 v[76:77], v5 offset:8192
    v_mfma_f32_16x16x32_bf16 v[44:47], v[92:95], v[116:119], v[44:47]
    ds_read_b64_tr_b16 v[78:79], v9 offset:8192
    s_waitcnt vmcnt(8) lgkmcnt(8)
    v_mfma_f32_16x16x32_bf16 v[16:19], v[48:51], v[120:123], v[16:19]
    ds_read_b64_tr_b16 v[80:81], v2 offset:12288
    v_mfma_f32_16x16x32_bf16 v[20:23], v[52:55], v[120:123], v[20:23]
    ds_read_b64_tr_b16 v[82:83], v6 offset:12288
    v_mfma_f32_16x16x32_bf16 v[24:27], v[56:59], v[120:123], v[24:27]
    ds_read_b64_tr_b16 v[84:85], v3 offset:12288
    v_mfma_f32_16x16x32_bf16 v[28:31], v[60:63], v[120:123], v[28:31]
    ds_read_b64_tr_b16 v[86:87], v7 offset:12288
    v_mfma_f32_16x16x32_bf16 v[32:35], v[48:51], v[124:127], v[32:35]
    ds_read_b64_tr_b16 v[88:89], v4 offset:12288
    v_mfma_f32_16x16x32_bf16 v[36:39], v[52:55], v[124:127], v[36:39]
    ds_read_b64_tr_b16 v[90:91], v8 offset:12288
    v_mfma_f32_16x16x32_bf16 v[40:43], v[56:59], v[124:127], v[40:43]
    ds_read_b64_tr_b16 v[92:93], v5 offset:12288
    v_mfma_f32_16x16x32_bf16 v[44:47], v[60:63], v[124:127], v[44:47]
    ds_read_b64_tr_b16 v[94:95], v9 offset:12288
    s_waitcnt vmcnt(6) lgkmcnt(8)
    v_mfma_f32_16x16x32_bf16 v[16:19], v[64:67], v[128:131], v[16:19]
    ds_read_b64_tr_b16 v[48:49], v2 offset:16384
    v_mfma_f32_16x16x32_bf16 v[20:23], v[68:71], v[128:131], v[20:23]
    ds_read_b64_tr_b16 v[50:51], v6 offset:16384
    v_mfma_f32_16x16x32_bf16 v[24:27], v[72:75], v[128:131], v[24:27]
    ds_read_b64_tr_b16 v[52:53], v3 offset:16384
    v_mfma_f32_16x16x32_bf16 v[28:31], v[76:79], v[128:131], v[28:31]
    ds_read_b64_tr_b16 v[54:55], v7 offset:16384
    v_mfma_f32_16x16x32_bf16 v[32:35], v[64:67], v[132:135], v[32:35]
    ds_read_b64_tr_b16 v[56:57], v4 offset:16384
    v_mfma_f32_16x16x32_bf16 v[36:39], v[68:71], v[132:135], v[36:39]
    ds_read_b64_tr_b16 v[58:59], v8 offset:16384
    v_mfma_f32_16x16x32_bf16 v[40:43], v[72:75], v[132:135], v[40:43]
    ds_read_b64_tr_b16 v[60:61], v5 offset:16384
    v_mfma_f32_16x16x32_bf16 v[44:47], v[76:79], v[132:135], v[44:47]
    ds_read_b64_tr_b16 v[62:63], v9 offset:16384
    s_waitcnt vmcnt(4) lgkmcnt(8)
    v_mfma_f32_16x16x32_bf16 v[16:19], v[80:83], v[136:139], v[16:19]
    ds_read_b64_tr_b16 v[64:65], v2 offset:20480
    v_mfma_f32_16x16x32_bf16 v[20:23], v[84:87], v[136:139], v[20:23]
    ds_read_b64_tr_b16 v[66:67], v6 offset:20480
    v_mfma_f32_16x16x32_bf16 v[24:27], v[88:91], v[136:139], v[24:27]
    ds_read_b64_tr_b16 v[68:69], v3 offset:20480
    v_mfma_f32_16x16x32_bf16 v[28:31], v[92:95], v[136:139], v[28:31]
    ds_read_b64_tr_b16 v[70:71], v7 offset:20480
    v_mfma_f32_16x16x32_bf16 v[32:35], v[80:83], v[140:143], v[32:35]
    ds_read_b64_tr_b16 v[72:73], v4 offset:20480
    v_mfma_f32_16x16x32_bf16 v[36:39], v[84:87], v[140:143], v[36:39]
    ds_read_b64_tr_b16 v[74:75], v8 offset:20480
    v_mfma_f32_16x16x32_bf16 v[40:43], v[88:91], v[140:143], v[40:43]
    ds_read_b64_tr_b16 v[76:77], v5 offset:20480
    v_mfma_f32_16x16x32_bf16 v[44:47], v[92:95], v[140:143], v[44:47]
    ds_read_b64_tr_b16 v[78:79], v9 offset:20480
    s_waitcnt vmcnt(2) lgkmcnt(8)
    v_mfma_f32_16x16x32_bf16 v[16:19], v[48:51], v[96:99], v[16:19]
    ds_read_b32 v223, v10 offset:28
    v_mfma_f32_16x16x32_bf16 v[20:23], v[52:55], v[96:99], v[20:23]
    v_mfma_f32_16x16x32_bf16 v[24:27], v[56:59], v[96:99], v[24:27]
    v_mfma_f32_16x16x32_bf16 v[28:31], v[60:63], v[96:99], v[28:31]
    v_mfma_f32_16x16x32_bf16 v[32:35], v[48:51], v[100:103], v[32:35]
    v_mfma_f32_16x16x32_bf16 v[36:39], v[52:55], v[100:103], v[36:39]
    v_mfma_f32_16x16x32_bf16 v[40:43], v[56:59], v[100:103], v[40:43]
    v_mfma_f32_16x16x32_bf16 v[44:47], v[60:63], v[100:103], v[44:47]
    s_waitcnt vmcnt(0) lgkmcnt(1)
    v_mfma_f32_16x16x32_bf16 v[16:19], v[64:67], v[104:107], v[16:19]
    v_mfma_f32_16x16x32_bf16 v[20:23], v[68:71], v[104:107], v[20:23]
    v_mfma_f32_16x16x32_bf16 v[24:27], v[72:75], v[104:107], v[24:27]
    v_mfma_f32_16x16x32_bf16 v[28:31], v[76:79], v[104:107], v[28:31]
    v_mfma_f32_16x16x32_bf16 v[32:35], v[64:67], v[108:111], v[32:35]
    v_mfma_f32_16x16x32_bf16 v[36:39], v[68:71], v[108:111], v[36:39]
    v_mfma_f32_16x16x32_bf16 v[40:43], v[72:75], v[108:111], v[40:43]
    v_mfma_f32_16x16x32_bf16 v[44:47], v[76:79], v[108:111], v[44:47]
    s_waitcnt lgkmcnt(0)
    v_cmp_gt_u32 vcc, 4, v223
    s_cbranch_vccnz LB_w7
LB_g7:
    v_cvt_pk_bf16_f32 v176, v16, v17
    v_cvt_pk_bf16_f32 v177, v18, v19
    v_cvt_pk_bf16_f32 v178, v20, v21
    v_cvt_pk_bf16_f32 v179, v22, v23
    s_nop 0
    v_permlane16_swap_b32 v176, v178
    v_permlane16_swap_b32 v177, v179
    ds_write_b128 v248, v[176:179] offset:0
    v_cvt_pk_bf16_f32 v180, v24, v25
    v_cvt_pk_bf16_f32 v181, v26, v27
    v_cvt_pk_bf16_f32 v182, v28, v29
    v_cvt_pk_bf16_f32 v183, v30, v31
    s_nop 0
    v_permlane16_swap_b32 v180, v182
    v_permlane16_swap_b32 v181, v183
    ds_write_b128 v249, v[180:183] offset:0
    ds_read_b128 v[192:195], v250 offset:0
    ds_read_b128 v[196:199], v250 offset:1024
    v_cvt_pk_bf16_f32 v184, v32, v33
    v_cvt_pk_bf16_f32 v185, v34, v35
    v_cvt_pk_bf16_f32 v186, v36, v37
    v_cvt_pk_bf16_f32 v187, v38, v39
    s_nop 0
    v_permlane16_swap_b32 v184, v186
    v_permlane16_swap_b32 v185, v187
    ds_write_b128 v248, v[184:187] offset:2048
    v_cvt_pk_bf16_f32 v188, v40, v41
    v_cvt_pk_bf16_f32 v189, v42, v43
    v_cvt_pk_bf16_f32 v190, v44, v45
    v_cvt_pk_bf16_f32 v191, v46, v47
    s_nop 0
    v_permlane16_swap_b32 v188, v190
    v_permlane16_swap_b32 v189, v191
    ds_write_b128 v249, v[188:191] offset:2048
    ds_read_b128 v[200:203], v250 offset:2048
    ds_read_b128 v[204:207], v250 offset:3072
    s_mov_b32 s95, 0
    s_waitcnt lgkmcnt(5)
    buffer_store_dwordx4 v[192:195], v246, s[60:63], s95 offen nt
    s_mov_b32 s95, 32768
    s_waitcnt lgkmcnt(4)
    buffer_store_dwordx4 v[196:199], v246, s[60:63], s95 offen nt
    s_mov_b32 s95, 65536
    s_waitcnt lgkmcnt(1)
    buffer_store_dwordx4 v[200:203], v246, s[60:63], s95 offen nt
    s_mov_b32 s95, 98304
    s_waitcnt lgkmcnt(0)
    buffer_store_dwordx4 v[204:207], v246, s[60:63], s95 offen nt
    s_endpgm
LA_slow:
    s_mov_b32 s79, 0
LA_slow1:
    s_mov_b64 exec, vcc
    s_sleep 8
    buffer_load_dword v136, v33, s[68:71], 0 offen sc1
    buffer_load_dword v137, v34, s[52:55], 0 offen sc1
    s_add_u32 s79, s79, 1
    s_cmp_gt_u32 s79, 200000
    s_waitcnt vmcnt(0)
    s_cbranch_scc1 LA_back
    v_cmp_ne_u32 vcc, v136, v137
    v_cmp_gt_u32 s[80:81], s96, v136
    s_nop 0
    s_or_b64 vcc, vcc, s[80:81]
    s_cbranch_vccnz LA_slow1
    s_branch LA_back
LB_slow:
    s_mov_b32 s79, 0
LB_pt:
    buffer_load_dword v222, v220, s[68:71], s98 offen sc1
    s_add_u32 s79, s79, 1
    s_cmp_gt_u32 s79, 200000
    s_cbranch_scc1 LB_pt_x
    s_waitcnt vmcnt(0)
    v_cmp_gt_u32 vcc, 4096, v222
    s_cbranch_vccz LB_pt_x
    s_mov_b64 exec, vcc
    s_sleep 8
    s_branch LB_pt
LB_pt_x:
    s_waitcnt vmcnt(0)
    s_branch LB_back
LB_w15:
    s_branch LB_s6_in
LB_s6:
    s_sleep 1
LB_s6_in:
    ds_read_b32 v223, v10 offset:24
    s_waitcnt lgkmcnt(0)
    v_readfirstlane_b32 s78, v223
    s_nop 0
    s_cmp_ge_u32 s78, 4
    s_cbranch_scc0 LB_s6
    s_branch LB_g15
LB_w4:
    s_branch LB_s4_in
LB_s4:
    s_sleep 1
LB_s4_in:
    ds_read_b32 v222, v10 offset:16
    s_waitcnt lgkmcnt(0)
    v_readfirstlane_b32 s78, v222
    s_nop 0
    s_cmp_ge_u32 s78, 4
    s_cbranch_scc0 LB_s4
    s_branch LB_g4
LB_w8:
    s_branch LB_s8_in
LB_s8:
    s_sleep 1
LB_s8_in:
    ds_read_b32 v223, v10 offset:32
    s_waitcnt lgkmcnt(0)
    v_readfirstlane_b32 s78, v223
    s_nop 0
    s_cmp_ge_u32 s78, 4
    s_cbranch_scc0 LB_s8
    s_branch LB_g8
LB_w7:
    s_branch LB_s7_in
LB_s7:
    s_sleep 1
LB_s7_in:
    ds_read_b32 v223, v10 offset:28
    s_waitcnt lgkmcnt(0)
    v_readfirstlane_b32 s78, v223
    s_nop 0
    s_cmp_ge_u32 s78, 4
    s_cbranch_scc0 LB_s7
    s_branch LB_g7
L_end:
    s_endpgm
.section .rodata,"a"
.p2align 6
.amdhsa_kernel concat_heads__ssm_conv_h3__sliding_local_dilated__prompt_kernel
  .amdhsa_next_free_vgpr 256
  .amdhsa_next_free_sgpr 102
  .amdhsa_accum_offset 256
  .amdhsa_group_segment_fixed_size 0
  .amdhsa_kernarg_size 96
  .amdhsa_user_sgpr_count 2
  .amdhsa_user_sgpr_kernarg_segment_ptr 1
  .amdhsa_system_sgpr_workgroup_id_x 1
.end_amdhsa_kernel
```

```asm
; @launch grid=(256,1,1) block=(512,1,1) lds=163840
.amdgcn_target "amdgcn-amd-amdhsa--gfx950"
.text
.globl concat_heads__ssm_conv_h3__sliding_local_dilated__prompt_kernel
.p2align 8
.type concat_heads__ssm_conv_h3__sliding_local_dilated__prompt_kernel,@function
concat_heads__ssm_conv_h3__sliding_local_dilated__prompt_kernel:
    s_cmp_ge_u32 s2, 256
    s_cbranch_scc1 L_end
    s_load_dwordx2 s[28:29], s[0:1], 48
    s_load_dwordx2 s[32:33], s[0:1], 56
    s_load_dwordx8 s[4:11], s[0:1], 0
    s_load_dwordx4 s[12:15], s[0:1], 32
    s_load_dwordx8 s[20:27], s[0:1], 64
    v_lshrrev_b32 v1, 6, v0
    v_and_b32 v0, 63, v0
    v_readfirstlane_b32 s3, v1
    s_nop 0
    s_cmp_lg_u32 s3, 4
    s_cbranch_scc1 L_nopf
    s_getpc_b64 s[80:81]
L_pc:
    s_bfe_u32 s78, s2, 0x40003
    v_lshl_add_u32 v1, v0, 4, s78
    v_lshlrev_b32 v1, 7, v1
    v_cmp_gt_u32 vcc, L_end-L_pc, v1
    s_nop 0
    s_and_saveexec_b64 s[82:83], vcc
    global_load_dword v222, v1, s[80:81]
    s_mov_b64 exec, -1
L_nopf:
    s_and_b32 s78, s2, 7
    s_lshr_b32 s79, s2, 3
    s_lshl_b32 s78, s78, 2
    s_lshr_b32 s78, 0x76325410, s78
    s_and_b32 s78, s78, 7
    s_and_b32 s80, s78, 1
    s_lshl_b32 s80, s80, 3
    s_lshr_b32 s81, s78, 1
    s_lshl_b32 s81, s81, 2
    s_and_b32 s72, s79, 7
    s_add_u32 s72, s72, s80
    s_lshr_b32 s73, s79, 3
    s_xor_b32 s73, s73, 3
    s_add_u32 s73, s73, s81
    s_cmp_ge_u32 s3, 4
    s_cbranch_scc1 L_B
    v_lshrrev_b32 v5, 3, v0
    v_and_b32 v6, 7, v0
    v_lshrrev_b32 v7, 4, v0
    s_lshl_b32 s79, s72, 7
    s_lshl_b32 s80, s3, 5
    s_add_u32 s81, s79, s80
    v_xor_b32 v8, v7, v6
    v_lshlrev_b32 v8, 4, v8
    v_add_u32 v240, s81, v5
    v_lshl_add_u32 v240, v240, 11, v8
    v_xor_b32 v241, 64, v240
    v_add_u32 v241, 15360, v241
    v_add_u32 v242, 30720, v240
    v_add_u32 v243, 30720, v241
    s_lshl_b32 s87, s3, 12
    s_add_u32 s87, s87, 75776
    s_and_b32 s98, s73, 12
    s_and_b32 s78, s72, 8
    s_add_u32 s98, s98, s78
    s_add_u32 s101, s72, s73
    s_and_b32 s101, s101, 3
    s_lshl_b32 s78, s101, 2
    s_lshr_b32 s97, 0x101, s78
    s_add_u32 s97, s97, s98
    s_and_b32 s97, s97, 15
    s_lshr_b32 s99, s97, 3
    s_xor_b32 s97, s97, s99
    s_mov_b32 m0, s87
    s_lshl_b32 s97, s97, 7
    s_mov_b32 s30, 0x400000
    s_mov_b32 s31, 0x20000
    s_waitcnt lgkmcnt(0)
    buffer_load_dwordx4 v240, s[28:31], s97 offen offset:0  lds
    s_and_b32 s78, s3, 1
    s_lshl_b32 s78, s78, 2
    s_lshl_b32 s80, s3, 3
    v_and_b32 v8, 1, v7
    v_lshl_or_b32 v8, v8, 1, s78
    v_xor_b32 v8, v8, v6
    buffer_load_dwordx4 v241, s[28:31], s97 offen offset:1024  lds
    v_lshlrev_b32 v8, 4, v8
    v_add_u32 v244, s80, v5
    v_mul_u32_u24 v244, 6144, v244
    s_lshl_b32 s82, s73, 7
    v_add3_u32 v244, v244, v8, s82
    buffer_load_dwordx4 v242, s[28:31], s97 offen offset:2048  lds
    v_add_u32 v245, 1024, v244
    v_add_u32 v246, 2048, v244
    s_bfe_u32 s62, s72, 0x10002
    s_mul_i32 s78, s62, 12288
    s_mul_i32 s80, s3, 3072
    s_add_u32 s60, s80, s78
    buffer_load_dwordx4 v243, s[28:31], s97 offen offset:3072  lds
    s_sub_u32 s61, s80, s78
    s_mul_i32 s62, s62, 196608
    s_sub_u32 s63, 196608, s62
    s_mov_b32 s34, 0x600000
    s_mov_b32 s35, 0x20000
    s_mul_i32 s16, s97, 3072
    s_add_u32 m0, s60, 0
    s_add_u32 s99, s16, s62
    buffer_load_dwordx4 v244, s[32:35], s99 offen offset:0  lds
    s_lshl_b32 s78, s3, 1
    s_lshl_b32 s80, s3, 2
    s_add_u32 s79, s79, s80
    s_sub_u32 s79, s79, 16
    v_add_u32 v8, s78, v7
    buffer_load_dwordx4 v245, s[32:35], s99 offen offset:1024  lds
    v_xor_b32 v8, v8, v6
    v_and_b32 v8, 7, v8
    v_lshlrev_b32 v8, 4, v8
    v_add_u32 v3, s79, v5
    buffer_load_dwordx4 v246, s[32:35], s99 offen offset:2048  lds
    v_lshl_add_u32 v3, v3, 11, v8
    s_lshl_b32 s86, s3, 10
    s_lshl_b32 s88, s3, 9
    s_add_u32 s88, s88, 73728
    s_add_u32 m0, s88, 0
    s_mov_b64 exec, 0xffffffff
    buffer_load_dwordx4 v3, s[28:31], s97 offen offset:0  lds
    s_mov_b64 exec, -1
    s_add_u32 m0, s61, 12288
    s_add_u32 s16, s16, s63
    buffer_load_dwordx4 v244, s[32:35], s16 offen offset:0  lds
    buffer_load_dwordx4 v245, s[32:35], s16 offen offset:1024  lds
    buffer_load_dwordx4 v246, s[32:35], s16 offen offset:2048  lds
    s_mov_b32 s0, 0x76583240
    s_mov_b32 s1, 0xfedba9c
    s_cmp_eq_u32 s101, 1
    s_cselect_b32 s0, 0x76943251, s0
    s_cselect_b32 s1, 0xfecbad8, s1
    s_cmp_eq_u32 s101, 2
    s_cselect_b32 s0, 0x7a543620, s0
    s_cselect_b32 s1, 0xfdcbe98, s1
    s_cmp_eq_u32 s101, 3
    s_cselect_b32 s0, 0xb6547231, s0
    s_cselect_b32 s1, 0xedcfa98, s1
    s_and_b32 s78, s73, 7
    s_cmp_lg_u32 s78, 3
    s_cbranch_scc1 LA_nb
    s_cmp_eq_u32 s101, 2
    s_cselect_b32 s0, 0x87654320, s0
    s_cselect_b32 s1, 0xfdcbea9, s1
    s_cmp_eq_u32 s101, 3
    s_cselect_b32 s0, 0x87654231, s0
    s_cselect_b32 s1, 0xedcfba9, s1
LA_nb:
    s_lshr_b32 s78, s2, 3
    s_and_b32 s76, s78, 3
    s_and_b32 s79, s73, 12
    s_add_u32 s76, s76, s79
    s_lshr_b32 s74, s78, 4
    s_add_u32 s74, s74, s79
    s_and_b32 s79, s72, 8
    s_lshr_b32 s77, s78, 2
    s_add_u32 s77, s77, s79
    s_lshr_b32 s79, s79, 2
    s_add_u32 s74, s74, s79
    s_xor_b32 s74, s74, 4
    s_and_b32 s75, s78, 15
    s_add_u32 s97, s98, s0
    s_lshr_b64 s[0:1], s[0:1], 4
    s_and_b32 s97, s97, 15
    s_lshr_b32 s99, s97, 3
    s_xor_b32 s97, s97, s99
    s_add_u32 m0, s87, 18432
    s_lshl_b32 s97, s97, 7
    buffer_load_dwordx4 v240, s[28:31], s97 offen offset:0  lds
    s_mov_b32 s36, s6
    s_mov_b32 s37, s7
    s_mov_b32 s38, 0x400000
    s_mov_b32 s39, 0x20000
    s_mov_b32 s40, s8
    s_mov_b32 s41, s9
    s_mov_b32 s42, 0x400000
    s_mov_b32 s43, 0x20000
    s_mov_b32 s44, s10
    s_mov_b32 s45, s11
    s_mov_b32 s46, 0x2000
    s_mov_b32 s47, 0x20000
    v_lshlrev_b32 v15, 4, v0
    v_and_b32 v7, 7, v0
    s_lshl_b32 s79, s74, 7
    v_lshl_add_u32 v7, v7, 4, s79
    s_lshl_b32 s78, s75, 7
    s_lshl_b32 s80, s3, 3
    s_add_u32 s80, s80, s78
    v_lshrrev_b32 v5, 3, v0
    s_and_b32 s79, s3, 1
    v_xor_b32 v5, s79, v5
    v_add_u32 v5, s80, v5
    v_lshl_add_u32 v10, v5, 11, v7
    s_xor_b32 s80, s3, 1
    s_add_u32 s80, s78, s80
    s_sub_u32 s80, s80, 4
    s_lshl_b32 s80, s80, 11
    v_add_u32 v11, s80, v7
    s_mov_b32 s52, s26
    s_mov_b32 s53, s27
    s_mov_b32 s54, 0x1000000
    s_mov_b32 s55, 0x20000
    v_and_b32 v7, 7, v0
    s_lshl_b32 s79, s74, 7
    v_lshl_add_u32 v7, v7, 4, s79
    s_lshl_b32 s78, s75, 7
    v_bfe_u32 v5, v0, 3, 2
    v_lshrrev_b32 v6, 5, v0
    s_lshl_b32 s80, s3, 5
    v_lshlrev_b32 v8, 3, v5
    v_lshl_add_u32 v8, v6, 2, v8
    v_add_u32 v8, s80, v8
    v_and_b32 v35, 7, v0
    v_lshlrev_b32 v16, 4, v35
    v_lshl_add_u32 v16, v8, 7, v16
    v_add_u32 v232, 129024, v16
    v_and_b32 v231, 1, v5
    v_lshl_add_u32 v16, v231, 7, v232
    v_xor_b32 v233, v231, v6
    v_xor_b32 v233, 1, v233
    v_lshl_add_u32 v232, v233, 7, v232
    v_xor_b32 v231, 128, v16
    v_xor_b32 v233, 128, v232
    v_lshrrev_b32 v33, 2, v35
    v_lshlrev_b32 v35, 6, v35
    v_lshl_add_u32 v35, v33, 4, v35
    v_add_u32 v35, 162816, v35
    v_add_u32 v8, s78, v8
    v_lshl_add_u32 v9, v8, 11, v7
    v_lshl_add_u32 v13, v8, 12, v7
    v_bfe_u32 v8, v0, 2, 1
    v_lshlrev_b32 v8, 1, v8
    v_add_u32 v8, v8, v6
    v_lshlrev_b32 v8, 16, v8
    v_lshl_add_u32 v8, v5, 6, v8
    v_and_b32 v7, 3, v0
    v_lshl_add_u32 v8, v7, 4, v8
    s_add_u32 s78, s78, s80
    s_lshl_b32 s78, s78, 3
    s_lshl_b32 s79, s74, 18
    s_add_u32 s78, s78, s79
    v_add_u32 v12, s78, v8
    s_mov_b32 s48, s12
    s_mov_b32 s49, s13
    s_mov_b32 s50, 0x400000
    s_mov_b32 s51, 0x20000
    s_mov_b32 s56, s4
    s_mov_b32 s57, s5
    s_mov_b32 s58, 0x400000
    s_mov_b32 s59, 0x20000
    s_mov_b32 s64, s20
    s_mov_b32 s65, s21
    s_mov_b32 s66, 0x200000
    s_mov_b32 s67, 0x20000
    s_lshl_b32 s91, s74, 4
    s_add_u32 s91, s91, s75
    s_lshr_b32 s78, s91, 3
    s_lshl_b32 s78, s78, 5
    s_and_b32 s79, s91, 7
    s_add_u32 s78, s78, s79
    s_lshl_b32 s79, s3, 3
    s_add_u32 s90, s78, s79
    s_lshl_b32 s91, s91, 14
    s_mov_b32 s96, 4096
    s_mul_i32 s94, s3, 8320
    s_add_u32 s94, s94, 129024
    v_mov_b32 v229, 0
    s_mov_b64 s[4:5], s[64:65]
    s_mov_b32 s6, 0x0
    s_mov_b32 s7, 0x20000
    v_mov_b32 v228, 0x40000000
    s_bitcmp1_b32 s73, 2
    s_cbranch_scc1 LA_nh0
    s_mov_b64 s[4:5], s[28:29]
    s_mov_b32 s6, 0x400000
    v_mov_b32 v229, 0x40000000
    s_and_b32 s78, s73, 3
    s_cmp_eq_u32 s78, 3
    s_cbranch_scc1 LA_nh0
    s_add_u32 s78, s72, 1
    s_and_b32 s78, s78, 3
    s_bfe_u32 s80, s72, 0x10002
    s_lshl_b32 s81, s101, 2
    s_lshl_b32 s82, s78, 1
    s_cmp_lt_u32 s78, 2
    s_cselect_b32 s79, 12, 24
    s_cselect_b32 s82, s82, 0
    s_cselect_b32 s83, 6, 7
    s_add_u32 s81, s81, s83
    s_add_u32 s80, s80, s82
    s_lshl_b32 s80, s80, 2
    s_add_u32 s80, s80, s3
    s_mul_i32 s80, s80, s79
    s_add_u32 s82, s81, s78
    s_add_u32 s81, s81, s98
    s_and_b32 s81, s81, 15
    s_lshr_b32 s83, s81, 3
    s_xor_b32 s81, s81, s83
    s_mul_i32 s81, s81, 192
    s_add_u32 s80, s80, s81
    s_or_b32 s81, s73, 3
    s_lshl_b32 s81, s81, 7
    v_add_u32 v5, s80, v0
    v_lshl_add_u32 v5, v5, 11, s81
    v_cmp_gt_u32 vcc, s79, v0
    s_nop 1
    v_cndmask_b32 v228, v228, v5, vcc
    s_cmp_ge_u32 s78, 2
    s_cbranch_scc1 LA_nh0
    s_add_u32 s82, s82, s98
    s_and_b32 s82, s82, 15
    s_lshr_b32 s83, s82, 3
    s_xor_b32 s82, s82, s83
    s_lshl_b32 s78, s82, 7
    s_lshl_b32 s79, s72, 7
    s_mul_i32 s80, s3, 36
    s_add_u32 s79, s79, s80
    s_sub_u32 s79, s79, 16
    v_add_u32 v5, s79, v0
    v_lshl_add_u32 v5, v5, 11, s78
    v_cmp_gt_u32 vcc, 36, v0
    s_nop 1
    v_cndmask_b32 v229, v229, v5, vcc
LA_nh0:
    buffer_load_dwordx4 v241, s[28:31], s97 offen offset:1024  lds
    s_mul_i32 s16, s97, 3072
    s_add_u32 m0, s60, 24576
    s_add_u32 s99, s16, s62
    buffer_load_dwordx4 v244, s[32:35], s99 offen offset:0  lds
    buffer_load_dwordx4 v245, s[32:35], s99 offen offset:1024  lds
    buffer_load_dwordx4 v246, s[32:35], s99 offen offset:2048  lds
    s_add_u32 m0, s87, 18432
    s_nop 0
    buffer_load_dwordx4 v242, s[28:31], s97 offen offset:2048  lds
    buffer_load_dwordx4 v243, s[28:31], s97 offen offset:3072  lds
    s_cmp_eq_u32 s101, 1
    s_cbranch_scc1 LA_c1
    s_cmp_eq_u32 s101, 2
    s_cbranch_scc1 LA_c2
    s_cmp_eq_u32 s101, 3
    s_cbranch_scc1 LA_c3
LA_c0:
    s_waitcnt vmcnt(7)
    s_barrier
    s_add_u32 m0, s88, 18432
    s_mov_b64 exec, 0xffffffff
    buffer_load_dwordx4 v3, s[28:31], s97 offen offset:0  lds
    s_mov_b64 exec, -1
    s_add_u32 m0, s61, 36864
    s_add_u32 s16, s16, s63
    buffer_load_dwordx4 v244, s[32:35], s16 offen offset:0  lds
    buffer_load_dwordx4 v245, s[32:35], s16 offen offset:1024  lds
    buffer_load_dwordx4 v246, s[32:35], s16 offen offset:2048  lds
    s_add_u32 s97, s98, s0
    s_lshr_b64 s[0:1], s[0:1], 4
    s_and_b32 s97, s97, 15
    s_lshr_b32 s99, s97, 3
    s_xor_b32 s97, s97, s99
    s_add_u32 m0, s87, 36864
    s_lshl_b32 s97, s97, 7
    buffer_load_dwordx4 v240, s[28:31], s97 offen offset:0  lds
    buffer_load_dwordx4 v241, s[28:31], s97 offen offset:1024  lds
    s_mul_i32 s16, s97, 3072
    s_add_u32 m0, s60, 49152
    s_add_u32 s99, s16, s62
    buffer_load_dwordx4 v244, s[32:35], s99 offen offset:0  lds
    buffer_load_dwordx4 v245, s[32:35], s99 offen offset:1024  lds
    buffer_load_dwordx4 v246, s[32:35], s99 offen offset:2048  lds
    s_add_u32 m0, s87, 36864
    s_nop 0
    buffer_load_dwordx4 v242, s[28:31], s97 offen offset:2048  lds
    buffer_load_dwordx4 v243, s[28:31], s97 offen offset:3072  lds
    s_add_u32 m0, s88, 36864
    s_mov_b64 exec, 0xffffffff
    buffer_load_dwordx4 v3, s[28:31], s97 offen offset:0  lds
    s_mov_b64 exec, -1
    s_add_u32 m0, s61, 61440
    s_add_u32 s16, s16, s63
    buffer_load_dwordx4 v244, s[32:35], s16 offen offset:0  lds
    buffer_load_dwordx4 v245, s[32:35], s16 offen offset:1024  lds
    buffer_load_dwordx4 v246, s[32:35], s16 offen offset:2048  lds
    s_waitcnt vmcnt(11)
    s_barrier
    s_add_u32 m0, s86, 129536
    s_mov_b32 s89, 0
    buffer_load_dwordx4 v10, s[36:39], s89 offen nt lds
    s_add_u32 m0, s86, 145920
    s_mov_b32 s89, 0
    buffer_load_dwordx4 v10, s[40:43], s89 offen nt lds
    s_add_u32 m0, s86, 133632
    s_mov_b32 s89, 65536
    buffer_load_dwordx4 v10, s[36:39], s89 offen nt lds
    s_add_u32 m0, s86, 150016
    s_mov_b32 s89, 65536
    buffer_load_dwordx4 v10, s[40:43], s89 offen nt lds
    s_add_u32 m0, s86, 137728
    s_mov_b32 s89, 131072
    buffer_load_dwordx4 v10, s[36:39], s89 offen nt lds
    s_add_u32 m0, s86, 154112
    s_mov_b32 s89, 131072
    buffer_load_dwordx4 v10, s[40:43], s89 offen nt lds
    s_add_u32 m0, s86, 141824
    s_mov_b32 s89, 196608
    buffer_load_dwordx4 v10, s[36:39], s89 offen nt lds
    s_add_u32 m0, s86, 158208
    s_mov_b32 s89, 196608
    buffer_load_dwordx4 v10, s[40:43], s89 offen nt lds
    s_mov_b64 exec, 0xff
    s_lshl_b32 s82, s3, 7
    s_add_u32 m0, s82, 129024
    s_mov_b32 s89, 0
    buffer_load_dwordx4 v11, s[36:39], s89 offen nt lds
    s_lshl_b32 s83, s74, 9
    s_add_u32 s83, s83, s82
    s_and_b32 s89, s3, 2
    s_lshl_b32 s89, s89, 3
    s_add_u32 s82, s82, s89
    s_add_u32 m0, s82, 162816
    s_add_u32 s89, s83, 0
    buffer_load_dwordx4 v15, s[44:47], s89 offen  lds
    s_mov_b64 exec, -1
    s_add_u32 s97, s98, s0
    s_lshr_b64 s[0:1], s[0:1], 4
    s_and_b32 s97, s97, 15
    s_lshr_b32 s99, s97, 3
    s_xor_b32 s97, s97, s99
    s_add_u32 m0, s87, 0
    s_lshl_b32 s97, s97, 7
    buffer_load_dwordx4 v240, s[28:31], s97 offen offset:0  lds
    buffer_load_dwordx4 v241, s[28:31], s97 offen offset:1024  lds
    s_mul_i32 s16, s97, 3072
    s_add_u32 m0, s60, 0
    s_add_u32 s99, s16, s62
    buffer_load_dwordx4 v244, s[32:35], s99 offen offset:0  lds
    buffer_load_dwordx4 v245, s[32:35], s99 offen offset:1024  lds
    buffer_load_dwordx4 v246, s[32:35], s99 offen offset:2048  lds
    s_add_u32 m0, s87, 0
    s_nop 0
    buffer_load_dwordx4 v242, s[28:31], s97 offen offset:2048  lds
    buffer_load_dwordx4 v243, s[28:31], s97 offen offset:3072  lds
    s_waitcnt vmcnt(17)
    s_barrier
    s_add_u32 m0, s88, 0
    s_mov_b64 exec, 0xffffffff
    buffer_load_dwordx4 v3, s[28:31], s97 offen offset:0  lds
    s_mov_b64 exec, -1
    s_add_u32 m0, s61, 12288
    s_add_u32 s16, s16, s63
    buffer_load_dwordx4 v244, s[32:35], s16 offen offset:0  lds
    buffer_load_dwordx4 v245, s[32:35], s16 offen offset:1024  lds
    buffer_load_dwordx4 v246, s[32:35], s16 offen offset:2048  lds
    buffer_load_dword v230, v229, s[4:7], 0 offen
    buffer_load_dword v230, v228, s[32:35], 0 offen
    s_add_u32 s97, s98, s0
    s_lshr_b64 s[0:1], s[0:1], 4
    s_and_b32 s97, s97, 15
    s_lshr_b32 s99, s97, 3
    s_xor_b32 s97, s97, s99
    s_add_u32 m0, s87, 18432
    s_lshl_b32 s97, s97, 7
    buffer_load_dwordx4 v240, s[28:31], s97 offen offset:0  lds
    buffer_load_dwordx4 v241, s[28:31], s97 offen offset:1024  lds
    s_mul_i32 s16, s97, 3072
    s_add_u32 m0, s60, 24576
    s_add_u32 s99, s16, s62
    buffer_load_dwordx4 v244, s[32:35], s99 offen offset:0  lds
    buffer_load_dwordx4 v245, s[32:35], s99 offen offset:1024  lds
    buffer_load_dwordx4 v246, s[32:35], s99 offen offset:2048  lds
    s_add_u32 m0, s87, 18432
    s_nop 0
    buffer_load_dwordx4 v242, s[28:31], s97 offen offset:2048  lds
    buffer_load_dwordx4 v243, s[28:31], s97 offen offset:3072  lds
    s_add_u32 m0, s88, 18432
    s_mov_b64 exec, 0xffffffff
    buffer_load_dwordx4 v3, s[28:31], s97 offen offset:0  lds
    s_mov_b64 exec, -1
    s_add_u32 m0, s61, 36864
    s_add_u32 s16, s16, s63
    buffer_load_dwordx4 v244, s[32:35], s16 offen offset:0  lds
    buffer_load_dwordx4 v245, s[32:35], s16 offen offset:1024  lds
    s_waitcnt vmcnt(12)
    s_barrier
    buffer_load_dwordx4 v246, s[32:35], s16 offen offset:2048  lds
    ds_read_b128 v[84:87], v35 offset:0
    ds_read_b128 v[88:91], v35 offset:16
    s_add_u32 s97, s98, s0
    s_lshr_b64 s[0:1], s[0:1], 4
    s_and_b32 s97, s97, 15
    s_lshr_b32 s99, s97, 3
    s_xor_b32 s97, s97, s99
    s_add_u32 m0, s87, 36864
    s_lshl_b32 s97, s97, 7
    buffer_load_dwordx4 v240, s[28:31], s97 offen offset:0  lds
    ds_read_b128 v[92:95], v35 offset:32
    buffer_load_dwordx4 v241, s[28:31], s97 offen offset:1024  lds
    ds_read_b128 v[96:99], v35 offset:48
    s_mul_i32 s16, s97, 3072
    s_add_u32 m0, s60, 49152
    s_add_u32 s99, s16, s62
    buffer_load_dwordx4 v244, s[32:35], s99 offen offset:0  lds
    ds_read_b128 v[40:43], v233 offset:0
    buffer_load_dwordx4 v245, s[32:35], s99 offen offset:1024  lds
    ds_read_b128 v[44:47], v232 offset:256
    ds_read_b128 v[48:51], v233 offset:256
    buffer_load_dwordx4 v246, s[32:35], s99 offen offset:2048  lds
    ds_read_b128 v[52:55], v16 offset:512
    s_add_u32 m0, s87, 36864
    s_nop 0
    buffer_load_dwordx4 v242, s[28:31], s97 offen offset:2048  lds
    ds_read_b128 v[56:59], v231 offset:512
    buffer_load_dwordx4 v243, s[28:31], s97 offen offset:3072  lds
    ds_read_b128 v[60:63], v16 offset:768
    s_add_u32 m0, s88, 36864
    s_mov_b64 exec, 0xffffffff
    buffer_load_dwordx4 v3, s[28:31], s97 offen offset:0  lds
    s_mov_b64 exec, -1
    ds_read_b128 v[64:67], v231 offset:768
    ds_read_b128 v[68:71], v16 offset:16896
    s_add_u32 m0, s61, 61440
    s_add_u32 s16, s16, s63
    buffer_load_dwordx4 v244, s[32:35], s16 offen offset:0  lds
    ds_read_b128 v[72:75], v231 offset:16896
    buffer_load_dwordx4 v245, s[32:35], s16 offen offset:1024  lds
    ds_read_b128 v[76:79], v16 offset:17152
    buffer_load_dwordx4 v246, s[32:35], s16 offen offset:2048  lds
    ds_read_b128 v[80:83], v231 offset:17152
    s_waitcnt vmcnt(11)
    s_waitcnt lgkmcnt(0)
    s_barrier
    s_add_u32 s97, s98, s0
    s_lshr_b64 s[0:1], s[0:1], 4
    s_and_b32 s97, s97, 15
    s_lshr_b32 s99, s97, 3
    s_xor_b32 s97, s97, s99
    s_add_u32 m0, s87, 0
    s_lshl_b32 s97, s97, 7
    buffer_load_dwordx4 v240, s[28:31], s97 offen offset:0  lds
    v_lshlrev_b32 v116, 16, v40
    v_lshlrev_b32 v117, 16, v44
    v_lshlrev_b32 v118, 16, v48
    v_lshlrev_b32 v119, 16, v52
    v_lshlrev_b32 v120, 16, v56
    buffer_load_dwordx4 v241, s[28:31], s97 offen offset:1024  lds
    v_lshlrev_b32 v121, 16, v60
    v_lshlrev_b32 v122, 16, v64
    v_lshlrev_b32 v127, 16, v84
    v_and_b32 v128, 0xffff0000, v84
    v_lshlrev_b32 v129, 16, v85
    s_mul_i32 s16, s97, 3072
    s_add_u32 m0, s60, 0
    s_add_u32 s99, s16, s62
    buffer_load_dwordx4 v244, s[32:35], s99 offen offset:0  lds
    v_and_b32 v130, 0xffff0000, v85
    v_lshlrev_b32 v123, 16, v68
    v_lshlrev_b32 v124, 16, v72
    v_lshlrev_b32 v125, 16, v76
    v_lshlrev_b32 v126, 16, v80
    buffer_load_dwordx4 v245, s[32:35], s99 offen offset:1024  lds
    v_mul_f32 v131, v116, v130
    v_mul_f32 v132, v117, v130
    v_mul_f32 v133, v118, v130
    v_mul_f32 v134, v119, v130
    v_fmac_f32 v131, v117, v129
    buffer_load_dwordx4 v246, s[32:35], s99 offen offset:2048  lds
    v_fmac_f32 v132, v118, v129
    v_fmac_f32 v133, v119, v129
    v_fmac_f32 v134, v120, v129
    v_fmac_f32 v131, v118, v128
    v_fmac_f32 v132, v119, v128
    s_add_u32 m0, s87, 0
    s_nop 0
    buffer_load_dwordx4 v242, s[28:31], s97 offen offset:2048  lds
    v_fmac_f32 v133, v120, v128
    v_fmac_f32 v134, v121, v128
    v_fmac_f32 v131, v119, v127
    v_fmac_f32 v132, v120, v127
    v_fmac_f32 v133, v121, v127
    buffer_load_dwordx4 v243, s[28:31], s97 offen offset:3072  lds
    v_fmac_f32 v134, v122, v127
    v_mul_f32 v131, v131, v123
    v_mul_f32 v132, v132, v124
    v_mul_f32 v133, v133, v125
    v_mul_f32 v134, v134, v126
    s_add_u32 m0, s88, 0
    s_mov_b64 exec, 0xffffffff
    buffer_load_dwordx4 v3, s[28:31], s97 offen offset:0  lds
    s_mov_b64 exec, -1
    v_cvt_pk_bf16_f32 v102, v134, v133
    v_cvt_pk_bf16_f32 v103, v132, v131
    v_lshlrev_b32 v116, 16, v42
    v_lshlrev_b32 v117, 16, v46
    v_lshlrev_b32 v118, 16, v50
    s_add_u32 m0, s61, 12288
    s_add_u32 s16, s16, s63
    buffer_load_dwordx4 v244, s[32:35], s16 offen offset:0  lds
    v_lshlrev_b32 v119, 16, v54
    v_lshlrev_b32 v120, 16, v58
    v_lshlrev_b32 v121, 16, v62
    v_lshlrev_b32 v122, 16, v66
    v_lshlrev_b32 v127, 16, v92
    buffer_load_dwordx4 v245, s[32:35], s16 offen offset:1024  lds
    v_and_b32 v128, 0xffff0000, v92
    v_lshlrev_b32 v129, 16, v93
    v_and_b32 v130, 0xffff0000, v93
    v_lshlrev_b32 v123, 16, v70
    v_lshlrev_b32 v124, 16, v74
    buffer_load_dwordx4 v246, s[32:35], s16 offen offset:2048  lds
    v_lshlrev_b32 v125, 16, v78
    v_lshlrev_b32 v126, 16, v82
    v_mul_f32 v131, v116, v130
    v_mul_f32 v132, v117, v130
    v_mul_f32 v133, v118, v130
    v_mul_f32 v134, v119, v130
    v_fmac_f32 v131, v117, v129
    v_fmac_f32 v132, v118, v129
    v_fmac_f32 v133, v119, v129
    v_fmac_f32 v134, v120, v129
    v_fmac_f32 v131, v118, v128
    v_fmac_f32 v132, v119, v128
    v_fmac_f32 v133, v120, v128
    v_fmac_f32 v134, v121, v128
    v_fmac_f32 v131, v119, v127
    v_fmac_f32 v132, v120, v127
    v_fmac_f32 v133, v121, v127
    v_fmac_f32 v134, v122, v127
    v_mul_f32 v131, v131, v123
    v_mul_f32 v132, v132, v124
    v_mul_f32 v133, v133, v125
    v_mul_f32 v134, v134, v126
    v_cvt_pk_bf16_f32 v100, v134, v133
    v_cvt_pk_bf16_f32 v101, v132, v131
    s_nop 0
    v_permlane32_swap_b32 v102, v100
    v_permlane32_swap_b32 v103, v101
    s_mov_b32 s89, 0
    buffer_store_dwordx4 v[100:103], v12, s[52:55], s89 offen sc1
    s_waitcnt vmcnt(12)
    s_barrier
    s_add_u32 s97, s98, s0
    s_lshr_b64 s[0:1], s[0:1], 4
    s_and_b32 s97, s97, 15
    s_lshr_b32 s99, s97, 3
    s_xor_b32 s97, s97, s99
    s_add_u32 m0, s87, 18432
    s_lshl_b32 s97, s97, 7
    buffer_load_dwordx4 v240, s[28:31], s97 offen offset:0  lds
    v_and_b32 v116, 0xffff0000, v40
    v_and_b32 v117, 0xffff0000, v44
    v_and_b32 v118, 0xffff0000, v48
    v_and_b32 v119, 0xffff0000, v52
    v_and_b32 v120, 0xffff0000, v56
    buffer_load_dwordx4 v241, s[28:31], s97 offen offset:1024  lds
    v_and_b32 v121, 0xffff0000, v60
    v_and_b32 v122, 0xffff0000, v64
    v_lshlrev_b32 v127, 16, v86
    v_and_b32 v128, 0xffff0000, v86
    v_lshlrev_b32 v129, 16, v87
    s_mul_i32 s16, s97, 3072
    s_add_u32 m0, s60, 24576
    s_add_u32 s99, s16, s62
    buffer_load_dwordx4 v244, s[32:35], s99 offen offset:0  lds
    v_and_b32 v130, 0xffff0000, v87
    v_and_b32 v123, 0xffff0000, v68
    v_and_b32 v124, 0xffff0000, v72
    v_and_b32 v125, 0xffff0000, v76
    v_and_b32 v126, 0xffff0000, v80
    buffer_load_dwordx4 v245, s[32:35], s99 offen offset:1024  lds
    v_mul_f32 v131, v116, v130
    v_mul_f32 v132, v117, v130
    v_mul_f32 v133, v118, v130
    v_mul_f32 v134, v119, v130
    v_fmac_f32 v131, v117, v129
    buffer_load_dwordx4 v246, s[32:35], s99 offen offset:2048  lds
    v_fmac_f32 v132, v118, v129
    v_fmac_f32 v133, v119, v129
    v_fmac_f32 v134, v120, v129
    v_fmac_f32 v131, v118, v128
    v_fmac_f32 v132, v119, v128
    s_add_u32 m0, s87, 18432
    s_nop 0
    buffer_load_dwordx4 v242, s[28:31], s97 offen offset:2048  lds
    v_fmac_f32 v133, v120, v128
    v_fmac_f32 v134, v121, v128
    v_fmac_f32 v131, v119, v127
    v_fmac_f32 v132, v120, v127
    v_fmac_f32 v133, v121, v127
    buffer_load_dwordx4 v243, s[28:31], s97 offen offset:3072  lds
    v_fmac_f32 v134, v122, v127
    v_mul_f32 v131, v131, v123
    v_mul_f32 v132, v132, v124
    v_mul_f32 v133, v133, v125
    v_mul_f32 v134, v134, v126
    s_add_u32 m0, s88, 18432
    s_mov_b64 exec, 0xffffffff
    buffer_load_dwordx4 v3, s[28:31], s97 offen offset:0  lds
    s_mov_b64 exec, -1
    v_cvt_pk_bf16_f32 v106, v134, v133
    v_cvt_pk_bf16_f32 v107, v132, v131
    v_and_b32 v116, 0xffff0000, v42
    v_and_b32 v117, 0xffff0000, v46
    v_and_b32 v118, 0xffff0000, v50
    s_add_u32 m0, s61, 36864
    s_add_u32 s16, s16, s63
    buffer_load_dwordx4 v244, s[32:35], s16 offen offset:0  lds
    v_and_b32 v119, 0xffff0000, v54
    v_and_b32 v120, 0xffff0000, v58
    v_and_b32 v121, 0xffff0000, v62
    v_and_b32 v122, 0xffff0000, v66
    v_lshlrev_b32 v127, 16, v94
    buffer_load_dwordx4 v245, s[32:35], s16 offen offset:1024  lds
    v_and_b32 v128, 0xffff0000, v94
    v_lshlrev_b32 v129, 16, v95
    v_and_b32 v130, 0xffff0000, v95
    v_and_b32 v123, 0xffff0000, v70
    v_and_b32 v124, 0xffff0000, v74
    buffer_load_dwordx4 v246, s[32:35], s16 offen offset:2048  lds
    v_and_b32 v125, 0xffff0000, v78
    v_and_b32 v126, 0xffff0000, v82
    v_mul_f32 v131, v116, v130
    v_mul_f32 v132, v117, v130
    v_mul_f32 v133, v118, v130
    v_mul_f32 v134, v119, v130
    v_fmac_f32 v131, v117, v129
    v_fmac_f32 v132, v118, v129
    v_fmac_f32 v133, v119, v129
    v_fmac_f32 v134, v120, v129
    v_fmac_f32 v131, v118, v128
    v_fmac_f32 v132, v119, v128
    v_fmac_f32 v133, v120, v128
    v_fmac_f32 v134, v121, v128
    v_fmac_f32 v131, v119, v127
    v_fmac_f32 v132, v120, v127
    v_fmac_f32 v133, v121, v127
    v_fmac_f32 v134, v122, v127
    v_mul_f32 v131, v131, v123
    v_mul_f32 v132, v132, v124
    v_mul_f32 v133, v133, v125
    v_mul_f32 v134, v134, v126
    v_cvt_pk_bf16_f32 v104, v134, v133
    v_cvt_pk_bf16_f32 v105, v132, v131
    s_nop 0
    v_permlane32_swap_b32 v106, v104
    v_permlane32_swap_b32 v107, v105
    s_mov_b32 s89, 16384
    buffer_store_dwordx4 v[104:107], v12, s[52:55], s89 offen sc1
    s_waitcnt vmcnt(13)
    s_barrier
    s_add_u32 s97, s98, s0
    s_lshr_b64 s[0:1], s[0:1], 4
    s_and_b32 s97, s97, 15
    s_lshr_b32 s99, s97, 3
    s_xor_b32 s97, s97, s99
    s_add_u32 m0, s87, 36864
    s_lshl_b32 s97, s97, 7
    buffer_load_dwordx4 v240, s[28:31], s97 offen offset:0  lds
    v_lshlrev_b32 v116, 16, v41
    v_lshlrev_b32 v117, 16, v45
    v_lshlrev_b32 v118, 16, v49
    v_lshlrev_b32 v119, 16, v53
    v_lshlrev_b32 v120, 16, v57
    buffer_load_dwordx4 v241, s[28:31], s97 offen offset:1024  lds
    v_lshlrev_b32 v121, 16, v61
    v_lshlrev_b32 v122, 16, v65
    v_lshlrev_b32 v127, 16, v88
    v_and_b32 v128, 0xffff0000, v88
    v_lshlrev_b32 v129, 16, v89
    s_mul_i32 s16, s97, 3072
    s_add_u32 m0, s60, 49152
    s_add_u32 s99, s16, s62
    buffer_load_dwordx4 v244, s[32:35], s99 offen offset:0  lds
    v_and_b32 v130, 0xffff0000, v89
    v_lshlrev_b32 v123, 16, v69
    v_lshlrev_b32 v124, 16, v73
    v_lshlrev_b32 v125, 16, v77
    v_lshlrev_b32 v126, 16, v81
    buffer_load_dwordx4 v245, s[32:35], s99 offen offset:1024  lds
    v_mul_f32 v131, v116, v130
    v_mul_f32 v132, v117, v130
    v_mul_f32 v133, v118, v130
    v_mul_f32 v134, v119, v130
    v_fmac_f32 v131, v117, v129
    buffer_load_dwordx4 v246, s[32:35], s99 offen offset:2048  lds
    v_fmac_f32 v132, v118, v129
    v_fmac_f32 v133, v119, v129
    v_fmac_f32 v134, v120, v129
    v_fmac_f32 v131, v118, v128
    v_fmac_f32 v132, v119, v128
    s_add_u32 m0, s87, 36864
    s_nop 0
    buffer_load_dwordx4 v242, s[28:31], s97 offen offset:2048  lds
    v_fmac_f32 v133, v120, v128
    v_fmac_f32 v134, v121, v128
    v_fmac_f32 v131, v119, v127
    v_fmac_f32 v132, v120, v127
    v_fmac_f32 v133, v121, v127
    buffer_load_dwordx4 v243, s[28:31], s97 offen offset:3072  lds
    v_fmac_f32 v134, v122, v127
    v_mul_f32 v131, v131, v123
    v_mul_f32 v132, v132, v124
    v_mul_f32 v133, v133, v125
    v_mul_f32 v134, v134, v126
    s_add_u32 m0, s88, 36864
    s_mov_b64 exec, 0xffffffff
    buffer_load_dwordx4 v3, s[28:31], s97 offen offset:0  lds
    s_mov_b64 exec, -1
    v_cvt_pk_bf16_f32 v110, v134, v133
    v_cvt_pk_bf16_f32 v111, v132, v131
    v_lshlrev_b32 v116, 16, v43
    v_lshlrev_b32 v117, 16, v47
    v_lshlrev_b32 v118, 16, v51
    s_add_u32 m0, s61, 61440
    s_add_u32 s16, s16, s63
    buffer_load_dwordx4 v244, s[32:35], s16 offen offset:0  lds
    v_lshlrev_b32 v119, 16, v55
    v_lshlrev_b32 v120, 16, v59
    v_lshlrev_b32 v121, 16, v63
    v_lshlrev_b32 v122, 16, v67
    v_lshlrev_b32 v127, 16, v96
    buffer_load_dwordx4 v245, s[32:35], s16 offen offset:1024  lds
    v_and_b32 v128, 0xffff0000, v96
    v_lshlrev_b32 v129, 16, v97
    v_and_b32 v130, 0xffff0000, v97
    v_lshlrev_b32 v123, 16, v71
    v_lshlrev_b32 v124, 16, v75
    buffer_load_dwordx4 v246, s[32:35], s16 offen offset:2048  lds
    v_lshlrev_b32 v125, 16, v79
    v_lshlrev_b32 v126, 16, v83
    v_mul_f32 v131, v116, v130
    v_mul_f32 v132, v117, v130
    v_mul_f32 v133, v118, v130
    v_mul_f32 v134, v119, v130
    v_fmac_f32 v131, v117, v129
    v_fmac_f32 v132, v118, v129
    v_fmac_f32 v133, v119, v129
    v_fmac_f32 v134, v120, v129
    v_fmac_f32 v131, v118, v128
    v_fmac_f32 v132, v119, v128
    v_fmac_f32 v133, v120, v128
    v_fmac_f32 v134, v121, v128
    v_fmac_f32 v131, v119, v127
    v_fmac_f32 v132, v120, v127
    v_fmac_f32 v133, v121, v127
    v_fmac_f32 v134, v122, v127
    v_mul_f32 v131, v131, v123
    v_mul_f32 v132, v132, v124
    v_mul_f32 v133, v133, v125
    v_mul_f32 v134, v134, v126
    v_cvt_pk_bf16_f32 v108, v134, v133
    v_cvt_pk_bf16_f32 v109, v132, v131
    s_nop 0
    v_permlane32_swap_b32 v110, v108
    v_permlane32_swap_b32 v111, v109
    s_mov_b32 s89, 32768
    buffer_store_dwordx4 v[108:111], v12, s[52:55], s89 offen sc1
    s_waitcnt vmcnt(13)
    s_barrier
    s_add_u32 s97, s98, s0
    s_lshr_b64 s[0:1], s[0:1], 4
    s_and_b32 s97, s97, 15
    s_lshr_b32 s99, s97, 3
    s_xor_b32 s97, s97, s99
    s_add_u32 m0, s87, 0
    s_lshl_b32 s97, s97, 7
    buffer_load_dwordx4 v240, s[28:31], s97 offen offset:0  lds
    v_and_b32 v116, 0xffff0000, v41
    v_and_b32 v117, 0xffff0000, v45
    v_and_b32 v118, 0xffff0000, v49
    v_and_b32 v119, 0xffff0000, v53
    v_and_b32 v120, 0xffff0000, v57
    buffer_load_dwordx4 v241, s[28:31], s97 offen offset:1024  lds
    v_and_b32 v121, 0xffff0000, v61
    v_and_b32 v122, 0xffff0000, v65
    v_lshlrev_b32 v127, 16, v90
    v_and_b32 v128, 0xffff0000, v90
    v_lshlrev_b32 v129, 16, v91
    s_mul_i32 s16, s97, 3072
    s_add_u32 m0, s60, 0
    s_add_u32 s99, s16, s62
    buffer_load_dwordx4 v244, s[32:35], s99 offen offset:0  lds
    v_and_b32 v130, 0xffff0000, v91
    v_and_b32 v123, 0xffff0000, v69
    v_and_b32 v124, 0xffff0000, v73
    v_and_b32 v125, 0xffff0000, v77
    v_and_b32 v126, 0xffff0000, v81
    buffer_load_dwordx4 v245, s[32:35], s99 offen offset:1024  lds
    v_mul_f32 v131, v116, v130
    v_mul_f32 v132, v117, v130
    v_mul_f32 v133, v118, v130
    v_mul_f32 v134, v119, v130
    v_fmac_f32 v131, v117, v129
    buffer_load_dwordx4 v246, s[32:35], s99 offen offset:2048  lds
    v_fmac_f32 v132, v118, v129
    v_fmac_f32 v133, v119, v129
    v_fmac_f32 v134, v120, v129
    v_fmac_f32 v131, v118, v128
    v_fmac_f32 v132, v119, v128
    s_add_u32 m0, s87, 0
    s_nop 0
    buffer_load_dwordx4 v242, s[28:31], s97 offen offset:2048  lds
    v_fmac_f32 v133, v120, v128
    v_fmac_f32 v134, v121, v128
    v_fmac_f32 v131, v119, v127
    v_fmac_f32 v132, v120, v127
    v_fmac_f32 v133, v121, v127
    buffer_load_dwordx4 v243, s[28:31], s97 offen offset:3072  lds
    v_fmac_f32 v134, v122, v127
    v_mul_f32 v131, v131, v123
    v_mul_f32 v132, v132, v124
    v_mul_f32 v133, v133, v125
    v_mul_f32 v134, v134, v126
    s_add_u32 m0, s88, 0
    s_mov_b64 exec, 0xffffffff
    buffer_load_dwordx4 v3, s[28:31], s97 offen offset:0  lds
    s_mov_b64 exec, -1
    v_cvt_pk_bf16_f32 v114, v134, v133
    v_cvt_pk_bf16_f32 v115, v132, v131
    v_and_b32 v116, 0xffff0000, v43
    v_and_b32 v117, 0xffff0000, v47
    v_and_b32 v118, 0xffff0000, v51
    s_add_u32 m0, s61, 12288
    s_add_u32 s16, s16, s63
    buffer_load_dwordx4 v244, s[32:35], s16 offen offset:0  lds
    v_and_b32 v119, 0xffff0000, v55
    v_and_b32 v120, 0xffff0000, v59
    v_and_b32 v121, 0xffff0000, v63
    v_and_b32 v122, 0xffff0000, v67
    v_lshlrev_b32 v127, 16, v98
    buffer_load_dwordx4 v245, s[32:35], s16 offen offset:1024  lds
    v_and_b32 v128, 0xffff0000, v98
    v_lshlrev_b32 v129, 16, v99
    v_and_b32 v130, 0xffff0000, v99
    v_and_b32 v123, 0xffff0000, v71
    v_and_b32 v124, 0xffff0000, v75
    buffer_load_dwordx4 v246, s[32:35], s16 offen offset:2048  lds
    v_and_b32 v125, 0xffff0000, v79
    v_and_b32 v126, 0xffff0000, v83
    v_mul_f32 v131, v116, v130
    v_mul_f32 v132, v117, v130
    v_mul_f32 v133, v118, v130
    v_mul_f32 v134, v119, v130
    v_fmac_f32 v131, v117, v129
    v_fmac_f32 v132, v118, v129
    v_fmac_f32 v133, v119, v129
    v_fmac_f32 v134, v120, v129
    v_fmac_f32 v131, v118, v128
    v_fmac_f32 v132, v119, v128
    v_fmac_f32 v133, v120, v128
    v_fmac_f32 v134, v121, v128
    v_fmac_f32 v131, v119, v127
    v_fmac_f32 v132, v120, v127
    v_fmac_f32 v133, v121, v127
    v_fmac_f32 v134, v122, v127
    v_mul_f32 v131, v131, v123
    v_mul_f32 v132, v132, v124
    v_mul_f32 v133, v133, v125
    v_mul_f32 v134, v134, v126
    v_cvt_pk_bf16_f32 v112, v134, v133
    v_cvt_pk_bf16_f32 v113, v132, v131
    s_nop 0
    v_permlane32_swap_b32 v114, v112
    v_permlane32_swap_b32 v115, v113
    s_mov_b32 s89, 49152
    buffer_store_dwordx4 v[112:115], v12, s[52:55], s89 offen sc1
    s_waitcnt vmcnt(13)
    s_barrier
    s_add_u32 s97, s98, s0
    s_lshr_b64 s[0:1], s[0:1], 4
    s_and_b32 s97, s97, 15
    s_lshr_b32 s99, s97, 3
    s_xor_b32 s97, s97, s99
    s_add_u32 m0, s87, 18432
    s_lshl_b32 s97, s97, 7
    buffer_load_dwordx4 v240, s[28:31], s97 offen offset:0  lds
    buffer_load_dwordx4 v241, s[28:31], s97 offen offset:1024  lds
    s_mul_i32 s16, s97, 3072
    s_add_u32 m0, s60, 24576
    s_add_u32 s99, s16, s62
    buffer_load_dwordx4 v244, s[32:35], s99 offen offset:0  lds
    buffer_load_dwordx4 v245, s[32:35], s99 offen offset:1024  lds
    buffer_load_dwordx4 v246, s[32:35], s99 offen offset:2048  lds
    s_add_u32 m0, s87, 18432
    s_nop 0
    buffer_load_dwordx4 v242, s[28:31], s97 offen offset:2048  lds
    buffer_load_dwordx4 v243, s[28:31], s97 offen offset:3072  lds
    s_add_u32 m0, s88, 18432
    s_mov_b64 exec, 0xffffffff
    buffer_load_dwordx4 v3, s[28:31], s97 offen offset:0  lds
    s_mov_b64 exec, -1
    s_add_u32 m0, s61, 36864
    s_add_u32 s16, s16, s63
    buffer_load_dwordx4 v244, s[32:35], s16 offen offset:0  lds
    buffer_load_dwordx4 v245, s[32:35], s16 offen offset:1024  lds
    buffer_load_dwordx4 v246, s[32:35], s16 offen offset:2048  lds
    s_waitcnt vmcnt(12)
    s_barrier
    s_add_u32 s97, s98, s0
    s_lshr_b64 s[0:1], s[0:1], 4
    s_and_b32 s97, s97, 15
    s_lshr_b32 s99, s97, 3
    s_xor_b32 s97, s97, s99
    s_add_u32 m0, s87, 36864
    s_lshl_b32 s97, s97, 7
    buffer_load_dwordx4 v240, s[28:31], s97 offen offset:0  lds
    buffer_load_dwordx4 v241, s[28:31], s97 offen offset:1024  lds
    s_mul_i32 s16, s97, 3072
    s_add_u32 m0, s60, 49152
    s_add_u32 s99, s16, s62
    buffer_load_dwordx4 v244, s[32:35], s99 offen offset:0  lds
    buffer_load_dwordx4 v245, s[32:35], s99 offen offset:1024  lds
    buffer_load_dwordx4 v246, s[32:35], s99 offen offset:2048  lds
    s_add_u32 m0, s87, 36864
    s_nop 0
    buffer_load_dwordx4 v242, s[28:31], s97 offen offset:2048  lds
    buffer_load_dwordx4 v243, s[28:31], s97 offen offset:3072  lds
    s_add_u32 m0, s88, 36864
    s_mov_b64 exec, 0xffffffff
    buffer_load_dwordx4 v3, s[28:31], s97 offen offset:0  lds
    s_mov_b64 exec, -1
    s_add_u32 m0, s61, 61440
    s_add_u32 s16, s16, s63
    buffer_load_dwordx4 v244, s[32:35], s16 offen offset:0  lds
    buffer_load_dwordx4 v245, s[32:35], s16 offen offset:1024  lds
    buffer_load_dwordx4 v246, s[32:35], s16 offen offset:2048  lds
    s_waitcnt vmcnt(11)
    s_barrier
    s_add_u32 m0, s94, 32
    s_lshl_b32 s89, s90, 12
    buffer_load_dwordx4 v15, s[48:51], s89 offen offset:0 nt lds
    s_mov_b32 s68, s24
    s_mov_b32 s69, s25
    s_mov_b32 s70, 0x100
    s_mov_b32 s71, 0x20000
    s_add_u32 m0, s94, 32
    s_lshl_b32 s89, s90, 12
    buffer_load_dwordx4 v15, s[48:51], s89 offen offset:1024 nt lds
    v_lshrrev_b32 v6, 5, v0
    v_and_b32 v7, 3, v0
    s_lshr_b32 s78, s90, 1
    s_add_u32 m0, s94, 32
    s_lshl_b32 s89, s90, 12
    buffer_load_dwordx4 v15, s[48:51], s89 offen offset:2048 nt lds
    s_lshl_b32 s78, s78, 2
    s_load_dword s92, s[14:15], s78
    v_bfe_u32 v5, v0, 2, 2
    v_lshlrev_b32 v5, 1, v5
    s_add_u32 m0, s94, 32
    s_lshl_b32 s89, s90, 12
    buffer_load_dwordx4 v15, s[48:51], s89 offen offset:3072 nt lds
    v_lshl_add_u32 v5, v6, 3, v5
    v_bfe_u32 v8, v0, 4, 1
    v_add_u32 v5, v5, v8
    s_add_u32 s97, s98, s0
    s_lshr_b64 s[0:1], s[0:1], 4
    s_and_b32 s97, s97, 15
    s_lshr_b32 s99, s97, 3
    s_xor_b32 s97, s97, s99
    s_add_u32 m0, s87, 0
    s_lshl_b32 s97, s97, 7
    buffer_load_dwordx4 v240, s[28:31], s97 offen offset:0  lds
    s_and_b32 s78, s3, 1
    s_lshl_b32 s78, s78, 1
    v_add_u32 v8, s78, v6
    v_xor_b32 v8, v8, v7
    buffer_load_dwordx4 v241, s[28:31], s97 offen offset:1024  lds
    v_lshlrev_b32 v8, 4, v8
    v_lshl_add_u32 v5, v5, 6, v8
    v_add_u32 v14, s86, v5
    s_mul_i32 s16, s97, 3072
    s_add_u32 m0, s60, 0
    s_add_u32 s99, s16, s62
    buffer_load_dwordx4 v244, s[32:35], s99 offen offset:0  lds
    v_mov_b32 v18, 162304
    v_mov_b32 v19, 1
    v_and_b32 v5, 3, v0
    s_lshl_b32 s78, s74, 4
    buffer_load_dwordx4 v245, s[32:35], s99 offen offset:1024  lds
    s_add_u32 s78, s78, s3
    v_lshl_add_u32 v6, v5, 2, s78
    s_lshr_b32 s78, s76, 3
    buffer_load_dwordx4 v246, s[32:35], s99 offen offset:2048  lds
    s_lshl_b32 s79, s3, 1
    s_add_u32 s78, s78, s79
    s_xor_b32 s78, s78, 2
    s_lshl_b32 s78, s78, 5
    s_add_u32 m0, s87, 0
    s_nop 0
    buffer_load_dwordx4 v242, s[28:31], s97 offen offset:2048  lds
    s_and_b32 s79, s76, 7
    s_add_u32 s78, s78, s79
    v_lshl_add_u32 v7, v5, 3, s78
    buffer_load_dwordx4 v243, s[28:31], s97 offen offset:3072  lds
    v_and_b32 v8, 4, v0
    v_cmp_eq_u32 vcc, 0, v8
    s_nop 1
    v_cndmask_b32 v6, v7, v6, vcc
    v_and_b32 v33, 0xf0, v6
    s_add_u32 m0, s88, 0
    s_mov_b64 exec, 0xffffffff
    buffer_load_dwordx4 v3, s[28:31], s97 offen offset:0  lds
    s_mov_b64 exec, -1
    v_lshlrev_b32 v34, 8, v6
    v_add_u32 v34, 12582912, v34
    v_and_b32 v5, 15, v0
    s_add_u32 m0, s61, 12288
    s_add_u32 s16, s16, s63
    buffer_load_dwordx4 v244, s[32:35], s16 offen offset:0  lds
    v_lshrrev_b32 v6, 4, v0
    v_add_u32 v7, 9, v5
    v_and_b32 v8, 1, v7
    v_mul_u32_u24 v8, 4160, v8
    buffer_load_dwordx4 v245, s[32:35], s16 offen offset:1024  lds
    v_lshrrev_b32 v7, 1, v7
    v_lshl_add_u32 v8, v7, 2, v8
    v_lshlrev_b32 v7, 4, v6
    buffer_load_dwordx4 v246, s[32:35], s16 offen offset:2048  lds
    v_sub_u32 v8, v8, v7
    s_add_u32 s78, s94, 32
    v_add_u32 v21, s78, v8
    s_waitcnt vmcnt(15)
    s_barrier
    s_add_u32 s97, s98, s0
    s_lshr_b64 s[0:1], s[0:1], 4
    s_and_b32 s97, s97, 15
    s_lshr_b32 s99, s97, 3
    s_xor_b32 s97, s97, s99
    s_add_u32 m0, s87, 18432
    s_lshl_b32 s97, s97, 7
    buffer_load_dwordx4 v240, s[28:31], s97 offen offset:0  lds
    v_add_u32 v22, 1024, v21
    v_add_u32 v23, 2048, v21
    v_add_u32 v24, 3072, v21
    v_lshl_add_u32 v7, v5, 1, v6
    v_add_u32 v7, 30, v7
    buffer_load_dwordx4 v241, s[28:31], s97 offen offset:1024  lds
    v_and_b32 v8, 1, v7
    v_bfe_u32 v136, v7, 1, 2
    v_lshl_add_u32 v136, v8, 2, v136
    v_lshlrev_b32 v136, 6, v136
    v_lshrrev_b32 v7, 3, v7
    s_mul_i32 s16, s97, 3072
    s_add_u32 m0, s60, 24576
    s_add_u32 s99, s16, s62
    buffer_load_dwordx4 v244, s[32:35], s99 offen offset:0  lds
    v_lshl_add_u32 v136, v7, 9, v136
    v_bitop3_b32 v8, v7, 3, s3 bitop3:0x6a
    v_lshl_add_u32 v25, v8, 4, v136
    v_add_u32 v25, 92160, v25
    v_subrev_u32 v7, 1, v7
    buffer_load_dwordx4 v245, s[32:35], s99 offen offset:1024  lds
    v_bitop3_b32 v8, v7, 3, s3 bitop3:0x6a
    v_lshl_add_u32 v27, v8, 4, v136
    v_add_u32 v27, 91648, v27
    v_subrev_u32 v7, 1, v7
    buffer_load_dwordx4 v246, s[32:35], s99 offen offset:2048  lds
    v_bitop3_b32 v8, v7, 3, s3 bitop3:0x6a
    v_lshl_add_u32 v29, v8, 4, v136
    v_add_u32 v29, 91136, v29
    v_subrev_u32 v7, 1, v7
    v_bitop3_b32 v8, v7, 3, s3 bitop3:0x6a
    s_add_u32 m0, s87, 18432
    s_nop 0
    buffer_load_dwordx4 v242, s[28:31], s97 offen offset:2048  lds
    v_lshl_add_u32 v31, v8, 4, v136
    v_add_u32 v31, 90624, v31
    v_lshl_add_u32 v7, v5, 1, v6
    v_add_u32 v7, 26, v7
    v_and_b32 v8, 1, v7
    buffer_load_dwordx4 v243, s[28:31], s97 offen offset:3072  lds
    v_bfe_u32 v136, v7, 1, 2
    v_lshl_add_u32 v136, v8, 2, v136
    v_lshlrev_b32 v136, 6, v136
    v_lshrrev_b32 v7, 3, v7
    v_lshl_add_u32 v136, v7, 9, v136
    s_add_u32 m0, s88, 18432
    s_mov_b64 exec, 0xffffffff
    buffer_load_dwordx4 v3, s[28:31], s97 offen offset:0  lds
    s_mov_b64 exec, -1
    v_bitop3_b32 v8, v7, 3, s3 bitop3:0x6a
    v_lshl_add_u32 v26, v8, 4, v136
    v_add_u32 v26, 92160, v26
    v_subrev_u32 v7, 1, v7
    s_add_u32 m0, s61, 36864
    s_add_u32 s16, s16, s63
    buffer_load_dwordx4 v244, s[32:35], s16 offen offset:0  lds
    v_bitop3_b32 v8, v7, 3, s3 bitop3:0x6a
    v_lshl_add_u32 v28, v8, 4, v136
    v_add_u32 v28, 91648, v28
    v_subrev_u32 v7, 1, v7
    v_bitop3_b32 v8, v7, 3, s3 bitop3:0x6a
    buffer_load_dwordx4 v245, s[32:35], s16 offen offset:1024  lds
    v_lshl_add_u32 v30, v8, 4, v136
    v_add_u32 v30, 91136, v30
    v_subrev_u32 v7, 1, v7
    v_bitop3_b32 v8, v7, 3, s3 bitop3:0x6a
    v_lshl_add_u32 v32, v8, 4, v136
    buffer_load_dwordx4 v246, s[32:35], s16 offen offset:2048  lds
    v_add_u32 v32, 90624, v32
    v_lshrrev_b32 v7, 1, v6
    v_lshl_add_u32 v7, v5, 1, v7
    v_add_u32 v7, 32, v7
    s_waitcnt vmcnt(11)
    s_barrier
    s_add_u32 s97, s98, s0
    s_lshr_b64 s[0:1], s[0:1], 4
    s_and_b32 s97, s97, 15
    s_lshr_b32 s99, s97, 3
    s_xor_b32 s97, s97, s99
    s_add_u32 m0, s87, 36864
    s_lshl_b32 s97, s97, 7
    buffer_load_dwordx4 v240, s[28:31], s97 offen offset:0  lds
    v_and_b32 v8, 1, v7
    v_bfe_u32 v136, v7, 1, 2
    v_lshl_add_u32 v136, v8, 2, v136
    v_lshlrev_b32 v136, 6, v136
    buffer_load_dwordx4 v241, s[28:31], s97 offen offset:1024  lds
    v_lshrrev_b32 v7, 3, v7
    v_lshl_add_u32 v136, v7, 9, v136
    v_bitop3_b32 v8, v7, 3, s3 bitop3:0x6a
    v_lshl_add_u32 v20, v8, 4, v136
    s_mul_i32 s16, s97, 3072
    s_add_u32 m0, s60, 49152
    s_add_u32 s99, s16, s62
    buffer_load_dwordx4 v244, s[32:35], s99 offen offset:0  lds
    v_add_u32 v20, 92160, v20
    v_and_b32 v8, 1, v6
    v_xor_b32 v8, 1, v8
    v_lshl_add_u32 v20, v8, 3, v20
    buffer_load_dwordx4 v245, s[32:35], s99 offen offset:1024  lds
    s_waitcnt lgkmcnt(0)
    s_and_b32 s78, s92, 0xffff0000
    s_lshl_b32 s92, s92, 16
    s_bitcmp1_b32 s90, 0
    s_cselect_b32 s92, s78, s92
    buffer_load_dwordx4 v246, s[32:35], s99 offen offset:2048  lds
    v_lshlrev_b32 v7, 3, v6
    v_sub_u32 v7, v7, v5
    v_subrev_u32 v7, 9, v7
    v_and_b32 v8, 1, v7
    s_add_u32 m0, s87, 36864
    s_nop 0
    buffer_load_dwordx4 v242, s[28:31], s97 offen offset:2048  lds
    v_xor_b32 v8, 1, v8
    v_lshlrev_b32 v8, 4, v8
    v_lshrrev_b32 v8, v8, s92
    v_ashrrev_i32 v7, 1, v7
    buffer_load_dwordx4 v243, s[28:31], s97 offen offset:3072  lds
    v_cmp_eq_u32 vcc, 0, v7
    s_nop 1
    v_cndmask_b32 v236, 0, v8, vcc
    v_cmp_eq_u32 vcc, 1, v7
    s_nop 1
    v_cndmask_b32 v237, 0, v8, vcc
    s_add_u32 m0, s88, 36864
    s_mov_b64 exec, 0xffffffff
    buffer_load_dwordx4 v3, s[28:31], s97 offen offset:0  lds
    s_mov_b64 exec, -1
    v_cmp_eq_u32 vcc, 2, v7
    s_nop 1
    v_cndmask_b32 v238, 0, v8, vcc
    v_cmp_eq_u32 vcc, 3, v7
    s_nop 1
    v_cndmask_b32 v239, 0, v8, vcc
    s_add_u32 m0, s61, 61440
    s_add_u32 s16, s16, s63
    buffer_load_dwordx4 v244, s[32:35], s16 offen offset:0  lds
    s_and_b32 s78, s77, 7
    s_mov_b32 s95, 0x76543210
    s_cmp_eq_u32 s78, 1
    s_cselect_b32 s95, 0x76543201, s95
    s_cmp_eq_u32 s78, 2
    s_cselect_b32 s95, 0x76543120, s95
    s_cmp_eq_u32 s78, 3
    s_cselect_b32 s95, 0x76542310, s95
    s_cmp_eq_u32 s78, 4
    s_cselect_b32 s95, 0x76534210, s95
    s_cmp_eq_u32 s78, 5
    s_cselect_b32 s95, 0x76453210, s95
    s_cmp_eq_u32 s78, 6
    s_cselect_b32 s95, 0x75643210, s95
    s_cmp_eq_u32 s78, 7
    s_cselect_b32 s95, 0x67543210, s95
    s_and_b32 s78, s76, 3
    s_mul_i32 s78, s78, 0x22222222
    s_add_u32 s95, s95, s78
    s_bfe_u32 s100, s95, 0x3001c
    s_lshl_b32 s100, s100, 18
    s_bfe_u32 s95, s95, 0x30018
    s_lshl_b32 s95, s95, 18
    v_lshrrev_b32 v136, 4, v0
    v_lshlrev_b32 v136, 1, v136
    v_and_b32 v137, 7, v0
    buffer_load_dwordx4 v245, s[32:35], s16 offen offset:1024  lds
    v_xor_b32 v136, v136, v137
    v_lshlrev_b32 v136, 4, v136
    v_lshrrev_b32 v137, 3, v0
    v_lshl_add_u32 v136, v137, 11, v136
    buffer_load_dwordx4 v246, s[32:35], s16 offen offset:2048  lds
    s_lshl_b32 s78, s77, 7
    s_lshl_b32 s79, s3, 14
    s_add_u32 s78, s78, s79
    v_add_u32 v17, s78, v136
    s_waitcnt vmcnt(11)
    s_barrier
    s_add_u32 s97, s98, s0
    s_lshr_b64 s[0:1], s[0:1], 4
    s_and_b32 s97, s97, 15
    s_lshr_b32 s99, s97, 3
    s_xor_b32 s97, s97, s99
    s_add_u32 m0, s87, 0
    s_lshl_b32 s97, s97, 7
    buffer_load_dwordx4 v240, s[28:31], s97 offen offset:0  lds
    v_add_u32 v5, s94, v15
    ds_read_b128 v[140:143], v5 offset:32
    ds_read_b32 v156, v5 offset:48
    ds_read_b128 v[144:147], v5 offset:1056
    buffer_load_dwordx4 v241, s[28:31], s97 offen offset:1024  lds
    ds_read_b32 v157, v5 offset:1072
    ds_read_b128 v[148:151], v5 offset:2080
    ds_read_b32 v158, v5 offset:2096
    s_mul_i32 s16, s97, 3072
    s_add_u32 m0, s60, 0
    s_add_u32 s99, s16, s62
    buffer_load_dwordx4 v244, s[32:35], s99 offen offset:0  lds
    ds_read_b128 v[152:155], v5 offset:3104
    ds_read_b32 v159, v5 offset:3120
    v_lshrrev_b32 v6, 3, v0
    buffer_load_dwordx4 v245, s[32:35], s99 offen offset:1024  lds
    v_mul_u32_u24 v6, 4160, v6
    v_and_b32 v7, 7, v0
    v_lshl_add_u32 v6, v7, 2, v6
    v_add_u32 v6, s94, v6
    buffer_load_dwordx4 v246, s[32:35], s99 offen offset:2048  lds
    v_mov_b32 v7, 0
    s_waitcnt lgkmcnt(0)
    v_readfirstlane_b32 s93, v140
    s_add_u32 m0, s87, 0
    s_nop 0
    buffer_load_dwordx4 v242, s[28:31], s97 offen offset:2048  lds
    s_lshl_b32 s93, s93, 16
    v_writelane_b32 v7, s93, 15
    v_alignbit_b32 v140, v141, v140, 16
    buffer_load_dwordx4 v243, s[28:31], s97 offen offset:3072  lds
    v_alignbit_b32 v141, v142, v141, 16
    v_alignbit_b32 v142, v143, v142, 16
    v_alignbit_b32 v143, v156, v143, 16
    v_alignbit_b32 v144, v145, v144, 16
    s_add_u32 m0, s88, 0
    s_mov_b64 exec, 0xffffffff
    buffer_load_dwordx4 v3, s[28:31], s97 offen offset:0  lds
    s_mov_b64 exec, -1
    v_alignbit_b32 v145, v146, v145, 16
    v_alignbit_b32 v146, v147, v146, 16
    v_alignbit_b32 v147, v157, v147, 16
    s_add_u32 m0, s61, 12288
    s_add_u32 s16, s16, s63
    buffer_load_dwordx4 v244, s[32:35], s16 offen offset:0  lds
    v_alignbit_b32 v148, v149, v148, 16
    v_alignbit_b32 v149, v150, v149, 16
    v_alignbit_b32 v150, v151, v150, 16
    buffer_load_dwordx4 v245, s[32:35], s16 offen offset:1024  lds
    v_alignbit_b32 v151, v158, v151, 16
    v_alignbit_b32 v152, v153, v152, 16
    v_alignbit_b32 v153, v154, v153, 16
    v_alignbit_b32 v154, v155, v154, 16
    buffer_load_dwordx4 v246, s[32:35], s16 offen offset:2048  lds
    v_alignbit_b32 v155, v159, v155, 16
    v_lshlrev_b32 v8, 3, v0
    s_add_u32 s78, s88, 18432
    s_mov_b64 exec, 0xff
    buffer_load_dword v136, v33, s[68:71], 0 offen sc1
    buffer_load_dword v137, v34, s[52:55], 0 offen sc1
    s_mov_b64 exec, -1
    v_add_u32 v8, s78, v8
    v_mov_b32 v156, 0
    v_mov_b32 v157, 0
    s_waitcnt vmcnt(13)
    s_barrier
    s_waitcnt vmcnt(0)
    s_branch LA_j
LA_c1:
    s_waitcnt vmcnt(7)
    s_barrier
    s_add_u32 m0, s88, 18432
    s_mov_b64 exec, 0xffffffff
    buffer_load_dwordx4 v3, s[28:31], s97 offen offset:0  lds
    s_mov_b64 exec, -1
    s_add_u32 m0, s61, 36864
    s_add_u32 s16, s16, s63
    buffer_load_dwordx4 v244, s[32:35], s16 offen offset:0  lds
    buffer_load_dwordx4 v245, s[32:35], s16 offen offset:1024  lds
    buffer_load_dwordx4 v246, s[32:35], s16 offen offset:2048  lds
    s_add_u32 s97, s98, s0
    s_lshr_b64 s[0:1], s[0:1], 4
    s_and_b32 s97, s97, 15
    s_lshr_b32 s99, s97, 3
    s_xor_b32 s97, s97, s99
    s_add_u32 m0, s87, 36864
    s_lshl_b32 s97, s97, 7
    buffer_load_dwordx4 v240, s[28:31], s97 offen offset:0  lds
    buffer_load_dwordx4 v241, s[28:31], s97 offen offset:1024  lds
    s_mul_i32 s16, s97, 3072
    s_add_u32 m0, s60, 49152
    s_add_u32 s99, s16, s62
    buffer_load_dwordx4 v244, s[32:35], s99 offen offset:0  lds
    buffer_load_dwordx4 v245, s[32:35], s99 offen offset:1024  lds
    buffer_load_dwordx4 v246, s[32:35], s99 offen offset:2048  lds
    s_add_u32 m0, s87, 36864
    s_nop 0
    buffer_load_dwordx4 v242, s[28:31], s97 offen offset:2048  lds
    buffer_load_dwordx4 v243, s[28:31], s97 offen offset:3072  lds
    s_add_u32 m0, s88, 36864
    s_mov_b64 exec, 0xffffffff
    buffer_load_dwordx4 v3, s[28:31], s97 offen offset:0  lds
    s_mov_b64 exec, -1
    s_add_u32 m0, s61, 61440
    s_add_u32 s16, s16, s63
    buffer_load_dwordx4 v244, s[32:35], s16 offen offset:0  lds
    buffer_load_dwordx4 v245, s[32:35], s16 offen offset:1024  lds
    buffer_load_dwordx4 v246, s[32:35], s16 offen offset:2048  lds
    s_waitcnt vmcnt(11)
    s_barrier
    s_add_u32 s97, s98, s0
    s_lshr_b64 s[0:1], s[0:1], 4
    s_and_b32 s97, s97, 15
    s_lshr_b32 s99, s97, 3
    s_xor_b32 s97, s97, s99
    s_add_u32 m0, s87, 0
    s_lshl_b32 s97, s97, 7
    buffer_load_dwordx4 v240, s[28:31], s97 offen offset:0  lds
    buffer_load_dwordx4 v241, s[28:31], s97 offen offset:1024  lds
    s_mul_i32 s16, s97, 3072
    s_add_u32 m0, s60, 0
    s_add_u32 s99, s16, s62
    buffer_load_dwordx4 v244, s[32:35], s99 offen offset:0  lds
    buffer_load_dwordx4 v245, s[32:35], s99 offen offset:1024  lds
    buffer_load_dwordx4 v246, s[32:35], s99 offen offset:2048  lds
    s_add_u32 m0, s87, 0
    s_nop 0
    buffer_load_dwordx4 v242, s[28:31], s97 offen offset:2048  lds
    buffer_load_dwordx4 v243, s[28:31], s97 offen offset:3072  lds
    s_add_u32 m0, s88, 0
    s_mov_b64 exec, 0xffffffff
    buffer_load_dwordx4 v3, s[28:31], s97 offen offset:0  lds
    s_mov_b64 exec, -1
    s_add_u32 m0, s61, 12288
    s_add_u32 s16, s16, s63
    buffer_load_dwordx4 v244, s[32:35], s16 offen offset:0  lds
    buffer_load_dwordx4 v245, s[32:35], s16 offen offset:1024  lds
    buffer_load_dwordx4 v246, s[32:35], s16 offen offset:2048  lds
    s_waitcnt vmcnt(11)
    s_barrier
    s_add_u32 m0, s86, 129536
    s_mov_b32 s89, 0
    buffer_load_dwordx4 v10, s[36:39], s89 offen nt lds
    s_add_u32 m0, s86, 145920
    s_mov_b32 s89, 0
    buffer_load_dwordx4 v10, s[40:43], s89 offen nt lds
    s_add_u32 m0, s86, 133632
    s_mov_b32 s89, 65536
    buffer_load_dwordx4 v10, s[36:39], s89 offen nt lds
    s_add_u32 m0, s86, 150016
    s_mov_b32 s89, 65536
    buffer_load_dwordx4 v10, s[40:43], s89 offen nt lds
    s_add_u32 m0, s86, 137728
    s_mov_b32 s89, 131072
    buffer_load_dwordx4 v10, s[36:39], s89 offen nt lds
    s_add_u32 m0, s86, 154112
    s_mov_b32 s89, 131072
    buffer_load_dwordx4 v10, s[40:43], s89 offen nt lds
    s_add_u32 m0, s86, 141824
    s_mov_b32 s89, 196608
    buffer_load_dwordx4 v10, s[36:39], s89 offen nt lds
    s_add_u32 m0, s86, 158208
    s_mov_b32 s89, 196608
    buffer_load_dwordx4 v10, s[40:43], s89 offen nt lds
    s_mov_b64 exec, 0xff
    s_lshl_b32 s82, s3, 7
    s_add_u32 m0, s82, 129024
    s_mov_b32 s89, 0
    buffer_load_dwordx4 v11, s[36:39], s89 offen nt lds
    s_lshl_b32 s83, s74, 9
    s_add_u32 s83, s83, s82
    s_and_b32 s89, s3, 2
    s_lshl_b32 s89, s89, 3
    s_add_u32 s82, s82, s89
    s_add_u32 m0, s82, 162816
    s_add_u32 s89, s83, 0
    buffer_load_dwordx4 v15, s[44:47], s89 offen  lds
    s_mov_b64 exec, -1
    s_add_u32 s97, s98, s0
    s_lshr_b64 s[0:1], s[0:1], 4
    s_and_b32 s97, s97, 15
    s_lshr_b32 s99, s97, 3
    s_xor_b32 s97, s97, s99
    s_add_u32 m0, s87, 18432
    s_lshl_b32 s97, s97, 7
    buffer_load_dwordx4 v240, s[28:31], s97 offen offset:0  lds
    buffer_load_dwordx4 v241, s[28:31], s97 offen offset:1024  lds
    s_mul_i32 s16, s97, 3072
    s_add_u32 m0, s60, 24576
    s_add_u32 s99, s16, s62
    buffer_load_dwordx4 v244, s[32:35], s99 offen offset:0  lds
    buffer_load_dwordx4 v245, s[32:35], s99 offen offset:1024  lds
    buffer_load_dwordx4 v246, s[32:35], s99 offen offset:2048  lds
    s_add_u32 m0, s87, 18432
    s_nop 0
    buffer_load_dwordx4 v242, s[28:31], s97 offen offset:2048  lds
    buffer_load_dwordx4 v243, s[28:31], s97 offen offset:3072  lds
    s_waitcnt vmcnt(17)
    s_barrier
    s_add_u32 m0, s88, 18432
    s_mov_b64 exec, 0xffffffff
    buffer_load_dwordx4 v3, s[28:31], s97 offen offset:0  lds
    s_mov_b64 exec, -1
    s_add_u32 m0, s61, 36864
    s_add_u32 s16, s16, s63
    buffer_load_dwordx4 v244, s[32:35], s16 offen offset:0  lds
    buffer_load_dwordx4 v245, s[32:35], s16 offen offset:1024  lds
    buffer_load_dwordx4 v246, s[32:35], s16 offen offset:2048  lds
    s_add_u32 s97, s98, s0
    s_lshr_b64 s[0:1], s[0:1], 4
    s_and_b32 s97, s97, 15
    s_lshr_b32 s99, s97, 3
    s_xor_b32 s97, s97, s99
    s_add_u32 m0, s87, 36864
    s_lshl_b32 s97, s97, 7
    buffer_load_dwordx4 v240, s[28:31], s97 offen offset:0  lds
    buffer_load_dwordx4 v241, s[28:31], s97 offen offset:1024  lds
    s_mul_i32 s16, s97, 3072
    s_add_u32 m0, s60, 49152
    s_add_u32 s99, s16, s62
    buffer_load_dwordx4 v244, s[32:35], s99 offen offset:0  lds
    buffer_load_dwordx4 v245, s[32:35], s99 offen offset:1024  lds
    buffer_load_dwordx4 v246, s[32:35], s99 offen offset:2048  lds
    s_add_u32 m0, s87, 36864
    s_nop 0
    buffer_load_dwordx4 v242, s[28:31], s97 offen offset:2048  lds
    buffer_load_dwordx4 v243, s[28:31], s97 offen offset:3072  lds
    s_add_u32 m0, s88, 36864
    s_mov_b64 exec, 0xffffffff
    buffer_load_dwordx4 v3, s[28:31], s97 offen offset:0  lds
    s_mov_b64 exec, -1
    s_add_u32 m0, s61, 61440
    s_add_u32 s16, s16, s63
    buffer_load_dwordx4 v244, s[32:35], s16 offen offset:0  lds
    buffer_load_dwordx4 v245, s[32:35], s16 offen offset:1024  lds
    buffer_load_dwordx4 v246, s[32:35], s16 offen offset:2048  lds
    s_waitcnt vmcnt(11)
    s_barrier
    s_add_u32 s97, s98, s0
    s_lshr_b64 s[0:1], s[0:1], 4
    s_and_b32 s97, s97, 15
    s_lshr_b32 s99, s97, 3
    s_xor_b32 s97, s97, s99
    s_add_u32 m0, s87, 0
    s_lshl_b32 s97, s97, 7
    buffer_load_dwordx4 v240, s[28:31], s97 offen offset:0  lds
    ds_read_b128 v[84:87], v35 offset:0
    ds_read_b128 v[88:91], v35 offset:16
    buffer_load_dwordx4 v241, s[28:31], s97 offen offset:1024  lds
    ds_read_b128 v[92:95], v35 offset:32
    s_mul_i32 s16, s97, 3072
    s_add_u32 m0, s60, 0
    s_add_u32 s99, s16, s62
    buffer_load_dwordx4 v244, s[32:35], s99 offen offset:0  lds
    ds_read_b128 v[96:99], v35 offset:48
    ds_read_b128 v[40:43], v233 offset:0
    buffer_load_dwordx4 v245, s[32:35], s99 offen offset:1024  lds
    ds_read_b128 v[44:47], v232 offset:256
    buffer_load_dwordx4 v246, s[32:35], s99 offen offset:2048  lds
    ds_read_b128 v[48:51], v233 offset:256
    s_add_u32 m0, s87, 0
    s_nop 0
    buffer_load_dwordx4 v242, s[28:31], s97 offen offset:2048  lds
    ds_read_b128 v[52:55], v16 offset:512
    ds_read_b128 v[56:59], v231 offset:512
    buffer_load_dwordx4 v243, s[28:31], s97 offen offset:3072  lds
    ds_read_b128 v[60:63], v16 offset:768
    s_add_u32 m0, s88, 0
    s_mov_b64 exec, 0xffffffff
    buffer_load_dwordx4 v3, s[28:31], s97 offen offset:0  lds
    s_mov_b64 exec, -1
    ds_read_b128 v[64:67], v231 offset:768
    s_add_u32 m0, s61, 12288
    s_add_u32 s16, s16, s63
    buffer_load_dwordx4 v244, s[32:35], s16 offen offset:0  lds
    ds_read_b128 v[68:71], v16 offset:16896
    ds_read_b128 v[72:75], v231 offset:16896
    buffer_load_dwordx4 v245, s[32:35], s16 offen offset:1024  lds
    ds_read_b128 v[76:79], v16 offset:17152
    buffer_load_dwordx4 v246, s[32:35], s16 offen offset:2048  lds
    ds_read_b128 v[80:83], v231 offset:17152
    s_waitcnt vmcnt(11)
    s_waitcnt lgkmcnt(0)
    s_barrier
    s_add_u32 s97, s98, s0
    s_lshr_b64 s[0:1], s[0:1], 4
    s_and_b32 s97, s97, 15
    s_lshr_b32 s99, s97, 3
    s_xor_b32 s97, s97, s99
    s_add_u32 m0, s87, 18432
    s_lshl_b32 s97, s97, 7
    buffer_load_dwordx4 v240, s[28:31], s97 offen offset:0  lds
    v_lshlrev_b32 v116, 16, v40
    v_lshlrev_b32 v117, 16, v44
    v_lshlrev_b32 v118, 16, v48
    v_lshlrev_b32 v119, 16, v52
    v_lshlrev_b32 v120, 16, v56
    buffer_load_dwordx4 v241, s[28:31], s97 offen offset:1024  lds
    v_lshlrev_b32 v121, 16, v60
    v_lshlrev_b32 v122, 16, v64
    v_lshlrev_b32 v127, 16, v84
    v_and_b32 v128, 0xffff0000, v84
    v_lshlrev_b32 v129, 16, v85
    s_mul_i32 s16, s97, 3072
    s_add_u32 m0, s60, 24576
    s_add_u32 s99, s16, s62
    buffer_load_dwordx4 v244, s[32:35], s99 offen offset:0  lds
    v_and_b32 v130, 0xffff0000, v85
    v_lshlrev_b32 v123, 16, v68
    v_lshlrev_b32 v124, 16, v72
    v_lshlrev_b32 v125, 16, v76
    v_lshlrev_b32 v126, 16, v80
    buffer_load_dwordx4 v245, s[32:35], s99 offen offset:1024  lds
    v_mul_f32 v131, v116, v130
    v_mul_f32 v132, v117, v130
    v_mul_f32 v133, v118, v130
    v_mul_f32 v134, v119, v130
    v_fmac_f32 v131, v117, v129
    buffer_load_dwordx4 v246, s[32:35], s99 offen offset:2048  lds
    v_fmac_f32 v132, v118, v129
    v_fmac_f32 v133, v119, v129
    v_fmac_f32 v134, v120, v129
    v_fmac_f32 v131, v118, v128
    v_fmac_f32 v132, v119, v128
    s_add_u32 m0, s87, 18432
    s_nop 0
    buffer_load_dwordx4 v242, s[28:31], s97 offen offset:2048  lds
    v_fmac_f32 v133, v120, v128
    v_fmac_f32 v134, v121, v128
    v_fmac_f32 v131, v119, v127
    v_fmac_f32 v132, v120, v127
    v_fmac_f32 v133, v121, v127
    buffer_load_dwordx4 v243, s[28:31], s97 offen offset:3072  lds
    v_fmac_f32 v134, v122, v127
    v_mul_f32 v131, v131, v123
    v_mul_f32 v132, v132, v124
    v_mul_f32 v133, v133, v125
    v_mul_f32 v134, v134, v126
    s_add_u32 m0, s88, 18432
    s_mov_b64 exec, 0xffffffff
    buffer_load_dwordx4 v3, s[28:31], s97 offen offset:0  lds
    s_mov_b64 exec, -1
    v_cvt_pk_bf16_f32 v102, v134, v133
    v_cvt_pk_bf16_f32 v103, v132, v131
    v_lshlrev_b32 v116, 16, v42
    v_lshlrev_b32 v117, 16, v46
    v_lshlrev_b32 v118, 16, v50
    s_add_u32 m0, s61, 36864
    s_add_u32 s16, s16, s63
    buffer_load_dwordx4 v244, s[32:35], s16 offen offset:0  lds
    v_lshlrev_b32 v119, 16, v54
    v_lshlrev_b32 v120, 16, v58
    v_lshlrev_b32 v121, 16, v62
    v_lshlrev_b32 v122, 16, v66
    v_lshlrev_b32 v127, 16, v92
    buffer_load_dwordx4 v245, s[32:35], s16 offen offset:1024  lds
    v_and_b32 v128, 0xffff0000, v92
    v_lshlrev_b32 v129, 16, v93
    v_and_b32 v130, 0xffff0000, v93
    v_lshlrev_b32 v123, 16, v70
    v_lshlrev_b32 v124, 16, v74
    buffer_load_dwordx4 v246, s[32:35], s16 offen offset:2048  lds
    v_lshlrev_b32 v125, 16, v78
    v_lshlrev_b32 v126, 16, v82
    v_mul_f32 v131, v116, v130
    v_mul_f32 v132, v117, v130
    v_mul_f32 v133, v118, v130
    v_mul_f32 v134, v119, v130
    v_fmac_f32 v131, v117, v129
    v_fmac_f32 v132, v118, v129
    v_fmac_f32 v133, v119, v129
    v_fmac_f32 v134, v120, v129
    v_fmac_f32 v131, v118, v128
    v_fmac_f32 v132, v119, v128
    v_fmac_f32 v133, v120, v128
    v_fmac_f32 v134, v121, v128
    v_fmac_f32 v131, v119, v127
    v_fmac_f32 v132, v120, v127
    v_fmac_f32 v133, v121, v127
    v_fmac_f32 v134, v122, v127
    v_mul_f32 v131, v131, v123
    v_mul_f32 v132, v132, v124
    v_mul_f32 v133, v133, v125
    v_mul_f32 v134, v134, v126
    v_cvt_pk_bf16_f32 v100, v134, v133
    v_cvt_pk_bf16_f32 v101, v132, v131
    s_nop 0
    v_permlane32_swap_b32 v102, v100
    v_permlane32_swap_b32 v103, v101
    s_mov_b32 s89, 0
    buffer_store_dwordx4 v[100:103], v12, s[52:55], s89 offen sc1
    s_waitcnt vmcnt(12)
    s_barrier
    buffer_load_dword v230, v229, s[4:7], 0 offen
    v_and_b32 v116, 0xffff0000, v40
    v_and_b32 v117, 0xffff0000, v44
    v_and_b32 v118, 0xffff0000, v48
    v_and_b32 v119, 0xffff0000, v52
    v_and_b32 v120, 0xffff0000, v56
    buffer_load_dword v230, v228, s[32:35], 0 offen
    v_and_b32 v121, 0xffff0000, v60
    v_and_b32 v122, 0xffff0000, v64
    v_lshlrev_b32 v127, 16, v86
    v_and_b32 v128, 0xffff0000, v86
    v_lshlrev_b32 v129, 16, v87
    s_add_u32 s97, s98, s0
    s_lshr_b64 s[0:1], s[0:1], 4
    s_and_b32 s97, s97, 15
    s_lshr_b32 s99, s97, 3
    s_xor_b32 s97, s97, s99
    s_add_u32 m0, s87, 36864
    s_lshl_b32 s97, s97, 7
    buffer_load_dwordx4 v240, s[28:31], s97 offen offset:0  lds
    v_and_b32 v130, 0xffff0000, v87
    v_and_b32 v123, 0xffff0000, v68
    v_and_b32 v124, 0xffff0000, v72
    v_and_b32 v125, 0xffff0000, v76
    v_and_b32 v126, 0xffff0000, v80
    buffer_load_dwordx4 v241, s[28:31], s97 offen offset:1024  lds
    v_mul_f32 v131, v116, v130
    v_mul_f32 v132, v117, v130
    v_mul_f32 v133, v118, v130
    v_mul_f32 v134, v119, v130
    v_fmac_f32 v131, v117, v129
    s_mul_i32 s16, s97, 3072
    s_add_u32 m0, s60, 49152
    s_add_u32 s99, s16, s62
    buffer_load_dwordx4 v244, s[32:35], s99 offen offset:0  lds
    v_fmac_f32 v132, v118, v129
    v_fmac_f32 v133, v119, v129
    v_fmac_f32 v134, v120, v129
    v_fmac_f32 v131, v118, v128
    v_fmac_f32 v132, v119, v128
    buffer_load_dwordx4 v245, s[32:35], s99 offen offset:1024  lds
    v_fmac_f32 v133, v120, v128
    v_fmac_f32 v134, v121, v128
    v_fmac_f32 v131, v119, v127
    v_fmac_f32 v132, v120, v127
    v_fmac_f32 v133, v121, v127
    buffer_load_dwordx4 v246, s[32:35], s99 offen offset:2048  lds
    v_fmac_f32 v134, v122, v127
    v_mul_f32 v131, v131, v123
    v_mul_f32 v132, v132, v124
    v_mul_f32 v133, v133, v125
    v_mul_f32 v134, v134, v126
    s_add_u32 m0, s87, 36864
    s_nop 0
    buffer_load_dwordx4 v242, s[28:31], s97 offen offset:2048  lds
    v_cvt_pk_bf16_f32 v106, v134, v133
    v_cvt_pk_bf16_f32 v107, v132, v131
    v_and_b32 v116, 0xffff0000, v42
    v_and_b32 v117, 0xffff0000, v46
    v_and_b32 v118, 0xffff0000, v50
    buffer_load_dwordx4 v243, s[28:31], s97 offen offset:3072  lds
    v_and_b32 v119, 0xffff0000, v54
    v_and_b32 v120, 0xffff0000, v58
    v_and_b32 v121, 0xffff0000, v62
    v_and_b32 v122, 0xffff0000, v66
    v_lshlrev_b32 v127, 16, v94
    s_add_u32 m0, s88, 36864
    s_mov_b64 exec, 0xffffffff
    buffer_load_dwordx4 v3, s[28:31], s97 offen offset:0  lds
    s_mov_b64 exec, -1
    v_and_b32 v128, 0xffff0000, v94
    v_lshlrev_b32 v129, 16, v95
    v_and_b32 v130, 0xffff0000, v95
    v_and_b32 v123, 0xffff0000, v70
    v_and_b32 v124, 0xffff0000, v74
    s_add_u32 m0, s61, 61440
    s_add_u32 s16, s16, s63
    buffer_load_dwordx4 v244, s[32:35], s16 offen offset:0  lds
    v_and_b32 v125, 0xffff0000, v78
    v_and_b32 v126, 0xffff0000, v82
    v_mul_f32 v131, v116, v130
    v_mul_f32 v132, v117, v130
    v_mul_f32 v133, v118, v130
    buffer_load_dwordx4 v245, s[32:35], s16 offen offset:1024  lds
    v_mul_f32 v134, v119, v130
    v_fmac_f32 v131, v117, v129
    v_fmac_f32 v132, v118, v129
    v_fmac_f32 v133, v119, v129
    v_fmac_f32 v134, v120, v129
    buffer_load_dwordx4 v246, s[32:35], s16 offen offset:2048  lds
    v_fmac_f32 v131, v118, v128
    v_fmac_f32 v132, v119, v128
    v_fmac_f32 v133, v120, v128
    v_fmac_f32 v134, v121, v128
    v_fmac_f32 v131, v119, v127
    v_fmac_f32 v132, v120, v127
    v_fmac_f32 v133, v121, v127
    v_fmac_f32 v134, v122, v127
    v_mul_f32 v131, v131, v123
    v_mul_f32 v132, v132, v124
    v_mul_f32 v133, v133, v125
    v_mul_f32 v134, v134, v126
    v_cvt_pk_bf16_f32 v104, v134, v133
    v_cvt_pk_bf16_f32 v105, v132, v131
    s_nop 0
    v_permlane32_swap_b32 v106, v104
    v_permlane32_swap_b32 v107, v105
    s_mov_b32 s89, 16384
    buffer_store_dwordx4 v[104:107], v12, s[52:55], s89 offen sc1
    s_waitcnt vmcnt(15)
    s_barrier
    s_add_u32 s97, s98, s0
    s_lshr_b64 s[0:1], s[0:1], 4
    s_and_b32 s97, s97, 15
    s_lshr_b32 s99, s97, 3
    s_xor_b32 s97, s97, s99
    s_add_u32 m0, s87, 0
    s_lshl_b32 s97, s97, 7
    buffer_load_dwordx4 v240, s[28:31], s97 offen offset:0  lds
    v_lshlrev_b32 v116, 16, v41
    v_lshlrev_b32 v117, 16, v45
    v_lshlrev_b32 v118, 16, v49
    v_lshlrev_b32 v119, 16, v53
    v_lshlrev_b32 v120, 16, v57
    buffer_load_dwordx4 v241, s[28:31], s97 offen offset:1024  lds
    v_lshlrev_b32 v121, 16, v61
    v_lshlrev_b32 v122, 16, v65
    v_lshlrev_b32 v127, 16, v88
    v_and_b32 v128, 0xffff0000, v88
    v_lshlrev_b32 v129, 16, v89
    s_mul_i32 s16, s97, 3072
    s_add_u32 m0, s60, 0
    s_add_u32 s99, s16, s62
    buffer_load_dwordx4 v244, s[32:35], s99 offen offset:0  lds
    v_and_b32 v130, 0xffff0000, v89
    v_lshlrev_b32 v123, 16, v69
    v_lshlrev_b32 v124, 16, v73
    v_lshlrev_b32 v125, 16, v77
    v_lshlrev_b32 v126, 16, v81
    buffer_load_dwordx4 v245, s[32:35], s99 offen offset:1024  lds
    v_mul_f32 v131, v116, v130
    v_mul_f32 v132, v117, v130
    v_mul_f32 v133, v118, v130
    v_mul_f32 v134, v119, v130
    v_fmac_f32 v131, v117, v129
    buffer_load_dwordx4 v246, s[32:35], s99 offen offset:2048  lds
    v_fmac_f32 v132, v118, v129
    v_fmac_f32 v133, v119, v129
    v_fmac_f32 v134, v120, v129
    v_fmac_f32 v131, v118, v128
    v_fmac_f32 v132, v119, v128
    s_add_u32 m0, s87, 0
    s_nop 0
    buffer_load_dwordx4 v242, s[28:31], s97 offen offset:2048  lds
    v_fmac_f32 v133, v120, v128
    v_fmac_f32 v134, v121, v128
    v_fmac_f32 v131, v119, v127
    v_fmac_f32 v132, v120, v127
    v_fmac_f32 v133, v121, v127
    buffer_load_dwordx4 v243, s[28:31], s97 offen offset:3072  lds
    v_fmac_f32 v134, v122, v127
    v_mul_f32 v131, v131, v123
    v_mul_f32 v132, v132, v124
    v_mul_f32 v133, v133, v125
    v_mul_f32 v134, v134, v126
    s_add_u32 m0, s88, 0
    s_mov_b64 exec, 0xffffffff
    buffer_load_dwordx4 v3, s[28:31], s97 offen offset:0  lds
    s_mov_b64 exec, -1
    v_cvt_pk_bf16_f32 v110, v134, v133
    v_cvt_pk_bf16_f32 v111, v132, v131
    v_lshlrev_b32 v116, 16, v43
    v_lshlrev_b32 v117, 16, v47
    v_lshlrev_b32 v118, 16, v51
    s_add_u32 m0, s61, 12288
    s_add_u32 s16, s16, s63
    buffer_load_dwordx4 v244, s[32:35], s16 offen offset:0  lds
    v_lshlrev_b32 v119, 16, v55
    v_lshlrev_b32 v120, 16, v59
    v_lshlrev_b32 v121, 16, v63
    v_lshlrev_b32 v122, 16, v67
    v_lshlrev_b32 v127, 16, v96
    buffer_load_dwordx4 v245, s[32:35], s16 offen offset:1024  lds
    v_and_b32 v128, 0xffff0000, v96
    v_lshlrev_b32 v129, 16, v97
    v_and_b32 v130, 0xffff0000, v97
    v_lshlrev_b32 v123, 16, v71
    v_lshlrev_b32 v124, 16, v75
    buffer_load_dwordx4 v246, s[32:35], s16 offen offset:2048  lds
    v_lshlrev_b32 v125, 16, v79
    v_lshlrev_b32 v126, 16, v83
    v_mul_f32 v131, v116, v130
    v_mul_f32 v132, v117, v130
    v_mul_f32 v133, v118, v130
    v_mul_f32 v134, v119, v130
    v_fmac_f32 v131, v117, v129
    v_fmac_f32 v132, v118, v129
    v_fmac_f32 v133, v119, v129
    v_fmac_f32 v134, v120, v129
    v_fmac_f32 v131, v118, v128
    v_fmac_f32 v132, v119, v128
    v_fmac_f32 v133, v120, v128
    v_fmac_f32 v134, v121, v128
    v_fmac_f32 v131, v119, v127
    v_fmac_f32 v132, v120, v127
    v_fmac_f32 v133, v121, v127
    v_fmac_f32 v134, v122, v127
    v_mul_f32 v131, v131, v123
    v_mul_f32 v132, v132, v124
    v_mul_f32 v133, v133, v125
    v_mul_f32 v134, v134, v126
    v_cvt_pk_bf16_f32 v108, v134, v133
    v_cvt_pk_bf16_f32 v109, v132, v131
    s_nop 0
    v_permlane32_swap_b32 v110, v108
    v_permlane32_swap_b32 v111, v109
    s_mov_b32 s89, 32768
    buffer_store_dwordx4 v[108:111], v12, s[52:55], s89 offen sc1
    s_waitcnt vmcnt(13)
    s_barrier
    s_add_u32 s97, s98, s0
    s_lshr_b64 s[0:1], s[0:1], 4
    s_and_b32 s97, s97, 15
    s_lshr_b32 s99, s97, 3
    s_xor_b32 s97, s97, s99
    s_add_u32 m0, s87, 18432
    s_lshl_b32 s97, s97, 7
    buffer_load_dwordx4 v240, s[28:31], s97 offen offset:0  lds
    v_and_b32 v116, 0xffff0000, v41
    v_and_b32 v117, 0xffff0000, v45
    v_and_b32 v118, 0xffff0000, v49
    v_and_b32 v119, 0xffff0000, v53
    v_and_b32 v120, 0xffff0000, v57
    buffer_load_dwordx4 v241, s[28:31], s97 offen offset:1024  lds
    v_and_b32 v121, 0xffff0000, v61
    v_and_b32 v122, 0xffff0000, v65
    v_lshlrev_b32 v127, 16, v90
    v_and_b32 v128, 0xffff0000, v90
    v_lshlrev_b32 v129, 16, v91
    s_mul_i32 s16, s97, 3072
    s_add_u32 m0, s60, 24576
    s_add_u32 s99, s16, s62
    buffer_load_dwordx4 v244, s[32:35], s99 offen offset:0  lds
    v_and_b32 v130, 0xffff0000, v91
    v_and_b32 v123, 0xffff0000, v69
    v_and_b32 v124, 0xffff0000, v73
    v_and_b32 v125, 0xffff0000, v77
    v_and_b32 v126, 0xffff0000, v81
    buffer_load_dwordx4 v245, s[32:35], s99 offen offset:1024  lds
    v_mul_f32 v131, v116, v130
    v_mul_f32 v132, v117, v130
    v_mul_f32 v133, v118, v130
    v_mul_f32 v134, v119, v130
    v_fmac_f32 v131, v117, v129
    buffer_load_dwordx4 v246, s[32:35], s99 offen offset:2048  lds
    v_fmac_f32 v132, v118, v129
    v_fmac_f32 v133, v119, v129
    v_fmac_f32 v134, v120, v129
    v_fmac_f32 v131, v118, v128
    v_fmac_f32 v132, v119, v128
    s_add_u32 m0, s87, 18432
    s_nop 0
    buffer_load_dwordx4 v242, s[28:31], s97 offen offset:2048  lds
    v_fmac_f32 v133, v120, v128
    v_fmac_f32 v134, v121, v128
    v_fmac_f32 v131, v119, v127
    v_fmac_f32 v132, v120, v127
    v_fmac_f32 v133, v121, v127
    buffer_load_dwordx4 v243, s[28:31], s97 offen offset:3072  lds
    v_fmac_f32 v134, v122, v127
    v_mul_f32 v131, v131, v123
    v_mul_f32 v132, v132, v124
    v_mul_f32 v133, v133, v125
    v_mul_f32 v134, v134, v126
    s_add_u32 m0, s88, 18432
    s_mov_b64 exec, 0xffffffff
    buffer_load_dwordx4 v3, s[28:31], s97 offen offset:0  lds
    s_mov_b64 exec, -1
    v_cvt_pk_bf16_f32 v114, v134, v133
    v_cvt_pk_bf16_f32 v115, v132, v131
    v_and_b32 v116, 0xffff0000, v43
    v_and_b32 v117, 0xffff0000, v47
    v_and_b32 v118, 0xffff0000, v51
    s_add_u32 m0, s61, 36864
    s_add_u32 s16, s16, s63
    buffer_load_dwordx4 v244, s[32:35], s16 offen offset:0  lds
    v_and_b32 v119, 0xffff0000, v55
    v_and_b32 v120, 0xffff0000, v59
    v_and_b32 v121, 0xffff0000, v63
    v_and_b32 v122, 0xffff0000, v67
    v_lshlrev_b32 v127, 16, v98
    buffer_load_dwordx4 v245, s[32:35], s16 offen offset:1024  lds
    v_and_b32 v128, 0xffff0000, v98
    v_lshlrev_b32 v129, 16, v99
    v_and_b32 v130, 0xffff0000, v99
    v_and_b32 v123, 0xffff0000, v71
    v_and_b32 v124, 0xffff0000, v75
    buffer_load_dwordx4 v246, s[32:35], s16 offen offset:2048  lds
    v_and_b32 v125, 0xffff0000, v79
    v_and_b32 v126, 0xffff0000, v83
    v_mul_f32 v131, v116, v130
    v_mul_f32 v132, v117, v130
    v_mul_f32 v133, v118, v130
    v_mul_f32 v134, v119, v130
    v_fmac_f32 v131, v117, v129
    v_fmac_f32 v132, v118, v129
    v_fmac_f32 v133, v119, v129
    v_fmac_f32 v134, v120, v129
    v_fmac_f32 v131, v118, v128
    v_fmac_f32 v132, v119, v128
    v_fmac_f32 v133, v120, v128
    v_fmac_f32 v134, v121, v128
    v_fmac_f32 v131, v119, v127
    v_fmac_f32 v132, v120, v127
    v_fmac_f32 v133, v121, v127
    v_fmac_f32 v134, v122, v127
    v_mul_f32 v131, v131, v123
    v_mul_f32 v132, v132, v124
    v_mul_f32 v133, v133, v125
    v_mul_f32 v134, v134, v126
    v_cvt_pk_bf16_f32 v112, v134, v133
    v_cvt_pk_bf16_f32 v113, v132, v131
    s_nop 0
    v_permlane32_swap_b32 v114, v112
    v_permlane32_swap_b32 v115, v113
    s_mov_b32 s89, 49152
    buffer_store_dwordx4 v[112:115], v12, s[52:55], s89 offen sc1
    s_waitcnt vmcnt(13)
    s_barrier
    s_add_u32 s97, s98, s0
    s_lshr_b64 s[0:1], s[0:1], 4
    s_and_b32 s97, s97, 15
    s_lshr_b32 s99, s97, 3
    s_xor_b32 s97, s97, s99
    s_add_u32 m0, s87, 36864
    s_lshl_b32 s97, s97, 7
    buffer_load_dwordx4 v240, s[28:31], s97 offen offset:0  lds
    buffer_load_dwordx4 v241, s[28:31], s97 offen offset:1024  lds
    s_mul_i32 s16, s97, 3072
    s_add_u32 m0, s60, 49152
    s_add_u32 s99, s16, s62
    buffer_load_dwordx4 v244, s[32:35], s99 offen offset:0  lds
    buffer_load_dwordx4 v245, s[32:35], s99 offen offset:1024  lds
    buffer_load_dwordx4 v246, s[32:35], s99 offen offset:2048  lds
    s_add_u32 m0, s87, 36864
    s_nop 0
    buffer_load_dwordx4 v242, s[28:31], s97 offen offset:2048  lds
    buffer_load_dwordx4 v243, s[28:31], s97 offen offset:3072  lds
    s_add_u32 m0, s88, 36864
    s_mov_b64 exec, 0xffffffff
    buffer_load_dwordx4 v3, s[28:31], s97 offen offset:0  lds
    s_mov_b64 exec, -1
    s_add_u32 m0, s61, 61440
    s_add_u32 s16, s16, s63
    buffer_load_dwordx4 v244, s[32:35], s16 offen offset:0  lds
    buffer_load_dwordx4 v245, s[32:35], s16 offen offset:1024  lds
    buffer_load_dwordx4 v246, s[32:35], s16 offen offset:2048  lds
    s_waitcnt vmcnt(12)
    s_barrier
    s_add_u32 m0, s94, 32
    s_lshl_b32 s89, s90, 12
    buffer_load_dwordx4 v15, s[48:51], s89 offen offset:0 nt lds
    s_mov_b32 s68, s24
    s_mov_b32 s69, s25
    s_mov_b32 s70, 0x100
    s_mov_b32 s71, 0x20000
    s_add_u32 m0, s94, 32
    s_lshl_b32 s89, s90, 12
    buffer_load_dwordx4 v15, s[48:51], s89 offen offset:1024 nt lds
    v_lshrrev_b32 v6, 5, v0
    v_and_b32 v7, 3, v0
    s_lshr_b32 s78, s90, 1
    s_add_u32 m0, s94, 32
    s_lshl_b32 s89, s90, 12
    buffer_load_dwordx4 v15, s[48:51], s89 offen offset:2048 nt lds
    s_lshl_b32 s78, s78, 2
    s_load_dword s92, s[14:15], s78
    v_bfe_u32 v5, v0, 2, 2
    v_lshlrev_b32 v5, 1, v5
    s_add_u32 m0, s94, 32
    s_lshl_b32 s89, s90, 12
    buffer_load_dwordx4 v15, s[48:51], s89 offen offset:3072 nt lds
    v_lshl_add_u32 v5, v6, 3, v5
    v_bfe_u32 v8, v0, 4, 1
    v_add_u32 v5, v5, v8
    s_add_u32 s97, s98, s0
    s_lshr_b64 s[0:1], s[0:1], 4
    s_and_b32 s97, s97, 15
    s_lshr_b32 s99, s97, 3
    s_xor_b32 s97, s97, s99
    s_add_u32 m0, s87, 0
    s_lshl_b32 s97, s97, 7
    buffer_load_dwordx4 v240, s[28:31], s97 offen offset:0  lds
    s_and_b32 s78, s3, 1
    s_lshl_b32 s78, s78, 1
    v_add_u32 v8, s78, v6
    v_xor_b32 v8, v8, v7
    buffer_load_dwordx4 v241, s[28:31], s97 offen offset:1024  lds
    v_lshlrev_b32 v8, 4, v8
    v_lshl_add_u32 v5, v5, 6, v8
    v_add_u32 v14, s86, v5
    s_mul_i32 s16, s97, 3072
    s_add_u32 m0, s60, 0
    s_add_u32 s99, s16, s62
    buffer_load_dwordx4 v244, s[32:35], s99 offen offset:0  lds
    v_mov_b32 v18, 162304
    v_mov_b32 v19, 1
    v_and_b32 v5, 3, v0
    s_lshl_b32 s78, s74, 4
    buffer_load_dwordx4 v245, s[32:35], s99 offen offset:1024  lds
    s_add_u32 s78, s78, s3
    v_lshl_add_u32 v6, v5, 2, s78
    s_lshr_b32 s78, s76, 3
    buffer_load_dwordx4 v246, s[32:35], s99 offen offset:2048  lds
    s_lshl_b32 s79, s3, 1
    s_add_u32 s78, s78, s79
    s_xor_b32 s78, s78, 2
    s_lshl_b32 s78, s78, 5
    s_add_u32 m0, s87, 0
    s_nop 0
    buffer_load_dwordx4 v242, s[28:31], s97 offen offset:2048  lds
    s_and_b32 s79, s76, 7
    s_add_u32 s78, s78, s79
    v_lshl_add_u32 v7, v5, 3, s78
    buffer_load_dwordx4 v243, s[28:31], s97 offen offset:3072  lds
    v_and_b32 v8, 4, v0
    v_cmp_eq_u32 vcc, 0, v8
    s_nop 1
    v_cndmask_b32 v6, v7, v6, vcc
    v_and_b32 v33, 0xf0, v6
    s_add_u32 m0, s88, 0
    s_mov_b64 exec, 0xffffffff
    buffer_load_dwordx4 v3, s[28:31], s97 offen offset:0  lds
    s_mov_b64 exec, -1
    v_lshlrev_b32 v34, 8, v6
    v_add_u32 v34, 12582912, v34
    v_and_b32 v5, 15, v0
    s_add_u32 m0, s61, 12288
    s_add_u32 s16, s16, s63
    buffer_load_dwordx4 v244, s[32:35], s16 offen offset:0  lds
    v_lshrrev_b32 v6, 4, v0
    v_add_u32 v7, 9, v5
    v_and_b32 v8, 1, v7
    v_mul_u32_u24 v8, 4160, v8
    buffer_load_dwordx4 v245, s[32:35], s16 offen offset:1024  lds
    v_lshrrev_b32 v7, 1, v7
    v_lshl_add_u32 v8, v7, 2, v8
    v_lshlrev_b32 v7, 4, v6
    buffer_load_dwordx4 v246, s[32:35], s16 offen offset:2048  lds
    v_sub_u32 v8, v8, v7
    s_add_u32 s78, s94, 32
    v_add_u32 v21, s78, v8
    s_waitcnt vmcnt(15)
    s_barrier
    s_add_u32 s97, s98, s0
    s_lshr_b64 s[0:1], s[0:1], 4
    s_and_b32 s97, s97, 15
    s_lshr_b32 s99, s97, 3
    s_xor_b32 s97, s97, s99
    s_add_u32 m0, s87, 18432
    s_lshl_b32 s97, s97, 7
    buffer_load_dwordx4 v240, s[28:31], s97 offen offset:0  lds
    v_add_u32 v22, 1024, v21
    v_add_u32 v23, 2048, v21
    v_add_u32 v24, 3072, v21
    v_lshl_add_u32 v7, v5, 1, v6
    v_add_u32 v7, 30, v7
    buffer_load_dwordx4 v241, s[28:31], s97 offen offset:1024  lds
    v_and_b32 v8, 1, v7
    v_bfe_u32 v136, v7, 1, 2
    v_lshl_add_u32 v136, v8, 2, v136
    v_lshlrev_b32 v136, 6, v136
    v_lshrrev_b32 v7, 3, v7
    s_mul_i32 s16, s97, 3072
    s_add_u32 m0, s60, 24576
    s_add_u32 s99, s16, s62
    buffer_load_dwordx4 v244, s[32:35], s99 offen offset:0  lds
    v_lshl_add_u32 v136, v7, 9, v136
    v_bitop3_b32 v8, v7, 3, s3 bitop3:0x6a
    v_lshl_add_u32 v25, v8, 4, v136
    v_add_u32 v25, 92160, v25
    v_subrev_u32 v7, 1, v7
    buffer_load_dwordx4 v245, s[32:35], s99 offen offset:1024  lds
    v_bitop3_b32 v8, v7, 3, s3 bitop3:0x6a
    v_lshl_add_u32 v27, v8, 4, v136
    v_add_u32 v27, 91648, v27
    v_subrev_u32 v7, 1, v7
    buffer_load_dwordx4 v246, s[32:35], s99 offen offset:2048  lds
    v_bitop3_b32 v8, v7, 3, s3 bitop3:0x6a
    v_lshl_add_u32 v29, v8, 4, v136
    v_add_u32 v29, 91136, v29
    v_subrev_u32 v7, 1, v7
    v_bitop3_b32 v8, v7, 3, s3 bitop3:0x6a
    s_add_u32 m0, s87, 18432
    s_nop 0
    buffer_load_dwordx4 v242, s[28:31], s97 offen offset:2048  lds
    v_lshl_add_u32 v31, v8, 4, v136
    v_add_u32 v31, 90624, v31
    v_lshl_add_u32 v7, v5, 1, v6
    v_add_u32 v7, 26, v7
    v_and_b32 v8, 1, v7
    buffer_load_dwordx4 v243, s[28:31], s97 offen offset:3072  lds
    v_bfe_u32 v136, v7, 1, 2
    v_lshl_add_u32 v136, v8, 2, v136
    v_lshlrev_b32 v136, 6, v136
    v_lshrrev_b32 v7, 3, v7
    v_lshl_add_u32 v136, v7, 9, v136
    s_add_u32 m0, s88, 18432
    s_mov_b64 exec, 0xffffffff
    buffer_load_dwordx4 v3, s[28:31], s97 offen offset:0  lds
    s_mov_b64 exec, -1
    v_bitop3_b32 v8, v7, 3, s3 bitop3:0x6a
    v_lshl_add_u32 v26, v8, 4, v136
    v_add_u32 v26, 92160, v26
    v_subrev_u32 v7, 1, v7
    s_add_u32 m0, s61, 36864
    s_add_u32 s16, s16, s63
    buffer_load_dwordx4 v244, s[32:35], s16 offen offset:0  lds
    v_bitop3_b32 v8, v7, 3, s3 bitop3:0x6a
    v_lshl_add_u32 v28, v8, 4, v136
    v_add_u32 v28, 91648, v28
    v_subrev_u32 v7, 1, v7
    v_bitop3_b32 v8, v7, 3, s3 bitop3:0x6a
    buffer_load_dwordx4 v245, s[32:35], s16 offen offset:1024  lds
    v_lshl_add_u32 v30, v8, 4, v136
    v_add_u32 v30, 91136, v30
    v_subrev_u32 v7, 1, v7
    v_bitop3_b32 v8, v7, 3, s3 bitop3:0x6a
    v_lshl_add_u32 v32, v8, 4, v136
    buffer_load_dwordx4 v246, s[32:35], s16 offen offset:2048  lds
    v_add_u32 v32, 90624, v32
    v_lshrrev_b32 v7, 1, v6
    v_lshl_add_u32 v7, v5, 1, v7
    v_add_u32 v7, 32, v7
    s_waitcnt vmcnt(11)
    s_barrier
    s_add_u32 s97, s98, s0
    s_lshr_b64 s[0:1], s[0:1], 4
    s_and_b32 s97, s97, 15
    s_lshr_b32 s99, s97, 3
    s_xor_b32 s97, s97, s99
    s_add_u32 m0, s87, 36864
    s_lshl_b32 s97, s97, 7
    buffer_load_dwordx4 v240, s[28:31], s97 offen offset:0  lds
    v_and_b32 v8, 1, v7
    v_bfe_u32 v136, v7, 1, 2
    v_lshl_add_u32 v136, v8, 2, v136
    v_lshlrev_b32 v136, 6, v136
    buffer_load_dwordx4 v241, s[28:31], s97 offen offset:1024  lds
    v_lshrrev_b32 v7, 3, v7
    v_lshl_add_u32 v136, v7, 9, v136
    v_bitop3_b32 v8, v7, 3, s3 bitop3:0x6a
    v_lshl_add_u32 v20, v8, 4, v136
    s_mul_i32 s16, s97, 3072
    s_add_u32 m0, s60, 49152
    s_add_u32 s99, s16, s62
    buffer_load_dwordx4 v244, s[32:35], s99 offen offset:0  lds
    v_add_u32 v20, 92160, v20
    v_and_b32 v8, 1, v6
    v_xor_b32 v8, 1, v8
    v_lshl_add_u32 v20, v8, 3, v20
    buffer_load_dwordx4 v245, s[32:35], s99 offen offset:1024  lds
    s_waitcnt lgkmcnt(0)
    s_and_b32 s78, s92, 0xffff0000
    s_lshl_b32 s92, s92, 16
    s_bitcmp1_b32 s90, 0
    s_cselect_b32 s92, s78, s92
    buffer_load_dwordx4 v246, s[32:35], s99 offen offset:2048  lds
    v_lshlrev_b32 v7, 3, v6
    v_sub_u32 v7, v7, v5
    v_subrev_u32 v7, 9, v7
    v_and_b32 v8, 1, v7
    s_add_u32 m0, s87, 36864
    s_nop 0
    buffer_load_dwordx4 v242, s[28:31], s97 offen offset:2048  lds
    v_xor_b32 v8, 1, v8
    v_lshlrev_b32 v8, 4, v8
    v_lshrrev_b32 v8, v8, s92
    v_ashrrev_i32 v7, 1, v7
    buffer_load_dwordx4 v243, s[28:31], s97 offen offset:3072  lds
    v_cmp_eq_u32 vcc, 0, v7
    s_nop 1
    v_cndmask_b32 v236, 0, v8, vcc
    v_cmp_eq_u32 vcc, 1, v7
    s_nop 1
    v_cndmask_b32 v237, 0, v8, vcc
    s_add_u32 m0, s88, 36864
    s_mov_b64 exec, 0xffffffff
    buffer_load_dwordx4 v3, s[28:31], s97 offen offset:0  lds
    s_mov_b64 exec, -1
    v_cmp_eq_u32 vcc, 2, v7
    s_nop 1
    v_cndmask_b32 v238, 0, v8, vcc
    v_cmp_eq_u32 vcc, 3, v7
    s_nop 1
    v_cndmask_b32 v239, 0, v8, vcc
    s_add_u32 m0, s61, 61440
    s_add_u32 s16, s16, s63
    buffer_load_dwordx4 v244, s[32:35], s16 offen offset:0  lds
    s_and_b32 s78, s77, 7
    s_mov_b32 s95, 0x76543210
    s_cmp_eq_u32 s78, 1
    s_cselect_b32 s95, 0x76543201, s95
    s_cmp_eq_u32 s78, 2
    s_cselect_b32 s95, 0x76543120, s95
    s_cmp_eq_u32 s78, 3
    s_cselect_b32 s95, 0x76542310, s95
    s_cmp_eq_u32 s78, 4
    s_cselect_b32 s95, 0x76534210, s95
    s_cmp_eq_u32 s78, 5
    s_cselect_b32 s95, 0x76453210, s95
    s_cmp_eq_u32 s78, 6
    s_cselect_b32 s95, 0x75643210, s95
    s_cmp_eq_u32 s78, 7
    s_cselect_b32 s95, 0x67543210, s95
    s_and_b32 s78, s76, 3
    s_mul_i32 s78, s78, 0x22222222
    s_add_u32 s95, s95, s78
    s_bfe_u32 s100, s95, 0x3001c
    s_lshl_b32 s100, s100, 18
    s_bfe_u32 s95, s95, 0x30018
    s_lshl_b32 s95, s95, 18
    v_lshrrev_b32 v136, 4, v0
    v_lshlrev_b32 v136, 1, v136
    v_and_b32 v137, 7, v0
    buffer_load_dwordx4 v245, s[32:35], s16 offen offset:1024  lds
    v_xor_b32 v136, v136, v137
    v_lshlrev_b32 v136, 4, v136
    v_lshrrev_b32 v137, 3, v0
    v_lshl_add_u32 v136, v137, 11, v136
    buffer_load_dwordx4 v246, s[32:35], s16 offen offset:2048  lds
    s_lshl_b32 s78, s77, 7
    s_lshl_b32 s79, s3, 14
    s_add_u32 s78, s78, s79
    v_add_u32 v17, s78, v136
    s_waitcnt vmcnt(11)
    s_barrier
    s_add_u32 s97, s98, s0
    s_lshr_b64 s[0:1], s[0:1], 4
    s_and_b32 s97, s97, 15
    s_lshr_b32 s99, s97, 3
    s_xor_b32 s97, s97, s99
    s_add_u32 m0, s87, 0
    s_lshl_b32 s97, s97, 7
    buffer_load_dwordx4 v240, s[28:31], s97 offen offset:0  lds
    v_add_u32 v5, s94, v15
    ds_read_b128 v[140:143], v5 offset:32
    ds_read_b32 v156, v5 offset:48
    ds_read_b128 v[144:147], v5 offset:1056
    buffer_load_dwordx4 v241, s[28:31], s97 offen offset:1024  lds
    ds_read_b32 v157, v5 offset:1072
    ds_read_b128 v[148:151], v5 offset:2080
    ds_read_b32 v158, v5 offset:2096
    s_mul_i32 s16, s97, 3072
    s_add_u32 m0, s60, 0
    s_add_u32 s99, s16, s62
    buffer_load_dwordx4 v244, s[32:35], s99 offen offset:0  lds
    ds_read_b128 v[152:155], v5 offset:3104
    ds_read_b32 v159, v5 offset:3120
    v_lshrrev_b32 v6, 3, v0
    buffer_load_dwordx4 v245, s[32:35], s99 offen offset:1024  lds
    v_mul_u32_u24 v6, 4160, v6
    v_and_b32 v7, 7, v0
    v_lshl_add_u32 v6, v7, 2, v6
    v_add_u32 v6, s94, v6
    buffer_load_dwordx4 v246, s[32:35], s99 offen offset:2048  lds
    v_mov_b32 v7, 0
    s_waitcnt lgkmcnt(0)
    v_readfirstlane_b32 s93, v140
    s_add_u32 m0, s87, 0
    s_nop 0
    buffer_load_dwordx4 v242, s[28:31], s97 offen offset:2048  lds
    s_lshl_b32 s93, s93, 16
    v_writelane_b32 v7, s93, 15
    v_alignbit_b32 v140, v141, v140, 16
    buffer_load_dwordx4 v243, s[28:31], s97 offen offset:3072  lds
    v_alignbit_b32 v141, v142, v141, 16
    v_alignbit_b32 v142, v143, v142, 16
    v_alignbit_b32 v143, v156, v143, 16
    v_alignbit_b32 v144, v145, v144, 16
    s_add_u32 m0, s88, 0
    s_mov_b64 exec, 0xffffffff
    buffer_load_dwordx4 v3, s[28:31], s97 offen offset:0  lds
    s_mov_b64 exec, -1
    v_alignbit_b32 v145, v146, v145, 16
    v_alignbit_b32 v146, v147, v146, 16
    v_alignbit_b32 v147, v157, v147, 16
    s_add_u32 m0, s61, 12288
    s_add_u32 s16, s16, s63
    buffer_load_dwordx4 v244, s[32:35], s16 offen offset:0  lds
    v_alignbit_b32 v148, v149, v148, 16
    v_alignbit_b32 v149, v150, v149, 16
    v_alignbit_b32 v150, v151, v150, 16
    buffer_load_dwordx4 v245, s[32:35], s16 offen offset:1024  lds
    v_alignbit_b32 v151, v158, v151, 16
    v_alignbit_b32 v152, v153, v152, 16
    v_alignbit_b32 v153, v154, v153, 16
    v_alignbit_b32 v154, v155, v154, 16
    buffer_load_dwordx4 v246, s[32:35], s16 offen offset:2048  lds
    v_alignbit_b32 v155, v159, v155, 16
    v_lshlrev_b32 v8, 3, v0
    s_add_u32 s78, s88, 18432
    s_mov_b64 exec, 0xff
    buffer_load_dword v136, v33, s[68:71], 0 offen sc1
    buffer_load_dword v137, v34, s[52:55], 0 offen sc1
    s_mov_b64 exec, -1
    v_add_u32 v8, s78, v8
    v_mov_b32 v156, 0
    v_mov_b32 v157, 0
    s_waitcnt vmcnt(13)
    s_barrier
    s_waitcnt vmcnt(0)
    s_branch LA_j
LA_c2:
    s_waitcnt vmcnt(7)
    s_barrier
    s_add_u32 m0, s88, 18432
    s_mov_b64 exec, 0xffffffff
    buffer_load_dwordx4 v3, s[28:31], s97 offen offset:0  lds
    s_mov_b64 exec, -1
    s_add_u32 m0, s61, 36864
    s_add_u32 s16, s16, s63
    buffer_load_dwordx4 v244, s[32:35], s16 offen offset:0  lds
    buffer_load_dwordx4 v245, s[32:35], s16 offen offset:1024  lds
    buffer_load_dwordx4 v246, s[32:35], s16 offen offset:2048  lds
    s_add_u32 s97, s98, s0
    s_lshr_b64 s[0:1], s[0:1], 4
    s_and_b32 s97, s97, 15
    s_lshr_b32 s99, s97, 3
    s_xor_b32 s97, s97, s99
    s_add_u32 m0, s87, 36864
    s_lshl_b32 s97, s97, 7
    buffer_load_dwordx4 v240, s[28:31], s97 offen offset:0  lds
    buffer_load_dwordx4 v241, s[28:31], s97 offen offset:1024  lds
    s_mul_i32 s16, s97, 3072
    s_add_u32 m0, s60, 49152
    s_add_u32 s99, s16, s62
    buffer_load_dwordx4 v244, s[32:35], s99 offen offset:0  lds
    buffer_load_dwordx4 v245, s[32:35], s99 offen offset:1024  lds
    buffer_load_dwordx4 v246, s[32:35], s99 offen offset:2048  lds
    s_add_u32 m0, s87, 36864
    s_nop 0
    buffer_load_dwordx4 v242, s[28:31], s97 offen offset:2048  lds
    buffer_load_dwordx4 v243, s[28:31], s97 offen offset:3072  lds
    s_add_u32 m0, s88, 36864
    s_mov_b64 exec, 0xffffffff
    buffer_load_dwordx4 v3, s[28:31], s97 offen offset:0  lds
    s_mov_b64 exec, -1
    s_add_u32 m0, s61, 61440
    s_add_u32 s16, s16, s63
    buffer_load_dwordx4 v244, s[32:35], s16 offen offset:0  lds
    buffer_load_dwordx4 v245, s[32:35], s16 offen offset:1024  lds
    buffer_load_dwordx4 v246, s[32:35], s16 offen offset:2048  lds
    s_waitcnt vmcnt(11)
    s_barrier
    s_add_u32 s97, s98, s0
    s_lshr_b64 s[0:1], s[0:1], 4
    s_and_b32 s97, s97, 15
    s_lshr_b32 s99, s97, 3
    s_xor_b32 s97, s97, s99
    s_add_u32 m0, s87, 0
    s_lshl_b32 s97, s97, 7
    buffer_load_dwordx4 v240, s[28:31], s97 offen offset:0  lds
    buffer_load_dwordx4 v241, s[28:31], s97 offen offset:1024  lds
    s_mul_i32 s16, s97, 3072
    s_add_u32 m0, s60, 0
    s_add_u32 s99, s16, s62
    buffer_load_dwordx4 v244, s[32:35], s99 offen offset:0  lds
    buffer_load_dwordx4 v245, s[32:35], s99 offen offset:1024  lds
    buffer_load_dwordx4 v246, s[32:35], s99 offen offset:2048  lds
    s_add_u32 m0, s87, 0
    s_nop 0
    buffer_load_dwordx4 v242, s[28:31], s97 offen offset:2048  lds
    buffer_load_dwordx4 v243, s[28:31], s97 offen offset:3072  lds
    s_add_u32 m0, s88, 0
    s_mov_b64 exec, 0xffffffff
    buffer_load_dwordx4 v3, s[28:31], s97 offen offset:0  lds
    s_mov_b64 exec, -1
    s_add_u32 m0, s61, 12288
    s_add_u32 s16, s16, s63
    buffer_load_dwordx4 v244, s[32:35], s16 offen offset:0  lds
    buffer_load_dwordx4 v245, s[32:35], s16 offen offset:1024  lds
    buffer_load_dwordx4 v246, s[32:35], s16 offen offset:2048  lds
    s_waitcnt vmcnt(11)
    s_barrier
    s_add_u32 s97, s98, s0
    s_lshr_b64 s[0:1], s[0:1], 4
    s_and_b32 s97, s97, 15
    s_lshr_b32 s99, s97, 3
    s_xor_b32 s97, s97, s99
    s_add_u32 m0, s87, 18432
    s_lshl_b32 s97, s97, 7
    buffer_load_dwordx4 v240, s[28:31], s97 offen offset:0  lds
    buffer_load_dwordx4 v241, s[28:31], s97 offen offset:1024  lds
    s_mul_i32 s16, s97, 3072
    s_add_u32 m0, s60, 24576
    s_add_u32 s99, s16, s62
    buffer_load_dwordx4 v244, s[32:35], s99 offen offset:0  lds
    buffer_load_dwordx4 v245, s[32:35], s99 offen offset:1024  lds
    buffer_load_dwordx4 v246, s[32:35], s99 offen offset:2048  lds
    s_add_u32 m0, s87, 18432
    s_nop 0
    buffer_load_dwordx4 v242, s[28:31], s97 offen offset:2048  lds
    buffer_load_dwordx4 v243, s[28:31], s97 offen offset:3072  lds
    s_add_u32 m0, s88, 18432
    s_mov_b64 exec, 0xffffffff
    buffer_load_dwordx4 v3, s[28:31], s97 offen offset:0  lds
    s_mov_b64 exec, -1
    s_add_u32 m0, s61, 36864
    s_add_u32 s16, s16, s63
    buffer_load_dwordx4 v244, s[32:35], s16 offen offset:0  lds
    buffer_load_dwordx4 v245, s[32:35], s16 offen offset:1024  lds
    buffer_load_dwordx4 v246, s[32:35], s16 offen offset:2048  lds
    s_waitcnt vmcnt(11)
    s_barrier
    s_add_u32 m0, s86, 129536
    s_mov_b32 s89, 0
    buffer_load_dwordx4 v10, s[36:39], s89 offen nt lds
    s_add_u32 m0, s86, 145920
    s_mov_b32 s89, 0
    buffer_load_dwordx4 v10, s[40:43], s89 offen nt lds
    s_add_u32 m0, s86, 133632
    s_mov_b32 s89, 65536
    buffer_load_dwordx4 v10, s[36:39], s89 offen nt lds
    s_add_u32 m0, s86, 150016
    s_mov_b32 s89, 65536
    buffer_load_dwordx4 v10, s[40:43], s89 offen nt lds
    s_add_u32 m0, s86, 137728
    s_mov_b32 s89, 131072
    buffer_load_dwordx4 v10, s[36:39], s89 offen nt lds
    s_add_u32 m0, s86, 154112
    s_mov_b32 s89, 131072
    buffer_load_dwordx4 v10, s[40:43], s89 offen nt lds
    s_add_u32 m0, s86, 141824
    s_mov_b32 s89, 196608
    buffer_load_dwordx4 v10, s[36:39], s89 offen nt lds
    s_add_u32 m0, s86, 158208
    s_mov_b32 s89, 196608
    buffer_load_dwordx4 v10, s[40:43], s89 offen nt lds
    s_mov_b64 exec, 0xff
    s_lshl_b32 s82, s3, 7
    s_add_u32 m0, s82, 129024
    s_mov_b32 s89, 0
    buffer_load_dwordx4 v11, s[36:39], s89 offen nt lds
    s_lshl_b32 s83, s74, 9
    s_add_u32 s83, s83, s82
    s_and_b32 s89, s3, 2
    s_lshl_b32 s89, s89, 3
    s_add_u32 s82, s82, s89
    s_add_u32 m0, s82, 162816
    s_add_u32 s89, s83, 0
    buffer_load_dwordx4 v15, s[44:47], s89 offen  lds
    s_mov_b64 exec, -1
    s_add_u32 s97, s98, s0
    s_lshr_b64 s[0:1], s[0:1], 4
    s_and_b32 s97, s97, 15
    s_lshr_b32 s99, s97, 3
    s_xor_b32 s97, s97, s99
    s_add_u32 m0, s87, 36864
    s_lshl_b32 s97, s97, 7
    buffer_load_dwordx4 v240, s[28:31], s97 offen offset:0  lds
    buffer_load_dwordx4 v241, s[28:31], s97 offen offset:1024  lds
    s_mul_i32 s16, s97, 3072
    s_add_u32 m0, s60, 49152
    s_add_u32 s99, s16, s62
    buffer_load_dwordx4 v244, s[32:35], s99 offen offset:0  lds
    buffer_load_dwordx4 v245, s[32:35], s99 offen offset:1024  lds
    buffer_load_dwordx4 v246, s[32:35], s99 offen offset:2048  lds
    s_add_u32 m0, s87, 36864
    s_nop 0
    buffer_load_dwordx4 v242, s[28:31], s97 offen offset:2048  lds
    buffer_load_dwordx4 v243, s[28:31], s97 offen offset:3072  lds
    s_waitcnt vmcnt(17)
    s_barrier
    s_add_u32 m0, s88, 36864
    s_mov_b64 exec, 0xffffffff
    buffer_load_dwordx4 v3, s[28:31], s97 offen offset:0  lds
    s_mov_b64 exec, -1
    s_add_u32 m0, s61, 61440
    s_add_u32 s16, s16, s63
    buffer_load_dwordx4 v244, s[32:35], s16 offen offset:0  lds
    buffer_load_dwordx4 v245, s[32:35], s16 offen offset:1024  lds
    buffer_load_dwordx4 v246, s[32:35], s16 offen offset:2048  lds
    s_add_u32 s97, s98, s0
    s_lshr_b64 s[0:1], s[0:1], 4
    s_and_b32 s97, s97, 15
    s_lshr_b32 s99, s97, 3
    s_xor_b32 s97, s97, s99
    s_add_u32 m0, s87, 0
    s_lshl_b32 s97, s97, 7
    buffer_load_dwordx4 v240, s[28:31], s97 offen offset:0  lds
    buffer_load_dwordx4 v241, s[28:31], s97 offen offset:1024  lds
    s_mul_i32 s16, s97, 3072
    s_add_u32 m0, s60, 0
    s_add_u32 s99, s16, s62
    buffer_load_dwordx4 v244, s[32:35], s99 offen offset:0  lds
    buffer_load_dwordx4 v245, s[32:35], s99 offen offset:1024  lds
    buffer_load_dwordx4 v246, s[32:35], s99 offen offset:2048  lds
    s_add_u32 m0, s87, 0
    s_nop 0
    buffer_load_dwordx4 v242, s[28:31], s97 offen offset:2048  lds
    buffer_load_dwordx4 v243, s[28:31], s97 offen offset:3072  lds
    s_add_u32 m0, s88, 0
    s_mov_b64 exec, 0xffffffff
    buffer_load_dwordx4 v3, s[28:31], s97 offen offset:0  lds
    s_mov_b64 exec, -1
    s_add_u32 m0, s61, 12288
    s_add_u32 s16, s16, s63
    buffer_load_dwordx4 v244, s[32:35], s16 offen offset:0  lds
    buffer_load_dwordx4 v245, s[32:35], s16 offen offset:1024  lds
    buffer_load_dwordx4 v246, s[32:35], s16 offen offset:2048  lds
    s_waitcnt vmcnt(11)
    s_barrier
    s_add_u32 s97, s98, s0
    s_lshr_b64 s[0:1], s[0:1], 4
    s_and_b32 s97, s97, 15
    s_lshr_b32 s99, s97, 3
    s_xor_b32 s97, s97, s99
    s_add_u32 m0, s87, 18432
    s_lshl_b32 s97, s97, 7
    buffer_load_dwordx4 v240, s[28:31], s97 offen offset:0  lds
    ds_read_b128 v[84:87], v35 offset:0
    ds_read_b128 v[88:91], v35 offset:16
    buffer_load_dwordx4 v241, s[28:31], s97 offen offset:1024  lds
    ds_read_b128 v[92:95], v35 offset:32
    s_mul_i32 s16, s97, 3072
    s_add_u32 m0, s60, 24576
    s_add_u32 s99, s16, s62
    buffer_load_dwordx4 v244, s[32:35], s99 offen offset:0  lds
    ds_read_b128 v[96:99], v35 offset:48
    ds_read_b128 v[40:43], v233 offset:0
    buffer_load_dwordx4 v245, s[32:35], s99 offen offset:1024  lds
    ds_read_b128 v[44:47], v232 offset:256
    buffer_load_dwordx4 v246, s[32:35], s99 offen offset:2048  lds
    ds_read_b128 v[48:51], v233 offset:256
    s_add_u32 m0, s87, 18432
    s_nop 0
    buffer_load_dwordx4 v242, s[28:31], s97 offen offset:2048  lds
    ds_read_b128 v[52:55], v16 offset:512
    ds_read_b128 v[56:59], v231 offset:512
    buffer_load_dwordx4 v243, s[28:31], s97 offen offset:3072  lds
    ds_read_b128 v[60:63], v16 offset:768
    s_add_u32 m0, s88, 18432
    s_mov_b64 exec, 0xffffffff
    buffer_load_dwordx4 v3, s[28:31], s97 offen offset:0  lds
    s_mov_b64 exec, -1
    ds_read_b128 v[64:67], v231 offset:768
    s_add_u32 m0, s61, 36864
    s_add_u32 s16, s16, s63
    buffer_load_dwordx4 v244, s[32:35], s16 offen offset:0  lds
    ds_read_b128 v[68:71], v16 offset:16896
    ds_read_b128 v[72:75], v231 offset:16896
    buffer_load_dwordx4 v245, s[32:35], s16 offen offset:1024  lds
    ds_read_b128 v[76:79], v16 offset:17152
    buffer_load_dwordx4 v246, s[32:35], s16 offen offset:2048  lds
    ds_read_b128 v[80:83], v231 offset:17152
    s_waitcnt vmcnt(11)
    s_waitcnt lgkmcnt(0)
    s_barrier
    s_add_u32 s97, s98, s0
    s_lshr_b64 s[0:1], s[0:1], 4
    s_and_b32 s97, s97, 15
    s_lshr_b32 s99, s97, 3
    s_xor_b32 s97, s97, s99
    s_add_u32 m0, s87, 36864
    s_lshl_b32 s97, s97, 7
    buffer_load_dwordx4 v240, s[28:31], s97 offen offset:0  lds
    v_lshlrev_b32 v116, 16, v40
    v_lshlrev_b32 v117, 16, v44
    v_lshlrev_b32 v118, 16, v48
    v_lshlrev_b32 v119, 16, v52
    v_lshlrev_b32 v120, 16, v56
    buffer_load_dwordx4 v241, s[28:31], s97 offen offset:1024  lds
    v_lshlrev_b32 v121, 16, v60
    v_lshlrev_b32 v122, 16, v64
    v_lshlrev_b32 v127, 16, v84
    v_and_b32 v128, 0xffff0000, v84
    v_lshlrev_b32 v129, 16, v85
    s_mul_i32 s16, s97, 3072
    s_add_u32 m0, s60, 49152
    s_add_u32 s99, s16, s62
    buffer_load_dwordx4 v244, s[32:35], s99 offen offset:0  lds
    v_and_b32 v130, 0xffff0000, v85
    v_lshlrev_b32 v123, 16, v68
    v_lshlrev_b32 v124, 16, v72
    v_lshlrev_b32 v125, 16, v76
    v_lshlrev_b32 v126, 16, v80
    buffer_load_dwordx4 v245, s[32:35], s99 offen offset:1024  lds
    v_mul_f32 v131, v116, v130
    v_mul_f32 v132, v117, v130
    v_mul_f32 v133, v118, v130
    v_mul_f32 v134, v119, v130
    v_fmac_f32 v131, v117, v129
    buffer_load_dwordx4 v246, s[32:35], s99 offen offset:2048  lds
    v_fmac_f32 v132, v118, v129
    v_fmac_f32 v133, v119, v129
    v_fmac_f32 v134, v120, v129
    v_fmac_f32 v131, v118, v128
    v_fmac_f32 v132, v119, v128
    s_add_u32 m0, s87, 36864
    s_nop 0
    buffer_load_dwordx4 v242, s[28:31], s97 offen offset:2048  lds
    v_fmac_f32 v133, v120, v128
    v_fmac_f32 v134, v121, v128
    v_fmac_f32 v131, v119, v127
    v_fmac_f32 v132, v120, v127
    v_fmac_f32 v133, v121, v127
    buffer_load_dwordx4 v243, s[28:31], s97 offen offset:3072  lds
    v_fmac_f32 v134, v122, v127
    v_mul_f32 v131, v131, v123
    v_mul_f32 v132, v132, v124
    v_mul_f32 v133, v133, v125
    v_mul_f32 v134, v134, v126
    s_add_u32 m0, s88, 36864
    s_mov_b64 exec, 0xffffffff
    buffer_load_dwordx4 v3, s[28:31], s97 offen offset:0  lds
    s_mov_b64 exec, -1
    v_cvt_pk_bf16_f32 v102, v134, v133
    v_cvt_pk_bf16_f32 v103, v132, v131
    v_lshlrev_b32 v116, 16, v42
    v_lshlrev_b32 v117, 16, v46
    v_lshlrev_b32 v118, 16, v50
    s_add_u32 m0, s61, 61440
    s_add_u32 s16, s16, s63
    buffer_load_dwordx4 v244, s[32:35], s16 offen offset:0  lds
    v_lshlrev_b32 v119, 16, v54
    v_lshlrev_b32 v120, 16, v58
    v_lshlrev_b32 v121, 16, v62
    v_lshlrev_b32 v122, 16, v66
    v_lshlrev_b32 v127, 16, v92
    buffer_load_dwordx4 v245, s[32:35], s16 offen offset:1024  lds
    v_and_b32 v128, 0xffff0000, v92
    v_lshlrev_b32 v129, 16, v93
    v_and_b32 v130, 0xffff0000, v93
    v_lshlrev_b32 v123, 16, v70
    v_lshlrev_b32 v124, 16, v74
    buffer_load_dwordx4 v246, s[32:35], s16 offen offset:2048  lds
    v_lshlrev_b32 v125, 16, v78
    v_lshlrev_b32 v126, 16, v82
    v_mul_f32 v131, v116, v130
    v_mul_f32 v132, v117, v130
    v_mul_f32 v133, v118, v130
    v_mul_f32 v134, v119, v130
    v_fmac_f32 v131, v117, v129
    v_fmac_f32 v132, v118, v129
    v_fmac_f32 v133, v119, v129
    v_fmac_f32 v134, v120, v129
    v_fmac_f32 v131, v118, v128
    v_fmac_f32 v132, v119, v128
    v_fmac_f32 v133, v120, v128
    v_fmac_f32 v134, v121, v128
    v_fmac_f32 v131, v119, v127
    v_fmac_f32 v132, v120, v127
    v_fmac_f32 v133, v121, v127
    v_fmac_f32 v134, v122, v127
    v_mul_f32 v131, v131, v123
    v_mul_f32 v132, v132, v124
    v_mul_f32 v133, v133, v125
    v_mul_f32 v134, v134, v126
    v_cvt_pk_bf16_f32 v100, v134, v133
    v_cvt_pk_bf16_f32 v101, v132, v131
    s_nop 0
    v_permlane32_swap_b32 v102, v100
    v_permlane32_swap_b32 v103, v101
    s_mov_b32 s89, 0
    buffer_store_dwordx4 v[100:103], v12, s[52:55], s89 offen sc1
    s_waitcnt vmcnt(12)
    s_barrier
    s_add_u32 s97, s98, s0
    s_lshr_b64 s[0:1], s[0:1], 4
    s_and_b32 s97, s97, 15
    s_lshr_b32 s99, s97, 3
    s_xor_b32 s97, s97, s99
    s_add_u32 m0, s87, 0
    s_lshl_b32 s97, s97, 7
    buffer_load_dwordx4 v240, s[28:31], s97 offen offset:0  lds
    v_and_b32 v116, 0xffff0000, v40
    v_and_b32 v117, 0xffff0000, v44
    v_and_b32 v118, 0xffff0000, v48
    v_and_b32 v119, 0xffff0000, v52
    v_and_b32 v120, 0xffff0000, v56
    buffer_load_dwordx4 v241, s[28:31], s97 offen offset:1024  lds
    v_and_b32 v121, 0xffff0000, v60
    v_and_b32 v122, 0xffff0000, v64
    v_lshlrev_b32 v127, 16, v86
    v_and_b32 v128, 0xffff0000, v86
    v_lshlrev_b32 v129, 16, v87
    s_mul_i32 s16, s97, 3072
    s_add_u32 m0, s60, 0
    s_add_u32 s99, s16, s62
    buffer_load_dwordx4 v244, s[32:35], s99 offen offset:0  lds
    v_and_b32 v130, 0xffff0000, v87
    v_and_b32 v123, 0xffff0000, v68
    v_and_b32 v124, 0xffff0000, v72
    v_and_b32 v125, 0xffff0000, v76
    v_and_b32 v126, 0xffff0000, v80
    buffer_load_dwordx4 v245, s[32:35], s99 offen offset:1024  lds
    v_mul_f32 v131, v116, v130
    v_mul_f32 v132, v117, v130
    v_mul_f32 v133, v118, v130
    v_mul_f32 v134, v119, v130
    v_fmac_f32 v131, v117, v129
    buffer_load_dwordx4 v246, s[32:35], s99 offen offset:2048  lds
    v_fmac_f32 v132, v118, v129
    v_fmac_f32 v133, v119, v129
    v_fmac_f32 v134, v120, v129
    v_fmac_f32 v131, v118, v128
    v_fmac_f32 v132, v119, v128
    s_add_u32 m0, s87, 0
    s_nop 0
    buffer_load_dwordx4 v242, s[28:31], s97 offen offset:2048  lds
    v_fmac_f32 v133, v120, v128
    v_fmac_f32 v134, v121, v128
    v_fmac_f32 v131, v119, v127
    v_fmac_f32 v132, v120, v127
    v_fmac_f32 v133, v121, v127
    buffer_load_dwordx4 v243, s[28:31], s97 offen offset:3072  lds
    v_fmac_f32 v134, v122, v127
    v_mul_f32 v131, v131, v123
    v_mul_f32 v132, v132, v124
    v_mul_f32 v133, v133, v125
    v_mul_f32 v134, v134, v126
    s_add_u32 m0, s88, 0
    s_mov_b64 exec, 0xffffffff
    buffer_load_dwordx4 v3, s[28:31], s97 offen offset:0  lds
    s_mov_b64 exec, -1
    v_cvt_pk_bf16_f32 v106, v134, v133
    v_cvt_pk_bf16_f32 v107, v132, v131
    v_and_b32 v116, 0xffff0000, v42
    v_and_b32 v117, 0xffff0000, v46
    v_and_b32 v118, 0xffff0000, v50
    s_add_u32 m0, s61, 12288
    s_add_u32 s16, s16, s63
    buffer_load_dwordx4 v244, s[32:35], s16 offen offset:0  lds
    v_and_b32 v119, 0xffff0000, v54
    v_and_b32 v120, 0xffff0000, v58
    v_and_b32 v121, 0xffff0000, v62
    v_and_b32 v122, 0xffff0000, v66
    v_lshlrev_b32 v127, 16, v94
    buffer_load_dwordx4 v245, s[32:35], s16 offen offset:1024  lds
    v_and_b32 v128, 0xffff0000, v94
    v_lshlrev_b32 v129, 16, v95
    v_and_b32 v130, 0xffff0000, v95
    v_and_b32 v123, 0xffff0000, v70
    v_and_b32 v124, 0xffff0000, v74
    buffer_load_dwordx4 v246, s[32:35], s16 offen offset:2048  lds
    v_and_b32 v125, 0xffff0000, v78
    v_and_b32 v126, 0xffff0000, v82
    v_mul_f32 v131, v116, v130
    v_mul_f32 v132, v117, v130
    v_mul_f32 v133, v118, v130
    v_mul_f32 v134, v119, v130
    v_fmac_f32 v131, v117, v129
    v_fmac_f32 v132, v118, v129
    v_fmac_f32 v133, v119, v129
    v_fmac_f32 v134, v120, v129
    v_fmac_f32 v131, v118, v128
    v_fmac_f32 v132, v119, v128
    v_fmac_f32 v133, v120, v128
    v_fmac_f32 v134, v121, v128
    v_fmac_f32 v131, v119, v127
    v_fmac_f32 v132, v120, v127
    v_fmac_f32 v133, v121, v127
    v_fmac_f32 v134, v122, v127
    v_mul_f32 v131, v131, v123
    v_mul_f32 v132, v132, v124
    v_mul_f32 v133, v133, v125
    v_mul_f32 v134, v134, v126
    v_cvt_pk_bf16_f32 v104, v134, v133
    v_cvt_pk_bf16_f32 v105, v132, v131
    s_nop 0
    v_permlane32_swap_b32 v106, v104
    v_permlane32_swap_b32 v107, v105
    s_mov_b32 s89, 16384
    buffer_store_dwordx4 v[104:107], v12, s[52:55], s89 offen sc1
    s_waitcnt vmcnt(13)
    s_barrier
    s_add_u32 s97, s98, s0
    s_lshr_b64 s[0:1], s[0:1], 4
    s_and_b32 s97, s97, 15
    s_lshr_b32 s99, s97, 3
    s_xor_b32 s97, s97, s99
    s_add_u32 m0, s87, 18432
    s_lshl_b32 s97, s97, 7
    buffer_load_dwordx4 v240, s[28:31], s97 offen offset:0  lds
    v_lshlrev_b32 v116, 16, v41
    v_lshlrev_b32 v117, 16, v45
    v_lshlrev_b32 v118, 16, v49
    v_lshlrev_b32 v119, 16, v53
    v_lshlrev_b32 v120, 16, v57
    buffer_load_dwordx4 v241, s[28:31], s97 offen offset:1024  lds
    v_lshlrev_b32 v121, 16, v61
    v_lshlrev_b32 v122, 16, v65
    v_lshlrev_b32 v127, 16, v88
    v_and_b32 v128, 0xffff0000, v88
    v_lshlrev_b32 v129, 16, v89
    s_mul_i32 s16, s97, 3072
    s_add_u32 m0, s60, 24576
    s_add_u32 s99, s16, s62
    buffer_load_dwordx4 v244, s[32:35], s99 offen offset:0  lds
    v_and_b32 v130, 0xffff0000, v89
    v_lshlrev_b32 v123, 16, v69
    v_lshlrev_b32 v124, 16, v73
    v_lshlrev_b32 v125, 16, v77
    v_lshlrev_b32 v126, 16, v81
    buffer_load_dwordx4 v245, s[32:35], s99 offen offset:1024  lds
    v_mul_f32 v131, v116, v130
    v_mul_f32 v132, v117, v130
    v_mul_f32 v133, v118, v130
    v_mul_f32 v134, v119, v130
    v_fmac_f32 v131, v117, v129
    buffer_load_dwordx4 v246, s[32:35], s99 offen offset:2048  lds
    v_fmac_f32 v132, v118, v129
    v_fmac_f32 v133, v119, v129
    v_fmac_f32 v134, v120, v129
    v_fmac_f32 v131, v118, v128
    v_fmac_f32 v132, v119, v128
    s_add_u32 m0, s87, 18432
    s_nop 0
    buffer_load_dwordx4 v242, s[28:31], s97 offen offset:2048  lds
    v_fmac_f32 v133, v120, v128
    v_fmac_f32 v134, v121, v128
    v_fmac_f32 v131, v119, v127
    v_fmac_f32 v132, v120, v127
    v_fmac_f32 v133, v121, v127
    buffer_load_dwordx4 v243, s[28:31], s97 offen offset:3072  lds
    v_fmac_f32 v134, v122, v127
    v_mul_f32 v131, v131, v123
    v_mul_f32 v132, v132, v124
    v_mul_f32 v133, v133, v125
    v_mul_f32 v134, v134, v126
    s_add_u32 m0, s88, 18432
    s_mov_b64 exec, 0xffffffff
    buffer_load_dwordx4 v3, s[28:31], s97 offen offset:0  lds
    s_mov_b64 exec, -1
    v_cvt_pk_bf16_f32 v110, v134, v133
    v_cvt_pk_bf16_f32 v111, v132, v131
    v_lshlrev_b32 v116, 16, v43
    v_lshlrev_b32 v117, 16, v47
    v_lshlrev_b32 v118, 16, v51
    s_add_u32 m0, s61, 36864
    s_add_u32 s16, s16, s63
    buffer_load_dwordx4 v244, s[32:35], s16 offen offset:0  lds
    v_lshlrev_b32 v119, 16, v55
    v_lshlrev_b32 v120, 16, v59
    v_lshlrev_b32 v121, 16, v63
    v_lshlrev_b32 v122, 16, v67
    v_lshlrev_b32 v127, 16, v96
    buffer_load_dwordx4 v245, s[32:35], s16 offen offset:1024  lds
    v_and_b32 v128, 0xffff0000, v96
    v_lshlrev_b32 v129, 16, v97
    v_and_b32 v130, 0xffff0000, v97
    v_lshlrev_b32 v123, 16, v71
    v_lshlrev_b32 v124, 16, v75
    buffer_load_dwordx4 v246, s[32:35], s16 offen offset:2048  lds
    v_lshlrev_b32 v125, 16, v79
    v_lshlrev_b32 v126, 16, v83
    v_mul_f32 v131, v116, v130
    v_mul_f32 v132, v117, v130
    v_mul_f32 v133, v118, v130
    v_mul_f32 v134, v119, v130
    v_fmac_f32 v131, v117, v129
    v_fmac_f32 v132, v118, v129
    v_fmac_f32 v133, v119, v129
    v_fmac_f32 v134, v120, v129
    v_fmac_f32 v131, v118, v128
    v_fmac_f32 v132, v119, v128
    v_fmac_f32 v133, v120, v128
    v_fmac_f32 v134, v121, v128
    v_fmac_f32 v131, v119, v127
    v_fmac_f32 v132, v120, v127
    v_fmac_f32 v133, v121, v127
    v_fmac_f32 v134, v122, v127
    v_mul_f32 v131, v131, v123
    v_mul_f32 v132, v132, v124
    v_mul_f32 v133, v133, v125
    v_mul_f32 v134, v134, v126
    v_cvt_pk_bf16_f32 v108, v134, v133
    v_cvt_pk_bf16_f32 v109, v132, v131
    s_nop 0
    v_permlane32_swap_b32 v110, v108
    v_permlane32_swap_b32 v111, v109
    s_mov_b32 s89, 32768
    buffer_store_dwordx4 v[108:111], v12, s[52:55], s89 offen sc1
    s_waitcnt vmcnt(13)
    s_barrier
    s_add_u32 s97, s98, s0
    s_lshr_b64 s[0:1], s[0:1], 4
    s_and_b32 s97, s97, 15
    s_lshr_b32 s99, s97, 3
    s_xor_b32 s97, s97, s99
    s_add_u32 m0, s87, 36864
    s_lshl_b32 s97, s97, 7
    buffer_load_dwordx4 v240, s[28:31], s97 offen offset:0  lds
    v_and_b32 v116, 0xffff0000, v41
    v_and_b32 v117, 0xffff0000, v45
    v_and_b32 v118, 0xffff0000, v49
    v_and_b32 v119, 0xffff0000, v53
    v_and_b32 v120, 0xffff0000, v57
    buffer_load_dwordx4 v241, s[28:31], s97 offen offset:1024  lds
    v_and_b32 v121, 0xffff0000, v61
    v_and_b32 v122, 0xffff0000, v65
    v_lshlrev_b32 v127, 16, v90
    v_and_b32 v128, 0xffff0000, v90
    v_lshlrev_b32 v129, 16, v91
    s_mul_i32 s16, s97, 3072
    s_add_u32 m0, s60, 49152
    s_add_u32 s99, s16, s62
    buffer_load_dwordx4 v244, s[32:35], s99 offen offset:0  lds
    v_and_b32 v130, 0xffff0000, v91
    v_and_b32 v123, 0xffff0000, v69
    v_and_b32 v124, 0xffff0000, v73
    v_and_b32 v125, 0xffff0000, v77
    v_and_b32 v126, 0xffff0000, v81
    buffer_load_dwordx4 v245, s[32:35], s99 offen offset:1024  lds
    v_mul_f32 v131, v116, v130
    v_mul_f32 v132, v117, v130
    v_mul_f32 v133, v118, v130
    v_mul_f32 v134, v119, v130
    v_fmac_f32 v131, v117, v129
    buffer_load_dwordx4 v246, s[32:35], s99 offen offset:2048  lds
    v_fmac_f32 v132, v118, v129
    v_fmac_f32 v133, v119, v129
    v_fmac_f32 v134, v120, v129
    v_fmac_f32 v131, v118, v128
    v_fmac_f32 v132, v119, v128
    s_add_u32 m0, s87, 36864
    s_nop 0
    buffer_load_dwordx4 v242, s[28:31], s97 offen offset:2048  lds
    v_fmac_f32 v133, v120, v128
    v_fmac_f32 v134, v121, v128
    v_fmac_f32 v131, v119, v127
    v_fmac_f32 v132, v120, v127
    v_fmac_f32 v133, v121, v127
    buffer_load_dwordx4 v243, s[28:31], s97 offen offset:3072  lds
    v_fmac_f32 v134, v122, v127
    v_mul_f32 v131, v131, v123
    v_mul_f32 v132, v132, v124
    v_mul_f32 v133, v133, v125
    v_mul_f32 v134, v134, v126
    s_add_u32 m0, s88, 36864
    s_mov_b64 exec, 0xffffffff
    buffer_load_dwordx4 v3, s[28:31], s97 offen offset:0  lds
    s_mov_b64 exec, -1
    v_cvt_pk_bf16_f32 v114, v134, v133
    v_cvt_pk_bf16_f32 v115, v132, v131
    v_and_b32 v116, 0xffff0000, v43
    v_and_b32 v117, 0xffff0000, v47
    v_and_b32 v118, 0xffff0000, v51
    s_add_u32 m0, s61, 61440
    s_add_u32 s16, s16, s63
    buffer_load_dwordx4 v244, s[32:35], s16 offen offset:0  lds
    v_and_b32 v119, 0xffff0000, v55
    v_and_b32 v120, 0xffff0000, v59
    v_and_b32 v121, 0xffff0000, v63
    v_and_b32 v122, 0xffff0000, v67
    v_lshlrev_b32 v127, 16, v98
    buffer_load_dwordx4 v245, s[32:35], s16 offen offset:1024  lds
    v_and_b32 v128, 0xffff0000, v98
    v_lshlrev_b32 v129, 16, v99
    v_and_b32 v130, 0xffff0000, v99
    v_and_b32 v123, 0xffff0000, v71
    v_and_b32 v124, 0xffff0000, v75
    buffer_load_dwordx4 v246, s[32:35], s16 offen offset:2048  lds
    v_and_b32 v125, 0xffff0000, v79
    v_and_b32 v126, 0xffff0000, v83
    v_mul_f32 v131, v116, v130
    v_mul_f32 v132, v117, v130
    v_mul_f32 v133, v118, v130
    v_mul_f32 v134, v119, v130
    v_fmac_f32 v131, v117, v129
    v_fmac_f32 v132, v118, v129
    v_fmac_f32 v133, v119, v129
    v_fmac_f32 v134, v120, v129
    v_fmac_f32 v131, v118, v128
    v_fmac_f32 v132, v119, v128
    v_fmac_f32 v133, v120, v128
    v_fmac_f32 v134, v121, v128
    v_fmac_f32 v131, v119, v127
    v_fmac_f32 v132, v120, v127
    v_fmac_f32 v133, v121, v127
    v_fmac_f32 v134, v122, v127
    v_mul_f32 v131, v131, v123
    v_mul_f32 v132, v132, v124
    v_mul_f32 v133, v133, v125
    v_mul_f32 v134, v134, v126
    v_cvt_pk_bf16_f32 v112, v134, v133
    v_cvt_pk_bf16_f32 v113, v132, v131
    s_nop 0
    v_permlane32_swap_b32 v114, v112
    v_permlane32_swap_b32 v115, v113
    s_mov_b32 s89, 49152
    buffer_store_dwordx4 v[112:115], v12, s[52:55], s89 offen sc1
    s_waitcnt vmcnt(13)
    s_barrier
    s_add_u32 s97, s98, s0
    s_lshr_b64 s[0:1], s[0:1], 4
    s_and_b32 s97, s97, 15
    s_lshr_b32 s99, s97, 3
    s_xor_b32 s97, s97, s99
    s_add_u32 m0, s87, 0
    s_lshl_b32 s97, s97, 7
    buffer_load_dwordx4 v240, s[28:31], s97 offen offset:0  lds
    s_mov_b32 s68, s24
    s_mov_b32 s69, s25
    s_mov_b32 s70, 0x100
    s_mov_b32 s71, 0x20000
    v_lshrrev_b32 v6, 5, v0
    buffer_load_dwordx4 v241, s[28:31], s97 offen offset:1024  lds
    v_and_b32 v7, 3, v0
    s_lshr_b32 s78, s90, 1
    s_lshl_b32 s78, s78, 2
    s_load_dword s92, s[14:15], s78
    v_bfe_u32 v5, v0, 2, 2
    s_mul_i32 s16, s97, 3072
    s_add_u32 m0, s60, 0
    s_add_u32 s99, s16, s62
    buffer_load_dwordx4 v244, s[32:35], s99 offen offset:0  lds
    v_lshlrev_b32 v5, 1, v5
    v_lshl_add_u32 v5, v6, 3, v5
    v_bfe_u32 v8, v0, 4, 1
    v_add_u32 v5, v5, v8
    s_and_b32 s78, s3, 1
    buffer_load_dwordx4 v245, s[32:35], s99 offen offset:1024  lds
    s_lshl_b32 s78, s78, 1
    v_add_u32 v8, s78, v6
    v_xor_b32 v8, v8, v7
    v_lshlrev_b32 v8, 4, v8
    buffer_load_dwordx4 v246, s[32:35], s99 offen offset:2048  lds
    v_lshl_add_u32 v5, v5, 6, v8
    v_add_u32 v14, s86, v5
    v_mov_b32 v18, 162304
    v_mov_b32 v19, 1
    v_and_b32 v5, 3, v0
    s_add_u32 m0, s87, 0
    s_nop 0
    buffer_load_dwordx4 v242, s[28:31], s97 offen offset:2048  lds
    s_lshl_b32 s78, s74, 4
    s_add_u32 s78, s78, s3
    v_lshl_add_u32 v6, v5, 2, s78
    s_lshr_b32 s78, s76, 3
    s_lshl_b32 s79, s3, 1
    buffer_load_dwordx4 v243, s[28:31], s97 offen offset:3072  lds
    s_add_u32 s78, s78, s79
    s_xor_b32 s78, s78, 2
    s_lshl_b32 s78, s78, 5
    s_and_b32 s79, s76, 7
    s_add_u32 s78, s78, s79
    s_add_u32 m0, s88, 0
    s_mov_b64 exec, 0xffffffff
    buffer_load_dwordx4 v3, s[28:31], s97 offen offset:0  lds
    s_mov_b64 exec, -1
    v_lshl_add_u32 v7, v5, 3, s78
    v_and_b32 v8, 4, v0
    v_cmp_eq_u32 vcc, 0, v8
    s_nop 1
    v_cndmask_b32 v6, v7, v6, vcc
    s_add_u32 m0, s61, 12288
    s_add_u32 s16, s16, s63
    buffer_load_dwordx4 v244, s[32:35], s16 offen offset:0  lds
    v_and_b32 v33, 0xf0, v6
    v_lshlrev_b32 v34, 8, v6
    v_add_u32 v34, 12582912, v34
    v_and_b32 v5, 15, v0
    v_lshrrev_b32 v6, 4, v0
    buffer_load_dwordx4 v245, s[32:35], s16 offen offset:1024  lds
    v_add_u32 v7, 9, v5
    v_and_b32 v8, 1, v7
    v_mul_u32_u24 v8, 4160, v8
    v_lshrrev_b32 v7, 1, v7
    v_lshl_add_u32 v8, v7, 2, v8
    buffer_load_dwordx4 v246, s[32:35], s16 offen offset:2048  lds
    v_lshlrev_b32 v7, 4, v6
    v_sub_u32 v8, v8, v7
    s_add_u32 s78, s94, 32
    v_add_u32 v21, s78, v8
    s_waitcnt vmcnt(12)
    s_waitcnt vmcnt(11)
    s_barrier
    s_add_u32 m0, s94, 32
    s_lshl_b32 s89, s90, 12
    buffer_load_dwordx4 v15, s[48:51], s89 offen offset:0 nt lds
    v_add_u32 v22, 1024, v21
    v_add_u32 v23, 2048, v21
    v_add_u32 v24, 3072, v21
    v_lshl_add_u32 v7, v5, 1, v6
    s_add_u32 m0, s94, 32
    s_lshl_b32 s89, s90, 12
    buffer_load_dwordx4 v15, s[48:51], s89 offen offset:1024 nt lds
    v_add_u32 v7, 30, v7
    v_and_b32 v8, 1, v7
    v_bfe_u32 v136, v7, 1, 2
    s_add_u32 m0, s94, 32
    s_lshl_b32 s89, s90, 12
    buffer_load_dwordx4 v15, s[48:51], s89 offen offset:2048 nt lds
    v_lshl_add_u32 v136, v8, 2, v136
    v_lshlrev_b32 v136, 6, v136
    v_lshrrev_b32 v7, 3, v7
    v_lshl_add_u32 v136, v7, 9, v136
    s_add_u32 m0, s94, 32
    s_lshl_b32 s89, s90, 12
    buffer_load_dwordx4 v15, s[48:51], s89 offen offset:3072 nt lds
    v_bitop3_b32 v8, v7, 3, s3 bitop3:0x6a
    v_lshl_add_u32 v25, v8, 4, v136
    v_add_u32 v25, 92160, v25
    s_add_u32 s97, s98, s0
    s_lshr_b64 s[0:1], s[0:1], 4
    s_and_b32 s97, s97, 15
    s_lshr_b32 s99, s97, 3
    s_xor_b32 s97, s97, s99
    s_add_u32 m0, s87, 18432
    s_lshl_b32 s97, s97, 7
    buffer_load_dwordx4 v240, s[28:31], s97 offen offset:0  lds
    v_subrev_u32 v7, 1, v7
    v_bitop3_b32 v8, v7, 3, s3 bitop3:0x6a
    v_lshl_add_u32 v27, v8, 4, v136
    v_add_u32 v27, 91648, v27
    buffer_load_dwordx4 v241, s[28:31], s97 offen offset:1024  lds
    v_subrev_u32 v7, 1, v7
    v_bitop3_b32 v8, v7, 3, s3 bitop3:0x6a
    v_lshl_add_u32 v29, v8, 4, v136
    s_mul_i32 s16, s97, 3072
    s_add_u32 m0, s60, 24576
    s_add_u32 s99, s16, s62
    buffer_load_dwordx4 v244, s[32:35], s99 offen offset:0  lds
    v_add_u32 v29, 91136, v29
    v_subrev_u32 v7, 1, v7
    v_bitop3_b32 v8, v7, 3, s3 bitop3:0x6a
    v_lshl_add_u32 v31, v8, 4, v136
    buffer_load_dwordx4 v245, s[32:35], s99 offen offset:1024  lds
    v_add_u32 v31, 90624, v31
    v_lshl_add_u32 v7, v5, 1, v6
    v_add_u32 v7, 26, v7
    buffer_load_dwordx4 v246, s[32:35], s99 offen offset:2048  lds
    v_and_b32 v8, 1, v7
    v_bfe_u32 v136, v7, 1, 2
    v_lshl_add_u32 v136, v8, 2, v136
    v_lshlrev_b32 v136, 6, v136
    s_add_u32 m0, s87, 18432
    s_nop 0
    buffer_load_dwordx4 v242, s[28:31], s97 offen offset:2048  lds
    v_lshrrev_b32 v7, 3, v7
    v_lshl_add_u32 v136, v7, 9, v136
    v_bitop3_b32 v8, v7, 3, s3 bitop3:0x6a
    buffer_load_dwordx4 v243, s[28:31], s97 offen offset:3072  lds
    v_lshl_add_u32 v26, v8, 4, v136
    v_add_u32 v26, 92160, v26
    v_subrev_u32 v7, 1, v7
    v_bitop3_b32 v8, v7, 3, s3 bitop3:0x6a
    s_add_u32 m0, s88, 18432
    s_mov_b64 exec, 0xffffffff
    buffer_load_dwordx4 v3, s[28:31], s97 offen offset:0  lds
    s_mov_b64 exec, -1
    v_lshl_add_u32 v28, v8, 4, v136
    v_add_u32 v28, 91648, v28
    v_subrev_u32 v7, 1, v7
    s_add_u32 m0, s61, 36864
    s_add_u32 s16, s16, s63
    buffer_load_dwordx4 v244, s[32:35], s16 offen offset:0  lds
    v_bitop3_b32 v8, v7, 3, s3 bitop3:0x6a
    v_lshl_add_u32 v30, v8, 4, v136
    v_add_u32 v30, 91136, v30
    v_subrev_u32 v7, 1, v7
    buffer_load_dwordx4 v245, s[32:35], s16 offen offset:1024  lds
    v_bitop3_b32 v8, v7, 3, s3 bitop3:0x6a
    v_lshl_add_u32 v32, v8, 4, v136
    v_add_u32 v32, 90624, v32
    buffer_load_dwordx4 v246, s[32:35], s16 offen offset:2048  lds
    v_lshrrev_b32 v7, 1, v6
    v_lshl_add_u32 v7, v5, 1, v7
    v_add_u32 v7, 32, v7
    s_waitcnt vmcnt(15)
    s_barrier
    s_add_u32 s97, s98, s0
    s_lshr_b64 s[0:1], s[0:1], 4
    s_and_b32 s97, s97, 15
    s_lshr_b32 s99, s97, 3
    s_xor_b32 s97, s97, s99
    s_add_u32 m0, s87, 36864
    s_lshl_b32 s97, s97, 7
    buffer_load_dwordx4 v240, s[28:31], s97 offen offset:0  lds
    v_and_b32 v8, 1, v7
    v_bfe_u32 v136, v7, 1, 2
    v_lshl_add_u32 v136, v8, 2, v136
    v_lshlrev_b32 v136, 6, v136
    buffer_load_dwordx4 v241, s[28:31], s97 offen offset:1024  lds
    v_lshrrev_b32 v7, 3, v7
    v_lshl_add_u32 v136, v7, 9, v136
    v_bitop3_b32 v8, v7, 3, s3 bitop3:0x6a
    v_lshl_add_u32 v20, v8, 4, v136
    s_mul_i32 s16, s97, 3072
    s_add_u32 m0, s60, 49152
    s_add_u32 s99, s16, s62
    buffer_load_dwordx4 v244, s[32:35], s99 offen offset:0  lds
    v_add_u32 v20, 92160, v20
    v_and_b32 v8, 1, v6
    v_xor_b32 v8, 1, v8
    v_lshl_add_u32 v20, v8, 3, v20
    buffer_load_dwordx4 v245, s[32:35], s99 offen offset:1024  lds
    s_waitcnt lgkmcnt(0)
    s_and_b32 s78, s92, 0xffff0000
    s_lshl_b32 s92, s92, 16
    s_bitcmp1_b32 s90, 0
    s_cselect_b32 s92, s78, s92
    buffer_load_dwordx4 v246, s[32:35], s99 offen offset:2048  lds
    v_lshlrev_b32 v7, 3, v6
    v_sub_u32 v7, v7, v5
    v_subrev_u32 v7, 9, v7
    v_and_b32 v8, 1, v7
    s_add_u32 m0, s87, 36864
    s_nop 0
    buffer_load_dwordx4 v242, s[28:31], s97 offen offset:2048  lds
    v_xor_b32 v8, 1, v8
    v_lshlrev_b32 v8, 4, v8
    v_lshrrev_b32 v8, v8, s92
    v_ashrrev_i32 v7, 1, v7
    buffer_load_dwordx4 v243, s[28:31], s97 offen offset:3072  lds
    v_cmp_eq_u32 vcc, 0, v7
    s_nop 1
    v_cndmask_b32 v236, 0, v8, vcc
    v_cmp_eq_u32 vcc, 1, v7
    s_nop 1
    v_cndmask_b32 v237, 0, v8, vcc
    s_add_u32 m0, s88, 36864
    s_mov_b64 exec, 0xffffffff
    buffer_load_dwordx4 v3, s[28:31], s97 offen offset:0  lds
    s_mov_b64 exec, -1
    v_cmp_eq_u32 vcc, 2, v7
    s_nop 1
    v_cndmask_b32 v238, 0, v8, vcc
    v_cmp_eq_u32 vcc, 3, v7
    s_nop 1
    v_cndmask_b32 v239, 0, v8, vcc
    s_add_u32 m0, s61, 61440
    s_add_u32 s16, s16, s63
    buffer_load_dwordx4 v244, s[32:35], s16 offen offset:0  lds
    s_and_b32 s78, s77, 7
    s_mov_b32 s95, 0x76543210
    s_cmp_eq_u32 s78, 1
    s_cselect_b32 s95, 0x76543201, s95
    s_cmp_eq_u32 s78, 2
    s_cselect_b32 s95, 0x76543120, s95
    s_cmp_eq_u32 s78, 3
    s_cselect_b32 s95, 0x76542310, s95
    s_cmp_eq_u32 s78, 4
    s_cselect_b32 s95, 0x76534210, s95
    s_cmp_eq_u32 s78, 5
    s_cselect_b32 s95, 0x76453210, s95
    s_cmp_eq_u32 s78, 6
    s_cselect_b32 s95, 0x75643210, s95
    s_cmp_eq_u32 s78, 7
    s_cselect_b32 s95, 0x67543210, s95
    s_and_b32 s78, s76, 3
    s_mul_i32 s78, s78, 0x22222222
    s_add_u32 s95, s95, s78
    s_bfe_u32 s100, s95, 0x3001c
    s_lshl_b32 s100, s100, 18
    s_bfe_u32 s95, s95, 0x30018
    s_lshl_b32 s95, s95, 18
    v_lshrrev_b32 v136, 4, v0
    v_lshlrev_b32 v136, 1, v136
    v_and_b32 v137, 7, v0
    buffer_load_dwordx4 v245, s[32:35], s16 offen offset:1024  lds
    v_xor_b32 v136, v136, v137
    v_lshlrev_b32 v136, 4, v136
    v_lshrrev_b32 v137, 3, v0
    v_lshl_add_u32 v136, v137, 11, v136
    buffer_load_dwordx4 v246, s[32:35], s16 offen offset:2048  lds
    s_lshl_b32 s78, s77, 7
    s_lshl_b32 s79, s3, 14
    s_add_u32 s78, s78, s79
    v_add_u32 v17, s78, v136
    s_waitcnt vmcnt(11)
    s_barrier
    s_add_u32 s97, s98, s0
    s_lshr_b64 s[0:1], s[0:1], 4
    s_and_b32 s97, s97, 15
    s_lshr_b32 s99, s97, 3
    s_xor_b32 s97, s97, s99
    s_add_u32 m0, s87, 0
    s_lshl_b32 s97, s97, 7
    buffer_load_dwordx4 v240, s[28:31], s97 offen offset:0  lds
    v_add_u32 v5, s94, v15
    ds_read_b128 v[140:143], v5 offset:32
    ds_read_b32 v156, v5 offset:48
    ds_read_b128 v[144:147], v5 offset:1056
    buffer_load_dwordx4 v241, s[28:31], s97 offen offset:1024  lds
    ds_read_b32 v157, v5 offset:1072
    ds_read_b128 v[148:151], v5 offset:2080
    ds_read_b32 v158, v5 offset:2096
    s_mul_i32 s16, s97, 3072
    s_add_u32 m0, s60, 0
    s_add_u32 s99, s16, s62
    buffer_load_dwordx4 v244, s[32:35], s99 offen offset:0  lds
    ds_read_b128 v[152:155], v5 offset:3104
    ds_read_b32 v159, v5 offset:3120
    v_lshrrev_b32 v6, 3, v0
    buffer_load_dwordx4 v245, s[32:35], s99 offen offset:1024  lds
    v_mul_u32_u24 v6, 4160, v6
    v_and_b32 v7, 7, v0
    v_lshl_add_u32 v6, v7, 2, v6
    v_add_u32 v6, s94, v6
    buffer_load_dwordx4 v246, s[32:35], s99 offen offset:2048  lds
    v_mov_b32 v7, 0
    s_waitcnt lgkmcnt(0)
    v_readfirstlane_b32 s93, v140
    s_add_u32 m0, s87, 0
    s_nop 0
    buffer_load_dwordx4 v242, s[28:31], s97 offen offset:2048  lds
    s_lshl_b32 s93, s93, 16
    v_writelane_b32 v7, s93, 15
    v_alignbit_b32 v140, v141, v140, 16
    buffer_load_dwordx4 v243, s[28:31], s97 offen offset:3072  lds
    v_alignbit_b32 v141, v142, v141, 16
    v_alignbit_b32 v142, v143, v142, 16
    v_alignbit_b32 v143, v156, v143, 16
    v_alignbit_b32 v144, v145, v144, 16
    s_add_u32 m0, s88, 0
    s_mov_b64 exec, 0xffffffff
    buffer_load_dwordx4 v3, s[28:31], s97 offen offset:0  lds
    s_mov_b64 exec, -1
    v_alignbit_b32 v145, v146, v145, 16
    v_alignbit_b32 v146, v147, v146, 16
    v_alignbit_b32 v147, v157, v147, 16
    s_add_u32 m0, s61, 12288
    s_add_u32 s16, s16, s63
    buffer_load_dwordx4 v244, s[32:35], s16 offen offset:0  lds
    v_alignbit_b32 v148, v149, v148, 16
    v_alignbit_b32 v149, v150, v149, 16
    v_alignbit_b32 v150, v151, v150, 16
    buffer_load_dwordx4 v245, s[32:35], s16 offen offset:1024  lds
    v_alignbit_b32 v151, v158, v151, 16
    v_alignbit_b32 v152, v153, v152, 16
    v_alignbit_b32 v153, v154, v153, 16
    v_alignbit_b32 v154, v155, v154, 16
    buffer_load_dwordx4 v246, s[32:35], s16 offen offset:2048  lds
    v_alignbit_b32 v155, v159, v155, 16
    v_lshlrev_b32 v8, 3, v0
    s_add_u32 s78, s88, 18432
    s_mov_b64 exec, 0xff
    buffer_load_dword v136, v33, s[68:71], 0 offen sc1
    buffer_load_dword v137, v34, s[52:55], 0 offen sc1
    s_mov_b64 exec, -1
    v_add_u32 v8, s78, v8
    v_mov_b32 v156, 0
    v_mov_b32 v157, 0
    s_waitcnt vmcnt(13)
    s_barrier
    s_waitcnt vmcnt(0)
    s_branch LA_j
LA_c3:
    s_waitcnt vmcnt(7)
    s_barrier
    s_add_u32 m0, s88, 18432
    s_mov_b64 exec, 0xffffffff
    buffer_load_dwordx4 v3, s[28:31], s97 offen offset:0  lds
    s_mov_b64 exec, -1
    s_add_u32 m0, s61, 36864
    s_add_u32 s16, s16, s63
    buffer_load_dwordx4 v244, s[32:35], s16 offen offset:0  lds
    buffer_load_dwordx4 v245, s[32:35], s16 offen offset:1024  lds
    buffer_load_dwordx4 v246, s[32:35], s16 offen offset:2048  lds
    s_add_u32 s97, s98, s0
    s_lshr_b64 s[0:1], s[0:1], 4
    s_and_b32 s97, s97, 15
    s_lshr_b32 s99, s97, 3
    s_xor_b32 s97, s97, s99
    s_add_u32 m0, s87, 36864
    s_lshl_b32 s97, s97, 7
    buffer_load_dwordx4 v240, s[28:31], s97 offen offset:0  lds
    buffer_load_dwordx4 v241, s[28:31], s97 offen offset:1024  lds
    s_mul_i32 s16, s97, 3072
    s_add_u32 m0, s60, 49152
    s_add_u32 s99, s16, s62
    buffer_load_dwordx4 v244, s[32:35], s99 offen offset:0  lds
    buffer_load_dwordx4 v245, s[32:35], s99 offen offset:1024  lds
    buffer_load_dwordx4 v246, s[32:35], s99 offen offset:2048  lds
    s_add_u32 m0, s87, 36864
    s_nop 0
    buffer_load_dwordx4 v242, s[28:31], s97 offen offset:2048  lds
    buffer_load_dwordx4 v243, s[28:31], s97 offen offset:3072  lds
    s_add_u32 m0, s88, 36864
    s_mov_b64 exec, 0xffffffff
    buffer_load_dwordx4 v3, s[28:31], s97 offen offset:0  lds
    s_mov_b64 exec, -1
    s_add_u32 m0, s61, 61440
    s_add_u32 s16, s16, s63
    buffer_load_dwordx4 v244, s[32:35], s16 offen offset:0  lds
    buffer_load_dwordx4 v245, s[32:35], s16 offen offset:1024  lds
    buffer_load_dwordx4 v246, s[32:35], s16 offen offset:2048  lds
    s_waitcnt vmcnt(11)
    s_barrier
    s_add_u32 s97, s98, s0
    s_lshr_b64 s[0:1], s[0:1], 4
    s_and_b32 s97, s97, 15
    s_lshr_b32 s99, s97, 3
    s_xor_b32 s97, s97, s99
    s_add_u32 m0, s87, 0
    s_lshl_b32 s97, s97, 7
    buffer_load_dwordx4 v240, s[28:31], s97 offen offset:0  lds
    buffer_load_dwordx4 v241, s[28:31], s97 offen offset:1024  lds
    s_mul_i32 s16, s97, 3072
    s_add_u32 m0, s60, 0
    s_add_u32 s99, s16, s62
    buffer_load_dwordx4 v244, s[32:35], s99 offen offset:0  lds
    buffer_load_dwordx4 v245, s[32:35], s99 offen offset:1024  lds
    buffer_load_dwordx4 v246, s[32:35], s99 offen offset:2048  lds
    s_add_u32 m0, s87, 0
    s_nop 0
    buffer_load_dwordx4 v242, s[28:31], s97 offen offset:2048  lds
    buffer_load_dwordx4 v243, s[28:31], s97 offen offset:3072  lds
    s_add_u32 m0, s88, 0
    s_mov_b64 exec, 0xffffffff
    buffer_load_dwordx4 v3, s[28:31], s97 offen offset:0  lds
    s_mov_b64 exec, -1
    s_add_u32 m0, s61, 12288
    s_add_u32 s16, s16, s63
    buffer_load_dwordx4 v244, s[32:35], s16 offen offset:0  lds
    buffer_load_dwordx4 v245, s[32:35], s16 offen offset:1024  lds
    buffer_load_dwordx4 v246, s[32:35], s16 offen offset:2048  lds
    s_waitcnt vmcnt(11)
    s_barrier
    s_add_u32 s97, s98, s0
    s_lshr_b64 s[0:1], s[0:1], 4
    s_and_b32 s97, s97, 15
    s_lshr_b32 s99, s97, 3
    s_xor_b32 s97, s97, s99
    s_add_u32 m0, s87, 18432
    s_lshl_b32 s97, s97, 7
    buffer_load_dwordx4 v240, s[28:31], s97 offen offset:0  lds
    buffer_load_dwordx4 v241, s[28:31], s97 offen offset:1024  lds
    s_mul_i32 s16, s97, 3072
    s_add_u32 m0, s60, 24576
    s_add_u32 s99, s16, s62
    buffer_load_dwordx4 v244, s[32:35], s99 offen offset:0  lds
    buffer_load_dwordx4 v245, s[32:35], s99 offen offset:1024  lds
    buffer_load_dwordx4 v246, s[32:35], s99 offen offset:2048  lds
    s_add_u32 m0, s87, 18432
    s_nop 0
    buffer_load_dwordx4 v242, s[28:31], s97 offen offset:2048  lds
    buffer_load_dwordx4 v243, s[28:31], s97 offen offset:3072  lds
    s_add_u32 m0, s88, 18432
    s_mov_b64 exec, 0xffffffff
    buffer_load_dwordx4 v3, s[28:31], s97 offen offset:0  lds
    s_mov_b64 exec, -1
    s_add_u32 m0, s61, 36864
    s_add_u32 s16, s16, s63
    buffer_load_dwordx4 v244, s[32:35], s16 offen offset:0  lds
    buffer_load_dwordx4 v245, s[32:35], s16 offen offset:1024  lds
    buffer_load_dwordx4 v246, s[32:35], s16 offen offset:2048  lds
    s_waitcnt vmcnt(11)
    s_barrier
    s_add_u32 m0, s86, 129536
    s_mov_b32 s89, 0
    buffer_load_dwordx4 v10, s[36:39], s89 offen nt lds
    s_add_u32 m0, s86, 145920
    s_mov_b32 s89, 0
    buffer_load_dwordx4 v10, s[40:43], s89 offen nt lds
    s_add_u32 m0, s86, 133632
    s_mov_b32 s89, 65536
    buffer_load_dwordx4 v10, s[36:39], s89 offen nt lds
    s_add_u32 m0, s86, 150016
    s_mov_b32 s89, 65536
    buffer_load_dwordx4 v10, s[40:43], s89 offen nt lds
    s_add_u32 m0, s86, 137728
    s_mov_b32 s89, 131072
    buffer_load_dwordx4 v10, s[36:39], s89 offen nt lds
    s_add_u32 m0, s86, 154112
    s_mov_b32 s89, 131072
    buffer_load_dwordx4 v10, s[40:43], s89 offen nt lds
    s_add_u32 m0, s86, 141824
    s_mov_b32 s89, 196608
    buffer_load_dwordx4 v10, s[36:39], s89 offen nt lds
    s_add_u32 m0, s86, 158208
    s_mov_b32 s89, 196608
    buffer_load_dwordx4 v10, s[40:43], s89 offen nt lds
    s_mov_b64 exec, 0xff
    s_lshl_b32 s82, s3, 7
    s_add_u32 m0, s82, 129024
    s_mov_b32 s89, 0
    buffer_load_dwordx4 v11, s[36:39], s89 offen nt lds
    s_lshl_b32 s83, s74, 9
    s_add_u32 s83, s83, s82
    s_and_b32 s89, s3, 2
    s_lshl_b32 s89, s89, 3
    s_add_u32 s82, s82, s89
    s_add_u32 m0, s82, 162816
    s_add_u32 s89, s83, 0
    buffer_load_dwordx4 v15, s[44:47], s89 offen  lds
    s_mov_b64 exec, -1
    s_add_u32 s97, s98, s0
    s_lshr_b64 s[0:1], s[0:1], 4
    s_and_b32 s97, s97, 15
    s_lshr_b32 s99, s97, 3
    s_xor_b32 s97, s97, s99
    s_add_u32 m0, s87, 36864
    s_lshl_b32 s97, s97, 7
    buffer_load_dwordx4 v240, s[28:31], s97 offen offset:0  lds
    buffer_load_dwordx4 v241, s[28:31], s97 offen offset:1024  lds
    s_mul_i32 s16, s97, 3072
    s_add_u32 m0, s60, 49152
    s_add_u32 s99, s16, s62
    buffer_load_dwordx4 v244, s[32:35], s99 offen offset:0  lds
    buffer_load_dwordx4 v245, s[32:35], s99 offen offset:1024  lds
    buffer_load_dwordx4 v246, s[32:35], s99 offen offset:2048  lds
    s_add_u32 m0, s87, 36864
    s_nop 0
    buffer_load_dwordx4 v242, s[28:31], s97 offen offset:2048  lds
    buffer_load_dwordx4 v243, s[28:31], s97 offen offset:3072  lds
    s_waitcnt vmcnt(17)
    s_barrier
    s_add_u32 m0, s88, 36864
    s_mov_b64 exec, 0xffffffff
    buffer_load_dwordx4 v3, s[28:31], s97 offen offset:0  lds
    s_mov_b64 exec, -1
    s_add_u32 m0, s61, 61440
    s_add_u32 s16, s16, s63
    buffer_load_dwordx4 v244, s[32:35], s16 offen offset:0  lds
    buffer_load_dwordx4 v245, s[32:35], s16 offen offset:1024  lds
    buffer_load_dwordx4 v246, s[32:35], s16 offen offset:2048  lds
    s_add_u32 s97, s98, s0
    s_lshr_b64 s[0:1], s[0:1], 4
    s_and_b32 s97, s97, 15
    s_lshr_b32 s99, s97, 3
    s_xor_b32 s97, s97, s99
    s_add_u32 m0, s87, 0
    s_lshl_b32 s97, s97, 7
    buffer_load_dwordx4 v240, s[28:31], s97 offen offset:0  lds
    buffer_load_dwordx4 v241, s[28:31], s97 offen offset:1024  lds
    s_mul_i32 s16, s97, 3072
    s_add_u32 m0, s60, 0
    s_add_u32 s99, s16, s62
    buffer_load_dwordx4 v244, s[32:35], s99 offen offset:0  lds
    buffer_load_dwordx4 v245, s[32:35], s99 offen offset:1024  lds
    buffer_load_dwordx4 v246, s[32:35], s99 offen offset:2048  lds
    s_add_u32 m0, s87, 0
    s_nop 0
    buffer_load_dwordx4 v242, s[28:31], s97 offen offset:2048  lds
    buffer_load_dwordx4 v243, s[28:31], s97 offen offset:3072  lds
    s_add_u32 m0, s88, 0
    s_mov_b64 exec, 0xffffffff
    buffer_load_dwordx4 v3, s[28:31], s97 offen offset:0  lds
    s_mov_b64 exec, -1
    s_add_u32 m0, s61, 12288
    s_add_u32 s16, s16, s63
    buffer_load_dwordx4 v244, s[32:35], s16 offen offset:0  lds
    buffer_load_dwordx4 v245, s[32:35], s16 offen offset:1024  lds
    buffer_load_dwordx4 v246, s[32:35], s16 offen offset:2048  lds
    s_waitcnt vmcnt(11)
    s_barrier
    s_add_u32 s97, s98, s0
    s_lshr_b64 s[0:1], s[0:1], 4
    s_and_b32 s97, s97, 15
    s_lshr_b32 s99, s97, 3
    s_xor_b32 s97, s97, s99
    s_add_u32 m0, s87, 18432
    s_lshl_b32 s97, s97, 7
    buffer_load_dwordx4 v240, s[28:31], s97 offen offset:0  lds
    ds_read_b128 v[84:87], v35 offset:0
    ds_read_b128 v[88:91], v35 offset:16
    buffer_load_dwordx4 v241, s[28:31], s97 offen offset:1024  lds
    ds_read_b128 v[92:95], v35 offset:32
    s_mul_i32 s16, s97, 3072
    s_add_u32 m0, s60, 24576
    s_add_u32 s99, s16, s62
    buffer_load_dwordx4 v244, s[32:35], s99 offen offset:0  lds
    ds_read_b128 v[96:99], v35 offset:48
    ds_read_b128 v[40:43], v233 offset:0
    buffer_load_dwordx4 v245, s[32:35], s99 offen offset:1024  lds
    ds_read_b128 v[44:47], v232 offset:256
    buffer_load_dwordx4 v246, s[32:35], s99 offen offset:2048  lds
    ds_read_b128 v[48:51], v233 offset:256
    s_add_u32 m0, s87, 18432
    s_nop 0
    buffer_load_dwordx4 v242, s[28:31], s97 offen offset:2048  lds
    ds_read_b128 v[52:55], v16 offset:512
    ds_read_b128 v[56:59], v231 offset:512
    buffer_load_dwordx4 v243, s[28:31], s97 offen offset:3072  lds
    ds_read_b128 v[60:63], v16 offset:768
    s_add_u32 m0, s88, 18432
    s_mov_b64 exec, 0xffffffff
    buffer_load_dwordx4 v3, s[28:31], s97 offen offset:0  lds
    s_mov_b64 exec, -1
    ds_read_b128 v[64:67], v231 offset:768
    s_add_u32 m0, s61, 36864
    s_add_u32 s16, s16, s63
    buffer_load_dwordx4 v244, s[32:35], s16 offen offset:0  lds
    ds_read_b128 v[68:71], v16 offset:16896
    ds_read_b128 v[72:75], v231 offset:16896
    buffer_load_dwordx4 v245, s[32:35], s16 offen offset:1024  lds
    ds_read_b128 v[76:79], v16 offset:17152
    buffer_load_dwordx4 v246, s[32:35], s16 offen offset:2048  lds
    ds_read_b128 v[80:83], v231 offset:17152
    s_waitcnt vmcnt(11)
    s_waitcnt lgkmcnt(0)
    s_barrier
    s_add_u32 s97, s98, s0
    s_lshr_b64 s[0:1], s[0:1], 4
    s_and_b32 s97, s97, 15
    s_lshr_b32 s99, s97, 3
    s_xor_b32 s97, s97, s99
    s_add_u32 m0, s87, 36864
    s_lshl_b32 s97, s97, 7
    buffer_load_dwordx4 v240, s[28:31], s97 offen offset:0  lds
    v_lshlrev_b32 v116, 16, v40
    v_lshlrev_b32 v117, 16, v44
    v_lshlrev_b32 v118, 16, v48
    v_lshlrev_b32 v119, 16, v52
    v_lshlrev_b32 v120, 16, v56
    buffer_load_dwordx4 v241, s[28:31], s97 offen offset:1024  lds
    v_lshlrev_b32 v121, 16, v60
    v_lshlrev_b32 v122, 16, v64
    v_lshlrev_b32 v127, 16, v84
    v_and_b32 v128, 0xffff0000, v84
    v_lshlrev_b32 v129, 16, v85
    s_mul_i32 s16, s97, 3072
    s_add_u32 m0, s60, 49152
    s_add_u32 s99, s16, s62
    buffer_load_dwordx4 v244, s[32:35], s99 offen offset:0  lds
    v_and_b32 v130, 0xffff0000, v85
    v_lshlrev_b32 v123, 16, v68
    v_lshlrev_b32 v124, 16, v72
    v_lshlrev_b32 v125, 16, v76
    v_lshlrev_b32 v126, 16, v80
    buffer_load_dwordx4 v245, s[32:35], s99 offen offset:1024  lds
    v_mul_f32 v131, v116, v130
    v_mul_f32 v132, v117, v130
    v_mul_f32 v133, v118, v130
    v_mul_f32 v134, v119, v130
    v_fmac_f32 v131, v117, v129
    buffer_load_dwordx4 v246, s[32:35], s99 offen offset:2048  lds
    v_fmac_f32 v132, v118, v129
    v_fmac_f32 v133, v119, v129
    v_fmac_f32 v134, v120, v129
    v_fmac_f32 v131, v118, v128
    v_fmac_f32 v132, v119, v128
    s_add_u32 m0, s87, 36864
    s_nop 0
    buffer_load_dwordx4 v242, s[28:31], s97 offen offset:2048  lds
    v_fmac_f32 v133, v120, v128
    v_fmac_f32 v134, v121, v128
    v_fmac_f32 v131, v119, v127
    v_fmac_f32 v132, v120, v127
    v_fmac_f32 v133, v121, v127
    buffer_load_dwordx4 v243, s[28:31], s97 offen offset:3072  lds
    v_fmac_f32 v134, v122, v127
    v_mul_f32 v131, v131, v123
    v_mul_f32 v132, v132, v124
    v_mul_f32 v133, v133, v125
    v_mul_f32 v134, v134, v126
    s_add_u32 m0, s88, 36864
    s_mov_b64 exec, 0xffffffff
    buffer_load_dwordx4 v3, s[28:31], s97 offen offset:0  lds
    s_mov_b64 exec, -1
    v_cvt_pk_bf16_f32 v102, v134, v133
    v_cvt_pk_bf16_f32 v103, v132, v131
    v_lshlrev_b32 v116, 16, v42
    v_lshlrev_b32 v117, 16, v46
    v_lshlrev_b32 v118, 16, v50
    s_add_u32 m0, s61, 61440
    s_add_u32 s16, s16, s63
    buffer_load_dwordx4 v244, s[32:35], s16 offen offset:0  lds
    v_lshlrev_b32 v119, 16, v54
    v_lshlrev_b32 v120, 16, v58
    v_lshlrev_b32 v121, 16, v62
    v_lshlrev_b32 v122, 16, v66
    v_lshlrev_b32 v127, 16, v92
    buffer_load_dwordx4 v245, s[32:35], s16 offen offset:1024  lds
    v_and_b32 v128, 0xffff0000, v92
    v_lshlrev_b32 v129, 16, v93
    v_and_b32 v130, 0xffff0000, v93
    v_lshlrev_b32 v123, 16, v70
    v_lshlrev_b32 v124, 16, v74
    buffer_load_dwordx4 v246, s[32:35], s16 offen offset:2048  lds
    v_lshlrev_b32 v125, 16, v78
    v_lshlrev_b32 v126, 16, v82
    v_mul_f32 v131, v116, v130
    v_mul_f32 v132, v117, v130
    v_mul_f32 v133, v118, v130
    v_mul_f32 v134, v119, v130
    v_fmac_f32 v131, v117, v129
    v_fmac_f32 v132, v118, v129
    v_fmac_f32 v133, v119, v129
    v_fmac_f32 v134, v120, v129
    v_fmac_f32 v131, v118, v128
    v_fmac_f32 v132, v119, v128
    v_fmac_f32 v133, v120, v128
    v_fmac_f32 v134, v121, v128
    v_fmac_f32 v131, v119, v127
    v_fmac_f32 v132, v120, v127
    v_fmac_f32 v133, v121, v127
    v_fmac_f32 v134, v122, v127
    v_mul_f32 v131, v131, v123
    v_mul_f32 v132, v132, v124
    v_mul_f32 v133, v133, v125
    v_mul_f32 v134, v134, v126
    v_cvt_pk_bf16_f32 v100, v134, v133
    v_cvt_pk_bf16_f32 v101, v132, v131
    s_nop 0
    v_permlane32_swap_b32 v102, v100
    v_permlane32_swap_b32 v103, v101
    s_mov_b32 s89, 0
    buffer_store_dwordx4 v[100:103], v12, s[52:55], s89 offen sc1
    s_waitcnt vmcnt(12)
    s_barrier
    s_add_u32 s97, s98, s0
    s_lshr_b64 s[0:1], s[0:1], 4
    s_and_b32 s97, s97, 15
    s_lshr_b32 s99, s97, 3
    s_xor_b32 s97, s97, s99
    s_add_u32 m0, s87, 0
    s_lshl_b32 s97, s97, 7
    buffer_load_dwordx4 v240, s[28:31], s97 offen offset:0  lds
    v_and_b32 v116, 0xffff0000, v40
    v_and_b32 v117, 0xffff0000, v44
    v_and_b32 v118, 0xffff0000, v48
    v_and_b32 v119, 0xffff0000, v52
    v_and_b32 v120, 0xffff0000, v56
    buffer_load_dwordx4 v241, s[28:31], s97 offen offset:1024  lds
    v_and_b32 v121, 0xffff0000, v60
    v_and_b32 v122, 0xffff0000, v64
    v_lshlrev_b32 v127, 16, v86
    v_and_b32 v128, 0xffff0000, v86
    v_lshlrev_b32 v129, 16, v87
    s_mul_i32 s16, s97, 3072
    s_add_u32 m0, s60, 0
    s_add_u32 s99, s16, s62
    buffer_load_dwordx4 v244, s[32:35], s99 offen offset:0  lds
    v_and_b32 v130, 0xffff0000, v87
    v_and_b32 v123, 0xffff0000, v68
    v_and_b32 v124, 0xffff0000, v72
    v_and_b32 v125, 0xffff0000, v76
    v_and_b32 v126, 0xffff0000, v80
    buffer_load_dwordx4 v245, s[32:35], s99 offen offset:1024  lds
    v_mul_f32 v131, v116, v130
    v_mul_f32 v132, v117, v130
    v_mul_f32 v133, v118, v130
    v_mul_f32 v134, v119, v130
    v_fmac_f32 v131, v117, v129
    buffer_load_dwordx4 v246, s[32:35], s99 offen offset:2048  lds
    v_fmac_f32 v132, v118, v129
    v_fmac_f32 v133, v119, v129
    v_fmac_f32 v134, v120, v129
    v_fmac_f32 v131, v118, v128
    v_fmac_f32 v132, v119, v128
    s_add_u32 m0, s87, 0
    s_nop 0
    buffer_load_dwordx4 v242, s[28:31], s97 offen offset:2048  lds
    v_fmac_f32 v133, v120, v128
    v_fmac_f32 v134, v121, v128
    v_fmac_f32 v131, v119, v127
    v_fmac_f32 v132, v120, v127
    v_fmac_f32 v133, v121, v127
    buffer_load_dwordx4 v243, s[28:31], s97 offen offset:3072  lds
    v_fmac_f32 v134, v122, v127
    v_mul_f32 v131, v131, v123
    v_mul_f32 v132, v132, v124
    v_mul_f32 v133, v133, v125
    v_mul_f32 v134, v134, v126
    s_add_u32 m0, s88, 0
    s_mov_b64 exec, 0xffffffff
    buffer_load_dwordx4 v3, s[28:31], s97 offen offset:0  lds
    s_mov_b64 exec, -1
    v_cvt_pk_bf16_f32 v106, v134, v133
    v_cvt_pk_bf16_f32 v107, v132, v131
    v_and_b32 v116, 0xffff0000, v42
    v_and_b32 v117, 0xffff0000, v46
    v_and_b32 v118, 0xffff0000, v50
    s_add_u32 m0, s61, 12288
    s_add_u32 s16, s16, s63
    buffer_load_dwordx4 v244, s[32:35], s16 offen offset:0  lds
    v_and_b32 v119, 0xffff0000, v54
    v_and_b32 v120, 0xffff0000, v58
    v_and_b32 v121, 0xffff0000, v62
    v_and_b32 v122, 0xffff0000, v66
    v_lshlrev_b32 v127, 16, v94
    buffer_load_dwordx4 v245, s[32:35], s16 offen offset:1024  lds
    v_and_b32 v128, 0xffff0000, v94
    v_lshlrev_b32 v129, 16, v95
    v_and_b32 v130, 0xffff0000, v95
    v_and_b32 v123, 0xffff0000, v70
    v_and_b32 v124, 0xffff0000, v74
    buffer_load_dwordx4 v246, s[32:35], s16 offen offset:2048  lds
    v_and_b32 v125, 0xffff0000, v78
    v_and_b32 v126, 0xffff0000, v82
    v_mul_f32 v131, v116, v130
    v_mul_f32 v132, v117, v130
    v_mul_f32 v133, v118, v130
    v_mul_f32 v134, v119, v130
    v_fmac_f32 v131, v117, v129
    v_fmac_f32 v132, v118, v129
    v_fmac_f32 v133, v119, v129
    v_fmac_f32 v134, v120, v129
    v_fmac_f32 v131, v118, v128
    v_fmac_f32 v132, v119, v128
    v_fmac_f32 v133, v120, v128
    v_fmac_f32 v134, v121, v128
    v_fmac_f32 v131, v119, v127
    v_fmac_f32 v132, v120, v127
    v_fmac_f32 v133, v121, v127
    v_fmac_f32 v134, v122, v127
    v_mul_f32 v131, v131, v123
    v_mul_f32 v132, v132, v124
    v_mul_f32 v133, v133, v125
    v_mul_f32 v134, v134, v126
    v_cvt_pk_bf16_f32 v104, v134, v133
    v_cvt_pk_bf16_f32 v105, v132, v131
    s_nop 0
    v_permlane32_swap_b32 v106, v104
    v_permlane32_swap_b32 v107, v105
    s_mov_b32 s89, 16384
    buffer_store_dwordx4 v[104:107], v12, s[52:55], s89 offen sc1
    s_waitcnt vmcnt(13)
    s_barrier
    s_add_u32 s97, s98, s0
    s_lshr_b64 s[0:1], s[0:1], 4
    s_and_b32 s97, s97, 15
    s_lshr_b32 s99, s97, 3
    s_xor_b32 s97, s97, s99
    s_add_u32 m0, s87, 18432
    s_lshl_b32 s97, s97, 7
    buffer_load_dwordx4 v240, s[28:31], s97 offen offset:0  lds
    v_lshlrev_b32 v116, 16, v41
    v_lshlrev_b32 v117, 16, v45
    v_lshlrev_b32 v118, 16, v49
    v_lshlrev_b32 v119, 16, v53
    v_lshlrev_b32 v120, 16, v57
    buffer_load_dwordx4 v241, s[28:31], s97 offen offset:1024  lds
    v_lshlrev_b32 v121, 16, v61
    v_lshlrev_b32 v122, 16, v65
    v_lshlrev_b32 v127, 16, v88
    v_and_b32 v128, 0xffff0000, v88
    v_lshlrev_b32 v129, 16, v89
    s_mul_i32 s16, s97, 3072
    s_add_u32 m0, s60, 24576
    s_add_u32 s99, s16, s62
    buffer_load_dwordx4 v244, s[32:35], s99 offen offset:0  lds
    v_and_b32 v130, 0xffff0000, v89
    v_lshlrev_b32 v123, 16, v69
    v_lshlrev_b32 v124, 16, v73
    v_lshlrev_b32 v125, 16, v77
    v_lshlrev_b32 v126, 16, v81
    buffer_load_dwordx4 v245, s[32:35], s99 offen offset:1024  lds
    v_mul_f32 v131, v116, v130
    v_mul_f32 v132, v117, v130
    v_mul_f32 v133, v118, v130
    v_mul_f32 v134, v119, v130
    v_fmac_f32 v131, v117, v129
    buffer_load_dwordx4 v246, s[32:35], s99 offen offset:2048  lds
    v_fmac_f32 v132, v118, v129
    v_fmac_f32 v133, v119, v129
    v_fmac_f32 v134, v120, v129
    v_fmac_f32 v131, v118, v128
    v_fmac_f32 v132, v119, v128
    s_add_u32 m0, s87, 18432
    s_nop 0
    buffer_load_dwordx4 v242, s[28:31], s97 offen offset:2048  lds
    v_fmac_f32 v133, v120, v128
    v_fmac_f32 v134, v121, v128
    v_fmac_f32 v131, v119, v127
    v_fmac_f32 v132, v120, v127
    v_fmac_f32 v133, v121, v127
    buffer_load_dwordx4 v243, s[28:31], s97 offen offset:3072  lds
    v_fmac_f32 v134, v122, v127
    v_mul_f32 v131, v131, v123
    v_mul_f32 v132, v132, v124
    v_mul_f32 v133, v133, v125
    v_mul_f32 v134, v134, v126
    s_add_u32 m0, s88, 18432
    s_mov_b64 exec, 0xffffffff
    buffer_load_dwordx4 v3, s[28:31], s97 offen offset:0  lds
    s_mov_b64 exec, -1
    v_cvt_pk_bf16_f32 v110, v134, v133
    v_cvt_pk_bf16_f32 v111, v132, v131
    v_lshlrev_b32 v116, 16, v43
    v_lshlrev_b32 v117, 16, v47
    v_lshlrev_b32 v118, 16, v51
    s_add_u32 m0, s61, 36864
    s_add_u32 s16, s16, s63
    buffer_load_dwordx4 v244, s[32:35], s16 offen offset:0  lds
    v_lshlrev_b32 v119, 16, v55
    v_lshlrev_b32 v120, 16, v59
    v_lshlrev_b32 v121, 16, v63
    v_lshlrev_b32 v122, 16, v67
    v_lshlrev_b32 v127, 16, v96
    buffer_load_dwordx4 v245, s[32:35], s16 offen offset:1024  lds
    v_and_b32 v128, 0xffff0000, v96
    v_lshlrev_b32 v129, 16, v97
    v_and_b32 v130, 0xffff0000, v97
    v_lshlrev_b32 v123, 16, v71
    v_lshlrev_b32 v124, 16, v75
    buffer_load_dwordx4 v246, s[32:35], s16 offen offset:2048  lds
    v_lshlrev_b32 v125, 16, v79
    v_lshlrev_b32 v126, 16, v83
    v_mul_f32 v131, v116, v130
    v_mul_f32 v132, v117, v130
    v_mul_f32 v133, v118, v130
    v_mul_f32 v134, v119, v130
    v_fmac_f32 v131, v117, v129
    v_fmac_f32 v132, v118, v129
    v_fmac_f32 v133, v119, v129
    v_fmac_f32 v134, v120, v129
    v_fmac_f32 v131, v118, v128
    v_fmac_f32 v132, v119, v128
    v_fmac_f32 v133, v120, v128
    v_fmac_f32 v134, v121, v128
    v_fmac_f32 v131, v119, v127
    v_fmac_f32 v132, v120, v127
    v_fmac_f32 v133, v121, v127
    v_fmac_f32 v134, v122, v127
    v_mul_f32 v131, v131, v123
    v_mul_f32 v132, v132, v124
    v_mul_f32 v133, v133, v125
    v_mul_f32 v134, v134, v126
    v_cvt_pk_bf16_f32 v108, v134, v133
    v_cvt_pk_bf16_f32 v109, v132, v131
    s_nop 0
    v_permlane32_swap_b32 v110, v108
    v_permlane32_swap_b32 v111, v109
    s_mov_b32 s89, 32768
    buffer_store_dwordx4 v[108:111], v12, s[52:55], s89 offen sc1
    s_waitcnt vmcnt(13)
    s_barrier
    s_add_u32 s97, s98, s0
    s_lshr_b64 s[0:1], s[0:1], 4
    s_and_b32 s97, s97, 15
    s_lshr_b32 s99, s97, 3
    s_xor_b32 s97, s97, s99
    s_add_u32 m0, s87, 36864
    s_lshl_b32 s97, s97, 7
    buffer_load_dwordx4 v240, s[28:31], s97 offen offset:0  lds
    v_and_b32 v116, 0xffff0000, v41
    v_and_b32 v117, 0xffff0000, v45
    v_and_b32 v118, 0xffff0000, v49
    v_and_b32 v119, 0xffff0000, v53
    v_and_b32 v120, 0xffff0000, v57
    buffer_load_dwordx4 v241, s[28:31], s97 offen offset:1024  lds
    v_and_b32 v121, 0xffff0000, v61
    v_and_b32 v122, 0xffff0000, v65
    v_lshlrev_b32 v127, 16, v90
    v_and_b32 v128, 0xffff0000, v90
    v_lshlrev_b32 v129, 16, v91
    s_mul_i32 s16, s97, 3072
    s_add_u32 m0, s60, 49152
    s_add_u32 s99, s16, s62
    buffer_load_dwordx4 v244, s[32:35], s99 offen offset:0  lds
    v_and_b32 v130, 0xffff0000, v91
    v_and_b32 v123, 0xffff0000, v69
    v_and_b32 v124, 0xffff0000, v73
    v_and_b32 v125, 0xffff0000, v77
    v_and_b32 v126, 0xffff0000, v81
    buffer_load_dwordx4 v245, s[32:35], s99 offen offset:1024  lds
    v_mul_f32 v131, v116, v130
    v_mul_f32 v132, v117, v130
    v_mul_f32 v133, v118, v130
    v_mul_f32 v134, v119, v130
    v_fmac_f32 v131, v117, v129
    buffer_load_dwordx4 v246, s[32:35], s99 offen offset:2048  lds
    v_fmac_f32 v132, v118, v129
    v_fmac_f32 v133, v119, v129
    v_fmac_f32 v134, v120, v129
    v_fmac_f32 v131, v118, v128
    v_fmac_f32 v132, v119, v128
    s_add_u32 m0, s87, 36864
    s_nop 0
    buffer_load_dwordx4 v242, s[28:31], s97 offen offset:2048  lds
    v_fmac_f32 v133, v120, v128
    v_fmac_f32 v134, v121, v128
    v_fmac_f32 v131, v119, v127
    v_fmac_f32 v132, v120, v127
    v_fmac_f32 v133, v121, v127
    buffer_load_dwordx4 v243, s[28:31], s97 offen offset:3072  lds
    v_fmac_f32 v134, v122, v127
    v_mul_f32 v131, v131, v123
    v_mul_f32 v132, v132, v124
    v_mul_f32 v133, v133, v125
    v_mul_f32 v134, v134, v126
    s_add_u32 m0, s88, 36864
    s_mov_b64 exec, 0xffffffff
    buffer_load_dwordx4 v3, s[28:31], s97 offen offset:0  lds
    s_mov_b64 exec, -1
    v_cvt_pk_bf16_f32 v114, v134, v133
    v_cvt_pk_bf16_f32 v115, v132, v131
    v_and_b32 v116, 0xffff0000, v43
    v_and_b32 v117, 0xffff0000, v47
    v_and_b32 v118, 0xffff0000, v51
    s_add_u32 m0, s61, 61440
    s_add_u32 s16, s16, s63
    buffer_load_dwordx4 v244, s[32:35], s16 offen offset:0  lds
    v_and_b32 v119, 0xffff0000, v55
    v_and_b32 v120, 0xffff0000, v59
    v_and_b32 v121, 0xffff0000, v63
    v_and_b32 v122, 0xffff0000, v67
    v_lshlrev_b32 v127, 16, v98
    buffer_load_dwordx4 v245, s[32:35], s16 offen offset:1024  lds
    v_and_b32 v128, 0xffff0000, v98
    v_lshlrev_b32 v129, 16, v99
    v_and_b32 v130, 0xffff0000, v99
    v_and_b32 v123, 0xffff0000, v71
    v_and_b32 v124, 0xffff0000, v75
    buffer_load_dwordx4 v246, s[32:35], s16 offen offset:2048  lds
    v_and_b32 v125, 0xffff0000, v79
    v_and_b32 v126, 0xffff0000, v83
    v_mul_f32 v131, v116, v130
    v_mul_f32 v132, v117, v130
    v_mul_f32 v133, v118, v130
    v_mul_f32 v134, v119, v130
    v_fmac_f32 v131, v117, v129
    v_fmac_f32 v132, v118, v129
    v_fmac_f32 v133, v119, v129
    v_fmac_f32 v134, v120, v129
    v_fmac_f32 v131, v118, v128
    v_fmac_f32 v132, v119, v128
    v_fmac_f32 v133, v120, v128
    v_fmac_f32 v134, v121, v128
    v_fmac_f32 v131, v119, v127
    v_fmac_f32 v132, v120, v127
    v_fmac_f32 v133, v121, v127
    v_fmac_f32 v134, v122, v127
    v_mul_f32 v131, v131, v123
    v_mul_f32 v132, v132, v124
    v_mul_f32 v133, v133, v125
    v_mul_f32 v134, v134, v126
    v_cvt_pk_bf16_f32 v112, v134, v133
    v_cvt_pk_bf16_f32 v113, v132, v131
    s_nop 0
    v_permlane32_swap_b32 v114, v112
    v_permlane32_swap_b32 v115, v113
    s_mov_b32 s89, 49152
    buffer_store_dwordx4 v[112:115], v12, s[52:55], s89 offen sc1
    s_waitcnt vmcnt(13)
    s_barrier
    s_add_u32 s97, s98, s0
    s_lshr_b64 s[0:1], s[0:1], 4
    s_and_b32 s97, s97, 15
    s_lshr_b32 s99, s97, 3
    s_xor_b32 s97, s97, s99
    s_add_u32 m0, s87, 0
    s_lshl_b32 s97, s97, 7
    buffer_load_dwordx4 v240, s[28:31], s97 offen offset:0  lds
    s_mov_b32 s68, s24
    s_mov_b32 s69, s25
    s_mov_b32 s70, 0x100
    s_mov_b32 s71, 0x20000
    v_lshrrev_b32 v6, 5, v0
    buffer_load_dwordx4 v241, s[28:31], s97 offen offset:1024  lds
    v_and_b32 v7, 3, v0
    s_lshr_b32 s78, s90, 1
    s_lshl_b32 s78, s78, 2
    s_load_dword s92, s[14:15], s78
    v_bfe_u32 v5, v0, 2, 2
    s_mul_i32 s16, s97, 3072
    s_add_u32 m0, s60, 0
    s_add_u32 s99, s16, s62
    buffer_load_dwordx4 v244, s[32:35], s99 offen offset:0  lds
    v_lshlrev_b32 v5, 1, v5
    v_lshl_add_u32 v5, v6, 3, v5
    v_bfe_u32 v8, v0, 4, 1
    v_add_u32 v5, v5, v8
    s_and_b32 s78, s3, 1
    buffer_load_dwordx4 v245, s[32:35], s99 offen offset:1024  lds
    s_lshl_b32 s78, s78, 1
    v_add_u32 v8, s78, v6
    v_xor_b32 v8, v8, v7
    v_lshlrev_b32 v8, 4, v8
    buffer_load_dwordx4 v246, s[32:35], s99 offen offset:2048  lds
    v_lshl_add_u32 v5, v5, 6, v8
    v_add_u32 v14, s86, v5
    v_mov_b32 v18, 162304
    v_mov_b32 v19, 1
    v_and_b32 v5, 3, v0
    s_add_u32 m0, s87, 0
    s_nop 0
    buffer_load_dwordx4 v242, s[28:31], s97 offen offset:2048  lds
    s_lshl_b32 s78, s74, 4
    s_add_u32 s78, s78, s3
    v_lshl_add_u32 v6, v5, 2, s78
    s_lshr_b32 s78, s76, 3
    s_lshl_b32 s79, s3, 1
    buffer_load_dwordx4 v243, s[28:31], s97 offen offset:3072  lds
    s_add_u32 s78, s78, s79
    s_xor_b32 s78, s78, 2
    s_lshl_b32 s78, s78, 5
    s_and_b32 s79, s76, 7
    s_add_u32 s78, s78, s79
    s_add_u32 m0, s88, 0
    s_mov_b64 exec, 0xffffffff
    buffer_load_dwordx4 v3, s[28:31], s97 offen offset:0  lds
    s_mov_b64 exec, -1
    v_lshl_add_u32 v7, v5, 3, s78
    v_and_b32 v8, 4, v0
    v_cmp_eq_u32 vcc, 0, v8
    s_nop 1
    v_cndmask_b32 v6, v7, v6, vcc
    s_add_u32 m0, s61, 12288
    s_add_u32 s16, s16, s63
    buffer_load_dwordx4 v244, s[32:35], s16 offen offset:0  lds
    v_and_b32 v33, 0xf0, v6
    v_lshlrev_b32 v34, 8, v6
    v_add_u32 v34, 12582912, v34
    v_and_b32 v5, 15, v0
    v_lshrrev_b32 v6, 4, v0
    buffer_load_dwordx4 v245, s[32:35], s16 offen offset:1024  lds
    v_add_u32 v7, 9, v5
    v_and_b32 v8, 1, v7
    v_mul_u32_u24 v8, 4160, v8
    v_lshrrev_b32 v7, 1, v7
    v_lshl_add_u32 v8, v7, 2, v8
    buffer_load_dwordx4 v246, s[32:35], s16 offen offset:2048  lds
    v_lshlrev_b32 v7, 4, v6
    v_sub_u32 v8, v8, v7
    s_add_u32 s78, s94, 32
    v_add_u32 v21, s78, v8
    s_waitcnt vmcnt(12)
    s_waitcnt vmcnt(11)
    s_barrier
    s_add_u32 m0, s94, 32
    s_lshl_b32 s89, s90, 12
    buffer_load_dwordx4 v15, s[48:51], s89 offen offset:0 nt lds
    v_add_u32 v22, 1024, v21
    v_add_u32 v23, 2048, v21
    v_add_u32 v24, 3072, v21
    v_lshl_add_u32 v7, v5, 1, v6
    s_add_u32 m0, s94, 32
    s_lshl_b32 s89, s90, 12
    buffer_load_dwordx4 v15, s[48:51], s89 offen offset:1024 nt lds
    v_add_u32 v7, 30, v7
    v_and_b32 v8, 1, v7
    v_bfe_u32 v136, v7, 1, 2
    s_add_u32 m0, s94, 32
    s_lshl_b32 s89, s90, 12
    buffer_load_dwordx4 v15, s[48:51], s89 offen offset:2048 nt lds
    v_lshl_add_u32 v136, v8, 2, v136
    v_lshlrev_b32 v136, 6, v136
    v_lshrrev_b32 v7, 3, v7
    v_lshl_add_u32 v136, v7, 9, v136
    s_add_u32 m0, s94, 32
    s_lshl_b32 s89, s90, 12
    buffer_load_dwordx4 v15, s[48:51], s89 offen offset:3072 nt lds
    v_bitop3_b32 v8, v7, 3, s3 bitop3:0x6a
    v_lshl_add_u32 v25, v8, 4, v136
    v_add_u32 v25, 92160, v25
    s_add_u32 s97, s98, s0
    s_lshr_b64 s[0:1], s[0:1], 4
    s_and_b32 s97, s97, 15
    s_lshr_b32 s99, s97, 3
    s_xor_b32 s97, s97, s99
    s_add_u32 m0, s87, 18432
    s_lshl_b32 s97, s97, 7
    buffer_load_dwordx4 v240, s[28:31], s97 offen offset:0  lds
    v_subrev_u32 v7, 1, v7
    v_bitop3_b32 v8, v7, 3, s3 bitop3:0x6a
    v_lshl_add_u32 v27, v8, 4, v136
    v_add_u32 v27, 91648, v27
    buffer_load_dwordx4 v241, s[28:31], s97 offen offset:1024  lds
    v_subrev_u32 v7, 1, v7
    v_bitop3_b32 v8, v7, 3, s3 bitop3:0x6a
    v_lshl_add_u32 v29, v8, 4, v136
    s_mul_i32 s16, s97, 3072
    s_add_u32 m0, s60, 24576
    s_add_u32 s99, s16, s62
    buffer_load_dwordx4 v244, s[32:35], s99 offen offset:0  lds
    v_add_u32 v29, 91136, v29
    v_subrev_u32 v7, 1, v7
    v_bitop3_b32 v8, v7, 3, s3 bitop3:0x6a
    v_lshl_add_u32 v31, v8, 4, v136
    buffer_load_dwordx4 v245, s[32:35], s99 offen offset:1024  lds
    v_add_u32 v31, 90624, v31
    v_lshl_add_u32 v7, v5, 1, v6
    v_add_u32 v7, 26, v7
    buffer_load_dwordx4 v246, s[32:35], s99 offen offset:2048  lds
    v_and_b32 v8, 1, v7
    v_bfe_u32 v136, v7, 1, 2
    v_lshl_add_u32 v136, v8, 2, v136
    v_lshlrev_b32 v136, 6, v136
    s_add_u32 m0, s87, 18432
    s_nop 0
    buffer_load_dwordx4 v242, s[28:31], s97 offen offset:2048  lds
    v_lshrrev_b32 v7, 3, v7
    v_lshl_add_u32 v136, v7, 9, v136
    v_bitop3_b32 v8, v7, 3, s3 bitop3:0x6a
    buffer_load_dwordx4 v243, s[28:31], s97 offen offset:3072  lds
    v_lshl_add_u32 v26, v8, 4, v136
    v_add_u32 v26, 92160, v26
    v_subrev_u32 v7, 1, v7
    v_bitop3_b32 v8, v7, 3, s3 bitop3:0x6a
    s_add_u32 m0, s88, 18432
    s_mov_b64 exec, 0xffffffff
    buffer_load_dwordx4 v3, s[28:31], s97 offen offset:0  lds
    s_mov_b64 exec, -1
    v_lshl_add_u32 v28, v8, 4, v136
    v_add_u32 v28, 91648, v28
    v_subrev_u32 v7, 1, v7
    s_add_u32 m0, s61, 36864
    s_add_u32 s16, s16, s63
    buffer_load_dwordx4 v244, s[32:35], s16 offen offset:0  lds
    v_bitop3_b32 v8, v7, 3, s3 bitop3:0x6a
    v_lshl_add_u32 v30, v8, 4, v136
    v_add_u32 v30, 91136, v30
    v_subrev_u32 v7, 1, v7
    buffer_load_dwordx4 v245, s[32:35], s16 offen offset:1024  lds
    v_bitop3_b32 v8, v7, 3, s3 bitop3:0x6a
    v_lshl_add_u32 v32, v8, 4, v136
    v_add_u32 v32, 90624, v32
    buffer_load_dwordx4 v246, s[32:35], s16 offen offset:2048  lds
    v_lshrrev_b32 v7, 1, v6
    v_lshl_add_u32 v7, v5, 1, v7
    v_add_u32 v7, 32, v7
    s_waitcnt vmcnt(15)
    s_barrier
    s_add_u32 s97, s98, s0
    s_lshr_b64 s[0:1], s[0:1], 4
    s_and_b32 s97, s97, 15
    s_lshr_b32 s99, s97, 3
    s_xor_b32 s97, s97, s99
    s_add_u32 m0, s87, 36864
    s_lshl_b32 s97, s97, 7
    buffer_load_dwordx4 v240, s[28:31], s97 offen offset:0  lds
    v_and_b32 v8, 1, v7
    v_bfe_u32 v136, v7, 1, 2
    v_lshl_add_u32 v136, v8, 2, v136
    v_lshlrev_b32 v136, 6, v136
    buffer_load_dwordx4 v241, s[28:31], s97 offen offset:1024  lds
    v_lshrrev_b32 v7, 3, v7
    v_lshl_add_u32 v136, v7, 9, v136
    v_bitop3_b32 v8, v7, 3, s3 bitop3:0x6a
    v_lshl_add_u32 v20, v8, 4, v136
    s_mul_i32 s16, s97, 3072
    s_add_u32 m0, s60, 49152
    s_add_u32 s99, s16, s62
    buffer_load_dwordx4 v244, s[32:35], s99 offen offset:0  lds
    v_add_u32 v20, 92160, v20
    v_and_b32 v8, 1, v6
    v_xor_b32 v8, 1, v8
    v_lshl_add_u32 v20, v8, 3, v20
    buffer_load_dwordx4 v245, s[32:35], s99 offen offset:1024  lds
    s_waitcnt lgkmcnt(0)
    s_and_b32 s78, s92, 0xffff0000
    s_lshl_b32 s92, s92, 16
    s_bitcmp1_b32 s90, 0
    s_cselect_b32 s92, s78, s92
    buffer_load_dwordx4 v246, s[32:35], s99 offen offset:2048  lds
    v_lshlrev_b32 v7, 3, v6
    v_sub_u32 v7, v7, v5
    v_subrev_u32 v7, 9, v7
    v_and_b32 v8, 1, v7
    s_add_u32 m0, s87, 36864
    s_nop 0
    buffer_load_dwordx4 v242, s[28:31], s97 offen offset:2048  lds
    v_xor_b32 v8, 1, v8
    v_lshlrev_b32 v8, 4, v8
    v_lshrrev_b32 v8, v8, s92
    v_ashrrev_i32 v7, 1, v7
    buffer_load_dwordx4 v243, s[28:31], s97 offen offset:3072  lds
    v_cmp_eq_u32 vcc, 0, v7
    s_nop 1
    v_cndmask_b32 v236, 0, v8, vcc
    v_cmp_eq_u32 vcc, 1, v7
    s_nop 1
    v_cndmask_b32 v237, 0, v8, vcc
    s_add_u32 m0, s88, 36864
    s_mov_b64 exec, 0xffffffff
    buffer_load_dwordx4 v3, s[28:31], s97 offen offset:0  lds
    s_mov_b64 exec, -1
    v_cmp_eq_u32 vcc, 2, v7
    s_nop 1
    v_cndmask_b32 v238, 0, v8, vcc
    v_cmp_eq_u32 vcc, 3, v7
    s_nop 1
    v_cndmask_b32 v239, 0, v8, vcc
    s_add_u32 m0, s61, 61440
    s_add_u32 s16, s16, s63
    buffer_load_dwordx4 v244, s[32:35], s16 offen offset:0  lds
    s_and_b32 s78, s77, 7
    s_mov_b32 s95, 0x76543210
    s_cmp_eq_u32 s78, 1
    s_cselect_b32 s95, 0x76543201, s95
    s_cmp_eq_u32 s78, 2
    s_cselect_b32 s95, 0x76543120, s95
    s_cmp_eq_u32 s78, 3
    s_cselect_b32 s95, 0x76542310, s95
    s_cmp_eq_u32 s78, 4
    s_cselect_b32 s95, 0x76534210, s95
    s_cmp_eq_u32 s78, 5
    s_cselect_b32 s95, 0x76453210, s95
    s_cmp_eq_u32 s78, 6
    s_cselect_b32 s95, 0x75643210, s95
    s_cmp_eq_u32 s78, 7
    s_cselect_b32 s95, 0x67543210, s95
    s_and_b32 s78, s76, 3
    s_mul_i32 s78, s78, 0x22222222
    s_add_u32 s95, s95, s78
    s_bfe_u32 s100, s95, 0x3001c
    s_lshl_b32 s100, s100, 18
    s_bfe_u32 s95, s95, 0x30018
    s_lshl_b32 s95, s95, 18
    v_lshrrev_b32 v136, 4, v0
    v_lshlrev_b32 v136, 1, v136
    v_and_b32 v137, 7, v0
    buffer_load_dwordx4 v245, s[32:35], s16 offen offset:1024  lds
    v_xor_b32 v136, v136, v137
    v_lshlrev_b32 v136, 4, v136
    v_lshrrev_b32 v137, 3, v0
    v_lshl_add_u32 v136, v137, 11, v136
    buffer_load_dwordx4 v246, s[32:35], s16 offen offset:2048  lds
    s_lshl_b32 s78, s77, 7
    s_lshl_b32 s79, s3, 14
    s_add_u32 s78, s78, s79
    v_add_u32 v17, s78, v136
    s_waitcnt vmcnt(11)
    s_barrier
    s_add_u32 s97, s98, s0
    s_lshr_b64 s[0:1], s[0:1], 4
    s_and_b32 s97, s97, 15
    s_lshr_b32 s99, s97, 3
    s_xor_b32 s97, s97, s99
    s_add_u32 m0, s87, 0
    s_lshl_b32 s97, s97, 7
    buffer_load_dwordx4 v240, s[28:31], s97 offen offset:0  lds
    v_add_u32 v5, s94, v15
    ds_read_b128 v[140:143], v5 offset:32
    ds_read_b32 v156, v5 offset:48
    ds_read_b128 v[144:147], v5 offset:1056
    buffer_load_dwordx4 v241, s[28:31], s97 offen offset:1024  lds
    ds_read_b32 v157, v5 offset:1072
    ds_read_b128 v[148:151], v5 offset:2080
    ds_read_b32 v158, v5 offset:2096
    s_mul_i32 s16, s97, 3072
    s_add_u32 m0, s60, 0
    s_add_u32 s99, s16, s62
    buffer_load_dwordx4 v244, s[32:35], s99 offen offset:0  lds
    ds_read_b128 v[152:155], v5 offset:3104
    ds_read_b32 v159, v5 offset:3120
    v_lshrrev_b32 v6, 3, v0
    buffer_load_dwordx4 v245, s[32:35], s99 offen offset:1024  lds
    v_mul_u32_u24 v6, 4160, v6
    v_and_b32 v7, 7, v0
    v_lshl_add_u32 v6, v7, 2, v6
    v_add_u32 v6, s94, v6
    buffer_load_dwordx4 v246, s[32:35], s99 offen offset:2048  lds
    v_mov_b32 v7, 0
    s_waitcnt lgkmcnt(0)
    v_readfirstlane_b32 s93, v140
    s_add_u32 m0, s87, 0
    s_nop 0
    buffer_load_dwordx4 v242, s[28:31], s97 offen offset:2048  lds
    s_lshl_b32 s93, s93, 16
    v_writelane_b32 v7, s93, 15
    v_alignbit_b32 v140, v141, v140, 16
    buffer_load_dwordx4 v243, s[28:31], s97 offen offset:3072  lds
    v_alignbit_b32 v141, v142, v141, 16
    v_alignbit_b32 v142, v143, v142, 16
    v_alignbit_b32 v143, v156, v143, 16
    v_alignbit_b32 v144, v145, v144, 16
    s_add_u32 m0, s88, 0
    s_mov_b64 exec, 0xffffffff
    buffer_load_dwordx4 v3, s[28:31], s97 offen offset:0  lds
    s_mov_b64 exec, -1
    v_alignbit_b32 v145, v146, v145, 16
    v_alignbit_b32 v146, v147, v146, 16
    v_alignbit_b32 v147, v157, v147, 16
    s_add_u32 m0, s61, 12288
    s_add_u32 s16, s16, s63
    buffer_load_dwordx4 v244, s[32:35], s16 offen offset:0  lds
    v_alignbit_b32 v148, v149, v148, 16
    v_alignbit_b32 v149, v150, v149, 16
    v_alignbit_b32 v150, v151, v150, 16
    buffer_load_dwordx4 v245, s[32:35], s16 offen offset:1024  lds
    v_alignbit_b32 v151, v158, v151, 16
    v_alignbit_b32 v152, v153, v152, 16
    v_alignbit_b32 v153, v154, v153, 16
    v_alignbit_b32 v154, v155, v154, 16
    buffer_load_dwordx4 v246, s[32:35], s16 offen offset:2048  lds
    v_alignbit_b32 v155, v159, v155, 16
    v_lshlrev_b32 v8, 3, v0
    s_add_u32 s78, s88, 18432
    s_mov_b64 exec, 0xff
    buffer_load_dword v136, v33, s[68:71], 0 offen sc1
    buffer_load_dword v137, v34, s[52:55], 0 offen sc1
    s_mov_b64 exec, -1
    v_add_u32 v8, s78, v8
    v_mov_b32 v156, 0
    v_mov_b32 v157, 0
    s_waitcnt vmcnt(13)
    s_barrier
    s_waitcnt vmcnt(0)
LA_j:
    s_mov_b64 exec, 1
    ds_add_u32 v18, v19 offset:24
    s_mov_b64 exec, -1
    s_mov_b64 exec, 0xff
    v_cmp_ne_u32 vcc, v136, v137
    v_cmp_gt_u32 s[80:81], s96, v136
    s_nop 0
    s_or_b64 vcc, vcc, s[80:81]
    s_cbranch_vccnz LA_slow
LA_back:
    s_mov_b64 exec, -1
    s_add_u32 m0, s86, 94208
    s_add_u32 s89, s91, 0
    buffer_load_dwordx4 v14, s[52:55], s89 offen sc1 lds
    s_add_u32 m0, s86, 98304
    s_add_u32 s89, s91, 4096
    buffer_load_dwordx4 v14, s[52:55], s89 offen sc1 lds
    s_add_u32 m0, s86, 102400
    s_add_u32 s89, s91, 8192
    buffer_load_dwordx4 v14, s[52:55], s89 offen sc1 lds
    s_add_u32 m0, s86, 106496
    s_add_u32 s89, s91, 12288
    buffer_load_dwordx4 v14, s[52:55], s89 offen sc1 lds
    s_add_u32 s89, s95, 131072
    buffer_load_dwordx4 v[228:231], v17, s[64:67], s89 offen
    s_add_u32 s89, s95, 196608
    buffer_load_dwordx4 v[232:235], v17, s[64:67], s89 offen
    s_add_u32 s89, s100, 0
    buffer_load_dwordx4 v[240:243], v17, s[64:67], s89 offen
    s_add_u32 s89, s100, 65536
    buffer_load_dwordx4 v[244:247], v17, s[64:67], s89 offen
    s_add_u32 s89, s100, 131072
    buffer_load_dwordx4 v[248:251], v17, s[64:67], s89 offen
    s_add_u32 s89, s100, 196608
    buffer_load_dwordx4 v[196:199], v17, s[64:67], s89 offen
    buffer_load_dwordx4 v[212:215], v9, s[56:59], 0 offen offset:0 nt
    buffer_load_dwordx4 v[216:219], v9, s[56:59], 0 offen offset:2048 nt
    buffer_load_dwordx4 v[220:223], v9, s[56:59], s96 offen offset:0 nt
    buffer_load_dwordx4 v[224:227], v9, s[56:59], s96 offen offset:2048 nt
    s_mov_b64 exec, 0xffff
    ds_write_b32 v6, v7
    s_mov_b64 exec, -1
    ds_write_b128 v5, v[140:143] offset:4192
    ds_write_b128 v5, v[144:147] offset:5216
    ds_write_b128 v5, v[148:151] offset:6240
    ds_write_b128 v5, v[152:155] offset:7264
    ds_write_b64 v8, v[156:157]
    ds_read2_b32 v[68:69], v21 offset0:0 offset1:1
    ds_read2_b32 v[70:71], v21 offset0:2 offset1:3
    ds_read2_b32 v[72:73], v21 offset0:128 offset1:129
    ds_read2_b32 v[74:75], v21 offset0:130 offset1:131
    ds_read2_b32 v[76:77], v22 offset0:0 offset1:1
    ds_read2_b32 v[78:79], v22 offset0:2 offset1:3
    ds_read2_b32 v[80:81], v22 offset0:128 offset1:129
    ds_read2_b32 v[82:83], v22 offset0:130 offset1:131
    ds_read2_b32 v[84:85], v23 offset0:0 offset1:1
    ds_read2_b32 v[86:87], v23 offset0:2 offset1:3
    ds_read2_b32 v[88:89], v23 offset0:128 offset1:129
    ds_read2_b32 v[90:91], v23 offset0:130 offset1:131
    ds_read2_b32 v[92:93], v24 offset0:0 offset1:1
    ds_read2_b32 v[94:95], v24 offset0:2 offset1:3
    ds_read2_b32 v[96:97], v24 offset0:128 offset1:129
    ds_read2_b32 v[98:99], v24 offset0:130 offset1:131
    s_waitcnt vmcnt(10)
    s_mov_b64 exec, 1
    ds_add_u32 v18, v19 offset:20
    s_mov_b64 exec, -1
    s_branch LA_s5_in
LA_s5:
    s_sleep 1
LA_s5_in:
    ds_read_b32 v6, v18 offset:20
    s_waitcnt lgkmcnt(0)
    v_readfirstlane_b32 s78, v6
    s_nop 0
    s_cmp_ge_u32 s78, 4
    s_cbranch_scc0 LA_s5
    s_mov_b64 exec, 1
    ds_add_u32 v18, v19 offset:8
    s_mov_b64 exec, -1
    ds_read_b128 v[100:103], v25 offset:0
    ds_read_b128 v[104:107], v25 offset:2048
    ds_read_b128 v[108:111], v25 offset:4096
    ds_read_b128 v[112:115], v25 offset:6144
    ds_read_b128 v[116:119], v25 offset:8192
    ds_read_b128 v[120:123], v25 offset:10240
    ds_read_b128 v[124:127], v25 offset:12288
    ds_read_b128 v[128:131], v25 offset:14336
    s_setprio 2
    s_waitcnt lgkmcnt(7)
    v_mfma_f32_16x16x32_bf16 v[36:39], v[236:239], v[100:103], 0
    ds_read2_b32 v[132:133], v21 offset0:16 offset1:17
    s_waitcnt lgkmcnt(7)
    v_mfma_f32_16x16x32_bf16 v[40:43], v[236:239], v[104:107], 0
    ds_read2_b32 v[134:135], v21 offset0:18 offset1:19
    s_waitcnt lgkmcnt(7)
    v_mfma_f32_16x16x32_bf16 v[44:47], v[236:239], v[108:111], 0
    s_waitcnt lgkmcnt(6)
    v_mfma_f32_16x16x32_bf16 v[48:51], v[236:239], v[112:115], 0
    ds_read_b128 v[164:167], v26 offset:0
    s_waitcnt lgkmcnt(6)
    v_mfma_f32_16x16x32_bf16 v[52:55], v[236:239], v[116:119], 0
    s_waitcnt lgkmcnt(5)
    v_mfma_f32_16x16x32_bf16 v[56:59], v[236:239], v[120:123], 0
    ds_read_b128 v[168:171], v26 offset:2048
    s_waitcnt lgkmcnt(5)
    v_mfma_f32_16x16x32_bf16 v[60:63], v[236:239], v[124:127], 0
    ds_read_b128 v[172:175], v26 offset:4096
    s_waitcnt lgkmcnt(5)
    v_mfma_f32_16x16x32_bf16 v[64:67], v[236:239], v[128:131], 0
    v_mfma_f32_16x16x32_bf16 v[36:39], v[68:71], v[100:103], v[36:39]
    ds_read_b128 v[176:179], v26 offset:6144
    v_mfma_f32_16x16x32_bf16 v[40:43], v[68:71], v[104:107], v[40:43]
    v_mfma_f32_16x16x32_bf16 v[44:47], v[68:71], v[108:111], v[44:47]
    ds_read_b128 v[180:183], v26 offset:8192
    v_mfma_f32_16x16x32_bf16 v[48:51], v[68:71], v[112:115], v[48:51]
    ds_read_b128 v[184:187], v26 offset:10240
    v_mfma_f32_16x16x32_bf16 v[52:55], v[68:71], v[116:119], v[52:55]
    v_mfma_f32_16x16x32_bf16 v[56:59], v[68:71], v[120:123], v[56:59]
    ds_read_b128 v[188:191], v26 offset:12288
    v_mfma_f32_16x16x32_bf16 v[60:63], v[68:71], v[124:127], v[60:63]
    v_mfma_f32_16x16x32_bf16 v[64:67], v[68:71], v[128:131], v[64:67]
    ds_read_b128 v[192:195], v26 offset:14336
    v_mfma_f32_16x16x32_bf16 v[40:43], v[72:75], v[100:103], v[40:43]
    ds_read2_b32 v[136:137], v21 offset0:144 offset1:145
    v_mfma_f32_16x16x32_bf16 v[44:47], v[72:75], v[104:107], v[44:47]
    v_mfma_f32_16x16x32_bf16 v[48:51], v[72:75], v[108:111], v[48:51]
    ds_read2_b32 v[138:139], v21 offset0:146 offset1:147
    v_mfma_f32_16x16x32_bf16 v[52:55], v[72:75], v[112:115], v[52:55]
    v_mfma_f32_16x16x32_bf16 v[56:59], v[72:75], v[116:119], v[56:59]
    ds_read2_b32 v[140:141], v22 offset0:16 offset1:17
    v_mfma_f32_16x16x32_bf16 v[60:63], v[72:75], v[120:123], v[60:63]
    ds_read2_b32 v[142:143], v22 offset0:18 offset1:19
    v_mfma_f32_16x16x32_bf16 v[64:67], v[72:75], v[124:127], v[64:67]
    v_mfma_f32_16x16x32_bf16 v[44:47], v[76:79], v[100:103], v[44:47]
    ds_read2_b32 v[144:145], v22 offset0:144 offset1:145
    v_mfma_f32_16x16x32_bf16 v[48:51], v[76:79], v[104:107], v[48:51]
    v_mfma_f32_16x16x32_bf16 v[52:55], v[76:79], v[108:111], v[52:55]
    ds_read2_b32 v[146:147], v22 offset0:146 offset1:147
    v_mfma_f32_16x16x32_bf16 v[56:59], v[76:79], v[112:115], v[56:59]
    ds_read2_b32 v[148:149], v23 offset0:16 offset1:17
    v_mfma_f32_16x16x32_bf16 v[60:63], v[76:79], v[116:119], v[60:63]
    v_mfma_f32_16x16x32_bf16 v[64:67], v[76:79], v[120:123], v[64:67]
    ds_read2_b32 v[150:151], v23 offset0:18 offset1:19
    v_mfma_f32_16x16x32_bf16 v[48:51], v[80:83], v[100:103], v[48:51]
    v_mfma_f32_16x16x32_bf16 v[52:55], v[80:83], v[104:107], v[52:55]
    ds_read2_b32 v[152:153], v23 offset0:144 offset1:145
    v_mfma_f32_16x16x32_bf16 v[56:59], v[80:83], v[108:111], v[56:59]
    ds_read2_b32 v[154:155], v23 offset0:146 offset1:147
    v_mfma_f32_16x16x32_bf16 v[60:63], v[80:83], v[112:115], v[60:63]
    v_mfma_f32_16x16x32_bf16 v[64:67], v[80:83], v[116:119], v[64:67]
    ds_read2_b32 v[156:157], v24 offset0:16 offset1:17
    v_mfma_f32_16x16x32_bf16 v[52:55], v[84:87], v[100:103], v[52:55]
    v_mfma_f32_16x16x32_bf16 v[56:59], v[84:87], v[104:107], v[56:59]
    ds_read2_b32 v[158:159], v24 offset0:18 offset1:19
    v_mfma_f32_16x16x32_bf16 v[60:63], v[84:87], v[108:111], v[60:63]
    ds_read2_b32 v[160:161], v24 offset0:144 offset1:145
    v_mfma_f32_16x16x32_bf16 v[64:67], v[84:87], v[112:115], v[64:67]
    v_mfma_f32_16x16x32_bf16 v[56:59], v[88:91], v[100:103], v[56:59]
    ds_read2_b32 v[162:163], v24 offset0:146 offset1:147
    v_mfma_f32_16x16x32_bf16 v[60:63], v[88:91], v[104:107], v[60:63]
    v_mfma_f32_16x16x32_bf16 v[64:67], v[88:91], v[108:111], v[64:67]
    v_mfma_f32_16x16x32_bf16 v[60:63], v[92:95], v[100:103], v[60:63]
    v_mfma_f32_16x16x32_bf16 v[64:67], v[92:95], v[104:107], v[64:67]
    v_mfma_f32_16x16x32_bf16 v[64:67], v[96:99], v[100:103], v[64:67]
    s_waitcnt lgkmcnt(14)
    v_mfma_f32_16x16x32_bf16 v[36:39], v[132:135], v[164:167], v[36:39]
    ds_read2_b32 v[68:69], v21 offset0:32 offset1:33
    v_mfma_f32_16x16x32_bf16 v[40:43], v[132:135], v[168:171], v[40:43]
    ds_read2_b32 v[70:71], v21 offset0:34 offset1:35
    v_mfma_f32_16x16x32_bf16 v[44:47], v[132:135], v[172:175], v[44:47]
    ds_read_b128 v[100:103], v27 offset:0
    v_mfma_f32_16x16x32_bf16 v[48:51], v[132:135], v[176:179], v[48:51]
    v_mfma_f32_16x16x32_bf16 v[52:55], v[132:135], v[180:183], v[52:55]
    ds_read_b128 v[104:107], v27 offset:2048
    v_mfma_f32_16x16x32_bf16 v[56:59], v[132:135], v[184:187], v[56:59]
    ds_read_b128 v[108:111], v27 offset:4096
    v_mfma_f32_16x16x32_bf16 v[60:63], v[132:135], v[188:191], v[60:63]
    ds_read_b128 v[112:115], v27 offset:6144
    v_mfma_f32_16x16x32_bf16 v[64:67], v[132:135], v[192:195], v[64:67]
    s_waitcnt lgkmcnt(14)
    v_mfma_f32_16x16x32_bf16 v[40:43], v[136:139], v[164:167], v[40:43]
    ds_read_b128 v[116:119], v27 offset:8192
    v_mfma_f32_16x16x32_bf16 v[44:47], v[136:139], v[168:171], v[44:47]
    ds_read_b128 v[120:123], v27 offset:10240
    v_mfma_f32_16x16x32_bf16 v[48:51], v[136:139], v[172:175], v[48:51]
    ds_read_b128 v[124:127], v27 offset:12288
    v_mfma_f32_16x16x32_bf16 v[52:55], v[136:139], v[176:179], v[52:55]
    v_mfma_f32_16x16x32_bf16 v[56:59], v[136:139], v[180:183], v[56:59]
    ds_read_b128 v[128:131], v27 offset:14336
    v_mfma_f32_16x16x32_bf16 v[60:63], v[136:139], v[184:187], v[60:63]
    ds_read2_b32 v[72:73], v21 offset0:160 offset1:161
    v_mfma_f32_16x16x32_bf16 v[64:67], v[136:139], v[188:191], v[64:67]
    ds_read2_b32 v[74:75], v21 offset0:162 offset1:163
    v_mfma_f32_16x16x32_bf16 v[44:47], v[140:143], v[164:167], v[44:47]
    v_mfma_f32_16x16x32_bf16 v[48:51], v[140:143], v[168:171], v[48:51]
    ds_read2_b32 v[76:77], v22 offset0:32 offset1:33
    v_mfma_f32_16x16x32_bf16 v[52:55], v[140:143], v[172:175], v[52:55]
    ds_read2_b32 v[78:79], v22 offset0:34 offset1:35
    v_mfma_f32_16x16x32_bf16 v[56:59], v[140:143], v[176:179], v[56:59]
    ds_read2_b32 v[80:81], v22 offset0:160 offset1:161
    v_mfma_f32_16x16x32_bf16 v[60:63], v[140:143], v[180:183], v[60:63]
    v_mfma_f32_16x16x32_bf16 v[64:67], v[140:143], v[184:187], v[64:67]
    ds_read2_b32 v[82:83], v22 offset0:162 offset1:163
    v_mfma_f32_16x16x32_bf16 v[48:51], v[144:147], v[164:167], v[48:51]
    ds_read2_b32 v[84:85], v23 offset0:32 offset1:33
    v_mfma_f32_16x16x32_bf16 v[52:55], v[144:147], v[168:171], v[52:55]
    ds_read2_b32 v[86:87], v23 offset0:34 offset1:35
    v_mfma_f32_16x16x32_bf16 v[56:59], v[144:147], v[172:175], v[56:59]
    v_mfma_f32_16x16x32_bf16 v[60:63], v[144:147], v[176:179], v[60:63]
    ds_read2_b32 v[88:89], v23 offset0:160 offset1:161
    v_mfma_f32_16x16x32_bf16 v[64:67], v[144:147], v[180:183], v[64:67]
    ds_read2_b32 v[90:91], v23 offset0:162 offset1:163
    s_waitcnt lgkmcnt(14)
    v_mfma_f32_16x16x32_bf16 v[52:55], v[148:151], v[164:167], v[52:55]
    ds_read2_b32 v[92:93], v24 offset0:32 offset1:33
    v_mfma_f32_16x16x32_bf16 v[56:59], v[148:151], v[168:171], v[56:59]
    v_mfma_f32_16x16x32_bf16 v[60:63], v[148:151], v[172:175], v[60:63]
    ds_read2_b32 v[94:95], v24 offset0:34 offset1:35
    v_mfma_f32_16x16x32_bf16 v[64:67], v[148:151], v[176:179], v[64:67]
    ds_read2_b32 v[96:97], v24 offset0:160 offset1:161
    v_mfma_f32_16x16x32_bf16 v[56:59], v[152:155], v[164:167], v[56:59]
    ds_read2_b32 v[98:99], v24 offset0:162 offset1:163
    v_mfma_f32_16x16x32_bf16 v[60:63], v[152:155], v[168:171], v[60:63]
    v_mfma_f32_16x16x32_bf16 v[64:67], v[152:155], v[172:175], v[64:67]
    v_mfma_f32_16x16x32_bf16 v[60:63], v[156:159], v[164:167], v[60:63]
    v_mfma_f32_16x16x32_bf16 v[64:67], v[156:159], v[168:171], v[64:67]
    v_mfma_f32_16x16x32_bf16 v[64:67], v[160:163], v[164:167], v[64:67]
    v_mfma_f32_16x16x32_bf16 v[36:39], v[68:71], v[100:103], v[36:39]
    ds_read2_b32 v[132:133], v21 offset0:48 offset1:49
    v_mfma_f32_16x16x32_bf16 v[40:43], v[68:71], v[104:107], v[40:43]
    ds_read2_b32 v[134:135], v21 offset0:50 offset1:51
    v_mfma_f32_16x16x32_bf16 v[44:47], v[68:71], v[108:111], v[44:47]
    ds_read_b128 v[164:167], v28 offset:0
    v_mfma_f32_16x16x32_bf16 v[48:51], v[68:71], v[112:115], v[48:51]
    s_waitcnt lgkmcnt(14)
    v_mfma_f32_16x16x32_bf16 v[52:55], v[68:71], v[116:119], v[52:55]
    ds_read_b128 v[168:171], v28 offset:2048
    v_mfma_f32_16x16x32_bf16 v[56:59], v[68:71], v[120:123], v[56:59]
    ds_read_b128 v[172:175], v28 offset:4096
    v_mfma_f32_16x16x32_bf16 v[60:63], v[68:71], v[124:127], v[60:63]
    ds_read_b128 v[176:179], v28 offset:6144
    v_mfma_f32_16x16x32_bf16 v[64:67], v[68:71], v[128:131], v[64:67]
    v_mfma_f32_16x16x32_bf16 v[40:43], v[72:75], v[100:103], v[40:43]
    ds_read_b128 v[180:183], v28 offset:8192
    v_mfma_f32_16x16x32_bf16 v[44:47], v[72:75], v[104:107], v[44:47]
    ds_read_b128 v[184:187], v28 offset:10240
    v_mfma_f32_16x16x32_bf16 v[48:51], v[72:75], v[108:111], v[48:51]
    ds_read_b128 v[188:191], v28 offset:12288
    v_mfma_f32_16x16x32_bf16 v[52:55], v[72:75], v[112:115], v[52:55]
    v_mfma_f32_16x16x32_bf16 v[56:59], v[72:75], v[116:119], v[56:59]
    ds_read_b128 v[192:195], v28 offset:14336
    v_mfma_f32_16x16x32_bf16 v[60:63], v[72:75], v[120:123], v[60:63]
    ds_read2_b32 v[136:137], v21 offset0:176 offset1:177
    v_mfma_f32_16x16x32_bf16 v[64:67], v[72:75], v[124:127], v[64:67]
    ds_read2_b32 v[138:139], v21 offset0:178 offset1:179
    s_waitcnt lgkmcnt(14)
    v_mfma_f32_16x16x32_bf16 v[44:47], v[76:79], v[100:103], v[44:47]
    v_mfma_f32_16x16x32_bf16 v[48:51], v[76:79], v[104:107], v[48:51]
    ds_read2_b32 v[140:141], v22 offset0:48 offset1:49
    v_mfma_f32_16x16x32_bf16 v[52:55], v[76:79], v[108:111], v[52:55]
    ds_read2_b32 v[142:143], v22 offset0:50 offset1:51
    v_mfma_f32_16x16x32_bf16 v[56:59], v[76:79], v[112:115], v[56:59]
    ds_read2_b32 v[144:145], v22 offset0:176 offset1:177
    v_mfma_f32_16x16x32_bf16 v[60:63], v[76:79], v[116:119], v[60:63]
    v_mfma_f32_16x16x32_bf16 v[64:67], v[76:79], v[120:123], v[64:67]
    ds_read2_b32 v[146:147], v22 offset0:178 offset1:179
    v_mfma_f32_16x16x32_bf16 v[48:51], v[80:83], v[100:103], v[48:51]
    ds_read2_b32 v[148:149], v23 offset0:48 offset1:49
    v_mfma_f32_16x16x32_bf16 v[52:55], v[80:83], v[104:107], v[52:55]
    ds_read2_b32 v[150:151], v23 offset0:50 offset1:51
    v_mfma_f32_16x16x32_bf16 v[56:59], v[80:83], v[108:111], v[56:59]
    v_mfma_f32_16x16x32_bf16 v[60:63], v[80:83], v[112:115], v[60:63]
    ds_read2_b32 v[152:153], v23 offset0:176 offset1:177
    v_mfma_f32_16x16x32_bf16 v[64:67], v[80:83], v[116:119], v[64:67]
    ds_read2_b32 v[154:155], v23 offset0:178 offset1:179
    v_mfma_f32_16x16x32_bf16 v[52:55], v[84:87], v[100:103], v[52:55]
    ds_read2_b32 v[156:157], v24 offset0:48 offset1:49
    v_mfma_f32_16x16x32_bf16 v[56:59], v[84:87], v[104:107], v[56:59]
    v_mfma_f32_16x16x32_bf16 v[60:63], v[84:87], v[108:111], v[60:63]
    ds_read2_b32 v[158:159], v24 offset0:50 offset1:51
    v_mfma_f32_16x16x32_bf16 v[64:67], v[84:87], v[112:115], v[64:67]
    ds_read2_b32 v[160:161], v24 offset0:176 offset1:177
    v_mfma_f32_16x16x32_bf16 v[56:59], v[88:91], v[100:103], v[56:59]
    ds_read2_b32 v[162:163], v24 offset0:178 offset1:179
    v_mfma_f32_16x16x32_bf16 v[60:63], v[88:91], v[104:107], v[60:63]
    v_mfma_f32_16x16x32_bf16 v[64:67], v[88:91], v[108:111], v[64:67]
    v_mfma_f32_16x16x32_bf16 v[60:63], v[92:95], v[100:103], v[60:63]
    v_mfma_f32_16x16x32_bf16 v[64:67], v[92:95], v[104:107], v[64:67]
    s_waitcnt lgkmcnt(14)
    v_mfma_f32_16x16x32_bf16 v[64:67], v[96:99], v[100:103], v[64:67]
    v_mfma_f32_16x16x32_bf16 v[36:39], v[132:135], v[164:167], v[36:39]
    ds_read2_b32 v[68:69], v21 offset0:64 offset1:65
    v_mfma_f32_16x16x32_bf16 v[40:43], v[132:135], v[168:171], v[40:43]
    ds_read2_b32 v[70:71], v21 offset0:66 offset1:67
    v_mfma_f32_16x16x32_bf16 v[44:47], v[132:135], v[172:175], v[44:47]
    ds_read_b128 v[100:103], v29 offset:0
    v_mfma_f32_16x16x32_bf16 v[48:51], v[132:135], v[176:179], v[48:51]
    v_mfma_f32_16x16x32_bf16 v[52:55], v[132:135], v[180:183], v[52:55]
    ds_read_b128 v[104:107], v29 offset:2048
    v_mfma_f32_16x16x32_bf16 v[56:59], v[132:135], v[184:187], v[56:59]
    ds_read_b128 v[108:111], v29 offset:4096
    v_mfma_f32_16x16x32_bf16 v[60:63], v[132:135], v[188:191], v[60:63]
    ds_read_b128 v[112:115], v29 offset:6144
    v_mfma_f32_16x16x32_bf16 v[64:67], v[132:135], v[192:195], v[64:67]
    s_waitcnt lgkmcnt(14)
    v_mfma_f32_16x16x32_bf16 v[40:43], v[136:139], v[164:167], v[40:43]
    ds_read_b128 v[116:119], v29 offset:8192
    v_mfma_f32_16x16x32_bf16 v[44:47], v[136:139], v[168:171], v[44:47]
    ds_read_b128 v[120:123], v29 offset:10240
    v_mfma_f32_16x16x32_bf16 v[48:51], v[136:139], v[172:175], v[48:51]
    ds_read_b128 v[124:127], v29 offset:12288
    v_mfma_f32_16x16x32_bf16 v[52:55], v[136:139], v[176:179], v[52:55]
    v_mfma_f32_16x16x32_bf16 v[56:59], v[136:139], v[180:183], v[56:59]
    ds_read_b128 v[128:131], v29 offset:14336
    v_mfma_f32_16x16x32_bf16 v[60:63], v[136:139], v[184:187], v[60:63]
    ds_read2_b32 v[72:73], v21 offset0:192 offset1:193
    v_mfma_f32_16x16x32_bf16 v[64:67], v[136:139], v[188:191], v[64:67]
    ds_read2_b32 v[74:75], v21 offset0:194 offset1:195
    v_mfma_f32_16x16x32_bf16 v[44:47], v[140:143], v[164:167], v[44:47]
    v_mfma_f32_16x16x32_bf16 v[48:51], v[140:143], v[168:171], v[48:51]
    ds_read2_b32 v[76:77], v22 offset0:64 offset1:65
    v_mfma_f32_16x16x32_bf16 v[52:55], v[140:143], v[172:175], v[52:55]
    ds_read2_b32 v[78:79], v22 offset0:66 offset1:67
    v_mfma_f32_16x16x32_bf16 v[56:59], v[140:143], v[176:179], v[56:59]
    ds_read2_b32 v[80:81], v22 offset0:192 offset1:193
    v_mfma_f32_16x16x32_bf16 v[60:63], v[140:143], v[180:183], v[60:63]
    v_mfma_f32_16x16x32_bf16 v[64:67], v[140:143], v[184:187], v[64:67]
    ds_read2_b32 v[82:83], v22 offset0:194 offset1:195
    v_mfma_f32_16x16x32_bf16 v[48:51], v[144:147], v[164:167], v[48:51]
    ds_read2_b32 v[84:85], v23 offset0:64 offset1:65
    v_mfma_f32_16x16x32_bf16 v[52:55], v[144:147], v[168:171], v[52:55]
    ds_read2_b32 v[86:87], v23 offset0:66 offset1:67
    v_mfma_f32_16x16x32_bf16 v[56:59], v[144:147], v[172:175], v[56:59]
    v_mfma_f32_16x16x32_bf16 v[60:63], v[144:147], v[176:179], v[60:63]
    ds_read2_b32 v[88:89], v23 offset0:192 offset1:193
    v_mfma_f32_16x16x32_bf16 v[64:67], v[144:147], v[180:183], v[64:67]
    ds_read2_b32 v[90:91], v23 offset0:194 offset1:195
    s_waitcnt lgkmcnt(14)
    v_mfma_f32_16x16x32_bf16 v[52:55], v[148:151], v[164:167], v[52:55]
    ds_read2_b32 v[92:93], v24 offset0:64 offset1:65
    v_mfma_f32_16x16x32_bf16 v[56:59], v[148:151], v[168:171], v[56:59]
    v_mfma_f32_16x16x32_bf16 v[60:63], v[148:151], v[172:175], v[60:63]
    ds_read2_b32 v[94:95], v24 offset0:66 offset1:67
    v_mfma_f32_16x16x32_bf16 v[64:67], v[148:151], v[176:179], v[64:67]
    ds_read2_b32 v[96:97], v24 offset0:192 offset1:193
    v_mfma_f32_16x16x32_bf16 v[56:59], v[152:155], v[164:167], v[56:59]
    ds_read2_b32 v[98:99], v24 offset0:194 offset1:195
    v_mfma_f32_16x16x32_bf16 v[60:63], v[152:155], v[168:171], v[60:63]
    v_mfma_f32_16x16x32_bf16 v[64:67], v[152:155], v[172:175], v[64:67]
    v_mfma_f32_16x16x32_bf16 v[60:63], v[156:159], v[164:167], v[60:63]
    v_mfma_f32_16x16x32_bf16 v[64:67], v[156:159], v[168:171], v[64:67]
    v_mfma_f32_16x16x32_bf16 v[64:67], v[160:163], v[164:167], v[64:67]
    v_mfma_f32_16x16x32_bf16 v[36:39], v[68:71], v[100:103], v[36:39]
    ds_read2_b32 v[132:133], v21 offset0:80 offset1:81
    v_mfma_f32_16x16x32_bf16 v[40:43], v[68:71], v[104:107], v[40:43]
    ds_read2_b32 v[134:135], v21 offset0:82 offset1:83
    v_mfma_f32_16x16x32_bf16 v[44:47], v[68:71], v[108:111], v[44:47]
    ds_read_b128 v[164:167], v30 offset:0
    v_mfma_f32_16x16x32_bf16 v[48:51], v[68:71], v[112:115], v[48:51]
    s_waitcnt lgkmcnt(14)
    v_mfma_f32_16x16x32_bf16 v[52:55], v[68:71], v[116:119], v[52:55]
    ds_read_b128 v[168:171], v30 offset:2048
    v_mfma_f32_16x16x32_bf16 v[56:59], v[68:71], v[120:123], v[56:59]
    ds_read_b128 v[172:175], v30 offset:4096
    v_mfma_f32_16x16x32_bf16 v[60:63], v[68:71], v[124:127], v[60:63]
    ds_read_b128 v[176:179], v30 offset:6144
    v_mfma_f32_16x16x32_bf16 v[64:67], v[68:71], v[128:131], v[64:67]
    v_mfma_f32_16x16x32_bf16 v[40:43], v[72:75], v[100:103], v[40:43]
    ds_read_b128 v[180:183], v30 offset:8192
    v_mfma_f32_16x16x32_bf16 v[44:47], v[72:75], v[104:107], v[44:47]
    ds_read_b128 v[184:187], v30 offset:10240
    v_mfma_f32_16x16x32_bf16 v[48:51], v[72:75], v[108:111], v[48:51]
    ds_read_b128 v[188:191], v30 offset:12288
    v_mfma_f32_16x16x32_bf16 v[52:55], v[72:75], v[112:115], v[52:55]
    v_mfma_f32_16x16x32_bf16 v[56:59], v[72:75], v[116:119], v[56:59]
    ds_read_b128 v[192:195], v30 offset:14336
    v_mfma_f32_16x16x32_bf16 v[60:63], v[72:75], v[120:123], v[60:63]
    ds_read2_b32 v[136:137], v21 offset0:208 offset1:209
    v_mfma_f32_16x16x32_bf16 v[64:67], v[72:75], v[124:127], v[64:67]
    ds_read2_b32 v[138:139], v21 offset0:210 offset1:211
    s_waitcnt lgkmcnt(14)
    v_mfma_f32_16x16x32_bf16 v[44:47], v[76:79], v[100:103], v[44:47]
    v_mfma_f32_16x16x32_bf16 v[48:51], v[76:79], v[104:107], v[48:51]
    ds_read2_b32 v[140:141], v22 offset0:80 offset1:81
    v_mfma_f32_16x16x32_bf16 v[52:55], v[76:79], v[108:111], v[52:55]
    ds_read2_b32 v[142:143], v22 offset0:82 offset1:83
    v_mfma_f32_16x16x32_bf16 v[56:59], v[76:79], v[112:115], v[56:59]
    ds_read2_b32 v[144:145], v22 offset0:208 offset1:209
    v_mfma_f32_16x16x32_bf16 v[60:63], v[76:79], v[116:119], v[60:63]
    v_mfma_f32_16x16x32_bf16 v[64:67], v[76:79], v[120:123], v[64:67]
    ds_read2_b32 v[146:147], v22 offset0:210 offset1:211
    v_mfma_f32_16x16x32_bf16 v[48:51], v[80:83], v[100:103], v[48:51]
    ds_read2_b32 v[148:149], v23 offset0:80 offset1:81
    v_mfma_f32_16x16x32_bf16 v[52:55], v[80:83], v[104:107], v[52:55]
    ds_read2_b32 v[150:151], v23 offset0:82 offset1:83
    v_mfma_f32_16x16x32_bf16 v[56:59], v[80:83], v[108:111], v[56:59]
    v_mfma_f32_16x16x32_bf16 v[60:63], v[80:83], v[112:115], v[60:63]
    ds_read2_b32 v[152:153], v23 offset0:208 offset1:209
    v_mfma_f32_16x16x32_bf16 v[64:67], v[80:83], v[116:119], v[64:67]
    ds_read2_b32 v[154:155], v23 offset0:210 offset1:211
    v_mfma_f32_16x16x32_bf16 v[52:55], v[84:87], v[100:103], v[52:55]
    ds_read2_b32 v[156:157], v24 offset0:80 offset1:81
    v_mfma_f32_16x16x32_bf16 v[56:59], v[84:87], v[104:107], v[56:59]
    v_mfma_f32_16x16x32_bf16 v[60:63], v[84:87], v[108:111], v[60:63]
    ds_read2_b32 v[158:159], v24 offset0:82 offset1:83
    v_mfma_f32_16x16x32_bf16 v[64:67], v[84:87], v[112:115], v[64:67]
    ds_read2_b32 v[160:161], v24 offset0:208 offset1:209
    v_mfma_f32_16x16x32_bf16 v[56:59], v[88:91], v[100:103], v[56:59]
    ds_read2_b32 v[162:163], v24 offset0:210 offset1:211
    v_mfma_f32_16x16x32_bf16 v[60:63], v[88:91], v[104:107], v[60:63]
    v_mfma_f32_16x16x32_bf16 v[64:67], v[88:91], v[108:111], v[64:67]
    v_mfma_f32_16x16x32_bf16 v[60:63], v[92:95], v[100:103], v[60:63]
    v_mfma_f32_16x16x32_bf16 v[64:67], v[92:95], v[104:107], v[64:67]
    s_waitcnt lgkmcnt(14)
    v_mfma_f32_16x16x32_bf16 v[64:67], v[96:99], v[100:103], v[64:67]
    v_mfma_f32_16x16x32_bf16 v[36:39], v[132:135], v[164:167], v[36:39]
    ds_read2_b32 v[68:69], v21 offset0:96 offset1:97
    v_mfma_f32_16x16x32_bf16 v[40:43], v[132:135], v[168:171], v[40:43]
    ds_read2_b32 v[70:71], v21 offset0:98 offset1:99
    v_mfma_f32_16x16x32_bf16 v[44:47], v[132:135], v[172:175], v[44:47]
    ds_read_b128 v[100:103], v31 offset:0
    v_mfma_f32_16x16x32_bf16 v[48:51], v[132:135], v[176:179], v[48:51]
    v_mfma_f32_16x16x32_bf16 v[52:55], v[132:135], v[180:183], v[52:55]
    ds_read_b128 v[104:107], v31 offset:2048
    v_mfma_f32_16x16x32_bf16 v[56:59], v[132:135], v[184:187], v[56:59]
    ds_read_b128 v[108:111], v31 offset:4096
    v_mfma_f32_16x16x32_bf16 v[60:63], v[132:135], v[188:191], v[60:63]
    ds_read_b128 v[112:115], v31 offset:6144
    v_mfma_f32_16x16x32_bf16 v[64:67], v[132:135], v[192:195], v[64:67]
    s_waitcnt lgkmcnt(14)
    v_mfma_f32_16x16x32_bf16 v[40:43], v[136:139], v[164:167], v[40:43]
    ds_read_b128 v[116:119], v31 offset:8192
    v_mfma_f32_16x16x32_bf16 v[44:47], v[136:139], v[168:171], v[44:47]
    ds_read_b128 v[120:123], v31 offset:10240
    v_mfma_f32_16x16x32_bf16 v[48:51], v[136:139], v[172:175], v[48:51]
    ds_read_b128 v[124:127], v31 offset:12288
    v_mfma_f32_16x16x32_bf16 v[52:55], v[136:139], v[176:179], v[52:55]
    v_mfma_f32_16x16x32_bf16 v[56:59], v[136:139], v[180:183], v[56:59]
    ds_read_b128 v[128:131], v31 offset:14336
    v_mfma_f32_16x16x32_bf16 v[60:63], v[136:139], v[184:187], v[60:63]
    ds_read2_b32 v[72:73], v21 offset0:224 offset1:225
    v_mfma_f32_16x16x32_bf16 v[64:67], v[136:139], v[188:191], v[64:67]
    ds_read2_b32 v[74:75], v21 offset0:226 offset1:227
    v_mfma_f32_16x16x32_bf16 v[44:47], v[140:143], v[164:167], v[44:47]
    v_mfma_f32_16x16x32_bf16 v[48:51], v[140:143], v[168:171], v[48:51]
    ds_read2_b32 v[76:77], v22 offset0:96 offset1:97
    v_mfma_f32_16x16x32_bf16 v[52:55], v[140:143], v[172:175], v[52:55]
    ds_read2_b32 v[78:79], v22 offset0:98 offset1:99
    v_mfma_f32_16x16x32_bf16 v[56:59], v[140:143], v[176:179], v[56:59]
    ds_read2_b32 v[80:81], v22 offset0:224 offset1:225
    v_mfma_f32_16x16x32_bf16 v[60:63], v[140:143], v[180:183], v[60:63]
    v_mfma_f32_16x16x32_bf16 v[64:67], v[140:143], v[184:187], v[64:67]
    ds_read2_b32 v[82:83], v22 offset0:226 offset1:227
    v_mfma_f32_16x16x32_bf16 v[48:51], v[144:147], v[164:167], v[48:51]
    ds_read2_b32 v[84:85], v23 offset0:96 offset1:97
    v_mfma_f32_16x16x32_bf16 v[52:55], v[144:147], v[168:171], v[52:55]
    ds_read2_b32 v[86:87], v23 offset0:98 offset1:99
    v_mfma_f32_16x16x32_bf16 v[56:59], v[144:147], v[172:175], v[56:59]
    v_mfma_f32_16x16x32_bf16 v[60:63], v[144:147], v[176:179], v[60:63]
    ds_read2_b32 v[88:89], v23 offset0:224 offset1:225
    v_mfma_f32_16x16x32_bf16 v[64:67], v[144:147], v[180:183], v[64:67]
    ds_read2_b32 v[90:91], v23 offset0:226 offset1:227
    s_waitcnt lgkmcnt(14)
    v_mfma_f32_16x16x32_bf16 v[52:55], v[148:151], v[164:167], v[52:55]
    ds_read2_b32 v[92:93], v24 offset0:96 offset1:97
    v_mfma_f32_16x16x32_bf16 v[56:59], v[148:151], v[168:171], v[56:59]
    v_mfma_f32_16x16x32_bf16 v[60:63], v[148:151], v[172:175], v[60:63]
    ds_read2_b32 v[94:95], v24 offset0:98 offset1:99
    v_mfma_f32_16x16x32_bf16 v[64:67], v[148:151], v[176:179], v[64:67]
    ds_read2_b32 v[96:97], v24 offset0:224 offset1:225
    v_mfma_f32_16x16x32_bf16 v[56:59], v[152:155], v[164:167], v[56:59]
    ds_read2_b32 v[98:99], v24 offset0:226 offset1:227
    v_mfma_f32_16x16x32_bf16 v[60:63], v[152:155], v[168:171], v[60:63]
    v_mfma_f32_16x16x32_bf16 v[64:67], v[152:155], v[172:175], v[64:67]
    v_mfma_f32_16x16x32_bf16 v[60:63], v[156:159], v[164:167], v[60:63]
    v_mfma_f32_16x16x32_bf16 v[64:67], v[156:159], v[168:171], v[64:67]
    v_mfma_f32_16x16x32_bf16 v[64:67], v[160:163], v[164:167], v[64:67]
    v_mfma_f32_16x16x32_bf16 v[36:39], v[68:71], v[100:103], v[36:39]
    ds_read2_b32 v[132:133], v21 offset0:112 offset1:113
    v_mfma_f32_16x16x32_bf16 v[40:43], v[68:71], v[104:107], v[40:43]
    ds_read2_b32 v[134:135], v21 offset0:114 offset1:115
    v_mfma_f32_16x16x32_bf16 v[44:47], v[68:71], v[108:111], v[44:47]
    ds_read_b128 v[164:167], v32 offset:0
    v_mfma_f32_16x16x32_bf16 v[48:51], v[68:71], v[112:115], v[48:51]
    s_waitcnt lgkmcnt(14)
    v_mfma_f32_16x16x32_bf16 v[52:55], v[68:71], v[116:119], v[52:55]
    ds_read_b128 v[168:171], v32 offset:2048
    v_mfma_f32_16x16x32_bf16 v[56:59], v[68:71], v[120:123], v[56:59]
    ds_read_b128 v[172:175], v32 offset:4096
    v_mfma_f32_16x16x32_bf16 v[60:63], v[68:71], v[124:127], v[60:63]
    ds_read_b128 v[176:179], v32 offset:6144
    v_mfma_f32_16x16x32_bf16 v[64:67], v[68:71], v[128:131], v[64:67]
    v_mfma_f32_16x16x32_bf16 v[40:43], v[72:75], v[100:103], v[40:43]
    ds_read_b128 v[180:183], v32 offset:8192
    v_mfma_f32_16x16x32_bf16 v[44:47], v[72:75], v[104:107], v[44:47]
    ds_read_b128 v[184:187], v32 offset:10240
    v_mfma_f32_16x16x32_bf16 v[48:51], v[72:75], v[108:111], v[48:51]
    ds_read_b128 v[188:191], v32 offset:12288
    v_mfma_f32_16x16x32_bf16 v[52:55], v[72:75], v[112:115], v[52:55]
    v_mfma_f32_16x16x32_bf16 v[56:59], v[72:75], v[116:119], v[56:59]
    ds_read_b128 v[192:195], v32 offset:14336
    v_mfma_f32_16x16x32_bf16 v[60:63], v[72:75], v[120:123], v[60:63]
    ds_read2_b32 v[136:137], v21 offset0:240 offset1:241
    v_mfma_f32_16x16x32_bf16 v[64:67], v[72:75], v[124:127], v[64:67]
    ds_read2_b32 v[138:139], v21 offset0:242 offset1:243
    s_waitcnt lgkmcnt(14)
    v_mfma_f32_16x16x32_bf16 v[44:47], v[76:79], v[100:103], v[44:47]
    v_mfma_f32_16x16x32_bf16 v[48:51], v[76:79], v[104:107], v[48:51]
    ds_read2_b32 v[140:141], v22 offset0:112 offset1:113
    v_mfma_f32_16x16x32_bf16 v[52:55], v[76:79], v[108:111], v[52:55]
    ds_read2_b32 v[142:143], v22 offset0:114 offset1:115
    v_mfma_f32_16x16x32_bf16 v[56:59], v[76:79], v[112:115], v[56:59]
    ds_read2_b32 v[144:145], v22 offset0:240 offset1:241
    v_mfma_f32_16x16x32_bf16 v[60:63], v[76:79], v[116:119], v[60:63]
    v_mfma_f32_16x16x32_bf16 v[64:67], v[76:79], v[120:123], v[64:67]
    ds_read2_b32 v[146:147], v22 offset0:242 offset1:243
    v_mfma_f32_16x16x32_bf16 v[48:51], v[80:83], v[100:103], v[48:51]
    ds_read2_b32 v[148:149], v23 offset0:112 offset1:113
    v_mfma_f32_16x16x32_bf16 v[52:55], v[80:83], v[104:107], v[52:55]
    ds_read2_b32 v[150:151], v23 offset0:114 offset1:115
    v_mfma_f32_16x16x32_bf16 v[56:59], v[80:83], v[108:111], v[56:59]
    v_mfma_f32_16x16x32_bf16 v[60:63], v[80:83], v[112:115], v[60:63]
    ds_read2_b32 v[152:153], v23 offset0:240 offset1:241
    v_mfma_f32_16x16x32_bf16 v[64:67], v[80:83], v[116:119], v[64:67]
    ds_read2_b32 v[154:155], v23 offset0:242 offset1:243
    v_mfma_f32_16x16x32_bf16 v[52:55], v[84:87], v[100:103], v[52:55]
    ds_read2_b32 v[156:157], v24 offset0:112 offset1:113
    v_mfma_f32_16x16x32_bf16 v[56:59], v[84:87], v[104:107], v[56:59]
    v_mfma_f32_16x16x32_bf16 v[60:63], v[84:87], v[108:111], v[60:63]
    ds_read2_b32 v[158:159], v24 offset0:114 offset1:115
    v_mfma_f32_16x16x32_bf16 v[64:67], v[84:87], v[112:115], v[64:67]
    ds_read2_b32 v[160:161], v24 offset0:240 offset1:241
    v_mfma_f32_16x16x32_bf16 v[56:59], v[88:91], v[100:103], v[56:59]
    ds_read2_b32 v[162:163], v24 offset0:242 offset1:243
    v_mfma_f32_16x16x32_bf16 v[60:63], v[88:91], v[104:107], v[60:63]
    v_mfma_f32_16x16x32_bf16 v[64:67], v[88:91], v[108:111], v[64:67]
    v_mfma_f32_16x16x32_bf16 v[60:63], v[92:95], v[100:103], v[60:63]
    v_mfma_f32_16x16x32_bf16 v[64:67], v[92:95], v[104:107], v[64:67]
    s_waitcnt lgkmcnt(14)
    v_mfma_f32_16x16x32_bf16 v[64:67], v[96:99], v[100:103], v[64:67]
    v_mfma_f32_16x16x32_bf16 v[36:39], v[132:135], v[164:167], v[36:39]
    v_mfma_f32_16x16x32_bf16 v[40:43], v[132:135], v[168:171], v[40:43]
    v_mfma_f32_16x16x32_bf16 v[44:47], v[132:135], v[172:175], v[44:47]
    v_mfma_f32_16x16x32_bf16 v[48:51], v[132:135], v[176:179], v[48:51]
    v_mfma_f32_16x16x32_bf16 v[52:55], v[132:135], v[180:183], v[52:55]
    v_mfma_f32_16x16x32_bf16 v[56:59], v[132:135], v[184:187], v[56:59]
    v_mfma_f32_16x16x32_bf16 v[60:63], v[132:135], v[188:191], v[60:63]
    v_mfma_f32_16x16x32_bf16 v[64:67], v[132:135], v[192:195], v[64:67]
    s_waitcnt lgkmcnt(12)
    v_mfma_f32_16x16x32_bf16 v[40:43], v[136:139], v[164:167], v[40:43]
    v_cvt_pk_bf16_f32 v68, v39, v38
    v_cvt_pk_bf16_f32 v69, v37, v36
    v_mfma_f32_16x16x32_bf16 v[44:47], v[136:139], v[168:171], v[44:47]
    ds_write_b64 v20, v[68:69] offset:0
    v_mfma_f32_16x16x32_bf16 v[48:51], v[136:139], v[172:175], v[48:51]
    v_mfma_f32_16x16x32_bf16 v[52:55], v[136:139], v[176:179], v[52:55]
    v_mfma_f32_16x16x32_bf16 v[56:59], v[136:139], v[180:183], v[56:59]
    v_mfma_f32_16x16x32_bf16 v[60:63], v[136:139], v[184:187], v[60:63]
    v_mfma_f32_16x16x32_bf16 v[64:67], v[136:139], v[188:191], v[64:67]
    s_waitcnt lgkmcnt(11)
    v_mfma_f32_16x16x32_bf16 v[44:47], v[140:143], v[164:167], v[44:47]
    v_mfma_f32_16x16x32_bf16 v[48:51], v[140:143], v[168:171], v[48:51]
    v_cvt_pk_bf16_f32 v70, v43, v42
    v_cvt_pk_bf16_f32 v71, v41, v40
    v_mfma_f32_16x16x32_bf16 v[52:55], v[140:143], v[172:175], v[52:55]
    ds_write_b64 v20, v[70:71] offset:2048
    v_mfma_f32_16x16x32_bf16 v[56:59], v[140:143], v[176:179], v[56:59]
    v_mfma_f32_16x16x32_bf16 v[60:63], v[140:143], v[180:183], v[60:63]
    v_mfma_f32_16x16x32_bf16 v[64:67], v[140:143], v[184:187], v[64:67]
    s_waitcnt lgkmcnt(10)
    v_mfma_f32_16x16x32_bf16 v[48:51], v[144:147], v[164:167], v[48:51]
    v_mfma_f32_16x16x32_bf16 v[52:55], v[144:147], v[168:171], v[52:55]
    v_mfma_f32_16x16x32_bf16 v[56:59], v[144:147], v[172:175], v[56:59]
    v_cvt_pk_bf16_f32 v72, v47, v46
    v_cvt_pk_bf16_f32 v73, v45, v44
    v_mfma_f32_16x16x32_bf16 v[60:63], v[144:147], v[176:179], v[60:63]
    ds_write_b64 v20, v[72:73] offset:4096
    v_mfma_f32_16x16x32_bf16 v[64:67], v[144:147], v[180:183], v[64:67]
    s_waitcnt lgkmcnt(9)
    v_mfma_f32_16x16x32_bf16 v[52:55], v[148:151], v[164:167], v[52:55]
    v_mfma_f32_16x16x32_bf16 v[56:59], v[148:151], v[168:171], v[56:59]
    v_mfma_f32_16x16x32_bf16 v[60:63], v[148:151], v[172:175], v[60:63]
    v_mfma_f32_16x16x32_bf16 v[64:67], v[148:151], v[176:179], v[64:67]
    v_cvt_pk_bf16_f32 v74, v51, v50
    v_cvt_pk_bf16_f32 v75, v49, v48
    s_waitcnt lgkmcnt(7)
    v_mfma_f32_16x16x32_bf16 v[56:59], v[152:155], v[164:167], v[56:59]
    ds_write_b64 v20, v[74:75] offset:6144
    v_mfma_f32_16x16x32_bf16 v[60:63], v[152:155], v[168:171], v[60:63]
    v_mfma_f32_16x16x32_bf16 v[64:67], v[152:155], v[172:175], v[64:67]
    s_waitcnt lgkmcnt(6)
    v_mfma_f32_16x16x32_bf16 v[60:63], v[156:159], v[164:167], v[60:63]
    v_mfma_f32_16x16x32_bf16 v[64:67], v[156:159], v[168:171], v[64:67]
    v_cvt_pk_bf16_f32 v76, v55, v54
    v_cvt_pk_bf16_f32 v77, v53, v52
    s_waitcnt lgkmcnt(4)
    v_mfma_f32_16x16x32_bf16 v[64:67], v[160:163], v[164:167], v[64:67]
    ds_write_b64 v20, v[76:77] offset:8192
    v_cvt_pk_bf16_f32 v78, v59, v58
    v_cvt_pk_bf16_f32 v79, v57, v56
    ds_write_b64 v20, v[78:79] offset:10240
    v_cvt_pk_bf16_f32 v80, v63, v62
    v_cvt_pk_bf16_f32 v81, v61, v60
    ds_write_b64 v20, v[80:81] offset:12288
    s_nop 0
    v_cvt_pk_bf16_f32 v82, v67, v66
    v_cvt_pk_bf16_f32 v83, v65, v64
    ds_write_b64 v20, v[82:83] offset:14336
    s_mov_b64 exec, 1
    ds_add_u32 v18, v19 offset:12
    s_mov_b64 exec, -1
    s_add_u32 s80, s86, 94208
    v_add_u32 v5, s80, v15
    s_branch LA_s3_in
LA_s3:
    s_sleep 1
LA_s3_in:
    ds_read_b32 v6, v18 offset:12
    ds_read_b128 v[84:87], v5 offset:0
    ds_read_b128 v[88:91], v5 offset:4096
    ds_read_b128 v[92:95], v5 offset:8192
    ds_read_b128 v[96:99], v5 offset:12288
    s_waitcnt lgkmcnt(0)
    v_readfirstlane_b32 s78, v6
    s_nop 0
    s_cmp_ge_u32 s78, 4
    s_cbranch_scc0 LA_s3
    s_add_u32 s89, s91, 4194304
    buffer_store_dwordx4 v[84:87], v14, s[52:55], s89 offen sc1
    s_add_u32 s89, s91, 4198400
    buffer_store_dwordx4 v[88:91], v14, s[52:55], s89 offen sc1
    s_add_u32 s89, s91, 4202496
    buffer_store_dwordx4 v[92:95], v14, s[52:55], s89 offen sc1
    s_add_u32 s89, s91, 4206592
    buffer_store_dwordx4 v[96:99], v14, s[52:55], s89 offen sc1
    s_add_u32 s80, s86, 129024
    v_add_u32 v5, s80, v15
    s_waitcnt vmcnt(13)
    ds_write_b128 v5, v[228:231] offset:0
    s_waitcnt vmcnt(12)
    ds_write_b128 v5, v[232:235] offset:4096
    s_waitcnt vmcnt(11)
    ds_write_b128 v5, v[240:243] offset:8192
    s_waitcnt vmcnt(10)
    ds_write_b128 v5, v[244:247] offset:12288
    s_waitcnt vmcnt(9)
    ds_write_b128 v5, v[248:251] offset:16384
    s_waitcnt vmcnt(8)
    ds_write_b128 v5, v[196:199] offset:20480
    s_mov_b64 exec, 1
    ds_add_u32 v18, v19 offset:32
    s_mov_b64 exec, -1
    s_setprio 0
    s_mov_b32 s60, s22
    s_mov_b32 s61, s23
    s_mov_b32 s62, 0x800000
    s_mov_b32 s63, 0x20000
    s_lshr_b32 s81, s91, 4
    s_lshl_b32 s82, s3, 8
    s_add_u32 s81, s81, s82
    s_add_u32 s81, s81, 12648448
    s_lshl_b32 s80, s74, 14
    s_and_b32 s82, s75, 3
    s_lshl_b32 s82, s82, 8
    s_add_u32 s80, s80, s82
    s_add_u32 s80, s80, 12648448
    v_mov_b32 v5, 0
    v_lshlrev_b32 v7, 10, v0
    s_waitcnt vmcnt(7)
    v_lshlrev_b32 v132, 16, v212
    v_and_b32 v133, 0xffff0000, v212
    v_lshlrev_b32 v134, 16, v213
    v_and_b32 v135, 0xffff0000, v213
    v_lshlrev_b32 v136, 16, v214
    v_and_b32 v137, 0xffff0000, v214
    v_lshlrev_b32 v138, 16, v215
    v_and_b32 v139, 0xffff0000, v215
    s_waitcnt vmcnt(6)
    v_lshlrev_b32 v140, 16, v216
    v_and_b32 v141, 0xffff0000, v216
    v_lshlrev_b32 v142, 16, v217
    v_and_b32 v143, 0xffff0000, v217
    v_lshlrev_b32 v144, 16, v218
    v_and_b32 v145, 0xffff0000, v218
    v_lshlrev_b32 v146, 16, v219
    v_and_b32 v147, 0xffff0000, v219
    s_waitcnt vmcnt(5)
    v_lshlrev_b32 v148, 16, v220
    v_and_b32 v149, 0xffff0000, v220
    v_lshlrev_b32 v150, 16, v221
    v_and_b32 v151, 0xffff0000, v221
    v_lshlrev_b32 v152, 16, v222
    v_and_b32 v153, 0xffff0000, v222
    v_lshlrev_b32 v154, 16, v223
    v_and_b32 v155, 0xffff0000, v223
    s_waitcnt vmcnt(4)
    v_lshlrev_b32 v156, 16, v224
    v_and_b32 v157, 0xffff0000, v224
    v_lshlrev_b32 v158, 16, v225
    v_and_b32 v159, 0xffff0000, v225
    v_lshlrev_b32 v160, 16, v226
    v_and_b32 v161, 0xffff0000, v226
    v_lshlrev_b32 v162, 16, v227
    v_and_b32 v163, 0xffff0000, v227
    s_waitcnt vmcnt(0)
    s_mov_b64 exec, 1
    buffer_store_dword v19, v5, s[52:55], s81 offen sc1
    s_mov_b64 exec, 0xffff
    s_waitcnt vmcnt(0)
    s_branch LA_s7a_in
LA_s7a:
    s_sleep 1
LA_s7a_in:
    ds_read_b32 v6, v18 offset:28
    s_waitcnt lgkmcnt(0)
    v_readfirstlane_b32 s78, v6
    s_nop 0
    s_cmp_ge_u32 s78, 4
    s_cbranch_scc0 LA_s7a
    s_setprio 2
    s_mov_b32 s79, 0
LA_py:
    buffer_load_dword v6, v7, s[52:55], s80 offen sc1
    s_add_u32 s79, s79, 1
    s_cmp_gt_u32 s79, 200000
    s_cbranch_scc1 LA_py_x
    s_waitcnt vmcnt(0)
    v_cmp_ne_u32 vcc, 1, v6
    s_cbranch_vccz LA_py_x
    s_mov_b64 exec, vcc
    s_sleep 8
    s_branch LA_py
LA_py_x:
    s_waitcnt vmcnt(0)
    s_mov_b64 exec, -1
    s_mov_b32 s89, 4194304
    buffer_load_dwordx4 v[100:103], v12, s[52:55], s89 offen sc1
    s_mov_b32 s89, 4210688
    buffer_load_dwordx4 v[104:107], v12, s[52:55], s89 offen sc1
    s_mov_b32 s89, 4227072
    buffer_load_dwordx4 v[108:111], v12, s[52:55], s89 offen sc1
    s_mov_b32 s89, 4243456
    buffer_load_dwordx4 v[112:115], v12, s[52:55], s89 offen sc1
    s_waitcnt vmcnt(3)
    v_permlane32_swap_b32 v102, v100
    v_permlane32_swap_b32 v103, v101
    s_waitcnt vmcnt(2)
    v_permlane32_swap_b32 v106, v104
    v_permlane32_swap_b32 v107, v105
    s_waitcnt vmcnt(1)
    v_permlane32_swap_b32 v110, v108
    v_permlane32_swap_b32 v111, v109
    s_waitcnt vmcnt(0)
    v_permlane32_swap_b32 v114, v112
    v_permlane32_swap_b32 v115, v113
    v_and_b32 v68, 0xffff0000, v103
    v_and_b32 v69, 0xffff0000, v107
    v_and_b32 v70, 0xffff0000, v111
    v_and_b32 v71, 0xffff0000, v115
    v_and_b32 v72, 0xffff0000, v101
    v_and_b32 v73, 0xffff0000, v105
    v_and_b32 v74, 0xffff0000, v109
    v_and_b32 v75, 0xffff0000, v113
    v_mul_f32 v68, v68, v132
    v_mul_f32 v69, v69, v133
    v_mul_f32 v70, v70, v134
    v_mul_f32 v71, v71, v135
    v_mul_f32 v72, v72, v136
    v_mul_f32 v73, v73, v137
    v_mul_f32 v74, v74, v138
    v_mul_f32 v75, v75, v139
    v_cvt_pk_bf16_f32 v36, v68, v69
    v_cvt_pk_bf16_f32 v37, v70, v71
    v_cvt_pk_bf16_f32 v38, v72, v73
    v_cvt_pk_bf16_f32 v39, v74, v75
    s_mov_b32 s89, 0
    buffer_store_dwordx4 v[36:39], v13, s[60:63], s89 offen nt
    v_lshlrev_b32 v68, 16, v103
    v_lshlrev_b32 v69, 16, v107
    v_lshlrev_b32 v70, 16, v111
    v_lshlrev_b32 v71, 16, v115
    v_lshlrev_b32 v72, 16, v101
    v_lshlrev_b32 v73, 16, v105
    v_lshlrev_b32 v74, 16, v109
    v_lshlrev_b32 v75, 16, v113
    v_mul_f32 v68, v68, v140
    v_mul_f32 v69, v69, v141
    v_mul_f32 v70, v70, v142
    v_mul_f32 v71, v71, v143
    v_mul_f32 v72, v72, v144
    v_mul_f32 v73, v73, v145
    v_mul_f32 v74, v74, v146
    v_mul_f32 v75, v75, v147
    v_cvt_pk_bf16_f32 v40, v68, v69
    v_cvt_pk_bf16_f32 v41, v70, v71
    v_cvt_pk_bf16_f32 v42, v72, v73
    v_cvt_pk_bf16_f32 v43, v74, v75
    s_mov_b32 s89, 4096
    buffer_store_dwordx4 v[40:43], v13, s[60:63], s89 offen nt
    v_and_b32 v68, 0xffff0000, v102
    v_and_b32 v69, 0xffff0000, v106
    v_and_b32 v70, 0xffff0000, v110
    v_and_b32 v71, 0xffff0000, v114
    v_and_b32 v72, 0xffff0000, v100
    v_and_b32 v73, 0xffff0000, v104
    v_and_b32 v74, 0xffff0000, v108
    v_and_b32 v75, 0xffff0000, v112
    v_mul_f32 v68, v68, v148
    v_mul_f32 v69, v69, v149
    v_mul_f32 v70, v70, v150
    v_mul_f32 v71, v71, v151
    v_mul_f32 v72, v72, v152
    v_mul_f32 v73, v73, v153
    v_mul_f32 v74, v74, v154
    v_mul_f32 v75, v75, v155
    v_cvt_pk_bf16_f32 v44, v68, v69
    v_cvt_pk_bf16_f32 v45, v70, v71
    v_cvt_pk_bf16_f32 v46, v72, v73
    v_cvt_pk_bf16_f32 v47, v74, v75
    s_mov_b32 s89, 8192
    buffer_store_dwordx4 v[44:47], v13, s[60:63], s89 offen nt
    v_lshlrev_b32 v68, 16, v102
    v_lshlrev_b32 v69, 16, v106
    v_lshlrev_b32 v70, 16, v110
    v_lshlrev_b32 v71, 16, v114
    v_lshlrev_b32 v72, 16, v100
    v_lshlrev_b32 v73, 16, v104
    v_lshlrev_b32 v74, 16, v108
    v_lshlrev_b32 v75, 16, v112
    v_mul_f32 v68, v68, v156
    v_mul_f32 v69, v69, v157
    v_mul_f32 v70, v70, v158
    v_mul_f32 v71, v71, v159
    v_mul_f32 v72, v72, v160
    v_mul_f32 v73, v73, v161
    v_mul_f32 v74, v74, v162
    v_mul_f32 v75, v75, v163
    v_cvt_pk_bf16_f32 v48, v68, v69
    v_cvt_pk_bf16_f32 v49, v70, v71
    v_cvt_pk_bf16_f32 v50, v72, v73
    v_cvt_pk_bf16_f32 v51, v74, v75
    s_mov_b32 s89, 12288
    buffer_store_dwordx4 v[48:51], v13, s[60:63], s89 offen nt
    s_endpgm
L_B:
    s_setprio 3
    s_and_b32 s3, s3, 3
    s_lshr_b32 s78, s2, 3
    s_and_b32 s76, s78, 3
    s_and_b32 s79, s73, 12
    s_add_u32 s76, s76, s79
    s_lshr_b32 s74, s78, 4
    s_add_u32 s74, s74, s79
    s_and_b32 s79, s72, 8
    s_lshr_b32 s77, s78, 2
    s_add_u32 s77, s77, s79
    s_lshr_b32 s79, s79, 2
    s_add_u32 s74, s74, s79
    s_xor_b32 s74, s74, 4
    s_and_b32 s75, s78, 15
    s_lshr_b32 s86, s3, 1
    s_and_b32 s87, s3, 1
    v_mov_b32 v10, 162304
    v_mov_b32 v11, 1
    v_lshlrev_b32 v12, 4, v0
    v_lshl_add_u32 v13, v0, 2, v10
    v_mov_b32 v14, 0
    ds_write_b32 v13, v14
    s_lshl_b32 s78, s74, 4
    s_add_u32 s78, s78, s75
    s_lshl_b32 s96, s78, 8
    s_add_u32 s96, s96, 12582912
    s_lshl_b32 s78, s78, 2
    s_add_u32 s78, s78, s3
    s_lshl_b32 s78, s78, 8
    s_add_u32 s80, s78, 12648448
    s_lshl_b32 s81, s72, 1
    s_add_u32 s81, s81, s86
    s_lshl_b32 s97, s81, 4
    s_add_u32 s97, s97, s73
    s_lshl_b32 s97, s97, 8
    s_add_u32 s97, s97, 12910464
    v_mov_b32 v15, s80
    v_mov_b32 v223, s97
    v_cmp_gt_u32 vcc, 8, v0
    s_nop 1
    v_cndmask_b32 v15, v223, v15, vcc
    v_add_u32 v221, v15, v12
    s_lshl_b32 s78, s87, 2
    s_add_u32 s78, s78, 128
    s_add_u32 s97, s97, s78
    s_lshl_b32 s82, s73, 1
    s_add_u32 s82, s82, s87
    s_lshl_b32 s78, s81, 7
    s_add_u32 s78, s78, s82
    s_lshl_b32 s94, s78, 10
    s_add_u32 s94, s94, 8388608
    v_mov_b32 v212, 0
    v_mov_b32 v213, 0
    v_mov_b32 v214, 0
    v_mov_b32 v215, 0
    v_mov_b32 v220, 0
    s_waitcnt lgkmcnt(0)
    s_mov_b32 s52, s26
    s_mov_b32 s53, s27
    s_mov_b32 s54, 0x1000000
    s_mov_b32 s55, 0x20000
    s_mov_b32 s68, s24
    s_mov_b32 s69, s25
    s_mov_b32 s70, 0x100
    s_mov_b32 s71, 0x20000
    s_lshl_b32 s98, s74, 4
    s_or_b32 s78, s75, s3
    s_cmp_lg_u32 s78, 0
    s_cbranch_scc1 LB_notag
    s_mov_b64 exec, 0xffff
    v_lshlrev_b32 v15, 8, v0
    buffer_load_dword v251, v15, s[52:55], s96 offen sc1
LB_notag:
    s_lshl_b32 s78, s87, 3
    s_lshr_b32 exec_lo, 0xffff, s78
    s_mov_b32 exec_hi, 0
    buffer_store_dwordx4 v[212:215], v221, s[52:55], 0 offen sc1
    s_mov_b64 exec, -1
    v_and_b32 v13, 15, v0
    v_lshrrev_b32 v14, 4, v0
    v_lshrrev_b32 v15, 1, v13
    v_xor_b32 v15, v15, v14
    v_lshlrev_b32 v15, 4, v15
    v_lshl_add_u32 v15, v13, 7, v15
    v_add_u32 v2, 73728, v15
    v_xor_b32 v3, 64, v2
    s_lshl_b32 s78, s86, 13
    s_add_u32 s78, s78, 2048
    v_add_u32 v4, s78, v2
    v_add_u32 v5, s78, v3
    v_bfe_u32 v15, v0, 3, 2
    s_lshl_b32 s78, s87, 1
    s_add_u32 s78, s78, s86
    v_xor_b32 v15, s78, v15
    v_lshlrev_b32 v15, 5, v15
    v_and_b32 v223, 3, v0
    v_lshl_add_u32 v15, v223, 3, v15
    v_bfe_u32 v223, v0, 2, 2
    v_lshl_add_u32 v15, v223, 7, v15
    v_mul_u32_u24 v223, 3072, v14
    v_add_u32 v6, v223, v15
    v_xor_b32 v7, 32, v6
    s_mov_b32 s60, s22
    s_mov_b32 s61, s23
    s_mov_b32 s62, 0x800000
    s_mov_b32 s63, 0x20000
    v_and_b32 v15, 1, v13
    v_cmp_eq_u32 s[88:89], 1, v15
    v_lshl_add_u32 v15, v14, 2, v15
    v_cmp_le_u32 s[90:91], v15, v13
    v_add_u32 v15, 2, v15
    v_cmp_le_u32 s[92:93], v15, v13
    v_mov_b32 v212, 0x0c0c0c0c
    v_mov_b32 v15, 0xc0c0100
    v_mov_b32 v223, 0x1000c0c
    v_cndmask_b32 v15, v15, v223, s[88:89]
    v_cndmask_b32 v208, v15, v212, s[90:91]
    v_cndmask_b32 v210, v212, v15, s[90:91]
    v_mov_b32 v15, 0xc0c0302
    v_mov_b32 v223, 0x3020c0c
    v_cndmask_b32 v15, v15, v223, s[88:89]
    v_cndmask_b32 v209, v15, v212, s[92:93]
    v_cndmask_b32 v211, v212, v15, s[92:93]
    s_or_b32 s78, s72, s86
    s_cmp_eq_u32 s78, 0
    s_cselect_b32 s78, 0xf149f2ca, 0
    v_mov_b32 v212, s78
    v_mov_b32 v213, s78
    v_mov_b32 v214, s78
    v_mov_b32 v215, s78
    s_lshl_b32 s78, s87, 12
    s_add_u32 s78, s78, 24576
    s_lshl_b32 s79, s86, 9
    s_add_u32 s79, s79, s78
    v_lshlrev_b32 v15, 3, v0
    v_add_u32 v216, s79, v15
    s_lshl_b32 s80, s86, 11
    v_add_u32 v218, s80, v216
    v_xor_b32 v219, 512, v218
    s_add_u32 s78, s78, 2048
    s_cmp_eq_u32 s86, 0
    s_cselect_b32 s78, s78, 32768
    v_add_u32 v217, s78, v15
    v_bfe_u32 v14, v0, 3, 2
    v_lshlrev_b32 v14, 5, v14
    v_and_b32 v15, 3, v0
    v_lshl_add_u32 v14, v15, 3, v14
    v_lshrrev_b32 v15, 2, v0
    v_lshl_add_u32 v14, v15, 7, v14
    s_lshl_b32 s78, s86, 11
    v_add_u32 v244, s78, v14
    s_mov_b32 s64, s20
    s_mov_b32 s65, s21
    s_mov_b32 s66, 0x200000
    s_mov_b32 s67, 0x20000
    v_lshrrev_b32 v14, 4, v0
    v_lshlrev_b32 v14, 1, v14
    v_and_b32 v15, 7, v0
    v_xor_b32 v14, v14, v15
    v_lshlrev_b32 v14, 4, v14
    v_lshrrev_b32 v15, 3, v0
    v_lshl_add_u32 v14, v15, 11, v14
    s_lshl_b32 s78, s77, 7
    s_lshl_b32 s79, s3, 14
    s_add_u32 s78, s78, s79
    v_add_u32 v245, s78, v14
    v_and_b32 v14, 15, v0
    s_lshl_b32 s78, s76, 2
    s_add_u32 s78, s78, s3
    s_lshl_b32 s79, s78, 5
    v_add_u32 v14, s79, v14
    v_lshlrev_b32 v14, 12, v14
    v_bfe_u32 v15, v0, 4, 1
    v_lshl_add_u32 v14, v15, 5, v14
    v_lshrrev_b32 v15, 5, v0
    v_lshl_add_u32 v14, v15, 4, v14
    s_lshl_b32 s79, s77, 7
    s_add_u32 s79, s79, 2048
    v_add_u32 v246, s79, v14
    s_lshl_b32 s28, s78, 16
    s_add_u32 s28, s28, 8388608
    s_lshl_b32 s30, s76, 1
    s_add_u32 s30, s30, s86
    s_lshl_b32 s30, s30, 12
    s_add_u32 s30, s30, 12910592
    v_lshrrev_b32 v15, 1, v0
    v_lshlrev_b32 v15, 8, v15
    v_and_b32 v14, 1, v0
    v_lshl_add_u32 v247, v14, 2, v15
    s_and_b32 s78, s77, 7
    s_mov_b32 s79, 0x76543210
    s_cmp_eq_u32 s78, 1
    s_cselect_b32 s79, 0x76543201, s79
    s_cmp_eq_u32 s78, 2
    s_cselect_b32 s79, 0x76543120, s79
    s_cmp_eq_u32 s78, 3
    s_cselect_b32 s79, 0x76542310, s79
    s_cmp_eq_u32 s78, 4
    s_cselect_b32 s79, 0x76534210, s79
    s_cmp_eq_u32 s78, 5
    s_cselect_b32 s79, 0x76453210, s79
    s_cmp_eq_u32 s78, 6
    s_cselect_b32 s79, 0x75643210, s79
    s_cmp_eq_u32 s78, 7
    s_cselect_b32 s79, 0x67543210, s79
    s_and_b32 s78, s76, 3
    s_mul_i32 s78, s78, 0x22222222
    s_add_u32 s79, s79, s78
    s_bfe_u32 s78, s79, 0x30000
    s_lshl_b32 s44, s78, 18
    s_lshl_b32 s78, s78, 12
    s_add_u32 s36, s78, s28
    s_bfe_u32 s78, s79, 0x30004
    s_lshl_b32 s45, s78, 18
    s_lshl_b32 s78, s78, 12
    s_add_u32 s37, s78, s28
    s_bfe_u32 s78, s79, 0x30008
    s_lshl_b32 s46, s78, 18
    s_lshl_b32 s78, s78, 12
    s_add_u32 s38, s78, s28
    s_bfe_u32 s78, s79, 0x3000c
    s_lshl_b32 s47, s78, 18
    s_lshl_b32 s78, s78, 12
    s_add_u32 s39, s78, s28
    s_bfe_u32 s78, s79, 0x30010
    s_lshl_b32 s48, s78, 18
    s_lshl_b32 s78, s78, 12
    s_add_u32 s40, s78, s28
    s_bfe_u32 s78, s79, 0x30014
    s_lshl_b32 s49, s78, 18
    s_lshl_b32 s78, s78, 12
    s_add_u32 s41, s78, s28
    s_bfe_u32 s78, s79, 0x30018
    s_lshl_b32 s50, s78, 18
    s_lshl_b32 s78, s78, 12
    s_add_u32 s42, s78, s28
    s_bfe_u32 s78, s79, 0x3001c
    s_lshl_b32 s51, s78, 18
    s_lshl_b32 s78, s78, 12
    s_add_u32 s43, s78, s28
    s_lshl_b32 s34, s3, 10
    v_bfe_u32 v14, v0, 4, 1
    v_lshrrev_b32 v15, 5, v0
    v_lshl_add_u32 v14, v14, 1, v15
    v_and_b32 v15, 7, v0
    v_xor_b32 v14, v14, v15
    v_lshlrev_b32 v14, 4, v14
    v_and_b32 v223, 15, v0
    v_lshl_add_u32 v14, v223, 7, v14
    s_lshl_b32 s78, s3, 12
    v_add_u32 v248, s78, v14
    v_xor_b32 v249, 64, v248
    v_add_u32 v250, s78, v12
    v_lshrrev_b32 v14, 3, v0
    v_xor_b32 v15, v15, v14
    v_lshlrev_b32 v15, 4, v15
    v_lshl_add_u32 v14, v14, 12, v15
    s_lshl_b32 s78, s76, 2
    s_add_u32 s78, s78, s3
    s_lshl_b32 s78, s78, 17
    s_lshl_b32 s79, s77, 7
    s_add_u32 s78, s78, s79
    s_add_u32 s78, s78, 2048
    v_add_u32 v246, s78, v14
    s_waitcnt lgkmcnt(0)
    s_barrier
    ds_read_b128 v[120:123], v4 offset:0
    ds_read_b128 v[124:127], v4 offset:2048
    ds_read_b128 v[128:131], v4 offset:4096
    ds_read_b128 v[132:135], v4 offset:6144
    ds_read_b128 v[136:139], v2 offset:0
    ds_read_b64_tr_b16 v[140:141], v6 offset:0
    ds_read_b64_tr_b16 v[142:143], v6 offset:512
    ds_read_b64_tr_b16 v[144:145], v7 offset:0
    ds_read_b64_tr_b16 v[146:147], v7 offset:512
    ds_read_b64_tr_b16 v[148:149], v6 offset:1024
    ds_read_b64_tr_b16 v[150:151], v6 offset:1536
    ds_read_b64_tr_b16 v[152:153], v7 offset:1024
    ds_read_b64_tr_b16 v[154:155], v7 offset:1536
    ds_read_b64_tr_b16 v[156:157], v6 offset:2048
    ds_read_b64_tr_b16 v[158:159], v6 offset:2560
    ds_read_b64_tr_b16 v[160:161], v7 offset:2048
    ds_read_b64_tr_b16 v[162:163], v7 offset:2560
    s_waitcnt lgkmcnt(0)
    v_mfma_f32_16x16x32_bf16 v[16:19], v[140:143], v[120:123], 0
    ds_read_b128 v[164:167], v5 offset:0
    v_mfma_f32_16x16x32_bf16 v[20:23], v[144:147], v[120:123], 0
    ds_read_b128 v[168:171], v5 offset:2048
    v_mfma_f32_16x16x32_bf16 v[52:55], v[152:155], v[120:123], 0
    ds_read_b128 v[172:175], v5 offset:4096
    v_mfma_f32_16x16x32_bf16 v[48:51], v[148:151], v[120:123], 0
    ds_read_b128 v[176:179], v5 offset:6144
    v_mfma_f32_16x16x32_bf16 v[56:59], v[148:151], v[124:127], 0
    ds_read_b128 v[180:183], v3 offset:0
    v_mfma_f32_16x16x32_bf16 v[60:63], v[152:155], v[124:127], 0
    ds_read_b64_tr_b16 v[184:185], v6 offset:12288
    v_mfma_f32_16x16x32_bf16 v[28:31], v[144:147], v[124:127], 0
    ds_read_b64_tr_b16 v[186:187], v6 offset:12800
    v_mfma_f32_16x16x32_bf16 v[24:27], v[140:143], v[124:127], 0
    ds_read_b64_tr_b16 v[188:189], v7 offset:12288
    v_mfma_f32_16x16x32_bf16 v[32:35], v[140:143], v[128:131], 0
    ds_read_b64_tr_b16 v[190:191], v7 offset:12800
    v_mfma_f32_16x16x32_bf16 v[36:39], v[144:147], v[128:131], 0
    ds_read_b64_tr_b16 v[192:193], v6 offset:13312
    v_mfma_f32_16x16x32_bf16 v[68:71], v[152:155], v[128:131], 0
    ds_read_b64_tr_b16 v[194:195], v6 offset:13824
    v_mfma_f32_16x16x32_bf16 v[64:67], v[148:151], v[128:131], 0
    ds_read_b64_tr_b16 v[196:197], v7 offset:13312
    v_mfma_f32_16x16x32_bf16 v[112:115], v[148:151], v[136:139], 0
    ds_read_b64_tr_b16 v[198:199], v7 offset:13824
    v_mfma_f32_16x16x32_bf16 v[72:75], v[148:151], v[132:135], 0
    ds_read_b64_tr_b16 v[200:201], v6 offset:14336
    v_mfma_f32_16x16x32_bf16 v[76:79], v[152:155], v[132:135], 0
    ds_read_b64_tr_b16 v[202:203], v6 offset:14848
    v_mfma_f32_16x16x32_bf16 v[44:47], v[144:147], v[132:135], 0
    ds_read_b64_tr_b16 v[204:205], v7 offset:14336
    v_mfma_f32_16x16x32_bf16 v[40:43], v[140:143], v[132:135], 0
    ds_read_b64_tr_b16 v[206:207], v7 offset:14848
    v_mfma_f32_16x16x32_bf16 v[104:107], v[132:135], v[156:159], 0
    v_mfma_f32_16x16x32_bf16 v[108:111], v[132:135], v[160:163], 0
    v_mfma_f32_16x16x32_bf16 v[100:103], v[128:131], v[160:163], 0
    v_mfma_f32_16x16x32_bf16 v[96:99], v[128:131], v[156:159], 0
    v_mfma_f32_16x16x32_bf16 v[88:91], v[124:127], v[156:159], 0
    v_mfma_f32_16x16x32_bf16 v[92:95], v[124:127], v[160:163], 0
    v_mfma_f32_16x16x32_bf16 v[84:87], v[120:123], v[160:163], 0
    v_mfma_f32_16x16x32_bf16 v[80:83], v[120:123], v[156:159], 0
    v_mfma_f32_16x16x32_bf16 v[116:119], v[136:139], v[156:159], 0
    s_waitcnt vmcnt(0)
    s_waitcnt lgkmcnt(0)
    s_barrier
    s_or_b32 s78, s75, s3
    s_cbranch_scc0 LB_tag
LB_tagb:
    v_mfma_f32_16x16x32_bf16 v[16:19], v[184:187], v[164:167], v[16:19]
    ds_read_b128 v[120:123], v4 offset:18432
    v_mfma_f32_16x16x32_bf16 v[20:23], v[188:191], v[164:167], v[20:23]
    ds_read_b128 v[124:127], v4 offset:20480
    v_mfma_f32_16x16x32_bf16 v[52:55], v[196:199], v[164:167], v[52:55]
    ds_read_b128 v[128:131], v4 offset:22528
    v_mfma_f32_16x16x32_bf16 v[48:51], v[192:195], v[164:167], v[48:51]
    ds_read_b128 v[132:135], v4 offset:24576
    v_mfma_f32_16x16x32_bf16 v[56:59], v[192:195], v[168:171], v[56:59]
    ds_read_b128 v[136:139], v2 offset:18432
    v_mfma_f32_16x16x32_bf16 v[60:63], v[196:199], v[168:171], v[60:63]
    ds_read_b64_tr_b16 v[140:141], v6 offset:24576
    v_mfma_f32_16x16x32_bf16 v[28:31], v[188:191], v[168:171], v[28:31]
    ds_read_b64_tr_b16 v[142:143], v6 offset:25088
    v_mfma_f32_16x16x32_bf16 v[24:27], v[184:187], v[168:171], v[24:27]
    ds_read_b64_tr_b16 v[144:145], v7 offset:24576
    v_mfma_f32_16x16x32_bf16 v[32:35], v[184:187], v[172:175], v[32:35]
    ds_read_b64_tr_b16 v[146:147], v7 offset:25088
    v_mfma_f32_16x16x32_bf16 v[36:39], v[188:191], v[172:175], v[36:39]
    ds_read_b64_tr_b16 v[148:149], v6 offset:25600
    v_mfma_f32_16x16x32_bf16 v[68:71], v[196:199], v[172:175], v[68:71]
    ds_read_b64_tr_b16 v[150:151], v6 offset:26112
    v_mfma_f32_16x16x32_bf16 v[64:67], v[192:195], v[172:175], v[64:67]
    ds_read_b64_tr_b16 v[152:153], v7 offset:25600
    v_mfma_f32_16x16x32_bf16 v[112:115], v[192:195], v[180:183], v[112:115]
    ds_read_b64_tr_b16 v[154:155], v7 offset:26112
    v_mfma_f32_16x16x32_bf16 v[72:75], v[192:195], v[176:179], v[72:75]
    ds_read_b64_tr_b16 v[156:157], v6 offset:26624
    v_mfma_f32_16x16x32_bf16 v[76:79], v[196:199], v[176:179], v[76:79]
    ds_read_b64_tr_b16 v[158:159], v6 offset:27136
    v_mfma_f32_16x16x32_bf16 v[44:47], v[188:191], v[176:179], v[44:47]
    ds_read_b64_tr_b16 v[160:161], v7 offset:26624
    v_mfma_f32_16x16x32_bf16 v[40:43], v[184:187], v[176:179], v[40:43]
    ds_read_b64_tr_b16 v[162:163], v7 offset:27136
    v_mfma_f32_16x16x32_bf16 v[104:107], v[176:179], v[200:203], v[104:107]
    v_mfma_f32_16x16x32_bf16 v[108:111], v[176:179], v[204:207], v[108:111]
    v_mfma_f32_16x16x32_bf16 v[100:103], v[172:175], v[204:207], v[100:103]
    v_mfma_f32_16x16x32_bf16 v[96:99], v[172:175], v[200:203], v[96:99]
    v_mfma_f32_16x16x32_bf16 v[88:91], v[168:171], v[200:203], v[88:91]
    v_mfma_f32_16x16x32_bf16 v[92:95], v[168:171], v[204:207], v[92:95]
    v_mfma_f32_16x16x32_bf16 v[84:87], v[164:167], v[204:207], v[84:87]
    v_mfma_f32_16x16x32_bf16 v[80:83], v[164:167], v[200:203], v[80:83]
    v_mfma_f32_16x16x32_bf16 v[116:119], v[180:183], v[200:203], v[116:119]
    s_waitcnt lgkmcnt(0)
    v_mfma_f32_16x16x32_bf16 v[16:19], v[140:143], v[120:123], v[16:19]
    ds_read_b128 v[164:167], v5 offset:18432
    v_mfma_f32_16x16x32_bf16 v[20:23], v[144:147], v[120:123], v[20:23]
    ds_read_b128 v[168:171], v5 offset:20480
    v_mfma_f32_16x16x32_bf16 v[52:55], v[152:155], v[120:123], v[52:55]
    ds_read_b128 v[172:175], v5 offset:22528
    v_mfma_f32_16x16x32_bf16 v[48:51], v[148:151], v[120:123], v[48:51]
    ds_read_b128 v[176:179], v5 offset:24576
    v_mfma_f32_16x16x32_bf16 v[56:59], v[148:151], v[124:127], v[56:59]
    ds_read_b128 v[180:183], v3 offset:18432
    v_mfma_f32_16x16x32_bf16 v[60:63], v[152:155], v[124:127], v[60:63]
    ds_read_b64_tr_b16 v[184:185], v6 offset:36864
    v_mfma_f32_16x16x32_bf16 v[28:31], v[144:147], v[124:127], v[28:31]
    ds_read_b64_tr_b16 v[186:187], v6 offset:37376
    v_mfma_f32_16x16x32_bf16 v[24:27], v[140:143], v[124:127], v[24:27]
    ds_read_b64_tr_b16 v[188:189], v7 offset:36864
    v_mfma_f32_16x16x32_bf16 v[32:35], v[140:143], v[128:131], v[32:35]
    ds_read_b64_tr_b16 v[190:191], v7 offset:37376
    v_mfma_f32_16x16x32_bf16 v[36:39], v[144:147], v[128:131], v[36:39]
    ds_read_b64_tr_b16 v[192:193], v6 offset:37888
    v_mfma_f32_16x16x32_bf16 v[68:71], v[152:155], v[128:131], v[68:71]
    ds_read_b64_tr_b16 v[194:195], v6 offset:38400
    v_mfma_f32_16x16x32_bf16 v[64:67], v[148:151], v[128:131], v[64:67]
    ds_read_b64_tr_b16 v[196:197], v7 offset:37888
    v_mfma_f32_16x16x32_bf16 v[112:115], v[148:151], v[136:139], v[112:115]
    ds_read_b64_tr_b16 v[198:199], v7 offset:38400
    v_mfma_f32_16x16x32_bf16 v[72:75], v[148:151], v[132:135], v[72:75]
    ds_read_b64_tr_b16 v[200:201], v6 offset:38912
    v_mfma_f32_16x16x32_bf16 v[76:79], v[152:155], v[132:135], v[76:79]
    ds_read_b64_tr_b16 v[202:203], v6 offset:39424
    v_mfma_f32_16x16x32_bf16 v[44:47], v[144:147], v[132:135], v[44:47]
    ds_read_b64_tr_b16 v[204:205], v7 offset:38912
    v_mfma_f32_16x16x32_bf16 v[40:43], v[140:143], v[132:135], v[40:43]
    ds_read_b64_tr_b16 v[206:207], v7 offset:39424
    v_mfma_f32_16x16x32_bf16 v[104:107], v[132:135], v[156:159], v[104:107]
    v_mfma_f32_16x16x32_bf16 v[108:111], v[132:135], v[160:163], v[108:111]
    v_mfma_f32_16x16x32_bf16 v[100:103], v[128:131], v[160:163], v[100:103]
    v_mfma_f32_16x16x32_bf16 v[96:99], v[128:131], v[156:159], v[96:99]
    v_mfma_f32_16x16x32_bf16 v[88:91], v[124:127], v[156:159], v[88:91]
    v_mfma_f32_16x16x32_bf16 v[92:95], v[124:127], v[160:163], v[92:95]
    v_mfma_f32_16x16x32_bf16 v[84:87], v[120:123], v[160:163], v[84:87]
    v_mfma_f32_16x16x32_bf16 v[80:83], v[120:123], v[156:159], v[80:83]
    v_mfma_f32_16x16x32_bf16 v[116:119], v[136:139], v[156:159], v[116:119]
    s_waitcnt lgkmcnt(0)
    s_barrier
    v_mfma_f32_16x16x32_bf16 v[16:19], v[184:187], v[164:167], v[16:19]
    ds_read_b128 v[120:123], v4 offset:36864
    v_mfma_f32_16x16x32_bf16 v[20:23], v[188:191], v[164:167], v[20:23]
    ds_read_b128 v[124:127], v4 offset:38912
    v_mfma_f32_16x16x32_bf16 v[52:55], v[196:199], v[164:167], v[52:55]
    ds_read_b128 v[128:131], v4 offset:40960
    v_mfma_f32_16x16x32_bf16 v[48:51], v[192:195], v[164:167], v[48:51]
    ds_read_b128 v[132:135], v4 offset:43008
    v_mfma_f32_16x16x32_bf16 v[56:59], v[192:195], v[168:171], v[56:59]
    ds_read_b128 v[136:139], v2 offset:36864
    v_mfma_f32_16x16x32_bf16 v[60:63], v[196:199], v[168:171], v[60:63]
    ds_read_b64_tr_b16 v[140:141], v6 offset:49152
    v_mfma_f32_16x16x32_bf16 v[28:31], v[188:191], v[168:171], v[28:31]
    ds_read_b64_tr_b16 v[142:143], v6 offset:49664
    v_mfma_f32_16x16x32_bf16 v[24:27], v[184:187], v[168:171], v[24:27]
    ds_read_b64_tr_b16 v[144:145], v7 offset:49152
    v_mfma_f32_16x16x32_bf16 v[32:35], v[184:187], v[172:175], v[32:35]
    ds_read_b64_tr_b16 v[146:147], v7 offset:49664
    v_mfma_f32_16x16x32_bf16 v[36:39], v[188:191], v[172:175], v[36:39]
    ds_read_b64_tr_b16 v[148:149], v6 offset:50176
    v_mfma_f32_16x16x32_bf16 v[68:71], v[196:199], v[172:175], v[68:71]
    ds_read_b64_tr_b16 v[150:151], v6 offset:50688
    v_mfma_f32_16x16x32_bf16 v[64:67], v[192:195], v[172:175], v[64:67]
    ds_read_b64_tr_b16 v[152:153], v7 offset:50176
    v_mfma_f32_16x16x32_bf16 v[112:115], v[192:195], v[180:183], v[112:115]
    ds_read_b64_tr_b16 v[154:155], v7 offset:50688
    v_mfma_f32_16x16x32_bf16 v[72:75], v[192:195], v[176:179], v[72:75]
    ds_read_b64_tr_b16 v[156:157], v6 offset:51200
    v_mfma_f32_16x16x32_bf16 v[76:79], v[196:199], v[176:179], v[76:79]
    ds_read_b64_tr_b16 v[158:159], v6 offset:51712
    v_mfma_f32_16x16x32_bf16 v[44:47], v[188:191], v[176:179], v[44:47]
    ds_read_b64_tr_b16 v[160:161], v7 offset:51200
    v_mfma_f32_16x16x32_bf16 v[40:43], v[184:187], v[176:179], v[40:43]
    ds_read_b64_tr_b16 v[162:163], v7 offset:51712
    v_mfma_f32_16x16x32_bf16 v[104:107], v[176:179], v[200:203], v[104:107]
    v_mfma_f32_16x16x32_bf16 v[108:111], v[176:179], v[204:207], v[108:111]
    v_mfma_f32_16x16x32_bf16 v[100:103], v[172:175], v[204:207], v[100:103]
    v_mfma_f32_16x16x32_bf16 v[96:99], v[172:175], v[200:203], v[96:99]
    v_mfma_f32_16x16x32_bf16 v[88:91], v[168:171], v[200:203], v[88:91]
    v_mfma_f32_16x16x32_bf16 v[92:95], v[168:171], v[204:207], v[92:95]
    v_mfma_f32_16x16x32_bf16 v[84:87], v[164:167], v[204:207], v[84:87]
    v_mfma_f32_16x16x32_bf16 v[80:83], v[164:167], v[200:203], v[80:83]
    v_mfma_f32_16x16x32_bf16 v[116:119], v[180:183], v[200:203], v[116:119]
    s_waitcnt lgkmcnt(0)
    v_mfma_f32_16x16x32_bf16 v[16:19], v[140:143], v[120:123], v[16:19]
    ds_read_b128 v[164:167], v5 offset:36864
    v_mfma_f32_16x16x32_bf16 v[20:23], v[144:147], v[120:123], v[20:23]
    ds_read_b128 v[168:171], v5 offset:38912
    v_mfma_f32_16x16x32_bf16 v[52:55], v[152:155], v[120:123], v[52:55]
    ds_read_b128 v[172:175], v5 offset:40960
    v_mfma_f32_16x16x32_bf16 v[48:51], v[148:151], v[120:123], v[48:51]
    ds_read_b128 v[176:179], v5 offset:43008
    v_mfma_f32_16x16x32_bf16 v[56:59], v[148:151], v[124:127], v[56:59]
    ds_read_b128 v[180:183], v3 offset:36864
    v_mfma_f32_16x16x32_bf16 v[60:63], v[152:155], v[124:127], v[60:63]
    ds_read_b64_tr_b16 v[184:185], v6 offset:61440
    v_mfma_f32_16x16x32_bf16 v[28:31], v[144:147], v[124:127], v[28:31]
    ds_read_b64_tr_b16 v[186:187], v6 offset:61952
    v_mfma_f32_16x16x32_bf16 v[24:27], v[140:143], v[124:127], v[24:27]
    ds_read_b64_tr_b16 v[188:189], v7 offset:61440
    v_mfma_f32_16x16x32_bf16 v[32:35], v[140:143], v[128:131], v[32:35]
    ds_read_b64_tr_b16 v[190:191], v7 offset:61952
    v_mfma_f32_16x16x32_bf16 v[36:39], v[144:147], v[128:131], v[36:39]
    ds_read_b64_tr_b16 v[192:193], v6 offset:62464
    v_mfma_f32_16x16x32_bf16 v[68:71], v[152:155], v[128:131], v[68:71]
    ds_read_b64_tr_b16 v[194:195], v6 offset:62976
    v_mfma_f32_16x16x32_bf16 v[64:67], v[148:151], v[128:131], v[64:67]
    ds_read_b64_tr_b16 v[196:197], v7 offset:62464
    v_mfma_f32_16x16x32_bf16 v[112:115], v[148:151], v[136:139], v[112:115]
    ds_read_b64_tr_b16 v[198:199], v7 offset:62976
    v_mfma_f32_16x16x32_bf16 v[72:75], v[148:151], v[132:135], v[72:75]
    ds_read_b64_tr_b16 v[200:201], v6 offset:63488
    v_mfma_f32_16x16x32_bf16 v[76:79], v[152:155], v[132:135], v[76:79]
    ds_read_b64_tr_b16 v[202:203], v6 offset:64000
    v_mfma_f32_16x16x32_bf16 v[44:47], v[144:147], v[132:135], v[44:47]
    ds_read_b64_tr_b16 v[204:205], v7 offset:63488
    v_mfma_f32_16x16x32_bf16 v[40:43], v[140:143], v[132:135], v[40:43]
    ds_read_b64_tr_b16 v[206:207], v7 offset:64000
    v_mfma_f32_16x16x32_bf16 v[104:107], v[132:135], v[156:159], v[104:107]
    v_mfma_f32_16x16x32_bf16 v[108:111], v[132:135], v[160:163], v[108:111]
    v_mfma_f32_16x16x32_bf16 v[100:103], v[128:131], v[160:163], v[100:103]
    v_mfma_f32_16x16x32_bf16 v[96:99], v[128:131], v[156:159], v[96:99]
    v_mfma_f32_16x16x32_bf16 v[88:91], v[124:127], v[156:159], v[88:91]
    v_mfma_f32_16x16x32_bf16 v[92:95], v[124:127], v[160:163], v[92:95]
    v_mfma_f32_16x16x32_bf16 v[84:87], v[120:123], v[160:163], v[84:87]
    v_mfma_f32_16x16x32_bf16 v[80:83], v[120:123], v[156:159], v[80:83]
    v_mfma_f32_16x16x32_bf16 v[116:119], v[136:139], v[156:159], v[116:119]
    s_waitcnt lgkmcnt(0)
    s_barrier
    v_mfma_f32_16x16x32_bf16 v[16:19], v[184:187], v[164:167], v[16:19]
    ds_read_b128 v[120:123], v4 offset:0
    v_mfma_f32_16x16x32_bf16 v[20:23], v[188:191], v[164:167], v[20:23]
    ds_read_b128 v[124:127], v4 offset:2048
    v_mfma_f32_16x16x32_bf16 v[52:55], v[196:199], v[164:167], v[52:55]
    ds_read_b128 v[128:131], v4 offset:4096
    v_mfma_f32_16x16x32_bf16 v[48:51], v[192:195], v[164:167], v[48:51]
    ds_read_b128 v[132:135], v4 offset:6144
    v_mfma_f32_16x16x32_bf16 v[56:59], v[192:195], v[168:171], v[56:59]
    ds_read_b128 v[136:139], v2 offset:0
    v_mfma_f32_16x16x32_bf16 v[60:63], v[196:199], v[168:171], v[60:63]
    ds_read_b64_tr_b16 v[140:141], v6 offset:0
    v_mfma_f32_16x16x32_bf16 v[28:31], v[188:191], v[168:171], v[28:31]
    ds_read_b64_tr_b16 v[142:143], v6 offset:512
    v_mfma_f32_16x16x32_bf16 v[24:27], v[184:187], v[168:171], v[24:27]
    ds_read_b64_tr_b16 v[144:145], v7 offset:0
    v_mfma_f32_16x16x32_bf16 v[32:35], v[184:187], v[172:175], v[32:35]
    ds_read_b64_tr_b16 v[146:147], v7 offset:512
    v_mfma_f32_16x16x32_bf16 v[36:39], v[188:191], v[172:175], v[36:39]
    ds_read_b64_tr_b16 v[148:149], v6 offset:1024
    v_mfma_f32_16x16x32_bf16 v[68:71], v[196:199], v[172:175], v[68:71]
    ds_read_b64_tr_b16 v[150:151], v6 offset:1536
    v_mfma_f32_16x16x32_bf16 v[64:67], v[192:195], v[172:175], v[64:67]
    ds_read_b64_tr_b16 v[152:153], v7 offset:1024
    v_mfma_f32_16x16x32_bf16 v[112:115], v[192:195], v[180:183], v[112:115]
    ds_read_b64_tr_b16 v[154:155], v7 offset:1536
    v_mfma_f32_16x16x32_bf16 v[72:75], v[192:195], v[176:179], v[72:75]
    ds_read_b64_tr_b16 v[156:157], v6 offset:2048
    v_mfma_f32_16x16x32_bf16 v[76:79], v[196:199], v[176:179], v[76:79]
    ds_read_b64_tr_b16 v[158:159], v6 offset:2560
    v_mfma_f32_16x16x32_bf16 v[44:47], v[188:191], v[176:179], v[44:47]
    ds_read_b64_tr_b16 v[160:161], v7 offset:2048
    v_mfma_f32_16x16x32_bf16 v[40:43], v[184:187], v[176:179], v[40:43]
    ds_read_b64_tr_b16 v[162:163], v7 offset:2560
    v_mfma_f32_16x16x32_bf16 v[104:107], v[176:179], v[200:203], v[104:107]
    v_mfma_f32_16x16x32_bf16 v[108:111], v[176:179], v[204:207], v[108:111]
    v_mfma_f32_16x16x32_bf16 v[100:103], v[172:175], v[204:207], v[100:103]
    v_mfma_f32_16x16x32_bf16 v[96:99], v[172:175], v[200:203], v[96:99]
    v_mfma_f32_16x16x32_bf16 v[88:91], v[168:171], v[200:203], v[88:91]
    v_mfma_f32_16x16x32_bf16 v[92:95], v[168:171], v[204:207], v[92:95]
    v_mfma_f32_16x16x32_bf16 v[84:87], v[164:167], v[204:207], v[84:87]
    v_mfma_f32_16x16x32_bf16 v[80:83], v[164:167], v[200:203], v[80:83]
    v_mfma_f32_16x16x32_bf16 v[116:119], v[180:183], v[200:203], v[116:119]
    s_waitcnt lgkmcnt(0)
    v_mfma_f32_16x16x32_bf16 v[16:19], v[140:143], v[120:123], v[16:19]
    ds_read_b128 v[164:167], v5 offset:0
    v_mfma_f32_16x16x32_bf16 v[20:23], v[144:147], v[120:123], v[20:23]
    ds_read_b128 v[168:171], v5 offset:2048
    v_mfma_f32_16x16x32_bf16 v[52:55], v[152:155], v[120:123], v[52:55]
    ds_read_b128 v[172:175], v5 offset:4096
    v_mfma_f32_16x16x32_bf16 v[48:51], v[148:151], v[120:123], v[48:51]
    ds_read_b128 v[176:179], v5 offset:6144
    v_mfma_f32_16x16x32_bf16 v[56:59], v[148:151], v[124:127], v[56:59]
    ds_read_b128 v[180:183], v3 offset:0
    v_mfma_f32_16x16x32_bf16 v[60:63], v[152:155], v[124:127], v[60:63]
    ds_read_b64_tr_b16 v[184:185], v6 offset:12288
    v_mfma_f32_16x16x32_bf16 v[28:31], v[144:147], v[124:127], v[28:31]
    ds_read_b64_tr_b16 v[186:187], v6 offset:12800
    v_mfma_f32_16x16x32_bf16 v[24:27], v[140:143], v[124:127], v[24:27]
    ds_read_b64_tr_b16 v[188:189], v7 offset:12288
    v_mfma_f32_16x16x32_bf16 v[32:35], v[140:143], v[128:131], v[32:35]
    ds_read_b64_tr_b16 v[190:191], v7 offset:12800
    v_mfma_f32_16x16x32_bf16 v[36:39], v[144:147], v[128:131], v[36:39]
    ds_read_b64_tr_b16 v[192:193], v6 offset:13312
    v_mfma_f32_16x16x32_bf16 v[68:71], v[152:155], v[128:131], v[68:71]
    ds_read_b64_tr_b16 v[194:195], v6 offset:13824
    v_mfma_f32_16x16x32_bf16 v[64:67], v[148:151], v[128:131], v[64:67]
    ds_read_b64_tr_b16 v[196:197], v7 offset:13312
    v_mfma_f32_16x16x32_bf16 v[112:115], v[148:151], v[136:139], v[112:115]
    ds_read_b64_tr_b16 v[198:199], v7 offset:13824
    v_mfma_f32_16x16x32_bf16 v[72:75], v[148:151], v[132:135], v[72:75]
    ds_read_b64_tr_b16 v[200:201], v6 offset:14336
    v_mfma_f32_16x16x32_bf16 v[76:79], v[152:155], v[132:135], v[76:79]
    ds_read_b64_tr_b16 v[202:203], v6 offset:14848
    v_mfma_f32_16x16x32_bf16 v[44:47], v[144:147], v[132:135], v[44:47]
    ds_read_b64_tr_b16 v[204:205], v7 offset:14336
    v_mfma_f32_16x16x32_bf16 v[40:43], v[140:143], v[132:135], v[40:43]
    ds_read_b64_tr_b16 v[206:207], v7 offset:14848
    v_mfma_f32_16x16x32_bf16 v[104:107], v[132:135], v[156:159], v[104:107]
    v_mfma_f32_16x16x32_bf16 v[108:111], v[132:135], v[160:163], v[108:111]
    v_mfma_f32_16x16x32_bf16 v[100:103], v[128:131], v[160:163], v[100:103]
    v_mfma_f32_16x16x32_bf16 v[96:99], v[128:131], v[156:159], v[96:99]
    v_mfma_f32_16x16x32_bf16 v[88:91], v[124:127], v[156:159], v[88:91]
    v_mfma_f32_16x16x32_bf16 v[92:95], v[124:127], v[160:163], v[92:95]
    v_mfma_f32_16x16x32_bf16 v[84:87], v[120:123], v[160:163], v[84:87]
    v_mfma_f32_16x16x32_bf16 v[80:83], v[120:123], v[156:159], v[80:83]
    v_mfma_f32_16x16x32_bf16 v[116:119], v[136:139], v[156:159], v[116:119]
    s_waitcnt lgkmcnt(0)
    s_barrier
    v_mfma_f32_16x16x32_bf16 v[16:19], v[184:187], v[164:167], v[16:19]
    ds_read_b128 v[120:123], v4 offset:18432
    v_mfma_f32_16x16x32_bf16 v[20:23], v[188:191], v[164:167], v[20:23]
    ds_read_b128 v[124:127], v4 offset:20480
    v_mfma_f32_16x16x32_bf16 v[52:55], v[196:199], v[164:167], v[52:55]
    ds_read_b128 v[128:131], v4 offset:22528
    v_mfma_f32_16x16x32_bf16 v[48:51], v[192:195], v[164:167], v[48:51]
    ds_read_b128 v[132:135], v4 offset:24576
    v_mfma_f32_16x16x32_bf16 v[56:59], v[192:195], v[168:171], v[56:59]
    ds_read_b128 v[136:139], v2 offset:18432
    v_mfma_f32_16x16x32_bf16 v[60:63], v[196:199], v[168:171], v[60:63]
    ds_read_b64_tr_b16 v[140:141], v6 offset:24576
    v_mfma_f32_16x16x32_bf16 v[28:31], v[188:191], v[168:171], v[28:31]
    ds_read_b64_tr_b16 v[142:143], v6 offset:25088
    v_mfma_f32_16x16x32_bf16 v[24:27], v[184:187], v[168:171], v[24:27]
    ds_read_b64_tr_b16 v[144:145], v7 offset:24576
    v_mfma_f32_16x16x32_bf16 v[32:35], v[184:187], v[172:175], v[32:35]
    ds_read_b64_tr_b16 v[146:147], v7 offset:25088
    v_mfma_f32_16x16x32_bf16 v[36:39], v[188:191], v[172:175], v[36:39]
    ds_read_b64_tr_b16 v[148:149], v6 offset:25600
    v_mfma_f32_16x16x32_bf16 v[68:71], v[196:199], v[172:175], v[68:71]
    ds_read_b64_tr_b16 v[150:151], v6 offset:26112
    v_mfma_f32_16x16x32_bf16 v[64:67], v[192:195], v[172:175], v[64:67]
    ds_read_b64_tr_b16 v[152:153], v7 offset:25600
    v_mfma_f32_16x16x32_bf16 v[112:115], v[192:195], v[180:183], v[112:115]
    ds_read_b64_tr_b16 v[154:155], v7 offset:26112
    v_mfma_f32_16x16x32_bf16 v[72:75], v[192:195], v[176:179], v[72:75]
    ds_read_b64_tr_b16 v[156:157], v6 offset:26624
    v_mfma_f32_16x16x32_bf16 v[76:79], v[196:199], v[176:179], v[76:79]
    ds_read_b64_tr_b16 v[158:159], v6 offset:27136
    v_mfma_f32_16x16x32_bf16 v[44:47], v[188:191], v[176:179], v[44:47]
    ds_read_b64_tr_b16 v[160:161], v7 offset:26624
    v_mfma_f32_16x16x32_bf16 v[40:43], v[184:187], v[176:179], v[40:43]
    ds_read_b64_tr_b16 v[162:163], v7 offset:27136
    v_mfma_f32_16x16x32_bf16 v[104:107], v[176:179], v[200:203], v[104:107]
    v_mfma_f32_16x16x32_bf16 v[108:111], v[176:179], v[204:207], v[108:111]
    v_mfma_f32_16x16x32_bf16 v[100:103], v[172:175], v[204:207], v[100:103]
    v_mfma_f32_16x16x32_bf16 v[96:99], v[172:175], v[200:203], v[96:99]
    v_mfma_f32_16x16x32_bf16 v[88:91], v[168:171], v[200:203], v[88:91]
    v_mfma_f32_16x16x32_bf16 v[92:95], v[168:171], v[204:207], v[92:95]
    v_mfma_f32_16x16x32_bf16 v[84:87], v[164:167], v[204:207], v[84:87]
    v_mfma_f32_16x16x32_bf16 v[80:83], v[164:167], v[200:203], v[80:83]
    v_mfma_f32_16x16x32_bf16 v[116:119], v[180:183], v[200:203], v[116:119]
    s_waitcnt lgkmcnt(0)
    v_mfma_f32_16x16x32_bf16 v[16:19], v[140:143], v[120:123], v[16:19]
    ds_read_b128 v[164:167], v5 offset:18432
    v_mfma_f32_16x16x32_bf16 v[20:23], v[144:147], v[120:123], v[20:23]
    ds_read_b128 v[168:171], v5 offset:20480
    v_mfma_f32_16x16x32_bf16 v[52:55], v[152:155], v[120:123], v[52:55]
    ds_read_b128 v[172:175], v5 offset:22528
    v_mfma_f32_16x16x32_bf16 v[48:51], v[148:151], v[120:123], v[48:51]
    ds_read_b128 v[176:179], v5 offset:24576
    v_mfma_f32_16x16x32_bf16 v[56:59], v[148:151], v[124:127], v[56:59]
    ds_read_b128 v[180:183], v3 offset:18432
    v_mfma_f32_16x16x32_bf16 v[60:63], v[152:155], v[124:127], v[60:63]
    ds_read_b64_tr_b16 v[184:185], v6 offset:36864
    v_mfma_f32_16x16x32_bf16 v[28:31], v[144:147], v[124:127], v[28:31]
    ds_read_b64_tr_b16 v[186:187], v6 offset:37376
    v_mfma_f32_16x16x32_bf16 v[24:27], v[140:143], v[124:127], v[24:27]
    ds_read_b64_tr_b16 v[188:189], v7 offset:36864
    v_mfma_f32_16x16x32_bf16 v[32:35], v[140:143], v[128:131], v[32:35]
    ds_read_b64_tr_b16 v[190:191], v7 offset:37376
    v_mfma_f32_16x16x32_bf16 v[36:39], v[144:147], v[128:131], v[36:39]
    ds_read_b64_tr_b16 v[192:193], v6 offset:37888
    v_mfma_f32_16x16x32_bf16 v[68:71], v[152:155], v[128:131], v[68:71]
    ds_read_b64_tr_b16 v[194:195], v6 offset:38400
    v_mfma_f32_16x16x32_bf16 v[64:67], v[148:151], v[128:131], v[64:67]
    ds_read_b64_tr_b16 v[196:197], v7 offset:37888
    v_mfma_f32_16x16x32_bf16 v[112:115], v[148:151], v[136:139], v[112:115]
    ds_read_b64_tr_b16 v[198:199], v7 offset:38400
    v_mfma_f32_16x16x32_bf16 v[72:75], v[148:151], v[132:135], v[72:75]
    ds_read_b64_tr_b16 v[200:201], v6 offset:38912
    v_mfma_f32_16x16x32_bf16 v[76:79], v[152:155], v[132:135], v[76:79]
    ds_read_b64_tr_b16 v[202:203], v6 offset:39424
    v_mfma_f32_16x16x32_bf16 v[44:47], v[144:147], v[132:135], v[44:47]
    ds_read_b64_tr_b16 v[204:205], v7 offset:38912
    v_mfma_f32_16x16x32_bf16 v[40:43], v[140:143], v[132:135], v[40:43]
    ds_read_b64_tr_b16 v[206:207], v7 offset:39424
    v_mfma_f32_16x16x32_bf16 v[104:107], v[132:135], v[156:159], v[104:107]
    v_mfma_f32_16x16x32_bf16 v[108:111], v[132:135], v[160:163], v[108:111]
    v_mfma_f32_16x16x32_bf16 v[100:103], v[128:131], v[160:163], v[100:103]
    v_mfma_f32_16x16x32_bf16 v[96:99], v[128:131], v[156:159], v[96:99]
    v_mfma_f32_16x16x32_bf16 v[88:91], v[124:127], v[156:159], v[88:91]
    v_mfma_f32_16x16x32_bf16 v[92:95], v[124:127], v[160:163], v[92:95]
    v_mfma_f32_16x16x32_bf16 v[84:87], v[120:123], v[160:163], v[84:87]
    v_mfma_f32_16x16x32_bf16 v[80:83], v[120:123], v[156:159], v[80:83]
    v_mfma_f32_16x16x32_bf16 v[116:119], v[136:139], v[156:159], v[116:119]
    s_waitcnt lgkmcnt(0)
    s_barrier
    v_mfma_f32_16x16x32_bf16 v[16:19], v[184:187], v[164:167], v[16:19]
    ds_read_b128 v[120:123], v4 offset:36864
    v_mfma_f32_16x16x32_bf16 v[20:23], v[188:191], v[164:167], v[20:23]
    ds_read_b128 v[124:127], v4 offset:38912
    v_mfma_f32_16x16x32_bf16 v[52:55], v[196:199], v[164:167], v[52:55]
    ds_read_b128 v[128:131], v4 offset:40960
    v_mfma_f32_16x16x32_bf16 v[48:51], v[192:195], v[164:167], v[48:51]
    ds_read_b128 v[132:135], v4 offset:43008
    v_mfma_f32_16x16x32_bf16 v[56:59], v[192:195], v[168:171], v[56:59]
    ds_read_b128 v[136:139], v2 offset:36864
    v_mfma_f32_16x16x32_bf16 v[60:63], v[196:199], v[168:171], v[60:63]
    ds_read_b64_tr_b16 v[140:141], v6 offset:49152
    v_mfma_f32_16x16x32_bf16 v[28:31], v[188:191], v[168:171], v[28:31]
    ds_read_b64_tr_b16 v[142:143], v6 offset:49664
    v_mfma_f32_16x16x32_bf16 v[24:27], v[184:187], v[168:171], v[24:27]
    ds_read_b64_tr_b16 v[144:145], v7 offset:49152
    v_mfma_f32_16x16x32_bf16 v[32:35], v[184:187], v[172:175], v[32:35]
    ds_read_b64_tr_b16 v[146:147], v7 offset:49664
    v_mfma_f32_16x16x32_bf16 v[36:39], v[188:191], v[172:175], v[36:39]
    ds_read_b64_tr_b16 v[148:149], v6 offset:50176
    v_mfma_f32_16x16x32_bf16 v[68:71], v[196:199], v[172:175], v[68:71]
    ds_read_b64_tr_b16 v[150:151], v6 offset:50688
    v_mfma_f32_16x16x32_bf16 v[64:67], v[192:195], v[172:175], v[64:67]
    ds_read_b64_tr_b16 v[152:153], v7 offset:50176
    v_mfma_f32_16x16x32_bf16 v[112:115], v[192:195], v[180:183], v[112:115]
    ds_read_b64_tr_b16 v[154:155], v7 offset:50688
    v_mfma_f32_16x16x32_bf16 v[72:75], v[192:195], v[176:179], v[72:75]
    ds_read_b64_tr_b16 v[156:157], v6 offset:51200
    v_mfma_f32_16x16x32_bf16 v[76:79], v[196:199], v[176:179], v[76:79]
    ds_read_b64_tr_b16 v[158:159], v6 offset:51712
    v_mfma_f32_16x16x32_bf16 v[44:47], v[188:191], v[176:179], v[44:47]
    ds_read_b64_tr_b16 v[160:161], v7 offset:51200
    v_mfma_f32_16x16x32_bf16 v[40:43], v[184:187], v[176:179], v[40:43]
    ds_read_b64_tr_b16 v[162:163], v7 offset:51712
    v_mfma_f32_16x16x32_bf16 v[104:107], v[176:179], v[200:203], v[104:107]
    v_mfma_f32_16x16x32_bf16 v[108:111], v[176:179], v[204:207], v[108:111]
    v_mfma_f32_16x16x32_bf16 v[100:103], v[172:175], v[204:207], v[100:103]
    v_mfma_f32_16x16x32_bf16 v[96:99], v[172:175], v[200:203], v[96:99]
    v_mfma_f32_16x16x32_bf16 v[88:91], v[168:171], v[200:203], v[88:91]
    v_mfma_f32_16x16x32_bf16 v[92:95], v[168:171], v[204:207], v[92:95]
    v_mfma_f32_16x16x32_bf16 v[84:87], v[164:167], v[204:207], v[84:87]
    v_mfma_f32_16x16x32_bf16 v[80:83], v[164:167], v[200:203], v[80:83]
    v_mfma_f32_16x16x32_bf16 v[116:119], v[180:183], v[200:203], v[116:119]
    s_waitcnt lgkmcnt(0)
    v_mfma_f32_16x16x32_bf16 v[16:19], v[140:143], v[120:123], v[16:19]
    ds_read_b128 v[164:167], v5 offset:36864
    v_mfma_f32_16x16x32_bf16 v[20:23], v[144:147], v[120:123], v[20:23]
    ds_read_b128 v[168:171], v5 offset:38912
    v_mfma_f32_16x16x32_bf16 v[52:55], v[152:155], v[120:123], v[52:55]
    ds_read_b128 v[172:175], v5 offset:40960
    v_mfma_f32_16x16x32_bf16 v[48:51], v[148:151], v[120:123], v[48:51]
    ds_read_b128 v[176:179], v5 offset:43008
    v_mfma_f32_16x16x32_bf16 v[56:59], v[148:151], v[124:127], v[56:59]
    ds_read_b128 v[180:183], v3 offset:36864
    v_mfma_f32_16x16x32_bf16 v[60:63], v[152:155], v[124:127], v[60:63]
    ds_read_b64_tr_b16 v[184:185], v6 offset:61440
    v_mfma_f32_16x16x32_bf16 v[28:31], v[144:147], v[124:127], v[28:31]
    ds_read_b64_tr_b16 v[186:187], v6 offset:61952
    v_mfma_f32_16x16x32_bf16 v[24:27], v[140:143], v[124:127], v[24:27]
    ds_read_b64_tr_b16 v[188:189], v7 offset:61440
    v_mfma_f32_16x16x32_bf16 v[32:35], v[140:143], v[128:131], v[32:35]
    ds_read_b64_tr_b16 v[190:191], v7 offset:61952
    v_mfma_f32_16x16x32_bf16 v[36:39], v[144:147], v[128:131], v[36:39]
    ds_read_b64_tr_b16 v[192:193], v6 offset:62464
    v_mfma_f32_16x16x32_bf16 v[68:71], v[152:155], v[128:131], v[68:71]
    ds_read_b64_tr_b16 v[194:195], v6 offset:62976
    v_mfma_f32_16x16x32_bf16 v[64:67], v[148:151], v[128:131], v[64:67]
    ds_read_b64_tr_b16 v[196:197], v7 offset:62464
    v_mfma_f32_16x16x32_bf16 v[112:115], v[148:151], v[136:139], v[112:115]
    ds_read_b64_tr_b16 v[198:199], v7 offset:62976
    v_mfma_f32_16x16x32_bf16 v[72:75], v[148:151], v[132:135], v[72:75]
    ds_read_b64_tr_b16 v[200:201], v6 offset:63488
    v_mfma_f32_16x16x32_bf16 v[76:79], v[152:155], v[132:135], v[76:79]
    ds_read_b64_tr_b16 v[202:203], v6 offset:64000
    v_mfma_f32_16x16x32_bf16 v[44:47], v[144:147], v[132:135], v[44:47]
    ds_read_b64_tr_b16 v[204:205], v7 offset:63488
    v_mfma_f32_16x16x32_bf16 v[40:43], v[140:143], v[132:135], v[40:43]
    ds_read_b64_tr_b16 v[206:207], v7 offset:64000
    v_mfma_f32_16x16x32_bf16 v[104:107], v[132:135], v[156:159], v[104:107]
    v_mfma_f32_16x16x32_bf16 v[108:111], v[132:135], v[160:163], v[108:111]
    v_mfma_f32_16x16x32_bf16 v[100:103], v[128:131], v[160:163], v[100:103]
    v_mfma_f32_16x16x32_bf16 v[96:99], v[128:131], v[156:159], v[96:99]
    v_mfma_f32_16x16x32_bf16 v[88:91], v[124:127], v[156:159], v[88:91]
    v_mfma_f32_16x16x32_bf16 v[92:95], v[124:127], v[160:163], v[92:95]
    v_mfma_f32_16x16x32_bf16 v[84:87], v[120:123], v[160:163], v[84:87]
    v_mfma_f32_16x16x32_bf16 v[80:83], v[120:123], v[156:159], v[80:83]
    v_mfma_f32_16x16x32_bf16 v[116:119], v[136:139], v[156:159], v[116:119]
    s_waitcnt lgkmcnt(0)
    s_barrier
    v_mfma_f32_16x16x32_bf16 v[16:19], v[184:187], v[164:167], v[16:19]
    ds_read_b128 v[120:123], v4 offset:0
    v_mfma_f32_16x16x32_bf16 v[20:23], v[188:191], v[164:167], v[20:23]
    ds_read_b128 v[124:127], v4 offset:2048
    v_mfma_f32_16x16x32_bf16 v[52:55], v[196:199], v[164:167], v[52:55]
    ds_read_b128 v[128:131], v4 offset:4096
    v_mfma_f32_16x16x32_bf16 v[48:51], v[192:195], v[164:167], v[48:51]
    ds_read_b128 v[132:135], v4 offset:6144
    v_mfma_f32_16x16x32_bf16 v[56:59], v[192:195], v[168:171], v[56:59]
    ds_read_b128 v[136:139], v2 offset:0
    v_mfma_f32_16x16x32_bf16 v[60:63], v[196:199], v[168:171], v[60:63]
    ds_read_b64_tr_b16 v[140:141], v6 offset:0
    v_mfma_f32_16x16x32_bf16 v[28:31], v[188:191], v[168:171], v[28:31]
    ds_read_b64_tr_b16 v[142:143], v6 offset:512
    v_mfma_f32_16x16x32_bf16 v[24:27], v[184:187], v[168:171], v[24:27]
    ds_read_b64_tr_b16 v[144:145], v7 offset:0
    v_mfma_f32_16x16x32_bf16 v[32:35], v[184:187], v[172:175], v[32:35]
    ds_read_b64_tr_b16 v[146:147], v7 offset:512
    v_mfma_f32_16x16x32_bf16 v[36:39], v[188:191], v[172:175], v[36:39]
    ds_read_b64_tr_b16 v[148:149], v6 offset:1024
    v_mfma_f32_16x16x32_bf16 v[68:71], v[196:199], v[172:175], v[68:71]
    ds_read_b64_tr_b16 v[150:151], v6 offset:1536
    v_mfma_f32_16x16x32_bf16 v[64:67], v[192:195], v[172:175], v[64:67]
    ds_read_b64_tr_b16 v[152:153], v7 offset:1024
    v_mfma_f32_16x16x32_bf16 v[112:115], v[192:195], v[180:183], v[112:115]
    ds_read_b64_tr_b16 v[154:155], v7 offset:1536
    v_mfma_f32_16x16x32_bf16 v[72:75], v[192:195], v[176:179], v[72:75]
    ds_read_b64_tr_b16 v[156:157], v6 offset:2048
    v_mfma_f32_16x16x32_bf16 v[76:79], v[196:199], v[176:179], v[76:79]
    ds_read_b64_tr_b16 v[158:159], v6 offset:2560
    v_mfma_f32_16x16x32_bf16 v[44:47], v[188:191], v[176:179], v[44:47]
    ds_read_b64_tr_b16 v[160:161], v7 offset:2048
    v_mfma_f32_16x16x32_bf16 v[40:43], v[184:187], v[176:179], v[40:43]
    ds_read_b64_tr_b16 v[162:163], v7 offset:2560
    v_mfma_f32_16x16x32_bf16 v[104:107], v[176:179], v[200:203], v[104:107]
    v_mfma_f32_16x16x32_bf16 v[108:111], v[176:179], v[204:207], v[108:111]
    v_mfma_f32_16x16x32_bf16 v[100:103], v[172:175], v[204:207], v[100:103]
    v_mfma_f32_16x16x32_bf16 v[96:99], v[172:175], v[200:203], v[96:99]
    v_mfma_f32_16x16x32_bf16 v[88:91], v[168:171], v[200:203], v[88:91]
    v_mfma_f32_16x16x32_bf16 v[92:95], v[168:171], v[204:207], v[92:95]
    v_mfma_f32_16x16x32_bf16 v[84:87], v[164:167], v[204:207], v[84:87]
    v_mfma_f32_16x16x32_bf16 v[80:83], v[164:167], v[200:203], v[80:83]
    v_mfma_f32_16x16x32_bf16 v[116:119], v[180:183], v[200:203], v[116:119]
    s_waitcnt lgkmcnt(0)
    v_mfma_f32_16x16x32_bf16 v[16:19], v[140:143], v[120:123], v[16:19]
    ds_read_b128 v[164:167], v5 offset:0
    v_mfma_f32_16x16x32_bf16 v[20:23], v[144:147], v[120:123], v[20:23]
    ds_read_b128 v[168:171], v5 offset:2048
    v_mfma_f32_16x16x32_bf16 v[52:55], v[152:155], v[120:123], v[52:55]
    ds_read_b128 v[172:175], v5 offset:4096
    v_mfma_f32_16x16x32_bf16 v[48:51], v[148:151], v[120:123], v[48:51]
    ds_read_b128 v[176:179], v5 offset:6144
    v_mfma_f32_16x16x32_bf16 v[56:59], v[148:151], v[124:127], v[56:59]
    ds_read_b128 v[180:183], v3 offset:0
    v_mfma_f32_16x16x32_bf16 v[60:63], v[152:155], v[124:127], v[60:63]
    ds_read_b64_tr_b16 v[184:185], v6 offset:12288
    v_mfma_f32_16x16x32_bf16 v[28:31], v[144:147], v[124:127], v[28:31]
    ds_read_b64_tr_b16 v[186:187], v6 offset:12800
    v_mfma_f32_16x16x32_bf16 v[24:27], v[140:143], v[124:127], v[24:27]
    ds_read_b64_tr_b16 v[188:189], v7 offset:12288
    v_mfma_f32_16x16x32_bf16 v[32:35], v[140:143], v[128:131], v[32:35]
    ds_read_b64_tr_b16 v[190:191], v7 offset:12800
    v_mfma_f32_16x16x32_bf16 v[36:39], v[144:147], v[128:131], v[36:39]
    ds_read_b64_tr_b16 v[192:193], v6 offset:13312
    v_mfma_f32_16x16x32_bf16 v[68:71], v[152:155], v[128:131], v[68:71]
    ds_read_b64_tr_b16 v[194:195], v6 offset:13824
    v_mfma_f32_16x16x32_bf16 v[64:67], v[148:151], v[128:131], v[64:67]
    ds_read_b64_tr_b16 v[196:197], v7 offset:13312
    v_mfma_f32_16x16x32_bf16 v[112:115], v[148:151], v[136:139], v[112:115]
    ds_read_b64_tr_b16 v[198:199], v7 offset:13824
    v_mfma_f32_16x16x32_bf16 v[72:75], v[148:151], v[132:135], v[72:75]
    ds_read_b64_tr_b16 v[200:201], v6 offset:14336
    v_mfma_f32_16x16x32_bf16 v[76:79], v[152:155], v[132:135], v[76:79]
    ds_read_b64_tr_b16 v[202:203], v6 offset:14848
    v_mfma_f32_16x16x32_bf16 v[44:47], v[144:147], v[132:135], v[44:47]
    ds_read_b64_tr_b16 v[204:205], v7 offset:14336
    v_mfma_f32_16x16x32_bf16 v[40:43], v[140:143], v[132:135], v[40:43]
    ds_read_b64_tr_b16 v[206:207], v7 offset:14848
    v_mfma_f32_16x16x32_bf16 v[104:107], v[132:135], v[156:159], v[104:107]
    v_mfma_f32_16x16x32_bf16 v[108:111], v[132:135], v[160:163], v[108:111]
    v_mfma_f32_16x16x32_bf16 v[100:103], v[128:131], v[160:163], v[100:103]
    v_mfma_f32_16x16x32_bf16 v[96:99], v[128:131], v[156:159], v[96:99]
    v_mfma_f32_16x16x32_bf16 v[88:91], v[124:127], v[156:159], v[88:91]
    v_mfma_f32_16x16x32_bf16 v[92:95], v[124:127], v[160:163], v[92:95]
    v_mfma_f32_16x16x32_bf16 v[84:87], v[120:123], v[160:163], v[84:87]
    v_mfma_f32_16x16x32_bf16 v[80:83], v[120:123], v[156:159], v[80:83]
    v_mfma_f32_16x16x32_bf16 v[116:119], v[136:139], v[156:159], v[116:119]
    s_waitcnt lgkmcnt(0)
    s_barrier
    v_mfma_f32_16x16x32_bf16 v[16:19], v[184:187], v[164:167], v[16:19]
    ds_read_b128 v[120:123], v4 offset:18432
    v_mfma_f32_16x16x32_bf16 v[20:23], v[188:191], v[164:167], v[20:23]
    ds_read_b128 v[124:127], v4 offset:20480
    v_mfma_f32_16x16x32_bf16 v[52:55], v[196:199], v[164:167], v[52:55]
    ds_read_b128 v[128:131], v4 offset:22528
    v_mfma_f32_16x16x32_bf16 v[48:51], v[192:195], v[164:167], v[48:51]
    ds_read_b128 v[132:135], v4 offset:24576
    v_mfma_f32_16x16x32_bf16 v[56:59], v[192:195], v[168:171], v[56:59]
    ds_read_b128 v[136:139], v2 offset:18432
    v_mfma_f32_16x16x32_bf16 v[60:63], v[196:199], v[168:171], v[60:63]
    ds_read_b64_tr_b16 v[140:141], v6 offset:24576
    v_mfma_f32_16x16x32_bf16 v[28:31], v[188:191], v[168:171], v[28:31]
    ds_read_b64_tr_b16 v[142:143], v6 offset:25088
    v_mfma_f32_16x16x32_bf16 v[24:27], v[184:187], v[168:171], v[24:27]
    ds_read_b64_tr_b16 v[144:145], v7 offset:24576
    v_mfma_f32_16x16x32_bf16 v[32:35], v[184:187], v[172:175], v[32:35]
    ds_read_b64_tr_b16 v[146:147], v7 offset:25088
    v_mfma_f32_16x16x32_bf16 v[36:39], v[188:191], v[172:175], v[36:39]
    ds_read_b64_tr_b16 v[148:149], v6 offset:25600
    v_mfma_f32_16x16x32_bf16 v[68:71], v[196:199], v[172:175], v[68:71]
    ds_read_b64_tr_b16 v[150:151], v6 offset:26112
    v_mfma_f32_16x16x32_bf16 v[64:67], v[192:195], v[172:175], v[64:67]
    ds_read_b64_tr_b16 v[152:153], v7 offset:25600
    v_mfma_f32_16x16x32_bf16 v[112:115], v[192:195], v[180:183], v[112:115]
    ds_read_b64_tr_b16 v[154:155], v7 offset:26112
    v_mfma_f32_16x16x32_bf16 v[72:75], v[192:195], v[176:179], v[72:75]
    ds_read_b64_tr_b16 v[156:157], v6 offset:26624
    v_mfma_f32_16x16x32_bf16 v[76:79], v[196:199], v[176:179], v[76:79]
    ds_read_b64_tr_b16 v[158:159], v6 offset:27136
    v_mfma_f32_16x16x32_bf16 v[44:47], v[188:191], v[176:179], v[44:47]
    ds_read_b64_tr_b16 v[160:161], v7 offset:26624
    v_mfma_f32_16x16x32_bf16 v[40:43], v[184:187], v[176:179], v[40:43]
    ds_read_b64_tr_b16 v[162:163], v7 offset:27136
    v_mfma_f32_16x16x32_bf16 v[104:107], v[176:179], v[200:203], v[104:107]
    v_mfma_f32_16x16x32_bf16 v[108:111], v[176:179], v[204:207], v[108:111]
    v_mfma_f32_16x16x32_bf16 v[100:103], v[172:175], v[204:207], v[100:103]
    v_mfma_f32_16x16x32_bf16 v[96:99], v[172:175], v[200:203], v[96:99]
    v_mfma_f32_16x16x32_bf16 v[88:91], v[168:171], v[200:203], v[88:91]
    v_mfma_f32_16x16x32_bf16 v[92:95], v[168:171], v[204:207], v[92:95]
    v_mfma_f32_16x16x32_bf16 v[84:87], v[164:167], v[204:207], v[84:87]
    v_mfma_f32_16x16x32_bf16 v[80:83], v[164:167], v[200:203], v[80:83]
    v_mfma_f32_16x16x32_bf16 v[116:119], v[180:183], v[200:203], v[116:119]
    s_waitcnt lgkmcnt(0)
    v_mfma_f32_16x16x32_bf16 v[16:19], v[140:143], v[120:123], v[16:19]
    ds_read_b128 v[164:167], v5 offset:18432
    v_mfma_f32_16x16x32_bf16 v[20:23], v[144:147], v[120:123], v[20:23]
    ds_read_b128 v[168:171], v5 offset:20480
    v_mfma_f32_16x16x32_bf16 v[52:55], v[152:155], v[120:123], v[52:55]
    ds_read_b128 v[172:175], v5 offset:22528
    v_mfma_f32_16x16x32_bf16 v[48:51], v[148:151], v[120:123], v[48:51]
    ds_read_b128 v[176:179], v5 offset:24576
    v_mfma_f32_16x16x32_bf16 v[56:59], v[148:151], v[124:127], v[56:59]
    ds_read_b128 v[180:183], v3 offset:18432
    v_mfma_f32_16x16x32_bf16 v[60:63], v[152:155], v[124:127], v[60:63]
    ds_read_b64_tr_b16 v[184:185], v6 offset:36864
    v_mfma_f32_16x16x32_bf16 v[28:31], v[144:147], v[124:127], v[28:31]
    ds_read_b64_tr_b16 v[186:187], v6 offset:37376
    v_mfma_f32_16x16x32_bf16 v[24:27], v[140:143], v[124:127], v[24:27]
    ds_read_b64_tr_b16 v[188:189], v7 offset:36864
    v_mfma_f32_16x16x32_bf16 v[32:35], v[140:143], v[128:131], v[32:35]
    ds_read_b64_tr_b16 v[190:191], v7 offset:37376
    v_mfma_f32_16x16x32_bf16 v[36:39], v[144:147], v[128:131], v[36:39]
    ds_read_b64_tr_b16 v[192:193], v6 offset:37888
    v_mfma_f32_16x16x32_bf16 v[68:71], v[152:155], v[128:131], v[68:71]
    ds_read_b64_tr_b16 v[194:195], v6 offset:38400
    v_mfma_f32_16x16x32_bf16 v[64:67], v[148:151], v[128:131], v[64:67]
    ds_read_b64_tr_b16 v[196:197], v7 offset:37888
    v_mfma_f32_16x16x32_bf16 v[112:115], v[148:151], v[136:139], v[112:115]
    ds_read_b64_tr_b16 v[198:199], v7 offset:38400
    v_mfma_f32_16x16x32_bf16 v[72:75], v[148:151], v[132:135], v[72:75]
    ds_read_b64_tr_b16 v[200:201], v6 offset:38912
    v_mfma_f32_16x16x32_bf16 v[76:79], v[152:155], v[132:135], v[76:79]
    ds_read_b64_tr_b16 v[202:203], v6 offset:39424
    v_mfma_f32_16x16x32_bf16 v[44:47], v[144:147], v[132:135], v[44:47]
    ds_read_b64_tr_b16 v[204:205], v7 offset:38912
    v_mfma_f32_16x16x32_bf16 v[40:43], v[140:143], v[132:135], v[40:43]
    ds_read_b64_tr_b16 v[206:207], v7 offset:39424
    v_mfma_f32_16x16x32_bf16 v[104:107], v[132:135], v[156:159], v[104:107]
    v_mfma_f32_16x16x32_bf16 v[108:111], v[132:135], v[160:163], v[108:111]
    v_mfma_f32_16x16x32_bf16 v[100:103], v[128:131], v[160:163], v[100:103]
    v_mfma_f32_16x16x32_bf16 v[96:99], v[128:131], v[156:159], v[96:99]
    v_mfma_f32_16x16x32_bf16 v[88:91], v[124:127], v[156:159], v[88:91]
    v_mfma_f32_16x16x32_bf16 v[92:95], v[124:127], v[160:163], v[92:95]
    v_mfma_f32_16x16x32_bf16 v[84:87], v[120:123], v[160:163], v[84:87]
    v_mfma_f32_16x16x32_bf16 v[80:83], v[120:123], v[156:159], v[80:83]
    v_mfma_f32_16x16x32_bf16 v[116:119], v[136:139], v[156:159], v[116:119]
    s_waitcnt lgkmcnt(0)
    s_barrier
    v_mfma_f32_16x16x32_bf16 v[16:19], v[184:187], v[164:167], v[16:19]
    ds_read_b128 v[120:123], v4 offset:36864
    v_mfma_f32_16x16x32_bf16 v[20:23], v[188:191], v[164:167], v[20:23]
    ds_read_b128 v[124:127], v4 offset:38912
    v_mfma_f32_16x16x32_bf16 v[52:55], v[196:199], v[164:167], v[52:55]
    ds_read_b128 v[128:131], v4 offset:40960
    v_mfma_f32_16x16x32_bf16 v[48:51], v[192:195], v[164:167], v[48:51]
    ds_read_b128 v[132:135], v4 offset:43008
    v_mfma_f32_16x16x32_bf16 v[56:59], v[192:195], v[168:171], v[56:59]
    ds_read_b128 v[136:139], v2 offset:36864
    v_mfma_f32_16x16x32_bf16 v[60:63], v[196:199], v[168:171], v[60:63]
    ds_read_b64_tr_b16 v[140:141], v6 offset:49152
    v_mfma_f32_16x16x32_bf16 v[28:31], v[188:191], v[168:171], v[28:31]
    ds_read_b64_tr_b16 v[142:143], v6 offset:49664
    v_mfma_f32_16x16x32_bf16 v[24:27], v[184:187], v[168:171], v[24:27]
    ds_read_b64_tr_b16 v[144:145], v7 offset:49152
    v_mfma_f32_16x16x32_bf16 v[32:35], v[184:187], v[172:175], v[32:35]
    ds_read_b64_tr_b16 v[146:147], v7 offset:49664
    v_mfma_f32_16x16x32_bf16 v[36:39], v[188:191], v[172:175], v[36:39]
    ds_read_b64_tr_b16 v[148:149], v6 offset:50176
    v_mfma_f32_16x16x32_bf16 v[68:71], v[196:199], v[172:175], v[68:71]
    ds_read_b64_tr_b16 v[150:151], v6 offset:50688
    v_mfma_f32_16x16x32_bf16 v[64:67], v[192:195], v[172:175], v[64:67]
    ds_read_b64_tr_b16 v[152:153], v7 offset:50176
    v_mfma_f32_16x16x32_bf16 v[112:115], v[192:195], v[180:183], v[112:115]
    ds_read_b64_tr_b16 v[154:155], v7 offset:50688
    v_mfma_f32_16x16x32_bf16 v[72:75], v[192:195], v[176:179], v[72:75]
    ds_read_b64_tr_b16 v[156:157], v6 offset:51200
    v_mfma_f32_16x16x32_bf16 v[76:79], v[196:199], v[176:179], v[76:79]
    ds_read_b64_tr_b16 v[158:159], v6 offset:51712
    v_mfma_f32_16x16x32_bf16 v[44:47], v[188:191], v[176:179], v[44:47]
    ds_read_b64_tr_b16 v[160:161], v7 offset:51200
    v_mfma_f32_16x16x32_bf16 v[40:43], v[184:187], v[176:179], v[40:43]
    ds_read_b64_tr_b16 v[162:163], v7 offset:51712
    v_mfma_f32_16x16x32_bf16 v[104:107], v[176:179], v[200:203], v[104:107]
    v_mfma_f32_16x16x32_bf16 v[108:111], v[176:179], v[204:207], v[108:111]
    v_mfma_f32_16x16x32_bf16 v[100:103], v[172:175], v[204:207], v[100:103]
    v_mfma_f32_16x16x32_bf16 v[96:99], v[172:175], v[200:203], v[96:99]
    v_mfma_f32_16x16x32_bf16 v[88:91], v[168:171], v[200:203], v[88:91]
    v_mfma_f32_16x16x32_bf16 v[92:95], v[168:171], v[204:207], v[92:95]
    v_mfma_f32_16x16x32_bf16 v[84:87], v[164:167], v[204:207], v[84:87]
    v_mfma_f32_16x16x32_bf16 v[80:83], v[164:167], v[200:203], v[80:83]
    v_mfma_f32_16x16x32_bf16 v[116:119], v[180:183], v[200:203], v[116:119]
    s_waitcnt lgkmcnt(0)
    v_mfma_f32_16x16x32_bf16 v[16:19], v[140:143], v[120:123], v[16:19]
    ds_read_b128 v[164:167], v5 offset:36864
    v_mfma_f32_16x16x32_bf16 v[20:23], v[144:147], v[120:123], v[20:23]
    ds_read_b128 v[168:171], v5 offset:38912
    v_mfma_f32_16x16x32_bf16 v[52:55], v[152:155], v[120:123], v[52:55]
    ds_read_b128 v[172:175], v5 offset:40960
    v_mfma_f32_16x16x32_bf16 v[48:51], v[148:151], v[120:123], v[48:51]
    ds_read_b128 v[176:179], v5 offset:43008
    v_mfma_f32_16x16x32_bf16 v[56:59], v[148:151], v[124:127], v[56:59]
    ds_read_b128 v[180:183], v3 offset:36864
    v_mfma_f32_16x16x32_bf16 v[60:63], v[152:155], v[124:127], v[60:63]
    ds_read_b64_tr_b16 v[184:185], v6 offset:61440
    v_mfma_f32_16x16x32_bf16 v[28:31], v[144:147], v[124:127], v[28:31]
    ds_read_b64_tr_b16 v[186:187], v6 offset:61952
    v_mfma_f32_16x16x32_bf16 v[24:27], v[140:143], v[124:127], v[24:27]
    ds_read_b64_tr_b16 v[188:189], v7 offset:61440
    v_mfma_f32_16x16x32_bf16 v[32:35], v[140:143], v[128:131], v[32:35]
    ds_read_b64_tr_b16 v[190:191], v7 offset:61952
    v_mfma_f32_16x16x32_bf16 v[36:39], v[144:147], v[128:131], v[36:39]
    ds_read_b64_tr_b16 v[192:193], v6 offset:62464
    v_mfma_f32_16x16x32_bf16 v[68:71], v[152:155], v[128:131], v[68:71]
    ds_read_b64_tr_b16 v[194:195], v6 offset:62976
    v_mfma_f32_16x16x32_bf16 v[64:67], v[148:151], v[128:131], v[64:67]
    ds_read_b64_tr_b16 v[196:197], v7 offset:62464
    v_mfma_f32_16x16x32_bf16 v[112:115], v[148:151], v[136:139], v[112:115]
    ds_read_b64_tr_b16 v[198:199], v7 offset:62976
    v_mfma_f32_16x16x32_bf16 v[72:75], v[148:151], v[132:135], v[72:75]
    ds_read_b64_tr_b16 v[200:201], v6 offset:63488
    v_mfma_f32_16x16x32_bf16 v[76:79], v[152:155], v[132:135], v[76:79]
    ds_read_b64_tr_b16 v[202:203], v6 offset:64000
    v_mfma_f32_16x16x32_bf16 v[44:47], v[144:147], v[132:135], v[44:47]
    ds_read_b64_tr_b16 v[204:205], v7 offset:63488
    v_mfma_f32_16x16x32_bf16 v[40:43], v[140:143], v[132:135], v[40:43]
    ds_read_b64_tr_b16 v[206:207], v7 offset:64000
    v_mfma_f32_16x16x32_bf16 v[104:107], v[132:135], v[156:159], v[104:107]
    buffer_load_dword v222, v220, s[68:71], s98 offen sc1
    v_mfma_f32_16x16x32_bf16 v[108:111], v[132:135], v[160:163], v[108:111]
    v_mfma_f32_16x16x32_bf16 v[100:103], v[128:131], v[160:163], v[100:103]
    v_mfma_f32_16x16x32_bf16 v[96:99], v[128:131], v[156:159], v[96:99]
    v_mfma_f32_16x16x32_bf16 v[88:91], v[124:127], v[156:159], v[88:91]
    v_mfma_f32_16x16x32_bf16 v[92:95], v[124:127], v[160:163], v[92:95]
    v_mfma_f32_16x16x32_bf16 v[84:87], v[120:123], v[160:163], v[84:87]
    v_mfma_f32_16x16x32_bf16 v[80:83], v[120:123], v[156:159], v[80:83]
    v_mfma_f32_16x16x32_bf16 v[116:119], v[136:139], v[156:159], v[116:119]
    s_waitcnt lgkmcnt(0)
    s_barrier
    v_mfma_f32_16x16x32_bf16 v[16:19], v[184:187], v[164:167], v[16:19]
    ds_read_b128 v[120:123], v4 offset:0
    v_mfma_f32_16x16x32_bf16 v[20:23], v[188:191], v[164:167], v[20:23]
    ds_read_b128 v[124:127], v4 offset:2048
    v_mfma_f32_16x16x32_bf16 v[52:55], v[196:199], v[164:167], v[52:55]
    ds_read_b128 v[128:131], v4 offset:4096
    v_mfma_f32_16x16x32_bf16 v[48:51], v[192:195], v[164:167], v[48:51]
    ds_read_b128 v[132:135], v4 offset:6144
    v_mfma_f32_16x16x32_bf16 v[56:59], v[192:195], v[168:171], v[56:59]
    ds_read_b128 v[136:139], v2 offset:0
    v_mfma_f32_16x16x32_bf16 v[60:63], v[196:199], v[168:171], v[60:63]
    ds_read_b64_tr_b16 v[140:141], v6 offset:0
    v_mfma_f32_16x16x32_bf16 v[28:31], v[188:191], v[168:171], v[28:31]
    ds_read_b64_tr_b16 v[142:143], v6 offset:512
    v_mfma_f32_16x16x32_bf16 v[24:27], v[184:187], v[168:171], v[24:27]
    ds_read_b64_tr_b16 v[144:145], v7 offset:0
    v_mfma_f32_16x16x32_bf16 v[32:35], v[184:187], v[172:175], v[32:35]
    ds_read_b64_tr_b16 v[146:147], v7 offset:512
    v_mfma_f32_16x16x32_bf16 v[36:39], v[188:191], v[172:175], v[36:39]
    ds_read_b64_tr_b16 v[148:149], v6 offset:1024
    v_mfma_f32_16x16x32_bf16 v[68:71], v[196:199], v[172:175], v[68:71]
    ds_read_b64_tr_b16 v[150:151], v6 offset:1536
    v_mfma_f32_16x16x32_bf16 v[64:67], v[192:195], v[172:175], v[64:67]
    ds_read_b64_tr_b16 v[152:153], v7 offset:1024
    v_mfma_f32_16x16x32_bf16 v[112:115], v[192:195], v[180:183], v[112:115]
    ds_read_b64_tr_b16 v[154:155], v7 offset:1536
    v_mfma_f32_16x16x32_bf16 v[72:75], v[192:195], v[176:179], v[72:75]
    ds_read_b64_tr_b16 v[156:157], v6 offset:2048
    v_mfma_f32_16x16x32_bf16 v[76:79], v[196:199], v[176:179], v[76:79]
    ds_read_b64_tr_b16 v[158:159], v6 offset:2560
    v_mfma_f32_16x16x32_bf16 v[44:47], v[188:191], v[176:179], v[44:47]
    ds_read_b64_tr_b16 v[160:161], v7 offset:2048
    v_mfma_f32_16x16x32_bf16 v[40:43], v[184:187], v[176:179], v[40:43]
    ds_read_b64_tr_b16 v[162:163], v7 offset:2560
    v_mfma_f32_16x16x32_bf16 v[104:107], v[176:179], v[200:203], v[104:107]
    v_mfma_f32_16x16x32_bf16 v[108:111], v[176:179], v[204:207], v[108:111]
    v_mfma_f32_16x16x32_bf16 v[100:103], v[172:175], v[204:207], v[100:103]
    v_mfma_f32_16x16x32_bf16 v[96:99], v[172:175], v[200:203], v[96:99]
    v_mfma_f32_16x16x32_bf16 v[88:91], v[168:171], v[200:203], v[88:91]
    v_mfma_f32_16x16x32_bf16 v[92:95], v[168:171], v[204:207], v[92:95]
    v_mfma_f32_16x16x32_bf16 v[84:87], v[164:167], v[204:207], v[84:87]
    v_mfma_f32_16x16x32_bf16 v[80:83], v[164:167], v[200:203], v[80:83]
    v_mfma_f32_16x16x32_bf16 v[116:119], v[180:183], v[200:203], v[116:119]
    s_waitcnt lgkmcnt(0)
    v_mfma_f32_16x16x32_bf16 v[16:19], v[140:143], v[120:123], v[16:19]
    ds_read_b128 v[164:167], v5 offset:0
    v_mfma_f32_16x16x32_bf16 v[20:23], v[144:147], v[120:123], v[20:23]
    ds_read_b128 v[168:171], v5 offset:2048
    v_mfma_f32_16x16x32_bf16 v[52:55], v[152:155], v[120:123], v[52:55]
    ds_read_b128 v[172:175], v5 offset:4096
    v_mfma_f32_16x16x32_bf16 v[48:51], v[148:151], v[120:123], v[48:51]
    ds_read_b128 v[176:179], v5 offset:6144
    v_mfma_f32_16x16x32_bf16 v[56:59], v[148:151], v[124:127], v[56:59]
    ds_read_b128 v[180:183], v3 offset:0
    v_mfma_f32_16x16x32_bf16 v[60:63], v[152:155], v[124:127], v[60:63]
    ds_read_b64_tr_b16 v[184:185], v6 offset:12288
    v_mfma_f32_16x16x32_bf16 v[28:31], v[144:147], v[124:127], v[28:31]
    ds_read_b64_tr_b16 v[186:187], v6 offset:12800
    v_mfma_f32_16x16x32_bf16 v[24:27], v[140:143], v[124:127], v[24:27]
    ds_read_b64_tr_b16 v[188:189], v7 offset:12288
    v_mfma_f32_16x16x32_bf16 v[32:35], v[140:143], v[128:131], v[32:35]
    ds_read_b64_tr_b16 v[190:191], v7 offset:12800
    v_mfma_f32_16x16x32_bf16 v[36:39], v[144:147], v[128:131], v[36:39]
    ds_read_b64_tr_b16 v[192:193], v6 offset:13312
    v_mfma_f32_16x16x32_bf16 v[68:71], v[152:155], v[128:131], v[68:71]
    ds_read_b64_tr_b16 v[194:195], v6 offset:13824
    v_mfma_f32_16x16x32_bf16 v[64:67], v[148:151], v[128:131], v[64:67]
    ds_read_b64_tr_b16 v[196:197], v7 offset:13312
    v_mfma_f32_16x16x32_bf16 v[112:115], v[148:151], v[136:139], v[112:115]
    ds_read_b64_tr_b16 v[198:199], v7 offset:13824
    v_mfma_f32_16x16x32_bf16 v[72:75], v[148:151], v[132:135], v[72:75]
    ds_read_b64_tr_b16 v[200:201], v6 offset:14336
    v_mfma_f32_16x16x32_bf16 v[76:79], v[152:155], v[132:135], v[76:79]
    ds_read_b64_tr_b16 v[202:203], v6 offset:14848
    v_mfma_f32_16x16x32_bf16 v[44:47], v[144:147], v[132:135], v[44:47]
    ds_read_b64_tr_b16 v[204:205], v7 offset:14336
    v_mfma_f32_16x16x32_bf16 v[40:43], v[140:143], v[132:135], v[40:43]
    ds_read_b64_tr_b16 v[206:207], v7 offset:14848
    v_mfma_f32_16x16x32_bf16 v[104:107], v[132:135], v[156:159], v[104:107]
    v_mfma_f32_16x16x32_bf16 v[108:111], v[132:135], v[160:163], v[108:111]
    v_mfma_f32_16x16x32_bf16 v[100:103], v[128:131], v[160:163], v[100:103]
    v_mfma_f32_16x16x32_bf16 v[96:99], v[128:131], v[156:159], v[96:99]
    v_mfma_f32_16x16x32_bf16 v[88:91], v[124:127], v[156:159], v[88:91]
    v_mfma_f32_16x16x32_bf16 v[92:95], v[124:127], v[160:163], v[92:95]
    v_mfma_f32_16x16x32_bf16 v[84:87], v[120:123], v[160:163], v[84:87]
    v_mfma_f32_16x16x32_bf16 v[80:83], v[120:123], v[156:159], v[80:83]
    v_mfma_f32_16x16x32_bf16 v[116:119], v[136:139], v[156:159], v[116:119]
    s_waitcnt lgkmcnt(0)
    s_barrier
    v_mfma_f32_16x16x32_bf16 v[16:19], v[184:187], v[164:167], v[16:19]
    ds_read_b128 v[120:123], v4 offset:18432
    v_mfma_f32_16x16x32_bf16 v[20:23], v[188:191], v[164:167], v[20:23]
    ds_read_b128 v[124:127], v4 offset:20480
    v_mfma_f32_16x16x32_bf16 v[52:55], v[196:199], v[164:167], v[52:55]
    ds_read_b128 v[128:131], v4 offset:22528
    v_mfma_f32_16x16x32_bf16 v[48:51], v[192:195], v[164:167], v[48:51]
    ds_read_b128 v[132:135], v4 offset:24576
    v_mfma_f32_16x16x32_bf16 v[56:59], v[192:195], v[168:171], v[56:59]
    ds_read_b128 v[136:139], v2 offset:18432
    v_mfma_f32_16x16x32_bf16 v[60:63], v[196:199], v[168:171], v[60:63]
    ds_read_b64_tr_b16 v[140:141], v6 offset:24576
    v_mfma_f32_16x16x32_bf16 v[28:31], v[188:191], v[168:171], v[28:31]
    ds_read_b64_tr_b16 v[142:143], v6 offset:25088
    v_mfma_f32_16x16x32_bf16 v[24:27], v[184:187], v[168:171], v[24:27]
    ds_read_b64_tr_b16 v[144:145], v7 offset:24576
    v_mfma_f32_16x16x32_bf16 v[32:35], v[184:187], v[172:175], v[32:35]
    ds_read_b64_tr_b16 v[146:147], v7 offset:25088
    v_mfma_f32_16x16x32_bf16 v[36:39], v[188:191], v[172:175], v[36:39]
    ds_read_b64_tr_b16 v[148:149], v6 offset:25600
    v_mfma_f32_16x16x32_bf16 v[68:71], v[196:199], v[172:175], v[68:71]
    ds_read_b64_tr_b16 v[150:151], v6 offset:26112
    v_mfma_f32_16x16x32_bf16 v[64:67], v[192:195], v[172:175], v[64:67]
    ds_read_b64_tr_b16 v[152:153], v7 offset:25600
    v_mfma_f32_16x16x32_bf16 v[112:115], v[192:195], v[180:183], v[112:115]
    ds_read_b64_tr_b16 v[154:155], v7 offset:26112
    v_mfma_f32_16x16x32_bf16 v[72:75], v[192:195], v[176:179], v[72:75]
    ds_read_b64_tr_b16 v[156:157], v6 offset:26624
    v_mfma_f32_16x16x32_bf16 v[76:79], v[196:199], v[176:179], v[76:79]
    ds_read_b64_tr_b16 v[158:159], v6 offset:27136
    v_mfma_f32_16x16x32_bf16 v[44:47], v[188:191], v[176:179], v[44:47]
    ds_read_b64_tr_b16 v[160:161], v7 offset:26624
    v_mfma_f32_16x16x32_bf16 v[40:43], v[184:187], v[176:179], v[40:43]
    ds_read_b64_tr_b16 v[162:163], v7 offset:27136
    v_mfma_f32_16x16x32_bf16 v[104:107], v[176:179], v[200:203], v[104:107]
    v_mfma_f32_16x16x32_bf16 v[108:111], v[176:179], v[204:207], v[108:111]
    v_mfma_f32_16x16x32_bf16 v[100:103], v[172:175], v[204:207], v[100:103]
    v_mfma_f32_16x16x32_bf16 v[96:99], v[172:175], v[200:203], v[96:99]
    v_mfma_f32_16x16x32_bf16 v[88:91], v[168:171], v[200:203], v[88:91]
    v_mfma_f32_16x16x32_bf16 v[92:95], v[168:171], v[204:207], v[92:95]
    v_mfma_f32_16x16x32_bf16 v[84:87], v[164:167], v[204:207], v[84:87]
    v_mfma_f32_16x16x32_bf16 v[80:83], v[164:167], v[200:203], v[80:83]
    v_mfma_f32_16x16x32_bf16 v[116:119], v[180:183], v[200:203], v[116:119]
    s_waitcnt lgkmcnt(0)
    v_mfma_f32_16x16x32_bf16 v[16:19], v[140:143], v[120:123], v[16:19]
    ds_read_b128 v[164:167], v5 offset:18432
    v_mfma_f32_16x16x32_bf16 v[20:23], v[144:147], v[120:123], v[20:23]
    ds_read_b128 v[168:171], v5 offset:20480
    v_mfma_f32_16x16x32_bf16 v[52:55], v[152:155], v[120:123], v[52:55]
    ds_read_b128 v[172:175], v5 offset:22528
    v_mfma_f32_16x16x32_bf16 v[48:51], v[148:151], v[120:123], v[48:51]
    ds_read_b128 v[176:179], v5 offset:24576
    v_mfma_f32_16x16x32_bf16 v[56:59], v[148:151], v[124:127], v[56:59]
    ds_read_b128 v[180:183], v3 offset:18432
    v_mfma_f32_16x16x32_bf16 v[60:63], v[152:155], v[124:127], v[60:63]
    ds_read_b64_tr_b16 v[184:185], v6 offset:36864
    v_mfma_f32_16x16x32_bf16 v[28:31], v[144:147], v[124:127], v[28:31]
    ds_read_b64_tr_b16 v[186:187], v6 offset:37376
    v_mfma_f32_16x16x32_bf16 v[24:27], v[140:143], v[124:127], v[24:27]
    ds_read_b64_tr_b16 v[188:189], v7 offset:36864
    v_mfma_f32_16x16x32_bf16 v[32:35], v[140:143], v[128:131], v[32:35]
    ds_read_b64_tr_b16 v[190:191], v7 offset:37376
    v_mfma_f32_16x16x32_bf16 v[36:39], v[144:147], v[128:131], v[36:39]
    ds_read_b64_tr_b16 v[192:193], v6 offset:37888
    v_mfma_f32_16x16x32_bf16 v[68:71], v[152:155], v[128:131], v[68:71]
    ds_read_b64_tr_b16 v[194:195], v6 offset:38400
    v_mfma_f32_16x16x32_bf16 v[64:67], v[148:151], v[128:131], v[64:67]
    ds_read_b64_tr_b16 v[196:197], v7 offset:37888
    v_mfma_f32_16x16x32_bf16 v[112:115], v[148:151], v[136:139], v[112:115]
    ds_read_b64_tr_b16 v[198:199], v7 offset:38400
    v_mfma_f32_16x16x32_bf16 v[72:75], v[148:151], v[132:135], v[72:75]
    ds_read_b64_tr_b16 v[200:201], v6 offset:38912
    v_mfma_f32_16x16x32_bf16 v[76:79], v[152:155], v[132:135], v[76:79]
    ds_read_b64_tr_b16 v[202:203], v6 offset:39424
    v_mfma_f32_16x16x32_bf16 v[44:47], v[144:147], v[132:135], v[44:47]
    ds_read_b64_tr_b16 v[204:205], v7 offset:38912
    v_mfma_f32_16x16x32_bf16 v[40:43], v[140:143], v[132:135], v[40:43]
    ds_read_b64_tr_b16 v[206:207], v7 offset:39424
    v_mfma_f32_16x16x32_bf16 v[104:107], v[132:135], v[156:159], v[104:107]
    v_mfma_f32_16x16x32_bf16 v[108:111], v[132:135], v[160:163], v[108:111]
    v_mfma_f32_16x16x32_bf16 v[100:103], v[128:131], v[160:163], v[100:103]
    v_mfma_f32_16x16x32_bf16 v[96:99], v[128:131], v[156:159], v[96:99]
    v_mfma_f32_16x16x32_bf16 v[88:91], v[124:127], v[156:159], v[88:91]
    v_mfma_f32_16x16x32_bf16 v[92:95], v[124:127], v[160:163], v[92:95]
    v_mfma_f32_16x16x32_bf16 v[84:87], v[120:123], v[160:163], v[84:87]
    v_mfma_f32_16x16x32_bf16 v[80:83], v[120:123], v[156:159], v[80:83]
    v_mfma_f32_16x16x32_bf16 v[116:119], v[136:139], v[156:159], v[116:119]
    s_waitcnt lgkmcnt(0)
    s_barrier
    s_cmp_lg_u32 s3, 0
    s_cbranch_scc1 LB_sk
    s_waitcnt vmcnt(0)
    v_cmp_eq_u32 vcc, 0, v222
    s_cbranch_vccnz LB_slow
LB_back:
    s_mov_b64 exec, 1
    buffer_store_dword v222, v220, s[52:55], s96 offen sc1
    s_mov_b64 exec, -1
LB_sk:
    v_mfma_f32_16x16x32_bf16 v[16:19], v[184:187], v[164:167], v[16:19]
    ds_read_b128 v[120:123], v4 offset:36864
    v_mfma_f32_16x16x32_bf16 v[20:23], v[188:191], v[164:167], v[20:23]
    ds_read_b128 v[124:127], v4 offset:38912
    v_mfma_f32_16x16x32_bf16 v[52:55], v[196:199], v[164:167], v[52:55]
    ds_read_b128 v[128:131], v4 offset:40960
    v_mfma_f32_16x16x32_bf16 v[48:51], v[192:195], v[164:167], v[48:51]
    ds_read_b128 v[132:135], v4 offset:43008
    v_mfma_f32_16x16x32_bf16 v[56:59], v[192:195], v[168:171], v[56:59]
    ds_read_b128 v[136:139], v2 offset:36864
    v_mfma_f32_16x16x32_bf16 v[60:63], v[196:199], v[168:171], v[60:63]
    ds_read_b64_tr_b16 v[140:141], v6 offset:49152
    v_mfma_f32_16x16x32_bf16 v[28:31], v[188:191], v[168:171], v[28:31]
    ds_read_b64_tr_b16 v[142:143], v6 offset:49664
    v_mfma_f32_16x16x32_bf16 v[24:27], v[184:187], v[168:171], v[24:27]
    ds_read_b64_tr_b16 v[144:145], v7 offset:49152
    v_mfma_f32_16x16x32_bf16 v[32:35], v[184:187], v[172:175], v[32:35]
    ds_read_b64_tr_b16 v[146:147], v7 offset:49664
    v_mfma_f32_16x16x32_bf16 v[36:39], v[188:191], v[172:175], v[36:39]
    ds_read_b64_tr_b16 v[148:149], v6 offset:50176
    v_mfma_f32_16x16x32_bf16 v[68:71], v[196:199], v[172:175], v[68:71]
    ds_read_b64_tr_b16 v[150:151], v6 offset:50688
    v_mfma_f32_16x16x32_bf16 v[64:67], v[192:195], v[172:175], v[64:67]
    ds_read_b64_tr_b16 v[152:153], v7 offset:50176
    v_mfma_f32_16x16x32_bf16 v[112:115], v[192:195], v[180:183], v[112:115]
    ds_read_b64_tr_b16 v[154:155], v7 offset:50688
    v_mfma_f32_16x16x32_bf16 v[72:75], v[192:195], v[176:179], v[72:75]
    ds_read_b64_tr_b16 v[156:157], v6 offset:51200
    v_mfma_f32_16x16x32_bf16 v[76:79], v[196:199], v[176:179], v[76:79]
    ds_read_b64_tr_b16 v[158:159], v6 offset:51712
    v_mfma_f32_16x16x32_bf16 v[44:47], v[188:191], v[176:179], v[44:47]
    ds_read_b64_tr_b16 v[160:161], v7 offset:51200
    v_mfma_f32_16x16x32_bf16 v[40:43], v[184:187], v[176:179], v[40:43]
    ds_read_b64_tr_b16 v[162:163], v7 offset:51712
    v_mfma_f32_16x16x32_bf16 v[104:107], v[176:179], v[200:203], v[104:107]
    v_mfma_f32_16x16x32_bf16 v[108:111], v[176:179], v[204:207], v[108:111]
    v_mfma_f32_16x16x32_bf16 v[100:103], v[172:175], v[204:207], v[100:103]
    v_mfma_f32_16x16x32_bf16 v[96:99], v[172:175], v[200:203], v[96:99]
    v_mfma_f32_16x16x32_bf16 v[88:91], v[168:171], v[200:203], v[88:91]
    v_mfma_f32_16x16x32_bf16 v[92:95], v[168:171], v[204:207], v[92:95]
    v_mfma_f32_16x16x32_bf16 v[84:87], v[164:167], v[204:207], v[84:87]
    v_mfma_f32_16x16x32_bf16 v[80:83], v[164:167], v[200:203], v[80:83]
    v_mfma_f32_16x16x32_bf16 v[116:119], v[180:183], v[200:203], v[116:119]
    s_waitcnt lgkmcnt(0)
    v_mfma_f32_16x16x32_bf16 v[16:19], v[140:143], v[120:123], v[16:19]
    ds_read_b128 v[164:167], v5 offset:36864
    v_mfma_f32_16x16x32_bf16 v[20:23], v[144:147], v[120:123], v[20:23]
    ds_read_b128 v[168:171], v5 offset:38912
    v_mfma_f32_16x16x32_bf16 v[52:55], v[152:155], v[120:123], v[52:55]
    ds_read_b128 v[172:175], v5 offset:40960
    v_mfma_f32_16x16x32_bf16 v[48:51], v[148:151], v[120:123], v[48:51]
    ds_read_b128 v[176:179], v5 offset:43008
    v_mfma_f32_16x16x32_bf16 v[56:59], v[148:151], v[124:127], v[56:59]
    ds_read_b128 v[180:183], v3 offset:36864
    v_mfma_f32_16x16x32_bf16 v[60:63], v[152:155], v[124:127], v[60:63]
    ds_read_b64_tr_b16 v[184:185], v6 offset:61440
    v_mfma_f32_16x16x32_bf16 v[28:31], v[144:147], v[124:127], v[28:31]
    ds_read_b64_tr_b16 v[186:187], v6 offset:61952
    v_mfma_f32_16x16x32_bf16 v[24:27], v[140:143], v[124:127], v[24:27]
    ds_read_b64_tr_b16 v[188:189], v7 offset:61440
    v_mfma_f32_16x16x32_bf16 v[32:35], v[140:143], v[128:131], v[32:35]
    ds_read_b64_tr_b16 v[190:191], v7 offset:61952
    v_mfma_f32_16x16x32_bf16 v[36:39], v[144:147], v[128:131], v[36:39]
    ds_read_b64_tr_b16 v[192:193], v6 offset:62464
    v_mfma_f32_16x16x32_bf16 v[68:71], v[152:155], v[128:131], v[68:71]
    ds_read_b64_tr_b16 v[194:195], v6 offset:62976
    v_mfma_f32_16x16x32_bf16 v[64:67], v[148:151], v[128:131], v[64:67]
    ds_read_b64_tr_b16 v[196:197], v7 offset:62464
    v_mfma_f32_16x16x32_bf16 v[112:115], v[148:151], v[136:139], v[112:115]
    ds_read_b64_tr_b16 v[198:199], v7 offset:62976
    v_mfma_f32_16x16x32_bf16 v[72:75], v[148:151], v[132:135], v[72:75]
    ds_read_b64_tr_b16 v[200:201], v6 offset:63488
    v_mfma_f32_16x16x32_bf16 v[76:79], v[152:155], v[132:135], v[76:79]
    ds_read_b64_tr_b16 v[202:203], v6 offset:64000
    v_mfma_f32_16x16x32_bf16 v[44:47], v[144:147], v[132:135], v[44:47]
    ds_read_b64_tr_b16 v[204:205], v7 offset:63488
    v_mfma_f32_16x16x32_bf16 v[40:43], v[140:143], v[132:135], v[40:43]
    ds_read_b64_tr_b16 v[206:207], v7 offset:64000
    v_mfma_f32_16x16x32_bf16 v[104:107], v[132:135], v[156:159], v[104:107]
    v_mfma_f32_16x16x32_bf16 v[108:111], v[132:135], v[160:163], v[108:111]
    v_mfma_f32_16x16x32_bf16 v[100:103], v[128:131], v[160:163], v[100:103]
    v_mfma_f32_16x16x32_bf16 v[96:99], v[128:131], v[156:159], v[96:99]
    v_mfma_f32_16x16x32_bf16 v[88:91], v[124:127], v[156:159], v[88:91]
    v_mfma_f32_16x16x32_bf16 v[92:95], v[124:127], v[160:163], v[92:95]
    v_mfma_f32_16x16x32_bf16 v[84:87], v[120:123], v[160:163], v[84:87]
    v_mfma_f32_16x16x32_bf16 v[80:83], v[120:123], v[156:159], v[80:83]
    v_mfma_f32_16x16x32_bf16 v[116:119], v[136:139], v[156:159], v[116:119]
    s_waitcnt lgkmcnt(0)
    s_barrier
    v_mfma_f32_16x16x32_bf16 v[16:19], v[184:187], v[164:167], v[16:19]
    ds_read_b128 v[120:123], v4 offset:0
    v_mfma_f32_16x16x32_bf16 v[20:23], v[188:191], v[164:167], v[20:23]
    ds_read_b128 v[124:127], v4 offset:2048
    v_mfma_f32_16x16x32_bf16 v[52:55], v[196:199], v[164:167], v[52:55]
    ds_read_b128 v[128:131], v4 offset:4096
    v_mfma_f32_16x16x32_bf16 v[48:51], v[192:195], v[164:167], v[48:51]
    ds_read_b128 v[132:135], v4 offset:6144
    v_mfma_f32_16x16x32_bf16 v[56:59], v[192:195], v[168:171], v[56:59]
    ds_read_b128 v[136:139], v2 offset:0
    v_mfma_f32_16x16x32_bf16 v[60:63], v[196:199], v[168:171], v[60:63]
    ds_read_b64_tr_b16 v[140:141], v6 offset:0
    v_mfma_f32_16x16x32_bf16 v[28:31], v[188:191], v[168:171], v[28:31]
    ds_read_b64_tr_b16 v[142:143], v6 offset:512
    v_mfma_f32_16x16x32_bf16 v[24:27], v[184:187], v[168:171], v[24:27]
    ds_read_b64_tr_b16 v[144:145], v7 offset:0
    v_mfma_f32_16x16x32_bf16 v[32:35], v[184:187], v[172:175], v[32:35]
    ds_read_b64_tr_b16 v[146:147], v7 offset:512
    v_mfma_f32_16x16x32_bf16 v[36:39], v[188:191], v[172:175], v[36:39]
    ds_read_b64_tr_b16 v[148:149], v6 offset:1024
    v_mfma_f32_16x16x32_bf16 v[68:71], v[196:199], v[172:175], v[68:71]
    ds_read_b64_tr_b16 v[150:151], v6 offset:1536
    v_mfma_f32_16x16x32_bf16 v[64:67], v[192:195], v[172:175], v[64:67]
    ds_read_b64_tr_b16 v[152:153], v7 offset:1024
    v_mfma_f32_16x16x32_bf16 v[112:115], v[192:195], v[180:183], v[112:115]
    ds_read_b64_tr_b16 v[154:155], v7 offset:1536
    v_mfma_f32_16x16x32_bf16 v[72:75], v[192:195], v[176:179], v[72:75]
    ds_read_b64_tr_b16 v[156:157], v6 offset:2048
    v_mfma_f32_16x16x32_bf16 v[76:79], v[196:199], v[176:179], v[76:79]
    ds_read_b64_tr_b16 v[158:159], v6 offset:2560
    v_mfma_f32_16x16x32_bf16 v[44:47], v[188:191], v[176:179], v[44:47]
    ds_read_b64_tr_b16 v[160:161], v7 offset:2048
    v_mfma_f32_16x16x32_bf16 v[40:43], v[184:187], v[176:179], v[40:43]
    ds_read_b64_tr_b16 v[162:163], v7 offset:2560
    v_mfma_f32_16x16x32_bf16 v[104:107], v[176:179], v[200:203], v[104:107]
    v_mfma_f32_16x16x32_bf16 v[108:111], v[176:179], v[204:207], v[108:111]
    v_mfma_f32_16x16x32_bf16 v[100:103], v[172:175], v[204:207], v[100:103]
    v_mfma_f32_16x16x32_bf16 v[96:99], v[172:175], v[200:203], v[96:99]
    v_mfma_f32_16x16x32_bf16 v[88:91], v[168:171], v[200:203], v[88:91]
    v_mfma_f32_16x16x32_bf16 v[92:95], v[168:171], v[204:207], v[92:95]
    v_mfma_f32_16x16x32_bf16 v[84:87], v[164:167], v[204:207], v[84:87]
    v_mfma_f32_16x16x32_bf16 v[80:83], v[164:167], v[200:203], v[80:83]
    v_mfma_f32_16x16x32_bf16 v[116:119], v[180:183], v[200:203], v[116:119]
    s_waitcnt lgkmcnt(0)
    v_mfma_f32_16x16x32_bf16 v[16:19], v[140:143], v[120:123], v[16:19]
    ds_read_b128 v[164:167], v5 offset:0
    v_mfma_f32_16x16x32_bf16 v[20:23], v[144:147], v[120:123], v[20:23]
    ds_read_b128 v[168:171], v5 offset:2048
    v_mfma_f32_16x16x32_bf16 v[52:55], v[152:155], v[120:123], v[52:55]
    ds_read_b128 v[172:175], v5 offset:4096
    v_mfma_f32_16x16x32_bf16 v[48:51], v[148:151], v[120:123], v[48:51]
    ds_read_b128 v[176:179], v5 offset:6144
    v_mfma_f32_16x16x32_bf16 v[56:59], v[148:151], v[124:127], v[56:59]
    ds_read_b128 v[180:183], v3 offset:0
    v_mfma_f32_16x16x32_bf16 v[60:63], v[152:155], v[124:127], v[60:63]
    ds_read_b64_tr_b16 v[184:185], v6 offset:12288
    v_mfma_f32_16x16x32_bf16 v[28:31], v[144:147], v[124:127], v[28:31]
    ds_read_b64_tr_b16 v[186:187], v6 offset:12800
    v_mfma_f32_16x16x32_bf16 v[24:27], v[140:143], v[124:127], v[24:27]
    ds_read_b64_tr_b16 v[188:189], v7 offset:12288
    v_mfma_f32_16x16x32_bf16 v[32:35], v[140:143], v[128:131], v[32:35]
    ds_read_b64_tr_b16 v[190:191], v7 offset:12800
    v_mfma_f32_16x16x32_bf16 v[36:39], v[144:147], v[128:131], v[36:39]
    ds_read_b64_tr_b16 v[192:193], v6 offset:13312
    v_mfma_f32_16x16x32_bf16 v[68:71], v[152:155], v[128:131], v[68:71]
    ds_read_b64_tr_b16 v[194:195], v6 offset:13824
    v_mfma_f32_16x16x32_bf16 v[64:67], v[148:151], v[128:131], v[64:67]
    ds_read_b64_tr_b16 v[196:197], v7 offset:13312
    v_mfma_f32_16x16x32_bf16 v[112:115], v[148:151], v[136:139], v[112:115]
    ds_read_b64_tr_b16 v[198:199], v7 offset:13824
    v_mfma_f32_16x16x32_bf16 v[72:75], v[148:151], v[132:135], v[72:75]
    ds_read_b64_tr_b16 v[200:201], v6 offset:14336
    v_mfma_f32_16x16x32_bf16 v[76:79], v[152:155], v[132:135], v[76:79]
    ds_read_b64_tr_b16 v[202:203], v6 offset:14848
    v_mfma_f32_16x16x32_bf16 v[44:47], v[144:147], v[132:135], v[44:47]
    ds_read_b64_tr_b16 v[204:205], v7 offset:14336
    v_mfma_f32_16x16x32_bf16 v[40:43], v[140:143], v[132:135], v[40:43]
    ds_read_b64_tr_b16 v[206:207], v7 offset:14848
    v_mfma_f32_16x16x32_bf16 v[104:107], v[132:135], v[156:159], v[104:107]
    v_mfma_f32_16x16x32_bf16 v[108:111], v[132:135], v[160:163], v[108:111]
    v_mfma_f32_16x16x32_bf16 v[100:103], v[128:131], v[160:163], v[100:103]
    v_mfma_f32_16x16x32_bf16 v[96:99], v[128:131], v[156:159], v[96:99]
    v_mfma_f32_16x16x32_bf16 v[88:91], v[124:127], v[156:159], v[88:91]
    v_mfma_f32_16x16x32_bf16 v[92:95], v[124:127], v[160:163], v[92:95]
    v_mfma_f32_16x16x32_bf16 v[84:87], v[120:123], v[160:163], v[84:87]
    v_mfma_f32_16x16x32_bf16 v[80:83], v[120:123], v[156:159], v[80:83]
    v_mfma_f32_16x16x32_bf16 v[116:119], v[136:139], v[156:159], v[116:119]
    s_waitcnt lgkmcnt(0)
    s_barrier
    v_mfma_f32_16x16x32_bf16 v[16:19], v[184:187], v[164:167], v[16:19]
    ds_read_b128 v[120:123], v4 offset:18432
    v_mfma_f32_16x16x32_bf16 v[20:23], v[188:191], v[164:167], v[20:23]
    ds_read_b128 v[124:127], v4 offset:20480
    v_mfma_f32_16x16x32_bf16 v[52:55], v[196:199], v[164:167], v[52:55]
    ds_read_b128 v[128:131], v4 offset:22528
    v_mfma_f32_16x16x32_bf16 v[48:51], v[192:195], v[164:167], v[48:51]
    ds_read_b128 v[132:135], v4 offset:24576
    v_mfma_f32_16x16x32_bf16 v[56:59], v[192:195], v[168:171], v[56:59]
    ds_read_b128 v[136:139], v2 offset:18432
    v_mfma_f32_16x16x32_bf16 v[60:63], v[196:199], v[168:171], v[60:63]
    ds_read_b64_tr_b16 v[140:141], v6 offset:24576
    v_mfma_f32_16x16x32_bf16 v[28:31], v[188:191], v[168:171], v[28:31]
    ds_read_b64_tr_b16 v[142:143], v6 offset:25088
    v_mfma_f32_16x16x32_bf16 v[24:27], v[184:187], v[168:171], v[24:27]
    ds_read_b64_tr_b16 v[144:145], v7 offset:24576
    v_mfma_f32_16x16x32_bf16 v[32:35], v[184:187], v[172:175], v[32:35]
    ds_read_b64_tr_b16 v[146:147], v7 offset:25088
    v_mfma_f32_16x16x32_bf16 v[36:39], v[188:191], v[172:175], v[36:39]
    ds_read_b64_tr_b16 v[148:149], v6 offset:25600
    v_mfma_f32_16x16x32_bf16 v[68:71], v[196:199], v[172:175], v[68:71]
    ds_read_b64_tr_b16 v[150:151], v6 offset:26112
    v_mfma_f32_16x16x32_bf16 v[64:67], v[192:195], v[172:175], v[64:67]
    ds_read_b64_tr_b16 v[152:153], v7 offset:25600
    v_mfma_f32_16x16x32_bf16 v[112:115], v[192:195], v[180:183], v[112:115]
    ds_read_b64_tr_b16 v[154:155], v7 offset:26112
    v_mfma_f32_16x16x32_bf16 v[72:75], v[192:195], v[176:179], v[72:75]
    ds_read_b64_tr_b16 v[156:157], v6 offset:26624
    v_mfma_f32_16x16x32_bf16 v[76:79], v[196:199], v[176:179], v[76:79]
    ds_read_b64_tr_b16 v[158:159], v6 offset:27136
    v_mfma_f32_16x16x32_bf16 v[44:47], v[188:191], v[176:179], v[44:47]
    ds_read_b64_tr_b16 v[160:161], v7 offset:26624
    v_mfma_f32_16x16x32_bf16 v[40:43], v[184:187], v[176:179], v[40:43]
    ds_read_b64_tr_b16 v[162:163], v7 offset:27136
    v_mfma_f32_16x16x32_bf16 v[104:107], v[176:179], v[200:203], v[104:107]
    v_mfma_f32_16x16x32_bf16 v[108:111], v[176:179], v[204:207], v[108:111]
    v_mfma_f32_16x16x32_bf16 v[100:103], v[172:175], v[204:207], v[100:103]
    v_mfma_f32_16x16x32_bf16 v[96:99], v[172:175], v[200:203], v[96:99]
    v_mfma_f32_16x16x32_bf16 v[88:91], v[168:171], v[200:203], v[88:91]
    v_mfma_f32_16x16x32_bf16 v[92:95], v[168:171], v[204:207], v[92:95]
    v_mfma_f32_16x16x32_bf16 v[84:87], v[164:167], v[204:207], v[84:87]
    v_mfma_f32_16x16x32_bf16 v[80:83], v[164:167], v[200:203], v[80:83]
    v_mfma_f32_16x16x32_bf16 v[116:119], v[180:183], v[200:203], v[116:119]
    s_waitcnt lgkmcnt(0)
    v_mfma_f32_16x16x32_bf16 v[16:19], v[140:143], v[120:123], v[16:19]
    ds_read_b128 v[164:167], v5 offset:18432
    v_mfma_f32_16x16x32_bf16 v[20:23], v[144:147], v[120:123], v[20:23]
    ds_read_b128 v[168:171], v5 offset:20480
    v_mfma_f32_16x16x32_bf16 v[52:55], v[152:155], v[120:123], v[52:55]
    ds_read_b128 v[172:175], v5 offset:22528
    v_mfma_f32_16x16x32_bf16 v[48:51], v[148:151], v[120:123], v[48:51]
    ds_read_b128 v[176:179], v5 offset:24576
    v_mfma_f32_16x16x32_bf16 v[56:59], v[148:151], v[124:127], v[56:59]
    ds_read_b128 v[180:183], v3 offset:18432
    v_mfma_f32_16x16x32_bf16 v[60:63], v[152:155], v[124:127], v[60:63]
    ds_read_b64_tr_b16 v[184:185], v6 offset:36864
    v_mfma_f32_16x16x32_bf16 v[28:31], v[144:147], v[124:127], v[28:31]
    ds_read_b64_tr_b16 v[186:187], v6 offset:37376
    v_mfma_f32_16x16x32_bf16 v[24:27], v[140:143], v[124:127], v[24:27]
    ds_read_b64_tr_b16 v[188:189], v7 offset:36864
    v_mfma_f32_16x16x32_bf16 v[32:35], v[140:143], v[128:131], v[32:35]
    ds_read_b64_tr_b16 v[190:191], v7 offset:37376
    v_mfma_f32_16x16x32_bf16 v[36:39], v[144:147], v[128:131], v[36:39]
    ds_read_b64_tr_b16 v[192:193], v6 offset:37888
    v_mfma_f32_16x16x32_bf16 v[68:71], v[152:155], v[128:131], v[68:71]
    ds_read_b64_tr_b16 v[194:195], v6 offset:38400
    v_mfma_f32_16x16x32_bf16 v[64:67], v[148:151], v[128:131], v[64:67]
    ds_read_b64_tr_b16 v[196:197], v7 offset:37888
    v_mfma_f32_16x16x32_bf16 v[112:115], v[148:151], v[136:139], v[112:115]
    ds_read_b64_tr_b16 v[198:199], v7 offset:38400
    v_mfma_f32_16x16x32_bf16 v[72:75], v[148:151], v[132:135], v[72:75]
    ds_read_b64_tr_b16 v[200:201], v6 offset:38912
    v_mfma_f32_16x16x32_bf16 v[76:79], v[152:155], v[132:135], v[76:79]
    ds_read_b64_tr_b16 v[202:203], v6 offset:39424
    v_mfma_f32_16x16x32_bf16 v[44:47], v[144:147], v[132:135], v[44:47]
    ds_read_b64_tr_b16 v[204:205], v7 offset:38912
    v_mfma_f32_16x16x32_bf16 v[40:43], v[140:143], v[132:135], v[40:43]
    ds_read_b64_tr_b16 v[206:207], v7 offset:39424
    v_mfma_f32_16x16x32_bf16 v[104:107], v[132:135], v[156:159], v[104:107]
    v_mfma_f32_16x16x32_bf16 v[108:111], v[132:135], v[160:163], v[108:111]
    v_mfma_f32_16x16x32_bf16 v[100:103], v[128:131], v[160:163], v[100:103]
    v_mfma_f32_16x16x32_bf16 v[96:99], v[128:131], v[156:159], v[96:99]
    v_mfma_f32_16x16x32_bf16 v[88:91], v[124:127], v[156:159], v[88:91]
    v_mfma_f32_16x16x32_bf16 v[92:95], v[124:127], v[160:163], v[92:95]
    v_mfma_f32_16x16x32_bf16 v[84:87], v[120:123], v[160:163], v[84:87]
    v_mfma_f32_16x16x32_bf16 v[80:83], v[120:123], v[156:159], v[80:83]
    v_mfma_f32_16x16x32_bf16 v[116:119], v[136:139], v[156:159], v[116:119]
    s_waitcnt lgkmcnt(0)
    s_barrier
    v_mfma_f32_16x16x32_bf16 v[16:19], v[184:187], v[164:167], v[16:19]
    ds_read_b128 v[120:123], v4 offset:36864
    v_mfma_f32_16x16x32_bf16 v[20:23], v[188:191], v[164:167], v[20:23]
    ds_read_b128 v[124:127], v4 offset:38912
    v_mfma_f32_16x16x32_bf16 v[52:55], v[196:199], v[164:167], v[52:55]
    ds_read_b128 v[128:131], v4 offset:40960
    v_mfma_f32_16x16x32_bf16 v[48:51], v[192:195], v[164:167], v[48:51]
    ds_read_b128 v[132:135], v4 offset:43008
    v_mfma_f32_16x16x32_bf16 v[56:59], v[192:195], v[168:171], v[56:59]
    ds_read_b128 v[136:139], v2 offset:36864
    v_mfma_f32_16x16x32_bf16 v[60:63], v[196:199], v[168:171], v[60:63]
    ds_read_b64_tr_b16 v[140:141], v6 offset:49152
    v_mfma_f32_16x16x32_bf16 v[28:31], v[188:191], v[168:171], v[28:31]
    ds_read_b64_tr_b16 v[142:143], v6 offset:49664
    v_mfma_f32_16x16x32_bf16 v[24:27], v[184:187], v[168:171], v[24:27]
    ds_read_b64_tr_b16 v[144:145], v7 offset:49152
    v_mfma_f32_16x16x32_bf16 v[32:35], v[184:187], v[172:175], v[32:35]
    ds_read_b64_tr_b16 v[146:147], v7 offset:49664
    v_mfma_f32_16x16x32_bf16 v[36:39], v[188:191], v[172:175], v[36:39]
    ds_read_b64_tr_b16 v[148:149], v6 offset:50176
    v_mfma_f32_16x16x32_bf16 v[68:71], v[196:199], v[172:175], v[68:71]
    ds_read_b64_tr_b16 v[150:151], v6 offset:50688
    v_mfma_f32_16x16x32_bf16 v[64:67], v[192:195], v[172:175], v[64:67]
    ds_read_b64_tr_b16 v[152:153], v7 offset:50176
    v_mfma_f32_16x16x32_bf16 v[112:115], v[192:195], v[180:183], v[112:115]
    ds_read_b64_tr_b16 v[154:155], v7 offset:50688
    v_mfma_f32_16x16x32_bf16 v[72:75], v[192:195], v[176:179], v[72:75]
    ds_read_b64_tr_b16 v[156:157], v6 offset:51200
    v_mfma_f32_16x16x32_bf16 v[76:79], v[196:199], v[176:179], v[76:79]
    ds_read_b64_tr_b16 v[158:159], v6 offset:51712
    v_mfma_f32_16x16x32_bf16 v[44:47], v[188:191], v[176:179], v[44:47]
    ds_read_b64_tr_b16 v[160:161], v7 offset:51200
    v_mfma_f32_16x16x32_bf16 v[40:43], v[184:187], v[176:179], v[40:43]
    ds_read_b64_tr_b16 v[162:163], v7 offset:51712
    v_mfma_f32_16x16x32_bf16 v[104:107], v[176:179], v[200:203], v[104:107]
    v_mfma_f32_16x16x32_bf16 v[108:111], v[176:179], v[204:207], v[108:111]
    v_mfma_f32_16x16x32_bf16 v[100:103], v[172:175], v[204:207], v[100:103]
    v_mfma_f32_16x16x32_bf16 v[96:99], v[172:175], v[200:203], v[96:99]
    v_mfma_f32_16x16x32_bf16 v[88:91], v[168:171], v[200:203], v[88:91]
    v_mfma_f32_16x16x32_bf16 v[92:95], v[168:171], v[204:207], v[92:95]
    v_mfma_f32_16x16x32_bf16 v[84:87], v[164:167], v[204:207], v[84:87]
    v_mfma_f32_16x16x32_bf16 v[80:83], v[164:167], v[200:203], v[80:83]
    v_mfma_f32_16x16x32_bf16 v[116:119], v[180:183], v[200:203], v[116:119]
    s_waitcnt lgkmcnt(0)
    v_mfma_f32_16x16x32_bf16 v[16:19], v[140:143], v[120:123], v[16:19]
    ds_read_b128 v[164:167], v5 offset:36864
    v_mfma_f32_16x16x32_bf16 v[20:23], v[144:147], v[120:123], v[20:23]
    ds_read_b128 v[168:171], v5 offset:38912
    v_mfma_f32_16x16x32_bf16 v[52:55], v[152:155], v[120:123], v[52:55]
    ds_read_b128 v[172:175], v5 offset:40960
    v_mfma_f32_16x16x32_bf16 v[48:51], v[148:151], v[120:123], v[48:51]
    ds_read_b128 v[176:179], v5 offset:43008
    v_mfma_f32_16x16x32_bf16 v[56:59], v[148:151], v[124:127], v[56:59]
    ds_read_b128 v[180:183], v3 offset:36864
    v_mfma_f32_16x16x32_bf16 v[60:63], v[152:155], v[124:127], v[60:63]
    ds_read_b64_tr_b16 v[184:185], v6 offset:61440
    v_mfma_f32_16x16x32_bf16 v[28:31], v[144:147], v[124:127], v[28:31]
    ds_read_b64_tr_b16 v[186:187], v6 offset:61952
    v_mfma_f32_16x16x32_bf16 v[24:27], v[140:143], v[124:127], v[24:27]
    ds_read_b64_tr_b16 v[188:189], v7 offset:61440
    v_mfma_f32_16x16x32_bf16 v[32:35], v[140:143], v[128:131], v[32:35]
    ds_read_b64_tr_b16 v[190:191], v7 offset:61952
    v_mfma_f32_16x16x32_bf16 v[36:39], v[144:147], v[128:131], v[36:39]
    ds_read_b64_tr_b16 v[192:193], v6 offset:62464
    v_mfma_f32_16x16x32_bf16 v[68:71], v[152:155], v[128:131], v[68:71]
    ds_read_b64_tr_b16 v[194:195], v6 offset:62976
    v_mfma_f32_16x16x32_bf16 v[64:67], v[148:151], v[128:131], v[64:67]
    ds_read_b64_tr_b16 v[196:197], v7 offset:62464
    v_mfma_f32_16x16x32_bf16 v[112:115], v[148:151], v[136:139], v[112:115]
    ds_read_b64_tr_b16 v[198:199], v7 offset:62976
    v_mfma_f32_16x16x32_bf16 v[72:75], v[148:151], v[132:135], v[72:75]
    ds_read_b64_tr_b16 v[200:201], v6 offset:63488
    v_mfma_f32_16x16x32_bf16 v[76:79], v[152:155], v[132:135], v[76:79]
    ds_read_b64_tr_b16 v[202:203], v6 offset:64000
    v_mfma_f32_16x16x32_bf16 v[44:47], v[144:147], v[132:135], v[44:47]
    ds_read_b64_tr_b16 v[204:205], v7 offset:63488
    v_mfma_f32_16x16x32_bf16 v[40:43], v[140:143], v[132:135], v[40:43]
    ds_read_b64_tr_b16 v[206:207], v7 offset:64000
    v_mfma_f32_16x16x32_bf16 v[104:107], v[132:135], v[156:159], v[104:107]
    s_nop 0
    v_mfma_f32_16x16x32_bf16 v[108:111], v[132:135], v[160:163], v[108:111]
    s_nop 0
    v_mfma_f32_16x16x32_bf16 v[100:103], v[128:131], v[160:163], v[100:103]
    s_nop 0
    v_mfma_f32_16x16x32_bf16 v[96:99], v[128:131], v[156:159], v[96:99]
    s_nop 0
    v_mfma_f32_16x16x32_bf16 v[88:91], v[124:127], v[156:159], v[88:91]
    ds_read_b32 v223, v10 offset:24
    v_mfma_f32_16x16x32_bf16 v[92:95], v[124:127], v[160:163], v[92:95]
    v_mfma_f32_16x16x32_bf16 v[84:87], v[120:123], v[160:163], v[84:87]
    v_mfma_f32_16x16x32_bf16 v[80:83], v[120:123], v[156:159], v[80:83]
    v_mfma_f32_16x16x32_bf16 v[116:119], v[136:139], v[156:159], v[116:119]
    s_waitcnt lgkmcnt(0)
    v_cmp_gt_u32 vcc, 4, v223
    s_cbranch_vccnz LB_w15
LB_g15:
    v_mfma_f32_16x16x32_bf16 v[16:19], v[184:187], v[164:167], v[16:19]
    ds_read_b128 v[120:123], v4 offset:0
    v_mfma_f32_16x16x32_bf16 v[20:23], v[188:191], v[164:167], v[20:23]
    ds_read_b128 v[124:127], v4 offset:2048
    v_mfma_f32_16x16x32_bf16 v[52:55], v[196:199], v[164:167], v[52:55]
    ds_read_b128 v[128:131], v4 offset:4096
    v_mfma_f32_16x16x32_bf16 v[48:51], v[192:195], v[164:167], v[48:51]
    ds_read_b128 v[132:135], v4 offset:6144
    v_mfma_f32_16x16x32_bf16 v[56:59], v[192:195], v[168:171], v[56:59]
    ds_read_b128 v[136:139], v2 offset:0
    v_mfma_f32_16x16x32_bf16 v[60:63], v[196:199], v[168:171], v[60:63]
    ds_read_b64_tr_b16 v[140:141], v6 offset:0
    v_mfma_f32_16x16x32_bf16 v[28:31], v[188:191], v[168:171], v[28:31]
    ds_read_b64_tr_b16 v[142:143], v6 offset:512
    v_mfma_f32_16x16x32_bf16 v[24:27], v[184:187], v[168:171], v[24:27]
    ds_read_b64_tr_b16 v[144:145], v7 offset:0
    v_mfma_f32_16x16x32_bf16 v[32:35], v[184:187], v[172:175], v[32:35]
    ds_read_b64_tr_b16 v[146:147], v7 offset:512
    v_mfma_f32_16x16x32_bf16 v[36:39], v[188:191], v[172:175], v[36:39]
    ds_read_b64_tr_b16 v[148:149], v6 offset:1024
    v_mfma_f32_16x16x32_bf16 v[68:71], v[196:199], v[172:175], v[68:71]
    ds_read_b64_tr_b16 v[150:151], v6 offset:1536
    v_mfma_f32_16x16x32_bf16 v[64:67], v[192:195], v[172:175], v[64:67]
    ds_read_b64_tr_b16 v[152:153], v7 offset:1024
    v_mfma_f32_16x16x32_bf16 v[112:115], v[192:195], v[180:183], v[112:115]
    ds_read_b64_tr_b16 v[154:155], v7 offset:1536
    v_mfma_f32_16x16x32_bf16 v[72:75], v[192:195], v[176:179], v[72:75]
    ds_read_b64_tr_b16 v[156:157], v6 offset:2048
    v_mfma_f32_16x16x32_bf16 v[76:79], v[196:199], v[176:179], v[76:79]
    ds_read_b64_tr_b16 v[158:159], v6 offset:2560
    v_mfma_f32_16x16x32_bf16 v[44:47], v[188:191], v[176:179], v[44:47]
    ds_read_b64_tr_b16 v[160:161], v7 offset:2048
    v_mfma_f32_16x16x32_bf16 v[40:43], v[184:187], v[176:179], v[40:43]
    ds_read_b64_tr_b16 v[162:163], v7 offset:2560
    v_mfma_f32_16x16x32_bf16 v[104:107], v[176:179], v[200:203], v[104:107]
    v_mfma_f32_16x16x32_bf16 v[108:111], v[176:179], v[204:207], v[108:111]
    v_mfma_f32_16x16x32_bf16 v[100:103], v[172:175], v[204:207], v[100:103]
    v_mfma_f32_16x16x32_bf16 v[96:99], v[172:175], v[200:203], v[96:99]
    v_mfma_f32_16x16x32_bf16 v[88:91], v[168:171], v[200:203], v[88:91]
    v_mfma_f32_16x16x32_bf16 v[92:95], v[168:171], v[204:207], v[92:95]
    v_mfma_f32_16x16x32_bf16 v[84:87], v[164:167], v[204:207], v[84:87]
    v_mfma_f32_16x16x32_bf16 v[80:83], v[164:167], v[200:203], v[80:83]
    v_mfma_f32_16x16x32_bf16 v[116:119], v[180:183], v[200:203], v[116:119]
    s_waitcnt lgkmcnt(0)
    v_mfma_f32_16x16x32_bf16 v[16:19], v[140:143], v[120:123], v[16:19]
    ds_read_b128 v[164:167], v5 offset:0
    v_mfma_f32_16x16x32_bf16 v[20:23], v[144:147], v[120:123], v[20:23]
    ds_read_b128 v[168:171], v5 offset:2048
    v_mfma_f32_16x16x32_bf16 v[52:55], v[152:155], v[120:123], v[52:55]
    ds_read_b128 v[172:175], v5 offset:4096
    v_mfma_f32_16x16x32_bf16 v[48:51], v[148:151], v[120:123], v[48:51]
    ds_read_b128 v[176:179], v5 offset:6144
    v_mfma_f32_16x16x32_bf16 v[56:59], v[148:151], v[124:127], v[56:59]
    ds_read_b128 v[180:183], v3 offset:0
    v_mfma_f32_16x16x32_bf16 v[60:63], v[152:155], v[124:127], v[60:63]
    ds_read_b64_tr_b16 v[184:185], v6 offset:12288
    v_mfma_f32_16x16x32_bf16 v[28:31], v[144:147], v[124:127], v[28:31]
    ds_read_b64_tr_b16 v[186:187], v6 offset:12800
    v_mfma_f32_16x16x32_bf16 v[24:27], v[140:143], v[124:127], v[24:27]
    ds_read_b64_tr_b16 v[188:189], v7 offset:12288
    v_mfma_f32_16x16x32_bf16 v[32:35], v[140:143], v[128:131], v[32:35]
    ds_read_b64_tr_b16 v[190:191], v7 offset:12800
    v_mfma_f32_16x16x32_bf16 v[36:39], v[144:147], v[128:131], v[36:39]
    ds_read_b64_tr_b16 v[192:193], v6 offset:13312
    v_mfma_f32_16x16x32_bf16 v[68:71], v[152:155], v[128:131], v[68:71]
    ds_read_b64_tr_b16 v[194:195], v6 offset:13824
    v_mfma_f32_16x16x32_bf16 v[64:67], v[148:151], v[128:131], v[64:67]
    ds_read_b64_tr_b16 v[196:197], v7 offset:13312
    v_mfma_f32_16x16x32_bf16 v[112:115], v[148:151], v[136:139], v[112:115]
    ds_read_b64_tr_b16 v[198:199], v7 offset:13824
    v_mfma_f32_16x16x32_bf16 v[72:75], v[148:151], v[132:135], v[72:75]
    ds_read_b64_tr_b16 v[200:201], v6 offset:14336
    v_mfma_f32_16x16x32_bf16 v[76:79], v[152:155], v[132:135], v[76:79]
    ds_read_b64_tr_b16 v[202:203], v6 offset:14848
    v_mfma_f32_16x16x32_bf16 v[44:47], v[144:147], v[132:135], v[44:47]
    ds_read_b64_tr_b16 v[204:205], v7 offset:14336
    v_mfma_f32_16x16x32_bf16 v[40:43], v[140:143], v[132:135], v[40:43]
    ds_read_b64_tr_b16 v[206:207], v7 offset:14848
    v_mfma_f32_16x16x32_bf16 v[104:107], v[132:135], v[156:159], v[104:107]
    v_mfma_f32_16x16x32_bf16 v[108:111], v[132:135], v[160:163], v[108:111]
    v_mfma_f32_16x16x32_bf16 v[100:103], v[128:131], v[160:163], v[100:103]
    v_mfma_f32_16x16x32_bf16 v[96:99], v[128:131], v[156:159], v[96:99]
    v_mfma_f32_16x16x32_bf16 v[88:91], v[124:127], v[156:159], v[88:91]
    v_mfma_f32_16x16x32_bf16 v[92:95], v[124:127], v[160:163], v[92:95]
    v_mfma_f32_16x16x32_bf16 v[84:87], v[120:123], v[160:163], v[84:87]
    v_mfma_f32_16x16x32_bf16 v[80:83], v[120:123], v[156:159], v[80:83]
    v_mfma_f32_16x16x32_bf16 v[116:119], v[136:139], v[156:159], v[116:119]
    s_waitcnt lgkmcnt(0)
    v_mfma_f32_16x16x32_bf16 v[112:115], v[192:195], v[180:183], v[112:115]
    v_mfma_f32_16x16x32_bf16 v[116:119], v[180:183], v[200:203], v[116:119]
    v_mfma_f32_16x16x32_bf16 v[72:75], v[192:195], v[176:179], v[72:75]
    v_mfma_f32_16x16x32_bf16 v[76:79], v[196:199], v[176:179], v[76:79]
    v_mfma_f32_16x16x32_bf16 v[104:107], v[176:179], v[200:203], v[104:107]
    v_mfma_f32_16x16x32_bf16 v[108:111], v[176:179], v[204:207], v[108:111]
    v_mfma_f32_16x16x32_bf16 v[40:43], v[184:187], v[176:179], v[40:43]
    v_mfma_f32_16x16x32_bf16 v[44:47], v[188:191], v[176:179], v[44:47]
    v_mfma_f32_16x16x32_bf16 v[64:67], v[192:195], v[172:175], v[64:67]
    v_mfma_f32_16x16x32_bf16 v[68:71], v[196:199], v[172:175], v[68:71]
    v_cvt_pk_bf16_f32 v156, v112, v113
    v_cvt_pk_bf16_f32 v157, v114, v115
    v_mfma_f32_16x16x32_bf16 v[32:35], v[184:187], v[172:175], v[32:35]
    v_cvt_pk_bf16_f32 v158, v116, v117
    v_cvt_pk_bf16_f32 v159, v118, v119
    v_mfma_f32_16x16x32_bf16 v[36:39], v[188:191], v[172:175], v[36:39]
    v_cvt_pk_bf16_f32 v152, v72, v73
    v_cvt_pk_bf16_f32 v153, v74, v75
    v_mfma_f32_16x16x32_bf16 v[56:59], v[192:195], v[168:171], v[56:59]
    v_cvt_pk_bf16_f32 v154, v76, v77
    v_cvt_pk_bf16_f32 v155, v78, v79
    v_mfma_f32_16x16x32_bf16 v[60:63], v[196:199], v[168:171], v[60:63]
    v_cvt_pk_bf16_f32 v232, v104, v105
    v_cvt_pk_bf16_f32 v233, v106, v107
    v_mfma_f32_16x16x32_bf16 v[24:27], v[184:187], v[168:171], v[24:27]
    v_cvt_pk_bf16_f32 v242, v108, v109
    v_cvt_pk_bf16_f32 v243, v110, v111
    v_mfma_f32_16x16x32_bf16 v[28:31], v[188:191], v[168:171], v[28:31]
    ds_write_b64 v216, v[156:157]
    ds_write_b64 v216, v[158:159] offset:1024
    v_mfma_f32_16x16x32_bf16 v[48:51], v[192:195], v[164:167], v[48:51]
    ds_write_b64 v217, v[152:153] offset:0
    ds_write_b64 v217, v[232:233] offset:1024
    v_mfma_f32_16x16x32_bf16 v[52:55], v[196:199], v[164:167], v[52:55]
    ds_write_b64 v217, v[154:155] offset:512
    ds_write_b64 v217, v[242:243] offset:1536
    v_mfma_f32_16x16x32_bf16 v[16:19], v[184:187], v[164:167], v[16:19]
    v_cvt_pk_bf16_f32 v132, v40, v41
    v_cvt_pk_bf16_f32 v133, v42, v43
    v_mfma_f32_16x16x32_bf16 v[20:23], v[188:191], v[164:167], v[20:23]
    v_cvt_pk_bf16_f32 v134, v44, v45
    v_cvt_pk_bf16_f32 v135, v46, v47
    v_mfma_f32_16x16x32_bf16 v[96:99], v[172:175], v[200:203], v[96:99]
    v_cvt_pk_bf16_f32 v148, v64, v65
    v_cvt_pk_bf16_f32 v149, v66, v67
    v_mfma_f32_16x16x32_bf16 v[100:103], v[172:175], v[204:207], v[100:103]
    v_cvt_pk_bf16_f32 v150, v68, v69
    v_cvt_pk_bf16_f32 v151, v70, v71
    v_mfma_f32_16x16x32_bf16 v[88:91], v[168:171], v[200:203], v[88:91]
    v_cvt_pk_bf16_f32 v128, v32, v33
    v_cvt_pk_bf16_f32 v129, v34, v35
    v_mfma_f32_16x16x32_bf16 v[92:95], v[168:171], v[204:207], v[92:95]
    v_cvt_pk_bf16_f32 v130, v36, v37
    v_cvt_pk_bf16_f32 v131, v38, v39
    v_mfma_f32_16x16x32_bf16 v[80:83], v[164:167], v[200:203], v[80:83]
    v_cvt_pk_bf16_f32 v144, v56, v57
    v_cvt_pk_bf16_f32 v145, v58, v59
    v_mfma_f32_16x16x32_bf16 v[84:87], v[164:167], v[204:207], v[84:87]
    v_cvt_pk_bf16_f32 v146, v60, v61
    v_cvt_pk_bf16_f32 v147, v62, v63
    v_cvt_pk_bf16_f32 v124, v24, v25
    v_cvt_pk_bf16_f32 v125, v26, v27
    v_cvt_pk_bf16_f32 v126, v28, v29
    v_cvt_pk_bf16_f32 v127, v30, v31
    s_mov_b64 exec, 1
    ds_add_u32 v10, v11 offset:0
    s_mov_b64 exec, -1
    v_cvt_pk_bf16_f32 v140, v48, v49
    v_cvt_pk_bf16_f32 v141, v50, v51
    v_cvt_pk_bf16_f32 v142, v52, v53
    v_cvt_pk_bf16_f32 v143, v54, v55
    v_cvt_pk_bf16_f32 v120, v16, v17
    v_cvt_pk_bf16_f32 v121, v18, v19
    v_cvt_pk_bf16_f32 v122, v20, v21
    v_cvt_pk_bf16_f32 v123, v22, v23
    v_mfma_f32_16x16x32_bf16 v[44:47], v[152:155], v[132:135], 0
    v_cvt_pk_bf16_f32 v230, v96, v97
    v_cvt_pk_bf16_f32 v231, v98, v99
    v_mfma_f32_16x16x32_bf16 v[40:43], v[148:151], v[132:135], 0
    v_cvt_pk_bf16_f32 v240, v100, v101
    v_cvt_pk_bf16_f32 v241, v102, v103
    v_mfma_f32_16x16x32_bf16 v[36:39], v[148:151], v[128:131], 0
    v_cvt_pk_bf16_f32 v228, v88, v89
    v_cvt_pk_bf16_f32 v229, v90, v91
    v_mfma_f32_16x16x32_bf16 v[32:35], v[144:147], v[128:131], 0
    v_cvt_pk_bf16_f32 v238, v92, v93
    v_cvt_pk_bf16_f32 v239, v94, v95
    v_mfma_f32_16x16x32_bf16 v[28:31], v[144:147], v[124:127], 0
    v_cvt_pk_bf16_f32 v226, v80, v81
    v_cvt_pk_bf16_f32 v227, v82, v83
    v_mfma_f32_16x16x32_bf16 v[24:27], v[140:143], v[124:127], 0
    v_cvt_pk_bf16_f32 v236, v84, v85
    v_cvt_pk_bf16_f32 v237, v86, v87
    v_mfma_f32_16x16x32_bf16 v[20:23], v[140:143], v[120:123], 0
    s_branch LB_s1_in
LB_s1:
    s_sleep 1
LB_s1_in:
    ds_read_b32 v14, v10 offset:0
    ds_read_b64 v[136:137], v218
    ds_read_b64 v[138:139], v219
    ds_read_b64 v[224:225], v218 offset:1024
    ds_read_b64 v[234:235], v219 offset:1024
    s_waitcnt lgkmcnt(0)
    v_readfirstlane_b32 s78, v14
    s_nop 0
    s_cmp_ge_u32 s78, 4
    s_cbranch_scc0 LB_s1
    v_mfma_f32_16x16x32_bf16 v[16:19], v[136:139], v[120:123], v[212:215]
    v_cndmask_b32 v60, v44, v45, s[88:89]
    s_add_u32 m0, s34, 36864
    s_add_u32 s35, s44, 0
    buffer_load_dwordx4 v245, s[64:67], s35 offen  lds
    v_cndmask_b32 v61, v40, v41, s[88:89]
    v_cndmask_b32 v54, v61, v60, s[90:91]
    v_cndmask_b32 v60, v46, v47, s[88:89]
    v_cndmask_b32 v61, v42, v43, s[88:89]
    v_cndmask_b32 v55, v61, v60, s[92:93]
    v_max_f32 v59, v54, v55
    v_cndmask_b32 v60, v36, v37, s[88:89]
    v_cndmask_b32 v61, v32, v33, s[88:89]
    v_cndmask_b32 v52, v61, v60, s[90:91]
    v_cndmask_b32 v60, v38, v39, s[88:89]
    v_cndmask_b32 v61, v34, v35, s[88:89]
    v_cndmask_b32 v53, v61, v60, s[92:93]
    v_max_f32 v58, v52, v53
    v_cndmask_b32 v60, v28, v29, s[88:89]
    v_cndmask_b32 v61, v24, v25, s[88:89]
    v_cndmask_b32 v50, v61, v60, s[90:91]
    v_cndmask_b32 v60, v30, v31, s[88:89]
    v_cndmask_b32 v61, v26, v27, s[88:89]
    s_add_u32 m0, s34, 40960
    s_add_u32 s35, s44, 65536
    buffer_load_dwordx4 v245, s[64:67], s35 offen  lds
    v_cndmask_b32 v51, v61, v60, s[92:93]
    v_max_f32 v57, v50, v51
    v_cndmask_b32 v60, v20, v21, s[88:89]
    v_cndmask_b32 v61, v16, v17, s[88:89]
    v_cndmask_b32 v48, v61, v60, s[90:91]
    v_cndmask_b32 v60, v22, v23, s[88:89]
    v_cndmask_b32 v61, v18, v19, s[88:89]
    v_cndmask_b32 v49, v61, v60, s[92:93]
    v_max_f32 v56, v48, v49
    s_mov_b32 s80, 0x3e8293ee
    v_permlane32_swap_b32 v58, v59
    v_permlane32_swap_b32 v56, v57
    v_max_f32 v58, v58, v59
    v_max_f32 v56, v56, v57
    s_nop 1
    v_permlane16_swap_b32 v56, v58
    v_max_f32 v56, v56, v58
    v_mul_f32 v56, s80, v56
    v_mov_b32 v58, v56
    s_nop 1
    v_permlane16_swap_b32 v56, v58
    s_add_u32 m0, s34, 45056
    s_add_u32 s35, s44, 131072
    buffer_load_dwordx4 v245, s[64:67], s35 offen  lds
    v_mov_b32 v57, v56
    v_mov_b32 v59, v58
    s_nop 0
    v_permlane32_swap_b32 v56, v57
    v_permlane32_swap_b32 v58, v59
    v_fma_f32 v48, v48, s80, -v56
    v_fma_f32 v49, v49, s80, -v56
    v_fma_f32 v50, v50, s80, -v57
    v_fma_f32 v51, v51, s80, -v57
    v_fma_f32 v52, v52, s80, -v58
    v_fma_f32 v53, v53, s80, -v58
    v_fma_f32 v54, v54, s80, -v59
    v_fma_f32 v55, v55, s80, -v59
    v_exp_f32 v48, v48
    v_exp_f32 v49, v49
    v_exp_f32 v50, v50
    v_exp_f32 v51, v51
    v_exp_f32 v52, v52
    v_exp_f32 v53, v53
    s_add_u32 m0, s34, 49152
    s_add_u32 s35, s44, 196608
    buffer_load_dwordx4 v245, s[64:67], s35 offen  lds
    v_exp_f32 v54, v54
    v_exp_f32 v55, v55
    v_add_f32 v56, v48, v49
    v_add_f32 v57, v50, v51
    v_add_f32 v58, v52, v53
    v_add_f32 v59, v54, v55
    s_nop 1
    v_permlane32_swap_b32 v58, v59
    v_permlane32_swap_b32 v56, v57
    v_add_f32 v58, v58, v59
    v_add_f32 v56, v56, v57
    s_nop 1
    v_permlane16_swap_b32 v56, v58
    v_add_f32 v56, v56, v58
    v_rcp_f32 v56, v56
    s_nop 0
    v_mov_b32 v58, v56
    s_nop 1
    v_permlane16_swap_b32 v56, v58
    v_mov_b32 v57, v56
    v_mov_b32 v59, v58
    s_nop 0
    v_permlane32_swap_b32 v56, v57
    v_permlane32_swap_b32 v58, v59
    s_add_u32 m0, s34, 53248
    s_add_u32 s35, s45, 0
    buffer_load_dwordx4 v245, s[64:67], s35 offen  lds
    v_mul_f32 v48, v48, v56
    v_mul_f32 v49, v49, v56
    v_cvt_pk_bf16_f32 v48, v48, v49
    v_perm_b32 v64, v48, v48, v208
    v_perm_b32 v65, v48, v48, v209
    v_perm_b32 v66, v48, v48, v210
    v_perm_b32 v67, v48, v48, v211
    v_mul_f32 v50, v50, v57
    v_mul_f32 v51, v51, v57
    v_cvt_pk_bf16_f32 v50, v50, v51
    v_perm_b32 v68, v50, v50, v208
    v_perm_b32 v69, v50, v50, v209
    v_perm_b32 v70, v50, v50, v210
    v_perm_b32 v71, v50, v50, v211
    v_mfma_f32_16x16x32_bf16 v[16:19], v[224:227], v[64:67], 0
    v_mfma_f32_16x16x32_bf16 v[20:23], v[234:237], v[64:67], 0
    v_mul_f32 v52, v52, v58
    v_mul_f32 v53, v53, v58
    s_add_u32 m0, s34, 57344
    s_add_u32 s35, s45, 65536
    buffer_load_dwordx4 v245, s[64:67], s35 offen  lds
    v_cvt_pk_bf16_f32 v52, v52, v53
    v_perm_b32 v72, v52, v52, v208
    v_perm_b32 v73, v52, v52, v209
    v_perm_b32 v74, v52, v52, v210
    v_perm_b32 v75, v52, v52, v211
    v_mfma_f32_16x16x32_bf16 v[24:27], v[226:229], v[68:71], 0
    v_mfma_f32_16x16x32_bf16 v[28:31], v[236:239], v[68:71], 0
    v_mul_f32 v54, v54, v59
    v_mul_f32 v55, v55, v59
    v_cvt_pk_bf16_f32 v54, v54, v55
    v_perm_b32 v76, v54, v54, v208
    v_perm_b32 v77, v54, v54, v209
    v_perm_b32 v78, v54, v54, v210
    v_perm_b32 v79, v54, v54, v211
    v_mfma_f32_16x16x32_bf16 v[32:35], v[228:231], v[72:75], 0
    v_mfma_f32_16x16x32_bf16 v[36:39], v[238:241], v[72:75], 0
    v_mfma_f32_16x16x32_bf16 v[40:43], v[230:233], v[76:79], 0
    v_mfma_f32_16x16x32_bf16 v[44:47], v[240:243], v[76:79], 0
    v_cvt_pk_bf16_f32 v80, v16, v17
    v_cvt_pk_bf16_f32 v81, v18, v19
    v_cvt_pk_bf16_f32 v82, v20, v21
    v_cvt_pk_bf16_f32 v83, v22, v23
    s_add_u32 s95, s94, 0
    buffer_store_dwordx4 v[80:83], v12, s[52:55], s95 offen sc1
    v_cvt_pk_bf16_f32 v84, v24, v25
    v_cvt_pk_bf16_f32 v85, v26, v27
    v_cvt_pk_bf16_f32 v86, v28, v29
    v_cvt_pk_bf16_f32 v87, v30, v31
    s_add_u32 s95, s94, 32768
    buffer_store_dwordx4 v[84:87], v12, s[52:55], s95 offen sc1
    v_cvt_pk_bf16_f32 v88, v32, v33
    v_cvt_pk_bf16_f32 v89, v34, v35
    v_cvt_pk_bf16_f32 v90, v36, v37
    v_cvt_pk_bf16_f32 v91, v38, v39
    s_add_u32 s95, s94, 65536
    buffer_store_dwordx4 v[88:91], v12, s[52:55], s95 offen sc1
    v_cvt_pk_bf16_f32 v92, v40, v41
    v_cvt_pk_bf16_f32 v93, v42, v43
    v_cvt_pk_bf16_f32 v94, v44, v45
    v_cvt_pk_bf16_f32 v95, v46, v47
    s_add_u32 s95, s94, 98304
    buffer_store_dwordx4 v[92:95], v12, s[52:55], s95 offen sc1
    s_add_u32 m0, s34, 61440
    s_add_u32 s35, s45, 131072
    buffer_load_dwordx4 v245, s[64:67], s35 offen  lds
    v_xor_b32 v2, 0, v244
    v_xor_b32 v3, 32, v244
    v_xor_b32 v4, 64, v244
    v_xor_b32 v5, 96, v244
    s_add_u32 m0, s34, 65536
    s_add_u32 s35, s45, 196608
    buffer_load_dwordx4 v245, s[64:67], s35 offen  lds
    v_xor_b32 v6, 2048, v244
    v_xor_b32 v7, 2080, v244
    v_xor_b32 v8, 2112, v244
    v_xor_b32 v9, 2144, v244
    s_waitcnt vmcnt(6)
    s_mov_b64 exec, 1
    ds_add_u32 v10, v11 offset:8
    s_mov_b64 exec, -1
    s_add_u32 m0, s34, 69632
    s_add_u32 s35, s46, 0
    buffer_load_dwordx4 v245, s[64:67], s35 offen  lds
    v_add_u32 v224, 65536, v2
    v_add_u32 v225, 65536, v3
    s_add_u32 m0, s34, 73728
    s_add_u32 s35, s46, 65536
    buffer_load_dwordx4 v245, s[64:67], s35 offen  lds
    v_add_u32 v226, 65536, v4
    s_add_u32 m0, s34, 77824
    s_add_u32 s35, s46, 131072
    buffer_load_dwordx4 v245, s[64:67], s35 offen  lds
    v_add_u32 v227, 65536, v5
    v_add_u32 v228, 65536, v6
    s_add_u32 m0, s34, 81920
    s_add_u32 s35, s46, 196608
    buffer_load_dwordx4 v245, s[64:67], s35 offen  lds
    v_add_u32 v229, 65536, v7
    s_add_u32 m0, s34, 86016
    s_add_u32 s35, s47, 0
    buffer_load_dwordx4 v245, s[64:67], s35 offen  lds
    v_add_u32 v230, 65536, v8
    v_add_u32 v231, 65536, v9
    s_add_u32 m0, s34, 0
    s_add_u32 s35, s47, 65536
    buffer_load_dwordx4 v245, s[64:67], s35 offen  lds
    v_add_u32 v15, 32768, v12
    s_waitcnt vmcnt(8)
    s_mov_b64 exec, 1
    buffer_store_dword v11, v220, s[52:55], s97 offen sc1
    s_mov_b64 exec, -1
    s_branch LB_s2_in
LB_s2:
    s_sleep 1
LB_s2_in:
    ds_read_b32 v14, v10 offset:8
    s_waitcnt lgkmcnt(0)
    v_readfirstlane_b32 s78, v14
    s_nop 0
    s_cmp_ge_u32 s78, 8
    s_cbranch_scc0 LB_s2
    s_add_u32 m0, s34, 4096
    s_add_u32 s35, s47, 131072
    buffer_load_dwordx4 v245, s[64:67], s35 offen  lds
    ds_read_b64_tr_b16 v[48:49], v2 offset:36864
    ds_read_b64_tr_b16 v[50:51], v6 offset:36864
    s_add_u32 m0, s34, 8192
    s_add_u32 s35, s47, 196608
    buffer_load_dwordx4 v245, s[64:67], s35 offen  lds
    ds_read_b64_tr_b16 v[52:53], v3 offset:36864
    s_add_u32 m0, s34, 12288
    s_add_u32 s35, s48, 0
    buffer_load_dwordx4 v245, s[64:67], s35 offen  lds
    ds_read_b64_tr_b16 v[54:55], v7 offset:36864
    s_add_u32 m0, s34, 16384
    s_add_u32 s35, s48, 65536
    buffer_load_dwordx4 v245, s[64:67], s35 offen  lds
    ds_read_b64_tr_b16 v[56:57], v4 offset:36864
    ds_read_b64_tr_b16 v[58:59], v8 offset:36864
    s_add_u32 m0, s34, 20480
    s_add_u32 s35, s48, 131072
    buffer_load_dwordx4 v245, s[64:67], s35 offen  lds
    ds_read_b64_tr_b16 v[60:61], v5 offset:36864
    s_add_u32 m0, s34, 110592
    s_add_u32 s35, s48, 196608
    buffer_load_dwordx4 v245, s[64:67], s35 offen  lds
    ds_read_b64_tr_b16 v[62:63], v9 offset:36864
    s_add_u32 m0, s34, 114688
    s_add_u32 s35, s49, 0
    buffer_load_dwordx4 v245, s[64:67], s35 offen  lds
    ds_read_b64_tr_b16 v[64:65], v2 offset:40960
    ds_read_b64_tr_b16 v[66:67], v6 offset:40960
    s_add_u32 m0, s34, 118784
    s_add_u32 s35, s49, 65536
    buffer_load_dwordx4 v245, s[64:67], s35 offen  lds
    ds_read_b64_tr_b16 v[68:69], v3 offset:40960
    s_add_u32 m0, s34, 122880
    s_add_u32 s35, s49, 131072
    buffer_load_dwordx4 v245, s[64:67], s35 offen  lds
    ds_read_b64_tr_b16 v[70:71], v7 offset:40960
    s_add_u32 m0, s34, 24576
    s_add_u32 s35, s49, 196608
    buffer_load_dwordx4 v245, s[64:67], s35 offen  lds
    ds_read_b64_tr_b16 v[72:73], v4 offset:40960
    ds_read_b64_tr_b16 v[74:75], v8 offset:40960
    s_add_u32 m0, s34, 28672
    s_add_u32 s35, s50, 0
    buffer_load_dwordx4 v245, s[64:67], s35 offen  lds
    ds_read_b64_tr_b16 v[76:77], v5 offset:40960
    s_add_u32 m0, s34, 32768
    s_add_u32 s35, s50, 65536
    buffer_load_dwordx4 v245, s[64:67], s35 offen  lds
    ds_read_b64_tr_b16 v[78:79], v9 offset:40960
    s_waitcnt vmcnt(0)
    s_mov_b64 exec, 1
    ds_add_u32 v10, v11 offset:16
    s_mov_b64 exec, -1
    s_mov_b64 exec, 0xffffffff
    s_mov_b32 s79, 0
LB_po:
    buffer_load_dword v14, v247, s[52:55], s30 offen sc1
    s_add_u32 s79, s79, 1
    s_cmp_gt_u32 s79, 200000
    s_cbranch_scc1 LB_po_x
    s_waitcnt vmcnt(0)
    v_cmp_ne_u32 vcc, 1, v14
    s_cbranch_vccz LB_po_x
    s_mov_b64 exec, vcc
    s_sleep 4
    s_branch LB_po
LB_po_x:
    s_waitcnt vmcnt(0)
    s_mov_b64 exec, -1
    ds_read_b32 v222, v10 offset:16
    buffer_load_dwordx4 v[96:99], v12, s[52:55], s36 offen offset:0 sc1
    buffer_load_dwordx4 v[100:103], v15, s[52:55], s36 offen offset:0 sc1
    buffer_load_dwordx4 v[104:107], v12, s[52:55], s36 offen offset:1024 sc1
    buffer_load_dwordx4 v[108:111], v15, s[52:55], s36 offen offset:1024 sc1
    buffer_load_dwordx4 v[112:115], v12, s[52:55], s36 offen offset:2048 sc1
    buffer_load_dwordx4 v[116:119], v15, s[52:55], s36 offen offset:2048 sc1
    buffer_load_dwordx4 v[120:123], v12, s[52:55], s36 offen offset:3072 sc1
    buffer_load_dwordx4 v[124:127], v15, s[52:55], s36 offen offset:3072 sc1
    buffer_load_dwordx4 v[128:131], v12, s[52:55], s37 offen offset:0 sc1
    buffer_load_dwordx4 v[132:135], v15, s[52:55], s37 offen offset:0 sc1
    s_setprio 1
    s_waitcnt lgkmcnt(0)
    v_cmp_gt_u32 vcc, 4, v222
    s_cbranch_vccnz LB_w4
LB_g4:
    s_waitcnt vmcnt(8)
    v_mfma_f32_16x16x32_bf16 v[16:19], v[48:51], v[96:99], 0
    buffer_load_dwordx4 v[136:139], v12, s[52:55], s37 offen offset:1024 sc1
    buffer_load_dwordx4 v[140:143], v15, s[52:55], s37 offen offset:1024 sc1
    v_mfma_f32_16x16x32_bf16 v[20:23], v[52:55], v[96:99], 0
    ds_read_b64_tr_b16 v[80:81], v2 offset:45056
    v_mfma_f32_16x16x32_bf16 v[24:27], v[56:59], v[96:99], 0
    ds_read_b64_tr_b16 v[82:83], v6 offset:45056
    v_mfma_f32_16x16x32_bf16 v[28:31], v[60:63], v[96:99], 0
    ds_read_b64_tr_b16 v[84:85], v3 offset:45056
    v_mfma_f32_16x16x32_bf16 v[32:35], v[48:51], v[100:103], 0
    ds_read_b64_tr_b16 v[86:87], v7 offset:45056
    ds_read_b64_tr_b16 v[88:89], v4 offset:45056
    v_mfma_f32_16x16x32_bf16 v[36:39], v[52:55], v[100:103], 0
    ds_read_b64_tr_b16 v[90:91], v8 offset:45056
    v_mfma_f32_16x16x32_bf16 v[40:43], v[56:59], v[100:103], 0
    ds_read_b64_tr_b16 v[92:93], v5 offset:45056
    v_mfma_f32_16x16x32_bf16 v[44:47], v[60:63], v[100:103], 0
    ds_read_b64_tr_b16 v[94:95], v9 offset:45056
    s_waitcnt vmcnt(8)
    v_mfma_f32_16x16x32_bf16 v[16:19], v[64:67], v[104:107], v[16:19]
    buffer_load_dwordx4 v[96:99], v12, s[52:55], s37 offen offset:2048 sc1
    buffer_load_dwordx4 v[100:103], v15, s[52:55], s37 offen offset:2048 sc1
    v_mfma_f32_16x16x32_bf16 v[20:23], v[68:71], v[104:107], v[20:23]
    ds_read_b64_tr_b16 v[48:49], v2 offset:49152
    v_mfma_f32_16x16x32_bf16 v[24:27], v[72:75], v[104:107], v[24:27]
    ds_read_b64_tr_b16 v[50:51], v6 offset:49152
    v_mfma_f32_16x16x32_bf16 v[28:31], v[76:79], v[104:107], v[28:31]
    ds_read_b64_tr_b16 v[52:53], v3 offset:49152
    v_mfma_f32_16x16x32_bf16 v[32:35], v[64:67], v[108:111], v[32:35]
    ds_read_b64_tr_b16 v[54:55], v7 offset:49152
    ds_read_b64_tr_b16 v[56:57], v4 offset:49152
    v_mfma_f32_16x16x32_bf16 v[36:39], v[68:71], v[108:111], v[36:39]
    ds_read_b64_tr_b16 v[58:59], v8 offset:49152
    v_mfma_f32_16x16x32_bf16 v[40:43], v[72:75], v[108:111], v[40:43]
    ds_read_b64_tr_b16 v[60:61], v5 offset:49152
    v_mfma_f32_16x16x32_bf16 v[44:47], v[76:79], v[108:111], v[44:47]
    ds_read_b64_tr_b16 v[62:63], v9 offset:49152
    s_waitcnt vmcnt(8) lgkmcnt(8)
    v_mfma_f32_16x16x32_bf16 v[16:19], v[80:83], v[112:115], v[16:19]
    buffer_load_dwordx4 v[104:107], v12, s[52:55], s37 offen offset:3072 sc1
    buffer_load_dwordx4 v[108:111], v15, s[52:55], s37 offen offset:3072 sc1
    v_mfma_f32_16x16x32_bf16 v[20:23], v[84:87], v[112:115], v[20:23]
    ds_read_b64_tr_b16 v[64:65], v2 offset:53248
    v_mfma_f32_16x16x32_bf16 v[24:27], v[88:91], v[112:115], v[24:27]
    ds_read_b64_tr_b16 v[66:67], v6 offset:53248
    v_mfma_f32_16x16x32_bf16 v[28:31], v[92:95], v[112:115], v[28:31]
    ds_read_b64_tr_b16 v[68:69], v3 offset:53248
    v_mfma_f32_16x16x32_bf16 v[32:35], v[80:83], v[116:119], v[32:35]
    ds_read_b64_tr_b16 v[70:71], v7 offset:53248
    ds_read_b64_tr_b16 v[72:73], v4 offset:53248
    v_mfma_f32_16x16x32_bf16 v[36:39], v[84:87], v[116:119], v[36:39]
    ds_read_b64_tr_b16 v[74:75], v8 offset:53248
    v_mfma_f32_16x16x32_bf16 v[40:43], v[88:91], v[116:119], v[40:43]
    ds_read_b64_tr_b16 v[76:77], v5 offset:53248
    v_mfma_f32_16x16x32_bf16 v[44:47], v[92:95], v[116:119], v[44:47]
    ds_read_b64_tr_b16 v[78:79], v9 offset:53248
    s_waitcnt vmcnt(8) lgkmcnt(8)
    v_mfma_f32_16x16x32_bf16 v[16:19], v[48:51], v[120:123], v[16:19]
    buffer_load_dwordx4 v[112:115], v12, s[52:55], s38 offen offset:0 sc1
    buffer_load_dwordx4 v[116:119], v15, s[52:55], s38 offen offset:0 sc1
    v_mfma_f32_16x16x32_bf16 v[20:23], v[52:55], v[120:123], v[20:23]
    ds_read_b64_tr_b16 v[80:81], v2 offset:57344
    v_mfma_f32_16x16x32_bf16 v[24:27], v[56:59], v[120:123], v[24:27]
    ds_read_b64_tr_b16 v[82:83], v6 offset:57344
    v_mfma_f32_16x16x32_bf16 v[28:31], v[60:63], v[120:123], v[28:31]
    ds_read_b64_tr_b16 v[84:85], v3 offset:57344
    v_mfma_f32_16x16x32_bf16 v[32:35], v[48:51], v[124:127], v[32:35]
    ds_read_b64_tr_b16 v[86:87], v7 offset:57344
    ds_read_b64_tr_b16 v[88:89], v4 offset:57344
    v_mfma_f32_16x16x32_bf16 v[36:39], v[52:55], v[124:127], v[36:39]
    ds_read_b64_tr_b16 v[90:91], v8 offset:57344
    v_mfma_f32_16x16x32_bf16 v[40:43], v[56:59], v[124:127], v[40:43]
    ds_read_b64_tr_b16 v[92:93], v5 offset:57344
    v_mfma_f32_16x16x32_bf16 v[44:47], v[60:63], v[124:127], v[44:47]
    ds_read_b64_tr_b16 v[94:95], v9 offset:57344
    s_waitcnt vmcnt(8) lgkmcnt(8)
    v_mfma_f32_16x16x32_bf16 v[16:19], v[64:67], v[128:131], v[16:19]
    buffer_load_dwordx4 v[120:123], v12, s[52:55], s38 offen offset:1024 sc1
    buffer_load_dwordx4 v[124:127], v15, s[52:55], s38 offen offset:1024 sc1
    v_mfma_f32_16x16x32_bf16 v[20:23], v[68:71], v[128:131], v[20:23]
    ds_read_b64_tr_b16 v[48:49], v2 offset:61440
    v_mfma_f32_16x16x32_bf16 v[24:27], v[72:75], v[128:131], v[24:27]
    ds_read_b64_tr_b16 v[50:51], v6 offset:61440
    v_mfma_f32_16x16x32_bf16 v[28:31], v[76:79], v[128:131], v[28:31]
    ds_read_b64_tr_b16 v[52:53], v3 offset:61440
    v_mfma_f32_16x16x32_bf16 v[32:35], v[64:67], v[132:135], v[32:35]
    ds_read_b64_tr_b16 v[54:55], v7 offset:61440
    ds_read_b64_tr_b16 v[56:57], v4 offset:61440
    v_mfma_f32_16x16x32_bf16 v[36:39], v[68:71], v[132:135], v[36:39]
    ds_read_b64_tr_b16 v[58:59], v8 offset:61440
    v_mfma_f32_16x16x32_bf16 v[40:43], v[72:75], v[132:135], v[40:43]
    ds_read_b64_tr_b16 v[60:61], v5 offset:61440
    v_mfma_f32_16x16x32_bf16 v[44:47], v[76:79], v[132:135], v[44:47]
    ds_read_b64_tr_b16 v[62:63], v9 offset:61440
    s_waitcnt vmcnt(8) lgkmcnt(8)
    v_mfma_f32_16x16x32_bf16 v[16:19], v[80:83], v[136:139], v[16:19]
    buffer_load_dwordx4 v[128:131], v12, s[52:55], s38 offen offset:2048 sc1
    buffer_load_dwordx4 v[132:135], v15, s[52:55], s38 offen offset:2048 sc1
    v_mfma_f32_16x16x32_bf16 v[20:23], v[84:87], v[136:139], v[20:23]
    ds_read_b64_tr_b16 v[64:65], v224 offset:0
    v_mfma_f32_16x16x32_bf16 v[24:27], v[88:91], v[136:139], v[24:27]
    ds_read_b64_tr_b16 v[66:67], v228 offset:0
    v_mfma_f32_16x16x32_bf16 v[28:31], v[92:95], v[136:139], v[28:31]
    ds_read_b64_tr_b16 v[68:69], v225 offset:0
    v_mfma_f32_16x16x32_bf16 v[32:35], v[80:83], v[140:143], v[32:35]
    ds_read_b64_tr_b16 v[70:71], v229 offset:0
    ds_read_b64_tr_b16 v[72:73], v226 offset:0
    v_mfma_f32_16x16x32_bf16 v[36:39], v[84:87], v[140:143], v[36:39]
    ds_read_b64_tr_b16 v[74:75], v230 offset:0
    v_mfma_f32_16x16x32_bf16 v[40:43], v[88:91], v[140:143], v[40:43]
    ds_read_b64_tr_b16 v[76:77], v227 offset:0
    v_mfma_f32_16x16x32_bf16 v[44:47], v[92:95], v[140:143], v[44:47]
    ds_read_b64_tr_b16 v[78:79], v231 offset:0
    s_waitcnt vmcnt(8) lgkmcnt(8)
    v_mfma_f32_16x16x32_bf16 v[16:19], v[48:51], v[96:99], v[16:19]
    buffer_load_dwordx4 v[136:139], v12, s[52:55], s38 offen offset:3072 sc1
    buffer_load_dwordx4 v[140:143], v15, s[52:55], s38 offen offset:3072 sc1
    v_mfma_f32_16x16x32_bf16 v[20:23], v[52:55], v[96:99], v[20:23]
    ds_read_b64_tr_b16 v[80:81], v224 offset:4096
    v_mfma_f32_16x16x32_bf16 v[24:27], v[56:59], v[96:99], v[24:27]
    ds_read_b64_tr_b16 v[82:83], v228 offset:4096
    v_mfma_f32_16x16x32_bf16 v[28:31], v[60:63], v[96:99], v[28:31]
    ds_read_b64_tr_b16 v[84:85], v225 offset:4096
    v_mfma_f32_16x16x32_bf16 v[32:35], v[48:51], v[100:103], v[32:35]
    ds_read_b64_tr_b16 v[86:87], v229 offset:4096
    ds_read_b64_tr_b16 v[88:89], v226 offset:4096
    v_mfma_f32_16x16x32_bf16 v[36:39], v[52:55], v[100:103], v[36:39]
    ds_read_b64_tr_b16 v[90:91], v230 offset:4096
    v_mfma_f32_16x16x32_bf16 v[40:43], v[56:59], v[100:103], v[40:43]
    ds_read_b64_tr_b16 v[92:93], v227 offset:4096
    v_mfma_f32_16x16x32_bf16 v[44:47], v[60:63], v[100:103], v[44:47]
    ds_read_b64_tr_b16 v[94:95], v231 offset:4096
    s_waitcnt vmcnt(8) lgkmcnt(8)
    v_mfma_f32_16x16x32_bf16 v[16:19], v[64:67], v[104:107], v[16:19]
    buffer_load_dwordx4 v[96:99], v12, s[52:55], s39 offen offset:0 sc1
    buffer_load_dwordx4 v[100:103], v15, s[52:55], s39 offen offset:0 sc1
    v_mfma_f32_16x16x32_bf16 v[20:23], v[68:71], v[104:107], v[20:23]
    ds_read_b64_tr_b16 v[48:49], v224 offset:8192
    v_mfma_f32_16x16x32_bf16 v[24:27], v[72:75], v[104:107], v[24:27]
    ds_read_b64_tr_b16 v[50:51], v228 offset:8192
    v_mfma_f32_16x16x32_bf16 v[28:31], v[76:79], v[104:107], v[28:31]
    ds_read_b64_tr_b16 v[52:53], v225 offset:8192
    v_mfma_f32_16x16x32_bf16 v[32:35], v[64:67], v[108:111], v[32:35]
    ds_read_b64_tr_b16 v[54:55], v229 offset:8192
    ds_read_b64_tr_b16 v[56:57], v226 offset:8192
    v_mfma_f32_16x16x32_bf16 v[36:39], v[68:71], v[108:111], v[36:39]
    ds_read_b64_tr_b16 v[58:59], v230 offset:8192
    v_mfma_f32_16x16x32_bf16 v[40:43], v[72:75], v[108:111], v[40:43]
    ds_read_b64_tr_b16 v[60:61], v227 offset:8192
    v_mfma_f32_16x16x32_bf16 v[44:47], v[76:79], v[108:111], v[44:47]
    ds_read_b64_tr_b16 v[62:63], v231 offset:8192
    s_waitcnt vmcnt(8) lgkmcnt(8)
    v_mfma_f32_16x16x32_bf16 v[16:19], v[80:83], v[112:115], v[16:19]
    buffer_load_dwordx4 v[104:107], v12, s[52:55], s39 offen offset:1024 sc1
    buffer_load_dwordx4 v[108:111], v15, s[52:55], s39 offen offset:1024 sc1
    v_mfma_f32_16x16x32_bf16 v[20:23], v[84:87], v[112:115], v[20:23]
    ds_read_b64_tr_b16 v[64:65], v224 offset:12288
    v_mfma_f32_16x16x32_bf16 v[24:27], v[88:91], v[112:115], v[24:27]
    ds_read_b64_tr_b16 v[66:67], v228 offset:12288
    v_mfma_f32_16x16x32_bf16 v[28:31], v[92:95], v[112:115], v[28:31]
    ds_read_b64_tr_b16 v[68:69], v225 offset:12288
    v_mfma_f32_16x16x32_bf16 v[32:35], v[80:83], v[116:119], v[32:35]
    ds_read_b64_tr_b16 v[70:71], v229 offset:12288
    ds_read_b64_tr_b16 v[72:73], v226 offset:12288
    v_mfma_f32_16x16x32_bf16 v[36:39], v[84:87], v[116:119], v[36:39]
    ds_read_b64_tr_b16 v[74:75], v230 offset:12288
    v_mfma_f32_16x16x32_bf16 v[40:43], v[88:91], v[116:119], v[40:43]
    ds_read_b64_tr_b16 v[76:77], v227 offset:12288
    v_mfma_f32_16x16x32_bf16 v[44:47], v[92:95], v[116:119], v[44:47]
    ds_read_b64_tr_b16 v[78:79], v231 offset:12288
    s_waitcnt vmcnt(8) lgkmcnt(8)
    v_mfma_f32_16x16x32_bf16 v[16:19], v[48:51], v[120:123], v[16:19]
    buffer_load_dwordx4 v[112:115], v12, s[52:55], s39 offen offset:2048 sc1
    buffer_load_dwordx4 v[116:119], v15, s[52:55], s39 offen offset:2048 sc1
    v_mfma_f32_16x16x32_bf16 v[20:23], v[52:55], v[120:123], v[20:23]
    ds_read_b64_tr_b16 v[80:81], v224 offset:16384
    v_mfma_f32_16x16x32_bf16 v[24:27], v[56:59], v[120:123], v[24:27]
    ds_read_b64_tr_b16 v[82:83], v228 offset:16384
    v_mfma_f32_16x16x32_bf16 v[28:31], v[60:63], v[120:123], v[28:31]
    ds_read_b64_tr_b16 v[84:85], v225 offset:16384
    v_mfma_f32_16x16x32_bf16 v[32:35], v[48:51], v[124:127], v[32:35]
    ds_read_b64_tr_b16 v[86:87], v229 offset:16384
    ds_read_b64_tr_b16 v[88:89], v226 offset:16384
    v_mfma_f32_16x16x32_bf16 v[36:39], v[52:55], v[124:127], v[36:39]
    ds_read_b64_tr_b16 v[90:91], v230 offset:16384
    v_mfma_f32_16x16x32_bf16 v[40:43], v[56:59], v[124:127], v[40:43]
    ds_read_b64_tr_b16 v[92:93], v227 offset:16384
    v_mfma_f32_16x16x32_bf16 v[44:47], v[60:63], v[124:127], v[44:47]
    ds_read_b64_tr_b16 v[94:95], v231 offset:16384
    s_waitcnt vmcnt(8) lgkmcnt(8)
    v_mfma_f32_16x16x32_bf16 v[16:19], v[64:67], v[128:131], v[16:19]
    buffer_load_dwordx4 v[120:123], v12, s[52:55], s39 offen offset:3072 sc1
    buffer_load_dwordx4 v[124:127], v15, s[52:55], s39 offen offset:3072 sc1
    v_mfma_f32_16x16x32_bf16 v[20:23], v[68:71], v[128:131], v[20:23]
    ds_read_b64_tr_b16 v[48:49], v224 offset:20480
    v_mfma_f32_16x16x32_bf16 v[24:27], v[72:75], v[128:131], v[24:27]
    ds_read_b64_tr_b16 v[50:51], v228 offset:20480
    v_mfma_f32_16x16x32_bf16 v[28:31], v[76:79], v[128:131], v[28:31]
    ds_read_b64_tr_b16 v[52:53], v225 offset:20480
    v_mfma_f32_16x16x32_bf16 v[32:35], v[64:67], v[132:135], v[32:35]
    ds_read_b64_tr_b16 v[54:55], v229 offset:20480
    ds_read_b64_tr_b16 v[56:57], v226 offset:20480
    v_mfma_f32_16x16x32_bf16 v[36:39], v[68:71], v[132:135], v[36:39]
    ds_read_b64_tr_b16 v[58:59], v230 offset:20480
    v_mfma_f32_16x16x32_bf16 v[40:43], v[72:75], v[132:135], v[40:43]
    ds_read_b64_tr_b16 v[60:61], v227 offset:20480
    v_mfma_f32_16x16x32_bf16 v[44:47], v[76:79], v[132:135], v[44:47]
    ds_read_b64_tr_b16 v[62:63], v231 offset:20480
    s_waitcnt vmcnt(8) lgkmcnt(8)
    v_mfma_f32_16x16x32_bf16 v[16:19], v[80:83], v[136:139], v[16:19]
    buffer_load_dwordx4 v[128:131], v12, s[52:55], s40 offen offset:0 sc1
    buffer_load_dwordx4 v[132:135], v15, s[52:55], s40 offen offset:0 sc1
    v_mfma_f32_16x16x32_bf16 v[20:23], v[84:87], v[136:139], v[20:23]
    ds_read_b64_tr_b16 v[64:65], v2 offset:0
    v_mfma_f32_16x16x32_bf16 v[24:27], v[88:91], v[136:139], v[24:27]
    ds_read_b64_tr_b16 v[66:67], v6 offset:0
    v_mfma_f32_16x16x32_bf16 v[28:31], v[92:95], v[136:139], v[28:31]
    ds_read_b64_tr_b16 v[68:69], v3 offset:0
    v_mfma_f32_16x16x32_bf16 v[32:35], v[80:83], v[140:143], v[32:35]
    ds_read_b64_tr_b16 v[70:71], v7 offset:0
    ds_read_b64_tr_b16 v[72:73], v4 offset:0
    v_mfma_f32_16x16x32_bf16 v[36:39], v[84:87], v[140:143], v[36:39]
    ds_read_b64_tr_b16 v[74:75], v8 offset:0
    v_mfma_f32_16x16x32_bf16 v[40:43], v[88:91], v[140:143], v[40:43]
    ds_read_b64_tr_b16 v[76:77], v5 offset:0
    v_mfma_f32_16x16x32_bf16 v[44:47], v[92:95], v[140:143], v[44:47]
    ds_read_b64_tr_b16 v[78:79], v9 offset:0
    s_waitcnt vmcnt(8) lgkmcnt(8)
    v_mfma_f32_16x16x32_bf16 v[16:19], v[48:51], v[96:99], v[16:19]
    buffer_load_dwordx4 v[136:139], v12, s[52:55], s40 offen offset:1024 sc1
    buffer_load_dwordx4 v[140:143], v15, s[52:55], s40 offen offset:1024 sc1
    v_mfma_f32_16x16x32_bf16 v[20:23], v[52:55], v[96:99], v[20:23]
    ds_read_b64_tr_b16 v[80:81], v2 offset:4096
    v_mfma_f32_16x16x32_bf16 v[24:27], v[56:59], v[96:99], v[24:27]
    ds_read_b64_tr_b16 v[82:83], v6 offset:4096
    v_mfma_f32_16x16x32_bf16 v[28:31], v[60:63], v[96:99], v[28:31]
    ds_read_b64_tr_b16 v[84:85], v3 offset:4096
    v_mfma_f32_16x16x32_bf16 v[32:35], v[48:51], v[100:103], v[32:35]
    ds_read_b64_tr_b16 v[86:87], v7 offset:4096
    ds_read_b64_tr_b16 v[88:89], v4 offset:4096
    v_mfma_f32_16x16x32_bf16 v[36:39], v[52:55], v[100:103], v[36:39]
    ds_read_b64_tr_b16 v[90:91], v8 offset:4096
    v_mfma_f32_16x16x32_bf16 v[40:43], v[56:59], v[100:103], v[40:43]
    ds_read_b64_tr_b16 v[92:93], v5 offset:4096
    v_mfma_f32_16x16x32_bf16 v[44:47], v[60:63], v[100:103], v[44:47]
    ds_read_b64_tr_b16 v[94:95], v9 offset:4096
    s_waitcnt vmcnt(8) lgkmcnt(8)
    v_mfma_f32_16x16x32_bf16 v[16:19], v[64:67], v[104:107], v[16:19]
    buffer_load_dwordx4 v[96:99], v12, s[52:55], s40 offen offset:2048 sc1
    buffer_load_dwordx4 v[100:103], v15, s[52:55], s40 offen offset:2048 sc1
    v_mfma_f32_16x16x32_bf16 v[20:23], v[68:71], v[104:107], v[20:23]
    ds_read_b64_tr_b16 v[48:49], v2 offset:8192
    v_mfma_f32_16x16x32_bf16 v[24:27], v[72:75], v[104:107], v[24:27]
    ds_read_b64_tr_b16 v[50:51], v6 offset:8192
    v_mfma_f32_16x16x32_bf16 v[28:31], v[76:79], v[104:107], v[28:31]
    ds_read_b64_tr_b16 v[52:53], v3 offset:8192
    v_mfma_f32_16x16x32_bf16 v[32:35], v[64:67], v[108:111], v[32:35]
    ds_read_b64_tr_b16 v[54:55], v7 offset:8192
    ds_read_b64_tr_b16 v[56:57], v4 offset:8192
    v_mfma_f32_16x16x32_bf16 v[36:39], v[68:71], v[108:111], v[36:39]
    ds_read_b64_tr_b16 v[58:59], v8 offset:8192
    v_mfma_f32_16x16x32_bf16 v[40:43], v[72:75], v[108:111], v[40:43]
    ds_read_b64_tr_b16 v[60:61], v5 offset:8192
    v_mfma_f32_16x16x32_bf16 v[44:47], v[76:79], v[108:111], v[44:47]
    ds_read_b64_tr_b16 v[62:63], v9 offset:8192
    s_waitcnt vmcnt(8) lgkmcnt(8)
    v_mfma_f32_16x16x32_bf16 v[16:19], v[80:83], v[112:115], v[16:19]
    buffer_load_dwordx4 v[104:107], v12, s[52:55], s40 offen offset:3072 sc1
    buffer_load_dwordx4 v[108:111], v15, s[52:55], s40 offen offset:3072 sc1
    v_mfma_f32_16x16x32_bf16 v[20:23], v[84:87], v[112:115], v[20:23]
    ds_read_b64_tr_b16 v[64:65], v2 offset:12288
    v_mfma_f32_16x16x32_bf16 v[24:27], v[88:91], v[112:115], v[24:27]
    ds_read_b64_tr_b16 v[66:67], v6 offset:12288
    v_mfma_f32_16x16x32_bf16 v[28:31], v[92:95], v[112:115], v[28:31]
    ds_read_b64_tr_b16 v[68:69], v3 offset:12288
    v_mfma_f32_16x16x32_bf16 v[32:35], v[80:83], v[116:119], v[32:35]
    ds_read_b64_tr_b16 v[70:71], v7 offset:12288
    ds_read_b64_tr_b16 v[72:73], v4 offset:12288
    v_mfma_f32_16x16x32_bf16 v[36:39], v[84:87], v[116:119], v[36:39]
    ds_read_b64_tr_b16 v[74:75], v8 offset:12288
    v_mfma_f32_16x16x32_bf16 v[40:43], v[88:91], v[116:119], v[40:43]
    ds_read_b64_tr_b16 v[76:77], v5 offset:12288
    v_mfma_f32_16x16x32_bf16 v[44:47], v[92:95], v[116:119], v[44:47]
    ds_read_b64_tr_b16 v[78:79], v9 offset:12288
    s_waitcnt vmcnt(8) lgkmcnt(8)
    v_mfma_f32_16x16x32_bf16 v[16:19], v[48:51], v[120:123], v[16:19]
    buffer_load_dwordx4 v[112:115], v12, s[52:55], s41 offen offset:0 sc1
    buffer_load_dwordx4 v[116:119], v15, s[52:55], s41 offen offset:0 sc1
    v_mfma_f32_16x16x32_bf16 v[20:23], v[52:55], v[120:123], v[20:23]
    ds_read_b64_tr_b16 v[80:81], v2 offset:16384
    v_mfma_f32_16x16x32_bf16 v[24:27], v[56:59], v[120:123], v[24:27]
    ds_read_b64_tr_b16 v[82:83], v6 offset:16384
    v_mfma_f32_16x16x32_bf16 v[28:31], v[60:63], v[120:123], v[28:31]
    ds_read_b64_tr_b16 v[84:85], v3 offset:16384
    v_mfma_f32_16x16x32_bf16 v[32:35], v[48:51], v[124:127], v[32:35]
    ds_read_b64_tr_b16 v[86:87], v7 offset:16384
    ds_read_b64_tr_b16 v[88:89], v4 offset:16384
    v_mfma_f32_16x16x32_bf16 v[36:39], v[52:55], v[124:127], v[36:39]
    ds_read_b64_tr_b16 v[90:91], v8 offset:16384
    v_mfma_f32_16x16x32_bf16 v[40:43], v[56:59], v[124:127], v[40:43]
    ds_read_b64_tr_b16 v[92:93], v5 offset:16384
    v_mfma_f32_16x16x32_bf16 v[44:47], v[60:63], v[124:127], v[44:47]
    ds_read_b64_tr_b16 v[94:95], v9 offset:16384
    s_waitcnt vmcnt(8) lgkmcnt(8)
    v_mfma_f32_16x16x32_bf16 v[16:19], v[64:67], v[128:131], v[16:19]
    buffer_load_dwordx4 v[120:123], v12, s[52:55], s41 offen offset:1024 sc1
    buffer_load_dwordx4 v[124:127], v15, s[52:55], s41 offen offset:1024 sc1
    v_mfma_f32_16x16x32_bf16 v[20:23], v[68:71], v[128:131], v[20:23]
    ds_read_b64_tr_b16 v[48:49], v2 offset:20480
    v_mfma_f32_16x16x32_bf16 v[24:27], v[72:75], v[128:131], v[24:27]
    ds_read_b64_tr_b16 v[50:51], v6 offset:20480
    v_mfma_f32_16x16x32_bf16 v[28:31], v[76:79], v[128:131], v[28:31]
    ds_read_b64_tr_b16 v[52:53], v3 offset:20480
    v_mfma_f32_16x16x32_bf16 v[32:35], v[64:67], v[132:135], v[32:35]
    ds_read_b64_tr_b16 v[54:55], v7 offset:20480
    ds_read_b64_tr_b16 v[56:57], v4 offset:20480
    v_mfma_f32_16x16x32_bf16 v[36:39], v[68:71], v[132:135], v[36:39]
    ds_read_b64_tr_b16 v[58:59], v8 offset:20480
    v_mfma_f32_16x16x32_bf16 v[40:43], v[72:75], v[132:135], v[40:43]
    ds_read_b64_tr_b16 v[60:61], v5 offset:20480
    v_mfma_f32_16x16x32_bf16 v[44:47], v[76:79], v[132:135], v[44:47]
    ds_read_b64_tr_b16 v[62:63], v9 offset:20480
    s_waitcnt vmcnt(8) lgkmcnt(8)
    s_mov_b64 exec, 1
    ds_add_u32 v10, v11 offset:28
    s_mov_b64 exec, -1
    v_mfma_f32_16x16x32_bf16 v[16:19], v[80:83], v[136:139], v[16:19]
    buffer_load_dwordx4 v[128:131], v12, s[52:55], s41 offen offset:2048 sc1
    buffer_load_dwordx4 v[132:135], v15, s[52:55], s41 offen offset:2048 sc1
    v_mfma_f32_16x16x32_bf16 v[20:23], v[84:87], v[136:139], v[20:23]
    ds_read_b64_tr_b16 v[64:65], v224 offset:45056
    v_mfma_f32_16x16x32_bf16 v[24:27], v[88:91], v[136:139], v[24:27]
    ds_read_b64_tr_b16 v[66:67], v228 offset:45056
    v_mfma_f32_16x16x32_bf16 v[28:31], v[92:95], v[136:139], v[28:31]
    ds_read_b64_tr_b16 v[68:69], v225 offset:45056
    v_mfma_f32_16x16x32_bf16 v[32:35], v[80:83], v[140:143], v[32:35]
    ds_read_b64_tr_b16 v[70:71], v229 offset:45056
    ds_read_b64_tr_b16 v[72:73], v226 offset:45056
    v_mfma_f32_16x16x32_bf16 v[36:39], v[84:87], v[140:143], v[36:39]
    ds_read_b64_tr_b16 v[74:75], v230 offset:45056
    v_mfma_f32_16x16x32_bf16 v[40:43], v[88:91], v[140:143], v[40:43]
    ds_read_b64_tr_b16 v[76:77], v227 offset:45056
    v_mfma_f32_16x16x32_bf16 v[44:47], v[92:95], v[140:143], v[44:47]
    ds_read_b64_tr_b16 v[78:79], v231 offset:45056
    s_waitcnt vmcnt(8) lgkmcnt(9)
    v_mfma_f32_16x16x32_bf16 v[16:19], v[48:51], v[96:99], v[16:19]
    buffer_load_dwordx4 v[136:139], v12, s[52:55], s41 offen offset:3072 sc1
    buffer_load_dwordx4 v[140:143], v15, s[52:55], s41 offen offset:3072 sc1
    v_mfma_f32_16x16x32_bf16 v[20:23], v[52:55], v[96:99], v[20:23]
    ds_read_b64_tr_b16 v[80:81], v224 offset:49152
    v_mfma_f32_16x16x32_bf16 v[24:27], v[56:59], v[96:99], v[24:27]
    ds_read_b64_tr_b16 v[82:83], v228 offset:49152
    v_mfma_f32_16x16x32_bf16 v[28:31], v[60:63], v[96:99], v[28:31]
    ds_read_b64_tr_b16 v[84:85], v225 offset:49152
    v_mfma_f32_16x16x32_bf16 v[32:35], v[48:51], v[100:103], v[32:35]
    ds_read_b64_tr_b16 v[86:87], v229 offset:49152
    ds_read_b64_tr_b16 v[88:89], v226 offset:49152
    v_mfma_f32_16x16x32_bf16 v[36:39], v[52:55], v[100:103], v[36:39]
    ds_read_b64_tr_b16 v[90:91], v230 offset:49152
    v_mfma_f32_16x16x32_bf16 v[40:43], v[56:59], v[100:103], v[40:43]
    ds_read_b64_tr_b16 v[92:93], v227 offset:49152
    v_mfma_f32_16x16x32_bf16 v[44:47], v[60:63], v[100:103], v[44:47]
    ds_read_b64_tr_b16 v[94:95], v231 offset:49152
    s_waitcnt vmcnt(8) lgkmcnt(8)
    v_mfma_f32_16x16x32_bf16 v[16:19], v[64:67], v[104:107], v[16:19]
    buffer_load_dwordx4 v[96:99], v12, s[52:55], s42 offen offset:0 sc1
    buffer_load_dwordx4 v[100:103], v15, s[52:55], s42 offen offset:0 sc1
    v_mfma_f32_16x16x32_bf16 v[20:23], v[68:71], v[104:107], v[20:23]
    ds_read_b64_tr_b16 v[48:49], v224 offset:53248
    v_mfma_f32_16x16x32_bf16 v[24:27], v[72:75], v[104:107], v[24:27]
    ds_read_b64_tr_b16 v[50:51], v228 offset:53248
    v_mfma_f32_16x16x32_bf16 v[28:31], v[76:79], v[104:107], v[28:31]
    ds_read_b64_tr_b16 v[52:53], v225 offset:53248
    v_mfma_f32_16x16x32_bf16 v[32:35], v[64:67], v[108:111], v[32:35]
    ds_read_b64_tr_b16 v[54:55], v229 offset:53248
    ds_read_b64_tr_b16 v[56:57], v226 offset:53248
    v_mfma_f32_16x16x32_bf16 v[36:39], v[68:71], v[108:111], v[36:39]
    ds_read_b64_tr_b16 v[58:59], v230 offset:53248
    v_mfma_f32_16x16x32_bf16 v[40:43], v[72:75], v[108:111], v[40:43]
    ds_read_b64_tr_b16 v[60:61], v227 offset:53248
    v_mfma_f32_16x16x32_bf16 v[44:47], v[76:79], v[108:111], v[44:47]
    ds_read_b64_tr_b16 v[62:63], v231 offset:53248
    s_waitcnt vmcnt(8) lgkmcnt(8)
    v_mfma_f32_16x16x32_bf16 v[16:19], v[80:83], v[112:115], v[16:19]
    buffer_load_dwordx4 v[104:107], v12, s[52:55], s42 offen offset:1024 sc1
    buffer_load_dwordx4 v[108:111], v15, s[52:55], s42 offen offset:1024 sc1
    v_mfma_f32_16x16x32_bf16 v[20:23], v[84:87], v[112:115], v[20:23]
    ds_read_b64_tr_b16 v[64:65], v224 offset:57344
    v_mfma_f32_16x16x32_bf16 v[24:27], v[88:91], v[112:115], v[24:27]
    ds_read_b64_tr_b16 v[66:67], v228 offset:57344
    v_mfma_f32_16x16x32_bf16 v[28:31], v[92:95], v[112:115], v[28:31]
    ds_read_b64_tr_b16 v[68:69], v225 offset:57344
    v_mfma_f32_16x16x32_bf16 v[32:35], v[80:83], v[116:119], v[32:35]
    ds_read_b64_tr_b16 v[70:71], v229 offset:57344
    ds_read_b64_tr_b16 v[72:73], v226 offset:57344
    v_mfma_f32_16x16x32_bf16 v[36:39], v[84:87], v[116:119], v[36:39]
    ds_read_b64_tr_b16 v[74:75], v230 offset:57344
    v_mfma_f32_16x16x32_bf16 v[40:43], v[88:91], v[116:119], v[40:43]
    ds_read_b64_tr_b16 v[76:77], v227 offset:57344
    v_mfma_f32_16x16x32_bf16 v[44:47], v[92:95], v[116:119], v[44:47]
    ds_read_b64_tr_b16 v[78:79], v231 offset:57344
    s_waitcnt vmcnt(8) lgkmcnt(8)
    v_mfma_f32_16x16x32_bf16 v[16:19], v[48:51], v[120:123], v[16:19]
    buffer_load_dwordx4 v[112:115], v12, s[52:55], s42 offen offset:2048 sc1
    buffer_load_dwordx4 v[116:119], v15, s[52:55], s42 offen offset:2048 sc1
    v_mfma_f32_16x16x32_bf16 v[20:23], v[52:55], v[120:123], v[20:23]
    ds_read_b64_tr_b16 v[80:81], v2 offset:24576
    v_mfma_f32_16x16x32_bf16 v[24:27], v[56:59], v[120:123], v[24:27]
    ds_read_b64_tr_b16 v[82:83], v6 offset:24576
    v_mfma_f32_16x16x32_bf16 v[28:31], v[60:63], v[120:123], v[28:31]
    ds_read_b64_tr_b16 v[84:85], v3 offset:24576
    v_mfma_f32_16x16x32_bf16 v[32:35], v[48:51], v[124:127], v[32:35]
    ds_read_b64_tr_b16 v[86:87], v7 offset:24576
    ds_read_b64_tr_b16 v[88:89], v4 offset:24576
    v_mfma_f32_16x16x32_bf16 v[36:39], v[52:55], v[124:127], v[36:39]
    ds_read_b64_tr_b16 v[90:91], v8 offset:24576
    v_mfma_f32_16x16x32_bf16 v[40:43], v[56:59], v[124:127], v[40:43]
    ds_read_b64_tr_b16 v[92:93], v5 offset:24576
    v_mfma_f32_16x16x32_bf16 v[44:47], v[60:63], v[124:127], v[44:47]
    ds_read_b64_tr_b16 v[94:95], v9 offset:24576
    s_waitcnt vmcnt(8) lgkmcnt(8)
    v_mfma_f32_16x16x32_bf16 v[16:19], v[64:67], v[128:131], v[16:19]
    buffer_load_dwordx4 v[120:123], v12, s[52:55], s42 offen offset:3072 sc1
    buffer_load_dwordx4 v[124:127], v15, s[52:55], s42 offen offset:3072 sc1
    v_mfma_f32_16x16x32_bf16 v[20:23], v[68:71], v[128:131], v[20:23]
    ds_read_b64_tr_b16 v[48:49], v2 offset:28672
    v_mfma_f32_16x16x32_bf16 v[24:27], v[72:75], v[128:131], v[24:27]
    ds_read_b64_tr_b16 v[50:51], v6 offset:28672
    v_mfma_f32_16x16x32_bf16 v[28:31], v[76:79], v[128:131], v[28:31]
    ds_read_b64_tr_b16 v[52:53], v3 offset:28672
    v_mfma_f32_16x16x32_bf16 v[32:35], v[64:67], v[132:135], v[32:35]
    ds_read_b64_tr_b16 v[54:55], v7 offset:28672
    ds_read_b64_tr_b16 v[56:57], v4 offset:28672
    v_mfma_f32_16x16x32_bf16 v[36:39], v[68:71], v[132:135], v[36:39]
    ds_read_b64_tr_b16 v[58:59], v8 offset:28672
    v_mfma_f32_16x16x32_bf16 v[40:43], v[72:75], v[132:135], v[40:43]
    ds_read_b64_tr_b16 v[60:61], v5 offset:28672
    v_mfma_f32_16x16x32_bf16 v[44:47], v[76:79], v[132:135], v[44:47]
    ds_read_b64_tr_b16 v[62:63], v9 offset:28672
    s_waitcnt vmcnt(8) lgkmcnt(8)
    v_mfma_f32_16x16x32_bf16 v[16:19], v[80:83], v[136:139], v[16:19]
    buffer_load_dwordx4 v[128:131], v12, s[52:55], s43 offen offset:0 sc1
    buffer_load_dwordx4 v[132:135], v15, s[52:55], s43 offen offset:0 sc1
    v_mfma_f32_16x16x32_bf16 v[20:23], v[84:87], v[136:139], v[20:23]
    ds_read_b32 v223, v10 offset:32
    v_mfma_f32_16x16x32_bf16 v[24:27], v[88:91], v[136:139], v[24:27]
    ds_read_b64_tr_b16 v[64:65], v2 offset:32768
    ds_read_b64_tr_b16 v[66:67], v6 offset:32768
    v_mfma_f32_16x16x32_bf16 v[28:31], v[92:95], v[136:139], v[28:31]
    ds_read_b64_tr_b16 v[68:69], v3 offset:32768
    v_mfma_f32_16x16x32_bf16 v[32:35], v[80:83], v[140:143], v[32:35]
    ds_read_b64_tr_b16 v[70:71], v7 offset:32768
    v_mfma_f32_16x16x32_bf16 v[36:39], v[84:87], v[140:143], v[36:39]
    ds_read_b64_tr_b16 v[72:73], v4 offset:32768
    ds_read_b64_tr_b16 v[74:75], v8 offset:32768
    v_mfma_f32_16x16x32_bf16 v[40:43], v[88:91], v[140:143], v[40:43]
    ds_read_b64_tr_b16 v[76:77], v5 offset:32768
    v_mfma_f32_16x16x32_bf16 v[44:47], v[92:95], v[140:143], v[44:47]
    ds_read_b64_tr_b16 v[78:79], v9 offset:32768
    s_waitcnt vmcnt(8) lgkmcnt(9)
    s_waitcnt lgkmcnt(8)
    v_cmp_gt_u32 vcc, 4, v223
    s_cbranch_vccnz LB_w8
LB_g8:
    v_mfma_f32_16x16x32_bf16 v[16:19], v[48:51], v[96:99], v[16:19]
    buffer_load_dwordx4 v[136:139], v12, s[52:55], s43 offen offset:1024 sc1
    buffer_load_dwordx4 v[140:143], v15, s[52:55], s43 offen offset:1024 sc1
    v_add_u32 v2, 129024, v2
    v_mfma_f32_16x16x32_bf16 v[20:23], v[52:55], v[96:99], v[20:23]
    ds_read_b64_tr_b16 v[80:81], v2 offset:0
    v_add_u32 v6, 129024, v6
    v_mfma_f32_16x16x32_bf16 v[24:27], v[56:59], v[96:99], v[24:27]
    ds_read_b64_tr_b16 v[82:83], v6 offset:0
    v_add_u32 v3, 129024, v3
    v_mfma_f32_16x16x32_bf16 v[28:31], v[60:63], v[96:99], v[28:31]
    ds_read_b64_tr_b16 v[84:85], v3 offset:0
    v_add_u32 v7, 129024, v7
    v_mfma_f32_16x16x32_bf16 v[32:35], v[48:51], v[100:103], v[32:35]
    ds_read_b64_tr_b16 v[86:87], v7 offset:0
    v_add_u32 v4, 129024, v4
    ds_read_b64_tr_b16 v[88:89], v4 offset:0
    v_mfma_f32_16x16x32_bf16 v[36:39], v[52:55], v[100:103], v[36:39]
    v_add_u32 v8, 129024, v8
    ds_read_b64_tr_b16 v[90:91], v8 offset:0
    v_mfma_f32_16x16x32_bf16 v[40:43], v[56:59], v[100:103], v[40:43]
    v_add_u32 v5, 129024, v5
    ds_read_b64_tr_b16 v[92:93], v5 offset:0
    v_mfma_f32_16x16x32_bf16 v[44:47], v[60:63], v[100:103], v[44:47]
    v_add_u32 v9, 129024, v9
    ds_read_b64_tr_b16 v[94:95], v9 offset:0
    s_waitcnt vmcnt(8) lgkmcnt(8)
    v_mfma_f32_16x16x32_bf16 v[16:19], v[64:67], v[104:107], v[16:19]
    buffer_load_dwordx4 v[96:99], v12, s[52:55], s43 offen offset:2048 sc1
    buffer_load_dwordx4 v[100:103], v15, s[52:55], s43 offen offset:2048 sc1
    v_mfma_f32_16x16x32_bf16 v[20:23], v[68:71], v[104:107], v[20:23]
    ds_read_b64_tr_b16 v[48:49], v2 offset:4096
    v_mfma_f32_16x16x32_bf16 v[24:27], v[72:75], v[104:107], v[24:27]
    ds_read_b64_tr_b16 v[50:51], v6 offset:4096
    v_mfma_f32_16x16x32_bf16 v[28:31], v[76:79], v[104:107], v[28:31]
    ds_read_b64_tr_b16 v[52:53], v3 offset:4096
    v_mfma_f32_16x16x32_bf16 v[32:35], v[64:67], v[108:111], v[32:35]
    ds_read_b64_tr_b16 v[54:55], v7 offset:4096
    ds_read_b64_tr_b16 v[56:57], v4 offset:4096
    v_mfma_f32_16x16x32_bf16 v[36:39], v[68:71], v[108:111], v[36:39]
    ds_read_b64_tr_b16 v[58:59], v8 offset:4096
    v_mfma_f32_16x16x32_bf16 v[40:43], v[72:75], v[108:111], v[40:43]
    ds_read_b64_tr_b16 v[60:61], v5 offset:4096
    v_mfma_f32_16x16x32_bf16 v[44:47], v[76:79], v[108:111], v[44:47]
    ds_read_b64_tr_b16 v[62:63], v9 offset:4096
    s_waitcnt vmcnt(8) lgkmcnt(8)
    v_mfma_f32_16x16x32_bf16 v[16:19], v[80:83], v[112:115], v[16:19]
    buffer_load_dwordx4 v[104:107], v12, s[52:55], s43 offen offset:3072 sc1
    buffer_load_dwordx4 v[108:111], v15, s[52:55], s43 offen offset:3072 sc1
    v_mfma_f32_16x16x32_bf16 v[20:23], v[84:87], v[112:115], v[20:23]
    ds_read_b64_tr_b16 v[64:65], v2 offset:8192
    v_mfma_f32_16x16x32_bf16 v[24:27], v[88:91], v[112:115], v[24:27]
    ds_read_b64_tr_b16 v[66:67], v6 offset:8192
    v_mfma_f32_16x16x32_bf16 v[28:31], v[92:95], v[112:115], v[28:31]
    ds_read_b64_tr_b16 v[68:69], v3 offset:8192
    v_mfma_f32_16x16x32_bf16 v[32:35], v[80:83], v[116:119], v[32:35]
    ds_read_b64_tr_b16 v[70:71], v7 offset:8192
    ds_read_b64_tr_b16 v[72:73], v4 offset:8192
    v_mfma_f32_16x16x32_bf16 v[36:39], v[84:87], v[116:119], v[36:39]
    ds_read_b64_tr_b16 v[74:75], v8 offset:8192
    v_mfma_f32_16x16x32_bf16 v[40:43], v[88:91], v[116:119], v[40:43]
    ds_read_b64_tr_b16 v[76:77], v5 offset:8192
    v_mfma_f32_16x16x32_bf16 v[44:47], v[92:95], v[116:119], v[44:47]
    ds_read_b64_tr_b16 v[78:79], v9 offset:8192
    s_waitcnt vmcnt(8) lgkmcnt(8)
    v_mfma_f32_16x16x32_bf16 v[16:19], v[48:51], v[120:123], v[16:19]
    ds_read_b64_tr_b16 v[80:81], v2 offset:12288
    v_mfma_f32_16x16x32_bf16 v[20:23], v[52:55], v[120:123], v[20:23]
    ds_read_b64_tr_b16 v[82:83], v6 offset:12288
    v_mfma_f32_16x16x32_bf16 v[24:27], v[56:59], v[120:123], v[24:27]
    ds_read_b64_tr_b16 v[84:85], v3 offset:12288
    v_mfma_f32_16x16x32_bf16 v[28:31], v[60:63], v[120:123], v[28:31]
    ds_read_b64_tr_b16 v[86:87], v7 offset:12288
    v_mfma_f32_16x16x32_bf16 v[32:35], v[48:51], v[124:127], v[32:35]
    ds_read_b64_tr_b16 v[88:89], v4 offset:12288
    v_mfma_f32_16x16x32_bf16 v[36:39], v[52:55], v[124:127], v[36:39]
    ds_read_b64_tr_b16 v[90:91], v8 offset:12288
    v_mfma_f32_16x16x32_bf16 v[40:43], v[56:59], v[124:127], v[40:43]
    ds_read_b64_tr_b16 v[92:93], v5 offset:12288
    v_mfma_f32_16x16x32_bf16 v[44:47], v[60:63], v[124:127], v[44:47]
    ds_read_b64_tr_b16 v[94:95], v9 offset:12288
    s_waitcnt vmcnt(6) lgkmcnt(8)
    v_mfma_f32_16x16x32_bf16 v[16:19], v[64:67], v[128:131], v[16:19]
    ds_read_b64_tr_b16 v[48:49], v2 offset:16384
    v_mfma_f32_16x16x32_bf16 v[20:23], v[68:71], v[128:131], v[20:23]
    ds_read_b64_tr_b16 v[50:51], v6 offset:16384
    v_mfma_f32_16x16x32_bf16 v[24:27], v[72:75], v[128:131], v[24:27]
    ds_read_b64_tr_b16 v[52:53], v3 offset:16384
    v_mfma_f32_16x16x32_bf16 v[28:31], v[76:79], v[128:131], v[28:31]
    ds_read_b64_tr_b16 v[54:55], v7 offset:16384
    v_mfma_f32_16x16x32_bf16 v[32:35], v[64:67], v[132:135], v[32:35]
    ds_read_b64_tr_b16 v[56:57], v4 offset:16384
    v_mfma_f32_16x16x32_bf16 v[36:39], v[68:71], v[132:135], v[36:39]
    ds_read_b64_tr_b16 v[58:59], v8 offset:16384
    v_mfma_f32_16x16x32_bf16 v[40:43], v[72:75], v[132:135], v[40:43]
    ds_read_b64_tr_b16 v[60:61], v5 offset:16384
    v_mfma_f32_16x16x32_bf16 v[44:47], v[76:79], v[132:135], v[44:47]
    ds_read_b64_tr_b16 v[62:63], v9 offset:16384
    s_waitcnt vmcnt(4) lgkmcnt(8)
    v_mfma_f32_16x16x32_bf16 v[16:19], v[80:83], v[136:139], v[16:19]
    ds_read_b64_tr_b16 v[64:65], v2 offset:20480
    v_mfma_f32_16x16x32_bf16 v[20:23], v[84:87], v[136:139], v[20:23]
    ds_read_b64_tr_b16 v[66:67], v6 offset:20480
    v_mfma_f32_16x16x32_bf16 v[24:27], v[88:91], v[136:139], v[24:27]
    ds_read_b64_tr_b16 v[68:69], v3 offset:20480
    v_mfma_f32_16x16x32_bf16 v[28:31], v[92:95], v[136:139], v[28:31]
    ds_read_b64_tr_b16 v[70:71], v7 offset:20480
    v_mfma_f32_16x16x32_bf16 v[32:35], v[80:83], v[140:143], v[32:35]
    ds_read_b64_tr_b16 v[72:73], v4 offset:20480
    v_mfma_f32_16x16x32_bf16 v[36:39], v[84:87], v[140:143], v[36:39]
    ds_read_b64_tr_b16 v[74:75], v8 offset:20480
    v_mfma_f32_16x16x32_bf16 v[40:43], v[88:91], v[140:143], v[40:43]
    ds_read_b64_tr_b16 v[76:77], v5 offset:20480
    v_mfma_f32_16x16x32_bf16 v[44:47], v[92:95], v[140:143], v[44:47]
    ds_read_b64_tr_b16 v[78:79], v9 offset:20480
    s_waitcnt vmcnt(2) lgkmcnt(8)
    v_mfma_f32_16x16x32_bf16 v[16:19], v[48:51], v[96:99], v[16:19]
    ds_read_b32 v223, v10 offset:28
    v_mfma_f32_16x16x32_bf16 v[20:23], v[52:55], v[96:99], v[20:23]
    v_mfma_f32_16x16x32_bf16 v[24:27], v[56:59], v[96:99], v[24:27]
    v_mfma_f32_16x16x32_bf16 v[28:31], v[60:63], v[96:99], v[28:31]
    v_mfma_f32_16x16x32_bf16 v[32:35], v[48:51], v[100:103], v[32:35]
    v_mfma_f32_16x16x32_bf16 v[36:39], v[52:55], v[100:103], v[36:39]
    v_mfma_f32_16x16x32_bf16 v[40:43], v[56:59], v[100:103], v[40:43]
    v_mfma_f32_16x16x32_bf16 v[44:47], v[60:63], v[100:103], v[44:47]
    s_waitcnt vmcnt(0) lgkmcnt(1)
    v_mfma_f32_16x16x32_bf16 v[16:19], v[64:67], v[104:107], v[16:19]
    v_mfma_f32_16x16x32_bf16 v[20:23], v[68:71], v[104:107], v[20:23]
    v_mfma_f32_16x16x32_bf16 v[24:27], v[72:75], v[104:107], v[24:27]
    v_mfma_f32_16x16x32_bf16 v[28:31], v[76:79], v[104:107], v[28:31]
    v_mfma_f32_16x16x32_bf16 v[32:35], v[64:67], v[108:111], v[32:35]
    v_mfma_f32_16x16x32_bf16 v[36:39], v[68:71], v[108:111], v[36:39]
    v_mfma_f32_16x16x32_bf16 v[40:43], v[72:75], v[108:111], v[40:43]
    v_mfma_f32_16x16x32_bf16 v[44:47], v[76:79], v[108:111], v[44:47]
    s_waitcnt lgkmcnt(0)
    v_cmp_gt_u32 vcc, 4, v223
    s_cbranch_vccnz LB_w7
LB_g7:
    v_cvt_pk_bf16_f32 v176, v16, v17
    v_cvt_pk_bf16_f32 v177, v18, v19
    v_cvt_pk_bf16_f32 v178, v20, v21
    v_cvt_pk_bf16_f32 v179, v22, v23
    s_nop 0
    v_permlane16_swap_b32 v176, v178
    v_permlane16_swap_b32 v177, v179
    ds_write_b128 v248, v[176:179] offset:0
    v_cvt_pk_bf16_f32 v180, v24, v25
    v_cvt_pk_bf16_f32 v181, v26, v27
    v_cvt_pk_bf16_f32 v182, v28, v29
    v_cvt_pk_bf16_f32 v183, v30, v31
    s_nop 0
    v_permlane16_swap_b32 v180, v182
    v_permlane16_swap_b32 v181, v183
    ds_write_b128 v249, v[180:183] offset:0
    ds_read_b128 v[192:195], v250 offset:0
    ds_read_b128 v[196:199], v250 offset:1024
    v_cvt_pk_bf16_f32 v184, v32, v33
    v_cvt_pk_bf16_f32 v185, v34, v35
    v_cvt_pk_bf16_f32 v186, v36, v37
    v_cvt_pk_bf16_f32 v187, v38, v39
    s_nop 0
    v_permlane16_swap_b32 v184, v186
    v_permlane16_swap_b32 v185, v187
    ds_write_b128 v248, v[184:187] offset:2048
    v_cvt_pk_bf16_f32 v188, v40, v41
    v_cvt_pk_bf16_f32 v189, v42, v43
    v_cvt_pk_bf16_f32 v190, v44, v45
    v_cvt_pk_bf16_f32 v191, v46, v47
    s_nop 0
    v_permlane16_swap_b32 v188, v190
    v_permlane16_swap_b32 v189, v191
    ds_write_b128 v249, v[188:191] offset:2048
    ds_read_b128 v[200:203], v250 offset:2048
    ds_read_b128 v[204:207], v250 offset:3072
    s_mov_b32 s95, 0
    s_waitcnt lgkmcnt(5)
    buffer_store_dwordx4 v[192:195], v246, s[60:63], s95 offen nt
    s_mov_b32 s95, 32768
    s_waitcnt lgkmcnt(4)
    buffer_store_dwordx4 v[196:199], v246, s[60:63], s95 offen nt
    s_mov_b32 s95, 65536
    s_waitcnt lgkmcnt(1)
    buffer_store_dwordx4 v[200:203], v246, s[60:63], s95 offen nt
    s_mov_b32 s95, 98304
    s_waitcnt lgkmcnt(0)
    buffer_store_dwordx4 v[204:207], v246, s[60:63], s95 offen nt
    s_endpgm
LA_slow:
    s_mov_b32 s79, 0
LA_slow1:
    s_mov_b64 exec, vcc
    s_sleep 8
    buffer_load_dword v136, v33, s[68:71], 0 offen sc1
    buffer_load_dword v137, v34, s[52:55], 0 offen sc1
    s_add_u32 s79, s79, 1
    s_cmp_gt_u32 s79, 200000
    s_waitcnt vmcnt(0)
    s_cbranch_scc1 LA_back
    v_cmp_ne_u32 vcc, v136, v137
    v_cmp_gt_u32 s[80:81], s96, v136
    s_nop 0
    s_or_b64 vcc, vcc, s[80:81]
    s_cbranch_vccnz LA_slow1
    s_branch LA_back
LB_tag:
    s_mov_b64 exec, 0xffff
    s_waitcnt vmcnt(0)
    v_lshrrev_b32 v251, v0, v251
    v_and_b32 v251, 1, v251
    v_cmp_eq_u32 vcc, 0, v251
    s_nop 1
    s_or_b32 s83, vcc_lo, 0x10000
    s_mov_b64 exec, 1
    v_mov_b32 v251, s83
    buffer_store_dword v251, v220, s[68:71], s98 offen sc1
    s_mov_b64 exec, -1
    s_branch LB_tagb
LB_slow:
    s_mov_b32 s79, 0
LB_pt:
    buffer_load_dword v222, v220, s[68:71], s98 offen sc1
    s_add_u32 s79, s79, 1
    s_cmp_gt_u32 s79, 200000
    s_cbranch_scc1 LB_pt_x
    s_waitcnt vmcnt(0)
    v_cmp_gt_u32 vcc, 4096, v222
    s_cbranch_vccz LB_pt_x
    s_mov_b64 exec, vcc
    s_sleep 8
    s_branch LB_pt
LB_pt_x:
    s_waitcnt vmcnt(0)
    s_branch LB_back
LB_w15:
    s_branch LB_s6_in
LB_s6:
    s_sleep 1
LB_s6_in:
    ds_read_b32 v223, v10 offset:24
    s_waitcnt lgkmcnt(0)
    v_readfirstlane_b32 s78, v223
    s_nop 0
    s_cmp_ge_u32 s78, 4
    s_cbranch_scc0 LB_s6
    s_branch LB_g15
LB_w4:
    s_branch LB_s4_in
LB_s4:
    s_sleep 1
LB_s4_in:
    ds_read_b32 v222, v10 offset:16
    s_waitcnt lgkmcnt(0)
    v_readfirstlane_b32 s78, v222
    s_nop 0
    s_cmp_ge_u32 s78, 4
    s_cbranch_scc0 LB_s4
    s_branch LB_g4
LB_w8:
    s_branch LB_s8_in
LB_s8:
    s_sleep 1
LB_s8_in:
    ds_read_b32 v223, v10 offset:32
    s_waitcnt lgkmcnt(0)
    v_readfirstlane_b32 s78, v223
    s_nop 0
    s_cmp_ge_u32 s78, 4
    s_cbranch_scc0 LB_s8
    s_branch LB_g8
LB_w7:
    s_branch LB_s7_in
LB_s7:
    s_sleep 1
LB_s7_in:
    ds_read_b32 v223, v10 offset:28
    s_waitcnt lgkmcnt(0)
    v_readfirstlane_b32 s78, v223
    s_nop 0
    s_cmp_ge_u32 s78, 4
    s_cbranch_scc0 LB_s7
    s_branch LB_g7
L_end:
    s_endpgm
.section .rodata,"a"
.p2align 6
.amdhsa_kernel concat_heads__ssm_conv_h3__sliding_local_dilated__prompt_kernel
  .amdhsa_next_free_vgpr 256
  .amdhsa_next_free_sgpr 102
  .amdhsa_accum_offset 256
  .amdhsa_group_segment_fixed_size 0
  .amdhsa_kernarg_size 96
  .amdhsa_user_sgpr_count 2
  .amdhsa_user_sgpr_kernarg_segment_ptr 1
  .amdhsa_system_sgpr_workgroup_id_x 1
.end_amdhsa_kernel
```

```asm
; @launch grid=(256,1,1) block=(512,1,1) lds=163840
.amdgcn_target "amdgcn-amd-amdhsa--gfx950"
.text
.globl concat_heads__ssm_conv_h3__sliding_local_dilated__prompt_kernel
.p2align 8
.type concat_heads__ssm_conv_h3__sliding_local_dilated__prompt_kernel,@function
concat_heads__ssm_conv_h3__sliding_local_dilated__prompt_kernel:
    s_cmp_ge_u32 s2, 256
    s_cbranch_scc1 L_end
    s_load_dwordx2 s[28:29], s[0:1], 48
    s_load_dwordx2 s[32:33], s[0:1], 56
    s_load_dwordx8 s[4:11], s[0:1], 0
    s_load_dwordx4 s[12:15], s[0:1], 32
    s_load_dwordx8 s[20:27], s[0:1], 64
    v_lshrrev_b32 v1, 6, v0
    v_and_b32 v0, 63, v0
    v_readfirstlane_b32 s3, v1
    s_nop 0
    s_cmp_lg_u32 s3, 4
    s_cbranch_scc1 L_nopf
    s_getpc_b64 s[80:81]
L_pc:
    s_bfe_u32 s78, s2, 0x40003
    v_lshl_add_u32 v1, v0, 4, s78
    v_lshlrev_b32 v1, 7, v1
    v_cmp_gt_u32 vcc, L_end-L_pc, v1
    s_nop 0
    s_and_saveexec_b64 s[82:83], vcc
    global_load_dword v222, v1, s[80:81]
    s_mov_b64 exec, -1
L_nopf:
    s_and_b32 s78, s2, 7
    s_lshr_b32 s79, s2, 3
    s_lshl_b32 s78, s78, 2
    s_lshr_b32 s78, 0x76325410, s78
    s_and_b32 s78, s78, 7
    s_and_b32 s80, s78, 1
    s_lshl_b32 s80, s80, 3
    s_lshr_b32 s81, s78, 1
    s_lshl_b32 s81, s81, 2
    s_and_b32 s72, s79, 7
    s_add_u32 s72, s72, s80
    s_lshr_b32 s73, s79, 3
    s_xor_b32 s73, s73, 3
    s_add_u32 s73, s73, s81
    s_cmp_ge_u32 s3, 4
    s_cbranch_scc1 L_B
    v_lshrrev_b32 v5, 3, v0
    v_and_b32 v6, 7, v0
    v_lshrrev_b32 v7, 4, v0
    s_lshl_b32 s79, s72, 7
    s_lshl_b32 s80, s3, 5
    s_add_u32 s81, s79, s80
    v_xor_b32 v8, v7, v6
    v_lshlrev_b32 v8, 4, v8
    v_add_u32 v240, s81, v5
    v_lshl_add_u32 v240, v240, 11, v8
    v_xor_b32 v241, 64, v240
    v_add_u32 v241, 15360, v241
    v_add_u32 v242, 30720, v240
    v_add_u32 v243, 30720, v241
    s_lshl_b32 s87, s3, 12
    s_add_u32 s87, s87, 75776
    s_and_b32 s98, s73, 12
    s_and_b32 s78, s72, 8
    s_add_u32 s98, s98, s78
    s_add_u32 s101, s72, s73
    s_and_b32 s101, s101, 3
    s_lshl_b32 s78, s101, 2
    s_lshr_b32 s97, 0x101, s78
    s_add_u32 s97, s97, s98
    s_and_b32 s97, s97, 15
    s_lshr_b32 s99, s97, 3
    s_xor_b32 s97, s97, s99
    s_mov_b32 m0, s87
    s_lshl_b32 s97, s97, 7
    s_mov_b32 s30, 0x400000
    s_mov_b32 s31, 0x20000
    s_waitcnt lgkmcnt(0)
    buffer_load_dwordx4 v240, s[28:31], s97 offen offset:0  lds
    s_and_b32 s78, s3, 1
    s_lshl_b32 s78, s78, 2
    s_lshl_b32 s80, s3, 3
    v_and_b32 v8, 1, v7
    v_lshl_or_b32 v8, v8, 1, s78
    v_xor_b32 v8, v8, v6
    buffer_load_dwordx4 v241, s[28:31], s97 offen offset:1024  lds
    v_lshlrev_b32 v8, 4, v8
    v_add_u32 v244, s80, v5
    v_mul_u32_u24 v244, 6144, v244
    s_lshl_b32 s82, s73, 7
    v_add3_u32 v244, v244, v8, s82
    buffer_load_dwordx4 v242, s[28:31], s97 offen offset:2048  lds
    v_add_u32 v245, 1024, v244
    v_add_u32 v246, 2048, v244
    s_bfe_u32 s62, s72, 0x10002
    s_mul_i32 s78, s62, 12288
    s_mul_i32 s80, s3, 3072
    s_add_u32 s60, s80, s78
    buffer_load_dwordx4 v243, s[28:31], s97 offen offset:3072  lds
    s_sub_u32 s61, s80, s78
    s_mul_i32 s62, s62, 196608
    s_sub_u32 s63, 196608, s62
    s_mov_b32 s34, 0x600000
    s_mov_b32 s35, 0x20000
    s_mul_i32 s16, s97, 3072
    s_add_u32 m0, s60, 0
    s_add_u32 s99, s16, s62
    buffer_load_dwordx4 v244, s[32:35], s99 offen offset:0  lds
    s_lshl_b32 s78, s3, 1
    s_lshl_b32 s80, s3, 2
    s_add_u32 s79, s79, s80
    s_sub_u32 s79, s79, 16
    v_add_u32 v8, s78, v7
    buffer_load_dwordx4 v245, s[32:35], s99 offen offset:1024  lds
    v_xor_b32 v8, v8, v6
    v_and_b32 v8, 7, v8
    v_lshlrev_b32 v8, 4, v8
    v_add_u32 v3, s79, v5
    buffer_load_dwordx4 v246, s[32:35], s99 offen offset:2048  lds
    v_lshl_add_u32 v3, v3, 11, v8
    s_lshl_b32 s86, s3, 10
    s_lshl_b32 s88, s3, 9
    s_add_u32 s88, s88, 73728
    s_add_u32 m0, s88, 0
    s_mov_b64 exec, 0xffffffff
    buffer_load_dwordx4 v3, s[28:31], s97 offen offset:0  lds
    s_mov_b64 exec, -1
    s_add_u32 m0, s61, 12288
    s_add_u32 s16, s16, s63
    buffer_load_dwordx4 v244, s[32:35], s16 offen offset:0  lds
    buffer_load_dwordx4 v245, s[32:35], s16 offen offset:1024  lds
    buffer_load_dwordx4 v246, s[32:35], s16 offen offset:2048  lds
    s_mov_b32 s0, 0x76583240
    s_mov_b32 s1, 0xfedba9c
    s_cmp_eq_u32 s101, 1
    s_cselect_b32 s0, 0x76943251, s0
    s_cselect_b32 s1, 0xfecbad8, s1
    s_cmp_eq_u32 s101, 2
    s_cselect_b32 s0, 0x7a543620, s0
    s_cselect_b32 s1, 0xfdcbe98, s1
    s_cmp_eq_u32 s101, 3
    s_cselect_b32 s0, 0xb6547231, s0
    s_cselect_b32 s1, 0xedcfa98, s1
    s_and_b32 s78, s73, 7
    s_cmp_lg_u32 s78, 3
    s_cbranch_scc1 LA_nb
    s_cmp_eq_u32 s101, 2
    s_cselect_b32 s0, 0x87654320, s0
    s_cselect_b32 s1, 0xfdcbea9, s1
    s_cmp_eq_u32 s101, 3
    s_cselect_b32 s0, 0x87654231, s0
    s_cselect_b32 s1, 0xedcfba9, s1
LA_nb:
    s_lshr_b32 s78, s2, 3
    s_and_b32 s76, s78, 3
    s_and_b32 s79, s73, 12
    s_add_u32 s76, s76, s79
    s_lshr_b32 s74, s78, 4
    s_add_u32 s74, s74, s79
    s_and_b32 s79, s72, 8
    s_lshr_b32 s77, s78, 2
    s_add_u32 s77, s77, s79
    s_lshr_b32 s79, s79, 2
    s_add_u32 s74, s74, s79
    s_xor_b32 s74, s74, 4
    s_and_b32 s75, s78, 15
    s_add_u32 s97, s98, s0
    s_lshr_b64 s[0:1], s[0:1], 4
    s_and_b32 s97, s97, 15
    s_lshr_b32 s99, s97, 3
    s_xor_b32 s97, s97, s99
    s_add_u32 m0, s87, 18432
    s_lshl_b32 s97, s97, 7
    buffer_load_dwordx4 v240, s[28:31], s97 offen offset:0  lds
    s_mov_b32 s36, s6
    s_mov_b32 s37, s7
    s_mov_b32 s38, 0x400000
    s_mov_b32 s39, 0x20000
    s_mov_b32 s40, s8
    s_mov_b32 s41, s9
    s_mov_b32 s42, 0x400000
    s_mov_b32 s43, 0x20000
    s_mov_b32 s44, s10
    s_mov_b32 s45, s11
    s_mov_b32 s46, 0x2000
    s_mov_b32 s47, 0x20000
    v_lshlrev_b32 v15, 4, v0
    v_and_b32 v7, 7, v0
    s_lshl_b32 s79, s74, 7
    v_lshl_add_u32 v7, v7, 4, s79
    s_lshl_b32 s78, s75, 7
    s_lshl_b32 s80, s3, 3
    s_add_u32 s80, s80, s78
    v_lshrrev_b32 v5, 3, v0
    s_and_b32 s79, s3, 1
    v_xor_b32 v5, s79, v5
    v_add_u32 v5, s80, v5
    v_lshl_add_u32 v10, v5, 11, v7
    s_xor_b32 s80, s3, 1
    s_add_u32 s80, s78, s80
    s_sub_u32 s80, s80, 4
    s_lshl_b32 s80, s80, 11
    v_add_u32 v11, s80, v7
    s_mov_b32 s52, s26
    s_mov_b32 s53, s27
    s_mov_b32 s54, 0x1000000
    s_mov_b32 s55, 0x20000
    v_and_b32 v7, 7, v0
    s_lshl_b32 s79, s74, 7
    v_lshl_add_u32 v7, v7, 4, s79
    s_lshl_b32 s78, s75, 7
    v_bfe_u32 v5, v0, 3, 2
    v_lshrrev_b32 v6, 5, v0
    s_lshl_b32 s80, s3, 5
    v_lshlrev_b32 v8, 3, v5
    v_lshl_add_u32 v8, v6, 2, v8
    v_add_u32 v8, s80, v8
    v_and_b32 v35, 7, v0
    v_lshl_add_u32 v16, v35, 1, v6
    v_lshlrev_b32 v232, 5, v16
    v_lshlrev_b32 v16, 3, v16
    v_lshl_add_u32 v16, v5, 10, v16
    v_and_b32 v231, 1, v5
    v_lshl_add_u32 v16, v231, 7, v16
    s_lshl_b32 s79, s3, 12
    s_add_u32 s79, s79, 129024
    v_add_u32 v16, s79, v16
    v_xor_b32 v231, 128, v16
    v_lshrrev_b32 v35, 2, v35
    v_lshl_add_u32 v35, v35, 4, v232
    v_add_u32 v35, 162816, v35
    v_add_u32 v8, s78, v8
    v_lshl_add_u32 v9, v8, 11, v7
    v_lshl_add_u32 v13, v8, 12, v7
    v_bfe_u32 v8, v0, 2, 1
    v_lshlrev_b32 v8, 1, v8
    v_add_u32 v8, v8, v6
    v_lshlrev_b32 v8, 16, v8
    v_lshl_add_u32 v8, v5, 6, v8
    v_and_b32 v7, 3, v0
    v_lshl_add_u32 v8, v7, 4, v8
    s_add_u32 s78, s78, s80
    s_lshl_b32 s78, s78, 3
    s_lshl_b32 s79, s74, 18
    s_add_u32 s78, s78, s79
    v_add_u32 v12, s78, v8
    s_mov_b32 s48, s12
    s_mov_b32 s49, s13
    s_mov_b32 s50, 0x400000
    s_mov_b32 s51, 0x20000
    s_mov_b32 s56, s4
    s_mov_b32 s57, s5
    s_mov_b32 s58, 0x400000
    s_mov_b32 s59, 0x20000
    s_mov_b32 s64, s20
    s_mov_b32 s65, s21
    s_mov_b32 s66, 0x200000
    s_mov_b32 s67, 0x20000
    s_lshl_b32 s91, s74, 4
    s_add_u32 s91, s91, s75
    s_lshr_b32 s78, s91, 3
    s_lshl_b32 s78, s78, 5
    s_and_b32 s79, s91, 7
    s_add_u32 s78, s78, s79
    s_lshl_b32 s79, s3, 3
    s_add_u32 s90, s78, s79
    s_lshl_b32 s91, s91, 14
    s_mov_b32 s96, 4096
    s_mul_i32 s94, s3, 8320
    s_add_u32 s94, s94, 129024
    v_mov_b32 v229, 0
    s_mov_b64 s[4:5], s[64:65]
    s_mov_b32 s6, 0x0
    s_mov_b32 s7, 0x20000
    v_mov_b32 v228, 0x40000000
    s_bitcmp1_b32 s73, 2
    s_cbranch_scc1 LA_nh0
    s_mov_b64 s[4:5], s[28:29]
    s_mov_b32 s6, 0x400000
    v_mov_b32 v229, 0x40000000
    s_and_b32 s78, s73, 3
    s_cmp_eq_u32 s78, 3
    s_cbranch_scc1 LA_nh0
    s_add_u32 s78, s72, 1
    s_and_b32 s78, s78, 3
    s_bfe_u32 s80, s72, 0x10002
    s_lshl_b32 s81, s101, 2
    s_lshl_b32 s82, s78, 1
    s_cmp_lt_u32 s78, 2
    s_cselect_b32 s79, 12, 24
    s_cselect_b32 s82, s82, 0
    s_cselect_b32 s83, 6, 7
    s_add_u32 s81, s81, s83
    s_add_u32 s80, s80, s82
    s_lshl_b32 s80, s80, 2
    s_add_u32 s80, s80, s3
    s_mul_i32 s80, s80, s79
    s_add_u32 s82, s81, s78
    s_add_u32 s81, s81, s98
    s_and_b32 s81, s81, 15
    s_lshr_b32 s83, s81, 3
    s_xor_b32 s81, s81, s83
    s_mul_i32 s81, s81, 192
    s_add_u32 s80, s80, s81
    s_or_b32 s81, s73, 3
    s_lshl_b32 s81, s81, 7
    v_add_u32 v5, s80, v0
    v_lshl_add_u32 v5, v5, 11, s81
    v_cmp_gt_u32 vcc, s79, v0
    s_nop 1
    v_cndmask_b32 v228, v228, v5, vcc
    s_cmp_ge_u32 s78, 2
    s_cbranch_scc1 LA_nh0
    s_add_u32 s82, s82, s98
    s_and_b32 s82, s82, 15
    s_lshr_b32 s83, s82, 3
    s_xor_b32 s82, s82, s83
    s_lshl_b32 s78, s82, 7
    s_lshl_b32 s79, s72, 7
    s_mul_i32 s80, s3, 36
    s_add_u32 s79, s79, s80
    s_sub_u32 s79, s79, 16
    v_add_u32 v5, s79, v0
    v_lshl_add_u32 v5, v5, 11, s78
    v_cmp_gt_u32 vcc, 36, v0
    s_nop 1
    v_cndmask_b32 v229, v229, v5, vcc
LA_nh0:
    buffer_load_dwordx4 v241, s[28:31], s97 offen offset:1024  lds
    s_mul_i32 s16, s97, 3072
    s_add_u32 m0, s60, 24576
    s_add_u32 s99, s16, s62
    buffer_load_dwordx4 v244, s[32:35], s99 offen offset:0  lds
    buffer_load_dwordx4 v245, s[32:35], s99 offen offset:1024  lds
    buffer_load_dwordx4 v246, s[32:35], s99 offen offset:2048  lds
    s_add_u32 m0, s87, 18432
    s_nop 0
    buffer_load_dwordx4 v242, s[28:31], s97 offen offset:2048  lds
    buffer_load_dwordx4 v243, s[28:31], s97 offen offset:3072  lds
    s_cmp_eq_u32 s101, 1
    s_cbranch_scc1 LA_c1
    s_cmp_eq_u32 s101, 2
    s_cbranch_scc1 LA_c2
    s_cmp_eq_u32 s101, 3
    s_cbranch_scc1 LA_c3
LA_c0:
    s_waitcnt vmcnt(7)
    s_barrier
    s_add_u32 m0, s88, 18432
    s_mov_b64 exec, 0xffffffff
    buffer_load_dwordx4 v3, s[28:31], s97 offen offset:0  lds
    s_mov_b64 exec, -1
    s_add_u32 m0, s61, 36864
    s_add_u32 s16, s16, s63
    buffer_load_dwordx4 v244, s[32:35], s16 offen offset:0  lds
    buffer_load_dwordx4 v245, s[32:35], s16 offen offset:1024  lds
    buffer_load_dwordx4 v246, s[32:35], s16 offen offset:2048  lds
    s_add_u32 s97, s98, s0
    s_lshr_b64 s[0:1], s[0:1], 4
    s_and_b32 s97, s97, 15
    s_lshr_b32 s99, s97, 3
    s_xor_b32 s97, s97, s99
    s_add_u32 m0, s87, 36864
    s_lshl_b32 s97, s97, 7
    buffer_load_dwordx4 v240, s[28:31], s97 offen offset:0  lds
    buffer_load_dwordx4 v241, s[28:31], s97 offen offset:1024  lds
    s_mul_i32 s16, s97, 3072
    s_add_u32 m0, s60, 49152
    s_add_u32 s99, s16, s62
    buffer_load_dwordx4 v244, s[32:35], s99 offen offset:0  lds
    buffer_load_dwordx4 v245, s[32:35], s99 offen offset:1024  lds
    buffer_load_dwordx4 v246, s[32:35], s99 offen offset:2048  lds
    s_add_u32 m0, s87, 36864
    s_nop 0
    buffer_load_dwordx4 v242, s[28:31], s97 offen offset:2048  lds
    buffer_load_dwordx4 v243, s[28:31], s97 offen offset:3072  lds
    s_add_u32 m0, s88, 36864
    s_mov_b64 exec, 0xffffffff
    buffer_load_dwordx4 v3, s[28:31], s97 offen offset:0  lds
    s_mov_b64 exec, -1
    s_add_u32 m0, s61, 61440
    s_add_u32 s16, s16, s63
    buffer_load_dwordx4 v244, s[32:35], s16 offen offset:0  lds
    buffer_load_dwordx4 v245, s[32:35], s16 offen offset:1024  lds
    buffer_load_dwordx4 v246, s[32:35], s16 offen offset:2048  lds
    s_waitcnt vmcnt(11)
    s_barrier
    s_add_u32 m0, s86, 129536
    s_mov_b32 s89, 0
    buffer_load_dwordx4 v10, s[36:39], s89 offen nt lds
    s_add_u32 m0, s86, 145920
    s_mov_b32 s89, 0
    buffer_load_dwordx4 v10, s[40:43], s89 offen nt lds
    s_add_u32 m0, s86, 133632
    s_mov_b32 s89, 65536
    buffer_load_dwordx4 v10, s[36:39], s89 offen nt lds
    s_add_u32 m0, s86, 150016
    s_mov_b32 s89, 65536
    buffer_load_dwordx4 v10, s[40:43], s89 offen nt lds
    s_add_u32 m0, s86, 137728
    s_mov_b32 s89, 131072
    buffer_load_dwordx4 v10, s[36:39], s89 offen nt lds
    s_add_u32 m0, s86, 154112
    s_mov_b32 s89, 131072
    buffer_load_dwordx4 v10, s[40:43], s89 offen nt lds
    s_add_u32 m0, s86, 141824
    s_mov_b32 s89, 196608
    buffer_load_dwordx4 v10, s[36:39], s89 offen nt lds
    s_add_u32 m0, s86, 158208
    s_mov_b32 s89, 196608
    buffer_load_dwordx4 v10, s[40:43], s89 offen nt lds
    s_mov_b64 exec, 0xff
    s_lshl_b32 s82, s3, 7
    s_add_u32 m0, s82, 129024
    s_mov_b32 s89, 0
    buffer_load_dwordx4 v11, s[36:39], s89 offen nt lds
    s_lshl_b32 s83, s74, 9
    s_add_u32 s83, s83, s82
    s_and_b32 s89, s3, 2
    s_lshl_b32 s89, s89, 3
    s_add_u32 s82, s82, s89
    s_add_u32 m0, s82, 162816
    s_add_u32 s89, s83, 0
    buffer_load_dwordx4 v15, s[44:47], s89 offen  lds
    s_mov_b64 exec, -1
    s_add_u32 s97, s98, s0
    s_lshr_b64 s[0:1], s[0:1], 4
    s_and_b32 s97, s97, 15
    s_lshr_b32 s99, s97, 3
    s_xor_b32 s97, s97, s99
    s_add_u32 m0, s87, 0
    s_lshl_b32 s97, s97, 7
    buffer_load_dwordx4 v240, s[28:31], s97 offen offset:0  lds
    buffer_load_dwordx4 v241, s[28:31], s97 offen offset:1024  lds
    s_mul_i32 s16, s97, 3072
    s_add_u32 m0, s60, 0
    s_add_u32 s99, s16, s62
    buffer_load_dwordx4 v244, s[32:35], s99 offen offset:0  lds
    buffer_load_dwordx4 v245, s[32:35], s99 offen offset:1024  lds
    buffer_load_dwordx4 v246, s[32:35], s99 offen offset:2048  lds
    s_add_u32 m0, s87, 0
    s_nop 0
    buffer_load_dwordx4 v242, s[28:31], s97 offen offset:2048  lds
    buffer_load_dwordx4 v243, s[28:31], s97 offen offset:3072  lds
    s_waitcnt vmcnt(17)
    s_barrier
    s_add_u32 m0, s88, 0
    s_mov_b64 exec, 0xffffffff
    buffer_load_dwordx4 v3, s[28:31], s97 offen offset:0  lds
    s_mov_b64 exec, -1
    s_add_u32 m0, s61, 12288
    s_add_u32 s16, s16, s63
    buffer_load_dwordx4 v244, s[32:35], s16 offen offset:0  lds
    buffer_load_dwordx4 v245, s[32:35], s16 offen offset:1024  lds
    buffer_load_dwordx4 v246, s[32:35], s16 offen offset:2048  lds
    buffer_load_dword v230, v229, s[4:7], 0 offen
    buffer_load_dword v230, v228, s[32:35], 0 offen
    s_add_u32 s97, s98, s0
    s_lshr_b64 s[0:1], s[0:1], 4
    s_and_b32 s97, s97, 15
    s_lshr_b32 s99, s97, 3
    s_xor_b32 s97, s97, s99
    s_add_u32 m0, s87, 18432
    s_lshl_b32 s97, s97, 7
    buffer_load_dwordx4 v240, s[28:31], s97 offen offset:0  lds
    buffer_load_dwordx4 v241, s[28:31], s97 offen offset:1024  lds
    s_mul_i32 s16, s97, 3072
    s_add_u32 m0, s60, 24576
    s_add_u32 s99, s16, s62
    buffer_load_dwordx4 v244, s[32:35], s99 offen offset:0  lds
    buffer_load_dwordx4 v245, s[32:35], s99 offen offset:1024  lds
    buffer_load_dwordx4 v246, s[32:35], s99 offen offset:2048  lds
    s_add_u32 m0, s87, 18432
    s_nop 0
    buffer_load_dwordx4 v242, s[28:31], s97 offen offset:2048  lds
    buffer_load_dwordx4 v243, s[28:31], s97 offen offset:3072  lds
    s_add_u32 m0, s88, 18432
    s_mov_b64 exec, 0xffffffff
    buffer_load_dwordx4 v3, s[28:31], s97 offen offset:0  lds
    s_mov_b64 exec, -1
    s_add_u32 m0, s61, 36864
    s_add_u32 s16, s16, s63
    buffer_load_dwordx4 v244, s[32:35], s16 offen offset:0  lds
    buffer_load_dwordx4 v245, s[32:35], s16 offen offset:1024  lds
    s_waitcnt vmcnt(12)
    s_barrier
    buffer_load_dwordx4 v246, s[32:35], s16 offen offset:2048  lds
    ds_read_b128 v[84:87], v35 offset:0
    ds_read_b128 v[88:91], v35 offset:16
    s_add_u32 s97, s98, s0
    s_lshr_b64 s[0:1], s[0:1], 4
    s_and_b32 s97, s97, 15
    s_lshr_b32 s99, s97, 3
    s_xor_b32 s97, s97, s99
    s_add_u32 m0, s87, 36864
    s_lshl_b32 s97, s97, 7
    buffer_load_dwordx4 v240, s[28:31], s97 offen offset:0  lds
    ds_read_b64 v[40:41], v16 offset:0
    ds_read_b64 v[42:43], v231 offset:256
    buffer_load_dwordx4 v241, s[28:31], s97 offen offset:1024  lds
    ds_read_b64 v[44:45], v16 offset:256
    ds_read_b64 v[46:47], v16 offset:512
    s_mul_i32 s16, s97, 3072
    s_add_u32 m0, s60, 49152
    s_add_u32 s99, s16, s62
    buffer_load_dwordx4 v244, s[32:35], s99 offen offset:0  lds
    ds_read_b64 v[48:49], v231 offset:512
    buffer_load_dwordx4 v245, s[32:35], s99 offen offset:1024  lds
    ds_read_b64 v[50:51], v16 offset:768
    ds_read_b64 v[52:53], v231 offset:768
    buffer_load_dwordx4 v246, s[32:35], s99 offen offset:2048  lds
    ds_read_b64 v[54:55], v16 offset:1024
    ds_read_b64 v[56:57], v231 offset:1024
    s_add_u32 m0, s87, 36864
    s_nop 0
    buffer_load_dwordx4 v242, s[28:31], s97 offen offset:2048  lds
    ds_read_b64 v[58:59], v16 offset:1280
    ds_read_b64 v[60:61], v231 offset:1280
    buffer_load_dwordx4 v243, s[28:31], s97 offen offset:3072  lds
    ds_read_b64 v[68:69], v16 offset:16896
    s_add_u32 m0, s88, 36864
    s_mov_b64 exec, 0xffffffff
    buffer_load_dwordx4 v3, s[28:31], s97 offen offset:0  lds
    s_mov_b64 exec, -1
    ds_read_b64 v[70:71], v231 offset:16896
    ds_read_b64 v[72:73], v16 offset:17152
    s_add_u32 m0, s61, 61440
    s_add_u32 s16, s16, s63
    buffer_load_dwordx4 v244, s[32:35], s16 offen offset:0  lds
    ds_read_b64 v[74:75], v231 offset:17152
    ds_read_b64 v[76:77], v16 offset:17408
    buffer_load_dwordx4 v245, s[32:35], s16 offen offset:1024  lds
    ds_read_b64 v[78:79], v231 offset:17408
    ds_read_b64 v[80:81], v16 offset:17664
    buffer_load_dwordx4 v246, s[32:35], s16 offen offset:2048  lds
    ds_read_b64 v[82:83], v231 offset:17664
    s_waitcnt vmcnt(11)
    s_waitcnt lgkmcnt(0)
    s_barrier
    s_add_u32 s97, s98, s0
    s_lshr_b64 s[0:1], s[0:1], 4
    s_and_b32 s97, s97, 15
    s_lshr_b32 s99, s97, 3
    s_xor_b32 s97, s97, s99
    s_add_u32 m0, s87, 0
    s_lshl_b32 s97, s97, 7
    buffer_load_dwordx4 v240, s[28:31], s97 offen offset:0  lds
    v_lshlrev_b32 v160, 16, v40
    v_lshlrev_b32 v161, 16, v42
    v_lshlrev_b32 v162, 16, v44
    v_lshlrev_b32 v163, 16, v46
    v_lshlrev_b32 v164, 16, v48
    buffer_load_dwordx4 v241, s[28:31], s97 offen offset:1024  lds
    v_lshlrev_b32 v165, 16, v50
    v_lshlrev_b32 v166, 16, v52
    v_lshlrev_b32 v167, 16, v54
    v_lshlrev_b32 v168, 16, v56
    v_lshlrev_b32 v169, 16, v58
    s_mul_i32 s16, s97, 3072
    s_add_u32 m0, s60, 0
    s_add_u32 s99, s16, s62
    buffer_load_dwordx4 v244, s[32:35], s99 offen offset:0  lds
    v_lshlrev_b32 v170, 16, v60
    v_lshlrev_b32 v172, 16, v84
    v_and_b32 v173, 0xffff0000, v84
    v_lshlrev_b32 v174, 16, v85
    v_and_b32 v175, 0xffff0000, v85
    buffer_load_dwordx4 v245, s[32:35], s99 offen offset:1024  lds
    v_lshlrev_b32 v176, 16, v68
    v_lshlrev_b32 v177, 16, v70
    v_lshlrev_b32 v178, 16, v72
    v_lshlrev_b32 v179, 16, v74
    v_lshlrev_b32 v180, 16, v76
    buffer_load_dwordx4 v246, s[32:35], s99 offen offset:2048  lds
    v_lshlrev_b32 v181, 16, v78
    v_lshlrev_b32 v182, 16, v80
    v_lshlrev_b32 v183, 16, v82
    v_mul_f32 v184, v160, v175
    v_mul_f32 v185, v161, v175
    s_add_u32 m0, s87, 0
    s_nop 0
    buffer_load_dwordx4 v242, s[28:31], s97 offen offset:2048  lds
    v_mul_f32 v186, v162, v175
    v_mul_f32 v187, v163, v175
    v_mul_f32 v188, v164, v175
    v_mul_f32 v189, v165, v175
    v_mul_f32 v190, v166, v175
    buffer_load_dwordx4 v243, s[28:31], s97 offen offset:3072  lds
    v_mul_f32 v191, v167, v175
    v_fmac_f32 v184, v161, v174
    v_fmac_f32 v185, v162, v174
    v_fmac_f32 v186, v163, v174
    v_fmac_f32 v187, v164, v174
    s_add_u32 m0, s88, 0
    s_mov_b64 exec, 0xffffffff
    buffer_load_dwordx4 v3, s[28:31], s97 offen offset:0  lds
    s_mov_b64 exec, -1
    v_fmac_f32 v188, v165, v174
    v_fmac_f32 v189, v166, v174
    v_fmac_f32 v190, v167, v174
    v_fmac_f32 v191, v168, v174
    v_fmac_f32 v184, v162, v173
    s_add_u32 m0, s61, 12288
    s_add_u32 s16, s16, s63
    buffer_load_dwordx4 v244, s[32:35], s16 offen offset:0  lds
    v_fmac_f32 v185, v163, v173
    v_fmac_f32 v186, v164, v173
    v_fmac_f32 v187, v165, v173
    v_fmac_f32 v188, v166, v173
    v_fmac_f32 v189, v167, v173
    buffer_load_dwordx4 v245, s[32:35], s16 offen offset:1024  lds
    v_fmac_f32 v190, v168, v173
    v_fmac_f32 v191, v169, v173
    v_fmac_f32 v184, v163, v172
    v_fmac_f32 v185, v164, v172
    v_fmac_f32 v186, v165, v172
    buffer_load_dwordx4 v246, s[32:35], s16 offen offset:2048  lds
    v_fmac_f32 v187, v166, v172
    v_fmac_f32 v188, v167, v172
    v_fmac_f32 v189, v168, v172
    v_fmac_f32 v190, v169, v172
    v_fmac_f32 v191, v170, v172
    v_mul_f32 v184, v184, v176
    v_mul_f32 v185, v185, v177
    v_mul_f32 v186, v186, v178
    v_mul_f32 v187, v187, v179
    v_mul_f32 v188, v188, v180
    v_mul_f32 v189, v189, v181
    v_mul_f32 v190, v190, v182
    v_mul_f32 v191, v191, v183
    v_cvt_pk_bf16_f32 v100, v191, v190
    v_cvt_pk_bf16_f32 v101, v189, v188
    v_cvt_pk_bf16_f32 v102, v187, v186
    v_cvt_pk_bf16_f32 v103, v185, v184
    s_mov_b32 s89, 0
    buffer_store_dwordx4 v[100:103], v12, s[52:55], s89 offen sc1
    s_waitcnt vmcnt(12)
    s_barrier
    s_add_u32 s97, s98, s0
    s_lshr_b64 s[0:1], s[0:1], 4
    s_and_b32 s97, s97, 15
    s_lshr_b32 s99, s97, 3
    s_xor_b32 s97, s97, s99
    s_add_u32 m0, s87, 18432
    s_lshl_b32 s97, s97, 7
    buffer_load_dwordx4 v240, s[28:31], s97 offen offset:0  lds
    v_and_b32 v160, 0xffff0000, v40
    v_and_b32 v161, 0xffff0000, v42
    v_and_b32 v162, 0xffff0000, v44
    v_and_b32 v163, 0xffff0000, v46
    v_and_b32 v164, 0xffff0000, v48
    buffer_load_dwordx4 v241, s[28:31], s97 offen offset:1024  lds
    v_and_b32 v165, 0xffff0000, v50
    v_and_b32 v166, 0xffff0000, v52
    v_and_b32 v167, 0xffff0000, v54
    v_and_b32 v168, 0xffff0000, v56
    v_and_b32 v169, 0xffff0000, v58
    s_mul_i32 s16, s97, 3072
    s_add_u32 m0, s60, 24576
    s_add_u32 s99, s16, s62
    buffer_load_dwordx4 v244, s[32:35], s99 offen offset:0  lds
    v_and_b32 v170, 0xffff0000, v60
    v_lshlrev_b32 v172, 16, v86
    v_and_b32 v173, 0xffff0000, v86
    v_lshlrev_b32 v174, 16, v87
    v_and_b32 v175, 0xffff0000, v87
    buffer_load_dwordx4 v245, s[32:35], s99 offen offset:1024  lds
    v_and_b32 v176, 0xffff0000, v68
    v_and_b32 v177, 0xffff0000, v70
    v_and_b32 v178, 0xffff0000, v72
    v_and_b32 v179, 0xffff0000, v74
    v_and_b32 v180, 0xffff0000, v76
    buffer_load_dwordx4 v246, s[32:35], s99 offen offset:2048  lds
    v_and_b32 v181, 0xffff0000, v78
    v_and_b32 v182, 0xffff0000, v80
    v_and_b32 v183, 0xffff0000, v82
    v_mul_f32 v184, v160, v175
    v_mul_f32 v185, v161, v175
    s_add_u32 m0, s87, 18432
    s_nop 0
    buffer_load_dwordx4 v242, s[28:31], s97 offen offset:2048  lds
    v_mul_f32 v186, v162, v175
    v_mul_f32 v187, v163, v175
    v_mul_f32 v188, v164, v175
    v_mul_f32 v189, v165, v175
    v_mul_f32 v190, v166, v175
    buffer_load_dwordx4 v243, s[28:31], s97 offen offset:3072  lds
    v_mul_f32 v191, v167, v175
    v_fmac_f32 v184, v161, v174
    v_fmac_f32 v185, v162, v174
    v_fmac_f32 v186, v163, v174
    v_fmac_f32 v187, v164, v174
    s_add_u32 m0, s88, 18432
    s_mov_b64 exec, 0xffffffff
    buffer_load_dwordx4 v3, s[28:31], s97 offen offset:0  lds
    s_mov_b64 exec, -1
    v_fmac_f32 v188, v165, v174
    v_fmac_f32 v189, v166, v174
    v_fmac_f32 v190, v167, v174
    v_fmac_f32 v191, v168, v174
    v_fmac_f32 v184, v162, v173
    s_add_u32 m0, s61, 36864
    s_add_u32 s16, s16, s63
    buffer_load_dwordx4 v244, s[32:35], s16 offen offset:0  lds
    v_fmac_f32 v185, v163, v173
    v_fmac_f32 v186, v164, v173
    v_fmac_f32 v187, v165, v173
    v_fmac_f32 v188, v166, v173
    v_fmac_f32 v189, v167, v173
    buffer_load_dwordx4 v245, s[32:35], s16 offen offset:1024  lds
    v_fmac_f32 v190, v168, v173
    v_fmac_f32 v191, v169, v173
    v_fmac_f32 v184, v163, v172
    v_fmac_f32 v185, v164, v172
    v_fmac_f32 v186, v165, v172
    buffer_load_dwordx4 v246, s[32:35], s16 offen offset:2048  lds
    v_fmac_f32 v187, v166, v172
    v_fmac_f32 v188, v167, v172
    v_fmac_f32 v189, v168, v172
    v_fmac_f32 v190, v169, v172
    v_fmac_f32 v191, v170, v172
    v_mul_f32 v184, v184, v176
    v_mul_f32 v185, v185, v177
    v_mul_f32 v186, v186, v178
    v_mul_f32 v187, v187, v179
    v_mul_f32 v188, v188, v180
    v_mul_f32 v189, v189, v181
    v_mul_f32 v190, v190, v182
    v_mul_f32 v191, v191, v183
    v_cvt_pk_bf16_f32 v104, v191, v190
    v_cvt_pk_bf16_f32 v105, v189, v188
    v_cvt_pk_bf16_f32 v106, v187, v186
    v_cvt_pk_bf16_f32 v107, v185, v184
    s_mov_b32 s89, 16384
    buffer_store_dwordx4 v[104:107], v12, s[52:55], s89 offen sc1
    s_waitcnt vmcnt(13)
    s_barrier
    s_add_u32 s97, s98, s0
    s_lshr_b64 s[0:1], s[0:1], 4
    s_and_b32 s97, s97, 15
    s_lshr_b32 s99, s97, 3
    s_xor_b32 s97, s97, s99
    s_add_u32 m0, s87, 36864
    s_lshl_b32 s97, s97, 7
    buffer_load_dwordx4 v240, s[28:31], s97 offen offset:0  lds
    v_lshlrev_b32 v160, 16, v41
    v_lshlrev_b32 v161, 16, v43
    v_lshlrev_b32 v162, 16, v45
    v_lshlrev_b32 v163, 16, v47
    v_lshlrev_b32 v164, 16, v49
    buffer_load_dwordx4 v241, s[28:31], s97 offen offset:1024  lds
    v_lshlrev_b32 v165, 16, v51
    v_lshlrev_b32 v166, 16, v53
    v_lshlrev_b32 v167, 16, v55
    v_lshlrev_b32 v168, 16, v57
    v_lshlrev_b32 v169, 16, v59
    s_mul_i32 s16, s97, 3072
    s_add_u32 m0, s60, 49152
    s_add_u32 s99, s16, s62
    buffer_load_dwordx4 v244, s[32:35], s99 offen offset:0  lds
    v_lshlrev_b32 v170, 16, v61
    v_lshlrev_b32 v172, 16, v88
    v_and_b32 v173, 0xffff0000, v88
    v_lshlrev_b32 v174, 16, v89
    v_and_b32 v175, 0xffff0000, v89
    buffer_load_dwordx4 v245, s[32:35], s99 offen offset:1024  lds
    v_lshlrev_b32 v176, 16, v69
    v_lshlrev_b32 v177, 16, v71
    v_lshlrev_b32 v178, 16, v73
    v_lshlrev_b32 v179, 16, v75
    v_lshlrev_b32 v180, 16, v77
    buffer_load_dwordx4 v246, s[32:35], s99 offen offset:2048  lds
    v_lshlrev_b32 v181, 16, v79
    v_lshlrev_b32 v182, 16, v81
    v_lshlrev_b32 v183, 16, v83
    v_mul_f32 v184, v160, v175
    v_mul_f32 v185, v161, v175
    s_add_u32 m0, s87, 36864
    s_nop 0
    buffer_load_dwordx4 v242, s[28:31], s97 offen offset:2048  lds
    v_mul_f32 v186, v162, v175
    v_mul_f32 v187, v163, v175
    v_mul_f32 v188, v164, v175
    v_mul_f32 v189, v165, v175
    v_mul_f32 v190, v166, v175
    buffer_load_dwordx4 v243, s[28:31], s97 offen offset:3072  lds
    v_mul_f32 v191, v167, v175
    v_fmac_f32 v184, v161, v174
    v_fmac_f32 v185, v162, v174
    v_fmac_f32 v186, v163, v174
    v_fmac_f32 v187, v164, v174
    s_add_u32 m0, s88, 36864
    s_mov_b64 exec, 0xffffffff
    buffer_load_dwordx4 v3, s[28:31], s97 offen offset:0  lds
    s_mov_b64 exec, -1
    v_fmac_f32 v188, v165, v174
    v_fmac_f32 v189, v166, v174
    v_fmac_f32 v190, v167, v174
    v_fmac_f32 v191, v168, v174
    v_fmac_f32 v184, v162, v173
    s_add_u32 m0, s61, 61440
    s_add_u32 s16, s16, s63
    buffer_load_dwordx4 v244, s[32:35], s16 offen offset:0  lds
    v_fmac_f32 v185, v163, v173
    v_fmac_f32 v186, v164, v173
    v_fmac_f32 v187, v165, v173
    v_fmac_f32 v188, v166, v173
    v_fmac_f32 v189, v167, v173
    buffer_load_dwordx4 v245, s[32:35], s16 offen offset:1024  lds
    v_fmac_f32 v190, v168, v173
    v_fmac_f32 v191, v169, v173
    v_fmac_f32 v184, v163, v172
    v_fmac_f32 v185, v164, v172
    v_fmac_f32 v186, v165, v172
    buffer_load_dwordx4 v246, s[32:35], s16 offen offset:2048  lds
    v_fmac_f32 v187, v166, v172
    v_fmac_f32 v188, v167, v172
    v_fmac_f32 v189, v168, v172
    v_fmac_f32 v190, v169, v172
    v_fmac_f32 v191, v170, v172
    v_mul_f32 v184, v184, v176
    v_mul_f32 v185, v185, v177
    v_mul_f32 v186, v186, v178
    v_mul_f32 v187, v187, v179
    v_mul_f32 v188, v188, v180
    v_mul_f32 v189, v189, v181
    v_mul_f32 v190, v190, v182
    v_mul_f32 v191, v191, v183
    v_cvt_pk_bf16_f32 v108, v191, v190
    v_cvt_pk_bf16_f32 v109, v189, v188
    v_cvt_pk_bf16_f32 v110, v187, v186
    v_cvt_pk_bf16_f32 v111, v185, v184
    s_mov_b32 s89, 32768
    buffer_store_dwordx4 v[108:111], v12, s[52:55], s89 offen sc1
    s_waitcnt vmcnt(13)
    s_barrier
    s_add_u32 s97, s98, s0
    s_lshr_b64 s[0:1], s[0:1], 4
    s_and_b32 s97, s97, 15
    s_lshr_b32 s99, s97, 3
    s_xor_b32 s97, s97, s99
    s_add_u32 m0, s87, 0
    s_lshl_b32 s97, s97, 7
    buffer_load_dwordx4 v240, s[28:31], s97 offen offset:0  lds
    v_and_b32 v160, 0xffff0000, v41
    v_and_b32 v161, 0xffff0000, v43
    v_and_b32 v162, 0xffff0000, v45
    v_and_b32 v163, 0xffff0000, v47
    v_and_b32 v164, 0xffff0000, v49
    buffer_load_dwordx4 v241, s[28:31], s97 offen offset:1024  lds
    v_and_b32 v165, 0xffff0000, v51
    v_and_b32 v166, 0xffff0000, v53
    v_and_b32 v167, 0xffff0000, v55
    v_and_b32 v168, 0xffff0000, v57
    v_and_b32 v169, 0xffff0000, v59
    s_mul_i32 s16, s97, 3072
    s_add_u32 m0, s60, 0
    s_add_u32 s99, s16, s62
    buffer_load_dwordx4 v244, s[32:35], s99 offen offset:0  lds
    v_and_b32 v170, 0xffff0000, v61
    v_lshlrev_b32 v172, 16, v90
    v_and_b32 v173, 0xffff0000, v90
    v_lshlrev_b32 v174, 16, v91
    v_and_b32 v175, 0xffff0000, v91
    buffer_load_dwordx4 v245, s[32:35], s99 offen offset:1024  lds
    v_and_b32 v176, 0xffff0000, v69
    v_and_b32 v177, 0xffff0000, v71
    v_and_b32 v178, 0xffff0000, v73
    v_and_b32 v179, 0xffff0000, v75
    v_and_b32 v180, 0xffff0000, v77
    buffer_load_dwordx4 v246, s[32:35], s99 offen offset:2048  lds
    v_and_b32 v181, 0xffff0000, v79
    v_and_b32 v182, 0xffff0000, v81
    v_and_b32 v183, 0xffff0000, v83
    v_mul_f32 v184, v160, v175
    v_mul_f32 v185, v161, v175
    s_add_u32 m0, s87, 0
    s_nop 0
    buffer_load_dwordx4 v242, s[28:31], s97 offen offset:2048  lds
    v_mul_f32 v186, v162, v175
    v_mul_f32 v187, v163, v175
    v_mul_f32 v188, v164, v175
    v_mul_f32 v189, v165, v175
    v_mul_f32 v190, v166, v175
    buffer_load_dwordx4 v243, s[28:31], s97 offen offset:3072  lds
    v_mul_f32 v191, v167, v175
    v_fmac_f32 v184, v161, v174
    v_fmac_f32 v185, v162, v174
    v_fmac_f32 v186, v163, v174
    v_fmac_f32 v187, v164, v174
    s_add_u32 m0, s88, 0
    s_mov_b64 exec, 0xffffffff
    buffer_load_dwordx4 v3, s[28:31], s97 offen offset:0  lds
    s_mov_b64 exec, -1
    v_fmac_f32 v188, v165, v174
    v_fmac_f32 v189, v166, v174
    v_fmac_f32 v190, v167, v174
    v_fmac_f32 v191, v168, v174
    v_fmac_f32 v184, v162, v173
    s_add_u32 m0, s61, 12288
    s_add_u32 s16, s16, s63
    buffer_load_dwordx4 v244, s[32:35], s16 offen offset:0  lds
    v_fmac_f32 v185, v163, v173
    v_fmac_f32 v186, v164, v173
    v_fmac_f32 v187, v165, v173
    v_fmac_f32 v188, v166, v173
    v_fmac_f32 v189, v167, v173
    buffer_load_dwordx4 v245, s[32:35], s16 offen offset:1024  lds
    v_fmac_f32 v190, v168, v173
    v_fmac_f32 v191, v169, v173
    v_fmac_f32 v184, v163, v172
    v_fmac_f32 v185, v164, v172
    v_fmac_f32 v186, v165, v172
    buffer_load_dwordx4 v246, s[32:35], s16 offen offset:2048  lds
    v_fmac_f32 v187, v166, v172
    v_fmac_f32 v188, v167, v172
    v_fmac_f32 v189, v168, v172
    v_fmac_f32 v190, v169, v172
    v_fmac_f32 v191, v170, v172
    v_mul_f32 v184, v184, v176
    v_mul_f32 v185, v185, v177
    v_mul_f32 v186, v186, v178
    v_mul_f32 v187, v187, v179
    v_mul_f32 v188, v188, v180
    v_mul_f32 v189, v189, v181
    v_mul_f32 v190, v190, v182
    v_mul_f32 v191, v191, v183
    v_cvt_pk_bf16_f32 v112, v191, v190
    v_cvt_pk_bf16_f32 v113, v189, v188
    v_cvt_pk_bf16_f32 v114, v187, v186
    v_cvt_pk_bf16_f32 v115, v185, v184
    s_mov_b32 s89, 49152
    buffer_store_dwordx4 v[112:115], v12, s[52:55], s89 offen sc1
    s_waitcnt vmcnt(13)
    s_barrier
    s_add_u32 s97, s98, s0
    s_lshr_b64 s[0:1], s[0:1], 4
    s_and_b32 s97, s97, 15
    s_lshr_b32 s99, s97, 3
    s_xor_b32 s97, s97, s99
    s_add_u32 m0, s87, 18432
    s_lshl_b32 s97, s97, 7
    buffer_load_dwordx4 v240, s[28:31], s97 offen offset:0  lds
    buffer_load_dwordx4 v241, s[28:31], s97 offen offset:1024  lds
    s_mul_i32 s16, s97, 3072
    s_add_u32 m0, s60, 24576
    s_add_u32 s99, s16, s62
    buffer_load_dwordx4 v244, s[32:35], s99 offen offset:0  lds
    buffer_load_dwordx4 v245, s[32:35], s99 offen offset:1024  lds
    buffer_load_dwordx4 v246, s[32:35], s99 offen offset:2048  lds
    s_add_u32 m0, s87, 18432
    s_nop 0
    buffer_load_dwordx4 v242, s[28:31], s97 offen offset:2048  lds
    buffer_load_dwordx4 v243, s[28:31], s97 offen offset:3072  lds
    s_add_u32 m0, s88, 18432
    s_mov_b64 exec, 0xffffffff
    buffer_load_dwordx4 v3, s[28:31], s97 offen offset:0  lds
    s_mov_b64 exec, -1
    s_add_u32 m0, s61, 36864
    s_add_u32 s16, s16, s63
    buffer_load_dwordx4 v244, s[32:35], s16 offen offset:0  lds
    buffer_load_dwordx4 v245, s[32:35], s16 offen offset:1024  lds
    buffer_load_dwordx4 v246, s[32:35], s16 offen offset:2048  lds
    s_waitcnt vmcnt(12)
    s_barrier
    s_add_u32 s97, s98, s0
    s_lshr_b64 s[0:1], s[0:1], 4
    s_and_b32 s97, s97, 15
    s_lshr_b32 s99, s97, 3
    s_xor_b32 s97, s97, s99
    s_add_u32 m0, s87, 36864
    s_lshl_b32 s97, s97, 7
    buffer_load_dwordx4 v240, s[28:31], s97 offen offset:0  lds
    buffer_load_dwordx4 v241, s[28:31], s97 offen offset:1024  lds
    s_mul_i32 s16, s97, 3072
    s_add_u32 m0, s60, 49152
    s_add_u32 s99, s16, s62
    buffer_load_dwordx4 v244, s[32:35], s99 offen offset:0  lds
    buffer_load_dwordx4 v245, s[32:35], s99 offen offset:1024  lds
    buffer_load_dwordx4 v246, s[32:35], s99 offen offset:2048  lds
    s_add_u32 m0, s87, 36864
    s_nop 0
    buffer_load_dwordx4 v242, s[28:31], s97 offen offset:2048  lds
    buffer_load_dwordx4 v243, s[28:31], s97 offen offset:3072  lds
    s_add_u32 m0, s88, 36864
    s_mov_b64 exec, 0xffffffff
    buffer_load_dwordx4 v3, s[28:31], s97 offen offset:0  lds
    s_mov_b64 exec, -1
    s_add_u32 m0, s61, 61440
    s_add_u32 s16, s16, s63
    buffer_load_dwordx4 v244, s[32:35], s16 offen offset:0  lds
    buffer_load_dwordx4 v245, s[32:35], s16 offen offset:1024  lds
    buffer_load_dwordx4 v246, s[32:35], s16 offen offset:2048  lds
    s_waitcnt vmcnt(11)
    s_barrier
    s_add_u32 m0, s94, 32
    s_lshl_b32 s89, s90, 12
    buffer_load_dwordx4 v15, s[48:51], s89 offen offset:0 nt lds
    s_mov_b32 s68, s24
    s_mov_b32 s69, s25
    s_mov_b32 s70, 0x100
    s_mov_b32 s71, 0x20000
    s_add_u32 m0, s94, 32
    s_lshl_b32 s89, s90, 12
    buffer_load_dwordx4 v15, s[48:51], s89 offen offset:1024 nt lds
    v_lshrrev_b32 v6, 5, v0
    v_and_b32 v7, 3, v0
    s_lshr_b32 s78, s90, 1
    s_add_u32 m0, s94, 32
    s_lshl_b32 s89, s90, 12
    buffer_load_dwordx4 v15, s[48:51], s89 offen offset:2048 nt lds
    s_lshl_b32 s78, s78, 2
    s_load_dword s92, s[14:15], s78
    v_bfe_u32 v5, v0, 2, 2
    v_lshlrev_b32 v5, 1, v5
    s_add_u32 m0, s94, 32
    s_lshl_b32 s89, s90, 12
    buffer_load_dwordx4 v15, s[48:51], s89 offen offset:3072 nt lds
    v_lshl_add_u32 v5, v6, 3, v5
    v_bfe_u32 v8, v0, 4, 1
    v_add_u32 v5, v5, v8
    s_add_u32 s97, s98, s0
    s_lshr_b64 s[0:1], s[0:1], 4
    s_and_b32 s97, s97, 15
    s_lshr_b32 s99, s97, 3
    s_xor_b32 s97, s97, s99
    s_add_u32 m0, s87, 0
    s_lshl_b32 s97, s97, 7
    buffer_load_dwordx4 v240, s[28:31], s97 offen offset:0  lds
    s_and_b32 s78, s3, 1
    s_lshl_b32 s78, s78, 1
    v_add_u32 v8, s78, v6
    v_xor_b32 v8, v8, v7
    buffer_load_dwordx4 v241, s[28:31], s97 offen offset:1024  lds
    v_lshlrev_b32 v8, 4, v8
    v_lshl_add_u32 v5, v5, 6, v8
    v_add_u32 v14, s86, v5
    s_mul_i32 s16, s97, 3072
    s_add_u32 m0, s60, 0
    s_add_u32 s99, s16, s62
    buffer_load_dwordx4 v244, s[32:35], s99 offen offset:0  lds
    v_mov_b32 v18, 162304
    v_mov_b32 v19, 1
    v_and_b32 v5, 3, v0
    s_lshl_b32 s78, s74, 4
    buffer_load_dwordx4 v245, s[32:35], s99 offen offset:1024  lds
    s_add_u32 s78, s78, s3
    v_lshl_add_u32 v6, v5, 2, s78
    s_lshr_b32 s78, s76, 3
    buffer_load_dwordx4 v246, s[32:35], s99 offen offset:2048  lds
    s_lshl_b32 s79, s3, 1
    s_add_u32 s78, s78, s79
    s_xor_b32 s78, s78, 2
    s_lshl_b32 s78, s78, 5
    s_add_u32 m0, s87, 0
    s_nop 0
    buffer_load_dwordx4 v242, s[28:31], s97 offen offset:2048  lds
    s_and_b32 s79, s76, 7
    s_add_u32 s78, s78, s79
    v_lshl_add_u32 v7, v5, 3, s78
    buffer_load_dwordx4 v243, s[28:31], s97 offen offset:3072  lds
    v_and_b32 v8, 4, v0
    v_cmp_eq_u32 vcc, 0, v8
    s_nop 1
    v_cndmask_b32 v6, v7, v6, vcc
    v_and_b32 v33, 0xf0, v6
    s_add_u32 m0, s88, 0
    s_mov_b64 exec, 0xffffffff
    buffer_load_dwordx4 v3, s[28:31], s97 offen offset:0  lds
    s_mov_b64 exec, -1
    v_lshlrev_b32 v34, 8, v6
    v_add_u32 v34, 12582912, v34
    v_and_b32 v5, 15, v0
    s_add_u32 m0, s61, 12288
    s_add_u32 s16, s16, s63
    buffer_load_dwordx4 v244, s[32:35], s16 offen offset:0  lds
    v_lshrrev_b32 v6, 4, v0
    v_add_u32 v7, 9, v5
    v_and_b32 v8, 1, v7
    v_mul_u32_u24 v8, 4160, v8
    buffer_load_dwordx4 v245, s[32:35], s16 offen offset:1024  lds
    v_lshrrev_b32 v7, 1, v7
    v_lshl_add_u32 v8, v7, 2, v8
    v_lshlrev_b32 v7, 4, v6
    buffer_load_dwordx4 v246, s[32:35], s16 offen offset:2048  lds
    v_sub_u32 v8, v8, v7
    s_add_u32 s78, s94, 32
    v_add_u32 v21, s78, v8
    s_waitcnt vmcnt(15)
    s_barrier
    s_add_u32 s97, s98, s0
    s_lshr_b64 s[0:1], s[0:1], 4
    s_and_b32 s97, s97, 15
    s_lshr_b32 s99, s97, 3
    s_xor_b32 s97, s97, s99
    s_add_u32 m0, s87, 18432
    s_lshl_b32 s97, s97, 7
    buffer_load_dwordx4 v240, s[28:31], s97 offen offset:0  lds
    v_add_u32 v22, 1024, v21
    v_add_u32 v23, 2048, v21
    v_add_u32 v24, 3072, v21
    v_lshl_add_u32 v7, v5, 1, v6
    v_add_u32 v7, 30, v7
    buffer_load_dwordx4 v241, s[28:31], s97 offen offset:1024  lds
    v_and_b32 v8, 1, v7
    v_bfe_u32 v136, v7, 1, 2
    v_lshl_add_u32 v136, v8, 2, v136
    v_lshlrev_b32 v136, 6, v136
    v_lshrrev_b32 v7, 3, v7
    s_mul_i32 s16, s97, 3072
    s_add_u32 m0, s60, 24576
    s_add_u32 s99, s16, s62
    buffer_load_dwordx4 v244, s[32:35], s99 offen offset:0  lds
    v_lshl_add_u32 v136, v7, 9, v136
    v_bitop3_b32 v8, v7, 3, s3 bitop3:0x6a
    v_lshl_add_u32 v25, v8, 4, v136
    v_add_u32 v25, 92160, v25
    v_subrev_u32 v7, 1, v7
    buffer_load_dwordx4 v245, s[32:35], s99 offen offset:1024  lds
    v_bitop3_b32 v8, v7, 3, s3 bitop3:0x6a
    v_lshl_add_u32 v27, v8, 4, v136
    v_add_u32 v27, 91648, v27
    v_subrev_u32 v7, 1, v7
    buffer_load_dwordx4 v246, s[32:35], s99 offen offset:2048  lds
    v_bitop3_b32 v8, v7, 3, s3 bitop3:0x6a
    v_lshl_add_u32 v29, v8, 4, v136
    v_add_u32 v29, 91136, v29
    v_subrev_u32 v7, 1, v7
    v_bitop3_b32 v8, v7, 3, s3 bitop3:0x6a
    s_add_u32 m0, s87, 18432
    s_nop 0
    buffer_load_dwordx4 v242, s[28:31], s97 offen offset:2048  lds
    v_lshl_add_u32 v31, v8, 4, v136
    v_add_u32 v31, 90624, v31
    v_lshl_add_u32 v7, v5, 1, v6
    v_add_u32 v7, 26, v7
    v_and_b32 v8, 1, v7
    buffer_load_dwordx4 v243, s[28:31], s97 offen offset:3072  lds
    v_bfe_u32 v136, v7, 1, 2
    v_lshl_add_u32 v136, v8, 2, v136
    v_lshlrev_b32 v136, 6, v136
    v_lshrrev_b32 v7, 3, v7
    v_lshl_add_u32 v136, v7, 9, v136
    s_add_u32 m0, s88, 18432
    s_mov_b64 exec, 0xffffffff
    buffer_load_dwordx4 v3, s[28:31], s97 offen offset:0  lds
    s_mov_b64 exec, -1
    v_bitop3_b32 v8, v7, 3, s3 bitop3:0x6a
    v_lshl_add_u32 v26, v8, 4, v136
    v_add_u32 v26, 92160, v26
    v_subrev_u32 v7, 1, v7
    s_add_u32 m0, s61, 36864
    s_add_u32 s16, s16, s63
    buffer_load_dwordx4 v244, s[32:35], s16 offen offset:0  lds
    v_bitop3_b32 v8, v7, 3, s3 bitop3:0x6a
    v_lshl_add_u32 v28, v8, 4, v136
    v_add_u32 v28, 91648, v28
    v_subrev_u32 v7, 1, v7
    v_bitop3_b32 v8, v7, 3, s3 bitop3:0x6a
    buffer_load_dwordx4 v245, s[32:35], s16 offen offset:1024  lds
    v_lshl_add_u32 v30, v8, 4, v136
    v_add_u32 v30, 91136, v30
    v_subrev_u32 v7, 1, v7
    v_bitop3_b32 v8, v7, 3, s3 bitop3:0x6a
    v_lshl_add_u32 v32, v8, 4, v136
    buffer_load_dwordx4 v246, s[32:35], s16 offen offset:2048  lds
    v_add_u32 v32, 90624, v32
    v_lshrrev_b32 v7, 1, v6
    v_lshl_add_u32 v7, v5, 1, v7
    v_add_u32 v7, 32, v7
    s_waitcnt vmcnt(11)
    s_barrier
    s_add_u32 s97, s98, s0
    s_lshr_b64 s[0:1], s[0:1], 4
    s_and_b32 s97, s97, 15
    s_lshr_b32 s99, s97, 3
    s_xor_b32 s97, s97, s99
    s_add_u32 m0, s87, 36864
    s_lshl_b32 s97, s97, 7
    buffer_load_dwordx4 v240, s[28:31], s97 offen offset:0  lds
    v_and_b32 v8, 1, v7
    v_bfe_u32 v136, v7, 1, 2
    v_lshl_add_u32 v136, v8, 2, v136
    v_lshlrev_b32 v136, 6, v136
    buffer_load_dwordx4 v241, s[28:31], s97 offen offset:1024  lds
    v_lshrrev_b32 v7, 3, v7
    v_lshl_add_u32 v136, v7, 9, v136
    v_bitop3_b32 v8, v7, 3, s3 bitop3:0x6a
    v_lshl_add_u32 v20, v8, 4, v136
    s_mul_i32 s16, s97, 3072
    s_add_u32 m0, s60, 49152
    s_add_u32 s99, s16, s62
    buffer_load_dwordx4 v244, s[32:35], s99 offen offset:0  lds
    v_add_u32 v20, 92160, v20
    v_and_b32 v8, 1, v6
    v_xor_b32 v8, 1, v8
    v_lshl_add_u32 v20, v8, 3, v20
    buffer_load_dwordx4 v245, s[32:35], s99 offen offset:1024  lds
    s_waitcnt lgkmcnt(0)
    s_and_b32 s78, s92, 0xffff0000
    s_lshl_b32 s92, s92, 16
    s_bitcmp1_b32 s90, 0
    s_cselect_b32 s92, s78, s92
    buffer_load_dwordx4 v246, s[32:35], s99 offen offset:2048  lds
    v_lshlrev_b32 v7, 3, v6
    v_sub_u32 v7, v7, v5
    v_subrev_u32 v7, 9, v7
    v_and_b32 v8, 1, v7
    s_add_u32 m0, s87, 36864
    s_nop 0
    buffer_load_dwordx4 v242, s[28:31], s97 offen offset:2048  lds
    v_xor_b32 v8, 1, v8
    v_lshlrev_b32 v8, 4, v8
    v_lshrrev_b32 v8, v8, s92
    v_ashrrev_i32 v7, 1, v7
    buffer_load_dwordx4 v243, s[28:31], s97 offen offset:3072  lds
    v_cmp_eq_u32 vcc, 0, v7
    s_nop 1
    v_cndmask_b32 v236, 0, v8, vcc
    v_cmp_eq_u32 vcc, 1, v7
    s_nop 1
    v_cndmask_b32 v237, 0, v8, vcc
    s_add_u32 m0, s88, 36864
    s_mov_b64 exec, 0xffffffff
    buffer_load_dwordx4 v3, s[28:31], s97 offen offset:0  lds
    s_mov_b64 exec, -1
    v_cmp_eq_u32 vcc, 2, v7
    s_nop 1
    v_cndmask_b32 v238, 0, v8, vcc
    v_cmp_eq_u32 vcc, 3, v7
    s_nop 1
    v_cndmask_b32 v239, 0, v8, vcc
    s_add_u32 m0, s61, 61440
    s_add_u32 s16, s16, s63
    buffer_load_dwordx4 v244, s[32:35], s16 offen offset:0  lds
    s_and_b32 s78, s77, 7
    s_mov_b32 s95, 0x76543210
    s_cmp_eq_u32 s78, 1
    s_cselect_b32 s95, 0x76543201, s95
    s_cmp_eq_u32 s78, 2
    s_cselect_b32 s95, 0x76543120, s95
    s_cmp_eq_u32 s78, 3
    s_cselect_b32 s95, 0x76542310, s95
    s_cmp_eq_u32 s78, 4
    s_cselect_b32 s95, 0x76534210, s95
    s_cmp_eq_u32 s78, 5
    s_cselect_b32 s95, 0x76453210, s95
    s_cmp_eq_u32 s78, 6
    s_cselect_b32 s95, 0x75643210, s95
    s_cmp_eq_u32 s78, 7
    s_cselect_b32 s95, 0x67543210, s95
    s_and_b32 s78, s76, 3
    s_mul_i32 s78, s78, 0x22222222
    s_add_u32 s95, s95, s78
    s_bfe_u32 s100, s95, 0x3001c
    s_lshl_b32 s100, s100, 18
    s_bfe_u32 s95, s95, 0x30018
    s_lshl_b32 s95, s95, 18
    v_lshrrev_b32 v136, 4, v0
    v_lshlrev_b32 v136, 1, v136
    v_and_b32 v137, 7, v0
    buffer_load_dwordx4 v245, s[32:35], s16 offen offset:1024  lds
    v_xor_b32 v136, v136, v137
    v_lshlrev_b32 v136, 4, v136
    v_lshrrev_b32 v137, 3, v0
    v_lshl_add_u32 v136, v137, 11, v136
    buffer_load_dwordx4 v246, s[32:35], s16 offen offset:2048  lds
    s_lshl_b32 s78, s77, 7
    s_lshl_b32 s79, s3, 14
    s_add_u32 s78, s78, s79
    v_add_u32 v17, s78, v136
    s_waitcnt vmcnt(11)
    s_barrier
    s_add_u32 s97, s98, s0
    s_lshr_b64 s[0:1], s[0:1], 4
    s_and_b32 s97, s97, 15
    s_lshr_b32 s99, s97, 3
    s_xor_b32 s97, s97, s99
    s_add_u32 m0, s87, 0
    s_lshl_b32 s97, s97, 7
    buffer_load_dwordx4 v240, s[28:31], s97 offen offset:0  lds
    v_add_u32 v5, s94, v15
    ds_read_b128 v[140:143], v5 offset:32
    ds_read_b32 v156, v5 offset:48
    ds_read_b128 v[144:147], v5 offset:1056
    buffer_load_dwordx4 v241, s[28:31], s97 offen offset:1024  lds
    ds_read_b32 v157, v5 offset:1072
    ds_read_b128 v[148:151], v5 offset:2080
    ds_read_b32 v158, v5 offset:2096
    s_mul_i32 s16, s97, 3072
    s_add_u32 m0, s60, 0
    s_add_u32 s99, s16, s62
    buffer_load_dwordx4 v244, s[32:35], s99 offen offset:0  lds
    ds_read_b128 v[152:155], v5 offset:3104
    ds_read_b32 v159, v5 offset:3120
    v_lshrrev_b32 v6, 3, v0
    buffer_load_dwordx4 v245, s[32:35], s99 offen offset:1024  lds
    v_mul_u32_u24 v6, 4160, v6
    v_and_b32 v7, 7, v0
    v_lshl_add_u32 v6, v7, 2, v6
    v_add_u32 v6, s94, v6
    buffer_load_dwordx4 v246, s[32:35], s99 offen offset:2048  lds
    v_mov_b32 v7, 0
    s_waitcnt lgkmcnt(0)
    v_readfirstlane_b32 s93, v140
    s_add_u32 m0, s87, 0
    s_nop 0
    buffer_load_dwordx4 v242, s[28:31], s97 offen offset:2048  lds
    s_lshl_b32 s93, s93, 16
    v_writelane_b32 v7, s93, 15
    v_alignbit_b32 v140, v141, v140, 16
    buffer_load_dwordx4 v243, s[28:31], s97 offen offset:3072  lds
    v_alignbit_b32 v141, v142, v141, 16
    v_alignbit_b32 v142, v143, v142, 16
    v_alignbit_b32 v143, v156, v143, 16
    v_alignbit_b32 v144, v145, v144, 16
    s_add_u32 m0, s88, 0
    s_mov_b64 exec, 0xffffffff
    buffer_load_dwordx4 v3, s[28:31], s97 offen offset:0  lds
    s_mov_b64 exec, -1
    v_alignbit_b32 v145, v146, v145, 16
    v_alignbit_b32 v146, v147, v146, 16
    v_alignbit_b32 v147, v157, v147, 16
    s_add_u32 m0, s61, 12288
    s_add_u32 s16, s16, s63
    buffer_load_dwordx4 v244, s[32:35], s16 offen offset:0  lds
    v_alignbit_b32 v148, v149, v148, 16
    v_alignbit_b32 v149, v150, v149, 16
    v_alignbit_b32 v150, v151, v150, 16
    buffer_load_dwordx4 v245, s[32:35], s16 offen offset:1024  lds
    v_alignbit_b32 v151, v158, v151, 16
    v_alignbit_b32 v152, v153, v152, 16
    v_alignbit_b32 v153, v154, v153, 16
    v_alignbit_b32 v154, v155, v154, 16
    buffer_load_dwordx4 v246, s[32:35], s16 offen offset:2048  lds
    v_alignbit_b32 v155, v159, v155, 16
    v_lshlrev_b32 v8, 3, v0
    s_add_u32 s78, s88, 18432
    s_mov_b64 exec, 0xff
    buffer_load_dword v136, v33, s[68:71], 0 offen sc1
    buffer_load_dword v137, v34, s[52:55], 0 offen sc1
    s_mov_b64 exec, -1
    v_add_u32 v8, s78, v8
    v_mov_b32 v156, 0
    v_mov_b32 v157, 0
    s_waitcnt vmcnt(13)
    s_barrier
    s_waitcnt vmcnt(0)
    s_branch LA_j
LA_c1:
    s_waitcnt vmcnt(7)
    s_barrier
    s_add_u32 m0, s88, 18432
    s_mov_b64 exec, 0xffffffff
    buffer_load_dwordx4 v3, s[28:31], s97 offen offset:0  lds
    s_mov_b64 exec, -1
    s_add_u32 m0, s61, 36864
    s_add_u32 s16, s16, s63
    buffer_load_dwordx4 v244, s[32:35], s16 offen offset:0  lds
    buffer_load_dwordx4 v245, s[32:35], s16 offen offset:1024  lds
    buffer_load_dwordx4 v246, s[32:35], s16 offen offset:2048  lds
    s_add_u32 s97, s98, s0
    s_lshr_b64 s[0:1], s[0:1], 4
    s_and_b32 s97, s97, 15
    s_lshr_b32 s99, s97, 3
    s_xor_b32 s97, s97, s99
    s_add_u32 m0, s87, 36864
    s_lshl_b32 s97, s97, 7
    buffer_load_dwordx4 v240, s[28:31], s97 offen offset:0  lds
    buffer_load_dwordx4 v241, s[28:31], s97 offen offset:1024  lds
    s_mul_i32 s16, s97, 3072
    s_add_u32 m0, s60, 49152
    s_add_u32 s99, s16, s62
    buffer_load_dwordx4 v244, s[32:35], s99 offen offset:0  lds
    buffer_load_dwordx4 v245, s[32:35], s99 offen offset:1024  lds
    buffer_load_dwordx4 v246, s[32:35], s99 offen offset:2048  lds
    s_add_u32 m0, s87, 36864
    s_nop 0
    buffer_load_dwordx4 v242, s[28:31], s97 offen offset:2048  lds
    buffer_load_dwordx4 v243, s[28:31], s97 offen offset:3072  lds
    s_add_u32 m0, s88, 36864
    s_mov_b64 exec, 0xffffffff
    buffer_load_dwordx4 v3, s[28:31], s97 offen offset:0  lds
    s_mov_b64 exec, -1
    s_add_u32 m0, s61, 61440
    s_add_u32 s16, s16, s63
    buffer_load_dwordx4 v244, s[32:35], s16 offen offset:0  lds
    buffer_load_dwordx4 v245, s[32:35], s16 offen offset:1024  lds
    buffer_load_dwordx4 v246, s[32:35], s16 offen offset:2048  lds
    s_waitcnt vmcnt(11)
    s_barrier
    s_add_u32 s97, s98, s0
    s_lshr_b64 s[0:1], s[0:1], 4
    s_and_b32 s97, s97, 15
    s_lshr_b32 s99, s97, 3
    s_xor_b32 s97, s97, s99
    s_add_u32 m0, s87, 0
    s_lshl_b32 s97, s97, 7
    buffer_load_dwordx4 v240, s[28:31], s97 offen offset:0  lds
    buffer_load_dwordx4 v241, s[28:31], s97 offen offset:1024  lds
    s_mul_i32 s16, s97, 3072
    s_add_u32 m0, s60, 0
    s_add_u32 s99, s16, s62
    buffer_load_dwordx4 v244, s[32:35], s99 offen offset:0  lds
    buffer_load_dwordx4 v245, s[32:35], s99 offen offset:1024  lds
    buffer_load_dwordx4 v246, s[32:35], s99 offen offset:2048  lds
    s_add_u32 m0, s87, 0
    s_nop 0
    buffer_load_dwordx4 v242, s[28:31], s97 offen offset:2048  lds
    buffer_load_dwordx4 v243, s[28:31], s97 offen offset:3072  lds
    s_add_u32 m0, s88, 0
    s_mov_b64 exec, 0xffffffff
    buffer_load_dwordx4 v3, s[28:31], s97 offen offset:0  lds
    s_mov_b64 exec, -1
    s_add_u32 m0, s61, 12288
    s_add_u32 s16, s16, s63
    buffer_load_dwordx4 v244, s[32:35], s16 offen offset:0  lds
    buffer_load_dwordx4 v245, s[32:35], s16 offen offset:1024  lds
    buffer_load_dwordx4 v246, s[32:35], s16 offen offset:2048  lds
    s_waitcnt vmcnt(11)
    s_barrier
    s_add_u32 m0, s86, 129536
    s_mov_b32 s89, 0
    buffer_load_dwordx4 v10, s[36:39], s89 offen nt lds
    s_add_u32 m0, s86, 145920
    s_mov_b32 s89, 0
    buffer_load_dwordx4 v10, s[40:43], s89 offen nt lds
    s_add_u32 m0, s86, 133632
    s_mov_b32 s89, 65536
    buffer_load_dwordx4 v10, s[36:39], s89 offen nt lds
    s_add_u32 m0, s86, 150016
    s_mov_b32 s89, 65536
    buffer_load_dwordx4 v10, s[40:43], s89 offen nt lds
    s_add_u32 m0, s86, 137728
    s_mov_b32 s89, 131072
    buffer_load_dwordx4 v10, s[36:39], s89 offen nt lds
    s_add_u32 m0, s86, 154112
    s_mov_b32 s89, 131072
    buffer_load_dwordx4 v10, s[40:43], s89 offen nt lds
    s_add_u32 m0, s86, 141824
    s_mov_b32 s89, 196608
    buffer_load_dwordx4 v10, s[36:39], s89 offen nt lds
    s_add_u32 m0, s86, 158208
    s_mov_b32 s89, 196608
    buffer_load_dwordx4 v10, s[40:43], s89 offen nt lds
    s_mov_b64 exec, 0xff
    s_lshl_b32 s82, s3, 7
    s_add_u32 m0, s82, 129024
    s_mov_b32 s89, 0
    buffer_load_dwordx4 v11, s[36:39], s89 offen nt lds
    s_lshl_b32 s83, s74, 9
    s_add_u32 s83, s83, s82
    s_and_b32 s89, s3, 2
    s_lshl_b32 s89, s89, 3
    s_add_u32 s82, s82, s89
    s_add_u32 m0, s82, 162816
    s_add_u32 s89, s83, 0
    buffer_load_dwordx4 v15, s[44:47], s89 offen  lds
    s_mov_b64 exec, -1
    s_add_u32 s97, s98, s0
    s_lshr_b64 s[0:1], s[0:1], 4
    s_and_b32 s97, s97, 15
    s_lshr_b32 s99, s97, 3
    s_xor_b32 s97, s97, s99
    s_add_u32 m0, s87, 18432
    s_lshl_b32 s97, s97, 7
    buffer_load_dwordx4 v240, s[28:31], s97 offen offset:0  lds
    buffer_load_dwordx4 v241, s[28:31], s97 offen offset:1024  lds
    s_mul_i32 s16, s97, 3072
    s_add_u32 m0, s60, 24576
    s_add_u32 s99, s16, s62
    buffer_load_dwordx4 v244, s[32:35], s99 offen offset:0  lds
    buffer_load_dwordx4 v245, s[32:35], s99 offen offset:1024  lds
    buffer_load_dwordx4 v246, s[32:35], s99 offen offset:2048  lds
    s_add_u32 m0, s87, 18432
    s_nop 0
    buffer_load_dwordx4 v242, s[28:31], s97 offen offset:2048  lds
    buffer_load_dwordx4 v243, s[28:31], s97 offen offset:3072  lds
    s_waitcnt vmcnt(17)
    s_barrier
    s_add_u32 m0, s88, 18432
    s_mov_b64 exec, 0xffffffff
    buffer_load_dwordx4 v3, s[28:31], s97 offen offset:0  lds
    s_mov_b64 exec, -1
    s_add_u32 m0, s61, 36864
    s_add_u32 s16, s16, s63
    buffer_load_dwordx4 v244, s[32:35], s16 offen offset:0  lds
    buffer_load_dwordx4 v245, s[32:35], s16 offen offset:1024  lds
    buffer_load_dwordx4 v246, s[32:35], s16 offen offset:2048  lds
    s_add_u32 s97, s98, s0
    s_lshr_b64 s[0:1], s[0:1], 4
    s_and_b32 s97, s97, 15
    s_lshr_b32 s99, s97, 3
    s_xor_b32 s97, s97, s99
    s_add_u32 m0, s87, 36864
    s_lshl_b32 s97, s97, 7
    buffer_load_dwordx4 v240, s[28:31], s97 offen offset:0  lds
    buffer_load_dwordx4 v241, s[28:31], s97 offen offset:1024  lds
    s_mul_i32 s16, s97, 3072
    s_add_u32 m0, s60, 49152
    s_add_u32 s99, s16, s62
    buffer_load_dwordx4 v244, s[32:35], s99 offen offset:0  lds
    buffer_load_dwordx4 v245, s[32:35], s99 offen offset:1024  lds
    buffer_load_dwordx4 v246, s[32:35], s99 offen offset:2048  lds
    s_add_u32 m0, s87, 36864
    s_nop 0
    buffer_load_dwordx4 v242, s[28:31], s97 offen offset:2048  lds
    buffer_load_dwordx4 v243, s[28:31], s97 offen offset:3072  lds
    s_add_u32 m0, s88, 36864
    s_mov_b64 exec, 0xffffffff
    buffer_load_dwordx4 v3, s[28:31], s97 offen offset:0  lds
    s_mov_b64 exec, -1
    s_add_u32 m0, s61, 61440
    s_add_u32 s16, s16, s63
    buffer_load_dwordx4 v244, s[32:35], s16 offen offset:0  lds
    buffer_load_dwordx4 v245, s[32:35], s16 offen offset:1024  lds
    buffer_load_dwordx4 v246, s[32:35], s16 offen offset:2048  lds
    s_waitcnt vmcnt(11)
    s_barrier
    s_add_u32 s97, s98, s0
    s_lshr_b64 s[0:1], s[0:1], 4
    s_and_b32 s97, s97, 15
    s_lshr_b32 s99, s97, 3
    s_xor_b32 s97, s97, s99
    s_add_u32 m0, s87, 0
    s_lshl_b32 s97, s97, 7
    buffer_load_dwordx4 v240, s[28:31], s97 offen offset:0  lds
    ds_read_b128 v[84:87], v35 offset:0
    ds_read_b128 v[88:91], v35 offset:16
    buffer_load_dwordx4 v241, s[28:31], s97 offen offset:1024  lds
    ds_read_b64 v[40:41], v16 offset:0
    ds_read_b64 v[42:43], v231 offset:256
    s_mul_i32 s16, s97, 3072
    s_add_u32 m0, s60, 0
    s_add_u32 s99, s16, s62
    buffer_load_dwordx4 v244, s[32:35], s99 offen offset:0  lds
    ds_read_b64 v[44:45], v16 offset:256
    ds_read_b64 v[46:47], v16 offset:512
    buffer_load_dwordx4 v245, s[32:35], s99 offen offset:1024  lds
    ds_read_b64 v[48:49], v231 offset:512
    ds_read_b64 v[50:51], v16 offset:768
    buffer_load_dwordx4 v246, s[32:35], s99 offen offset:2048  lds
    ds_read_b64 v[52:53], v231 offset:768
    ds_read_b64 v[54:55], v16 offset:1024
    s_add_u32 m0, s87, 0
    s_nop 0
    buffer_load_dwordx4 v242, s[28:31], s97 offen offset:2048  lds
    ds_read_b64 v[56:57], v231 offset:1024
    ds_read_b64 v[58:59], v16 offset:1280
    buffer_load_dwordx4 v243, s[28:31], s97 offen offset:3072  lds
    ds_read_b64 v[60:61], v231 offset:1280
    ds_read_b64 v[68:69], v16 offset:16896
    s_add_u32 m0, s88, 0
    s_mov_b64 exec, 0xffffffff
    buffer_load_dwordx4 v3, s[28:31], s97 offen offset:0  lds
    s_mov_b64 exec, -1
    ds_read_b64 v[70:71], v231 offset:16896
    ds_read_b64 v[72:73], v16 offset:17152
    s_add_u32 m0, s61, 12288
    s_add_u32 s16, s16, s63
    buffer_load_dwordx4 v244, s[32:35], s16 offen offset:0  lds
    ds_read_b64 v[74:75], v231 offset:17152
    ds_read_b64 v[76:77], v16 offset:17408
    buffer_load_dwordx4 v245, s[32:35], s16 offen offset:1024  lds
    ds_read_b64 v[78:79], v231 offset:17408
    ds_read_b64 v[80:81], v16 offset:17664
    buffer_load_dwordx4 v246, s[32:35], s16 offen offset:2048  lds
    ds_read_b64 v[82:83], v231 offset:17664
    s_waitcnt vmcnt(11)
    s_waitcnt lgkmcnt(0)
    s_barrier
    s_add_u32 s97, s98, s0
    s_lshr_b64 s[0:1], s[0:1], 4
    s_and_b32 s97, s97, 15
    s_lshr_b32 s99, s97, 3
    s_xor_b32 s97, s97, s99
    s_add_u32 m0, s87, 18432
    s_lshl_b32 s97, s97, 7
    buffer_load_dwordx4 v240, s[28:31], s97 offen offset:0  lds
    v_lshlrev_b32 v160, 16, v40
    v_lshlrev_b32 v161, 16, v42
    v_lshlrev_b32 v162, 16, v44
    v_lshlrev_b32 v163, 16, v46
    v_lshlrev_b32 v164, 16, v48
    buffer_load_dwordx4 v241, s[28:31], s97 offen offset:1024  lds
    v_lshlrev_b32 v165, 16, v50
    v_lshlrev_b32 v166, 16, v52
    v_lshlrev_b32 v167, 16, v54
    v_lshlrev_b32 v168, 16, v56
    v_lshlrev_b32 v169, 16, v58
    s_mul_i32 s16, s97, 3072
    s_add_u32 m0, s60, 24576
    s_add_u32 s99, s16, s62
    buffer_load_dwordx4 v244, s[32:35], s99 offen offset:0  lds
    v_lshlrev_b32 v170, 16, v60
    v_lshlrev_b32 v172, 16, v84
    v_and_b32 v173, 0xffff0000, v84
    v_lshlrev_b32 v174, 16, v85
    v_and_b32 v175, 0xffff0000, v85
    buffer_load_dwordx4 v245, s[32:35], s99 offen offset:1024  lds
    v_lshlrev_b32 v176, 16, v68
    v_lshlrev_b32 v177, 16, v70
    v_lshlrev_b32 v178, 16, v72
    v_lshlrev_b32 v179, 16, v74
    v_lshlrev_b32 v180, 16, v76
    buffer_load_dwordx4 v246, s[32:35], s99 offen offset:2048  lds
    v_lshlrev_b32 v181, 16, v78
    v_lshlrev_b32 v182, 16, v80
    v_lshlrev_b32 v183, 16, v82
    v_mul_f32 v184, v160, v175
    v_mul_f32 v185, v161, v175
    s_add_u32 m0, s87, 18432
    s_nop 0
    buffer_load_dwordx4 v242, s[28:31], s97 offen offset:2048  lds
    v_mul_f32 v186, v162, v175
    v_mul_f32 v187, v163, v175
    v_mul_f32 v188, v164, v175
    v_mul_f32 v189, v165, v175
    v_mul_f32 v190, v166, v175
    buffer_load_dwordx4 v243, s[28:31], s97 offen offset:3072  lds
    v_mul_f32 v191, v167, v175
    v_fmac_f32 v184, v161, v174
    v_fmac_f32 v185, v162, v174
    v_fmac_f32 v186, v163, v174
    v_fmac_f32 v187, v164, v174
    s_add_u32 m0, s88, 18432
    s_mov_b64 exec, 0xffffffff
    buffer_load_dwordx4 v3, s[28:31], s97 offen offset:0  lds
    s_mov_b64 exec, -1
    v_fmac_f32 v188, v165, v174
    v_fmac_f32 v189, v166, v174
    v_fmac_f32 v190, v167, v174
    v_fmac_f32 v191, v168, v174
    v_fmac_f32 v184, v162, v173
    s_add_u32 m0, s61, 36864
    s_add_u32 s16, s16, s63
    buffer_load_dwordx4 v244, s[32:35], s16 offen offset:0  lds
    v_fmac_f32 v185, v163, v173
    v_fmac_f32 v186, v164, v173
    v_fmac_f32 v187, v165, v173
    v_fmac_f32 v188, v166, v173
    v_fmac_f32 v189, v167, v173
    buffer_load_dwordx4 v245, s[32:35], s16 offen offset:1024  lds
    v_fmac_f32 v190, v168, v173
    v_fmac_f32 v191, v169, v173
    v_fmac_f32 v184, v163, v172
    v_fmac_f32 v185, v164, v172
    v_fmac_f32 v186, v165, v172
    buffer_load_dwordx4 v246, s[32:35], s16 offen offset:2048  lds
    v_fmac_f32 v187, v166, v172
    v_fmac_f32 v188, v167, v172
    v_fmac_f32 v189, v168, v172
    v_fmac_f32 v190, v169, v172
    v_fmac_f32 v191, v170, v172
    v_mul_f32 v184, v184, v176
    v_mul_f32 v185, v185, v177
    v_mul_f32 v186, v186, v178
    v_mul_f32 v187, v187, v179
    v_mul_f32 v188, v188, v180
    v_mul_f32 v189, v189, v181
    v_mul_f32 v190, v190, v182
    v_mul_f32 v191, v191, v183
    v_cvt_pk_bf16_f32 v100, v191, v190
    v_cvt_pk_bf16_f32 v101, v189, v188
    v_cvt_pk_bf16_f32 v102, v187, v186
    v_cvt_pk_bf16_f32 v103, v185, v184
    s_mov_b32 s89, 0
    buffer_store_dwordx4 v[100:103], v12, s[52:55], s89 offen sc1
    s_waitcnt vmcnt(12)
    s_barrier
    buffer_load_dword v230, v229, s[4:7], 0 offen
    v_and_b32 v160, 0xffff0000, v40
    v_and_b32 v161, 0xffff0000, v42
    v_and_b32 v162, 0xffff0000, v44
    v_and_b32 v163, 0xffff0000, v46
    v_and_b32 v164, 0xffff0000, v48
    buffer_load_dword v230, v228, s[32:35], 0 offen
    v_and_b32 v165, 0xffff0000, v50
    v_and_b32 v166, 0xffff0000, v52
    v_and_b32 v167, 0xffff0000, v54
    v_and_b32 v168, 0xffff0000, v56
    v_and_b32 v169, 0xffff0000, v58
    s_add_u32 s97, s98, s0
    s_lshr_b64 s[0:1], s[0:1], 4
    s_and_b32 s97, s97, 15
    s_lshr_b32 s99, s97, 3
    s_xor_b32 s97, s97, s99
    s_add_u32 m0, s87, 36864
    s_lshl_b32 s97, s97, 7
    buffer_load_dwordx4 v240, s[28:31], s97 offen offset:0  lds
    v_and_b32 v170, 0xffff0000, v60
    v_lshlrev_b32 v172, 16, v86
    v_and_b32 v173, 0xffff0000, v86
    v_lshlrev_b32 v174, 16, v87
    v_and_b32 v175, 0xffff0000, v87
    buffer_load_dwordx4 v241, s[28:31], s97 offen offset:1024  lds
    v_and_b32 v176, 0xffff0000, v68
    v_and_b32 v177, 0xffff0000, v70
    v_and_b32 v178, 0xffff0000, v72
    v_and_b32 v179, 0xffff0000, v74
    v_and_b32 v180, 0xffff0000, v76
    s_mul_i32 s16, s97, 3072
    s_add_u32 m0, s60, 49152
    s_add_u32 s99, s16, s62
    buffer_load_dwordx4 v244, s[32:35], s99 offen offset:0  lds
    v_and_b32 v181, 0xffff0000, v78
    v_and_b32 v182, 0xffff0000, v80
    v_and_b32 v183, 0xffff0000, v82
    v_mul_f32 v184, v160, v175
    v_mul_f32 v185, v161, v175
    buffer_load_dwordx4 v245, s[32:35], s99 offen offset:1024  lds
    v_mul_f32 v186, v162, v175
    v_mul_f32 v187, v163, v175
    v_mul_f32 v188, v164, v175
    v_mul_f32 v189, v165, v175
    v_mul_f32 v190, v166, v175
    buffer_load_dwordx4 v246, s[32:35], s99 offen offset:2048  lds
    v_mul_f32 v191, v167, v175
    v_fmac_f32 v184, v161, v174
    v_fmac_f32 v185, v162, v174
    v_fmac_f32 v186, v163, v174
    v_fmac_f32 v187, v164, v174
    s_add_u32 m0, s87, 36864
    s_nop 0
    buffer_load_dwordx4 v242, s[28:31], s97 offen offset:2048  lds
    v_fmac_f32 v188, v165, v174
    v_fmac_f32 v189, v166, v174
    v_fmac_f32 v190, v167, v174
    v_fmac_f32 v191, v168, v174
    v_fmac_f32 v184, v162, v173
    buffer_load_dwordx4 v243, s[28:31], s97 offen offset:3072  lds
    v_fmac_f32 v185, v163, v173
    v_fmac_f32 v186, v164, v173
    v_fmac_f32 v187, v165, v173
    v_fmac_f32 v188, v166, v173
    v_fmac_f32 v189, v167, v173
    s_add_u32 m0, s88, 36864
    s_mov_b64 exec, 0xffffffff
    buffer_load_dwordx4 v3, s[28:31], s97 offen offset:0  lds
    s_mov_b64 exec, -1
    v_fmac_f32 v190, v168, v173
    v_fmac_f32 v191, v169, v173
    v_fmac_f32 v184, v163, v172
    v_fmac_f32 v185, v164, v172
    v_fmac_f32 v186, v165, v172
    s_add_u32 m0, s61, 61440
    s_add_u32 s16, s16, s63
    buffer_load_dwordx4 v244, s[32:35], s16 offen offset:0  lds
    v_fmac_f32 v187, v166, v172
    v_fmac_f32 v188, v167, v172
    v_fmac_f32 v189, v168, v172
    v_fmac_f32 v190, v169, v172
    v_fmac_f32 v191, v170, v172
    buffer_load_dwordx4 v245, s[32:35], s16 offen offset:1024  lds
    v_mul_f32 v184, v184, v176
    v_mul_f32 v185, v185, v177
    v_mul_f32 v186, v186, v178
    v_mul_f32 v187, v187, v179
    v_mul_f32 v188, v188, v180
    buffer_load_dwordx4 v246, s[32:35], s16 offen offset:2048  lds
    v_mul_f32 v189, v189, v181
    v_mul_f32 v190, v190, v182
    v_mul_f32 v191, v191, v183
    v_cvt_pk_bf16_f32 v104, v191, v190
    v_cvt_pk_bf16_f32 v105, v189, v188
    v_cvt_pk_bf16_f32 v106, v187, v186
    v_cvt_pk_bf16_f32 v107, v185, v184
    s_mov_b32 s89, 16384
    buffer_store_dwordx4 v[104:107], v12, s[52:55], s89 offen sc1
    s_waitcnt vmcnt(15)
    s_barrier
    s_add_u32 s97, s98, s0
    s_lshr_b64 s[0:1], s[0:1], 4
    s_and_b32 s97, s97, 15
    s_lshr_b32 s99, s97, 3
    s_xor_b32 s97, s97, s99
    s_add_u32 m0, s87, 0
    s_lshl_b32 s97, s97, 7
    buffer_load_dwordx4 v240, s[28:31], s97 offen offset:0  lds
    v_lshlrev_b32 v160, 16, v41
    v_lshlrev_b32 v161, 16, v43
    v_lshlrev_b32 v162, 16, v45
    v_lshlrev_b32 v163, 16, v47
    v_lshlrev_b32 v164, 16, v49
    buffer_load_dwordx4 v241, s[28:31], s97 offen offset:1024  lds
    v_lshlrev_b32 v165, 16, v51
    v_lshlrev_b32 v166, 16, v53
    v_lshlrev_b32 v167, 16, v55
    v_lshlrev_b32 v168, 16, v57
    v_lshlrev_b32 v169, 16, v59
    s_mul_i32 s16, s97, 3072
    s_add_u32 m0, s60, 0
    s_add_u32 s99, s16, s62
    buffer_load_dwordx4 v244, s[32:35], s99 offen offset:0  lds
    v_lshlrev_b32 v170, 16, v61
    v_lshlrev_b32 v172, 16, v88
    v_and_b32 v173, 0xffff0000, v88
    v_lshlrev_b32 v174, 16, v89
    v_and_b32 v175, 0xffff0000, v89
    buffer_load_dwordx4 v245, s[32:35], s99 offen offset:1024  lds
    v_lshlrev_b32 v176, 16, v69
    v_lshlrev_b32 v177, 16, v71
    v_lshlrev_b32 v178, 16, v73
    v_lshlrev_b32 v179, 16, v75
    v_lshlrev_b32 v180, 16, v77
    buffer_load_dwordx4 v246, s[32:35], s99 offen offset:2048  lds
    v_lshlrev_b32 v181, 16, v79
    v_lshlrev_b32 v182, 16, v81
    v_lshlrev_b32 v183, 16, v83
    v_mul_f32 v184, v160, v175
    v_mul_f32 v185, v161, v175
    s_add_u32 m0, s87, 0
    s_nop 0
    buffer_load_dwordx4 v242, s[28:31], s97 offen offset:2048  lds
    v_mul_f32 v186, v162, v175
    v_mul_f32 v187, v163, v175
    v_mul_f32 v188, v164, v175
    v_mul_f32 v189, v165, v175
    v_mul_f32 v190, v166, v175
    buffer_load_dwordx4 v243, s[28:31], s97 offen offset:3072  lds
    v_mul_f32 v191, v167, v175
    v_fmac_f32 v184, v161, v174
    v_fmac_f32 v185, v162, v174
    v_fmac_f32 v186, v163, v174
    v_fmac_f32 v187, v164, v174
    s_add_u32 m0, s88, 0
    s_mov_b64 exec, 0xffffffff
    buffer_load_dwordx4 v3, s[28:31], s97 offen offset:0  lds
    s_mov_b64 exec, -1
    v_fmac_f32 v188, v165, v174
    v_fmac_f32 v189, v166, v174
    v_fmac_f32 v190, v167, v174
    v_fmac_f32 v191, v168, v174
    v_fmac_f32 v184, v162, v173
    s_add_u32 m0, s61, 12288
    s_add_u32 s16, s16, s63
    buffer_load_dwordx4 v244, s[32:35], s16 offen offset:0  lds
    v_fmac_f32 v185, v163, v173
    v_fmac_f32 v186, v164, v173
    v_fmac_f32 v187, v165, v173
    v_fmac_f32 v188, v166, v173
    v_fmac_f32 v189, v167, v173
    buffer_load_dwordx4 v245, s[32:35], s16 offen offset:1024  lds
    v_fmac_f32 v190, v168, v173
    v_fmac_f32 v191, v169, v173
    v_fmac_f32 v184, v163, v172
    v_fmac_f32 v185, v164, v172
    v_fmac_f32 v186, v165, v172
    buffer_load_dwordx4 v246, s[32:35], s16 offen offset:2048  lds
    v_fmac_f32 v187, v166, v172
    v_fmac_f32 v188, v167, v172
    v_fmac_f32 v189, v168, v172
    v_fmac_f32 v190, v169, v172
    v_fmac_f32 v191, v170, v172
    v_mul_f32 v184, v184, v176
    v_mul_f32 v185, v185, v177
    v_mul_f32 v186, v186, v178
    v_mul_f32 v187, v187, v179
    v_mul_f32 v188, v188, v180
    v_mul_f32 v189, v189, v181
    v_mul_f32 v190, v190, v182
    v_mul_f32 v191, v191, v183
    v_cvt_pk_bf16_f32 v108, v191, v190
    v_cvt_pk_bf16_f32 v109, v189, v188
    v_cvt_pk_bf16_f32 v110, v187, v186
    v_cvt_pk_bf16_f32 v111, v185, v184
    s_mov_b32 s89, 32768
    buffer_store_dwordx4 v[108:111], v12, s[52:55], s89 offen sc1
    s_waitcnt vmcnt(13)
    s_barrier
    s_add_u32 s97, s98, s0
    s_lshr_b64 s[0:1], s[0:1], 4
    s_and_b32 s97, s97, 15
    s_lshr_b32 s99, s97, 3
    s_xor_b32 s97, s97, s99
    s_add_u32 m0, s87, 18432
    s_lshl_b32 s97, s97, 7
    buffer_load_dwordx4 v240, s[28:31], s97 offen offset:0  lds
    v_and_b32 v160, 0xffff0000, v41
    v_and_b32 v161, 0xffff0000, v43
    v_and_b32 v162, 0xffff0000, v45
    v_and_b32 v163, 0xffff0000, v47
    v_and_b32 v164, 0xffff0000, v49
    buffer_load_dwordx4 v241, s[28:31], s97 offen offset:1024  lds
    v_and_b32 v165, 0xffff0000, v51
    v_and_b32 v166, 0xffff0000, v53
    v_and_b32 v167, 0xffff0000, v55
    v_and_b32 v168, 0xffff0000, v57
    v_and_b32 v169, 0xffff0000, v59
    s_mul_i32 s16, s97, 3072
    s_add_u32 m0, s60, 24576
    s_add_u32 s99, s16, s62
    buffer_load_dwordx4 v244, s[32:35], s99 offen offset:0  lds
    v_and_b32 v170, 0xffff0000, v61
    v_lshlrev_b32 v172, 16, v90
    v_and_b32 v173, 0xffff0000, v90
    v_lshlrev_b32 v174, 16, v91
    v_and_b32 v175, 0xffff0000, v91
    buffer_load_dwordx4 v245, s[32:35], s99 offen offset:1024  lds
    v_and_b32 v176, 0xffff0000, v69
    v_and_b32 v177, 0xffff0000, v71
    v_and_b32 v178, 0xffff0000, v73
    v_and_b32 v179, 0xffff0000, v75
    v_and_b32 v180, 0xffff0000, v77
    buffer_load_dwordx4 v246, s[32:35], s99 offen offset:2048  lds
    v_and_b32 v181, 0xffff0000, v79
    v_and_b32 v182, 0xffff0000, v81
    v_and_b32 v183, 0xffff0000, v83
    v_mul_f32 v184, v160, v175
    v_mul_f32 v185, v161, v175
    s_add_u32 m0, s87, 18432
    s_nop 0
    buffer_load_dwordx4 v242, s[28:31], s97 offen offset:2048  lds
    v_mul_f32 v186, v162, v175
    v_mul_f32 v187, v163, v175
    v_mul_f32 v188, v164, v175
    v_mul_f32 v189, v165, v175
    v_mul_f32 v190, v166, v175
    buffer_load_dwordx4 v243, s[28:31], s97 offen offset:3072  lds
    v_mul_f32 v191, v167, v175
    v_fmac_f32 v184, v161, v174
    v_fmac_f32 v185, v162, v174
    v_fmac_f32 v186, v163, v174
    v_fmac_f32 v187, v164, v174
    s_add_u32 m0, s88, 18432
    s_mov_b64 exec, 0xffffffff
    buffer_load_dwordx4 v3, s[28:31], s97 offen offset:0  lds
    s_mov_b64 exec, -1
    v_fmac_f32 v188, v165, v174
    v_fmac_f32 v189, v166, v174
    v_fmac_f32 v190, v167, v174
    v_fmac_f32 v191, v168, v174
    v_fmac_f32 v184, v162, v173
    s_add_u32 m0, s61, 36864
    s_add_u32 s16, s16, s63
    buffer_load_dwordx4 v244, s[32:35], s16 offen offset:0  lds
    v_fmac_f32 v185, v163, v173
    v_fmac_f32 v186, v164, v173
    v_fmac_f32 v187, v165, v173
    v_fmac_f32 v188, v166, v173
    v_fmac_f32 v189, v167, v173
    buffer_load_dwordx4 v245, s[32:35], s16 offen offset:1024  lds
    v_fmac_f32 v190, v168, v173
    v_fmac_f32 v191, v169, v173
    v_fmac_f32 v184, v163, v172
    v_fmac_f32 v185, v164, v172
    v_fmac_f32 v186, v165, v172
    buffer_load_dwordx4 v246, s[32:35], s16 offen offset:2048  lds
    v_fmac_f32 v187, v166, v172
    v_fmac_f32 v188, v167, v172
    v_fmac_f32 v189, v168, v172
    v_fmac_f32 v190, v169, v172
    v_fmac_f32 v191, v170, v172
    v_mul_f32 v184, v184, v176
    v_mul_f32 v185, v185, v177
    v_mul_f32 v186, v186, v178
    v_mul_f32 v187, v187, v179
    v_mul_f32 v188, v188, v180
    v_mul_f32 v189, v189, v181
    v_mul_f32 v190, v190, v182
    v_mul_f32 v191, v191, v183
    v_cvt_pk_bf16_f32 v112, v191, v190
    v_cvt_pk_bf16_f32 v113, v189, v188
    v_cvt_pk_bf16_f32 v114, v187, v186
    v_cvt_pk_bf16_f32 v115, v185, v184
    s_mov_b32 s89, 49152
    buffer_store_dwordx4 v[112:115], v12, s[52:55], s89 offen sc1
    s_waitcnt vmcnt(13)
    s_barrier
    s_add_u32 s97, s98, s0
    s_lshr_b64 s[0:1], s[0:1], 4
    s_and_b32 s97, s97, 15
    s_lshr_b32 s99, s97, 3
    s_xor_b32 s97, s97, s99
    s_add_u32 m0, s87, 36864
    s_lshl_b32 s97, s97, 7
    buffer_load_dwordx4 v240, s[28:31], s97 offen offset:0  lds
    buffer_load_dwordx4 v241, s[28:31], s97 offen offset:1024  lds
    s_mul_i32 s16, s97, 3072
    s_add_u32 m0, s60, 49152
    s_add_u32 s99, s16, s62
    buffer_load_dwordx4 v244, s[32:35], s99 offen offset:0  lds
    buffer_load_dwordx4 v245, s[32:35], s99 offen offset:1024  lds
    buffer_load_dwordx4 v246, s[32:35], s99 offen offset:2048  lds
    s_add_u32 m0, s87, 36864
    s_nop 0
    buffer_load_dwordx4 v242, s[28:31], s97 offen offset:2048  lds
    buffer_load_dwordx4 v243, s[28:31], s97 offen offset:3072  lds
    s_add_u32 m0, s88, 36864
    s_mov_b64 exec, 0xffffffff
    buffer_load_dwordx4 v3, s[28:31], s97 offen offset:0  lds
    s_mov_b64 exec, -1
    s_add_u32 m0, s61, 61440
    s_add_u32 s16, s16, s63
    buffer_load_dwordx4 v244, s[32:35], s16 offen offset:0  lds
    buffer_load_dwordx4 v245, s[32:35], s16 offen offset:1024  lds
    buffer_load_dwordx4 v246, s[32:35], s16 offen offset:2048  lds
    s_waitcnt vmcnt(12)
    s_barrier
    s_add_u32 m0, s94, 32
    s_lshl_b32 s89, s90, 12
    buffer_load_dwordx4 v15, s[48:51], s89 offen offset:0 nt lds
    s_mov_b32 s68, s24
    s_mov_b32 s69, s25
    s_mov_b32 s70, 0x100
    s_mov_b32 s71, 0x20000
    s_add_u32 m0, s94, 32
    s_lshl_b32 s89, s90, 12
    buffer_load_dwordx4 v15, s[48:51], s89 offen offset:1024 nt lds
    v_lshrrev_b32 v6, 5, v0
    v_and_b32 v7, 3, v0
    s_lshr_b32 s78, s90, 1
    s_add_u32 m0, s94, 32
    s_lshl_b32 s89, s90, 12
    buffer_load_dwordx4 v15, s[48:51], s89 offen offset:2048 nt lds
    s_lshl_b32 s78, s78, 2
    s_load_dword s92, s[14:15], s78
    v_bfe_u32 v5, v0, 2, 2
    v_lshlrev_b32 v5, 1, v5
    s_add_u32 m0, s94, 32
    s_lshl_b32 s89, s90, 12
    buffer_load_dwordx4 v15, s[48:51], s89 offen offset:3072 nt lds
    v_lshl_add_u32 v5, v6, 3, v5
    v_bfe_u32 v8, v0, 4, 1
    v_add_u32 v5, v5, v8
    s_add_u32 s97, s98, s0
    s_lshr_b64 s[0:1], s[0:1], 4
    s_and_b32 s97, s97, 15
    s_lshr_b32 s99, s97, 3
    s_xor_b32 s97, s97, s99
    s_add_u32 m0, s87, 0
    s_lshl_b32 s97, s97, 7
    buffer_load_dwordx4 v240, s[28:31], s97 offen offset:0  lds
    s_and_b32 s78, s3, 1
    s_lshl_b32 s78, s78, 1
    v_add_u32 v8, s78, v6
    v_xor_b32 v8, v8, v7
    buffer_load_dwordx4 v241, s[28:31], s97 offen offset:1024  lds
    v_lshlrev_b32 v8, 4, v8
    v_lshl_add_u32 v5, v5, 6, v8
    v_add_u32 v14, s86, v5
    s_mul_i32 s16, s97, 3072
    s_add_u32 m0, s60, 0
    s_add_u32 s99, s16, s62
    buffer_load_dwordx4 v244, s[32:35], s99 offen offset:0  lds
    v_mov_b32 v18, 162304
    v_mov_b32 v19, 1
    v_and_b32 v5, 3, v0
    s_lshl_b32 s78, s74, 4
    buffer_load_dwordx4 v245, s[32:35], s99 offen offset:1024  lds
    s_add_u32 s78, s78, s3
    v_lshl_add_u32 v6, v5, 2, s78
    s_lshr_b32 s78, s76, 3
    buffer_load_dwordx4 v246, s[32:35], s99 offen offset:2048  lds
    s_lshl_b32 s79, s3, 1
    s_add_u32 s78, s78, s79
    s_xor_b32 s78, s78, 2
    s_lshl_b32 s78, s78, 5
    s_add_u32 m0, s87, 0
    s_nop 0
    buffer_load_dwordx4 v242, s[28:31], s97 offen offset:2048  lds
    s_and_b32 s79, s76, 7
    s_add_u32 s78, s78, s79
    v_lshl_add_u32 v7, v5, 3, s78
    buffer_load_dwordx4 v243, s[28:31], s97 offen offset:3072  lds
    v_and_b32 v8, 4, v0
    v_cmp_eq_u32 vcc, 0, v8
    s_nop 1
    v_cndmask_b32 v6, v7, v6, vcc
    v_and_b32 v33, 0xf0, v6
    s_add_u32 m0, s88, 0
    s_mov_b64 exec, 0xffffffff
    buffer_load_dwordx4 v3, s[28:31], s97 offen offset:0  lds
    s_mov_b64 exec, -1
    v_lshlrev_b32 v34, 8, v6
    v_add_u32 v34, 12582912, v34
    v_and_b32 v5, 15, v0
    s_add_u32 m0, s61, 12288
    s_add_u32 s16, s16, s63
    buffer_load_dwordx4 v244, s[32:35], s16 offen offset:0  lds
    v_lshrrev_b32 v6, 4, v0
    v_add_u32 v7, 9, v5
    v_and_b32 v8, 1, v7
    v_mul_u32_u24 v8, 4160, v8
    buffer_load_dwordx4 v245, s[32:35], s16 offen offset:1024  lds
    v_lshrrev_b32 v7, 1, v7
    v_lshl_add_u32 v8, v7, 2, v8
    v_lshlrev_b32 v7, 4, v6
    buffer_load_dwordx4 v246, s[32:35], s16 offen offset:2048  lds
    v_sub_u32 v8, v8, v7
    s_add_u32 s78, s94, 32
    v_add_u32 v21, s78, v8
    s_waitcnt vmcnt(15)
    s_barrier
    s_add_u32 s97, s98, s0
    s_lshr_b64 s[0:1], s[0:1], 4
    s_and_b32 s97, s97, 15
    s_lshr_b32 s99, s97, 3
    s_xor_b32 s97, s97, s99
    s_add_u32 m0, s87, 18432
    s_lshl_b32 s97, s97, 7
    buffer_load_dwordx4 v240, s[28:31], s97 offen offset:0  lds
    v_add_u32 v22, 1024, v21
    v_add_u32 v23, 2048, v21
    v_add_u32 v24, 3072, v21
    v_lshl_add_u32 v7, v5, 1, v6
    v_add_u32 v7, 30, v7
    buffer_load_dwordx4 v241, s[28:31], s97 offen offset:1024  lds
    v_and_b32 v8, 1, v7
    v_bfe_u32 v136, v7, 1, 2
    v_lshl_add_u32 v136, v8, 2, v136
    v_lshlrev_b32 v136, 6, v136
    v_lshrrev_b32 v7, 3, v7
    s_mul_i32 s16, s97, 3072
    s_add_u32 m0, s60, 24576
    s_add_u32 s99, s16, s62
    buffer_load_dwordx4 v244, s[32:35], s99 offen offset:0  lds
    v_lshl_add_u32 v136, v7, 9, v136
    v_bitop3_b32 v8, v7, 3, s3 bitop3:0x6a
    v_lshl_add_u32 v25, v8, 4, v136
    v_add_u32 v25, 92160, v25
    v_subrev_u32 v7, 1, v7
    buffer_load_dwordx4 v245, s[32:35], s99 offen offset:1024  lds
    v_bitop3_b32 v8, v7, 3, s3 bitop3:0x6a
    v_lshl_add_u32 v27, v8, 4, v136
    v_add_u32 v27, 91648, v27
    v_subrev_u32 v7, 1, v7
    buffer_load_dwordx4 v246, s[32:35], s99 offen offset:2048  lds
    v_bitop3_b32 v8, v7, 3, s3 bitop3:0x6a
    v_lshl_add_u32 v29, v8, 4, v136
    v_add_u32 v29, 91136, v29
    v_subrev_u32 v7, 1, v7
    v_bitop3_b32 v8, v7, 3, s3 bitop3:0x6a
    s_add_u32 m0, s87, 18432
    s_nop 0
    buffer_load_dwordx4 v242, s[28:31], s97 offen offset:2048  lds
    v_lshl_add_u32 v31, v8, 4, v136
    v_add_u32 v31, 90624, v31
    v_lshl_add_u32 v7, v5, 1, v6
    v_add_u32 v7, 26, v7
    v_and_b32 v8, 1, v7
    buffer_load_dwordx4 v243, s[28:31], s97 offen offset:3072  lds
    v_bfe_u32 v136, v7, 1, 2
    v_lshl_add_u32 v136, v8, 2, v136
    v_lshlrev_b32 v136, 6, v136
    v_lshrrev_b32 v7, 3, v7
    v_lshl_add_u32 v136, v7, 9, v136
    s_add_u32 m0, s88, 18432
    s_mov_b64 exec, 0xffffffff
    buffer_load_dwordx4 v3, s[28:31], s97 offen offset:0  lds
    s_mov_b64 exec, -1
    v_bitop3_b32 v8, v7, 3, s3 bitop3:0x6a
    v_lshl_add_u32 v26, v8, 4, v136
    v_add_u32 v26, 92160, v26
    v_subrev_u32 v7, 1, v7
    s_add_u32 m0, s61, 36864
    s_add_u32 s16, s16, s63
    buffer_load_dwordx4 v244, s[32:35], s16 offen offset:0  lds
    v_bitop3_b32 v8, v7, 3, s3 bitop3:0x6a
    v_lshl_add_u32 v28, v8, 4, v136
    v_add_u32 v28, 91648, v28
    v_subrev_u32 v7, 1, v7
    v_bitop3_b32 v8, v7, 3, s3 bitop3:0x6a
    buffer_load_dwordx4 v245, s[32:35], s16 offen offset:1024  lds
    v_lshl_add_u32 v30, v8, 4, v136
    v_add_u32 v30, 91136, v30
    v_subrev_u32 v7, 1, v7
    v_bitop3_b32 v8, v7, 3, s3 bitop3:0x6a
    v_lshl_add_u32 v32, v8, 4, v136
    buffer_load_dwordx4 v246, s[32:35], s16 offen offset:2048  lds
    v_add_u32 v32, 90624, v32
    v_lshrrev_b32 v7, 1, v6
    v_lshl_add_u32 v7, v5, 1, v7
    v_add_u32 v7, 32, v7
    s_waitcnt vmcnt(11)
    s_barrier
    s_add_u32 s97, s98, s0
    s_lshr_b64 s[0:1], s[0:1], 4
    s_and_b32 s97, s97, 15
    s_lshr_b32 s99, s97, 3
    s_xor_b32 s97, s97, s99
    s_add_u32 m0, s87, 36864
    s_lshl_b32 s97, s97, 7
    buffer_load_dwordx4 v240, s[28:31], s97 offen offset:0  lds
    v_and_b32 v8, 1, v7
    v_bfe_u32 v136, v7, 1, 2
    v_lshl_add_u32 v136, v8, 2, v136
    v_lshlrev_b32 v136, 6, v136
    buffer_load_dwordx4 v241, s[28:31], s97 offen offset:1024  lds
    v_lshrrev_b32 v7, 3, v7
    v_lshl_add_u32 v136, v7, 9, v136
    v_bitop3_b32 v8, v7, 3, s3 bitop3:0x6a
    v_lshl_add_u32 v20, v8, 4, v136
    s_mul_i32 s16, s97, 3072
    s_add_u32 m0, s60, 49152
    s_add_u32 s99, s16, s62
    buffer_load_dwordx4 v244, s[32:35], s99 offen offset:0  lds
    v_add_u32 v20, 92160, v20
    v_and_b32 v8, 1, v6
    v_xor_b32 v8, 1, v8
    v_lshl_add_u32 v20, v8, 3, v20
    buffer_load_dwordx4 v245, s[32:35], s99 offen offset:1024  lds
    s_waitcnt lgkmcnt(0)
    s_and_b32 s78, s92, 0xffff0000
    s_lshl_b32 s92, s92, 16
    s_bitcmp1_b32 s90, 0
    s_cselect_b32 s92, s78, s92
    buffer_load_dwordx4 v246, s[32:35], s99 offen offset:2048  lds
    v_lshlrev_b32 v7, 3, v6
    v_sub_u32 v7, v7, v5
    v_subrev_u32 v7, 9, v7
    v_and_b32 v8, 1, v7
    s_add_u32 m0, s87, 36864
    s_nop 0
    buffer_load_dwordx4 v242, s[28:31], s97 offen offset:2048  lds
    v_xor_b32 v8, 1, v8
    v_lshlrev_b32 v8, 4, v8
    v_lshrrev_b32 v8, v8, s92
    v_ashrrev_i32 v7, 1, v7
    buffer_load_dwordx4 v243, s[28:31], s97 offen offset:3072  lds
    v_cmp_eq_u32 vcc, 0, v7
    s_nop 1
    v_cndmask_b32 v236, 0, v8, vcc
    v_cmp_eq_u32 vcc, 1, v7
    s_nop 1
    v_cndmask_b32 v237, 0, v8, vcc
    s_add_u32 m0, s88, 36864
    s_mov_b64 exec, 0xffffffff
    buffer_load_dwordx4 v3, s[28:31], s97 offen offset:0  lds
    s_mov_b64 exec, -1
    v_cmp_eq_u32 vcc, 2, v7
    s_nop 1
    v_cndmask_b32 v238, 0, v8, vcc
    v_cmp_eq_u32 vcc, 3, v7
    s_nop 1
    v_cndmask_b32 v239, 0, v8, vcc
    s_add_u32 m0, s61, 61440
    s_add_u32 s16, s16, s63
    buffer_load_dwordx4 v244, s[32:35], s16 offen offset:0  lds
    s_and_b32 s78, s77, 7
    s_mov_b32 s95, 0x76543210
    s_cmp_eq_u32 s78, 1
    s_cselect_b32 s95, 0x76543201, s95
    s_cmp_eq_u32 s78, 2
    s_cselect_b32 s95, 0x76543120, s95
    s_cmp_eq_u32 s78, 3
    s_cselect_b32 s95, 0x76542310, s95
    s_cmp_eq_u32 s78, 4
    s_cselect_b32 s95, 0x76534210, s95
    s_cmp_eq_u32 s78, 5
    s_cselect_b32 s95, 0x76453210, s95
    s_cmp_eq_u32 s78, 6
    s_cselect_b32 s95, 0x75643210, s95
    s_cmp_eq_u32 s78, 7
    s_cselect_b32 s95, 0x67543210, s95
    s_and_b32 s78, s76, 3
    s_mul_i32 s78, s78, 0x22222222
    s_add_u32 s95, s95, s78
    s_bfe_u32 s100, s95, 0x3001c
    s_lshl_b32 s100, s100, 18
    s_bfe_u32 s95, s95, 0x30018
    s_lshl_b32 s95, s95, 18
    v_lshrrev_b32 v136, 4, v0
    v_lshlrev_b32 v136, 1, v136
    v_and_b32 v137, 7, v0
    buffer_load_dwordx4 v245, s[32:35], s16 offen offset:1024  lds
    v_xor_b32 v136, v136, v137
    v_lshlrev_b32 v136, 4, v136
    v_lshrrev_b32 v137, 3, v0
    v_lshl_add_u32 v136, v137, 11, v136
    buffer_load_dwordx4 v246, s[32:35], s16 offen offset:2048  lds
    s_lshl_b32 s78, s77, 7
    s_lshl_b32 s79, s3, 14
    s_add_u32 s78, s78, s79
    v_add_u32 v17, s78, v136
    s_waitcnt vmcnt(11)
    s_barrier
    s_add_u32 s97, s98, s0
    s_lshr_b64 s[0:1], s[0:1], 4
    s_and_b32 s97, s97, 15
    s_lshr_b32 s99, s97, 3
    s_xor_b32 s97, s97, s99
    s_add_u32 m0, s87, 0
    s_lshl_b32 s97, s97, 7
    buffer_load_dwordx4 v240, s[28:31], s97 offen offset:0  lds
    v_add_u32 v5, s94, v15
    ds_read_b128 v[140:143], v5 offset:32
    ds_read_b32 v156, v5 offset:48
    ds_read_b128 v[144:147], v5 offset:1056
    buffer_load_dwordx4 v241, s[28:31], s97 offen offset:1024  lds
    ds_read_b32 v157, v5 offset:1072
    ds_read_b128 v[148:151], v5 offset:2080
    ds_read_b32 v158, v5 offset:2096
    s_mul_i32 s16, s97, 3072
    s_add_u32 m0, s60, 0
    s_add_u32 s99, s16, s62
    buffer_load_dwordx4 v244, s[32:35], s99 offen offset:0  lds
    ds_read_b128 v[152:155], v5 offset:3104
    ds_read_b32 v159, v5 offset:3120
    v_lshrrev_b32 v6, 3, v0
    buffer_load_dwordx4 v245, s[32:35], s99 offen offset:1024  lds
    v_mul_u32_u24 v6, 4160, v6
    v_and_b32 v7, 7, v0
    v_lshl_add_u32 v6, v7, 2, v6
    v_add_u32 v6, s94, v6
    buffer_load_dwordx4 v246, s[32:35], s99 offen offset:2048  lds
    v_mov_b32 v7, 0
    s_waitcnt lgkmcnt(0)
    v_readfirstlane_b32 s93, v140
    s_add_u32 m0, s87, 0
    s_nop 0
    buffer_load_dwordx4 v242, s[28:31], s97 offen offset:2048  lds
    s_lshl_b32 s93, s93, 16
    v_writelane_b32 v7, s93, 15
    v_alignbit_b32 v140, v141, v140, 16
    buffer_load_dwordx4 v243, s[28:31], s97 offen offset:3072  lds
    v_alignbit_b32 v141, v142, v141, 16
    v_alignbit_b32 v142, v143, v142, 16
    v_alignbit_b32 v143, v156, v143, 16
    v_alignbit_b32 v144, v145, v144, 16
    s_add_u32 m0, s88, 0
    s_mov_b64 exec, 0xffffffff
    buffer_load_dwordx4 v3, s[28:31], s97 offen offset:0  lds
    s_mov_b64 exec, -1
    v_alignbit_b32 v145, v146, v145, 16
    v_alignbit_b32 v146, v147, v146, 16
    v_alignbit_b32 v147, v157, v147, 16
    s_add_u32 m0, s61, 12288
    s_add_u32 s16, s16, s63
    buffer_load_dwordx4 v244, s[32:35], s16 offen offset:0  lds
    v_alignbit_b32 v148, v149, v148, 16
    v_alignbit_b32 v149, v150, v149, 16
    v_alignbit_b32 v150, v151, v150, 16
    buffer_load_dwordx4 v245, s[32:35], s16 offen offset:1024  lds
    v_alignbit_b32 v151, v158, v151, 16
    v_alignbit_b32 v152, v153, v152, 16
    v_alignbit_b32 v153, v154, v153, 16
    v_alignbit_b32 v154, v155, v154, 16
    buffer_load_dwordx4 v246, s[32:35], s16 offen offset:2048  lds
    v_alignbit_b32 v155, v159, v155, 16
    v_lshlrev_b32 v8, 3, v0
    s_add_u32 s78, s88, 18432
    s_mov_b64 exec, 0xff
    buffer_load_dword v136, v33, s[68:71], 0 offen sc1
    buffer_load_dword v137, v34, s[52:55], 0 offen sc1
    s_mov_b64 exec, -1
    v_add_u32 v8, s78, v8
    v_mov_b32 v156, 0
    v_mov_b32 v157, 0
    s_waitcnt vmcnt(13)
    s_barrier
    s_waitcnt vmcnt(0)
    s_branch LA_j
LA_c2:
    s_waitcnt vmcnt(7)
    s_barrier
    s_add_u32 m0, s88, 18432
    s_mov_b64 exec, 0xffffffff
    buffer_load_dwordx4 v3, s[28:31], s97 offen offset:0  lds
    s_mov_b64 exec, -1
    s_add_u32 m0, s61, 36864
    s_add_u32 s16, s16, s63
    buffer_load_dwordx4 v244, s[32:35], s16 offen offset:0  lds
    buffer_load_dwordx4 v245, s[32:35], s16 offen offset:1024  lds
    buffer_load_dwordx4 v246, s[32:35], s16 offen offset:2048  lds
    s_add_u32 s97, s98, s0
    s_lshr_b64 s[0:1], s[0:1], 4
    s_and_b32 s97, s97, 15
    s_lshr_b32 s99, s97, 3
    s_xor_b32 s97, s97, s99
    s_add_u32 m0, s87, 36864
    s_lshl_b32 s97, s97, 7
    buffer_load_dwordx4 v240, s[28:31], s97 offen offset:0  lds
    buffer_load_dwordx4 v241, s[28:31], s97 offen offset:1024  lds
    s_mul_i32 s16, s97, 3072
    s_add_u32 m0, s60, 49152
    s_add_u32 s99, s16, s62
    buffer_load_dwordx4 v244, s[32:35], s99 offen offset:0  lds
    buffer_load_dwordx4 v245, s[32:35], s99 offen offset:1024  lds
    buffer_load_dwordx4 v246, s[32:35], s99 offen offset:2048  lds
    s_add_u32 m0, s87, 36864
    s_nop 0
    buffer_load_dwordx4 v242, s[28:31], s97 offen offset:2048  lds
    buffer_load_dwordx4 v243, s[28:31], s97 offen offset:3072  lds
    s_add_u32 m0, s88, 36864
    s_mov_b64 exec, 0xffffffff
    buffer_load_dwordx4 v3, s[28:31], s97 offen offset:0  lds
    s_mov_b64 exec, -1
    s_add_u32 m0, s61, 61440
    s_add_u32 s16, s16, s63
    buffer_load_dwordx4 v244, s[32:35], s16 offen offset:0  lds
    buffer_load_dwordx4 v245, s[32:35], s16 offen offset:1024  lds
    buffer_load_dwordx4 v246, s[32:35], s16 offen offset:2048  lds
    s_waitcnt vmcnt(11)
    s_barrier
    s_add_u32 s97, s98, s0
    s_lshr_b64 s[0:1], s[0:1], 4
    s_and_b32 s97, s97, 15
    s_lshr_b32 s99, s97, 3
    s_xor_b32 s97, s97, s99
    s_add_u32 m0, s87, 0
    s_lshl_b32 s97, s97, 7
    buffer_load_dwordx4 v240, s[28:31], s97 offen offset:0  lds
    buffer_load_dwordx4 v241, s[28:31], s97 offen offset:1024  lds
    s_mul_i32 s16, s97, 3072
    s_add_u32 m0, s60, 0
    s_add_u32 s99, s16, s62
    buffer_load_dwordx4 v244, s[32:35], s99 offen offset:0  lds
    buffer_load_dwordx4 v245, s[32:35], s99 offen offset:1024  lds
    buffer_load_dwordx4 v246, s[32:35], s99 offen offset:2048  lds
    s_add_u32 m0, s87, 0
    s_nop 0
    buffer_load_dwordx4 v242, s[28:31], s97 offen offset:2048  lds
    buffer_load_dwordx4 v243, s[28:31], s97 offen offset:3072  lds
    s_add_u32 m0, s88, 0
    s_mov_b64 exec, 0xffffffff
    buffer_load_dwordx4 v3, s[28:31], s97 offen offset:0  lds
    s_mov_b64 exec, -1
    s_add_u32 m0, s61, 12288
    s_add_u32 s16, s16, s63
    buffer_load_dwordx4 v244, s[32:35], s16 offen offset:0  lds
    buffer_load_dwordx4 v245, s[32:35], s16 offen offset:1024  lds
    buffer_load_dwordx4 v246, s[32:35], s16 offen offset:2048  lds
    s_waitcnt vmcnt(11)
    s_barrier
    s_add_u32 s97, s98, s0
    s_lshr_b64 s[0:1], s[0:1], 4
    s_and_b32 s97, s97, 15
    s_lshr_b32 s99, s97, 3
    s_xor_b32 s97, s97, s99
    s_add_u32 m0, s87, 18432
    s_lshl_b32 s97, s97, 7
    buffer_load_dwordx4 v240, s[28:31], s97 offen offset:0  lds
    buffer_load_dwordx4 v241, s[28:31], s97 offen offset:1024  lds
    s_mul_i32 s16, s97, 3072
    s_add_u32 m0, s60, 24576
    s_add_u32 s99, s16, s62
    buffer_load_dwordx4 v244, s[32:35], s99 offen offset:0  lds
    buffer_load_dwordx4 v245, s[32:35], s99 offen offset:1024  lds
    buffer_load_dwordx4 v246, s[32:35], s99 offen offset:2048  lds
    s_add_u32 m0, s87, 18432
    s_nop 0
    buffer_load_dwordx4 v242, s[28:31], s97 offen offset:2048  lds
    buffer_load_dwordx4 v243, s[28:31], s97 offen offset:3072  lds
    s_add_u32 m0, s88, 18432
    s_mov_b64 exec, 0xffffffff
    buffer_load_dwordx4 v3, s[28:31], s97 offen offset:0  lds
    s_mov_b64 exec, -1
    s_add_u32 m0, s61, 36864
    s_add_u32 s16, s16, s63
    buffer_load_dwordx4 v244, s[32:35], s16 offen offset:0  lds
    buffer_load_dwordx4 v245, s[32:35], s16 offen offset:1024  lds
    buffer_load_dwordx4 v246, s[32:35], s16 offen offset:2048  lds
    s_waitcnt vmcnt(11)
    s_barrier
    s_add_u32 m0, s86, 129536
    s_mov_b32 s89, 0
    buffer_load_dwordx4 v10, s[36:39], s89 offen nt lds
    s_add_u32 m0, s86, 145920
    s_mov_b32 s89, 0
    buffer_load_dwordx4 v10, s[40:43], s89 offen nt lds
    s_add_u32 m0, s86, 133632
    s_mov_b32 s89, 65536
    buffer_load_dwordx4 v10, s[36:39], s89 offen nt lds
    s_add_u32 m0, s86, 150016
    s_mov_b32 s89, 65536
    buffer_load_dwordx4 v10, s[40:43], s89 offen nt lds
    s_add_u32 m0, s86, 137728
    s_mov_b32 s89, 131072
    buffer_load_dwordx4 v10, s[36:39], s89 offen nt lds
    s_add_u32 m0, s86, 154112
    s_mov_b32 s89, 131072
    buffer_load_dwordx4 v10, s[40:43], s89 offen nt lds
    s_add_u32 m0, s86, 141824
    s_mov_b32 s89, 196608
    buffer_load_dwordx4 v10, s[36:39], s89 offen nt lds
    s_add_u32 m0, s86, 158208
    s_mov_b32 s89, 196608
    buffer_load_dwordx4 v10, s[40:43], s89 offen nt lds
    s_mov_b64 exec, 0xff
    s_lshl_b32 s82, s3, 7
    s_add_u32 m0, s82, 129024
    s_mov_b32 s89, 0
    buffer_load_dwordx4 v11, s[36:39], s89 offen nt lds
    s_lshl_b32 s83, s74, 9
    s_add_u32 s83, s83, s82
    s_and_b32 s89, s3, 2
    s_lshl_b32 s89, s89, 3
    s_add_u32 s82, s82, s89
    s_add_u32 m0, s82, 162816
    s_add_u32 s89, s83, 0
    buffer_load_dwordx4 v15, s[44:47], s89 offen  lds
    s_mov_b64 exec, -1
    s_add_u32 s97, s98, s0
    s_lshr_b64 s[0:1], s[0:1], 4
    s_and_b32 s97, s97, 15
    s_lshr_b32 s99, s97, 3
    s_xor_b32 s97, s97, s99
    s_add_u32 m0, s87, 36864
    s_lshl_b32 s97, s97, 7
    buffer_load_dwordx4 v240, s[28:31], s97 offen offset:0  lds
    buffer_load_dwordx4 v241, s[28:31], s97 offen offset:1024  lds
    s_mul_i32 s16, s97, 3072
    s_add_u32 m0, s60, 49152
    s_add_u32 s99, s16, s62
    buffer_load_dwordx4 v244, s[32:35], s99 offen offset:0  lds
    buffer_load_dwordx4 v245, s[32:35], s99 offen offset:1024  lds
    buffer_load_dwordx4 v246, s[32:35], s99 offen offset:2048  lds
    s_add_u32 m0, s87, 36864
    s_nop 0
    buffer_load_dwordx4 v242, s[28:31], s97 offen offset:2048  lds
    buffer_load_dwordx4 v243, s[28:31], s97 offen offset:3072  lds
    s_waitcnt vmcnt(17)
    s_barrier
    s_add_u32 m0, s88, 36864
    s_mov_b64 exec, 0xffffffff
    buffer_load_dwordx4 v3, s[28:31], s97 offen offset:0  lds
    s_mov_b64 exec, -1
    s_add_u32 m0, s61, 61440
    s_add_u32 s16, s16, s63
    buffer_load_dwordx4 v244, s[32:35], s16 offen offset:0  lds
    buffer_load_dwordx4 v245, s[32:35], s16 offen offset:1024  lds
    buffer_load_dwordx4 v246, s[32:35], s16 offen offset:2048  lds
    s_add_u32 s97, s98, s0
    s_lshr_b64 s[0:1], s[0:1], 4
    s_and_b32 s97, s97, 15
    s_lshr_b32 s99, s97, 3
    s_xor_b32 s97, s97, s99
    s_add_u32 m0, s87, 0
    s_lshl_b32 s97, s97, 7
    buffer_load_dwordx4 v240, s[28:31], s97 offen offset:0  lds
    buffer_load_dwordx4 v241, s[28:31], s97 offen offset:1024  lds
    s_mul_i32 s16, s97, 3072
    s_add_u32 m0, s60, 0
    s_add_u32 s99, s16, s62
    buffer_load_dwordx4 v244, s[32:35], s99 offen offset:0  lds
    buffer_load_dwordx4 v245, s[32:35], s99 offen offset:1024  lds
    buffer_load_dwordx4 v246, s[32:35], s99 offen offset:2048  lds
    s_add_u32 m0, s87, 0
    s_nop 0
    buffer_load_dwordx4 v242, s[28:31], s97 offen offset:2048  lds
    buffer_load_dwordx4 v243, s[28:31], s97 offen offset:3072  lds
    s_add_u32 m0, s88, 0
    s_mov_b64 exec, 0xffffffff
    buffer_load_dwordx4 v3, s[28:31], s97 offen offset:0  lds
    s_mov_b64 exec, -1
    s_add_u32 m0, s61, 12288
    s_add_u32 s16, s16, s63
    buffer_load_dwordx4 v244, s[32:35], s16 offen offset:0  lds
    buffer_load_dwordx4 v245, s[32:35], s16 offen offset:1024  lds
    buffer_load_dwordx4 v246, s[32:35], s16 offen offset:2048  lds
    s_waitcnt vmcnt(11)
    s_barrier
    s_add_u32 s97, s98, s0
    s_lshr_b64 s[0:1], s[0:1], 4
    s_and_b32 s97, s97, 15
    s_lshr_b32 s99, s97, 3
    s_xor_b32 s97, s97, s99
    s_add_u32 m0, s87, 18432
    s_lshl_b32 s97, s97, 7
    buffer_load_dwordx4 v240, s[28:31], s97 offen offset:0  lds
    ds_read_b128 v[84:87], v35 offset:0
    ds_read_b128 v[88:91], v35 offset:16
    buffer_load_dwordx4 v241, s[28:31], s97 offen offset:1024  lds
    ds_read_b64 v[40:41], v16 offset:0
    ds_read_b64 v[42:43], v231 offset:256
    s_mul_i32 s16, s97, 3072
    s_add_u32 m0, s60, 24576
    s_add_u32 s99, s16, s62
    buffer_load_dwordx4 v244, s[32:35], s99 offen offset:0  lds
    ds_read_b64 v[44:45], v16 offset:256
    ds_read_b64 v[46:47], v16 offset:512
    buffer_load_dwordx4 v245, s[32:35], s99 offen offset:1024  lds
    ds_read_b64 v[48:49], v231 offset:512
    ds_read_b64 v[50:51], v16 offset:768
    buffer_load_dwordx4 v246, s[32:35], s99 offen offset:2048  lds
    ds_read_b64 v[52:53], v231 offset:768
    ds_read_b64 v[54:55], v16 offset:1024
    s_add_u32 m0, s87, 18432
    s_nop 0
    buffer_load_dwordx4 v242, s[28:31], s97 offen offset:2048  lds
    ds_read_b64 v[56:57], v231 offset:1024
    ds_read_b64 v[58:59], v16 offset:1280
    buffer_load_dwordx4 v243, s[28:31], s97 offen offset:3072  lds
    ds_read_b64 v[60:61], v231 offset:1280
    ds_read_b64 v[68:69], v16 offset:16896
    s_add_u32 m0, s88, 18432
    s_mov_b64 exec, 0xffffffff
    buffer_load_dwordx4 v3, s[28:31], s97 offen offset:0  lds
    s_mov_b64 exec, -1
    ds_read_b64 v[70:71], v231 offset:16896
    ds_read_b64 v[72:73], v16 offset:17152
    s_add_u32 m0, s61, 36864
    s_add_u32 s16, s16, s63
    buffer_load_dwordx4 v244, s[32:35], s16 offen offset:0  lds
    ds_read_b64 v[74:75], v231 offset:17152
    ds_read_b64 v[76:77], v16 offset:17408
    buffer_load_dwordx4 v245, s[32:35], s16 offen offset:1024  lds
    ds_read_b64 v[78:79], v231 offset:17408
    ds_read_b64 v[80:81], v16 offset:17664
    buffer_load_dwordx4 v246, s[32:35], s16 offen offset:2048  lds
    ds_read_b64 v[82:83], v231 offset:17664
    s_waitcnt vmcnt(11)
    s_waitcnt lgkmcnt(0)
    s_barrier
    s_add_u32 s97, s98, s0
    s_lshr_b64 s[0:1], s[0:1], 4
    s_and_b32 s97, s97, 15
    s_lshr_b32 s99, s97, 3
    s_xor_b32 s97, s97, s99
    s_add_u32 m0, s87, 36864
    s_lshl_b32 s97, s97, 7
    buffer_load_dwordx4 v240, s[28:31], s97 offen offset:0  lds
    v_lshlrev_b32 v160, 16, v40
    v_lshlrev_b32 v161, 16, v42
    v_lshlrev_b32 v162, 16, v44
    v_lshlrev_b32 v163, 16, v46
    v_lshlrev_b32 v164, 16, v48
    buffer_load_dwordx4 v241, s[28:31], s97 offen offset:1024  lds
    v_lshlrev_b32 v165, 16, v50
    v_lshlrev_b32 v166, 16, v52
    v_lshlrev_b32 v167, 16, v54
    v_lshlrev_b32 v168, 16, v56
    v_lshlrev_b32 v169, 16, v58
    s_mul_i32 s16, s97, 3072
    s_add_u32 m0, s60, 49152
    s_add_u32 s99, s16, s62
    buffer_load_dwordx4 v244, s[32:35], s99 offen offset:0  lds
    v_lshlrev_b32 v170, 16, v60
    v_lshlrev_b32 v172, 16, v84
    v_and_b32 v173, 0xffff0000, v84
    v_lshlrev_b32 v174, 16, v85
    v_and_b32 v175, 0xffff0000, v85
    buffer_load_dwordx4 v245, s[32:35], s99 offen offset:1024  lds
    v_lshlrev_b32 v176, 16, v68
    v_lshlrev_b32 v177, 16, v70
    v_lshlrev_b32 v178, 16, v72
    v_lshlrev_b32 v179, 16, v74
    v_lshlrev_b32 v180, 16, v76
    buffer_load_dwordx4 v246, s[32:35], s99 offen offset:2048  lds
    v_lshlrev_b32 v181, 16, v78
    v_lshlrev_b32 v182, 16, v80
    v_lshlrev_b32 v183, 16, v82
    v_mul_f32 v184, v160, v175
    v_mul_f32 v185, v161, v175
    s_add_u32 m0, s87, 36864
    s_nop 0
    buffer_load_dwordx4 v242, s[28:31], s97 offen offset:2048  lds
    v_mul_f32 v186, v162, v175
    v_mul_f32 v187, v163, v175
    v_mul_f32 v188, v164, v175
    v_mul_f32 v189, v165, v175
    v_mul_f32 v190, v166, v175
    buffer_load_dwordx4 v243, s[28:31], s97 offen offset:3072  lds
    v_mul_f32 v191, v167, v175
    v_fmac_f32 v184, v161, v174
    v_fmac_f32 v185, v162, v174
    v_fmac_f32 v186, v163, v174
    v_fmac_f32 v187, v164, v174
    s_add_u32 m0, s88, 36864
    s_mov_b64 exec, 0xffffffff
    buffer_load_dwordx4 v3, s[28:31], s97 offen offset:0  lds
    s_mov_b64 exec, -1
    v_fmac_f32 v188, v165, v174
    v_fmac_f32 v189, v166, v174
    v_fmac_f32 v190, v167, v174
    v_fmac_f32 v191, v168, v174
    v_fmac_f32 v184, v162, v173
    s_add_u32 m0, s61, 61440
    s_add_u32 s16, s16, s63
    buffer_load_dwordx4 v244, s[32:35], s16 offen offset:0  lds
    v_fmac_f32 v185, v163, v173
    v_fmac_f32 v186, v164, v173
    v_fmac_f32 v187, v165, v173
    v_fmac_f32 v188, v166, v173
    v_fmac_f32 v189, v167, v173
    buffer_load_dwordx4 v245, s[32:35], s16 offen offset:1024  lds
    v_fmac_f32 v190, v168, v173
    v_fmac_f32 v191, v169, v173
    v_fmac_f32 v184, v163, v172
    v_fmac_f32 v185, v164, v172
    v_fmac_f32 v186, v165, v172
    buffer_load_dwordx4 v246, s[32:35], s16 offen offset:2048  lds
    v_fmac_f32 v187, v166, v172
    v_fmac_f32 v188, v167, v172
    v_fmac_f32 v189, v168, v172
    v_fmac_f32 v190, v169, v172
    v_fmac_f32 v191, v170, v172
    v_mul_f32 v184, v184, v176
    v_mul_f32 v185, v185, v177
    v_mul_f32 v186, v186, v178
    v_mul_f32 v187, v187, v179
    v_mul_f32 v188, v188, v180
    v_mul_f32 v189, v189, v181
    v_mul_f32 v190, v190, v182
    v_mul_f32 v191, v191, v183
    v_cvt_pk_bf16_f32 v100, v191, v190
    v_cvt_pk_bf16_f32 v101, v189, v188
    v_cvt_pk_bf16_f32 v102, v187, v186
    v_cvt_pk_bf16_f32 v103, v185, v184
    s_mov_b32 s89, 0
    buffer_store_dwordx4 v[100:103], v12, s[52:55], s89 offen sc1
    s_waitcnt vmcnt(12)
    s_barrier
    s_add_u32 s97, s98, s0
    s_lshr_b64 s[0:1], s[0:1], 4
    s_and_b32 s97, s97, 15
    s_lshr_b32 s99, s97, 3
    s_xor_b32 s97, s97, s99
    s_add_u32 m0, s87, 0
    s_lshl_b32 s97, s97, 7
    buffer_load_dwordx4 v240, s[28:31], s97 offen offset:0  lds
    v_and_b32 v160, 0xffff0000, v40
    v_and_b32 v161, 0xffff0000, v42
    v_and_b32 v162, 0xffff0000, v44
    v_and_b32 v163, 0xffff0000, v46
    v_and_b32 v164, 0xffff0000, v48
    buffer_load_dwordx4 v241, s[28:31], s97 offen offset:1024  lds
    v_and_b32 v165, 0xffff0000, v50
    v_and_b32 v166, 0xffff0000, v52
    v_and_b32 v167, 0xffff0000, v54
    v_and_b32 v168, 0xffff0000, v56
    v_and_b32 v169, 0xffff0000, v58
    s_mul_i32 s16, s97, 3072
    s_add_u32 m0, s60, 0
    s_add_u32 s99, s16, s62
    buffer_load_dwordx4 v244, s[32:35], s99 offen offset:0  lds
    v_and_b32 v170, 0xffff0000, v60
    v_lshlrev_b32 v172, 16, v86
    v_and_b32 v173, 0xffff0000, v86
    v_lshlrev_b32 v174, 16, v87
    v_and_b32 v175, 0xffff0000, v87
    buffer_load_dwordx4 v245, s[32:35], s99 offen offset:1024  lds
    v_and_b32 v176, 0xffff0000, v68
    v_and_b32 v177, 0xffff0000, v70
    v_and_b32 v178, 0xffff0000, v72
    v_and_b32 v179, 0xffff0000, v74
    v_and_b32 v180, 0xffff0000, v76
    buffer_load_dwordx4 v246, s[32:35], s99 offen offset:2048  lds
    v_and_b32 v181, 0xffff0000, v78
    v_and_b32 v182, 0xffff0000, v80
    v_and_b32 v183, 0xffff0000, v82
    v_mul_f32 v184, v160, v175
    v_mul_f32 v185, v161, v175
    s_add_u32 m0, s87, 0
    s_nop 0
    buffer_load_dwordx4 v242, s[28:31], s97 offen offset:2048  lds
    v_mul_f32 v186, v162, v175
    v_mul_f32 v187, v163, v175
    v_mul_f32 v188, v164, v175
    v_mul_f32 v189, v165, v175
    v_mul_f32 v190, v166, v175
    buffer_load_dwordx4 v243, s[28:31], s97 offen offset:3072  lds
    v_mul_f32 v191, v167, v175
    v_fmac_f32 v184, v161, v174
    v_fmac_f32 v185, v162, v174
    v_fmac_f32 v186, v163, v174
    v_fmac_f32 v187, v164, v174
    s_add_u32 m0, s88, 0
    s_mov_b64 exec, 0xffffffff
    buffer_load_dwordx4 v3, s[28:31], s97 offen offset:0  lds
    s_mov_b64 exec, -1
    v_fmac_f32 v188, v165, v174
    v_fmac_f32 v189, v166, v174
    v_fmac_f32 v190, v167, v174
    v_fmac_f32 v191, v168, v174
    v_fmac_f32 v184, v162, v173
    s_add_u32 m0, s61, 12288
    s_add_u32 s16, s16, s63
    buffer_load_dwordx4 v244, s[32:35], s16 offen offset:0  lds
    v_fmac_f32 v185, v163, v173
    v_fmac_f32 v186, v164, v173
    v_fmac_f32 v187, v165, v173
    v_fmac_f32 v188, v166, v173
    v_fmac_f32 v189, v167, v173
    buffer_load_dwordx4 v245, s[32:35], s16 offen offset:1024  lds
    v_fmac_f32 v190, v168, v173
    v_fmac_f32 v191, v169, v173
    v_fmac_f32 v184, v163, v172
    v_fmac_f32 v185, v164, v172
    v_fmac_f32 v186, v165, v172
    buffer_load_dwordx4 v246, s[32:35], s16 offen offset:2048  lds
    v_fmac_f32 v187, v166, v172
    v_fmac_f32 v188, v167, v172
    v_fmac_f32 v189, v168, v172
    v_fmac_f32 v190, v169, v172
    v_fmac_f32 v191, v170, v172
    v_mul_f32 v184, v184, v176
    v_mul_f32 v185, v185, v177
    v_mul_f32 v186, v186, v178
    v_mul_f32 v187, v187, v179
    v_mul_f32 v188, v188, v180
    v_mul_f32 v189, v189, v181
    v_mul_f32 v190, v190, v182
    v_mul_f32 v191, v191, v183
    v_cvt_pk_bf16_f32 v104, v191, v190
    v_cvt_pk_bf16_f32 v105, v189, v188
    v_cvt_pk_bf16_f32 v106, v187, v186
    v_cvt_pk_bf16_f32 v107, v185, v184
    s_mov_b32 s89, 16384
    buffer_store_dwordx4 v[104:107], v12, s[52:55], s89 offen sc1
    s_waitcnt vmcnt(13)
    s_barrier
    s_add_u32 s97, s98, s0
    s_lshr_b64 s[0:1], s[0:1], 4
    s_and_b32 s97, s97, 15
    s_lshr_b32 s99, s97, 3
    s_xor_b32 s97, s97, s99
    s_add_u32 m0, s87, 18432
    s_lshl_b32 s97, s97, 7
    buffer_load_dwordx4 v240, s[28:31], s97 offen offset:0  lds
    v_lshlrev_b32 v160, 16, v41
    v_lshlrev_b32 v161, 16, v43
    v_lshlrev_b32 v162, 16, v45
    v_lshlrev_b32 v163, 16, v47
    v_lshlrev_b32 v164, 16, v49
    buffer_load_dwordx4 v241, s[28:31], s97 offen offset:1024  lds
    v_lshlrev_b32 v165, 16, v51
    v_lshlrev_b32 v166, 16, v53
    v_lshlrev_b32 v167, 16, v55
    v_lshlrev_b32 v168, 16, v57
    v_lshlrev_b32 v169, 16, v59
    s_mul_i32 s16, s97, 3072
    s_add_u32 m0, s60, 24576
    s_add_u32 s99, s16, s62
    buffer_load_dwordx4 v244, s[32:35], s99 offen offset:0  lds
    v_lshlrev_b32 v170, 16, v61
    v_lshlrev_b32 v172, 16, v88
    v_and_b32 v173, 0xffff0000, v88
    v_lshlrev_b32 v174, 16, v89
    v_and_b32 v175, 0xffff0000, v89
    buffer_load_dwordx4 v245, s[32:35], s99 offen offset:1024  lds
    v_lshlrev_b32 v176, 16, v69
    v_lshlrev_b32 v177, 16, v71
    v_lshlrev_b32 v178, 16, v73
    v_lshlrev_b32 v179, 16, v75
    v_lshlrev_b32 v180, 16, v77
    buffer_load_dwordx4 v246, s[32:35], s99 offen offset:2048  lds
    v_lshlrev_b32 v181, 16, v79
    v_lshlrev_b32 v182, 16, v81
    v_lshlrev_b32 v183, 16, v83
    v_mul_f32 v184, v160, v175
    v_mul_f32 v185, v161, v175
    s_add_u32 m0, s87, 18432
    s_nop 0
    buffer_load_dwordx4 v242, s[28:31], s97 offen offset:2048  lds
    v_mul_f32 v186, v162, v175
    v_mul_f32 v187, v163, v175
    v_mul_f32 v188, v164, v175
    v_mul_f32 v189, v165, v175
    v_mul_f32 v190, v166, v175
    buffer_load_dwordx4 v243, s[28:31], s97 offen offset:3072  lds
    v_mul_f32 v191, v167, v175
    v_fmac_f32 v184, v161, v174
    v_fmac_f32 v185, v162, v174
    v_fmac_f32 v186, v163, v174
    v_fmac_f32 v187, v164, v174
    s_add_u32 m0, s88, 18432
    s_mov_b64 exec, 0xffffffff
    buffer_load_dwordx4 v3, s[28:31], s97 offen offset:0  lds
    s_mov_b64 exec, -1
    v_fmac_f32 v188, v165, v174
    v_fmac_f32 v189, v166, v174
    v_fmac_f32 v190, v167, v174
    v_fmac_f32 v191, v168, v174
    v_fmac_f32 v184, v162, v173
    s_add_u32 m0, s61, 36864
    s_add_u32 s16, s16, s63
    buffer_load_dwordx4 v244, s[32:35], s16 offen offset:0  lds
    v_fmac_f32 v185, v163, v173
    v_fmac_f32 v186, v164, v173
    v_fmac_f32 v187, v165, v173
    v_fmac_f32 v188, v166, v173
    v_fmac_f32 v189, v167, v173
    buffer_load_dwordx4 v245, s[32:35], s16 offen offset:1024  lds
    v_fmac_f32 v190, v168, v173
    v_fmac_f32 v191, v169, v173
    v_fmac_f32 v184, v163, v172
    v_fmac_f32 v185, v164, v172
    v_fmac_f32 v186, v165, v172
    buffer_load_dwordx4 v246, s[32:35], s16 offen offset:2048  lds
    v_fmac_f32 v187, v166, v172
    v_fmac_f32 v188, v167, v172
    v_fmac_f32 v189, v168, v172
    v_fmac_f32 v190, v169, v172
    v_fmac_f32 v191, v170, v172
    v_mul_f32 v184, v184, v176
    v_mul_f32 v185, v185, v177
    v_mul_f32 v186, v186, v178
    v_mul_f32 v187, v187, v179
    v_mul_f32 v188, v188, v180
    v_mul_f32 v189, v189, v181
    v_mul_f32 v190, v190, v182
    v_mul_f32 v191, v191, v183
    v_cvt_pk_bf16_f32 v108, v191, v190
    v_cvt_pk_bf16_f32 v109, v189, v188
    v_cvt_pk_bf16_f32 v110, v187, v186
    v_cvt_pk_bf16_f32 v111, v185, v184
    s_mov_b32 s89, 32768
    buffer_store_dwordx4 v[108:111], v12, s[52:55], s89 offen sc1
    s_waitcnt vmcnt(13)
    s_barrier
    s_add_u32 s97, s98, s0
    s_lshr_b64 s[0:1], s[0:1], 4
    s_and_b32 s97, s97, 15
    s_lshr_b32 s99, s97, 3
    s_xor_b32 s97, s97, s99
    s_add_u32 m0, s87, 36864
    s_lshl_b32 s97, s97, 7
    buffer_load_dwordx4 v240, s[28:31], s97 offen offset:0  lds
    v_and_b32 v160, 0xffff0000, v41
    v_and_b32 v161, 0xffff0000, v43
    v_and_b32 v162, 0xffff0000, v45
    v_and_b32 v163, 0xffff0000, v47
    v_and_b32 v164, 0xffff0000, v49
    buffer_load_dwordx4 v241, s[28:31], s97 offen offset:1024  lds
    v_and_b32 v165, 0xffff0000, v51
    v_and_b32 v166, 0xffff0000, v53
    v_and_b32 v167, 0xffff0000, v55
    v_and_b32 v168, 0xffff0000, v57
    v_and_b32 v169, 0xffff0000, v59
    s_mul_i32 s16, s97, 3072
    s_add_u32 m0, s60, 49152
    s_add_u32 s99, s16, s62
    buffer_load_dwordx4 v244, s[32:35], s99 offen offset:0  lds
    v_and_b32 v170, 0xffff0000, v61
    v_lshlrev_b32 v172, 16, v90
    v_and_b32 v173, 0xffff0000, v90
    v_lshlrev_b32 v174, 16, v91
    v_and_b32 v175, 0xffff0000, v91
    buffer_load_dwordx4 v245, s[32:35], s99 offen offset:1024  lds
    v_and_b32 v176, 0xffff0000, v69
    v_and_b32 v177, 0xffff0000, v71
    v_and_b32 v178, 0xffff0000, v73
    v_and_b32 v179, 0xffff0000, v75
    v_and_b32 v180, 0xffff0000, v77
    buffer_load_dwordx4 v246, s[32:35], s99 offen offset:2048  lds
    v_and_b32 v181, 0xffff0000, v79
    v_and_b32 v182, 0xffff0000, v81
    v_and_b32 v183, 0xffff0000, v83
    v_mul_f32 v184, v160, v175
    v_mul_f32 v185, v161, v175
    s_add_u32 m0, s87, 36864
    s_nop 0
    buffer_load_dwordx4 v242, s[28:31], s97 offen offset:2048  lds
    v_mul_f32 v186, v162, v175
    v_mul_f32 v187, v163, v175
    v_mul_f32 v188, v164, v175
    v_mul_f32 v189, v165, v175
    v_mul_f32 v190, v166, v175
    buffer_load_dwordx4 v243, s[28:31], s97 offen offset:3072  lds
    v_mul_f32 v191, v167, v175
    v_fmac_f32 v184, v161, v174
    v_fmac_f32 v185, v162, v174
    v_fmac_f32 v186, v163, v174
    v_fmac_f32 v187, v164, v174
    s_add_u32 m0, s88, 36864
    s_mov_b64 exec, 0xffffffff
    buffer_load_dwordx4 v3, s[28:31], s97 offen offset:0  lds
    s_mov_b64 exec, -1
    v_fmac_f32 v188, v165, v174
    v_fmac_f32 v189, v166, v174
    v_fmac_f32 v190, v167, v174
    v_fmac_f32 v191, v168, v174
    v_fmac_f32 v184, v162, v173
    s_add_u32 m0, s61, 61440
    s_add_u32 s16, s16, s63
    buffer_load_dwordx4 v244, s[32:35], s16 offen offset:0  lds
    v_fmac_f32 v185, v163, v173
    v_fmac_f32 v186, v164, v173
    v_fmac_f32 v187, v165, v173
    v_fmac_f32 v188, v166, v173
    v_fmac_f32 v189, v167, v173
    buffer_load_dwordx4 v245, s[32:35], s16 offen offset:1024  lds
    v_fmac_f32 v190, v168, v173
    v_fmac_f32 v191, v169, v173
    v_fmac_f32 v184, v163, v172
    v_fmac_f32 v185, v164, v172
    v_fmac_f32 v186, v165, v172
    buffer_load_dwordx4 v246, s[32:35], s16 offen offset:2048  lds
    v_fmac_f32 v187, v166, v172
    v_fmac_f32 v188, v167, v172
    v_fmac_f32 v189, v168, v172
    v_fmac_f32 v190, v169, v172
    v_fmac_f32 v191, v170, v172
    v_mul_f32 v184, v184, v176
    v_mul_f32 v185, v185, v177
    v_mul_f32 v186, v186, v178
    v_mul_f32 v187, v187, v179
    v_mul_f32 v188, v188, v180
    v_mul_f32 v189, v189, v181
    v_mul_f32 v190, v190, v182
    v_mul_f32 v191, v191, v183
    v_cvt_pk_bf16_f32 v112, v191, v190
    v_cvt_pk_bf16_f32 v113, v189, v188
    v_cvt_pk_bf16_f32 v114, v187, v186
    v_cvt_pk_bf16_f32 v115, v185, v184
    s_mov_b32 s89, 49152
    buffer_store_dwordx4 v[112:115], v12, s[52:55], s89 offen sc1
    s_waitcnt vmcnt(13)
    s_barrier
    s_add_u32 s97, s98, s0
    s_lshr_b64 s[0:1], s[0:1], 4
    s_and_b32 s97, s97, 15
    s_lshr_b32 s99, s97, 3
    s_xor_b32 s97, s97, s99
    s_add_u32 m0, s87, 0
    s_lshl_b32 s97, s97, 7
    buffer_load_dwordx4 v240, s[28:31], s97 offen offset:0  lds
    s_mov_b32 s68, s24
    s_mov_b32 s69, s25
    s_mov_b32 s70, 0x100
    s_mov_b32 s71, 0x20000
    v_lshrrev_b32 v6, 5, v0
    buffer_load_dwordx4 v241, s[28:31], s97 offen offset:1024  lds
    v_and_b32 v7, 3, v0
    s_lshr_b32 s78, s90, 1
    s_lshl_b32 s78, s78, 2
    s_load_dword s92, s[14:15], s78
    v_bfe_u32 v5, v0, 2, 2
    s_mul_i32 s16, s97, 3072
    s_add_u32 m0, s60, 0
    s_add_u32 s99, s16, s62
    buffer_load_dwordx4 v244, s[32:35], s99 offen offset:0  lds
    v_lshlrev_b32 v5, 1, v5
    v_lshl_add_u32 v5, v6, 3, v5
    v_bfe_u32 v8, v0, 4, 1
    v_add_u32 v5, v5, v8
    s_and_b32 s78, s3, 1
    buffer_load_dwordx4 v245, s[32:35], s99 offen offset:1024  lds
    s_lshl_b32 s78, s78, 1
    v_add_u32 v8, s78, v6
    v_xor_b32 v8, v8, v7
    v_lshlrev_b32 v8, 4, v8
    buffer_load_dwordx4 v246, s[32:35], s99 offen offset:2048  lds
    v_lshl_add_u32 v5, v5, 6, v8
    v_add_u32 v14, s86, v5
    v_mov_b32 v18, 162304
    v_mov_b32 v19, 1
    v_and_b32 v5, 3, v0
    s_add_u32 m0, s87, 0
    s_nop 0
    buffer_load_dwordx4 v242, s[28:31], s97 offen offset:2048  lds
    s_lshl_b32 s78, s74, 4
    s_add_u32 s78, s78, s3
    v_lshl_add_u32 v6, v5, 2, s78
    s_lshr_b32 s78, s76, 3
    s_lshl_b32 s79, s3, 1
    buffer_load_dwordx4 v243, s[28:31], s97 offen offset:3072  lds
    s_add_u32 s78, s78, s79
    s_xor_b32 s78, s78, 2
    s_lshl_b32 s78, s78, 5
    s_and_b32 s79, s76, 7
    s_add_u32 s78, s78, s79
    s_add_u32 m0, s88, 0
    s_mov_b64 exec, 0xffffffff
    buffer_load_dwordx4 v3, s[28:31], s97 offen offset:0  lds
    s_mov_b64 exec, -1
    v_lshl_add_u32 v7, v5, 3, s78
    v_and_b32 v8, 4, v0
    v_cmp_eq_u32 vcc, 0, v8
    s_nop 1
    v_cndmask_b32 v6, v7, v6, vcc
    s_add_u32 m0, s61, 12288
    s_add_u32 s16, s16, s63
    buffer_load_dwordx4 v244, s[32:35], s16 offen offset:0  lds
    v_and_b32 v33, 0xf0, v6
    v_lshlrev_b32 v34, 8, v6
    v_add_u32 v34, 12582912, v34
    v_and_b32 v5, 15, v0
    v_lshrrev_b32 v6, 4, v0
    buffer_load_dwordx4 v245, s[32:35], s16 offen offset:1024  lds
    v_add_u32 v7, 9, v5
    v_and_b32 v8, 1, v7
    v_mul_u32_u24 v8, 4160, v8
    v_lshrrev_b32 v7, 1, v7
    v_lshl_add_u32 v8, v7, 2, v8
    buffer_load_dwordx4 v246, s[32:35], s16 offen offset:2048  lds
    v_lshlrev_b32 v7, 4, v6
    v_sub_u32 v8, v8, v7
    s_add_u32 s78, s94, 32
    v_add_u32 v21, s78, v8
    s_waitcnt vmcnt(12)
    s_waitcnt vmcnt(11)
    s_barrier
    s_add_u32 m0, s94, 32
    s_lshl_b32 s89, s90, 12
    buffer_load_dwordx4 v15, s[48:51], s89 offen offset:0 nt lds
    v_add_u32 v22, 1024, v21
    v_add_u32 v23, 2048, v21
    v_add_u32 v24, 3072, v21
    v_lshl_add_u32 v7, v5, 1, v6
    s_add_u32 m0, s94, 32
    s_lshl_b32 s89, s90, 12
    buffer_load_dwordx4 v15, s[48:51], s89 offen offset:1024 nt lds
    v_add_u32 v7, 30, v7
    v_and_b32 v8, 1, v7
    v_bfe_u32 v136, v7, 1, 2
    s_add_u32 m0, s94, 32
    s_lshl_b32 s89, s90, 12
    buffer_load_dwordx4 v15, s[48:51], s89 offen offset:2048 nt lds
    v_lshl_add_u32 v136, v8, 2, v136
    v_lshlrev_b32 v136, 6, v136
    v_lshrrev_b32 v7, 3, v7
    v_lshl_add_u32 v136, v7, 9, v136
    s_add_u32 m0, s94, 32
    s_lshl_b32 s89, s90, 12
    buffer_load_dwordx4 v15, s[48:51], s89 offen offset:3072 nt lds
    v_bitop3_b32 v8, v7, 3, s3 bitop3:0x6a
    v_lshl_add_u32 v25, v8, 4, v136
    v_add_u32 v25, 92160, v25
    s_add_u32 s97, s98, s0
    s_lshr_b64 s[0:1], s[0:1], 4
    s_and_b32 s97, s97, 15
    s_lshr_b32 s99, s97, 3
    s_xor_b32 s97, s97, s99
    s_add_u32 m0, s87, 18432
    s_lshl_b32 s97, s97, 7
    buffer_load_dwordx4 v240, s[28:31], s97 offen offset:0  lds
    v_subrev_u32 v7, 1, v7
    v_bitop3_b32 v8, v7, 3, s3 bitop3:0x6a
    v_lshl_add_u32 v27, v8, 4, v136
    v_add_u32 v27, 91648, v27
    buffer_load_dwordx4 v241, s[28:31], s97 offen offset:1024  lds
    v_subrev_u32 v7, 1, v7
    v_bitop3_b32 v8, v7, 3, s3 bitop3:0x6a
    v_lshl_add_u32 v29, v8, 4, v136
    s_mul_i32 s16, s97, 3072
    s_add_u32 m0, s60, 24576
    s_add_u32 s99, s16, s62
    buffer_load_dwordx4 v244, s[32:35], s99 offen offset:0  lds
    v_add_u32 v29, 91136, v29
    v_subrev_u32 v7, 1, v7
    v_bitop3_b32 v8, v7, 3, s3 bitop3:0x6a
    v_lshl_add_u32 v31, v8, 4, v136
    buffer_load_dwordx4 v245, s[32:35], s99 offen offset:1024  lds
    v_add_u32 v31, 90624, v31
    v_lshl_add_u32 v7, v5, 1, v6
    v_add_u32 v7, 26, v7
    buffer_load_dwordx4 v246, s[32:35], s99 offen offset:2048  lds
    v_and_b32 v8, 1, v7
    v_bfe_u32 v136, v7, 1, 2
    v_lshl_add_u32 v136, v8, 2, v136
    v_lshlrev_b32 v136, 6, v136
    s_add_u32 m0, s87, 18432
    s_nop 0
    buffer_load_dwordx4 v242, s[28:31], s97 offen offset:2048  lds
    v_lshrrev_b32 v7, 3, v7
    v_lshl_add_u32 v136, v7, 9, v136
    v_bitop3_b32 v8, v7, 3, s3 bitop3:0x6a
    buffer_load_dwordx4 v243, s[28:31], s97 offen offset:3072  lds
    v_lshl_add_u32 v26, v8, 4, v136
    v_add_u32 v26, 92160, v26
    v_subrev_u32 v7, 1, v7
    v_bitop3_b32 v8, v7, 3, s3 bitop3:0x6a
    s_add_u32 m0, s88, 18432
    s_mov_b64 exec, 0xffffffff
    buffer_load_dwordx4 v3, s[28:31], s97 offen offset:0  lds
    s_mov_b64 exec, -1
    v_lshl_add_u32 v28, v8, 4, v136
    v_add_u32 v28, 91648, v28
    v_subrev_u32 v7, 1, v7
    s_add_u32 m0, s61, 36864
    s_add_u32 s16, s16, s63
    buffer_load_dwordx4 v244, s[32:35], s16 offen offset:0  lds
    v_bitop3_b32 v8, v7, 3, s3 bitop3:0x6a
    v_lshl_add_u32 v30, v8, 4, v136
    v_add_u32 v30, 91136, v30
    v_subrev_u32 v7, 1, v7
    buffer_load_dwordx4 v245, s[32:35], s16 offen offset:1024  lds
    v_bitop3_b32 v8, v7, 3, s3 bitop3:0x6a
    v_lshl_add_u32 v32, v8, 4, v136
    v_add_u32 v32, 90624, v32
    buffer_load_dwordx4 v246, s[32:35], s16 offen offset:2048  lds
    v_lshrrev_b32 v7, 1, v6
    v_lshl_add_u32 v7, v5, 1, v7
    v_add_u32 v7, 32, v7
    s_waitcnt vmcnt(15)
    s_barrier
    s_add_u32 s97, s98, s0
    s_lshr_b64 s[0:1], s[0:1], 4
    s_and_b32 s97, s97, 15
    s_lshr_b32 s99, s97, 3
    s_xor_b32 s97, s97, s99
    s_add_u32 m0, s87, 36864
    s_lshl_b32 s97, s97, 7
    buffer_load_dwordx4 v240, s[28:31], s97 offen offset:0  lds
    v_and_b32 v8, 1, v7
    v_bfe_u32 v136, v7, 1, 2
    v_lshl_add_u32 v136, v8, 2, v136
    v_lshlrev_b32 v136, 6, v136
    buffer_load_dwordx4 v241, s[28:31], s97 offen offset:1024  lds
    v_lshrrev_b32 v7, 3, v7
    v_lshl_add_u32 v136, v7, 9, v136
    v_bitop3_b32 v8, v7, 3, s3 bitop3:0x6a
    v_lshl_add_u32 v20, v8, 4, v136
    s_mul_i32 s16, s97, 3072
    s_add_u32 m0, s60, 49152
    s_add_u32 s99, s16, s62
    buffer_load_dwordx4 v244, s[32:35], s99 offen offset:0  lds
    v_add_u32 v20, 92160, v20
    v_and_b32 v8, 1, v6
    v_xor_b32 v8, 1, v8
    v_lshl_add_u32 v20, v8, 3, v20
    buffer_load_dwordx4 v245, s[32:35], s99 offen offset:1024  lds
    s_waitcnt lgkmcnt(0)
    s_and_b32 s78, s92, 0xffff0000
    s_lshl_b32 s92, s92, 16
    s_bitcmp1_b32 s90, 0
    s_cselect_b32 s92, s78, s92
    buffer_load_dwordx4 v246, s[32:35], s99 offen offset:2048  lds
    v_lshlrev_b32 v7, 3, v6
    v_sub_u32 v7, v7, v5
    v_subrev_u32 v7, 9, v7
    v_and_b32 v8, 1, v7
    s_add_u32 m0, s87, 36864
    s_nop 0
    buffer_load_dwordx4 v242, s[28:31], s97 offen offset:2048  lds
    v_xor_b32 v8, 1, v8
    v_lshlrev_b32 v8, 4, v8
    v_lshrrev_b32 v8, v8, s92
    v_ashrrev_i32 v7, 1, v7
    buffer_load_dwordx4 v243, s[28:31], s97 offen offset:3072  lds
    v_cmp_eq_u32 vcc, 0, v7
    s_nop 1
    v_cndmask_b32 v236, 0, v8, vcc
    v_cmp_eq_u32 vcc, 1, v7
    s_nop 1
    v_cndmask_b32 v237, 0, v8, vcc
    s_add_u32 m0, s88, 36864
    s_mov_b64 exec, 0xffffffff
    buffer_load_dwordx4 v3, s[28:31], s97 offen offset:0  lds
    s_mov_b64 exec, -1
    v_cmp_eq_u32 vcc, 2, v7
    s_nop 1
    v_cndmask_b32 v238, 0, v8, vcc
    v_cmp_eq_u32 vcc, 3, v7
    s_nop 1
    v_cndmask_b32 v239, 0, v8, vcc
    s_add_u32 m0, s61, 61440
    s_add_u32 s16, s16, s63
    buffer_load_dwordx4 v244, s[32:35], s16 offen offset:0  lds
    s_and_b32 s78, s77, 7
    s_mov_b32 s95, 0x76543210
    s_cmp_eq_u32 s78, 1
    s_cselect_b32 s95, 0x76543201, s95
    s_cmp_eq_u32 s78, 2
    s_cselect_b32 s95, 0x76543120, s95
    s_cmp_eq_u32 s78, 3
    s_cselect_b32 s95, 0x76542310, s95
    s_cmp_eq_u32 s78, 4
    s_cselect_b32 s95, 0x76534210, s95
    s_cmp_eq_u32 s78, 5
    s_cselect_b32 s95, 0x76453210, s95
    s_cmp_eq_u32 s78, 6
    s_cselect_b32 s95, 0x75643210, s95
    s_cmp_eq_u32 s78, 7
    s_cselect_b32 s95, 0x67543210, s95
    s_and_b32 s78, s76, 3
    s_mul_i32 s78, s78, 0x22222222
    s_add_u32 s95, s95, s78
    s_bfe_u32 s100, s95, 0x3001c
    s_lshl_b32 s100, s100, 18
    s_bfe_u32 s95, s95, 0x30018
    s_lshl_b32 s95, s95, 18
    v_lshrrev_b32 v136, 4, v0
    v_lshlrev_b32 v136, 1, v136
    v_and_b32 v137, 7, v0
    buffer_load_dwordx4 v245, s[32:35], s16 offen offset:1024  lds
    v_xor_b32 v136, v136, v137
    v_lshlrev_b32 v136, 4, v136
    v_lshrrev_b32 v137, 3, v0
    v_lshl_add_u32 v136, v137, 11, v136
    buffer_load_dwordx4 v246, s[32:35], s16 offen offset:2048  lds
    s_lshl_b32 s78, s77, 7
    s_lshl_b32 s79, s3, 14
    s_add_u32 s78, s78, s79
    v_add_u32 v17, s78, v136
    s_waitcnt vmcnt(11)
    s_barrier
    s_add_u32 s97, s98, s0
    s_lshr_b64 s[0:1], s[0:1], 4
    s_and_b32 s97, s97, 15
    s_lshr_b32 s99, s97, 3
    s_xor_b32 s97, s97, s99
    s_add_u32 m0, s87, 0
    s_lshl_b32 s97, s97, 7
    buffer_load_dwordx4 v240, s[28:31], s97 offen offset:0  lds
    v_add_u32 v5, s94, v15
    ds_read_b128 v[140:143], v5 offset:32
    ds_read_b32 v156, v5 offset:48
    ds_read_b128 v[144:147], v5 offset:1056
    buffer_load_dwordx4 v241, s[28:31], s97 offen offset:1024  lds
    ds_read_b32 v157, v5 offset:1072
    ds_read_b128 v[148:151], v5 offset:2080
    ds_read_b32 v158, v5 offset:2096
    s_mul_i32 s16, s97, 3072
    s_add_u32 m0, s60, 0
    s_add_u32 s99, s16, s62
    buffer_load_dwordx4 v244, s[32:35], s99 offen offset:0  lds
    ds_read_b128 v[152:155], v5 offset:3104
    ds_read_b32 v159, v5 offset:3120
    v_lshrrev_b32 v6, 3, v0
    buffer_load_dwordx4 v245, s[32:35], s99 offen offset:1024  lds
    v_mul_u32_u24 v6, 4160, v6
    v_and_b32 v7, 7, v0
    v_lshl_add_u32 v6, v7, 2, v6
    v_add_u32 v6, s94, v6
    buffer_load_dwordx4 v246, s[32:35], s99 offen offset:2048  lds
    v_mov_b32 v7, 0
    s_waitcnt lgkmcnt(0)
    v_readfirstlane_b32 s93, v140
    s_add_u32 m0, s87, 0
    s_nop 0
    buffer_load_dwordx4 v242, s[28:31], s97 offen offset:2048  lds
    s_lshl_b32 s93, s93, 16
    v_writelane_b32 v7, s93, 15
    v_alignbit_b32 v140, v141, v140, 16
    buffer_load_dwordx4 v243, s[28:31], s97 offen offset:3072  lds
    v_alignbit_b32 v141, v142, v141, 16
    v_alignbit_b32 v142, v143, v142, 16
    v_alignbit_b32 v143, v156, v143, 16
    v_alignbit_b32 v144, v145, v144, 16
    s_add_u32 m0, s88, 0
    s_mov_b64 exec, 0xffffffff
    buffer_load_dwordx4 v3, s[28:31], s97 offen offset:0  lds
    s_mov_b64 exec, -1
    v_alignbit_b32 v145, v146, v145, 16
    v_alignbit_b32 v146, v147, v146, 16
    v_alignbit_b32 v147, v157, v147, 16
    s_add_u32 m0, s61, 12288
    s_add_u32 s16, s16, s63
    buffer_load_dwordx4 v244, s[32:35], s16 offen offset:0  lds
    v_alignbit_b32 v148, v149, v148, 16
    v_alignbit_b32 v149, v150, v149, 16
    v_alignbit_b32 v150, v151, v150, 16
    buffer_load_dwordx4 v245, s[32:35], s16 offen offset:1024  lds
    v_alignbit_b32 v151, v158, v151, 16
    v_alignbit_b32 v152, v153, v152, 16
    v_alignbit_b32 v153, v154, v153, 16
    v_alignbit_b32 v154, v155, v154, 16
    buffer_load_dwordx4 v246, s[32:35], s16 offen offset:2048  lds
    v_alignbit_b32 v155, v159, v155, 16
    v_lshlrev_b32 v8, 3, v0
    s_add_u32 s78, s88, 18432
    s_mov_b64 exec, 0xff
    buffer_load_dword v136, v33, s[68:71], 0 offen sc1
    buffer_load_dword v137, v34, s[52:55], 0 offen sc1
    s_mov_b64 exec, -1
    v_add_u32 v8, s78, v8
    v_mov_b32 v156, 0
    v_mov_b32 v157, 0
    s_waitcnt vmcnt(13)
    s_barrier
    s_waitcnt vmcnt(0)
    s_branch LA_j
LA_c3:
    s_waitcnt vmcnt(7)
    s_barrier
    s_add_u32 m0, s88, 18432
    s_mov_b64 exec, 0xffffffff
    buffer_load_dwordx4 v3, s[28:31], s97 offen offset:0  lds
    s_mov_b64 exec, -1
    s_add_u32 m0, s61, 36864
    s_add_u32 s16, s16, s63
    buffer_load_dwordx4 v244, s[32:35], s16 offen offset:0  lds
    buffer_load_dwordx4 v245, s[32:35], s16 offen offset:1024  lds
    buffer_load_dwordx4 v246, s[32:35], s16 offen offset:2048  lds
    s_add_u32 s97, s98, s0
    s_lshr_b64 s[0:1], s[0:1], 4
    s_and_b32 s97, s97, 15
    s_lshr_b32 s99, s97, 3
    s_xor_b32 s97, s97, s99
    s_add_u32 m0, s87, 36864
    s_lshl_b32 s97, s97, 7
    buffer_load_dwordx4 v240, s[28:31], s97 offen offset:0  lds
    buffer_load_dwordx4 v241, s[28:31], s97 offen offset:1024  lds
    s_mul_i32 s16, s97, 3072
    s_add_u32 m0, s60, 49152
    s_add_u32 s99, s16, s62
    buffer_load_dwordx4 v244, s[32:35], s99 offen offset:0  lds
    buffer_load_dwordx4 v245, s[32:35], s99 offen offset:1024  lds
    buffer_load_dwordx4 v246, s[32:35], s99 offen offset:2048  lds
    s_add_u32 m0, s87, 36864
    s_nop 0
    buffer_load_dwordx4 v242, s[28:31], s97 offen offset:2048  lds
    buffer_load_dwordx4 v243, s[28:31], s97 offen offset:3072  lds
    s_add_u32 m0, s88, 36864
    s_mov_b64 exec, 0xffffffff
    buffer_load_dwordx4 v3, s[28:31], s97 offen offset:0  lds
    s_mov_b64 exec, -1
    s_add_u32 m0, s61, 61440
    s_add_u32 s16, s16, s63
    buffer_load_dwordx4 v244, s[32:35], s16 offen offset:0  lds
    buffer_load_dwordx4 v245, s[32:35], s16 offen offset:1024  lds
    buffer_load_dwordx4 v246, s[32:35], s16 offen offset:2048  lds
    s_waitcnt vmcnt(11)
    s_barrier
    s_add_u32 s97, s98, s0
    s_lshr_b64 s[0:1], s[0:1], 4
    s_and_b32 s97, s97, 15
    s_lshr_b32 s99, s97, 3
    s_xor_b32 s97, s97, s99
    s_add_u32 m0, s87, 0
    s_lshl_b32 s97, s97, 7
    buffer_load_dwordx4 v240, s[28:31], s97 offen offset:0  lds
    buffer_load_dwordx4 v241, s[28:31], s97 offen offset:1024  lds
    s_mul_i32 s16, s97, 3072
    s_add_u32 m0, s60, 0
    s_add_u32 s99, s16, s62
    buffer_load_dwordx4 v244, s[32:35], s99 offen offset:0  lds
    buffer_load_dwordx4 v245, s[32:35], s99 offen offset:1024  lds
    buffer_load_dwordx4 v246, s[32:35], s99 offen offset:2048  lds
    s_add_u32 m0, s87, 0
    s_nop 0
    buffer_load_dwordx4 v242, s[28:31], s97 offen offset:2048  lds
    buffer_load_dwordx4 v243, s[28:31], s97 offen offset:3072  lds
    s_add_u32 m0, s88, 0
    s_mov_b64 exec, 0xffffffff
    buffer_load_dwordx4 v3, s[28:31], s97 offen offset:0  lds
    s_mov_b64 exec, -1
    s_add_u32 m0, s61, 12288
    s_add_u32 s16, s16, s63
    buffer_load_dwordx4 v244, s[32:35], s16 offen offset:0  lds
    buffer_load_dwordx4 v245, s[32:35], s16 offen offset:1024  lds
    buffer_load_dwordx4 v246, s[32:35], s16 offen offset:2048  lds
    s_waitcnt vmcnt(11)
    s_barrier
    s_add_u32 s97, s98, s0
    s_lshr_b64 s[0:1], s[0:1], 4
    s_and_b32 s97, s97, 15
    s_lshr_b32 s99, s97, 3
    s_xor_b32 s97, s97, s99
    s_add_u32 m0, s87, 18432
    s_lshl_b32 s97, s97, 7
    buffer_load_dwordx4 v240, s[28:31], s97 offen offset:0  lds
    buffer_load_dwordx4 v241, s[28:31], s97 offen offset:1024  lds
    s_mul_i32 s16, s97, 3072
    s_add_u32 m0, s60, 24576
    s_add_u32 s99, s16, s62
    buffer_load_dwordx4 v244, s[32:35], s99 offen offset:0  lds
    buffer_load_dwordx4 v245, s[32:35], s99 offen offset:1024  lds
    buffer_load_dwordx4 v246, s[32:35], s99 offen offset:2048  lds
    s_add_u32 m0, s87, 18432
    s_nop 0
    buffer_load_dwordx4 v242, s[28:31], s97 offen offset:2048  lds
    buffer_load_dwordx4 v243, s[28:31], s97 offen offset:3072  lds
    s_add_u32 m0, s88, 18432
    s_mov_b64 exec, 0xffffffff
    buffer_load_dwordx4 v3, s[28:31], s97 offen offset:0  lds
    s_mov_b64 exec, -1
    s_add_u32 m0, s61, 36864
    s_add_u32 s16, s16, s63
    buffer_load_dwordx4 v244, s[32:35], s16 offen offset:0  lds
    buffer_load_dwordx4 v245, s[32:35], s16 offen offset:1024  lds
    buffer_load_dwordx4 v246, s[32:35], s16 offen offset:2048  lds
    s_waitcnt vmcnt(11)
    s_barrier
    s_add_u32 m0, s86, 129536
    s_mov_b32 s89, 0
    buffer_load_dwordx4 v10, s[36:39], s89 offen nt lds
    s_add_u32 m0, s86, 145920
    s_mov_b32 s89, 0
    buffer_load_dwordx4 v10, s[40:43], s89 offen nt lds
    s_add_u32 m0, s86, 133632
    s_mov_b32 s89, 65536
    buffer_load_dwordx4 v10, s[36:39], s89 offen nt lds
    s_add_u32 m0, s86, 150016
    s_mov_b32 s89, 65536
    buffer_load_dwordx4 v10, s[40:43], s89 offen nt lds
    s_add_u32 m0, s86, 137728
    s_mov_b32 s89, 131072
    buffer_load_dwordx4 v10, s[36:39], s89 offen nt lds
    s_add_u32 m0, s86, 154112
    s_mov_b32 s89, 131072
    buffer_load_dwordx4 v10, s[40:43], s89 offen nt lds
    s_add_u32 m0, s86, 141824
    s_mov_b32 s89, 196608
    buffer_load_dwordx4 v10, s[36:39], s89 offen nt lds
    s_add_u32 m0, s86, 158208
    s_mov_b32 s89, 196608
    buffer_load_dwordx4 v10, s[40:43], s89 offen nt lds
    s_mov_b64 exec, 0xff
    s_lshl_b32 s82, s3, 7
    s_add_u32 m0, s82, 129024
    s_mov_b32 s89, 0
    buffer_load_dwordx4 v11, s[36:39], s89 offen nt lds
    s_lshl_b32 s83, s74, 9
    s_add_u32 s83, s83, s82
    s_and_b32 s89, s3, 2
    s_lshl_b32 s89, s89, 3
    s_add_u32 s82, s82, s89
    s_add_u32 m0, s82, 162816
    s_add_u32 s89, s83, 0
    buffer_load_dwordx4 v15, s[44:47], s89 offen  lds
    s_mov_b64 exec, -1
    s_add_u32 s97, s98, s0
    s_lshr_b64 s[0:1], s[0:1], 4
    s_and_b32 s97, s97, 15
    s_lshr_b32 s99, s97, 3
    s_xor_b32 s97, s97, s99
    s_add_u32 m0, s87, 36864
    s_lshl_b32 s97, s97, 7
    buffer_load_dwordx4 v240, s[28:31], s97 offen offset:0  lds
    buffer_load_dwordx4 v241, s[28:31], s97 offen offset:1024  lds
    s_mul_i32 s16, s97, 3072
    s_add_u32 m0, s60, 49152
    s_add_u32 s99, s16, s62
    buffer_load_dwordx4 v244, s[32:35], s99 offen offset:0  lds
    buffer_load_dwordx4 v245, s[32:35], s99 offen offset:1024  lds
    buffer_load_dwordx4 v246, s[32:35], s99 offen offset:2048  lds
    s_add_u32 m0, s87, 36864
    s_nop 0
    buffer_load_dwordx4 v242, s[28:31], s97 offen offset:2048  lds
    buffer_load_dwordx4 v243, s[28:31], s97 offen offset:3072  lds
    s_waitcnt vmcnt(17)
    s_barrier
    s_add_u32 m0, s88, 36864
    s_mov_b64 exec, 0xffffffff
    buffer_load_dwordx4 v3, s[28:31], s97 offen offset:0  lds
    s_mov_b64 exec, -1
    s_add_u32 m0, s61, 61440
    s_add_u32 s16, s16, s63
    buffer_load_dwordx4 v244, s[32:35], s16 offen offset:0  lds
    buffer_load_dwordx4 v245, s[32:35], s16 offen offset:1024  lds
    buffer_load_dwordx4 v246, s[32:35], s16 offen offset:2048  lds
    s_add_u32 s97, s98, s0
    s_lshr_b64 s[0:1], s[0:1], 4
    s_and_b32 s97, s97, 15
    s_lshr_b32 s99, s97, 3
    s_xor_b32 s97, s97, s99
    s_add_u32 m0, s87, 0
    s_lshl_b32 s97, s97, 7
    buffer_load_dwordx4 v240, s[28:31], s97 offen offset:0  lds
    buffer_load_dwordx4 v241, s[28:31], s97 offen offset:1024  lds
    s_mul_i32 s16, s97, 3072
    s_add_u32 m0, s60, 0
    s_add_u32 s99, s16, s62
    buffer_load_dwordx4 v244, s[32:35], s99 offen offset:0  lds
    buffer_load_dwordx4 v245, s[32:35], s99 offen offset:1024  lds
    buffer_load_dwordx4 v246, s[32:35], s99 offen offset:2048  lds
    s_add_u32 m0, s87, 0
    s_nop 0
    buffer_load_dwordx4 v242, s[28:31], s97 offen offset:2048  lds
    buffer_load_dwordx4 v243, s[28:31], s97 offen offset:3072  lds
    s_add_u32 m0, s88, 0
    s_mov_b64 exec, 0xffffffff
    buffer_load_dwordx4 v3, s[28:31], s97 offen offset:0  lds
    s_mov_b64 exec, -1
    s_add_u32 m0, s61, 12288
    s_add_u32 s16, s16, s63
    buffer_load_dwordx4 v244, s[32:35], s16 offen offset:0  lds
    buffer_load_dwordx4 v245, s[32:35], s16 offen offset:1024  lds
    buffer_load_dwordx4 v246, s[32:35], s16 offen offset:2048  lds
    s_waitcnt vmcnt(11)
    s_barrier
    s_add_u32 s97, s98, s0
    s_lshr_b64 s[0:1], s[0:1], 4
    s_and_b32 s97, s97, 15
    s_lshr_b32 s99, s97, 3
    s_xor_b32 s97, s97, s99
    s_add_u32 m0, s87, 18432
    s_lshl_b32 s97, s97, 7
    buffer_load_dwordx4 v240, s[28:31], s97 offen offset:0  lds
    ds_read_b128 v[84:87], v35 offset:0
    ds_read_b128 v[88:91], v35 offset:16
    buffer_load_dwordx4 v241, s[28:31], s97 offen offset:1024  lds
    ds_read_b64 v[40:41], v16 offset:0
    ds_read_b64 v[42:43], v231 offset:256
    s_mul_i32 s16, s97, 3072
    s_add_u32 m0, s60, 24576
    s_add_u32 s99, s16, s62
    buffer_load_dwordx4 v244, s[32:35], s99 offen offset:0  lds
    ds_read_b64 v[44:45], v16 offset:256
    ds_read_b64 v[46:47], v16 offset:512
    buffer_load_dwordx4 v245, s[32:35], s99 offen offset:1024  lds
    ds_read_b64 v[48:49], v231 offset:512
    ds_read_b64 v[50:51], v16 offset:768
    buffer_load_dwordx4 v246, s[32:35], s99 offen offset:2048  lds
    ds_read_b64 v[52:53], v231 offset:768
    ds_read_b64 v[54:55], v16 offset:1024
    s_add_u32 m0, s87, 18432
    s_nop 0
    buffer_load_dwordx4 v242, s[28:31], s97 offen offset:2048  lds
    ds_read_b64 v[56:57], v231 offset:1024
    ds_read_b64 v[58:59], v16 offset:1280
    buffer_load_dwordx4 v243, s[28:31], s97 offen offset:3072  lds
    ds_read_b64 v[60:61], v231 offset:1280
    ds_read_b64 v[68:69], v16 offset:16896
    s_add_u32 m0, s88, 18432
    s_mov_b64 exec, 0xffffffff
    buffer_load_dwordx4 v3, s[28:31], s97 offen offset:0  lds
    s_mov_b64 exec, -1
    ds_read_b64 v[70:71], v231 offset:16896
    ds_read_b64 v[72:73], v16 offset:17152
    s_add_u32 m0, s61, 36864
    s_add_u32 s16, s16, s63
    buffer_load_dwordx4 v244, s[32:35], s16 offen offset:0  lds
    ds_read_b64 v[74:75], v231 offset:17152
    ds_read_b64 v[76:77], v16 offset:17408
    buffer_load_dwordx4 v245, s[32:35], s16 offen offset:1024  lds
    ds_read_b64 v[78:79], v231 offset:17408
    ds_read_b64 v[80:81], v16 offset:17664
    buffer_load_dwordx4 v246, s[32:35], s16 offen offset:2048  lds
    ds_read_b64 v[82:83], v231 offset:17664
    s_waitcnt vmcnt(11)
    s_waitcnt lgkmcnt(0)
    s_barrier
    s_add_u32 s97, s98, s0
    s_lshr_b64 s[0:1], s[0:1], 4
    s_and_b32 s97, s97, 15
    s_lshr_b32 s99, s97, 3
    s_xor_b32 s97, s97, s99
    s_add_u32 m0, s87, 36864
    s_lshl_b32 s97, s97, 7
    buffer_load_dwordx4 v240, s[28:31], s97 offen offset:0  lds
    v_lshlrev_b32 v160, 16, v40
    v_lshlrev_b32 v161, 16, v42
    v_lshlrev_b32 v162, 16, v44
    v_lshlrev_b32 v163, 16, v46
    v_lshlrev_b32 v164, 16, v48
    buffer_load_dwordx4 v241, s[28:31], s97 offen offset:1024  lds
    v_lshlrev_b32 v165, 16, v50
    v_lshlrev_b32 v166, 16, v52
    v_lshlrev_b32 v167, 16, v54
    v_lshlrev_b32 v168, 16, v56
    v_lshlrev_b32 v169, 16, v58
    s_mul_i32 s16, s97, 3072
    s_add_u32 m0, s60, 49152
    s_add_u32 s99, s16, s62
    buffer_load_dwordx4 v244, s[32:35], s99 offen offset:0  lds
    v_lshlrev_b32 v170, 16, v60
    v_lshlrev_b32 v172, 16, v84
    v_and_b32 v173, 0xffff0000, v84
    v_lshlrev_b32 v174, 16, v85
    v_and_b32 v175, 0xffff0000, v85
    buffer_load_dwordx4 v245, s[32:35], s99 offen offset:1024  lds
    v_lshlrev_b32 v176, 16, v68
    v_lshlrev_b32 v177, 16, v70
    v_lshlrev_b32 v178, 16, v72
    v_lshlrev_b32 v179, 16, v74
    v_lshlrev_b32 v180, 16, v76
    buffer_load_dwordx4 v246, s[32:35], s99 offen offset:2048  lds
    v_lshlrev_b32 v181, 16, v78
    v_lshlrev_b32 v182, 16, v80
    v_lshlrev_b32 v183, 16, v82
    v_mul_f32 v184, v160, v175
    v_mul_f32 v185, v161, v175
    s_add_u32 m0, s87, 36864
    s_nop 0
    buffer_load_dwordx4 v242, s[28:31], s97 offen offset:2048  lds
    v_mul_f32 v186, v162, v175
    v_mul_f32 v187, v163, v175
    v_mul_f32 v188, v164, v175
    v_mul_f32 v189, v165, v175
    v_mul_f32 v190, v166, v175
    buffer_load_dwordx4 v243, s[28:31], s97 offen offset:3072  lds
    v_mul_f32 v191, v167, v175
    v_fmac_f32 v184, v161, v174
    v_fmac_f32 v185, v162, v174
    v_fmac_f32 v186, v163, v174
    v_fmac_f32 v187, v164, v174
    s_add_u32 m0, s88, 36864
    s_mov_b64 exec, 0xffffffff
    buffer_load_dwordx4 v3, s[28:31], s97 offen offset:0  lds
    s_mov_b64 exec, -1
    v_fmac_f32 v188, v165, v174
    v_fmac_f32 v189, v166, v174
    v_fmac_f32 v190, v167, v174
    v_fmac_f32 v191, v168, v174
    v_fmac_f32 v184, v162, v173
    s_add_u32 m0, s61, 61440
    s_add_u32 s16, s16, s63
    buffer_load_dwordx4 v244, s[32:35], s16 offen offset:0  lds
    v_fmac_f32 v185, v163, v173
    v_fmac_f32 v186, v164, v173
    v_fmac_f32 v187, v165, v173
    v_fmac_f32 v188, v166, v173
    v_fmac_f32 v189, v167, v173
    buffer_load_dwordx4 v245, s[32:35], s16 offen offset:1024  lds
    v_fmac_f32 v190, v168, v173
    v_fmac_f32 v191, v169, v173
    v_fmac_f32 v184, v163, v172
    v_fmac_f32 v185, v164, v172
    v_fmac_f32 v186, v165, v172
    buffer_load_dwordx4 v246, s[32:35], s16 offen offset:2048  lds
    v_fmac_f32 v187, v166, v172
    v_fmac_f32 v188, v167, v172
    v_fmac_f32 v189, v168, v172
    v_fmac_f32 v190, v169, v172
    v_fmac_f32 v191, v170, v172
    v_mul_f32 v184, v184, v176
    v_mul_f32 v185, v185, v177
    v_mul_f32 v186, v186, v178
    v_mul_f32 v187, v187, v179
    v_mul_f32 v188, v188, v180
    v_mul_f32 v189, v189, v181
    v_mul_f32 v190, v190, v182
    v_mul_f32 v191, v191, v183
    v_cvt_pk_bf16_f32 v100, v191, v190
    v_cvt_pk_bf16_f32 v101, v189, v188
    v_cvt_pk_bf16_f32 v102, v187, v186
    v_cvt_pk_bf16_f32 v103, v185, v184
    s_mov_b32 s89, 0
    buffer_store_dwordx4 v[100:103], v12, s[52:55], s89 offen sc1
    s_waitcnt vmcnt(12)
    s_barrier
    s_add_u32 s97, s98, s0
    s_lshr_b64 s[0:1], s[0:1], 4
    s_and_b32 s97, s97, 15
    s_lshr_b32 s99, s97, 3
    s_xor_b32 s97, s97, s99
    s_add_u32 m0, s87, 0
    s_lshl_b32 s97, s97, 7
    buffer_load_dwordx4 v240, s[28:31], s97 offen offset:0  lds
    v_and_b32 v160, 0xffff0000, v40
    v_and_b32 v161, 0xffff0000, v42
    v_and_b32 v162, 0xffff0000, v44
    v_and_b32 v163, 0xffff0000, v46
    v_and_b32 v164, 0xffff0000, v48
    buffer_load_dwordx4 v241, s[28:31], s97 offen offset:1024  lds
    v_and_b32 v165, 0xffff0000, v50
    v_and_b32 v166, 0xffff0000, v52
    v_and_b32 v167, 0xffff0000, v54
    v_and_b32 v168, 0xffff0000, v56
    v_and_b32 v169, 0xffff0000, v58
    s_mul_i32 s16, s97, 3072
    s_add_u32 m0, s60, 0
    s_add_u32 s99, s16, s62
    buffer_load_dwordx4 v244, s[32:35], s99 offen offset:0  lds
    v_and_b32 v170, 0xffff0000, v60
    v_lshlrev_b32 v172, 16, v86
    v_and_b32 v173, 0xffff0000, v86
    v_lshlrev_b32 v174, 16, v87
    v_and_b32 v175, 0xffff0000, v87
    buffer_load_dwordx4 v245, s[32:35], s99 offen offset:1024  lds
    v_and_b32 v176, 0xffff0000, v68
    v_and_b32 v177, 0xffff0000, v70
    v_and_b32 v178, 0xffff0000, v72
    v_and_b32 v179, 0xffff0000, v74
    v_and_b32 v180, 0xffff0000, v76
    buffer_load_dwordx4 v246, s[32:35], s99 offen offset:2048  lds
    v_and_b32 v181, 0xffff0000, v78
    v_and_b32 v182, 0xffff0000, v80
    v_and_b32 v183, 0xffff0000, v82
    v_mul_f32 v184, v160, v175
    v_mul_f32 v185, v161, v175
    s_add_u32 m0, s87, 0
    s_nop 0
    buffer_load_dwordx4 v242, s[28:31], s97 offen offset:2048  lds
    v_mul_f32 v186, v162, v175
    v_mul_f32 v187, v163, v175
    v_mul_f32 v188, v164, v175
    v_mul_f32 v189, v165, v175
    v_mul_f32 v190, v166, v175
    buffer_load_dwordx4 v243, s[28:31], s97 offen offset:3072  lds
    v_mul_f32 v191, v167, v175
    v_fmac_f32 v184, v161, v174
    v_fmac_f32 v185, v162, v174
    v_fmac_f32 v186, v163, v174
    v_fmac_f32 v187, v164, v174
    s_add_u32 m0, s88, 0
    s_mov_b64 exec, 0xffffffff
    buffer_load_dwordx4 v3, s[28:31], s97 offen offset:0  lds
    s_mov_b64 exec, -1
    v_fmac_f32 v188, v165, v174
    v_fmac_f32 v189, v166, v174
    v_fmac_f32 v190, v167, v174
    v_fmac_f32 v191, v168, v174
    v_fmac_f32 v184, v162, v173
    s_add_u32 m0, s61, 12288
    s_add_u32 s16, s16, s63
    buffer_load_dwordx4 v244, s[32:35], s16 offen offset:0  lds
    v_fmac_f32 v185, v163, v173
    v_fmac_f32 v186, v164, v173
    v_fmac_f32 v187, v165, v173
    v_fmac_f32 v188, v166, v173
    v_fmac_f32 v189, v167, v173
    buffer_load_dwordx4 v245, s[32:35], s16 offen offset:1024  lds
    v_fmac_f32 v190, v168, v173
    v_fmac_f32 v191, v169, v173
    v_fmac_f32 v184, v163, v172
    v_fmac_f32 v185, v164, v172
    v_fmac_f32 v186, v165, v172
    buffer_load_dwordx4 v246, s[32:35], s16 offen offset:2048  lds
    v_fmac_f32 v187, v166, v172
    v_fmac_f32 v188, v167, v172
    v_fmac_f32 v189, v168, v172
    v_fmac_f32 v190, v169, v172
    v_fmac_f32 v191, v170, v172
    v_mul_f32 v184, v184, v176
    v_mul_f32 v185, v185, v177
    v_mul_f32 v186, v186, v178
    v_mul_f32 v187, v187, v179
    v_mul_f32 v188, v188, v180
    v_mul_f32 v189, v189, v181
    v_mul_f32 v190, v190, v182
    v_mul_f32 v191, v191, v183
    v_cvt_pk_bf16_f32 v104, v191, v190
    v_cvt_pk_bf16_f32 v105, v189, v188
    v_cvt_pk_bf16_f32 v106, v187, v186
    v_cvt_pk_bf16_f32 v107, v185, v184
    s_mov_b32 s89, 16384
    buffer_store_dwordx4 v[104:107], v12, s[52:55], s89 offen sc1
    s_waitcnt vmcnt(13)
    s_barrier
    s_add_u32 s97, s98, s0
    s_lshr_b64 s[0:1], s[0:1], 4
    s_and_b32 s97, s97, 15
    s_lshr_b32 s99, s97, 3
    s_xor_b32 s97, s97, s99
    s_add_u32 m0, s87, 18432
    s_lshl_b32 s97, s97, 7
    buffer_load_dwordx4 v240, s[28:31], s97 offen offset:0  lds
    v_lshlrev_b32 v160, 16, v41
    v_lshlrev_b32 v161, 16, v43
    v_lshlrev_b32 v162, 16, v45
    v_lshlrev_b32 v163, 16, v47
    v_lshlrev_b32 v164, 16, v49
    buffer_load_dwordx4 v241, s[28:31], s97 offen offset:1024  lds
    v_lshlrev_b32 v165, 16, v51
    v_lshlrev_b32 v166, 16, v53
    v_lshlrev_b32 v167, 16, v55
    v_lshlrev_b32 v168, 16, v57
    v_lshlrev_b32 v169, 16, v59
    s_mul_i32 s16, s97, 3072
    s_add_u32 m0, s60, 24576
    s_add_u32 s99, s16, s62
    buffer_load_dwordx4 v244, s[32:35], s99 offen offset:0  lds
    v_lshlrev_b32 v170, 16, v61
    v_lshlrev_b32 v172, 16, v88
    v_and_b32 v173, 0xffff0000, v88
    v_lshlrev_b32 v174, 16, v89
    v_and_b32 v175, 0xffff0000, v89
    buffer_load_dwordx4 v245, s[32:35], s99 offen offset:1024  lds
    v_lshlrev_b32 v176, 16, v69
    v_lshlrev_b32 v177, 16, v71
    v_lshlrev_b32 v178, 16, v73
    v_lshlrev_b32 v179, 16, v75
    v_lshlrev_b32 v180, 16, v77
    buffer_load_dwordx4 v246, s[32:35], s99 offen offset:2048  lds
    v_lshlrev_b32 v181, 16, v79
    v_lshlrev_b32 v182, 16, v81
    v_lshlrev_b32 v183, 16, v83
    v_mul_f32 v184, v160, v175
    v_mul_f32 v185, v161, v175
    s_add_u32 m0, s87, 18432
    s_nop 0
    buffer_load_dwordx4 v242, s[28:31], s97 offen offset:2048  lds
    v_mul_f32 v186, v162, v175
    v_mul_f32 v187, v163, v175
    v_mul_f32 v188, v164, v175
    v_mul_f32 v189, v165, v175
    v_mul_f32 v190, v166, v175
    buffer_load_dwordx4 v243, s[28:31], s97 offen offset:3072  lds
    v_mul_f32 v191, v167, v175
    v_fmac_f32 v184, v161, v174
    v_fmac_f32 v185, v162, v174
    v_fmac_f32 v186, v163, v174
    v_fmac_f32 v187, v164, v174
    s_add_u32 m0, s88, 18432
    s_mov_b64 exec, 0xffffffff
    buffer_load_dwordx4 v3, s[28:31], s97 offen offset:0  lds
    s_mov_b64 exec, -1
    v_fmac_f32 v188, v165, v174
    v_fmac_f32 v189, v166, v174
    v_fmac_f32 v190, v167, v174
    v_fmac_f32 v191, v168, v174
    v_fmac_f32 v184, v162, v173
    s_add_u32 m0, s61, 36864
    s_add_u32 s16, s16, s63
    buffer_load_dwordx4 v244, s[32:35], s16 offen offset:0  lds
    v_fmac_f32 v185, v163, v173
    v_fmac_f32 v186, v164, v173
    v_fmac_f32 v187, v165, v173
    v_fmac_f32 v188, v166, v173
    v_fmac_f32 v189, v167, v173
    buffer_load_dwordx4 v245, s[32:35], s16 offen offset:1024  lds
    v_fmac_f32 v190, v168, v173
    v_fmac_f32 v191, v169, v173
    v_fmac_f32 v184, v163, v172
    v_fmac_f32 v185, v164, v172
    v_fmac_f32 v186, v165, v172
    buffer_load_dwordx4 v246, s[32:35], s16 offen offset:2048  lds
    v_fmac_f32 v187, v166, v172
    v_fmac_f32 v188, v167, v172
    v_fmac_f32 v189, v168, v172
    v_fmac_f32 v190, v169, v172
    v_fmac_f32 v191, v170, v172
    v_mul_f32 v184, v184, v176
    v_mul_f32 v185, v185, v177
    v_mul_f32 v186, v186, v178
    v_mul_f32 v187, v187, v179
    v_mul_f32 v188, v188, v180
    v_mul_f32 v189, v189, v181
    v_mul_f32 v190, v190, v182
    v_mul_f32 v191, v191, v183
    v_cvt_pk_bf16_f32 v108, v191, v190
    v_cvt_pk_bf16_f32 v109, v189, v188
    v_cvt_pk_bf16_f32 v110, v187, v186
    v_cvt_pk_bf16_f32 v111, v185, v184
    s_mov_b32 s89, 32768
    buffer_store_dwordx4 v[108:111], v12, s[52:55], s89 offen sc1
    s_waitcnt vmcnt(13)
    s_barrier
    s_add_u32 s97, s98, s0
    s_lshr_b64 s[0:1], s[0:1], 4
    s_and_b32 s97, s97, 15
    s_lshr_b32 s99, s97, 3
    s_xor_b32 s97, s97, s99
    s_add_u32 m0, s87, 36864
    s_lshl_b32 s97, s97, 7
    buffer_load_dwordx4 v240, s[28:31], s97 offen offset:0  lds
    v_and_b32 v160, 0xffff0000, v41
    v_and_b32 v161, 0xffff0000, v43
    v_and_b32 v162, 0xffff0000, v45
    v_and_b32 v163, 0xffff0000, v47
    v_and_b32 v164, 0xffff0000, v49
    buffer_load_dwordx4 v241, s[28:31], s97 offen offset:1024  lds
    v_and_b32 v165, 0xffff0000, v51
    v_and_b32 v166, 0xffff0000, v53
    v_and_b32 v167, 0xffff0000, v55
    v_and_b32 v168, 0xffff0000, v57
    v_and_b32 v169, 0xffff0000, v59
    s_mul_i32 s16, s97, 3072
    s_add_u32 m0, s60, 49152
    s_add_u32 s99, s16, s62
    buffer_load_dwordx4 v244, s[32:35], s99 offen offset:0  lds
    v_and_b32 v170, 0xffff0000, v61
    v_lshlrev_b32 v172, 16, v90
    v_and_b32 v173, 0xffff0000, v90
    v_lshlrev_b32 v174, 16, v91
    v_and_b32 v175, 0xffff0000, v91
    buffer_load_dwordx4 v245, s[32:35], s99 offen offset:1024  lds
    v_and_b32 v176, 0xffff0000, v69
    v_and_b32 v177, 0xffff0000, v71
    v_and_b32 v178, 0xffff0000, v73
    v_and_b32 v179, 0xffff0000, v75
    v_and_b32 v180, 0xffff0000, v77
    buffer_load_dwordx4 v246, s[32:35], s99 offen offset:2048  lds
    v_and_b32 v181, 0xffff0000, v79
    v_and_b32 v182, 0xffff0000, v81
    v_and_b32 v183, 0xffff0000, v83
    v_mul_f32 v184, v160, v175
    v_mul_f32 v185, v161, v175
    s_add_u32 m0, s87, 36864
    s_nop 0
    buffer_load_dwordx4 v242, s[28:31], s97 offen offset:2048  lds
    v_mul_f32 v186, v162, v175
    v_mul_f32 v187, v163, v175
    v_mul_f32 v188, v164, v175
    v_mul_f32 v189, v165, v175
    v_mul_f32 v190, v166, v175
    buffer_load_dwordx4 v243, s[28:31], s97 offen offset:3072  lds
    v_mul_f32 v191, v167, v175
    v_fmac_f32 v184, v161, v174
    v_fmac_f32 v185, v162, v174
    v_fmac_f32 v186, v163, v174
    v_fmac_f32 v187, v164, v174
    s_add_u32 m0, s88, 36864
    s_mov_b64 exec, 0xffffffff
    buffer_load_dwordx4 v3, s[28:31], s97 offen offset:0  lds
    s_mov_b64 exec, -1
    v_fmac_f32 v188, v165, v174
    v_fmac_f32 v189, v166, v174
    v_fmac_f32 v190, v167, v174
    v_fmac_f32 v191, v168, v174
    v_fmac_f32 v184, v162, v173
    s_add_u32 m0, s61, 61440
    s_add_u32 s16, s16, s63
    buffer_load_dwordx4 v244, s[32:35], s16 offen offset:0  lds
    v_fmac_f32 v185, v163, v173
    v_fmac_f32 v186, v164, v173
    v_fmac_f32 v187, v165, v173
    v_fmac_f32 v188, v166, v173
    v_fmac_f32 v189, v167, v173
    buffer_load_dwordx4 v245, s[32:35], s16 offen offset:1024  lds
    v_fmac_f32 v190, v168, v173
    v_fmac_f32 v191, v169, v173
    v_fmac_f32 v184, v163, v172
    v_fmac_f32 v185, v164, v172
    v_fmac_f32 v186, v165, v172
    buffer_load_dwordx4 v246, s[32:35], s16 offen offset:2048  lds
    v_fmac_f32 v187, v166, v172
    v_fmac_f32 v188, v167, v172
    v_fmac_f32 v189, v168, v172
    v_fmac_f32 v190, v169, v172
    v_fmac_f32 v191, v170, v172
    v_mul_f32 v184, v184, v176
    v_mul_f32 v185, v185, v177
    v_mul_f32 v186, v186, v178
    v_mul_f32 v187, v187, v179
    v_mul_f32 v188, v188, v180
    v_mul_f32 v189, v189, v181
    v_mul_f32 v190, v190, v182
    v_mul_f32 v191, v191, v183
    v_cvt_pk_bf16_f32 v112, v191, v190
    v_cvt_pk_bf16_f32 v113, v189, v188
    v_cvt_pk_bf16_f32 v114, v187, v186
    v_cvt_pk_bf16_f32 v115, v185, v184
    s_mov_b32 s89, 49152
    buffer_store_dwordx4 v[112:115], v12, s[52:55], s89 offen sc1
    s_waitcnt vmcnt(13)
    s_barrier
    s_add_u32 s97, s98, s0
    s_lshr_b64 s[0:1], s[0:1], 4
    s_and_b32 s97, s97, 15
    s_lshr_b32 s99, s97, 3
    s_xor_b32 s97, s97, s99
    s_add_u32 m0, s87, 0
    s_lshl_b32 s97, s97, 7
    buffer_load_dwordx4 v240, s[28:31], s97 offen offset:0  lds
    s_mov_b32 s68, s24
    s_mov_b32 s69, s25
    s_mov_b32 s70, 0x100
    s_mov_b32 s71, 0x20000
    v_lshrrev_b32 v6, 5, v0
    buffer_load_dwordx4 v241, s[28:31], s97 offen offset:1024  lds
    v_and_b32 v7, 3, v0
    s_lshr_b32 s78, s90, 1
    s_lshl_b32 s78, s78, 2
    s_load_dword s92, s[14:15], s78
    v_bfe_u32 v5, v0, 2, 2
    s_mul_i32 s16, s97, 3072
    s_add_u32 m0, s60, 0
    s_add_u32 s99, s16, s62
    buffer_load_dwordx4 v244, s[32:35], s99 offen offset:0  lds
    v_lshlrev_b32 v5, 1, v5
    v_lshl_add_u32 v5, v6, 3, v5
    v_bfe_u32 v8, v0, 4, 1
    v_add_u32 v5, v5, v8
    s_and_b32 s78, s3, 1
    buffer_load_dwordx4 v245, s[32:35], s99 offen offset:1024  lds
    s_lshl_b32 s78, s78, 1
    v_add_u32 v8, s78, v6
    v_xor_b32 v8, v8, v7
    v_lshlrev_b32 v8, 4, v8
    buffer_load_dwordx4 v246, s[32:35], s99 offen offset:2048  lds
    v_lshl_add_u32 v5, v5, 6, v8
    v_add_u32 v14, s86, v5
    v_mov_b32 v18, 162304
    v_mov_b32 v19, 1
    v_and_b32 v5, 3, v0
    s_add_u32 m0, s87, 0
    s_nop 0
    buffer_load_dwordx4 v242, s[28:31], s97 offen offset:2048  lds
    s_lshl_b32 s78, s74, 4
    s_add_u32 s78, s78, s3
    v_lshl_add_u32 v6, v5, 2, s78
    s_lshr_b32 s78, s76, 3
    s_lshl_b32 s79, s3, 1
    buffer_load_dwordx4 v243, s[28:31], s97 offen offset:3072  lds
    s_add_u32 s78, s78, s79
    s_xor_b32 s78, s78, 2
    s_lshl_b32 s78, s78, 5
    s_and_b32 s79, s76, 7
    s_add_u32 s78, s78, s79
    s_add_u32 m0, s88, 0
    s_mov_b64 exec, 0xffffffff
    buffer_load_dwordx4 v3, s[28:31], s97 offen offset:0  lds
    s_mov_b64 exec, -1
    v_lshl_add_u32 v7, v5, 3, s78
    v_and_b32 v8, 4, v0
    v_cmp_eq_u32 vcc, 0, v8
    s_nop 1
    v_cndmask_b32 v6, v7, v6, vcc
    s_add_u32 m0, s61, 12288
    s_add_u32 s16, s16, s63
    buffer_load_dwordx4 v244, s[32:35], s16 offen offset:0  lds
    v_and_b32 v33, 0xf0, v6
    v_lshlrev_b32 v34, 8, v6
    v_add_u32 v34, 12582912, v34
    v_and_b32 v5, 15, v0
    v_lshrrev_b32 v6, 4, v0
    buffer_load_dwordx4 v245, s[32:35], s16 offen offset:1024  lds
    v_add_u32 v7, 9, v5
    v_and_b32 v8, 1, v7
    v_mul_u32_u24 v8, 4160, v8
    v_lshrrev_b32 v7, 1, v7
    v_lshl_add_u32 v8, v7, 2, v8
    buffer_load_dwordx4 v246, s[32:35], s16 offen offset:2048  lds
    v_lshlrev_b32 v7, 4, v6
    v_sub_u32 v8, v8, v7
    s_add_u32 s78, s94, 32
    v_add_u32 v21, s78, v8
    s_waitcnt vmcnt(12)
    s_waitcnt vmcnt(11)
    s_barrier
    s_add_u32 m0, s94, 32
    s_lshl_b32 s89, s90, 12
    buffer_load_dwordx4 v15, s[48:51], s89 offen offset:0 nt lds
    v_add_u32 v22, 1024, v21
    v_add_u32 v23, 2048, v21
    v_add_u32 v24, 3072, v21
    v_lshl_add_u32 v7, v5, 1, v6
    s_add_u32 m0, s94, 32
    s_lshl_b32 s89, s90, 12
    buffer_load_dwordx4 v15, s[48:51], s89 offen offset:1024 nt lds
    v_add_u32 v7, 30, v7
    v_and_b32 v8, 1, v7
    v_bfe_u32 v136, v7, 1, 2
    s_add_u32 m0, s94, 32
    s_lshl_b32 s89, s90, 12
    buffer_load_dwordx4 v15, s[48:51], s89 offen offset:2048 nt lds
    v_lshl_add_u32 v136, v8, 2, v136
    v_lshlrev_b32 v136, 6, v136
    v_lshrrev_b32 v7, 3, v7
    v_lshl_add_u32 v136, v7, 9, v136
    s_add_u32 m0, s94, 32
    s_lshl_b32 s89, s90, 12
    buffer_load_dwordx4 v15, s[48:51], s89 offen offset:3072 nt lds
    v_bitop3_b32 v8, v7, 3, s3 bitop3:0x6a
    v_lshl_add_u32 v25, v8, 4, v136
    v_add_u32 v25, 92160, v25
    s_add_u32 s97, s98, s0
    s_lshr_b64 s[0:1], s[0:1], 4
    s_and_b32 s97, s97, 15
    s_lshr_b32 s99, s97, 3
    s_xor_b32 s97, s97, s99
    s_add_u32 m0, s87, 18432
    s_lshl_b32 s97, s97, 7
    buffer_load_dwordx4 v240, s[28:31], s97 offen offset:0  lds
    v_subrev_u32 v7, 1, v7
    v_bitop3_b32 v8, v7, 3, s3 bitop3:0x6a
    v_lshl_add_u32 v27, v8, 4, v136
    v_add_u32 v27, 91648, v27
    buffer_load_dwordx4 v241, s[28:31], s97 offen offset:1024  lds
    v_subrev_u32 v7, 1, v7
    v_bitop3_b32 v8, v7, 3, s3 bitop3:0x6a
    v_lshl_add_u32 v29, v8, 4, v136
    s_mul_i32 s16, s97, 3072
    s_add_u32 m0, s60, 24576
    s_add_u32 s99, s16, s62
    buffer_load_dwordx4 v244, s[32:35], s99 offen offset:0  lds
    v_add_u32 v29, 91136, v29
    v_subrev_u32 v7, 1, v7
    v_bitop3_b32 v8, v7, 3, s3 bitop3:0x6a
    v_lshl_add_u32 v31, v8, 4, v136
    buffer_load_dwordx4 v245, s[32:35], s99 offen offset:1024  lds
    v_add_u32 v31, 90624, v31
    v_lshl_add_u32 v7, v5, 1, v6
    v_add_u32 v7, 26, v7
    buffer_load_dwordx4 v246, s[32:35], s99 offen offset:2048  lds
    v_and_b32 v8, 1, v7
    v_bfe_u32 v136, v7, 1, 2
    v_lshl_add_u32 v136, v8, 2, v136
    v_lshlrev_b32 v136, 6, v136
    s_add_u32 m0, s87, 18432
    s_nop 0
    buffer_load_dwordx4 v242, s[28:31], s97 offen offset:2048  lds
    v_lshrrev_b32 v7, 3, v7
    v_lshl_add_u32 v136, v7, 9, v136
    v_bitop3_b32 v8, v7, 3, s3 bitop3:0x6a
    buffer_load_dwordx4 v243, s[28:31], s97 offen offset:3072  lds
    v_lshl_add_u32 v26, v8, 4, v136
    v_add_u32 v26, 92160, v26
    v_subrev_u32 v7, 1, v7
    v_bitop3_b32 v8, v7, 3, s3 bitop3:0x6a
    s_add_u32 m0, s88, 18432
    s_mov_b64 exec, 0xffffffff
    buffer_load_dwordx4 v3, s[28:31], s97 offen offset:0  lds
    s_mov_b64 exec, -1
    v_lshl_add_u32 v28, v8, 4, v136
    v_add_u32 v28, 91648, v28
    v_subrev_u32 v7, 1, v7
    s_add_u32 m0, s61, 36864
    s_add_u32 s16, s16, s63
    buffer_load_dwordx4 v244, s[32:35], s16 offen offset:0  lds
    v_bitop3_b32 v8, v7, 3, s3 bitop3:0x6a
    v_lshl_add_u32 v30, v8, 4, v136
    v_add_u32 v30, 91136, v30
    v_subrev_u32 v7, 1, v7
    buffer_load_dwordx4 v245, s[32:35], s16 offen offset:1024  lds
    v_bitop3_b32 v8, v7, 3, s3 bitop3:0x6a
    v_lshl_add_u32 v32, v8, 4, v136
    v_add_u32 v32, 90624, v32
    buffer_load_dwordx4 v246, s[32:35], s16 offen offset:2048  lds
    v_lshrrev_b32 v7, 1, v6
    v_lshl_add_u32 v7, v5, 1, v7
    v_add_u32 v7, 32, v7
    s_waitcnt vmcnt(15)
    s_barrier
    s_add_u32 s97, s98, s0
    s_lshr_b64 s[0:1], s[0:1], 4
    s_and_b32 s97, s97, 15
    s_lshr_b32 s99, s97, 3
    s_xor_b32 s97, s97, s99
    s_add_u32 m0, s87, 36864
    s_lshl_b32 s97, s97, 7
    buffer_load_dwordx4 v240, s[28:31], s97 offen offset:0  lds
    v_and_b32 v8, 1, v7
    v_bfe_u32 v136, v7, 1, 2
    v_lshl_add_u32 v136, v8, 2, v136
    v_lshlrev_b32 v136, 6, v136
    buffer_load_dwordx4 v241, s[28:31], s97 offen offset:1024  lds
    v_lshrrev_b32 v7, 3, v7
    v_lshl_add_u32 v136, v7, 9, v136
    v_bitop3_b32 v8, v7, 3, s3 bitop3:0x6a
    v_lshl_add_u32 v20, v8, 4, v136
    s_mul_i32 s16, s97, 3072
    s_add_u32 m0, s60, 49152
    s_add_u32 s99, s16, s62
    buffer_load_dwordx4 v244, s[32:35], s99 offen offset:0  lds
    v_add_u32 v20, 92160, v20
    v_and_b32 v8, 1, v6
    v_xor_b32 v8, 1, v8
    v_lshl_add_u32 v20, v8, 3, v20
    buffer_load_dwordx4 v245, s[32:35], s99 offen offset:1024  lds
    s_waitcnt lgkmcnt(0)
    s_and_b32 s78, s92, 0xffff0000
    s_lshl_b32 s92, s92, 16
    s_bitcmp1_b32 s90, 0
    s_cselect_b32 s92, s78, s92
    buffer_load_dwordx4 v246, s[32:35], s99 offen offset:2048  lds
    v_lshlrev_b32 v7, 3, v6
    v_sub_u32 v7, v7, v5
    v_subrev_u32 v7, 9, v7
    v_and_b32 v8, 1, v7
    s_add_u32 m0, s87, 36864
    s_nop 0
    buffer_load_dwordx4 v242, s[28:31], s97 offen offset:2048  lds
    v_xor_b32 v8, 1, v8
    v_lshlrev_b32 v8, 4, v8
    v_lshrrev_b32 v8, v8, s92
    v_ashrrev_i32 v7, 1, v7
    buffer_load_dwordx4 v243, s[28:31], s97 offen offset:3072  lds
    v_cmp_eq_u32 vcc, 0, v7
    s_nop 1
    v_cndmask_b32 v236, 0, v8, vcc
    v_cmp_eq_u32 vcc, 1, v7
    s_nop 1
    v_cndmask_b32 v237, 0, v8, vcc
    s_add_u32 m0, s88, 36864
    s_mov_b64 exec, 0xffffffff
    buffer_load_dwordx4 v3, s[28:31], s97 offen offset:0  lds
    s_mov_b64 exec, -1
    v_cmp_eq_u32 vcc, 2, v7
    s_nop 1
    v_cndmask_b32 v238, 0, v8, vcc
    v_cmp_eq_u32 vcc, 3, v7
    s_nop 1
    v_cndmask_b32 v239, 0, v8, vcc
    s_add_u32 m0, s61, 61440
    s_add_u32 s16, s16, s63
    buffer_load_dwordx4 v244, s[32:35], s16 offen offset:0  lds
    s_and_b32 s78, s77, 7
    s_mov_b32 s95, 0x76543210
    s_cmp_eq_u32 s78, 1
    s_cselect_b32 s95, 0x76543201, s95
    s_cmp_eq_u32 s78, 2
    s_cselect_b32 s95, 0x76543120, s95
    s_cmp_eq_u32 s78, 3
    s_cselect_b32 s95, 0x76542310, s95
    s_cmp_eq_u32 s78, 4
    s_cselect_b32 s95, 0x76534210, s95
    s_cmp_eq_u32 s78, 5
    s_cselect_b32 s95, 0x76453210, s95
    s_cmp_eq_u32 s78, 6
    s_cselect_b32 s95, 0x75643210, s95
    s_cmp_eq_u32 s78, 7
    s_cselect_b32 s95, 0x67543210, s95
    s_and_b32 s78, s76, 3
    s_mul_i32 s78, s78, 0x22222222
    s_add_u32 s95, s95, s78
    s_bfe_u32 s100, s95, 0x3001c
    s_lshl_b32 s100, s100, 18
    s_bfe_u32 s95, s95, 0x30018
    s_lshl_b32 s95, s95, 18
    v_lshrrev_b32 v136, 4, v0
    v_lshlrev_b32 v136, 1, v136
    v_and_b32 v137, 7, v0
    buffer_load_dwordx4 v245, s[32:35], s16 offen offset:1024  lds
    v_xor_b32 v136, v136, v137
    v_lshlrev_b32 v136, 4, v136
    v_lshrrev_b32 v137, 3, v0
    v_lshl_add_u32 v136, v137, 11, v136
    buffer_load_dwordx4 v246, s[32:35], s16 offen offset:2048  lds
    s_lshl_b32 s78, s77, 7
    s_lshl_b32 s79, s3, 14
    s_add_u32 s78, s78, s79
    v_add_u32 v17, s78, v136
    s_waitcnt vmcnt(11)
    s_barrier
    s_add_u32 s97, s98, s0
    s_lshr_b64 s[0:1], s[0:1], 4
    s_and_b32 s97, s97, 15
    s_lshr_b32 s99, s97, 3
    s_xor_b32 s97, s97, s99
    s_add_u32 m0, s87, 0
    s_lshl_b32 s97, s97, 7
    buffer_load_dwordx4 v240, s[28:31], s97 offen offset:0  lds
    v_add_u32 v5, s94, v15
    ds_read_b128 v[140:143], v5 offset:32
    ds_read_b32 v156, v5 offset:48
    ds_read_b128 v[144:147], v5 offset:1056
    buffer_load_dwordx4 v241, s[28:31], s97 offen offset:1024  lds
    ds_read_b32 v157, v5 offset:1072
    ds_read_b128 v[148:151], v5 offset:2080
    ds_read_b32 v158, v5 offset:2096
    s_mul_i32 s16, s97, 3072
    s_add_u32 m0, s60, 0
    s_add_u32 s99, s16, s62
    buffer_load_dwordx4 v244, s[32:35], s99 offen offset:0  lds
    ds_read_b128 v[152:155], v5 offset:3104
    ds_read_b32 v159, v5 offset:3120
    v_lshrrev_b32 v6, 3, v0
    buffer_load_dwordx4 v245, s[32:35], s99 offen offset:1024  lds
    v_mul_u32_u24 v6, 4160, v6
    v_and_b32 v7, 7, v0
    v_lshl_add_u32 v6, v7, 2, v6
    v_add_u32 v6, s94, v6
    buffer_load_dwordx4 v246, s[32:35], s99 offen offset:2048  lds
    v_mov_b32 v7, 0
    s_waitcnt lgkmcnt(0)
    v_readfirstlane_b32 s93, v140
    s_add_u32 m0, s87, 0
    s_nop 0
    buffer_load_dwordx4 v242, s[28:31], s97 offen offset:2048  lds
    s_lshl_b32 s93, s93, 16
    v_writelane_b32 v7, s93, 15
    v_alignbit_b32 v140, v141, v140, 16
    buffer_load_dwordx4 v243, s[28:31], s97 offen offset:3072  lds
    v_alignbit_b32 v141, v142, v141, 16
    v_alignbit_b32 v142, v143, v142, 16
    v_alignbit_b32 v143, v156, v143, 16
    v_alignbit_b32 v144, v145, v144, 16
    s_add_u32 m0, s88, 0
    s_mov_b64 exec, 0xffffffff
    buffer_load_dwordx4 v3, s[28:31], s97 offen offset:0  lds
    s_mov_b64 exec, -1
    v_alignbit_b32 v145, v146, v145, 16
    v_alignbit_b32 v146, v147, v146, 16
    v_alignbit_b32 v147, v157, v147, 16
    s_add_u32 m0, s61, 12288
    s_add_u32 s16, s16, s63
    buffer_load_dwordx4 v244, s[32:35], s16 offen offset:0  lds
    v_alignbit_b32 v148, v149, v148, 16
    v_alignbit_b32 v149, v150, v149, 16
    v_alignbit_b32 v150, v151, v150, 16
    buffer_load_dwordx4 v245, s[32:35], s16 offen offset:1024  lds
    v_alignbit_b32 v151, v158, v151, 16
    v_alignbit_b32 v152, v153, v152, 16
    v_alignbit_b32 v153, v154, v153, 16
    v_alignbit_b32 v154, v155, v154, 16
    buffer_load_dwordx4 v246, s[32:35], s16 offen offset:2048  lds
    v_alignbit_b32 v155, v159, v155, 16
    v_lshlrev_b32 v8, 3, v0
    s_add_u32 s78, s88, 18432
    s_mov_b64 exec, 0xff
    buffer_load_dword v136, v33, s[68:71], 0 offen sc1
    buffer_load_dword v137, v34, s[52:55], 0 offen sc1
    s_mov_b64 exec, -1
    v_add_u32 v8, s78, v8
    v_mov_b32 v156, 0
    v_mov_b32 v157, 0
    s_waitcnt vmcnt(13)
    s_barrier
    s_waitcnt vmcnt(0)
LA_j:
    s_mov_b64 exec, 1
    ds_add_u32 v18, v19 offset:24
    s_mov_b64 exec, -1
    s_mov_b64 exec, 0xff
    v_cmp_ne_u32 vcc, v136, v137
    v_cmp_gt_u32 s[80:81], s96, v136
    s_nop 0
    s_or_b64 vcc, vcc, s[80:81]
    s_cbranch_vccnz LA_slow
LA_back:
    s_mov_b64 exec, -1
    s_add_u32 m0, s86, 94208
    s_add_u32 s89, s91, 0
    buffer_load_dwordx4 v14, s[52:55], s89 offen sc1 lds
    s_add_u32 m0, s86, 98304
    s_add_u32 s89, s91, 4096
    buffer_load_dwordx4 v14, s[52:55], s89 offen sc1 lds
    s_add_u32 m0, s86, 102400
    s_add_u32 s89, s91, 8192
    buffer_load_dwordx4 v14, s[52:55], s89 offen sc1 lds
    s_add_u32 m0, s86, 106496
    s_add_u32 s89, s91, 12288
    buffer_load_dwordx4 v14, s[52:55], s89 offen sc1 lds
    s_add_u32 s89, s95, 131072
    buffer_load_dwordx4 v[228:231], v17, s[64:67], s89 offen
    s_add_u32 s89, s95, 196608
    buffer_load_dwordx4 v[232:235], v17, s[64:67], s89 offen
    s_add_u32 s89, s100, 0
    buffer_load_dwordx4 v[240:243], v17, s[64:67], s89 offen
    s_add_u32 s89, s100, 65536
    buffer_load_dwordx4 v[244:247], v17, s[64:67], s89 offen
    s_add_u32 s89, s100, 131072
    buffer_load_dwordx4 v[248:251], v17, s[64:67], s89 offen
    s_add_u32 s89, s100, 196608
    buffer_load_dwordx4 v[196:199], v17, s[64:67], s89 offen
    buffer_load_dwordx4 v[212:215], v9, s[56:59], 0 offen offset:0 nt
    buffer_load_dwordx4 v[216:219], v9, s[56:59], 0 offen offset:2048 nt
    buffer_load_dwordx4 v[220:223], v9, s[56:59], s96 offen offset:0 nt
    buffer_load_dwordx4 v[224:227], v9, s[56:59], s96 offen offset:2048 nt
    s_mov_b64 exec, 0xffff
    ds_write_b32 v6, v7
    s_mov_b64 exec, -1
    ds_write_b128 v5, v[140:143] offset:4192
    ds_write_b128 v5, v[144:147] offset:5216
    ds_write_b128 v5, v[148:151] offset:6240
    ds_write_b128 v5, v[152:155] offset:7264
    ds_write_b64 v8, v[156:157]
    ds_read2_b32 v[68:69], v21 offset0:0 offset1:1
    ds_read2_b32 v[70:71], v21 offset0:2 offset1:3
    ds_read2_b32 v[72:73], v21 offset0:128 offset1:129
    ds_read2_b32 v[74:75], v21 offset0:130 offset1:131
    ds_read2_b32 v[76:77], v22 offset0:0 offset1:1
    ds_read2_b32 v[78:79], v22 offset0:2 offset1:3
    ds_read2_b32 v[80:81], v22 offset0:128 offset1:129
    ds_read2_b32 v[82:83], v22 offset0:130 offset1:131
    ds_read2_b32 v[84:85], v23 offset0:0 offset1:1
    ds_read2_b32 v[86:87], v23 offset0:2 offset1:3
    ds_read2_b32 v[88:89], v23 offset0:128 offset1:129
    ds_read2_b32 v[90:91], v23 offset0:130 offset1:131
    ds_read2_b32 v[92:93], v24 offset0:0 offset1:1
    ds_read2_b32 v[94:95], v24 offset0:2 offset1:3
    ds_read2_b32 v[96:97], v24 offset0:128 offset1:129
    ds_read2_b32 v[98:99], v24 offset0:130 offset1:131
    s_waitcnt vmcnt(10)
    s_mov_b64 exec, 1
    ds_add_u32 v18, v19 offset:20
    s_mov_b64 exec, -1
    s_branch LA_s5_in
LA_s5:
    s_sleep 1
LA_s5_in:
    ds_read_b32 v6, v18 offset:20
    s_waitcnt lgkmcnt(0)
    v_readfirstlane_b32 s78, v6
    s_nop 0
    s_cmp_ge_u32 s78, 4
    s_cbranch_scc0 LA_s5
    s_mov_b64 exec, 1
    ds_add_u32 v18, v19 offset:8
    s_mov_b64 exec, -1
    ds_read_b128 v[100:103], v25 offset:0
    ds_read_b128 v[104:107], v25 offset:2048
    ds_read_b128 v[108:111], v25 offset:4096
    ds_read_b128 v[112:115], v25 offset:6144
    ds_read_b128 v[116:119], v25 offset:8192
    ds_read_b128 v[120:123], v25 offset:10240
    ds_read_b128 v[124:127], v25 offset:12288
    ds_read_b128 v[128:131], v25 offset:14336
    s_setprio 2
    s_waitcnt lgkmcnt(7)
    v_mfma_f32_16x16x32_bf16 v[36:39], v[236:239], v[100:103], 0
    ds_read2_b32 v[132:133], v21 offset0:16 offset1:17
    s_waitcnt lgkmcnt(7)
    v_mfma_f32_16x16x32_bf16 v[40:43], v[236:239], v[104:107], 0
    ds_read2_b32 v[134:135], v21 offset0:18 offset1:19
    s_waitcnt lgkmcnt(7)
    v_mfma_f32_16x16x32_bf16 v[44:47], v[236:239], v[108:111], 0
    s_waitcnt lgkmcnt(6)
    v_mfma_f32_16x16x32_bf16 v[48:51], v[236:239], v[112:115], 0
    ds_read_b128 v[164:167], v26 offset:0
    s_waitcnt lgkmcnt(6)
    v_mfma_f32_16x16x32_bf16 v[52:55], v[236:239], v[116:119], 0
    s_waitcnt lgkmcnt(5)
    v_mfma_f32_16x16x32_bf16 v[56:59], v[236:239], v[120:123], 0
    ds_read_b128 v[168:171], v26 offset:2048
    s_waitcnt lgkmcnt(5)
    v_mfma_f32_16x16x32_bf16 v[60:63], v[236:239], v[124:127], 0
    ds_read_b128 v[172:175], v26 offset:4096
    s_waitcnt lgkmcnt(5)
    v_mfma_f32_16x16x32_bf16 v[64:67], v[236:239], v[128:131], 0
    v_mfma_f32_16x16x32_bf16 v[36:39], v[68:71], v[100:103], v[36:39]
    ds_read_b128 v[176:179], v26 offset:6144
    v_mfma_f32_16x16x32_bf16 v[40:43], v[68:71], v[104:107], v[40:43]
    v_mfma_f32_16x16x32_bf16 v[44:47], v[68:71], v[108:111], v[44:47]
    ds_read_b128 v[180:183], v26 offset:8192
    v_mfma_f32_16x16x32_bf16 v[48:51], v[68:71], v[112:115], v[48:51]
    ds_read_b128 v[184:187], v26 offset:10240
    v_mfma_f32_16x16x32_bf16 v[52:55], v[68:71], v[116:119], v[52:55]
    v_mfma_f32_16x16x32_bf16 v[56:59], v[68:71], v[120:123], v[56:59]
    ds_read_b128 v[188:191], v26 offset:12288
    v_mfma_f32_16x16x32_bf16 v[60:63], v[68:71], v[124:127], v[60:63]
    v_mfma_f32_16x16x32_bf16 v[64:67], v[68:71], v[128:131], v[64:67]
    ds_read_b128 v[192:195], v26 offset:14336
    v_mfma_f32_16x16x32_bf16 v[40:43], v[72:75], v[100:103], v[40:43]
    ds_read2_b32 v[136:137], v21 offset0:144 offset1:145
    v_mfma_f32_16x16x32_bf16 v[44:47], v[72:75], v[104:107], v[44:47]
    v_mfma_f32_16x16x32_bf16 v[48:51], v[72:75], v[108:111], v[48:51]
    ds_read2_b32 v[138:139], v21 offset0:146 offset1:147
    v_mfma_f32_16x16x32_bf16 v[52:55], v[72:75], v[112:115], v[52:55]
    v_mfma_f32_16x16x32_bf16 v[56:59], v[72:75], v[116:119], v[56:59]
    ds_read2_b32 v[140:141], v22 offset0:16 offset1:17
    v_mfma_f32_16x16x32_bf16 v[60:63], v[72:75], v[120:123], v[60:63]
    ds_read2_b32 v[142:143], v22 offset0:18 offset1:19
    v_mfma_f32_16x16x32_bf16 v[64:67], v[72:75], v[124:127], v[64:67]
    v_mfma_f32_16x16x32_bf16 v[44:47], v[76:79], v[100:103], v[44:47]
    ds_read2_b32 v[144:145], v22 offset0:144 offset1:145
    v_mfma_f32_16x16x32_bf16 v[48:51], v[76:79], v[104:107], v[48:51]
    v_mfma_f32_16x16x32_bf16 v[52:55], v[76:79], v[108:111], v[52:55]
    ds_read2_b32 v[146:147], v22 offset0:146 offset1:147
    v_mfma_f32_16x16x32_bf16 v[56:59], v[76:79], v[112:115], v[56:59]
    ds_read2_b32 v[148:149], v23 offset0:16 offset1:17
    v_mfma_f32_16x16x32_bf16 v[60:63], v[76:79], v[116:119], v[60:63]
    v_mfma_f32_16x16x32_bf16 v[64:67], v[76:79], v[120:123], v[64:67]
    ds_read2_b32 v[150:151], v23 offset0:18 offset1:19
    v_mfma_f32_16x16x32_bf16 v[48:51], v[80:83], v[100:103], v[48:51]
    v_mfma_f32_16x16x32_bf16 v[52:55], v[80:83], v[104:107], v[52:55]
    ds_read2_b32 v[152:153], v23 offset0:144 offset1:145
    v_mfma_f32_16x16x32_bf16 v[56:59], v[80:83], v[108:111], v[56:59]
    ds_read2_b32 v[154:155], v23 offset0:146 offset1:147
    v_mfma_f32_16x16x32_bf16 v[60:63], v[80:83], v[112:115], v[60:63]
    v_mfma_f32_16x16x32_bf16 v[64:67], v[80:83], v[116:119], v[64:67]
    ds_read2_b32 v[156:157], v24 offset0:16 offset1:17
    v_mfma_f32_16x16x32_bf16 v[52:55], v[84:87], v[100:103], v[52:55]
    v_mfma_f32_16x16x32_bf16 v[56:59], v[84:87], v[104:107], v[56:59]
    ds_read2_b32 v[158:159], v24 offset0:18 offset1:19
    v_mfma_f32_16x16x32_bf16 v[60:63], v[84:87], v[108:111], v[60:63]
    ds_read2_b32 v[160:161], v24 offset0:144 offset1:145
    v_mfma_f32_16x16x32_bf16 v[64:67], v[84:87], v[112:115], v[64:67]
    v_mfma_f32_16x16x32_bf16 v[56:59], v[88:91], v[100:103], v[56:59]
    ds_read2_b32 v[162:163], v24 offset0:146 offset1:147
    v_mfma_f32_16x16x32_bf16 v[60:63], v[88:91], v[104:107], v[60:63]
    v_mfma_f32_16x16x32_bf16 v[64:67], v[88:91], v[108:111], v[64:67]
    v_mfma_f32_16x16x32_bf16 v[60:63], v[92:95], v[100:103], v[60:63]
    v_mfma_f32_16x16x32_bf16 v[64:67], v[92:95], v[104:107], v[64:67]
    v_mfma_f32_16x16x32_bf16 v[64:67], v[96:99], v[100:103], v[64:67]
    s_waitcnt lgkmcnt(14)
    v_mfma_f32_16x16x32_bf16 v[36:39], v[132:135], v[164:167], v[36:39]
    ds_read2_b32 v[68:69], v21 offset0:32 offset1:33
    v_mfma_f32_16x16x32_bf16 v[40:43], v[132:135], v[168:171], v[40:43]
    ds_read2_b32 v[70:71], v21 offset0:34 offset1:35
    v_mfma_f32_16x16x32_bf16 v[44:47], v[132:135], v[172:175], v[44:47]
    ds_read_b128 v[100:103], v27 offset:0
    v_mfma_f32_16x16x32_bf16 v[48:51], v[132:135], v[176:179], v[48:51]
    v_mfma_f32_16x16x32_bf16 v[52:55], v[132:135], v[180:183], v[52:55]
    ds_read_b128 v[104:107], v27 offset:2048
    v_mfma_f32_16x16x32_bf16 v[56:59], v[132:135], v[184:187], v[56:59]
    ds_read_b128 v[108:111], v27 offset:4096
    v_mfma_f32_16x16x32_bf16 v[60:63], v[132:135], v[188:191], v[60:63]
    ds_read_b128 v[112:115], v27 offset:6144
    v_mfma_f32_16x16x32_bf16 v[64:67], v[132:135], v[192:195], v[64:67]
    s_waitcnt lgkmcnt(14)
    v_mfma_f32_16x16x32_bf16 v[40:43], v[136:139], v[164:167], v[40:43]
    ds_read_b128 v[116:119], v27 offset:8192
    v_mfma_f32_16x16x32_bf16 v[44:47], v[136:139], v[168:171], v[44:47]
    ds_read_b128 v[120:123], v27 offset:10240
    v_mfma_f32_16x16x32_bf16 v[48:51], v[136:139], v[172:175], v[48:51]
    ds_read_b128 v[124:127], v27 offset:12288
    v_mfma_f32_16x16x32_bf16 v[52:55], v[136:139], v[176:179], v[52:55]
    v_mfma_f32_16x16x32_bf16 v[56:59], v[136:139], v[180:183], v[56:59]
    ds_read_b128 v[128:131], v27 offset:14336
    v_mfma_f32_16x16x32_bf16 v[60:63], v[136:139], v[184:187], v[60:63]
    ds_read2_b32 v[72:73], v21 offset0:160 offset1:161
    v_mfma_f32_16x16x32_bf16 v[64:67], v[136:139], v[188:191], v[64:67]
    ds_read2_b32 v[74:75], v21 offset0:162 offset1:163
    v_mfma_f32_16x16x32_bf16 v[44:47], v[140:143], v[164:167], v[44:47]
    v_mfma_f32_16x16x32_bf16 v[48:51], v[140:143], v[168:171], v[48:51]
    ds_read2_b32 v[76:77], v22 offset0:32 offset1:33
    v_mfma_f32_16x16x32_bf16 v[52:55], v[140:143], v[172:175], v[52:55]
    ds_read2_b32 v[78:79], v22 offset0:34 offset1:35
    v_mfma_f32_16x16x32_bf16 v[56:59], v[140:143], v[176:179], v[56:59]
    ds_read2_b32 v[80:81], v22 offset0:160 offset1:161
    v_mfma_f32_16x16x32_bf16 v[60:63], v[140:143], v[180:183], v[60:63]
    v_mfma_f32_16x16x32_bf16 v[64:67], v[140:143], v[184:187], v[64:67]
    ds_read2_b32 v[82:83], v22 offset0:162 offset1:163
    v_mfma_f32_16x16x32_bf16 v[48:51], v[144:147], v[164:167], v[48:51]
    ds_read2_b32 v[84:85], v23 offset0:32 offset1:33
    v_mfma_f32_16x16x32_bf16 v[52:55], v[144:147], v[168:171], v[52:55]
    ds_read2_b32 v[86:87], v23 offset0:34 offset1:35
    v_mfma_f32_16x16x32_bf16 v[56:59], v[144:147], v[172:175], v[56:59]
    v_mfma_f32_16x16x32_bf16 v[60:63], v[144:147], v[176:179], v[60:63]
    ds_read2_b32 v[88:89], v23 offset0:160 offset1:161
    v_mfma_f32_16x16x32_bf16 v[64:67], v[144:147], v[180:183], v[64:67]
    ds_read2_b32 v[90:91], v23 offset0:162 offset1:163
    s_waitcnt lgkmcnt(14)
    v_mfma_f32_16x16x32_bf16 v[52:55], v[148:151], v[164:167], v[52:55]
    ds_read2_b32 v[92:93], v24 offset0:32 offset1:33
    v_mfma_f32_16x16x32_bf16 v[56:59], v[148:151], v[168:171], v[56:59]
    v_mfma_f32_16x16x32_bf16 v[60:63], v[148:151], v[172:175], v[60:63]
    ds_read2_b32 v[94:95], v24 offset0:34 offset1:35
    v_mfma_f32_16x16x32_bf16 v[64:67], v[148:151], v[176:179], v[64:67]
    ds_read2_b32 v[96:97], v24 offset0:160 offset1:161
    v_mfma_f32_16x16x32_bf16 v[56:59], v[152:155], v[164:167], v[56:59]
    ds_read2_b32 v[98:99], v24 offset0:162 offset1:163
    v_mfma_f32_16x16x32_bf16 v[60:63], v[152:155], v[168:171], v[60:63]
    v_mfma_f32_16x16x32_bf16 v[64:67], v[152:155], v[172:175], v[64:67]
    v_mfma_f32_16x16x32_bf16 v[60:63], v[156:159], v[164:167], v[60:63]
    v_mfma_f32_16x16x32_bf16 v[64:67], v[156:159], v[168:171], v[64:67]
    v_mfma_f32_16x16x32_bf16 v[64:67], v[160:163], v[164:167], v[64:67]
    v_mfma_f32_16x16x32_bf16 v[36:39], v[68:71], v[100:103], v[36:39]
    ds_read2_b32 v[132:133], v21 offset0:48 offset1:49
    v_mfma_f32_16x16x32_bf16 v[40:43], v[68:71], v[104:107], v[40:43]
    ds_read2_b32 v[134:135], v21 offset0:50 offset1:51
    v_mfma_f32_16x16x32_bf16 v[44:47], v[68:71], v[108:111], v[44:47]
    ds_read_b128 v[164:167], v28 offset:0
    v_mfma_f32_16x16x32_bf16 v[48:51], v[68:71], v[112:115], v[48:51]
    s_waitcnt lgkmcnt(14)
    v_mfma_f32_16x16x32_bf16 v[52:55], v[68:71], v[116:119], v[52:55]
    ds_read_b128 v[168:171], v28 offset:2048
    v_mfma_f32_16x16x32_bf16 v[56:59], v[68:71], v[120:123], v[56:59]
    ds_read_b128 v[172:175], v28 offset:4096
    v_mfma_f32_16x16x32_bf16 v[60:63], v[68:71], v[124:127], v[60:63]
    ds_read_b128 v[176:179], v28 offset:6144
    v_mfma_f32_16x16x32_bf16 v[64:67], v[68:71], v[128:131], v[64:67]
    v_mfma_f32_16x16x32_bf16 v[40:43], v[72:75], v[100:103], v[40:43]
    ds_read_b128 v[180:183], v28 offset:8192
    v_mfma_f32_16x16x32_bf16 v[44:47], v[72:75], v[104:107], v[44:47]
    ds_read_b128 v[184:187], v28 offset:10240
    v_mfma_f32_16x16x32_bf16 v[48:51], v[72:75], v[108:111], v[48:51]
    ds_read_b128 v[188:191], v28 offset:12288
    v_mfma_f32_16x16x32_bf16 v[52:55], v[72:75], v[112:115], v[52:55]
    v_mfma_f32_16x16x32_bf16 v[56:59], v[72:75], v[116:119], v[56:59]
    ds_read_b128 v[192:195], v28 offset:14336
    v_mfma_f32_16x16x32_bf16 v[60:63], v[72:75], v[120:123], v[60:63]
    ds_read2_b32 v[136:137], v21 offset0:176 offset1:177
    v_mfma_f32_16x16x32_bf16 v[64:67], v[72:75], v[124:127], v[64:67]
    ds_read2_b32 v[138:139], v21 offset0:178 offset1:179
    s_waitcnt lgkmcnt(14)
    v_mfma_f32_16x16x32_bf16 v[44:47], v[76:79], v[100:103], v[44:47]
    v_mfma_f32_16x16x32_bf16 v[48:51], v[76:79], v[104:107], v[48:51]
    ds_read2_b32 v[140:141], v22 offset0:48 offset1:49
    v_mfma_f32_16x16x32_bf16 v[52:55], v[76:79], v[108:111], v[52:55]
    ds_read2_b32 v[142:143], v22 offset0:50 offset1:51
    v_mfma_f32_16x16x32_bf16 v[56:59], v[76:79], v[112:115], v[56:59]
    ds_read2_b32 v[144:145], v22 offset0:176 offset1:177
    v_mfma_f32_16x16x32_bf16 v[60:63], v[76:79], v[116:119], v[60:63]
    v_mfma_f32_16x16x32_bf16 v[64:67], v[76:79], v[120:123], v[64:67]
    ds_read2_b32 v[146:147], v22 offset0:178 offset1:179
    v_mfma_f32_16x16x32_bf16 v[48:51], v[80:83], v[100:103], v[48:51]
    ds_read2_b32 v[148:149], v23 offset0:48 offset1:49
    v_mfma_f32_16x16x32_bf16 v[52:55], v[80:83], v[104:107], v[52:55]
    ds_read2_b32 v[150:151], v23 offset0:50 offset1:51
    v_mfma_f32_16x16x32_bf16 v[56:59], v[80:83], v[108:111], v[56:59]
    v_mfma_f32_16x16x32_bf16 v[60:63], v[80:83], v[112:115], v[60:63]
    ds_read2_b32 v[152:153], v23 offset0:176 offset1:177
    v_mfma_f32_16x16x32_bf16 v[64:67], v[80:83], v[116:119], v[64:67]
    ds_read2_b32 v[154:155], v23 offset0:178 offset1:179
    v_mfma_f32_16x16x32_bf16 v[52:55], v[84:87], v[100:103], v[52:55]
    ds_read2_b32 v[156:157], v24 offset0:48 offset1:49
    v_mfma_f32_16x16x32_bf16 v[56:59], v[84:87], v[104:107], v[56:59]
    v_mfma_f32_16x16x32_bf16 v[60:63], v[84:87], v[108:111], v[60:63]
    ds_read2_b32 v[158:159], v24 offset0:50 offset1:51
    v_mfma_f32_16x16x32_bf16 v[64:67], v[84:87], v[112:115], v[64:67]
    ds_read2_b32 v[160:161], v24 offset0:176 offset1:177
    v_mfma_f32_16x16x32_bf16 v[56:59], v[88:91], v[100:103], v[56:59]
    ds_read2_b32 v[162:163], v24 offset0:178 offset1:179
    v_mfma_f32_16x16x32_bf16 v[60:63], v[88:91], v[104:107], v[60:63]
    v_mfma_f32_16x16x32_bf16 v[64:67], v[88:91], v[108:111], v[64:67]
    v_mfma_f32_16x16x32_bf16 v[60:63], v[92:95], v[100:103], v[60:63]
    v_mfma_f32_16x16x32_bf16 v[64:67], v[92:95], v[104:107], v[64:67]
    s_waitcnt lgkmcnt(14)
    v_mfma_f32_16x16x32_bf16 v[64:67], v[96:99], v[100:103], v[64:67]
    v_mfma_f32_16x16x32_bf16 v[36:39], v[132:135], v[164:167], v[36:39]
    ds_read2_b32 v[68:69], v21 offset0:64 offset1:65
    v_mfma_f32_16x16x32_bf16 v[40:43], v[132:135], v[168:171], v[40:43]
    ds_read2_b32 v[70:71], v21 offset0:66 offset1:67
    v_mfma_f32_16x16x32_bf16 v[44:47], v[132:135], v[172:175], v[44:47]
    ds_read_b128 v[100:103], v29 offset:0
    v_mfma_f32_16x16x32_bf16 v[48:51], v[132:135], v[176:179], v[48:51]
    v_mfma_f32_16x16x32_bf16 v[52:55], v[132:135], v[180:183], v[52:55]
    ds_read_b128 v[104:107], v29 offset:2048
    v_mfma_f32_16x16x32_bf16 v[56:59], v[132:135], v[184:187], v[56:59]
    ds_read_b128 v[108:111], v29 offset:4096
    v_mfma_f32_16x16x32_bf16 v[60:63], v[132:135], v[188:191], v[60:63]
    ds_read_b128 v[112:115], v29 offset:6144
    v_mfma_f32_16x16x32_bf16 v[64:67], v[132:135], v[192:195], v[64:67]
    s_waitcnt lgkmcnt(14)
    v_mfma_f32_16x16x32_bf16 v[40:43], v[136:139], v[164:167], v[40:43]
    ds_read_b128 v[116:119], v29 offset:8192
    v_mfma_f32_16x16x32_bf16 v[44:47], v[136:139], v[168:171], v[44:47]
    ds_read_b128 v[120:123], v29 offset:10240
    v_mfma_f32_16x16x32_bf16 v[48:51], v[136:139], v[172:175], v[48:51]
    ds_read_b128 v[124:127], v29 offset:12288
    v_mfma_f32_16x16x32_bf16 v[52:55], v[136:139], v[176:179], v[52:55]
    v_mfma_f32_16x16x32_bf16 v[56:59], v[136:139], v[180:183], v[56:59]
    ds_read_b128 v[128:131], v29 offset:14336
    v_mfma_f32_16x16x32_bf16 v[60:63], v[136:139], v[184:187], v[60:63]
    ds_read2_b32 v[72:73], v21 offset0:192 offset1:193
    v_mfma_f32_16x16x32_bf16 v[64:67], v[136:139], v[188:191], v[64:67]
    ds_read2_b32 v[74:75], v21 offset0:194 offset1:195
    v_mfma_f32_16x16x32_bf16 v[44:47], v[140:143], v[164:167], v[44:47]
    v_mfma_f32_16x16x32_bf16 v[48:51], v[140:143], v[168:171], v[48:51]
    ds_read2_b32 v[76:77], v22 offset0:64 offset1:65
    v_mfma_f32_16x16x32_bf16 v[52:55], v[140:143], v[172:175], v[52:55]
    ds_read2_b32 v[78:79], v22 offset0:66 offset1:67
    v_mfma_f32_16x16x32_bf16 v[56:59], v[140:143], v[176:179], v[56:59]
    ds_read2_b32 v[80:81], v22 offset0:192 offset1:193
    v_mfma_f32_16x16x32_bf16 v[60:63], v[140:143], v[180:183], v[60:63]
    v_mfma_f32_16x16x32_bf16 v[64:67], v[140:143], v[184:187], v[64:67]
    ds_read2_b32 v[82:83], v22 offset0:194 offset1:195
    v_mfma_f32_16x16x32_bf16 v[48:51], v[144:147], v[164:167], v[48:51]
    ds_read2_b32 v[84:85], v23 offset0:64 offset1:65
    v_mfma_f32_16x16x32_bf16 v[52:55], v[144:147], v[168:171], v[52:55]
    ds_read2_b32 v[86:87], v23 offset0:66 offset1:67
    v_mfma_f32_16x16x32_bf16 v[56:59], v[144:147], v[172:175], v[56:59]
    v_mfma_f32_16x16x32_bf16 v[60:63], v[144:147], v[176:179], v[60:63]
    ds_read2_b32 v[88:89], v23 offset0:192 offset1:193
    v_mfma_f32_16x16x32_bf16 v[64:67], v[144:147], v[180:183], v[64:67]
    ds_read2_b32 v[90:91], v23 offset0:194 offset1:195
    s_waitcnt lgkmcnt(14)
    v_mfma_f32_16x16x32_bf16 v[52:55], v[148:151], v[164:167], v[52:55]
    ds_read2_b32 v[92:93], v24 offset0:64 offset1:65
    v_mfma_f32_16x16x32_bf16 v[56:59], v[148:151], v[168:171], v[56:59]
    v_mfma_f32_16x16x32_bf16 v[60:63], v[148:151], v[172:175], v[60:63]
    ds_read2_b32 v[94:95], v24 offset0:66 offset1:67
    v_mfma_f32_16x16x32_bf16 v[64:67], v[148:151], v[176:179], v[64:67]
    ds_read2_b32 v[96:97], v24 offset0:192 offset1:193
    v_mfma_f32_16x16x32_bf16 v[56:59], v[152:155], v[164:167], v[56:59]
    ds_read2_b32 v[98:99], v24 offset0:194 offset1:195
    v_mfma_f32_16x16x32_bf16 v[60:63], v[152:155], v[168:171], v[60:63]
    v_mfma_f32_16x16x32_bf16 v[64:67], v[152:155], v[172:175], v[64:67]
    v_mfma_f32_16x16x32_bf16 v[60:63], v[156:159], v[164:167], v[60:63]
    v_mfma_f32_16x16x32_bf16 v[64:67], v[156:159], v[168:171], v[64:67]
    v_mfma_f32_16x16x32_bf16 v[64:67], v[160:163], v[164:167], v[64:67]
    v_mfma_f32_16x16x32_bf16 v[36:39], v[68:71], v[100:103], v[36:39]
    ds_read2_b32 v[132:133], v21 offset0:80 offset1:81
    v_mfma_f32_16x16x32_bf16 v[40:43], v[68:71], v[104:107], v[40:43]
    ds_read2_b32 v[134:135], v21 offset0:82 offset1:83
    v_mfma_f32_16x16x32_bf16 v[44:47], v[68:71], v[108:111], v[44:47]
    ds_read_b128 v[164:167], v30 offset:0
    v_mfma_f32_16x16x32_bf16 v[48:51], v[68:71], v[112:115], v[48:51]
    s_waitcnt lgkmcnt(14)
    v_mfma_f32_16x16x32_bf16 v[52:55], v[68:71], v[116:119], v[52:55]
    ds_read_b128 v[168:171], v30 offset:2048
    v_mfma_f32_16x16x32_bf16 v[56:59], v[68:71], v[120:123], v[56:59]
    ds_read_b128 v[172:175], v30 offset:4096
    v_mfma_f32_16x16x32_bf16 v[60:63], v[68:71], v[124:127], v[60:63]
    ds_read_b128 v[176:179], v30 offset:6144
    v_mfma_f32_16x16x32_bf16 v[64:67], v[68:71], v[128:131], v[64:67]
    v_mfma_f32_16x16x32_bf16 v[40:43], v[72:75], v[100:103], v[40:43]
    ds_read_b128 v[180:183], v30 offset:8192
    v_mfma_f32_16x16x32_bf16 v[44:47], v[72:75], v[104:107], v[44:47]
    ds_read_b128 v[184:187], v30 offset:10240
    v_mfma_f32_16x16x32_bf16 v[48:51], v[72:75], v[108:111], v[48:51]
    ds_read_b128 v[188:191], v30 offset:12288
    v_mfma_f32_16x16x32_bf16 v[52:55], v[72:75], v[112:115], v[52:55]
    v_mfma_f32_16x16x32_bf16 v[56:59], v[72:75], v[116:119], v[56:59]
    ds_read_b128 v[192:195], v30 offset:14336
    v_mfma_f32_16x16x32_bf16 v[60:63], v[72:75], v[120:123], v[60:63]
    ds_read2_b32 v[136:137], v21 offset0:208 offset1:209
    v_mfma_f32_16x16x32_bf16 v[64:67], v[72:75], v[124:127], v[64:67]
    ds_read2_b32 v[138:139], v21 offset0:210 offset1:211
    s_waitcnt lgkmcnt(14)
    v_mfma_f32_16x16x32_bf16 v[44:47], v[76:79], v[100:103], v[44:47]
    v_mfma_f32_16x16x32_bf16 v[48:51], v[76:79], v[104:107], v[48:51]
    ds_read2_b32 v[140:141], v22 offset0:80 offset1:81
    v_mfma_f32_16x16x32_bf16 v[52:55], v[76:79], v[108:111], v[52:55]
    ds_read2_b32 v[142:143], v22 offset0:82 offset1:83
    v_mfma_f32_16x16x32_bf16 v[56:59], v[76:79], v[112:115], v[56:59]
    ds_read2_b32 v[144:145], v22 offset0:208 offset1:209
    v_mfma_f32_16x16x32_bf16 v[60:63], v[76:79], v[116:119], v[60:63]
    v_mfma_f32_16x16x32_bf16 v[64:67], v[76:79], v[120:123], v[64:67]
    ds_read2_b32 v[146:147], v22 offset0:210 offset1:211
    v_mfma_f32_16x16x32_bf16 v[48:51], v[80:83], v[100:103], v[48:51]
    ds_read2_b32 v[148:149], v23 offset0:80 offset1:81
    v_mfma_f32_16x16x32_bf16 v[52:55], v[80:83], v[104:107], v[52:55]
    ds_read2_b32 v[150:151], v23 offset0:82 offset1:83
    v_mfma_f32_16x16x32_bf16 v[56:59], v[80:83], v[108:111], v[56:59]
    v_mfma_f32_16x16x32_bf16 v[60:63], v[80:83], v[112:115], v[60:63]
    ds_read2_b32 v[152:153], v23 offset0:208 offset1:209
    v_mfma_f32_16x16x32_bf16 v[64:67], v[80:83], v[116:119], v[64:67]
    ds_read2_b32 v[154:155], v23 offset0:210 offset1:211
    v_mfma_f32_16x16x32_bf16 v[52:55], v[84:87], v[100:103], v[52:55]
    ds_read2_b32 v[156:157], v24 offset0:80 offset1:81
    v_mfma_f32_16x16x32_bf16 v[56:59], v[84:87], v[104:107], v[56:59]
    v_mfma_f32_16x16x32_bf16 v[60:63], v[84:87], v[108:111], v[60:63]
    ds_read2_b32 v[158:159], v24 offset0:82 offset1:83
    v_mfma_f32_16x16x32_bf16 v[64:67], v[84:87], v[112:115], v[64:67]
    ds_read2_b32 v[160:161], v24 offset0:208 offset1:209
    v_mfma_f32_16x16x32_bf16 v[56:59], v[88:91], v[100:103], v[56:59]
    ds_read2_b32 v[162:163], v24 offset0:210 offset1:211
    v_mfma_f32_16x16x32_bf16 v[60:63], v[88:91], v[104:107], v[60:63]
    v_mfma_f32_16x16x32_bf16 v[64:67], v[88:91], v[108:111], v[64:67]
    v_mfma_f32_16x16x32_bf16 v[60:63], v[92:95], v[100:103], v[60:63]
    v_mfma_f32_16x16x32_bf16 v[64:67], v[92:95], v[104:107], v[64:67]
    s_waitcnt lgkmcnt(14)
    v_mfma_f32_16x16x32_bf16 v[64:67], v[96:99], v[100:103], v[64:67]
    v_mfma_f32_16x16x32_bf16 v[36:39], v[132:135], v[164:167], v[36:39]
    ds_read2_b32 v[68:69], v21 offset0:96 offset1:97
    v_mfma_f32_16x16x32_bf16 v[40:43], v[132:135], v[168:171], v[40:43]
    ds_read2_b32 v[70:71], v21 offset0:98 offset1:99
    v_mfma_f32_16x16x32_bf16 v[44:47], v[132:135], v[172:175], v[44:47]
    ds_read_b128 v[100:103], v31 offset:0
    v_mfma_f32_16x16x32_bf16 v[48:51], v[132:135], v[176:179], v[48:51]
    v_mfma_f32_16x16x32_bf16 v[52:55], v[132:135], v[180:183], v[52:55]
    ds_read_b128 v[104:107], v31 offset:2048
    v_mfma_f32_16x16x32_bf16 v[56:59], v[132:135], v[184:187], v[56:59]
    ds_read_b128 v[108:111], v31 offset:4096
    v_mfma_f32_16x16x32_bf16 v[60:63], v[132:135], v[188:191], v[60:63]
    ds_read_b128 v[112:115], v31 offset:6144
    v_mfma_f32_16x16x32_bf16 v[64:67], v[132:135], v[192:195], v[64:67]
    s_waitcnt lgkmcnt(14)
    v_mfma_f32_16x16x32_bf16 v[40:43], v[136:139], v[164:167], v[40:43]
    ds_read_b128 v[116:119], v31 offset:8192
    v_mfma_f32_16x16x32_bf16 v[44:47], v[136:139], v[168:171], v[44:47]
    ds_read_b128 v[120:123], v31 offset:10240
    v_mfma_f32_16x16x32_bf16 v[48:51], v[136:139], v[172:175], v[48:51]
    ds_read_b128 v[124:127], v31 offset:12288
    v_mfma_f32_16x16x32_bf16 v[52:55], v[136:139], v[176:179], v[52:55]
    v_mfma_f32_16x16x32_bf16 v[56:59], v[136:139], v[180:183], v[56:59]
    ds_read_b128 v[128:131], v31 offset:14336
    v_mfma_f32_16x16x32_bf16 v[60:63], v[136:139], v[184:187], v[60:63]
    ds_read2_b32 v[72:73], v21 offset0:224 offset1:225
    v_mfma_f32_16x16x32_bf16 v[64:67], v[136:139], v[188:191], v[64:67]
    ds_read2_b32 v[74:75], v21 offset0:226 offset1:227
    v_mfma_f32_16x16x32_bf16 v[44:47], v[140:143], v[164:167], v[44:47]
    v_mfma_f32_16x16x32_bf16 v[48:51], v[140:143], v[168:171], v[48:51]
    ds_read2_b32 v[76:77], v22 offset0:96 offset1:97
    v_mfma_f32_16x16x32_bf16 v[52:55], v[140:143], v[172:175], v[52:55]
    ds_read2_b32 v[78:79], v22 offset0:98 offset1:99
    v_mfma_f32_16x16x32_bf16 v[56:59], v[140:143], v[176:179], v[56:59]
    ds_read2_b32 v[80:81], v22 offset0:224 offset1:225
    v_mfma_f32_16x16x32_bf16 v[60:63], v[140:143], v[180:183], v[60:63]
    v_mfma_f32_16x16x32_bf16 v[64:67], v[140:143], v[184:187], v[64:67]
    ds_read2_b32 v[82:83], v22 offset0:226 offset1:227
    v_mfma_f32_16x16x32_bf16 v[48:51], v[144:147], v[164:167], v[48:51]
    ds_read2_b32 v[84:85], v23 offset0:96 offset1:97
    v_mfma_f32_16x16x32_bf16 v[52:55], v[144:147], v[168:171], v[52:55]
    ds_read2_b32 v[86:87], v23 offset0:98 offset1:99
    v_mfma_f32_16x16x32_bf16 v[56:59], v[144:147], v[172:175], v[56:59]
    v_mfma_f32_16x16x32_bf16 v[60:63], v[144:147], v[176:179], v[60:63]
    ds_read2_b32 v[88:89], v23 offset0:224 offset1:225
    v_mfma_f32_16x16x32_bf16 v[64:67], v[144:147], v[180:183], v[64:67]
    ds_read2_b32 v[90:91], v23 offset0:226 offset1:227
    s_waitcnt lgkmcnt(14)
    v_mfma_f32_16x16x32_bf16 v[52:55], v[148:151], v[164:167], v[52:55]
    ds_read2_b32 v[92:93], v24 offset0:96 offset1:97
    v_mfma_f32_16x16x32_bf16 v[56:59], v[148:151], v[168:171], v[56:59]
    v_mfma_f32_16x16x32_bf16 v[60:63], v[148:151], v[172:175], v[60:63]
    ds_read2_b32 v[94:95], v24 offset0:98 offset1:99
    v_mfma_f32_16x16x32_bf16 v[64:67], v[148:151], v[176:179], v[64:67]
    ds_read2_b32 v[96:97], v24 offset0:224 offset1:225
    v_mfma_f32_16x16x32_bf16 v[56:59], v[152:155], v[164:167], v[56:59]
    ds_read2_b32 v[98:99], v24 offset0:226 offset1:227
    v_mfma_f32_16x16x32_bf16 v[60:63], v[152:155], v[168:171], v[60:63]
    v_mfma_f32_16x16x32_bf16 v[64:67], v[152:155], v[172:175], v[64:67]
    v_mfma_f32_16x16x32_bf16 v[60:63], v[156:159], v[164:167], v[60:63]
    v_mfma_f32_16x16x32_bf16 v[64:67], v[156:159], v[168:171], v[64:67]
    v_mfma_f32_16x16x32_bf16 v[64:67], v[160:163], v[164:167], v[64:67]
    v_mfma_f32_16x16x32_bf16 v[36:39], v[68:71], v[100:103], v[36:39]
    ds_read2_b32 v[132:133], v21 offset0:112 offset1:113
    v_mfma_f32_16x16x32_bf16 v[40:43], v[68:71], v[104:107], v[40:43]
    ds_read2_b32 v[134:135], v21 offset0:114 offset1:115
    v_mfma_f32_16x16x32_bf16 v[44:47], v[68:71], v[108:111], v[44:47]
    ds_read_b128 v[164:167], v32 offset:0
    v_mfma_f32_16x16x32_bf16 v[48:51], v[68:71], v[112:115], v[48:51]
    s_waitcnt lgkmcnt(14)
    v_mfma_f32_16x16x32_bf16 v[52:55], v[68:71], v[116:119], v[52:55]
    ds_read_b128 v[168:171], v32 offset:2048
    v_mfma_f32_16x16x32_bf16 v[56:59], v[68:71], v[120:123], v[56:59]
    ds_read_b128 v[172:175], v32 offset:4096
    v_mfma_f32_16x16x32_bf16 v[60:63], v[68:71], v[124:127], v[60:63]
    ds_read_b128 v[176:179], v32 offset:6144
    v_mfma_f32_16x16x32_bf16 v[64:67], v[68:71], v[128:131], v[64:67]
    v_mfma_f32_16x16x32_bf16 v[40:43], v[72:75], v[100:103], v[40:43]
    ds_read_b128 v[180:183], v32 offset:8192
    v_mfma_f32_16x16x32_bf16 v[44:47], v[72:75], v[104:107], v[44:47]
    ds_read_b128 v[184:187], v32 offset:10240
    v_mfma_f32_16x16x32_bf16 v[48:51], v[72:75], v[108:111], v[48:51]
    ds_read_b128 v[188:191], v32 offset:12288
    v_mfma_f32_16x16x32_bf16 v[52:55], v[72:75], v[112:115], v[52:55]
    v_mfma_f32_16x16x32_bf16 v[56:59], v[72:75], v[116:119], v[56:59]
    ds_read_b128 v[192:195], v32 offset:14336
    v_mfma_f32_16x16x32_bf16 v[60:63], v[72:75], v[120:123], v[60:63]
    ds_read2_b32 v[136:137], v21 offset0:240 offset1:241
    v_mfma_f32_16x16x32_bf16 v[64:67], v[72:75], v[124:127], v[64:67]
    ds_read2_b32 v[138:139], v21 offset0:242 offset1:243
    s_waitcnt lgkmcnt(14)
    v_mfma_f32_16x16x32_bf16 v[44:47], v[76:79], v[100:103], v[44:47]
    v_mfma_f32_16x16x32_bf16 v[48:51], v[76:79], v[104:107], v[48:51]
    ds_read2_b32 v[140:141], v22 offset0:112 offset1:113
    v_mfma_f32_16x16x32_bf16 v[52:55], v[76:79], v[108:111], v[52:55]
    ds_read2_b32 v[142:143], v22 offset0:114 offset1:115
    v_mfma_f32_16x16x32_bf16 v[56:59], v[76:79], v[112:115], v[56:59]
    ds_read2_b32 v[144:145], v22 offset0:240 offset1:241
    v_mfma_f32_16x16x32_bf16 v[60:63], v[76:79], v[116:119], v[60:63]
    v_mfma_f32_16x16x32_bf16 v[64:67], v[76:79], v[120:123], v[64:67]
    ds_read2_b32 v[146:147], v22 offset0:242 offset1:243
    v_mfma_f32_16x16x32_bf16 v[48:51], v[80:83], v[100:103], v[48:51]
    ds_read2_b32 v[148:149], v23 offset0:112 offset1:113
    v_mfma_f32_16x16x32_bf16 v[52:55], v[80:83], v[104:107], v[52:55]
    ds_read2_b32 v[150:151], v23 offset0:114 offset1:115
    v_mfma_f32_16x16x32_bf16 v[56:59], v[80:83], v[108:111], v[56:59]
    v_mfma_f32_16x16x32_bf16 v[60:63], v[80:83], v[112:115], v[60:63]
    ds_read2_b32 v[152:153], v23 offset0:240 offset1:241
    v_mfma_f32_16x16x32_bf16 v[64:67], v[80:83], v[116:119], v[64:67]
    ds_read2_b32 v[154:155], v23 offset0:242 offset1:243
    v_mfma_f32_16x16x32_bf16 v[52:55], v[84:87], v[100:103], v[52:55]
    ds_read2_b32 v[156:157], v24 offset0:112 offset1:113
    v_mfma_f32_16x16x32_bf16 v[56:59], v[84:87], v[104:107], v[56:59]
    v_mfma_f32_16x16x32_bf16 v[60:63], v[84:87], v[108:111], v[60:63]
    ds_read2_b32 v[158:159], v24 offset0:114 offset1:115
    v_mfma_f32_16x16x32_bf16 v[64:67], v[84:87], v[112:115], v[64:67]
    ds_read2_b32 v[160:161], v24 offset0:240 offset1:241
    v_mfma_f32_16x16x32_bf16 v[56:59], v[88:91], v[100:103], v[56:59]
    ds_read2_b32 v[162:163], v24 offset0:242 offset1:243
    v_mfma_f32_16x16x32_bf16 v[60:63], v[88:91], v[104:107], v[60:63]
    v_mfma_f32_16x16x32_bf16 v[64:67], v[88:91], v[108:111], v[64:67]
    v_mfma_f32_16x16x32_bf16 v[60:63], v[92:95], v[100:103], v[60:63]
    v_mfma_f32_16x16x32_bf16 v[64:67], v[92:95], v[104:107], v[64:67]
    s_waitcnt lgkmcnt(14)
    v_mfma_f32_16x16x32_bf16 v[64:67], v[96:99], v[100:103], v[64:67]
    v_mfma_f32_16x16x32_bf16 v[36:39], v[132:135], v[164:167], v[36:39]
    v_mfma_f32_16x16x32_bf16 v[40:43], v[132:135], v[168:171], v[40:43]
    v_mfma_f32_16x16x32_bf16 v[44:47], v[132:135], v[172:175], v[44:47]
    v_mfma_f32_16x16x32_bf16 v[48:51], v[132:135], v[176:179], v[48:51]
    v_mfma_f32_16x16x32_bf16 v[52:55], v[132:135], v[180:183], v[52:55]
    v_mfma_f32_16x16x32_bf16 v[56:59], v[132:135], v[184:187], v[56:59]
    v_mfma_f32_16x16x32_bf16 v[60:63], v[132:135], v[188:191], v[60:63]
    v_mfma_f32_16x16x32_bf16 v[64:67], v[132:135], v[192:195], v[64:67]
    s_waitcnt lgkmcnt(12)
    v_mfma_f32_16x16x32_bf16 v[40:43], v[136:139], v[164:167], v[40:43]
    v_cvt_pk_bf16_f32 v68, v39, v38
    v_cvt_pk_bf16_f32 v69, v37, v36
    v_mfma_f32_16x16x32_bf16 v[44:47], v[136:139], v[168:171], v[44:47]
    ds_write_b64 v20, v[68:69] offset:0
    v_mfma_f32_16x16x32_bf16 v[48:51], v[136:139], v[172:175], v[48:51]
    v_mfma_f32_16x16x32_bf16 v[52:55], v[136:139], v[176:179], v[52:55]
    v_mfma_f32_16x16x32_bf16 v[56:59], v[136:139], v[180:183], v[56:59]
    v_mfma_f32_16x16x32_bf16 v[60:63], v[136:139], v[184:187], v[60:63]
    v_mfma_f32_16x16x32_bf16 v[64:67], v[136:139], v[188:191], v[64:67]
    s_waitcnt lgkmcnt(11)
    v_mfma_f32_16x16x32_bf16 v[44:47], v[140:143], v[164:167], v[44:47]
    v_mfma_f32_16x16x32_bf16 v[48:51], v[140:143], v[168:171], v[48:51]
    v_cvt_pk_bf16_f32 v70, v43, v42
    v_cvt_pk_bf16_f32 v71, v41, v40
    v_mfma_f32_16x16x32_bf16 v[52:55], v[140:143], v[172:175], v[52:55]
    ds_write_b64 v20, v[70:71] offset:2048
    v_mfma_f32_16x16x32_bf16 v[56:59], v[140:143], v[176:179], v[56:59]
    v_mfma_f32_16x16x32_bf16 v[60:63], v[140:143], v[180:183], v[60:63]
    v_mfma_f32_16x16x32_bf16 v[64:67], v[140:143], v[184:187], v[64:67]
    s_waitcnt lgkmcnt(10)
    v_mfma_f32_16x16x32_bf16 v[48:51], v[144:147], v[164:167], v[48:51]
    v_mfma_f32_16x16x32_bf16 v[52:55], v[144:147], v[168:171], v[52:55]
    v_mfma_f32_16x16x32_bf16 v[56:59], v[144:147], v[172:175], v[56:59]
    v_cvt_pk_bf16_f32 v72, v47, v46
    v_cvt_pk_bf16_f32 v73, v45, v44
    v_mfma_f32_16x16x32_bf16 v[60:63], v[144:147], v[176:179], v[60:63]
    ds_write_b64 v20, v[72:73] offset:4096
    v_mfma_f32_16x16x32_bf16 v[64:67], v[144:147], v[180:183], v[64:67]
    s_waitcnt lgkmcnt(9)
    v_mfma_f32_16x16x32_bf16 v[52:55], v[148:151], v[164:167], v[52:55]
    v_mfma_f32_16x16x32_bf16 v[56:59], v[148:151], v[168:171], v[56:59]
    v_mfma_f32_16x16x32_bf16 v[60:63], v[148:151], v[172:175], v[60:63]
    v_mfma_f32_16x16x32_bf16 v[64:67], v[148:151], v[176:179], v[64:67]
    v_cvt_pk_bf16_f32 v74, v51, v50
    v_cvt_pk_bf16_f32 v75, v49, v48
    s_waitcnt lgkmcnt(7)
    v_mfma_f32_16x16x32_bf16 v[56:59], v[152:155], v[164:167], v[56:59]
    ds_write_b64 v20, v[74:75] offset:6144
    v_mfma_f32_16x16x32_bf16 v[60:63], v[152:155], v[168:171], v[60:63]
    v_mfma_f32_16x16x32_bf16 v[64:67], v[152:155], v[172:175], v[64:67]
    s_waitcnt lgkmcnt(6)
    v_mfma_f32_16x16x32_bf16 v[60:63], v[156:159], v[164:167], v[60:63]
    v_mfma_f32_16x16x32_bf16 v[64:67], v[156:159], v[168:171], v[64:67]
    v_cvt_pk_bf16_f32 v76, v55, v54
    v_cvt_pk_bf16_f32 v77, v53, v52
    s_waitcnt lgkmcnt(4)
    v_mfma_f32_16x16x32_bf16 v[64:67], v[160:163], v[164:167], v[64:67]
    ds_write_b64 v20, v[76:77] offset:8192
    v_cvt_pk_bf16_f32 v78, v59, v58
    v_cvt_pk_bf16_f32 v79, v57, v56
    ds_write_b64 v20, v[78:79] offset:10240
    v_cvt_pk_bf16_f32 v80, v63, v62
    v_cvt_pk_bf16_f32 v81, v61, v60
    ds_write_b64 v20, v[80:81] offset:12288
    s_nop 0
    v_cvt_pk_bf16_f32 v82, v67, v66
    v_cvt_pk_bf16_f32 v83, v65, v64
    ds_write_b64 v20, v[82:83] offset:14336
    s_mov_b64 exec, 1
    ds_add_u32 v18, v19 offset:12
    s_mov_b64 exec, -1
    s_add_u32 s80, s86, 94208
    v_add_u32 v5, s80, v15
    s_branch LA_s3_in
LA_s3:
    s_sleep 1
LA_s3_in:
    ds_read_b32 v6, v18 offset:12
    ds_read_b128 v[84:87], v5 offset:0
    ds_read_b128 v[88:91], v5 offset:4096
    ds_read_b128 v[92:95], v5 offset:8192
    ds_read_b128 v[96:99], v5 offset:12288
    s_waitcnt lgkmcnt(0)
    v_readfirstlane_b32 s78, v6
    s_nop 0
    s_cmp_ge_u32 s78, 4
    s_cbranch_scc0 LA_s3
    s_add_u32 s89, s91, 4194304
    buffer_store_dwordx4 v[84:87], v14, s[52:55], s89 offen sc1
    s_add_u32 s89, s91, 4198400
    buffer_store_dwordx4 v[88:91], v14, s[52:55], s89 offen sc1
    s_add_u32 s89, s91, 4202496
    buffer_store_dwordx4 v[92:95], v14, s[52:55], s89 offen sc1
    s_add_u32 s89, s91, 4206592
    buffer_store_dwordx4 v[96:99], v14, s[52:55], s89 offen sc1
    s_add_u32 s80, s86, 129024
    v_add_u32 v5, s80, v15
    s_waitcnt vmcnt(13)
    ds_write_b128 v5, v[228:231] offset:0
    s_waitcnt vmcnt(12)
    ds_write_b128 v5, v[232:235] offset:4096
    s_waitcnt vmcnt(11)
    ds_write_b128 v5, v[240:243] offset:8192
    s_waitcnt vmcnt(10)
    ds_write_b128 v5, v[244:247] offset:12288
    s_waitcnt vmcnt(9)
    ds_write_b128 v5, v[248:251] offset:16384
    s_waitcnt vmcnt(8)
    ds_write_b128 v5, v[196:199] offset:20480
    s_mov_b64 exec, 1
    ds_add_u32 v18, v19 offset:32
    s_mov_b64 exec, -1
    s_setprio 0
    s_mov_b32 s60, s22
    s_mov_b32 s61, s23
    s_mov_b32 s62, 0x800000
    s_mov_b32 s63, 0x20000
    s_lshr_b32 s81, s91, 4
    s_lshl_b32 s82, s3, 8
    s_add_u32 s81, s81, s82
    s_add_u32 s81, s81, 12648448
    s_lshl_b32 s80, s74, 14
    s_and_b32 s82, s75, 3
    s_lshl_b32 s82, s82, 8
    s_add_u32 s80, s80, s82
    s_add_u32 s80, s80, 12648448
    v_mov_b32 v5, 0
    v_lshlrev_b32 v7, 10, v0
    s_waitcnt vmcnt(7)
    v_lshlrev_b32 v132, 16, v212
    v_and_b32 v133, 0xffff0000, v212
    v_lshlrev_b32 v134, 16, v213
    v_and_b32 v135, 0xffff0000, v213
    v_lshlrev_b32 v136, 16, v214
    v_and_b32 v137, 0xffff0000, v214
    v_lshlrev_b32 v138, 16, v215
    v_and_b32 v139, 0xffff0000, v215
    s_waitcnt vmcnt(6)
    v_lshlrev_b32 v140, 16, v216
    v_and_b32 v141, 0xffff0000, v216
    v_lshlrev_b32 v142, 16, v217
    v_and_b32 v143, 0xffff0000, v217
    v_lshlrev_b32 v144, 16, v218
    v_and_b32 v145, 0xffff0000, v218
    v_lshlrev_b32 v146, 16, v219
    v_and_b32 v147, 0xffff0000, v219
    s_waitcnt vmcnt(5)
    v_lshlrev_b32 v148, 16, v220
    v_and_b32 v149, 0xffff0000, v220
    v_lshlrev_b32 v150, 16, v221
    v_and_b32 v151, 0xffff0000, v221
    v_lshlrev_b32 v152, 16, v222
    v_and_b32 v153, 0xffff0000, v222
    v_lshlrev_b32 v154, 16, v223
    v_and_b32 v155, 0xffff0000, v223
    s_waitcnt vmcnt(4)
    v_lshlrev_b32 v156, 16, v224
    v_and_b32 v157, 0xffff0000, v224
    v_lshlrev_b32 v158, 16, v225
    v_and_b32 v159, 0xffff0000, v225
    v_lshlrev_b32 v160, 16, v226
    v_and_b32 v161, 0xffff0000, v226
    v_lshlrev_b32 v162, 16, v227
    v_and_b32 v163, 0xffff0000, v227
    s_waitcnt vmcnt(0)
    s_mov_b64 exec, 1
    buffer_store_dword v19, v5, s[52:55], s81 offen sc1
    s_mov_b64 exec, 0xffff
    s_waitcnt vmcnt(0)
    s_branch LA_s7a_in
LA_s7a:
    s_sleep 1
LA_s7a_in:
    ds_read_b32 v6, v18 offset:28
    s_waitcnt lgkmcnt(0)
    v_readfirstlane_b32 s78, v6
    s_nop 0
    s_cmp_ge_u32 s78, 4
    s_cbranch_scc0 LA_s7a
    s_setprio 2
    s_mov_b32 s79, 0
LA_py:
    buffer_load_dword v6, v7, s[52:55], s80 offen sc1
    s_add_u32 s79, s79, 1
    s_cmp_gt_u32 s79, 200000
    s_cbranch_scc1 LA_py_x
    s_waitcnt vmcnt(0)
    v_cmp_ne_u32 vcc, 1, v6
    s_cbranch_vccz LA_py_x
    s_mov_b64 exec, vcc
    s_sleep 8
    s_branch LA_py
LA_py_x:
    s_waitcnt vmcnt(0)
    s_mov_b64 exec, -1
    s_mov_b32 s89, 4194304
    buffer_load_dwordx4 v[100:103], v12, s[52:55], s89 offen sc1
    s_mov_b32 s89, 4210688
    buffer_load_dwordx4 v[104:107], v12, s[52:55], s89 offen sc1
    s_mov_b32 s89, 4227072
    buffer_load_dwordx4 v[108:111], v12, s[52:55], s89 offen sc1
    s_mov_b32 s89, 4243456
    buffer_load_dwordx4 v[112:115], v12, s[52:55], s89 offen sc1
    s_waitcnt vmcnt(3)
    v_permlane32_swap_b32 v102, v100
    v_permlane32_swap_b32 v103, v101
    s_waitcnt vmcnt(2)
    v_permlane32_swap_b32 v106, v104
    v_permlane32_swap_b32 v107, v105
    s_waitcnt vmcnt(1)
    v_permlane32_swap_b32 v110, v108
    v_permlane32_swap_b32 v111, v109
    s_waitcnt vmcnt(0)
    v_permlane32_swap_b32 v114, v112
    v_permlane32_swap_b32 v115, v113
    v_and_b32 v68, 0xffff0000, v103
    v_and_b32 v69, 0xffff0000, v107
    v_and_b32 v70, 0xffff0000, v111
    v_and_b32 v71, 0xffff0000, v115
    v_and_b32 v72, 0xffff0000, v101
    v_and_b32 v73, 0xffff0000, v105
    v_and_b32 v74, 0xffff0000, v109
    v_and_b32 v75, 0xffff0000, v113
    v_mul_f32 v68, v68, v132
    v_mul_f32 v69, v69, v133
    v_mul_f32 v70, v70, v134
    v_mul_f32 v71, v71, v135
    v_mul_f32 v72, v72, v136
    v_mul_f32 v73, v73, v137
    v_mul_f32 v74, v74, v138
    v_mul_f32 v75, v75, v139
    v_cvt_pk_bf16_f32 v36, v68, v69
    v_cvt_pk_bf16_f32 v37, v70, v71
    v_cvt_pk_bf16_f32 v38, v72, v73
    v_cvt_pk_bf16_f32 v39, v74, v75
    s_mov_b32 s89, 0
    buffer_store_dwordx4 v[36:39], v13, s[60:63], s89 offen nt
    v_lshlrev_b32 v68, 16, v103
    v_lshlrev_b32 v69, 16, v107
    v_lshlrev_b32 v70, 16, v111
    v_lshlrev_b32 v71, 16, v115
    v_lshlrev_b32 v72, 16, v101
    v_lshlrev_b32 v73, 16, v105
    v_lshlrev_b32 v74, 16, v109
    v_lshlrev_b32 v75, 16, v113
    v_mul_f32 v68, v68, v140
    v_mul_f32 v69, v69, v141
    v_mul_f32 v70, v70, v142
    v_mul_f32 v71, v71, v143
    v_mul_f32 v72, v72, v144
    v_mul_f32 v73, v73, v145
    v_mul_f32 v74, v74, v146
    v_mul_f32 v75, v75, v147
    v_cvt_pk_bf16_f32 v40, v68, v69
    v_cvt_pk_bf16_f32 v41, v70, v71
    v_cvt_pk_bf16_f32 v42, v72, v73
    v_cvt_pk_bf16_f32 v43, v74, v75
    s_mov_b32 s89, 4096
    buffer_store_dwordx4 v[40:43], v13, s[60:63], s89 offen nt
    v_and_b32 v68, 0xffff0000, v102
    v_and_b32 v69, 0xffff0000, v106
    v_and_b32 v70, 0xffff0000, v110
    v_and_b32 v71, 0xffff0000, v114
    v_and_b32 v72, 0xffff0000, v100
    v_and_b32 v73, 0xffff0000, v104
    v_and_b32 v74, 0xffff0000, v108
    v_and_b32 v75, 0xffff0000, v112
    v_mul_f32 v68, v68, v148
    v_mul_f32 v69, v69, v149
    v_mul_f32 v70, v70, v150
    v_mul_f32 v71, v71, v151
    v_mul_f32 v72, v72, v152
    v_mul_f32 v73, v73, v153
    v_mul_f32 v74, v74, v154
    v_mul_f32 v75, v75, v155
    v_cvt_pk_bf16_f32 v44, v68, v69
    v_cvt_pk_bf16_f32 v45, v70, v71
    v_cvt_pk_bf16_f32 v46, v72, v73
    v_cvt_pk_bf16_f32 v47, v74, v75
    s_mov_b32 s89, 8192
    buffer_store_dwordx4 v[44:47], v13, s[60:63], s89 offen nt
    v_lshlrev_b32 v68, 16, v102
    v_lshlrev_b32 v69, 16, v106
    v_lshlrev_b32 v70, 16, v110
    v_lshlrev_b32 v71, 16, v114
    v_lshlrev_b32 v72, 16, v100
    v_lshlrev_b32 v73, 16, v104
    v_lshlrev_b32 v74, 16, v108
    v_lshlrev_b32 v75, 16, v112
    v_mul_f32 v68, v68, v156
    v_mul_f32 v69, v69, v157
    v_mul_f32 v70, v70, v158
    v_mul_f32 v71, v71, v159
    v_mul_f32 v72, v72, v160
    v_mul_f32 v73, v73, v161
    v_mul_f32 v74, v74, v162
    v_mul_f32 v75, v75, v163
    v_cvt_pk_bf16_f32 v48, v68, v69
    v_cvt_pk_bf16_f32 v49, v70, v71
    v_cvt_pk_bf16_f32 v50, v72, v73
    v_cvt_pk_bf16_f32 v51, v74, v75
    s_mov_b32 s89, 12288
    buffer_store_dwordx4 v[48:51], v13, s[60:63], s89 offen nt
    s_endpgm
L_B:
    s_setprio 3
    s_and_b32 s3, s3, 3
    s_lshr_b32 s78, s2, 3
    s_and_b32 s76, s78, 3
    s_and_b32 s79, s73, 12
    s_add_u32 s76, s76, s79
    s_lshr_b32 s74, s78, 4
    s_add_u32 s74, s74, s79
    s_and_b32 s79, s72, 8
    s_lshr_b32 s77, s78, 2
    s_add_u32 s77, s77, s79
    s_lshr_b32 s79, s79, 2
    s_add_u32 s74, s74, s79
    s_xor_b32 s74, s74, 4
    s_and_b32 s75, s78, 15
    s_lshr_b32 s86, s3, 1
    s_and_b32 s87, s3, 1
    v_mov_b32 v10, 162304
    v_mov_b32 v11, 1
    v_lshlrev_b32 v12, 4, v0
    v_lshl_add_u32 v13, v0, 2, v10
    v_mov_b32 v14, 0
    ds_write_b32 v13, v14
    s_lshl_b32 s78, s74, 4
    s_add_u32 s78, s78, s75
    s_lshl_b32 s96, s78, 8
    s_add_u32 s96, s96, 12582912
    s_lshl_b32 s78, s78, 2
    s_add_u32 s78, s78, s3
    s_lshl_b32 s78, s78, 8
    s_add_u32 s80, s78, 12648448
    s_lshl_b32 s81, s72, 1
    s_add_u32 s81, s81, s86
    s_lshl_b32 s97, s81, 4
    s_add_u32 s97, s97, s73
    s_lshl_b32 s97, s97, 8
    s_add_u32 s97, s97, 12910464
    v_mov_b32 v15, s80
    v_mov_b32 v223, s97
    v_cmp_gt_u32 vcc, 8, v0
    s_nop 1
    v_cndmask_b32 v15, v223, v15, vcc
    v_add_u32 v221, v15, v12
    s_lshl_b32 s78, s87, 2
    s_add_u32 s78, s78, 128
    s_add_u32 s97, s97, s78
    s_lshl_b32 s82, s73, 1
    s_add_u32 s82, s82, s87
    s_lshl_b32 s78, s81, 7
    s_add_u32 s78, s78, s82
    s_lshl_b32 s94, s78, 10
    s_add_u32 s94, s94, 8388608
    v_mov_b32 v212, 0
    v_mov_b32 v213, 0
    v_mov_b32 v214, 0
    v_mov_b32 v215, 0
    v_mov_b32 v220, 0
    s_waitcnt lgkmcnt(0)
    s_mov_b32 s52, s26
    s_mov_b32 s53, s27
    s_mov_b32 s54, 0x1000000
    s_mov_b32 s55, 0x20000
    s_mov_b32 s68, s24
    s_mov_b32 s69, s25
    s_mov_b32 s70, 0x100
    s_mov_b32 s71, 0x20000
    s_lshl_b32 s98, s74, 4
    s_or_b32 s78, s75, s3
    s_cmp_lg_u32 s78, 0
    s_cbranch_scc1 LB_notag
    s_mov_b64 exec, 0xffff
    v_lshlrev_b32 v15, 8, v0
    buffer_load_dword v251, v15, s[52:55], s96 offen sc1
LB_notag:
    s_lshl_b32 s78, s87, 3
    s_lshr_b32 exec_lo, 0xffff, s78
    s_mov_b32 exec_hi, 0
    buffer_store_dwordx4 v[212:215], v221, s[52:55], 0 offen sc1
    s_mov_b64 exec, -1
    v_and_b32 v13, 15, v0
    v_lshrrev_b32 v14, 4, v0
    v_lshrrev_b32 v15, 1, v13
    v_xor_b32 v15, v15, v14
    v_lshlrev_b32 v15, 4, v15
    v_lshl_add_u32 v15, v13, 7, v15
    v_add_u32 v2, 73728, v15
    v_xor_b32 v3, 64, v2
    s_lshl_b32 s78, s86, 13
    s_add_u32 s78, s78, 2048
    v_add_u32 v4, s78, v2
    v_add_u32 v5, s78, v3
    v_bfe_u32 v15, v0, 3, 2
    s_lshl_b32 s78, s87, 1
    s_add_u32 s78, s78, s86
    v_xor_b32 v15, s78, v15
    v_lshlrev_b32 v15, 5, v15
    v_and_b32 v223, 3, v0
    v_lshl_add_u32 v15, v223, 3, v15
    v_bfe_u32 v223, v0, 2, 2
    v_lshl_add_u32 v15, v223, 7, v15
    v_mul_u32_u24 v223, 3072, v14
    v_add_u32 v6, v223, v15
    v_xor_b32 v7, 32, v6
    s_mov_b32 s60, s22
    s_mov_b32 s61, s23
    s_mov_b32 s62, 0x800000
    s_mov_b32 s63, 0x20000
    v_and_b32 v15, 1, v13
    v_cmp_eq_u32 s[88:89], 1, v15
    v_lshl_add_u32 v15, v14, 2, v15
    v_cmp_le_u32 s[90:91], v15, v13
    v_add_u32 v15, 2, v15
    v_cmp_le_u32 s[92:93], v15, v13
    v_mov_b32 v212, 0x0c0c0c0c
    v_mov_b32 v15, 0xc0c0100
    v_mov_b32 v223, 0x1000c0c
    v_cndmask_b32 v15, v15, v223, s[88:89]
    v_cndmask_b32 v208, v15, v212, s[90:91]
    v_cndmask_b32 v210, v212, v15, s[90:91]
    v_mov_b32 v15, 0xc0c0302
    v_mov_b32 v223, 0x3020c0c
    v_cndmask_b32 v15, v15, v223, s[88:89]
    v_cndmask_b32 v209, v15, v212, s[92:93]
    v_cndmask_b32 v211, v212, v15, s[92:93]
    s_or_b32 s78, s72, s86
    s_cmp_eq_u32 s78, 0
    s_cselect_b32 s78, 0xf149f2ca, 0
    v_mov_b32 v212, s78
    v_mov_b32 v213, s78
    v_mov_b32 v214, s78
    v_mov_b32 v215, s78
    s_lshl_b32 s78, s87, 12
    s_add_u32 s78, s78, 24576
    s_lshl_b32 s79, s86, 9
    s_add_u32 s79, s79, s78
    v_lshlrev_b32 v15, 3, v0
    v_add_u32 v216, s79, v15
    s_lshl_b32 s80, s86, 11
    v_add_u32 v218, s80, v216
    v_xor_b32 v219, 512, v218
    s_add_u32 s78, s78, 2048
    s_cmp_eq_u32 s86, 0
    s_cselect_b32 s78, s78, 32768
    v_add_u32 v217, s78, v15
    v_bfe_u32 v14, v0, 3, 2
    v_lshlrev_b32 v14, 5, v14
    v_and_b32 v15, 3, v0
    v_lshl_add_u32 v14, v15, 3, v14
    v_lshrrev_b32 v15, 2, v0
    v_lshl_add_u32 v14, v15, 7, v14
    s_lshl_b32 s78, s86, 11
    v_add_u32 v244, s78, v14
    s_mov_b32 s64, s20
    s_mov_b32 s65, s21
    s_mov_b32 s66, 0x200000
    s_mov_b32 s67, 0x20000
    v_lshrrev_b32 v14, 4, v0
    v_lshlrev_b32 v14, 1, v14
    v_and_b32 v15, 7, v0
    v_xor_b32 v14, v14, v15
    v_lshlrev_b32 v14, 4, v14
    v_lshrrev_b32 v15, 3, v0
    v_lshl_add_u32 v14, v15, 11, v14
    s_lshl_b32 s78, s77, 7
    s_lshl_b32 s79, s3, 14
    s_add_u32 s78, s78, s79
    v_add_u32 v245, s78, v14
    v_and_b32 v14, 15, v0
    s_lshl_b32 s78, s76, 2
    s_add_u32 s78, s78, s3
    s_lshl_b32 s79, s78, 5
    v_add_u32 v14, s79, v14
    v_lshlrev_b32 v14, 12, v14
    v_bfe_u32 v15, v0, 4, 1
    v_lshl_add_u32 v14, v15, 5, v14
    v_lshrrev_b32 v15, 5, v0
    v_lshl_add_u32 v14, v15, 4, v14
    s_lshl_b32 s79, s77, 7
    s_add_u32 s79, s79, 2048
    v_add_u32 v246, s79, v14
    s_lshl_b32 s28, s78, 16
    s_add_u32 s28, s28, 8388608
    s_lshl_b32 s30, s76, 1
    s_add_u32 s30, s30, s86
    s_lshl_b32 s30, s30, 12
    s_add_u32 s30, s30, 12910592
    v_lshrrev_b32 v15, 1, v0
    v_lshlrev_b32 v15, 8, v15
    v_and_b32 v14, 1, v0
    v_lshl_add_u32 v247, v14, 2, v15
    s_and_b32 s78, s77, 7
    s_mov_b32 s79, 0x76543210
    s_cmp_eq_u32 s78, 1
    s_cselect_b32 s79, 0x76543201, s79
    s_cmp_eq_u32 s78, 2
    s_cselect_b32 s79, 0x76543120, s79
    s_cmp_eq_u32 s78, 3
    s_cselect_b32 s79, 0x76542310, s79
    s_cmp_eq_u32 s78, 4
    s_cselect_b32 s79, 0x76534210, s79
    s_cmp_eq_u32 s78, 5
    s_cselect_b32 s79, 0x76453210, s79
    s_cmp_eq_u32 s78, 6
    s_cselect_b32 s79, 0x75643210, s79
    s_cmp_eq_u32 s78, 7
    s_cselect_b32 s79, 0x67543210, s79
    s_and_b32 s78, s76, 3
    s_mul_i32 s78, s78, 0x22222222
    s_add_u32 s79, s79, s78
    s_bfe_u32 s78, s79, 0x30000
    s_lshl_b32 s44, s78, 18
    s_lshl_b32 s78, s78, 12
    s_add_u32 s36, s78, s28
    s_bfe_u32 s78, s79, 0x30004
    s_lshl_b32 s45, s78, 18
    s_lshl_b32 s78, s78, 12
    s_add_u32 s37, s78, s28
    s_bfe_u32 s78, s79, 0x30008
    s_lshl_b32 s46, s78, 18
    s_lshl_b32 s78, s78, 12
    s_add_u32 s38, s78, s28
    s_bfe_u32 s78, s79, 0x3000c
    s_lshl_b32 s47, s78, 18
    s_lshl_b32 s78, s78, 12
    s_add_u32 s39, s78, s28
    s_bfe_u32 s78, s79, 0x30010
    s_lshl_b32 s48, s78, 18
    s_lshl_b32 s78, s78, 12
    s_add_u32 s40, s78, s28
    s_bfe_u32 s78, s79, 0x30014
    s_lshl_b32 s49, s78, 18
    s_lshl_b32 s78, s78, 12
    s_add_u32 s41, s78, s28
    s_bfe_u32 s78, s79, 0x30018
    s_lshl_b32 s50, s78, 18
    s_lshl_b32 s78, s78, 12
    s_add_u32 s42, s78, s28
    s_bfe_u32 s78, s79, 0x3001c
    s_lshl_b32 s51, s78, 18
    s_lshl_b32 s78, s78, 12
    s_add_u32 s43, s78, s28
    s_lshl_b32 s34, s3, 10
    v_bfe_u32 v14, v0, 4, 1
    v_lshrrev_b32 v15, 5, v0
    v_lshl_add_u32 v14, v14, 1, v15
    v_and_b32 v15, 7, v0
    v_xor_b32 v14, v14, v15
    v_lshlrev_b32 v14, 4, v14
    v_and_b32 v223, 15, v0
    v_lshl_add_u32 v14, v223, 7, v14
    s_lshl_b32 s78, s3, 12
    v_add_u32 v248, s78, v14
    v_xor_b32 v249, 64, v248
    v_add_u32 v250, s78, v12
    v_lshrrev_b32 v14, 3, v0
    v_xor_b32 v15, v15, v14
    v_lshlrev_b32 v15, 4, v15
    v_lshl_add_u32 v14, v14, 12, v15
    s_lshl_b32 s78, s76, 2
    s_add_u32 s78, s78, s3
    s_lshl_b32 s78, s78, 17
    s_lshl_b32 s79, s77, 7
    s_add_u32 s78, s78, s79
    s_add_u32 s78, s78, 2048
    v_add_u32 v246, s78, v14
    s_waitcnt lgkmcnt(0)
    s_barrier
    ds_read_b128 v[120:123], v4 offset:0
    ds_read_b128 v[124:127], v4 offset:2048
    ds_read_b128 v[128:131], v4 offset:4096
    ds_read_b128 v[132:135], v4 offset:6144
    ds_read_b128 v[136:139], v2 offset:0
    ds_read_b64_tr_b16 v[140:141], v6 offset:0
    ds_read_b64_tr_b16 v[142:143], v6 offset:512
    ds_read_b64_tr_b16 v[144:145], v7 offset:0
    ds_read_b64_tr_b16 v[146:147], v7 offset:512
    ds_read_b64_tr_b16 v[148:149], v6 offset:1024
    ds_read_b64_tr_b16 v[150:151], v6 offset:1536
    ds_read_b64_tr_b16 v[152:153], v7 offset:1024
    ds_read_b64_tr_b16 v[154:155], v7 offset:1536
    ds_read_b64_tr_b16 v[156:157], v6 offset:2048
    ds_read_b64_tr_b16 v[158:159], v6 offset:2560
    ds_read_b64_tr_b16 v[160:161], v7 offset:2048
    ds_read_b64_tr_b16 v[162:163], v7 offset:2560
    s_waitcnt lgkmcnt(0)
    v_mfma_f32_16x16x32_bf16 v[16:19], v[140:143], v[120:123], 0
    ds_read_b128 v[164:167], v5 offset:0
    v_mfma_f32_16x16x32_bf16 v[20:23], v[144:147], v[120:123], 0
    ds_read_b128 v[168:171], v5 offset:2048
    v_mfma_f32_16x16x32_bf16 v[52:55], v[152:155], v[120:123], 0
    ds_read_b128 v[172:175], v5 offset:4096
    v_mfma_f32_16x16x32_bf16 v[48:51], v[148:151], v[120:123], 0
    ds_read_b128 v[176:179], v5 offset:6144
    v_mfma_f32_16x16x32_bf16 v[56:59], v[148:151], v[124:127], 0
    ds_read_b128 v[180:183], v3 offset:0
    v_mfma_f32_16x16x32_bf16 v[60:63], v[152:155], v[124:127], 0
    ds_read_b64_tr_b16 v[184:185], v6 offset:12288
    v_mfma_f32_16x16x32_bf16 v[28:31], v[144:147], v[124:127], 0
    ds_read_b64_tr_b16 v[186:187], v6 offset:12800
    v_mfma_f32_16x16x32_bf16 v[24:27], v[140:143], v[124:127], 0
    ds_read_b64_tr_b16 v[188:189], v7 offset:12288
    v_mfma_f32_16x16x32_bf16 v[32:35], v[140:143], v[128:131], 0
    ds_read_b64_tr_b16 v[190:191], v7 offset:12800
    v_mfma_f32_16x16x32_bf16 v[36:39], v[144:147], v[128:131], 0
    ds_read_b64_tr_b16 v[192:193], v6 offset:13312
    v_mfma_f32_16x16x32_bf16 v[68:71], v[152:155], v[128:131], 0
    ds_read_b64_tr_b16 v[194:195], v6 offset:13824
    v_mfma_f32_16x16x32_bf16 v[64:67], v[148:151], v[128:131], 0
    ds_read_b64_tr_b16 v[196:197], v7 offset:13312
    v_mfma_f32_16x16x32_bf16 v[112:115], v[148:151], v[136:139], 0
    ds_read_b64_tr_b16 v[198:199], v7 offset:13824
    v_mfma_f32_16x16x32_bf16 v[72:75], v[148:151], v[132:135], 0
    ds_read_b64_tr_b16 v[200:201], v6 offset:14336
    v_mfma_f32_16x16x32_bf16 v[76:79], v[152:155], v[132:135], 0
    ds_read_b64_tr_b16 v[202:203], v6 offset:14848
    v_mfma_f32_16x16x32_bf16 v[44:47], v[144:147], v[132:135], 0
    ds_read_b64_tr_b16 v[204:205], v7 offset:14336
    v_mfma_f32_16x16x32_bf16 v[40:43], v[140:143], v[132:135], 0
    ds_read_b64_tr_b16 v[206:207], v7 offset:14848
    v_mfma_f32_16x16x32_bf16 v[104:107], v[132:135], v[156:159], 0
    v_mfma_f32_16x16x32_bf16 v[108:111], v[132:135], v[160:163], 0
    v_mfma_f32_16x16x32_bf16 v[100:103], v[128:131], v[160:163], 0
    v_mfma_f32_16x16x32_bf16 v[96:99], v[128:131], v[156:159], 0
    v_mfma_f32_16x16x32_bf16 v[88:91], v[124:127], v[156:159], 0
    v_mfma_f32_16x16x32_bf16 v[92:95], v[124:127], v[160:163], 0
    v_mfma_f32_16x16x32_bf16 v[84:87], v[120:123], v[160:163], 0
    v_mfma_f32_16x16x32_bf16 v[80:83], v[120:123], v[156:159], 0
    v_mfma_f32_16x16x32_bf16 v[116:119], v[136:139], v[156:159], 0
    s_waitcnt vmcnt(0)
    s_waitcnt lgkmcnt(0)
    s_barrier
    s_or_b32 s78, s75, s3
    s_cbranch_scc0 LB_tag
LB_tagb:
    v_mfma_f32_16x16x32_bf16 v[16:19], v[184:187], v[164:167], v[16:19]
    ds_read_b128 v[120:123], v4 offset:18432
    v_mfma_f32_16x16x32_bf16 v[20:23], v[188:191], v[164:167], v[20:23]
    ds_read_b128 v[124:127], v4 offset:20480
    v_mfma_f32_16x16x32_bf16 v[52:55], v[196:199], v[164:167], v[52:55]
    ds_read_b128 v[128:131], v4 offset:22528
    v_mfma_f32_16x16x32_bf16 v[48:51], v[192:195], v[164:167], v[48:51]
    ds_read_b128 v[132:135], v4 offset:24576
    v_mfma_f32_16x16x32_bf16 v[56:59], v[192:195], v[168:171], v[56:59]
    ds_read_b128 v[136:139], v2 offset:18432
    v_mfma_f32_16x16x32_bf16 v[60:63], v[196:199], v[168:171], v[60:63]
    ds_read_b64_tr_b16 v[140:141], v6 offset:24576
    v_mfma_f32_16x16x32_bf16 v[28:31], v[188:191], v[168:171], v[28:31]
    ds_read_b64_tr_b16 v[142:143], v6 offset:25088
    v_mfma_f32_16x16x32_bf16 v[24:27], v[184:187], v[168:171], v[24:27]
    ds_read_b64_tr_b16 v[144:145], v7 offset:24576
    v_mfma_f32_16x16x32_bf16 v[32:35], v[184:187], v[172:175], v[32:35]
    ds_read_b64_tr_b16 v[146:147], v7 offset:25088
    v_mfma_f32_16x16x32_bf16 v[36:39], v[188:191], v[172:175], v[36:39]
    ds_read_b64_tr_b16 v[148:149], v6 offset:25600
    v_mfma_f32_16x16x32_bf16 v[68:71], v[196:199], v[172:175], v[68:71]
    ds_read_b64_tr_b16 v[150:151], v6 offset:26112
    v_mfma_f32_16x16x32_bf16 v[64:67], v[192:195], v[172:175], v[64:67]
    ds_read_b64_tr_b16 v[152:153], v7 offset:25600
    v_mfma_f32_16x16x32_bf16 v[112:115], v[192:195], v[180:183], v[112:115]
    ds_read_b64_tr_b16 v[154:155], v7 offset:26112
    v_mfma_f32_16x16x32_bf16 v[72:75], v[192:195], v[176:179], v[72:75]
    ds_read_b64_tr_b16 v[156:157], v6 offset:26624
    v_mfma_f32_16x16x32_bf16 v[76:79], v[196:199], v[176:179], v[76:79]
    ds_read_b64_tr_b16 v[158:159], v6 offset:27136
    v_mfma_f32_16x16x32_bf16 v[44:47], v[188:191], v[176:179], v[44:47]
    ds_read_b64_tr_b16 v[160:161], v7 offset:26624
    v_mfma_f32_16x16x32_bf16 v[40:43], v[184:187], v[176:179], v[40:43]
    ds_read_b64_tr_b16 v[162:163], v7 offset:27136
    v_mfma_f32_16x16x32_bf16 v[104:107], v[176:179], v[200:203], v[104:107]
    v_mfma_f32_16x16x32_bf16 v[108:111], v[176:179], v[204:207], v[108:111]
    v_mfma_f32_16x16x32_bf16 v[100:103], v[172:175], v[204:207], v[100:103]
    v_mfma_f32_16x16x32_bf16 v[96:99], v[172:175], v[200:203], v[96:99]
    v_mfma_f32_16x16x32_bf16 v[88:91], v[168:171], v[200:203], v[88:91]
    v_mfma_f32_16x16x32_bf16 v[92:95], v[168:171], v[204:207], v[92:95]
    v_mfma_f32_16x16x32_bf16 v[84:87], v[164:167], v[204:207], v[84:87]
    v_mfma_f32_16x16x32_bf16 v[80:83], v[164:167], v[200:203], v[80:83]
    v_mfma_f32_16x16x32_bf16 v[116:119], v[180:183], v[200:203], v[116:119]
    s_waitcnt lgkmcnt(0)
    v_mfma_f32_16x16x32_bf16 v[16:19], v[140:143], v[120:123], v[16:19]
    ds_read_b128 v[164:167], v5 offset:18432
    v_mfma_f32_16x16x32_bf16 v[20:23], v[144:147], v[120:123], v[20:23]
    ds_read_b128 v[168:171], v5 offset:20480
    v_mfma_f32_16x16x32_bf16 v[52:55], v[152:155], v[120:123], v[52:55]
    ds_read_b128 v[172:175], v5 offset:22528
    v_mfma_f32_16x16x32_bf16 v[48:51], v[148:151], v[120:123], v[48:51]
    ds_read_b128 v[176:179], v5 offset:24576
    v_mfma_f32_16x16x32_bf16 v[56:59], v[148:151], v[124:127], v[56:59]
    ds_read_b128 v[180:183], v3 offset:18432
    v_mfma_f32_16x16x32_bf16 v[60:63], v[152:155], v[124:127], v[60:63]
    ds_read_b64_tr_b16 v[184:185], v6 offset:36864
    v_mfma_f32_16x16x32_bf16 v[28:31], v[144:147], v[124:127], v[28:31]
    ds_read_b64_tr_b16 v[186:187], v6 offset:37376
    v_mfma_f32_16x16x32_bf16 v[24:27], v[140:143], v[124:127], v[24:27]
    ds_read_b64_tr_b16 v[188:189], v7 offset:36864
    v_mfma_f32_16x16x32_bf16 v[32:35], v[140:143], v[128:131], v[32:35]
    ds_read_b64_tr_b16 v[190:191], v7 offset:37376
    v_mfma_f32_16x16x32_bf16 v[36:39], v[144:147], v[128:131], v[36:39]
    ds_read_b64_tr_b16 v[192:193], v6 offset:37888
    v_mfma_f32_16x16x32_bf16 v[68:71], v[152:155], v[128:131], v[68:71]
    ds_read_b64_tr_b16 v[194:195], v6 offset:38400
    v_mfma_f32_16x16x32_bf16 v[64:67], v[148:151], v[128:131], v[64:67]
    ds_read_b64_tr_b16 v[196:197], v7 offset:37888
    v_mfma_f32_16x16x32_bf16 v[112:115], v[148:151], v[136:139], v[112:115]
    ds_read_b64_tr_b16 v[198:199], v7 offset:38400
    v_mfma_f32_16x16x32_bf16 v[72:75], v[148:151], v[132:135], v[72:75]
    ds_read_b64_tr_b16 v[200:201], v6 offset:38912
    v_mfma_f32_16x16x32_bf16 v[76:79], v[152:155], v[132:135], v[76:79]
    ds_read_b64_tr_b16 v[202:203], v6 offset:39424
    v_mfma_f32_16x16x32_bf16 v[44:47], v[144:147], v[132:135], v[44:47]
    ds_read_b64_tr_b16 v[204:205], v7 offset:38912
    v_mfma_f32_16x16x32_bf16 v[40:43], v[140:143], v[132:135], v[40:43]
    ds_read_b64_tr_b16 v[206:207], v7 offset:39424
    v_mfma_f32_16x16x32_bf16 v[104:107], v[132:135], v[156:159], v[104:107]
    v_mfma_f32_16x16x32_bf16 v[108:111], v[132:135], v[160:163], v[108:111]
    v_mfma_f32_16x16x32_bf16 v[100:103], v[128:131], v[160:163], v[100:103]
    v_mfma_f32_16x16x32_bf16 v[96:99], v[128:131], v[156:159], v[96:99]
    v_mfma_f32_16x16x32_bf16 v[88:91], v[124:127], v[156:159], v[88:91]
    v_mfma_f32_16x16x32_bf16 v[92:95], v[124:127], v[160:163], v[92:95]
    v_mfma_f32_16x16x32_bf16 v[84:87], v[120:123], v[160:163], v[84:87]
    v_mfma_f32_16x16x32_bf16 v[80:83], v[120:123], v[156:159], v[80:83]
    v_mfma_f32_16x16x32_bf16 v[116:119], v[136:139], v[156:159], v[116:119]
    s_waitcnt lgkmcnt(0)
    s_barrier
    v_mfma_f32_16x16x32_bf16 v[16:19], v[184:187], v[164:167], v[16:19]
    ds_read_b128 v[120:123], v4 offset:36864
    v_mfma_f32_16x16x32_bf16 v[20:23], v[188:191], v[164:167], v[20:23]
    ds_read_b128 v[124:127], v4 offset:38912
    v_mfma_f32_16x16x32_bf16 v[52:55], v[196:199], v[164:167], v[52:55]
    ds_read_b128 v[128:131], v4 offset:40960
    v_mfma_f32_16x16x32_bf16 v[48:51], v[192:195], v[164:167], v[48:51]
    ds_read_b128 v[132:135], v4 offset:43008
    v_mfma_f32_16x16x32_bf16 v[56:59], v[192:195], v[168:171], v[56:59]
    ds_read_b128 v[136:139], v2 offset:36864
    v_mfma_f32_16x16x32_bf16 v[60:63], v[196:199], v[168:171], v[60:63]
    ds_read_b64_tr_b16 v[140:141], v6 offset:49152
    v_mfma_f32_16x16x32_bf16 v[28:31], v[188:191], v[168:171], v[28:31]
    ds_read_b64_tr_b16 v[142:143], v6 offset:49664
    v_mfma_f32_16x16x32_bf16 v[24:27], v[184:187], v[168:171], v[24:27]
    ds_read_b64_tr_b16 v[144:145], v7 offset:49152
    v_mfma_f32_16x16x32_bf16 v[32:35], v[184:187], v[172:175], v[32:35]
    ds_read_b64_tr_b16 v[146:147], v7 offset:49664
    v_mfma_f32_16x16x32_bf16 v[36:39], v[188:191], v[172:175], v[36:39]
    ds_read_b64_tr_b16 v[148:149], v6 offset:50176
    v_mfma_f32_16x16x32_bf16 v[68:71], v[196:199], v[172:175], v[68:71]
    ds_read_b64_tr_b16 v[150:151], v6 offset:50688
    v_mfma_f32_16x16x32_bf16 v[64:67], v[192:195], v[172:175], v[64:67]
    ds_read_b64_tr_b16 v[152:153], v7 offset:50176
    v_mfma_f32_16x16x32_bf16 v[112:115], v[192:195], v[180:183], v[112:115]
    ds_read_b64_tr_b16 v[154:155], v7 offset:50688
    v_mfma_f32_16x16x32_bf16 v[72:75], v[192:195], v[176:179], v[72:75]
    ds_read_b64_tr_b16 v[156:157], v6 offset:51200
    v_mfma_f32_16x16x32_bf16 v[76:79], v[196:199], v[176:179], v[76:79]
    ds_read_b64_tr_b16 v[158:159], v6 offset:51712
    v_mfma_f32_16x16x32_bf16 v[44:47], v[188:191], v[176:179], v[44:47]
    ds_read_b64_tr_b16 v[160:161], v7 offset:51200
    v_mfma_f32_16x16x32_bf16 v[40:43], v[184:187], v[176:179], v[40:43]
    ds_read_b64_tr_b16 v[162:163], v7 offset:51712
    v_mfma_f32_16x16x32_bf16 v[104:107], v[176:179], v[200:203], v[104:107]
    v_mfma_f32_16x16x32_bf16 v[108:111], v[176:179], v[204:207], v[108:111]
    v_mfma_f32_16x16x32_bf16 v[100:103], v[172:175], v[204:207], v[100:103]
    v_mfma_f32_16x16x32_bf16 v[96:99], v[172:175], v[200:203], v[96:99]
    v_mfma_f32_16x16x32_bf16 v[88:91], v[168:171], v[200:203], v[88:91]
    v_mfma_f32_16x16x32_bf16 v[92:95], v[168:171], v[204:207], v[92:95]
    v_mfma_f32_16x16x32_bf16 v[84:87], v[164:167], v[204:207], v[84:87]
    v_mfma_f32_16x16x32_bf16 v[80:83], v[164:167], v[200:203], v[80:83]
    v_mfma_f32_16x16x32_bf16 v[116:119], v[180:183], v[200:203], v[116:119]
    s_waitcnt lgkmcnt(0)
    v_mfma_f32_16x16x32_bf16 v[16:19], v[140:143], v[120:123], v[16:19]
    ds_read_b128 v[164:167], v5 offset:36864
    v_mfma_f32_16x16x32_bf16 v[20:23], v[144:147], v[120:123], v[20:23]
    ds_read_b128 v[168:171], v5 offset:38912
    v_mfma_f32_16x16x32_bf16 v[52:55], v[152:155], v[120:123], v[52:55]
    ds_read_b128 v[172:175], v5 offset:40960
    v_mfma_f32_16x16x32_bf16 v[48:51], v[148:151], v[120:123], v[48:51]
    ds_read_b128 v[176:179], v5 offset:43008
    v_mfma_f32_16x16x32_bf16 v[56:59], v[148:151], v[124:127], v[56:59]
    ds_read_b128 v[180:183], v3 offset:36864
    v_mfma_f32_16x16x32_bf16 v[60:63], v[152:155], v[124:127], v[60:63]
    ds_read_b64_tr_b16 v[184:185], v6 offset:61440
    v_mfma_f32_16x16x32_bf16 v[28:31], v[144:147], v[124:127], v[28:31]
    ds_read_b64_tr_b16 v[186:187], v6 offset:61952
    v_mfma_f32_16x16x32_bf16 v[24:27], v[140:143], v[124:127], v[24:27]
    ds_read_b64_tr_b16 v[188:189], v7 offset:61440
    v_mfma_f32_16x16x32_bf16 v[32:35], v[140:143], v[128:131], v[32:35]
    ds_read_b64_tr_b16 v[190:191], v7 offset:61952
    v_mfma_f32_16x16x32_bf16 v[36:39], v[144:147], v[128:131], v[36:39]
    ds_read_b64_tr_b16 v[192:193], v6 offset:62464
    v_mfma_f32_16x16x32_bf16 v[68:71], v[152:155], v[128:131], v[68:71]
    ds_read_b64_tr_b16 v[194:195], v6 offset:62976
    v_mfma_f32_16x16x32_bf16 v[64:67], v[148:151], v[128:131], v[64:67]
    ds_read_b64_tr_b16 v[196:197], v7 offset:62464
    v_mfma_f32_16x16x32_bf16 v[112:115], v[148:151], v[136:139], v[112:115]
    ds_read_b64_tr_b16 v[198:199], v7 offset:62976
    v_mfma_f32_16x16x32_bf16 v[72:75], v[148:151], v[132:135], v[72:75]
    ds_read_b64_tr_b16 v[200:201], v6 offset:63488
    v_mfma_f32_16x16x32_bf16 v[76:79], v[152:155], v[132:135], v[76:79]
    ds_read_b64_tr_b16 v[202:203], v6 offset:64000
    v_mfma_f32_16x16x32_bf16 v[44:47], v[144:147], v[132:135], v[44:47]
    ds_read_b64_tr_b16 v[204:205], v7 offset:63488
    v_mfma_f32_16x16x32_bf16 v[40:43], v[140:143], v[132:135], v[40:43]
    ds_read_b64_tr_b16 v[206:207], v7 offset:64000
    v_mfma_f32_16x16x32_bf16 v[104:107], v[132:135], v[156:159], v[104:107]
    v_mfma_f32_16x16x32_bf16 v[108:111], v[132:135], v[160:163], v[108:111]
    v_mfma_f32_16x16x32_bf16 v[100:103], v[128:131], v[160:163], v[100:103]
    v_mfma_f32_16x16x32_bf16 v[96:99], v[128:131], v[156:159], v[96:99]
    v_mfma_f32_16x16x32_bf16 v[88:91], v[124:127], v[156:159], v[88:91]
    v_mfma_f32_16x16x32_bf16 v[92:95], v[124:127], v[160:163], v[92:95]
    v_mfma_f32_16x16x32_bf16 v[84:87], v[120:123], v[160:163], v[84:87]
    v_mfma_f32_16x16x32_bf16 v[80:83], v[120:123], v[156:159], v[80:83]
    v_mfma_f32_16x16x32_bf16 v[116:119], v[136:139], v[156:159], v[116:119]
    s_waitcnt lgkmcnt(0)
    s_barrier
    v_mfma_f32_16x16x32_bf16 v[16:19], v[184:187], v[164:167], v[16:19]
    ds_read_b128 v[120:123], v4 offset:0
    v_mfma_f32_16x16x32_bf16 v[20:23], v[188:191], v[164:167], v[20:23]
    ds_read_b128 v[124:127], v4 offset:2048
    v_mfma_f32_16x16x32_bf16 v[52:55], v[196:199], v[164:167], v[52:55]
    ds_read_b128 v[128:131], v4 offset:4096
    v_mfma_f32_16x16x32_bf16 v[48:51], v[192:195], v[164:167], v[48:51]
    ds_read_b128 v[132:135], v4 offset:6144
    v_mfma_f32_16x16x32_bf16 v[56:59], v[192:195], v[168:171], v[56:59]
    ds_read_b128 v[136:139], v2 offset:0
    v_mfma_f32_16x16x32_bf16 v[60:63], v[196:199], v[168:171], v[60:63]
    ds_read_b64_tr_b16 v[140:141], v6 offset:0
    v_mfma_f32_16x16x32_bf16 v[28:31], v[188:191], v[168:171], v[28:31]
    ds_read_b64_tr_b16 v[142:143], v6 offset:512
    v_mfma_f32_16x16x32_bf16 v[24:27], v[184:187], v[168:171], v[24:27]
    ds_read_b64_tr_b16 v[144:145], v7 offset:0
    v_mfma_f32_16x16x32_bf16 v[32:35], v[184:187], v[172:175], v[32:35]
    ds_read_b64_tr_b16 v[146:147], v7 offset:512
    v_mfma_f32_16x16x32_bf16 v[36:39], v[188:191], v[172:175], v[36:39]
    ds_read_b64_tr_b16 v[148:149], v6 offset:1024
    v_mfma_f32_16x16x32_bf16 v[68:71], v[196:199], v[172:175], v[68:71]
    ds_read_b64_tr_b16 v[150:151], v6 offset:1536
    v_mfma_f32_16x16x32_bf16 v[64:67], v[192:195], v[172:175], v[64:67]
    ds_read_b64_tr_b16 v[152:153], v7 offset:1024
    v_mfma_f32_16x16x32_bf16 v[112:115], v[192:195], v[180:183], v[112:115]
    ds_read_b64_tr_b16 v[154:155], v7 offset:1536
    v_mfma_f32_16x16x32_bf16 v[72:75], v[192:195], v[176:179], v[72:75]
    ds_read_b64_tr_b16 v[156:157], v6 offset:2048
    v_mfma_f32_16x16x32_bf16 v[76:79], v[196:199], v[176:179], v[76:79]
    ds_read_b64_tr_b16 v[158:159], v6 offset:2560
    v_mfma_f32_16x16x32_bf16 v[44:47], v[188:191], v[176:179], v[44:47]
    ds_read_b64_tr_b16 v[160:161], v7 offset:2048
    v_mfma_f32_16x16x32_bf16 v[40:43], v[184:187], v[176:179], v[40:43]
    ds_read_b64_tr_b16 v[162:163], v7 offset:2560
    v_mfma_f32_16x16x32_bf16 v[104:107], v[176:179], v[200:203], v[104:107]
    v_mfma_f32_16x16x32_bf16 v[108:111], v[176:179], v[204:207], v[108:111]
    v_mfma_f32_16x16x32_bf16 v[100:103], v[172:175], v[204:207], v[100:103]
    v_mfma_f32_16x16x32_bf16 v[96:99], v[172:175], v[200:203], v[96:99]
    v_mfma_f32_16x16x32_bf16 v[88:91], v[168:171], v[200:203], v[88:91]
    v_mfma_f32_16x16x32_bf16 v[92:95], v[168:171], v[204:207], v[92:95]
    v_mfma_f32_16x16x32_bf16 v[84:87], v[164:167], v[204:207], v[84:87]
    v_mfma_f32_16x16x32_bf16 v[80:83], v[164:167], v[200:203], v[80:83]
    v_mfma_f32_16x16x32_bf16 v[116:119], v[180:183], v[200:203], v[116:119]
    s_waitcnt lgkmcnt(0)
    v_mfma_f32_16x16x32_bf16 v[16:19], v[140:143], v[120:123], v[16:19]
    ds_read_b128 v[164:167], v5 offset:0
    v_mfma_f32_16x16x32_bf16 v[20:23], v[144:147], v[120:123], v[20:23]
    ds_read_b128 v[168:171], v5 offset:2048
    v_mfma_f32_16x16x32_bf16 v[52:55], v[152:155], v[120:123], v[52:55]
    ds_read_b128 v[172:175], v5 offset:4096
    v_mfma_f32_16x16x32_bf16 v[48:51], v[148:151], v[120:123], v[48:51]
    ds_read_b128 v[176:179], v5 offset:6144
    v_mfma_f32_16x16x32_bf16 v[56:59], v[148:151], v[124:127], v[56:59]
    ds_read_b128 v[180:183], v3 offset:0
    v_mfma_f32_16x16x32_bf16 v[60:63], v[152:155], v[124:127], v[60:63]
    ds_read_b64_tr_b16 v[184:185], v6 offset:12288
    v_mfma_f32_16x16x32_bf16 v[28:31], v[144:147], v[124:127], v[28:31]
    ds_read_b64_tr_b16 v[186:187], v6 offset:12800
    v_mfma_f32_16x16x32_bf16 v[24:27], v[140:143], v[124:127], v[24:27]
    ds_read_b64_tr_b16 v[188:189], v7 offset:12288
    v_mfma_f32_16x16x32_bf16 v[32:35], v[140:143], v[128:131], v[32:35]
    ds_read_b64_tr_b16 v[190:191], v7 offset:12800
    v_mfma_f32_16x16x32_bf16 v[36:39], v[144:147], v[128:131], v[36:39]
    ds_read_b64_tr_b16 v[192:193], v6 offset:13312
    v_mfma_f32_16x16x32_bf16 v[68:71], v[152:155], v[128:131], v[68:71]
    ds_read_b64_tr_b16 v[194:195], v6 offset:13824
    v_mfma_f32_16x16x32_bf16 v[64:67], v[148:151], v[128:131], v[64:67]
    ds_read_b64_tr_b16 v[196:197], v7 offset:13312
    v_mfma_f32_16x16x32_bf16 v[112:115], v[148:151], v[136:139], v[112:115]
    ds_read_b64_tr_b16 v[198:199], v7 offset:13824
    v_mfma_f32_16x16x32_bf16 v[72:75], v[148:151], v[132:135], v[72:75]
    ds_read_b64_tr_b16 v[200:201], v6 offset:14336
    v_mfma_f32_16x16x32_bf16 v[76:79], v[152:155], v[132:135], v[76:79]
    ds_read_b64_tr_b16 v[202:203], v6 offset:14848
    v_mfma_f32_16x16x32_bf16 v[44:47], v[144:147], v[132:135], v[44:47]
    ds_read_b64_tr_b16 v[204:205], v7 offset:14336
    v_mfma_f32_16x16x32_bf16 v[40:43], v[140:143], v[132:135], v[40:43]
    ds_read_b64_tr_b16 v[206:207], v7 offset:14848
    v_mfma_f32_16x16x32_bf16 v[104:107], v[132:135], v[156:159], v[104:107]
    v_mfma_f32_16x16x32_bf16 v[108:111], v[132:135], v[160:163], v[108:111]
    v_mfma_f32_16x16x32_bf16 v[100:103], v[128:131], v[160:163], v[100:103]
    v_mfma_f32_16x16x32_bf16 v[96:99], v[128:131], v[156:159], v[96:99]
    v_mfma_f32_16x16x32_bf16 v[88:91], v[124:127], v[156:159], v[88:91]
    v_mfma_f32_16x16x32_bf16 v[92:95], v[124:127], v[160:163], v[92:95]
    v_mfma_f32_16x16x32_bf16 v[84:87], v[120:123], v[160:163], v[84:87]
    v_mfma_f32_16x16x32_bf16 v[80:83], v[120:123], v[156:159], v[80:83]
    v_mfma_f32_16x16x32_bf16 v[116:119], v[136:139], v[156:159], v[116:119]
    s_waitcnt lgkmcnt(0)
    s_barrier
    v_mfma_f32_16x16x32_bf16 v[16:19], v[184:187], v[164:167], v[16:19]
    ds_read_b128 v[120:123], v4 offset:18432
    v_mfma_f32_16x16x32_bf16 v[20:23], v[188:191], v[164:167], v[20:23]
    ds_read_b128 v[124:127], v4 offset:20480
    v_mfma_f32_16x16x32_bf16 v[52:55], v[196:199], v[164:167], v[52:55]
    ds_read_b128 v[128:131], v4 offset:22528
    v_mfma_f32_16x16x32_bf16 v[48:51], v[192:195], v[164:167], v[48:51]
    ds_read_b128 v[132:135], v4 offset:24576
    v_mfma_f32_16x16x32_bf16 v[56:59], v[192:195], v[168:171], v[56:59]
    ds_read_b128 v[136:139], v2 offset:18432
    v_mfma_f32_16x16x32_bf16 v[60:63], v[196:199], v[168:171], v[60:63]
    ds_read_b64_tr_b16 v[140:141], v6 offset:24576
    v_mfma_f32_16x16x32_bf16 v[28:31], v[188:191], v[168:171], v[28:31]
    ds_read_b64_tr_b16 v[142:143], v6 offset:25088
    v_mfma_f32_16x16x32_bf16 v[24:27], v[184:187], v[168:171], v[24:27]
    ds_read_b64_tr_b16 v[144:145], v7 offset:24576
    v_mfma_f32_16x16x32_bf16 v[32:35], v[184:187], v[172:175], v[32:35]
    ds_read_b64_tr_b16 v[146:147], v7 offset:25088
    v_mfma_f32_16x16x32_bf16 v[36:39], v[188:191], v[172:175], v[36:39]
    ds_read_b64_tr_b16 v[148:149], v6 offset:25600
    v_mfma_f32_16x16x32_bf16 v[68:71], v[196:199], v[172:175], v[68:71]
    ds_read_b64_tr_b16 v[150:151], v6 offset:26112
    v_mfma_f32_16x16x32_bf16 v[64:67], v[192:195], v[172:175], v[64:67]
    ds_read_b64_tr_b16 v[152:153], v7 offset:25600
    v_mfma_f32_16x16x32_bf16 v[112:115], v[192:195], v[180:183], v[112:115]
    ds_read_b64_tr_b16 v[154:155], v7 offset:26112
    v_mfma_f32_16x16x32_bf16 v[72:75], v[192:195], v[176:179], v[72:75]
    ds_read_b64_tr_b16 v[156:157], v6 offset:26624
    v_mfma_f32_16x16x32_bf16 v[76:79], v[196:199], v[176:179], v[76:79]
    ds_read_b64_tr_b16 v[158:159], v6 offset:27136
    v_mfma_f32_16x16x32_bf16 v[44:47], v[188:191], v[176:179], v[44:47]
    ds_read_b64_tr_b16 v[160:161], v7 offset:26624
    v_mfma_f32_16x16x32_bf16 v[40:43], v[184:187], v[176:179], v[40:43]
    ds_read_b64_tr_b16 v[162:163], v7 offset:27136
    v_mfma_f32_16x16x32_bf16 v[104:107], v[176:179], v[200:203], v[104:107]
    v_mfma_f32_16x16x32_bf16 v[108:111], v[176:179], v[204:207], v[108:111]
    v_mfma_f32_16x16x32_bf16 v[100:103], v[172:175], v[204:207], v[100:103]
    v_mfma_f32_16x16x32_bf16 v[96:99], v[172:175], v[200:203], v[96:99]
    v_mfma_f32_16x16x32_bf16 v[88:91], v[168:171], v[200:203], v[88:91]
    v_mfma_f32_16x16x32_bf16 v[92:95], v[168:171], v[204:207], v[92:95]
    v_mfma_f32_16x16x32_bf16 v[84:87], v[164:167], v[204:207], v[84:87]
    v_mfma_f32_16x16x32_bf16 v[80:83], v[164:167], v[200:203], v[80:83]
    v_mfma_f32_16x16x32_bf16 v[116:119], v[180:183], v[200:203], v[116:119]
    s_waitcnt lgkmcnt(0)
    v_mfma_f32_16x16x32_bf16 v[16:19], v[140:143], v[120:123], v[16:19]
    ds_read_b128 v[164:167], v5 offset:18432
    v_mfma_f32_16x16x32_bf16 v[20:23], v[144:147], v[120:123], v[20:23]
    ds_read_b128 v[168:171], v5 offset:20480
    v_mfma_f32_16x16x32_bf16 v[52:55], v[152:155], v[120:123], v[52:55]
    ds_read_b128 v[172:175], v5 offset:22528
    v_mfma_f32_16x16x32_bf16 v[48:51], v[148:151], v[120:123], v[48:51]
    ds_read_b128 v[176:179], v5 offset:24576
    v_mfma_f32_16x16x32_bf16 v[56:59], v[148:151], v[124:127], v[56:59]
    ds_read_b128 v[180:183], v3 offset:18432
    v_mfma_f32_16x16x32_bf16 v[60:63], v[152:155], v[124:127], v[60:63]
    ds_read_b64_tr_b16 v[184:185], v6 offset:36864
    v_mfma_f32_16x16x32_bf16 v[28:31], v[144:147], v[124:127], v[28:31]
    ds_read_b64_tr_b16 v[186:187], v6 offset:37376
    v_mfma_f32_16x16x32_bf16 v[24:27], v[140:143], v[124:127], v[24:27]
    ds_read_b64_tr_b16 v[188:189], v7 offset:36864
    v_mfma_f32_16x16x32_bf16 v[32:35], v[140:143], v[128:131], v[32:35]
    ds_read_b64_tr_b16 v[190:191], v7 offset:37376
    v_mfma_f32_16x16x32_bf16 v[36:39], v[144:147], v[128:131], v[36:39]
    ds_read_b64_tr_b16 v[192:193], v6 offset:37888
    v_mfma_f32_16x16x32_bf16 v[68:71], v[152:155], v[128:131], v[68:71]
    ds_read_b64_tr_b16 v[194:195], v6 offset:38400
    v_mfma_f32_16x16x32_bf16 v[64:67], v[148:151], v[128:131], v[64:67]
    ds_read_b64_tr_b16 v[196:197], v7 offset:37888
    v_mfma_f32_16x16x32_bf16 v[112:115], v[148:151], v[136:139], v[112:115]
    ds_read_b64_tr_b16 v[198:199], v7 offset:38400
    v_mfma_f32_16x16x32_bf16 v[72:75], v[148:151], v[132:135], v[72:75]
    ds_read_b64_tr_b16 v[200:201], v6 offset:38912
    v_mfma_f32_16x16x32_bf16 v[76:79], v[152:155], v[132:135], v[76:79]
    ds_read_b64_tr_b16 v[202:203], v6 offset:39424
    v_mfma_f32_16x16x32_bf16 v[44:47], v[144:147], v[132:135], v[44:47]
    ds_read_b64_tr_b16 v[204:205], v7 offset:38912
    v_mfma_f32_16x16x32_bf16 v[40:43], v[140:143], v[132:135], v[40:43]
    ds_read_b64_tr_b16 v[206:207], v7 offset:39424
    v_mfma_f32_16x16x32_bf16 v[104:107], v[132:135], v[156:159], v[104:107]
    v_mfma_f32_16x16x32_bf16 v[108:111], v[132:135], v[160:163], v[108:111]
    v_mfma_f32_16x16x32_bf16 v[100:103], v[128:131], v[160:163], v[100:103]
    v_mfma_f32_16x16x32_bf16 v[96:99], v[128:131], v[156:159], v[96:99]
    v_mfma_f32_16x16x32_bf16 v[88:91], v[124:127], v[156:159], v[88:91]
    v_mfma_f32_16x16x32_bf16 v[92:95], v[124:127], v[160:163], v[92:95]
    v_mfma_f32_16x16x32_bf16 v[84:87], v[120:123], v[160:163], v[84:87]
    v_mfma_f32_16x16x32_bf16 v[80:83], v[120:123], v[156:159], v[80:83]
    v_mfma_f32_16x16x32_bf16 v[116:119], v[136:139], v[156:159], v[116:119]
    s_waitcnt lgkmcnt(0)
    s_barrier
    v_mfma_f32_16x16x32_bf16 v[16:19], v[184:187], v[164:167], v[16:19]
    ds_read_b128 v[120:123], v4 offset:36864
    v_mfma_f32_16x16x32_bf16 v[20:23], v[188:191], v[164:167], v[20:23]
    ds_read_b128 v[124:127], v4 offset:38912
    v_mfma_f32_16x16x32_bf16 v[52:55], v[196:199], v[164:167], v[52:55]
    ds_read_b128 v[128:131], v4 offset:40960
    v_mfma_f32_16x16x32_bf16 v[48:51], v[192:195], v[164:167], v[48:51]
    ds_read_b128 v[132:135], v4 offset:43008
    v_mfma_f32_16x16x32_bf16 v[56:59], v[192:195], v[168:171], v[56:59]
    ds_read_b128 v[136:139], v2 offset:36864
    v_mfma_f32_16x16x32_bf16 v[60:63], v[196:199], v[168:171], v[60:63]
    ds_read_b64_tr_b16 v[140:141], v6 offset:49152
    v_mfma_f32_16x16x32_bf16 v[28:31], v[188:191], v[168:171], v[28:31]
    ds_read_b64_tr_b16 v[142:143], v6 offset:49664
    v_mfma_f32_16x16x32_bf16 v[24:27], v[184:187], v[168:171], v[24:27]
    ds_read_b64_tr_b16 v[144:145], v7 offset:49152
    v_mfma_f32_16x16x32_bf16 v[32:35], v[184:187], v[172:175], v[32:35]
    ds_read_b64_tr_b16 v[146:147], v7 offset:49664
    v_mfma_f32_16x16x32_bf16 v[36:39], v[188:191], v[172:175], v[36:39]
    ds_read_b64_tr_b16 v[148:149], v6 offset:50176
    v_mfma_f32_16x16x32_bf16 v[68:71], v[196:199], v[172:175], v[68:71]
    ds_read_b64_tr_b16 v[150:151], v6 offset:50688
    v_mfma_f32_16x16x32_bf16 v[64:67], v[192:195], v[172:175], v[64:67]
    ds_read_b64_tr_b16 v[152:153], v7 offset:50176
    v_mfma_f32_16x16x32_bf16 v[112:115], v[192:195], v[180:183], v[112:115]
    ds_read_b64_tr_b16 v[154:155], v7 offset:50688
    v_mfma_f32_16x16x32_bf16 v[72:75], v[192:195], v[176:179], v[72:75]
    ds_read_b64_tr_b16 v[156:157], v6 offset:51200
    v_mfma_f32_16x16x32_bf16 v[76:79], v[196:199], v[176:179], v[76:79]
    ds_read_b64_tr_b16 v[158:159], v6 offset:51712
    v_mfma_f32_16x16x32_bf16 v[44:47], v[188:191], v[176:179], v[44:47]
    ds_read_b64_tr_b16 v[160:161], v7 offset:51200
    v_mfma_f32_16x16x32_bf16 v[40:43], v[184:187], v[176:179], v[40:43]
    ds_read_b64_tr_b16 v[162:163], v7 offset:51712
    v_mfma_f32_16x16x32_bf16 v[104:107], v[176:179], v[200:203], v[104:107]
    v_mfma_f32_16x16x32_bf16 v[108:111], v[176:179], v[204:207], v[108:111]
    v_mfma_f32_16x16x32_bf16 v[100:103], v[172:175], v[204:207], v[100:103]
    v_mfma_f32_16x16x32_bf16 v[96:99], v[172:175], v[200:203], v[96:99]
    v_mfma_f32_16x16x32_bf16 v[88:91], v[168:171], v[200:203], v[88:91]
    v_mfma_f32_16x16x32_bf16 v[92:95], v[168:171], v[204:207], v[92:95]
    v_mfma_f32_16x16x32_bf16 v[84:87], v[164:167], v[204:207], v[84:87]
    v_mfma_f32_16x16x32_bf16 v[80:83], v[164:167], v[200:203], v[80:83]
    v_mfma_f32_16x16x32_bf16 v[116:119], v[180:183], v[200:203], v[116:119]
    s_waitcnt lgkmcnt(0)
    v_mfma_f32_16x16x32_bf16 v[16:19], v[140:143], v[120:123], v[16:19]
    ds_read_b128 v[164:167], v5 offset:36864
    v_mfma_f32_16x16x32_bf16 v[20:23], v[144:147], v[120:123], v[20:23]
    ds_read_b128 v[168:171], v5 offset:38912
    v_mfma_f32_16x16x32_bf16 v[52:55], v[152:155], v[120:123], v[52:55]
    ds_read_b128 v[172:175], v5 offset:40960
    v_mfma_f32_16x16x32_bf16 v[48:51], v[148:151], v[120:123], v[48:51]
    ds_read_b128 v[176:179], v5 offset:43008
    v_mfma_f32_16x16x32_bf16 v[56:59], v[148:151], v[124:127], v[56:59]
    ds_read_b128 v[180:183], v3 offset:36864
    v_mfma_f32_16x16x32_bf16 v[60:63], v[152:155], v[124:127], v[60:63]
    ds_read_b64_tr_b16 v[184:185], v6 offset:61440
    v_mfma_f32_16x16x32_bf16 v[28:31], v[144:147], v[124:127], v[28:31]
    ds_read_b64_tr_b16 v[186:187], v6 offset:61952
    v_mfma_f32_16x16x32_bf16 v[24:27], v[140:143], v[124:127], v[24:27]
    ds_read_b64_tr_b16 v[188:189], v7 offset:61440
    v_mfma_f32_16x16x32_bf16 v[32:35], v[140:143], v[128:131], v[32:35]
    ds_read_b64_tr_b16 v[190:191], v7 offset:61952
    v_mfma_f32_16x16x32_bf16 v[36:39], v[144:147], v[128:131], v[36:39]
    ds_read_b64_tr_b16 v[192:193], v6 offset:62464
    v_mfma_f32_16x16x32_bf16 v[68:71], v[152:155], v[128:131], v[68:71]
    ds_read_b64_tr_b16 v[194:195], v6 offset:62976
    v_mfma_f32_16x16x32_bf16 v[64:67], v[148:151], v[128:131], v[64:67]
    ds_read_b64_tr_b16 v[196:197], v7 offset:62464
    v_mfma_f32_16x16x32_bf16 v[112:115], v[148:151], v[136:139], v[112:115]
    ds_read_b64_tr_b16 v[198:199], v7 offset:62976
    v_mfma_f32_16x16x32_bf16 v[72:75], v[148:151], v[132:135], v[72:75]
    ds_read_b64_tr_b16 v[200:201], v6 offset:63488
    v_mfma_f32_16x16x32_bf16 v[76:79], v[152:155], v[132:135], v[76:79]
    ds_read_b64_tr_b16 v[202:203], v6 offset:64000
    v_mfma_f32_16x16x32_bf16 v[44:47], v[144:147], v[132:135], v[44:47]
    ds_read_b64_tr_b16 v[204:205], v7 offset:63488
    v_mfma_f32_16x16x32_bf16 v[40:43], v[140:143], v[132:135], v[40:43]
    ds_read_b64_tr_b16 v[206:207], v7 offset:64000
    v_mfma_f32_16x16x32_bf16 v[104:107], v[132:135], v[156:159], v[104:107]
    v_mfma_f32_16x16x32_bf16 v[108:111], v[132:135], v[160:163], v[108:111]
    v_mfma_f32_16x16x32_bf16 v[100:103], v[128:131], v[160:163], v[100:103]
    v_mfma_f32_16x16x32_bf16 v[96:99], v[128:131], v[156:159], v[96:99]
    v_mfma_f32_16x16x32_bf16 v[88:91], v[124:127], v[156:159], v[88:91]
    v_mfma_f32_16x16x32_bf16 v[92:95], v[124:127], v[160:163], v[92:95]
    v_mfma_f32_16x16x32_bf16 v[84:87], v[120:123], v[160:163], v[84:87]
    v_mfma_f32_16x16x32_bf16 v[80:83], v[120:123], v[156:159], v[80:83]
    v_mfma_f32_16x16x32_bf16 v[116:119], v[136:139], v[156:159], v[116:119]
    s_waitcnt lgkmcnt(0)
    s_barrier
    v_mfma_f32_16x16x32_bf16 v[16:19], v[184:187], v[164:167], v[16:19]
    ds_read_b128 v[120:123], v4 offset:0
    v_mfma_f32_16x16x32_bf16 v[20:23], v[188:191], v[164:167], v[20:23]
    ds_read_b128 v[124:127], v4 offset:2048
    v_mfma_f32_16x16x32_bf16 v[52:55], v[196:199], v[164:167], v[52:55]
    ds_read_b128 v[128:131], v4 offset:4096
    v_mfma_f32_16x16x32_bf16 v[48:51], v[192:195], v[164:167], v[48:51]
    ds_read_b128 v[132:135], v4 offset:6144
    v_mfma_f32_16x16x32_bf16 v[56:59], v[192:195], v[168:171], v[56:59]
    ds_read_b128 v[136:139], v2 offset:0
    v_mfma_f32_16x16x32_bf16 v[60:63], v[196:199], v[168:171], v[60:63]
    ds_read_b64_tr_b16 v[140:141], v6 offset:0
    v_mfma_f32_16x16x32_bf16 v[28:31], v[188:191], v[168:171], v[28:31]
    ds_read_b64_tr_b16 v[142:143], v6 offset:512
    v_mfma_f32_16x16x32_bf16 v[24:27], v[184:187], v[168:171], v[24:27]
    ds_read_b64_tr_b16 v[144:145], v7 offset:0
    v_mfma_f32_16x16x32_bf16 v[32:35], v[184:187], v[172:175], v[32:35]
    ds_read_b64_tr_b16 v[146:147], v7 offset:512
    v_mfma_f32_16x16x32_bf16 v[36:39], v[188:191], v[172:175], v[36:39]
    ds_read_b64_tr_b16 v[148:149], v6 offset:1024
    v_mfma_f32_16x16x32_bf16 v[68:71], v[196:199], v[172:175], v[68:71]
    ds_read_b64_tr_b16 v[150:151], v6 offset:1536
    v_mfma_f32_16x16x32_bf16 v[64:67], v[192:195], v[172:175], v[64:67]
    ds_read_b64_tr_b16 v[152:153], v7 offset:1024
    v_mfma_f32_16x16x32_bf16 v[112:115], v[192:195], v[180:183], v[112:115]
    ds_read_b64_tr_b16 v[154:155], v7 offset:1536
    v_mfma_f32_16x16x32_bf16 v[72:75], v[192:195], v[176:179], v[72:75]
    ds_read_b64_tr_b16 v[156:157], v6 offset:2048
    v_mfma_f32_16x16x32_bf16 v[76:79], v[196:199], v[176:179], v[76:79]
    ds_read_b64_tr_b16 v[158:159], v6 offset:2560
    v_mfma_f32_16x16x32_bf16 v[44:47], v[188:191], v[176:179], v[44:47]
    ds_read_b64_tr_b16 v[160:161], v7 offset:2048
    v_mfma_f32_16x16x32_bf16 v[40:43], v[184:187], v[176:179], v[40:43]
    ds_read_b64_tr_b16 v[162:163], v7 offset:2560
    v_mfma_f32_16x16x32_bf16 v[104:107], v[176:179], v[200:203], v[104:107]
    v_mfma_f32_16x16x32_bf16 v[108:111], v[176:179], v[204:207], v[108:111]
    v_mfma_f32_16x16x32_bf16 v[100:103], v[172:175], v[204:207], v[100:103]
    v_mfma_f32_16x16x32_bf16 v[96:99], v[172:175], v[200:203], v[96:99]
    v_mfma_f32_16x16x32_bf16 v[88:91], v[168:171], v[200:203], v[88:91]
    v_mfma_f32_16x16x32_bf16 v[92:95], v[168:171], v[204:207], v[92:95]
    v_mfma_f32_16x16x32_bf16 v[84:87], v[164:167], v[204:207], v[84:87]
    v_mfma_f32_16x16x32_bf16 v[80:83], v[164:167], v[200:203], v[80:83]
    v_mfma_f32_16x16x32_bf16 v[116:119], v[180:183], v[200:203], v[116:119]
    s_waitcnt lgkmcnt(0)
    v_mfma_f32_16x16x32_bf16 v[16:19], v[140:143], v[120:123], v[16:19]
    ds_read_b128 v[164:167], v5 offset:0
    v_mfma_f32_16x16x32_bf16 v[20:23], v[144:147], v[120:123], v[20:23]
    ds_read_b128 v[168:171], v5 offset:2048
    v_mfma_f32_16x16x32_bf16 v[52:55], v[152:155], v[120:123], v[52:55]
    ds_read_b128 v[172:175], v5 offset:4096
    v_mfma_f32_16x16x32_bf16 v[48:51], v[148:151], v[120:123], v[48:51]
    ds_read_b128 v[176:179], v5 offset:6144
    v_mfma_f32_16x16x32_bf16 v[56:59], v[148:151], v[124:127], v[56:59]
    ds_read_b128 v[180:183], v3 offset:0
    v_mfma_f32_16x16x32_bf16 v[60:63], v[152:155], v[124:127], v[60:63]
    ds_read_b64_tr_b16 v[184:185], v6 offset:12288
    v_mfma_f32_16x16x32_bf16 v[28:31], v[144:147], v[124:127], v[28:31]
    ds_read_b64_tr_b16 v[186:187], v6 offset:12800
    v_mfma_f32_16x16x32_bf16 v[24:27], v[140:143], v[124:127], v[24:27]
    ds_read_b64_tr_b16 v[188:189], v7 offset:12288
    v_mfma_f32_16x16x32_bf16 v[32:35], v[140:143], v[128:131], v[32:35]
    ds_read_b64_tr_b16 v[190:191], v7 offset:12800
    v_mfma_f32_16x16x32_bf16 v[36:39], v[144:147], v[128:131], v[36:39]
    ds_read_b64_tr_b16 v[192:193], v6 offset:13312
    v_mfma_f32_16x16x32_bf16 v[68:71], v[152:155], v[128:131], v[68:71]
    ds_read_b64_tr_b16 v[194:195], v6 offset:13824
    v_mfma_f32_16x16x32_bf16 v[64:67], v[148:151], v[128:131], v[64:67]
    ds_read_b64_tr_b16 v[196:197], v7 offset:13312
    v_mfma_f32_16x16x32_bf16 v[112:115], v[148:151], v[136:139], v[112:115]
    ds_read_b64_tr_b16 v[198:199], v7 offset:13824
    v_mfma_f32_16x16x32_bf16 v[72:75], v[148:151], v[132:135], v[72:75]
    ds_read_b64_tr_b16 v[200:201], v6 offset:14336
    v_mfma_f32_16x16x32_bf16 v[76:79], v[152:155], v[132:135], v[76:79]
    ds_read_b64_tr_b16 v[202:203], v6 offset:14848
    v_mfma_f32_16x16x32_bf16 v[44:47], v[144:147], v[132:135], v[44:47]
    ds_read_b64_tr_b16 v[204:205], v7 offset:14336
    v_mfma_f32_16x16x32_bf16 v[40:43], v[140:143], v[132:135], v[40:43]
    ds_read_b64_tr_b16 v[206:207], v7 offset:14848
    v_mfma_f32_16x16x32_bf16 v[104:107], v[132:135], v[156:159], v[104:107]
    v_mfma_f32_16x16x32_bf16 v[108:111], v[132:135], v[160:163], v[108:111]
    v_mfma_f32_16x16x32_bf16 v[100:103], v[128:131], v[160:163], v[100:103]
    v_mfma_f32_16x16x32_bf16 v[96:99], v[128:131], v[156:159], v[96:99]
    v_mfma_f32_16x16x32_bf16 v[88:91], v[124:127], v[156:159], v[88:91]
    v_mfma_f32_16x16x32_bf16 v[92:95], v[124:127], v[160:163], v[92:95]
    v_mfma_f32_16x16x32_bf16 v[84:87], v[120:123], v[160:163], v[84:87]
    v_mfma_f32_16x16x32_bf16 v[80:83], v[120:123], v[156:159], v[80:83]
    v_mfma_f32_16x16x32_bf16 v[116:119], v[136:139], v[156:159], v[116:119]
    s_waitcnt lgkmcnt(0)
    s_barrier
    v_mfma_f32_16x16x32_bf16 v[16:19], v[184:187], v[164:167], v[16:19]
    ds_read_b128 v[120:123], v4 offset:18432
    v_mfma_f32_16x16x32_bf16 v[20:23], v[188:191], v[164:167], v[20:23]
    ds_read_b128 v[124:127], v4 offset:20480
    v_mfma_f32_16x16x32_bf16 v[52:55], v[196:199], v[164:167], v[52:55]
    ds_read_b128 v[128:131], v4 offset:22528
    v_mfma_f32_16x16x32_bf16 v[48:51], v[192:195], v[164:167], v[48:51]
    ds_read_b128 v[132:135], v4 offset:24576
    v_mfma_f32_16x16x32_bf16 v[56:59], v[192:195], v[168:171], v[56:59]
    ds_read_b128 v[136:139], v2 offset:18432
    v_mfma_f32_16x16x32_bf16 v[60:63], v[196:199], v[168:171], v[60:63]
    ds_read_b64_tr_b16 v[140:141], v6 offset:24576
    v_mfma_f32_16x16x32_bf16 v[28:31], v[188:191], v[168:171], v[28:31]
    ds_read_b64_tr_b16 v[142:143], v6 offset:25088
    v_mfma_f32_16x16x32_bf16 v[24:27], v[184:187], v[168:171], v[24:27]
    ds_read_b64_tr_b16 v[144:145], v7 offset:24576
    v_mfma_f32_16x16x32_bf16 v[32:35], v[184:187], v[172:175], v[32:35]
    ds_read_b64_tr_b16 v[146:147], v7 offset:25088
    v_mfma_f32_16x16x32_bf16 v[36:39], v[188:191], v[172:175], v[36:39]
    ds_read_b64_tr_b16 v[148:149], v6 offset:25600
    v_mfma_f32_16x16x32_bf16 v[68:71], v[196:199], v[172:175], v[68:71]
    ds_read_b64_tr_b16 v[150:151], v6 offset:26112
    v_mfma_f32_16x16x32_bf16 v[64:67], v[192:195], v[172:175], v[64:67]
    ds_read_b64_tr_b16 v[152:153], v7 offset:25600
    v_mfma_f32_16x16x32_bf16 v[112:115], v[192:195], v[180:183], v[112:115]
    ds_read_b64_tr_b16 v[154:155], v7 offset:26112
    v_mfma_f32_16x16x32_bf16 v[72:75], v[192:195], v[176:179], v[72:75]
    ds_read_b64_tr_b16 v[156:157], v6 offset:26624
    v_mfma_f32_16x16x32_bf16 v[76:79], v[196:199], v[176:179], v[76:79]
    ds_read_b64_tr_b16 v[158:159], v6 offset:27136
    v_mfma_f32_16x16x32_bf16 v[44:47], v[188:191], v[176:179], v[44:47]
    ds_read_b64_tr_b16 v[160:161], v7 offset:26624
    v_mfma_f32_16x16x32_bf16 v[40:43], v[184:187], v[176:179], v[40:43]
    ds_read_b64_tr_b16 v[162:163], v7 offset:27136
    v_mfma_f32_16x16x32_bf16 v[104:107], v[176:179], v[200:203], v[104:107]
    v_mfma_f32_16x16x32_bf16 v[108:111], v[176:179], v[204:207], v[108:111]
    v_mfma_f32_16x16x32_bf16 v[100:103], v[172:175], v[204:207], v[100:103]
    v_mfma_f32_16x16x32_bf16 v[96:99], v[172:175], v[200:203], v[96:99]
    v_mfma_f32_16x16x32_bf16 v[88:91], v[168:171], v[200:203], v[88:91]
    v_mfma_f32_16x16x32_bf16 v[92:95], v[168:171], v[204:207], v[92:95]
    v_mfma_f32_16x16x32_bf16 v[84:87], v[164:167], v[204:207], v[84:87]
    v_mfma_f32_16x16x32_bf16 v[80:83], v[164:167], v[200:203], v[80:83]
    v_mfma_f32_16x16x32_bf16 v[116:119], v[180:183], v[200:203], v[116:119]
    s_waitcnt lgkmcnt(0)
    v_mfma_f32_16x16x32_bf16 v[16:19], v[140:143], v[120:123], v[16:19]
    ds_read_b128 v[164:167], v5 offset:18432
    v_mfma_f32_16x16x32_bf16 v[20:23], v[144:147], v[120:123], v[20:23]
    ds_read_b128 v[168:171], v5 offset:20480
    v_mfma_f32_16x16x32_bf16 v[52:55], v[152:155], v[120:123], v[52:55]
    ds_read_b128 v[172:175], v5 offset:22528
    v_mfma_f32_16x16x32_bf16 v[48:51], v[148:151], v[120:123], v[48:51]
    ds_read_b128 v[176:179], v5 offset:24576
    v_mfma_f32_16x16x32_bf16 v[56:59], v[148:151], v[124:127], v[56:59]
    ds_read_b128 v[180:183], v3 offset:18432
    v_mfma_f32_16x16x32_bf16 v[60:63], v[152:155], v[124:127], v[60:63]
    ds_read_b64_tr_b16 v[184:185], v6 offset:36864
    v_mfma_f32_16x16x32_bf16 v[28:31], v[144:147], v[124:127], v[28:31]
    ds_read_b64_tr_b16 v[186:187], v6 offset:37376
    v_mfma_f32_16x16x32_bf16 v[24:27], v[140:143], v[124:127], v[24:27]
    ds_read_b64_tr_b16 v[188:189], v7 offset:36864
    v_mfma_f32_16x16x32_bf16 v[32:35], v[140:143], v[128:131], v[32:35]
    ds_read_b64_tr_b16 v[190:191], v7 offset:37376
    v_mfma_f32_16x16x32_bf16 v[36:39], v[144:147], v[128:131], v[36:39]
    ds_read_b64_tr_b16 v[192:193], v6 offset:37888
    v_mfma_f32_16x16x32_bf16 v[68:71], v[152:155], v[128:131], v[68:71]
    ds_read_b64_tr_b16 v[194:195], v6 offset:38400
    v_mfma_f32_16x16x32_bf16 v[64:67], v[148:151], v[128:131], v[64:67]
    ds_read_b64_tr_b16 v[196:197], v7 offset:37888
    v_mfma_f32_16x16x32_bf16 v[112:115], v[148:151], v[136:139], v[112:115]
    ds_read_b64_tr_b16 v[198:199], v7 offset:38400
    v_mfma_f32_16x16x32_bf16 v[72:75], v[148:151], v[132:135], v[72:75]
    ds_read_b64_tr_b16 v[200:201], v6 offset:38912
    v_mfma_f32_16x16x32_bf16 v[76:79], v[152:155], v[132:135], v[76:79]
    ds_read_b64_tr_b16 v[202:203], v6 offset:39424
    v_mfma_f32_16x16x32_bf16 v[44:47], v[144:147], v[132:135], v[44:47]
    ds_read_b64_tr_b16 v[204:205], v7 offset:38912
    v_mfma_f32_16x16x32_bf16 v[40:43], v[140:143], v[132:135], v[40:43]
    ds_read_b64_tr_b16 v[206:207], v7 offset:39424
    v_mfma_f32_16x16x32_bf16 v[104:107], v[132:135], v[156:159], v[104:107]
    v_mfma_f32_16x16x32_bf16 v[108:111], v[132:135], v[160:163], v[108:111]
    v_mfma_f32_16x16x32_bf16 v[100:103], v[128:131], v[160:163], v[100:103]
    v_mfma_f32_16x16x32_bf16 v[96:99], v[128:131], v[156:159], v[96:99]
    v_mfma_f32_16x16x32_bf16 v[88:91], v[124:127], v[156:159], v[88:91]
    v_mfma_f32_16x16x32_bf16 v[92:95], v[124:127], v[160:163], v[92:95]
    v_mfma_f32_16x16x32_bf16 v[84:87], v[120:123], v[160:163], v[84:87]
    v_mfma_f32_16x16x32_bf16 v[80:83], v[120:123], v[156:159], v[80:83]
    v_mfma_f32_16x16x32_bf16 v[116:119], v[136:139], v[156:159], v[116:119]
    s_waitcnt lgkmcnt(0)
    s_barrier
    v_mfma_f32_16x16x32_bf16 v[16:19], v[184:187], v[164:167], v[16:19]
    ds_read_b128 v[120:123], v4 offset:36864
    v_mfma_f32_16x16x32_bf16 v[20:23], v[188:191], v[164:167], v[20:23]
    ds_read_b128 v[124:127], v4 offset:38912
    v_mfma_f32_16x16x32_bf16 v[52:55], v[196:199], v[164:167], v[52:55]
    ds_read_b128 v[128:131], v4 offset:40960
    v_mfma_f32_16x16x32_bf16 v[48:51], v[192:195], v[164:167], v[48:51]
    ds_read_b128 v[132:135], v4 offset:43008
    v_mfma_f32_16x16x32_bf16 v[56:59], v[192:195], v[168:171], v[56:59]
    ds_read_b128 v[136:139], v2 offset:36864
    v_mfma_f32_16x16x32_bf16 v[60:63], v[196:199], v[168:171], v[60:63]
    ds_read_b64_tr_b16 v[140:141], v6 offset:49152
    v_mfma_f32_16x16x32_bf16 v[28:31], v[188:191], v[168:171], v[28:31]
    ds_read_b64_tr_b16 v[142:143], v6 offset:49664
    v_mfma_f32_16x16x32_bf16 v[24:27], v[184:187], v[168:171], v[24:27]
    ds_read_b64_tr_b16 v[144:145], v7 offset:49152
    v_mfma_f32_16x16x32_bf16 v[32:35], v[184:187], v[172:175], v[32:35]
    ds_read_b64_tr_b16 v[146:147], v7 offset:49664
    v_mfma_f32_16x16x32_bf16 v[36:39], v[188:191], v[172:175], v[36:39]
    ds_read_b64_tr_b16 v[148:149], v6 offset:50176
    v_mfma_f32_16x16x32_bf16 v[68:71], v[196:199], v[172:175], v[68:71]
    ds_read_b64_tr_b16 v[150:151], v6 offset:50688
    v_mfma_f32_16x16x32_bf16 v[64:67], v[192:195], v[172:175], v[64:67]
    ds_read_b64_tr_b16 v[152:153], v7 offset:50176
    v_mfma_f32_16x16x32_bf16 v[112:115], v[192:195], v[180:183], v[112:115]
    ds_read_b64_tr_b16 v[154:155], v7 offset:50688
    v_mfma_f32_16x16x32_bf16 v[72:75], v[192:195], v[176:179], v[72:75]
    ds_read_b64_tr_b16 v[156:157], v6 offset:51200
    v_mfma_f32_16x16x32_bf16 v[76:79], v[196:199], v[176:179], v[76:79]
    ds_read_b64_tr_b16 v[158:159], v6 offset:51712
    v_mfma_f32_16x16x32_bf16 v[44:47], v[188:191], v[176:179], v[44:47]
    ds_read_b64_tr_b16 v[160:161], v7 offset:51200
    v_mfma_f32_16x16x32_bf16 v[40:43], v[184:187], v[176:179], v[40:43]
    ds_read_b64_tr_b16 v[162:163], v7 offset:51712
    v_mfma_f32_16x16x32_bf16 v[104:107], v[176:179], v[200:203], v[104:107]
    v_mfma_f32_16x16x32_bf16 v[108:111], v[176:179], v[204:207], v[108:111]
    v_mfma_f32_16x16x32_bf16 v[100:103], v[172:175], v[204:207], v[100:103]
    v_mfma_f32_16x16x32_bf16 v[96:99], v[172:175], v[200:203], v[96:99]
    v_mfma_f32_16x16x32_bf16 v[88:91], v[168:171], v[200:203], v[88:91]
    v_mfma_f32_16x16x32_bf16 v[92:95], v[168:171], v[204:207], v[92:95]
    v_mfma_f32_16x16x32_bf16 v[84:87], v[164:167], v[204:207], v[84:87]
    v_mfma_f32_16x16x32_bf16 v[80:83], v[164:167], v[200:203], v[80:83]
    v_mfma_f32_16x16x32_bf16 v[116:119], v[180:183], v[200:203], v[116:119]
    s_waitcnt lgkmcnt(0)
    v_mfma_f32_16x16x32_bf16 v[16:19], v[140:143], v[120:123], v[16:19]
    ds_read_b128 v[164:167], v5 offset:36864
    v_mfma_f32_16x16x32_bf16 v[20:23], v[144:147], v[120:123], v[20:23]
    ds_read_b128 v[168:171], v5 offset:38912
    v_mfma_f32_16x16x32_bf16 v[52:55], v[152:155], v[120:123], v[52:55]
    ds_read_b128 v[172:175], v5 offset:40960
    v_mfma_f32_16x16x32_bf16 v[48:51], v[148:151], v[120:123], v[48:51]
    ds_read_b128 v[176:179], v5 offset:43008
    v_mfma_f32_16x16x32_bf16 v[56:59], v[148:151], v[124:127], v[56:59]
    ds_read_b128 v[180:183], v3 offset:36864
    v_mfma_f32_16x16x32_bf16 v[60:63], v[152:155], v[124:127], v[60:63]
    ds_read_b64_tr_b16 v[184:185], v6 offset:61440
    v_mfma_f32_16x16x32_bf16 v[28:31], v[144:147], v[124:127], v[28:31]
    ds_read_b64_tr_b16 v[186:187], v6 offset:61952
    v_mfma_f32_16x16x32_bf16 v[24:27], v[140:143], v[124:127], v[24:27]
    ds_read_b64_tr_b16 v[188:189], v7 offset:61440
    v_mfma_f32_16x16x32_bf16 v[32:35], v[140:143], v[128:131], v[32:35]
    ds_read_b64_tr_b16 v[190:191], v7 offset:61952
    v_mfma_f32_16x16x32_bf16 v[36:39], v[144:147], v[128:131], v[36:39]
    ds_read_b64_tr_b16 v[192:193], v6 offset:62464
    v_mfma_f32_16x16x32_bf16 v[68:71], v[152:155], v[128:131], v[68:71]
    ds_read_b64_tr_b16 v[194:195], v6 offset:62976
    v_mfma_f32_16x16x32_bf16 v[64:67], v[148:151], v[128:131], v[64:67]
    ds_read_b64_tr_b16 v[196:197], v7 offset:62464
    v_mfma_f32_16x16x32_bf16 v[112:115], v[148:151], v[136:139], v[112:115]
    ds_read_b64_tr_b16 v[198:199], v7 offset:62976
    v_mfma_f32_16x16x32_bf16 v[72:75], v[148:151], v[132:135], v[72:75]
    ds_read_b64_tr_b16 v[200:201], v6 offset:63488
    v_mfma_f32_16x16x32_bf16 v[76:79], v[152:155], v[132:135], v[76:79]
    ds_read_b64_tr_b16 v[202:203], v6 offset:64000
    v_mfma_f32_16x16x32_bf16 v[44:47], v[144:147], v[132:135], v[44:47]
    ds_read_b64_tr_b16 v[204:205], v7 offset:63488
    v_mfma_f32_16x16x32_bf16 v[40:43], v[140:143], v[132:135], v[40:43]
    ds_read_b64_tr_b16 v[206:207], v7 offset:64000
    v_mfma_f32_16x16x32_bf16 v[104:107], v[132:135], v[156:159], v[104:107]
    buffer_load_dword v222, v220, s[68:71], s98 offen sc1
    v_mfma_f32_16x16x32_bf16 v[108:111], v[132:135], v[160:163], v[108:111]
    v_mfma_f32_16x16x32_bf16 v[100:103], v[128:131], v[160:163], v[100:103]
    v_mfma_f32_16x16x32_bf16 v[96:99], v[128:131], v[156:159], v[96:99]
    v_mfma_f32_16x16x32_bf16 v[88:91], v[124:127], v[156:159], v[88:91]
    v_mfma_f32_16x16x32_bf16 v[92:95], v[124:127], v[160:163], v[92:95]
    v_mfma_f32_16x16x32_bf16 v[84:87], v[120:123], v[160:163], v[84:87]
    v_mfma_f32_16x16x32_bf16 v[80:83], v[120:123], v[156:159], v[80:83]
    v_mfma_f32_16x16x32_bf16 v[116:119], v[136:139], v[156:159], v[116:119]
    s_waitcnt lgkmcnt(0)
    s_barrier
    v_mfma_f32_16x16x32_bf16 v[16:19], v[184:187], v[164:167], v[16:19]
    ds_read_b128 v[120:123], v4 offset:0
    v_mfma_f32_16x16x32_bf16 v[20:23], v[188:191], v[164:167], v[20:23]
    ds_read_b128 v[124:127], v4 offset:2048
    v_mfma_f32_16x16x32_bf16 v[52:55], v[196:199], v[164:167], v[52:55]
    ds_read_b128 v[128:131], v4 offset:4096
    v_mfma_f32_16x16x32_bf16 v[48:51], v[192:195], v[164:167], v[48:51]
    ds_read_b128 v[132:135], v4 offset:6144
    v_mfma_f32_16x16x32_bf16 v[56:59], v[192:195], v[168:171], v[56:59]
    ds_read_b128 v[136:139], v2 offset:0
    v_mfma_f32_16x16x32_bf16 v[60:63], v[196:199], v[168:171], v[60:63]
    ds_read_b64_tr_b16 v[140:141], v6 offset:0
    v_mfma_f32_16x16x32_bf16 v[28:31], v[188:191], v[168:171], v[28:31]
    ds_read_b64_tr_b16 v[142:143], v6 offset:512
    v_mfma_f32_16x16x32_bf16 v[24:27], v[184:187], v[168:171], v[24:27]
    ds_read_b64_tr_b16 v[144:145], v7 offset:0
    v_mfma_f32_16x16x32_bf16 v[32:35], v[184:187], v[172:175], v[32:35]
    ds_read_b64_tr_b16 v[146:147], v7 offset:512
    v_mfma_f32_16x16x32_bf16 v[36:39], v[188:191], v[172:175], v[36:39]
    ds_read_b64_tr_b16 v[148:149], v6 offset:1024
    v_mfma_f32_16x16x32_bf16 v[68:71], v[196:199], v[172:175], v[68:71]
    ds_read_b64_tr_b16 v[150:151], v6 offset:1536
    v_mfma_f32_16x16x32_bf16 v[64:67], v[192:195], v[172:175], v[64:67]
    ds_read_b64_tr_b16 v[152:153], v7 offset:1024
    v_mfma_f32_16x16x32_bf16 v[112:115], v[192:195], v[180:183], v[112:115]
    ds_read_b64_tr_b16 v[154:155], v7 offset:1536
    v_mfma_f32_16x16x32_bf16 v[72:75], v[192:195], v[176:179], v[72:75]
    ds_read_b64_tr_b16 v[156:157], v6 offset:2048
    v_mfma_f32_16x16x32_bf16 v[76:79], v[196:199], v[176:179], v[76:79]
    ds_read_b64_tr_b16 v[158:159], v6 offset:2560
    v_mfma_f32_16x16x32_bf16 v[44:47], v[188:191], v[176:179], v[44:47]
    ds_read_b64_tr_b16 v[160:161], v7 offset:2048
    v_mfma_f32_16x16x32_bf16 v[40:43], v[184:187], v[176:179], v[40:43]
    ds_read_b64_tr_b16 v[162:163], v7 offset:2560
    v_mfma_f32_16x16x32_bf16 v[104:107], v[176:179], v[200:203], v[104:107]
    v_mfma_f32_16x16x32_bf16 v[108:111], v[176:179], v[204:207], v[108:111]
    v_mfma_f32_16x16x32_bf16 v[100:103], v[172:175], v[204:207], v[100:103]
    v_mfma_f32_16x16x32_bf16 v[96:99], v[172:175], v[200:203], v[96:99]
    v_mfma_f32_16x16x32_bf16 v[88:91], v[168:171], v[200:203], v[88:91]
    v_mfma_f32_16x16x32_bf16 v[92:95], v[168:171], v[204:207], v[92:95]
    v_mfma_f32_16x16x32_bf16 v[84:87], v[164:167], v[204:207], v[84:87]
    v_mfma_f32_16x16x32_bf16 v[80:83], v[164:167], v[200:203], v[80:83]
    v_mfma_f32_16x16x32_bf16 v[116:119], v[180:183], v[200:203], v[116:119]
    s_waitcnt lgkmcnt(0)
    v_mfma_f32_16x16x32_bf16 v[16:19], v[140:143], v[120:123], v[16:19]
    ds_read_b128 v[164:167], v5 offset:0
    v_mfma_f32_16x16x32_bf16 v[20:23], v[144:147], v[120:123], v[20:23]
    ds_read_b128 v[168:171], v5 offset:2048
    v_mfma_f32_16x16x32_bf16 v[52:55], v[152:155], v[120:123], v[52:55]
    ds_read_b128 v[172:175], v5 offset:4096
    v_mfma_f32_16x16x32_bf16 v[48:51], v[148:151], v[120:123], v[48:51]
    ds_read_b128 v[176:179], v5 offset:6144
    v_mfma_f32_16x16x32_bf16 v[56:59], v[148:151], v[124:127], v[56:59]
    ds_read_b128 v[180:183], v3 offset:0
    v_mfma_f32_16x16x32_bf16 v[60:63], v[152:155], v[124:127], v[60:63]
    ds_read_b64_tr_b16 v[184:185], v6 offset:12288
    v_mfma_f32_16x16x32_bf16 v[28:31], v[144:147], v[124:127], v[28:31]
    ds_read_b64_tr_b16 v[186:187], v6 offset:12800
    v_mfma_f32_16x16x32_bf16 v[24:27], v[140:143], v[124:127], v[24:27]
    ds_read_b64_tr_b16 v[188:189], v7 offset:12288
    v_mfma_f32_16x16x32_bf16 v[32:35], v[140:143], v[128:131], v[32:35]
    ds_read_b64_tr_b16 v[190:191], v7 offset:12800
    v_mfma_f32_16x16x32_bf16 v[36:39], v[144:147], v[128:131], v[36:39]
    ds_read_b64_tr_b16 v[192:193], v6 offset:13312
    v_mfma_f32_16x16x32_bf16 v[68:71], v[152:155], v[128:131], v[68:71]
    ds_read_b64_tr_b16 v[194:195], v6 offset:13824
    v_mfma_f32_16x16x32_bf16 v[64:67], v[148:151], v[128:131], v[64:67]
    ds_read_b64_tr_b16 v[196:197], v7 offset:13312
    v_mfma_f32_16x16x32_bf16 v[112:115], v[148:151], v[136:139], v[112:115]
    ds_read_b64_tr_b16 v[198:199], v7 offset:13824
    v_mfma_f32_16x16x32_bf16 v[72:75], v[148:151], v[132:135], v[72:75]
    ds_read_b64_tr_b16 v[200:201], v6 offset:14336
    v_mfma_f32_16x16x32_bf16 v[76:79], v[152:155], v[132:135], v[76:79]
    ds_read_b64_tr_b16 v[202:203], v6 offset:14848
    v_mfma_f32_16x16x32_bf16 v[44:47], v[144:147], v[132:135], v[44:47]
    ds_read_b64_tr_b16 v[204:205], v7 offset:14336
    v_mfma_f32_16x16x32_bf16 v[40:43], v[140:143], v[132:135], v[40:43]
    ds_read_b64_tr_b16 v[206:207], v7 offset:14848
    v_mfma_f32_16x16x32_bf16 v[104:107], v[132:135], v[156:159], v[104:107]
    v_mfma_f32_16x16x32_bf16 v[108:111], v[132:135], v[160:163], v[108:111]
    v_mfma_f32_16x16x32_bf16 v[100:103], v[128:131], v[160:163], v[100:103]
    v_mfma_f32_16x16x32_bf16 v[96:99], v[128:131], v[156:159], v[96:99]
    v_mfma_f32_16x16x32_bf16 v[88:91], v[124:127], v[156:159], v[88:91]
    v_mfma_f32_16x16x32_bf16 v[92:95], v[124:127], v[160:163], v[92:95]
    v_mfma_f32_16x16x32_bf16 v[84:87], v[120:123], v[160:163], v[84:87]
    v_mfma_f32_16x16x32_bf16 v[80:83], v[120:123], v[156:159], v[80:83]
    v_mfma_f32_16x16x32_bf16 v[116:119], v[136:139], v[156:159], v[116:119]
    s_waitcnt lgkmcnt(0)
    s_barrier
    v_mfma_f32_16x16x32_bf16 v[16:19], v[184:187], v[164:167], v[16:19]
    ds_read_b128 v[120:123], v4 offset:18432
    v_mfma_f32_16x16x32_bf16 v[20:23], v[188:191], v[164:167], v[20:23]
    ds_read_b128 v[124:127], v4 offset:20480
    v_mfma_f32_16x16x32_bf16 v[52:55], v[196:199], v[164:167], v[52:55]
    ds_read_b128 v[128:131], v4 offset:22528
    v_mfma_f32_16x16x32_bf16 v[48:51], v[192:195], v[164:167], v[48:51]
    ds_read_b128 v[132:135], v4 offset:24576
    v_mfma_f32_16x16x32_bf16 v[56:59], v[192:195], v[168:171], v[56:59]
    ds_read_b128 v[136:139], v2 offset:18432
    v_mfma_f32_16x16x32_bf16 v[60:63], v[196:199], v[168:171], v[60:63]
    ds_read_b64_tr_b16 v[140:141], v6 offset:24576
    v_mfma_f32_16x16x32_bf16 v[28:31], v[188:191], v[168:171], v[28:31]
    ds_read_b64_tr_b16 v[142:143], v6 offset:25088
    v_mfma_f32_16x16x32_bf16 v[24:27], v[184:187], v[168:171], v[24:27]
    ds_read_b64_tr_b16 v[144:145], v7 offset:24576
    v_mfma_f32_16x16x32_bf16 v[32:35], v[184:187], v[172:175], v[32:35]
    ds_read_b64_tr_b16 v[146:147], v7 offset:25088
    v_mfma_f32_16x16x32_bf16 v[36:39], v[188:191], v[172:175], v[36:39]
    ds_read_b64_tr_b16 v[148:149], v6 offset:25600
    v_mfma_f32_16x16x32_bf16 v[68:71], v[196:199], v[172:175], v[68:71]
    ds_read_b64_tr_b16 v[150:151], v6 offset:26112
    v_mfma_f32_16x16x32_bf16 v[64:67], v[192:195], v[172:175], v[64:67]
    ds_read_b64_tr_b16 v[152:153], v7 offset:25600
    v_mfma_f32_16x16x32_bf16 v[112:115], v[192:195], v[180:183], v[112:115]
    ds_read_b64_tr_b16 v[154:155], v7 offset:26112
    v_mfma_f32_16x16x32_bf16 v[72:75], v[192:195], v[176:179], v[72:75]
    ds_read_b64_tr_b16 v[156:157], v6 offset:26624
    v_mfma_f32_16x16x32_bf16 v[76:79], v[196:199], v[176:179], v[76:79]
    ds_read_b64_tr_b16 v[158:159], v6 offset:27136
    v_mfma_f32_16x16x32_bf16 v[44:47], v[188:191], v[176:179], v[44:47]
    ds_read_b64_tr_b16 v[160:161], v7 offset:26624
    v_mfma_f32_16x16x32_bf16 v[40:43], v[184:187], v[176:179], v[40:43]
    ds_read_b64_tr_b16 v[162:163], v7 offset:27136
    v_mfma_f32_16x16x32_bf16 v[104:107], v[176:179], v[200:203], v[104:107]
    v_mfma_f32_16x16x32_bf16 v[108:111], v[176:179], v[204:207], v[108:111]
    v_mfma_f32_16x16x32_bf16 v[100:103], v[172:175], v[204:207], v[100:103]
    v_mfma_f32_16x16x32_bf16 v[96:99], v[172:175], v[200:203], v[96:99]
    v_mfma_f32_16x16x32_bf16 v[88:91], v[168:171], v[200:203], v[88:91]
    v_mfma_f32_16x16x32_bf16 v[92:95], v[168:171], v[204:207], v[92:95]
    v_mfma_f32_16x16x32_bf16 v[84:87], v[164:167], v[204:207], v[84:87]
    v_mfma_f32_16x16x32_bf16 v[80:83], v[164:167], v[200:203], v[80:83]
    v_mfma_f32_16x16x32_bf16 v[116:119], v[180:183], v[200:203], v[116:119]
    s_waitcnt lgkmcnt(0)
    v_mfma_f32_16x16x32_bf16 v[16:19], v[140:143], v[120:123], v[16:19]
    ds_read_b128 v[164:167], v5 offset:18432
    v_mfma_f32_16x16x32_bf16 v[20:23], v[144:147], v[120:123], v[20:23]
    ds_read_b128 v[168:171], v5 offset:20480
    v_mfma_f32_16x16x32_bf16 v[52:55], v[152:155], v[120:123], v[52:55]
    ds_read_b128 v[172:175], v5 offset:22528
    v_mfma_f32_16x16x32_bf16 v[48:51], v[148:151], v[120:123], v[48:51]
    ds_read_b128 v[176:179], v5 offset:24576
    v_mfma_f32_16x16x32_bf16 v[56:59], v[148:151], v[124:127], v[56:59]
    ds_read_b128 v[180:183], v3 offset:18432
    v_mfma_f32_16x16x32_bf16 v[60:63], v[152:155], v[124:127], v[60:63]
    ds_read_b64_tr_b16 v[184:185], v6 offset:36864
    v_mfma_f32_16x16x32_bf16 v[28:31], v[144:147], v[124:127], v[28:31]
    ds_read_b64_tr_b16 v[186:187], v6 offset:37376
    v_mfma_f32_16x16x32_bf16 v[24:27], v[140:143], v[124:127], v[24:27]
    ds_read_b64_tr_b16 v[188:189], v7 offset:36864
    v_mfma_f32_16x16x32_bf16 v[32:35], v[140:143], v[128:131], v[32:35]
    ds_read_b64_tr_b16 v[190:191], v7 offset:37376
    v_mfma_f32_16x16x32_bf16 v[36:39], v[144:147], v[128:131], v[36:39]
    ds_read_b64_tr_b16 v[192:193], v6 offset:37888
    v_mfma_f32_16x16x32_bf16 v[68:71], v[152:155], v[128:131], v[68:71]
    ds_read_b64_tr_b16 v[194:195], v6 offset:38400
    v_mfma_f32_16x16x32_bf16 v[64:67], v[148:151], v[128:131], v[64:67]
    ds_read_b64_tr_b16 v[196:197], v7 offset:37888
    v_mfma_f32_16x16x32_bf16 v[112:115], v[148:151], v[136:139], v[112:115]
    ds_read_b64_tr_b16 v[198:199], v7 offset:38400
    v_mfma_f32_16x16x32_bf16 v[72:75], v[148:151], v[132:135], v[72:75]
    ds_read_b64_tr_b16 v[200:201], v6 offset:38912
    v_mfma_f32_16x16x32_bf16 v[76:79], v[152:155], v[132:135], v[76:79]
    ds_read_b64_tr_b16 v[202:203], v6 offset:39424
    v_mfma_f32_16x16x32_bf16 v[44:47], v[144:147], v[132:135], v[44:47]
    ds_read_b64_tr_b16 v[204:205], v7 offset:38912
    v_mfma_f32_16x16x32_bf16 v[40:43], v[140:143], v[132:135], v[40:43]
    ds_read_b64_tr_b16 v[206:207], v7 offset:39424
    v_mfma_f32_16x16x32_bf16 v[104:107], v[132:135], v[156:159], v[104:107]
    v_mfma_f32_16x16x32_bf16 v[108:111], v[132:135], v[160:163], v[108:111]
    v_mfma_f32_16x16x32_bf16 v[100:103], v[128:131], v[160:163], v[100:103]
    v_mfma_f32_16x16x32_bf16 v[96:99], v[128:131], v[156:159], v[96:99]
    v_mfma_f32_16x16x32_bf16 v[88:91], v[124:127], v[156:159], v[88:91]
    v_mfma_f32_16x16x32_bf16 v[92:95], v[124:127], v[160:163], v[92:95]
    v_mfma_f32_16x16x32_bf16 v[84:87], v[120:123], v[160:163], v[84:87]
    v_mfma_f32_16x16x32_bf16 v[80:83], v[120:123], v[156:159], v[80:83]
    v_mfma_f32_16x16x32_bf16 v[116:119], v[136:139], v[156:159], v[116:119]
    s_waitcnt lgkmcnt(0)
    s_barrier
    s_cmp_lg_u32 s3, 0
    s_cbranch_scc1 LB_sk
    s_waitcnt vmcnt(0)
    v_cmp_eq_u32 vcc, 0, v222
    s_cbranch_vccnz LB_slow
LB_back:
    s_mov_b64 exec, 1
    buffer_store_dword v222, v220, s[52:55], s96 offen sc1
    s_mov_b64 exec, -1
LB_sk:
    v_mfma_f32_16x16x32_bf16 v[16:19], v[184:187], v[164:167], v[16:19]
    ds_read_b128 v[120:123], v4 offset:36864
    v_mfma_f32_16x16x32_bf16 v[20:23], v[188:191], v[164:167], v[20:23]
    ds_read_b128 v[124:127], v4 offset:38912
    v_mfma_f32_16x16x32_bf16 v[52:55], v[196:199], v[164:167], v[52:55]
    ds_read_b128 v[128:131], v4 offset:40960
    v_mfma_f32_16x16x32_bf16 v[48:51], v[192:195], v[164:167], v[48:51]
    ds_read_b128 v[132:135], v4 offset:43008
    v_mfma_f32_16x16x32_bf16 v[56:59], v[192:195], v[168:171], v[56:59]
    ds_read_b128 v[136:139], v2 offset:36864
    v_mfma_f32_16x16x32_bf16 v[60:63], v[196:199], v[168:171], v[60:63]
    ds_read_b64_tr_b16 v[140:141], v6 offset:49152
    v_mfma_f32_16x16x32_bf16 v[28:31], v[188:191], v[168:171], v[28:31]
    ds_read_b64_tr_b16 v[142:143], v6 offset:49664
    v_mfma_f32_16x16x32_bf16 v[24:27], v[184:187], v[168:171], v[24:27]
    ds_read_b64_tr_b16 v[144:145], v7 offset:49152
    v_mfma_f32_16x16x32_bf16 v[32:35], v[184:187], v[172:175], v[32:35]
    ds_read_b64_tr_b16 v[146:147], v7 offset:49664
    v_mfma_f32_16x16x32_bf16 v[36:39], v[188:191], v[172:175], v[36:39]
    ds_read_b64_tr_b16 v[148:149], v6 offset:50176
    v_mfma_f32_16x16x32_bf16 v[68:71], v[196:199], v[172:175], v[68:71]
    ds_read_b64_tr_b16 v[150:151], v6 offset:50688
    v_mfma_f32_16x16x32_bf16 v[64:67], v[192:195], v[172:175], v[64:67]
    ds_read_b64_tr_b16 v[152:153], v7 offset:50176
    v_mfma_f32_16x16x32_bf16 v[112:115], v[192:195], v[180:183], v[112:115]
    ds_read_b64_tr_b16 v[154:155], v7 offset:50688
    v_mfma_f32_16x16x32_bf16 v[72:75], v[192:195], v[176:179], v[72:75]
    ds_read_b64_tr_b16 v[156:157], v6 offset:51200
    v_mfma_f32_16x16x32_bf16 v[76:79], v[196:199], v[176:179], v[76:79]
    ds_read_b64_tr_b16 v[158:159], v6 offset:51712
    v_mfma_f32_16x16x32_bf16 v[44:47], v[188:191], v[176:179], v[44:47]
    ds_read_b64_tr_b16 v[160:161], v7 offset:51200
    v_mfma_f32_16x16x32_bf16 v[40:43], v[184:187], v[176:179], v[40:43]
    ds_read_b64_tr_b16 v[162:163], v7 offset:51712
    v_mfma_f32_16x16x32_bf16 v[104:107], v[176:179], v[200:203], v[104:107]
    v_mfma_f32_16x16x32_bf16 v[108:111], v[176:179], v[204:207], v[108:111]
    v_mfma_f32_16x16x32_bf16 v[100:103], v[172:175], v[204:207], v[100:103]
    v_mfma_f32_16x16x32_bf16 v[96:99], v[172:175], v[200:203], v[96:99]
    v_mfma_f32_16x16x32_bf16 v[88:91], v[168:171], v[200:203], v[88:91]
    v_mfma_f32_16x16x32_bf16 v[92:95], v[168:171], v[204:207], v[92:95]
    v_mfma_f32_16x16x32_bf16 v[84:87], v[164:167], v[204:207], v[84:87]
    v_mfma_f32_16x16x32_bf16 v[80:83], v[164:167], v[200:203], v[80:83]
    v_mfma_f32_16x16x32_bf16 v[116:119], v[180:183], v[200:203], v[116:119]
    s_waitcnt lgkmcnt(0)
    v_mfma_f32_16x16x32_bf16 v[16:19], v[140:143], v[120:123], v[16:19]
    ds_read_b128 v[164:167], v5 offset:36864
    v_mfma_f32_16x16x32_bf16 v[20:23], v[144:147], v[120:123], v[20:23]
    ds_read_b128 v[168:171], v5 offset:38912
    v_mfma_f32_16x16x32_bf16 v[52:55], v[152:155], v[120:123], v[52:55]
    ds_read_b128 v[172:175], v5 offset:40960
    v_mfma_f32_16x16x32_bf16 v[48:51], v[148:151], v[120:123], v[48:51]
    ds_read_b128 v[176:179], v5 offset:43008
    v_mfma_f32_16x16x32_bf16 v[56:59], v[148:151], v[124:127], v[56:59]
    ds_read_b128 v[180:183], v3 offset:36864
    v_mfma_f32_16x16x32_bf16 v[60:63], v[152:155], v[124:127], v[60:63]
    ds_read_b64_tr_b16 v[184:185], v6 offset:61440
    v_mfma_f32_16x16x32_bf16 v[28:31], v[144:147], v[124:127], v[28:31]
    ds_read_b64_tr_b16 v[186:187], v6 offset:61952
    v_mfma_f32_16x16x32_bf16 v[24:27], v[140:143], v[124:127], v[24:27]
    ds_read_b64_tr_b16 v[188:189], v7 offset:61440
    v_mfma_f32_16x16x32_bf16 v[32:35], v[140:143], v[128:131], v[32:35]
    ds_read_b64_tr_b16 v[190:191], v7 offset:61952
    v_mfma_f32_16x16x32_bf16 v[36:39], v[144:147], v[128:131], v[36:39]
    ds_read_b64_tr_b16 v[192:193], v6 offset:62464
    v_mfma_f32_16x16x32_bf16 v[68:71], v[152:155], v[128:131], v[68:71]
    ds_read_b64_tr_b16 v[194:195], v6 offset:62976
    v_mfma_f32_16x16x32_bf16 v[64:67], v[148:151], v[128:131], v[64:67]
    ds_read_b64_tr_b16 v[196:197], v7 offset:62464
    v_mfma_f32_16x16x32_bf16 v[112:115], v[148:151], v[136:139], v[112:115]
    ds_read_b64_tr_b16 v[198:199], v7 offset:62976
    v_mfma_f32_16x16x32_bf16 v[72:75], v[148:151], v[132:135], v[72:75]
    ds_read_b64_tr_b16 v[200:201], v6 offset:63488
    v_mfma_f32_16x16x32_bf16 v[76:79], v[152:155], v[132:135], v[76:79]
    ds_read_b64_tr_b16 v[202:203], v6 offset:64000
    v_mfma_f32_16x16x32_bf16 v[44:47], v[144:147], v[132:135], v[44:47]
    ds_read_b64_tr_b16 v[204:205], v7 offset:63488
    v_mfma_f32_16x16x32_bf16 v[40:43], v[140:143], v[132:135], v[40:43]
    ds_read_b64_tr_b16 v[206:207], v7 offset:64000
    v_mfma_f32_16x16x32_bf16 v[104:107], v[132:135], v[156:159], v[104:107]
    v_mfma_f32_16x16x32_bf16 v[108:111], v[132:135], v[160:163], v[108:111]
    v_mfma_f32_16x16x32_bf16 v[100:103], v[128:131], v[160:163], v[100:103]
    v_mfma_f32_16x16x32_bf16 v[96:99], v[128:131], v[156:159], v[96:99]
    v_mfma_f32_16x16x32_bf16 v[88:91], v[124:127], v[156:159], v[88:91]
    v_mfma_f32_16x16x32_bf16 v[92:95], v[124:127], v[160:163], v[92:95]
    v_mfma_f32_16x16x32_bf16 v[84:87], v[120:123], v[160:163], v[84:87]
    v_mfma_f32_16x16x32_bf16 v[80:83], v[120:123], v[156:159], v[80:83]
    v_mfma_f32_16x16x32_bf16 v[116:119], v[136:139], v[156:159], v[116:119]
    s_waitcnt lgkmcnt(0)
    s_barrier
    v_mfma_f32_16x16x32_bf16 v[16:19], v[184:187], v[164:167], v[16:19]
    ds_read_b128 v[120:123], v4 offset:0
    v_mfma_f32_16x16x32_bf16 v[20:23], v[188:191], v[164:167], v[20:23]
    ds_read_b128 v[124:127], v4 offset:2048
    v_mfma_f32_16x16x32_bf16 v[52:55], v[196:199], v[164:167], v[52:55]
    ds_read_b128 v[128:131], v4 offset:4096
    v_mfma_f32_16x16x32_bf16 v[48:51], v[192:195], v[164:167], v[48:51]
    ds_read_b128 v[132:135], v4 offset:6144
    v_mfma_f32_16x16x32_bf16 v[56:59], v[192:195], v[168:171], v[56:59]
    ds_read_b128 v[136:139], v2 offset:0
    v_mfma_f32_16x16x32_bf16 v[60:63], v[196:199], v[168:171], v[60:63]
    ds_read_b64_tr_b16 v[140:141], v6 offset:0
    v_mfma_f32_16x16x32_bf16 v[28:31], v[188:191], v[168:171], v[28:31]
    ds_read_b64_tr_b16 v[142:143], v6 offset:512
    v_mfma_f32_16x16x32_bf16 v[24:27], v[184:187], v[168:171], v[24:27]
    ds_read_b64_tr_b16 v[144:145], v7 offset:0
    v_mfma_f32_16x16x32_bf16 v[32:35], v[184:187], v[172:175], v[32:35]
    ds_read_b64_tr_b16 v[146:147], v7 offset:512
    v_mfma_f32_16x16x32_bf16 v[36:39], v[188:191], v[172:175], v[36:39]
    ds_read_b64_tr_b16 v[148:149], v6 offset:1024
    v_mfma_f32_16x16x32_bf16 v[68:71], v[196:199], v[172:175], v[68:71]
    ds_read_b64_tr_b16 v[150:151], v6 offset:1536
    v_mfma_f32_16x16x32_bf16 v[64:67], v[192:195], v[172:175], v[64:67]
    ds_read_b64_tr_b16 v[152:153], v7 offset:1024
    v_mfma_f32_16x16x32_bf16 v[112:115], v[192:195], v[180:183], v[112:115]
    ds_read_b64_tr_b16 v[154:155], v7 offset:1536
    v_mfma_f32_16x16x32_bf16 v[72:75], v[192:195], v[176:179], v[72:75]
    ds_read_b64_tr_b16 v[156:157], v6 offset:2048
    v_mfma_f32_16x16x32_bf16 v[76:79], v[196:199], v[176:179], v[76:79]
    ds_read_b64_tr_b16 v[158:159], v6 offset:2560
    v_mfma_f32_16x16x32_bf16 v[44:47], v[188:191], v[176:179], v[44:47]
    ds_read_b64_tr_b16 v[160:161], v7 offset:2048
    v_mfma_f32_16x16x32_bf16 v[40:43], v[184:187], v[176:179], v[40:43]
    ds_read_b64_tr_b16 v[162:163], v7 offset:2560
    v_mfma_f32_16x16x32_bf16 v[104:107], v[176:179], v[200:203], v[104:107]
    v_mfma_f32_16x16x32_bf16 v[108:111], v[176:179], v[204:207], v[108:111]
    v_mfma_f32_16x16x32_bf16 v[100:103], v[172:175], v[204:207], v[100:103]
    v_mfma_f32_16x16x32_bf16 v[96:99], v[172:175], v[200:203], v[96:99]
    v_mfma_f32_16x16x32_bf16 v[88:91], v[168:171], v[200:203], v[88:91]
    v_mfma_f32_16x16x32_bf16 v[92:95], v[168:171], v[204:207], v[92:95]
    v_mfma_f32_16x16x32_bf16 v[84:87], v[164:167], v[204:207], v[84:87]
    v_mfma_f32_16x16x32_bf16 v[80:83], v[164:167], v[200:203], v[80:83]
    v_mfma_f32_16x16x32_bf16 v[116:119], v[180:183], v[200:203], v[116:119]
    s_waitcnt lgkmcnt(0)
    v_mfma_f32_16x16x32_bf16 v[16:19], v[140:143], v[120:123], v[16:19]
    ds_read_b128 v[164:167], v5 offset:0
    v_mfma_f32_16x16x32_bf16 v[20:23], v[144:147], v[120:123], v[20:23]
    ds_read_b128 v[168:171], v5 offset:2048
    v_mfma_f32_16x16x32_bf16 v[52:55], v[152:155], v[120:123], v[52:55]
    ds_read_b128 v[172:175], v5 offset:4096
    v_mfma_f32_16x16x32_bf16 v[48:51], v[148:151], v[120:123], v[48:51]
    ds_read_b128 v[176:179], v5 offset:6144
    v_mfma_f32_16x16x32_bf16 v[56:59], v[148:151], v[124:127], v[56:59]
    ds_read_b128 v[180:183], v3 offset:0
    v_mfma_f32_16x16x32_bf16 v[60:63], v[152:155], v[124:127], v[60:63]
    ds_read_b64_tr_b16 v[184:185], v6 offset:12288
    v_mfma_f32_16x16x32_bf16 v[28:31], v[144:147], v[124:127], v[28:31]
    ds_read_b64_tr_b16 v[186:187], v6 offset:12800
    v_mfma_f32_16x16x32_bf16 v[24:27], v[140:143], v[124:127], v[24:27]
    ds_read_b64_tr_b16 v[188:189], v7 offset:12288
    v_mfma_f32_16x16x32_bf16 v[32:35], v[140:143], v[128:131], v[32:35]
    ds_read_b64_tr_b16 v[190:191], v7 offset:12800
    v_mfma_f32_16x16x32_bf16 v[36:39], v[144:147], v[128:131], v[36:39]
    ds_read_b64_tr_b16 v[192:193], v6 offset:13312
    v_mfma_f32_16x16x32_bf16 v[68:71], v[152:155], v[128:131], v[68:71]
    ds_read_b64_tr_b16 v[194:195], v6 offset:13824
    v_mfma_f32_16x16x32_bf16 v[64:67], v[148:151], v[128:131], v[64:67]
    ds_read_b64_tr_b16 v[196:197], v7 offset:13312
    v_mfma_f32_16x16x32_bf16 v[112:115], v[148:151], v[136:139], v[112:115]
    ds_read_b64_tr_b16 v[198:199], v7 offset:13824
    v_mfma_f32_16x16x32_bf16 v[72:75], v[148:151], v[132:135], v[72:75]
    ds_read_b64_tr_b16 v[200:201], v6 offset:14336
    v_mfma_f32_16x16x32_bf16 v[76:79], v[152:155], v[132:135], v[76:79]
    ds_read_b64_tr_b16 v[202:203], v6 offset:14848
    v_mfma_f32_16x16x32_bf16 v[44:47], v[144:147], v[132:135], v[44:47]
    ds_read_b64_tr_b16 v[204:205], v7 offset:14336
    v_mfma_f32_16x16x32_bf16 v[40:43], v[140:143], v[132:135], v[40:43]
    ds_read_b64_tr_b16 v[206:207], v7 offset:14848
    v_mfma_f32_16x16x32_bf16 v[104:107], v[132:135], v[156:159], v[104:107]
    v_mfma_f32_16x16x32_bf16 v[108:111], v[132:135], v[160:163], v[108:111]
    v_mfma_f32_16x16x32_bf16 v[100:103], v[128:131], v[160:163], v[100:103]
    v_mfma_f32_16x16x32_bf16 v[96:99], v[128:131], v[156:159], v[96:99]
    v_mfma_f32_16x16x32_bf16 v[88:91], v[124:127], v[156:159], v[88:91]
    v_mfma_f32_16x16x32_bf16 v[92:95], v[124:127], v[160:163], v[92:95]
    v_mfma_f32_16x16x32_bf16 v[84:87], v[120:123], v[160:163], v[84:87]
    v_mfma_f32_16x16x32_bf16 v[80:83], v[120:123], v[156:159], v[80:83]
    v_mfma_f32_16x16x32_bf16 v[116:119], v[136:139], v[156:159], v[116:119]
    s_waitcnt lgkmcnt(0)
    s_barrier
    v_mfma_f32_16x16x32_bf16 v[16:19], v[184:187], v[164:167], v[16:19]
    ds_read_b128 v[120:123], v4 offset:18432
    v_mfma_f32_16x16x32_bf16 v[20:23], v[188:191], v[164:167], v[20:23]
    ds_read_b128 v[124:127], v4 offset:20480
    v_mfma_f32_16x16x32_bf16 v[52:55], v[196:199], v[164:167], v[52:55]
    ds_read_b128 v[128:131], v4 offset:22528
    v_mfma_f32_16x16x32_bf16 v[48:51], v[192:195], v[164:167], v[48:51]
    ds_read_b128 v[132:135], v4 offset:24576
    v_mfma_f32_16x16x32_bf16 v[56:59], v[192:195], v[168:171], v[56:59]
    ds_read_b128 v[136:139], v2 offset:18432
    v_mfma_f32_16x16x32_bf16 v[60:63], v[196:199], v[168:171], v[60:63]
    ds_read_b64_tr_b16 v[140:141], v6 offset:24576
    v_mfma_f32_16x16x32_bf16 v[28:31], v[188:191], v[168:171], v[28:31]
    ds_read_b64_tr_b16 v[142:143], v6 offset:25088
    v_mfma_f32_16x16x32_bf16 v[24:27], v[184:187], v[168:171], v[24:27]
    ds_read_b64_tr_b16 v[144:145], v7 offset:24576
    v_mfma_f32_16x16x32_bf16 v[32:35], v[184:187], v[172:175], v[32:35]
    ds_read_b64_tr_b16 v[146:147], v7 offset:25088
    v_mfma_f32_16x16x32_bf16 v[36:39], v[188:191], v[172:175], v[36:39]
    ds_read_b64_tr_b16 v[148:149], v6 offset:25600
    v_mfma_f32_16x16x32_bf16 v[68:71], v[196:199], v[172:175], v[68:71]
    ds_read_b64_tr_b16 v[150:151], v6 offset:26112
    v_mfma_f32_16x16x32_bf16 v[64:67], v[192:195], v[172:175], v[64:67]
    ds_read_b64_tr_b16 v[152:153], v7 offset:25600
    v_mfma_f32_16x16x32_bf16 v[112:115], v[192:195], v[180:183], v[112:115]
    ds_read_b64_tr_b16 v[154:155], v7 offset:26112
    v_mfma_f32_16x16x32_bf16 v[72:75], v[192:195], v[176:179], v[72:75]
    ds_read_b64_tr_b16 v[156:157], v6 offset:26624
    v_mfma_f32_16x16x32_bf16 v[76:79], v[196:199], v[176:179], v[76:79]
    ds_read_b64_tr_b16 v[158:159], v6 offset:27136
    v_mfma_f32_16x16x32_bf16 v[44:47], v[188:191], v[176:179], v[44:47]
    ds_read_b64_tr_b16 v[160:161], v7 offset:26624
    v_mfma_f32_16x16x32_bf16 v[40:43], v[184:187], v[176:179], v[40:43]
    ds_read_b64_tr_b16 v[162:163], v7 offset:27136
    v_mfma_f32_16x16x32_bf16 v[104:107], v[176:179], v[200:203], v[104:107]
    v_mfma_f32_16x16x32_bf16 v[108:111], v[176:179], v[204:207], v[108:111]
    v_mfma_f32_16x16x32_bf16 v[100:103], v[172:175], v[204:207], v[100:103]
    v_mfma_f32_16x16x32_bf16 v[96:99], v[172:175], v[200:203], v[96:99]
    v_mfma_f32_16x16x32_bf16 v[88:91], v[168:171], v[200:203], v[88:91]
    v_mfma_f32_16x16x32_bf16 v[92:95], v[168:171], v[204:207], v[92:95]
    v_mfma_f32_16x16x32_bf16 v[84:87], v[164:167], v[204:207], v[84:87]
    v_mfma_f32_16x16x32_bf16 v[80:83], v[164:167], v[200:203], v[80:83]
    v_mfma_f32_16x16x32_bf16 v[116:119], v[180:183], v[200:203], v[116:119]
    s_waitcnt lgkmcnt(0)
    v_mfma_f32_16x16x32_bf16 v[16:19], v[140:143], v[120:123], v[16:19]
    ds_read_b128 v[164:167], v5 offset:18432
    v_mfma_f32_16x16x32_bf16 v[20:23], v[144:147], v[120:123], v[20:23]
    ds_read_b128 v[168:171], v5 offset:20480
    v_mfma_f32_16x16x32_bf16 v[52:55], v[152:155], v[120:123], v[52:55]
    ds_read_b128 v[172:175], v5 offset:22528
    v_mfma_f32_16x16x32_bf16 v[48:51], v[148:151], v[120:123], v[48:51]
    ds_read_b128 v[176:179], v5 offset:24576
    v_mfma_f32_16x16x32_bf16 v[56:59], v[148:151], v[124:127], v[56:59]
    ds_read_b128 v[180:183], v3 offset:18432
    v_mfma_f32_16x16x32_bf16 v[60:63], v[152:155], v[124:127], v[60:63]
    ds_read_b64_tr_b16 v[184:185], v6 offset:36864
    v_mfma_f32_16x16x32_bf16 v[28:31], v[144:147], v[124:127], v[28:31]
    ds_read_b64_tr_b16 v[186:187], v6 offset:37376
    v_mfma_f32_16x16x32_bf16 v[24:27], v[140:143], v[124:127], v[24:27]
    ds_read_b64_tr_b16 v[188:189], v7 offset:36864
    v_mfma_f32_16x16x32_bf16 v[32:35], v[140:143], v[128:131], v[32:35]
    ds_read_b64_tr_b16 v[190:191], v7 offset:37376
    v_mfma_f32_16x16x32_bf16 v[36:39], v[144:147], v[128:131], v[36:39]
    ds_read_b64_tr_b16 v[192:193], v6 offset:37888
    v_mfma_f32_16x16x32_bf16 v[68:71], v[152:155], v[128:131], v[68:71]
    ds_read_b64_tr_b16 v[194:195], v6 offset:38400
    v_mfma_f32_16x16x32_bf16 v[64:67], v[148:151], v[128:131], v[64:67]
    ds_read_b64_tr_b16 v[196:197], v7 offset:37888
    v_mfma_f32_16x16x32_bf16 v[112:115], v[148:151], v[136:139], v[112:115]
    ds_read_b64_tr_b16 v[198:199], v7 offset:38400
    v_mfma_f32_16x16x32_bf16 v[72:75], v[148:151], v[132:135], v[72:75]
    ds_read_b64_tr_b16 v[200:201], v6 offset:38912
    v_mfma_f32_16x16x32_bf16 v[76:79], v[152:155], v[132:135], v[76:79]
    ds_read_b64_tr_b16 v[202:203], v6 offset:39424
    v_mfma_f32_16x16x32_bf16 v[44:47], v[144:147], v[132:135], v[44:47]
    ds_read_b64_tr_b16 v[204:205], v7 offset:38912
    v_mfma_f32_16x16x32_bf16 v[40:43], v[140:143], v[132:135], v[40:43]
    ds_read_b64_tr_b16 v[206:207], v7 offset:39424
    v_mfma_f32_16x16x32_bf16 v[104:107], v[132:135], v[156:159], v[104:107]
    v_mfma_f32_16x16x32_bf16 v[108:111], v[132:135], v[160:163], v[108:111]
    v_mfma_f32_16x16x32_bf16 v[100:103], v[128:131], v[160:163], v[100:103]
    v_mfma_f32_16x16x32_bf16 v[96:99], v[128:131], v[156:159], v[96:99]
    v_mfma_f32_16x16x32_bf16 v[88:91], v[124:127], v[156:159], v[88:91]
    v_mfma_f32_16x16x32_bf16 v[92:95], v[124:127], v[160:163], v[92:95]
    v_mfma_f32_16x16x32_bf16 v[84:87], v[120:123], v[160:163], v[84:87]
    v_mfma_f32_16x16x32_bf16 v[80:83], v[120:123], v[156:159], v[80:83]
    v_mfma_f32_16x16x32_bf16 v[116:119], v[136:139], v[156:159], v[116:119]
    s_waitcnt lgkmcnt(0)
    s_barrier
    v_mfma_f32_16x16x32_bf16 v[16:19], v[184:187], v[164:167], v[16:19]
    ds_read_b128 v[120:123], v4 offset:36864
    v_mfma_f32_16x16x32_bf16 v[20:23], v[188:191], v[164:167], v[20:23]
    ds_read_b128 v[124:127], v4 offset:38912
    v_mfma_f32_16x16x32_bf16 v[52:55], v[196:199], v[164:167], v[52:55]
    ds_read_b128 v[128:131], v4 offset:40960
    v_mfma_f32_16x16x32_bf16 v[48:51], v[192:195], v[164:167], v[48:51]
    ds_read_b128 v[132:135], v4 offset:43008
    v_mfma_f32_16x16x32_bf16 v[56:59], v[192:195], v[168:171], v[56:59]
    ds_read_b128 v[136:139], v2 offset:36864
    v_mfma_f32_16x16x32_bf16 v[60:63], v[196:199], v[168:171], v[60:63]
    ds_read_b64_tr_b16 v[140:141], v6 offset:49152
    v_mfma_f32_16x16x32_bf16 v[28:31], v[188:191], v[168:171], v[28:31]
    ds_read_b64_tr_b16 v[142:143], v6 offset:49664
    v_mfma_f32_16x16x32_bf16 v[24:27], v[184:187], v[168:171], v[24:27]
    ds_read_b64_tr_b16 v[144:145], v7 offset:49152
    v_mfma_f32_16x16x32_bf16 v[32:35], v[184:187], v[172:175], v[32:35]
    ds_read_b64_tr_b16 v[146:147], v7 offset:49664
    v_mfma_f32_16x16x32_bf16 v[36:39], v[188:191], v[172:175], v[36:39]
    ds_read_b64_tr_b16 v[148:149], v6 offset:50176
    v_mfma_f32_16x16x32_bf16 v[68:71], v[196:199], v[172:175], v[68:71]
    ds_read_b64_tr_b16 v[150:151], v6 offset:50688
    v_mfma_f32_16x16x32_bf16 v[64:67], v[192:195], v[172:175], v[64:67]
    ds_read_b64_tr_b16 v[152:153], v7 offset:50176
    v_mfma_f32_16x16x32_bf16 v[112:115], v[192:195], v[180:183], v[112:115]
    ds_read_b64_tr_b16 v[154:155], v7 offset:50688
    v_mfma_f32_16x16x32_bf16 v[72:75], v[192:195], v[176:179], v[72:75]
    ds_read_b64_tr_b16 v[156:157], v6 offset:51200
    v_mfma_f32_16x16x32_bf16 v[76:79], v[196:199], v[176:179], v[76:79]
    ds_read_b64_tr_b16 v[158:159], v6 offset:51712
    v_mfma_f32_16x16x32_bf16 v[44:47], v[188:191], v[176:179], v[44:47]
    ds_read_b64_tr_b16 v[160:161], v7 offset:51200
    v_mfma_f32_16x16x32_bf16 v[40:43], v[184:187], v[176:179], v[40:43]
    ds_read_b64_tr_b16 v[162:163], v7 offset:51712
    v_mfma_f32_16x16x32_bf16 v[104:107], v[176:179], v[200:203], v[104:107]
    v_mfma_f32_16x16x32_bf16 v[108:111], v[176:179], v[204:207], v[108:111]
    v_mfma_f32_16x16x32_bf16 v[100:103], v[172:175], v[204:207], v[100:103]
    v_mfma_f32_16x16x32_bf16 v[96:99], v[172:175], v[200:203], v[96:99]
    v_mfma_f32_16x16x32_bf16 v[88:91], v[168:171], v[200:203], v[88:91]
    v_mfma_f32_16x16x32_bf16 v[92:95], v[168:171], v[204:207], v[92:95]
    v_mfma_f32_16x16x32_bf16 v[84:87], v[164:167], v[204:207], v[84:87]
    v_mfma_f32_16x16x32_bf16 v[80:83], v[164:167], v[200:203], v[80:83]
    v_mfma_f32_16x16x32_bf16 v[116:119], v[180:183], v[200:203], v[116:119]
    s_waitcnt lgkmcnt(0)
    v_mfma_f32_16x16x32_bf16 v[16:19], v[140:143], v[120:123], v[16:19]
    ds_read_b128 v[164:167], v5 offset:36864
    v_mfma_f32_16x16x32_bf16 v[20:23], v[144:147], v[120:123], v[20:23]
    ds_read_b128 v[168:171], v5 offset:38912
    v_mfma_f32_16x16x32_bf16 v[52:55], v[152:155], v[120:123], v[52:55]
    ds_read_b128 v[172:175], v5 offset:40960
    v_mfma_f32_16x16x32_bf16 v[48:51], v[148:151], v[120:123], v[48:51]
    ds_read_b128 v[176:179], v5 offset:43008
    v_mfma_f32_16x16x32_bf16 v[56:59], v[148:151], v[124:127], v[56:59]
    ds_read_b128 v[180:183], v3 offset:36864
    v_mfma_f32_16x16x32_bf16 v[60:63], v[152:155], v[124:127], v[60:63]
    ds_read_b64_tr_b16 v[184:185], v6 offset:61440
    v_mfma_f32_16x16x32_bf16 v[28:31], v[144:147], v[124:127], v[28:31]
    ds_read_b64_tr_b16 v[186:187], v6 offset:61952
    v_mfma_f32_16x16x32_bf16 v[24:27], v[140:143], v[124:127], v[24:27]
    ds_read_b64_tr_b16 v[188:189], v7 offset:61440
    v_mfma_f32_16x16x32_bf16 v[32:35], v[140:143], v[128:131], v[32:35]
    ds_read_b64_tr_b16 v[190:191], v7 offset:61952
    v_mfma_f32_16x16x32_bf16 v[36:39], v[144:147], v[128:131], v[36:39]
    ds_read_b64_tr_b16 v[192:193], v6 offset:62464
    v_mfma_f32_16x16x32_bf16 v[68:71], v[152:155], v[128:131], v[68:71]
    ds_read_b64_tr_b16 v[194:195], v6 offset:62976
    v_mfma_f32_16x16x32_bf16 v[64:67], v[148:151], v[128:131], v[64:67]
    ds_read_b64_tr_b16 v[196:197], v7 offset:62464
    v_mfma_f32_16x16x32_bf16 v[112:115], v[148:151], v[136:139], v[112:115]
    ds_read_b64_tr_b16 v[198:199], v7 offset:62976
    v_mfma_f32_16x16x32_bf16 v[72:75], v[148:151], v[132:135], v[72:75]
    ds_read_b64_tr_b16 v[200:201], v6 offset:63488
    v_mfma_f32_16x16x32_bf16 v[76:79], v[152:155], v[132:135], v[76:79]
    ds_read_b64_tr_b16 v[202:203], v6 offset:64000
    v_mfma_f32_16x16x32_bf16 v[44:47], v[144:147], v[132:135], v[44:47]
    ds_read_b64_tr_b16 v[204:205], v7 offset:63488
    v_mfma_f32_16x16x32_bf16 v[40:43], v[140:143], v[132:135], v[40:43]
    ds_read_b64_tr_b16 v[206:207], v7 offset:64000
    v_mfma_f32_16x16x32_bf16 v[104:107], v[132:135], v[156:159], v[104:107]
    s_nop 0
    v_mfma_f32_16x16x32_bf16 v[108:111], v[132:135], v[160:163], v[108:111]
    s_nop 0
    v_mfma_f32_16x16x32_bf16 v[100:103], v[128:131], v[160:163], v[100:103]
    s_nop 0
    v_mfma_f32_16x16x32_bf16 v[96:99], v[128:131], v[156:159], v[96:99]
    s_nop 0
    v_mfma_f32_16x16x32_bf16 v[88:91], v[124:127], v[156:159], v[88:91]
    ds_read_b32 v223, v10 offset:24
    v_mfma_f32_16x16x32_bf16 v[92:95], v[124:127], v[160:163], v[92:95]
    v_mfma_f32_16x16x32_bf16 v[84:87], v[120:123], v[160:163], v[84:87]
    v_mfma_f32_16x16x32_bf16 v[80:83], v[120:123], v[156:159], v[80:83]
    v_mfma_f32_16x16x32_bf16 v[116:119], v[136:139], v[156:159], v[116:119]
    s_waitcnt lgkmcnt(0)
    v_cmp_gt_u32 vcc, 4, v223
    s_cbranch_vccnz LB_w15
LB_g15:
    v_mfma_f32_16x16x32_bf16 v[16:19], v[184:187], v[164:167], v[16:19]
    ds_read_b128 v[120:123], v4 offset:0
    v_mfma_f32_16x16x32_bf16 v[20:23], v[188:191], v[164:167], v[20:23]
    ds_read_b128 v[124:127], v4 offset:2048
    v_mfma_f32_16x16x32_bf16 v[52:55], v[196:199], v[164:167], v[52:55]
    ds_read_b128 v[128:131], v4 offset:4096
    v_mfma_f32_16x16x32_bf16 v[48:51], v[192:195], v[164:167], v[48:51]
    ds_read_b128 v[132:135], v4 offset:6144
    v_mfma_f32_16x16x32_bf16 v[56:59], v[192:195], v[168:171], v[56:59]
    ds_read_b128 v[136:139], v2 offset:0
    v_mfma_f32_16x16x32_bf16 v[60:63], v[196:199], v[168:171], v[60:63]
    ds_read_b64_tr_b16 v[140:141], v6 offset:0
    v_mfma_f32_16x16x32_bf16 v[28:31], v[188:191], v[168:171], v[28:31]
    ds_read_b64_tr_b16 v[142:143], v6 offset:512
    v_mfma_f32_16x16x32_bf16 v[24:27], v[184:187], v[168:171], v[24:27]
    ds_read_b64_tr_b16 v[144:145], v7 offset:0
    v_mfma_f32_16x16x32_bf16 v[32:35], v[184:187], v[172:175], v[32:35]
    ds_read_b64_tr_b16 v[146:147], v7 offset:512
    v_mfma_f32_16x16x32_bf16 v[36:39], v[188:191], v[172:175], v[36:39]
    ds_read_b64_tr_b16 v[148:149], v6 offset:1024
    v_mfma_f32_16x16x32_bf16 v[68:71], v[196:199], v[172:175], v[68:71]
    ds_read_b64_tr_b16 v[150:151], v6 offset:1536
    v_mfma_f32_16x16x32_bf16 v[64:67], v[192:195], v[172:175], v[64:67]
    ds_read_b64_tr_b16 v[152:153], v7 offset:1024
    v_mfma_f32_16x16x32_bf16 v[112:115], v[192:195], v[180:183], v[112:115]
    ds_read_b64_tr_b16 v[154:155], v7 offset:1536
    v_mfma_f32_16x16x32_bf16 v[72:75], v[192:195], v[176:179], v[72:75]
    ds_read_b64_tr_b16 v[156:157], v6 offset:2048
    v_mfma_f32_16x16x32_bf16 v[76:79], v[196:199], v[176:179], v[76:79]
    ds_read_b64_tr_b16 v[158:159], v6 offset:2560
    v_mfma_f32_16x16x32_bf16 v[44:47], v[188:191], v[176:179], v[44:47]
    ds_read_b64_tr_b16 v[160:161], v7 offset:2048
    v_mfma_f32_16x16x32_bf16 v[40:43], v[184:187], v[176:179], v[40:43]
    ds_read_b64_tr_b16 v[162:163], v7 offset:2560
    v_mfma_f32_16x16x32_bf16 v[104:107], v[176:179], v[200:203], v[104:107]
    v_mfma_f32_16x16x32_bf16 v[108:111], v[176:179], v[204:207], v[108:111]
    v_mfma_f32_16x16x32_bf16 v[100:103], v[172:175], v[204:207], v[100:103]
    v_mfma_f32_16x16x32_bf16 v[96:99], v[172:175], v[200:203], v[96:99]
    v_mfma_f32_16x16x32_bf16 v[88:91], v[168:171], v[200:203], v[88:91]
    v_mfma_f32_16x16x32_bf16 v[92:95], v[168:171], v[204:207], v[92:95]
    v_mfma_f32_16x16x32_bf16 v[84:87], v[164:167], v[204:207], v[84:87]
    v_mfma_f32_16x16x32_bf16 v[80:83], v[164:167], v[200:203], v[80:83]
    v_mfma_f32_16x16x32_bf16 v[116:119], v[180:183], v[200:203], v[116:119]
    s_waitcnt lgkmcnt(0)
    v_mfma_f32_16x16x32_bf16 v[16:19], v[140:143], v[120:123], v[16:19]
    ds_read_b128 v[164:167], v5 offset:0
    v_mfma_f32_16x16x32_bf16 v[20:23], v[144:147], v[120:123], v[20:23]
    ds_read_b128 v[168:171], v5 offset:2048
    v_mfma_f32_16x16x32_bf16 v[52:55], v[152:155], v[120:123], v[52:55]
    ds_read_b128 v[172:175], v5 offset:4096
    v_mfma_f32_16x16x32_bf16 v[48:51], v[148:151], v[120:123], v[48:51]
    ds_read_b128 v[176:179], v5 offset:6144
    v_mfma_f32_16x16x32_bf16 v[56:59], v[148:151], v[124:127], v[56:59]
    ds_read_b128 v[180:183], v3 offset:0
    v_mfma_f32_16x16x32_bf16 v[60:63], v[152:155], v[124:127], v[60:63]
    ds_read_b64_tr_b16 v[184:185], v6 offset:12288
    v_mfma_f32_16x16x32_bf16 v[28:31], v[144:147], v[124:127], v[28:31]
    ds_read_b64_tr_b16 v[186:187], v6 offset:12800
    v_mfma_f32_16x16x32_bf16 v[24:27], v[140:143], v[124:127], v[24:27]
    ds_read_b64_tr_b16 v[188:189], v7 offset:12288
    v_mfma_f32_16x16x32_bf16 v[32:35], v[140:143], v[128:131], v[32:35]
    ds_read_b64_tr_b16 v[190:191], v7 offset:12800
    v_mfma_f32_16x16x32_bf16 v[36:39], v[144:147], v[128:131], v[36:39]
    ds_read_b64_tr_b16 v[192:193], v6 offset:13312
    v_mfma_f32_16x16x32_bf16 v[68:71], v[152:155], v[128:131], v[68:71]
    ds_read_b64_tr_b16 v[194:195], v6 offset:13824
    v_mfma_f32_16x16x32_bf16 v[64:67], v[148:151], v[128:131], v[64:67]
    ds_read_b64_tr_b16 v[196:197], v7 offset:13312
    v_mfma_f32_16x16x32_bf16 v[112:115], v[148:151], v[136:139], v[112:115]
    ds_read_b64_tr_b16 v[198:199], v7 offset:13824
    v_mfma_f32_16x16x32_bf16 v[72:75], v[148:151], v[132:135], v[72:75]
    ds_read_b64_tr_b16 v[200:201], v6 offset:14336
    v_mfma_f32_16x16x32_bf16 v[76:79], v[152:155], v[132:135], v[76:79]
    ds_read_b64_tr_b16 v[202:203], v6 offset:14848
    v_mfma_f32_16x16x32_bf16 v[44:47], v[144:147], v[132:135], v[44:47]
    ds_read_b64_tr_b16 v[204:205], v7 offset:14336
    v_mfma_f32_16x16x32_bf16 v[40:43], v[140:143], v[132:135], v[40:43]
    ds_read_b64_tr_b16 v[206:207], v7 offset:14848
    v_mfma_f32_16x16x32_bf16 v[104:107], v[132:135], v[156:159], v[104:107]
    v_mfma_f32_16x16x32_bf16 v[108:111], v[132:135], v[160:163], v[108:111]
    v_mfma_f32_16x16x32_bf16 v[100:103], v[128:131], v[160:163], v[100:103]
    v_mfma_f32_16x16x32_bf16 v[96:99], v[128:131], v[156:159], v[96:99]
    v_mfma_f32_16x16x32_bf16 v[88:91], v[124:127], v[156:159], v[88:91]
    v_mfma_f32_16x16x32_bf16 v[92:95], v[124:127], v[160:163], v[92:95]
    v_mfma_f32_16x16x32_bf16 v[84:87], v[120:123], v[160:163], v[84:87]
    v_mfma_f32_16x16x32_bf16 v[80:83], v[120:123], v[156:159], v[80:83]
    v_mfma_f32_16x16x32_bf16 v[116:119], v[136:139], v[156:159], v[116:119]
    s_waitcnt lgkmcnt(0)
    v_mfma_f32_16x16x32_bf16 v[112:115], v[192:195], v[180:183], v[112:115]
    v_mfma_f32_16x16x32_bf16 v[116:119], v[180:183], v[200:203], v[116:119]
    v_mfma_f32_16x16x32_bf16 v[72:75], v[192:195], v[176:179], v[72:75]
    v_mfma_f32_16x16x32_bf16 v[76:79], v[196:199], v[176:179], v[76:79]
    v_mfma_f32_16x16x32_bf16 v[104:107], v[176:179], v[200:203], v[104:107]
    v_mfma_f32_16x16x32_bf16 v[108:111], v[176:179], v[204:207], v[108:111]
    v_mfma_f32_16x16x32_bf16 v[40:43], v[184:187], v[176:179], v[40:43]
    v_mfma_f32_16x16x32_bf16 v[44:47], v[188:191], v[176:179], v[44:47]
    v_mfma_f32_16x16x32_bf16 v[64:67], v[192:195], v[172:175], v[64:67]
    v_mfma_f32_16x16x32_bf16 v[68:71], v[196:199], v[172:175], v[68:71]
    v_cvt_pk_bf16_f32 v156, v112, v113
    v_cvt_pk_bf16_f32 v157, v114, v115
    v_mfma_f32_16x16x32_bf16 v[32:35], v[184:187], v[172:175], v[32:35]
    v_cvt_pk_bf16_f32 v158, v116, v117
    v_cvt_pk_bf16_f32 v159, v118, v119
    v_mfma_f32_16x16x32_bf16 v[36:39], v[188:191], v[172:175], v[36:39]
    v_cvt_pk_bf16_f32 v152, v72, v73
    v_cvt_pk_bf16_f32 v153, v74, v75
    v_mfma_f32_16x16x32_bf16 v[56:59], v[192:195], v[168:171], v[56:59]
    v_cvt_pk_bf16_f32 v154, v76, v77
    v_cvt_pk_bf16_f32 v155, v78, v79
    v_mfma_f32_16x16x32_bf16 v[60:63], v[196:199], v[168:171], v[60:63]
    v_cvt_pk_bf16_f32 v232, v104, v105
    v_cvt_pk_bf16_f32 v233, v106, v107
    v_mfma_f32_16x16x32_bf16 v[24:27], v[184:187], v[168:171], v[24:27]
    v_cvt_pk_bf16_f32 v242, v108, v109
    v_cvt_pk_bf16_f32 v243, v110, v111
    v_mfma_f32_16x16x32_bf16 v[28:31], v[188:191], v[168:171], v[28:31]
    ds_write_b64 v216, v[156:157]
    ds_write_b64 v216, v[158:159] offset:1024
    v_mfma_f32_16x16x32_bf16 v[48:51], v[192:195], v[164:167], v[48:51]
    ds_write_b64 v217, v[152:153] offset:0
    ds_write_b64 v217, v[232:233] offset:1024
    v_mfma_f32_16x16x32_bf16 v[52:55], v[196:199], v[164:167], v[52:55]
    ds_write_b64 v217, v[154:155] offset:512
    ds_write_b64 v217, v[242:243] offset:1536
    v_mfma_f32_16x16x32_bf16 v[16:19], v[184:187], v[164:167], v[16:19]
    v_cvt_pk_bf16_f32 v132, v40, v41
    v_cvt_pk_bf16_f32 v133, v42, v43
    v_mfma_f32_16x16x32_bf16 v[20:23], v[188:191], v[164:167], v[20:23]
    v_cvt_pk_bf16_f32 v134, v44, v45
    v_cvt_pk_bf16_f32 v135, v46, v47
    v_mfma_f32_16x16x32_bf16 v[96:99], v[172:175], v[200:203], v[96:99]
    v_cvt_pk_bf16_f32 v148, v64, v65
    v_cvt_pk_bf16_f32 v149, v66, v67
    v_mfma_f32_16x16x32_bf16 v[100:103], v[172:175], v[204:207], v[100:103]
    v_cvt_pk_bf16_f32 v150, v68, v69
    v_cvt_pk_bf16_f32 v151, v70, v71
    v_mfma_f32_16x16x32_bf16 v[88:91], v[168:171], v[200:203], v[88:91]
    v_cvt_pk_bf16_f32 v128, v32, v33
    v_cvt_pk_bf16_f32 v129, v34, v35
    v_mfma_f32_16x16x32_bf16 v[92:95], v[168:171], v[204:207], v[92:95]
    v_cvt_pk_bf16_f32 v130, v36, v37
    v_cvt_pk_bf16_f32 v131, v38, v39
    v_mfma_f32_16x16x32_bf16 v[80:83], v[164:167], v[200:203], v[80:83]
    v_cvt_pk_bf16_f32 v144, v56, v57
    v_cvt_pk_bf16_f32 v145, v58, v59
    v_mfma_f32_16x16x32_bf16 v[84:87], v[164:167], v[204:207], v[84:87]
    v_cvt_pk_bf16_f32 v146, v60, v61
    v_cvt_pk_bf16_f32 v147, v62, v63
    v_cvt_pk_bf16_f32 v124, v24, v25
    v_cvt_pk_bf16_f32 v125, v26, v27
    v_cvt_pk_bf16_f32 v126, v28, v29
    v_cvt_pk_bf16_f32 v127, v30, v31
    s_mov_b64 exec, 1
    ds_add_u32 v10, v11 offset:0
    s_mov_b64 exec, -1
    v_cvt_pk_bf16_f32 v140, v48, v49
    v_cvt_pk_bf16_f32 v141, v50, v51
    v_cvt_pk_bf16_f32 v142, v52, v53
    v_cvt_pk_bf16_f32 v143, v54, v55
    v_cvt_pk_bf16_f32 v120, v16, v17
    v_cvt_pk_bf16_f32 v121, v18, v19
    v_cvt_pk_bf16_f32 v122, v20, v21
    v_cvt_pk_bf16_f32 v123, v22, v23
    v_mfma_f32_16x16x32_bf16 v[44:47], v[152:155], v[132:135], 0
    v_cvt_pk_bf16_f32 v230, v96, v97
    v_cvt_pk_bf16_f32 v231, v98, v99
    v_mfma_f32_16x16x32_bf16 v[40:43], v[148:151], v[132:135], 0
    v_cvt_pk_bf16_f32 v240, v100, v101
    v_cvt_pk_bf16_f32 v241, v102, v103
    v_mfma_f32_16x16x32_bf16 v[36:39], v[148:151], v[128:131], 0
    v_cvt_pk_bf16_f32 v228, v88, v89
    v_cvt_pk_bf16_f32 v229, v90, v91
    v_mfma_f32_16x16x32_bf16 v[32:35], v[144:147], v[128:131], 0
    v_cvt_pk_bf16_f32 v238, v92, v93
    v_cvt_pk_bf16_f32 v239, v94, v95
    v_mfma_f32_16x16x32_bf16 v[28:31], v[144:147], v[124:127], 0
    v_cvt_pk_bf16_f32 v226, v80, v81
    v_cvt_pk_bf16_f32 v227, v82, v83
    v_mfma_f32_16x16x32_bf16 v[24:27], v[140:143], v[124:127], 0
    v_cvt_pk_bf16_f32 v236, v84, v85
    v_cvt_pk_bf16_f32 v237, v86, v87
    v_mfma_f32_16x16x32_bf16 v[20:23], v[140:143], v[120:123], 0
    s_branch LB_s1_in
LB_s1:
    s_sleep 1
LB_s1_in:
    ds_read_b32 v14, v10 offset:0
    ds_read_b64 v[136:137], v218
    ds_read_b64 v[138:139], v219
    ds_read_b64 v[224:225], v218 offset:1024
    ds_read_b64 v[234:235], v219 offset:1024
    s_waitcnt lgkmcnt(0)
    v_readfirstlane_b32 s78, v14
    s_nop 0
    s_cmp_ge_u32 s78, 4
    s_cbranch_scc0 LB_s1
    v_mfma_f32_16x16x32_bf16 v[16:19], v[136:139], v[120:123], v[212:215]
    v_cndmask_b32 v60, v44, v45, s[88:89]
    s_add_u32 m0, s34, 36864
    s_add_u32 s35, s44, 0
    buffer_load_dwordx4 v245, s[64:67], s35 offen  lds
    v_cndmask_b32 v61, v40, v41, s[88:89]
    v_cndmask_b32 v54, v61, v60, s[90:91]
    v_cndmask_b32 v60, v46, v47, s[88:89]
    v_cndmask_b32 v61, v42, v43, s[88:89]
    v_cndmask_b32 v55, v61, v60, s[92:93]
    v_max_f32 v59, v54, v55
    v_cndmask_b32 v60, v36, v37, s[88:89]
    v_cndmask_b32 v61, v32, v33, s[88:89]
    v_cndmask_b32 v52, v61, v60, s[90:91]
    v_cndmask_b32 v60, v38, v39, s[88:89]
    v_cndmask_b32 v61, v34, v35, s[88:89]
    v_cndmask_b32 v53, v61, v60, s[92:93]
    v_max_f32 v58, v52, v53
    v_cndmask_b32 v60, v28, v29, s[88:89]
    v_cndmask_b32 v61, v24, v25, s[88:89]
    v_cndmask_b32 v50, v61, v60, s[90:91]
    v_cndmask_b32 v60, v30, v31, s[88:89]
    v_cndmask_b32 v61, v26, v27, s[88:89]
    s_add_u32 m0, s34, 40960
    s_add_u32 s35, s44, 65536
    buffer_load_dwordx4 v245, s[64:67], s35 offen  lds
    v_cndmask_b32 v51, v61, v60, s[92:93]
    v_max_f32 v57, v50, v51
    v_cndmask_b32 v60, v20, v21, s[88:89]
    v_cndmask_b32 v61, v16, v17, s[88:89]
    v_cndmask_b32 v48, v61, v60, s[90:91]
    v_cndmask_b32 v60, v22, v23, s[88:89]
    v_cndmask_b32 v61, v18, v19, s[88:89]
    v_cndmask_b32 v49, v61, v60, s[92:93]
    v_max_f32 v56, v48, v49
    s_mov_b32 s80, 0x3e8293ee
    v_permlane32_swap_b32 v58, v59
    v_permlane32_swap_b32 v56, v57
    v_max_f32 v58, v58, v59
    v_max_f32 v56, v56, v57
    s_nop 1
    v_permlane16_swap_b32 v56, v58
    v_max_f32 v56, v56, v58
    v_mul_f32 v56, s80, v56
    v_mov_b32 v58, v56
    s_nop 1
    v_permlane16_swap_b32 v56, v58
    s_add_u32 m0, s34, 45056
    s_add_u32 s35, s44, 131072
    buffer_load_dwordx4 v245, s[64:67], s35 offen  lds
    v_mov_b32 v57, v56
    v_mov_b32 v59, v58
    s_nop 0
    v_permlane32_swap_b32 v56, v57
    v_permlane32_swap_b32 v58, v59
    v_fma_f32 v48, v48, s80, -v56
    v_fma_f32 v49, v49, s80, -v56
    v_fma_f32 v50, v50, s80, -v57
    v_fma_f32 v51, v51, s80, -v57
    v_fma_f32 v52, v52, s80, -v58
    v_fma_f32 v53, v53, s80, -v58
    v_fma_f32 v54, v54, s80, -v59
    v_fma_f32 v55, v55, s80, -v59
    v_exp_f32 v48, v48
    v_exp_f32 v49, v49
    v_exp_f32 v50, v50
    v_exp_f32 v51, v51
    v_exp_f32 v52, v52
    v_exp_f32 v53, v53
    s_add_u32 m0, s34, 49152
    s_add_u32 s35, s44, 196608
    buffer_load_dwordx4 v245, s[64:67], s35 offen  lds
    v_exp_f32 v54, v54
    v_exp_f32 v55, v55
    v_add_f32 v56, v48, v49
    v_add_f32 v57, v50, v51
    v_add_f32 v58, v52, v53
    v_add_f32 v59, v54, v55
    s_nop 1
    v_permlane32_swap_b32 v58, v59
    v_permlane32_swap_b32 v56, v57
    v_add_f32 v58, v58, v59
    v_add_f32 v56, v56, v57
    s_nop 1
    v_permlane16_swap_b32 v56, v58
    v_add_f32 v56, v56, v58
    v_rcp_f32 v56, v56
    s_nop 0
    v_mov_b32 v58, v56
    s_nop 1
    v_permlane16_swap_b32 v56, v58
    v_mov_b32 v57, v56
    v_mov_b32 v59, v58
    s_nop 0
    v_permlane32_swap_b32 v56, v57
    v_permlane32_swap_b32 v58, v59
    s_add_u32 m0, s34, 53248
    s_add_u32 s35, s45, 0
    buffer_load_dwordx4 v245, s[64:67], s35 offen  lds
    v_mul_f32 v48, v48, v56
    v_mul_f32 v49, v49, v56
    v_cvt_pk_bf16_f32 v48, v48, v49
    v_perm_b32 v64, v48, v48, v208
    v_perm_b32 v65, v48, v48, v209
    v_perm_b32 v66, v48, v48, v210
    v_perm_b32 v67, v48, v48, v211
    v_mul_f32 v50, v50, v57
    v_mul_f32 v51, v51, v57
    v_cvt_pk_bf16_f32 v50, v50, v51
    v_perm_b32 v68, v50, v50, v208
    v_perm_b32 v69, v50, v50, v209
    v_perm_b32 v70, v50, v50, v210
    v_perm_b32 v71, v50, v50, v211
    v_mfma_f32_16x16x32_bf16 v[16:19], v[224:227], v[64:67], 0
    v_mfma_f32_16x16x32_bf16 v[20:23], v[234:237], v[64:67], 0
    v_mul_f32 v52, v52, v58
    v_mul_f32 v53, v53, v58
    s_add_u32 m0, s34, 57344
    s_add_u32 s35, s45, 65536
    buffer_load_dwordx4 v245, s[64:67], s35 offen  lds
    v_cvt_pk_bf16_f32 v52, v52, v53
    v_perm_b32 v72, v52, v52, v208
    v_perm_b32 v73, v52, v52, v209
    v_perm_b32 v74, v52, v52, v210
    v_perm_b32 v75, v52, v52, v211
    v_mfma_f32_16x16x32_bf16 v[24:27], v[226:229], v[68:71], 0
    v_mfma_f32_16x16x32_bf16 v[28:31], v[236:239], v[68:71], 0
    v_mul_f32 v54, v54, v59
    v_mul_f32 v55, v55, v59
    v_cvt_pk_bf16_f32 v54, v54, v55
    v_perm_b32 v76, v54, v54, v208
    v_perm_b32 v77, v54, v54, v209
    v_perm_b32 v78, v54, v54, v210
    v_perm_b32 v79, v54, v54, v211
    v_mfma_f32_16x16x32_bf16 v[32:35], v[228:231], v[72:75], 0
    v_mfma_f32_16x16x32_bf16 v[36:39], v[238:241], v[72:75], 0
    v_mfma_f32_16x16x32_bf16 v[40:43], v[230:233], v[76:79], 0
    v_mfma_f32_16x16x32_bf16 v[44:47], v[240:243], v[76:79], 0
    v_cvt_pk_bf16_f32 v80, v16, v17
    v_cvt_pk_bf16_f32 v81, v18, v19
    v_cvt_pk_bf16_f32 v82, v20, v21
    v_cvt_pk_bf16_f32 v83, v22, v23
    s_add_u32 s95, s94, 0
    buffer_store_dwordx4 v[80:83], v12, s[52:55], s95 offen sc1
    v_cvt_pk_bf16_f32 v84, v24, v25
    v_cvt_pk_bf16_f32 v85, v26, v27
    v_cvt_pk_bf16_f32 v86, v28, v29
    v_cvt_pk_bf16_f32 v87, v30, v31
    s_add_u32 s95, s94, 32768
    buffer_store_dwordx4 v[84:87], v12, s[52:55], s95 offen sc1
    v_cvt_pk_bf16_f32 v88, v32, v33
    v_cvt_pk_bf16_f32 v89, v34, v35
    v_cvt_pk_bf16_f32 v90, v36, v37
    v_cvt_pk_bf16_f32 v91, v38, v39
    s_add_u32 s95, s94, 65536
    buffer_store_dwordx4 v[88:91], v12, s[52:55], s95 offen sc1
    v_cvt_pk_bf16_f32 v92, v40, v41
    v_cvt_pk_bf16_f32 v93, v42, v43
    v_cvt_pk_bf16_f32 v94, v44, v45
    v_cvt_pk_bf16_f32 v95, v46, v47
    s_add_u32 s95, s94, 98304
    buffer_store_dwordx4 v[92:95], v12, s[52:55], s95 offen sc1
    s_add_u32 m0, s34, 61440
    s_add_u32 s35, s45, 131072
    buffer_load_dwordx4 v245, s[64:67], s35 offen  lds
    v_xor_b32 v2, 0, v244
    v_xor_b32 v3, 32, v244
    v_xor_b32 v4, 64, v244
    v_xor_b32 v5, 96, v244
    s_add_u32 m0, s34, 65536
    s_add_u32 s35, s45, 196608
    buffer_load_dwordx4 v245, s[64:67], s35 offen  lds
    v_xor_b32 v6, 2048, v244
    v_xor_b32 v7, 2080, v244
    v_xor_b32 v8, 2112, v244
    v_xor_b32 v9, 2144, v244
    s_waitcnt vmcnt(6)
    s_mov_b64 exec, 1
    ds_add_u32 v10, v11 offset:8
    s_mov_b64 exec, -1
    s_add_u32 m0, s34, 69632
    s_add_u32 s35, s46, 0
    buffer_load_dwordx4 v245, s[64:67], s35 offen  lds
    v_add_u32 v224, 65536, v2
    v_add_u32 v225, 65536, v3
    s_add_u32 m0, s34, 73728
    s_add_u32 s35, s46, 65536
    buffer_load_dwordx4 v245, s[64:67], s35 offen  lds
    v_add_u32 v226, 65536, v4
    s_add_u32 m0, s34, 77824
    s_add_u32 s35, s46, 131072
    buffer_load_dwordx4 v245, s[64:67], s35 offen  lds
    v_add_u32 v227, 65536, v5
    v_add_u32 v228, 65536, v6
    s_add_u32 m0, s34, 81920
    s_add_u32 s35, s46, 196608
    buffer_load_dwordx4 v245, s[64:67], s35 offen  lds
    v_add_u32 v229, 65536, v7
    s_add_u32 m0, s34, 86016
    s_add_u32 s35, s47, 0
    buffer_load_dwordx4 v245, s[64:67], s35 offen  lds
    v_add_u32 v230, 65536, v8
    v_add_u32 v231, 65536, v9
    s_add_u32 m0, s34, 0
    s_add_u32 s35, s47, 65536
    buffer_load_dwordx4 v245, s[64:67], s35 offen  lds
    v_add_u32 v15, 32768, v12
    s_waitcnt vmcnt(8)
    s_mov_b64 exec, 1
    buffer_store_dword v11, v220, s[52:55], s97 offen sc1
    s_mov_b64 exec, -1
    s_branch LB_s2_in
LB_s2:
    s_sleep 1
LB_s2_in:
    ds_read_b32 v14, v10 offset:8
    s_waitcnt lgkmcnt(0)
    v_readfirstlane_b32 s78, v14
    s_nop 0
    s_cmp_ge_u32 s78, 8
    s_cbranch_scc0 LB_s2
    s_add_u32 m0, s34, 4096
    s_add_u32 s35, s47, 131072
    buffer_load_dwordx4 v245, s[64:67], s35 offen  lds
    ds_read_b64_tr_b16 v[48:49], v2 offset:36864
    ds_read_b64_tr_b16 v[50:51], v6 offset:36864
    s_add_u32 m0, s34, 8192
    s_add_u32 s35, s47, 196608
    buffer_load_dwordx4 v245, s[64:67], s35 offen  lds
    ds_read_b64_tr_b16 v[52:53], v3 offset:36864
    s_add_u32 m0, s34, 12288
    s_add_u32 s35, s48, 0
    buffer_load_dwordx4 v245, s[64:67], s35 offen  lds
    ds_read_b64_tr_b16 v[54:55], v7 offset:36864
    s_add_u32 m0, s34, 16384
    s_add_u32 s35, s48, 65536
    buffer_load_dwordx4 v245, s[64:67], s35 offen  lds
    ds_read_b64_tr_b16 v[56:57], v4 offset:36864
    ds_read_b64_tr_b16 v[58:59], v8 offset:36864
    s_add_u32 m0, s34, 20480
    s_add_u32 s35, s48, 131072
    buffer_load_dwordx4 v245, s[64:67], s35 offen  lds
    ds_read_b64_tr_b16 v[60:61], v5 offset:36864
    s_add_u32 m0, s34, 110592
    s_add_u32 s35, s48, 196608
    buffer_load_dwordx4 v245, s[64:67], s35 offen  lds
    ds_read_b64_tr_b16 v[62:63], v9 offset:36864
    s_add_u32 m0, s34, 114688
    s_add_u32 s35, s49, 0
    buffer_load_dwordx4 v245, s[64:67], s35 offen  lds
    ds_read_b64_tr_b16 v[64:65], v2 offset:40960
    ds_read_b64_tr_b16 v[66:67], v6 offset:40960
    s_add_u32 m0, s34, 118784
    s_add_u32 s35, s49, 65536
    buffer_load_dwordx4 v245, s[64:67], s35 offen  lds
    ds_read_b64_tr_b16 v[68:69], v3 offset:40960
    s_add_u32 m0, s34, 122880
    s_add_u32 s35, s49, 131072
    buffer_load_dwordx4 v245, s[64:67], s35 offen  lds
    ds_read_b64_tr_b16 v[70:71], v7 offset:40960
    s_add_u32 m0, s34, 24576
    s_add_u32 s35, s49, 196608
    buffer_load_dwordx4 v245, s[64:67], s35 offen  lds
    ds_read_b64_tr_b16 v[72:73], v4 offset:40960
    ds_read_b64_tr_b16 v[74:75], v8 offset:40960
    s_add_u32 m0, s34, 28672
    s_add_u32 s35, s50, 0
    buffer_load_dwordx4 v245, s[64:67], s35 offen  lds
    ds_read_b64_tr_b16 v[76:77], v5 offset:40960
    s_add_u32 m0, s34, 32768
    s_add_u32 s35, s50, 65536
    buffer_load_dwordx4 v245, s[64:67], s35 offen  lds
    ds_read_b64_tr_b16 v[78:79], v9 offset:40960
    s_waitcnt vmcnt(0)
    s_mov_b64 exec, 1
    ds_add_u32 v10, v11 offset:16
    s_mov_b64 exec, -1
    s_mov_b64 exec, 0xffffffff
    s_mov_b32 s79, 0
LB_po:
    buffer_load_dword v14, v247, s[52:55], s30 offen sc1
    s_add_u32 s79, s79, 1
    s_cmp_gt_u32 s79, 200000
    s_cbranch_scc1 LB_po_x
    s_waitcnt vmcnt(0)
    v_cmp_ne_u32 vcc, 1, v14
    s_cbranch_vccz LB_po_x
    s_mov_b64 exec, vcc
    s_sleep 4
    s_branch LB_po
LB_po_x:
    s_waitcnt vmcnt(0)
    s_mov_b64 exec, -1
    ds_read_b32 v222, v10 offset:16
    buffer_load_dwordx4 v[96:99], v12, s[52:55], s36 offen offset:0 sc1
    buffer_load_dwordx4 v[100:103], v15, s[52:55], s36 offen offset:0 sc1
    buffer_load_dwordx4 v[104:107], v12, s[52:55], s36 offen offset:1024 sc1
    buffer_load_dwordx4 v[108:111], v15, s[52:55], s36 offen offset:1024 sc1
    buffer_load_dwordx4 v[112:115], v12, s[52:55], s36 offen offset:2048 sc1
    buffer_load_dwordx4 v[116:119], v15, s[52:55], s36 offen offset:2048 sc1
    buffer_load_dwordx4 v[120:123], v12, s[52:55], s36 offen offset:3072 sc1
    buffer_load_dwordx4 v[124:127], v15, s[52:55], s36 offen offset:3072 sc1
    buffer_load_dwordx4 v[128:131], v12, s[52:55], s37 offen offset:0 sc1
    buffer_load_dwordx4 v[132:135], v15, s[52:55], s37 offen offset:0 sc1
    s_setprio 1
    s_waitcnt lgkmcnt(0)
    v_cmp_gt_u32 vcc, 4, v222
    s_cbranch_vccnz LB_w4
LB_g4:
    s_waitcnt vmcnt(8)
    v_mfma_f32_16x16x32_bf16 v[16:19], v[48:51], v[96:99], 0
    buffer_load_dwordx4 v[136:139], v12, s[52:55], s37 offen offset:1024 sc1
    buffer_load_dwordx4 v[140:143], v15, s[52:55], s37 offen offset:1024 sc1
    v_mfma_f32_16x16x32_bf16 v[20:23], v[52:55], v[96:99], 0
    ds_read_b64_tr_b16 v[80:81], v2 offset:45056
    v_mfma_f32_16x16x32_bf16 v[24:27], v[56:59], v[96:99], 0
    ds_read_b64_tr_b16 v[82:83], v6 offset:45056
    v_mfma_f32_16x16x32_bf16 v[28:31], v[60:63], v[96:99], 0
    ds_read_b64_tr_b16 v[84:85], v3 offset:45056
    v_mfma_f32_16x16x32_bf16 v[32:35], v[48:51], v[100:103], 0
    ds_read_b64_tr_b16 v[86:87], v7 offset:45056
    ds_read_b64_tr_b16 v[88:89], v4 offset:45056
    v_mfma_f32_16x16x32_bf16 v[36:39], v[52:55], v[100:103], 0
    ds_read_b64_tr_b16 v[90:91], v8 offset:45056
    v_mfma_f32_16x16x32_bf16 v[40:43], v[56:59], v[100:103], 0
    ds_read_b64_tr_b16 v[92:93], v5 offset:45056
    v_mfma_f32_16x16x32_bf16 v[44:47], v[60:63], v[100:103], 0
    ds_read_b64_tr_b16 v[94:95], v9 offset:45056
    s_waitcnt vmcnt(8)
    v_mfma_f32_16x16x32_bf16 v[16:19], v[64:67], v[104:107], v[16:19]
    buffer_load_dwordx4 v[96:99], v12, s[52:55], s37 offen offset:2048 sc1
    buffer_load_dwordx4 v[100:103], v15, s[52:55], s37 offen offset:2048 sc1
    v_mfma_f32_16x16x32_bf16 v[20:23], v[68:71], v[104:107], v[20:23]
    ds_read_b64_tr_b16 v[48:49], v2 offset:49152
    v_mfma_f32_16x16x32_bf16 v[24:27], v[72:75], v[104:107], v[24:27]
    ds_read_b64_tr_b16 v[50:51], v6 offset:49152
    v_mfma_f32_16x16x32_bf16 v[28:31], v[76:79], v[104:107], v[28:31]
    ds_read_b64_tr_b16 v[52:53], v3 offset:49152
    v_mfma_f32_16x16x32_bf16 v[32:35], v[64:67], v[108:111], v[32:35]
    ds_read_b64_tr_b16 v[54:55], v7 offset:49152
    ds_read_b64_tr_b16 v[56:57], v4 offset:49152
    v_mfma_f32_16x16x32_bf16 v[36:39], v[68:71], v[108:111], v[36:39]
    ds_read_b64_tr_b16 v[58:59], v8 offset:49152
    v_mfma_f32_16x16x32_bf16 v[40:43], v[72:75], v[108:111], v[40:43]
    ds_read_b64_tr_b16 v[60:61], v5 offset:49152
    v_mfma_f32_16x16x32_bf16 v[44:47], v[76:79], v[108:111], v[44:47]
    ds_read_b64_tr_b16 v[62:63], v9 offset:49152
    s_waitcnt vmcnt(8) lgkmcnt(8)
    v_mfma_f32_16x16x32_bf16 v[16:19], v[80:83], v[112:115], v[16:19]
    buffer_load_dwordx4 v[104:107], v12, s[52:55], s37 offen offset:3072 sc1
    buffer_load_dwordx4 v[108:111], v15, s[52:55], s37 offen offset:3072 sc1
    v_mfma_f32_16x16x32_bf16 v[20:23], v[84:87], v[112:115], v[20:23]
    ds_read_b64_tr_b16 v[64:65], v2 offset:53248
    v_mfma_f32_16x16x32_bf16 v[24:27], v[88:91], v[112:115], v[24:27]
    ds_read_b64_tr_b16 v[66:67], v6 offset:53248
    v_mfma_f32_16x16x32_bf16 v[28:31], v[92:95], v[112:115], v[28:31]
    ds_read_b64_tr_b16 v[68:69], v3 offset:53248
    v_mfma_f32_16x16x32_bf16 v[32:35], v[80:83], v[116:119], v[32:35]
    ds_read_b64_tr_b16 v[70:71], v7 offset:53248
    ds_read_b64_tr_b16 v[72:73], v4 offset:53248
    v_mfma_f32_16x16x32_bf16 v[36:39], v[84:87], v[116:119], v[36:39]
    ds_read_b64_tr_b16 v[74:75], v8 offset:53248
    v_mfma_f32_16x16x32_bf16 v[40:43], v[88:91], v[116:119], v[40:43]
    ds_read_b64_tr_b16 v[76:77], v5 offset:53248
    v_mfma_f32_16x16x32_bf16 v[44:47], v[92:95], v[116:119], v[44:47]
    ds_read_b64_tr_b16 v[78:79], v9 offset:53248
    s_waitcnt vmcnt(8) lgkmcnt(8)
    v_mfma_f32_16x16x32_bf16 v[16:19], v[48:51], v[120:123], v[16:19]
    buffer_load_dwordx4 v[112:115], v12, s[52:55], s38 offen offset:0 sc1
    buffer_load_dwordx4 v[116:119], v15, s[52:55], s38 offen offset:0 sc1
    v_mfma_f32_16x16x32_bf16 v[20:23], v[52:55], v[120:123], v[20:23]
    ds_read_b64_tr_b16 v[80:81], v2 offset:57344
    v_mfma_f32_16x16x32_bf16 v[24:27], v[56:59], v[120:123], v[24:27]
    ds_read_b64_tr_b16 v[82:83], v6 offset:57344
    v_mfma_f32_16x16x32_bf16 v[28:31], v[60:63], v[120:123], v[28:31]
    ds_read_b64_tr_b16 v[84:85], v3 offset:57344
    v_mfma_f32_16x16x32_bf16 v[32:35], v[48:51], v[124:127], v[32:35]
    ds_read_b64_tr_b16 v[86:87], v7 offset:57344
    ds_read_b64_tr_b16 v[88:89], v4 offset:57344
    v_mfma_f32_16x16x32_bf16 v[36:39], v[52:55], v[124:127], v[36:39]
    ds_read_b64_tr_b16 v[90:91], v8 offset:57344
    v_mfma_f32_16x16x32_bf16 v[40:43], v[56:59], v[124:127], v[40:43]
    ds_read_b64_tr_b16 v[92:93], v5 offset:57344
    v_mfma_f32_16x16x32_bf16 v[44:47], v[60:63], v[124:127], v[44:47]
    ds_read_b64_tr_b16 v[94:95], v9 offset:57344
    s_waitcnt vmcnt(8) lgkmcnt(8)
    v_mfma_f32_16x16x32_bf16 v[16:19], v[64:67], v[128:131], v[16:19]
    buffer_load_dwordx4 v[120:123], v12, s[52:55], s38 offen offset:1024 sc1
    buffer_load_dwordx4 v[124:127], v15, s[52:55], s38 offen offset:1024 sc1
    v_mfma_f32_16x16x32_bf16 v[20:23], v[68:71], v[128:131], v[20:23]
    ds_read_b64_tr_b16 v[48:49], v2 offset:61440
    v_mfma_f32_16x16x32_bf16 v[24:27], v[72:75], v[128:131], v[24:27]
    ds_read_b64_tr_b16 v[50:51], v6 offset:61440
    v_mfma_f32_16x16x32_bf16 v[28:31], v[76:79], v[128:131], v[28:31]
    ds_read_b64_tr_b16 v[52:53], v3 offset:61440
    v_mfma_f32_16x16x32_bf16 v[32:35], v[64:67], v[132:135], v[32:35]
    ds_read_b64_tr_b16 v[54:55], v7 offset:61440
    ds_read_b64_tr_b16 v[56:57], v4 offset:61440
    v_mfma_f32_16x16x32_bf16 v[36:39], v[68:71], v[132:135], v[36:39]
    ds_read_b64_tr_b16 v[58:59], v8 offset:61440
    v_mfma_f32_16x16x32_bf16 v[40:43], v[72:75], v[132:135], v[40:43]
    ds_read_b64_tr_b16 v[60:61], v5 offset:61440
    v_mfma_f32_16x16x32_bf16 v[44:47], v[76:79], v[132:135], v[44:47]
    ds_read_b64_tr_b16 v[62:63], v9 offset:61440
    s_waitcnt vmcnt(8) lgkmcnt(8)
    v_mfma_f32_16x16x32_bf16 v[16:19], v[80:83], v[136:139], v[16:19]
    buffer_load_dwordx4 v[128:131], v12, s[52:55], s38 offen offset:2048 sc1
    buffer_load_dwordx4 v[132:135], v15, s[52:55], s38 offen offset:2048 sc1
    v_mfma_f32_16x16x32_bf16 v[20:23], v[84:87], v[136:139], v[20:23]
    ds_read_b64_tr_b16 v[64:65], v224 offset:0
    v_mfma_f32_16x16x32_bf16 v[24:27], v[88:91], v[136:139], v[24:27]
    ds_read_b64_tr_b16 v[66:67], v228 offset:0
    v_mfma_f32_16x16x32_bf16 v[28:31], v[92:95], v[136:139], v[28:31]
    ds_read_b64_tr_b16 v[68:69], v225 offset:0
    v_mfma_f32_16x16x32_bf16 v[32:35], v[80:83], v[140:143], v[32:35]
    ds_read_b64_tr_b16 v[70:71], v229 offset:0
    ds_read_b64_tr_b16 v[72:73], v226 offset:0
    v_mfma_f32_16x16x32_bf16 v[36:39], v[84:87], v[140:143], v[36:39]
    ds_read_b64_tr_b16 v[74:75], v230 offset:0
    v_mfma_f32_16x16x32_bf16 v[40:43], v[88:91], v[140:143], v[40:43]
    ds_read_b64_tr_b16 v[76:77], v227 offset:0
    v_mfma_f32_16x16x32_bf16 v[44:47], v[92:95], v[140:143], v[44:47]
    ds_read_b64_tr_b16 v[78:79], v231 offset:0
    s_waitcnt vmcnt(8) lgkmcnt(8)
    v_mfma_f32_16x16x32_bf16 v[16:19], v[48:51], v[96:99], v[16:19]
    buffer_load_dwordx4 v[136:139], v12, s[52:55], s38 offen offset:3072 sc1
    buffer_load_dwordx4 v[140:143], v15, s[52:55], s38 offen offset:3072 sc1
    v_mfma_f32_16x16x32_bf16 v[20:23], v[52:55], v[96:99], v[20:23]
    ds_read_b64_tr_b16 v[80:81], v224 offset:4096
    v_mfma_f32_16x16x32_bf16 v[24:27], v[56:59], v[96:99], v[24:27]
    ds_read_b64_tr_b16 v[82:83], v228 offset:4096
    v_mfma_f32_16x16x32_bf16 v[28:31], v[60:63], v[96:99], v[28:31]
    ds_read_b64_tr_b16 v[84:85], v225 offset:4096
    v_mfma_f32_16x16x32_bf16 v[32:35], v[48:51], v[100:103], v[32:35]
    ds_read_b64_tr_b16 v[86:87], v229 offset:4096
    ds_read_b64_tr_b16 v[88:89], v226 offset:4096
    v_mfma_f32_16x16x32_bf16 v[36:39], v[52:55], v[100:103], v[36:39]
    ds_read_b64_tr_b16 v[90:91], v230 offset:4096
    v_mfma_f32_16x16x32_bf16 v[40:43], v[56:59], v[100:103], v[40:43]
    ds_read_b64_tr_b16 v[92:93], v227 offset:4096
    v_mfma_f32_16x16x32_bf16 v[44:47], v[60:63], v[100:103], v[44:47]
    ds_read_b64_tr_b16 v[94:95], v231 offset:4096
    s_waitcnt vmcnt(8) lgkmcnt(8)
    v_mfma_f32_16x16x32_bf16 v[16:19], v[64:67], v[104:107], v[16:19]
    buffer_load_dwordx4 v[96:99], v12, s[52:55], s39 offen offset:0 sc1
    buffer_load_dwordx4 v[100:103], v15, s[52:55], s39 offen offset:0 sc1
    v_mfma_f32_16x16x32_bf16 v[20:23], v[68:71], v[104:107], v[20:23]
    ds_read_b64_tr_b16 v[48:49], v224 offset:8192
    v_mfma_f32_16x16x32_bf16 v[24:27], v[72:75], v[104:107], v[24:27]
    ds_read_b64_tr_b16 v[50:51], v228 offset:8192
    v_mfma_f32_16x16x32_bf16 v[28:31], v[76:79], v[104:107], v[28:31]
    ds_read_b64_tr_b16 v[52:53], v225 offset:8192
    v_mfma_f32_16x16x32_bf16 v[32:35], v[64:67], v[108:111], v[32:35]
    ds_read_b64_tr_b16 v[54:55], v229 offset:8192
    ds_read_b64_tr_b16 v[56:57], v226 offset:8192
    v_mfma_f32_16x16x32_bf16 v[36:39], v[68:71], v[108:111], v[36:39]
    ds_read_b64_tr_b16 v[58:59], v230 offset:8192
    v_mfma_f32_16x16x32_bf16 v[40:43], v[72:75], v[108:111], v[40:43]
    ds_read_b64_tr_b16 v[60:61], v227 offset:8192
    v_mfma_f32_16x16x32_bf16 v[44:47], v[76:79], v[108:111], v[44:47]
    ds_read_b64_tr_b16 v[62:63], v231 offset:8192
    s_waitcnt vmcnt(8) lgkmcnt(8)
    v_mfma_f32_16x16x32_bf16 v[16:19], v[80:83], v[112:115], v[16:19]
    buffer_load_dwordx4 v[104:107], v12, s[52:55], s39 offen offset:1024 sc1
    buffer_load_dwordx4 v[108:111], v15, s[52:55], s39 offen offset:1024 sc1
    v_mfma_f32_16x16x32_bf16 v[20:23], v[84:87], v[112:115], v[20:23]
    ds_read_b64_tr_b16 v[64:65], v224 offset:12288
    v_mfma_f32_16x16x32_bf16 v[24:27], v[88:91], v[112:115], v[24:27]
    ds_read_b64_tr_b16 v[66:67], v228 offset:12288
    v_mfma_f32_16x16x32_bf16 v[28:31], v[92:95], v[112:115], v[28:31]
    ds_read_b64_tr_b16 v[68:69], v225 offset:12288
    v_mfma_f32_16x16x32_bf16 v[32:35], v[80:83], v[116:119], v[32:35]
    ds_read_b64_tr_b16 v[70:71], v229 offset:12288
    ds_read_b64_tr_b16 v[72:73], v226 offset:12288
    v_mfma_f32_16x16x32_bf16 v[36:39], v[84:87], v[116:119], v[36:39]
    ds_read_b64_tr_b16 v[74:75], v230 offset:12288
    v_mfma_f32_16x16x32_bf16 v[40:43], v[88:91], v[116:119], v[40:43]
    ds_read_b64_tr_b16 v[76:77], v227 offset:12288
    v_mfma_f32_16x16x32_bf16 v[44:47], v[92:95], v[116:119], v[44:47]
    ds_read_b64_tr_b16 v[78:79], v231 offset:12288
    s_waitcnt vmcnt(8) lgkmcnt(8)
    v_mfma_f32_16x16x32_bf16 v[16:19], v[48:51], v[120:123], v[16:19]
    buffer_load_dwordx4 v[112:115], v12, s[52:55], s39 offen offset:2048 sc1
    buffer_load_dwordx4 v[116:119], v15, s[52:55], s39 offen offset:2048 sc1
    v_mfma_f32_16x16x32_bf16 v[20:23], v[52:55], v[120:123], v[20:23]
    ds_read_b64_tr_b16 v[80:81], v224 offset:16384
    v_mfma_f32_16x16x32_bf16 v[24:27], v[56:59], v[120:123], v[24:27]
    ds_read_b64_tr_b16 v[82:83], v228 offset:16384
    v_mfma_f32_16x16x32_bf16 v[28:31], v[60:63], v[120:123], v[28:31]
    ds_read_b64_tr_b16 v[84:85], v225 offset:16384
    v_mfma_f32_16x16x32_bf16 v[32:35], v[48:51], v[124:127], v[32:35]
    ds_read_b64_tr_b16 v[86:87], v229 offset:16384
    ds_read_b64_tr_b16 v[88:89], v226 offset:16384
    v_mfma_f32_16x16x32_bf16 v[36:39], v[52:55], v[124:127], v[36:39]
    ds_read_b64_tr_b16 v[90:91], v230 offset:16384
    v_mfma_f32_16x16x32_bf16 v[40:43], v[56:59], v[124:127], v[40:43]
    ds_read_b64_tr_b16 v[92:93], v227 offset:16384
    v_mfma_f32_16x16x32_bf16 v[44:47], v[60:63], v[124:127], v[44:47]
    ds_read_b64_tr_b16 v[94:95], v231 offset:16384
    s_waitcnt vmcnt(8) lgkmcnt(8)
    v_mfma_f32_16x16x32_bf16 v[16:19], v[64:67], v[128:131], v[16:19]
    buffer_load_dwordx4 v[120:123], v12, s[52:55], s39 offen offset:3072 sc1
    buffer_load_dwordx4 v[124:127], v15, s[52:55], s39 offen offset:3072 sc1
    v_mfma_f32_16x16x32_bf16 v[20:23], v[68:71], v[128:131], v[20:23]
    ds_read_b64_tr_b16 v[48:49], v224 offset:20480
    v_mfma_f32_16x16x32_bf16 v[24:27], v[72:75], v[128:131], v[24:27]
    ds_read_b64_tr_b16 v[50:51], v228 offset:20480
    v_mfma_f32_16x16x32_bf16 v[28:31], v[76:79], v[128:131], v[28:31]
    ds_read_b64_tr_b16 v[52:53], v225 offset:20480
    v_mfma_f32_16x16x32_bf16 v[32:35], v[64:67], v[132:135], v[32:35]
    ds_read_b64_tr_b16 v[54:55], v229 offset:20480
    ds_read_b64_tr_b16 v[56:57], v226 offset:20480
    v_mfma_f32_16x16x32_bf16 v[36:39], v[68:71], v[132:135], v[36:39]
    ds_read_b64_tr_b16 v[58:59], v230 offset:20480
    v_mfma_f32_16x16x32_bf16 v[40:43], v[72:75], v[132:135], v[40:43]
    ds_read_b64_tr_b16 v[60:61], v227 offset:20480
    v_mfma_f32_16x16x32_bf16 v[44:47], v[76:79], v[132:135], v[44:47]
    ds_read_b64_tr_b16 v[62:63], v231 offset:20480
    s_waitcnt vmcnt(8) lgkmcnt(8)
    v_mfma_f32_16x16x32_bf16 v[16:19], v[80:83], v[136:139], v[16:19]
    buffer_load_dwordx4 v[128:131], v12, s[52:55], s40 offen offset:0 sc1
    buffer_load_dwordx4 v[132:135], v15, s[52:55], s40 offen offset:0 sc1
    v_mfma_f32_16x16x32_bf16 v[20:23], v[84:87], v[136:139], v[20:23]
    ds_read_b64_tr_b16 v[64:65], v2 offset:0
    v_mfma_f32_16x16x32_bf16 v[24:27], v[88:91], v[136:139], v[24:27]
    ds_read_b64_tr_b16 v[66:67], v6 offset:0
    v_mfma_f32_16x16x32_bf16 v[28:31], v[92:95], v[136:139], v[28:31]
    ds_read_b64_tr_b16 v[68:69], v3 offset:0
    v_mfma_f32_16x16x32_bf16 v[32:35], v[80:83], v[140:143], v[32:35]
    ds_read_b64_tr_b16 v[70:71], v7 offset:0
    ds_read_b64_tr_b16 v[72:73], v4 offset:0
    v_mfma_f32_16x16x32_bf16 v[36:39], v[84:87], v[140:143], v[36:39]
    ds_read_b64_tr_b16 v[74:75], v8 offset:0
    v_mfma_f32_16x16x32_bf16 v[40:43], v[88:91], v[140:143], v[40:43]
    ds_read_b64_tr_b16 v[76:77], v5 offset:0
    v_mfma_f32_16x16x32_bf16 v[44:47], v[92:95], v[140:143], v[44:47]
    ds_read_b64_tr_b16 v[78:79], v9 offset:0
    s_waitcnt vmcnt(8) lgkmcnt(8)
    v_mfma_f32_16x16x32_bf16 v[16:19], v[48:51], v[96:99], v[16:19]
    buffer_load_dwordx4 v[136:139], v12, s[52:55], s40 offen offset:1024 sc1
    buffer_load_dwordx4 v[140:143], v15, s[52:55], s40 offen offset:1024 sc1
    v_mfma_f32_16x16x32_bf16 v[20:23], v[52:55], v[96:99], v[20:23]
    ds_read_b64_tr_b16 v[80:81], v2 offset:4096
    v_mfma_f32_16x16x32_bf16 v[24:27], v[56:59], v[96:99], v[24:27]
    ds_read_b64_tr_b16 v[82:83], v6 offset:4096
    v_mfma_f32_16x16x32_bf16 v[28:31], v[60:63], v[96:99], v[28:31]
    ds_read_b64_tr_b16 v[84:85], v3 offset:4096
    v_mfma_f32_16x16x32_bf16 v[32:35], v[48:51], v[100:103], v[32:35]
    ds_read_b64_tr_b16 v[86:87], v7 offset:4096
    ds_read_b64_tr_b16 v[88:89], v4 offset:4096
    v_mfma_f32_16x16x32_bf16 v[36:39], v[52:55], v[100:103], v[36:39]
    ds_read_b64_tr_b16 v[90:91], v8 offset:4096
    v_mfma_f32_16x16x32_bf16 v[40:43], v[56:59], v[100:103], v[40:43]
    ds_read_b64_tr_b16 v[92:93], v5 offset:4096
    v_mfma_f32_16x16x32_bf16 v[44:47], v[60:63], v[100:103], v[44:47]
    ds_read_b64_tr_b16 v[94:95], v9 offset:4096
    s_waitcnt vmcnt(8) lgkmcnt(8)
    v_mfma_f32_16x16x32_bf16 v[16:19], v[64:67], v[104:107], v[16:19]
    buffer_load_dwordx4 v[96:99], v12, s[52:55], s40 offen offset:2048 sc1
    buffer_load_dwordx4 v[100:103], v15, s[52:55], s40 offen offset:2048 sc1
    v_mfma_f32_16x16x32_bf16 v[20:23], v[68:71], v[104:107], v[20:23]
    ds_read_b64_tr_b16 v[48:49], v2 offset:8192
    v_mfma_f32_16x16x32_bf16 v[24:27], v[72:75], v[104:107], v[24:27]
    ds_read_b64_tr_b16 v[50:51], v6 offset:8192
    v_mfma_f32_16x16x32_bf16 v[28:31], v[76:79], v[104:107], v[28:31]
    ds_read_b64_tr_b16 v[52:53], v3 offset:8192
    v_mfma_f32_16x16x32_bf16 v[32:35], v[64:67], v[108:111], v[32:35]
    ds_read_b64_tr_b16 v[54:55], v7 offset:8192
    ds_read_b64_tr_b16 v[56:57], v4 offset:8192
    v_mfma_f32_16x16x32_bf16 v[36:39], v[68:71], v[108:111], v[36:39]
    ds_read_b64_tr_b16 v[58:59], v8 offset:8192
    v_mfma_f32_16x16x32_bf16 v[40:43], v[72:75], v[108:111], v[40:43]
    ds_read_b64_tr_b16 v[60:61], v5 offset:8192
    v_mfma_f32_16x16x32_bf16 v[44:47], v[76:79], v[108:111], v[44:47]
    ds_read_b64_tr_b16 v[62:63], v9 offset:8192
    s_waitcnt vmcnt(8) lgkmcnt(8)
    v_mfma_f32_16x16x32_bf16 v[16:19], v[80:83], v[112:115], v[16:19]
    buffer_load_dwordx4 v[104:107], v12, s[52:55], s40 offen offset:3072 sc1
    buffer_load_dwordx4 v[108:111], v15, s[52:55], s40 offen offset:3072 sc1
    v_mfma_f32_16x16x32_bf16 v[20:23], v[84:87], v[112:115], v[20:23]
    ds_read_b64_tr_b16 v[64:65], v2 offset:12288
    v_mfma_f32_16x16x32_bf16 v[24:27], v[88:91], v[112:115], v[24:27]
    ds_read_b64_tr_b16 v[66:67], v6 offset:12288
    v_mfma_f32_16x16x32_bf16 v[28:31], v[92:95], v[112:115], v[28:31]
    ds_read_b64_tr_b16 v[68:69], v3 offset:12288
    v_mfma_f32_16x16x32_bf16 v[32:35], v[80:83], v[116:119], v[32:35]
    ds_read_b64_tr_b16 v[70:71], v7 offset:12288
    ds_read_b64_tr_b16 v[72:73], v4 offset:12288
    v_mfma_f32_16x16x32_bf16 v[36:39], v[84:87], v[116:119], v[36:39]
    ds_read_b64_tr_b16 v[74:75], v8 offset:12288
    v_mfma_f32_16x16x32_bf16 v[40:43], v[88:91], v[116:119], v[40:43]
    ds_read_b64_tr_b16 v[76:77], v5 offset:12288
    v_mfma_f32_16x16x32_bf16 v[44:47], v[92:95], v[116:119], v[44:47]
    ds_read_b64_tr_b16 v[78:79], v9 offset:12288
    s_waitcnt vmcnt(8) lgkmcnt(8)
    v_mfma_f32_16x16x32_bf16 v[16:19], v[48:51], v[120:123], v[16:19]
    buffer_load_dwordx4 v[112:115], v12, s[52:55], s41 offen offset:0 sc1
    buffer_load_dwordx4 v[116:119], v15, s[52:55], s41 offen offset:0 sc1
    v_mfma_f32_16x16x32_bf16 v[20:23], v[52:55], v[120:123], v[20:23]
    ds_read_b64_tr_b16 v[80:81], v2 offset:16384
    v_mfma_f32_16x16x32_bf16 v[24:27], v[56:59], v[120:123], v[24:27]
    ds_read_b64_tr_b16 v[82:83], v6 offset:16384
    v_mfma_f32_16x16x32_bf16 v[28:31], v[60:63], v[120:123], v[28:31]
    ds_read_b64_tr_b16 v[84:85], v3 offset:16384
    v_mfma_f32_16x16x32_bf16 v[32:35], v[48:51], v[124:127], v[32:35]
    ds_read_b64_tr_b16 v[86:87], v7 offset:16384
    ds_read_b64_tr_b16 v[88:89], v4 offset:16384
    v_mfma_f32_16x16x32_bf16 v[36:39], v[52:55], v[124:127], v[36:39]
    ds_read_b64_tr_b16 v[90:91], v8 offset:16384
    v_mfma_f32_16x16x32_bf16 v[40:43], v[56:59], v[124:127], v[40:43]
    ds_read_b64_tr_b16 v[92:93], v5 offset:16384
    v_mfma_f32_16x16x32_bf16 v[44:47], v[60:63], v[124:127], v[44:47]
    ds_read_b64_tr_b16 v[94:95], v9 offset:16384
    s_waitcnt vmcnt(8) lgkmcnt(8)
    v_mfma_f32_16x16x32_bf16 v[16:19], v[64:67], v[128:131], v[16:19]
    buffer_load_dwordx4 v[120:123], v12, s[52:55], s41 offen offset:1024 sc1
    buffer_load_dwordx4 v[124:127], v15, s[52:55], s41 offen offset:1024 sc1
    v_mfma_f32_16x16x32_bf16 v[20:23], v[68:71], v[128:131], v[20:23]
    ds_read_b64_tr_b16 v[48:49], v2 offset:20480
    v_mfma_f32_16x16x32_bf16 v[24:27], v[72:75], v[128:131], v[24:27]
    ds_read_b64_tr_b16 v[50:51], v6 offset:20480
    v_mfma_f32_16x16x32_bf16 v[28:31], v[76:79], v[128:131], v[28:31]
    ds_read_b64_tr_b16 v[52:53], v3 offset:20480
    v_mfma_f32_16x16x32_bf16 v[32:35], v[64:67], v[132:135], v[32:35]
    ds_read_b64_tr_b16 v[54:55], v7 offset:20480
    ds_read_b64_tr_b16 v[56:57], v4 offset:20480
    v_mfma_f32_16x16x32_bf16 v[36:39], v[68:71], v[132:135], v[36:39]
    ds_read_b64_tr_b16 v[58:59], v8 offset:20480
    v_mfma_f32_16x16x32_bf16 v[40:43], v[72:75], v[132:135], v[40:43]
    ds_read_b64_tr_b16 v[60:61], v5 offset:20480
    v_mfma_f32_16x16x32_bf16 v[44:47], v[76:79], v[132:135], v[44:47]
    ds_read_b64_tr_b16 v[62:63], v9 offset:20480
    s_waitcnt vmcnt(8) lgkmcnt(8)
    s_mov_b64 exec, 1
    ds_add_u32 v10, v11 offset:28
    s_mov_b64 exec, -1
    v_mfma_f32_16x16x32_bf16 v[16:19], v[80:83], v[136:139], v[16:19]
    buffer_load_dwordx4 v[128:131], v12, s[52:55], s41 offen offset:2048 sc1
    buffer_load_dwordx4 v[132:135], v15, s[52:55], s41 offen offset:2048 sc1
    v_mfma_f32_16x16x32_bf16 v[20:23], v[84:87], v[136:139], v[20:23]
    ds_read_b64_tr_b16 v[64:65], v224 offset:45056
    v_mfma_f32_16x16x32_bf16 v[24:27], v[88:91], v[136:139], v[24:27]
    ds_read_b64_tr_b16 v[66:67], v228 offset:45056
    v_mfma_f32_16x16x32_bf16 v[28:31], v[92:95], v[136:139], v[28:31]
    ds_read_b64_tr_b16 v[68:69], v225 offset:45056
    v_mfma_f32_16x16x32_bf16 v[32:35], v[80:83], v[140:143], v[32:35]
    ds_read_b64_tr_b16 v[70:71], v229 offset:45056
    ds_read_b64_tr_b16 v[72:73], v226 offset:45056
    v_mfma_f32_16x16x32_bf16 v[36:39], v[84:87], v[140:143], v[36:39]
    ds_read_b64_tr_b16 v[74:75], v230 offset:45056
    v_mfma_f32_16x16x32_bf16 v[40:43], v[88:91], v[140:143], v[40:43]
    ds_read_b64_tr_b16 v[76:77], v227 offset:45056
    v_mfma_f32_16x16x32_bf16 v[44:47], v[92:95], v[140:143], v[44:47]
    ds_read_b64_tr_b16 v[78:79], v231 offset:45056
    s_waitcnt vmcnt(8) lgkmcnt(9)
    v_mfma_f32_16x16x32_bf16 v[16:19], v[48:51], v[96:99], v[16:19]
    buffer_load_dwordx4 v[136:139], v12, s[52:55], s41 offen offset:3072 sc1
    buffer_load_dwordx4 v[140:143], v15, s[52:55], s41 offen offset:3072 sc1
    v_mfma_f32_16x16x32_bf16 v[20:23], v[52:55], v[96:99], v[20:23]
    ds_read_b64_tr_b16 v[80:81], v224 offset:49152
    v_mfma_f32_16x16x32_bf16 v[24:27], v[56:59], v[96:99], v[24:27]
    ds_read_b64_tr_b16 v[82:83], v228 offset:49152
    v_mfma_f32_16x16x32_bf16 v[28:31], v[60:63], v[96:99], v[28:31]
    ds_read_b64_tr_b16 v[84:85], v225 offset:49152
    v_mfma_f32_16x16x32_bf16 v[32:35], v[48:51], v[100:103], v[32:35]
    ds_read_b64_tr_b16 v[86:87], v229 offset:49152
    ds_read_b64_tr_b16 v[88:89], v226 offset:49152
    v_mfma_f32_16x16x32_bf16 v[36:39], v[52:55], v[100:103], v[36:39]
    ds_read_b64_tr_b16 v[90:91], v230 offset:49152
    v_mfma_f32_16x16x32_bf16 v[40:43], v[56:59], v[100:103], v[40:43]
    ds_read_b64_tr_b16 v[92:93], v227 offset:49152
    v_mfma_f32_16x16x32_bf16 v[44:47], v[60:63], v[100:103], v[44:47]
    ds_read_b64_tr_b16 v[94:95], v231 offset:49152
    s_waitcnt vmcnt(8) lgkmcnt(8)
    v_mfma_f32_16x16x32_bf16 v[16:19], v[64:67], v[104:107], v[16:19]
    buffer_load_dwordx4 v[96:99], v12, s[52:55], s42 offen offset:0 sc1
    buffer_load_dwordx4 v[100:103], v15, s[52:55], s42 offen offset:0 sc1
    v_mfma_f32_16x16x32_bf16 v[20:23], v[68:71], v[104:107], v[20:23]
    ds_read_b64_tr_b16 v[48:49], v224 offset:53248
    v_mfma_f32_16x16x32_bf16 v[24:27], v[72:75], v[104:107], v[24:27]
    ds_read_b64_tr_b16 v[50:51], v228 offset:53248
    v_mfma_f32_16x16x32_bf16 v[28:31], v[76:79], v[104:107], v[28:31]
    ds_read_b64_tr_b16 v[52:53], v225 offset:53248
    v_mfma_f32_16x16x32_bf16 v[32:35], v[64:67], v[108:111], v[32:35]
    ds_read_b64_tr_b16 v[54:55], v229 offset:53248
    ds_read_b64_tr_b16 v[56:57], v226 offset:53248
    v_mfma_f32_16x16x32_bf16 v[36:39], v[68:71], v[108:111], v[36:39]
    ds_read_b64_tr_b16 v[58:59], v230 offset:53248
    v_mfma_f32_16x16x32_bf16 v[40:43], v[72:75], v[108:111], v[40:43]
    ds_read_b64_tr_b16 v[60:61], v227 offset:53248
    v_mfma_f32_16x16x32_bf16 v[44:47], v[76:79], v[108:111], v[44:47]
    ds_read_b64_tr_b16 v[62:63], v231 offset:53248
    s_waitcnt vmcnt(8) lgkmcnt(8)
    v_mfma_f32_16x16x32_bf16 v[16:19], v[80:83], v[112:115], v[16:19]
    buffer_load_dwordx4 v[104:107], v12, s[52:55], s42 offen offset:1024 sc1
    buffer_load_dwordx4 v[108:111], v15, s[52:55], s42 offen offset:1024 sc1
    v_mfma_f32_16x16x32_bf16 v[20:23], v[84:87], v[112:115], v[20:23]
    ds_read_b64_tr_b16 v[64:65], v224 offset:57344
    v_mfma_f32_16x16x32_bf16 v[24:27], v[88:91], v[112:115], v[24:27]
    ds_read_b64_tr_b16 v[66:67], v228 offset:57344
    v_mfma_f32_16x16x32_bf16 v[28:31], v[92:95], v[112:115], v[28:31]
    ds_read_b64_tr_b16 v[68:69], v225 offset:57344
    v_mfma_f32_16x16x32_bf16 v[32:35], v[80:83], v[116:119], v[32:35]
    ds_read_b64_tr_b16 v[70:71], v229 offset:57344
    ds_read_b64_tr_b16 v[72:73], v226 offset:57344
    v_mfma_f32_16x16x32_bf16 v[36:39], v[84:87], v[116:119], v[36:39]
    ds_read_b64_tr_b16 v[74:75], v230 offset:57344
    v_mfma_f32_16x16x32_bf16 v[40:43], v[88:91], v[116:119], v[40:43]
    ds_read_b64_tr_b16 v[76:77], v227 offset:57344
    v_mfma_f32_16x16x32_bf16 v[44:47], v[92:95], v[116:119], v[44:47]
    ds_read_b64_tr_b16 v[78:79], v231 offset:57344
    s_waitcnt vmcnt(8) lgkmcnt(8)
    v_mfma_f32_16x16x32_bf16 v[16:19], v[48:51], v[120:123], v[16:19]
    buffer_load_dwordx4 v[112:115], v12, s[52:55], s42 offen offset:2048 sc1
    buffer_load_dwordx4 v[116:119], v15, s[52:55], s42 offen offset:2048 sc1
    v_mfma_f32_16x16x32_bf16 v[20:23], v[52:55], v[120:123], v[20:23]
    ds_read_b64_tr_b16 v[80:81], v2 offset:24576
    v_mfma_f32_16x16x32_bf16 v[24:27], v[56:59], v[120:123], v[24:27]
    ds_read_b64_tr_b16 v[82:83], v6 offset:24576
    v_mfma_f32_16x16x32_bf16 v[28:31], v[60:63], v[120:123], v[28:31]
    ds_read_b64_tr_b16 v[84:85], v3 offset:24576
    v_mfma_f32_16x16x32_bf16 v[32:35], v[48:51], v[124:127], v[32:35]
    ds_read_b64_tr_b16 v[86:87], v7 offset:24576
    ds_read_b64_tr_b16 v[88:89], v4 offset:24576
    v_mfma_f32_16x16x32_bf16 v[36:39], v[52:55], v[124:127], v[36:39]
    ds_read_b64_tr_b16 v[90:91], v8 offset:24576
    v_mfma_f32_16x16x32_bf16 v[40:43], v[56:59], v[124:127], v[40:43]
    ds_read_b64_tr_b16 v[92:93], v5 offset:24576
    v_mfma_f32_16x16x32_bf16 v[44:47], v[60:63], v[124:127], v[44:47]
    ds_read_b64_tr_b16 v[94:95], v9 offset:24576
    s_waitcnt vmcnt(8) lgkmcnt(8)
    v_mfma_f32_16x16x32_bf16 v[16:19], v[64:67], v[128:131], v[16:19]
    buffer_load_dwordx4 v[120:123], v12, s[52:55], s42 offen offset:3072 sc1
    buffer_load_dwordx4 v[124:127], v15, s[52:55], s42 offen offset:3072 sc1
    v_mfma_f32_16x16x32_bf16 v[20:23], v[68:71], v[128:131], v[20:23]
    ds_read_b64_tr_b16 v[48:49], v2 offset:28672
    v_mfma_f32_16x16x32_bf16 v[24:27], v[72:75], v[128:131], v[24:27]
    ds_read_b64_tr_b16 v[50:51], v6 offset:28672
    v_mfma_f32_16x16x32_bf16 v[28:31], v[76:79], v[128:131], v[28:31]
    ds_read_b64_tr_b16 v[52:53], v3 offset:28672
    v_mfma_f32_16x16x32_bf16 v[32:35], v[64:67], v[132:135], v[32:35]
    ds_read_b64_tr_b16 v[54:55], v7 offset:28672
    ds_read_b64_tr_b16 v[56:57], v4 offset:28672
    v_mfma_f32_16x16x32_bf16 v[36:39], v[68:71], v[132:135], v[36:39]
    ds_read_b64_tr_b16 v[58:59], v8 offset:28672
    v_mfma_f32_16x16x32_bf16 v[40:43], v[72:75], v[132:135], v[40:43]
    ds_read_b64_tr_b16 v[60:61], v5 offset:28672
    v_mfma_f32_16x16x32_bf16 v[44:47], v[76:79], v[132:135], v[44:47]
    ds_read_b64_tr_b16 v[62:63], v9 offset:28672
    s_waitcnt vmcnt(8) lgkmcnt(8)
    v_mfma_f32_16x16x32_bf16 v[16:19], v[80:83], v[136:139], v[16:19]
    buffer_load_dwordx4 v[128:131], v12, s[52:55], s43 offen offset:0 sc1
    buffer_load_dwordx4 v[132:135], v15, s[52:55], s43 offen offset:0 sc1
    v_mfma_f32_16x16x32_bf16 v[20:23], v[84:87], v[136:139], v[20:23]
    ds_read_b32 v223, v10 offset:32
    v_mfma_f32_16x16x32_bf16 v[24:27], v[88:91], v[136:139], v[24:27]
    ds_read_b64_tr_b16 v[64:65], v2 offset:32768
    ds_read_b64_tr_b16 v[66:67], v6 offset:32768
    v_mfma_f32_16x16x32_bf16 v[28:31], v[92:95], v[136:139], v[28:31]
    ds_read_b64_tr_b16 v[68:69], v3 offset:32768
    v_mfma_f32_16x16x32_bf16 v[32:35], v[80:83], v[140:143], v[32:35]
    ds_read_b64_tr_b16 v[70:71], v7 offset:32768
    v_mfma_f32_16x16x32_bf16 v[36:39], v[84:87], v[140:143], v[36:39]
    ds_read_b64_tr_b16 v[72:73], v4 offset:32768
    ds_read_b64_tr_b16 v[74:75], v8 offset:32768
    v_mfma_f32_16x16x32_bf16 v[40:43], v[88:91], v[140:143], v[40:43]
    ds_read_b64_tr_b16 v[76:77], v5 offset:32768
    v_mfma_f32_16x16x32_bf16 v[44:47], v[92:95], v[140:143], v[44:47]
    ds_read_b64_tr_b16 v[78:79], v9 offset:32768
    s_waitcnt vmcnt(8) lgkmcnt(9)
    s_waitcnt lgkmcnt(8)
    v_cmp_gt_u32 vcc, 4, v223
    s_cbranch_vccnz LB_w8
LB_g8:
    v_mfma_f32_16x16x32_bf16 v[16:19], v[48:51], v[96:99], v[16:19]
    buffer_load_dwordx4 v[136:139], v12, s[52:55], s43 offen offset:1024 sc1
    buffer_load_dwordx4 v[140:143], v15, s[52:55], s43 offen offset:1024 sc1
    v_add_u32 v2, 129024, v2
    v_mfma_f32_16x16x32_bf16 v[20:23], v[52:55], v[96:99], v[20:23]
    ds_read_b64_tr_b16 v[80:81], v2 offset:0
    v_add_u32 v6, 129024, v6
    v_mfma_f32_16x16x32_bf16 v[24:27], v[56:59], v[96:99], v[24:27]
    ds_read_b64_tr_b16 v[82:83], v6 offset:0
    v_add_u32 v3, 129024, v3
    v_mfma_f32_16x16x32_bf16 v[28:31], v[60:63], v[96:99], v[28:31]
    ds_read_b64_tr_b16 v[84:85], v3 offset:0
    v_add_u32 v7, 129024, v7
    v_mfma_f32_16x16x32_bf16 v[32:35], v[48:51], v[100:103], v[32:35]
    ds_read_b64_tr_b16 v[86:87], v7 offset:0
    v_add_u32 v4, 129024, v4
    ds_read_b64_tr_b16 v[88:89], v4 offset:0
    v_mfma_f32_16x16x32_bf16 v[36:39], v[52:55], v[100:103], v[36:39]
    v_add_u32 v8, 129024, v8
    ds_read_b64_tr_b16 v[90:91], v8 offset:0
    v_mfma_f32_16x16x32_bf16 v[40:43], v[56:59], v[100:103], v[40:43]
    v_add_u32 v5, 129024, v5
    ds_read_b64_tr_b16 v[92:93], v5 offset:0
    v_mfma_f32_16x16x32_bf16 v[44:47], v[60:63], v[100:103], v[44:47]
    v_add_u32 v9, 129024, v9
    ds_read_b64_tr_b16 v[94:95], v9 offset:0
    s_waitcnt vmcnt(8) lgkmcnt(8)
    v_mfma_f32_16x16x32_bf16 v[16:19], v[64:67], v[104:107], v[16:19]
    buffer_load_dwordx4 v[96:99], v12, s[52:55], s43 offen offset:2048 sc1
    buffer_load_dwordx4 v[100:103], v15, s[52:55], s43 offen offset:2048 sc1
    v_mfma_f32_16x16x32_bf16 v[20:23], v[68:71], v[104:107], v[20:23]
    ds_read_b64_tr_b16 v[48:49], v2 offset:4096
    v_mfma_f32_16x16x32_bf16 v[24:27], v[72:75], v[104:107], v[24:27]
    ds_read_b64_tr_b16 v[50:51], v6 offset:4096
    v_mfma_f32_16x16x32_bf16 v[28:31], v[76:79], v[104:107], v[28:31]
    ds_read_b64_tr_b16 v[52:53], v3 offset:4096
    v_mfma_f32_16x16x32_bf16 v[32:35], v[64:67], v[108:111], v[32:35]
    ds_read_b64_tr_b16 v[54:55], v7 offset:4096
    ds_read_b64_tr_b16 v[56:57], v4 offset:4096
    v_mfma_f32_16x16x32_bf16 v[36:39], v[68:71], v[108:111], v[36:39]
    ds_read_b64_tr_b16 v[58:59], v8 offset:4096
    v_mfma_f32_16x16x32_bf16 v[40:43], v[72:75], v[108:111], v[40:43]
    ds_read_b64_tr_b16 v[60:61], v5 offset:4096
    v_mfma_f32_16x16x32_bf16 v[44:47], v[76:79], v[108:111], v[44:47]
    ds_read_b64_tr_b16 v[62:63], v9 offset:4096
    s_waitcnt vmcnt(8) lgkmcnt(8)
    v_mfma_f32_16x16x32_bf16 v[16:19], v[80:83], v[112:115], v[16:19]
    buffer_load_dwordx4 v[104:107], v12, s[52:55], s43 offen offset:3072 sc1
    buffer_load_dwordx4 v[108:111], v15, s[52:55], s43 offen offset:3072 sc1
    v_mfma_f32_16x16x32_bf16 v[20:23], v[84:87], v[112:115], v[20:23]
    ds_read_b64_tr_b16 v[64:65], v2 offset:8192
    v_mfma_f32_16x16x32_bf16 v[24:27], v[88:91], v[112:115], v[24:27]
    ds_read_b64_tr_b16 v[66:67], v6 offset:8192
    v_mfma_f32_16x16x32_bf16 v[28:31], v[92:95], v[112:115], v[28:31]
    ds_read_b64_tr_b16 v[68:69], v3 offset:8192
    v_mfma_f32_16x16x32_bf16 v[32:35], v[80:83], v[116:119], v[32:35]
    ds_read_b64_tr_b16 v[70:71], v7 offset:8192
    ds_read_b64_tr_b16 v[72:73], v4 offset:8192
    v_mfma_f32_16x16x32_bf16 v[36:39], v[84:87], v[116:119], v[36:39]
    ds_read_b64_tr_b16 v[74:75], v8 offset:8192
    v_mfma_f32_16x16x32_bf16 v[40:43], v[88:91], v[116:119], v[40:43]
    ds_read_b64_tr_b16 v[76:77], v5 offset:8192
    v_mfma_f32_16x16x32_bf16 v[44:47], v[92:95], v[116:119], v[44:47]
    ds_read_b64_tr_b16 v[78:79], v9 offset:8192
    s_waitcnt vmcnt(8) lgkmcnt(8)
    v_mfma_f32_16x16x32_bf16 v[16:19], v[48:51], v[120:123], v[16:19]
    ds_read_b64_tr_b16 v[80:81], v2 offset:12288
    v_mfma_f32_16x16x32_bf16 v[20:23], v[52:55], v[120:123], v[20:23]
    ds_read_b64_tr_b16 v[82:83], v6 offset:12288
    v_mfma_f32_16x16x32_bf16 v[24:27], v[56:59], v[120:123], v[24:27]
    ds_read_b64_tr_b16 v[84:85], v3 offset:12288
    v_mfma_f32_16x16x32_bf16 v[28:31], v[60:63], v[120:123], v[28:31]
    ds_read_b64_tr_b16 v[86:87], v7 offset:12288
    v_mfma_f32_16x16x32_bf16 v[32:35], v[48:51], v[124:127], v[32:35]
    ds_read_b64_tr_b16 v[88:89], v4 offset:12288
    v_mfma_f32_16x16x32_bf16 v[36:39], v[52:55], v[124:127], v[36:39]
    ds_read_b64_tr_b16 v[90:91], v8 offset:12288
    v_mfma_f32_16x16x32_bf16 v[40:43], v[56:59], v[124:127], v[40:43]
    ds_read_b64_tr_b16 v[92:93], v5 offset:12288
    v_mfma_f32_16x16x32_bf16 v[44:47], v[60:63], v[124:127], v[44:47]
    ds_read_b64_tr_b16 v[94:95], v9 offset:12288
    s_waitcnt vmcnt(6) lgkmcnt(8)
    v_mfma_f32_16x16x32_bf16 v[16:19], v[64:67], v[128:131], v[16:19]
    ds_read_b64_tr_b16 v[48:49], v2 offset:16384
    v_mfma_f32_16x16x32_bf16 v[20:23], v[68:71], v[128:131], v[20:23]
    ds_read_b64_tr_b16 v[50:51], v6 offset:16384
    v_mfma_f32_16x16x32_bf16 v[24:27], v[72:75], v[128:131], v[24:27]
    ds_read_b64_tr_b16 v[52:53], v3 offset:16384
    v_mfma_f32_16x16x32_bf16 v[28:31], v[76:79], v[128:131], v[28:31]
    ds_read_b64_tr_b16 v[54:55], v7 offset:16384
    v_mfma_f32_16x16x32_bf16 v[32:35], v[64:67], v[132:135], v[32:35]
    ds_read_b64_tr_b16 v[56:57], v4 offset:16384
    v_mfma_f32_16x16x32_bf16 v[36:39], v[68:71], v[132:135], v[36:39]
    ds_read_b64_tr_b16 v[58:59], v8 offset:16384
    v_mfma_f32_16x16x32_bf16 v[40:43], v[72:75], v[132:135], v[40:43]
    ds_read_b64_tr_b16 v[60:61], v5 offset:16384
    v_mfma_f32_16x16x32_bf16 v[44:47], v[76:79], v[132:135], v[44:47]
    ds_read_b64_tr_b16 v[62:63], v9 offset:16384
    s_waitcnt vmcnt(4) lgkmcnt(8)
    v_mfma_f32_16x16x32_bf16 v[16:19], v[80:83], v[136:139], v[16:19]
    ds_read_b64_tr_b16 v[64:65], v2 offset:20480
    v_mfma_f32_16x16x32_bf16 v[20:23], v[84:87], v[136:139], v[20:23]
    ds_read_b64_tr_b16 v[66:67], v6 offset:20480
    v_mfma_f32_16x16x32_bf16 v[24:27], v[88:91], v[136:139], v[24:27]
    ds_read_b64_tr_b16 v[68:69], v3 offset:20480
    v_mfma_f32_16x16x32_bf16 v[28:31], v[92:95], v[136:139], v[28:31]
    ds_read_b64_tr_b16 v[70:71], v7 offset:20480
    v_mfma_f32_16x16x32_bf16 v[32:35], v[80:83], v[140:143], v[32:35]
    ds_read_b64_tr_b16 v[72:73], v4 offset:20480
    v_mfma_f32_16x16x32_bf16 v[36:39], v[84:87], v[140:143], v[36:39]
    ds_read_b64_tr_b16 v[74:75], v8 offset:20480
    v_mfma_f32_16x16x32_bf16 v[40:43], v[88:91], v[140:143], v[40:43]
    ds_read_b64_tr_b16 v[76:77], v5 offset:20480
    v_mfma_f32_16x16x32_bf16 v[44:47], v[92:95], v[140:143], v[44:47]
    ds_read_b64_tr_b16 v[78:79], v9 offset:20480
    s_waitcnt vmcnt(2) lgkmcnt(8)
    v_mfma_f32_16x16x32_bf16 v[16:19], v[48:51], v[96:99], v[16:19]
    ds_read_b32 v223, v10 offset:28
    v_mfma_f32_16x16x32_bf16 v[20:23], v[52:55], v[96:99], v[20:23]
    v_mfma_f32_16x16x32_bf16 v[24:27], v[56:59], v[96:99], v[24:27]
    v_mfma_f32_16x16x32_bf16 v[28:31], v[60:63], v[96:99], v[28:31]
    v_mfma_f32_16x16x32_bf16 v[32:35], v[48:51], v[100:103], v[32:35]
    v_mfma_f32_16x16x32_bf16 v[36:39], v[52:55], v[100:103], v[36:39]
    v_mfma_f32_16x16x32_bf16 v[40:43], v[56:59], v[100:103], v[40:43]
    v_mfma_f32_16x16x32_bf16 v[44:47], v[60:63], v[100:103], v[44:47]
    s_waitcnt vmcnt(0) lgkmcnt(1)
    v_mfma_f32_16x16x32_bf16 v[16:19], v[64:67], v[104:107], v[16:19]
    v_mfma_f32_16x16x32_bf16 v[20:23], v[68:71], v[104:107], v[20:23]
    v_mfma_f32_16x16x32_bf16 v[24:27], v[72:75], v[104:107], v[24:27]
    v_mfma_f32_16x16x32_bf16 v[28:31], v[76:79], v[104:107], v[28:31]
    v_mfma_f32_16x16x32_bf16 v[32:35], v[64:67], v[108:111], v[32:35]
    v_mfma_f32_16x16x32_bf16 v[36:39], v[68:71], v[108:111], v[36:39]
    v_mfma_f32_16x16x32_bf16 v[40:43], v[72:75], v[108:111], v[40:43]
    v_mfma_f32_16x16x32_bf16 v[44:47], v[76:79], v[108:111], v[44:47]
    s_waitcnt lgkmcnt(0)
    v_cmp_gt_u32 vcc, 4, v223
    s_cbranch_vccnz LB_w7
LB_g7:
    v_cvt_pk_bf16_f32 v176, v16, v17
    v_cvt_pk_bf16_f32 v177, v18, v19
    v_cvt_pk_bf16_f32 v178, v20, v21
    v_cvt_pk_bf16_f32 v179, v22, v23
    s_nop 0
    v_permlane16_swap_b32 v176, v178
    v_permlane16_swap_b32 v177, v179
    ds_write_b128 v248, v[176:179] offset:0
    v_cvt_pk_bf16_f32 v180, v24, v25
    v_cvt_pk_bf16_f32 v181, v26, v27
    v_cvt_pk_bf16_f32 v182, v28, v29
    v_cvt_pk_bf16_f32 v183, v30, v31
    s_nop 0
    v_permlane16_swap_b32 v180, v182
    v_permlane16_swap_b32 v181, v183
    ds_write_b128 v249, v[180:183] offset:0
    ds_read_b128 v[192:195], v250 offset:0
    ds_read_b128 v[196:199], v250 offset:1024
    v_cvt_pk_bf16_f32 v184, v32, v33
    v_cvt_pk_bf16_f32 v185, v34, v35
    v_cvt_pk_bf16_f32 v186, v36, v37
    v_cvt_pk_bf16_f32 v187, v38, v39
    s_nop 0
    v_permlane16_swap_b32 v184, v186
    v_permlane16_swap_b32 v185, v187
    ds_write_b128 v248, v[184:187] offset:2048
    v_cvt_pk_bf16_f32 v188, v40, v41
    v_cvt_pk_bf16_f32 v189, v42, v43
    v_cvt_pk_bf16_f32 v190, v44, v45
    v_cvt_pk_bf16_f32 v191, v46, v47
    s_nop 0
    v_permlane16_swap_b32 v188, v190
    v_permlane16_swap_b32 v189, v191
    ds_write_b128 v249, v[188:191] offset:2048
    ds_read_b128 v[200:203], v250 offset:2048
    ds_read_b128 v[204:207], v250 offset:3072
    s_mov_b32 s95, 0
    s_waitcnt lgkmcnt(5)
    buffer_store_dwordx4 v[192:195], v246, s[60:63], s95 offen nt
    s_mov_b32 s95, 32768
    s_waitcnt lgkmcnt(4)
    buffer_store_dwordx4 v[196:199], v246, s[60:63], s95 offen nt
    s_mov_b32 s95, 65536
    s_waitcnt lgkmcnt(1)
    buffer_store_dwordx4 v[200:203], v246, s[60:63], s95 offen nt
    s_mov_b32 s95, 98304
    s_waitcnt lgkmcnt(0)
    buffer_store_dwordx4 v[204:207], v246, s[60:63], s95 offen nt
    s_endpgm
LA_slow:
    s_mov_b32 s79, 0
LA_slow1:
    s_mov_b64 exec, vcc
    s_sleep 8
    buffer_load_dword v136, v33, s[68:71], 0 offen sc1
    buffer_load_dword v137, v34, s[52:55], 0 offen sc1
    s_add_u32 s79, s79, 1
    s_cmp_gt_u32 s79, 200000
    s_waitcnt vmcnt(0)
    s_cbranch_scc1 LA_back
    v_cmp_ne_u32 vcc, v136, v137
    v_cmp_gt_u32 s[80:81], s96, v136
    s_nop 0
    s_or_b64 vcc, vcc, s[80:81]
    s_cbranch_vccnz LA_slow1
    s_branch LA_back
LB_tag:
    s_mov_b64 exec, 0xffff
    s_waitcnt vmcnt(0)
    v_lshrrev_b32 v251, v0, v251
    v_and_b32 v251, 1, v251
    v_cmp_eq_u32 vcc, 0, v251
    s_nop 1
    s_or_b32 s83, vcc_lo, 0x10000
    s_mov_b64 exec, 1
    v_mov_b32 v251, s83
    buffer_store_dword v251, v220, s[68:71], s98 offen sc1
    s_mov_b64 exec, -1
    s_branch LB_tagb
LB_slow:
    s_mov_b32 s79, 0
LB_pt:
    buffer_load_dword v222, v220, s[68:71], s98 offen sc1
    s_add_u32 s79, s79, 1
    s_cmp_gt_u32 s79, 200000
    s_cbranch_scc1 LB_pt_x
    s_waitcnt vmcnt(0)
    v_cmp_gt_u32 vcc, 4096, v222
    s_cbranch_vccz LB_pt_x
    s_mov_b64 exec, vcc
    s_sleep 8
    s_branch LB_pt
LB_pt_x:
    s_waitcnt vmcnt(0)
    s_branch LB_back
LB_w15:
    s_branch LB_s6_in
LB_s6:
    s_sleep 1
LB_s6_in:
    ds_read_b32 v223, v10 offset:24
    s_waitcnt lgkmcnt(0)
    v_readfirstlane_b32 s78, v223
    s_nop 0
    s_cmp_ge_u32 s78, 4
    s_cbranch_scc0 LB_s6
    s_branch LB_g15
LB_w4:
    s_branch LB_s4_in
LB_s4:
    s_sleep 1
LB_s4_in:
    ds_read_b32 v222, v10 offset:16
    s_waitcnt lgkmcnt(0)
    v_readfirstlane_b32 s78, v222
    s_nop 0
    s_cmp_ge_u32 s78, 4
    s_cbranch_scc0 LB_s4
    s_branch LB_g4
LB_w8:
    s_branch LB_s8_in
LB_s8:
    s_sleep 1
LB_s8_in:
    ds_read_b32 v223, v10 offset:32
    s_waitcnt lgkmcnt(0)
    v_readfirstlane_b32 s78, v223
    s_nop 0
    s_cmp_ge_u32 s78, 4
    s_cbranch_scc0 LB_s8
    s_branch LB_g8
LB_w7:
    s_branch LB_s7_in
LB_s7:
    s_sleep 1
LB_s7_in:
    ds_read_b32 v223, v10 offset:28
    s_waitcnt lgkmcnt(0)
    v_readfirstlane_b32 s78, v223
    s_nop 0
    s_cmp_ge_u32 s78, 4
    s_cbranch_scc0 LB_s7
    s_branch LB_g7
L_end:
    s_endpgm
.section .rodata,"a"
.p2align 6
.amdhsa_kernel concat_heads__ssm_conv_h3__sliding_local_dilated__prompt_kernel
  .amdhsa_next_free_vgpr 256
  .amdhsa_next_free_sgpr 102
  .amdhsa_accum_offset 256
  .amdhsa_group_segment_fixed_size 0
  .amdhsa_kernarg_size 96
  .amdhsa_user_sgpr_count 2
  .amdhsa_user_sgpr_kernarg_segment_ptr 1
  .amdhsa_system_sgpr_workgroup_id_x 1
.end_amdhsa_kernel
```

```asm
; @launch grid=(256,1,1) block=(512,1,1) lds=163840
.amdgcn_target "amdgcn-amd-amdhsa--gfx950"
.text
.globl concat_heads__ssm_conv_h3__sliding_local_dilated__prompt_kernel
.p2align 8
.type concat_heads__ssm_conv_h3__sliding_local_dilated__prompt_kernel,@function
concat_heads__ssm_conv_h3__sliding_local_dilated__prompt_kernel:
    s_cmp_ge_u32 s2, 256
    s_cbranch_scc1 L_end
    s_load_dwordx2 s[28:29], s[0:1], 48
    s_load_dwordx2 s[32:33], s[0:1], 56
    s_load_dwordx8 s[4:11], s[0:1], 0
    s_load_dwordx4 s[12:15], s[0:1], 32
    s_load_dwordx8 s[20:27], s[0:1], 64
    v_lshrrev_b32 v1, 6, v0
    v_and_b32 v0, 63, v0
    v_readfirstlane_b32 s3, v1
    s_nop 0
    s_cmp_lg_u32 s3, 4
    s_cbranch_scc1 L_nopf
    s_getpc_b64 s[80:81]
L_pc:
    s_bfe_u32 s78, s2, 0x40003
    v_lshl_add_u32 v1, v0, 4, s78
    v_lshlrev_b32 v1, 7, v1
    v_cmp_gt_u32 vcc, L_end-L_pc, v1
    s_nop 0
    s_and_saveexec_b64 s[82:83], vcc
    global_load_dword v222, v1, s[80:81]
    s_mov_b64 exec, -1
L_nopf:
    s_and_b32 s78, s2, 7
    s_lshr_b32 s79, s2, 3
    s_lshl_b32 s78, s78, 2
    s_lshr_b32 s78, 0x76325410, s78
    s_and_b32 s78, s78, 7
    s_and_b32 s80, s78, 1
    s_lshl_b32 s80, s80, 3
    s_lshr_b32 s81, s78, 1
    s_lshl_b32 s81, s81, 2
    s_and_b32 s72, s79, 7
    s_add_u32 s72, s72, s80
    s_lshr_b32 s73, s79, 3
    s_xor_b32 s73, s73, 3
    s_add_u32 s73, s73, s81
    s_cmp_ge_u32 s3, 4
    s_cbranch_scc1 L_B
    v_lshrrev_b32 v5, 3, v0
    v_and_b32 v6, 7, v0
    v_lshrrev_b32 v7, 4, v0
    s_lshl_b32 s79, s72, 7
    s_lshl_b32 s80, s3, 5
    s_add_u32 s81, s79, s80
    v_xor_b32 v8, v7, v6
    v_lshlrev_b32 v8, 4, v8
    v_add_u32 v240, s81, v5
    v_lshl_add_u32 v240, v240, 11, v8
    v_xor_b32 v241, 64, v240
    v_add_u32 v241, 15360, v241
    v_add_u32 v242, 30720, v240
    v_add_u32 v243, 30720, v241
    s_lshl_b32 s87, s3, 12
    s_add_u32 s87, s87, 75776
    s_and_b32 s98, s73, 12
    s_and_b32 s78, s72, 8
    s_add_u32 s98, s98, s78
    s_add_u32 s101, s72, s73
    s_and_b32 s101, s101, 3
    s_lshl_b32 s78, s101, 2
    s_lshr_b32 s97, 0x101, s78
    s_add_u32 s97, s97, s98
    s_and_b32 s97, s97, 15
    s_lshr_b32 s99, s97, 3
    s_xor_b32 s97, s97, s99
    s_mov_b32 m0, s87
    s_lshl_b32 s97, s97, 7
    s_mov_b32 s30, 0x400000
    s_mov_b32 s31, 0x20000
    s_waitcnt lgkmcnt(0)
    buffer_load_dwordx4 v240, s[28:31], s97 offen offset:0  lds
    s_and_b32 s78, s3, 1
    s_lshl_b32 s78, s78, 2
    s_lshl_b32 s80, s3, 3
    v_and_b32 v8, 1, v7
    v_lshl_or_b32 v8, v8, 1, s78
    v_xor_b32 v8, v8, v6
    buffer_load_dwordx4 v241, s[28:31], s97 offen offset:1024  lds
    v_lshlrev_b32 v8, 4, v8
    v_add_u32 v244, s80, v5
    v_mul_u32_u24 v244, 6144, v244
    s_lshl_b32 s82, s73, 7
    v_add3_u32 v244, v244, v8, s82
    buffer_load_dwordx4 v242, s[28:31], s97 offen offset:2048  lds
    v_add_u32 v245, 1024, v244
    v_add_u32 v246, 2048, v244
    s_bfe_u32 s62, s72, 0x10002
    s_mul_i32 s78, s62, 12288
    s_mul_i32 s80, s3, 3072
    s_add_u32 s60, s80, s78
    buffer_load_dwordx4 v243, s[28:31], s97 offen offset:3072  lds
    s_sub_u32 s61, s80, s78
    s_mul_i32 s62, s62, 196608
    s_sub_u32 s63, 196608, s62
    s_mov_b32 s34, 0x600000
    s_mov_b32 s35, 0x20000
    s_mul_i32 s16, s97, 3072
    s_add_u32 m0, s60, 0
    s_add_u32 s99, s16, s62
    buffer_load_dwordx4 v244, s[32:35], s99 offen offset:0  lds
    s_lshl_b32 s78, s3, 1
    s_lshl_b32 s80, s3, 2
    s_add_u32 s79, s79, s80
    s_sub_u32 s79, s79, 16
    v_add_u32 v8, s78, v7
    buffer_load_dwordx4 v245, s[32:35], s99 offen offset:1024  lds
    v_xor_b32 v8, v8, v6
    v_and_b32 v8, 7, v8
    v_lshlrev_b32 v8, 4, v8
    v_add_u32 v3, s79, v5
    buffer_load_dwordx4 v246, s[32:35], s99 offen offset:2048  lds
    v_lshl_add_u32 v3, v3, 11, v8
    s_lshl_b32 s86, s3, 10
    s_lshl_b32 s88, s3, 9
    s_add_u32 s88, s88, 73728
    s_add_u32 m0, s88, 0
    s_mov_b64 exec, 0xffffffff
    buffer_load_dwordx4 v3, s[28:31], s97 offen offset:0  lds
    s_mov_b64 exec, -1
    s_add_u32 m0, s61, 12288
    s_add_u32 s16, s16, s63
    buffer_load_dwordx4 v244, s[32:35], s16 offen offset:0  lds
    buffer_load_dwordx4 v245, s[32:35], s16 offen offset:1024  lds
    buffer_load_dwordx4 v246, s[32:35], s16 offen offset:2048  lds
    s_mov_b32 s0, 0x76583240
    s_mov_b32 s1, 0xfedba9c
    s_cmp_eq_u32 s101, 1
    s_cselect_b32 s0, 0x76943251, s0
    s_cselect_b32 s1, 0xfecbad8, s1
    s_cmp_eq_u32 s101, 2
    s_cselect_b32 s0, 0x7a543620, s0
    s_cselect_b32 s1, 0xfdcbe98, s1
    s_cmp_eq_u32 s101, 3
    s_cselect_b32 s0, 0xb6547231, s0
    s_cselect_b32 s1, 0xedcfa98, s1
    s_and_b32 s78, s73, 7
    s_cmp_lg_u32 s78, 3
    s_cbranch_scc1 LA_nb
    s_cmp_eq_u32 s101, 2
    s_cselect_b32 s0, 0x87654320, s0
    s_cselect_b32 s1, 0xfdcbea9, s1
    s_cmp_eq_u32 s101, 3
    s_cselect_b32 s0, 0x87654231, s0
    s_cselect_b32 s1, 0xedcfba9, s1
LA_nb:
    s_lshr_b32 s78, s2, 3
    s_and_b32 s76, s78, 3
    s_and_b32 s79, s73, 12
    s_add_u32 s76, s76, s79
    s_lshr_b32 s74, s78, 4
    s_add_u32 s74, s74, s79
    s_and_b32 s79, s72, 8
    s_lshr_b32 s77, s78, 2
    s_add_u32 s77, s77, s79
    s_lshr_b32 s79, s79, 2
    s_add_u32 s74, s74, s79
    s_xor_b32 s74, s74, 4
    s_and_b32 s75, s78, 15
    s_add_u32 s97, s98, s0
    s_lshr_b64 s[0:1], s[0:1], 4
    s_and_b32 s97, s97, 15
    s_lshr_b32 s99, s97, 3
    s_xor_b32 s97, s97, s99
    s_add_u32 m0, s87, 18432
    s_lshl_b32 s97, s97, 7
    buffer_load_dwordx4 v240, s[28:31], s97 offen offset:0  lds
    s_mov_b32 s36, s6
    s_mov_b32 s37, s7
    s_mov_b32 s38, 0x400000
    s_mov_b32 s39, 0x20000
    s_mov_b32 s40, s8
    s_mov_b32 s41, s9
    s_mov_b32 s42, 0x400000
    s_mov_b32 s43, 0x20000
    s_mov_b32 s44, s10
    s_mov_b32 s45, s11
    s_mov_b32 s46, 0x2000
    s_mov_b32 s47, 0x20000
    v_lshlrev_b32 v15, 4, v0
    v_and_b32 v7, 7, v0
    s_lshl_b32 s79, s74, 7
    v_lshl_add_u32 v7, v7, 4, s79
    s_lshl_b32 s78, s75, 7
    s_lshl_b32 s80, s3, 3
    s_add_u32 s80, s80, s78
    v_lshrrev_b32 v5, 3, v0
    s_and_b32 s79, s3, 1
    v_xor_b32 v5, s79, v5
    v_add_u32 v5, s80, v5
    v_lshl_add_u32 v10, v5, 11, v7
    s_xor_b32 s80, s3, 1
    s_add_u32 s80, s78, s80
    s_sub_u32 s80, s80, 4
    s_lshl_b32 s80, s80, 11
    v_add_u32 v11, s80, v7
    s_mov_b32 s52, s26
    s_mov_b32 s53, s27
    s_mov_b32 s54, 0x1000000
    s_mov_b32 s55, 0x20000
    v_and_b32 v7, 7, v0
    s_lshl_b32 s79, s74, 7
    v_lshl_add_u32 v7, v7, 4, s79
    s_lshl_b32 s78, s75, 7
    v_bfe_u32 v5, v0, 3, 2
    v_lshrrev_b32 v6, 5, v0
    s_lshl_b32 s80, s3, 5
    v_lshlrev_b32 v8, 3, v5
    v_lshl_add_u32 v8, v6, 2, v8
    v_add_u32 v8, s80, v8
    v_and_b32 v35, 7, v0
    v_lshl_add_u32 v16, v35, 1, v6
    v_lshlrev_b32 v232, 5, v16
    v_lshlrev_b32 v16, 3, v16
    v_lshl_add_u32 v16, v5, 10, v16
    v_and_b32 v231, 1, v5
    v_lshl_add_u32 v16, v231, 7, v16
    s_lshl_b32 s79, s3, 12
    s_add_u32 s79, s79, 129024
    v_add_u32 v16, s79, v16
    v_xor_b32 v231, 128, v16
    v_lshrrev_b32 v35, 2, v35
    v_lshl_add_u32 v35, v35, 4, v232
    v_add_u32 v35, 162816, v35
    v_add_u32 v8, s78, v8
    v_lshl_add_u32 v9, v8, 11, v7
    v_lshl_add_u32 v13, v8, 12, v7
    v_bfe_u32 v8, v0, 2, 1
    v_lshlrev_b32 v8, 1, v8
    v_add_u32 v8, v8, v6
    v_lshlrev_b32 v8, 16, v8
    v_lshl_add_u32 v8, v5, 6, v8
    v_and_b32 v7, 3, v0
    v_lshl_add_u32 v8, v7, 4, v8
    s_add_u32 s78, s78, s80
    s_lshl_b32 s78, s78, 3
    s_lshl_b32 s79, s74, 18
    s_add_u32 s78, s78, s79
    v_add_u32 v12, s78, v8
    s_mov_b32 s48, s12
    s_mov_b32 s49, s13
    s_mov_b32 s50, 0x400000
    s_mov_b32 s51, 0x20000
    s_mov_b32 s56, s4
    s_mov_b32 s57, s5
    s_mov_b32 s58, 0x400000
    s_mov_b32 s59, 0x20000
    s_mov_b32 s64, s20
    s_mov_b32 s65, s21
    s_mov_b32 s66, 0x200000
    s_mov_b32 s67, 0x20000
    s_lshl_b32 s91, s74, 4
    s_add_u32 s91, s91, s75
    s_lshr_b32 s78, s91, 3
    s_lshl_b32 s78, s78, 5
    s_and_b32 s79, s91, 7
    s_add_u32 s78, s78, s79
    s_lshl_b32 s79, s3, 3
    s_add_u32 s90, s78, s79
    s_lshl_b32 s91, s91, 14
    s_mov_b32 s96, 4096
    s_mul_i32 s94, s3, 8320
    s_add_u32 s94, s94, 129024
    v_mov_b32 v229, 0
    s_mov_b64 s[4:5], s[64:65]
    s_mov_b32 s6, 0x0
    s_mov_b32 s7, 0x20000
    v_mov_b32 v228, 0x40000000
    s_bitcmp1_b32 s73, 2
    s_cbranch_scc1 LA_nh0
    s_mov_b64 s[4:5], s[28:29]
    s_mov_b32 s6, 0x400000
    v_mov_b32 v229, 0x40000000
    s_and_b32 s78, s73, 3
    s_cmp_eq_u32 s78, 3
    s_cbranch_scc1 LA_nh0
    s_add_u32 s78, s72, 1
    s_and_b32 s78, s78, 3
    s_bfe_u32 s80, s72, 0x10002
    s_lshl_b32 s81, s101, 2
    s_lshl_b32 s82, s78, 1
    s_cmp_lt_u32 s78, 2
    s_cselect_b32 s79, 12, 24
    s_cselect_b32 s82, s82, 0
    s_cselect_b32 s83, 6, 7
    s_add_u32 s81, s81, s83
    s_add_u32 s80, s80, s82
    s_lshl_b32 s80, s80, 2
    s_add_u32 s80, s80, s3
    s_mul_i32 s80, s80, s79
    s_add_u32 s82, s81, s78
    s_add_u32 s81, s81, s98
    s_and_b32 s81, s81, 15
    s_lshr_b32 s83, s81, 3
    s_xor_b32 s81, s81, s83
    s_mul_i32 s81, s81, 192
    s_add_u32 s80, s80, s81
    s_or_b32 s81, s73, 3
    s_lshl_b32 s81, s81, 7
    v_add_u32 v5, s80, v0
    v_lshl_add_u32 v5, v5, 11, s81
    v_cmp_gt_u32 vcc, s79, v0
    s_nop 1
    v_cndmask_b32 v228, v228, v5, vcc
    s_cmp_ge_u32 s78, 2
    s_cbranch_scc1 LA_nh0
    s_add_u32 s82, s82, s98
    s_and_b32 s82, s82, 15
    s_lshr_b32 s83, s82, 3
    s_xor_b32 s82, s82, s83
    s_lshl_b32 s78, s82, 7
    s_lshl_b32 s79, s72, 7
    s_mul_i32 s80, s3, 36
    s_add_u32 s79, s79, s80
    s_sub_u32 s79, s79, 16
    v_add_u32 v5, s79, v0
    v_lshl_add_u32 v5, v5, 11, s78
    v_cmp_gt_u32 vcc, 36, v0
    s_nop 1
    v_cndmask_b32 v229, v229, v5, vcc
LA_nh0:
    buffer_load_dwordx4 v241, s[28:31], s97 offen offset:1024  lds
    buffer_load_dwordx4 v242, s[28:31], s97 offen offset:2048  lds
    buffer_load_dwordx4 v243, s[28:31], s97 offen offset:3072  lds
    s_add_u32 m0, s88, 18432
    s_mov_b64 exec, 0xffffffff
    buffer_load_dwordx4 v3, s[28:31], s97 offen offset:0  lds
    s_mov_b64 exec, -1
    s_mul_i32 s16, s97, 3072
    s_add_u32 m0, s60, 24576
    s_add_u32 s99, s16, s62
    buffer_load_dwordx4 v244, s[32:35], s99 offen offset:0  lds
    buffer_load_dwordx4 v245, s[32:35], s99 offen offset:1024  lds
    s_waitcnt vmcnt(7)
    s_barrier
    buffer_load_dwordx4 v246, s[32:35], s99 offen offset:2048  lds
    s_add_u32 m0, s61, 36864
    s_add_u32 s16, s16, s63
    buffer_load_dwordx4 v244, s[32:35], s16 offen offset:0  lds
    buffer_load_dwordx4 v245, s[32:35], s16 offen offset:1024  lds
    buffer_load_dwordx4 v246, s[32:35], s16 offen offset:2048  lds
    s_add_u32 s97, s98, s0
    s_lshr_b64 s[0:1], s[0:1], 4
    s_and_b32 s97, s97, 15
    s_lshr_b32 s99, s97, 3
    s_xor_b32 s97, s97, s99
    s_add_u32 m0, s87, 36864
    s_lshl_b32 s97, s97, 7
    buffer_load_dwordx4 v240, s[28:31], s97 offen offset:0  lds
    buffer_load_dwordx4 v241, s[28:31], s97 offen offset:1024  lds
    buffer_load_dwordx4 v242, s[28:31], s97 offen offset:2048  lds
    buffer_load_dwordx4 v243, s[28:31], s97 offen offset:3072  lds
    s_add_u32 m0, s88, 36864
    s_mov_b64 exec, 0xffffffff
    buffer_load_dwordx4 v3, s[28:31], s97 offen offset:0  lds
    s_mov_b64 exec, -1
    s_cmp_eq_u32 s101, 1
    s_cbranch_scc1 LA_c1
    s_cmp_eq_u32 s101, 2
    s_cbranch_scc1 LA_c2
    s_cmp_eq_u32 s101, 3
    s_cbranch_scc1 LA_c3
LA_c0:
    s_waitcnt vmcnt(11)
    s_barrier
    s_mul_i32 s16, s97, 3072
    s_add_u32 m0, s60, 49152
    s_add_u32 s99, s16, s62
    buffer_load_dwordx4 v244, s[32:35], s99 offen offset:0  lds
    buffer_load_dwordx4 v245, s[32:35], s99 offen offset:1024  lds
    buffer_load_dwordx4 v246, s[32:35], s99 offen offset:2048  lds
    s_add_u32 m0, s61, 61440
    s_add_u32 s16, s16, s63
    buffer_load_dwordx4 v244, s[32:35], s16 offen offset:0  lds
    buffer_load_dwordx4 v245, s[32:35], s16 offen offset:1024  lds
    buffer_load_dwordx4 v246, s[32:35], s16 offen offset:2048  lds
    s_add_u32 s97, s98, s0
    s_lshr_b64 s[0:1], s[0:1], 4
    s_and_b32 s97, s97, 15
    s_lshr_b32 s99, s97, 3
    s_xor_b32 s97, s97, s99
    s_add_u32 m0, s87, 0
    s_lshl_b32 s97, s97, 7
    buffer_load_dwordx4 v240, s[28:31], s97 offen offset:0  lds
    buffer_load_dwordx4 v241, s[28:31], s97 offen offset:1024  lds
    buffer_load_dwordx4 v242, s[28:31], s97 offen offset:2048  lds
    buffer_load_dwordx4 v243, s[28:31], s97 offen offset:3072  lds
    s_add_u32 m0, s88, 0
    s_mov_b64 exec, 0xffffffff
    buffer_load_dwordx4 v3, s[28:31], s97 offen offset:0  lds
    s_mov_b64 exec, -1
    s_waitcnt vmcnt(11)
    s_barrier
    s_mul_i32 s16, s97, 3072
    s_add_u32 m0, s60, 0
    s_add_u32 s99, s16, s62
    buffer_load_dwordx4 v244, s[32:35], s99 offen offset:0  lds
    buffer_load_dwordx4 v245, s[32:35], s99 offen offset:1024  lds
    buffer_load_dwordx4 v246, s[32:35], s99 offen offset:2048  lds
    s_add_u32 m0, s61, 12288
    s_add_u32 s16, s16, s63
    buffer_load_dwordx4 v244, s[32:35], s16 offen offset:0  lds
    buffer_load_dwordx4 v245, s[32:35], s16 offen offset:1024  lds
    buffer_load_dwordx4 v246, s[32:35], s16 offen offset:2048  lds
    buffer_load_dword v230, v229, s[4:7], 0 offen
    buffer_load_dword v230, v228, s[32:35], 0 offen
    s_add_u32 m0, s86, 129536
    s_mov_b32 s89, 0
    buffer_load_dwordx4 v10, s[36:39], s89 offen nt lds
    s_add_u32 m0, s86, 145920
    s_mov_b32 s89, 0
    buffer_load_dwordx4 v10, s[40:43], s89 offen nt lds
    s_add_u32 m0, s86, 133632
    s_mov_b32 s89, 65536
    buffer_load_dwordx4 v10, s[36:39], s89 offen nt lds
    s_add_u32 m0, s86, 150016
    s_mov_b32 s89, 65536
    buffer_load_dwordx4 v10, s[40:43], s89 offen nt lds
    s_add_u32 m0, s86, 137728
    s_mov_b32 s89, 131072
    buffer_load_dwordx4 v10, s[36:39], s89 offen nt lds
    s_add_u32 m0, s86, 154112
    s_mov_b32 s89, 131072
    buffer_load_dwordx4 v10, s[40:43], s89 offen nt lds
    s_add_u32 m0, s86, 141824
    s_mov_b32 s89, 196608
    buffer_load_dwordx4 v10, s[36:39], s89 offen nt lds
    s_add_u32 m0, s86, 158208
    s_mov_b32 s89, 196608
    buffer_load_dwordx4 v10, s[40:43], s89 offen nt lds
    s_waitcnt vmcnt(16)
    s_barrier
    s_mov_b64 exec, 0xff
    s_lshl_b32 s82, s3, 7
    s_add_u32 m0, s82, 129024
    s_mov_b32 s89, 0
    buffer_load_dwordx4 v11, s[36:39], s89 offen nt lds
    s_lshl_b32 s83, s74, 9
    s_add_u32 s83, s83, s82
    s_and_b32 s89, s3, 2
    s_lshl_b32 s89, s89, 3
    s_add_u32 s82, s82, s89
    s_add_u32 m0, s82, 162816
    s_add_u32 s89, s83, 0
    buffer_load_dwordx4 v15, s[44:47], s89 offen  lds
    s_mov_b64 exec, -1
    s_add_u32 s97, s98, s0
    s_lshr_b64 s[0:1], s[0:1], 4
    s_and_b32 s97, s97, 15
    s_lshr_b32 s99, s97, 3
    s_xor_b32 s97, s97, s99
    s_add_u32 m0, s87, 18432
    s_lshl_b32 s97, s97, 7
    buffer_load_dwordx4 v240, s[28:31], s97 offen offset:0  lds
    buffer_load_dwordx4 v241, s[28:31], s97 offen offset:1024  lds
    buffer_load_dwordx4 v242, s[28:31], s97 offen offset:2048  lds
    buffer_load_dwordx4 v243, s[28:31], s97 offen offset:3072  lds
    s_add_u32 m0, s88, 18432
    s_mov_b64 exec, 0xffffffff
    buffer_load_dwordx4 v3, s[28:31], s97 offen offset:0  lds
    s_mov_b64 exec, -1
    s_mul_i32 s16, s97, 3072
    s_add_u32 m0, s60, 24576
    s_add_u32 s99, s16, s62
    buffer_load_dwordx4 v244, s[32:35], s99 offen offset:0  lds
    buffer_load_dwordx4 v245, s[32:35], s99 offen offset:1024  lds
    buffer_load_dwordx4 v246, s[32:35], s99 offen offset:2048  lds
    s_add_u32 m0, s61, 36864
    s_add_u32 s16, s16, s63
    buffer_load_dwordx4 v244, s[32:35], s16 offen offset:0  lds
    buffer_load_dwordx4 v245, s[32:35], s16 offen offset:1024  lds
    buffer_load_dwordx4 v246, s[32:35], s16 offen offset:2048  lds
    s_add_u32 s97, s98, s0
    s_lshr_b64 s[0:1], s[0:1], 4
    s_and_b32 s97, s97, 15
    s_lshr_b32 s99, s97, 3
    s_xor_b32 s97, s97, s99
    s_add_u32 m0, s87, 36864
    s_lshl_b32 s97, s97, 7
    buffer_load_dwordx4 v240, s[28:31], s97 offen offset:0  lds
    buffer_load_dwordx4 v241, s[28:31], s97 offen offset:1024  lds
    buffer_load_dwordx4 v242, s[28:31], s97 offen offset:2048  lds
    buffer_load_dwordx4 v243, s[28:31], s97 offen offset:3072  lds
    s_waitcnt vmcnt(10)
    s_barrier
    s_add_u32 m0, s88, 36864
    s_mov_b64 exec, 0xffffffff
    buffer_load_dwordx4 v3, s[28:31], s97 offen offset:0  lds
    s_mov_b64 exec, -1
    ds_read_b128 v[84:87], v35 offset:0
    ds_read_b128 v[88:91], v35 offset:16
    s_mul_i32 s16, s97, 3072
    s_add_u32 m0, s60, 49152
    s_add_u32 s99, s16, s62
    buffer_load_dwordx4 v244, s[32:35], s99 offen offset:0  lds
    ds_read_b64 v[40:41], v16 offset:0
    ds_read_b64 v[42:43], v231 offset:256
    buffer_load_dwordx4 v245, s[32:35], s99 offen offset:1024  lds
    ds_read_b64 v[44:45], v16 offset:256
    ds_read_b64 v[46:47], v16 offset:512
    buffer_load_dwordx4 v246, s[32:35], s99 offen offset:2048  lds
    ds_read_b64 v[48:49], v231 offset:512
    s_add_u32 m0, s61, 61440
    s_add_u32 s16, s16, s63
    buffer_load_dwordx4 v244, s[32:35], s16 offen offset:0  lds
    ds_read_b64 v[50:51], v16 offset:768
    ds_read_b64 v[52:53], v231 offset:768
    buffer_load_dwordx4 v245, s[32:35], s16 offen offset:1024  lds
    ds_read_b64 v[54:55], v16 offset:1024
    ds_read_b64 v[56:57], v231 offset:1024
    buffer_load_dwordx4 v246, s[32:35], s16 offen offset:2048  lds
    ds_read_b64 v[58:59], v16 offset:1280
    ds_read_b64 v[60:61], v231 offset:1280
    s_add_u32 s97, s98, s0
    s_lshr_b64 s[0:1], s[0:1], 4
    s_and_b32 s97, s97, 15
    s_lshr_b32 s99, s97, 3
    s_xor_b32 s97, s97, s99
    s_add_u32 m0, s87, 0
    s_lshl_b32 s97, s97, 7
    buffer_load_dwordx4 v240, s[28:31], s97 offen offset:0  lds
    ds_read_b64 v[68:69], v16 offset:16896
    buffer_load_dwordx4 v241, s[28:31], s97 offen offset:1024  lds
    ds_read_b64 v[70:71], v231 offset:16896
    ds_read_b64 v[72:73], v16 offset:17152
    buffer_load_dwordx4 v242, s[28:31], s97 offen offset:2048  lds
    ds_read_b64 v[74:75], v231 offset:17152
    ds_read_b64 v[76:77], v16 offset:17408
    buffer_load_dwordx4 v243, s[28:31], s97 offen offset:3072  lds
    ds_read_b64 v[78:79], v231 offset:17408
    ds_read_b64 v[80:81], v16 offset:17664
    s_add_u32 m0, s88, 0
    s_mov_b64 exec, 0xffffffff
    buffer_load_dwordx4 v3, s[28:31], s97 offen offset:0  lds
    s_mov_b64 exec, -1
    ds_read_b64 v[82:83], v231 offset:17664
    s_waitcnt vmcnt(11)
    s_waitcnt lgkmcnt(0)
    s_barrier
    s_mul_i32 s16, s97, 3072
    s_add_u32 m0, s60, 0
    s_add_u32 s99, s16, s62
    buffer_load_dwordx4 v244, s[32:35], s99 offen offset:0  lds
    v_lshlrev_b32 v160, 16, v40
    v_lshlrev_b32 v161, 16, v42
    v_lshlrev_b32 v162, 16, v44
    v_lshlrev_b32 v163, 16, v46
    v_lshlrev_b32 v164, 16, v48
    buffer_load_dwordx4 v245, s[32:35], s99 offen offset:1024  lds
    v_lshlrev_b32 v165, 16, v50
    v_lshlrev_b32 v166, 16, v52
    v_lshlrev_b32 v167, 16, v54
    v_lshlrev_b32 v168, 16, v56
    v_lshlrev_b32 v169, 16, v58
    buffer_load_dwordx4 v246, s[32:35], s99 offen offset:2048  lds
    v_lshlrev_b32 v170, 16, v60
    v_lshlrev_b32 v172, 16, v84
    v_and_b32 v173, 0xffff0000, v84
    v_lshlrev_b32 v174, 16, v85
    v_and_b32 v175, 0xffff0000, v85
    s_add_u32 m0, s61, 12288
    s_add_u32 s16, s16, s63
    buffer_load_dwordx4 v244, s[32:35], s16 offen offset:0  lds
    v_lshlrev_b32 v176, 16, v68
    v_lshlrev_b32 v177, 16, v70
    v_lshlrev_b32 v178, 16, v72
    v_lshlrev_b32 v179, 16, v74
    v_lshlrev_b32 v180, 16, v76
    buffer_load_dwordx4 v245, s[32:35], s16 offen offset:1024  lds
    v_lshlrev_b32 v181, 16, v78
    v_lshlrev_b32 v182, 16, v80
    v_lshlrev_b32 v183, 16, v82
    v_mul_f32 v184, v160, v175
    v_mul_f32 v185, v161, v175
    buffer_load_dwordx4 v246, s[32:35], s16 offen offset:2048  lds
    v_mul_f32 v186, v162, v175
    v_mul_f32 v187, v163, v175
    v_mul_f32 v188, v164, v175
    v_mul_f32 v189, v165, v175
    v_mul_f32 v190, v166, v175
    s_add_u32 s97, s98, s0
    s_lshr_b64 s[0:1], s[0:1], 4
    s_and_b32 s97, s97, 15
    s_lshr_b32 s99, s97, 3
    s_xor_b32 s97, s97, s99
    s_add_u32 m0, s87, 18432
    s_lshl_b32 s97, s97, 7
    buffer_load_dwordx4 v240, s[28:31], s97 offen offset:0  lds
    v_mul_f32 v191, v167, v175
    v_fmac_f32 v184, v161, v174
    v_fmac_f32 v185, v162, v174
    v_fmac_f32 v186, v163, v174
    v_fmac_f32 v187, v164, v174
    buffer_load_dwordx4 v241, s[28:31], s97 offen offset:1024  lds
    v_fmac_f32 v188, v165, v174
    v_fmac_f32 v189, v166, v174
    v_fmac_f32 v190, v167, v174
    v_fmac_f32 v191, v168, v174
    v_fmac_f32 v184, v162, v173
    buffer_load_dwordx4 v242, s[28:31], s97 offen offset:2048  lds
    v_fmac_f32 v185, v163, v173
    v_fmac_f32 v186, v164, v173
    v_fmac_f32 v187, v165, v173
    v_fmac_f32 v188, v166, v173
    v_fmac_f32 v189, v167, v173
    buffer_load_dwordx4 v243, s[28:31], s97 offen offset:3072  lds
    v_fmac_f32 v190, v168, v173
    v_fmac_f32 v191, v169, v173
    v_fmac_f32 v184, v163, v172
    v_fmac_f32 v185, v164, v172
    v_fmac_f32 v186, v165, v172
    s_add_u32 m0, s88, 18432
    s_mov_b64 exec, 0xffffffff
    buffer_load_dwordx4 v3, s[28:31], s97 offen offset:0  lds
    s_mov_b64 exec, -1
    v_fmac_f32 v187, v166, v172
    v_fmac_f32 v188, v167, v172
    v_fmac_f32 v189, v168, v172
    v_fmac_f32 v190, v169, v172
    v_fmac_f32 v191, v170, v172
    v_mul_f32 v184, v184, v176
    v_mul_f32 v185, v185, v177
    v_mul_f32 v186, v186, v178
    v_mul_f32 v187, v187, v179
    v_mul_f32 v188, v188, v180
    v_mul_f32 v189, v189, v181
    v_mul_f32 v190, v190, v182
    v_mul_f32 v191, v191, v183
    v_cvt_pk_bf16_f32 v100, v191, v190
    v_cvt_pk_bf16_f32 v101, v189, v188
    v_cvt_pk_bf16_f32 v102, v187, v186
    v_cvt_pk_bf16_f32 v103, v185, v184
    s_mov_b32 s89, 0
    buffer_store_dwordx4 v[100:103], v12, s[52:55], s89 offen sc1
    s_waitcnt vmcnt(12)
    s_barrier
    s_mul_i32 s16, s97, 3072
    s_add_u32 m0, s60, 24576
    s_add_u32 s99, s16, s62
    buffer_load_dwordx4 v244, s[32:35], s99 offen offset:0  lds
    v_and_b32 v160, 0xffff0000, v40
    v_and_b32 v161, 0xffff0000, v42
    v_and_b32 v162, 0xffff0000, v44
    v_and_b32 v163, 0xffff0000, v46
    v_and_b32 v164, 0xffff0000, v48
    buffer_load_dwordx4 v245, s[32:35], s99 offen offset:1024  lds
    v_and_b32 v165, 0xffff0000, v50
    v_and_b32 v166, 0xffff0000, v52
    v_and_b32 v167, 0xffff0000, v54
    v_and_b32 v168, 0xffff0000, v56
    v_and_b32 v169, 0xffff0000, v58
    buffer_load_dwordx4 v246, s[32:35], s99 offen offset:2048  lds
    v_and_b32 v170, 0xffff0000, v60
    v_lshlrev_b32 v172, 16, v86
    v_and_b32 v173, 0xffff0000, v86
    v_lshlrev_b32 v174, 16, v87
    v_and_b32 v175, 0xffff0000, v87
    s_add_u32 m0, s61, 36864
    s_add_u32 s16, s16, s63
    buffer_load_dwordx4 v244, s[32:35], s16 offen offset:0  lds
    v_and_b32 v176, 0xffff0000, v68
    v_and_b32 v177, 0xffff0000, v70
    v_and_b32 v178, 0xffff0000, v72
    v_and_b32 v179, 0xffff0000, v74
    v_and_b32 v180, 0xffff0000, v76
    buffer_load_dwordx4 v245, s[32:35], s16 offen offset:1024  lds
    v_and_b32 v181, 0xffff0000, v78
    v_and_b32 v182, 0xffff0000, v80
    v_and_b32 v183, 0xffff0000, v82
    v_mul_f32 v184, v160, v175
    v_mul_f32 v185, v161, v175
    buffer_load_dwordx4 v246, s[32:35], s16 offen offset:2048  lds
    v_mul_f32 v186, v162, v175
    v_mul_f32 v187, v163, v175
    v_mul_f32 v188, v164, v175
    v_mul_f32 v189, v165, v175
    v_mul_f32 v190, v166, v175
    s_add_u32 s97, s98, s0
    s_lshr_b64 s[0:1], s[0:1], 4
    s_and_b32 s97, s97, 15
    s_lshr_b32 s99, s97, 3
    s_xor_b32 s97, s97, s99
    s_add_u32 m0, s87, 36864
    s_lshl_b32 s97, s97, 7
    buffer_load_dwordx4 v240, s[28:31], s97 offen offset:0  lds
    v_mul_f32 v191, v167, v175
    v_fmac_f32 v184, v161, v174
    v_fmac_f32 v185, v162, v174
    v_fmac_f32 v186, v163, v174
    v_fmac_f32 v187, v164, v174
    buffer_load_dwordx4 v241, s[28:31], s97 offen offset:1024  lds
    v_fmac_f32 v188, v165, v174
    v_fmac_f32 v189, v166, v174
    v_fmac_f32 v190, v167, v174
    v_fmac_f32 v191, v168, v174
    v_fmac_f32 v184, v162, v173
    buffer_load_dwordx4 v242, s[28:31], s97 offen offset:2048  lds
    v_fmac_f32 v185, v163, v173
    v_fmac_f32 v186, v164, v173
    v_fmac_f32 v187, v165, v173
    v_fmac_f32 v188, v166, v173
    v_fmac_f32 v189, v167, v173
    buffer_load_dwordx4 v243, s[28:31], s97 offen offset:3072  lds
    v_fmac_f32 v190, v168, v173
    v_fmac_f32 v191, v169, v173
    v_fmac_f32 v184, v163, v172
    v_fmac_f32 v185, v164, v172
    v_fmac_f32 v186, v165, v172
    s_add_u32 m0, s88, 36864
    s_mov_b64 exec, 0xffffffff
    buffer_load_dwordx4 v3, s[28:31], s97 offen offset:0  lds
    s_mov_b64 exec, -1
    v_fmac_f32 v187, v166, v172
    v_fmac_f32 v188, v167, v172
    v_fmac_f32 v189, v168, v172
    v_fmac_f32 v190, v169, v172
    v_fmac_f32 v191, v170, v172
    v_mul_f32 v184, v184, v176
    v_mul_f32 v185, v185, v177
    v_mul_f32 v186, v186, v178
    v_mul_f32 v187, v187, v179
    v_mul_f32 v188, v188, v180
    v_mul_f32 v189, v189, v181
    v_mul_f32 v190, v190, v182
    v_mul_f32 v191, v191, v183
    v_cvt_pk_bf16_f32 v104, v191, v190
    v_cvt_pk_bf16_f32 v105, v189, v188
    v_cvt_pk_bf16_f32 v106, v187, v186
    v_cvt_pk_bf16_f32 v107, v185, v184
    s_mov_b32 s89, 16384
    buffer_store_dwordx4 v[104:107], v12, s[52:55], s89 offen sc1
    s_waitcnt vmcnt(13)
    s_barrier
    s_mul_i32 s16, s97, 3072
    s_add_u32 m0, s60, 49152
    s_add_u32 s99, s16, s62
    buffer_load_dwordx4 v244, s[32:35], s99 offen offset:0  lds
    v_lshlrev_b32 v160, 16, v41
    v_lshlrev_b32 v161, 16, v43
    v_lshlrev_b32 v162, 16, v45
    v_lshlrev_b32 v163, 16, v47
    v_lshlrev_b32 v164, 16, v49
    buffer_load_dwordx4 v245, s[32:35], s99 offen offset:1024  lds
    v_lshlrev_b32 v165, 16, v51
    v_lshlrev_b32 v166, 16, v53
    v_lshlrev_b32 v167, 16, v55
    v_lshlrev_b32 v168, 16, v57
    v_lshlrev_b32 v169, 16, v59
    buffer_load_dwordx4 v246, s[32:35], s99 offen offset:2048  lds
    v_lshlrev_b32 v170, 16, v61
    v_lshlrev_b32 v172, 16, v88
    v_and_b32 v173, 0xffff0000, v88
    v_lshlrev_b32 v174, 16, v89
    v_and_b32 v175, 0xffff0000, v89
    s_add_u32 m0, s61, 61440
    s_add_u32 s16, s16, s63
    buffer_load_dwordx4 v244, s[32:35], s16 offen offset:0  lds
    v_lshlrev_b32 v176, 16, v69
    v_lshlrev_b32 v177, 16, v71
    v_lshlrev_b32 v178, 16, v73
    v_lshlrev_b32 v179, 16, v75
    v_lshlrev_b32 v180, 16, v77
    buffer_load_dwordx4 v245, s[32:35], s16 offen offset:1024  lds
    v_lshlrev_b32 v181, 16, v79
    v_lshlrev_b32 v182, 16, v81
    v_lshlrev_b32 v183, 16, v83
    v_mul_f32 v184, v160, v175
    v_mul_f32 v185, v161, v175
    buffer_load_dwordx4 v246, s[32:35], s16 offen offset:2048  lds
    v_mul_f32 v186, v162, v175
    v_mul_f32 v187, v163, v175
    v_mul_f32 v188, v164, v175
    v_mul_f32 v189, v165, v175
    v_mul_f32 v190, v166, v175
    s_add_u32 s97, s98, s0
    s_lshr_b64 s[0:1], s[0:1], 4
    s_and_b32 s97, s97, 15
    s_lshr_b32 s99, s97, 3
    s_xor_b32 s97, s97, s99
    s_add_u32 m0, s87, 0
    s_lshl_b32 s97, s97, 7
    buffer_load_dwordx4 v240, s[28:31], s97 offen offset:0  lds
    v_mul_f32 v191, v167, v175
    v_fmac_f32 v184, v161, v174
    v_fmac_f32 v185, v162, v174
    v_fmac_f32 v186, v163, v174
    v_fmac_f32 v187, v164, v174
    buffer_load_dwordx4 v241, s[28:31], s97 offen offset:1024  lds
    v_fmac_f32 v188, v165, v174
    v_fmac_f32 v189, v166, v174
    v_fmac_f32 v190, v167, v174
    v_fmac_f32 v191, v168, v174
    v_fmac_f32 v184, v162, v173
    buffer_load_dwordx4 v242, s[28:31], s97 offen offset:2048  lds
    v_fmac_f32 v185, v163, v173
    v_fmac_f32 v186, v164, v173
    v_fmac_f32 v187, v165, v173
    v_fmac_f32 v188, v166, v173
    v_fmac_f32 v189, v167, v173
    buffer_load_dwordx4 v243, s[28:31], s97 offen offset:3072  lds
    v_fmac_f32 v190, v168, v173
    v_fmac_f32 v191, v169, v173
    v_fmac_f32 v184, v163, v172
    v_fmac_f32 v185, v164, v172
    v_fmac_f32 v186, v165, v172
    s_add_u32 m0, s88, 0
    s_mov_b64 exec, 0xffffffff
    buffer_load_dwordx4 v3, s[28:31], s97 offen offset:0  lds
    s_mov_b64 exec, -1
    v_fmac_f32 v187, v166, v172
    v_fmac_f32 v188, v167, v172
    v_fmac_f32 v189, v168, v172
    v_fmac_f32 v190, v169, v172
    v_fmac_f32 v191, v170, v172
    v_mul_f32 v184, v184, v176
    v_mul_f32 v185, v185, v177
    v_mul_f32 v186, v186, v178
    v_mul_f32 v187, v187, v179
    v_mul_f32 v188, v188, v180
    v_mul_f32 v189, v189, v181
    v_mul_f32 v190, v190, v182
    v_mul_f32 v191, v191, v183
    v_cvt_pk_bf16_f32 v108, v191, v190
    v_cvt_pk_bf16_f32 v109, v189, v188
    v_cvt_pk_bf16_f32 v110, v187, v186
    v_cvt_pk_bf16_f32 v111, v185, v184
    s_mov_b32 s89, 32768
    buffer_store_dwordx4 v[108:111], v12, s[52:55], s89 offen sc1
    s_waitcnt vmcnt(13)
    s_barrier
    s_mul_i32 s16, s97, 3072
    s_add_u32 m0, s60, 0
    s_add_u32 s99, s16, s62
    buffer_load_dwordx4 v244, s[32:35], s99 offen offset:0  lds
    v_and_b32 v160, 0xffff0000, v41
    v_and_b32 v161, 0xffff0000, v43
    v_and_b32 v162, 0xffff0000, v45
    v_and_b32 v163, 0xffff0000, v47
    v_and_b32 v164, 0xffff0000, v49
    buffer_load_dwordx4 v245, s[32:35], s99 offen offset:1024  lds
    v_and_b32 v165, 0xffff0000, v51
    v_and_b32 v166, 0xffff0000, v53
    v_and_b32 v167, 0xffff0000, v55
    v_and_b32 v168, 0xffff0000, v57
    v_and_b32 v169, 0xffff0000, v59
    buffer_load_dwordx4 v246, s[32:35], s99 offen offset:2048  lds
    v_and_b32 v170, 0xffff0000, v61
    v_lshlrev_b32 v172, 16, v90
    v_and_b32 v173, 0xffff0000, v90
    v_lshlrev_b32 v174, 16, v91
    v_and_b32 v175, 0xffff0000, v91
    s_add_u32 m0, s61, 12288
    s_add_u32 s16, s16, s63
    buffer_load_dwordx4 v244, s[32:35], s16 offen offset:0  lds
    v_and_b32 v176, 0xffff0000, v69
    v_and_b32 v177, 0xffff0000, v71
    v_and_b32 v178, 0xffff0000, v73
    v_and_b32 v179, 0xffff0000, v75
    v_and_b32 v180, 0xffff0000, v77
    buffer_load_dwordx4 v245, s[32:35], s16 offen offset:1024  lds
    v_and_b32 v181, 0xffff0000, v79
    v_and_b32 v182, 0xffff0000, v81
    v_and_b32 v183, 0xffff0000, v83
    v_mul_f32 v184, v160, v175
    v_mul_f32 v185, v161, v175
    buffer_load_dwordx4 v246, s[32:35], s16 offen offset:2048  lds
    v_mul_f32 v186, v162, v175
    v_mul_f32 v187, v163, v175
    v_mul_f32 v188, v164, v175
    v_mul_f32 v189, v165, v175
    v_mul_f32 v190, v166, v175
    s_add_u32 s97, s98, s0
    s_lshr_b64 s[0:1], s[0:1], 4
    s_and_b32 s97, s97, 15
    s_lshr_b32 s99, s97, 3
    s_xor_b32 s97, s97, s99
    s_add_u32 m0, s87, 18432
    s_lshl_b32 s97, s97, 7
    buffer_load_dwordx4 v240, s[28:31], s97 offen offset:0  lds
    v_mul_f32 v191, v167, v175
    v_fmac_f32 v184, v161, v174
    v_fmac_f32 v185, v162, v174
    v_fmac_f32 v186, v163, v174
    v_fmac_f32 v187, v164, v174
    buffer_load_dwordx4 v241, s[28:31], s97 offen offset:1024  lds
    v_fmac_f32 v188, v165, v174
    v_fmac_f32 v189, v166, v174
    v_fmac_f32 v190, v167, v174
    v_fmac_f32 v191, v168, v174
    v_fmac_f32 v184, v162, v173
    buffer_load_dwordx4 v242, s[28:31], s97 offen offset:2048  lds
    v_fmac_f32 v185, v163, v173
    v_fmac_f32 v186, v164, v173
    v_fmac_f32 v187, v165, v173
    v_fmac_f32 v188, v166, v173
    v_fmac_f32 v189, v167, v173
    buffer_load_dwordx4 v243, s[28:31], s97 offen offset:3072  lds
    v_fmac_f32 v190, v168, v173
    v_fmac_f32 v191, v169, v173
    v_fmac_f32 v184, v163, v172
    v_fmac_f32 v185, v164, v172
    v_fmac_f32 v186, v165, v172
    s_add_u32 m0, s88, 18432
    s_mov_b64 exec, 0xffffffff
    buffer_load_dwordx4 v3, s[28:31], s97 offen offset:0  lds
    s_mov_b64 exec, -1
    v_fmac_f32 v187, v166, v172
    v_fmac_f32 v188, v167, v172
    v_fmac_f32 v189, v168, v172
    v_fmac_f32 v190, v169, v172
    v_fmac_f32 v191, v170, v172
    v_mul_f32 v184, v184, v176
    v_mul_f32 v185, v185, v177
    v_mul_f32 v186, v186, v178
    v_mul_f32 v187, v187, v179
    v_mul_f32 v188, v188, v180
    v_mul_f32 v189, v189, v181
    v_mul_f32 v190, v190, v182
    v_mul_f32 v191, v191, v183
    v_cvt_pk_bf16_f32 v112, v191, v190
    v_cvt_pk_bf16_f32 v113, v189, v188
    v_cvt_pk_bf16_f32 v114, v187, v186
    v_cvt_pk_bf16_f32 v115, v185, v184
    s_mov_b32 s89, 49152
    buffer_store_dwordx4 v[112:115], v12, s[52:55], s89 offen sc1
    s_waitcnt vmcnt(13)
    s_barrier
    s_mul_i32 s16, s97, 3072
    s_add_u32 m0, s60, 24576
    s_add_u32 s99, s16, s62
    buffer_load_dwordx4 v244, s[32:35], s99 offen offset:0  lds
    buffer_load_dwordx4 v245, s[32:35], s99 offen offset:1024  lds
    buffer_load_dwordx4 v246, s[32:35], s99 offen offset:2048  lds
    s_add_u32 m0, s61, 36864
    s_add_u32 s16, s16, s63
    buffer_load_dwordx4 v244, s[32:35], s16 offen offset:0  lds
    buffer_load_dwordx4 v245, s[32:35], s16 offen offset:1024  lds
    buffer_load_dwordx4 v246, s[32:35], s16 offen offset:2048  lds
    s_add_u32 s97, s98, s0
    s_lshr_b64 s[0:1], s[0:1], 4
    s_and_b32 s97, s97, 15
    s_lshr_b32 s99, s97, 3
    s_xor_b32 s97, s97, s99
    s_add_u32 m0, s87, 36864
    s_lshl_b32 s97, s97, 7
    buffer_load_dwordx4 v240, s[28:31], s97 offen offset:0  lds
    buffer_load_dwordx4 v241, s[28:31], s97 offen offset:1024  lds
    buffer_load_dwordx4 v242, s[28:31], s97 offen offset:2048  lds
    buffer_load_dwordx4 v243, s[28:31], s97 offen offset:3072  lds
    s_add_u32 m0, s88, 36864
    s_mov_b64 exec, 0xffffffff
    buffer_load_dwordx4 v3, s[28:31], s97 offen offset:0  lds
    s_mov_b64 exec, -1
    s_waitcnt vmcnt(12)
    s_barrier
    s_mul_i32 s16, s97, 3072
    s_add_u32 m0, s60, 49152
    s_add_u32 s99, s16, s62
    buffer_load_dwordx4 v244, s[32:35], s99 offen offset:0  lds
    buffer_load_dwordx4 v245, s[32:35], s99 offen offset:1024  lds
    buffer_load_dwordx4 v246, s[32:35], s99 offen offset:2048  lds
    s_add_u32 m0, s61, 61440
    s_add_u32 s16, s16, s63
    buffer_load_dwordx4 v244, s[32:35], s16 offen offset:0  lds
    buffer_load_dwordx4 v245, s[32:35], s16 offen offset:1024  lds
    buffer_load_dwordx4 v246, s[32:35], s16 offen offset:2048  lds
    s_add_u32 m0, s94, 32
    s_lshl_b32 s89, s90, 12
    buffer_load_dwordx4 v15, s[48:51], s89 offen offset:0 nt lds
    s_add_u32 m0, s94, 32
    s_lshl_b32 s89, s90, 12
    buffer_load_dwordx4 v15, s[48:51], s89 offen offset:1024 nt lds
    s_add_u32 m0, s94, 32
    s_lshl_b32 s89, s90, 12
    buffer_load_dwordx4 v15, s[48:51], s89 offen offset:2048 nt lds
    s_add_u32 m0, s94, 32
    s_lshl_b32 s89, s90, 12
    buffer_load_dwordx4 v15, s[48:51], s89 offen offset:3072 nt lds
    s_add_u32 s97, s98, s0
    s_lshr_b64 s[0:1], s[0:1], 4
    s_and_b32 s97, s97, 15
    s_lshr_b32 s99, s97, 3
    s_xor_b32 s97, s97, s99
    s_add_u32 m0, s87, 0
    s_lshl_b32 s97, s97, 7
    buffer_load_dwordx4 v240, s[28:31], s97 offen offset:0  lds
    buffer_load_dwordx4 v241, s[28:31], s97 offen offset:1024  lds
    buffer_load_dwordx4 v242, s[28:31], s97 offen offset:2048  lds
    buffer_load_dwordx4 v243, s[28:31], s97 offen offset:3072  lds
    s_add_u32 m0, s88, 0
    s_mov_b64 exec, 0xffffffff
    buffer_load_dwordx4 v3, s[28:31], s97 offen offset:0  lds
    s_mov_b64 exec, -1
    s_waitcnt vmcnt(15)
    s_barrier
    s_mul_i32 s16, s97, 3072
    s_add_u32 m0, s60, 0
    s_add_u32 s99, s16, s62
    buffer_load_dwordx4 v244, s[32:35], s99 offen offset:0  lds
    s_mov_b32 s68, s24
    s_mov_b32 s69, s25
    s_mov_b32 s70, 0x100
    s_mov_b32 s71, 0x20000
    v_lshrrev_b32 v6, 5, v0
    buffer_load_dwordx4 v245, s[32:35], s99 offen offset:1024  lds
    v_and_b32 v7, 3, v0
    s_lshr_b32 s78, s90, 1
    s_lshl_b32 s78, s78, 2
    s_load_dword s92, s[14:15], s78
    v_bfe_u32 v5, v0, 2, 2
    buffer_load_dwordx4 v246, s[32:35], s99 offen offset:2048  lds
    v_lshlrev_b32 v5, 1, v5
    v_lshl_add_u32 v5, v6, 3, v5
    v_bfe_u32 v8, v0, 4, 1
    v_add_u32 v5, v5, v8
    s_and_b32 s78, s3, 1
    s_add_u32 m0, s61, 12288
    s_add_u32 s16, s16, s63
    buffer_load_dwordx4 v244, s[32:35], s16 offen offset:0  lds
    s_lshl_b32 s78, s78, 1
    v_add_u32 v8, s78, v6
    v_xor_b32 v8, v8, v7
    v_lshlrev_b32 v8, 4, v8
    buffer_load_dwordx4 v245, s[32:35], s16 offen offset:1024  lds
    v_lshl_add_u32 v5, v5, 6, v8
    v_add_u32 v14, s86, v5
    v_mov_b32 v18, 162304
    v_mov_b32 v19, 1
    v_and_b32 v5, 3, v0
    buffer_load_dwordx4 v246, s[32:35], s16 offen offset:2048  lds
    s_lshl_b32 s78, s74, 4
    s_add_u32 s78, s78, s3
    v_lshl_add_u32 v6, v5, 2, s78
    s_lshr_b32 s78, s76, 3
    s_lshl_b32 s79, s3, 1
    s_add_u32 s97, s98, s0
    s_lshr_b64 s[0:1], s[0:1], 4
    s_and_b32 s97, s97, 15
    s_lshr_b32 s99, s97, 3
    s_xor_b32 s97, s97, s99
    s_add_u32 m0, s87, 18432
    s_lshl_b32 s97, s97, 7
    buffer_load_dwordx4 v240, s[28:31], s97 offen offset:0  lds
    s_add_u32 s78, s78, s79
    s_xor_b32 s78, s78, 2
    s_lshl_b32 s78, s78, 5
    s_and_b32 s79, s76, 7
    s_add_u32 s78, s78, s79
    buffer_load_dwordx4 v241, s[28:31], s97 offen offset:1024  lds
    v_lshl_add_u32 v7, v5, 3, s78
    v_and_b32 v8, 4, v0
    v_cmp_eq_u32 vcc, 0, v8
    s_nop 1
    v_cndmask_b32 v6, v7, v6, vcc
    buffer_load_dwordx4 v242, s[28:31], s97 offen offset:2048  lds
    v_and_b32 v33, 0xf0, v6
    v_lshlrev_b32 v34, 8, v6
    v_add_u32 v34, 12582912, v34
    v_and_b32 v5, 15, v0
    v_lshrrev_b32 v6, 4, v0
    buffer_load_dwordx4 v243, s[28:31], s97 offen offset:3072  lds
    v_add_u32 v7, 9, v5
    v_and_b32 v8, 1, v7
    v_mul_u32_u24 v8, 4160, v8
    v_lshrrev_b32 v7, 1, v7
    v_lshl_add_u32 v8, v7, 2, v8
    s_add_u32 m0, s88, 18432
    s_mov_b64 exec, 0xffffffff
    buffer_load_dwordx4 v3, s[28:31], s97 offen offset:0  lds
    s_mov_b64 exec, -1
    v_lshlrev_b32 v7, 4, v6
    v_sub_u32 v8, v8, v7
    s_add_u32 s78, s94, 32
    v_add_u32 v21, s78, v8
    s_waitcnt vmcnt(11)
    s_barrier
    s_mul_i32 s16, s97, 3072
    s_add_u32 m0, s60, 24576
    s_add_u32 s99, s16, s62
    buffer_load_dwordx4 v244, s[32:35], s99 offen offset:0  lds
    v_add_u32 v22, 1024, v21
    v_add_u32 v23, 2048, v21
    v_add_u32 v24, 3072, v21
    v_lshl_add_u32 v7, v5, 1, v6
    v_add_u32 v7, 30, v7
    buffer_load_dwordx4 v245, s[32:35], s99 offen offset:1024  lds
    v_and_b32 v8, 1, v7
    v_bfe_u32 v136, v7, 1, 2
    v_lshl_add_u32 v136, v8, 2, v136
    v_lshlrev_b32 v136, 6, v136
    v_lshrrev_b32 v7, 3, v7
    buffer_load_dwordx4 v246, s[32:35], s99 offen offset:2048  lds
    v_lshl_add_u32 v136, v7, 9, v136
    v_bitop3_b32 v8, v7, 3, s3 bitop3:0x6a
    v_lshl_add_u32 v25, v8, 4, v136
    v_add_u32 v25, 92160, v25
    v_subrev_u32 v7, 1, v7
    s_add_u32 m0, s61, 36864
    s_add_u32 s16, s16, s63
    buffer_load_dwordx4 v244, s[32:35], s16 offen offset:0  lds
    v_bitop3_b32 v8, v7, 3, s3 bitop3:0x6a
    v_lshl_add_u32 v27, v8, 4, v136
    v_add_u32 v27, 91648, v27
    v_subrev_u32 v7, 1, v7
    buffer_load_dwordx4 v245, s[32:35], s16 offen offset:1024  lds
    v_bitop3_b32 v8, v7, 3, s3 bitop3:0x6a
    v_lshl_add_u32 v29, v8, 4, v136
    v_add_u32 v29, 91136, v29
    v_subrev_u32 v7, 1, v7
    v_bitop3_b32 v8, v7, 3, s3 bitop3:0x6a
    buffer_load_dwordx4 v246, s[32:35], s16 offen offset:2048  lds
    v_lshl_add_u32 v31, v8, 4, v136
    v_add_u32 v31, 90624, v31
    v_lshl_add_u32 v7, v5, 1, v6
    v_add_u32 v7, 26, v7
    v_and_b32 v8, 1, v7
    s_add_u32 s97, s98, s0
    s_lshr_b64 s[0:1], s[0:1], 4
    s_and_b32 s97, s97, 15
    s_lshr_b32 s99, s97, 3
    s_xor_b32 s97, s97, s99
    s_add_u32 m0, s87, 36864
    s_lshl_b32 s97, s97, 7
    buffer_load_dwordx4 v240, s[28:31], s97 offen offset:0  lds
    v_bfe_u32 v136, v7, 1, 2
    v_lshl_add_u32 v136, v8, 2, v136
    v_lshlrev_b32 v136, 6, v136
    v_lshrrev_b32 v7, 3, v7
    v_lshl_add_u32 v136, v7, 9, v136
    buffer_load_dwordx4 v241, s[28:31], s97 offen offset:1024  lds
    v_bitop3_b32 v8, v7, 3, s3 bitop3:0x6a
    v_lshl_add_u32 v26, v8, 4, v136
    v_add_u32 v26, 92160, v26
    v_subrev_u32 v7, 1, v7
    buffer_load_dwordx4 v242, s[28:31], s97 offen offset:2048  lds
    v_bitop3_b32 v8, v7, 3, s3 bitop3:0x6a
    v_lshl_add_u32 v28, v8, 4, v136
    v_add_u32 v28, 91648, v28
    v_subrev_u32 v7, 1, v7
    v_bitop3_b32 v8, v7, 3, s3 bitop3:0x6a
    buffer_load_dwordx4 v243, s[28:31], s97 offen offset:3072  lds
    v_lshl_add_u32 v30, v8, 4, v136
    v_add_u32 v30, 91136, v30
    v_subrev_u32 v7, 1, v7
    v_bitop3_b32 v8, v7, 3, s3 bitop3:0x6a
    v_lshl_add_u32 v32, v8, 4, v136
    s_add_u32 m0, s88, 36864
    s_mov_b64 exec, 0xffffffff
    buffer_load_dwordx4 v3, s[28:31], s97 offen offset:0  lds
    s_mov_b64 exec, -1
    v_add_u32 v32, 90624, v32
    v_lshrrev_b32 v7, 1, v6
    v_lshl_add_u32 v7, v5, 1, v7
    v_add_u32 v7, 32, v7
    s_waitcnt vmcnt(11)
    s_barrier
    s_mul_i32 s16, s97, 3072
    s_add_u32 m0, s60, 49152
    s_add_u32 s99, s16, s62
    buffer_load_dwordx4 v244, s[32:35], s99 offen offset:0  lds
    v_and_b32 v8, 1, v7
    v_bfe_u32 v136, v7, 1, 2
    v_lshl_add_u32 v136, v8, 2, v136
    v_lshlrev_b32 v136, 6, v136
    buffer_load_dwordx4 v245, s[32:35], s99 offen offset:1024  lds
    v_lshrrev_b32 v7, 3, v7
    v_lshl_add_u32 v136, v7, 9, v136
    v_bitop3_b32 v8, v7, 3, s3 bitop3:0x6a
    v_lshl_add_u32 v20, v8, 4, v136
    buffer_load_dwordx4 v246, s[32:35], s99 offen offset:2048  lds
    v_add_u32 v20, 92160, v20
    v_and_b32 v8, 1, v6
    v_xor_b32 v8, 1, v8
    v_lshl_add_u32 v20, v8, 3, v20
    s_add_u32 m0, s61, 61440
    s_add_u32 s16, s16, s63
    buffer_load_dwordx4 v244, s[32:35], s16 offen offset:0  lds
    s_waitcnt lgkmcnt(0)
    s_and_b32 s78, s92, 0xffff0000
    s_lshl_b32 s92, s92, 16
    s_bitcmp1_b32 s90, 0
    s_cselect_b32 s92, s78, s92
    buffer_load_dwordx4 v245, s[32:35], s16 offen offset:1024  lds
    v_lshlrev_b32 v7, 3, v6
    v_sub_u32 v7, v7, v5
    v_subrev_u32 v7, 9, v7
    v_and_b32 v8, 1, v7
    buffer_load_dwordx4 v246, s[32:35], s16 offen offset:2048  lds
    v_xor_b32 v8, 1, v8
    v_lshlrev_b32 v8, 4, v8
    v_lshrrev_b32 v8, v8, s92
    v_ashrrev_i32 v7, 1, v7
    s_add_u32 s97, s98, s0
    s_lshr_b64 s[0:1], s[0:1], 4
    s_and_b32 s97, s97, 15
    s_lshr_b32 s99, s97, 3
    s_xor_b32 s97, s97, s99
    s_add_u32 m0, s87, 0
    s_lshl_b32 s97, s97, 7
    buffer_load_dwordx4 v240, s[28:31], s97 offen offset:0  lds
    v_cmp_eq_u32 vcc, 0, v7
    s_nop 1
    v_cndmask_b32 v236, 0, v8, vcc
    v_cmp_eq_u32 vcc, 1, v7
    s_nop 1
    v_cndmask_b32 v237, 0, v8, vcc
    buffer_load_dwordx4 v241, s[28:31], s97 offen offset:1024  lds
    v_cmp_eq_u32 vcc, 2, v7
    s_nop 1
    v_cndmask_b32 v238, 0, v8, vcc
    v_cmp_eq_u32 vcc, 3, v7
    s_nop 1
    v_cndmask_b32 v239, 0, v8, vcc
    buffer_load_dwordx4 v242, s[28:31], s97 offen offset:2048  lds
    s_and_b32 s78, s77, 7
    s_mov_b32 s95, 0x76543210
    s_cmp_eq_u32 s78, 1
    s_cselect_b32 s95, 0x76543201, s95
    s_cmp_eq_u32 s78, 2
    s_cselect_b32 s95, 0x76543120, s95
    s_cmp_eq_u32 s78, 3
    s_cselect_b32 s95, 0x76542310, s95
    s_cmp_eq_u32 s78, 4
    s_cselect_b32 s95, 0x76534210, s95
    s_cmp_eq_u32 s78, 5
    s_cselect_b32 s95, 0x76453210, s95
    s_cmp_eq_u32 s78, 6
    s_cselect_b32 s95, 0x75643210, s95
    s_cmp_eq_u32 s78, 7
    s_cselect_b32 s95, 0x67543210, s95
    s_and_b32 s78, s76, 3
    s_mul_i32 s78, s78, 0x22222222
    s_add_u32 s95, s95, s78
    s_bfe_u32 s100, s95, 0x3001c
    s_lshl_b32 s100, s100, 18
    s_bfe_u32 s95, s95, 0x30018
    s_lshl_b32 s95, s95, 18
    v_lshrrev_b32 v136, 4, v0
    v_lshlrev_b32 v136, 1, v136
    v_and_b32 v137, 7, v0
    buffer_load_dwordx4 v243, s[28:31], s97 offen offset:3072  lds
    v_xor_b32 v136, v136, v137
    v_lshlrev_b32 v136, 4, v136
    v_lshrrev_b32 v137, 3, v0
    v_lshl_add_u32 v136, v137, 11, v136
    s_add_u32 m0, s88, 0
    s_mov_b64 exec, 0xffffffff
    buffer_load_dwordx4 v3, s[28:31], s97 offen offset:0  lds
    s_mov_b64 exec, -1
    s_lshl_b32 s78, s77, 7
    s_lshl_b32 s79, s3, 14
    s_add_u32 s78, s78, s79
    v_add_u32 v17, s78, v136
    s_waitcnt vmcnt(11)
    s_barrier
    s_mul_i32 s16, s97, 3072
    s_add_u32 m0, s60, 0
    s_add_u32 s99, s16, s62
    buffer_load_dwordx4 v244, s[32:35], s99 offen offset:0  lds
    v_add_u32 v5, s94, v15
    ds_read_b128 v[140:143], v5 offset:32
    ds_read_b32 v156, v5 offset:48
    ds_read_b128 v[144:147], v5 offset:1056
    ds_read_b32 v157, v5 offset:1072
    buffer_load_dwordx4 v245, s[32:35], s99 offen offset:1024  lds
    ds_read_b128 v[148:151], v5 offset:2080
    ds_read_b32 v158, v5 offset:2096
    ds_read_b128 v[152:155], v5 offset:3104
    ds_read_b32 v159, v5 offset:3120
    v_lshrrev_b32 v6, 3, v0
    buffer_load_dwordx4 v246, s[32:35], s99 offen offset:2048  lds
    v_mul_u32_u24 v6, 4160, v6
    v_and_b32 v7, 7, v0
    v_lshl_add_u32 v6, v7, 2, v6
    v_add_u32 v6, s94, v6
    v_mov_b32 v7, 0
    s_add_u32 m0, s61, 12288
    s_add_u32 s16, s16, s63
    buffer_load_dwordx4 v244, s[32:35], s16 offen offset:0  lds
    s_waitcnt lgkmcnt(0)
    v_readfirstlane_b32 s93, v140
    s_nop 0
    s_lshl_b32 s93, s93, 16
    s_nop 1
    v_writelane_b32 v7, s93, 15
    v_alignbit_b32 v140, v141, v140, 16
    buffer_load_dwordx4 v245, s[32:35], s16 offen offset:1024  lds
    v_alignbit_b32 v141, v142, v141, 16
    v_alignbit_b32 v142, v143, v142, 16
    v_alignbit_b32 v143, v156, v143, 16
    v_alignbit_b32 v144, v145, v144, 16
    v_alignbit_b32 v145, v146, v145, 16
    buffer_load_dwordx4 v246, s[32:35], s16 offen offset:2048  lds
    v_alignbit_b32 v146, v147, v146, 16
    v_alignbit_b32 v147, v157, v147, 16
    v_alignbit_b32 v148, v149, v148, 16
    v_alignbit_b32 v149, v150, v149, 16
    v_alignbit_b32 v150, v151, v150, 16
    s_mov_b64 exec, 0xff
    buffer_load_dword v136, v33, s[68:71], 0 offen sc1
    buffer_load_dword v137, v34, s[52:55], 0 offen sc1
    s_mov_b64 exec, -1
    v_alignbit_b32 v151, v158, v151, 16
    v_alignbit_b32 v152, v153, v152, 16
    v_alignbit_b32 v153, v154, v153, 16
    v_alignbit_b32 v154, v155, v154, 16
    v_alignbit_b32 v155, v159, v155, 16
    v_lshlrev_b32 v8, 3, v0
    s_add_u32 s78, s88, 18432
    v_add_u32 v8, s78, v8
    v_mov_b32 v156, 0
    v_mov_b32 v157, 0
    s_waitcnt vmcnt(8)
    s_waitcnt vmcnt(2)
    s_barrier
    s_waitcnt vmcnt(0)
    s_branch LA_j
LA_c1:
    s_waitcnt vmcnt(11)
    s_barrier
    s_mul_i32 s16, s97, 3072
    s_add_u32 m0, s60, 49152
    s_add_u32 s99, s16, s62
    buffer_load_dwordx4 v244, s[32:35], s99 offen offset:0  lds
    buffer_load_dwordx4 v245, s[32:35], s99 offen offset:1024  lds
    buffer_load_dwordx4 v246, s[32:35], s99 offen offset:2048  lds
    s_add_u32 m0, s61, 61440
    s_add_u32 s16, s16, s63
    buffer_load_dwordx4 v244, s[32:35], s16 offen offset:0  lds
    buffer_load_dwordx4 v245, s[32:35], s16 offen offset:1024  lds
    buffer_load_dwordx4 v246, s[32:35], s16 offen offset:2048  lds
    s_add_u32 s97, s98, s0
    s_lshr_b64 s[0:1], s[0:1], 4
    s_and_b32 s97, s97, 15
    s_lshr_b32 s99, s97, 3
    s_xor_b32 s97, s97, s99
    s_add_u32 m0, s87, 0
    s_lshl_b32 s97, s97, 7
    buffer_load_dwordx4 v240, s[28:31], s97 offen offset:0  lds
    buffer_load_dwordx4 v241, s[28:31], s97 offen offset:1024  lds
    buffer_load_dwordx4 v242, s[28:31], s97 offen offset:2048  lds
    buffer_load_dwordx4 v243, s[28:31], s97 offen offset:3072  lds
    s_add_u32 m0, s88, 0
    s_mov_b64 exec, 0xffffffff
    buffer_load_dwordx4 v3, s[28:31], s97 offen offset:0  lds
    s_mov_b64 exec, -1
    s_waitcnt vmcnt(11)
    s_barrier
    s_mul_i32 s16, s97, 3072
    s_add_u32 m0, s60, 0
    s_add_u32 s99, s16, s62
    buffer_load_dwordx4 v244, s[32:35], s99 offen offset:0  lds
    buffer_load_dwordx4 v245, s[32:35], s99 offen offset:1024  lds
    buffer_load_dwordx4 v246, s[32:35], s99 offen offset:2048  lds
    s_add_u32 m0, s61, 12288
    s_add_u32 s16, s16, s63
    buffer_load_dwordx4 v244, s[32:35], s16 offen offset:0  lds
    buffer_load_dwordx4 v245, s[32:35], s16 offen offset:1024  lds
    buffer_load_dwordx4 v246, s[32:35], s16 offen offset:2048  lds
    s_add_u32 m0, s86, 129536
    s_mov_b32 s89, 0
    buffer_load_dwordx4 v10, s[36:39], s89 offen nt lds
    s_add_u32 m0, s86, 145920
    s_mov_b32 s89, 0
    buffer_load_dwordx4 v10, s[40:43], s89 offen nt lds
    s_add_u32 m0, s86, 133632
    s_mov_b32 s89, 65536
    buffer_load_dwordx4 v10, s[36:39], s89 offen nt lds
    s_add_u32 m0, s86, 150016
    s_mov_b32 s89, 65536
    buffer_load_dwordx4 v10, s[40:43], s89 offen nt lds
    s_add_u32 m0, s86, 137728
    s_mov_b32 s89, 131072
    buffer_load_dwordx4 v10, s[36:39], s89 offen nt lds
    s_add_u32 m0, s86, 154112
    s_mov_b32 s89, 131072
    buffer_load_dwordx4 v10, s[40:43], s89 offen nt lds
    s_add_u32 m0, s86, 141824
    s_mov_b32 s89, 196608
    buffer_load_dwordx4 v10, s[36:39], s89 offen nt lds
    s_add_u32 m0, s86, 158208
    s_mov_b32 s89, 196608
    buffer_load_dwordx4 v10, s[40:43], s89 offen nt lds
    s_mov_b64 exec, 0xff
    s_lshl_b32 s82, s3, 7
    s_add_u32 m0, s82, 129024
    s_mov_b32 s89, 0
    buffer_load_dwordx4 v11, s[36:39], s89 offen nt lds
    s_lshl_b32 s83, s74, 9
    s_add_u32 s83, s83, s82
    s_and_b32 s89, s3, 2
    s_lshl_b32 s89, s89, 3
    s_add_u32 s82, s82, s89
    s_add_u32 m0, s82, 162816
    s_add_u32 s89, s83, 0
    buffer_load_dwordx4 v15, s[44:47], s89 offen  lds
    s_mov_b64 exec, -1
    s_add_u32 s97, s98, s0
    s_lshr_b64 s[0:1], s[0:1], 4
    s_and_b32 s97, s97, 15
    s_lshr_b32 s99, s97, 3
    s_xor_b32 s97, s97, s99
    s_add_u32 m0, s87, 18432
    s_lshl_b32 s97, s97, 7
    buffer_load_dwordx4 v240, s[28:31], s97 offen offset:0  lds
    s_waitcnt vmcnt(17)
    s_barrier
    buffer_load_dwordx4 v241, s[28:31], s97 offen offset:1024  lds
    buffer_load_dwordx4 v242, s[28:31], s97 offen offset:2048  lds
    buffer_load_dwordx4 v243, s[28:31], s97 offen offset:3072  lds
    s_add_u32 m0, s88, 18432
    s_mov_b64 exec, 0xffffffff
    buffer_load_dwordx4 v3, s[28:31], s97 offen offset:0  lds
    s_mov_b64 exec, -1
    s_mul_i32 s16, s97, 3072
    s_add_u32 m0, s60, 24576
    s_add_u32 s99, s16, s62
    buffer_load_dwordx4 v244, s[32:35], s99 offen offset:0  lds
    buffer_load_dwordx4 v245, s[32:35], s99 offen offset:1024  lds
    buffer_load_dwordx4 v246, s[32:35], s99 offen offset:2048  lds
    s_add_u32 m0, s61, 36864
    s_add_u32 s16, s16, s63
    buffer_load_dwordx4 v244, s[32:35], s16 offen offset:0  lds
    buffer_load_dwordx4 v245, s[32:35], s16 offen offset:1024  lds
    buffer_load_dwordx4 v246, s[32:35], s16 offen offset:2048  lds
    s_add_u32 s97, s98, s0
    s_lshr_b64 s[0:1], s[0:1], 4
    s_and_b32 s97, s97, 15
    s_lshr_b32 s99, s97, 3
    s_xor_b32 s97, s97, s99
    s_add_u32 m0, s87, 36864
    s_lshl_b32 s97, s97, 7
    buffer_load_dwordx4 v240, s[28:31], s97 offen offset:0  lds
    buffer_load_dwordx4 v241, s[28:31], s97 offen offset:1024  lds
    buffer_load_dwordx4 v242, s[28:31], s97 offen offset:2048  lds
    buffer_load_dwordx4 v243, s[28:31], s97 offen offset:3072  lds
    s_add_u32 m0, s88, 36864
    s_mov_b64 exec, 0xffffffff
    buffer_load_dwordx4 v3, s[28:31], s97 offen offset:0  lds
    s_mov_b64 exec, -1
    s_waitcnt vmcnt(11)
    s_barrier
    s_mul_i32 s16, s97, 3072
    s_add_u32 m0, s60, 49152
    s_add_u32 s99, s16, s62
    buffer_load_dwordx4 v244, s[32:35], s99 offen offset:0  lds
    ds_read_b128 v[84:87], v35 offset:0
    ds_read_b128 v[88:91], v35 offset:16
    buffer_load_dwordx4 v245, s[32:35], s99 offen offset:1024  lds
    ds_read_b64 v[40:41], v16 offset:0
    ds_read_b64 v[42:43], v231 offset:256
    buffer_load_dwordx4 v246, s[32:35], s99 offen offset:2048  lds
    ds_read_b64 v[44:45], v16 offset:256
    ds_read_b64 v[46:47], v16 offset:512
    s_add_u32 m0, s61, 61440
    s_add_u32 s16, s16, s63
    buffer_load_dwordx4 v244, s[32:35], s16 offen offset:0  lds
    ds_read_b64 v[48:49], v231 offset:512
    ds_read_b64 v[50:51], v16 offset:768
    buffer_load_dwordx4 v245, s[32:35], s16 offen offset:1024  lds
    ds_read_b64 v[52:53], v231 offset:768
    ds_read_b64 v[54:55], v16 offset:1024
    buffer_load_dwordx4 v246, s[32:35], s16 offen offset:2048  lds
    ds_read_b64 v[56:57], v231 offset:1024
    ds_read_b64 v[58:59], v16 offset:1280
    s_add_u32 s97, s98, s0
    s_lshr_b64 s[0:1], s[0:1], 4
    s_and_b32 s97, s97, 15
    s_lshr_b32 s99, s97, 3
    s_xor_b32 s97, s97, s99
    s_add_u32 m0, s87, 0
    s_lshl_b32 s97, s97, 7
    buffer_load_dwordx4 v240, s[28:31], s97 offen offset:0  lds
    ds_read_b64 v[60:61], v231 offset:1280
    ds_read_b64 v[68:69], v16 offset:16896
    buffer_load_dwordx4 v241, s[28:31], s97 offen offset:1024  lds
    ds_read_b64 v[70:71], v231 offset:16896
    ds_read_b64 v[72:73], v16 offset:17152
    buffer_load_dwordx4 v242, s[28:31], s97 offen offset:2048  lds
    ds_read_b64 v[74:75], v231 offset:17152
    ds_read_b64 v[76:77], v16 offset:17408
    buffer_load_dwordx4 v243, s[28:31], s97 offen offset:3072  lds
    ds_read_b64 v[78:79], v231 offset:17408
    ds_read_b64 v[80:81], v16 offset:17664
    s_add_u32 m0, s88, 0
    s_mov_b64 exec, 0xffffffff
    buffer_load_dwordx4 v3, s[28:31], s97 offen offset:0  lds
    s_mov_b64 exec, -1
    ds_read_b64 v[82:83], v231 offset:17664
    s_waitcnt vmcnt(11)
    s_waitcnt lgkmcnt(0)
    s_barrier
    s_mul_i32 s16, s97, 3072
    s_add_u32 m0, s60, 0
    s_add_u32 s99, s16, s62
    buffer_load_dwordx4 v244, s[32:35], s99 offen offset:0  lds
    v_lshlrev_b32 v160, 16, v40
    v_lshlrev_b32 v161, 16, v42
    v_lshlrev_b32 v162, 16, v44
    v_lshlrev_b32 v163, 16, v46
    v_lshlrev_b32 v164, 16, v48
    buffer_load_dwordx4 v245, s[32:35], s99 offen offset:1024  lds
    v_lshlrev_b32 v165, 16, v50
    v_lshlrev_b32 v166, 16, v52
    v_lshlrev_b32 v167, 16, v54
    v_lshlrev_b32 v168, 16, v56
    v_lshlrev_b32 v169, 16, v58
    buffer_load_dwordx4 v246, s[32:35], s99 offen offset:2048  lds
    v_lshlrev_b32 v170, 16, v60
    v_lshlrev_b32 v172, 16, v84
    v_and_b32 v173, 0xffff0000, v84
    v_lshlrev_b32 v174, 16, v85
    v_and_b32 v175, 0xffff0000, v85
    s_add_u32 m0, s61, 12288
    s_add_u32 s16, s16, s63
    buffer_load_dwordx4 v244, s[32:35], s16 offen offset:0  lds
    v_lshlrev_b32 v176, 16, v68
    v_lshlrev_b32 v177, 16, v70
    v_lshlrev_b32 v178, 16, v72
    v_lshlrev_b32 v179, 16, v74
    v_lshlrev_b32 v180, 16, v76
    buffer_load_dwordx4 v245, s[32:35], s16 offen offset:1024  lds
    v_lshlrev_b32 v181, 16, v78
    v_lshlrev_b32 v182, 16, v80
    v_lshlrev_b32 v183, 16, v82
    v_mul_f32 v184, v160, v175
    v_mul_f32 v185, v161, v175
    buffer_load_dwordx4 v246, s[32:35], s16 offen offset:2048  lds
    v_mul_f32 v186, v162, v175
    v_mul_f32 v187, v163, v175
    v_mul_f32 v188, v164, v175
    v_mul_f32 v189, v165, v175
    v_mul_f32 v190, v166, v175
    s_add_u32 s97, s98, s0
    s_lshr_b64 s[0:1], s[0:1], 4
    s_and_b32 s97, s97, 15
    s_lshr_b32 s99, s97, 3
    s_xor_b32 s97, s97, s99
    s_add_u32 m0, s87, 18432
    s_lshl_b32 s97, s97, 7
    buffer_load_dwordx4 v240, s[28:31], s97 offen offset:0  lds
    v_mul_f32 v191, v167, v175
    v_fmac_f32 v184, v161, v174
    v_fmac_f32 v185, v162, v174
    v_fmac_f32 v186, v163, v174
    v_fmac_f32 v187, v164, v174
    buffer_load_dwordx4 v241, s[28:31], s97 offen offset:1024  lds
    v_fmac_f32 v188, v165, v174
    v_fmac_f32 v189, v166, v174
    v_fmac_f32 v190, v167, v174
    v_fmac_f32 v191, v168, v174
    v_fmac_f32 v184, v162, v173
    buffer_load_dwordx4 v242, s[28:31], s97 offen offset:2048  lds
    v_fmac_f32 v185, v163, v173
    v_fmac_f32 v186, v164, v173
    v_fmac_f32 v187, v165, v173
    v_fmac_f32 v188, v166, v173
    v_fmac_f32 v189, v167, v173
    buffer_load_dwordx4 v243, s[28:31], s97 offen offset:3072  lds
    v_fmac_f32 v190, v168, v173
    v_fmac_f32 v191, v169, v173
    v_fmac_f32 v184, v163, v172
    v_fmac_f32 v185, v164, v172
    v_fmac_f32 v186, v165, v172
    s_add_u32 m0, s88, 18432
    s_mov_b64 exec, 0xffffffff
    buffer_load_dwordx4 v3, s[28:31], s97 offen offset:0  lds
    s_mov_b64 exec, -1
    v_fmac_f32 v187, v166, v172
    v_fmac_f32 v188, v167, v172
    v_fmac_f32 v189, v168, v172
    v_fmac_f32 v190, v169, v172
    v_fmac_f32 v191, v170, v172
    v_mul_f32 v184, v184, v176
    v_mul_f32 v185, v185, v177
    v_mul_f32 v186, v186, v178
    v_mul_f32 v187, v187, v179
    v_mul_f32 v188, v188, v180
    v_mul_f32 v189, v189, v181
    v_mul_f32 v190, v190, v182
    v_mul_f32 v191, v191, v183
    v_cvt_pk_bf16_f32 v100, v191, v190
    v_cvt_pk_bf16_f32 v101, v189, v188
    v_cvt_pk_bf16_f32 v102, v187, v186
    v_cvt_pk_bf16_f32 v103, v185, v184
    s_mov_b32 s89, 0
    buffer_store_dwordx4 v[100:103], v12, s[52:55], s89 offen sc1
    s_waitcnt vmcnt(12)
    s_barrier
    s_mul_i32 s16, s97, 3072
    s_add_u32 m0, s60, 24576
    s_add_u32 s99, s16, s62
    buffer_load_dwordx4 v244, s[32:35], s99 offen offset:0  lds
    v_and_b32 v160, 0xffff0000, v40
    v_and_b32 v161, 0xffff0000, v42
    v_and_b32 v162, 0xffff0000, v44
    v_and_b32 v163, 0xffff0000, v46
    v_and_b32 v164, 0xffff0000, v48
    buffer_load_dwordx4 v245, s[32:35], s99 offen offset:1024  lds
    v_and_b32 v165, 0xffff0000, v50
    v_and_b32 v166, 0xffff0000, v52
    v_and_b32 v167, 0xffff0000, v54
    v_and_b32 v168, 0xffff0000, v56
    v_and_b32 v169, 0xffff0000, v58
    buffer_load_dwordx4 v246, s[32:35], s99 offen offset:2048  lds
    v_and_b32 v170, 0xffff0000, v60
    v_lshlrev_b32 v172, 16, v86
    v_and_b32 v173, 0xffff0000, v86
    v_lshlrev_b32 v174, 16, v87
    v_and_b32 v175, 0xffff0000, v87
    s_add_u32 m0, s61, 36864
    s_add_u32 s16, s16, s63
    buffer_load_dwordx4 v244, s[32:35], s16 offen offset:0  lds
    v_and_b32 v176, 0xffff0000, v68
    v_and_b32 v177, 0xffff0000, v70
    v_and_b32 v178, 0xffff0000, v72
    v_and_b32 v179, 0xffff0000, v74
    v_and_b32 v180, 0xffff0000, v76
    buffer_load_dwordx4 v245, s[32:35], s16 offen offset:1024  lds
    v_and_b32 v181, 0xffff0000, v78
    v_and_b32 v182, 0xffff0000, v80
    v_and_b32 v183, 0xffff0000, v82
    v_mul_f32 v184, v160, v175
    v_mul_f32 v185, v161, v175
    buffer_load_dwordx4 v246, s[32:35], s16 offen offset:2048  lds
    v_mul_f32 v186, v162, v175
    v_mul_f32 v187, v163, v175
    v_mul_f32 v188, v164, v175
    v_mul_f32 v189, v165, v175
    v_mul_f32 v190, v166, v175
    buffer_load_dword v230, v229, s[4:7], 0 offen
    v_mul_f32 v191, v167, v175
    v_fmac_f32 v184, v161, v174
    v_fmac_f32 v185, v162, v174
    v_fmac_f32 v186, v163, v174
    v_fmac_f32 v187, v164, v174
    buffer_load_dword v230, v228, s[32:35], 0 offen
    v_fmac_f32 v188, v165, v174
    v_fmac_f32 v189, v166, v174
    v_fmac_f32 v190, v167, v174
    v_fmac_f32 v191, v168, v174
    v_fmac_f32 v184, v162, v173
    s_add_u32 s97, s98, s0
    s_lshr_b64 s[0:1], s[0:1], 4
    s_and_b32 s97, s97, 15
    s_lshr_b32 s99, s97, 3
    s_xor_b32 s97, s97, s99
    s_add_u32 m0, s87, 36864
    s_lshl_b32 s97, s97, 7
    buffer_load_dwordx4 v240, s[28:31], s97 offen offset:0  lds
    v_fmac_f32 v185, v163, v173
    v_fmac_f32 v186, v164, v173
    v_fmac_f32 v187, v165, v173
    v_fmac_f32 v188, v166, v173
    v_fmac_f32 v189, v167, v173
    buffer_load_dwordx4 v241, s[28:31], s97 offen offset:1024  lds
    v_fmac_f32 v190, v168, v173
    v_fmac_f32 v191, v169, v173
    v_fmac_f32 v184, v163, v172
    v_fmac_f32 v185, v164, v172
    v_fmac_f32 v186, v165, v172
    buffer_load_dwordx4 v242, s[28:31], s97 offen offset:2048  lds
    v_fmac_f32 v187, v166, v172
    v_fmac_f32 v188, v167, v172
    v_fmac_f32 v189, v168, v172
    v_fmac_f32 v190, v169, v172
    v_fmac_f32 v191, v170, v172
    buffer_load_dwordx4 v243, s[28:31], s97 offen offset:3072  lds
    v_mul_f32 v184, v184, v176
    v_mul_f32 v185, v185, v177
    v_mul_f32 v186, v186, v178
    v_mul_f32 v187, v187, v179
    v_mul_f32 v188, v188, v180
    s_add_u32 m0, s88, 36864
    s_mov_b64 exec, 0xffffffff
    buffer_load_dwordx4 v3, s[28:31], s97 offen offset:0  lds
    s_mov_b64 exec, -1
    v_mul_f32 v189, v189, v181
    v_mul_f32 v190, v190, v182
    v_mul_f32 v191, v191, v183
    v_cvt_pk_bf16_f32 v104, v191, v190
    v_cvt_pk_bf16_f32 v105, v189, v188
    v_cvt_pk_bf16_f32 v106, v187, v186
    v_cvt_pk_bf16_f32 v107, v185, v184
    s_mov_b32 s89, 16384
    buffer_store_dwordx4 v[104:107], v12, s[52:55], s89 offen sc1
    s_waitcnt vmcnt(15)
    s_barrier
    s_mul_i32 s16, s97, 3072
    s_add_u32 m0, s60, 49152
    s_add_u32 s99, s16, s62
    buffer_load_dwordx4 v244, s[32:35], s99 offen offset:0  lds
    v_lshlrev_b32 v160, 16, v41
    v_lshlrev_b32 v161, 16, v43
    v_lshlrev_b32 v162, 16, v45
    v_lshlrev_b32 v163, 16, v47
    v_lshlrev_b32 v164, 16, v49
    buffer_load_dwordx4 v245, s[32:35], s99 offen offset:1024  lds
    v_lshlrev_b32 v165, 16, v51
    v_lshlrev_b32 v166, 16, v53
    v_lshlrev_b32 v167, 16, v55
    v_lshlrev_b32 v168, 16, v57
    v_lshlrev_b32 v169, 16, v59
    buffer_load_dwordx4 v246, s[32:35], s99 offen offset:2048  lds
    v_lshlrev_b32 v170, 16, v61
    v_lshlrev_b32 v172, 16, v88
    v_and_b32 v173, 0xffff0000, v88
    v_lshlrev_b32 v174, 16, v89
    v_and_b32 v175, 0xffff0000, v89
    s_add_u32 m0, s61, 61440
    s_add_u32 s16, s16, s63
    buffer_load_dwordx4 v244, s[32:35], s16 offen offset:0  lds
    v_lshlrev_b32 v176, 16, v69
    v_lshlrev_b32 v177, 16, v71
    v_lshlrev_b32 v178, 16, v73
    v_lshlrev_b32 v179, 16, v75
    v_lshlrev_b32 v180, 16, v77
    buffer_load_dwordx4 v245, s[32:35], s16 offen offset:1024  lds
    v_lshlrev_b32 v181, 16, v79
    v_lshlrev_b32 v182, 16, v81
    v_lshlrev_b32 v183, 16, v83
    v_mul_f32 v184, v160, v175
    v_mul_f32 v185, v161, v175
    buffer_load_dwordx4 v246, s[32:35], s16 offen offset:2048  lds
    v_mul_f32 v186, v162, v175
    v_mul_f32 v187, v163, v175
    v_mul_f32 v188, v164, v175
    v_mul_f32 v189, v165, v175
    v_mul_f32 v190, v166, v175
    s_add_u32 s97, s98, s0
    s_lshr_b64 s[0:1], s[0:1], 4
    s_and_b32 s97, s97, 15
    s_lshr_b32 s99, s97, 3
    s_xor_b32 s97, s97, s99
    s_add_u32 m0, s87, 0
    s_lshl_b32 s97, s97, 7
    buffer_load_dwordx4 v240, s[28:31], s97 offen offset:0  lds
    v_mul_f32 v191, v167, v175
    v_fmac_f32 v184, v161, v174
    v_fmac_f32 v185, v162, v174
    v_fmac_f32 v186, v163, v174
    v_fmac_f32 v187, v164, v174
    buffer_load_dwordx4 v241, s[28:31], s97 offen offset:1024  lds
    v_fmac_f32 v188, v165, v174
    v_fmac_f32 v189, v166, v174
    v_fmac_f32 v190, v167, v174
    v_fmac_f32 v191, v168, v174
    v_fmac_f32 v184, v162, v173
    buffer_load_dwordx4 v242, s[28:31], s97 offen offset:2048  lds
    v_fmac_f32 v185, v163, v173
    v_fmac_f32 v186, v164, v173
    v_fmac_f32 v187, v165, v173
    v_fmac_f32 v188, v166, v173
    v_fmac_f32 v189, v167, v173
    buffer_load_dwordx4 v243, s[28:31], s97 offen offset:3072  lds
    v_fmac_f32 v190, v168, v173
    v_fmac_f32 v191, v169, v173
    v_fmac_f32 v184, v163, v172
    v_fmac_f32 v185, v164, v172
    v_fmac_f32 v186, v165, v172
    s_add_u32 m0, s88, 0
    s_mov_b64 exec, 0xffffffff
    buffer_load_dwordx4 v3, s[28:31], s97 offen offset:0  lds
    s_mov_b64 exec, -1
    v_fmac_f32 v187, v166, v172
    v_fmac_f32 v188, v167, v172
    v_fmac_f32 v189, v168, v172
    v_fmac_f32 v190, v169, v172
    v_fmac_f32 v191, v170, v172
    v_mul_f32 v184, v184, v176
    v_mul_f32 v185, v185, v177
    v_mul_f32 v186, v186, v178
    v_mul_f32 v187, v187, v179
    v_mul_f32 v188, v188, v180
    v_mul_f32 v189, v189, v181
    v_mul_f32 v190, v190, v182
    v_mul_f32 v191, v191, v183
    v_cvt_pk_bf16_f32 v108, v191, v190
    v_cvt_pk_bf16_f32 v109, v189, v188
    v_cvt_pk_bf16_f32 v110, v187, v186
    v_cvt_pk_bf16_f32 v111, v185, v184
    s_mov_b32 s89, 32768
    buffer_store_dwordx4 v[108:111], v12, s[52:55], s89 offen sc1
    s_waitcnt vmcnt(13)
    s_barrier
    s_mul_i32 s16, s97, 3072
    s_add_u32 m0, s60, 0
    s_add_u32 s99, s16, s62
    buffer_load_dwordx4 v244, s[32:35], s99 offen offset:0  lds
    v_and_b32 v160, 0xffff0000, v41
    v_and_b32 v161, 0xffff0000, v43
    v_and_b32 v162, 0xffff0000, v45
    v_and_b32 v163, 0xffff0000, v47
    v_and_b32 v164, 0xffff0000, v49
    buffer_load_dwordx4 v245, s[32:35], s99 offen offset:1024  lds
    v_and_b32 v165, 0xffff0000, v51
    v_and_b32 v166, 0xffff0000, v53
    v_and_b32 v167, 0xffff0000, v55
    v_and_b32 v168, 0xffff0000, v57
    v_and_b32 v169, 0xffff0000, v59
    buffer_load_dwordx4 v246, s[32:35], s99 offen offset:2048  lds
    v_and_b32 v170, 0xffff0000, v61
    v_lshlrev_b32 v172, 16, v90
    v_and_b32 v173, 0xffff0000, v90
    v_lshlrev_b32 v174, 16, v91
    v_and_b32 v175, 0xffff0000, v91
    s_add_u32 m0, s61, 12288
    s_add_u32 s16, s16, s63
    buffer_load_dwordx4 v244, s[32:35], s16 offen offset:0  lds
    v_and_b32 v176, 0xffff0000, v69
    v_and_b32 v177, 0xffff0000, v71
    v_and_b32 v178, 0xffff0000, v73
    v_and_b32 v179, 0xffff0000, v75
    v_and_b32 v180, 0xffff0000, v77
    buffer_load_dwordx4 v245, s[32:35], s16 offen offset:1024  lds
    v_and_b32 v181, 0xffff0000, v79
    v_and_b32 v182, 0xffff0000, v81
    v_and_b32 v183, 0xffff0000, v83
    v_mul_f32 v184, v160, v175
    v_mul_f32 v185, v161, v175
    buffer_load_dwordx4 v246, s[32:35], s16 offen offset:2048  lds
    v_mul_f32 v186, v162, v175
    v_mul_f32 v187, v163, v175
    v_mul_f32 v188, v164, v175
    v_mul_f32 v189, v165, v175
    v_mul_f32 v190, v166, v175
    s_add_u32 s97, s98, s0
    s_lshr_b64 s[0:1], s[0:1], 4
    s_and_b32 s97, s97, 15
    s_lshr_b32 s99, s97, 3
    s_xor_b32 s97, s97, s99
    s_add_u32 m0, s87, 18432
    s_lshl_b32 s97, s97, 7
    buffer_load_dwordx4 v240, s[28:31], s97 offen offset:0  lds
    v_mul_f32 v191, v167, v175
    v_fmac_f32 v184, v161, v174
    v_fmac_f32 v185, v162, v174
    v_fmac_f32 v186, v163, v174
    v_fmac_f32 v187, v164, v174
    buffer_load_dwordx4 v241, s[28:31], s97 offen offset:1024  lds
    v_fmac_f32 v188, v165, v174
    v_fmac_f32 v189, v166, v174
    v_fmac_f32 v190, v167, v174
    v_fmac_f32 v191, v168, v174
    v_fmac_f32 v184, v162, v173
    buffer_load_dwordx4 v242, s[28:31], s97 offen offset:2048  lds
    v_fmac_f32 v185, v163, v173
    v_fmac_f32 v186, v164, v173
    v_fmac_f32 v187, v165, v173
    v_fmac_f32 v188, v166, v173
    v_fmac_f32 v189, v167, v173
    buffer_load_dwordx4 v243, s[28:31], s97 offen offset:3072  lds
    v_fmac_f32 v190, v168, v173
    v_fmac_f32 v191, v169, v173
    v_fmac_f32 v184, v163, v172
    v_fmac_f32 v185, v164, v172
    v_fmac_f32 v186, v165, v172
    s_add_u32 m0, s88, 18432
    s_mov_b64 exec, 0xffffffff
    buffer_load_dwordx4 v3, s[28:31], s97 offen offset:0  lds
    s_mov_b64 exec, -1
    v_fmac_f32 v187, v166, v172
    v_fmac_f32 v188, v167, v172
    v_fmac_f32 v189, v168, v172
    v_fmac_f32 v190, v169, v172
    v_fmac_f32 v191, v170, v172
    v_mul_f32 v184, v184, v176
    v_mul_f32 v185, v185, v177
    v_mul_f32 v186, v186, v178
    v_mul_f32 v187, v187, v179
    v_mul_f32 v188, v188, v180
    v_mul_f32 v189, v189, v181
    v_mul_f32 v190, v190, v182
    v_mul_f32 v191, v191, v183
    v_cvt_pk_bf16_f32 v112, v191, v190
    v_cvt_pk_bf16_f32 v113, v189, v188
    v_cvt_pk_bf16_f32 v114, v187, v186
    v_cvt_pk_bf16_f32 v115, v185, v184
    s_mov_b32 s89, 49152
    buffer_store_dwordx4 v[112:115], v12, s[52:55], s89 offen sc1
    s_waitcnt vmcnt(13)
    s_barrier
    s_mul_i32 s16, s97, 3072
    s_add_u32 m0, s60, 24576
    s_add_u32 s99, s16, s62
    buffer_load_dwordx4 v244, s[32:35], s99 offen offset:0  lds
    buffer_load_dwordx4 v245, s[32:35], s99 offen offset:1024  lds
    buffer_load_dwordx4 v246, s[32:35], s99 offen offset:2048  lds
    s_add_u32 m0, s61, 36864
    s_add_u32 s16, s16, s63
    buffer_load_dwordx4 v244, s[32:35], s16 offen offset:0  lds
    buffer_load_dwordx4 v245, s[32:35], s16 offen offset:1024  lds
    buffer_load_dwordx4 v246, s[32:35], s16 offen offset:2048  lds
    s_add_u32 s97, s98, s0
    s_lshr_b64 s[0:1], s[0:1], 4
    s_and_b32 s97, s97, 15
    s_lshr_b32 s99, s97, 3
    s_xor_b32 s97, s97, s99
    s_add_u32 m0, s87, 36864
    s_lshl_b32 s97, s97, 7
    buffer_load_dwordx4 v240, s[28:31], s97 offen offset:0  lds
    buffer_load_dwordx4 v241, s[28:31], s97 offen offset:1024  lds
    buffer_load_dwordx4 v242, s[28:31], s97 offen offset:2048  lds
    buffer_load_dwordx4 v243, s[28:31], s97 offen offset:3072  lds
    s_add_u32 m0, s88, 36864
    s_mov_b64 exec, 0xffffffff
    buffer_load_dwordx4 v3, s[28:31], s97 offen offset:0  lds
    s_mov_b64 exec, -1
    s_waitcnt vmcnt(12)
    s_barrier
    s_mul_i32 s16, s97, 3072
    s_add_u32 m0, s60, 49152
    s_add_u32 s99, s16, s62
    buffer_load_dwordx4 v244, s[32:35], s99 offen offset:0  lds
    buffer_load_dwordx4 v245, s[32:35], s99 offen offset:1024  lds
    buffer_load_dwordx4 v246, s[32:35], s99 offen offset:2048  lds
    s_add_u32 m0, s61, 61440
    s_add_u32 s16, s16, s63
    buffer_load_dwordx4 v244, s[32:35], s16 offen offset:0  lds
    buffer_load_dwordx4 v245, s[32:35], s16 offen offset:1024  lds
    buffer_load_dwordx4 v246, s[32:35], s16 offen offset:2048  lds
    s_add_u32 m0, s94, 32
    s_lshl_b32 s89, s90, 12
    buffer_load_dwordx4 v15, s[48:51], s89 offen offset:0 nt lds
    s_add_u32 m0, s94, 32
    s_lshl_b32 s89, s90, 12
    buffer_load_dwordx4 v15, s[48:51], s89 offen offset:1024 nt lds
    s_add_u32 m0, s94, 32
    s_lshl_b32 s89, s90, 12
    buffer_load_dwordx4 v15, s[48:51], s89 offen offset:2048 nt lds
    s_add_u32 m0, s94, 32
    s_lshl_b32 s89, s90, 12
    buffer_load_dwordx4 v15, s[48:51], s89 offen offset:3072 nt lds
    s_add_u32 s97, s98, s0
    s_lshr_b64 s[0:1], s[0:1], 4
    s_and_b32 s97, s97, 15
    s_lshr_b32 s99, s97, 3
    s_xor_b32 s97, s97, s99
    s_add_u32 m0, s87, 0
    s_lshl_b32 s97, s97, 7
    buffer_load_dwordx4 v240, s[28:31], s97 offen offset:0  lds
    buffer_load_dwordx4 v241, s[28:31], s97 offen offset:1024  lds
    buffer_load_dwordx4 v242, s[28:31], s97 offen offset:2048  lds
    buffer_load_dwordx4 v243, s[28:31], s97 offen offset:3072  lds
    s_add_u32 m0, s88, 0
    s_mov_b64 exec, 0xffffffff
    buffer_load_dwordx4 v3, s[28:31], s97 offen offset:0  lds
    s_mov_b64 exec, -1
    s_waitcnt vmcnt(15)
    s_barrier
    s_mul_i32 s16, s97, 3072
    s_add_u32 m0, s60, 0
    s_add_u32 s99, s16, s62
    buffer_load_dwordx4 v244, s[32:35], s99 offen offset:0  lds
    s_mov_b32 s68, s24
    s_mov_b32 s69, s25
    s_mov_b32 s70, 0x100
    s_mov_b32 s71, 0x20000
    v_lshrrev_b32 v6, 5, v0
    buffer_load_dwordx4 v245, s[32:35], s99 offen offset:1024  lds
    v_and_b32 v7, 3, v0
    s_lshr_b32 s78, s90, 1
    s_lshl_b32 s78, s78, 2
    s_load_dword s92, s[14:15], s78
    v_bfe_u32 v5, v0, 2, 2
    buffer_load_dwordx4 v246, s[32:35], s99 offen offset:2048  lds
    v_lshlrev_b32 v5, 1, v5
    v_lshl_add_u32 v5, v6, 3, v5
    v_bfe_u32 v8, v0, 4, 1
    v_add_u32 v5, v5, v8
    s_and_b32 s78, s3, 1
    s_add_u32 m0, s61, 12288
    s_add_u32 s16, s16, s63
    buffer_load_dwordx4 v244, s[32:35], s16 offen offset:0  lds
    s_lshl_b32 s78, s78, 1
    v_add_u32 v8, s78, v6
    v_xor_b32 v8, v8, v7
    v_lshlrev_b32 v8, 4, v8
    buffer_load_dwordx4 v245, s[32:35], s16 offen offset:1024  lds
    v_lshl_add_u32 v5, v5, 6, v8
    v_add_u32 v14, s86, v5
    v_mov_b32 v18, 162304
    v_mov_b32 v19, 1
    v_and_b32 v5, 3, v0
    buffer_load_dwordx4 v246, s[32:35], s16 offen offset:2048  lds
    s_lshl_b32 s78, s74, 4
    s_add_u32 s78, s78, s3
    v_lshl_add_u32 v6, v5, 2, s78
    s_lshr_b32 s78, s76, 3
    s_lshl_b32 s79, s3, 1
    s_add_u32 s97, s98, s0
    s_lshr_b64 s[0:1], s[0:1], 4
    s_and_b32 s97, s97, 15
    s_lshr_b32 s99, s97, 3
    s_xor_b32 s97, s97, s99
    s_add_u32 m0, s87, 18432
    s_lshl_b32 s97, s97, 7
    buffer_load_dwordx4 v240, s[28:31], s97 offen offset:0  lds
    s_add_u32 s78, s78, s79
    s_xor_b32 s78, s78, 2
    s_lshl_b32 s78, s78, 5
    s_and_b32 s79, s76, 7
    s_add_u32 s78, s78, s79
    buffer_load_dwordx4 v241, s[28:31], s97 offen offset:1024  lds
    v_lshl_add_u32 v7, v5, 3, s78
    v_and_b32 v8, 4, v0
    v_cmp_eq_u32 vcc, 0, v8
    s_nop 1
    v_cndmask_b32 v6, v7, v6, vcc
    buffer_load_dwordx4 v242, s[28:31], s97 offen offset:2048  lds
    v_and_b32 v33, 0xf0, v6
    v_lshlrev_b32 v34, 8, v6
    v_add_u32 v34, 12582912, v34
    v_and_b32 v5, 15, v0
    v_lshrrev_b32 v6, 4, v0
    buffer_load_dwordx4 v243, s[28:31], s97 offen offset:3072  lds
    v_add_u32 v7, 9, v5
    v_and_b32 v8, 1, v7
    v_mul_u32_u24 v8, 4160, v8
    v_lshrrev_b32 v7, 1, v7
    v_lshl_add_u32 v8, v7, 2, v8
    s_add_u32 m0, s88, 18432
    s_mov_b64 exec, 0xffffffff
    buffer_load_dwordx4 v3, s[28:31], s97 offen offset:0  lds
    s_mov_b64 exec, -1
    v_lshlrev_b32 v7, 4, v6
    v_sub_u32 v8, v8, v7
    s_add_u32 s78, s94, 32
    v_add_u32 v21, s78, v8
    s_waitcnt vmcnt(11)
    s_barrier
    s_mul_i32 s16, s97, 3072
    s_add_u32 m0, s60, 24576
    s_add_u32 s99, s16, s62
    buffer_load_dwordx4 v244, s[32:35], s99 offen offset:0  lds
    v_add_u32 v22, 1024, v21
    v_add_u32 v23, 2048, v21
    v_add_u32 v24, 3072, v21
    v_lshl_add_u32 v7, v5, 1, v6
    v_add_u32 v7, 30, v7
    buffer_load_dwordx4 v245, s[32:35], s99 offen offset:1024  lds
    v_and_b32 v8, 1, v7
    v_bfe_u32 v136, v7, 1, 2
    v_lshl_add_u32 v136, v8, 2, v136
    v_lshlrev_b32 v136, 6, v136
    v_lshrrev_b32 v7, 3, v7
    buffer_load_dwordx4 v246, s[32:35], s99 offen offset:2048  lds
    v_lshl_add_u32 v136, v7, 9, v136
    v_bitop3_b32 v8, v7, 3, s3 bitop3:0x6a
    v_lshl_add_u32 v25, v8, 4, v136
    v_add_u32 v25, 92160, v25
    v_subrev_u32 v7, 1, v7
    s_add_u32 m0, s61, 36864
    s_add_u32 s16, s16, s63
    buffer_load_dwordx4 v244, s[32:35], s16 offen offset:0  lds
    v_bitop3_b32 v8, v7, 3, s3 bitop3:0x6a
    v_lshl_add_u32 v27, v8, 4, v136
    v_add_u32 v27, 91648, v27
    v_subrev_u32 v7, 1, v7
    buffer_load_dwordx4 v245, s[32:35], s16 offen offset:1024  lds
    v_bitop3_b32 v8, v7, 3, s3 bitop3:0x6a
    v_lshl_add_u32 v29, v8, 4, v136
    v_add_u32 v29, 91136, v29
    v_subrev_u32 v7, 1, v7
    v_bitop3_b32 v8, v7, 3, s3 bitop3:0x6a
    buffer_load_dwordx4 v246, s[32:35], s16 offen offset:2048  lds
    v_lshl_add_u32 v31, v8, 4, v136
    v_add_u32 v31, 90624, v31
    v_lshl_add_u32 v7, v5, 1, v6
    v_add_u32 v7, 26, v7
    v_and_b32 v8, 1, v7
    s_add_u32 s97, s98, s0
    s_lshr_b64 s[0:1], s[0:1], 4
    s_and_b32 s97, s97, 15
    s_lshr_b32 s99, s97, 3
    s_xor_b32 s97, s97, s99
    s_add_u32 m0, s87, 36864
    s_lshl_b32 s97, s97, 7
    buffer_load_dwordx4 v240, s[28:31], s97 offen offset:0  lds
    v_bfe_u32 v136, v7, 1, 2
    v_lshl_add_u32 v136, v8, 2, v136
    v_lshlrev_b32 v136, 6, v136
    v_lshrrev_b32 v7, 3, v7
    v_lshl_add_u32 v136, v7, 9, v136
    buffer_load_dwordx4 v241, s[28:31], s97 offen offset:1024  lds
    v_bitop3_b32 v8, v7, 3, s3 bitop3:0x6a
    v_lshl_add_u32 v26, v8, 4, v136
    v_add_u32 v26, 92160, v26
    v_subrev_u32 v7, 1, v7
    buffer_load_dwordx4 v242, s[28:31], s97 offen offset:2048  lds
    v_bitop3_b32 v8, v7, 3, s3 bitop3:0x6a
    v_lshl_add_u32 v28, v8, 4, v136
    v_add_u32 v28, 91648, v28
    v_subrev_u32 v7, 1, v7
    v_bitop3_b32 v8, v7, 3, s3 bitop3:0x6a
    buffer_load_dwordx4 v243, s[28:31], s97 offen offset:3072  lds
    v_lshl_add_u32 v30, v8, 4, v136
    v_add_u32 v30, 91136, v30
    v_subrev_u32 v7, 1, v7
    v_bitop3_b32 v8, v7, 3, s3 bitop3:0x6a
    v_lshl_add_u32 v32, v8, 4, v136
    s_add_u32 m0, s88, 36864
    s_mov_b64 exec, 0xffffffff
    buffer_load_dwordx4 v3, s[28:31], s97 offen offset:0  lds
    s_mov_b64 exec, -1
    v_add_u32 v32, 90624, v32
    v_lshrrev_b32 v7, 1, v6
    v_lshl_add_u32 v7, v5, 1, v7
    v_add_u32 v7, 32, v7
    s_waitcnt vmcnt(11)
    s_barrier
    s_mul_i32 s16, s97, 3072
    s_add_u32 m0, s60, 49152
    s_add_u32 s99, s16, s62
    buffer_load_dwordx4 v244, s[32:35], s99 offen offset:0  lds
    v_and_b32 v8, 1, v7
    v_bfe_u32 v136, v7, 1, 2
    v_lshl_add_u32 v136, v8, 2, v136
    v_lshlrev_b32 v136, 6, v136
    buffer_load_dwordx4 v245, s[32:35], s99 offen offset:1024  lds
    v_lshrrev_b32 v7, 3, v7
    v_lshl_add_u32 v136, v7, 9, v136
    v_bitop3_b32 v8, v7, 3, s3 bitop3:0x6a
    v_lshl_add_u32 v20, v8, 4, v136
    buffer_load_dwordx4 v246, s[32:35], s99 offen offset:2048  lds
    v_add_u32 v20, 92160, v20
    v_and_b32 v8, 1, v6
    v_xor_b32 v8, 1, v8
    v_lshl_add_u32 v20, v8, 3, v20
    s_add_u32 m0, s61, 61440
    s_add_u32 s16, s16, s63
    buffer_load_dwordx4 v244, s[32:35], s16 offen offset:0  lds
    s_waitcnt lgkmcnt(0)
    s_and_b32 s78, s92, 0xffff0000
    s_lshl_b32 s92, s92, 16
    s_bitcmp1_b32 s90, 0
    s_cselect_b32 s92, s78, s92
    buffer_load_dwordx4 v245, s[32:35], s16 offen offset:1024  lds
    v_lshlrev_b32 v7, 3, v6
    v_sub_u32 v7, v7, v5
    v_subrev_u32 v7, 9, v7
    v_and_b32 v8, 1, v7
    buffer_load_dwordx4 v246, s[32:35], s16 offen offset:2048  lds
    v_xor_b32 v8, 1, v8
    v_lshlrev_b32 v8, 4, v8
    v_lshrrev_b32 v8, v8, s92
    v_ashrrev_i32 v7, 1, v7
    s_add_u32 s97, s98, s0
    s_lshr_b64 s[0:1], s[0:1], 4
    s_and_b32 s97, s97, 15
    s_lshr_b32 s99, s97, 3
    s_xor_b32 s97, s97, s99
    s_add_u32 m0, s87, 0
    s_lshl_b32 s97, s97, 7
    buffer_load_dwordx4 v240, s[28:31], s97 offen offset:0  lds
    v_cmp_eq_u32 vcc, 0, v7
    s_nop 1
    v_cndmask_b32 v236, 0, v8, vcc
    v_cmp_eq_u32 vcc, 1, v7
    s_nop 1
    v_cndmask_b32 v237, 0, v8, vcc
    buffer_load_dwordx4 v241, s[28:31], s97 offen offset:1024  lds
    v_cmp_eq_u32 vcc, 2, v7
    s_nop 1
    v_cndmask_b32 v238, 0, v8, vcc
    v_cmp_eq_u32 vcc, 3, v7
    s_nop 1
    v_cndmask_b32 v239, 0, v8, vcc
    buffer_load_dwordx4 v242, s[28:31], s97 offen offset:2048  lds
    s_and_b32 s78, s77, 7
    s_mov_b32 s95, 0x76543210
    s_cmp_eq_u32 s78, 1
    s_cselect_b32 s95, 0x76543201, s95
    s_cmp_eq_u32 s78, 2
    s_cselect_b32 s95, 0x76543120, s95
    s_cmp_eq_u32 s78, 3
    s_cselect_b32 s95, 0x76542310, s95
    s_cmp_eq_u32 s78, 4
    s_cselect_b32 s95, 0x76534210, s95
    s_cmp_eq_u32 s78, 5
    s_cselect_b32 s95, 0x76453210, s95
    s_cmp_eq_u32 s78, 6
    s_cselect_b32 s95, 0x75643210, s95
    s_cmp_eq_u32 s78, 7
    s_cselect_b32 s95, 0x67543210, s95
    s_and_b32 s78, s76, 3
    s_mul_i32 s78, s78, 0x22222222
    s_add_u32 s95, s95, s78
    s_bfe_u32 s100, s95, 0x3001c
    s_lshl_b32 s100, s100, 18
    s_bfe_u32 s95, s95, 0x30018
    s_lshl_b32 s95, s95, 18
    v_lshrrev_b32 v136, 4, v0
    v_lshlrev_b32 v136, 1, v136
    v_and_b32 v137, 7, v0
    buffer_load_dwordx4 v243, s[28:31], s97 offen offset:3072  lds
    v_xor_b32 v136, v136, v137
    v_lshlrev_b32 v136, 4, v136
    v_lshrrev_b32 v137, 3, v0
    v_lshl_add_u32 v136, v137, 11, v136
    s_add_u32 m0, s88, 0
    s_mov_b64 exec, 0xffffffff
    buffer_load_dwordx4 v3, s[28:31], s97 offen offset:0  lds
    s_mov_b64 exec, -1
    s_lshl_b32 s78, s77, 7
    s_lshl_b32 s79, s3, 14
    s_add_u32 s78, s78, s79
    v_add_u32 v17, s78, v136
    s_waitcnt vmcnt(11)
    s_barrier
    s_mul_i32 s16, s97, 3072
    s_add_u32 m0, s60, 0
    s_add_u32 s99, s16, s62
    buffer_load_dwordx4 v244, s[32:35], s99 offen offset:0  lds
    v_add_u32 v5, s94, v15
    ds_read_b128 v[140:143], v5 offset:32
    ds_read_b32 v156, v5 offset:48
    ds_read_b128 v[144:147], v5 offset:1056
    ds_read_b32 v157, v5 offset:1072
    buffer_load_dwordx4 v245, s[32:35], s99 offen offset:1024  lds
    ds_read_b128 v[148:151], v5 offset:2080
    ds_read_b32 v158, v5 offset:2096
    ds_read_b128 v[152:155], v5 offset:3104
    ds_read_b32 v159, v5 offset:3120
    v_lshrrev_b32 v6, 3, v0
    buffer_load_dwordx4 v246, s[32:35], s99 offen offset:2048  lds
    v_mul_u32_u24 v6, 4160, v6
    v_and_b32 v7, 7, v0
    v_lshl_add_u32 v6, v7, 2, v6
    v_add_u32 v6, s94, v6
    v_mov_b32 v7, 0
    s_add_u32 m0, s61, 12288
    s_add_u32 s16, s16, s63
    buffer_load_dwordx4 v244, s[32:35], s16 offen offset:0  lds
    s_waitcnt lgkmcnt(0)
    v_readfirstlane_b32 s93, v140
    s_nop 0
    s_lshl_b32 s93, s93, 16
    s_nop 1
    v_writelane_b32 v7, s93, 15
    v_alignbit_b32 v140, v141, v140, 16
    buffer_load_dwordx4 v245, s[32:35], s16 offen offset:1024  lds
    v_alignbit_b32 v141, v142, v141, 16
    v_alignbit_b32 v142, v143, v142, 16
    v_alignbit_b32 v143, v156, v143, 16
    v_alignbit_b32 v144, v145, v144, 16
    v_alignbit_b32 v145, v146, v145, 16
    buffer_load_dwordx4 v246, s[32:35], s16 offen offset:2048  lds
    v_alignbit_b32 v146, v147, v146, 16
    v_alignbit_b32 v147, v157, v147, 16
    v_alignbit_b32 v148, v149, v148, 16
    v_alignbit_b32 v149, v150, v149, 16
    v_alignbit_b32 v150, v151, v150, 16
    s_mov_b64 exec, 0xff
    buffer_load_dword v136, v33, s[68:71], 0 offen sc1
    buffer_load_dword v137, v34, s[52:55], 0 offen sc1
    s_mov_b64 exec, -1
    v_alignbit_b32 v151, v158, v151, 16
    v_alignbit_b32 v152, v153, v152, 16
    v_alignbit_b32 v153, v154, v153, 16
    v_alignbit_b32 v154, v155, v154, 16
    v_alignbit_b32 v155, v159, v155, 16
    v_lshlrev_b32 v8, 3, v0
    s_add_u32 s78, s88, 18432
    v_add_u32 v8, s78, v8
    v_mov_b32 v156, 0
    v_mov_b32 v157, 0
    s_waitcnt vmcnt(8)
    s_waitcnt vmcnt(2)
    s_barrier
    s_waitcnt vmcnt(0)
    s_branch LA_j
LA_c2:
    s_waitcnt vmcnt(11)
    s_barrier
    s_mul_i32 s16, s97, 3072
    s_add_u32 m0, s60, 49152
    s_add_u32 s99, s16, s62
    buffer_load_dwordx4 v244, s[32:35], s99 offen offset:0  lds
    buffer_load_dwordx4 v245, s[32:35], s99 offen offset:1024  lds
    buffer_load_dwordx4 v246, s[32:35], s99 offen offset:2048  lds
    s_add_u32 m0, s61, 61440
    s_add_u32 s16, s16, s63
    buffer_load_dwordx4 v244, s[32:35], s16 offen offset:0  lds
    buffer_load_dwordx4 v245, s[32:35], s16 offen offset:1024  lds
    buffer_load_dwordx4 v246, s[32:35], s16 offen offset:2048  lds
    s_add_u32 s97, s98, s0
    s_lshr_b64 s[0:1], s[0:1], 4
    s_and_b32 s97, s97, 15
    s_lshr_b32 s99, s97, 3
    s_xor_b32 s97, s97, s99
    s_add_u32 m0, s87, 0
    s_lshl_b32 s97, s97, 7
    buffer_load_dwordx4 v240, s[28:31], s97 offen offset:0  lds
    buffer_load_dwordx4 v241, s[28:31], s97 offen offset:1024  lds
    buffer_load_dwordx4 v242, s[28:31], s97 offen offset:2048  lds
    buffer_load_dwordx4 v243, s[28:31], s97 offen offset:3072  lds
    s_add_u32 m0, s88, 0
    s_mov_b64 exec, 0xffffffff
    buffer_load_dwordx4 v3, s[28:31], s97 offen offset:0  lds
    s_mov_b64 exec, -1
    s_waitcnt vmcnt(11)
    s_barrier
    s_mul_i32 s16, s97, 3072
    s_add_u32 m0, s60, 0
    s_add_u32 s99, s16, s62
    buffer_load_dwordx4 v244, s[32:35], s99 offen offset:0  lds
    buffer_load_dwordx4 v245, s[32:35], s99 offen offset:1024  lds
    buffer_load_dwordx4 v246, s[32:35], s99 offen offset:2048  lds
    s_add_u32 m0, s61, 12288
    s_add_u32 s16, s16, s63
    buffer_load_dwordx4 v244, s[32:35], s16 offen offset:0  lds
    buffer_load_dwordx4 v245, s[32:35], s16 offen offset:1024  lds
    buffer_load_dwordx4 v246, s[32:35], s16 offen offset:2048  lds
    s_add_u32 s97, s98, s0
    s_lshr_b64 s[0:1], s[0:1], 4
    s_and_b32 s97, s97, 15
    s_lshr_b32 s99, s97, 3
    s_xor_b32 s97, s97, s99
    s_add_u32 m0, s87, 18432
    s_lshl_b32 s97, s97, 7
    buffer_load_dwordx4 v240, s[28:31], s97 offen offset:0  lds
    buffer_load_dwordx4 v241, s[28:31], s97 offen offset:1024  lds
    buffer_load_dwordx4 v242, s[28:31], s97 offen offset:2048  lds
    buffer_load_dwordx4 v243, s[28:31], s97 offen offset:3072  lds
    s_add_u32 m0, s88, 18432
    s_mov_b64 exec, 0xffffffff
    buffer_load_dwordx4 v3, s[28:31], s97 offen offset:0  lds
    s_mov_b64 exec, -1
    s_waitcnt vmcnt(11)
    s_barrier
    s_mul_i32 s16, s97, 3072
    s_add_u32 m0, s60, 24576
    s_add_u32 s99, s16, s62
    buffer_load_dwordx4 v244, s[32:35], s99 offen offset:0  lds
    buffer_load_dwordx4 v245, s[32:35], s99 offen offset:1024  lds
    buffer_load_dwordx4 v246, s[32:35], s99 offen offset:2048  lds
    s_add_u32 m0, s61, 36864
    s_add_u32 s16, s16, s63
    buffer_load_dwordx4 v244, s[32:35], s16 offen offset:0  lds
    buffer_load_dwordx4 v245, s[32:35], s16 offen offset:1024  lds
    buffer_load_dwordx4 v246, s[32:35], s16 offen offset:2048  lds
    s_add_u32 m0, s86, 129536
    s_mov_b32 s89, 0
    buffer_load_dwordx4 v10, s[36:39], s89 offen nt lds
    s_add_u32 m0, s86, 145920
    s_mov_b32 s89, 0
    buffer_load_dwordx4 v10, s[40:43], s89 offen nt lds
    s_add_u32 m0, s86, 133632
    s_mov_b32 s89, 65536
    buffer_load_dwordx4 v10, s[36:39], s89 offen nt lds
    s_add_u32 m0, s86, 150016
    s_mov_b32 s89, 65536
    buffer_load_dwordx4 v10, s[40:43], s89 offen nt lds
    s_add_u32 m0, s86, 137728
    s_mov_b32 s89, 131072
    buffer_load_dwordx4 v10, s[36:39], s89 offen nt lds
    s_add_u32 m0, s86, 154112
    s_mov_b32 s89, 131072
    buffer_load_dwordx4 v10, s[40:43], s89 offen nt lds
    s_add_u32 m0, s86, 141824
    s_mov_b32 s89, 196608
    buffer_load_dwordx4 v10, s[36:39], s89 offen nt lds
    s_add_u32 m0, s86, 158208
    s_mov_b32 s89, 196608
    buffer_load_dwordx4 v10, s[40:43], s89 offen nt lds
    s_mov_b64 exec, 0xff
    s_lshl_b32 s82, s3, 7
    s_add_u32 m0, s82, 129024
    s_mov_b32 s89, 0
    buffer_load_dwordx4 v11, s[36:39], s89 offen nt lds
    s_lshl_b32 s83, s74, 9
    s_add_u32 s83, s83, s82
    s_and_b32 s89, s3, 2
    s_lshl_b32 s89, s89, 3
    s_add_u32 s82, s82, s89
    s_add_u32 m0, s82, 162816
    s_add_u32 s89, s83, 0
    buffer_load_dwordx4 v15, s[44:47], s89 offen  lds
    s_mov_b64 exec, -1
    s_add_u32 s97, s98, s0
    s_lshr_b64 s[0:1], s[0:1], 4
    s_and_b32 s97, s97, 15
    s_lshr_b32 s99, s97, 3
    s_xor_b32 s97, s97, s99
    s_add_u32 m0, s87, 36864
    s_lshl_b32 s97, s97, 7
    buffer_load_dwordx4 v240, s[28:31], s97 offen offset:0  lds
    s_waitcnt vmcnt(17)
    s_barrier
    buffer_load_dwordx4 v241, s[28:31], s97 offen offset:1024  lds
    buffer_load_dwordx4 v242, s[28:31], s97 offen offset:2048  lds
    buffer_load_dwordx4 v243, s[28:31], s97 offen offset:3072  lds
    s_add_u32 m0, s88, 36864
    s_mov_b64 exec, 0xffffffff
    buffer_load_dwordx4 v3, s[28:31], s97 offen offset:0  lds
    s_mov_b64 exec, -1
    s_mul_i32 s16, s97, 3072
    s_add_u32 m0, s60, 49152
    s_add_u32 s99, s16, s62
    buffer_load_dwordx4 v244, s[32:35], s99 offen offset:0  lds
    buffer_load_dwordx4 v245, s[32:35], s99 offen offset:1024  lds
    buffer_load_dwordx4 v246, s[32:35], s99 offen offset:2048  lds
    s_add_u32 m0, s61, 61440
    s_add_u32 s16, s16, s63
    buffer_load_dwordx4 v244, s[32:35], s16 offen offset:0  lds
    buffer_load_dwordx4 v245, s[32:35], s16 offen offset:1024  lds
    buffer_load_dwordx4 v246, s[32:35], s16 offen offset:2048  lds
    s_add_u32 s97, s98, s0
    s_lshr_b64 s[0:1], s[0:1], 4
    s_and_b32 s97, s97, 15
    s_lshr_b32 s99, s97, 3
    s_xor_b32 s97, s97, s99
    s_add_u32 m0, s87, 0
    s_lshl_b32 s97, s97, 7
    buffer_load_dwordx4 v240, s[28:31], s97 offen offset:0  lds
    buffer_load_dwordx4 v241, s[28:31], s97 offen offset:1024  lds
    buffer_load_dwordx4 v242, s[28:31], s97 offen offset:2048  lds
    buffer_load_dwordx4 v243, s[28:31], s97 offen offset:3072  lds
    s_add_u32 m0, s88, 0
    s_mov_b64 exec, 0xffffffff
    buffer_load_dwordx4 v3, s[28:31], s97 offen offset:0  lds
    s_mov_b64 exec, -1
    s_waitcnt vmcnt(11)
    s_barrier
    s_mul_i32 s16, s97, 3072
    s_add_u32 m0, s60, 0
    s_add_u32 s99, s16, s62
    buffer_load_dwordx4 v244, s[32:35], s99 offen offset:0  lds
    ds_read_b128 v[84:87], v35 offset:0
    ds_read_b128 v[88:91], v35 offset:16
    buffer_load_dwordx4 v245, s[32:35], s99 offen offset:1024  lds
    ds_read_b64 v[40:41], v16 offset:0
    ds_read_b64 v[42:43], v231 offset:256
    buffer_load_dwordx4 v246, s[32:35], s99 offen offset:2048  lds
    ds_read_b64 v[44:45], v16 offset:256
    ds_read_b64 v[46:47], v16 offset:512
    s_add_u32 m0, s61, 12288
    s_add_u32 s16, s16, s63
    buffer_load_dwordx4 v244, s[32:35], s16 offen offset:0  lds
    ds_read_b64 v[48:49], v231 offset:512
    ds_read_b64 v[50:51], v16 offset:768
    buffer_load_dwordx4 v245, s[32:35], s16 offen offset:1024  lds
    ds_read_b64 v[52:53], v231 offset:768
    ds_read_b64 v[54:55], v16 offset:1024
    buffer_load_dwordx4 v246, s[32:35], s16 offen offset:2048  lds
    ds_read_b64 v[56:57], v231 offset:1024
    ds_read_b64 v[58:59], v16 offset:1280
    s_add_u32 s97, s98, s0
    s_lshr_b64 s[0:1], s[0:1], 4
    s_and_b32 s97, s97, 15
    s_lshr_b32 s99, s97, 3
    s_xor_b32 s97, s97, s99
    s_add_u32 m0, s87, 18432
    s_lshl_b32 s97, s97, 7
    buffer_load_dwordx4 v240, s[28:31], s97 offen offset:0  lds
    ds_read_b64 v[60:61], v231 offset:1280
    ds_read_b64 v[68:69], v16 offset:16896
    buffer_load_dwordx4 v241, s[28:31], s97 offen offset:1024  lds
    ds_read_b64 v[70:71], v231 offset:16896
    ds_read_b64 v[72:73], v16 offset:17152
    buffer_load_dwordx4 v242, s[28:31], s97 offen offset:2048  lds
    ds_read_b64 v[74:75], v231 offset:17152
    ds_read_b64 v[76:77], v16 offset:17408
    buffer_load_dwordx4 v243, s[28:31], s97 offen offset:3072  lds
    ds_read_b64 v[78:79], v231 offset:17408
    ds_read_b64 v[80:81], v16 offset:17664
    s_add_u32 m0, s88, 18432
    s_mov_b64 exec, 0xffffffff
    buffer_load_dwordx4 v3, s[28:31], s97 offen offset:0  lds
    s_mov_b64 exec, -1
    ds_read_b64 v[82:83], v231 offset:17664
    s_waitcnt vmcnt(11)
    s_waitcnt lgkmcnt(0)
    s_barrier
    s_mul_i32 s16, s97, 3072
    s_add_u32 m0, s60, 24576
    s_add_u32 s99, s16, s62
    buffer_load_dwordx4 v244, s[32:35], s99 offen offset:0  lds
    v_lshlrev_b32 v160, 16, v40
    v_lshlrev_b32 v161, 16, v42
    v_lshlrev_b32 v162, 16, v44
    v_lshlrev_b32 v163, 16, v46
    v_lshlrev_b32 v164, 16, v48
    buffer_load_dwordx4 v245, s[32:35], s99 offen offset:1024  lds
    v_lshlrev_b32 v165, 16, v50
    v_lshlrev_b32 v166, 16, v52
    v_lshlrev_b32 v167, 16, v54
    v_lshlrev_b32 v168, 16, v56
    v_lshlrev_b32 v169, 16, v58
    buffer_load_dwordx4 v246, s[32:35], s99 offen offset:2048  lds
    v_lshlrev_b32 v170, 16, v60
    v_lshlrev_b32 v172, 16, v84
    v_and_b32 v173, 0xffff0000, v84
    v_lshlrev_b32 v174, 16, v85
    v_and_b32 v175, 0xffff0000, v85
    s_add_u32 m0, s61, 36864
    s_add_u32 s16, s16, s63
    buffer_load_dwordx4 v244, s[32:35], s16 offen offset:0  lds
    v_lshlrev_b32 v176, 16, v68
    v_lshlrev_b32 v177, 16, v70
    v_lshlrev_b32 v178, 16, v72
    v_lshlrev_b32 v179, 16, v74
    v_lshlrev_b32 v180, 16, v76
    buffer_load_dwordx4 v245, s[32:35], s16 offen offset:1024  lds
    v_lshlrev_b32 v181, 16, v78
    v_lshlrev_b32 v182, 16, v80
    v_lshlrev_b32 v183, 16, v82
    v_mul_f32 v184, v160, v175
    v_mul_f32 v185, v161, v175
    buffer_load_dwordx4 v246, s[32:35], s16 offen offset:2048  lds
    v_mul_f32 v186, v162, v175
    v_mul_f32 v187, v163, v175
    v_mul_f32 v188, v164, v175
    v_mul_f32 v189, v165, v175
    v_mul_f32 v190, v166, v175
    s_add_u32 s97, s98, s0
    s_lshr_b64 s[0:1], s[0:1], 4
    s_and_b32 s97, s97, 15
    s_lshr_b32 s99, s97, 3
    s_xor_b32 s97, s97, s99
    s_add_u32 m0, s87, 36864
    s_lshl_b32 s97, s97, 7
    buffer_load_dwordx4 v240, s[28:31], s97 offen offset:0  lds
    v_mul_f32 v191, v167, v175
    v_fmac_f32 v184, v161, v174
    v_fmac_f32 v185, v162, v174
    v_fmac_f32 v186, v163, v174
    v_fmac_f32 v187, v164, v174
    buffer_load_dwordx4 v241, s[28:31], s97 offen offset:1024  lds
    v_fmac_f32 v188, v165, v174
    v_fmac_f32 v189, v166, v174
    v_fmac_f32 v190, v167, v174
    v_fmac_f32 v191, v168, v174
    v_fmac_f32 v184, v162, v173
    buffer_load_dwordx4 v242, s[28:31], s97 offen offset:2048  lds
    v_fmac_f32 v185, v163, v173
    v_fmac_f32 v186, v164, v173
    v_fmac_f32 v187, v165, v173
    v_fmac_f32 v188, v166, v173
    v_fmac_f32 v189, v167, v173
    buffer_load_dwordx4 v243, s[28:31], s97 offen offset:3072  lds
    v_fmac_f32 v190, v168, v173
    v_fmac_f32 v191, v169, v173
    v_fmac_f32 v184, v163, v172
    v_fmac_f32 v185, v164, v172
    v_fmac_f32 v186, v165, v172
    s_add_u32 m0, s88, 36864
    s_mov_b64 exec, 0xffffffff
    buffer_load_dwordx4 v3, s[28:31], s97 offen offset:0  lds
    s_mov_b64 exec, -1
    v_fmac_f32 v187, v166, v172
    v_fmac_f32 v188, v167, v172
    v_fmac_f32 v189, v168, v172
    v_fmac_f32 v190, v169, v172
    v_fmac_f32 v191, v170, v172
    v_mul_f32 v184, v184, v176
    v_mul_f32 v185, v185, v177
    v_mul_f32 v186, v186, v178
    v_mul_f32 v187, v187, v179
    v_mul_f32 v188, v188, v180
    v_mul_f32 v189, v189, v181
    v_mul_f32 v190, v190, v182
    v_mul_f32 v191, v191, v183
    v_cvt_pk_bf16_f32 v100, v191, v190
    v_cvt_pk_bf16_f32 v101, v189, v188
    v_cvt_pk_bf16_f32 v102, v187, v186
    v_cvt_pk_bf16_f32 v103, v185, v184
    s_mov_b32 s89, 0
    buffer_store_dwordx4 v[100:103], v12, s[52:55], s89 offen sc1
    s_waitcnt vmcnt(12)
    s_barrier
    s_mul_i32 s16, s97, 3072
    s_add_u32 m0, s60, 49152
    s_add_u32 s99, s16, s62
    buffer_load_dwordx4 v244, s[32:35], s99 offen offset:0  lds
    v_and_b32 v160, 0xffff0000, v40
    v_and_b32 v161, 0xffff0000, v42
    v_and_b32 v162, 0xffff0000, v44
    v_and_b32 v163, 0xffff0000, v46
    v_and_b32 v164, 0xffff0000, v48
    buffer_load_dwordx4 v245, s[32:35], s99 offen offset:1024  lds
    v_and_b32 v165, 0xffff0000, v50
    v_and_b32 v166, 0xffff0000, v52
    v_and_b32 v167, 0xffff0000, v54
    v_and_b32 v168, 0xffff0000, v56
    v_and_b32 v169, 0xffff0000, v58
    buffer_load_dwordx4 v246, s[32:35], s99 offen offset:2048  lds
    v_and_b32 v170, 0xffff0000, v60
    v_lshlrev_b32 v172, 16, v86
    v_and_b32 v173, 0xffff0000, v86
    v_lshlrev_b32 v174, 16, v87
    v_and_b32 v175, 0xffff0000, v87
    s_add_u32 m0, s61, 61440
    s_add_u32 s16, s16, s63
    buffer_load_dwordx4 v244, s[32:35], s16 offen offset:0  lds
    v_and_b32 v176, 0xffff0000, v68
    v_and_b32 v177, 0xffff0000, v70
    v_and_b32 v178, 0xffff0000, v72
    v_and_b32 v179, 0xffff0000, v74
    v_and_b32 v180, 0xffff0000, v76
    buffer_load_dwordx4 v245, s[32:35], s16 offen offset:1024  lds
    v_and_b32 v181, 0xffff0000, v78
    v_and_b32 v182, 0xffff0000, v80
    v_and_b32 v183, 0xffff0000, v82
    v_mul_f32 v184, v160, v175
    v_mul_f32 v185, v161, v175
    buffer_load_dwordx4 v246, s[32:35], s16 offen offset:2048  lds
    v_mul_f32 v186, v162, v175
    v_mul_f32 v187, v163, v175
    v_mul_f32 v188, v164, v175
    v_mul_f32 v189, v165, v175
    v_mul_f32 v190, v166, v175
    s_add_u32 s97, s98, s0
    s_lshr_b64 s[0:1], s[0:1], 4
    s_and_b32 s97, s97, 15
    s_lshr_b32 s99, s97, 3
    s_xor_b32 s97, s97, s99
    s_add_u32 m0, s87, 0
    s_lshl_b32 s97, s97, 7
    buffer_load_dwordx4 v240, s[28:31], s97 offen offset:0  lds
    v_mul_f32 v191, v167, v175
    v_fmac_f32 v184, v161, v174
    v_fmac_f32 v185, v162, v174
    v_fmac_f32 v186, v163, v174
    v_fmac_f32 v187, v164, v174
    buffer_load_dwordx4 v241, s[28:31], s97 offen offset:1024  lds
    v_fmac_f32 v188, v165, v174
    v_fmac_f32 v189, v166, v174
    v_fmac_f32 v190, v167, v174
    v_fmac_f32 v191, v168, v174
    v_fmac_f32 v184, v162, v173
    buffer_load_dwordx4 v242, s[28:31], s97 offen offset:2048  lds
    v_fmac_f32 v185, v163, v173
    v_fmac_f32 v186, v164, v173
    v_fmac_f32 v187, v165, v173
    v_fmac_f32 v188, v166, v173
    v_fmac_f32 v189, v167, v173
    buffer_load_dwordx4 v243, s[28:31], s97 offen offset:3072  lds
    v_fmac_f32 v190, v168, v173
    v_fmac_f32 v191, v169, v173
    v_fmac_f32 v184, v163, v172
    v_fmac_f32 v185, v164, v172
    v_fmac_f32 v186, v165, v172
    s_add_u32 m0, s88, 0
    s_mov_b64 exec, 0xffffffff
    buffer_load_dwordx4 v3, s[28:31], s97 offen offset:0  lds
    s_mov_b64 exec, -1
    v_fmac_f32 v187, v166, v172
    v_fmac_f32 v188, v167, v172
    v_fmac_f32 v189, v168, v172
    v_fmac_f32 v190, v169, v172
    v_fmac_f32 v191, v170, v172
    v_mul_f32 v184, v184, v176
    v_mul_f32 v185, v185, v177
    v_mul_f32 v186, v186, v178
    v_mul_f32 v187, v187, v179
    v_mul_f32 v188, v188, v180
    v_mul_f32 v189, v189, v181
    v_mul_f32 v190, v190, v182
    v_mul_f32 v191, v191, v183
    v_cvt_pk_bf16_f32 v104, v191, v190
    v_cvt_pk_bf16_f32 v105, v189, v188
    v_cvt_pk_bf16_f32 v106, v187, v186
    v_cvt_pk_bf16_f32 v107, v185, v184
    s_mov_b32 s89, 16384
    buffer_store_dwordx4 v[104:107], v12, s[52:55], s89 offen sc1
    s_waitcnt vmcnt(13)
    s_barrier
    s_mul_i32 s16, s97, 3072
    s_add_u32 m0, s60, 0
    s_add_u32 s99, s16, s62
    buffer_load_dwordx4 v244, s[32:35], s99 offen offset:0  lds
    v_lshlrev_b32 v160, 16, v41
    v_lshlrev_b32 v161, 16, v43
    v_lshlrev_b32 v162, 16, v45
    v_lshlrev_b32 v163, 16, v47
    v_lshlrev_b32 v164, 16, v49
    buffer_load_dwordx4 v245, s[32:35], s99 offen offset:1024  lds
    v_lshlrev_b32 v165, 16, v51
    v_lshlrev_b32 v166, 16, v53
    v_lshlrev_b32 v167, 16, v55
    v_lshlrev_b32 v168, 16, v57
    v_lshlrev_b32 v169, 16, v59
    buffer_load_dwordx4 v246, s[32:35], s99 offen offset:2048  lds
    v_lshlrev_b32 v170, 16, v61
    v_lshlrev_b32 v172, 16, v88
    v_and_b32 v173, 0xffff0000, v88
    v_lshlrev_b32 v174, 16, v89
    v_and_b32 v175, 0xffff0000, v89
    s_add_u32 m0, s61, 12288
    s_add_u32 s16, s16, s63
    buffer_load_dwordx4 v244, s[32:35], s16 offen offset:0  lds
    v_lshlrev_b32 v176, 16, v69
    v_lshlrev_b32 v177, 16, v71
    v_lshlrev_b32 v178, 16, v73
    v_lshlrev_b32 v179, 16, v75
    v_lshlrev_b32 v180, 16, v77
    buffer_load_dwordx4 v245, s[32:35], s16 offen offset:1024  lds
    v_lshlrev_b32 v181, 16, v79
    v_lshlrev_b32 v182, 16, v81
    v_lshlrev_b32 v183, 16, v83
    v_mul_f32 v184, v160, v175
    v_mul_f32 v185, v161, v175
    buffer_load_dwordx4 v246, s[32:35], s16 offen offset:2048  lds
    v_mul_f32 v186, v162, v175
    v_mul_f32 v187, v163, v175
    v_mul_f32 v188, v164, v175
    v_mul_f32 v189, v165, v175
    v_mul_f32 v190, v166, v175
    s_add_u32 s97, s98, s0
    s_lshr_b64 s[0:1], s[0:1], 4
    s_and_b32 s97, s97, 15
    s_lshr_b32 s99, s97, 3
    s_xor_b32 s97, s97, s99
    s_add_u32 m0, s87, 18432
    s_lshl_b32 s97, s97, 7
    buffer_load_dwordx4 v240, s[28:31], s97 offen offset:0  lds
    v_mul_f32 v191, v167, v175
    v_fmac_f32 v184, v161, v174
    v_fmac_f32 v185, v162, v174
    v_fmac_f32 v186, v163, v174
    v_fmac_f32 v187, v164, v174
    buffer_load_dwordx4 v241, s[28:31], s97 offen offset:1024  lds
    v_fmac_f32 v188, v165, v174
    v_fmac_f32 v189, v166, v174
    v_fmac_f32 v190, v167, v174
    v_fmac_f32 v191, v168, v174
    v_fmac_f32 v184, v162, v173
    buffer_load_dwordx4 v242, s[28:31], s97 offen offset:2048  lds
    v_fmac_f32 v185, v163, v173
    v_fmac_f32 v186, v164, v173
    v_fmac_f32 v187, v165, v173
    v_fmac_f32 v188, v166, v173
    v_fmac_f32 v189, v167, v173
    buffer_load_dwordx4 v243, s[28:31], s97 offen offset:3072  lds
    v_fmac_f32 v190, v168, v173
    v_fmac_f32 v191, v169, v173
    v_fmac_f32 v184, v163, v172
    v_fmac_f32 v185, v164, v172
    v_fmac_f32 v186, v165, v172
    s_add_u32 m0, s88, 18432
    s_mov_b64 exec, 0xffffffff
    buffer_load_dwordx4 v3, s[28:31], s97 offen offset:0  lds
    s_mov_b64 exec, -1
    v_fmac_f32 v187, v166, v172
    v_fmac_f32 v188, v167, v172
    v_fmac_f32 v189, v168, v172
    v_fmac_f32 v190, v169, v172
    v_fmac_f32 v191, v170, v172
    v_mul_f32 v184, v184, v176
    v_mul_f32 v185, v185, v177
    v_mul_f32 v186, v186, v178
    v_mul_f32 v187, v187, v179
    v_mul_f32 v188, v188, v180
    v_mul_f32 v189, v189, v181
    v_mul_f32 v190, v190, v182
    v_mul_f32 v191, v191, v183
    v_cvt_pk_bf16_f32 v108, v191, v190
    v_cvt_pk_bf16_f32 v109, v189, v188
    v_cvt_pk_bf16_f32 v110, v187, v186
    v_cvt_pk_bf16_f32 v111, v185, v184
    s_mov_b32 s89, 32768
    buffer_store_dwordx4 v[108:111], v12, s[52:55], s89 offen sc1
    s_waitcnt vmcnt(13)
    s_barrier
    s_mul_i32 s16, s97, 3072
    s_add_u32 m0, s60, 24576
    s_add_u32 s99, s16, s62
    buffer_load_dwordx4 v244, s[32:35], s99 offen offset:0  lds
    v_and_b32 v160, 0xffff0000, v41
    v_and_b32 v161, 0xffff0000, v43
    v_and_b32 v162, 0xffff0000, v45
    v_and_b32 v163, 0xffff0000, v47
    v_and_b32 v164, 0xffff0000, v49
    buffer_load_dwordx4 v245, s[32:35], s99 offen offset:1024  lds
    v_and_b32 v165, 0xffff0000, v51
    v_and_b32 v166, 0xffff0000, v53
    v_and_b32 v167, 0xffff0000, v55
    v_and_b32 v168, 0xffff0000, v57
    v_and_b32 v169, 0xffff0000, v59
    buffer_load_dwordx4 v246, s[32:35], s99 offen offset:2048  lds
    v_and_b32 v170, 0xffff0000, v61
    v_lshlrev_b32 v172, 16, v90
    v_and_b32 v173, 0xffff0000, v90
    v_lshlrev_b32 v174, 16, v91
    v_and_b32 v175, 0xffff0000, v91
    s_add_u32 m0, s61, 36864
    s_add_u32 s16, s16, s63
    buffer_load_dwordx4 v244, s[32:35], s16 offen offset:0  lds
    v_and_b32 v176, 0xffff0000, v69
    v_and_b32 v177, 0xffff0000, v71
    v_and_b32 v178, 0xffff0000, v73
    v_and_b32 v179, 0xffff0000, v75
    v_and_b32 v180, 0xffff0000, v77
    buffer_load_dwordx4 v245, s[32:35], s16 offen offset:1024  lds
    v_and_b32 v181, 0xffff0000, v79
    v_and_b32 v182, 0xffff0000, v81
    v_and_b32 v183, 0xffff0000, v83
    v_mul_f32 v184, v160, v175
    v_mul_f32 v185, v161, v175
    buffer_load_dwordx4 v246, s[32:35], s16 offen offset:2048  lds
    v_mul_f32 v186, v162, v175
    v_mul_f32 v187, v163, v175
    v_mul_f32 v188, v164, v175
    v_mul_f32 v189, v165, v175
    v_mul_f32 v190, v166, v175
    s_add_u32 s97, s98, s0
    s_lshr_b64 s[0:1], s[0:1], 4
    s_and_b32 s97, s97, 15
    s_lshr_b32 s99, s97, 3
    s_xor_b32 s97, s97, s99
    s_add_u32 m0, s87, 36864
    s_lshl_b32 s97, s97, 7
    buffer_load_dwordx4 v240, s[28:31], s97 offen offset:0  lds
    v_mul_f32 v191, v167, v175
    v_fmac_f32 v184, v161, v174
    v_fmac_f32 v185, v162, v174
    v_fmac_f32 v186, v163, v174
    v_fmac_f32 v187, v164, v174
    buffer_load_dwordx4 v241, s[28:31], s97 offen offset:1024  lds
    v_fmac_f32 v188, v165, v174
    v_fmac_f32 v189, v166, v174
    v_fmac_f32 v190, v167, v174
    v_fmac_f32 v191, v168, v174
    v_fmac_f32 v184, v162, v173
    buffer_load_dwordx4 v242, s[28:31], s97 offen offset:2048  lds
    v_fmac_f32 v185, v163, v173
    v_fmac_f32 v186, v164, v173
    v_fmac_f32 v187, v165, v173
    v_fmac_f32 v188, v166, v173
    v_fmac_f32 v189, v167, v173
    buffer_load_dwordx4 v243, s[28:31], s97 offen offset:3072  lds
    v_fmac_f32 v190, v168, v173
    v_fmac_f32 v191, v169, v173
    v_fmac_f32 v184, v163, v172
    v_fmac_f32 v185, v164, v172
    v_fmac_f32 v186, v165, v172
    s_add_u32 m0, s88, 36864
    s_mov_b64 exec, 0xffffffff
    buffer_load_dwordx4 v3, s[28:31], s97 offen offset:0  lds
    s_mov_b64 exec, -1
    v_fmac_f32 v187, v166, v172
    v_fmac_f32 v188, v167, v172
    v_fmac_f32 v189, v168, v172
    v_fmac_f32 v190, v169, v172
    v_fmac_f32 v191, v170, v172
    v_mul_f32 v184, v184, v176
    v_mul_f32 v185, v185, v177
    v_mul_f32 v186, v186, v178
    v_mul_f32 v187, v187, v179
    v_mul_f32 v188, v188, v180
    v_mul_f32 v189, v189, v181
    v_mul_f32 v190, v190, v182
    v_mul_f32 v191, v191, v183
    v_cvt_pk_bf16_f32 v112, v191, v190
    v_cvt_pk_bf16_f32 v113, v189, v188
    v_cvt_pk_bf16_f32 v114, v187, v186
    v_cvt_pk_bf16_f32 v115, v185, v184
    s_mov_b32 s89, 49152
    buffer_store_dwordx4 v[112:115], v12, s[52:55], s89 offen sc1
    s_waitcnt vmcnt(13)
    s_barrier
    s_mul_i32 s16, s97, 3072
    s_add_u32 m0, s60, 49152
    s_add_u32 s99, s16, s62
    buffer_load_dwordx4 v244, s[32:35], s99 offen offset:0  lds
    buffer_load_dwordx4 v245, s[32:35], s99 offen offset:1024  lds
    buffer_load_dwordx4 v246, s[32:35], s99 offen offset:2048  lds
    s_add_u32 m0, s61, 61440
    s_add_u32 s16, s16, s63
    buffer_load_dwordx4 v244, s[32:35], s16 offen offset:0  lds
    buffer_load_dwordx4 v245, s[32:35], s16 offen offset:1024  lds
    buffer_load_dwordx4 v246, s[32:35], s16 offen offset:2048  lds
    s_add_u32 s97, s98, s0
    s_lshr_b64 s[0:1], s[0:1], 4
    s_and_b32 s97, s97, 15
    s_lshr_b32 s99, s97, 3
    s_xor_b32 s97, s97, s99
    s_add_u32 m0, s87, 0
    s_lshl_b32 s97, s97, 7
    buffer_load_dwordx4 v240, s[28:31], s97 offen offset:0  lds
    buffer_load_dwordx4 v241, s[28:31], s97 offen offset:1024  lds
    buffer_load_dwordx4 v242, s[28:31], s97 offen offset:2048  lds
    buffer_load_dwordx4 v243, s[28:31], s97 offen offset:3072  lds
    s_add_u32 m0, s88, 0
    s_mov_b64 exec, 0xffffffff
    buffer_load_dwordx4 v3, s[28:31], s97 offen offset:0  lds
    s_mov_b64 exec, -1
    s_waitcnt vmcnt(12)
    s_waitcnt vmcnt(11)
    s_barrier
    s_mul_i32 s16, s97, 3072
    s_add_u32 m0, s60, 0
    s_add_u32 s99, s16, s62
    buffer_load_dwordx4 v244, s[32:35], s99 offen offset:0  lds
    s_mov_b32 s68, s24
    s_mov_b32 s69, s25
    s_mov_b32 s70, 0x100
    s_mov_b32 s71, 0x20000
    buffer_load_dwordx4 v245, s[32:35], s99 offen offset:1024  lds
    v_lshrrev_b32 v6, 5, v0
    v_and_b32 v7, 3, v0
    s_lshr_b32 s78, s90, 1
    buffer_load_dwordx4 v246, s[32:35], s99 offen offset:2048  lds
    s_lshl_b32 s78, s78, 2
    s_load_dword s92, s[14:15], s78
    v_bfe_u32 v5, v0, 2, 2
    v_lshlrev_b32 v5, 1, v5
    s_add_u32 m0, s61, 12288
    s_add_u32 s16, s16, s63
    buffer_load_dwordx4 v244, s[32:35], s16 offen offset:0  lds
    v_lshl_add_u32 v5, v6, 3, v5
    v_bfe_u32 v8, v0, 4, 1
    v_add_u32 v5, v5, v8
    buffer_load_dwordx4 v245, s[32:35], s16 offen offset:1024  lds
    s_and_b32 s78, s3, 1
    s_lshl_b32 s78, s78, 1
    v_add_u32 v8, s78, v6
    v_xor_b32 v8, v8, v7
    buffer_load_dwordx4 v246, s[32:35], s16 offen offset:2048  lds
    v_lshlrev_b32 v8, 4, v8
    v_lshl_add_u32 v5, v5, 6, v8
    v_add_u32 v14, s86, v5
    s_add_u32 m0, s94, 32
    s_lshl_b32 s89, s90, 12
    buffer_load_dwordx4 v15, s[48:51], s89 offen offset:0 nt lds
    v_mov_b32 v18, 162304
    v_mov_b32 v19, 1
    v_and_b32 v5, 3, v0
    s_lshl_b32 s78, s74, 4
    s_add_u32 m0, s94, 32
    s_lshl_b32 s89, s90, 12
    buffer_load_dwordx4 v15, s[48:51], s89 offen offset:1024 nt lds
    s_add_u32 s78, s78, s3
    v_lshl_add_u32 v6, v5, 2, s78
    s_lshr_b32 s78, s76, 3
    s_add_u32 m0, s94, 32
    s_lshl_b32 s89, s90, 12
    buffer_load_dwordx4 v15, s[48:51], s89 offen offset:2048 nt lds
    s_lshl_b32 s79, s3, 1
    s_add_u32 s78, s78, s79
    s_xor_b32 s78, s78, 2
    s_lshl_b32 s78, s78, 5
    s_add_u32 m0, s94, 32
    s_lshl_b32 s89, s90, 12
    buffer_load_dwordx4 v15, s[48:51], s89 offen offset:3072 nt lds
    s_and_b32 s79, s76, 7
    s_add_u32 s78, s78, s79
    v_lshl_add_u32 v7, v5, 3, s78
    s_add_u32 s97, s98, s0
    s_lshr_b64 s[0:1], s[0:1], 4
    s_and_b32 s97, s97, 15
    s_lshr_b32 s99, s97, 3
    s_xor_b32 s97, s97, s99
    s_add_u32 m0, s87, 18432
    s_lshl_b32 s97, s97, 7
    buffer_load_dwordx4 v240, s[28:31], s97 offen offset:0  lds
    v_and_b32 v8, 4, v0
    v_cmp_eq_u32 vcc, 0, v8
    s_nop 1
    v_cndmask_b32 v6, v7, v6, vcc
    v_and_b32 v33, 0xf0, v6
    buffer_load_dwordx4 v241, s[28:31], s97 offen offset:1024  lds
    v_lshlrev_b32 v34, 8, v6
    v_add_u32 v34, 12582912, v34
    v_and_b32 v5, 15, v0
    buffer_load_dwordx4 v242, s[28:31], s97 offen offset:2048  lds
    v_lshrrev_b32 v6, 4, v0
    v_add_u32 v7, 9, v5
    v_and_b32 v8, 1, v7
    v_mul_u32_u24 v8, 4160, v8
    buffer_load_dwordx4 v243, s[28:31], s97 offen offset:3072  lds
    v_lshrrev_b32 v7, 1, v7
    v_lshl_add_u32 v8, v7, 2, v8
    v_lshlrev_b32 v7, 4, v6
    s_add_u32 m0, s88, 18432
    s_mov_b64 exec, 0xffffffff
    buffer_load_dwordx4 v3, s[28:31], s97 offen offset:0  lds
    s_mov_b64 exec, -1
    v_sub_u32 v8, v8, v7
    s_add_u32 s78, s94, 32
    v_add_u32 v21, s78, v8
    s_waitcnt vmcnt(15)
    s_barrier
    s_mul_i32 s16, s97, 3072
    s_add_u32 m0, s60, 24576
    s_add_u32 s99, s16, s62
    buffer_load_dwordx4 v244, s[32:35], s99 offen offset:0  lds
    v_add_u32 v22, 1024, v21
    v_add_u32 v23, 2048, v21
    v_add_u32 v24, 3072, v21
    v_lshl_add_u32 v7, v5, 1, v6
    v_add_u32 v7, 30, v7
    buffer_load_dwordx4 v245, s[32:35], s99 offen offset:1024  lds
    v_and_b32 v8, 1, v7
    v_bfe_u32 v136, v7, 1, 2
    v_lshl_add_u32 v136, v8, 2, v136
    v_lshlrev_b32 v136, 6, v136
    v_lshrrev_b32 v7, 3, v7
    buffer_load_dwordx4 v246, s[32:35], s99 offen offset:2048  lds
    v_lshl_add_u32 v136, v7, 9, v136
    v_bitop3_b32 v8, v7, 3, s3 bitop3:0x6a
    v_lshl_add_u32 v25, v8, 4, v136
    v_add_u32 v25, 92160, v25
    v_subrev_u32 v7, 1, v7
    s_add_u32 m0, s61, 36864
    s_add_u32 s16, s16, s63
    buffer_load_dwordx4 v244, s[32:35], s16 offen offset:0  lds
    v_bitop3_b32 v8, v7, 3, s3 bitop3:0x6a
    v_lshl_add_u32 v27, v8, 4, v136
    v_add_u32 v27, 91648, v27
    v_subrev_u32 v7, 1, v7
    buffer_load_dwordx4 v245, s[32:35], s16 offen offset:1024  lds
    v_bitop3_b32 v8, v7, 3, s3 bitop3:0x6a
    v_lshl_add_u32 v29, v8, 4, v136
    v_add_u32 v29, 91136, v29
    v_subrev_u32 v7, 1, v7
    v_bitop3_b32 v8, v7, 3, s3 bitop3:0x6a
    buffer_load_dwordx4 v246, s[32:35], s16 offen offset:2048  lds
    v_lshl_add_u32 v31, v8, 4, v136
    v_add_u32 v31, 90624, v31
    v_lshl_add_u32 v7, v5, 1, v6
    v_add_u32 v7, 26, v7
    v_and_b32 v8, 1, v7
    s_add_u32 s97, s98, s0
    s_lshr_b64 s[0:1], s[0:1], 4
    s_and_b32 s97, s97, 15
    s_lshr_b32 s99, s97, 3
    s_xor_b32 s97, s97, s99
    s_add_u32 m0, s87, 36864
    s_lshl_b32 s97, s97, 7
    buffer_load_dwordx4 v240, s[28:31], s97 offen offset:0  lds
    v_bfe_u32 v136, v7, 1, 2
    v_lshl_add_u32 v136, v8, 2, v136
    v_lshlrev_b32 v136, 6, v136
    v_lshrrev_b32 v7, 3, v7
    v_lshl_add_u32 v136, v7, 9, v136
    buffer_load_dwordx4 v241, s[28:31], s97 offen offset:1024  lds
    v_bitop3_b32 v8, v7, 3, s3 bitop3:0x6a
    v_lshl_add_u32 v26, v8, 4, v136
    v_add_u32 v26, 92160, v26
    v_subrev_u32 v7, 1, v7
    buffer_load_dwordx4 v242, s[28:31], s97 offen offset:2048  lds
    v_bitop3_b32 v8, v7, 3, s3 bitop3:0x6a
    v_lshl_add_u32 v28, v8, 4, v136
    v_add_u32 v28, 91648, v28
    v_subrev_u32 v7, 1, v7
    v_bitop3_b32 v8, v7, 3, s3 bitop3:0x6a
    buffer_load_dwordx4 v243, s[28:31], s97 offen offset:3072  lds
    v_lshl_add_u32 v30, v8, 4, v136
    v_add_u32 v30, 91136, v30
    v_subrev_u32 v7, 1, v7
    v_bitop3_b32 v8, v7, 3, s3 bitop3:0x6a
    v_lshl_add_u32 v32, v8, 4, v136
    s_add_u32 m0, s88, 36864
    s_mov_b64 exec, 0xffffffff
    buffer_load_dwordx4 v3, s[28:31], s97 offen offset:0  lds
    s_mov_b64 exec, -1
    v_add_u32 v32, 90624, v32
    v_lshrrev_b32 v7, 1, v6
    v_lshl_add_u32 v7, v5, 1, v7
    v_add_u32 v7, 32, v7
    s_waitcnt vmcnt(11)
    s_barrier
    s_mul_i32 s16, s97, 3072
    s_add_u32 m0, s60, 49152
    s_add_u32 s99, s16, s62
    buffer_load_dwordx4 v244, s[32:35], s99 offen offset:0  lds
    v_and_b32 v8, 1, v7
    v_bfe_u32 v136, v7, 1, 2
    v_lshl_add_u32 v136, v8, 2, v136
    v_lshlrev_b32 v136, 6, v136
    buffer_load_dwordx4 v245, s[32:35], s99 offen offset:1024  lds
    v_lshrrev_b32 v7, 3, v7
    v_lshl_add_u32 v136, v7, 9, v136
    v_bitop3_b32 v8, v7, 3, s3 bitop3:0x6a
    v_lshl_add_u32 v20, v8, 4, v136
    buffer_load_dwordx4 v246, s[32:35], s99 offen offset:2048  lds
    v_add_u32 v20, 92160, v20
    v_and_b32 v8, 1, v6
    v_xor_b32 v8, 1, v8
    v_lshl_add_u32 v20, v8, 3, v20
    s_add_u32 m0, s61, 61440
    s_add_u32 s16, s16, s63
    buffer_load_dwordx4 v244, s[32:35], s16 offen offset:0  lds
    s_waitcnt lgkmcnt(0)
    s_and_b32 s78, s92, 0xffff0000
    s_lshl_b32 s92, s92, 16
    s_bitcmp1_b32 s90, 0
    s_cselect_b32 s92, s78, s92
    buffer_load_dwordx4 v245, s[32:35], s16 offen offset:1024  lds
    v_lshlrev_b32 v7, 3, v6
    v_sub_u32 v7, v7, v5
    v_subrev_u32 v7, 9, v7
    v_and_b32 v8, 1, v7
    buffer_load_dwordx4 v246, s[32:35], s16 offen offset:2048  lds
    v_xor_b32 v8, 1, v8
    v_lshlrev_b32 v8, 4, v8
    v_lshrrev_b32 v8, v8, s92
    v_ashrrev_i32 v7, 1, v7
    s_add_u32 s97, s98, s0
    s_lshr_b64 s[0:1], s[0:1], 4
    s_and_b32 s97, s97, 15
    s_lshr_b32 s99, s97, 3
    s_xor_b32 s97, s97, s99
    s_add_u32 m0, s87, 0
    s_lshl_b32 s97, s97, 7
    buffer_load_dwordx4 v240, s[28:31], s97 offen offset:0  lds
    v_cmp_eq_u32 vcc, 0, v7
    s_nop 1
    v_cndmask_b32 v236, 0, v8, vcc
    v_cmp_eq_u32 vcc, 1, v7
    s_nop 1
    v_cndmask_b32 v237, 0, v8, vcc
    buffer_load_dwordx4 v241, s[28:31], s97 offen offset:1024  lds
    v_cmp_eq_u32 vcc, 2, v7
    s_nop 1
    v_cndmask_b32 v238, 0, v8, vcc
    v_cmp_eq_u32 vcc, 3, v7
    s_nop 1
    v_cndmask_b32 v239, 0, v8, vcc
    buffer_load_dwordx4 v242, s[28:31], s97 offen offset:2048  lds
    s_and_b32 s78, s77, 7
    s_mov_b32 s95, 0x76543210
    s_cmp_eq_u32 s78, 1
    s_cselect_b32 s95, 0x76543201, s95
    s_cmp_eq_u32 s78, 2
    s_cselect_b32 s95, 0x76543120, s95
    s_cmp_eq_u32 s78, 3
    s_cselect_b32 s95, 0x76542310, s95
    s_cmp_eq_u32 s78, 4
    s_cselect_b32 s95, 0x76534210, s95
    s_cmp_eq_u32 s78, 5
    s_cselect_b32 s95, 0x76453210, s95
    s_cmp_eq_u32 s78, 6
    s_cselect_b32 s95, 0x75643210, s95
    s_cmp_eq_u32 s78, 7
    s_cselect_b32 s95, 0x67543210, s95
    s_and_b32 s78, s76, 3
    s_mul_i32 s78, s78, 0x22222222
    s_add_u32 s95, s95, s78
    s_bfe_u32 s100, s95, 0x3001c
    s_lshl_b32 s100, s100, 18
    s_bfe_u32 s95, s95, 0x30018
    s_lshl_b32 s95, s95, 18
    v_lshrrev_b32 v136, 4, v0
    v_lshlrev_b32 v136, 1, v136
    v_and_b32 v137, 7, v0
    buffer_load_dwordx4 v243, s[28:31], s97 offen offset:3072  lds
    v_xor_b32 v136, v136, v137
    v_lshlrev_b32 v136, 4, v136
    v_lshrrev_b32 v137, 3, v0
    v_lshl_add_u32 v136, v137, 11, v136
    s_add_u32 m0, s88, 0
    s_mov_b64 exec, 0xffffffff
    buffer_load_dwordx4 v3, s[28:31], s97 offen offset:0  lds
    s_mov_b64 exec, -1
    s_lshl_b32 s78, s77, 7
    s_lshl_b32 s79, s3, 14
    s_add_u32 s78, s78, s79
    v_add_u32 v17, s78, v136
    s_waitcnt vmcnt(11)
    s_barrier
    s_mul_i32 s16, s97, 3072
    s_add_u32 m0, s60, 0
    s_add_u32 s99, s16, s62
    buffer_load_dwordx4 v244, s[32:35], s99 offen offset:0  lds
    v_add_u32 v5, s94, v15
    ds_read_b128 v[140:143], v5 offset:32
    ds_read_b32 v156, v5 offset:48
    ds_read_b128 v[144:147], v5 offset:1056
    ds_read_b32 v157, v5 offset:1072
    buffer_load_dwordx4 v245, s[32:35], s99 offen offset:1024  lds
    ds_read_b128 v[148:151], v5 offset:2080
    ds_read_b32 v158, v5 offset:2096
    ds_read_b128 v[152:155], v5 offset:3104
    ds_read_b32 v159, v5 offset:3120
    v_lshrrev_b32 v6, 3, v0
    buffer_load_dwordx4 v246, s[32:35], s99 offen offset:2048  lds
    v_mul_u32_u24 v6, 4160, v6
    v_and_b32 v7, 7, v0
    v_lshl_add_u32 v6, v7, 2, v6
    v_add_u32 v6, s94, v6
    v_mov_b32 v7, 0
    s_add_u32 m0, s61, 12288
    s_add_u32 s16, s16, s63
    buffer_load_dwordx4 v244, s[32:35], s16 offen offset:0  lds
    s_waitcnt lgkmcnt(0)
    v_readfirstlane_b32 s93, v140
    s_nop 0
    s_lshl_b32 s93, s93, 16
    s_nop 1
    v_writelane_b32 v7, s93, 15
    v_alignbit_b32 v140, v141, v140, 16
    buffer_load_dwordx4 v245, s[32:35], s16 offen offset:1024  lds
    v_alignbit_b32 v141, v142, v141, 16
    v_alignbit_b32 v142, v143, v142, 16
    v_alignbit_b32 v143, v156, v143, 16
    v_alignbit_b32 v144, v145, v144, 16
    v_alignbit_b32 v145, v146, v145, 16
    buffer_load_dwordx4 v246, s[32:35], s16 offen offset:2048  lds
    v_alignbit_b32 v146, v147, v146, 16
    v_alignbit_b32 v147, v157, v147, 16
    v_alignbit_b32 v148, v149, v148, 16
    v_alignbit_b32 v149, v150, v149, 16
    v_alignbit_b32 v150, v151, v150, 16
    s_mov_b64 exec, 0xff
    buffer_load_dword v136, v33, s[68:71], 0 offen sc1
    buffer_load_dword v137, v34, s[52:55], 0 offen sc1
    s_mov_b64 exec, -1
    v_alignbit_b32 v151, v158, v151, 16
    v_alignbit_b32 v152, v153, v152, 16
    v_alignbit_b32 v153, v154, v153, 16
    v_alignbit_b32 v154, v155, v154, 16
    v_alignbit_b32 v155, v159, v155, 16
    v_lshlrev_b32 v8, 3, v0
    s_add_u32 s78, s88, 18432
    v_add_u32 v8, s78, v8
    v_mov_b32 v156, 0
    v_mov_b32 v157, 0
    s_waitcnt vmcnt(8)
    s_waitcnt vmcnt(2)
    s_barrier
    s_waitcnt vmcnt(0)
    s_branch LA_j
LA_c3:
    s_waitcnt vmcnt(11)
    s_barrier
    s_mul_i32 s16, s97, 3072
    s_add_u32 m0, s60, 49152
    s_add_u32 s99, s16, s62
    buffer_load_dwordx4 v244, s[32:35], s99 offen offset:0  lds
    buffer_load_dwordx4 v245, s[32:35], s99 offen offset:1024  lds
    buffer_load_dwordx4 v246, s[32:35], s99 offen offset:2048  lds
    s_add_u32 m0, s61, 61440
    s_add_u32 s16, s16, s63
    buffer_load_dwordx4 v244, s[32:35], s16 offen offset:0  lds
    buffer_load_dwordx4 v245, s[32:35], s16 offen offset:1024  lds
    buffer_load_dwordx4 v246, s[32:35], s16 offen offset:2048  lds
    s_add_u32 s97, s98, s0
    s_lshr_b64 s[0:1], s[0:1], 4
    s_and_b32 s97, s97, 15
    s_lshr_b32 s99, s97, 3
    s_xor_b32 s97, s97, s99
    s_add_u32 m0, s87, 0
    s_lshl_b32 s97, s97, 7
    buffer_load_dwordx4 v240, s[28:31], s97 offen offset:0  lds
    buffer_load_dwordx4 v241, s[28:31], s97 offen offset:1024  lds
    buffer_load_dwordx4 v242, s[28:31], s97 offen offset:2048  lds
    buffer_load_dwordx4 v243, s[28:31], s97 offen offset:3072  lds
    s_add_u32 m0, s88, 0
    s_mov_b64 exec, 0xffffffff
    buffer_load_dwordx4 v3, s[28:31], s97 offen offset:0  lds
    s_mov_b64 exec, -1
    s_waitcnt vmcnt(11)
    s_barrier
    s_mul_i32 s16, s97, 3072
    s_add_u32 m0, s60, 0
    s_add_u32 s99, s16, s62
    buffer_load_dwordx4 v244, s[32:35], s99 offen offset:0  lds
    buffer_load_dwordx4 v245, s[32:35], s99 offen offset:1024  lds
    buffer_load_dwordx4 v246, s[32:35], s99 offen offset:2048  lds
    s_add_u32 m0, s61, 12288
    s_add_u32 s16, s16, s63
    buffer_load_dwordx4 v244, s[32:35], s16 offen offset:0  lds
    buffer_load_dwordx4 v245, s[32:35], s16 offen offset:1024  lds
    buffer_load_dwordx4 v246, s[32:35], s16 offen offset:2048  lds
    s_add_u32 s97, s98, s0
    s_lshr_b64 s[0:1], s[0:1], 4
    s_and_b32 s97, s97, 15
    s_lshr_b32 s99, s97, 3
    s_xor_b32 s97, s97, s99
    s_add_u32 m0, s87, 18432
    s_lshl_b32 s97, s97, 7
    buffer_load_dwordx4 v240, s[28:31], s97 offen offset:0  lds
    buffer_load_dwordx4 v241, s[28:31], s97 offen offset:1024  lds
    buffer_load_dwordx4 v242, s[28:31], s97 offen offset:2048  lds
    buffer_load_dwordx4 v243, s[28:31], s97 offen offset:3072  lds
    s_add_u32 m0, s88, 18432
    s_mov_b64 exec, 0xffffffff
    buffer_load_dwordx4 v3, s[28:31], s97 offen offset:0  lds
    s_mov_b64 exec, -1
    s_waitcnt vmcnt(11)
    s_barrier
    s_mul_i32 s16, s97, 3072
    s_add_u32 m0, s60, 24576
    s_add_u32 s99, s16, s62
    buffer_load_dwordx4 v244, s[32:35], s99 offen offset:0  lds
    buffer_load_dwordx4 v245, s[32:35], s99 offen offset:1024  lds
    buffer_load_dwordx4 v246, s[32:35], s99 offen offset:2048  lds
    s_add_u32 m0, s61, 36864
    s_add_u32 s16, s16, s63
    buffer_load_dwordx4 v244, s[32:35], s16 offen offset:0  lds
    buffer_load_dwordx4 v245, s[32:35], s16 offen offset:1024  lds
    buffer_load_dwordx4 v246, s[32:35], s16 offen offset:2048  lds
    s_add_u32 m0, s86, 129536
    s_mov_b32 s89, 0
    buffer_load_dwordx4 v10, s[36:39], s89 offen nt lds
    s_add_u32 m0, s86, 145920
    s_mov_b32 s89, 0
    buffer_load_dwordx4 v10, s[40:43], s89 offen nt lds
    s_add_u32 m0, s86, 133632
    s_mov_b32 s89, 65536
    buffer_load_dwordx4 v10, s[36:39], s89 offen nt lds
    s_add_u32 m0, s86, 150016
    s_mov_b32 s89, 65536
    buffer_load_dwordx4 v10, s[40:43], s89 offen nt lds
    s_add_u32 m0, s86, 137728
    s_mov_b32 s89, 131072
    buffer_load_dwordx4 v10, s[36:39], s89 offen nt lds
    s_add_u32 m0, s86, 154112
    s_mov_b32 s89, 131072
    buffer_load_dwordx4 v10, s[40:43], s89 offen nt lds
    s_add_u32 m0, s86, 141824
    s_mov_b32 s89, 196608
    buffer_load_dwordx4 v10, s[36:39], s89 offen nt lds
    s_add_u32 m0, s86, 158208
    s_mov_b32 s89, 196608
    buffer_load_dwordx4 v10, s[40:43], s89 offen nt lds
    s_mov_b64 exec, 0xff
    s_lshl_b32 s82, s3, 7
    s_add_u32 m0, s82, 129024
    s_mov_b32 s89, 0
    buffer_load_dwordx4 v11, s[36:39], s89 offen nt lds
    s_lshl_b32 s83, s74, 9
    s_add_u32 s83, s83, s82
    s_and_b32 s89, s3, 2
    s_lshl_b32 s89, s89, 3
    s_add_u32 s82, s82, s89
    s_add_u32 m0, s82, 162816
    s_add_u32 s89, s83, 0
    buffer_load_dwordx4 v15, s[44:47], s89 offen  lds
    s_mov_b64 exec, -1
    s_add_u32 s97, s98, s0
    s_lshr_b64 s[0:1], s[0:1], 4
    s_and_b32 s97, s97, 15
    s_lshr_b32 s99, s97, 3
    s_xor_b32 s97, s97, s99
    s_add_u32 m0, s87, 36864
    s_lshl_b32 s97, s97, 7
    buffer_load_dwordx4 v240, s[28:31], s97 offen offset:0  lds
    s_waitcnt vmcnt(17)
    s_barrier
    buffer_load_dwordx4 v241, s[28:31], s97 offen offset:1024  lds
    buffer_load_dwordx4 v242, s[28:31], s97 offen offset:2048  lds
    buffer_load_dwordx4 v243, s[28:31], s97 offen offset:3072  lds
    s_add_u32 m0, s88, 36864
    s_mov_b64 exec, 0xffffffff
    buffer_load_dwordx4 v3, s[28:31], s97 offen offset:0  lds
    s_mov_b64 exec, -1
    s_mul_i32 s16, s97, 3072
    s_add_u32 m0, s60, 49152
    s_add_u32 s99, s16, s62
    buffer_load_dwordx4 v244, s[32:35], s99 offen offset:0  lds
    buffer_load_dwordx4 v245, s[32:35], s99 offen offset:1024  lds
    buffer_load_dwordx4 v246, s[32:35], s99 offen offset:2048  lds
    s_add_u32 m0, s61, 61440
    s_add_u32 s16, s16, s63
    buffer_load_dwordx4 v244, s[32:35], s16 offen offset:0  lds
    buffer_load_dwordx4 v245, s[32:35], s16 offen offset:1024  lds
    buffer_load_dwordx4 v246, s[32:35], s16 offen offset:2048  lds
    s_add_u32 s97, s98, s0
    s_lshr_b64 s[0:1], s[0:1], 4
    s_and_b32 s97, s97, 15
    s_lshr_b32 s99, s97, 3
    s_xor_b32 s97, s97, s99
    s_add_u32 m0, s87, 0
    s_lshl_b32 s97, s97, 7
    buffer_load_dwordx4 v240, s[28:31], s97 offen offset:0  lds
    buffer_load_dwordx4 v241, s[28:31], s97 offen offset:1024  lds
    buffer_load_dwordx4 v242, s[28:31], s97 offen offset:2048  lds
    buffer_load_dwordx4 v243, s[28:31], s97 offen offset:3072  lds
    s_add_u32 m0, s88, 0
    s_mov_b64 exec, 0xffffffff
    buffer_load_dwordx4 v3, s[28:31], s97 offen offset:0  lds
    s_mov_b64 exec, -1
    s_waitcnt vmcnt(11)
    s_barrier
    s_mul_i32 s16, s97, 3072
    s_add_u32 m0, s60, 0
    s_add_u32 s99, s16, s62
    buffer_load_dwordx4 v244, s[32:35], s99 offen offset:0  lds
    ds_read_b128 v[84:87], v35 offset:0
    ds_read_b128 v[88:91], v35 offset:16
    buffer_load_dwordx4 v245, s[32:35], s99 offen offset:1024  lds
    ds_read_b64 v[40:41], v16 offset:0
    ds_read_b64 v[42:43], v231 offset:256
    buffer_load_dwordx4 v246, s[32:35], s99 offen offset:2048  lds
    ds_read_b64 v[44:45], v16 offset:256
    ds_read_b64 v[46:47], v16 offset:512
    s_add_u32 m0, s61, 12288
    s_add_u32 s16, s16, s63
    buffer_load_dwordx4 v244, s[32:35], s16 offen offset:0  lds
    ds_read_b64 v[48:49], v231 offset:512
    ds_read_b64 v[50:51], v16 offset:768
    buffer_load_dwordx4 v245, s[32:35], s16 offen offset:1024  lds
    ds_read_b64 v[52:53], v231 offset:768
    ds_read_b64 v[54:55], v16 offset:1024
    buffer_load_dwordx4 v246, s[32:35], s16 offen offset:2048  lds
    ds_read_b64 v[56:57], v231 offset:1024
    ds_read_b64 v[58:59], v16 offset:1280
    s_add_u32 s97, s98, s0
    s_lshr_b64 s[0:1], s[0:1], 4
    s_and_b32 s97, s97, 15
    s_lshr_b32 s99, s97, 3
    s_xor_b32 s97, s97, s99
    s_add_u32 m0, s87, 18432
    s_lshl_b32 s97, s97, 7
    buffer_load_dwordx4 v240, s[28:31], s97 offen offset:0  lds
    ds_read_b64 v[60:61], v231 offset:1280
    ds_read_b64 v[68:69], v16 offset:16896
    buffer_load_dwordx4 v241, s[28:31], s97 offen offset:1024  lds
    ds_read_b64 v[70:71], v231 offset:16896
    ds_read_b64 v[72:73], v16 offset:17152
    buffer_load_dwordx4 v242, s[28:31], s97 offen offset:2048  lds
    ds_read_b64 v[74:75], v231 offset:17152
    ds_read_b64 v[76:77], v16 offset:17408
    buffer_load_dwordx4 v243, s[28:31], s97 offen offset:3072  lds
    ds_read_b64 v[78:79], v231 offset:17408
    ds_read_b64 v[80:81], v16 offset:17664
    s_add_u32 m0, s88, 18432
    s_mov_b64 exec, 0xffffffff
    buffer_load_dwordx4 v3, s[28:31], s97 offen offset:0  lds
    s_mov_b64 exec, -1
    ds_read_b64 v[82:83], v231 offset:17664
    s_waitcnt vmcnt(11)
    s_waitcnt lgkmcnt(0)
    s_barrier
    s_mul_i32 s16, s97, 3072
    s_add_u32 m0, s60, 24576
    s_add_u32 s99, s16, s62
    buffer_load_dwordx4 v244, s[32:35], s99 offen offset:0  lds
    v_lshlrev_b32 v160, 16, v40
    v_lshlrev_b32 v161, 16, v42
    v_lshlrev_b32 v162, 16, v44
    v_lshlrev_b32 v163, 16, v46
    v_lshlrev_b32 v164, 16, v48
    buffer_load_dwordx4 v245, s[32:35], s99 offen offset:1024  lds
    v_lshlrev_b32 v165, 16, v50
    v_lshlrev_b32 v166, 16, v52
    v_lshlrev_b32 v167, 16, v54
    v_lshlrev_b32 v168, 16, v56
    v_lshlrev_b32 v169, 16, v58
    buffer_load_dwordx4 v246, s[32:35], s99 offen offset:2048  lds
    v_lshlrev_b32 v170, 16, v60
    v_lshlrev_b32 v172, 16, v84
    v_and_b32 v173, 0xffff0000, v84
    v_lshlrev_b32 v174, 16, v85
    v_and_b32 v175, 0xffff0000, v85
    s_add_u32 m0, s61, 36864
    s_add_u32 s16, s16, s63
    buffer_load_dwordx4 v244, s[32:35], s16 offen offset:0  lds
    v_lshlrev_b32 v176, 16, v68
    v_lshlrev_b32 v177, 16, v70
    v_lshlrev_b32 v178, 16, v72
    v_lshlrev_b32 v179, 16, v74
    v_lshlrev_b32 v180, 16, v76
    buffer_load_dwordx4 v245, s[32:35], s16 offen offset:1024  lds
    v_lshlrev_b32 v181, 16, v78
    v_lshlrev_b32 v182, 16, v80
    v_lshlrev_b32 v183, 16, v82
    v_mul_f32 v184, v160, v175
    v_mul_f32 v185, v161, v175
    buffer_load_dwordx4 v246, s[32:35], s16 offen offset:2048  lds
    v_mul_f32 v186, v162, v175
    v_mul_f32 v187, v163, v175
    v_mul_f32 v188, v164, v175
    v_mul_f32 v189, v165, v175
    v_mul_f32 v190, v166, v175
    s_add_u32 s97, s98, s0
    s_lshr_b64 s[0:1], s[0:1], 4
    s_and_b32 s97, s97, 15
    s_lshr_b32 s99, s97, 3
    s_xor_b32 s97, s97, s99
    s_add_u32 m0, s87, 36864
    s_lshl_b32 s97, s97, 7
    buffer_load_dwordx4 v240, s[28:31], s97 offen offset:0  lds
    v_mul_f32 v191, v167, v175
    v_fmac_f32 v184, v161, v174
    v_fmac_f32 v185, v162, v174
    v_fmac_f32 v186, v163, v174
    v_fmac_f32 v187, v164, v174
    buffer_load_dwordx4 v241, s[28:31], s97 offen offset:1024  lds
    v_fmac_f32 v188, v165, v174
    v_fmac_f32 v189, v166, v174
    v_fmac_f32 v190, v167, v174
    v_fmac_f32 v191, v168, v174
    v_fmac_f32 v184, v162, v173
    buffer_load_dwordx4 v242, s[28:31], s97 offen offset:2048  lds
    v_fmac_f32 v185, v163, v173
    v_fmac_f32 v186, v164, v173
    v_fmac_f32 v187, v165, v173
    v_fmac_f32 v188, v166, v173
    v_fmac_f32 v189, v167, v173
    buffer_load_dwordx4 v243, s[28:31], s97 offen offset:3072  lds
    v_fmac_f32 v190, v168, v173
    v_fmac_f32 v191, v169, v173
    v_fmac_f32 v184, v163, v172
    v_fmac_f32 v185, v164, v172
    v_fmac_f32 v186, v165, v172
    s_add_u32 m0, s88, 36864
    s_mov_b64 exec, 0xffffffff
    buffer_load_dwordx4 v3, s[28:31], s97 offen offset:0  lds
    s_mov_b64 exec, -1
    v_fmac_f32 v187, v166, v172
    v_fmac_f32 v188, v167, v172
    v_fmac_f32 v189, v168, v172
    v_fmac_f32 v190, v169, v172
    v_fmac_f32 v191, v170, v172
    v_mul_f32 v184, v184, v176
    v_mul_f32 v185, v185, v177
    v_mul_f32 v186, v186, v178
    v_mul_f32 v187, v187, v179
    v_mul_f32 v188, v188, v180
    v_mul_f32 v189, v189, v181
    v_mul_f32 v190, v190, v182
    v_mul_f32 v191, v191, v183
    v_cvt_pk_bf16_f32 v100, v191, v190
    v_cvt_pk_bf16_f32 v101, v189, v188
    v_cvt_pk_bf16_f32 v102, v187, v186
    v_cvt_pk_bf16_f32 v103, v185, v184
    s_mov_b32 s89, 0
    buffer_store_dwordx4 v[100:103], v12, s[52:55], s89 offen sc1
    s_waitcnt vmcnt(12)
    s_barrier
    s_mul_i32 s16, s97, 3072
    s_add_u32 m0, s60, 49152
    s_add_u32 s99, s16, s62
    buffer_load_dwordx4 v244, s[32:35], s99 offen offset:0  lds
    v_and_b32 v160, 0xffff0000, v40
    v_and_b32 v161, 0xffff0000, v42
    v_and_b32 v162, 0xffff0000, v44
    v_and_b32 v163, 0xffff0000, v46
    v_and_b32 v164, 0xffff0000, v48
    buffer_load_dwordx4 v245, s[32:35], s99 offen offset:1024  lds
    v_and_b32 v165, 0xffff0000, v50
    v_and_b32 v166, 0xffff0000, v52
    v_and_b32 v167, 0xffff0000, v54
    v_and_b32 v168, 0xffff0000, v56
    v_and_b32 v169, 0xffff0000, v58
    buffer_load_dwordx4 v246, s[32:35], s99 offen offset:2048  lds
    v_and_b32 v170, 0xffff0000, v60
    v_lshlrev_b32 v172, 16, v86
    v_and_b32 v173, 0xffff0000, v86
    v_lshlrev_b32 v174, 16, v87
    v_and_b32 v175, 0xffff0000, v87
    s_add_u32 m0, s61, 61440
    s_add_u32 s16, s16, s63
    buffer_load_dwordx4 v244, s[32:35], s16 offen offset:0  lds
    v_and_b32 v176, 0xffff0000, v68
    v_and_b32 v177, 0xffff0000, v70
    v_and_b32 v178, 0xffff0000, v72
    v_and_b32 v179, 0xffff0000, v74
    v_and_b32 v180, 0xffff0000, v76
    buffer_load_dwordx4 v245, s[32:35], s16 offen offset:1024  lds
    v_and_b32 v181, 0xffff0000, v78
    v_and_b32 v182, 0xffff0000, v80
    v_and_b32 v183, 0xffff0000, v82
    v_mul_f32 v184, v160, v175
    v_mul_f32 v185, v161, v175
    buffer_load_dwordx4 v246, s[32:35], s16 offen offset:2048  lds
    v_mul_f32 v186, v162, v175
    v_mul_f32 v187, v163, v175
    v_mul_f32 v188, v164, v175
    v_mul_f32 v189, v165, v175
    v_mul_f32 v190, v166, v175
    s_add_u32 s97, s98, s0
    s_lshr_b64 s[0:1], s[0:1], 4
    s_and_b32 s97, s97, 15
    s_lshr_b32 s99, s97, 3
    s_xor_b32 s97, s97, s99
    s_add_u32 m0, s87, 0
    s_lshl_b32 s97, s97, 7
    buffer_load_dwordx4 v240, s[28:31], s97 offen offset:0  lds
    v_mul_f32 v191, v167, v175
    v_fmac_f32 v184, v161, v174
    v_fmac_f32 v185, v162, v174
    v_fmac_f32 v186, v163, v174
    v_fmac_f32 v187, v164, v174
    buffer_load_dwordx4 v241, s[28:31], s97 offen offset:1024  lds
    v_fmac_f32 v188, v165, v174
    v_fmac_f32 v189, v166, v174
    v_fmac_f32 v190, v167, v174
    v_fmac_f32 v191, v168, v174
    v_fmac_f32 v184, v162, v173
    buffer_load_dwordx4 v242, s[28:31], s97 offen offset:2048  lds
    v_fmac_f32 v185, v163, v173
    v_fmac_f32 v186, v164, v173
    v_fmac_f32 v187, v165, v173
    v_fmac_f32 v188, v166, v173
    v_fmac_f32 v189, v167, v173
    buffer_load_dwordx4 v243, s[28:31], s97 offen offset:3072  lds
    v_fmac_f32 v190, v168, v173
    v_fmac_f32 v191, v169, v173
    v_fmac_f32 v184, v163, v172
    v_fmac_f32 v185, v164, v172
    v_fmac_f32 v186, v165, v172
    s_add_u32 m0, s88, 0
    s_mov_b64 exec, 0xffffffff
    buffer_load_dwordx4 v3, s[28:31], s97 offen offset:0  lds
    s_mov_b64 exec, -1
    v_fmac_f32 v187, v166, v172
    v_fmac_f32 v188, v167, v172
    v_fmac_f32 v189, v168, v172
    v_fmac_f32 v190, v169, v172
    v_fmac_f32 v191, v170, v172
    v_mul_f32 v184, v184, v176
    v_mul_f32 v185, v185, v177
    v_mul_f32 v186, v186, v178
    v_mul_f32 v187, v187, v179
    v_mul_f32 v188, v188, v180
    v_mul_f32 v189, v189, v181
    v_mul_f32 v190, v190, v182
    v_mul_f32 v191, v191, v183
    v_cvt_pk_bf16_f32 v104, v191, v190
    v_cvt_pk_bf16_f32 v105, v189, v188
    v_cvt_pk_bf16_f32 v106, v187, v186
    v_cvt_pk_bf16_f32 v107, v185, v184
    s_mov_b32 s89, 16384
    buffer_store_dwordx4 v[104:107], v12, s[52:55], s89 offen sc1
    s_waitcnt vmcnt(13)
    s_barrier
    s_mul_i32 s16, s97, 3072
    s_add_u32 m0, s60, 0
    s_add_u32 s99, s16, s62
    buffer_load_dwordx4 v244, s[32:35], s99 offen offset:0  lds
    v_lshlrev_b32 v160, 16, v41
    v_lshlrev_b32 v161, 16, v43
    v_lshlrev_b32 v162, 16, v45
    v_lshlrev_b32 v163, 16, v47
    v_lshlrev_b32 v164, 16, v49
    buffer_load_dwordx4 v245, s[32:35], s99 offen offset:1024  lds
    v_lshlrev_b32 v165, 16, v51
    v_lshlrev_b32 v166, 16, v53
    v_lshlrev_b32 v167, 16, v55
    v_lshlrev_b32 v168, 16, v57
    v_lshlrev_b32 v169, 16, v59
    buffer_load_dwordx4 v246, s[32:35], s99 offen offset:2048  lds
    v_lshlrev_b32 v170, 16, v61
    v_lshlrev_b32 v172, 16, v88
    v_and_b32 v173, 0xffff0000, v88
    v_lshlrev_b32 v174, 16, v89
    v_and_b32 v175, 0xffff0000, v89
    s_add_u32 m0, s61, 12288
    s_add_u32 s16, s16, s63
    buffer_load_dwordx4 v244, s[32:35], s16 offen offset:0  lds
    v_lshlrev_b32 v176, 16, v69
    v_lshlrev_b32 v177, 16, v71
    v_lshlrev_b32 v178, 16, v73
    v_lshlrev_b32 v179, 16, v75
    v_lshlrev_b32 v180, 16, v77
    buffer_load_dwordx4 v245, s[32:35], s16 offen offset:1024  lds
    v_lshlrev_b32 v181, 16, v79
    v_lshlrev_b32 v182, 16, v81
    v_lshlrev_b32 v183, 16, v83
    v_mul_f32 v184, v160, v175
    v_mul_f32 v185, v161, v175
    buffer_load_dwordx4 v246, s[32:35], s16 offen offset:2048  lds
    v_mul_f32 v186, v162, v175
    v_mul_f32 v187, v163, v175
    v_mul_f32 v188, v164, v175
    v_mul_f32 v189, v165, v175
    v_mul_f32 v190, v166, v175
    s_add_u32 s97, s98, s0
    s_lshr_b64 s[0:1], s[0:1], 4
    s_and_b32 s97, s97, 15
    s_lshr_b32 s99, s97, 3
    s_xor_b32 s97, s97, s99
    s_add_u32 m0, s87, 18432
    s_lshl_b32 s97, s97, 7
    buffer_load_dwordx4 v240, s[28:31], s97 offen offset:0  lds
    v_mul_f32 v191, v167, v175
    v_fmac_f32 v184, v161, v174
    v_fmac_f32 v185, v162, v174
    v_fmac_f32 v186, v163, v174
    v_fmac_f32 v187, v164, v174
    buffer_load_dwordx4 v241, s[28:31], s97 offen offset:1024  lds
    v_fmac_f32 v188, v165, v174
    v_fmac_f32 v189, v166, v174
    v_fmac_f32 v190, v167, v174
    v_fmac_f32 v191, v168, v174
    v_fmac_f32 v184, v162, v173
    buffer_load_dwordx4 v242, s[28:31], s97 offen offset:2048  lds
    v_fmac_f32 v185, v163, v173
    v_fmac_f32 v186, v164, v173
    v_fmac_f32 v187, v165, v173
    v_fmac_f32 v188, v166, v173
    v_fmac_f32 v189, v167, v173
    buffer_load_dwordx4 v243, s[28:31], s97 offen offset:3072  lds
    v_fmac_f32 v190, v168, v173
    v_fmac_f32 v191, v169, v173
    v_fmac_f32 v184, v163, v172
    v_fmac_f32 v185, v164, v172
    v_fmac_f32 v186, v165, v172
    s_add_u32 m0, s88, 18432
    s_mov_b64 exec, 0xffffffff
    buffer_load_dwordx4 v3, s[28:31], s97 offen offset:0  lds
    s_mov_b64 exec, -1
    v_fmac_f32 v187, v166, v172
    v_fmac_f32 v188, v167, v172
    v_fmac_f32 v189, v168, v172
    v_fmac_f32 v190, v169, v172
    v_fmac_f32 v191, v170, v172
    v_mul_f32 v184, v184, v176
    v_mul_f32 v185, v185, v177
    v_mul_f32 v186, v186, v178
    v_mul_f32 v187, v187, v179
    v_mul_f32 v188, v188, v180
    v_mul_f32 v189, v189, v181
    v_mul_f32 v190, v190, v182
    v_mul_f32 v191, v191, v183
    v_cvt_pk_bf16_f32 v108, v191, v190
    v_cvt_pk_bf16_f32 v109, v189, v188
    v_cvt_pk_bf16_f32 v110, v187, v186
    v_cvt_pk_bf16_f32 v111, v185, v184
    s_mov_b32 s89, 32768
    buffer_store_dwordx4 v[108:111], v12, s[52:55], s89 offen sc1
    s_waitcnt vmcnt(13)
    s_barrier
    s_mul_i32 s16, s97, 3072
    s_add_u32 m0, s60, 24576
    s_add_u32 s99, s16, s62
    buffer_load_dwordx4 v244, s[32:35], s99 offen offset:0  lds
    v_and_b32 v160, 0xffff0000, v41
    v_and_b32 v161, 0xffff0000, v43
    v_and_b32 v162, 0xffff0000, v45
    v_and_b32 v163, 0xffff0000, v47
    v_and_b32 v164, 0xffff0000, v49
    buffer_load_dwordx4 v245, s[32:35], s99 offen offset:1024  lds
    v_and_b32 v165, 0xffff0000, v51
    v_and_b32 v166, 0xffff0000, v53
    v_and_b32 v167, 0xffff0000, v55
    v_and_b32 v168, 0xffff0000, v57
    v_and_b32 v169, 0xffff0000, v59
    buffer_load_dwordx4 v246, s[32:35], s99 offen offset:2048  lds
    v_and_b32 v170, 0xffff0000, v61
    v_lshlrev_b32 v172, 16, v90
    v_and_b32 v173, 0xffff0000, v90
    v_lshlrev_b32 v174, 16, v91
    v_and_b32 v175, 0xffff0000, v91
    s_add_u32 m0, s61, 36864
    s_add_u32 s16, s16, s63
    buffer_load_dwordx4 v244, s[32:35], s16 offen offset:0  lds
    v_and_b32 v176, 0xffff0000, v69
    v_and_b32 v177, 0xffff0000, v71
    v_and_b32 v178, 0xffff0000, v73
    v_and_b32 v179, 0xffff0000, v75
    v_and_b32 v180, 0xffff0000, v77
    buffer_load_dwordx4 v245, s[32:35], s16 offen offset:1024  lds
    v_and_b32 v181, 0xffff0000, v79
    v_and_b32 v182, 0xffff0000, v81
    v_and_b32 v183, 0xffff0000, v83
    v_mul_f32 v184, v160, v175
    v_mul_f32 v185, v161, v175
    buffer_load_dwordx4 v246, s[32:35], s16 offen offset:2048  lds
    v_mul_f32 v186, v162, v175
    v_mul_f32 v187, v163, v175
    v_mul_f32 v188, v164, v175
    v_mul_f32 v189, v165, v175
    v_mul_f32 v190, v166, v175
    s_add_u32 s97, s98, s0
    s_lshr_b64 s[0:1], s[0:1], 4
    s_and_b32 s97, s97, 15
    s_lshr_b32 s99, s97, 3
    s_xor_b32 s97, s97, s99
    s_add_u32 m0, s87, 36864
    s_lshl_b32 s97, s97, 7
    buffer_load_dwordx4 v240, s[28:31], s97 offen offset:0  lds
    v_mul_f32 v191, v167, v175
    v_fmac_f32 v184, v161, v174
    v_fmac_f32 v185, v162, v174
    v_fmac_f32 v186, v163, v174
    v_fmac_f32 v187, v164, v174
    buffer_load_dwordx4 v241, s[28:31], s97 offen offset:1024  lds
    v_fmac_f32 v188, v165, v174
    v_fmac_f32 v189, v166, v174
    v_fmac_f32 v190, v167, v174
    v_fmac_f32 v191, v168, v174
    v_fmac_f32 v184, v162, v173
    buffer_load_dwordx4 v242, s[28:31], s97 offen offset:2048  lds
    v_fmac_f32 v185, v163, v173
    v_fmac_f32 v186, v164, v173
    v_fmac_f32 v187, v165, v173
    v_fmac_f32 v188, v166, v173
    v_fmac_f32 v189, v167, v173
    buffer_load_dwordx4 v243, s[28:31], s97 offen offset:3072  lds
    v_fmac_f32 v190, v168, v173
    v_fmac_f32 v191, v169, v173
    v_fmac_f32 v184, v163, v172
    v_fmac_f32 v185, v164, v172
    v_fmac_f32 v186, v165, v172
    s_add_u32 m0, s88, 36864
    s_mov_b64 exec, 0xffffffff
    buffer_load_dwordx4 v3, s[28:31], s97 offen offset:0  lds
    s_mov_b64 exec, -1
    v_fmac_f32 v187, v166, v172
    v_fmac_f32 v188, v167, v172
    v_fmac_f32 v189, v168, v172
    v_fmac_f32 v190, v169, v172
    v_fmac_f32 v191, v170, v172
    v_mul_f32 v184, v184, v176
    v_mul_f32 v185, v185, v177
    v_mul_f32 v186, v186, v178
    v_mul_f32 v187, v187, v179
    v_mul_f32 v188, v188, v180
    v_mul_f32 v189, v189, v181
    v_mul_f32 v190, v190, v182
    v_mul_f32 v191, v191, v183
    v_cvt_pk_bf16_f32 v112, v191, v190
    v_cvt_pk_bf16_f32 v113, v189, v188
    v_cvt_pk_bf16_f32 v114, v187, v186
    v_cvt_pk_bf16_f32 v115, v185, v184
    s_mov_b32 s89, 49152
    buffer_store_dwordx4 v[112:115], v12, s[52:55], s89 offen sc1
    s_waitcnt vmcnt(13)
    s_barrier
    s_mul_i32 s16, s97, 3072
    s_add_u32 m0, s60, 49152
    s_add_u32 s99, s16, s62
    buffer_load_dwordx4 v244, s[32:35], s99 offen offset:0  lds
    buffer_load_dwordx4 v245, s[32:35], s99 offen offset:1024  lds
    buffer_load_dwordx4 v246, s[32:35], s99 offen offset:2048  lds
    s_add_u32 m0, s61, 61440
    s_add_u32 s16, s16, s63
    buffer_load_dwordx4 v244, s[32:35], s16 offen offset:0  lds
    buffer_load_dwordx4 v245, s[32:35], s16 offen offset:1024  lds
    buffer_load_dwordx4 v246, s[32:35], s16 offen offset:2048  lds
    s_add_u32 s97, s98, s0
    s_lshr_b64 s[0:1], s[0:1], 4
    s_and_b32 s97, s97, 15
    s_lshr_b32 s99, s97, 3
    s_xor_b32 s97, s97, s99
    s_add_u32 m0, s87, 0
    s_lshl_b32 s97, s97, 7
    buffer_load_dwordx4 v240, s[28:31], s97 offen offset:0  lds
    buffer_load_dwordx4 v241, s[28:31], s97 offen offset:1024  lds
    buffer_load_dwordx4 v242, s[28:31], s97 offen offset:2048  lds
    buffer_load_dwordx4 v243, s[28:31], s97 offen offset:3072  lds
    s_add_u32 m0, s88, 0
    s_mov_b64 exec, 0xffffffff
    buffer_load_dwordx4 v3, s[28:31], s97 offen offset:0  lds
    s_mov_b64 exec, -1
    s_waitcnt vmcnt(12)
    s_waitcnt vmcnt(11)
    s_barrier
    s_mul_i32 s16, s97, 3072
    s_add_u32 m0, s60, 0
    s_add_u32 s99, s16, s62
    buffer_load_dwordx4 v244, s[32:35], s99 offen offset:0  lds
    s_mov_b32 s68, s24
    s_mov_b32 s69, s25
    s_mov_b32 s70, 0x100
    s_mov_b32 s71, 0x20000
    buffer_load_dwordx4 v245, s[32:35], s99 offen offset:1024  lds
    v_lshrrev_b32 v6, 5, v0
    v_and_b32 v7, 3, v0
    s_lshr_b32 s78, s90, 1
    buffer_load_dwordx4 v246, s[32:35], s99 offen offset:2048  lds
    s_lshl_b32 s78, s78, 2
    s_load_dword s92, s[14:15], s78
    v_bfe_u32 v5, v0, 2, 2
    v_lshlrev_b32 v5, 1, v5
    s_add_u32 m0, s61, 12288
    s_add_u32 s16, s16, s63
    buffer_load_dwordx4 v244, s[32:35], s16 offen offset:0  lds
    v_lshl_add_u32 v5, v6, 3, v5
    v_bfe_u32 v8, v0, 4, 1
    v_add_u32 v5, v5, v8
    buffer_load_dwordx4 v245, s[32:35], s16 offen offset:1024  lds
    s_and_b32 s78, s3, 1
    s_lshl_b32 s78, s78, 1
    v_add_u32 v8, s78, v6
    v_xor_b32 v8, v8, v7
    buffer_load_dwordx4 v246, s[32:35], s16 offen offset:2048  lds
    v_lshlrev_b32 v8, 4, v8
    v_lshl_add_u32 v5, v5, 6, v8
    v_add_u32 v14, s86, v5
    s_add_u32 m0, s94, 32
    s_lshl_b32 s89, s90, 12
    buffer_load_dwordx4 v15, s[48:51], s89 offen offset:0 nt lds
    v_mov_b32 v18, 162304
    v_mov_b32 v19, 1
    v_and_b32 v5, 3, v0
    s_lshl_b32 s78, s74, 4
    s_add_u32 m0, s94, 32
    s_lshl_b32 s89, s90, 12
    buffer_load_dwordx4 v15, s[48:51], s89 offen offset:1024 nt lds
    s_add_u32 s78, s78, s3
    v_lshl_add_u32 v6, v5, 2, s78
    s_lshr_b32 s78, s76, 3
    s_add_u32 m0, s94, 32
    s_lshl_b32 s89, s90, 12
    buffer_load_dwordx4 v15, s[48:51], s89 offen offset:2048 nt lds
    s_lshl_b32 s79, s3, 1
    s_add_u32 s78, s78, s79
    s_xor_b32 s78, s78, 2
    s_lshl_b32 s78, s78, 5
    s_add_u32 m0, s94, 32
    s_lshl_b32 s89, s90, 12
    buffer_load_dwordx4 v15, s[48:51], s89 offen offset:3072 nt lds
    s_and_b32 s79, s76, 7
    s_add_u32 s78, s78, s79
    v_lshl_add_u32 v7, v5, 3, s78
    s_add_u32 s97, s98, s0
    s_lshr_b64 s[0:1], s[0:1], 4
    s_and_b32 s97, s97, 15
    s_lshr_b32 s99, s97, 3
    s_xor_b32 s97, s97, s99
    s_add_u32 m0, s87, 18432
    s_lshl_b32 s97, s97, 7
    buffer_load_dwordx4 v240, s[28:31], s97 offen offset:0  lds
    v_and_b32 v8, 4, v0
    v_cmp_eq_u32 vcc, 0, v8
    s_nop 1
    v_cndmask_b32 v6, v7, v6, vcc
    v_and_b32 v33, 0xf0, v6
    buffer_load_dwordx4 v241, s[28:31], s97 offen offset:1024  lds
    v_lshlrev_b32 v34, 8, v6
    v_add_u32 v34, 12582912, v34
    v_and_b32 v5, 15, v0
    buffer_load_dwordx4 v242, s[28:31], s97 offen offset:2048  lds
    v_lshrrev_b32 v6, 4, v0
    v_add_u32 v7, 9, v5
    v_and_b32 v8, 1, v7
    v_mul_u32_u24 v8, 4160, v8
    buffer_load_dwordx4 v243, s[28:31], s97 offen offset:3072  lds
    v_lshrrev_b32 v7, 1, v7
    v_lshl_add_u32 v8, v7, 2, v8
    v_lshlrev_b32 v7, 4, v6
    s_add_u32 m0, s88, 18432
    s_mov_b64 exec, 0xffffffff
    buffer_load_dwordx4 v3, s[28:31], s97 offen offset:0  lds
    s_mov_b64 exec, -1
    v_sub_u32 v8, v8, v7
    s_add_u32 s78, s94, 32
    v_add_u32 v21, s78, v8
    s_waitcnt vmcnt(15)
    s_barrier
    s_mul_i32 s16, s97, 3072
    s_add_u32 m0, s60, 24576
    s_add_u32 s99, s16, s62
    buffer_load_dwordx4 v244, s[32:35], s99 offen offset:0  lds
    v_add_u32 v22, 1024, v21
    v_add_u32 v23, 2048, v21
    v_add_u32 v24, 3072, v21
    v_lshl_add_u32 v7, v5, 1, v6
    v_add_u32 v7, 30, v7
    buffer_load_dwordx4 v245, s[32:35], s99 offen offset:1024  lds
    v_and_b32 v8, 1, v7
    v_bfe_u32 v136, v7, 1, 2
    v_lshl_add_u32 v136, v8, 2, v136
    v_lshlrev_b32 v136, 6, v136
    v_lshrrev_b32 v7, 3, v7
    buffer_load_dwordx4 v246, s[32:35], s99 offen offset:2048  lds
    v_lshl_add_u32 v136, v7, 9, v136
    v_bitop3_b32 v8, v7, 3, s3 bitop3:0x6a
    v_lshl_add_u32 v25, v8, 4, v136
    v_add_u32 v25, 92160, v25
    v_subrev_u32 v7, 1, v7
    s_add_u32 m0, s61, 36864
    s_add_u32 s16, s16, s63
    buffer_load_dwordx4 v244, s[32:35], s16 offen offset:0  lds
    v_bitop3_b32 v8, v7, 3, s3 bitop3:0x6a
    v_lshl_add_u32 v27, v8, 4, v136
    v_add_u32 v27, 91648, v27
    v_subrev_u32 v7, 1, v7
    buffer_load_dwordx4 v245, s[32:35], s16 offen offset:1024  lds
    v_bitop3_b32 v8, v7, 3, s3 bitop3:0x6a
    v_lshl_add_u32 v29, v8, 4, v136
    v_add_u32 v29, 91136, v29
    v_subrev_u32 v7, 1, v7
    v_bitop3_b32 v8, v7, 3, s3 bitop3:0x6a
    buffer_load_dwordx4 v246, s[32:35], s16 offen offset:2048  lds
    v_lshl_add_u32 v31, v8, 4, v136
    v_add_u32 v31, 90624, v31
    v_lshl_add_u32 v7, v5, 1, v6
    v_add_u32 v7, 26, v7
    v_and_b32 v8, 1, v7
    s_add_u32 s97, s98, s0
    s_lshr_b64 s[0:1], s[0:1], 4
    s_and_b32 s97, s97, 15
    s_lshr_b32 s99, s97, 3
    s_xor_b32 s97, s97, s99
    s_add_u32 m0, s87, 36864
    s_lshl_b32 s97, s97, 7
    buffer_load_dwordx4 v240, s[28:31], s97 offen offset:0  lds
    v_bfe_u32 v136, v7, 1, 2
    v_lshl_add_u32 v136, v8, 2, v136
    v_lshlrev_b32 v136, 6, v136
    v_lshrrev_b32 v7, 3, v7
    v_lshl_add_u32 v136, v7, 9, v136
    buffer_load_dwordx4 v241, s[28:31], s97 offen offset:1024  lds
    v_bitop3_b32 v8, v7, 3, s3 bitop3:0x6a
    v_lshl_add_u32 v26, v8, 4, v136
    v_add_u32 v26, 92160, v26
    v_subrev_u32 v7, 1, v7
    buffer_load_dwordx4 v242, s[28:31], s97 offen offset:2048  lds
    v_bitop3_b32 v8, v7, 3, s3 bitop3:0x6a
    v_lshl_add_u32 v28, v8, 4, v136
    v_add_u32 v28, 91648, v28
    v_subrev_u32 v7, 1, v7
    v_bitop3_b32 v8, v7, 3, s3 bitop3:0x6a
    buffer_load_dwordx4 v243, s[28:31], s97 offen offset:3072  lds
    v_lshl_add_u32 v30, v8, 4, v136
    v_add_u32 v30, 91136, v30
    v_subrev_u32 v7, 1, v7
    v_bitop3_b32 v8, v7, 3, s3 bitop3:0x6a
    v_lshl_add_u32 v32, v8, 4, v136
    s_add_u32 m0, s88, 36864
    s_mov_b64 exec, 0xffffffff
    buffer_load_dwordx4 v3, s[28:31], s97 offen offset:0  lds
    s_mov_b64 exec, -1
    v_add_u32 v32, 90624, v32
    v_lshrrev_b32 v7, 1, v6
    v_lshl_add_u32 v7, v5, 1, v7
    v_add_u32 v7, 32, v7
    s_waitcnt vmcnt(11)
    s_barrier
    s_mul_i32 s16, s97, 3072
    s_add_u32 m0, s60, 49152
    s_add_u32 s99, s16, s62
    buffer_load_dwordx4 v244, s[32:35], s99 offen offset:0  lds
    v_and_b32 v8, 1, v7
    v_bfe_u32 v136, v7, 1, 2
    v_lshl_add_u32 v136, v8, 2, v136
    v_lshlrev_b32 v136, 6, v136
    buffer_load_dwordx4 v245, s[32:35], s99 offen offset:1024  lds
    v_lshrrev_b32 v7, 3, v7
    v_lshl_add_u32 v136, v7, 9, v136
    v_bitop3_b32 v8, v7, 3, s3 bitop3:0x6a
    v_lshl_add_u32 v20, v8, 4, v136
    buffer_load_dwordx4 v246, s[32:35], s99 offen offset:2048  lds
    v_add_u32 v20, 92160, v20
    v_and_b32 v8, 1, v6
    v_xor_b32 v8, 1, v8
    v_lshl_add_u32 v20, v8, 3, v20
    s_add_u32 m0, s61, 61440
    s_add_u32 s16, s16, s63
    buffer_load_dwordx4 v244, s[32:35], s16 offen offset:0  lds
    s_waitcnt lgkmcnt(0)
    s_and_b32 s78, s92, 0xffff0000
    s_lshl_b32 s92, s92, 16
    s_bitcmp1_b32 s90, 0
    s_cselect_b32 s92, s78, s92
    buffer_load_dwordx4 v245, s[32:35], s16 offen offset:1024  lds
    v_lshlrev_b32 v7, 3, v6
    v_sub_u32 v7, v7, v5
    v_subrev_u32 v7, 9, v7
    v_and_b32 v8, 1, v7
    buffer_load_dwordx4 v246, s[32:35], s16 offen offset:2048  lds
    v_xor_b32 v8, 1, v8
    v_lshlrev_b32 v8, 4, v8
    v_lshrrev_b32 v8, v8, s92
    v_ashrrev_i32 v7, 1, v7
    s_add_u32 s97, s98, s0
    s_lshr_b64 s[0:1], s[0:1], 4
    s_and_b32 s97, s97, 15
    s_lshr_b32 s99, s97, 3
    s_xor_b32 s97, s97, s99
    s_add_u32 m0, s87, 0
    s_lshl_b32 s97, s97, 7
    buffer_load_dwordx4 v240, s[28:31], s97 offen offset:0  lds
    v_cmp_eq_u32 vcc, 0, v7
    s_nop 1
    v_cndmask_b32 v236, 0, v8, vcc
    v_cmp_eq_u32 vcc, 1, v7
    s_nop 1
    v_cndmask_b32 v237, 0, v8, vcc
    buffer_load_dwordx4 v241, s[28:31], s97 offen offset:1024  lds
    v_cmp_eq_u32 vcc, 2, v7
    s_nop 1
    v_cndmask_b32 v238, 0, v8, vcc
    v_cmp_eq_u32 vcc, 3, v7
    s_nop 1
    v_cndmask_b32 v239, 0, v8, vcc
    buffer_load_dwordx4 v242, s[28:31], s97 offen offset:2048  lds
    s_and_b32 s78, s77, 7
    s_mov_b32 s95, 0x76543210
    s_cmp_eq_u32 s78, 1
    s_cselect_b32 s95, 0x76543201, s95
    s_cmp_eq_u32 s78, 2
    s_cselect_b32 s95, 0x76543120, s95
    s_cmp_eq_u32 s78, 3
    s_cselect_b32 s95, 0x76542310, s95
    s_cmp_eq_u32 s78, 4
    s_cselect_b32 s95, 0x76534210, s95
    s_cmp_eq_u32 s78, 5
    s_cselect_b32 s95, 0x76453210, s95
    s_cmp_eq_u32 s78, 6
    s_cselect_b32 s95, 0x75643210, s95
    s_cmp_eq_u32 s78, 7
    s_cselect_b32 s95, 0x67543210, s95
    s_and_b32 s78, s76, 3
    s_mul_i32 s78, s78, 0x22222222
    s_add_u32 s95, s95, s78
    s_bfe_u32 s100, s95, 0x3001c
    s_lshl_b32 s100, s100, 18
    s_bfe_u32 s95, s95, 0x30018
    s_lshl_b32 s95, s95, 18
    v_lshrrev_b32 v136, 4, v0
    v_lshlrev_b32 v136, 1, v136
    v_and_b32 v137, 7, v0
    buffer_load_dwordx4 v243, s[28:31], s97 offen offset:3072  lds
    v_xor_b32 v136, v136, v137
    v_lshlrev_b32 v136, 4, v136
    v_lshrrev_b32 v137, 3, v0
    v_lshl_add_u32 v136, v137, 11, v136
    s_add_u32 m0, s88, 0
    s_mov_b64 exec, 0xffffffff
    buffer_load_dwordx4 v3, s[28:31], s97 offen offset:0  lds
    s_mov_b64 exec, -1
    s_lshl_b32 s78, s77, 7
    s_lshl_b32 s79, s3, 14
    s_add_u32 s78, s78, s79
    v_add_u32 v17, s78, v136
    s_waitcnt vmcnt(11)
    s_barrier
    s_mul_i32 s16, s97, 3072
    s_add_u32 m0, s60, 0
    s_add_u32 s99, s16, s62
    buffer_load_dwordx4 v244, s[32:35], s99 offen offset:0  lds
    v_add_u32 v5, s94, v15
    ds_read_b128 v[140:143], v5 offset:32
    ds_read_b32 v156, v5 offset:48
    ds_read_b128 v[144:147], v5 offset:1056
    ds_read_b32 v157, v5 offset:1072
    buffer_load_dwordx4 v245, s[32:35], s99 offen offset:1024  lds
    ds_read_b128 v[148:151], v5 offset:2080
    ds_read_b32 v158, v5 offset:2096
    ds_read_b128 v[152:155], v5 offset:3104
    ds_read_b32 v159, v5 offset:3120
    v_lshrrev_b32 v6, 3, v0
    buffer_load_dwordx4 v246, s[32:35], s99 offen offset:2048  lds
    v_mul_u32_u24 v6, 4160, v6
    v_and_b32 v7, 7, v0
    v_lshl_add_u32 v6, v7, 2, v6
    v_add_u32 v6, s94, v6
    v_mov_b32 v7, 0
    s_add_u32 m0, s61, 12288
    s_add_u32 s16, s16, s63
    buffer_load_dwordx4 v244, s[32:35], s16 offen offset:0  lds
    s_waitcnt lgkmcnt(0)
    v_readfirstlane_b32 s93, v140
    s_nop 0
    s_lshl_b32 s93, s93, 16
    s_nop 1
    v_writelane_b32 v7, s93, 15
    v_alignbit_b32 v140, v141, v140, 16
    buffer_load_dwordx4 v245, s[32:35], s16 offen offset:1024  lds
    v_alignbit_b32 v141, v142, v141, 16
    v_alignbit_b32 v142, v143, v142, 16
    v_alignbit_b32 v143, v156, v143, 16
    v_alignbit_b32 v144, v145, v144, 16
    v_alignbit_b32 v145, v146, v145, 16
    buffer_load_dwordx4 v246, s[32:35], s16 offen offset:2048  lds
    v_alignbit_b32 v146, v147, v146, 16
    v_alignbit_b32 v147, v157, v147, 16
    v_alignbit_b32 v148, v149, v148, 16
    v_alignbit_b32 v149, v150, v149, 16
    v_alignbit_b32 v150, v151, v150, 16
    s_mov_b64 exec, 0xff
    buffer_load_dword v136, v33, s[68:71], 0 offen sc1
    buffer_load_dword v137, v34, s[52:55], 0 offen sc1
    s_mov_b64 exec, -1
    v_alignbit_b32 v151, v158, v151, 16
    v_alignbit_b32 v152, v153, v152, 16
    v_alignbit_b32 v153, v154, v153, 16
    v_alignbit_b32 v154, v155, v154, 16
    v_alignbit_b32 v155, v159, v155, 16
    v_lshlrev_b32 v8, 3, v0
    s_add_u32 s78, s88, 18432
    v_add_u32 v8, s78, v8
    v_mov_b32 v156, 0
    v_mov_b32 v157, 0
    s_waitcnt vmcnt(8)
    s_waitcnt vmcnt(2)
    s_barrier
    s_waitcnt vmcnt(0)
LA_j:
    s_mov_b64 exec, 0xff
    v_cmp_ne_u32 vcc, v136, v137
    v_cmp_gt_u32 s[80:81], s96, v136
    s_nop 0
    s_or_b64 vcc, vcc, s[80:81]
    s_cbranch_vccnz LA_slow
LA_back:
    s_mov_b64 exec, -1
    s_add_u32 m0, s86, 94208
    s_add_u32 s89, s91, 0
    buffer_load_dwordx4 v14, s[52:55], s89 offen sc1 lds
    s_add_u32 m0, s86, 98304
    s_add_u32 s89, s91, 4096
    buffer_load_dwordx4 v14, s[52:55], s89 offen sc1 lds
    s_add_u32 m0, s86, 102400
    s_add_u32 s89, s91, 8192
    buffer_load_dwordx4 v14, s[52:55], s89 offen sc1 lds
    s_add_u32 m0, s86, 106496
    s_add_u32 s89, s91, 12288
    buffer_load_dwordx4 v14, s[52:55], s89 offen sc1 lds
    s_add_u32 s89, s95, 131072
    buffer_load_dwordx4 v[228:231], v17, s[64:67], s89 offen
    s_add_u32 s89, s95, 196608
    buffer_load_dwordx4 v[232:235], v17, s[64:67], s89 offen
    s_add_u32 s89, s100, 0
    buffer_load_dwordx4 v[240:243], v17, s[64:67], s89 offen
    s_add_u32 s89, s100, 65536
    buffer_load_dwordx4 v[244:247], v17, s[64:67], s89 offen
    s_add_u32 s89, s100, 131072
    buffer_load_dwordx4 v[248:251], v17, s[64:67], s89 offen
    s_add_u32 s89, s100, 196608
    buffer_load_dwordx4 v[196:199], v17, s[64:67], s89 offen
    buffer_load_dwordx4 v[212:215], v9, s[56:59], 0 offen offset:0 nt
    buffer_load_dwordx4 v[216:219], v9, s[56:59], 0 offen offset:2048 nt
    buffer_load_dwordx4 v[220:223], v9, s[56:59], s96 offen offset:0 nt
    buffer_load_dwordx4 v[224:227], v9, s[56:59], s96 offen offset:2048 nt
    s_mov_b64 exec, 0xffff
    ds_write_b32 v6, v7
    s_mov_b64 exec, -1
    ds_write_b128 v5, v[140:143] offset:4192
    ds_write_b128 v5, v[144:147] offset:5216
    ds_write_b128 v5, v[148:151] offset:6240
    ds_write_b128 v5, v[152:155] offset:7264
    ds_write_b64 v8, v[156:157]
    ds_read2_b32 v[68:69], v21 offset0:0 offset1:1
    ds_read2_b32 v[70:71], v21 offset0:2 offset1:3
    ds_read2_b32 v[72:73], v21 offset0:128 offset1:129
    ds_read2_b32 v[74:75], v21 offset0:130 offset1:131
    ds_read2_b32 v[76:77], v22 offset0:0 offset1:1
    ds_read2_b32 v[78:79], v22 offset0:2 offset1:3
    ds_read2_b32 v[80:81], v22 offset0:128 offset1:129
    ds_read2_b32 v[82:83], v22 offset0:130 offset1:131
    ds_read2_b32 v[84:85], v23 offset0:0 offset1:1
    ds_read2_b32 v[86:87], v23 offset0:2 offset1:3
    ds_read2_b32 v[88:89], v23 offset0:128 offset1:129
    ds_read2_b32 v[90:91], v23 offset0:130 offset1:131
    ds_read2_b32 v[92:93], v24 offset0:0 offset1:1
    ds_read2_b32 v[94:95], v24 offset0:2 offset1:3
    ds_read2_b32 v[96:97], v24 offset0:128 offset1:129
    ds_read2_b32 v[98:99], v24 offset0:130 offset1:131
    s_waitcnt vmcnt(10)
    s_mov_b64 exec, 1
    ds_add_u32 v18, v19 offset:20
    s_mov_b64 exec, -1
    s_branch LA_s5_in
LA_s5:
    s_sleep 1
LA_s5_in:
    ds_read_b32 v6, v18 offset:20
    s_waitcnt lgkmcnt(0)
    v_readfirstlane_b32 s78, v6
    s_nop 0
    s_cmp_ge_u32 s78, 4
    s_cbranch_scc0 LA_s5
    s_mov_b64 exec, 1
    ds_add_u32 v18, v19 offset:8
    s_mov_b64 exec, -1
    ds_read_b128 v[100:103], v25 offset:0
    ds_read_b128 v[104:107], v25 offset:2048
    ds_read_b128 v[108:111], v25 offset:4096
    ds_read_b128 v[112:115], v25 offset:6144
    ds_read_b128 v[116:119], v25 offset:8192
    ds_read_b128 v[120:123], v25 offset:10240
    ds_read_b128 v[124:127], v25 offset:12288
    ds_read_b128 v[128:131], v25 offset:14336
    s_setprio 2
    s_waitcnt lgkmcnt(7)
    v_mfma_f32_16x16x32_bf16 v[36:39], v[236:239], v[100:103], 0
    ds_read2_b32 v[132:133], v21 offset0:16 offset1:17
    v_mfma_f32_16x16x32_bf16 v[36:39], v[68:71], v[100:103], v[36:39]
    ds_read2_b32 v[134:135], v21 offset0:18 offset1:19
    s_waitcnt lgkmcnt(8)
    v_mfma_f32_16x16x32_bf16 v[40:43], v[236:239], v[104:107], 0
    v_mfma_f32_16x16x32_bf16 v[40:43], v[68:71], v[104:107], v[40:43]
    ds_read_b128 v[164:167], v26 offset:0
    v_mfma_f32_16x16x32_bf16 v[40:43], v[72:75], v[100:103], v[40:43]
    s_waitcnt lgkmcnt(8)
    v_mfma_f32_16x16x32_bf16 v[44:47], v[236:239], v[108:111], 0
    ds_read2_b32 v[136:137], v21 offset0:144 offset1:145
    v_mfma_f32_16x16x32_bf16 v[44:47], v[68:71], v[108:111], v[44:47]
    ds_read2_b32 v[138:139], v21 offset0:146 offset1:147
    v_mfma_f32_16x16x32_bf16 v[44:47], v[72:75], v[104:107], v[44:47]
    v_mfma_f32_16x16x32_bf16 v[44:47], v[76:79], v[100:103], v[44:47]
    ds_read_b128 v[168:171], v26 offset:2048
    s_waitcnt lgkmcnt(10)
    v_mfma_f32_16x16x32_bf16 v[48:51], v[236:239], v[112:115], 0
    v_mfma_f32_16x16x32_bf16 v[48:51], v[68:71], v[112:115], v[48:51]
    ds_read2_b32 v[140:141], v22 offset0:16 offset1:17
    v_mfma_f32_16x16x32_bf16 v[48:51], v[72:75], v[108:111], v[48:51]
    ds_read2_b32 v[142:143], v22 offset0:18 offset1:19
    v_mfma_f32_16x16x32_bf16 v[48:51], v[76:79], v[104:107], v[48:51]
    v_mfma_f32_16x16x32_bf16 v[48:51], v[80:83], v[100:103], v[48:51]
    ds_read_b128 v[172:175], v26 offset:4096
    s_waitcnt lgkmcnt(12)
    v_mfma_f32_16x16x32_bf16 v[52:55], v[236:239], v[116:119], 0
    v_mfma_f32_16x16x32_bf16 v[52:55], v[68:71], v[116:119], v[52:55]
    ds_read2_b32 v[144:145], v22 offset0:144 offset1:145
    v_mfma_f32_16x16x32_bf16 v[52:55], v[72:75], v[112:115], v[52:55]
    ds_read2_b32 v[146:147], v22 offset0:146 offset1:147
    v_mfma_f32_16x16x32_bf16 v[52:55], v[76:79], v[108:111], v[52:55]
    v_mfma_f32_16x16x32_bf16 v[52:55], v[80:83], v[104:107], v[52:55]
    ds_read_b128 v[176:179], v26 offset:6144
    v_mfma_f32_16x16x32_bf16 v[52:55], v[84:87], v[100:103], v[52:55]
    s_waitcnt lgkmcnt(14)
    v_mfma_f32_16x16x32_bf16 v[56:59], v[236:239], v[120:123], 0
    ds_read2_b32 v[148:149], v23 offset0:16 offset1:17
    v_mfma_f32_16x16x32_bf16 v[56:59], v[68:71], v[120:123], v[56:59]
    ds_read2_b32 v[150:151], v23 offset0:18 offset1:19
    v_mfma_f32_16x16x32_bf16 v[56:59], v[72:75], v[116:119], v[56:59]
    v_mfma_f32_16x16x32_bf16 v[56:59], v[76:79], v[112:115], v[56:59]
    ds_read_b128 v[180:183], v26 offset:8192
    v_mfma_f32_16x16x32_bf16 v[56:59], v[80:83], v[108:111], v[56:59]
    v_mfma_f32_16x16x32_bf16 v[56:59], v[84:87], v[104:107], v[56:59]
    ds_read2_b32 v[152:153], v23 offset0:144 offset1:145
    v_mfma_f32_16x16x32_bf16 v[56:59], v[88:91], v[100:103], v[56:59]
    ds_read2_b32 v[154:155], v23 offset0:146 offset1:147
    s_waitcnt lgkmcnt(14)
    v_mfma_f32_16x16x32_bf16 v[60:63], v[236:239], v[124:127], 0
    v_mfma_f32_16x16x32_bf16 v[60:63], v[68:71], v[124:127], v[60:63]
    ds_read_b128 v[184:187], v26 offset:10240
    v_mfma_f32_16x16x32_bf16 v[60:63], v[72:75], v[120:123], v[60:63]
    v_mfma_f32_16x16x32_bf16 v[60:63], v[76:79], v[116:119], v[60:63]
    ds_read2_b32 v[156:157], v24 offset0:16 offset1:17
    v_mfma_f32_16x16x32_bf16 v[60:63], v[80:83], v[112:115], v[60:63]
    ds_read2_b32 v[158:159], v24 offset0:18 offset1:19
    v_mfma_f32_16x16x32_bf16 v[60:63], v[84:87], v[108:111], v[60:63]
    v_mfma_f32_16x16x32_bf16 v[60:63], v[88:91], v[104:107], v[60:63]
    ds_read_b128 v[188:191], v26 offset:12288
    v_mfma_f32_16x16x32_bf16 v[60:63], v[92:95], v[100:103], v[60:63]
    v_mfma_f32_16x16x32_bf16 v[64:67], v[236:239], v[128:131], 0
    ds_read2_b32 v[160:161], v24 offset0:144 offset1:145
    v_mfma_f32_16x16x32_bf16 v[64:67], v[68:71], v[128:131], v[64:67]
    ds_read2_b32 v[162:163], v24 offset0:146 offset1:147
    v_mfma_f32_16x16x32_bf16 v[64:67], v[72:75], v[124:127], v[64:67]
    v_mfma_f32_16x16x32_bf16 v[64:67], v[76:79], v[120:123], v[64:67]
    ds_read_b128 v[192:195], v26 offset:14336
    v_mfma_f32_16x16x32_bf16 v[64:67], v[80:83], v[116:119], v[64:67]
    v_mfma_f32_16x16x32_bf16 v[64:67], v[84:87], v[112:115], v[64:67]
    v_mfma_f32_16x16x32_bf16 v[64:67], v[88:91], v[108:111], v[64:67]
    v_mfma_f32_16x16x32_bf16 v[64:67], v[92:95], v[104:107], v[64:67]
    v_mfma_f32_16x16x32_bf16 v[64:67], v[96:99], v[100:103], v[64:67]
    v_mfma_f32_16x16x32_bf16 v[36:39], v[132:135], v[164:167], v[36:39]
    ds_read2_b32 v[68:69], v21 offset0:32 offset1:33
    s_waitcnt lgkmcnt(14)
    v_mfma_f32_16x16x32_bf16 v[40:43], v[136:139], v[164:167], v[40:43]
    ds_read2_b32 v[70:71], v21 offset0:34 offset1:35
    v_mfma_f32_16x16x32_bf16 v[40:43], v[132:135], v[168:171], v[40:43]
    ds_read_b128 v[100:103], v27 offset:0
    v_mfma_f32_16x16x32_bf16 v[44:47], v[132:135], v[172:175], v[44:47]
    v_mfma_f32_16x16x32_bf16 v[44:47], v[136:139], v[168:171], v[44:47]
    ds_read2_b32 v[72:73], v21 offset0:160 offset1:161
    v_mfma_f32_16x16x32_bf16 v[44:47], v[140:143], v[164:167], v[44:47]
    ds_read2_b32 v[74:75], v21 offset0:162 offset1:163
    v_mfma_f32_16x16x32_bf16 v[48:51], v[144:147], v[164:167], v[48:51]
    ds_read_b128 v[104:107], v27 offset:2048
    v_mfma_f32_16x16x32_bf16 v[48:51], v[140:143], v[168:171], v[48:51]
    v_mfma_f32_16x16x32_bf16 v[48:51], v[136:139], v[172:175], v[48:51]
    ds_read2_b32 v[76:77], v22 offset0:32 offset1:33
    s_waitcnt lgkmcnt(14)
    v_mfma_f32_16x16x32_bf16 v[48:51], v[132:135], v[176:179], v[48:51]
    ds_read2_b32 v[78:79], v22 offset0:34 offset1:35
    v_mfma_f32_16x16x32_bf16 v[52:55], v[132:135], v[180:183], v[52:55]
    ds_read_b128 v[108:111], v27 offset:4096
    v_mfma_f32_16x16x32_bf16 v[52:55], v[136:139], v[176:179], v[52:55]
    v_mfma_f32_16x16x32_bf16 v[52:55], v[140:143], v[172:175], v[52:55]
    ds_read2_b32 v[80:81], v22 offset0:160 offset1:161
    v_mfma_f32_16x16x32_bf16 v[52:55], v[144:147], v[168:171], v[52:55]
    ds_read2_b32 v[82:83], v22 offset0:162 offset1:163
    v_mfma_f32_16x16x32_bf16 v[52:55], v[148:151], v[164:167], v[52:55]
    ds_read_b128 v[112:115], v27 offset:6144
    v_mfma_f32_16x16x32_bf16 v[56:59], v[152:155], v[164:167], v[56:59]
    v_mfma_f32_16x16x32_bf16 v[56:59], v[148:151], v[168:171], v[56:59]
    ds_read2_b32 v[84:85], v23 offset0:32 offset1:33
    v_mfma_f32_16x16x32_bf16 v[56:59], v[144:147], v[172:175], v[56:59]
    ds_read2_b32 v[86:87], v23 offset0:34 offset1:35
    v_mfma_f32_16x16x32_bf16 v[56:59], v[140:143], v[176:179], v[56:59]
    ds_read_b128 v[116:119], v27 offset:8192
    v_mfma_f32_16x16x32_bf16 v[56:59], v[136:139], v[180:183], v[56:59]
    s_waitcnt lgkmcnt(14)
    v_mfma_f32_16x16x32_bf16 v[56:59], v[132:135], v[184:187], v[56:59]
    ds_read2_b32 v[88:89], v23 offset0:160 offset1:161
    v_mfma_f32_16x16x32_bf16 v[60:63], v[132:135], v[188:191], v[60:63]
    ds_read2_b32 v[90:91], v23 offset0:162 offset1:163
    v_mfma_f32_16x16x32_bf16 v[60:63], v[136:139], v[184:187], v[60:63]
    ds_read_b128 v[120:123], v27 offset:10240
    v_mfma_f32_16x16x32_bf16 v[60:63], v[140:143], v[180:183], v[60:63]
    v_mfma_f32_16x16x32_bf16 v[60:63], v[144:147], v[176:179], v[60:63]
    ds_read2_b32 v[92:93], v24 offset0:32 offset1:33
    v_mfma_f32_16x16x32_bf16 v[60:63], v[148:151], v[172:175], v[60:63]
    ds_read2_b32 v[94:95], v24 offset0:34 offset1:35
    v_mfma_f32_16x16x32_bf16 v[60:63], v[152:155], v[168:171], v[60:63]
    ds_read_b128 v[124:127], v27 offset:12288
    v_mfma_f32_16x16x32_bf16 v[60:63], v[156:159], v[164:167], v[60:63]
    v_mfma_f32_16x16x32_bf16 v[64:67], v[160:163], v[164:167], v[64:67]
    ds_read2_b32 v[96:97], v24 offset0:160 offset1:161
    v_mfma_f32_16x16x32_bf16 v[64:67], v[156:159], v[168:171], v[64:67]
    ds_read2_b32 v[98:99], v24 offset0:162 offset1:163
    v_mfma_f32_16x16x32_bf16 v[64:67], v[152:155], v[172:175], v[64:67]
    ds_read_b128 v[128:131], v27 offset:14336
    v_mfma_f32_16x16x32_bf16 v[64:67], v[148:151], v[176:179], v[64:67]
    v_mfma_f32_16x16x32_bf16 v[64:67], v[144:147], v[180:183], v[64:67]
    v_mfma_f32_16x16x32_bf16 v[64:67], v[140:143], v[184:187], v[64:67]
    v_mfma_f32_16x16x32_bf16 v[64:67], v[136:139], v[188:191], v[64:67]
    v_mfma_f32_16x16x32_bf16 v[64:67], v[132:135], v[192:195], v[64:67]
    s_waitcnt lgkmcnt(14)
    v_mfma_f32_16x16x32_bf16 v[36:39], v[68:71], v[100:103], v[36:39]
    ds_read2_b32 v[132:133], v21 offset0:48 offset1:49
    v_mfma_f32_16x16x32_bf16 v[40:43], v[72:75], v[100:103], v[40:43]
    ds_read2_b32 v[134:135], v21 offset0:50 offset1:51
    v_mfma_f32_16x16x32_bf16 v[40:43], v[68:71], v[104:107], v[40:43]
    ds_read_b128 v[164:167], v28 offset:0
    v_mfma_f32_16x16x32_bf16 v[44:47], v[68:71], v[108:111], v[44:47]
    v_mfma_f32_16x16x32_bf16 v[44:47], v[72:75], v[104:107], v[44:47]
    ds_read2_b32 v[136:137], v21 offset0:176 offset1:177
    v_mfma_f32_16x16x32_bf16 v[44:47], v[76:79], v[100:103], v[44:47]
    ds_read2_b32 v[138:139], v21 offset0:178 offset1:179
    s_waitcnt lgkmcnt(14)
    v_mfma_f32_16x16x32_bf16 v[48:51], v[80:83], v[100:103], v[48:51]
    ds_read_b128 v[168:171], v28 offset:2048
    v_mfma_f32_16x16x32_bf16 v[48:51], v[76:79], v[104:107], v[48:51]
    v_mfma_f32_16x16x32_bf16 v[48:51], v[72:75], v[108:111], v[48:51]
    ds_read2_b32 v[140:141], v22 offset0:48 offset1:49
    v_mfma_f32_16x16x32_bf16 v[48:51], v[68:71], v[112:115], v[48:51]
    ds_read2_b32 v[142:143], v22 offset0:50 offset1:51
    v_mfma_f32_16x16x32_bf16 v[52:55], v[68:71], v[116:119], v[52:55]
    ds_read_b128 v[172:175], v28 offset:4096
    v_mfma_f32_16x16x32_bf16 v[52:55], v[72:75], v[112:115], v[52:55]
    v_mfma_f32_16x16x32_bf16 v[52:55], v[76:79], v[108:111], v[52:55]
    ds_read2_b32 v[144:145], v22 offset0:176 offset1:177
    v_mfma_f32_16x16x32_bf16 v[52:55], v[80:83], v[104:107], v[52:55]
    ds_read2_b32 v[146:147], v22 offset0:178 offset1:179
    v_mfma_f32_16x16x32_bf16 v[52:55], v[84:87], v[100:103], v[52:55]
    ds_read_b128 v[176:179], v28 offset:6144
    s_waitcnt lgkmcnt(14)
    v_mfma_f32_16x16x32_bf16 v[56:59], v[88:91], v[100:103], v[56:59]
    v_mfma_f32_16x16x32_bf16 v[56:59], v[84:87], v[104:107], v[56:59]
    ds_read2_b32 v[148:149], v23 offset0:48 offset1:49
    v_mfma_f32_16x16x32_bf16 v[56:59], v[80:83], v[108:111], v[56:59]
    ds_read2_b32 v[150:151], v23 offset0:50 offset1:51
    v_mfma_f32_16x16x32_bf16 v[56:59], v[76:79], v[112:115], v[56:59]
    ds_read_b128 v[180:183], v28 offset:8192
    v_mfma_f32_16x16x32_bf16 v[56:59], v[72:75], v[116:119], v[56:59]
    v_mfma_f32_16x16x32_bf16 v[56:59], v[68:71], v[120:123], v[56:59]
    ds_read2_b32 v[152:153], v23 offset0:176 offset1:177
    v_mfma_f32_16x16x32_bf16 v[60:63], v[68:71], v[124:127], v[60:63]
    ds_read2_b32 v[154:155], v23 offset0:178 offset1:179
    v_mfma_f32_16x16x32_bf16 v[60:63], v[72:75], v[120:123], v[60:63]
    ds_read_b128 v[184:187], v28 offset:10240
    v_mfma_f32_16x16x32_bf16 v[60:63], v[76:79], v[116:119], v[60:63]
    v_mfma_f32_16x16x32_bf16 v[60:63], v[80:83], v[112:115], v[60:63]
    ds_read2_b32 v[156:157], v24 offset0:48 offset1:49
    v_mfma_f32_16x16x32_bf16 v[60:63], v[84:87], v[108:111], v[60:63]
    ds_read2_b32 v[158:159], v24 offset0:50 offset1:51
    v_mfma_f32_16x16x32_bf16 v[60:63], v[88:91], v[104:107], v[60:63]
    ds_read_b128 v[188:191], v28 offset:12288
    v_mfma_f32_16x16x32_bf16 v[60:63], v[92:95], v[100:103], v[60:63]
    s_waitcnt lgkmcnt(14)
    v_mfma_f32_16x16x32_bf16 v[64:67], v[96:99], v[100:103], v[64:67]
    ds_read2_b32 v[160:161], v24 offset0:176 offset1:177
    v_mfma_f32_16x16x32_bf16 v[64:67], v[92:95], v[104:107], v[64:67]
    ds_read2_b32 v[162:163], v24 offset0:178 offset1:179
    v_mfma_f32_16x16x32_bf16 v[64:67], v[88:91], v[108:111], v[64:67]
    ds_read_b128 v[192:195], v28 offset:14336
    v_mfma_f32_16x16x32_bf16 v[64:67], v[84:87], v[112:115], v[64:67]
    v_mfma_f32_16x16x32_bf16 v[64:67], v[80:83], v[116:119], v[64:67]
    v_mfma_f32_16x16x32_bf16 v[64:67], v[76:79], v[120:123], v[64:67]
    v_mfma_f32_16x16x32_bf16 v[64:67], v[72:75], v[124:127], v[64:67]
    v_mfma_f32_16x16x32_bf16 v[64:67], v[68:71], v[128:131], v[64:67]
    v_mfma_f32_16x16x32_bf16 v[36:39], v[132:135], v[164:167], v[36:39]
    ds_read2_b32 v[68:69], v21 offset0:64 offset1:65
    v_mfma_f32_16x16x32_bf16 v[40:43], v[136:139], v[164:167], v[40:43]
    ds_read2_b32 v[70:71], v21 offset0:66 offset1:67
    v_mfma_f32_16x16x32_bf16 v[40:43], v[132:135], v[168:171], v[40:43]
    ds_read_b128 v[100:103], v29 offset:0
    s_waitcnt lgkmcnt(14)
    v_mfma_f32_16x16x32_bf16 v[44:47], v[132:135], v[172:175], v[44:47]
    v_mfma_f32_16x16x32_bf16 v[44:47], v[136:139], v[168:171], v[44:47]
    ds_read2_b32 v[72:73], v21 offset0:192 offset1:193
    v_mfma_f32_16x16x32_bf16 v[44:47], v[140:143], v[164:167], v[44:47]
    ds_read2_b32 v[74:75], v21 offset0:194 offset1:195
    v_mfma_f32_16x16x32_bf16 v[48:51], v[144:147], v[164:167], v[48:51]
    ds_read_b128 v[104:107], v29 offset:2048
    v_mfma_f32_16x16x32_bf16 v[48:51], v[140:143], v[168:171], v[48:51]
    v_mfma_f32_16x16x32_bf16 v[48:51], v[136:139], v[172:175], v[48:51]
    ds_read2_b32 v[76:77], v22 offset0:64 offset1:65
    v_mfma_f32_16x16x32_bf16 v[48:51], v[132:135], v[176:179], v[48:51]
    ds_read2_b32 v[78:79], v22 offset0:66 offset1:67
    s_waitcnt lgkmcnt(14)
    v_mfma_f32_16x16x32_bf16 v[52:55], v[132:135], v[180:183], v[52:55]
    ds_read_b128 v[108:111], v29 offset:4096
    v_mfma_f32_16x16x32_bf16 v[52:55], v[136:139], v[176:179], v[52:55]
    v_mfma_f32_16x16x32_bf16 v[52:55], v[140:143], v[172:175], v[52:55]
    ds_read2_b32 v[80:81], v22 offset0:192 offset1:193
    v_mfma_f32_16x16x32_bf16 v[52:55], v[144:147], v[168:171], v[52:55]
    ds_read2_b32 v[82:83], v22 offset0:194 offset1:195
    v_mfma_f32_16x16x32_bf16 v[52:55], v[148:151], v[164:167], v[52:55]
    ds_read_b128 v[112:115], v29 offset:6144
    v_mfma_f32_16x16x32_bf16 v[56:59], v[152:155], v[164:167], v[56:59]
    v_mfma_f32_16x16x32_bf16 v[56:59], v[148:151], v[168:171], v[56:59]
    ds_read2_b32 v[84:85], v23 offset0:64 offset1:65
    v_mfma_f32_16x16x32_bf16 v[56:59], v[144:147], v[172:175], v[56:59]
    ds_read2_b32 v[86:87], v23 offset0:66 offset1:67
    v_mfma_f32_16x16x32_bf16 v[56:59], v[140:143], v[176:179], v[56:59]
    ds_read_b128 v[116:119], v29 offset:8192
    v_mfma_f32_16x16x32_bf16 v[56:59], v[136:139], v[180:183], v[56:59]
    v_mfma_f32_16x16x32_bf16 v[56:59], v[132:135], v[184:187], v[56:59]
    ds_read2_b32 v[88:89], v23 offset0:192 offset1:193
    s_waitcnt lgkmcnt(14)
    v_mfma_f32_16x16x32_bf16 v[60:63], v[132:135], v[188:191], v[60:63]
    ds_read2_b32 v[90:91], v23 offset0:194 offset1:195
    v_mfma_f32_16x16x32_bf16 v[60:63], v[136:139], v[184:187], v[60:63]
    ds_read_b128 v[120:123], v29 offset:10240
    v_mfma_f32_16x16x32_bf16 v[60:63], v[140:143], v[180:183], v[60:63]
    v_mfma_f32_16x16x32_bf16 v[60:63], v[144:147], v[176:179], v[60:63]
    ds_read2_b32 v[92:93], v24 offset0:64 offset1:65
    v_mfma_f32_16x16x32_bf16 v[60:63], v[148:151], v[172:175], v[60:63]
    ds_read2_b32 v[94:95], v24 offset0:66 offset1:67
    v_mfma_f32_16x16x32_bf16 v[60:63], v[152:155], v[168:171], v[60:63]
    ds_read_b128 v[124:127], v29 offset:12288
    v_mfma_f32_16x16x32_bf16 v[60:63], v[156:159], v[164:167], v[60:63]
    v_mfma_f32_16x16x32_bf16 v[64:67], v[160:163], v[164:167], v[64:67]
    ds_read2_b32 v[96:97], v24 offset0:192 offset1:193
    v_mfma_f32_16x16x32_bf16 v[64:67], v[156:159], v[168:171], v[64:67]
    ds_read2_b32 v[98:99], v24 offset0:194 offset1:195
    v_mfma_f32_16x16x32_bf16 v[64:67], v[152:155], v[172:175], v[64:67]
    ds_read_b128 v[128:131], v29 offset:14336
    v_mfma_f32_16x16x32_bf16 v[64:67], v[148:151], v[176:179], v[64:67]
    v_mfma_f32_16x16x32_bf16 v[64:67], v[144:147], v[180:183], v[64:67]
    v_mfma_f32_16x16x32_bf16 v[64:67], v[140:143], v[184:187], v[64:67]
    v_mfma_f32_16x16x32_bf16 v[64:67], v[136:139], v[188:191], v[64:67]
    v_mfma_f32_16x16x32_bf16 v[64:67], v[132:135], v[192:195], v[64:67]
    s_waitcnt lgkmcnt(14)
    v_mfma_f32_16x16x32_bf16 v[36:39], v[68:71], v[100:103], v[36:39]
    ds_read2_b32 v[132:133], v21 offset0:80 offset1:81
    v_mfma_f32_16x16x32_bf16 v[40:43], v[72:75], v[100:103], v[40:43]
    ds_read2_b32 v[134:135], v21 offset0:82 offset1:83
    v_mfma_f32_16x16x32_bf16 v[40:43], v[68:71], v[104:107], v[40:43]
    ds_read_b128 v[164:167], v30 offset:0
    v_mfma_f32_16x16x32_bf16 v[44:47], v[68:71], v[108:111], v[44:47]
    v_mfma_f32_16x16x32_bf16 v[44:47], v[72:75], v[104:107], v[44:47]
    ds_read2_b32 v[136:137], v21 offset0:208 offset1:209
    v_mfma_f32_16x16x32_bf16 v[44:47], v[76:79], v[100:103], v[44:47]
    ds_read2_b32 v[138:139], v21 offset0:210 offset1:211
    s_waitcnt lgkmcnt(14)
    v_mfma_f32_16x16x32_bf16 v[48:51], v[80:83], v[100:103], v[48:51]
    ds_read_b128 v[168:171], v30 offset:2048
    v_mfma_f32_16x16x32_bf16 v[48:51], v[76:79], v[104:107], v[48:51]
    v_mfma_f32_16x16x32_bf16 v[48:51], v[72:75], v[108:111], v[48:51]
    ds_read2_b32 v[140:141], v22 offset0:80 offset1:81
    v_mfma_f32_16x16x32_bf16 v[48:51], v[68:71], v[112:115], v[48:51]
    ds_read2_b32 v[142:143], v22 offset0:82 offset1:83
    v_mfma_f32_16x16x32_bf16 v[52:55], v[68:71], v[116:119], v[52:55]
    ds_read_b128 v[172:175], v30 offset:4096
    v_mfma_f32_16x16x32_bf16 v[52:55], v[72:75], v[112:115], v[52:55]
    v_mfma_f32_16x16x32_bf16 v[52:55], v[76:79], v[108:111], v[52:55]
    ds_read2_b32 v[144:145], v22 offset0:208 offset1:209
    v_mfma_f32_16x16x32_bf16 v[52:55], v[80:83], v[104:107], v[52:55]
    ds_read2_b32 v[146:147], v22 offset0:210 offset1:211
    v_mfma_f32_16x16x32_bf16 v[52:55], v[84:87], v[100:103], v[52:55]
    ds_read_b128 v[176:179], v30 offset:6144
    s_waitcnt lgkmcnt(14)
    v_mfma_f32_16x16x32_bf16 v[56:59], v[88:91], v[100:103], v[56:59]
    v_mfma_f32_16x16x32_bf16 v[56:59], v[84:87], v[104:107], v[56:59]
    ds_read2_b32 v[148:149], v23 offset0:80 offset1:81
    v_mfma_f32_16x16x32_bf16 v[56:59], v[80:83], v[108:111], v[56:59]
    ds_read2_b32 v[150:151], v23 offset0:82 offset1:83
    v_mfma_f32_16x16x32_bf16 v[56:59], v[76:79], v[112:115], v[56:59]
    ds_read_b128 v[180:183], v30 offset:8192
    v_mfma_f32_16x16x32_bf16 v[56:59], v[72:75], v[116:119], v[56:59]
    v_mfma_f32_16x16x32_bf16 v[56:59], v[68:71], v[120:123], v[56:59]
    ds_read2_b32 v[152:153], v23 offset0:208 offset1:209
    v_mfma_f32_16x16x32_bf16 v[60:63], v[68:71], v[124:127], v[60:63]
    ds_read2_b32 v[154:155], v23 offset0:210 offset1:211
    v_mfma_f32_16x16x32_bf16 v[60:63], v[72:75], v[120:123], v[60:63]
    ds_read_b128 v[184:187], v30 offset:10240
    v_mfma_f32_16x16x32_bf16 v[60:63], v[76:79], v[116:119], v[60:63]
    v_mfma_f32_16x16x32_bf16 v[60:63], v[80:83], v[112:115], v[60:63]
    ds_read2_b32 v[156:157], v24 offset0:80 offset1:81
    v_mfma_f32_16x16x32_bf16 v[60:63], v[84:87], v[108:111], v[60:63]
    ds_read2_b32 v[158:159], v24 offset0:82 offset1:83
    v_mfma_f32_16x16x32_bf16 v[60:63], v[88:91], v[104:107], v[60:63]
    ds_read_b128 v[188:191], v30 offset:12288
    v_mfma_f32_16x16x32_bf16 v[60:63], v[92:95], v[100:103], v[60:63]
    s_waitcnt lgkmcnt(14)
    v_mfma_f32_16x16x32_bf16 v[64:67], v[96:99], v[100:103], v[64:67]
    ds_read2_b32 v[160:161], v24 offset0:208 offset1:209
    v_mfma_f32_16x16x32_bf16 v[64:67], v[92:95], v[104:107], v[64:67]
    ds_read2_b32 v[162:163], v24 offset0:210 offset1:211
    v_mfma_f32_16x16x32_bf16 v[64:67], v[88:91], v[108:111], v[64:67]
    ds_read_b128 v[192:195], v30 offset:14336
    v_mfma_f32_16x16x32_bf16 v[64:67], v[84:87], v[112:115], v[64:67]
    v_mfma_f32_16x16x32_bf16 v[64:67], v[80:83], v[116:119], v[64:67]
    v_mfma_f32_16x16x32_bf16 v[64:67], v[76:79], v[120:123], v[64:67]
    v_mfma_f32_16x16x32_bf16 v[64:67], v[72:75], v[124:127], v[64:67]
    v_mfma_f32_16x16x32_bf16 v[64:67], v[68:71], v[128:131], v[64:67]
    v_mfma_f32_16x16x32_bf16 v[36:39], v[132:135], v[164:167], v[36:39]
    ds_read2_b32 v[68:69], v21 offset0:96 offset1:97
    v_mfma_f32_16x16x32_bf16 v[40:43], v[136:139], v[164:167], v[40:43]
    ds_read2_b32 v[70:71], v21 offset0:98 offset1:99
    v_mfma_f32_16x16x32_bf16 v[40:43], v[132:135], v[168:171], v[40:43]
    ds_read_b128 v[100:103], v31 offset:0
    s_waitcnt lgkmcnt(14)
    v_mfma_f32_16x16x32_bf16 v[44:47], v[132:135], v[172:175], v[44:47]
    v_mfma_f32_16x16x32_bf16 v[44:47], v[136:139], v[168:171], v[44:47]
    ds_read2_b32 v[72:73], v21 offset0:224 offset1:225
    v_mfma_f32_16x16x32_bf16 v[44:47], v[140:143], v[164:167], v[44:47]
    ds_read2_b32 v[74:75], v21 offset0:226 offset1:227
    v_mfma_f32_16x16x32_bf16 v[48:51], v[144:147], v[164:167], v[48:51]
    ds_read_b128 v[104:107], v31 offset:2048
    v_mfma_f32_16x16x32_bf16 v[48:51], v[140:143], v[168:171], v[48:51]
    v_mfma_f32_16x16x32_bf16 v[48:51], v[136:139], v[172:175], v[48:51]
    ds_read2_b32 v[76:77], v22 offset0:96 offset1:97
    v_mfma_f32_16x16x32_bf16 v[48:51], v[132:135], v[176:179], v[48:51]
    ds_read2_b32 v[78:79], v22 offset0:98 offset1:99
    s_waitcnt lgkmcnt(14)
    v_mfma_f32_16x16x32_bf16 v[52:55], v[132:135], v[180:183], v[52:55]
    ds_read_b128 v[108:111], v31 offset:4096
    v_mfma_f32_16x16x32_bf16 v[52:55], v[136:139], v[176:179], v[52:55]
    v_mfma_f32_16x16x32_bf16 v[52:55], v[140:143], v[172:175], v[52:55]
    ds_read2_b32 v[80:81], v22 offset0:224 offset1:225
    v_mfma_f32_16x16x32_bf16 v[52:55], v[144:147], v[168:171], v[52:55]
    ds_read2_b32 v[82:83], v22 offset0:226 offset1:227
    v_mfma_f32_16x16x32_bf16 v[52:55], v[148:151], v[164:167], v[52:55]
    ds_read_b128 v[112:115], v31 offset:6144
    v_mfma_f32_16x16x32_bf16 v[56:59], v[152:155], v[164:167], v[56:59]
    v_mfma_f32_16x16x32_bf16 v[56:59], v[148:151], v[168:171], v[56:59]
    ds_read2_b32 v[84:85], v23 offset0:96 offset1:97
    v_mfma_f32_16x16x32_bf16 v[56:59], v[144:147], v[172:175], v[56:59]
    ds_read2_b32 v[86:87], v23 offset0:98 offset1:99
    v_mfma_f32_16x16x32_bf16 v[56:59], v[140:143], v[176:179], v[56:59]
    ds_read_b128 v[116:119], v31 offset:8192
    v_mfma_f32_16x16x32_bf16 v[56:59], v[136:139], v[180:183], v[56:59]
    v_mfma_f32_16x16x32_bf16 v[56:59], v[132:135], v[184:187], v[56:59]
    ds_read2_b32 v[88:89], v23 offset0:224 offset1:225
    s_waitcnt lgkmcnt(14)
    v_mfma_f32_16x16x32_bf16 v[60:63], v[132:135], v[188:191], v[60:63]
    ds_read2_b32 v[90:91], v23 offset0:226 offset1:227
    v_mfma_f32_16x16x32_bf16 v[60:63], v[136:139], v[184:187], v[60:63]
    ds_read_b128 v[120:123], v31 offset:10240
    v_mfma_f32_16x16x32_bf16 v[60:63], v[140:143], v[180:183], v[60:63]
    v_mfma_f32_16x16x32_bf16 v[60:63], v[144:147], v[176:179], v[60:63]
    ds_read2_b32 v[92:93], v24 offset0:96 offset1:97
    v_mfma_f32_16x16x32_bf16 v[60:63], v[148:151], v[172:175], v[60:63]
    ds_read2_b32 v[94:95], v24 offset0:98 offset1:99
    v_mfma_f32_16x16x32_bf16 v[60:63], v[152:155], v[168:171], v[60:63]
    ds_read_b128 v[124:127], v31 offset:12288
    v_mfma_f32_16x16x32_bf16 v[60:63], v[156:159], v[164:167], v[60:63]
    v_mfma_f32_16x16x32_bf16 v[64:67], v[160:163], v[164:167], v[64:67]
    ds_read2_b32 v[96:97], v24 offset0:224 offset1:225
    v_mfma_f32_16x16x32_bf16 v[64:67], v[156:159], v[168:171], v[64:67]
    ds_read2_b32 v[98:99], v24 offset0:226 offset1:227
    v_mfma_f32_16x16x32_bf16 v[64:67], v[152:155], v[172:175], v[64:67]
    ds_read_b128 v[128:131], v31 offset:14336
    v_mfma_f32_16x16x32_bf16 v[64:67], v[148:151], v[176:179], v[64:67]
    v_mfma_f32_16x16x32_bf16 v[64:67], v[144:147], v[180:183], v[64:67]
    v_mfma_f32_16x16x32_bf16 v[64:67], v[140:143], v[184:187], v[64:67]
    v_mfma_f32_16x16x32_bf16 v[64:67], v[136:139], v[188:191], v[64:67]
    v_mfma_f32_16x16x32_bf16 v[64:67], v[132:135], v[192:195], v[64:67]
    s_waitcnt lgkmcnt(14)
    v_mfma_f32_16x16x32_bf16 v[36:39], v[68:71], v[100:103], v[36:39]
    ds_read2_b32 v[132:133], v21 offset0:112 offset1:113
    v_mfma_f32_16x16x32_bf16 v[40:43], v[72:75], v[100:103], v[40:43]
    ds_read2_b32 v[134:135], v21 offset0:114 offset1:115
    v_mfma_f32_16x16x32_bf16 v[40:43], v[68:71], v[104:107], v[40:43]
    ds_read_b128 v[164:167], v32 offset:0
    v_mfma_f32_16x16x32_bf16 v[44:47], v[68:71], v[108:111], v[44:47]
    v_mfma_f32_16x16x32_bf16 v[44:47], v[72:75], v[104:107], v[44:47]
    ds_read2_b32 v[136:137], v21 offset0:240 offset1:241
    v_mfma_f32_16x16x32_bf16 v[44:47], v[76:79], v[100:103], v[44:47]
    ds_read2_b32 v[138:139], v21 offset0:242 offset1:243
    s_waitcnt lgkmcnt(14)
    v_mfma_f32_16x16x32_bf16 v[48:51], v[80:83], v[100:103], v[48:51]
    ds_read_b128 v[168:171], v32 offset:2048
    v_mfma_f32_16x16x32_bf16 v[48:51], v[76:79], v[104:107], v[48:51]
    v_mfma_f32_16x16x32_bf16 v[48:51], v[72:75], v[108:111], v[48:51]
    ds_read2_b32 v[140:141], v22 offset0:112 offset1:113
    v_mfma_f32_16x16x32_bf16 v[48:51], v[68:71], v[112:115], v[48:51]
    ds_read2_b32 v[142:143], v22 offset0:114 offset1:115
    v_mfma_f32_16x16x32_bf16 v[52:55], v[68:71], v[116:119], v[52:55]
    ds_read_b128 v[172:175], v32 offset:4096
    v_mfma_f32_16x16x32_bf16 v[52:55], v[72:75], v[112:115], v[52:55]
    v_mfma_f32_16x16x32_bf16 v[52:55], v[76:79], v[108:111], v[52:55]
    ds_read2_b32 v[144:145], v22 offset0:240 offset1:241
    v_mfma_f32_16x16x32_bf16 v[52:55], v[80:83], v[104:107], v[52:55]
    ds_read2_b32 v[146:147], v22 offset0:242 offset1:243
    v_mfma_f32_16x16x32_bf16 v[52:55], v[84:87], v[100:103], v[52:55]
    ds_read_b128 v[176:179], v32 offset:6144
    s_waitcnt lgkmcnt(14)
    v_mfma_f32_16x16x32_bf16 v[56:59], v[88:91], v[100:103], v[56:59]
    v_mfma_f32_16x16x32_bf16 v[56:59], v[84:87], v[104:107], v[56:59]
    ds_read2_b32 v[148:149], v23 offset0:112 offset1:113
    v_mfma_f32_16x16x32_bf16 v[56:59], v[80:83], v[108:111], v[56:59]
    ds_read2_b32 v[150:151], v23 offset0:114 offset1:115
    v_mfma_f32_16x16x32_bf16 v[56:59], v[76:79], v[112:115], v[56:59]
    ds_read_b128 v[180:183], v32 offset:8192
    v_mfma_f32_16x16x32_bf16 v[56:59], v[72:75], v[116:119], v[56:59]
    v_mfma_f32_16x16x32_bf16 v[56:59], v[68:71], v[120:123], v[56:59]
    ds_read2_b32 v[152:153], v23 offset0:240 offset1:241
    v_mfma_f32_16x16x32_bf16 v[60:63], v[68:71], v[124:127], v[60:63]
    ds_read2_b32 v[154:155], v23 offset0:242 offset1:243
    v_mfma_f32_16x16x32_bf16 v[60:63], v[72:75], v[120:123], v[60:63]
    ds_read_b128 v[184:187], v32 offset:10240
    v_mfma_f32_16x16x32_bf16 v[60:63], v[76:79], v[116:119], v[60:63]
    v_mfma_f32_16x16x32_bf16 v[60:63], v[80:83], v[112:115], v[60:63]
    ds_read2_b32 v[156:157], v24 offset0:112 offset1:113
    v_mfma_f32_16x16x32_bf16 v[60:63], v[84:87], v[108:111], v[60:63]
    ds_read2_b32 v[158:159], v24 offset0:114 offset1:115
    v_mfma_f32_16x16x32_bf16 v[60:63], v[88:91], v[104:107], v[60:63]
    ds_read_b128 v[188:191], v32 offset:12288
    v_mfma_f32_16x16x32_bf16 v[60:63], v[92:95], v[100:103], v[60:63]
    s_waitcnt lgkmcnt(14)
    v_mfma_f32_16x16x32_bf16 v[64:67], v[96:99], v[100:103], v[64:67]
    ds_read2_b32 v[160:161], v24 offset0:240 offset1:241
    v_mfma_f32_16x16x32_bf16 v[64:67], v[92:95], v[104:107], v[64:67]
    ds_read2_b32 v[162:163], v24 offset0:242 offset1:243
    v_mfma_f32_16x16x32_bf16 v[64:67], v[88:91], v[108:111], v[64:67]
    ds_read_b128 v[192:195], v32 offset:14336
    v_mfma_f32_16x16x32_bf16 v[64:67], v[84:87], v[112:115], v[64:67]
    v_mfma_f32_16x16x32_bf16 v[64:67], v[80:83], v[116:119], v[64:67]
    v_mfma_f32_16x16x32_bf16 v[64:67], v[76:79], v[120:123], v[64:67]
    v_mfma_f32_16x16x32_bf16 v[64:67], v[72:75], v[124:127], v[64:67]
    v_mfma_f32_16x16x32_bf16 v[64:67], v[68:71], v[128:131], v[64:67]
    v_mfma_f32_16x16x32_bf16 v[36:39], v[132:135], v[164:167], v[36:39]
    v_mfma_f32_16x16x32_bf16 v[40:43], v[136:139], v[164:167], v[40:43]
    v_mfma_f32_16x16x32_bf16 v[40:43], v[132:135], v[168:171], v[40:43]
    s_waitcnt lgkmcnt(14)
    v_mfma_f32_16x16x32_bf16 v[44:47], v[132:135], v[172:175], v[44:47]
    v_mfma_f32_16x16x32_bf16 v[44:47], v[136:139], v[168:171], v[44:47]
    v_mfma_f32_16x16x32_bf16 v[44:47], v[140:143], v[164:167], v[44:47]
    s_waitcnt lgkmcnt(13)
    v_mfma_f32_16x16x32_bf16 v[48:51], v[144:147], v[164:167], v[48:51]
    v_mfma_f32_16x16x32_bf16 v[48:51], v[140:143], v[168:171], v[48:51]
    s_waitcnt lgkmcnt(0)
    v_cvt_pk_bf16_f32 v68, v39, v38
    v_cvt_pk_bf16_f32 v69, v37, v36
    v_mfma_f32_16x16x32_bf16 v[48:51], v[136:139], v[172:175], v[48:51]
    ds_write_b64 v20, v[68:69] offset:0
    v_cvt_pk_bf16_f32 v70, v43, v42
    v_mfma_f32_16x16x32_bf16 v[48:51], v[132:135], v[176:179], v[48:51]
    v_cvt_pk_bf16_f32 v71, v41, v40
    ds_write_b64 v20, v[70:71] offset:2048
    v_mfma_f32_16x16x32_bf16 v[52:55], v[132:135], v[180:183], v[52:55]
    v_mfma_f32_16x16x32_bf16 v[52:55], v[136:139], v[176:179], v[52:55]
    v_cvt_pk_bf16_f32 v72, v47, v46
    v_cvt_pk_bf16_f32 v73, v45, v44
    v_mfma_f32_16x16x32_bf16 v[52:55], v[140:143], v[172:175], v[52:55]
    ds_write_b64 v20, v[72:73] offset:4096
    v_mfma_f32_16x16x32_bf16 v[52:55], v[144:147], v[168:171], v[52:55]
    v_mfma_f32_16x16x32_bf16 v[52:55], v[148:151], v[164:167], v[52:55]
    v_mfma_f32_16x16x32_bf16 v[56:59], v[152:155], v[164:167], v[56:59]
    v_cvt_pk_bf16_f32 v74, v51, v50
    v_cvt_pk_bf16_f32 v75, v49, v48
    v_mfma_f32_16x16x32_bf16 v[56:59], v[148:151], v[168:171], v[56:59]
    ds_write_b64 v20, v[74:75] offset:6144
    v_mfma_f32_16x16x32_bf16 v[56:59], v[144:147], v[172:175], v[56:59]
    v_mfma_f32_16x16x32_bf16 v[56:59], v[140:143], v[176:179], v[56:59]
    v_mfma_f32_16x16x32_bf16 v[56:59], v[136:139], v[180:183], v[56:59]
    v_mfma_f32_16x16x32_bf16 v[56:59], v[132:135], v[184:187], v[56:59]
    v_cvt_pk_bf16_f32 v76, v55, v54
    v_cvt_pk_bf16_f32 v77, v53, v52
    v_mfma_f32_16x16x32_bf16 v[60:63], v[132:135], v[188:191], v[60:63]
    ds_write_b64 v20, v[76:77] offset:8192
    v_mfma_f32_16x16x32_bf16 v[60:63], v[136:139], v[184:187], v[60:63]
    v_mfma_f32_16x16x32_bf16 v[60:63], v[140:143], v[180:183], v[60:63]
    v_mfma_f32_16x16x32_bf16 v[60:63], v[144:147], v[176:179], v[60:63]
    v_mfma_f32_16x16x32_bf16 v[60:63], v[148:151], v[172:175], v[60:63]
    v_mfma_f32_16x16x32_bf16 v[60:63], v[152:155], v[168:171], v[60:63]
    v_cvt_pk_bf16_f32 v78, v59, v58
    v_cvt_pk_bf16_f32 v79, v57, v56
    v_mfma_f32_16x16x32_bf16 v[60:63], v[156:159], v[164:167], v[60:63]
    ds_write_b64 v20, v[78:79] offset:10240
    v_mfma_f32_16x16x32_bf16 v[64:67], v[160:163], v[164:167], v[64:67]
    v_mfma_f32_16x16x32_bf16 v[64:67], v[156:159], v[168:171], v[64:67]
    v_mfma_f32_16x16x32_bf16 v[64:67], v[152:155], v[172:175], v[64:67]
    v_mfma_f32_16x16x32_bf16 v[64:67], v[148:151], v[176:179], v[64:67]
    v_mfma_f32_16x16x32_bf16 v[64:67], v[144:147], v[180:183], v[64:67]
    v_mfma_f32_16x16x32_bf16 v[64:67], v[140:143], v[184:187], v[64:67]
    s_nop 0
    v_cvt_pk_bf16_f32 v80, v63, v62
    v_cvt_pk_bf16_f32 v81, v61, v60
    v_mfma_f32_16x16x32_bf16 v[64:67], v[136:139], v[188:191], v[64:67]
    ds_write_b64 v20, v[80:81] offset:12288
    v_mfma_f32_16x16x32_bf16 v[64:67], v[132:135], v[192:195], v[64:67]
    s_nop 7
    v_cvt_pk_bf16_f32 v82, v67, v66
    v_cvt_pk_bf16_f32 v83, v65, v64
    ds_write_b64 v20, v[82:83] offset:14336
    s_mov_b64 exec, 1
    ds_add_u32 v18, v19 offset:12
    s_mov_b64 exec, -1
    s_add_u32 s80, s86, 94208
    v_add_u32 v5, s80, v15
    s_branch LA_s3_in
LA_s3:
    s_sleep 1
LA_s3_in:
    ds_read_b32 v6, v18 offset:12
    ds_read_b128 v[84:87], v5 offset:0
    ds_read_b128 v[88:91], v5 offset:4096
    ds_read_b128 v[92:95], v5 offset:8192
    ds_read_b128 v[96:99], v5 offset:12288
    s_waitcnt lgkmcnt(0)
    v_readfirstlane_b32 s78, v6
    s_nop 0
    s_cmp_ge_u32 s78, 4
    s_cbranch_scc0 LA_s3
    s_add_u32 s89, s91, 4194304
    buffer_store_dwordx4 v[84:87], v14, s[52:55], s89 offen sc1
    s_add_u32 s89, s91, 4198400
    buffer_store_dwordx4 v[88:91], v14, s[52:55], s89 offen sc1
    s_add_u32 s89, s91, 4202496
    buffer_store_dwordx4 v[92:95], v14, s[52:55], s89 offen sc1
    s_add_u32 s89, s91, 4206592
    buffer_store_dwordx4 v[96:99], v14, s[52:55], s89 offen sc1
    s_add_u32 s80, s86, 129024
    v_add_u32 v5, s80, v15
    s_waitcnt vmcnt(13)
    ds_write_b128 v5, v[228:231] offset:0
    s_waitcnt vmcnt(12)
    ds_write_b128 v5, v[232:235] offset:4096
    s_waitcnt vmcnt(11)
    ds_write_b128 v5, v[240:243] offset:8192
    s_waitcnt vmcnt(10)
    ds_write_b128 v5, v[244:247] offset:12288
    s_waitcnt vmcnt(9)
    ds_write_b128 v5, v[248:251] offset:16384
    s_waitcnt vmcnt(8)
    ds_write_b128 v5, v[196:199] offset:20480
    s_mov_b64 exec, 1
    ds_add_u32 v18, v19 offset:32
    s_mov_b64 exec, -1
    s_setprio 0
    s_mov_b32 s60, s22
    s_mov_b32 s61, s23
    s_mov_b32 s62, 0x800000
    s_mov_b32 s63, 0x20000
    s_lshr_b32 s81, s91, 4
    s_lshl_b32 s82, s3, 8
    s_add_u32 s81, s81, s82
    s_add_u32 s81, s81, 12648448
    s_lshl_b32 s80, s74, 14
    s_and_b32 s82, s75, 3
    s_lshl_b32 s82, s82, 8
    s_add_u32 s80, s80, s82
    s_add_u32 s80, s80, 12648448
    v_mov_b32 v5, 0
    v_lshlrev_b32 v7, 10, v0
    s_waitcnt vmcnt(7)
    v_lshlrev_b32 v132, 16, v212
    v_and_b32 v133, 0xffff0000, v212
    v_lshlrev_b32 v134, 16, v213
    v_and_b32 v135, 0xffff0000, v213
    v_lshlrev_b32 v136, 16, v214
    v_and_b32 v137, 0xffff0000, v214
    v_lshlrev_b32 v138, 16, v215
    v_and_b32 v139, 0xffff0000, v215
    s_waitcnt vmcnt(6)
    v_lshlrev_b32 v140, 16, v216
    v_and_b32 v141, 0xffff0000, v216
    v_lshlrev_b32 v142, 16, v217
    v_and_b32 v143, 0xffff0000, v217
    v_lshlrev_b32 v144, 16, v218
    v_and_b32 v145, 0xffff0000, v218
    v_lshlrev_b32 v146, 16, v219
    v_and_b32 v147, 0xffff0000, v219
    s_waitcnt vmcnt(5)
    v_lshlrev_b32 v148, 16, v220
    v_and_b32 v149, 0xffff0000, v220
    v_lshlrev_b32 v150, 16, v221
    v_and_b32 v151, 0xffff0000, v221
    v_lshlrev_b32 v152, 16, v222
    v_and_b32 v153, 0xffff0000, v222
    v_lshlrev_b32 v154, 16, v223
    v_and_b32 v155, 0xffff0000, v223
    s_waitcnt vmcnt(4)
    v_lshlrev_b32 v156, 16, v224
    v_and_b32 v157, 0xffff0000, v224
    v_lshlrev_b32 v158, 16, v225
    v_and_b32 v159, 0xffff0000, v225
    v_lshlrev_b32 v160, 16, v226
    v_and_b32 v161, 0xffff0000, v226
    v_lshlrev_b32 v162, 16, v227
    v_and_b32 v163, 0xffff0000, v227
    s_waitcnt vmcnt(0)
    s_mov_b64 exec, 1
    buffer_store_dword v19, v5, s[52:55], s81 offen sc1
    s_mov_b64 exec, 0xffff
    s_waitcnt vmcnt(0)
    s_branch LA_s7a_in
LA_s7a:
    s_sleep 1
LA_s7a_in:
    ds_read_b32 v6, v18 offset:28
    s_waitcnt lgkmcnt(0)
    v_readfirstlane_b32 s78, v6
    s_nop 0
    s_cmp_ge_u32 s78, 4
    s_cbranch_scc0 LA_s7a
    s_setprio 2
    s_mov_b32 s79, 0
LA_py:
    buffer_load_dword v6, v7, s[52:55], s80 offen sc1
    s_add_u32 s79, s79, 1
    s_cmp_gt_u32 s79, 200000
    s_cbranch_scc1 LA_py_x
    s_waitcnt vmcnt(0)
    v_cmp_ne_u32 vcc, 1, v6
    s_cbranch_vccz LA_py_x
    s_mov_b64 exec, vcc
    s_sleep 8
    s_branch LA_py
LA_py_x:
    s_waitcnt vmcnt(0)
    s_mov_b64 exec, -1
    s_mov_b32 s89, 4194304
    buffer_load_dwordx4 v[100:103], v12, s[52:55], s89 offen sc1
    s_mov_b32 s89, 4210688
    buffer_load_dwordx4 v[104:107], v12, s[52:55], s89 offen sc1
    s_mov_b32 s89, 4227072
    buffer_load_dwordx4 v[108:111], v12, s[52:55], s89 offen sc1
    s_mov_b32 s89, 4243456
    buffer_load_dwordx4 v[112:115], v12, s[52:55], s89 offen sc1
    s_waitcnt vmcnt(3)
    v_permlane32_swap_b32 v102, v100
    v_permlane32_swap_b32 v103, v101
    s_waitcnt vmcnt(2)
    v_permlane32_swap_b32 v106, v104
    v_permlane32_swap_b32 v107, v105
    s_waitcnt vmcnt(1)
    v_permlane32_swap_b32 v110, v108
    v_permlane32_swap_b32 v111, v109
    s_waitcnt vmcnt(0)
    v_permlane32_swap_b32 v114, v112
    v_permlane32_swap_b32 v115, v113
    v_and_b32 v68, 0xffff0000, v103
    v_and_b32 v69, 0xffff0000, v107
    v_and_b32 v70, 0xffff0000, v111
    v_and_b32 v71, 0xffff0000, v115
    v_and_b32 v72, 0xffff0000, v101
    v_and_b32 v73, 0xffff0000, v105
    v_and_b32 v74, 0xffff0000, v109
    v_and_b32 v75, 0xffff0000, v113
    v_mul_f32 v68, v68, v132
    v_mul_f32 v69, v69, v133
    v_mul_f32 v70, v70, v134
    v_mul_f32 v71, v71, v135
    v_mul_f32 v72, v72, v136
    v_mul_f32 v73, v73, v137
    v_mul_f32 v74, v74, v138
    v_mul_f32 v75, v75, v139
    v_cvt_pk_bf16_f32 v36, v68, v69
    v_cvt_pk_bf16_f32 v37, v70, v71
    v_cvt_pk_bf16_f32 v38, v72, v73
    v_cvt_pk_bf16_f32 v39, v74, v75
    s_mov_b32 s89, 0
    buffer_store_dwordx4 v[36:39], v13, s[60:63], s89 offen nt
    v_lshlrev_b32 v68, 16, v103
    v_lshlrev_b32 v69, 16, v107
    v_lshlrev_b32 v70, 16, v111
    v_lshlrev_b32 v71, 16, v115
    v_lshlrev_b32 v72, 16, v101
    v_lshlrev_b32 v73, 16, v105
    v_lshlrev_b32 v74, 16, v109
    v_lshlrev_b32 v75, 16, v113
    v_mul_f32 v68, v68, v140
    v_mul_f32 v69, v69, v141
    v_mul_f32 v70, v70, v142
    v_mul_f32 v71, v71, v143
    v_mul_f32 v72, v72, v144
    v_mul_f32 v73, v73, v145
    v_mul_f32 v74, v74, v146
    v_mul_f32 v75, v75, v147
    v_cvt_pk_bf16_f32 v40, v68, v69
    v_cvt_pk_bf16_f32 v41, v70, v71
    v_cvt_pk_bf16_f32 v42, v72, v73
    v_cvt_pk_bf16_f32 v43, v74, v75
    s_mov_b32 s89, 4096
    buffer_store_dwordx4 v[40:43], v13, s[60:63], s89 offen nt
    v_and_b32 v68, 0xffff0000, v102
    v_and_b32 v69, 0xffff0000, v106
    v_and_b32 v70, 0xffff0000, v110
    v_and_b32 v71, 0xffff0000, v114
    v_and_b32 v72, 0xffff0000, v100
    v_and_b32 v73, 0xffff0000, v104
    v_and_b32 v74, 0xffff0000, v108
    v_and_b32 v75, 0xffff0000, v112
    v_mul_f32 v68, v68, v148
    v_mul_f32 v69, v69, v149
    v_mul_f32 v70, v70, v150
    v_mul_f32 v71, v71, v151
    v_mul_f32 v72, v72, v152
    v_mul_f32 v73, v73, v153
    v_mul_f32 v74, v74, v154
    v_mul_f32 v75, v75, v155
    v_cvt_pk_bf16_f32 v44, v68, v69
    v_cvt_pk_bf16_f32 v45, v70, v71
    v_cvt_pk_bf16_f32 v46, v72, v73
    v_cvt_pk_bf16_f32 v47, v74, v75
    s_mov_b32 s89, 8192
    buffer_store_dwordx4 v[44:47], v13, s[60:63], s89 offen nt
    v_lshlrev_b32 v68, 16, v102
    v_lshlrev_b32 v69, 16, v106
    v_lshlrev_b32 v70, 16, v110
    v_lshlrev_b32 v71, 16, v114
    v_lshlrev_b32 v72, 16, v100
    v_lshlrev_b32 v73, 16, v104
    v_lshlrev_b32 v74, 16, v108
    v_lshlrev_b32 v75, 16, v112
    v_mul_f32 v68, v68, v156
    v_mul_f32 v69, v69, v157
    v_mul_f32 v70, v70, v158
    v_mul_f32 v71, v71, v159
    v_mul_f32 v72, v72, v160
    v_mul_f32 v73, v73, v161
    v_mul_f32 v74, v74, v162
    v_mul_f32 v75, v75, v163
    v_cvt_pk_bf16_f32 v48, v68, v69
    v_cvt_pk_bf16_f32 v49, v70, v71
    v_cvt_pk_bf16_f32 v50, v72, v73
    v_cvt_pk_bf16_f32 v51, v74, v75
    s_mov_b32 s89, 12288
    buffer_store_dwordx4 v[48:51], v13, s[60:63], s89 offen nt
    s_endpgm
L_B:
    s_setprio 3
    s_and_b32 s3, s3, 3
    s_lshr_b32 s78, s2, 3
    s_and_b32 s76, s78, 3
    s_and_b32 s79, s73, 12
    s_add_u32 s76, s76, s79
    s_lshr_b32 s74, s78, 4
    s_add_u32 s74, s74, s79
    s_and_b32 s79, s72, 8
    s_lshr_b32 s77, s78, 2
    s_add_u32 s77, s77, s79
    s_lshr_b32 s79, s79, 2
    s_add_u32 s74, s74, s79
    s_xor_b32 s74, s74, 4
    s_and_b32 s75, s78, 15
    s_lshr_b32 s86, s3, 1
    s_and_b32 s87, s3, 1
    v_mov_b32 v10, 162304
    v_mov_b32 v11, 1
    v_lshlrev_b32 v12, 4, v0
    v_lshl_add_u32 v13, v0, 2, v10
    v_mov_b32 v14, 0
    ds_write_b32 v13, v14
    s_lshl_b32 s78, s74, 4
    s_add_u32 s78, s78, s75
    s_lshl_b32 s96, s78, 8
    s_add_u32 s96, s96, 12582912
    s_lshl_b32 s78, s78, 2
    s_add_u32 s78, s78, s3
    s_lshl_b32 s78, s78, 8
    s_add_u32 s80, s78, 12648448
    s_lshl_b32 s81, s72, 1
    s_add_u32 s81, s81, s86
    s_lshl_b32 s97, s81, 4
    s_add_u32 s97, s97, s73
    s_lshl_b32 s97, s97, 8
    s_add_u32 s97, s97, 12910464
    v_mov_b32 v15, s80
    v_mov_b32 v223, s97
    v_cmp_gt_u32 vcc, 8, v0
    s_nop 1
    v_cndmask_b32 v15, v223, v15, vcc
    v_add_u32 v221, v15, v12
    s_lshl_b32 s78, s87, 2
    s_add_u32 s78, s78, 128
    s_add_u32 s97, s97, s78
    s_lshl_b32 s82, s73, 1
    s_add_u32 s82, s82, s87
    s_lshl_b32 s78, s81, 7
    s_add_u32 s78, s78, s82
    s_lshl_b32 s94, s78, 10
    s_add_u32 s94, s94, 8388608
    v_mov_b32 v212, 0
    v_mov_b32 v213, 0
    v_mov_b32 v214, 0
    v_mov_b32 v215, 0
    v_mov_b32 v220, 0
    s_waitcnt lgkmcnt(0)
    s_mov_b32 s52, s26
    s_mov_b32 s53, s27
    s_mov_b32 s54, 0x1000000
    s_mov_b32 s55, 0x20000
    s_mov_b32 s68, s24
    s_mov_b32 s69, s25
    s_mov_b32 s70, 0x100
    s_mov_b32 s71, 0x20000
    s_lshl_b32 s98, s74, 4
    s_or_b32 s78, s75, s3
    s_cmp_lg_u32 s78, 0
    s_cbranch_scc1 LB_notag
    s_mov_b64 exec, 0xffff
    v_lshlrev_b32 v15, 8, v0
    buffer_load_dword v251, v15, s[52:55], s96 offen sc1
LB_notag:
    s_lshl_b32 s78, s87, 3
    s_lshr_b32 exec_lo, 0xffff, s78
    s_mov_b32 exec_hi, 0
    buffer_store_dwordx4 v[212:215], v221, s[52:55], 0 offen sc1
    s_mov_b64 exec, -1
    v_and_b32 v13, 15, v0
    v_lshrrev_b32 v14, 4, v0
    v_lshrrev_b32 v15, 1, v13
    v_xor_b32 v15, v15, v14
    v_lshlrev_b32 v15, 4, v15
    v_lshl_add_u32 v15, v13, 7, v15
    v_add_u32 v2, 73728, v15
    v_xor_b32 v3, 64, v2
    s_lshl_b32 s78, s86, 13
    s_add_u32 s78, s78, 2048
    v_add_u32 v4, s78, v2
    v_add_u32 v5, s78, v3
    v_bfe_u32 v15, v0, 3, 2
    s_lshl_b32 s78, s87, 1
    s_add_u32 s78, s78, s86
    v_xor_b32 v15, s78, v15
    v_lshlrev_b32 v15, 5, v15
    v_and_b32 v223, 3, v0
    v_lshl_add_u32 v15, v223, 3, v15
    v_bfe_u32 v223, v0, 2, 2
    v_lshl_add_u32 v15, v223, 7, v15
    v_mul_u32_u24 v223, 3072, v14
    v_add_u32 v6, v223, v15
    v_xor_b32 v7, 32, v6
    s_mov_b32 s60, s22
    s_mov_b32 s61, s23
    s_mov_b32 s62, 0x800000
    s_mov_b32 s63, 0x20000
    v_and_b32 v15, 1, v13
    v_cmp_eq_u32 s[88:89], 1, v15
    v_lshl_add_u32 v15, v14, 2, v15
    v_cmp_le_u32 s[90:91], v15, v13
    v_add_u32 v15, 2, v15
    v_cmp_le_u32 s[92:93], v15, v13
    v_mov_b32 v212, 0x0c0c0c0c
    v_mov_b32 v15, 0xc0c0100
    v_mov_b32 v223, 0x1000c0c
    v_cndmask_b32 v15, v15, v223, s[88:89]
    v_cndmask_b32 v208, v15, v212, s[90:91]
    v_cndmask_b32 v210, v212, v15, s[90:91]
    v_mov_b32 v15, 0xc0c0302
    v_mov_b32 v223, 0x3020c0c
    v_cndmask_b32 v15, v15, v223, s[88:89]
    v_cndmask_b32 v209, v15, v212, s[92:93]
    v_cndmask_b32 v211, v212, v15, s[92:93]
    s_or_b32 s78, s72, s86
    s_cmp_eq_u32 s78, 0
    s_cselect_b32 s78, 0xf149f2ca, 0
    v_mov_b32 v212, s78
    v_mov_b32 v213, s78
    v_mov_b32 v214, s78
    v_mov_b32 v215, s78
    s_lshl_b32 s78, s87, 12
    s_add_u32 s78, s78, 24576
    s_lshl_b32 s79, s86, 9
    s_add_u32 s79, s79, s78
    v_lshlrev_b32 v15, 3, v0
    v_add_u32 v216, s79, v15
    s_lshl_b32 s80, s86, 11
    v_add_u32 v218, s80, v216
    v_xor_b32 v219, 512, v218
    s_add_u32 s78, s78, 2048
    s_cmp_eq_u32 s86, 0
    s_cselect_b32 s78, s78, 32768
    v_add_u32 v217, s78, v15
    v_bfe_u32 v14, v0, 3, 2
    v_lshlrev_b32 v14, 5, v14
    v_and_b32 v15, 3, v0
    v_lshl_add_u32 v14, v15, 3, v14
    v_lshrrev_b32 v15, 2, v0
    v_lshl_add_u32 v14, v15, 7, v14
    s_lshl_b32 s78, s86, 11
    v_add_u32 v244, s78, v14
    s_mov_b32 s64, s20
    s_mov_b32 s65, s21
    s_mov_b32 s66, 0x200000
    s_mov_b32 s67, 0x20000
    v_lshrrev_b32 v14, 4, v0
    v_lshlrev_b32 v14, 1, v14
    v_and_b32 v15, 7, v0
    v_xor_b32 v14, v14, v15
    v_lshlrev_b32 v14, 4, v14
    v_lshrrev_b32 v15, 3, v0
    v_lshl_add_u32 v14, v15, 11, v14
    s_lshl_b32 s78, s77, 7
    s_lshl_b32 s79, s3, 14
    s_add_u32 s78, s78, s79
    v_add_u32 v245, s78, v14
    v_and_b32 v14, 15, v0
    s_lshl_b32 s78, s76, 2
    s_add_u32 s78, s78, s3
    s_lshl_b32 s79, s78, 5
    v_add_u32 v14, s79, v14
    v_lshlrev_b32 v14, 12, v14
    v_bfe_u32 v15, v0, 4, 1
    v_lshl_add_u32 v14, v15, 5, v14
    v_lshrrev_b32 v15, 5, v0
    v_lshl_add_u32 v14, v15, 4, v14
    s_lshl_b32 s79, s77, 7
    s_add_u32 s79, s79, 2048
    v_add_u32 v246, s79, v14
    s_lshl_b32 s28, s78, 16
    s_add_u32 s28, s28, 8388608
    s_lshl_b32 s30, s76, 1
    s_add_u32 s30, s30, s86
    s_lshl_b32 s30, s30, 12
    s_add_u32 s30, s30, 12910592
    v_lshrrev_b32 v15, 1, v0
    v_lshlrev_b32 v15, 8, v15
    v_and_b32 v14, 1, v0
    v_lshl_add_u32 v247, v14, 2, v15
    s_and_b32 s78, s77, 7
    s_mov_b32 s79, 0x76543210
    s_cmp_eq_u32 s78, 1
    s_cselect_b32 s79, 0x76543201, s79
    s_cmp_eq_u32 s78, 2
    s_cselect_b32 s79, 0x76543120, s79
    s_cmp_eq_u32 s78, 3
    s_cselect_b32 s79, 0x76542310, s79
    s_cmp_eq_u32 s78, 4
    s_cselect_b32 s79, 0x76534210, s79
    s_cmp_eq_u32 s78, 5
    s_cselect_b32 s79, 0x76453210, s79
    s_cmp_eq_u32 s78, 6
    s_cselect_b32 s79, 0x75643210, s79
    s_cmp_eq_u32 s78, 7
    s_cselect_b32 s79, 0x67543210, s79
    s_and_b32 s78, s76, 3
    s_mul_i32 s78, s78, 0x22222222
    s_add_u32 s79, s79, s78
    s_bfe_u32 s78, s79, 0x30000
    s_lshl_b32 s44, s78, 18
    s_lshl_b32 s78, s78, 12
    s_add_u32 s36, s78, s28
    s_bfe_u32 s78, s79, 0x30004
    s_lshl_b32 s45, s78, 18
    s_lshl_b32 s78, s78, 12
    s_add_u32 s37, s78, s28
    s_bfe_u32 s78, s79, 0x30008
    s_lshl_b32 s46, s78, 18
    s_lshl_b32 s78, s78, 12
    s_add_u32 s38, s78, s28
    s_bfe_u32 s78, s79, 0x3000c
    s_lshl_b32 s47, s78, 18
    s_lshl_b32 s78, s78, 12
    s_add_u32 s39, s78, s28
    s_bfe_u32 s78, s79, 0x30010
    s_lshl_b32 s48, s78, 18
    s_lshl_b32 s78, s78, 12
    s_add_u32 s40, s78, s28
    s_bfe_u32 s78, s79, 0x30014
    s_lshl_b32 s49, s78, 18
    s_lshl_b32 s78, s78, 12
    s_add_u32 s41, s78, s28
    s_bfe_u32 s78, s79, 0x30018
    s_lshl_b32 s50, s78, 18
    s_lshl_b32 s78, s78, 12
    s_add_u32 s42, s78, s28
    s_bfe_u32 s78, s79, 0x3001c
    s_lshl_b32 s51, s78, 18
    s_lshl_b32 s78, s78, 12
    s_add_u32 s43, s78, s28
    s_lshl_b32 s34, s3, 10
    v_bfe_u32 v14, v0, 4, 1
    v_lshrrev_b32 v15, 5, v0
    v_lshl_add_u32 v14, v14, 1, v15
    v_and_b32 v15, 7, v0
    v_xor_b32 v14, v14, v15
    v_lshlrev_b32 v14, 4, v14
    v_and_b32 v223, 15, v0
    v_lshl_add_u32 v14, v223, 7, v14
    s_lshl_b32 s78, s3, 12
    v_add_u32 v248, s78, v14
    v_xor_b32 v249, 64, v248
    v_add_u32 v250, s78, v12
    v_lshrrev_b32 v14, 3, v0
    v_xor_b32 v15, v15, v14
    v_lshlrev_b32 v15, 4, v15
    v_lshl_add_u32 v14, v14, 12, v15
    s_lshl_b32 s78, s76, 2
    s_add_u32 s78, s78, s3
    s_lshl_b32 s78, s78, 17
    s_lshl_b32 s79, s77, 7
    s_add_u32 s78, s78, s79
    s_add_u32 s78, s78, 2048
    v_add_u32 v246, s78, v14
    s_waitcnt lgkmcnt(0)
    s_barrier
    ds_read_b64_tr_b16 v[200:201], v6 offset:1024
    ds_read_b64_tr_b16 v[202:203], v6 offset:1536
    ds_read_b64_tr_b16 v[204:205], v6 offset:13312
    ds_read_b64_tr_b16 v[206:207], v6 offset:13824
    ds_read_b128 v[152:155], v2 offset:0
    ds_read_b128 v[156:159], v3 offset:0
    ds_read_b128 v[144:147], v4 offset:6144
    ds_read_b128 v[148:151], v5 offset:6144
    ds_read_b128 v[136:139], v4 offset:4096
    ds_read_b128 v[140:143], v5 offset:4096
    ds_read_b128 v[128:131], v4 offset:2048
    ds_read_b128 v[132:135], v5 offset:2048
    ds_read_b128 v[120:123], v4 offset:0
    ds_read_b128 v[124:127], v5 offset:0
    ds_read_b64_tr_b16 v[224:225], v7 offset:1024
    ds_read_b64_tr_b16 v[226:227], v7 offset:1536
    ds_read_b64_tr_b16 v[228:229], v7 offset:13312
    ds_read_b64_tr_b16 v[230:231], v7 offset:13824
    s_waitcnt lgkmcnt(13)
    v_mfma_f32_16x16x32_bf16 v[112:115], v[200:203], v[152:155], 0
    ds_read_b64_tr_b16 v[232:233], v6 offset:0
    s_waitcnt lgkmcnt(13)
    v_mfma_f32_16x16x32_bf16 v[112:115], v[204:207], v[156:159], v[112:115]
    ds_read_b64_tr_b16 v[234:235], v6 offset:512
    s_waitcnt lgkmcnt(12)
    v_mfma_f32_16x16x32_bf16 v[72:75], v[204:207], v[148:151], 0
    ds_read_b64_tr_b16 v[236:237], v6 offset:12288
    v_mfma_f32_16x16x32_bf16 v[72:75], v[200:203], v[144:147], v[72:75]
    ds_read_b64_tr_b16 v[238:239], v6 offset:12800
    s_waitcnt lgkmcnt(13)
    v_mfma_f32_16x16x32_bf16 v[64:67], v[200:203], v[136:139], 0
    s_waitcnt lgkmcnt(12)
    v_mfma_f32_16x16x32_bf16 v[64:67], v[204:207], v[140:143], v[64:67]
    s_waitcnt lgkmcnt(10)
    v_mfma_f32_16x16x32_bf16 v[56:59], v[204:207], v[132:135], 0
    v_mfma_f32_16x16x32_bf16 v[56:59], v[200:203], v[128:131], v[56:59]
    s_waitcnt lgkmcnt(9)
    v_mfma_f32_16x16x32_bf16 v[48:51], v[200:203], v[120:123], 0
    s_waitcnt lgkmcnt(8)
    v_mfma_f32_16x16x32_bf16 v[48:51], v[204:207], v[124:127], v[48:51]
    s_waitcnt lgkmcnt(4)
    v_mfma_f32_16x16x32_bf16 v[52:55], v[228:231], v[124:127], 0
    ds_read_b64_tr_b16 v[200:201], v7 offset:0
    v_mfma_f32_16x16x32_bf16 v[52:55], v[224:227], v[120:123], v[52:55]
    ds_read_b64_tr_b16 v[202:203], v7 offset:512
    v_mfma_f32_16x16x32_bf16 v[60:63], v[224:227], v[128:131], 0
    ds_read_b64_tr_b16 v[204:205], v7 offset:12288
    v_mfma_f32_16x16x32_bf16 v[60:63], v[228:231], v[132:135], v[60:63]
    ds_read_b64_tr_b16 v[206:207], v7 offset:12800
    v_mfma_f32_16x16x32_bf16 v[68:71], v[228:231], v[140:143], 0
    v_mfma_f32_16x16x32_bf16 v[68:71], v[224:227], v[136:139], v[68:71]
    v_mfma_f32_16x16x32_bf16 v[76:79], v[224:227], v[144:147], 0
    v_mfma_f32_16x16x32_bf16 v[76:79], v[228:231], v[148:151], v[76:79]
    s_barrier
    s_waitcnt lgkmcnt(4)
    v_mfma_f32_16x16x32_bf16 v[40:43], v[236:239], v[148:151], 0
    ds_read_b64_tr_b16 v[224:225], v6 offset:2048
    ds_read_b64_tr_b16 v[226:227], v6 offset:2560
    v_mfma_f32_16x16x32_bf16 v[40:43], v[232:235], v[144:147], v[40:43]
    ds_read_b64_tr_b16 v[228:229], v6 offset:14336
    ds_read_b64_tr_b16 v[230:231], v6 offset:14848
    v_mfma_f32_16x16x32_bf16 v[32:35], v[232:235], v[136:139], 0
    ds_read_b128 v[192:195], v2 offset:18432
    ds_read_b128 v[196:199], v3 offset:18432
    v_mfma_f32_16x16x32_bf16 v[32:35], v[236:239], v[140:143], v[32:35]
    ds_read_b128 v[184:187], v4 offset:24576
    ds_read_b128 v[188:191], v5 offset:24576
    v_mfma_f32_16x16x32_bf16 v[24:27], v[236:239], v[132:135], 0
    ds_read_b128 v[176:179], v4 offset:22528
    v_mfma_f32_16x16x32_bf16 v[24:27], v[232:235], v[128:131], v[24:27]
    v_mfma_f32_16x16x32_bf16 v[16:19], v[232:235], v[120:123], 0
    v_mfma_f32_16x16x32_bf16 v[16:19], v[236:239], v[124:127], v[16:19]
    s_waitcnt lgkmcnt(9)
    v_mfma_f32_16x16x32_bf16 v[20:23], v[204:207], v[124:127], 0
    ds_read_b64_tr_b16 v[232:233], v7 offset:2048
    ds_read_b64_tr_b16 v[234:235], v7 offset:2560
    v_mfma_f32_16x16x32_bf16 v[20:23], v[200:203], v[120:123], v[20:23]
    ds_read_b64_tr_b16 v[236:237], v7 offset:14336
    ds_read_b64_tr_b16 v[238:239], v7 offset:14848
    v_mfma_f32_16x16x32_bf16 v[28:31], v[200:203], v[128:131], 0
    ds_read_b128 v[180:183], v5 offset:22528
    ds_read_b128 v[168:171], v4 offset:20480
    v_mfma_f32_16x16x32_bf16 v[28:31], v[204:207], v[132:135], v[28:31]
    ds_read_b128 v[172:175], v5 offset:20480
    ds_read_b128 v[160:163], v4 offset:18432
    v_mfma_f32_16x16x32_bf16 v[36:39], v[204:207], v[140:143], 0
    ds_read_b128 v[164:167], v5 offset:18432
    v_mfma_f32_16x16x32_bf16 v[36:39], v[200:203], v[136:139], v[36:39]
    v_mfma_f32_16x16x32_bf16 v[44:47], v[200:203], v[144:147], 0
    v_mfma_f32_16x16x32_bf16 v[44:47], v[204:207], v[148:151], v[44:47]
    s_waitcnt lgkmcnt(14)
    v_mfma_f32_16x16x32_bf16 v[116:119], v[156:159], v[228:231], 0
    v_mfma_f32_16x16x32_bf16 v[116:119], v[152:155], v[224:227], v[116:119]
    v_mfma_f32_16x16x32_bf16 v[104:107], v[144:147], v[224:227], 0
    v_mfma_f32_16x16x32_bf16 v[104:107], v[148:151], v[228:231], v[104:107]
    v_mfma_f32_16x16x32_bf16 v[96:99], v[140:143], v[228:231], 0
    v_mfma_f32_16x16x32_bf16 v[96:99], v[136:139], v[224:227], v[96:99]
    s_waitcnt vmcnt(0) lgkmcnt(0)
    s_barrier
    s_or_b32 s78, s75, s3
    s_cbranch_scc0 LB_tag
LB_tagb:
    v_mfma_f32_16x16x32_bf16 v[88:91], v[128:131], v[224:227], 0
    ds_read_b64_tr_b16 v[200:201], v6 offset:25600
    v_mfma_f32_16x16x32_bf16 v[88:91], v[132:135], v[228:231], v[88:91]
    ds_read_b64_tr_b16 v[202:203], v6 offset:26112
    v_mfma_f32_16x16x32_bf16 v[80:83], v[124:127], v[228:231], 0
    ds_read_b64_tr_b16 v[204:205], v6 offset:37888
    v_mfma_f32_16x16x32_bf16 v[80:83], v[120:123], v[224:227], v[80:83]
    ds_read_b64_tr_b16 v[206:207], v6 offset:38400
    v_mfma_f32_16x16x32_bf16 v[84:87], v[120:123], v[232:235], 0
    ds_read_b64_tr_b16 v[224:225], v7 offset:25600
    v_mfma_f32_16x16x32_bf16 v[84:87], v[124:127], v[236:239], v[84:87]
    ds_read_b64_tr_b16 v[226:227], v7 offset:26112
    v_mfma_f32_16x16x32_bf16 v[92:95], v[132:135], v[236:239], 0
    ds_read_b64_tr_b16 v[228:229], v7 offset:37888
    v_mfma_f32_16x16x32_bf16 v[92:95], v[128:131], v[232:235], v[92:95]
    ds_read_b64_tr_b16 v[230:231], v7 offset:38400
    v_mfma_f32_16x16x32_bf16 v[100:103], v[136:139], v[232:235], 0
    v_mfma_f32_16x16x32_bf16 v[100:103], v[140:143], v[236:239], v[100:103]
    v_mfma_f32_16x16x32_bf16 v[108:111], v[148:151], v[236:239], 0
    v_mfma_f32_16x16x32_bf16 v[108:111], v[144:147], v[232:235], v[108:111]
    s_waitcnt lgkmcnt(4)
    v_mfma_f32_16x16x32_bf16 v[112:115], v[200:203], v[192:195], v[112:115]
    ds_read_b64_tr_b16 v[232:233], v6 offset:24576
    v_mfma_f32_16x16x32_bf16 v[112:115], v[204:207], v[196:199], v[112:115]
    ds_read_b64_tr_b16 v[234:235], v6 offset:25088
    v_mfma_f32_16x16x32_bf16 v[72:75], v[204:207], v[188:191], v[72:75]
    ds_read_b64_tr_b16 v[236:237], v6 offset:36864
    v_mfma_f32_16x16x32_bf16 v[72:75], v[200:203], v[184:187], v[72:75]
    ds_read_b64_tr_b16 v[238:239], v6 offset:37376
    v_mfma_f32_16x16x32_bf16 v[64:67], v[200:203], v[176:179], v[64:67]
    ds_read_b128 v[152:155], v2 offset:36864
    v_mfma_f32_16x16x32_bf16 v[64:67], v[204:207], v[180:183], v[64:67]
    ds_read_b128 v[156:159], v3 offset:36864
    v_mfma_f32_16x16x32_bf16 v[56:59], v[204:207], v[172:175], v[56:59]
    ds_read_b128 v[144:147], v4 offset:43008
    v_mfma_f32_16x16x32_bf16 v[56:59], v[200:203], v[168:171], v[56:59]
    ds_read_b128 v[148:151], v5 offset:43008
    v_mfma_f32_16x16x32_bf16 v[48:51], v[200:203], v[160:163], v[48:51]
    v_mfma_f32_16x16x32_bf16 v[48:51], v[204:207], v[164:167], v[48:51]
    s_waitcnt lgkmcnt(8)
    v_mfma_f32_16x16x32_bf16 v[52:55], v[228:231], v[164:167], v[52:55]
    ds_read_b64_tr_b16 v[200:201], v7 offset:24576
    v_mfma_f32_16x16x32_bf16 v[52:55], v[224:227], v[160:163], v[52:55]
    ds_read_b64_tr_b16 v[202:203], v7 offset:25088
    v_mfma_f32_16x16x32_bf16 v[60:63], v[224:227], v[168:171], v[60:63]
    ds_read_b64_tr_b16 v[204:205], v7 offset:36864
    v_mfma_f32_16x16x32_bf16 v[60:63], v[228:231], v[172:175], v[60:63]
    ds_read_b64_tr_b16 v[206:207], v7 offset:37376
    v_mfma_f32_16x16x32_bf16 v[68:71], v[228:231], v[180:183], v[68:71]
    ds_read_b128 v[136:139], v4 offset:40960
    v_mfma_f32_16x16x32_bf16 v[68:71], v[224:227], v[176:179], v[68:71]
    ds_read_b128 v[140:143], v5 offset:40960
    v_mfma_f32_16x16x32_bf16 v[76:79], v[224:227], v[184:187], v[76:79]
    ds_read_b128 v[128:131], v4 offset:38912
    v_mfma_f32_16x16x32_bf16 v[76:79], v[228:231], v[188:191], v[76:79]
    s_waitcnt lgkmcnt(11)
    v_mfma_f32_16x16x32_bf16 v[40:43], v[236:239], v[188:191], v[40:43]
    ds_read_b64_tr_b16 v[224:225], v6 offset:26624
    v_mfma_f32_16x16x32_bf16 v[40:43], v[232:235], v[184:187], v[40:43]
    ds_read_b64_tr_b16 v[226:227], v6 offset:27136
    v_mfma_f32_16x16x32_bf16 v[32:35], v[232:235], v[176:179], v[32:35]
    ds_read_b64_tr_b16 v[228:229], v6 offset:38912
    v_mfma_f32_16x16x32_bf16 v[32:35], v[236:239], v[180:183], v[32:35]
    ds_read_b64_tr_b16 v[230:231], v6 offset:39424
    v_mfma_f32_16x16x32_bf16 v[24:27], v[236:239], v[172:175], v[24:27]
    ds_read_b128 v[132:135], v5 offset:38912
    v_mfma_f32_16x16x32_bf16 v[24:27], v[232:235], v[168:171], v[24:27]
    ds_read_b128 v[120:123], v4 offset:36864
    v_mfma_f32_16x16x32_bf16 v[16:19], v[232:235], v[160:163], v[16:19]
    ds_read_b128 v[124:127], v5 offset:36864
    v_mfma_f32_16x16x32_bf16 v[16:19], v[236:239], v[164:167], v[16:19]
    s_waitcnt lgkmcnt(10)
    v_mfma_f32_16x16x32_bf16 v[20:23], v[204:207], v[164:167], v[20:23]
    ds_read_b64_tr_b16 v[232:233], v7 offset:26624
    v_mfma_f32_16x16x32_bf16 v[20:23], v[200:203], v[160:163], v[20:23]
    ds_read_b64_tr_b16 v[234:235], v7 offset:27136
    v_mfma_f32_16x16x32_bf16 v[28:31], v[200:203], v[168:171], v[28:31]
    ds_read_b64_tr_b16 v[236:237], v7 offset:38912
    v_mfma_f32_16x16x32_bf16 v[28:31], v[204:207], v[172:175], v[28:31]
    ds_read_b64_tr_b16 v[238:239], v7 offset:39424
    v_mfma_f32_16x16x32_bf16 v[36:39], v[204:207], v[180:183], v[36:39]
    v_mfma_f32_16x16x32_bf16 v[36:39], v[200:203], v[176:179], v[36:39]
    v_mfma_f32_16x16x32_bf16 v[44:47], v[200:203], v[184:187], v[44:47]
    v_mfma_f32_16x16x32_bf16 v[44:47], v[204:207], v[188:191], v[44:47]
    s_waitcnt lgkmcnt(7)
    v_mfma_f32_16x16x32_bf16 v[116:119], v[196:199], v[228:231], v[116:119]
    v_mfma_f32_16x16x32_bf16 v[116:119], v[192:195], v[224:227], v[116:119]
    v_mfma_f32_16x16x32_bf16 v[104:107], v[184:187], v[224:227], v[104:107]
    v_mfma_f32_16x16x32_bf16 v[104:107], v[188:191], v[228:231], v[104:107]
    v_mfma_f32_16x16x32_bf16 v[96:99], v[180:183], v[228:231], v[96:99]
    v_mfma_f32_16x16x32_bf16 v[96:99], v[176:179], v[224:227], v[96:99]
    s_waitcnt lgkmcnt(0)
    s_barrier
    v_mfma_f32_16x16x32_bf16 v[88:91], v[168:171], v[224:227], v[88:91]
    ds_read_b64_tr_b16 v[200:201], v6 offset:50176
    v_mfma_f32_16x16x32_bf16 v[88:91], v[172:175], v[228:231], v[88:91]
    ds_read_b64_tr_b16 v[202:203], v6 offset:50688
    v_mfma_f32_16x16x32_bf16 v[80:83], v[164:167], v[228:231], v[80:83]
    ds_read_b64_tr_b16 v[204:205], v6 offset:62464
    v_mfma_f32_16x16x32_bf16 v[80:83], v[160:163], v[224:227], v[80:83]
    ds_read_b64_tr_b16 v[206:207], v6 offset:62976
    v_mfma_f32_16x16x32_bf16 v[84:87], v[160:163], v[232:235], v[84:87]
    ds_read_b64_tr_b16 v[224:225], v7 offset:50176
    v_mfma_f32_16x16x32_bf16 v[84:87], v[164:167], v[236:239], v[84:87]
    ds_read_b64_tr_b16 v[226:227], v7 offset:50688
    v_mfma_f32_16x16x32_bf16 v[92:95], v[172:175], v[236:239], v[92:95]
    ds_read_b64_tr_b16 v[228:229], v7 offset:62464
    v_mfma_f32_16x16x32_bf16 v[92:95], v[168:171], v[232:235], v[92:95]
    ds_read_b64_tr_b16 v[230:231], v7 offset:62976
    v_mfma_f32_16x16x32_bf16 v[100:103], v[176:179], v[232:235], v[100:103]
    v_mfma_f32_16x16x32_bf16 v[100:103], v[180:183], v[236:239], v[100:103]
    v_mfma_f32_16x16x32_bf16 v[108:111], v[188:191], v[236:239], v[108:111]
    v_mfma_f32_16x16x32_bf16 v[108:111], v[184:187], v[232:235], v[108:111]
    s_waitcnt lgkmcnt(4)
    v_mfma_f32_16x16x32_bf16 v[112:115], v[200:203], v[152:155], v[112:115]
    ds_read_b64_tr_b16 v[232:233], v6 offset:49152
    v_mfma_f32_16x16x32_bf16 v[112:115], v[204:207], v[156:159], v[112:115]
    ds_read_b64_tr_b16 v[234:235], v6 offset:49664
    v_mfma_f32_16x16x32_bf16 v[72:75], v[204:207], v[148:151], v[72:75]
    ds_read_b64_tr_b16 v[236:237], v6 offset:61440
    v_mfma_f32_16x16x32_bf16 v[72:75], v[200:203], v[144:147], v[72:75]
    ds_read_b64_tr_b16 v[238:239], v6 offset:61952
    v_mfma_f32_16x16x32_bf16 v[64:67], v[200:203], v[136:139], v[64:67]
    ds_read_b128 v[192:195], v2 offset:0
    v_mfma_f32_16x16x32_bf16 v[64:67], v[204:207], v[140:143], v[64:67]
    ds_read_b128 v[196:199], v3 offset:0
    v_mfma_f32_16x16x32_bf16 v[56:59], v[204:207], v[132:135], v[56:59]
    ds_read_b128 v[184:187], v4 offset:6144
    v_mfma_f32_16x16x32_bf16 v[56:59], v[200:203], v[128:131], v[56:59]
    ds_read_b128 v[188:191], v5 offset:6144
    v_mfma_f32_16x16x32_bf16 v[48:51], v[200:203], v[120:123], v[48:51]
    v_mfma_f32_16x16x32_bf16 v[48:51], v[204:207], v[124:127], v[48:51]
    s_waitcnt lgkmcnt(8)
    v_mfma_f32_16x16x32_bf16 v[52:55], v[228:231], v[124:127], v[52:55]
    ds_read_b64_tr_b16 v[200:201], v7 offset:49152
    v_mfma_f32_16x16x32_bf16 v[52:55], v[224:227], v[120:123], v[52:55]
    ds_read_b64_tr_b16 v[202:203], v7 offset:49664
    v_mfma_f32_16x16x32_bf16 v[60:63], v[224:227], v[128:131], v[60:63]
    ds_read_b64_tr_b16 v[204:205], v7 offset:61440
    v_mfma_f32_16x16x32_bf16 v[60:63], v[228:231], v[132:135], v[60:63]
    ds_read_b64_tr_b16 v[206:207], v7 offset:61952
    v_mfma_f32_16x16x32_bf16 v[68:71], v[228:231], v[140:143], v[68:71]
    ds_read_b128 v[176:179], v4 offset:4096
    v_mfma_f32_16x16x32_bf16 v[68:71], v[224:227], v[136:139], v[68:71]
    ds_read_b128 v[180:183], v5 offset:4096
    v_mfma_f32_16x16x32_bf16 v[76:79], v[224:227], v[144:147], v[76:79]
    ds_read_b128 v[168:171], v4 offset:2048
    v_mfma_f32_16x16x32_bf16 v[76:79], v[228:231], v[148:151], v[76:79]
    s_waitcnt lgkmcnt(11)
    v_mfma_f32_16x16x32_bf16 v[40:43], v[236:239], v[148:151], v[40:43]
    ds_read_b64_tr_b16 v[224:225], v6 offset:51200
    v_mfma_f32_16x16x32_bf16 v[40:43], v[232:235], v[144:147], v[40:43]
    ds_read_b64_tr_b16 v[226:227], v6 offset:51712
    v_mfma_f32_16x16x32_bf16 v[32:35], v[232:235], v[136:139], v[32:35]
    ds_read_b64_tr_b16 v[228:229], v6 offset:63488
    v_mfma_f32_16x16x32_bf16 v[32:35], v[236:239], v[140:143], v[32:35]
    ds_read_b64_tr_b16 v[230:231], v6 offset:64000
    v_mfma_f32_16x16x32_bf16 v[24:27], v[236:239], v[132:135], v[24:27]
    ds_read_b128 v[172:175], v5 offset:2048
    v_mfma_f32_16x16x32_bf16 v[24:27], v[232:235], v[128:131], v[24:27]
    ds_read_b128 v[160:163], v4 offset:0
    v_mfma_f32_16x16x32_bf16 v[16:19], v[232:235], v[120:123], v[16:19]
    ds_read_b128 v[164:167], v5 offset:0
    v_mfma_f32_16x16x32_bf16 v[16:19], v[236:239], v[124:127], v[16:19]
    s_waitcnt lgkmcnt(10)
    v_mfma_f32_16x16x32_bf16 v[20:23], v[204:207], v[124:127], v[20:23]
    ds_read_b64_tr_b16 v[232:233], v7 offset:51200
    v_mfma_f32_16x16x32_bf16 v[20:23], v[200:203], v[120:123], v[20:23]
    ds_read_b64_tr_b16 v[234:235], v7 offset:51712
    v_mfma_f32_16x16x32_bf16 v[28:31], v[200:203], v[128:131], v[28:31]
    ds_read_b64_tr_b16 v[236:237], v7 offset:63488
    v_mfma_f32_16x16x32_bf16 v[28:31], v[204:207], v[132:135], v[28:31]
    ds_read_b64_tr_b16 v[238:239], v7 offset:64000
    v_mfma_f32_16x16x32_bf16 v[36:39], v[204:207], v[140:143], v[36:39]
    v_mfma_f32_16x16x32_bf16 v[36:39], v[200:203], v[136:139], v[36:39]
    v_mfma_f32_16x16x32_bf16 v[44:47], v[200:203], v[144:147], v[44:47]
    v_mfma_f32_16x16x32_bf16 v[44:47], v[204:207], v[148:151], v[44:47]
    s_waitcnt lgkmcnt(7)
    v_mfma_f32_16x16x32_bf16 v[116:119], v[156:159], v[228:231], v[116:119]
    v_mfma_f32_16x16x32_bf16 v[116:119], v[152:155], v[224:227], v[116:119]
    v_mfma_f32_16x16x32_bf16 v[104:107], v[144:147], v[224:227], v[104:107]
    v_mfma_f32_16x16x32_bf16 v[104:107], v[148:151], v[228:231], v[104:107]
    v_mfma_f32_16x16x32_bf16 v[96:99], v[140:143], v[228:231], v[96:99]
    v_mfma_f32_16x16x32_bf16 v[96:99], v[136:139], v[224:227], v[96:99]
    s_waitcnt lgkmcnt(0)
    s_barrier
    v_mfma_f32_16x16x32_bf16 v[88:91], v[128:131], v[224:227], v[88:91]
    ds_read_b64_tr_b16 v[200:201], v6 offset:1024
    v_mfma_f32_16x16x32_bf16 v[88:91], v[132:135], v[228:231], v[88:91]
    ds_read_b64_tr_b16 v[202:203], v6 offset:1536
    v_mfma_f32_16x16x32_bf16 v[80:83], v[124:127], v[228:231], v[80:83]
    ds_read_b64_tr_b16 v[204:205], v6 offset:13312
    v_mfma_f32_16x16x32_bf16 v[80:83], v[120:123], v[224:227], v[80:83]
    ds_read_b64_tr_b16 v[206:207], v6 offset:13824
    v_mfma_f32_16x16x32_bf16 v[84:87], v[120:123], v[232:235], v[84:87]
    ds_read_b64_tr_b16 v[224:225], v7 offset:1024
    v_mfma_f32_16x16x32_bf16 v[84:87], v[124:127], v[236:239], v[84:87]
    ds_read_b64_tr_b16 v[226:227], v7 offset:1536
    v_mfma_f32_16x16x32_bf16 v[92:95], v[132:135], v[236:239], v[92:95]
    ds_read_b64_tr_b16 v[228:229], v7 offset:13312
    v_mfma_f32_16x16x32_bf16 v[92:95], v[128:131], v[232:235], v[92:95]
    ds_read_b64_tr_b16 v[230:231], v7 offset:13824
    v_mfma_f32_16x16x32_bf16 v[100:103], v[136:139], v[232:235], v[100:103]
    v_mfma_f32_16x16x32_bf16 v[100:103], v[140:143], v[236:239], v[100:103]
    v_mfma_f32_16x16x32_bf16 v[108:111], v[148:151], v[236:239], v[108:111]
    v_mfma_f32_16x16x32_bf16 v[108:111], v[144:147], v[232:235], v[108:111]
    s_waitcnt lgkmcnt(4)
    v_mfma_f32_16x16x32_bf16 v[112:115], v[200:203], v[192:195], v[112:115]
    ds_read_b64_tr_b16 v[232:233], v6 offset:0
    v_mfma_f32_16x16x32_bf16 v[112:115], v[204:207], v[196:199], v[112:115]
    ds_read_b64_tr_b16 v[234:235], v6 offset:512
    v_mfma_f32_16x16x32_bf16 v[72:75], v[204:207], v[188:191], v[72:75]
    ds_read_b64_tr_b16 v[236:237], v6 offset:12288
    v_mfma_f32_16x16x32_bf16 v[72:75], v[200:203], v[184:187], v[72:75]
    ds_read_b64_tr_b16 v[238:239], v6 offset:12800
    v_mfma_f32_16x16x32_bf16 v[64:67], v[200:203], v[176:179], v[64:67]
    ds_read_b128 v[152:155], v2 offset:18432
    v_mfma_f32_16x16x32_bf16 v[64:67], v[204:207], v[180:183], v[64:67]
    ds_read_b128 v[156:159], v3 offset:18432
    v_mfma_f32_16x16x32_bf16 v[56:59], v[204:207], v[172:175], v[56:59]
    ds_read_b128 v[144:147], v4 offset:24576
    v_mfma_f32_16x16x32_bf16 v[56:59], v[200:203], v[168:171], v[56:59]
    ds_read_b128 v[148:151], v5 offset:24576
    v_mfma_f32_16x16x32_bf16 v[48:51], v[200:203], v[160:163], v[48:51]
    v_mfma_f32_16x16x32_bf16 v[48:51], v[204:207], v[164:167], v[48:51]
    s_waitcnt lgkmcnt(8)
    v_mfma_f32_16x16x32_bf16 v[52:55], v[228:231], v[164:167], v[52:55]
    ds_read_b64_tr_b16 v[200:201], v7 offset:0
    v_mfma_f32_16x16x32_bf16 v[52:55], v[224:227], v[160:163], v[52:55]
    ds_read_b64_tr_b16 v[202:203], v7 offset:512
    v_mfma_f32_16x16x32_bf16 v[60:63], v[224:227], v[168:171], v[60:63]
    ds_read_b64_tr_b16 v[204:205], v7 offset:12288
    v_mfma_f32_16x16x32_bf16 v[60:63], v[228:231], v[172:175], v[60:63]
    ds_read_b64_tr_b16 v[206:207], v7 offset:12800
    v_mfma_f32_16x16x32_bf16 v[68:71], v[228:231], v[180:183], v[68:71]
    ds_read_b128 v[136:139], v4 offset:22528
    v_mfma_f32_16x16x32_bf16 v[68:71], v[224:227], v[176:179], v[68:71]
    ds_read_b128 v[140:143], v5 offset:22528
    v_mfma_f32_16x16x32_bf16 v[76:79], v[224:227], v[184:187], v[76:79]
    ds_read_b128 v[128:131], v4 offset:20480
    v_mfma_f32_16x16x32_bf16 v[76:79], v[228:231], v[188:191], v[76:79]
    s_waitcnt lgkmcnt(11)
    v_mfma_f32_16x16x32_bf16 v[40:43], v[236:239], v[188:191], v[40:43]
    ds_read_b64_tr_b16 v[224:225], v6 offset:2048
    v_mfma_f32_16x16x32_bf16 v[40:43], v[232:235], v[184:187], v[40:43]
    ds_read_b64_tr_b16 v[226:227], v6 offset:2560
    v_mfma_f32_16x16x32_bf16 v[32:35], v[232:235], v[176:179], v[32:35]
    ds_read_b64_tr_b16 v[228:229], v6 offset:14336
    v_mfma_f32_16x16x32_bf16 v[32:35], v[236:239], v[180:183], v[32:35]
    ds_read_b64_tr_b16 v[230:231], v6 offset:14848
    v_mfma_f32_16x16x32_bf16 v[24:27], v[236:239], v[172:175], v[24:27]
    ds_read_b128 v[132:135], v5 offset:20480
    v_mfma_f32_16x16x32_bf16 v[24:27], v[232:235], v[168:171], v[24:27]
    ds_read_b128 v[120:123], v4 offset:18432
    v_mfma_f32_16x16x32_bf16 v[16:19], v[232:235], v[160:163], v[16:19]
    ds_read_b128 v[124:127], v5 offset:18432
    v_mfma_f32_16x16x32_bf16 v[16:19], v[236:239], v[164:167], v[16:19]
    s_waitcnt lgkmcnt(10)
    v_mfma_f32_16x16x32_bf16 v[20:23], v[204:207], v[164:167], v[20:23]
    ds_read_b64_tr_b16 v[232:233], v7 offset:2048
    v_mfma_f32_16x16x32_bf16 v[20:23], v[200:203], v[160:163], v[20:23]
    ds_read_b64_tr_b16 v[234:235], v7 offset:2560
    v_mfma_f32_16x16x32_bf16 v[28:31], v[200:203], v[168:171], v[28:31]
    ds_read_b64_tr_b16 v[236:237], v7 offset:14336
    v_mfma_f32_16x16x32_bf16 v[28:31], v[204:207], v[172:175], v[28:31]
    ds_read_b64_tr_b16 v[238:239], v7 offset:14848
    v_mfma_f32_16x16x32_bf16 v[36:39], v[204:207], v[180:183], v[36:39]
    v_mfma_f32_16x16x32_bf16 v[36:39], v[200:203], v[176:179], v[36:39]
    v_mfma_f32_16x16x32_bf16 v[44:47], v[200:203], v[184:187], v[44:47]
    v_mfma_f32_16x16x32_bf16 v[44:47], v[204:207], v[188:191], v[44:47]
    s_waitcnt lgkmcnt(7)
    v_mfma_f32_16x16x32_bf16 v[116:119], v[196:199], v[228:231], v[116:119]
    v_mfma_f32_16x16x32_bf16 v[116:119], v[192:195], v[224:227], v[116:119]
    v_mfma_f32_16x16x32_bf16 v[104:107], v[184:187], v[224:227], v[104:107]
    v_mfma_f32_16x16x32_bf16 v[104:107], v[188:191], v[228:231], v[104:107]
    v_mfma_f32_16x16x32_bf16 v[96:99], v[180:183], v[228:231], v[96:99]
    v_mfma_f32_16x16x32_bf16 v[96:99], v[176:179], v[224:227], v[96:99]
    s_waitcnt lgkmcnt(0)
    s_barrier
    v_mfma_f32_16x16x32_bf16 v[88:91], v[168:171], v[224:227], v[88:91]
    ds_read_b64_tr_b16 v[200:201], v6 offset:25600
    v_mfma_f32_16x16x32_bf16 v[88:91], v[172:175], v[228:231], v[88:91]
    ds_read_b64_tr_b16 v[202:203], v6 offset:26112
    v_mfma_f32_16x16x32_bf16 v[80:83], v[164:167], v[228:231], v[80:83]
    ds_read_b64_tr_b16 v[204:205], v6 offset:37888
    v_mfma_f32_16x16x32_bf16 v[80:83], v[160:163], v[224:227], v[80:83]
    ds_read_b64_tr_b16 v[206:207], v6 offset:38400
    v_mfma_f32_16x16x32_bf16 v[84:87], v[160:163], v[232:235], v[84:87]
    ds_read_b64_tr_b16 v[224:225], v7 offset:25600
    v_mfma_f32_16x16x32_bf16 v[84:87], v[164:167], v[236:239], v[84:87]
    ds_read_b64_tr_b16 v[226:227], v7 offset:26112
    v_mfma_f32_16x16x32_bf16 v[92:95], v[172:175], v[236:239], v[92:95]
    ds_read_b64_tr_b16 v[228:229], v7 offset:37888
    v_mfma_f32_16x16x32_bf16 v[92:95], v[168:171], v[232:235], v[92:95]
    ds_read_b64_tr_b16 v[230:231], v7 offset:38400
    v_mfma_f32_16x16x32_bf16 v[100:103], v[176:179], v[232:235], v[100:103]
    v_mfma_f32_16x16x32_bf16 v[100:103], v[180:183], v[236:239], v[100:103]
    v_mfma_f32_16x16x32_bf16 v[108:111], v[188:191], v[236:239], v[108:111]
    v_mfma_f32_16x16x32_bf16 v[108:111], v[184:187], v[232:235], v[108:111]
    s_waitcnt lgkmcnt(4)
    v_mfma_f32_16x16x32_bf16 v[112:115], v[200:203], v[152:155], v[112:115]
    ds_read_b64_tr_b16 v[232:233], v6 offset:24576
    v_mfma_f32_16x16x32_bf16 v[112:115], v[204:207], v[156:159], v[112:115]
    ds_read_b64_tr_b16 v[234:235], v6 offset:25088
    v_mfma_f32_16x16x32_bf16 v[72:75], v[204:207], v[148:151], v[72:75]
    ds_read_b64_tr_b16 v[236:237], v6 offset:36864
    v_mfma_f32_16x16x32_bf16 v[72:75], v[200:203], v[144:147], v[72:75]
    ds_read_b64_tr_b16 v[238:239], v6 offset:37376
    v_mfma_f32_16x16x32_bf16 v[64:67], v[200:203], v[136:139], v[64:67]
    ds_read_b128 v[192:195], v2 offset:36864
    v_mfma_f32_16x16x32_bf16 v[64:67], v[204:207], v[140:143], v[64:67]
    ds_read_b128 v[196:199], v3 offset:36864
    v_mfma_f32_16x16x32_bf16 v[56:59], v[204:207], v[132:135], v[56:59]
    ds_read_b128 v[184:187], v4 offset:43008
    v_mfma_f32_16x16x32_bf16 v[56:59], v[200:203], v[128:131], v[56:59]
    ds_read_b128 v[188:191], v5 offset:43008
    v_mfma_f32_16x16x32_bf16 v[48:51], v[200:203], v[120:123], v[48:51]
    v_mfma_f32_16x16x32_bf16 v[48:51], v[204:207], v[124:127], v[48:51]
    s_waitcnt lgkmcnt(8)
    v_mfma_f32_16x16x32_bf16 v[52:55], v[228:231], v[124:127], v[52:55]
    ds_read_b64_tr_b16 v[200:201], v7 offset:24576
    v_mfma_f32_16x16x32_bf16 v[52:55], v[224:227], v[120:123], v[52:55]
    ds_read_b64_tr_b16 v[202:203], v7 offset:25088
    v_mfma_f32_16x16x32_bf16 v[60:63], v[224:227], v[128:131], v[60:63]
    ds_read_b64_tr_b16 v[204:205], v7 offset:36864
    v_mfma_f32_16x16x32_bf16 v[60:63], v[228:231], v[132:135], v[60:63]
    ds_read_b64_tr_b16 v[206:207], v7 offset:37376
    v_mfma_f32_16x16x32_bf16 v[68:71], v[228:231], v[140:143], v[68:71]
    ds_read_b128 v[176:179], v4 offset:40960
    v_mfma_f32_16x16x32_bf16 v[68:71], v[224:227], v[136:139], v[68:71]
    ds_read_b128 v[180:183], v5 offset:40960
    v_mfma_f32_16x16x32_bf16 v[76:79], v[224:227], v[144:147], v[76:79]
    ds_read_b128 v[168:171], v4 offset:38912
    v_mfma_f32_16x16x32_bf16 v[76:79], v[228:231], v[148:151], v[76:79]
    s_waitcnt lgkmcnt(11)
    v_mfma_f32_16x16x32_bf16 v[40:43], v[236:239], v[148:151], v[40:43]
    ds_read_b64_tr_b16 v[224:225], v6 offset:26624
    v_mfma_f32_16x16x32_bf16 v[40:43], v[232:235], v[144:147], v[40:43]
    ds_read_b64_tr_b16 v[226:227], v6 offset:27136
    v_mfma_f32_16x16x32_bf16 v[32:35], v[232:235], v[136:139], v[32:35]
    ds_read_b64_tr_b16 v[228:229], v6 offset:38912
    v_mfma_f32_16x16x32_bf16 v[32:35], v[236:239], v[140:143], v[32:35]
    ds_read_b64_tr_b16 v[230:231], v6 offset:39424
    v_mfma_f32_16x16x32_bf16 v[24:27], v[236:239], v[132:135], v[24:27]
    ds_read_b128 v[172:175], v5 offset:38912
    v_mfma_f32_16x16x32_bf16 v[24:27], v[232:235], v[128:131], v[24:27]
    ds_read_b128 v[160:163], v4 offset:36864
    v_mfma_f32_16x16x32_bf16 v[16:19], v[232:235], v[120:123], v[16:19]
    ds_read_b128 v[164:167], v5 offset:36864
    v_mfma_f32_16x16x32_bf16 v[16:19], v[236:239], v[124:127], v[16:19]
    s_waitcnt lgkmcnt(10)
    v_mfma_f32_16x16x32_bf16 v[20:23], v[204:207], v[124:127], v[20:23]
    ds_read_b64_tr_b16 v[232:233], v7 offset:26624
    v_mfma_f32_16x16x32_bf16 v[20:23], v[200:203], v[120:123], v[20:23]
    ds_read_b64_tr_b16 v[234:235], v7 offset:27136
    v_mfma_f32_16x16x32_bf16 v[28:31], v[200:203], v[128:131], v[28:31]
    ds_read_b64_tr_b16 v[236:237], v7 offset:38912
    v_mfma_f32_16x16x32_bf16 v[28:31], v[204:207], v[132:135], v[28:31]
    ds_read_b64_tr_b16 v[238:239], v7 offset:39424
    v_mfma_f32_16x16x32_bf16 v[36:39], v[204:207], v[140:143], v[36:39]
    v_mfma_f32_16x16x32_bf16 v[36:39], v[200:203], v[136:139], v[36:39]
    v_mfma_f32_16x16x32_bf16 v[44:47], v[200:203], v[144:147], v[44:47]
    v_mfma_f32_16x16x32_bf16 v[44:47], v[204:207], v[148:151], v[44:47]
    s_waitcnt lgkmcnt(7)
    v_mfma_f32_16x16x32_bf16 v[116:119], v[156:159], v[228:231], v[116:119]
    v_mfma_f32_16x16x32_bf16 v[116:119], v[152:155], v[224:227], v[116:119]
    v_mfma_f32_16x16x32_bf16 v[104:107], v[144:147], v[224:227], v[104:107]
    v_mfma_f32_16x16x32_bf16 v[104:107], v[148:151], v[228:231], v[104:107]
    v_mfma_f32_16x16x32_bf16 v[96:99], v[140:143], v[228:231], v[96:99]
    v_mfma_f32_16x16x32_bf16 v[96:99], v[136:139], v[224:227], v[96:99]
    s_waitcnt lgkmcnt(0)
    s_barrier
    v_mfma_f32_16x16x32_bf16 v[88:91], v[128:131], v[224:227], v[88:91]
    ds_read_b64_tr_b16 v[200:201], v6 offset:50176
    v_mfma_f32_16x16x32_bf16 v[88:91], v[132:135], v[228:231], v[88:91]
    ds_read_b64_tr_b16 v[202:203], v6 offset:50688
    v_mfma_f32_16x16x32_bf16 v[80:83], v[124:127], v[228:231], v[80:83]
    ds_read_b64_tr_b16 v[204:205], v6 offset:62464
    v_mfma_f32_16x16x32_bf16 v[80:83], v[120:123], v[224:227], v[80:83]
    ds_read_b64_tr_b16 v[206:207], v6 offset:62976
    v_mfma_f32_16x16x32_bf16 v[84:87], v[120:123], v[232:235], v[84:87]
    ds_read_b64_tr_b16 v[224:225], v7 offset:50176
    v_mfma_f32_16x16x32_bf16 v[84:87], v[124:127], v[236:239], v[84:87]
    ds_read_b64_tr_b16 v[226:227], v7 offset:50688
    v_mfma_f32_16x16x32_bf16 v[92:95], v[132:135], v[236:239], v[92:95]
    ds_read_b64_tr_b16 v[228:229], v7 offset:62464
    v_mfma_f32_16x16x32_bf16 v[92:95], v[128:131], v[232:235], v[92:95]
    ds_read_b64_tr_b16 v[230:231], v7 offset:62976
    v_mfma_f32_16x16x32_bf16 v[100:103], v[136:139], v[232:235], v[100:103]
    v_mfma_f32_16x16x32_bf16 v[100:103], v[140:143], v[236:239], v[100:103]
    v_mfma_f32_16x16x32_bf16 v[108:111], v[148:151], v[236:239], v[108:111]
    v_mfma_f32_16x16x32_bf16 v[108:111], v[144:147], v[232:235], v[108:111]
    s_waitcnt lgkmcnt(4)
    v_mfma_f32_16x16x32_bf16 v[112:115], v[200:203], v[192:195], v[112:115]
    ds_read_b64_tr_b16 v[232:233], v6 offset:49152
    v_mfma_f32_16x16x32_bf16 v[112:115], v[204:207], v[196:199], v[112:115]
    ds_read_b64_tr_b16 v[234:235], v6 offset:49664
    v_mfma_f32_16x16x32_bf16 v[72:75], v[204:207], v[188:191], v[72:75]
    ds_read_b64_tr_b16 v[236:237], v6 offset:61440
    v_mfma_f32_16x16x32_bf16 v[72:75], v[200:203], v[184:187], v[72:75]
    ds_read_b64_tr_b16 v[238:239], v6 offset:61952
    v_mfma_f32_16x16x32_bf16 v[64:67], v[200:203], v[176:179], v[64:67]
    ds_read_b128 v[152:155], v2 offset:0
    v_mfma_f32_16x16x32_bf16 v[64:67], v[204:207], v[180:183], v[64:67]
    ds_read_b128 v[156:159], v3 offset:0
    v_mfma_f32_16x16x32_bf16 v[56:59], v[204:207], v[172:175], v[56:59]
    ds_read_b128 v[144:147], v4 offset:6144
    v_mfma_f32_16x16x32_bf16 v[56:59], v[200:203], v[168:171], v[56:59]
    ds_read_b128 v[148:151], v5 offset:6144
    v_mfma_f32_16x16x32_bf16 v[48:51], v[200:203], v[160:163], v[48:51]
    v_mfma_f32_16x16x32_bf16 v[48:51], v[204:207], v[164:167], v[48:51]
    s_waitcnt lgkmcnt(8)
    v_mfma_f32_16x16x32_bf16 v[52:55], v[228:231], v[164:167], v[52:55]
    ds_read_b64_tr_b16 v[200:201], v7 offset:49152
    v_mfma_f32_16x16x32_bf16 v[52:55], v[224:227], v[160:163], v[52:55]
    ds_read_b64_tr_b16 v[202:203], v7 offset:49664
    v_mfma_f32_16x16x32_bf16 v[60:63], v[224:227], v[168:171], v[60:63]
    ds_read_b64_tr_b16 v[204:205], v7 offset:61440
    v_mfma_f32_16x16x32_bf16 v[60:63], v[228:231], v[172:175], v[60:63]
    ds_read_b64_tr_b16 v[206:207], v7 offset:61952
    v_mfma_f32_16x16x32_bf16 v[68:71], v[228:231], v[180:183], v[68:71]
    ds_read_b128 v[136:139], v4 offset:4096
    v_mfma_f32_16x16x32_bf16 v[68:71], v[224:227], v[176:179], v[68:71]
    ds_read_b128 v[140:143], v5 offset:4096
    v_mfma_f32_16x16x32_bf16 v[76:79], v[224:227], v[184:187], v[76:79]
    ds_read_b128 v[128:131], v4 offset:2048
    v_mfma_f32_16x16x32_bf16 v[76:79], v[228:231], v[188:191], v[76:79]
    s_waitcnt lgkmcnt(11)
    v_mfma_f32_16x16x32_bf16 v[40:43], v[236:239], v[188:191], v[40:43]
    ds_read_b64_tr_b16 v[224:225], v6 offset:51200
    v_mfma_f32_16x16x32_bf16 v[40:43], v[232:235], v[184:187], v[40:43]
    ds_read_b64_tr_b16 v[226:227], v6 offset:51712
    v_mfma_f32_16x16x32_bf16 v[32:35], v[232:235], v[176:179], v[32:35]
    ds_read_b64_tr_b16 v[228:229], v6 offset:63488
    v_mfma_f32_16x16x32_bf16 v[32:35], v[236:239], v[180:183], v[32:35]
    ds_read_b64_tr_b16 v[230:231], v6 offset:64000
    v_mfma_f32_16x16x32_bf16 v[24:27], v[236:239], v[172:175], v[24:27]
    ds_read_b128 v[132:135], v5 offset:2048
    v_mfma_f32_16x16x32_bf16 v[24:27], v[232:235], v[168:171], v[24:27]
    ds_read_b128 v[120:123], v4 offset:0
    v_mfma_f32_16x16x32_bf16 v[16:19], v[232:235], v[160:163], v[16:19]
    ds_read_b128 v[124:127], v5 offset:0
    v_mfma_f32_16x16x32_bf16 v[16:19], v[236:239], v[164:167], v[16:19]
    s_waitcnt lgkmcnt(10)
    v_mfma_f32_16x16x32_bf16 v[20:23], v[204:207], v[164:167], v[20:23]
    ds_read_b64_tr_b16 v[232:233], v7 offset:51200
    v_mfma_f32_16x16x32_bf16 v[20:23], v[200:203], v[160:163], v[20:23]
    ds_read_b64_tr_b16 v[234:235], v7 offset:51712
    v_mfma_f32_16x16x32_bf16 v[28:31], v[200:203], v[168:171], v[28:31]
    ds_read_b64_tr_b16 v[236:237], v7 offset:63488
    v_mfma_f32_16x16x32_bf16 v[28:31], v[204:207], v[172:175], v[28:31]
    ds_read_b64_tr_b16 v[238:239], v7 offset:64000
    v_mfma_f32_16x16x32_bf16 v[36:39], v[204:207], v[180:183], v[36:39]
    v_mfma_f32_16x16x32_bf16 v[36:39], v[200:203], v[176:179], v[36:39]
    v_mfma_f32_16x16x32_bf16 v[44:47], v[200:203], v[184:187], v[44:47]
    v_mfma_f32_16x16x32_bf16 v[44:47], v[204:207], v[188:191], v[44:47]
    s_waitcnt lgkmcnt(7)
    v_mfma_f32_16x16x32_bf16 v[116:119], v[196:199], v[228:231], v[116:119]
    v_mfma_f32_16x16x32_bf16 v[116:119], v[192:195], v[224:227], v[116:119]
    v_mfma_f32_16x16x32_bf16 v[104:107], v[184:187], v[224:227], v[104:107]
    v_mfma_f32_16x16x32_bf16 v[104:107], v[188:191], v[228:231], v[104:107]
    v_mfma_f32_16x16x32_bf16 v[96:99], v[180:183], v[228:231], v[96:99]
    v_mfma_f32_16x16x32_bf16 v[96:99], v[176:179], v[224:227], v[96:99]
    s_waitcnt lgkmcnt(0)
    s_barrier
    v_mfma_f32_16x16x32_bf16 v[88:91], v[168:171], v[224:227], v[88:91]
    ds_read_b64_tr_b16 v[200:201], v6 offset:1024
    v_mfma_f32_16x16x32_bf16 v[88:91], v[172:175], v[228:231], v[88:91]
    ds_read_b64_tr_b16 v[202:203], v6 offset:1536
    v_mfma_f32_16x16x32_bf16 v[80:83], v[164:167], v[228:231], v[80:83]
    ds_read_b64_tr_b16 v[204:205], v6 offset:13312
    v_mfma_f32_16x16x32_bf16 v[80:83], v[160:163], v[224:227], v[80:83]
    ds_read_b64_tr_b16 v[206:207], v6 offset:13824
    v_mfma_f32_16x16x32_bf16 v[84:87], v[160:163], v[232:235], v[84:87]
    ds_read_b64_tr_b16 v[224:225], v7 offset:1024
    v_mfma_f32_16x16x32_bf16 v[84:87], v[164:167], v[236:239], v[84:87]
    ds_read_b64_tr_b16 v[226:227], v7 offset:1536
    v_mfma_f32_16x16x32_bf16 v[92:95], v[172:175], v[236:239], v[92:95]
    ds_read_b64_tr_b16 v[228:229], v7 offset:13312
    v_mfma_f32_16x16x32_bf16 v[92:95], v[168:171], v[232:235], v[92:95]
    ds_read_b64_tr_b16 v[230:231], v7 offset:13824
    v_mfma_f32_16x16x32_bf16 v[100:103], v[176:179], v[232:235], v[100:103]
    v_mfma_f32_16x16x32_bf16 v[100:103], v[180:183], v[236:239], v[100:103]
    v_mfma_f32_16x16x32_bf16 v[108:111], v[188:191], v[236:239], v[108:111]
    v_mfma_f32_16x16x32_bf16 v[108:111], v[184:187], v[232:235], v[108:111]
    s_waitcnt lgkmcnt(4)
    v_mfma_f32_16x16x32_bf16 v[112:115], v[200:203], v[152:155], v[112:115]
    ds_read_b64_tr_b16 v[232:233], v6 offset:0
    v_mfma_f32_16x16x32_bf16 v[112:115], v[204:207], v[156:159], v[112:115]
    ds_read_b64_tr_b16 v[234:235], v6 offset:512
    v_mfma_f32_16x16x32_bf16 v[72:75], v[204:207], v[148:151], v[72:75]
    ds_read_b64_tr_b16 v[236:237], v6 offset:12288
    v_mfma_f32_16x16x32_bf16 v[72:75], v[200:203], v[144:147], v[72:75]
    ds_read_b64_tr_b16 v[238:239], v6 offset:12800
    v_mfma_f32_16x16x32_bf16 v[64:67], v[200:203], v[136:139], v[64:67]
    ds_read_b128 v[192:195], v2 offset:18432
    v_mfma_f32_16x16x32_bf16 v[64:67], v[204:207], v[140:143], v[64:67]
    ds_read_b128 v[196:199], v3 offset:18432
    v_mfma_f32_16x16x32_bf16 v[56:59], v[204:207], v[132:135], v[56:59]
    ds_read_b128 v[184:187], v4 offset:24576
    v_mfma_f32_16x16x32_bf16 v[56:59], v[200:203], v[128:131], v[56:59]
    ds_read_b128 v[188:191], v5 offset:24576
    v_mfma_f32_16x16x32_bf16 v[48:51], v[200:203], v[120:123], v[48:51]
    v_mfma_f32_16x16x32_bf16 v[48:51], v[204:207], v[124:127], v[48:51]
    s_waitcnt lgkmcnt(8)
    v_mfma_f32_16x16x32_bf16 v[52:55], v[228:231], v[124:127], v[52:55]
    ds_read_b64_tr_b16 v[200:201], v7 offset:0
    v_mfma_f32_16x16x32_bf16 v[52:55], v[224:227], v[120:123], v[52:55]
    ds_read_b64_tr_b16 v[202:203], v7 offset:512
    v_mfma_f32_16x16x32_bf16 v[60:63], v[224:227], v[128:131], v[60:63]
    ds_read_b64_tr_b16 v[204:205], v7 offset:12288
    v_mfma_f32_16x16x32_bf16 v[60:63], v[228:231], v[132:135], v[60:63]
    ds_read_b64_tr_b16 v[206:207], v7 offset:12800
    v_mfma_f32_16x16x32_bf16 v[68:71], v[228:231], v[140:143], v[68:71]
    ds_read_b128 v[176:179], v4 offset:22528
    v_mfma_f32_16x16x32_bf16 v[68:71], v[224:227], v[136:139], v[68:71]
    ds_read_b128 v[180:183], v5 offset:22528
    v_mfma_f32_16x16x32_bf16 v[76:79], v[224:227], v[144:147], v[76:79]
    ds_read_b128 v[168:171], v4 offset:20480
    v_mfma_f32_16x16x32_bf16 v[76:79], v[228:231], v[148:151], v[76:79]
    s_waitcnt lgkmcnt(11)
    v_mfma_f32_16x16x32_bf16 v[40:43], v[236:239], v[148:151], v[40:43]
    ds_read_b64_tr_b16 v[224:225], v6 offset:2048
    v_mfma_f32_16x16x32_bf16 v[40:43], v[232:235], v[144:147], v[40:43]
    ds_read_b64_tr_b16 v[226:227], v6 offset:2560
    v_mfma_f32_16x16x32_bf16 v[32:35], v[232:235], v[136:139], v[32:35]
    ds_read_b64_tr_b16 v[228:229], v6 offset:14336
    v_mfma_f32_16x16x32_bf16 v[32:35], v[236:239], v[140:143], v[32:35]
    ds_read_b64_tr_b16 v[230:231], v6 offset:14848
    v_mfma_f32_16x16x32_bf16 v[24:27], v[236:239], v[132:135], v[24:27]
    ds_read_b128 v[172:175], v5 offset:20480
    v_mfma_f32_16x16x32_bf16 v[24:27], v[232:235], v[128:131], v[24:27]
    ds_read_b128 v[160:163], v4 offset:18432
    v_mfma_f32_16x16x32_bf16 v[16:19], v[232:235], v[120:123], v[16:19]
    ds_read_b128 v[164:167], v5 offset:18432
    v_mfma_f32_16x16x32_bf16 v[16:19], v[236:239], v[124:127], v[16:19]
    s_waitcnt lgkmcnt(10)
    v_mfma_f32_16x16x32_bf16 v[20:23], v[204:207], v[124:127], v[20:23]
    ds_read_b64_tr_b16 v[232:233], v7 offset:2048
    v_mfma_f32_16x16x32_bf16 v[20:23], v[200:203], v[120:123], v[20:23]
    ds_read_b64_tr_b16 v[234:235], v7 offset:2560
    v_mfma_f32_16x16x32_bf16 v[28:31], v[200:203], v[128:131], v[28:31]
    ds_read_b64_tr_b16 v[236:237], v7 offset:14336
    v_mfma_f32_16x16x32_bf16 v[28:31], v[204:207], v[132:135], v[28:31]
    ds_read_b64_tr_b16 v[238:239], v7 offset:14848
    v_mfma_f32_16x16x32_bf16 v[36:39], v[204:207], v[140:143], v[36:39]
    v_mfma_f32_16x16x32_bf16 v[36:39], v[200:203], v[136:139], v[36:39]
    v_mfma_f32_16x16x32_bf16 v[44:47], v[200:203], v[144:147], v[44:47]
    v_mfma_f32_16x16x32_bf16 v[44:47], v[204:207], v[148:151], v[44:47]
    s_waitcnt lgkmcnt(7)
    v_mfma_f32_16x16x32_bf16 v[116:119], v[156:159], v[228:231], v[116:119]
    v_mfma_f32_16x16x32_bf16 v[116:119], v[152:155], v[224:227], v[116:119]
    v_mfma_f32_16x16x32_bf16 v[104:107], v[144:147], v[224:227], v[104:107]
    v_mfma_f32_16x16x32_bf16 v[104:107], v[148:151], v[228:231], v[104:107]
    v_mfma_f32_16x16x32_bf16 v[96:99], v[140:143], v[228:231], v[96:99]
    v_mfma_f32_16x16x32_bf16 v[96:99], v[136:139], v[224:227], v[96:99]
    s_waitcnt lgkmcnt(0)
    s_barrier
    v_mfma_f32_16x16x32_bf16 v[88:91], v[128:131], v[224:227], v[88:91]
    ds_read_b64_tr_b16 v[200:201], v6 offset:25600
    v_mfma_f32_16x16x32_bf16 v[88:91], v[132:135], v[228:231], v[88:91]
    ds_read_b64_tr_b16 v[202:203], v6 offset:26112
    v_mfma_f32_16x16x32_bf16 v[80:83], v[124:127], v[228:231], v[80:83]
    ds_read_b64_tr_b16 v[204:205], v6 offset:37888
    v_mfma_f32_16x16x32_bf16 v[80:83], v[120:123], v[224:227], v[80:83]
    ds_read_b64_tr_b16 v[206:207], v6 offset:38400
    v_mfma_f32_16x16x32_bf16 v[84:87], v[120:123], v[232:235], v[84:87]
    ds_read_b64_tr_b16 v[224:225], v7 offset:25600
    v_mfma_f32_16x16x32_bf16 v[84:87], v[124:127], v[236:239], v[84:87]
    ds_read_b64_tr_b16 v[226:227], v7 offset:26112
    v_mfma_f32_16x16x32_bf16 v[92:95], v[132:135], v[236:239], v[92:95]
    ds_read_b64_tr_b16 v[228:229], v7 offset:37888
    v_mfma_f32_16x16x32_bf16 v[92:95], v[128:131], v[232:235], v[92:95]
    ds_read_b64_tr_b16 v[230:231], v7 offset:38400
    v_mfma_f32_16x16x32_bf16 v[100:103], v[136:139], v[232:235], v[100:103]
    v_mfma_f32_16x16x32_bf16 v[100:103], v[140:143], v[236:239], v[100:103]
    v_mfma_f32_16x16x32_bf16 v[108:111], v[148:151], v[236:239], v[108:111]
    v_mfma_f32_16x16x32_bf16 v[108:111], v[144:147], v[232:235], v[108:111]
    s_waitcnt lgkmcnt(4)
    v_mfma_f32_16x16x32_bf16 v[112:115], v[200:203], v[192:195], v[112:115]
    ds_read_b64_tr_b16 v[232:233], v6 offset:24576
    v_mfma_f32_16x16x32_bf16 v[112:115], v[204:207], v[196:199], v[112:115]
    ds_read_b64_tr_b16 v[234:235], v6 offset:25088
    v_mfma_f32_16x16x32_bf16 v[72:75], v[204:207], v[188:191], v[72:75]
    ds_read_b64_tr_b16 v[236:237], v6 offset:36864
    v_mfma_f32_16x16x32_bf16 v[72:75], v[200:203], v[184:187], v[72:75]
    ds_read_b64_tr_b16 v[238:239], v6 offset:37376
    v_mfma_f32_16x16x32_bf16 v[64:67], v[200:203], v[176:179], v[64:67]
    ds_read_b128 v[152:155], v2 offset:36864
    v_mfma_f32_16x16x32_bf16 v[64:67], v[204:207], v[180:183], v[64:67]
    ds_read_b128 v[156:159], v3 offset:36864
    v_mfma_f32_16x16x32_bf16 v[56:59], v[204:207], v[172:175], v[56:59]
    ds_read_b128 v[144:147], v4 offset:43008
    v_mfma_f32_16x16x32_bf16 v[56:59], v[200:203], v[168:171], v[56:59]
    ds_read_b128 v[148:151], v5 offset:43008
    v_mfma_f32_16x16x32_bf16 v[48:51], v[200:203], v[160:163], v[48:51]
    v_mfma_f32_16x16x32_bf16 v[48:51], v[204:207], v[164:167], v[48:51]
    s_waitcnt lgkmcnt(8)
    v_mfma_f32_16x16x32_bf16 v[52:55], v[228:231], v[164:167], v[52:55]
    ds_read_b64_tr_b16 v[200:201], v7 offset:24576
    v_mfma_f32_16x16x32_bf16 v[52:55], v[224:227], v[160:163], v[52:55]
    ds_read_b64_tr_b16 v[202:203], v7 offset:25088
    v_mfma_f32_16x16x32_bf16 v[60:63], v[224:227], v[168:171], v[60:63]
    ds_read_b64_tr_b16 v[204:205], v7 offset:36864
    v_mfma_f32_16x16x32_bf16 v[60:63], v[228:231], v[172:175], v[60:63]
    ds_read_b64_tr_b16 v[206:207], v7 offset:37376
    v_mfma_f32_16x16x32_bf16 v[68:71], v[228:231], v[180:183], v[68:71]
    ds_read_b128 v[136:139], v4 offset:40960
    v_mfma_f32_16x16x32_bf16 v[68:71], v[224:227], v[176:179], v[68:71]
    ds_read_b128 v[140:143], v5 offset:40960
    v_mfma_f32_16x16x32_bf16 v[76:79], v[224:227], v[184:187], v[76:79]
    ds_read_b128 v[128:131], v4 offset:38912
    v_mfma_f32_16x16x32_bf16 v[76:79], v[228:231], v[188:191], v[76:79]
    s_waitcnt lgkmcnt(11)
    v_mfma_f32_16x16x32_bf16 v[40:43], v[236:239], v[188:191], v[40:43]
    ds_read_b64_tr_b16 v[224:225], v6 offset:26624
    v_mfma_f32_16x16x32_bf16 v[40:43], v[232:235], v[184:187], v[40:43]
    ds_read_b64_tr_b16 v[226:227], v6 offset:27136
    v_mfma_f32_16x16x32_bf16 v[32:35], v[232:235], v[176:179], v[32:35]
    ds_read_b64_tr_b16 v[228:229], v6 offset:38912
    v_mfma_f32_16x16x32_bf16 v[32:35], v[236:239], v[180:183], v[32:35]
    ds_read_b64_tr_b16 v[230:231], v6 offset:39424
    v_mfma_f32_16x16x32_bf16 v[24:27], v[236:239], v[172:175], v[24:27]
    ds_read_b128 v[132:135], v5 offset:38912
    v_mfma_f32_16x16x32_bf16 v[24:27], v[232:235], v[168:171], v[24:27]
    ds_read_b128 v[120:123], v4 offset:36864
    v_mfma_f32_16x16x32_bf16 v[16:19], v[232:235], v[160:163], v[16:19]
    ds_read_b128 v[124:127], v5 offset:36864
    v_mfma_f32_16x16x32_bf16 v[16:19], v[236:239], v[164:167], v[16:19]
    s_waitcnt lgkmcnt(10)
    v_mfma_f32_16x16x32_bf16 v[20:23], v[204:207], v[164:167], v[20:23]
    ds_read_b64_tr_b16 v[232:233], v7 offset:26624
    v_mfma_f32_16x16x32_bf16 v[20:23], v[200:203], v[160:163], v[20:23]
    ds_read_b64_tr_b16 v[234:235], v7 offset:27136
    v_mfma_f32_16x16x32_bf16 v[28:31], v[200:203], v[168:171], v[28:31]
    ds_read_b64_tr_b16 v[236:237], v7 offset:38912
    v_mfma_f32_16x16x32_bf16 v[28:31], v[204:207], v[172:175], v[28:31]
    ds_read_b64_tr_b16 v[238:239], v7 offset:39424
    v_mfma_f32_16x16x32_bf16 v[36:39], v[204:207], v[180:183], v[36:39]
    buffer_load_dword v222, v220, s[68:71], s98 offen sc1
    v_mfma_f32_16x16x32_bf16 v[36:39], v[200:203], v[176:179], v[36:39]
    v_mfma_f32_16x16x32_bf16 v[44:47], v[200:203], v[184:187], v[44:47]
    v_mfma_f32_16x16x32_bf16 v[44:47], v[204:207], v[188:191], v[44:47]
    s_waitcnt lgkmcnt(7)
    v_mfma_f32_16x16x32_bf16 v[116:119], v[196:199], v[228:231], v[116:119]
    v_mfma_f32_16x16x32_bf16 v[116:119], v[192:195], v[224:227], v[116:119]
    v_mfma_f32_16x16x32_bf16 v[104:107], v[184:187], v[224:227], v[104:107]
    v_mfma_f32_16x16x32_bf16 v[104:107], v[188:191], v[228:231], v[104:107]
    v_mfma_f32_16x16x32_bf16 v[96:99], v[180:183], v[228:231], v[96:99]
    v_mfma_f32_16x16x32_bf16 v[96:99], v[176:179], v[224:227], v[96:99]
    s_waitcnt lgkmcnt(0)
    s_barrier
    v_mfma_f32_16x16x32_bf16 v[88:91], v[168:171], v[224:227], v[88:91]
    ds_read_b64_tr_b16 v[200:201], v6 offset:50176
    v_mfma_f32_16x16x32_bf16 v[88:91], v[172:175], v[228:231], v[88:91]
    ds_read_b64_tr_b16 v[202:203], v6 offset:50688
    v_mfma_f32_16x16x32_bf16 v[80:83], v[164:167], v[228:231], v[80:83]
    ds_read_b64_tr_b16 v[204:205], v6 offset:62464
    v_mfma_f32_16x16x32_bf16 v[80:83], v[160:163], v[224:227], v[80:83]
    ds_read_b64_tr_b16 v[206:207], v6 offset:62976
    v_mfma_f32_16x16x32_bf16 v[84:87], v[160:163], v[232:235], v[84:87]
    ds_read_b64_tr_b16 v[224:225], v7 offset:50176
    v_mfma_f32_16x16x32_bf16 v[84:87], v[164:167], v[236:239], v[84:87]
    ds_read_b64_tr_b16 v[226:227], v7 offset:50688
    v_mfma_f32_16x16x32_bf16 v[92:95], v[172:175], v[236:239], v[92:95]
    ds_read_b64_tr_b16 v[228:229], v7 offset:62464
    v_mfma_f32_16x16x32_bf16 v[92:95], v[168:171], v[232:235], v[92:95]
    ds_read_b64_tr_b16 v[230:231], v7 offset:62976
    v_mfma_f32_16x16x32_bf16 v[100:103], v[176:179], v[232:235], v[100:103]
    v_mfma_f32_16x16x32_bf16 v[100:103], v[180:183], v[236:239], v[100:103]
    v_mfma_f32_16x16x32_bf16 v[108:111], v[188:191], v[236:239], v[108:111]
    v_mfma_f32_16x16x32_bf16 v[108:111], v[184:187], v[232:235], v[108:111]
    s_waitcnt lgkmcnt(4)
    v_mfma_f32_16x16x32_bf16 v[112:115], v[200:203], v[152:155], v[112:115]
    ds_read_b64_tr_b16 v[232:233], v6 offset:49152
    v_mfma_f32_16x16x32_bf16 v[112:115], v[204:207], v[156:159], v[112:115]
    ds_read_b64_tr_b16 v[234:235], v6 offset:49664
    v_mfma_f32_16x16x32_bf16 v[72:75], v[204:207], v[148:151], v[72:75]
    ds_read_b64_tr_b16 v[236:237], v6 offset:61440
    v_mfma_f32_16x16x32_bf16 v[72:75], v[200:203], v[144:147], v[72:75]
    ds_read_b64_tr_b16 v[238:239], v6 offset:61952
    v_mfma_f32_16x16x32_bf16 v[64:67], v[200:203], v[136:139], v[64:67]
    ds_read_b128 v[192:195], v2 offset:0
    v_mfma_f32_16x16x32_bf16 v[64:67], v[204:207], v[140:143], v[64:67]
    ds_read_b128 v[196:199], v3 offset:0
    v_mfma_f32_16x16x32_bf16 v[56:59], v[204:207], v[132:135], v[56:59]
    ds_read_b128 v[184:187], v4 offset:6144
    v_mfma_f32_16x16x32_bf16 v[56:59], v[200:203], v[128:131], v[56:59]
    ds_read_b128 v[188:191], v5 offset:6144
    v_mfma_f32_16x16x32_bf16 v[48:51], v[200:203], v[120:123], v[48:51]
    v_mfma_f32_16x16x32_bf16 v[48:51], v[204:207], v[124:127], v[48:51]
    s_waitcnt lgkmcnt(8)
    v_mfma_f32_16x16x32_bf16 v[52:55], v[228:231], v[124:127], v[52:55]
    ds_read_b64_tr_b16 v[200:201], v7 offset:49152
    v_mfma_f32_16x16x32_bf16 v[52:55], v[224:227], v[120:123], v[52:55]
    ds_read_b64_tr_b16 v[202:203], v7 offset:49664
    v_mfma_f32_16x16x32_bf16 v[60:63], v[224:227], v[128:131], v[60:63]
    ds_read_b64_tr_b16 v[204:205], v7 offset:61440
    v_mfma_f32_16x16x32_bf16 v[60:63], v[228:231], v[132:135], v[60:63]
    ds_read_b64_tr_b16 v[206:207], v7 offset:61952
    v_mfma_f32_16x16x32_bf16 v[68:71], v[228:231], v[140:143], v[68:71]
    ds_read_b128 v[176:179], v4 offset:4096
    v_mfma_f32_16x16x32_bf16 v[68:71], v[224:227], v[136:139], v[68:71]
    ds_read_b128 v[180:183], v5 offset:4096
    v_mfma_f32_16x16x32_bf16 v[76:79], v[224:227], v[144:147], v[76:79]
    ds_read_b128 v[168:171], v4 offset:2048
    v_mfma_f32_16x16x32_bf16 v[76:79], v[228:231], v[148:151], v[76:79]
    s_waitcnt lgkmcnt(11)
    v_mfma_f32_16x16x32_bf16 v[40:43], v[236:239], v[148:151], v[40:43]
    ds_read_b64_tr_b16 v[224:225], v6 offset:51200
    v_mfma_f32_16x16x32_bf16 v[40:43], v[232:235], v[144:147], v[40:43]
    ds_read_b64_tr_b16 v[226:227], v6 offset:51712
    v_mfma_f32_16x16x32_bf16 v[32:35], v[232:235], v[136:139], v[32:35]
    ds_read_b64_tr_b16 v[228:229], v6 offset:63488
    v_mfma_f32_16x16x32_bf16 v[32:35], v[236:239], v[140:143], v[32:35]
    ds_read_b64_tr_b16 v[230:231], v6 offset:64000
    v_mfma_f32_16x16x32_bf16 v[24:27], v[236:239], v[132:135], v[24:27]
    ds_read_b128 v[172:175], v5 offset:2048
    v_mfma_f32_16x16x32_bf16 v[24:27], v[232:235], v[128:131], v[24:27]
    ds_read_b128 v[160:163], v4 offset:0
    v_mfma_f32_16x16x32_bf16 v[16:19], v[232:235], v[120:123], v[16:19]
    ds_read_b128 v[164:167], v5 offset:0
    v_mfma_f32_16x16x32_bf16 v[16:19], v[236:239], v[124:127], v[16:19]
    s_waitcnt lgkmcnt(10)
    v_mfma_f32_16x16x32_bf16 v[20:23], v[204:207], v[124:127], v[20:23]
    ds_read_b64_tr_b16 v[232:233], v7 offset:51200
    v_mfma_f32_16x16x32_bf16 v[20:23], v[200:203], v[120:123], v[20:23]
    ds_read_b64_tr_b16 v[234:235], v7 offset:51712
    v_mfma_f32_16x16x32_bf16 v[28:31], v[200:203], v[128:131], v[28:31]
    ds_read_b64_tr_b16 v[236:237], v7 offset:63488
    v_mfma_f32_16x16x32_bf16 v[28:31], v[204:207], v[132:135], v[28:31]
    ds_read_b64_tr_b16 v[238:239], v7 offset:64000
    v_mfma_f32_16x16x32_bf16 v[36:39], v[204:207], v[140:143], v[36:39]
    v_mfma_f32_16x16x32_bf16 v[36:39], v[200:203], v[136:139], v[36:39]
    v_mfma_f32_16x16x32_bf16 v[44:47], v[200:203], v[144:147], v[44:47]
    v_mfma_f32_16x16x32_bf16 v[44:47], v[204:207], v[148:151], v[44:47]
    s_waitcnt lgkmcnt(7)
    v_mfma_f32_16x16x32_bf16 v[116:119], v[156:159], v[228:231], v[116:119]
    v_mfma_f32_16x16x32_bf16 v[116:119], v[152:155], v[224:227], v[116:119]
    v_mfma_f32_16x16x32_bf16 v[104:107], v[144:147], v[224:227], v[104:107]
    v_mfma_f32_16x16x32_bf16 v[104:107], v[148:151], v[228:231], v[104:107]
    v_mfma_f32_16x16x32_bf16 v[96:99], v[140:143], v[228:231], v[96:99]
    v_mfma_f32_16x16x32_bf16 v[96:99], v[136:139], v[224:227], v[96:99]
    s_waitcnt lgkmcnt(0)
    s_barrier
    v_mfma_f32_16x16x32_bf16 v[88:91], v[128:131], v[224:227], v[88:91]
    ds_read_b64_tr_b16 v[200:201], v6 offset:1024
    v_mfma_f32_16x16x32_bf16 v[88:91], v[132:135], v[228:231], v[88:91]
    ds_read_b64_tr_b16 v[202:203], v6 offset:1536
    v_mfma_f32_16x16x32_bf16 v[80:83], v[124:127], v[228:231], v[80:83]
    ds_read_b64_tr_b16 v[204:205], v6 offset:13312
    v_mfma_f32_16x16x32_bf16 v[80:83], v[120:123], v[224:227], v[80:83]
    ds_read_b64_tr_b16 v[206:207], v6 offset:13824
    v_mfma_f32_16x16x32_bf16 v[84:87], v[120:123], v[232:235], v[84:87]
    ds_read_b64_tr_b16 v[224:225], v7 offset:1024
    v_mfma_f32_16x16x32_bf16 v[84:87], v[124:127], v[236:239], v[84:87]
    ds_read_b64_tr_b16 v[226:227], v7 offset:1536
    v_mfma_f32_16x16x32_bf16 v[92:95], v[132:135], v[236:239], v[92:95]
    ds_read_b64_tr_b16 v[228:229], v7 offset:13312
    v_mfma_f32_16x16x32_bf16 v[92:95], v[128:131], v[232:235], v[92:95]
    ds_read_b64_tr_b16 v[230:231], v7 offset:13824
    v_mfma_f32_16x16x32_bf16 v[100:103], v[136:139], v[232:235], v[100:103]
    v_mfma_f32_16x16x32_bf16 v[100:103], v[140:143], v[236:239], v[100:103]
    v_mfma_f32_16x16x32_bf16 v[108:111], v[148:151], v[236:239], v[108:111]
    v_mfma_f32_16x16x32_bf16 v[108:111], v[144:147], v[232:235], v[108:111]
    s_waitcnt lgkmcnt(4)
    v_mfma_f32_16x16x32_bf16 v[112:115], v[200:203], v[192:195], v[112:115]
    ds_read_b64_tr_b16 v[232:233], v6 offset:0
    v_mfma_f32_16x16x32_bf16 v[112:115], v[204:207], v[196:199], v[112:115]
    ds_read_b64_tr_b16 v[234:235], v6 offset:512
    v_mfma_f32_16x16x32_bf16 v[72:75], v[204:207], v[188:191], v[72:75]
    ds_read_b64_tr_b16 v[236:237], v6 offset:12288
    v_mfma_f32_16x16x32_bf16 v[72:75], v[200:203], v[184:187], v[72:75]
    ds_read_b64_tr_b16 v[238:239], v6 offset:12800
    v_mfma_f32_16x16x32_bf16 v[64:67], v[200:203], v[176:179], v[64:67]
    ds_read_b128 v[152:155], v2 offset:18432
    v_mfma_f32_16x16x32_bf16 v[64:67], v[204:207], v[180:183], v[64:67]
    ds_read_b128 v[156:159], v3 offset:18432
    v_mfma_f32_16x16x32_bf16 v[56:59], v[204:207], v[172:175], v[56:59]
    ds_read_b128 v[144:147], v4 offset:24576
    v_mfma_f32_16x16x32_bf16 v[56:59], v[200:203], v[168:171], v[56:59]
    ds_read_b128 v[148:151], v5 offset:24576
    v_mfma_f32_16x16x32_bf16 v[48:51], v[200:203], v[160:163], v[48:51]
    v_mfma_f32_16x16x32_bf16 v[48:51], v[204:207], v[164:167], v[48:51]
    s_waitcnt lgkmcnt(8)
    v_mfma_f32_16x16x32_bf16 v[52:55], v[228:231], v[164:167], v[52:55]
    ds_read_b64_tr_b16 v[200:201], v7 offset:0
    v_mfma_f32_16x16x32_bf16 v[52:55], v[224:227], v[160:163], v[52:55]
    ds_read_b64_tr_b16 v[202:203], v7 offset:512
    v_mfma_f32_16x16x32_bf16 v[60:63], v[224:227], v[168:171], v[60:63]
    ds_read_b64_tr_b16 v[204:205], v7 offset:12288
    v_mfma_f32_16x16x32_bf16 v[60:63], v[228:231], v[172:175], v[60:63]
    ds_read_b64_tr_b16 v[206:207], v7 offset:12800
    v_mfma_f32_16x16x32_bf16 v[68:71], v[228:231], v[180:183], v[68:71]
    ds_read_b128 v[136:139], v4 offset:22528
    v_mfma_f32_16x16x32_bf16 v[68:71], v[224:227], v[176:179], v[68:71]
    ds_read_b128 v[140:143], v5 offset:22528
    v_mfma_f32_16x16x32_bf16 v[76:79], v[224:227], v[184:187], v[76:79]
    ds_read_b128 v[128:131], v4 offset:20480
    v_mfma_f32_16x16x32_bf16 v[76:79], v[228:231], v[188:191], v[76:79]
    s_waitcnt lgkmcnt(11)
    v_mfma_f32_16x16x32_bf16 v[40:43], v[236:239], v[188:191], v[40:43]
    ds_read_b64_tr_b16 v[224:225], v6 offset:2048
    v_mfma_f32_16x16x32_bf16 v[40:43], v[232:235], v[184:187], v[40:43]
    ds_read_b64_tr_b16 v[226:227], v6 offset:2560
    v_mfma_f32_16x16x32_bf16 v[32:35], v[232:235], v[176:179], v[32:35]
    ds_read_b64_tr_b16 v[228:229], v6 offset:14336
    v_mfma_f32_16x16x32_bf16 v[32:35], v[236:239], v[180:183], v[32:35]
    ds_read_b64_tr_b16 v[230:231], v6 offset:14848
    v_mfma_f32_16x16x32_bf16 v[24:27], v[236:239], v[172:175], v[24:27]
    ds_read_b128 v[132:135], v5 offset:20480
    v_mfma_f32_16x16x32_bf16 v[24:27], v[232:235], v[168:171], v[24:27]
    ds_read_b128 v[120:123], v4 offset:18432
    v_mfma_f32_16x16x32_bf16 v[16:19], v[232:235], v[160:163], v[16:19]
    ds_read_b128 v[124:127], v5 offset:18432
    v_mfma_f32_16x16x32_bf16 v[16:19], v[236:239], v[164:167], v[16:19]
    s_waitcnt lgkmcnt(10)
    v_mfma_f32_16x16x32_bf16 v[20:23], v[204:207], v[164:167], v[20:23]
    ds_read_b64_tr_b16 v[232:233], v7 offset:2048
    v_mfma_f32_16x16x32_bf16 v[20:23], v[200:203], v[160:163], v[20:23]
    ds_read_b64_tr_b16 v[234:235], v7 offset:2560
    v_mfma_f32_16x16x32_bf16 v[28:31], v[200:203], v[168:171], v[28:31]
    ds_read_b64_tr_b16 v[236:237], v7 offset:14336
    v_mfma_f32_16x16x32_bf16 v[28:31], v[204:207], v[172:175], v[28:31]
    ds_read_b64_tr_b16 v[238:239], v7 offset:14848
    v_mfma_f32_16x16x32_bf16 v[36:39], v[204:207], v[180:183], v[36:39]
    v_mfma_f32_16x16x32_bf16 v[36:39], v[200:203], v[176:179], v[36:39]
    v_mfma_f32_16x16x32_bf16 v[44:47], v[200:203], v[184:187], v[44:47]
    v_mfma_f32_16x16x32_bf16 v[44:47], v[204:207], v[188:191], v[44:47]
    s_waitcnt lgkmcnt(7)
    v_mfma_f32_16x16x32_bf16 v[116:119], v[196:199], v[228:231], v[116:119]
    v_mfma_f32_16x16x32_bf16 v[116:119], v[192:195], v[224:227], v[116:119]
    v_mfma_f32_16x16x32_bf16 v[104:107], v[184:187], v[224:227], v[104:107]
    v_mfma_f32_16x16x32_bf16 v[104:107], v[188:191], v[228:231], v[104:107]
    v_mfma_f32_16x16x32_bf16 v[96:99], v[180:183], v[228:231], v[96:99]
    v_mfma_f32_16x16x32_bf16 v[96:99], v[176:179], v[224:227], v[96:99]
    s_waitcnt lgkmcnt(0)
    s_barrier
    s_cmp_lg_u32 s3, 0
    s_cbranch_scc1 LB_sk
    s_waitcnt vmcnt(0)
    v_cmp_eq_u32 vcc, 0, v222
    s_cbranch_vccnz LB_slow
LB_back:
    s_mov_b64 exec, 1
    buffer_store_dword v222, v220, s[52:55], s96 offen sc1
    s_mov_b64 exec, -1
LB_sk:
    v_mfma_f32_16x16x32_bf16 v[88:91], v[168:171], v[224:227], v[88:91]
    ds_read_b64_tr_b16 v[200:201], v6 offset:25600
    v_mfma_f32_16x16x32_bf16 v[88:91], v[172:175], v[228:231], v[88:91]
    ds_read_b64_tr_b16 v[202:203], v6 offset:26112
    v_mfma_f32_16x16x32_bf16 v[80:83], v[164:167], v[228:231], v[80:83]
    ds_read_b64_tr_b16 v[204:205], v6 offset:37888
    v_mfma_f32_16x16x32_bf16 v[80:83], v[160:163], v[224:227], v[80:83]
    ds_read_b64_tr_b16 v[206:207], v6 offset:38400
    v_mfma_f32_16x16x32_bf16 v[84:87], v[160:163], v[232:235], v[84:87]
    ds_read_b64_tr_b16 v[224:225], v7 offset:25600
    v_mfma_f32_16x16x32_bf16 v[84:87], v[164:167], v[236:239], v[84:87]
    ds_read_b64_tr_b16 v[226:227], v7 offset:26112
    v_mfma_f32_16x16x32_bf16 v[92:95], v[172:175], v[236:239], v[92:95]
    ds_read_b64_tr_b16 v[228:229], v7 offset:37888
    v_mfma_f32_16x16x32_bf16 v[92:95], v[168:171], v[232:235], v[92:95]
    ds_read_b64_tr_b16 v[230:231], v7 offset:38400
    v_mfma_f32_16x16x32_bf16 v[100:103], v[176:179], v[232:235], v[100:103]
    v_mfma_f32_16x16x32_bf16 v[100:103], v[180:183], v[236:239], v[100:103]
    v_mfma_f32_16x16x32_bf16 v[108:111], v[188:191], v[236:239], v[108:111]
    v_mfma_f32_16x16x32_bf16 v[108:111], v[184:187], v[232:235], v[108:111]
    s_waitcnt lgkmcnt(4)
    v_mfma_f32_16x16x32_bf16 v[112:115], v[200:203], v[152:155], v[112:115]
    ds_read_b64_tr_b16 v[232:233], v6 offset:24576
    v_mfma_f32_16x16x32_bf16 v[112:115], v[204:207], v[156:159], v[112:115]
    ds_read_b64_tr_b16 v[234:235], v6 offset:25088
    v_mfma_f32_16x16x32_bf16 v[72:75], v[204:207], v[148:151], v[72:75]
    ds_read_b64_tr_b16 v[236:237], v6 offset:36864
    v_mfma_f32_16x16x32_bf16 v[72:75], v[200:203], v[144:147], v[72:75]
    ds_read_b64_tr_b16 v[238:239], v6 offset:37376
    v_mfma_f32_16x16x32_bf16 v[64:67], v[200:203], v[136:139], v[64:67]
    ds_read_b128 v[192:195], v2 offset:36864
    v_mfma_f32_16x16x32_bf16 v[64:67], v[204:207], v[140:143], v[64:67]
    ds_read_b128 v[196:199], v3 offset:36864
    v_mfma_f32_16x16x32_bf16 v[56:59], v[204:207], v[132:135], v[56:59]
    ds_read_b128 v[184:187], v4 offset:43008
    v_mfma_f32_16x16x32_bf16 v[56:59], v[200:203], v[128:131], v[56:59]
    ds_read_b128 v[188:191], v5 offset:43008
    v_mfma_f32_16x16x32_bf16 v[48:51], v[200:203], v[120:123], v[48:51]
    v_mfma_f32_16x16x32_bf16 v[48:51], v[204:207], v[124:127], v[48:51]
    s_waitcnt lgkmcnt(8)
    v_mfma_f32_16x16x32_bf16 v[52:55], v[228:231], v[124:127], v[52:55]
    ds_read_b64_tr_b16 v[200:201], v7 offset:24576
    v_mfma_f32_16x16x32_bf16 v[52:55], v[224:227], v[120:123], v[52:55]
    ds_read_b64_tr_b16 v[202:203], v7 offset:25088
    v_mfma_f32_16x16x32_bf16 v[60:63], v[224:227], v[128:131], v[60:63]
    ds_read_b64_tr_b16 v[204:205], v7 offset:36864
    v_mfma_f32_16x16x32_bf16 v[60:63], v[228:231], v[132:135], v[60:63]
    ds_read_b64_tr_b16 v[206:207], v7 offset:37376
    v_mfma_f32_16x16x32_bf16 v[68:71], v[228:231], v[140:143], v[68:71]
    ds_read_b128 v[176:179], v4 offset:40960
    v_mfma_f32_16x16x32_bf16 v[68:71], v[224:227], v[136:139], v[68:71]
    ds_read_b128 v[180:183], v5 offset:40960
    v_mfma_f32_16x16x32_bf16 v[76:79], v[224:227], v[144:147], v[76:79]
    ds_read_b128 v[168:171], v4 offset:38912
    v_mfma_f32_16x16x32_bf16 v[76:79], v[228:231], v[148:151], v[76:79]
    s_waitcnt lgkmcnt(11)
    v_mfma_f32_16x16x32_bf16 v[40:43], v[236:239], v[148:151], v[40:43]
    ds_read_b64_tr_b16 v[224:225], v6 offset:26624
    v_mfma_f32_16x16x32_bf16 v[40:43], v[232:235], v[144:147], v[40:43]
    ds_read_b64_tr_b16 v[226:227], v6 offset:27136
    v_mfma_f32_16x16x32_bf16 v[32:35], v[232:235], v[136:139], v[32:35]
    ds_read_b64_tr_b16 v[228:229], v6 offset:38912
    v_mfma_f32_16x16x32_bf16 v[32:35], v[236:239], v[140:143], v[32:35]
    ds_read_b64_tr_b16 v[230:231], v6 offset:39424
    v_mfma_f32_16x16x32_bf16 v[24:27], v[236:239], v[132:135], v[24:27]
    ds_read_b128 v[172:175], v5 offset:38912
    v_mfma_f32_16x16x32_bf16 v[24:27], v[232:235], v[128:131], v[24:27]
    ds_read_b128 v[160:163], v4 offset:36864
    v_mfma_f32_16x16x32_bf16 v[16:19], v[232:235], v[120:123], v[16:19]
    ds_read_b128 v[164:167], v5 offset:36864
    v_mfma_f32_16x16x32_bf16 v[16:19], v[236:239], v[124:127], v[16:19]
    s_waitcnt lgkmcnt(10)
    v_mfma_f32_16x16x32_bf16 v[20:23], v[204:207], v[124:127], v[20:23]
    ds_read_b64_tr_b16 v[232:233], v7 offset:26624
    v_mfma_f32_16x16x32_bf16 v[20:23], v[200:203], v[120:123], v[20:23]
    ds_read_b64_tr_b16 v[234:235], v7 offset:27136
    v_mfma_f32_16x16x32_bf16 v[28:31], v[200:203], v[128:131], v[28:31]
    ds_read_b64_tr_b16 v[236:237], v7 offset:38912
    v_mfma_f32_16x16x32_bf16 v[28:31], v[204:207], v[132:135], v[28:31]
    ds_read_b64_tr_b16 v[238:239], v7 offset:39424
    v_mfma_f32_16x16x32_bf16 v[36:39], v[204:207], v[140:143], v[36:39]
    v_mfma_f32_16x16x32_bf16 v[36:39], v[200:203], v[136:139], v[36:39]
    v_mfma_f32_16x16x32_bf16 v[44:47], v[200:203], v[144:147], v[44:47]
    v_mfma_f32_16x16x32_bf16 v[44:47], v[204:207], v[148:151], v[44:47]
    s_waitcnt lgkmcnt(7)
    v_mfma_f32_16x16x32_bf16 v[116:119], v[156:159], v[228:231], v[116:119]
    v_mfma_f32_16x16x32_bf16 v[116:119], v[152:155], v[224:227], v[116:119]
    v_mfma_f32_16x16x32_bf16 v[104:107], v[144:147], v[224:227], v[104:107]
    v_mfma_f32_16x16x32_bf16 v[104:107], v[148:151], v[228:231], v[104:107]
    v_mfma_f32_16x16x32_bf16 v[96:99], v[140:143], v[228:231], v[96:99]
    v_mfma_f32_16x16x32_bf16 v[96:99], v[136:139], v[224:227], v[96:99]
    s_waitcnt lgkmcnt(0)
    s_barrier
    v_mfma_f32_16x16x32_bf16 v[88:91], v[128:131], v[224:227], v[88:91]
    ds_read_b64_tr_b16 v[200:201], v6 offset:50176
    v_mfma_f32_16x16x32_bf16 v[88:91], v[132:135], v[228:231], v[88:91]
    ds_read_b64_tr_b16 v[202:203], v6 offset:50688
    v_mfma_f32_16x16x32_bf16 v[80:83], v[124:127], v[228:231], v[80:83]
    ds_read_b64_tr_b16 v[204:205], v6 offset:62464
    v_mfma_f32_16x16x32_bf16 v[80:83], v[120:123], v[224:227], v[80:83]
    ds_read_b64_tr_b16 v[206:207], v6 offset:62976
    v_mfma_f32_16x16x32_bf16 v[84:87], v[120:123], v[232:235], v[84:87]
    ds_read_b64_tr_b16 v[224:225], v7 offset:50176
    v_mfma_f32_16x16x32_bf16 v[84:87], v[124:127], v[236:239], v[84:87]
    ds_read_b64_tr_b16 v[226:227], v7 offset:50688
    v_mfma_f32_16x16x32_bf16 v[92:95], v[132:135], v[236:239], v[92:95]
    ds_read_b64_tr_b16 v[228:229], v7 offset:62464
    v_mfma_f32_16x16x32_bf16 v[92:95], v[128:131], v[232:235], v[92:95]
    ds_read_b64_tr_b16 v[230:231], v7 offset:62976
    v_mfma_f32_16x16x32_bf16 v[100:103], v[136:139], v[232:235], v[100:103]
    v_mfma_f32_16x16x32_bf16 v[100:103], v[140:143], v[236:239], v[100:103]
    v_mfma_f32_16x16x32_bf16 v[108:111], v[148:151], v[236:239], v[108:111]
    v_mfma_f32_16x16x32_bf16 v[108:111], v[144:147], v[232:235], v[108:111]
    s_waitcnt lgkmcnt(4)
    v_mfma_f32_16x16x32_bf16 v[112:115], v[200:203], v[192:195], v[112:115]
    ds_read_b64_tr_b16 v[232:233], v6 offset:49152
    v_mfma_f32_16x16x32_bf16 v[112:115], v[204:207], v[196:199], v[112:115]
    ds_read_b64_tr_b16 v[234:235], v6 offset:49664
    v_mfma_f32_16x16x32_bf16 v[72:75], v[204:207], v[188:191], v[72:75]
    ds_read_b64_tr_b16 v[236:237], v6 offset:61440
    v_mfma_f32_16x16x32_bf16 v[72:75], v[200:203], v[184:187], v[72:75]
    ds_read_b64_tr_b16 v[238:239], v6 offset:61952
    v_mfma_f32_16x16x32_bf16 v[64:67], v[200:203], v[176:179], v[64:67]
    ds_read_b128 v[152:155], v2 offset:0
    v_mfma_f32_16x16x32_bf16 v[64:67], v[204:207], v[180:183], v[64:67]
    ds_read_b128 v[156:159], v3 offset:0
    v_mfma_f32_16x16x32_bf16 v[56:59], v[204:207], v[172:175], v[56:59]
    ds_read_b128 v[144:147], v4 offset:6144
    v_mfma_f32_16x16x32_bf16 v[56:59], v[200:203], v[168:171], v[56:59]
    ds_read_b128 v[148:151], v5 offset:6144
    v_mfma_f32_16x16x32_bf16 v[48:51], v[200:203], v[160:163], v[48:51]
    v_mfma_f32_16x16x32_bf16 v[48:51], v[204:207], v[164:167], v[48:51]
    s_waitcnt lgkmcnt(8)
    v_mfma_f32_16x16x32_bf16 v[52:55], v[228:231], v[164:167], v[52:55]
    ds_read_b64_tr_b16 v[200:201], v7 offset:49152
    v_mfma_f32_16x16x32_bf16 v[52:55], v[224:227], v[160:163], v[52:55]
    ds_read_b64_tr_b16 v[202:203], v7 offset:49664
    v_mfma_f32_16x16x32_bf16 v[60:63], v[224:227], v[168:171], v[60:63]
    ds_read_b64_tr_b16 v[204:205], v7 offset:61440
    v_mfma_f32_16x16x32_bf16 v[60:63], v[228:231], v[172:175], v[60:63]
    ds_read_b64_tr_b16 v[206:207], v7 offset:61952
    v_mfma_f32_16x16x32_bf16 v[68:71], v[228:231], v[180:183], v[68:71]
    ds_read_b128 v[136:139], v4 offset:4096
    v_mfma_f32_16x16x32_bf16 v[68:71], v[224:227], v[176:179], v[68:71]
    ds_read_b128 v[140:143], v5 offset:4096
    v_mfma_f32_16x16x32_bf16 v[76:79], v[224:227], v[184:187], v[76:79]
    ds_read_b128 v[128:131], v4 offset:2048
    v_mfma_f32_16x16x32_bf16 v[76:79], v[228:231], v[188:191], v[76:79]
    s_waitcnt lgkmcnt(11)
    v_mfma_f32_16x16x32_bf16 v[40:43], v[236:239], v[188:191], v[40:43]
    ds_read_b64_tr_b16 v[224:225], v6 offset:51200
    v_mfma_f32_16x16x32_bf16 v[40:43], v[232:235], v[184:187], v[40:43]
    ds_read_b64_tr_b16 v[226:227], v6 offset:51712
    v_mfma_f32_16x16x32_bf16 v[32:35], v[232:235], v[176:179], v[32:35]
    ds_read_b64_tr_b16 v[228:229], v6 offset:63488
    v_mfma_f32_16x16x32_bf16 v[32:35], v[236:239], v[180:183], v[32:35]
    ds_read_b64_tr_b16 v[230:231], v6 offset:64000
    v_mfma_f32_16x16x32_bf16 v[24:27], v[236:239], v[172:175], v[24:27]
    ds_read_b128 v[132:135], v5 offset:2048
    v_mfma_f32_16x16x32_bf16 v[24:27], v[232:235], v[168:171], v[24:27]
    ds_read_b128 v[120:123], v4 offset:0
    v_mfma_f32_16x16x32_bf16 v[16:19], v[232:235], v[160:163], v[16:19]
    ds_read_b128 v[124:127], v5 offset:0
    v_mfma_f32_16x16x32_bf16 v[16:19], v[236:239], v[164:167], v[16:19]
    s_waitcnt lgkmcnt(10)
    v_mfma_f32_16x16x32_bf16 v[20:23], v[204:207], v[164:167], v[20:23]
    ds_read_b64_tr_b16 v[232:233], v7 offset:51200
    v_mfma_f32_16x16x32_bf16 v[20:23], v[200:203], v[160:163], v[20:23]
    ds_read_b64_tr_b16 v[234:235], v7 offset:51712
    v_mfma_f32_16x16x32_bf16 v[28:31], v[200:203], v[168:171], v[28:31]
    ds_read_b64_tr_b16 v[236:237], v7 offset:63488
    v_mfma_f32_16x16x32_bf16 v[28:31], v[204:207], v[172:175], v[28:31]
    ds_read_b64_tr_b16 v[238:239], v7 offset:64000
    v_mfma_f32_16x16x32_bf16 v[36:39], v[204:207], v[180:183], v[36:39]
    v_mfma_f32_16x16x32_bf16 v[36:39], v[200:203], v[176:179], v[36:39]
    v_mfma_f32_16x16x32_bf16 v[44:47], v[200:203], v[184:187], v[44:47]
    v_mfma_f32_16x16x32_bf16 v[44:47], v[204:207], v[188:191], v[44:47]
    s_waitcnt lgkmcnt(7)
    v_mfma_f32_16x16x32_bf16 v[116:119], v[196:199], v[228:231], v[116:119]
    v_mfma_f32_16x16x32_bf16 v[116:119], v[192:195], v[224:227], v[116:119]
    v_mfma_f32_16x16x32_bf16 v[104:107], v[184:187], v[224:227], v[104:107]
    v_mfma_f32_16x16x32_bf16 v[104:107], v[188:191], v[228:231], v[104:107]
    v_mfma_f32_16x16x32_bf16 v[96:99], v[180:183], v[228:231], v[96:99]
    v_mfma_f32_16x16x32_bf16 v[96:99], v[176:179], v[224:227], v[96:99]
    s_waitcnt lgkmcnt(0)
    s_barrier
    v_mfma_f32_16x16x32_bf16 v[88:91], v[168:171], v[224:227], v[88:91]
    ds_read_b64_tr_b16 v[200:201], v6 offset:1024
    v_mfma_f32_16x16x32_bf16 v[88:91], v[172:175], v[228:231], v[88:91]
    ds_read_b64_tr_b16 v[202:203], v6 offset:1536
    v_mfma_f32_16x16x32_bf16 v[80:83], v[164:167], v[228:231], v[80:83]
    ds_read_b64_tr_b16 v[204:205], v6 offset:13312
    v_mfma_f32_16x16x32_bf16 v[80:83], v[160:163], v[224:227], v[80:83]
    ds_read_b64_tr_b16 v[206:207], v6 offset:13824
    v_mfma_f32_16x16x32_bf16 v[84:87], v[160:163], v[232:235], v[84:87]
    ds_read_b64_tr_b16 v[224:225], v7 offset:1024
    v_mfma_f32_16x16x32_bf16 v[84:87], v[164:167], v[236:239], v[84:87]
    ds_read_b64_tr_b16 v[226:227], v7 offset:1536
    v_mfma_f32_16x16x32_bf16 v[92:95], v[172:175], v[236:239], v[92:95]
    ds_read_b64_tr_b16 v[228:229], v7 offset:13312
    v_mfma_f32_16x16x32_bf16 v[92:95], v[168:171], v[232:235], v[92:95]
    ds_read_b64_tr_b16 v[230:231], v7 offset:13824
    v_mfma_f32_16x16x32_bf16 v[100:103], v[176:179], v[232:235], v[100:103]
    v_mfma_f32_16x16x32_bf16 v[100:103], v[180:183], v[236:239], v[100:103]
    v_mfma_f32_16x16x32_bf16 v[108:111], v[188:191], v[236:239], v[108:111]
    v_mfma_f32_16x16x32_bf16 v[108:111], v[184:187], v[232:235], v[108:111]
    s_waitcnt lgkmcnt(4)
    v_mfma_f32_16x16x32_bf16 v[112:115], v[200:203], v[152:155], v[112:115]
    ds_read_b64_tr_b16 v[232:233], v6 offset:0
    v_mfma_f32_16x16x32_bf16 v[112:115], v[204:207], v[156:159], v[112:115]
    ds_read_b64_tr_b16 v[234:235], v6 offset:512
    v_mfma_f32_16x16x32_bf16 v[72:75], v[204:207], v[148:151], v[72:75]
    ds_read_b64_tr_b16 v[236:237], v6 offset:12288
    v_mfma_f32_16x16x32_bf16 v[72:75], v[200:203], v[144:147], v[72:75]
    ds_read_b64_tr_b16 v[238:239], v6 offset:12800
    v_mfma_f32_16x16x32_bf16 v[64:67], v[200:203], v[136:139], v[64:67]
    ds_read_b128 v[192:195], v2 offset:18432
    v_mfma_f32_16x16x32_bf16 v[64:67], v[204:207], v[140:143], v[64:67]
    ds_read_b128 v[196:199], v3 offset:18432
    v_mfma_f32_16x16x32_bf16 v[56:59], v[204:207], v[132:135], v[56:59]
    ds_read_b128 v[184:187], v4 offset:24576
    v_mfma_f32_16x16x32_bf16 v[56:59], v[200:203], v[128:131], v[56:59]
    ds_read_b128 v[188:191], v5 offset:24576
    v_mfma_f32_16x16x32_bf16 v[48:51], v[200:203], v[120:123], v[48:51]
    v_mfma_f32_16x16x32_bf16 v[48:51], v[204:207], v[124:127], v[48:51]
    s_waitcnt lgkmcnt(8)
    v_mfma_f32_16x16x32_bf16 v[52:55], v[228:231], v[124:127], v[52:55]
    ds_read_b64_tr_b16 v[200:201], v7 offset:0
    v_mfma_f32_16x16x32_bf16 v[52:55], v[224:227], v[120:123], v[52:55]
    ds_read_b64_tr_b16 v[202:203], v7 offset:512
    v_mfma_f32_16x16x32_bf16 v[60:63], v[224:227], v[128:131], v[60:63]
    ds_read_b64_tr_b16 v[204:205], v7 offset:12288
    v_mfma_f32_16x16x32_bf16 v[60:63], v[228:231], v[132:135], v[60:63]
    ds_read_b64_tr_b16 v[206:207], v7 offset:12800
    v_mfma_f32_16x16x32_bf16 v[68:71], v[228:231], v[140:143], v[68:71]
    ds_read_b128 v[176:179], v4 offset:22528
    v_mfma_f32_16x16x32_bf16 v[68:71], v[224:227], v[136:139], v[68:71]
    ds_read_b128 v[180:183], v5 offset:22528
    v_mfma_f32_16x16x32_bf16 v[76:79], v[224:227], v[144:147], v[76:79]
    ds_read_b128 v[168:171], v4 offset:20480
    v_mfma_f32_16x16x32_bf16 v[76:79], v[228:231], v[148:151], v[76:79]
    s_waitcnt lgkmcnt(11)
    v_mfma_f32_16x16x32_bf16 v[40:43], v[236:239], v[148:151], v[40:43]
    ds_read_b64_tr_b16 v[224:225], v6 offset:2048
    v_mfma_f32_16x16x32_bf16 v[40:43], v[232:235], v[144:147], v[40:43]
    ds_read_b64_tr_b16 v[226:227], v6 offset:2560
    v_mfma_f32_16x16x32_bf16 v[32:35], v[232:235], v[136:139], v[32:35]
    ds_read_b64_tr_b16 v[228:229], v6 offset:14336
    v_mfma_f32_16x16x32_bf16 v[32:35], v[236:239], v[140:143], v[32:35]
    ds_read_b64_tr_b16 v[230:231], v6 offset:14848
    v_mfma_f32_16x16x32_bf16 v[24:27], v[236:239], v[132:135], v[24:27]
    ds_read_b128 v[172:175], v5 offset:20480
    v_mfma_f32_16x16x32_bf16 v[24:27], v[232:235], v[128:131], v[24:27]
    ds_read_b128 v[160:163], v4 offset:18432
    v_mfma_f32_16x16x32_bf16 v[16:19], v[232:235], v[120:123], v[16:19]
    ds_read_b128 v[164:167], v5 offset:18432
    v_mfma_f32_16x16x32_bf16 v[16:19], v[236:239], v[124:127], v[16:19]
    s_waitcnt lgkmcnt(10)
    v_mfma_f32_16x16x32_bf16 v[20:23], v[204:207], v[124:127], v[20:23]
    ds_read_b64_tr_b16 v[232:233], v7 offset:2048
    v_mfma_f32_16x16x32_bf16 v[20:23], v[200:203], v[120:123], v[20:23]
    ds_read_b64_tr_b16 v[234:235], v7 offset:2560
    v_mfma_f32_16x16x32_bf16 v[28:31], v[200:203], v[128:131], v[28:31]
    ds_read_b64_tr_b16 v[236:237], v7 offset:14336
    v_mfma_f32_16x16x32_bf16 v[28:31], v[204:207], v[132:135], v[28:31]
    ds_read_b64_tr_b16 v[238:239], v7 offset:14848
    v_mfma_f32_16x16x32_bf16 v[36:39], v[204:207], v[140:143], v[36:39]
    v_mfma_f32_16x16x32_bf16 v[36:39], v[200:203], v[136:139], v[36:39]
    v_mfma_f32_16x16x32_bf16 v[44:47], v[200:203], v[144:147], v[44:47]
    v_mfma_f32_16x16x32_bf16 v[44:47], v[204:207], v[148:151], v[44:47]
    s_waitcnt lgkmcnt(7)
    v_mfma_f32_16x16x32_bf16 v[116:119], v[156:159], v[228:231], v[116:119]
    v_mfma_f32_16x16x32_bf16 v[116:119], v[152:155], v[224:227], v[116:119]
    v_mfma_f32_16x16x32_bf16 v[104:107], v[144:147], v[224:227], v[104:107]
    v_mfma_f32_16x16x32_bf16 v[104:107], v[148:151], v[228:231], v[104:107]
    v_mfma_f32_16x16x32_bf16 v[96:99], v[140:143], v[228:231], v[96:99]
    v_mfma_f32_16x16x32_bf16 v[96:99], v[136:139], v[224:227], v[96:99]
    s_waitcnt lgkmcnt(0)
    s_barrier
    v_mfma_f32_16x16x32_bf16 v[88:91], v[128:131], v[224:227], v[88:91]
    ds_read_b64_tr_b16 v[200:201], v6 offset:25600
    v_mfma_f32_16x16x32_bf16 v[88:91], v[132:135], v[228:231], v[88:91]
    ds_read_b64_tr_b16 v[202:203], v6 offset:26112
    v_mfma_f32_16x16x32_bf16 v[80:83], v[124:127], v[228:231], v[80:83]
    ds_read_b64_tr_b16 v[204:205], v6 offset:37888
    v_mfma_f32_16x16x32_bf16 v[80:83], v[120:123], v[224:227], v[80:83]
    ds_read_b64_tr_b16 v[206:207], v6 offset:38400
    v_mfma_f32_16x16x32_bf16 v[84:87], v[120:123], v[232:235], v[84:87]
    ds_read_b64_tr_b16 v[224:225], v7 offset:25600
    v_mfma_f32_16x16x32_bf16 v[84:87], v[124:127], v[236:239], v[84:87]
    ds_read_b64_tr_b16 v[226:227], v7 offset:26112
    v_mfma_f32_16x16x32_bf16 v[92:95], v[132:135], v[236:239], v[92:95]
    ds_read_b64_tr_b16 v[228:229], v7 offset:37888
    v_mfma_f32_16x16x32_bf16 v[92:95], v[128:131], v[232:235], v[92:95]
    ds_read_b64_tr_b16 v[230:231], v7 offset:38400
    v_mfma_f32_16x16x32_bf16 v[100:103], v[136:139], v[232:235], v[100:103]
    v_mfma_f32_16x16x32_bf16 v[100:103], v[140:143], v[236:239], v[100:103]
    v_mfma_f32_16x16x32_bf16 v[108:111], v[148:151], v[236:239], v[108:111]
    v_mfma_f32_16x16x32_bf16 v[108:111], v[144:147], v[232:235], v[108:111]
    s_waitcnt lgkmcnt(4)
    v_mfma_f32_16x16x32_bf16 v[112:115], v[200:203], v[192:195], v[112:115]
    ds_read_b64_tr_b16 v[232:233], v6 offset:24576
    v_mfma_f32_16x16x32_bf16 v[112:115], v[204:207], v[196:199], v[112:115]
    ds_read_b64_tr_b16 v[234:235], v6 offset:25088
    v_mfma_f32_16x16x32_bf16 v[72:75], v[204:207], v[188:191], v[72:75]
    ds_read_b64_tr_b16 v[236:237], v6 offset:36864
    v_mfma_f32_16x16x32_bf16 v[72:75], v[200:203], v[184:187], v[72:75]
    ds_read_b64_tr_b16 v[238:239], v6 offset:37376
    v_mfma_f32_16x16x32_bf16 v[64:67], v[200:203], v[176:179], v[64:67]
    ds_read_b128 v[152:155], v2 offset:36864
    v_mfma_f32_16x16x32_bf16 v[64:67], v[204:207], v[180:183], v[64:67]
    ds_read_b128 v[156:159], v3 offset:36864
    v_mfma_f32_16x16x32_bf16 v[56:59], v[204:207], v[172:175], v[56:59]
    ds_read_b128 v[144:147], v4 offset:43008
    v_mfma_f32_16x16x32_bf16 v[56:59], v[200:203], v[168:171], v[56:59]
    ds_read_b128 v[148:151], v5 offset:43008
    v_mfma_f32_16x16x32_bf16 v[48:51], v[200:203], v[160:163], v[48:51]
    v_mfma_f32_16x16x32_bf16 v[48:51], v[204:207], v[164:167], v[48:51]
    s_waitcnt lgkmcnt(8)
    v_mfma_f32_16x16x32_bf16 v[52:55], v[228:231], v[164:167], v[52:55]
    ds_read_b64_tr_b16 v[200:201], v7 offset:24576
    v_mfma_f32_16x16x32_bf16 v[52:55], v[224:227], v[160:163], v[52:55]
    ds_read_b64_tr_b16 v[202:203], v7 offset:25088
    v_mfma_f32_16x16x32_bf16 v[60:63], v[224:227], v[168:171], v[60:63]
    ds_read_b64_tr_b16 v[204:205], v7 offset:36864
    v_mfma_f32_16x16x32_bf16 v[60:63], v[228:231], v[172:175], v[60:63]
    ds_read_b64_tr_b16 v[206:207], v7 offset:37376
    v_mfma_f32_16x16x32_bf16 v[68:71], v[228:231], v[180:183], v[68:71]
    ds_read_b128 v[136:139], v4 offset:40960
    v_mfma_f32_16x16x32_bf16 v[68:71], v[224:227], v[176:179], v[68:71]
    ds_read_b128 v[140:143], v5 offset:40960
    v_mfma_f32_16x16x32_bf16 v[76:79], v[224:227], v[184:187], v[76:79]
    ds_read_b128 v[128:131], v4 offset:38912
    v_mfma_f32_16x16x32_bf16 v[76:79], v[228:231], v[188:191], v[76:79]
    s_waitcnt lgkmcnt(11)
    v_mfma_f32_16x16x32_bf16 v[40:43], v[236:239], v[188:191], v[40:43]
    ds_read_b64_tr_b16 v[224:225], v6 offset:26624
    v_mfma_f32_16x16x32_bf16 v[40:43], v[232:235], v[184:187], v[40:43]
    ds_read_b64_tr_b16 v[226:227], v6 offset:27136
    v_mfma_f32_16x16x32_bf16 v[32:35], v[232:235], v[176:179], v[32:35]
    ds_read_b64_tr_b16 v[228:229], v6 offset:38912
    v_mfma_f32_16x16x32_bf16 v[32:35], v[236:239], v[180:183], v[32:35]
    ds_read_b64_tr_b16 v[230:231], v6 offset:39424
    v_mfma_f32_16x16x32_bf16 v[24:27], v[236:239], v[172:175], v[24:27]
    ds_read_b128 v[132:135], v5 offset:38912
    v_mfma_f32_16x16x32_bf16 v[24:27], v[232:235], v[168:171], v[24:27]
    ds_read_b128 v[120:123], v4 offset:36864
    v_mfma_f32_16x16x32_bf16 v[16:19], v[232:235], v[160:163], v[16:19]
    ds_read_b128 v[124:127], v5 offset:36864
    v_mfma_f32_16x16x32_bf16 v[16:19], v[236:239], v[164:167], v[16:19]
    s_waitcnt lgkmcnt(10)
    v_mfma_f32_16x16x32_bf16 v[20:23], v[204:207], v[164:167], v[20:23]
    ds_read_b64_tr_b16 v[232:233], v7 offset:26624
    v_mfma_f32_16x16x32_bf16 v[20:23], v[200:203], v[160:163], v[20:23]
    ds_read_b64_tr_b16 v[234:235], v7 offset:27136
    v_mfma_f32_16x16x32_bf16 v[28:31], v[200:203], v[168:171], v[28:31]
    ds_read_b64_tr_b16 v[236:237], v7 offset:38912
    v_mfma_f32_16x16x32_bf16 v[28:31], v[204:207], v[172:175], v[28:31]
    ds_read_b64_tr_b16 v[238:239], v7 offset:39424
    v_mfma_f32_16x16x32_bf16 v[36:39], v[204:207], v[180:183], v[36:39]
    v_mfma_f32_16x16x32_bf16 v[36:39], v[200:203], v[176:179], v[36:39]
    v_mfma_f32_16x16x32_bf16 v[44:47], v[200:203], v[184:187], v[44:47]
    v_mfma_f32_16x16x32_bf16 v[44:47], v[204:207], v[188:191], v[44:47]
    s_waitcnt lgkmcnt(7)
    v_mfma_f32_16x16x32_bf16 v[116:119], v[196:199], v[228:231], v[116:119]
    v_mfma_f32_16x16x32_bf16 v[116:119], v[192:195], v[224:227], v[116:119]
    v_mfma_f32_16x16x32_bf16 v[104:107], v[184:187], v[224:227], v[104:107]
    v_mfma_f32_16x16x32_bf16 v[104:107], v[188:191], v[228:231], v[104:107]
    v_mfma_f32_16x16x32_bf16 v[96:99], v[180:183], v[228:231], v[96:99]
    v_mfma_f32_16x16x32_bf16 v[96:99], v[176:179], v[224:227], v[96:99]
    s_waitcnt lgkmcnt(0)
    s_barrier
    v_mfma_f32_16x16x32_bf16 v[88:91], v[168:171], v[224:227], v[88:91]
    ds_read_b64_tr_b16 v[200:201], v6 offset:50176
    v_mfma_f32_16x16x32_bf16 v[88:91], v[172:175], v[228:231], v[88:91]
    ds_read_b64_tr_b16 v[202:203], v6 offset:50688
    v_mfma_f32_16x16x32_bf16 v[80:83], v[164:167], v[228:231], v[80:83]
    ds_read_b64_tr_b16 v[204:205], v6 offset:62464
    v_mfma_f32_16x16x32_bf16 v[80:83], v[160:163], v[224:227], v[80:83]
    ds_read_b64_tr_b16 v[206:207], v6 offset:62976
    v_mfma_f32_16x16x32_bf16 v[84:87], v[160:163], v[232:235], v[84:87]
    ds_read_b64_tr_b16 v[224:225], v7 offset:50176
    v_mfma_f32_16x16x32_bf16 v[84:87], v[164:167], v[236:239], v[84:87]
    ds_read_b64_tr_b16 v[226:227], v7 offset:50688
    v_mfma_f32_16x16x32_bf16 v[92:95], v[172:175], v[236:239], v[92:95]
    ds_read_b64_tr_b16 v[228:229], v7 offset:62464
    v_mfma_f32_16x16x32_bf16 v[92:95], v[168:171], v[232:235], v[92:95]
    ds_read_b64_tr_b16 v[230:231], v7 offset:62976
    v_mfma_f32_16x16x32_bf16 v[100:103], v[176:179], v[232:235], v[100:103]
    v_mfma_f32_16x16x32_bf16 v[100:103], v[180:183], v[236:239], v[100:103]
    v_mfma_f32_16x16x32_bf16 v[108:111], v[188:191], v[236:239], v[108:111]
    v_mfma_f32_16x16x32_bf16 v[108:111], v[184:187], v[232:235], v[108:111]
    s_waitcnt lgkmcnt(4)
    v_mfma_f32_16x16x32_bf16 v[112:115], v[200:203], v[152:155], v[112:115]
    ds_read_b64_tr_b16 v[232:233], v6 offset:49152
    v_mfma_f32_16x16x32_bf16 v[112:115], v[204:207], v[156:159], v[112:115]
    ds_read_b64_tr_b16 v[234:235], v6 offset:49664
    v_mfma_f32_16x16x32_bf16 v[72:75], v[204:207], v[148:151], v[72:75]
    ds_read_b64_tr_b16 v[236:237], v6 offset:61440
    v_mfma_f32_16x16x32_bf16 v[72:75], v[200:203], v[144:147], v[72:75]
    ds_read_b64_tr_b16 v[238:239], v6 offset:61952
    v_mfma_f32_16x16x32_bf16 v[64:67], v[200:203], v[136:139], v[64:67]
    ds_read_b128 v[192:195], v2 offset:0
    v_mfma_f32_16x16x32_bf16 v[64:67], v[204:207], v[140:143], v[64:67]
    ds_read_b128 v[196:199], v3 offset:0
    v_mfma_f32_16x16x32_bf16 v[56:59], v[204:207], v[132:135], v[56:59]
    ds_read_b128 v[184:187], v4 offset:6144
    v_mfma_f32_16x16x32_bf16 v[56:59], v[200:203], v[128:131], v[56:59]
    ds_read_b128 v[188:191], v5 offset:6144
    v_mfma_f32_16x16x32_bf16 v[48:51], v[200:203], v[120:123], v[48:51]
    v_mfma_f32_16x16x32_bf16 v[48:51], v[204:207], v[124:127], v[48:51]
    s_waitcnt lgkmcnt(8)
    v_mfma_f32_16x16x32_bf16 v[52:55], v[228:231], v[124:127], v[52:55]
    ds_read_b64_tr_b16 v[200:201], v7 offset:49152
    v_mfma_f32_16x16x32_bf16 v[52:55], v[224:227], v[120:123], v[52:55]
    ds_read_b64_tr_b16 v[202:203], v7 offset:49664
    v_mfma_f32_16x16x32_bf16 v[60:63], v[224:227], v[128:131], v[60:63]
    ds_read_b64_tr_b16 v[204:205], v7 offset:61440
    v_mfma_f32_16x16x32_bf16 v[60:63], v[228:231], v[132:135], v[60:63]
    ds_read_b64_tr_b16 v[206:207], v7 offset:61952
    v_mfma_f32_16x16x32_bf16 v[68:71], v[228:231], v[140:143], v[68:71]
    ds_read_b128 v[176:179], v4 offset:4096
    v_mfma_f32_16x16x32_bf16 v[68:71], v[224:227], v[136:139], v[68:71]
    ds_read_b128 v[180:183], v5 offset:4096
    v_mfma_f32_16x16x32_bf16 v[76:79], v[224:227], v[144:147], v[76:79]
    ds_read_b128 v[168:171], v4 offset:2048
    v_mfma_f32_16x16x32_bf16 v[76:79], v[228:231], v[148:151], v[76:79]
    s_waitcnt lgkmcnt(11)
    v_mfma_f32_16x16x32_bf16 v[40:43], v[236:239], v[148:151], v[40:43]
    ds_read_b64_tr_b16 v[224:225], v6 offset:51200
    v_mfma_f32_16x16x32_bf16 v[40:43], v[232:235], v[144:147], v[40:43]
    ds_read_b64_tr_b16 v[226:227], v6 offset:51712
    v_mfma_f32_16x16x32_bf16 v[32:35], v[232:235], v[136:139], v[32:35]
    ds_read_b64_tr_b16 v[228:229], v6 offset:63488
    v_mfma_f32_16x16x32_bf16 v[32:35], v[236:239], v[140:143], v[32:35]
    ds_read_b64_tr_b16 v[230:231], v6 offset:64000
    v_mfma_f32_16x16x32_bf16 v[24:27], v[236:239], v[132:135], v[24:27]
    ds_read_b128 v[172:175], v5 offset:2048
    v_mfma_f32_16x16x32_bf16 v[24:27], v[232:235], v[128:131], v[24:27]
    ds_read_b128 v[160:163], v4 offset:0
    v_mfma_f32_16x16x32_bf16 v[16:19], v[232:235], v[120:123], v[16:19]
    ds_read_b128 v[164:167], v5 offset:0
    v_mfma_f32_16x16x32_bf16 v[16:19], v[236:239], v[124:127], v[16:19]
    s_waitcnt lgkmcnt(10)
    v_mfma_f32_16x16x32_bf16 v[20:23], v[204:207], v[124:127], v[20:23]
    ds_read_b64_tr_b16 v[232:233], v7 offset:51200
    v_mfma_f32_16x16x32_bf16 v[20:23], v[200:203], v[120:123], v[20:23]
    ds_read_b64_tr_b16 v[234:235], v7 offset:51712
    v_mfma_f32_16x16x32_bf16 v[28:31], v[200:203], v[128:131], v[28:31]
    ds_read_b64_tr_b16 v[236:237], v7 offset:63488
    v_mfma_f32_16x16x32_bf16 v[28:31], v[204:207], v[132:135], v[28:31]
    ds_read_b64_tr_b16 v[238:239], v7 offset:64000
    v_mfma_f32_16x16x32_bf16 v[36:39], v[204:207], v[140:143], v[36:39]
    v_mfma_f32_16x16x32_bf16 v[36:39], v[200:203], v[136:139], v[36:39]
    v_mfma_f32_16x16x32_bf16 v[44:47], v[200:203], v[144:147], v[44:47]
    v_mfma_f32_16x16x32_bf16 v[44:47], v[204:207], v[148:151], v[44:47]
    s_waitcnt lgkmcnt(7)
    v_mfma_f32_16x16x32_bf16 v[116:119], v[156:159], v[228:231], v[116:119]
    ds_read_b64_tr_b16 v[200:201], v6 offset:1024
    v_mfma_f32_16x16x32_bf16 v[116:119], v[152:155], v[224:227], v[116:119]
    ds_read_b64_tr_b16 v[202:203], v6 offset:1536
    v_mfma_f32_16x16x32_bf16 v[104:107], v[144:147], v[224:227], v[104:107]
    ds_read_b64_tr_b16 v[204:205], v6 offset:13312
    v_mfma_f32_16x16x32_bf16 v[104:107], v[148:151], v[228:231], v[104:107]
    ds_read_b64_tr_b16 v[206:207], v6 offset:13824
    v_mfma_f32_16x16x32_bf16 v[96:99], v[140:143], v[228:231], v[96:99]
    v_mfma_f32_16x16x32_bf16 v[96:99], v[136:139], v[224:227], v[96:99]
    v_mfma_f32_16x16x32_bf16 v[88:91], v[128:131], v[224:227], v[88:91]
    v_mfma_f32_16x16x32_bf16 v[88:91], v[132:135], v[228:231], v[88:91]
    v_mfma_f32_16x16x32_bf16 v[80:83], v[124:127], v[228:231], v[80:83]
    v_mfma_f32_16x16x32_bf16 v[80:83], v[120:123], v[224:227], v[80:83]
    s_waitcnt lgkmcnt(4)
    v_mfma_f32_16x16x32_bf16 v[84:87], v[120:123], v[232:235], v[84:87]
    ds_read_b64_tr_b16 v[224:225], v7 offset:1024
    v_mfma_f32_16x16x32_bf16 v[84:87], v[124:127], v[236:239], v[84:87]
    ds_read_b64_tr_b16 v[226:227], v7 offset:1536
    v_mfma_f32_16x16x32_bf16 v[92:95], v[132:135], v[236:239], v[92:95]
    ds_read_b64_tr_b16 v[228:229], v7 offset:13312
    v_mfma_f32_16x16x32_bf16 v[92:95], v[128:131], v[232:235], v[92:95]
    ds_read_b64_tr_b16 v[230:231], v7 offset:13824
    v_mfma_f32_16x16x32_bf16 v[100:103], v[136:139], v[232:235], v[100:103]
    v_mfma_f32_16x16x32_bf16 v[100:103], v[140:143], v[236:239], v[100:103]
    v_mfma_f32_16x16x32_bf16 v[108:111], v[148:151], v[236:239], v[108:111]
    v_mfma_f32_16x16x32_bf16 v[108:111], v[144:147], v[232:235], v[108:111]
    s_waitcnt lgkmcnt(6)
    v_mfma_f32_16x16x32_bf16 v[112:115], v[200:203], v[192:195], v[112:115]
    ds_read_b64_tr_b16 v[120:121], v6 offset:0
    ds_read_b64_tr_b16 v[122:123], v6 offset:512
    s_waitcnt lgkmcnt(6)
    v_mfma_f32_16x16x32_bf16 v[112:115], v[204:207], v[196:199], v[112:115]
    ds_read_b64_tr_b16 v[124:125], v6 offset:12288
    ds_read_b64_tr_b16 v[126:127], v6 offset:12800
    v_mfma_f32_16x16x32_bf16 v[72:75], v[204:207], v[188:191], v[72:75]
    ds_read_b64_tr_b16 v[128:129], v7 offset:0
    ds_read_b64_tr_b16 v[130:131], v7 offset:512
    v_mfma_f32_16x16x32_bf16 v[72:75], v[200:203], v[184:187], v[72:75]
    ds_read_b64_tr_b16 v[132:133], v7 offset:12288
    ds_read_b64_tr_b16 v[134:135], v7 offset:12800
    v_mfma_f32_16x16x32_bf16 v[64:67], v[200:203], v[176:179], v[64:67]
    ds_read_b64_tr_b16 v[136:137], v6 offset:2048
    ds_read_b64_tr_b16 v[138:139], v6 offset:2560
    v_mfma_f32_16x16x32_bf16 v[64:67], v[204:207], v[180:183], v[64:67]
    ds_read_b64_tr_b16 v[140:141], v6 offset:14336
    ds_read_b64_tr_b16 v[142:143], v6 offset:14848
    v_mfma_f32_16x16x32_bf16 v[56:59], v[204:207], v[172:175], v[56:59]
    ds_read_b64_tr_b16 v[144:145], v7 offset:2048
    ds_read_b64_tr_b16 v[146:147], v7 offset:2560
    v_mfma_f32_16x16x32_bf16 v[56:59], v[200:203], v[168:171], v[56:59]
    ds_read_b64_tr_b16 v[148:149], v7 offset:14336
    ds_read_b64_tr_b16 v[150:151], v7 offset:14848
    v_mfma_f32_16x16x32_bf16 v[48:51], v[200:203], v[160:163], v[48:51]
    v_cvt_pk_bf16_f32 v72, v72, v73
    v_cvt_pk_bf16_f32 v73, v74, v75
    v_mfma_f32_16x16x32_bf16 v[48:51], v[204:207], v[164:167], v[48:51]
    v_cvt_pk_bf16_f32 v64, v64, v65
    v_cvt_pk_bf16_f32 v65, v66, v67
    s_waitcnt lgkmcnt(14)
    v_mfma_f32_16x16x32_bf16 v[76:79], v[228:231], v[188:191], v[76:79]
    v_cvt_pk_bf16_f32 v56, v56, v57
    v_cvt_pk_bf16_f32 v57, v58, v59
    v_mfma_f32_16x16x32_bf16 v[76:79], v[224:227], v[184:187], v[76:79]
    v_cvt_pk_bf16_f32 v200, v112, v113
    v_cvt_pk_bf16_f32 v201, v114, v115
    v_mfma_f32_16x16x32_bf16 v[68:71], v[224:227], v[176:179], v[68:71]
    ds_write_b64 v216, v[200:201]
    ds_write_b64 v217, v[72:73]
    v_mfma_f32_16x16x32_bf16 v[68:71], v[228:231], v[180:183], v[68:71]
    v_cvt_pk_bf16_f32 v48, v48, v49
    v_cvt_pk_bf16_f32 v49, v50, v51
    v_mfma_f32_16x16x32_bf16 v[60:63], v[228:231], v[172:175], v[60:63]
    v_cvt_pk_bf16_f32 v74, v76, v77
    v_cvt_pk_bf16_f32 v75, v78, v79
    v_mfma_f32_16x16x32_bf16 v[60:63], v[224:227], v[168:171], v[60:63]
    ds_write_b64 v217, v[74:75] offset:512
    s_mov_b64 exec, 1
    ds_add_u32 v10, v11 offset:0
    s_mov_b64 exec, -1
    v_mfma_f32_16x16x32_bf16 v[52:55], v[224:227], v[160:163], v[52:55]
    v_cvt_pk_bf16_f32 v66, v68, v69
    v_cvt_pk_bf16_f32 v67, v70, v71
    v_mfma_f32_16x16x32_bf16 v[52:55], v[228:231], v[164:167], v[52:55]
    v_cvt_pk_bf16_f32 v58, v60, v61
    v_cvt_pk_bf16_f32 v59, v62, v63
    s_waitcnt lgkmcnt(14)
    v_mfma_f32_16x16x32_bf16 v[40:43], v[124:127], v[188:191], v[40:43]
    s_nop 1
    v_mfma_f32_16x16x32_bf16 v[40:43], v[120:123], v[184:187], v[40:43]
    s_nop 1
    v_mfma_f32_16x16x32_bf16 v[32:35], v[120:123], v[176:179], v[32:35]
    v_cvt_pk_bf16_f32 v50, v52, v53
    v_cvt_pk_bf16_f32 v51, v54, v55
    v_mfma_f32_16x16x32_bf16 v[32:35], v[124:127], v[180:183], v[32:35]
    s_nop 1
    v_mfma_f32_16x16x32_bf16 v[24:27], v[124:127], v[172:175], v[24:27]
    v_cvt_pk_bf16_f32 v40, v40, v41
    v_cvt_pk_bf16_f32 v41, v42, v43
    v_mfma_f32_16x16x32_bf16 v[24:27], v[120:123], v[168:171], v[24:27]
    s_nop 1
    v_mfma_f32_16x16x32_bf16 v[16:19], v[120:123], v[160:163], v[16:19]
    v_cvt_pk_bf16_f32 v32, v32, v33
    v_cvt_pk_bf16_f32 v33, v34, v35
    v_mfma_f32_16x16x32_bf16 v[16:19], v[124:127], v[164:167], v[16:19]
    s_nop 1
    s_waitcnt lgkmcnt(12)
    v_mfma_f32_16x16x32_bf16 v[44:47], v[132:135], v[188:191], v[44:47]
    v_cvt_pk_bf16_f32 v24, v24, v25
    v_cvt_pk_bf16_f32 v25, v26, v27
    v_mfma_f32_16x16x32_bf16 v[44:47], v[128:131], v[184:187], v[44:47]
    s_nop 1
    v_mfma_f32_16x16x32_bf16 v[36:39], v[128:131], v[176:179], v[36:39]
    v_cvt_pk_bf16_f32 v16, v16, v17
    v_cvt_pk_bf16_f32 v17, v18, v19
    v_mfma_f32_16x16x32_bf16 v[36:39], v[132:135], v[180:183], v[36:39]
    s_nop 1
    v_mfma_f32_16x16x32_bf16 v[28:31], v[132:135], v[172:175], v[28:31]
    v_cvt_pk_bf16_f32 v42, v44, v45
    v_cvt_pk_bf16_f32 v43, v46, v47
    v_mfma_f32_16x16x32_bf16 v[28:31], v[128:131], v[168:171], v[28:31]
    ds_read_b32 v223, v10 offset:0
    ds_read_b64 v[204:205], v218
    v_mfma_f32_16x16x32_bf16 v[20:23], v[128:131], v[160:163], v[20:23]
    ds_read_b64 v[206:207], v219
    v_cvt_pk_bf16_f32 v34, v36, v37
    v_mfma_f32_16x16x32_bf16 v[20:23], v[132:135], v[164:167], v[20:23]
    v_cvt_pk_bf16_f32 v35, v38, v39
    s_nop 0
    s_waitcnt lgkmcnt(11)
    v_mfma_f32_16x16x32_bf16 v[116:119], v[196:199], v[140:143], v[116:119]
    v_cvt_pk_bf16_f32 v26, v28, v29
    v_cvt_pk_bf16_f32 v27, v30, v31
    v_mfma_f32_16x16x32_bf16 v[116:119], v[192:195], v[136:139], v[116:119]
    s_nop 1
    v_mfma_f32_16x16x32_bf16 v[104:107], v[184:187], v[136:139], v[104:107]
    v_cvt_pk_bf16_f32 v18, v20, v21
    v_cvt_pk_bf16_f32 v19, v22, v23
    v_mfma_f32_16x16x32_bf16 v[104:107], v[188:191], v[140:143], v[104:107]
    s_nop 1
    v_mfma_f32_16x16x32_bf16 v[44:47], v[72:75], v[40:43], 0
    v_cvt_pk_bf16_f32 v202, v116, v117
    v_cvt_pk_bf16_f32 v203, v118, v119
    v_mfma_f32_16x16x32_bf16 v[76:79], v[64:67], v[40:43], 0
    s_nop 1
    v_mfma_f32_16x16x32_bf16 v[36:39], v[64:67], v[32:35], 0
    v_cvt_pk_bf16_f32 v232, v104, v105
    v_cvt_pk_bf16_f32 v233, v106, v107
    v_mfma_f32_16x16x32_bf16 v[68:71], v[56:59], v[32:35], 0
    ds_write_b64 v216, v[202:203] offset:1024
    ds_write_b64 v217, v[232:233] offset:1024
    v_mfma_f32_16x16x32_bf16 v[96:99], v[180:183], v[140:143], v[96:99]
    s_waitcnt lgkmcnt(4)
    v_cmp_gt_u32 vcc, 4, v223
    s_cbranch_vccnz LB_w1
LB_g1:
    v_mfma_f32_16x16x32_bf16 v[96:99], v[176:179], v[136:139], v[96:99]
    v_cndmask_b32 v124, v44, v45, s[88:89]
    v_cndmask_b32 v125, v76, v77, s[88:89]
    v_mfma_f32_16x16x32_bf16 v[28:31], v[56:59], v[24:27], 0
    v_cndmask_b32 v158, v125, v124, s[90:91]
    v_cndmask_b32 v126, v46, v47, s[88:89]
    v_mfma_f32_16x16x32_bf16 v[60:63], v[48:51], v[24:27], 0
    v_cndmask_b32 v127, v78, v79, s[88:89]
    v_cndmask_b32 v159, v127, v126, s[92:93]
    v_mfma_f32_16x16x32_bf16 v[20:23], v[48:51], v[16:19], 0
    v_max_f32 v123, v158, v159
    v_cndmask_b32 v124, v36, v37, s[88:89]
    v_mfma_f32_16x16x32_bf16 v[88:91], v[168:171], v[136:139], v[88:91]
    v_cndmask_b32 v125, v68, v69, s[88:89]
    v_cndmask_b32 v156, v125, v124, s[90:91]
    v_mfma_f32_16x16x32_bf16 v[88:91], v[172:175], v[140:143], v[88:91]
    v_cndmask_b32 v126, v38, v39, s[88:89]
    v_cndmask_b32 v127, v70, v71, s[88:89]
    s_waitcnt lgkmcnt(2)
    v_mfma_f32_16x16x32_bf16 v[52:55], v[204:207], v[16:19], v[212:215]
    v_cndmask_b32 v157, v127, v126, s[92:93]
    v_max_f32 v122, v156, v157
    v_mfma_f32_16x16x32_bf16 v[80:83], v[164:167], v[140:143], v[80:83]
    v_cndmask_b32 v124, v28, v29, s[88:89]
    v_cndmask_b32 v125, v60, v61, s[88:89]
    v_mfma_f32_16x16x32_bf16 v[80:83], v[160:163], v[136:139], v[80:83]
    v_cndmask_b32 v154, v125, v124, s[90:91]
    v_cndmask_b32 v126, v30, v31, s[88:89]
    v_mfma_f32_16x16x32_bf16 v[108:111], v[184:187], v[144:147], v[108:111]
    v_cndmask_b32 v127, v62, v63, s[88:89]
    v_cndmask_b32 v155, v127, v126, s[92:93]
    v_mfma_f32_16x16x32_bf16 v[108:111], v[188:191], v[148:151], v[108:111]
    v_max_f32 v121, v154, v155
    s_nop 0
    v_mfma_f32_16x16x32_bf16 v[100:103], v[180:183], v[148:151], v[100:103]
    s_nop 1
    v_mfma_f32_16x16x32_bf16 v[100:103], v[176:179], v[144:147], v[100:103]
    s_nop 1
    v_mfma_f32_16x16x32_bf16 v[92:95], v[168:171], v[144:147], v[92:95]
    v_cvt_pk_bf16_f32 v242, v108, v109
    v_cvt_pk_bf16_f32 v243, v110, v111
    v_mfma_f32_16x16x32_bf16 v[92:95], v[172:175], v[148:151], v[92:95]
    ds_write_b64 v217, v[242:243] offset:1536
    s_mov_b64 exec, 1
    ds_add_u32 v10, v11 offset:24
    s_mov_b64 exec, -1
    v_mfma_f32_16x16x32_bf16 v[84:87], v[164:167], v[148:151], v[84:87]
    v_cndmask_b32 v124, v20, v21, s[88:89]
    v_cndmask_b32 v125, v52, v53, s[88:89]
    v_mfma_f32_16x16x32_bf16 v[84:87], v[160:163], v[144:147], v[84:87]
    v_cndmask_b32 v152, v125, v124, s[90:91]
    v_cndmask_b32 v126, v22, v23, s[88:89]
    v_cndmask_b32 v127, v54, v55, s[88:89]
    v_cndmask_b32 v153, v127, v126, s[92:93]
    v_max_f32 v120, v152, v153
    s_mov_b32 s80, 0x3e8293ee
    s_add_u32 m0, s34, 36864
    s_add_u32 s35, s44, 0
    buffer_load_dwordx4 v245, s[64:67], s35 offen  lds
    v_cvt_pk_bf16_f32 v230, v96, v97
    v_permlane32_swap_b32 v122, v123
    v_permlane32_swap_b32 v120, v121
    v_max_f32 v122, v122, v123
    v_max_f32 v120, v120, v121
    v_cvt_pk_bf16_f32 v231, v98, v99
    v_cvt_pk_bf16_f32 v240, v100, v101
    v_permlane16_swap_b32 v120, v122
    v_max_f32 v120, v120, v122
    v_mul_f32 v120, s80, v120
    v_mov_b32 v122, v120
    v_cvt_pk_bf16_f32 v241, v102, v103
    v_cvt_pk_bf16_f32 v228, v88, v89
    v_permlane16_swap_b32 v120, v122
    v_mov_b32 v121, v120
    v_mov_b32 v123, v122
    s_add_u32 m0, s34, 40960
    s_add_u32 s35, s44, 65536
    buffer_load_dwordx4 v245, s[64:67], s35 offen  lds
    v_cvt_pk_bf16_f32 v229, v90, v91
    v_permlane32_swap_b32 v120, v121
    v_permlane32_swap_b32 v122, v123
    v_fma_f32 v152, v152, s80, -v120
    v_fma_f32 v153, v153, s80, -v120
    v_fma_f32 v154, v154, s80, -v121
    v_fma_f32 v155, v155, s80, -v121
    v_fma_f32 v156, v156, s80, -v122
    v_fma_f32 v157, v157, s80, -v122
    v_fma_f32 v158, v158, s80, -v123
    v_fma_f32 v159, v159, s80, -v123
    ds_read_b32 v223, v10 offset:24
    ds_read_b64 v[224:225], v218 offset:1024
    ds_read_b64 v[234:235], v219 offset:1024
    v_exp_f32 v152, v152
    v_exp_f32 v153, v153
    v_exp_f32 v154, v154
    s_add_u32 m0, s34, 45056
    s_add_u32 s35, s44, 131072
    buffer_load_dwordx4 v245, s[64:67], s35 offen  lds
    v_exp_f32 v155, v155
    v_exp_f32 v156, v156
    v_exp_f32 v157, v157
    v_exp_f32 v158, v158
    v_exp_f32 v159, v159
    v_add_f32 v120, v152, v153
    v_add_f32 v121, v154, v155
    v_add_f32 v122, v156, v157
    v_add_f32 v123, v158, v159
    v_cvt_pk_bf16_f32 v238, v92, v93
    s_nop 0
    v_permlane32_swap_b32 v122, v123
    v_permlane32_swap_b32 v120, v121
    v_add_f32 v122, v122, v123
    v_add_f32 v120, v120, v121
    v_cvt_pk_bf16_f32 v239, v94, v95
    v_cvt_pk_bf16_f32 v226, v80, v81
    s_add_u32 m0, s34, 49152
    s_add_u32 s35, s44, 196608
    buffer_load_dwordx4 v245, s[64:67], s35 offen  lds
    v_permlane16_swap_b32 v120, v122
    v_add_f32 v120, v120, v122
    v_rcp_f32 v120, v120
    s_nop 0
    v_mov_b32 v122, v120
    v_cvt_pk_bf16_f32 v227, v82, v83
    v_cvt_pk_bf16_f32 v236, v84, v85
    v_permlane16_swap_b32 v120, v122
    v_mov_b32 v121, v120
    v_mov_b32 v123, v122
    v_cvt_pk_bf16_f32 v237, v86, v87
    v_permlane32_swap_b32 v120, v121
    v_permlane32_swap_b32 v122, v123
    s_waitcnt lgkmcnt(2)
    v_cmp_gt_u32 vcc, 4, v223
    s_cbranch_vccnz LB_w6
LB_g6:
    v_mul_f32 v152, v152, v120
    v_mul_f32 v153, v153, v120
    v_cvt_pk_bf16_f32 v152, v152, v153
    v_perm_b32 v160, v152, v152, v208
    s_add_u32 m0, s34, 53248
    s_add_u32 s35, s45, 0
    buffer_load_dwordx4 v245, s[64:67], s35 offen  lds
    v_perm_b32 v161, v152, v152, v209
    v_perm_b32 v162, v152, v152, v210
    v_perm_b32 v163, v152, v152, v211
    v_mul_f32 v154, v154, v121
    v_mul_f32 v155, v155, v121
    v_cvt_pk_bf16_f32 v154, v154, v155
    v_perm_b32 v164, v154, v154, v208
    v_perm_b32 v165, v154, v154, v209
    v_perm_b32 v166, v154, v154, v210
    v_perm_b32 v167, v154, v154, v211
    s_waitcnt lgkmcnt(1)
    v_mfma_f32_16x16x32_bf16 v[16:19], v[224:227], v[160:163], 0
    s_waitcnt lgkmcnt(0)
    v_mfma_f32_16x16x32_bf16 v[20:23], v[234:237], v[160:163], 0
    v_mul_f32 v156, v156, v122
    v_mul_f32 v157, v157, v122
    v_cvt_pk_bf16_f32 v156, v156, v157
    v_perm_b32 v168, v156, v156, v208
    s_add_u32 m0, s34, 57344
    s_add_u32 s35, s45, 65536
    buffer_load_dwordx4 v245, s[64:67], s35 offen  lds
    v_perm_b32 v169, v156, v156, v209
    v_perm_b32 v170, v156, v156, v210
    v_perm_b32 v171, v156, v156, v211
    v_mfma_f32_16x16x32_bf16 v[24:27], v[226:229], v[164:167], 0
    v_mfma_f32_16x16x32_bf16 v[28:31], v[236:239], v[164:167], 0
    v_mul_f32 v158, v158, v123
    v_mul_f32 v159, v159, v123
    v_cvt_pk_bf16_f32 v158, v158, v159
    v_perm_b32 v172, v158, v158, v208
    v_perm_b32 v173, v158, v158, v209
    v_perm_b32 v174, v158, v158, v210
    v_perm_b32 v175, v158, v158, v211
    v_mfma_f32_16x16x32_bf16 v[32:35], v[228:231], v[168:171], 0
    v_mfma_f32_16x16x32_bf16 v[36:39], v[238:241], v[168:171], 0
    v_mfma_f32_16x16x32_bf16 v[40:43], v[230:233], v[172:175], 0
    v_mfma_f32_16x16x32_bf16 v[44:47], v[240:243], v[172:175], 0
    v_cvt_pk_bf16_f32 v80, v16, v17
    v_cvt_pk_bf16_f32 v81, v18, v19
    v_cvt_pk_bf16_f32 v82, v20, v21
    v_cvt_pk_bf16_f32 v83, v22, v23
    s_add_u32 s95, s94, 0
    buffer_store_dwordx4 v[80:83], v12, s[52:55], s95 offen sc1
    v_cvt_pk_bf16_f32 v84, v24, v25
    v_cvt_pk_bf16_f32 v85, v26, v27
    v_cvt_pk_bf16_f32 v86, v28, v29
    v_cvt_pk_bf16_f32 v87, v30, v31
    s_add_u32 s95, s94, 32768
    buffer_store_dwordx4 v[84:87], v12, s[52:55], s95 offen sc1
    v_cvt_pk_bf16_f32 v88, v32, v33
    v_cvt_pk_bf16_f32 v89, v34, v35
    v_cvt_pk_bf16_f32 v90, v36, v37
    v_cvt_pk_bf16_f32 v91, v38, v39
    s_add_u32 s95, s94, 65536
    buffer_store_dwordx4 v[88:91], v12, s[52:55], s95 offen sc1
    v_cvt_pk_bf16_f32 v92, v40, v41
    v_cvt_pk_bf16_f32 v93, v42, v43
    v_cvt_pk_bf16_f32 v94, v44, v45
    v_cvt_pk_bf16_f32 v95, v46, v47
    s_add_u32 s95, s94, 98304
    buffer_store_dwordx4 v[92:95], v12, s[52:55], s95 offen sc1
    s_add_u32 m0, s34, 61440
    s_add_u32 s35, s45, 131072
    buffer_load_dwordx4 v245, s[64:67], s35 offen  lds
    v_xor_b32 v2, 0, v244
    v_xor_b32 v3, 32, v244
    v_xor_b32 v4, 64, v244
    v_xor_b32 v5, 96, v244
    s_add_u32 m0, s34, 65536
    s_add_u32 s35, s45, 196608
    buffer_load_dwordx4 v245, s[64:67], s35 offen  lds
    v_xor_b32 v6, 2048, v244
    v_xor_b32 v7, 2080, v244
    v_xor_b32 v8, 2112, v244
    v_xor_b32 v9, 2144, v244
    s_waitcnt vmcnt(6)
    s_mov_b64 exec, 1
    ds_add_u32 v10, v11 offset:8
    s_mov_b64 exec, -1
    s_add_u32 m0, s34, 69632
    s_add_u32 s35, s46, 0
    buffer_load_dwordx4 v245, s[64:67], s35 offen  lds
    v_add_u32 v224, 65536, v2
    v_add_u32 v225, 65536, v3
    v_add_u32 v226, 65536, v4
    s_add_u32 m0, s34, 73728
    s_add_u32 s35, s46, 65536
    buffer_load_dwordx4 v245, s[64:67], s35 offen  lds
    v_add_u32 v227, 65536, v5
    v_add_u32 v228, 65536, v6
    v_add_u32 v229, 65536, v7
    s_add_u32 m0, s34, 77824
    s_add_u32 s35, s46, 131072
    buffer_load_dwordx4 v245, s[64:67], s35 offen  lds
    v_add_u32 v230, 65536, v8
    v_add_u32 v231, 65536, v9
    v_add_u32 v15, 32768, v12
    s_add_u32 m0, s34, 81920
    s_add_u32 s35, s46, 196608
    buffer_load_dwordx4 v245, s[64:67], s35 offen  lds
    v_add_u32 v232, 129024, v2
    v_add_u32 v233, 129024, v3
    v_add_u32 v234, 129024, v4
    s_add_u32 m0, s34, 86016
    s_add_u32 s35, s47, 0
    buffer_load_dwordx4 v245, s[64:67], s35 offen  lds
    v_add_u32 v235, 129024, v5
    v_add_u32 v236, 129024, v6
    v_add_u32 v237, 129024, v7
    s_add_u32 m0, s34, 0
    s_add_u32 s35, s47, 65536
    buffer_load_dwordx4 v245, s[64:67], s35 offen  lds
    v_add_u32 v238, 129024, v8
    v_add_u32 v239, 129024, v9
    s_waitcnt vmcnt(8)
    s_mov_b64 exec, 1
    buffer_store_dword v11, v220, s[52:55], s97 offen sc1
    s_mov_b64 exec, -1
    s_branch LB_s2_in
LB_s2:
    s_sleep 1
LB_s2_in:
    ds_read_b32 v14, v10 offset:8
    s_waitcnt lgkmcnt(0)
    v_readfirstlane_b32 s78, v14
    s_nop 0
    s_cmp_ge_u32 s78, 8
    s_cbranch_scc0 LB_s2
    s_add_u32 m0, s34, 4096
    s_add_u32 s35, s47, 131072
    buffer_load_dwordx4 v245, s[64:67], s35 offen  lds
    ds_read_b64_tr_b16 v[48:49], v2 offset:36864
    ds_read_b64_tr_b16 v[50:51], v6 offset:36864
    s_add_u32 m0, s34, 8192
    s_add_u32 s35, s47, 196608
    buffer_load_dwordx4 v245, s[64:67], s35 offen  lds
    ds_read_b64_tr_b16 v[52:53], v2 offset:40960
    s_add_u32 m0, s34, 12288
    s_add_u32 s35, s48, 0
    buffer_load_dwordx4 v245, s[64:67], s35 offen  lds
    ds_read_b64_tr_b16 v[54:55], v6 offset:40960
    s_add_u32 m0, s34, 16384
    s_add_u32 s35, s48, 65536
    buffer_load_dwordx4 v245, s[64:67], s35 offen  lds
    ds_read_b64_tr_b16 v[56:57], v2 offset:45056
    ds_read_b64_tr_b16 v[58:59], v6 offset:45056
    s_add_u32 m0, s34, 20480
    s_add_u32 s35, s48, 131072
    buffer_load_dwordx4 v245, s[64:67], s35 offen  lds
    ds_read_b64_tr_b16 v[60:61], v2 offset:49152
    s_add_u32 m0, s34, 110592
    s_add_u32 s35, s48, 196608
    buffer_load_dwordx4 v245, s[64:67], s35 offen  lds
    ds_read_b64_tr_b16 v[62:63], v6 offset:49152
    s_add_u32 m0, s34, 114688
    s_add_u32 s35, s49, 0
    buffer_load_dwordx4 v245, s[64:67], s35 offen  lds
    ds_read_b64_tr_b16 v[64:65], v3 offset:36864
    ds_read_b64_tr_b16 v[66:67], v7 offset:36864
    s_add_u32 m0, s34, 118784
    s_add_u32 s35, s49, 65536
    buffer_load_dwordx4 v245, s[64:67], s35 offen  lds
    ds_read_b64_tr_b16 v[68:69], v3 offset:40960
    s_add_u32 m0, s34, 122880
    s_add_u32 s35, s49, 131072
    buffer_load_dwordx4 v245, s[64:67], s35 offen  lds
    ds_read_b64_tr_b16 v[70:71], v7 offset:40960
    s_add_u32 m0, s34, 24576
    s_add_u32 s35, s49, 196608
    buffer_load_dwordx4 v245, s[64:67], s35 offen  lds
    ds_read_b64_tr_b16 v[72:73], v3 offset:45056
    ds_read_b64_tr_b16 v[74:75], v7 offset:45056
    s_add_u32 m0, s34, 28672
    s_add_u32 s35, s50, 0
    buffer_load_dwordx4 v245, s[64:67], s35 offen  lds
    ds_read_b64_tr_b16 v[76:77], v3 offset:49152
    s_add_u32 m0, s34, 32768
    s_add_u32 s35, s50, 65536
    buffer_load_dwordx4 v245, s[64:67], s35 offen  lds
    ds_read_b64_tr_b16 v[78:79], v7 offset:49152
    s_waitcnt vmcnt(0)
    s_mov_b64 exec, 1
    ds_add_u32 v10, v11 offset:16
    s_mov_b64 exec, -1
    s_mov_b64 exec, 0xffffffff
    s_mov_b32 s79, 0
LB_po:
    buffer_load_dword v14, v247, s[52:55], s30 offen sc1
    s_add_u32 s79, s79, 1
    s_cmp_gt_u32 s79, 200000
    s_cbranch_scc1 LB_po_x
    s_waitcnt vmcnt(0)
    v_cmp_ne_u32 vcc, 1, v14
    s_cbranch_vccz LB_po_x
    s_mov_b64 exec, vcc
    s_sleep 4
    s_branch LB_po
LB_po_x:
    s_waitcnt vmcnt(0)
    s_mov_b64 exec, -1
    ds_read_b32 v222, v10 offset:16
    buffer_load_dwordx4 v[96:99], v12, s[52:55], s36 offen offset:0 sc1
    buffer_load_dwordx4 v[100:103], v12, s[52:55], s36 offen offset:1024 sc1
    buffer_load_dwordx4 v[104:107], v12, s[52:55], s36 offen offset:2048 sc1
    buffer_load_dwordx4 v[108:111], v12, s[52:55], s36 offen offset:3072 sc1
    buffer_load_dwordx4 v[112:115], v15, s[52:55], s36 offen offset:0 sc1
    buffer_load_dwordx4 v[116:119], v15, s[52:55], s36 offen offset:1024 sc1
    buffer_load_dwordx4 v[120:123], v15, s[52:55], s36 offen offset:2048 sc1
    buffer_load_dwordx4 v[124:127], v15, s[52:55], s36 offen offset:3072 sc1
    buffer_load_dwordx4 v[128:131], v12, s[52:55], s37 offen offset:0 sc1
    buffer_load_dwordx4 v[132:135], v12, s[52:55], s37 offen offset:1024 sc1
    s_setprio 1
    s_waitcnt lgkmcnt(0)
    v_cmp_gt_u32 vcc, 4, v222
    s_cbranch_vccnz LB_w4
LB_g4:
    s_waitcnt vmcnt(9)
    v_mfma_f32_16x16x32_bf16 v[16:19], v[48:51], v[96:99], 0
    buffer_load_dwordx4 v[136:139], v12, s[52:55], s37 offen offset:2048 sc1
    buffer_load_dwordx4 v[140:143], v12, s[52:55], s37 offen offset:3072 sc1
    s_waitcnt vmcnt(10)
    v_mfma_f32_16x16x32_bf16 v[16:19], v[52:55], v[100:103], v[16:19]
    buffer_load_dwordx4 v[144:147], v15, s[52:55], s37 offen offset:0 sc1
    s_waitcnt vmcnt(10)
    v_mfma_f32_16x16x32_bf16 v[16:19], v[56:59], v[104:107], v[16:19]
    buffer_load_dwordx4 v[148:151], v15, s[52:55], s37 offen offset:1024 sc1
    ds_read_b64_tr_b16 v[80:81], v4 offset:36864
    s_waitcnt vmcnt(10)
    v_mfma_f32_16x16x32_bf16 v[16:19], v[60:63], v[108:111], v[16:19]
    ds_read_b64_tr_b16 v[82:83], v8 offset:36864
    s_waitcnt vmcnt(6)
    v_mfma_f32_16x16x32_bf16 v[32:35], v[60:63], v[124:127], 0
    ds_read_b64_tr_b16 v[84:85], v4 offset:40960
    ds_read_b64_tr_b16 v[86:87], v8 offset:40960
    v_mfma_f32_16x16x32_bf16 v[32:35], v[56:59], v[120:123], v[32:35]
    ds_read_b64_tr_b16 v[88:89], v4 offset:45056
    v_mfma_f32_16x16x32_bf16 v[32:35], v[52:55], v[116:119], v[32:35]
    ds_read_b64_tr_b16 v[90:91], v8 offset:45056
    ds_read_b64_tr_b16 v[92:93], v4 offset:49152
    v_mfma_f32_16x16x32_bf16 v[32:35], v[48:51], v[112:115], v[32:35]
    ds_read_b64_tr_b16 v[94:95], v8 offset:49152
    v_mfma_f32_16x16x32_bf16 v[36:39], v[64:67], v[112:115], 0
    buffer_load_dwordx4 v[152:155], v15, s[52:55], s37 offen offset:2048 sc1
    buffer_load_dwordx4 v[156:159], v15, s[52:55], s37 offen offset:3072 sc1
    v_mfma_f32_16x16x32_bf16 v[36:39], v[68:71], v[116:119], v[36:39]
    buffer_load_dwordx4 v[160:163], v12, s[52:55], s38 offen offset:0 sc1
    v_mfma_f32_16x16x32_bf16 v[36:39], v[72:75], v[120:123], v[36:39]
    buffer_load_dwordx4 v[164:167], v12, s[52:55], s38 offen offset:1024 sc1
    ds_read_b64_tr_b16 v[48:49], v5 offset:36864
    v_mfma_f32_16x16x32_bf16 v[36:39], v[76:79], v[124:127], v[36:39]
    ds_read_b64_tr_b16 v[50:51], v9 offset:36864
    v_mfma_f32_16x16x32_bf16 v[20:23], v[76:79], v[108:111], 0
    ds_read_b64_tr_b16 v[52:53], v5 offset:40960
    ds_read_b64_tr_b16 v[54:55], v9 offset:40960
    v_mfma_f32_16x16x32_bf16 v[20:23], v[72:75], v[104:107], v[20:23]
    ds_read_b64_tr_b16 v[56:57], v5 offset:45056
    v_mfma_f32_16x16x32_bf16 v[20:23], v[68:71], v[100:103], v[20:23]
    ds_read_b64_tr_b16 v[58:59], v9 offset:45056
    ds_read_b64_tr_b16 v[60:61], v5 offset:49152
    v_mfma_f32_16x16x32_bf16 v[20:23], v[64:67], v[96:99], v[20:23]
    ds_read_b64_tr_b16 v[62:63], v9 offset:49152
    s_waitcnt lgkmcnt(14)
    v_mfma_f32_16x16x32_bf16 v[24:27], v[80:83], v[96:99], 0
    buffer_load_dwordx4 v[168:171], v12, s[52:55], s38 offen offset:2048 sc1
    buffer_load_dwordx4 v[172:175], v12, s[52:55], s38 offen offset:3072 sc1
    s_waitcnt lgkmcnt(12)
    v_mfma_f32_16x16x32_bf16 v[24:27], v[84:87], v[100:103], v[24:27]
    buffer_load_dwordx4 v[176:179], v15, s[52:55], s38 offen offset:0 sc1
    s_waitcnt lgkmcnt(10)
    v_mfma_f32_16x16x32_bf16 v[24:27], v[88:91], v[104:107], v[24:27]
    buffer_load_dwordx4 v[180:183], v15, s[52:55], s38 offen offset:1024 sc1
    ds_read_b64_tr_b16 v[64:65], v2 offset:53248
    s_waitcnt lgkmcnt(9)
    v_mfma_f32_16x16x32_bf16 v[24:27], v[92:95], v[108:111], v[24:27]
    ds_read_b64_tr_b16 v[66:67], v6 offset:53248
    v_mfma_f32_16x16x32_bf16 v[40:43], v[92:95], v[124:127], 0
    ds_read_b64_tr_b16 v[68:69], v2 offset:57344
    ds_read_b64_tr_b16 v[70:71], v6 offset:57344
    v_mfma_f32_16x16x32_bf16 v[40:43], v[88:91], v[120:123], v[40:43]
    ds_read_b64_tr_b16 v[72:73], v2 offset:61440
    v_mfma_f32_16x16x32_bf16 v[40:43], v[84:87], v[116:119], v[40:43]
    ds_read_b64_tr_b16 v[74:75], v6 offset:61440
    ds_read_b64_tr_b16 v[76:77], v224 offset:0
    v_mfma_f32_16x16x32_bf16 v[40:43], v[80:83], v[112:115], v[40:43]
    ds_read_b64_tr_b16 v[78:79], v228 offset:0
    s_waitcnt lgkmcnt(14)
    v_mfma_f32_16x16x32_bf16 v[44:47], v[48:51], v[112:115], 0
    buffer_load_dwordx4 v[184:187], v15, s[52:55], s38 offen offset:2048 sc1
    buffer_load_dwordx4 v[188:191], v15, s[52:55], s38 offen offset:3072 sc1
    s_waitcnt lgkmcnt(12)
    v_mfma_f32_16x16x32_bf16 v[44:47], v[52:55], v[116:119], v[44:47]
    ds_read_b64_tr_b16 v[80:81], v3 offset:53248
    s_waitcnt lgkmcnt(11)
    v_mfma_f32_16x16x32_bf16 v[44:47], v[56:59], v[120:123], v[44:47]
    ds_read_b64_tr_b16 v[82:83], v7 offset:53248
    s_waitcnt lgkmcnt(10)
    v_mfma_f32_16x16x32_bf16 v[44:47], v[60:63], v[124:127], v[44:47]
    ds_read_b64_tr_b16 v[84:85], v3 offset:57344
    v_mfma_f32_16x16x32_bf16 v[28:31], v[60:63], v[108:111], 0
    ds_read_b64_tr_b16 v[86:87], v7 offset:57344
    ds_read_b64_tr_b16 v[88:89], v3 offset:61440
    v_mfma_f32_16x16x32_bf16 v[28:31], v[56:59], v[104:107], v[28:31]
    ds_read_b64_tr_b16 v[90:91], v7 offset:61440
    v_mfma_f32_16x16x32_bf16 v[28:31], v[52:55], v[100:103], v[28:31]
    ds_read_b64_tr_b16 v[92:93], v225 offset:0
    v_mfma_f32_16x16x32_bf16 v[28:31], v[48:51], v[96:99], v[28:31]
    ds_read_b64_tr_b16 v[94:95], v229 offset:0
    s_waitcnt vmcnt(8) lgkmcnt(8)
    v_mfma_f32_16x16x32_bf16 v[16:19], v[64:67], v[128:131], v[16:19]
    buffer_load_dwordx4 v[96:99], v12, s[52:55], s39 offen offset:0 sc1
    buffer_load_dwordx4 v[100:103], v12, s[52:55], s39 offen offset:1024 sc1
    v_mfma_f32_16x16x32_bf16 v[16:19], v[68:71], v[132:135], v[16:19]
    ds_read_b64_tr_b16 v[48:49], v4 offset:53248
    v_mfma_f32_16x16x32_bf16 v[16:19], v[72:75], v[136:139], v[16:19]
    ds_read_b64_tr_b16 v[50:51], v8 offset:53248
    v_mfma_f32_16x16x32_bf16 v[16:19], v[76:79], v[140:143], v[16:19]
    ds_read_b64_tr_b16 v[52:53], v4 offset:57344
    v_mfma_f32_16x16x32_bf16 v[32:35], v[76:79], v[156:159], v[32:35]
    ds_read_b64_tr_b16 v[54:55], v8 offset:57344
    ds_read_b64_tr_b16 v[56:57], v4 offset:61440
    v_mfma_f32_16x16x32_bf16 v[32:35], v[72:75], v[152:155], v[32:35]
    ds_read_b64_tr_b16 v[58:59], v8 offset:61440
    v_mfma_f32_16x16x32_bf16 v[32:35], v[68:71], v[148:151], v[32:35]
    ds_read_b64_tr_b16 v[60:61], v226 offset:0
    v_mfma_f32_16x16x32_bf16 v[32:35], v[64:67], v[144:147], v[32:35]
    ds_read_b64_tr_b16 v[62:63], v230 offset:0
    s_waitcnt lgkmcnt(8)
    v_mfma_f32_16x16x32_bf16 v[36:39], v[80:83], v[144:147], v[36:39]
    buffer_load_dwordx4 v[104:107], v12, s[52:55], s39 offen offset:2048 sc1
    buffer_load_dwordx4 v[108:111], v12, s[52:55], s39 offen offset:3072 sc1
    v_mfma_f32_16x16x32_bf16 v[36:39], v[84:87], v[148:151], v[36:39]
    ds_read_b64_tr_b16 v[64:65], v5 offset:53248
    v_mfma_f32_16x16x32_bf16 v[36:39], v[88:91], v[152:155], v[36:39]
    ds_read_b64_tr_b16 v[66:67], v9 offset:53248
    v_mfma_f32_16x16x32_bf16 v[36:39], v[92:95], v[156:159], v[36:39]
    ds_read_b64_tr_b16 v[68:69], v5 offset:57344
    v_mfma_f32_16x16x32_bf16 v[20:23], v[92:95], v[140:143], v[20:23]
    ds_read_b64_tr_b16 v[70:71], v9 offset:57344
    ds_read_b64_tr_b16 v[72:73], v5 offset:61440
    v_mfma_f32_16x16x32_bf16 v[20:23], v[88:91], v[136:139], v[20:23]
    ds_read_b64_tr_b16 v[74:75], v9 offset:61440
    v_mfma_f32_16x16x32_bf16 v[20:23], v[84:87], v[132:135], v[20:23]
    ds_read_b64_tr_b16 v[76:77], v227 offset:0
    v_mfma_f32_16x16x32_bf16 v[20:23], v[80:83], v[128:131], v[20:23]
    ds_read_b64_tr_b16 v[78:79], v231 offset:0
    s_waitcnt lgkmcnt(8)
    v_mfma_f32_16x16x32_bf16 v[24:27], v[48:51], v[128:131], v[24:27]
    buffer_load_dwordx4 v[112:115], v15, s[52:55], s39 offen offset:0 sc1
    buffer_load_dwordx4 v[116:119], v15, s[52:55], s39 offen offset:1024 sc1
    v_mfma_f32_16x16x32_bf16 v[24:27], v[52:55], v[132:135], v[24:27]
    ds_read_b64_tr_b16 v[80:81], v224 offset:4096
    v_mfma_f32_16x16x32_bf16 v[24:27], v[56:59], v[136:139], v[24:27]
    ds_read_b64_tr_b16 v[82:83], v228 offset:4096
    v_mfma_f32_16x16x32_bf16 v[24:27], v[60:63], v[140:143], v[24:27]
    ds_read_b64_tr_b16 v[84:85], v224 offset:8192
    v_mfma_f32_16x16x32_bf16 v[40:43], v[60:63], v[156:159], v[40:43]
    ds_read_b64_tr_b16 v[86:87], v228 offset:8192
    ds_read_b64_tr_b16 v[88:89], v224 offset:12288
    v_mfma_f32_16x16x32_bf16 v[40:43], v[56:59], v[152:155], v[40:43]
    ds_read_b64_tr_b16 v[90:91], v228 offset:12288
    v_mfma_f32_16x16x32_bf16 v[40:43], v[52:55], v[148:151], v[40:43]
    ds_read_b64_tr_b16 v[92:93], v224 offset:16384
    v_mfma_f32_16x16x32_bf16 v[40:43], v[48:51], v[144:147], v[40:43]
    ds_read_b64_tr_b16 v[94:95], v228 offset:16384
    s_waitcnt lgkmcnt(8)
    v_mfma_f32_16x16x32_bf16 v[44:47], v[64:67], v[144:147], v[44:47]
    buffer_load_dwordx4 v[120:123], v15, s[52:55], s39 offen offset:2048 sc1
    buffer_load_dwordx4 v[124:127], v15, s[52:55], s39 offen offset:3072 sc1
    v_mfma_f32_16x16x32_bf16 v[44:47], v[68:71], v[148:151], v[44:47]
    ds_read_b64_tr_b16 v[48:49], v225 offset:4096
    v_mfma_f32_16x16x32_bf16 v[44:47], v[72:75], v[152:155], v[44:47]
    ds_read_b64_tr_b16 v[50:51], v229 offset:4096
    v_mfma_f32_16x16x32_bf16 v[44:47], v[76:79], v[156:159], v[44:47]
    ds_read_b64_tr_b16 v[52:53], v225 offset:8192
    v_mfma_f32_16x16x32_bf16 v[28:31], v[76:79], v[140:143], v[28:31]
    ds_read_b64_tr_b16 v[54:55], v229 offset:8192
    ds_read_b64_tr_b16 v[56:57], v225 offset:12288
    v_mfma_f32_16x16x32_bf16 v[28:31], v[72:75], v[136:139], v[28:31]
    ds_read_b64_tr_b16 v[58:59], v229 offset:12288
    v_mfma_f32_16x16x32_bf16 v[28:31], v[68:71], v[132:135], v[28:31]
    ds_read_b64_tr_b16 v[60:61], v225 offset:16384
    v_mfma_f32_16x16x32_bf16 v[28:31], v[64:67], v[128:131], v[28:31]
    ds_read_b64_tr_b16 v[62:63], v229 offset:16384
    s_waitcnt vmcnt(8) lgkmcnt(8)
    v_mfma_f32_16x16x32_bf16 v[16:19], v[80:83], v[160:163], v[16:19]
    buffer_load_dwordx4 v[128:131], v12, s[52:55], s40 offen offset:0 sc1
    buffer_load_dwordx4 v[132:135], v12, s[52:55], s40 offen offset:1024 sc1
    v_mfma_f32_16x16x32_bf16 v[16:19], v[84:87], v[164:167], v[16:19]
    ds_read_b64_tr_b16 v[64:65], v226 offset:4096
    v_mfma_f32_16x16x32_bf16 v[16:19], v[88:91], v[168:171], v[16:19]
    ds_read_b64_tr_b16 v[66:67], v230 offset:4096
    v_mfma_f32_16x16x32_bf16 v[16:19], v[92:95], v[172:175], v[16:19]
    ds_read_b64_tr_b16 v[68:69], v226 offset:8192
    v_mfma_f32_16x16x32_bf16 v[32:35], v[92:95], v[188:191], v[32:35]
    ds_read_b64_tr_b16 v[70:71], v230 offset:8192
    ds_read_b64_tr_b16 v[72:73], v226 offset:12288
    v_mfma_f32_16x16x32_bf16 v[32:35], v[88:91], v[184:187], v[32:35]
    ds_read_b64_tr_b16 v[74:75], v230 offset:12288
    v_mfma_f32_16x16x32_bf16 v[32:35], v[84:87], v[180:183], v[32:35]
    ds_read_b64_tr_b16 v[76:77], v226 offset:16384
    v_mfma_f32_16x16x32_bf16 v[32:35], v[80:83], v[176:179], v[32:35]
    ds_read_b64_tr_b16 v[78:79], v230 offset:16384
    s_waitcnt lgkmcnt(8)
    v_mfma_f32_16x16x32_bf16 v[36:39], v[48:51], v[176:179], v[36:39]
    buffer_load_dwordx4 v[136:139], v12, s[52:55], s40 offen offset:2048 sc1
    buffer_load_dwordx4 v[140:143], v12, s[52:55], s40 offen offset:3072 sc1
    v_mfma_f32_16x16x32_bf16 v[36:39], v[52:55], v[180:183], v[36:39]
    ds_read_b64_tr_b16 v[80:81], v227 offset:4096
    v_mfma_f32_16x16x32_bf16 v[36:39], v[56:59], v[184:187], v[36:39]
    ds_read_b64_tr_b16 v[82:83], v231 offset:4096
    v_mfma_f32_16x16x32_bf16 v[36:39], v[60:63], v[188:191], v[36:39]
    ds_read_b64_tr_b16 v[84:85], v227 offset:8192
    v_mfma_f32_16x16x32_bf16 v[20:23], v[60:63], v[172:175], v[20:23]
    ds_read_b64_tr_b16 v[86:87], v231 offset:8192
    ds_read_b64_tr_b16 v[88:89], v227 offset:12288
    v_mfma_f32_16x16x32_bf16 v[20:23], v[56:59], v[168:171], v[20:23]
    ds_read_b64_tr_b16 v[90:91], v231 offset:12288
    v_mfma_f32_16x16x32_bf16 v[20:23], v[52:55], v[164:167], v[20:23]
    ds_read_b64_tr_b16 v[92:93], v227 offset:16384
    v_mfma_f32_16x16x32_bf16 v[20:23], v[48:51], v[160:163], v[20:23]
    ds_read_b64_tr_b16 v[94:95], v231 offset:16384
    s_waitcnt lgkmcnt(8)
    v_mfma_f32_16x16x32_bf16 v[24:27], v[64:67], v[160:163], v[24:27]
    buffer_load_dwordx4 v[144:147], v15, s[52:55], s40 offen offset:0 sc1
    buffer_load_dwordx4 v[148:151], v15, s[52:55], s40 offen offset:1024 sc1
    v_mfma_f32_16x16x32_bf16 v[24:27], v[68:71], v[164:167], v[24:27]
    ds_read_b64_tr_b16 v[48:49], v224 offset:20480
    v_mfma_f32_16x16x32_bf16 v[24:27], v[72:75], v[168:171], v[24:27]
    ds_read_b64_tr_b16 v[50:51], v228 offset:20480
    v_mfma_f32_16x16x32_bf16 v[24:27], v[76:79], v[172:175], v[24:27]
    ds_read_b64_tr_b16 v[52:53], v2 offset:0
    v_mfma_f32_16x16x32_bf16 v[40:43], v[76:79], v[188:191], v[40:43]
    ds_read_b64_tr_b16 v[54:55], v6 offset:0
    ds_read_b64_tr_b16 v[56:57], v2 offset:4096
    v_mfma_f32_16x16x32_bf16 v[40:43], v[72:75], v[184:187], v[40:43]
    ds_read_b64_tr_b16 v[58:59], v6 offset:4096
    v_mfma_f32_16x16x32_bf16 v[40:43], v[68:71], v[180:183], v[40:43]
    ds_read_b64_tr_b16 v[60:61], v2 offset:8192
    v_mfma_f32_16x16x32_bf16 v[40:43], v[64:67], v[176:179], v[40:43]
    ds_read_b64_tr_b16 v[62:63], v6 offset:8192
    s_waitcnt lgkmcnt(8)
    v_mfma_f32_16x16x32_bf16 v[44:47], v[80:83], v[176:179], v[44:47]
    buffer_load_dwordx4 v[152:155], v15, s[52:55], s40 offen offset:2048 sc1
    buffer_load_dwordx4 v[156:159], v15, s[52:55], s40 offen offset:3072 sc1
    v_mfma_f32_16x16x32_bf16 v[44:47], v[84:87], v[180:183], v[44:47]
    ds_read_b64_tr_b16 v[64:65], v225 offset:20480
    v_mfma_f32_16x16x32_bf16 v[44:47], v[88:91], v[184:187], v[44:47]
    ds_read_b64_tr_b16 v[66:67], v229 offset:20480
    v_mfma_f32_16x16x32_bf16 v[44:47], v[92:95], v[188:191], v[44:47]
    ds_read_b64_tr_b16 v[68:69], v3 offset:0
    v_mfma_f32_16x16x32_bf16 v[28:31], v[92:95], v[172:175], v[28:31]
    ds_read_b64_tr_b16 v[70:71], v7 offset:0
    ds_read_b64_tr_b16 v[72:73], v3 offset:4096
    v_mfma_f32_16x16x32_bf16 v[28:31], v[88:91], v[168:171], v[28:31]
    ds_read_b64_tr_b16 v[74:75], v7 offset:4096
    v_mfma_f32_16x16x32_bf16 v[28:31], v[84:87], v[164:167], v[28:31]
    ds_read_b64_tr_b16 v[76:77], v3 offset:8192
    v_mfma_f32_16x16x32_bf16 v[28:31], v[80:83], v[160:163], v[28:31]
    ds_read_b64_tr_b16 v[78:79], v7 offset:8192
    s_waitcnt vmcnt(8) lgkmcnt(8)
    v_mfma_f32_16x16x32_bf16 v[16:19], v[48:51], v[96:99], v[16:19]
    buffer_load_dwordx4 v[160:163], v12, s[52:55], s41 offen offset:0 sc1
    buffer_load_dwordx4 v[164:167], v12, s[52:55], s41 offen offset:1024 sc1
    v_mfma_f32_16x16x32_bf16 v[16:19], v[52:55], v[100:103], v[16:19]
    ds_read_b64_tr_b16 v[80:81], v226 offset:20480
    v_mfma_f32_16x16x32_bf16 v[16:19], v[56:59], v[104:107], v[16:19]
    ds_read_b64_tr_b16 v[82:83], v230 offset:20480
    v_mfma_f32_16x16x32_bf16 v[16:19], v[60:63], v[108:111], v[16:19]
    ds_read_b64_tr_b16 v[84:85], v4 offset:0
    v_mfma_f32_16x16x32_bf16 v[32:35], v[60:63], v[124:127], v[32:35]
    ds_read_b64_tr_b16 v[86:87], v8 offset:0
    ds_read_b64_tr_b16 v[88:89], v4 offset:4096
    v_mfma_f32_16x16x32_bf16 v[32:35], v[56:59], v[120:123], v[32:35]
    ds_read_b64_tr_b16 v[90:91], v8 offset:4096
    v_mfma_f32_16x16x32_bf16 v[32:35], v[52:55], v[116:119], v[32:35]
    ds_read_b64_tr_b16 v[92:93], v4 offset:8192
    v_mfma_f32_16x16x32_bf16 v[32:35], v[48:51], v[112:115], v[32:35]
    ds_read_b64_tr_b16 v[94:95], v8 offset:8192
    s_waitcnt lgkmcnt(8)
    v_mfma_f32_16x16x32_bf16 v[36:39], v[64:67], v[112:115], v[36:39]
    buffer_load_dwordx4 v[168:171], v12, s[52:55], s41 offen offset:2048 sc1
    buffer_load_dwordx4 v[172:175], v12, s[52:55], s41 offen offset:3072 sc1
    v_mfma_f32_16x16x32_bf16 v[36:39], v[68:71], v[116:119], v[36:39]
    ds_read_b64_tr_b16 v[48:49], v227 offset:20480
    v_mfma_f32_16x16x32_bf16 v[36:39], v[72:75], v[120:123], v[36:39]
    ds_read_b64_tr_b16 v[50:51], v231 offset:20480
    v_mfma_f32_16x16x32_bf16 v[36:39], v[76:79], v[124:127], v[36:39]
    ds_read_b64_tr_b16 v[52:53], v5 offset:0
    v_mfma_f32_16x16x32_bf16 v[20:23], v[76:79], v[108:111], v[20:23]
    ds_read_b64_tr_b16 v[54:55], v9 offset:0
    ds_read_b64_tr_b16 v[56:57], v5 offset:4096
    v_mfma_f32_16x16x32_bf16 v[20:23], v[72:75], v[104:107], v[20:23]
    ds_read_b64_tr_b16 v[58:59], v9 offset:4096
    v_mfma_f32_16x16x32_bf16 v[20:23], v[68:71], v[100:103], v[20:23]
    ds_read_b64_tr_b16 v[60:61], v5 offset:8192
    v_mfma_f32_16x16x32_bf16 v[20:23], v[64:67], v[96:99], v[20:23]
    ds_read_b64_tr_b16 v[62:63], v9 offset:8192
    s_waitcnt lgkmcnt(8)
    v_mfma_f32_16x16x32_bf16 v[24:27], v[80:83], v[96:99], v[24:27]
    buffer_load_dwordx4 v[176:179], v15, s[52:55], s41 offen offset:0 sc1
    buffer_load_dwordx4 v[180:183], v15, s[52:55], s41 offen offset:1024 sc1
    v_mfma_f32_16x16x32_bf16 v[24:27], v[84:87], v[100:103], v[24:27]
    ds_read_b64_tr_b16 v[64:65], v2 offset:12288
    v_mfma_f32_16x16x32_bf16 v[24:27], v[88:91], v[104:107], v[24:27]
    ds_read_b64_tr_b16 v[66:67], v6 offset:12288
    v_mfma_f32_16x16x32_bf16 v[24:27], v[92:95], v[108:111], v[24:27]
    ds_read_b64_tr_b16 v[68:69], v2 offset:16384
    v_mfma_f32_16x16x32_bf16 v[40:43], v[92:95], v[124:127], v[40:43]
    ds_read_b64_tr_b16 v[70:71], v6 offset:16384
    ds_read_b64_tr_b16 v[72:73], v2 offset:20480
    v_mfma_f32_16x16x32_bf16 v[40:43], v[88:91], v[120:123], v[40:43]
    ds_read_b64_tr_b16 v[74:75], v6 offset:20480
    v_mfma_f32_16x16x32_bf16 v[40:43], v[84:87], v[116:119], v[40:43]
    ds_read_b64_tr_b16 v[76:77], v224 offset:45056
    v_mfma_f32_16x16x32_bf16 v[40:43], v[80:83], v[112:115], v[40:43]
    ds_read_b64_tr_b16 v[78:79], v228 offset:45056
    s_waitcnt lgkmcnt(8)
    v_mfma_f32_16x16x32_bf16 v[44:47], v[48:51], v[112:115], v[44:47]
    buffer_load_dwordx4 v[184:187], v15, s[52:55], s41 offen offset:2048 sc1
    buffer_load_dwordx4 v[188:191], v15, s[52:55], s41 offen offset:3072 sc1
    v_mfma_f32_16x16x32_bf16 v[44:47], v[52:55], v[116:119], v[44:47]
    ds_read_b64_tr_b16 v[80:81], v3 offset:12288
    v_mfma_f32_16x16x32_bf16 v[44:47], v[56:59], v[120:123], v[44:47]
    ds_read_b64_tr_b16 v[82:83], v7 offset:12288
    v_mfma_f32_16x16x32_bf16 v[44:47], v[60:63], v[124:127], v[44:47]
    ds_read_b64_tr_b16 v[84:85], v3 offset:16384
    v_mfma_f32_16x16x32_bf16 v[28:31], v[60:63], v[108:111], v[28:31]
    ds_read_b64_tr_b16 v[86:87], v7 offset:16384
    ds_read_b64_tr_b16 v[88:89], v3 offset:20480
    v_mfma_f32_16x16x32_bf16 v[28:31], v[56:59], v[104:107], v[28:31]
    ds_read_b64_tr_b16 v[90:91], v7 offset:20480
    v_mfma_f32_16x16x32_bf16 v[28:31], v[52:55], v[100:103], v[28:31]
    ds_read_b64_tr_b16 v[92:93], v225 offset:45056
    v_mfma_f32_16x16x32_bf16 v[28:31], v[48:51], v[96:99], v[28:31]
    ds_read_b64_tr_b16 v[94:95], v229 offset:45056
    s_waitcnt vmcnt(8) lgkmcnt(8)
    v_mfma_f32_16x16x32_bf16 v[16:19], v[64:67], v[128:131], v[16:19]
    buffer_load_dwordx4 v[96:99], v12, s[52:55], s42 offen offset:0 sc1
    buffer_load_dwordx4 v[100:103], v12, s[52:55], s42 offen offset:1024 sc1
    v_mfma_f32_16x16x32_bf16 v[16:19], v[68:71], v[132:135], v[16:19]
    ds_read_b64_tr_b16 v[48:49], v4 offset:12288
    v_mfma_f32_16x16x32_bf16 v[16:19], v[72:75], v[136:139], v[16:19]
    ds_read_b64_tr_b16 v[50:51], v8 offset:12288
    v_mfma_f32_16x16x32_bf16 v[16:19], v[76:79], v[140:143], v[16:19]
    ds_read_b64_tr_b16 v[52:53], v4 offset:16384
    v_mfma_f32_16x16x32_bf16 v[32:35], v[76:79], v[156:159], v[32:35]
    ds_read_b64_tr_b16 v[54:55], v8 offset:16384
    ds_read_b64_tr_b16 v[56:57], v4 offset:20480
    v_mfma_f32_16x16x32_bf16 v[32:35], v[72:75], v[152:155], v[32:35]
    ds_read_b64_tr_b16 v[58:59], v8 offset:20480
    v_mfma_f32_16x16x32_bf16 v[32:35], v[68:71], v[148:151], v[32:35]
    ds_read_b64_tr_b16 v[60:61], v226 offset:45056
    v_mfma_f32_16x16x32_bf16 v[32:35], v[64:67], v[144:147], v[32:35]
    ds_read_b64_tr_b16 v[62:63], v230 offset:45056
    s_mov_b64 exec, 1
    ds_add_u32 v10, v11 offset:28
    s_mov_b64 exec, -1
    s_waitcnt lgkmcnt(9)
    v_mfma_f32_16x16x32_bf16 v[36:39], v[80:83], v[144:147], v[36:39]
    buffer_load_dwordx4 v[104:107], v12, s[52:55], s42 offen offset:2048 sc1
    buffer_load_dwordx4 v[108:111], v12, s[52:55], s42 offen offset:3072 sc1
    v_mfma_f32_16x16x32_bf16 v[36:39], v[84:87], v[148:151], v[36:39]
    ds_read_b64_tr_b16 v[64:65], v5 offset:12288
    v_mfma_f32_16x16x32_bf16 v[36:39], v[88:91], v[152:155], v[36:39]
    ds_read_b64_tr_b16 v[66:67], v9 offset:12288
    v_mfma_f32_16x16x32_bf16 v[36:39], v[92:95], v[156:159], v[36:39]
    ds_read_b64_tr_b16 v[68:69], v5 offset:16384
    v_mfma_f32_16x16x32_bf16 v[20:23], v[92:95], v[140:143], v[20:23]
    ds_read_b64_tr_b16 v[70:71], v9 offset:16384
    ds_read_b64_tr_b16 v[72:73], v5 offset:20480
    v_mfma_f32_16x16x32_bf16 v[20:23], v[88:91], v[136:139], v[20:23]
    ds_read_b64_tr_b16 v[74:75], v9 offset:20480
    v_mfma_f32_16x16x32_bf16 v[20:23], v[84:87], v[132:135], v[20:23]
    ds_read_b64_tr_b16 v[76:77], v227 offset:45056
    v_mfma_f32_16x16x32_bf16 v[20:23], v[80:83], v[128:131], v[20:23]
    ds_read_b64_tr_b16 v[78:79], v231 offset:45056
    s_waitcnt lgkmcnt(9)
    v_mfma_f32_16x16x32_bf16 v[24:27], v[48:51], v[128:131], v[24:27]
    buffer_load_dwordx4 v[112:115], v15, s[52:55], s42 offen offset:0 sc1
    buffer_load_dwordx4 v[116:119], v15, s[52:55], s42 offen offset:1024 sc1
    v_mfma_f32_16x16x32_bf16 v[24:27], v[52:55], v[132:135], v[24:27]
    ds_read_b64_tr_b16 v[80:81], v224 offset:49152
    v_mfma_f32_16x16x32_bf16 v[24:27], v[56:59], v[136:139], v[24:27]
    ds_read_b64_tr_b16 v[82:83], v228 offset:49152
    v_mfma_f32_16x16x32_bf16 v[24:27], v[60:63], v[140:143], v[24:27]
    ds_read_b64_tr_b16 v[84:85], v224 offset:53248
    v_mfma_f32_16x16x32_bf16 v[40:43], v[60:63], v[156:159], v[40:43]
    ds_read_b64_tr_b16 v[86:87], v228 offset:53248
    ds_read_b64_tr_b16 v[88:89], v224 offset:57344
    v_mfma_f32_16x16x32_bf16 v[40:43], v[56:59], v[152:155], v[40:43]
    ds_read_b64_tr_b16 v[90:91], v228 offset:57344
    v_mfma_f32_16x16x32_bf16 v[40:43], v[52:55], v[148:151], v[40:43]
    ds_read_b64_tr_b16 v[92:93], v2 offset:24576
    v_mfma_f32_16x16x32_bf16 v[40:43], v[48:51], v[144:147], v[40:43]
    ds_read_b64_tr_b16 v[94:95], v6 offset:24576
    s_waitcnt lgkmcnt(8)
    v_mfma_f32_16x16x32_bf16 v[44:47], v[64:67], v[144:147], v[44:47]
    buffer_load_dwordx4 v[120:123], v15, s[52:55], s42 offen offset:2048 sc1
    buffer_load_dwordx4 v[124:127], v15, s[52:55], s42 offen offset:3072 sc1
    v_mfma_f32_16x16x32_bf16 v[44:47], v[68:71], v[148:151], v[44:47]
    ds_read_b64_tr_b16 v[48:49], v225 offset:49152
    v_mfma_f32_16x16x32_bf16 v[44:47], v[72:75], v[152:155], v[44:47]
    ds_read_b64_tr_b16 v[50:51], v229 offset:49152
    v_mfma_f32_16x16x32_bf16 v[44:47], v[76:79], v[156:159], v[44:47]
    ds_read_b64_tr_b16 v[52:53], v225 offset:53248
    v_mfma_f32_16x16x32_bf16 v[28:31], v[76:79], v[140:143], v[28:31]
    ds_read_b64_tr_b16 v[54:55], v229 offset:53248
    ds_read_b64_tr_b16 v[56:57], v225 offset:57344
    v_mfma_f32_16x16x32_bf16 v[28:31], v[72:75], v[136:139], v[28:31]
    ds_read_b64_tr_b16 v[58:59], v229 offset:57344
    v_mfma_f32_16x16x32_bf16 v[28:31], v[68:71], v[132:135], v[28:31]
    ds_read_b64_tr_b16 v[60:61], v3 offset:24576
    v_mfma_f32_16x16x32_bf16 v[28:31], v[64:67], v[128:131], v[28:31]
    ds_read_b64_tr_b16 v[62:63], v7 offset:24576
    s_waitcnt vmcnt(8) lgkmcnt(8)
    v_mfma_f32_16x16x32_bf16 v[16:19], v[80:83], v[160:163], v[16:19]
    buffer_load_dwordx4 v[128:131], v12, s[52:55], s43 offen offset:0 sc1
    buffer_load_dwordx4 v[132:135], v12, s[52:55], s43 offen offset:1024 sc1
    v_mfma_f32_16x16x32_bf16 v[16:19], v[84:87], v[164:167], v[16:19]
    ds_read_b64_tr_b16 v[64:65], v226 offset:49152
    v_mfma_f32_16x16x32_bf16 v[16:19], v[88:91], v[168:171], v[16:19]
    ds_read_b64_tr_b16 v[66:67], v230 offset:49152
    v_mfma_f32_16x16x32_bf16 v[16:19], v[92:95], v[172:175], v[16:19]
    ds_read_b64_tr_b16 v[68:69], v226 offset:53248
    v_mfma_f32_16x16x32_bf16 v[32:35], v[92:95], v[188:191], v[32:35]
    ds_read_b64_tr_b16 v[70:71], v230 offset:53248
    ds_read_b64_tr_b16 v[72:73], v226 offset:57344
    v_mfma_f32_16x16x32_bf16 v[32:35], v[88:91], v[184:187], v[32:35]
    ds_read_b64_tr_b16 v[74:75], v230 offset:57344
    v_mfma_f32_16x16x32_bf16 v[32:35], v[84:87], v[180:183], v[32:35]
    ds_read_b64_tr_b16 v[76:77], v4 offset:24576
    v_mfma_f32_16x16x32_bf16 v[32:35], v[80:83], v[176:179], v[32:35]
    ds_read_b64_tr_b16 v[78:79], v8 offset:24576
    s_mov_b64 exec, 1
    ds_add_u32 v10, v11 offset:40
    s_mov_b64 exec, -1
    s_waitcnt lgkmcnt(9)
    v_mfma_f32_16x16x32_bf16 v[36:39], v[48:51], v[176:179], v[36:39]
    buffer_load_dwordx4 v[136:139], v12, s[52:55], s43 offen offset:2048 sc1
    buffer_load_dwordx4 v[140:143], v12, s[52:55], s43 offen offset:3072 sc1
    v_mfma_f32_16x16x32_bf16 v[36:39], v[52:55], v[180:183], v[36:39]
    ds_read_b32 v223, v10 offset:32
    v_mfma_f32_16x16x32_bf16 v[36:39], v[56:59], v[184:187], v[36:39]
    ds_read_b64_tr_b16 v[80:81], v227 offset:49152
    ds_read_b64_tr_b16 v[82:83], v231 offset:49152
    v_mfma_f32_16x16x32_bf16 v[36:39], v[60:63], v[188:191], v[36:39]
    ds_read_b64_tr_b16 v[84:85], v227 offset:53248
    v_mfma_f32_16x16x32_bf16 v[20:23], v[60:63], v[172:175], v[20:23]
    ds_read_b64_tr_b16 v[86:87], v231 offset:53248
    v_mfma_f32_16x16x32_bf16 v[20:23], v[56:59], v[168:171], v[20:23]
    ds_read_b64_tr_b16 v[88:89], v227 offset:57344
    ds_read_b64_tr_b16 v[90:91], v231 offset:57344
    v_mfma_f32_16x16x32_bf16 v[20:23], v[52:55], v[164:167], v[20:23]
    ds_read_b64_tr_b16 v[92:93], v5 offset:24576
    v_mfma_f32_16x16x32_bf16 v[20:23], v[48:51], v[160:163], v[20:23]
    ds_read_b64_tr_b16 v[94:95], v9 offset:24576
    s_waitcnt lgkmcnt(8)
    v_cmp_gt_u32 vcc, 4, v223
    s_cbranch_vccnz LB_w8
LB_g8:
    v_mfma_f32_16x16x32_bf16 v[24:27], v[64:67], v[160:163], v[24:27]
    buffer_load_dwordx4 v[144:147], v15, s[52:55], s43 offen offset:0 sc1
    buffer_load_dwordx4 v[148:151], v15, s[52:55], s43 offen offset:1024 sc1
    v_mfma_f32_16x16x32_bf16 v[24:27], v[68:71], v[164:167], v[24:27]
    ds_read_b64_tr_b16 v[48:49], v2 offset:28672
    v_mfma_f32_16x16x32_bf16 v[24:27], v[72:75], v[168:171], v[24:27]
    ds_read_b64_tr_b16 v[50:51], v6 offset:28672
    v_mfma_f32_16x16x32_bf16 v[24:27], v[76:79], v[172:175], v[24:27]
    ds_read_b64_tr_b16 v[52:53], v2 offset:32768
    v_mfma_f32_16x16x32_bf16 v[40:43], v[76:79], v[188:191], v[40:43]
    ds_read_b64_tr_b16 v[54:55], v6 offset:32768
    ds_read_b64_tr_b16 v[56:57], v232 offset:0
    v_mfma_f32_16x16x32_bf16 v[40:43], v[72:75], v[184:187], v[40:43]
    ds_read_b64_tr_b16 v[58:59], v236 offset:0
    v_mfma_f32_16x16x32_bf16 v[40:43], v[68:71], v[180:183], v[40:43]
    ds_read_b64_tr_b16 v[60:61], v232 offset:4096
    v_mfma_f32_16x16x32_bf16 v[40:43], v[64:67], v[176:179], v[40:43]
    ds_read_b64_tr_b16 v[62:63], v236 offset:4096
    s_waitcnt lgkmcnt(8)
    v_mfma_f32_16x16x32_bf16 v[44:47], v[80:83], v[176:179], v[44:47]
    buffer_load_dwordx4 v[152:155], v15, s[52:55], s43 offen offset:2048 sc1
    buffer_load_dwordx4 v[156:159], v15, s[52:55], s43 offen offset:3072 sc1
    v_mfma_f32_16x16x32_bf16 v[44:47], v[84:87], v[180:183], v[44:47]
    ds_read_b64_tr_b16 v[64:65], v3 offset:28672
    v_mfma_f32_16x16x32_bf16 v[44:47], v[88:91], v[184:187], v[44:47]
    ds_read_b64_tr_b16 v[66:67], v7 offset:28672
    v_mfma_f32_16x16x32_bf16 v[44:47], v[92:95], v[188:191], v[44:47]
    ds_read_b64_tr_b16 v[68:69], v3 offset:32768
    v_mfma_f32_16x16x32_bf16 v[28:31], v[92:95], v[172:175], v[28:31]
    ds_read_b64_tr_b16 v[70:71], v7 offset:32768
    ds_read_b64_tr_b16 v[72:73], v233 offset:0
    v_mfma_f32_16x16x32_bf16 v[28:31], v[88:91], v[168:171], v[28:31]
    ds_read_b64_tr_b16 v[74:75], v237 offset:0
    v_mfma_f32_16x16x32_bf16 v[28:31], v[84:87], v[164:167], v[28:31]
    ds_read_b64_tr_b16 v[76:77], v233 offset:4096
    v_mfma_f32_16x16x32_bf16 v[28:31], v[80:83], v[160:163], v[28:31]
    ds_read_b64_tr_b16 v[78:79], v237 offset:4096
    s_waitcnt vmcnt(8) lgkmcnt(8)
    v_mfma_f32_16x16x32_bf16 v[16:19], v[48:51], v[96:99], v[16:19]
    ds_read_b64_tr_b16 v[80:81], v4 offset:28672
    v_mfma_f32_16x16x32_bf16 v[16:19], v[52:55], v[100:103], v[16:19]
    ds_read_b64_tr_b16 v[82:83], v8 offset:28672
    v_mfma_f32_16x16x32_bf16 v[16:19], v[56:59], v[104:107], v[16:19]
    ds_read_b64_tr_b16 v[84:85], v4 offset:32768
    v_mfma_f32_16x16x32_bf16 v[16:19], v[60:63], v[108:111], v[16:19]
    ds_read_b64_tr_b16 v[86:87], v8 offset:32768
    v_mfma_f32_16x16x32_bf16 v[32:35], v[60:63], v[124:127], v[32:35]
    ds_read_b64_tr_b16 v[88:89], v234 offset:0
    v_mfma_f32_16x16x32_bf16 v[32:35], v[56:59], v[120:123], v[32:35]
    ds_read_b64_tr_b16 v[90:91], v238 offset:0
    v_mfma_f32_16x16x32_bf16 v[32:35], v[52:55], v[116:119], v[32:35]
    ds_read_b64_tr_b16 v[92:93], v234 offset:4096
    v_mfma_f32_16x16x32_bf16 v[32:35], v[48:51], v[112:115], v[32:35]
    ds_read_b64_tr_b16 v[94:95], v238 offset:4096
    s_waitcnt lgkmcnt(8)
    v_mfma_f32_16x16x32_bf16 v[36:39], v[64:67], v[112:115], v[36:39]
    ds_read_b64_tr_b16 v[48:49], v5 offset:28672
    v_mfma_f32_16x16x32_bf16 v[36:39], v[68:71], v[116:119], v[36:39]
    ds_read_b64_tr_b16 v[50:51], v9 offset:28672
    v_mfma_f32_16x16x32_bf16 v[36:39], v[72:75], v[120:123], v[36:39]
    ds_read_b64_tr_b16 v[52:53], v5 offset:32768
    v_mfma_f32_16x16x32_bf16 v[36:39], v[76:79], v[124:127], v[36:39]
    ds_read_b64_tr_b16 v[54:55], v9 offset:32768
    v_mfma_f32_16x16x32_bf16 v[20:23], v[76:79], v[108:111], v[20:23]
    ds_read_b64_tr_b16 v[56:57], v235 offset:0
    v_mfma_f32_16x16x32_bf16 v[20:23], v[72:75], v[104:107], v[20:23]
    ds_read_b64_tr_b16 v[58:59], v239 offset:0
    v_mfma_f32_16x16x32_bf16 v[20:23], v[68:71], v[100:103], v[20:23]
    ds_read_b64_tr_b16 v[60:61], v235 offset:4096
    v_mfma_f32_16x16x32_bf16 v[20:23], v[64:67], v[96:99], v[20:23]
    ds_read_b64_tr_b16 v[62:63], v239 offset:4096
    s_waitcnt lgkmcnt(8)
    v_mfma_f32_16x16x32_bf16 v[24:27], v[80:83], v[96:99], v[24:27]
    ds_read_b64_tr_b16 v[64:65], v232 offset:8192
    v_mfma_f32_16x16x32_bf16 v[24:27], v[84:87], v[100:103], v[24:27]
    ds_read_b64_tr_b16 v[66:67], v236 offset:8192
    v_mfma_f32_16x16x32_bf16 v[24:27], v[88:91], v[104:107], v[24:27]
    ds_read_b64_tr_b16 v[68:69], v232 offset:12288
    v_mfma_f32_16x16x32_bf16 v[24:27], v[92:95], v[108:111], v[24:27]
    ds_read_b64_tr_b16 v[70:71], v236 offset:12288
    v_mfma_f32_16x16x32_bf16 v[40:43], v[92:95], v[124:127], v[40:43]
    ds_read_b64_tr_b16 v[72:73], v232 offset:16384
    v_mfma_f32_16x16x32_bf16 v[40:43], v[88:91], v[120:123], v[40:43]
    ds_read_b64_tr_b16 v[74:75], v236 offset:16384
    v_mfma_f32_16x16x32_bf16 v[40:43], v[84:87], v[116:119], v[40:43]
    ds_read_b64_tr_b16 v[76:77], v232 offset:20480
    v_mfma_f32_16x16x32_bf16 v[40:43], v[80:83], v[112:115], v[40:43]
    ds_read_b64_tr_b16 v[78:79], v236 offset:20480
    s_waitcnt lgkmcnt(8)
    v_mfma_f32_16x16x32_bf16 v[44:47], v[48:51], v[112:115], v[44:47]
    ds_read_b64_tr_b16 v[80:81], v233 offset:8192
    v_mfma_f32_16x16x32_bf16 v[44:47], v[52:55], v[116:119], v[44:47]
    ds_read_b64_tr_b16 v[82:83], v237 offset:8192
    v_mfma_f32_16x16x32_bf16 v[44:47], v[56:59], v[120:123], v[44:47]
    ds_read_b64_tr_b16 v[84:85], v233 offset:12288
    v_mfma_f32_16x16x32_bf16 v[44:47], v[60:63], v[124:127], v[44:47]
    ds_read_b64_tr_b16 v[86:87], v237 offset:12288
    v_mfma_f32_16x16x32_bf16 v[28:31], v[60:63], v[108:111], v[28:31]
    ds_read_b64_tr_b16 v[88:89], v233 offset:16384
    v_mfma_f32_16x16x32_bf16 v[28:31], v[56:59], v[104:107], v[28:31]
    ds_read_b64_tr_b16 v[90:91], v237 offset:16384
    v_mfma_f32_16x16x32_bf16 v[28:31], v[52:55], v[100:103], v[28:31]
    ds_read_b64_tr_b16 v[92:93], v233 offset:20480
    v_mfma_f32_16x16x32_bf16 v[28:31], v[48:51], v[96:99], v[28:31]
    ds_read_b64_tr_b16 v[94:95], v237 offset:20480
    s_waitcnt vmcnt(0) lgkmcnt(8)
    v_mfma_f32_16x16x32_bf16 v[16:19], v[64:67], v[128:131], v[16:19]
    ds_read_b32 v223, v10 offset:40
    ds_read_b64_tr_b16 v[48:49], v234 offset:8192
    v_mfma_f32_16x16x32_bf16 v[16:19], v[68:71], v[132:135], v[16:19]
    ds_read_b64_tr_b16 v[50:51], v238 offset:8192
    v_mfma_f32_16x16x32_bf16 v[16:19], v[72:75], v[136:139], v[16:19]
    ds_read_b64_tr_b16 v[52:53], v234 offset:12288
    v_mfma_f32_16x16x32_bf16 v[16:19], v[76:79], v[140:143], v[16:19]
    ds_read_b64_tr_b16 v[54:55], v238 offset:12288
    v_mfma_f32_16x16x32_bf16 v[32:35], v[76:79], v[156:159], v[32:35]
    ds_read_b64_tr_b16 v[56:57], v234 offset:16384
    v_mfma_f32_16x16x32_bf16 v[32:35], v[72:75], v[152:155], v[32:35]
    ds_read_b64_tr_b16 v[58:59], v238 offset:16384
    v_mfma_f32_16x16x32_bf16 v[32:35], v[68:71], v[148:151], v[32:35]
    ds_read_b64_tr_b16 v[60:61], v234 offset:20480
    v_mfma_f32_16x16x32_bf16 v[32:35], v[64:67], v[144:147], v[32:35]
    ds_read_b64_tr_b16 v[62:63], v238 offset:20480
    s_waitcnt lgkmcnt(9)
    v_mfma_f32_16x16x32_bf16 v[36:39], v[80:83], v[144:147], v[36:39]
    ds_read_b64_tr_b16 v[64:65], v235 offset:8192
    v_mfma_f32_16x16x32_bf16 v[36:39], v[84:87], v[148:151], v[36:39]
    ds_read_b64_tr_b16 v[66:67], v239 offset:8192
    v_mfma_f32_16x16x32_bf16 v[36:39], v[88:91], v[152:155], v[36:39]
    ds_read_b64_tr_b16 v[68:69], v235 offset:12288
    v_mfma_f32_16x16x32_bf16 v[36:39], v[92:95], v[156:159], v[36:39]
    ds_read_b64_tr_b16 v[70:71], v239 offset:12288
    v_mfma_f32_16x16x32_bf16 v[20:23], v[92:95], v[140:143], v[20:23]
    ds_read_b64_tr_b16 v[72:73], v235 offset:16384
    v_mfma_f32_16x16x32_bf16 v[20:23], v[88:91], v[136:139], v[20:23]
    ds_read_b64_tr_b16 v[74:75], v239 offset:16384
    v_mfma_f32_16x16x32_bf16 v[20:23], v[84:87], v[132:135], v[20:23]
    ds_read_b64_tr_b16 v[76:77], v235 offset:20480
    v_mfma_f32_16x16x32_bf16 v[20:23], v[80:83], v[128:131], v[20:23]
    ds_read_b64_tr_b16 v[78:79], v239 offset:20480
    s_waitcnt lgkmcnt(8)
    v_cmp_gt_u32 vcc, 4, v223
    s_cbranch_vccnz LB_w7
LB_g7:
    v_mfma_f32_16x16x32_bf16 v[24:27], v[48:51], v[128:131], v[24:27]
    v_mfma_f32_16x16x32_bf16 v[24:27], v[52:55], v[132:135], v[24:27]
    v_mfma_f32_16x16x32_bf16 v[24:27], v[56:59], v[136:139], v[24:27]
    v_cvt_pk_bf16_f32 v200, v32, v33
    v_mfma_f32_16x16x32_bf16 v[24:27], v[60:63], v[140:143], v[24:27]
    v_cvt_pk_bf16_f32 v201, v34, v35
    v_mfma_f32_16x16x32_bf16 v[40:43], v[60:63], v[156:159], v[40:43]
    v_cvt_pk_bf16_f32 v202, v36, v37
    v_mfma_f32_16x16x32_bf16 v[40:43], v[56:59], v[152:155], v[40:43]
    v_cvt_pk_bf16_f32 v203, v38, v39
    v_permlane16_swap_b32 v200, v202
    v_mfma_f32_16x16x32_bf16 v[40:43], v[52:55], v[148:151], v[40:43]
    v_permlane16_swap_b32 v201, v203
    v_mfma_f32_16x16x32_bf16 v[40:43], v[48:51], v[144:147], v[40:43]
    ds_write_b128 v248, v[200:203] offset:2048
    s_waitcnt lgkmcnt(1)
    v_mfma_f32_16x16x32_bf16 v[44:47], v[64:67], v[144:147], v[44:47]
    v_cvt_pk_bf16_f32 v192, v16, v17
    v_mfma_f32_16x16x32_bf16 v[44:47], v[68:71], v[148:151], v[44:47]
    v_cvt_pk_bf16_f32 v193, v18, v19
    v_mfma_f32_16x16x32_bf16 v[44:47], v[72:75], v[152:155], v[44:47]
    v_cvt_pk_bf16_f32 v194, v20, v21
    v_mfma_f32_16x16x32_bf16 v[44:47], v[76:79], v[156:159], v[44:47]
    v_cvt_pk_bf16_f32 v195, v22, v23
    v_mfma_f32_16x16x32_bf16 v[28:31], v[76:79], v[140:143], v[28:31]
    v_permlane16_swap_b32 v192, v194
    v_mfma_f32_16x16x32_bf16 v[28:31], v[72:75], v[136:139], v[28:31]
    v_permlane16_swap_b32 v193, v195
    v_mfma_f32_16x16x32_bf16 v[28:31], v[68:71], v[132:135], v[28:31]
    ds_write_b128 v248, v[192:195] offset:0
    v_mfma_f32_16x16x32_bf16 v[28:31], v[64:67], v[128:131], v[28:31]
    v_cvt_pk_bf16_f32 v204, v40, v41
    v_cvt_pk_bf16_f32 v205, v42, v43
    v_cvt_pk_bf16_f32 v206, v44, v45
    v_cvt_pk_bf16_f32 v207, v46, v47
    s_nop 0
    v_permlane16_swap_b32 v204, v206
    v_permlane16_swap_b32 v205, v207
    ds_write_b128 v249, v[204:207] offset:2048
    ds_read_b128 v[56:59], v250 offset:2048
    ds_read_b128 v[60:63], v250 offset:3072
    v_cvt_pk_bf16_f32 v196, v24, v25
    v_cvt_pk_bf16_f32 v197, v26, v27
    v_cvt_pk_bf16_f32 v198, v28, v29
    v_cvt_pk_bf16_f32 v199, v30, v31
    s_nop 0
    v_permlane16_swap_b32 v196, v198
    v_permlane16_swap_b32 v197, v199
    ds_write_b128 v249, v[196:199] offset:0
    ds_read_b128 v[48:51], v250 offset:0
    ds_read_b128 v[52:55], v250 offset:1024
    s_mov_b32 s95, 65536
    s_waitcnt lgkmcnt(4)
    buffer_store_dwordx4 v[56:59], v246, s[60:63], s95 offen nt
    s_mov_b32 s95, 98304
    s_waitcnt lgkmcnt(3)
    buffer_store_dwordx4 v[60:63], v246, s[60:63], s95 offen nt
    s_mov_b32 s95, 0
    s_waitcnt lgkmcnt(1)
    buffer_store_dwordx4 v[48:51], v246, s[60:63], s95 offen nt
    s_mov_b32 s95, 32768
    s_waitcnt lgkmcnt(0)
    buffer_store_dwordx4 v[52:55], v246, s[60:63], s95 offen nt
    s_endpgm
LA_slow:
    s_mov_b32 s79, 0
LA_slow1:
    s_mov_b64 exec, vcc
    s_sleep 8
    buffer_load_dword v136, v33, s[68:71], 0 offen sc1
    buffer_load_dword v137, v34, s[52:55], 0 offen sc1
    s_add_u32 s79, s79, 1
    s_cmp_gt_u32 s79, 200000
    s_waitcnt vmcnt(0)
    s_cbranch_scc1 LA_back
    v_cmp_ne_u32 vcc, v136, v137
    v_cmp_gt_u32 s[80:81], s96, v136
    s_nop 0
    s_or_b64 vcc, vcc, s[80:81]
    s_cbranch_vccnz LA_slow1
    s_branch LA_back
LB_tag:
    s_mov_b64 exec, 0xffff
    s_waitcnt vmcnt(0)
    v_lshrrev_b32 v251, v0, v251
    v_and_b32 v251, 1, v251
    v_cmp_eq_u32 vcc, 0, v251
    s_nop 1
    s_or_b32 s83, vcc_lo, 0x10000
    s_mov_b64 exec, 1
    v_mov_b32 v251, s83
    buffer_store_dword v251, v220, s[68:71], s98 offen sc1
    s_mov_b64 exec, -1
    s_branch LB_tagb
LB_slow:
    s_mov_b32 s79, 0
LB_pt:
    buffer_load_dword v222, v220, s[68:71], s98 offen sc1
    s_add_u32 s79, s79, 1
    s_cmp_gt_u32 s79, 200000
    s_cbranch_scc1 LB_pt_x
    s_waitcnt vmcnt(0)
    v_cmp_gt_u32 vcc, 4096, v222
    s_cbranch_vccz LB_pt_x
    s_mov_b64 exec, vcc
    s_sleep 8
    s_branch LB_pt
LB_pt_x:
    s_waitcnt vmcnt(0)
    s_branch LB_back
LB_w1:
    s_branch LB_s1_in
LB_s1:
    s_sleep 1
LB_s1_in:
    ds_read_b32 v223, v10 offset:0
    ds_read_b64 v[204:205], v218
    ds_read_b64 v[206:207], v219
    s_waitcnt lgkmcnt(0)
    v_readfirstlane_b32 s78, v223
    s_nop 0
    s_cmp_ge_u32 s78, 4
    s_cbranch_scc0 LB_s1
    s_branch LB_g1
LB_w6:
    s_branch LB_s6_in
LB_s6:
    s_sleep 1
LB_s6_in:
    ds_read_b32 v223, v10 offset:24
    ds_read_b64 v[224:225], v218 offset:1024
    ds_read_b64 v[234:235], v219 offset:1024
    s_waitcnt lgkmcnt(0)
    v_readfirstlane_b32 s78, v223
    s_nop 0
    s_cmp_ge_u32 s78, 4
    s_cbranch_scc0 LB_s6
    s_branch LB_g6
LB_w4:
    s_branch LB_s4_in
LB_s4:
    s_sleep 1
LB_s4_in:
    ds_read_b32 v222, v10 offset:16
    s_waitcnt lgkmcnt(0)
    v_readfirstlane_b32 s78, v222
    s_nop 0
    s_cmp_ge_u32 s78, 4
    s_cbranch_scc0 LB_s4
    s_branch LB_g4
LB_w8:
    s_branch LB_s8_in
LB_s8:
    s_sleep 1
LB_s8_in:
    ds_read_b32 v223, v10 offset:32
    s_waitcnt lgkmcnt(0)
    v_readfirstlane_b32 s78, v223
    s_nop 0
    s_cmp_ge_u32 s78, 4
    s_cbranch_scc0 LB_s8
    s_branch LB_g8
LB_w7:
    s_branch LB_s7_in
LB_s7:
    s_sleep 1
LB_s7_in:
    ds_read_b32 v223, v10 offset:40
    s_waitcnt lgkmcnt(0)
    v_readfirstlane_b32 s78, v223
    s_nop 0
    s_cmp_ge_u32 s78, 4
    s_cbranch_scc0 LB_s7
    s_branch LB_g7
L_end:
    s_endpgm
.section .rodata,"a"
.p2align 6
.amdhsa_kernel concat_heads__ssm_conv_h3__sliding_local_dilated__prompt_kernel
  .amdhsa_next_free_vgpr 256
  .amdhsa_next_free_sgpr 102
  .amdhsa_accum_offset 256
  .amdhsa_group_segment_fixed_size 0
  .amdhsa_kernarg_size 96
  .amdhsa_user_sgpr_count 2
  .amdhsa_user_sgpr_kernarg_segment_ptr 1
  .amdhsa_system_sgpr_workgroup_id_x 1
.end_amdhsa_kernel
```

```asm
; @launch grid=(256,1,1) block=(512,1,1) lds=163840
.amdgcn_target "amdgcn-amd-amdhsa--gfx950"
.text
.globl concat_heads__ssm_conv_h3__sliding_local_dilated__prompt_kernel
.p2align 8
.type concat_heads__ssm_conv_h3__sliding_local_dilated__prompt_kernel,@function
concat_heads__ssm_conv_h3__sliding_local_dilated__prompt_kernel:
    s_cmp_ge_u32 s2, 256
    s_cbranch_scc1 L_end
    s_load_dwordx2 s[28:29], s[0:1], 48
    s_load_dwordx2 s[32:33], s[0:1], 56
    s_load_dwordx8 s[4:11], s[0:1], 0
    s_load_dwordx4 s[12:15], s[0:1], 32
    s_load_dwordx8 s[20:27], s[0:1], 64
    v_lshrrev_b32 v1, 6, v0
    v_and_b32 v0, 63, v0
    v_readfirstlane_b32 s3, v1
    s_nop 0
    s_cmp_lg_u32 s3, 4
    s_cbranch_scc1 L_nopf
    s_getpc_b64 s[80:81]
L_pc:
    s_bfe_u32 s78, s2, 0x40003
    v_lshl_add_u32 v1, v0, 4, s78
    v_lshlrev_b32 v1, 7, v1
    v_cmp_gt_u32 vcc, L_end-L_pc, v1
    s_nop 0
    s_and_saveexec_b64 s[82:83], vcc
    global_load_dword v222, v1, s[80:81]
    s_mov_b64 exec, -1
L_nopf:
    s_and_b32 s78, s2, 7
    s_lshr_b32 s79, s2, 3
    s_and_b32 s80, s78, 1
    s_lshl_b32 s80, s80, 3
    s_lshr_b32 s81, s78, 1
    s_lshl_b32 s81, s81, 2
    s_and_b32 s72, s79, 7
    s_add_u32 s72, s72, s80
    s_lshr_b32 s73, s79, 3
    s_xor_b32 s73, s73, 3
    s_add_u32 s73, s73, s81
    s_cmp_ge_u32 s3, 4
    s_cbranch_scc1 L_B
    v_lshrrev_b32 v5, 3, v0
    v_and_b32 v6, 7, v0
    v_lshrrev_b32 v7, 4, v0
    s_lshl_b32 s79, s72, 7
    s_lshl_b32 s80, s3, 5
    s_add_u32 s81, s79, s80
    v_xor_b32 v8, v7, v6
    v_lshlrev_b32 v8, 4, v8
    v_add_u32 v240, s81, v5
    v_lshl_add_u32 v240, v240, 11, v8
    v_xor_b32 v241, 64, v240
    v_add_u32 v241, 15360, v241
    v_add_u32 v242, 30720, v240
    v_add_u32 v243, 30720, v241
    s_lshl_b32 s87, s3, 12
    s_add_u32 s87, s87, 75776
    s_and_b32 s98, s73, 12
    s_and_b32 s78, s72, 8
    s_add_u32 s98, s98, s78
    s_add_u32 s101, s72, s73
    s_and_b32 s101, s101, 3
    s_lshl_b32 s78, s101, 2
    s_lshr_b32 s97, 0x101, s78
    s_add_u32 s97, s97, s98
    s_and_b32 s97, s97, 15
    s_lshr_b32 s99, s97, 3
    s_xor_b32 s97, s97, s99
    s_mov_b32 m0, s87
    s_lshl_b32 s97, s97, 7
    s_mov_b32 s30, 0x400000
    s_mov_b32 s31, 0x20000
    s_waitcnt lgkmcnt(0)
    buffer_load_dwordx4 v240, s[28:31], s97 offen offset:0  lds
    s_and_b32 s78, s3, 1
    s_lshl_b32 s78, s78, 2
    s_lshl_b32 s80, s3, 3
    v_and_b32 v8, 1, v7
    v_lshl_or_b32 v8, v8, 1, s78
    v_xor_b32 v8, v8, v6
    buffer_load_dwordx4 v241, s[28:31], s97 offen offset:1024  lds
    v_lshlrev_b32 v8, 4, v8
    v_add_u32 v244, s80, v5
    v_mul_u32_u24 v244, 6144, v244
    s_lshl_b32 s82, s73, 7
    v_add3_u32 v244, v244, v8, s82
    buffer_load_dwordx4 v242, s[28:31], s97 offen offset:2048  lds
    v_add_u32 v245, 1024, v244
    v_add_u32 v246, 2048, v244
    s_bfe_u32 s62, s72, 0x10002
    s_mul_i32 s78, s62, 12288
    s_mul_i32 s80, s3, 3072
    s_add_u32 s60, s80, s78
    buffer_load_dwordx4 v243, s[28:31], s97 offen offset:3072  lds
    s_sub_u32 s61, s80, s78
    s_mul_i32 s62, s62, 196608
    s_sub_u32 s63, 196608, s62
    s_mov_b32 s34, 0x600000
    s_mov_b32 s35, 0x20000
    s_mul_i32 s16, s97, 3072
    s_add_u32 m0, s60, 0
    s_add_u32 s99, s16, s62
    buffer_load_dwordx4 v244, s[32:35], s99 offen offset:0  lds
    s_lshl_b32 s78, s3, 1
    s_lshl_b32 s80, s3, 2
    s_add_u32 s79, s79, s80
    s_sub_u32 s79, s79, 16
    v_add_u32 v8, s78, v7
    buffer_load_dwordx4 v245, s[32:35], s99 offen offset:1024  lds
    v_xor_b32 v8, v8, v6
    v_and_b32 v8, 7, v8
    v_lshlrev_b32 v8, 4, v8
    v_add_u32 v3, s79, v5
    buffer_load_dwordx4 v246, s[32:35], s99 offen offset:2048  lds
    v_lshl_add_u32 v3, v3, 11, v8
    s_lshl_b32 s86, s3, 10
    s_lshl_b32 s88, s3, 9
    s_add_u32 s88, s88, 73728
    s_add_u32 m0, s88, 0
    s_mov_b64 exec, 0xffffffff
    buffer_load_dwordx4 v3, s[28:31], s97 offen offset:0  lds
    s_mov_b64 exec, -1
    s_add_u32 m0, s61, 12288
    s_add_u32 s16, s16, s63
    buffer_load_dwordx4 v244, s[32:35], s16 offen offset:0  lds
    buffer_load_dwordx4 v245, s[32:35], s16 offen offset:1024  lds
    buffer_load_dwordx4 v246, s[32:35], s16 offen offset:2048  lds
    s_mov_b32 s0, 0x76583240
    s_mov_b32 s1, 0xfedba9c
    s_cmp_eq_u32 s101, 1
    s_cselect_b32 s0, 0x76943251, s0
    s_cselect_b32 s1, 0xfecbad8, s1
    s_cmp_eq_u32 s101, 2
    s_cselect_b32 s0, 0x7a543620, s0
    s_cselect_b32 s1, 0xfdcbe98, s1
    s_cmp_eq_u32 s101, 3
    s_cselect_b32 s0, 0xb6547231, s0
    s_cselect_b32 s1, 0xedcfa98, s1
    s_and_b32 s78, s73, 7
    s_cmp_lg_u32 s78, 3
    s_cbranch_scc1 LA_nb
    s_cmp_eq_u32 s101, 2
    s_cselect_b32 s0, 0x87654320, s0
    s_cselect_b32 s1, 0xfdcbea9, s1
    s_cmp_eq_u32 s101, 3
    s_cselect_b32 s0, 0x87654231, s0
    s_cselect_b32 s1, 0xedcfba9, s1
LA_nb:
    s_add_u32 s79, s72, s73
    s_add_u32 s78, s72, 0
    s_and_b32 s78, s78, 7
    s_lshl_b32 s78, s78, 1
    s_and_b32 s75, s79, 1
    s_add_u32 s78, s78, s75
    s_andn2_b32 s79, 2, s79
    s_lshl_b32 s79, s79, 3
    s_add_u32 s78, s78, s79
    s_and_b32 s76, s78, 3
    s_and_b32 s79, s73, 12
    s_add_u32 s76, s76, s79
    s_lshr_b32 s74, s78, 4
    s_add_u32 s74, s74, s79
    s_and_b32 s79, s72, 8
    s_lshr_b32 s77, s78, 2
    s_add_u32 s77, s77, s79
    s_lshr_b32 s79, s79, 2
    s_add_u32 s74, s74, s79
    s_xor_b32 s74, s74, 4
    s_and_b32 s75, s78, 15
    s_add_u32 s97, s98, s0
    s_lshr_b64 s[0:1], s[0:1], 4
    s_and_b32 s97, s97, 15
    s_lshr_b32 s99, s97, 3
    s_xor_b32 s97, s97, s99
    s_add_u32 m0, s87, 18432
    s_lshl_b32 s97, s97, 7
    buffer_load_dwordx4 v240, s[28:31], s97 offen offset:0  lds
    s_mov_b32 s36, s6
    s_mov_b32 s37, s7
    s_mov_b32 s38, 0x400000
    s_mov_b32 s39, 0x20000
    s_mov_b32 s40, s8
    s_mov_b32 s41, s9
    s_mov_b32 s42, 0x400000
    s_mov_b32 s43, 0x20000
    s_mov_b32 s44, s10
    s_mov_b32 s45, s11
    s_mov_b32 s46, 0x2000
    s_mov_b32 s47, 0x20000
    v_lshlrev_b32 v15, 4, v0
    v_and_b32 v7, 7, v0
    s_lshl_b32 s79, s74, 7
    v_lshl_add_u32 v7, v7, 4, s79
    s_lshl_b32 s78, s75, 7
    s_lshl_b32 s80, s3, 3
    s_add_u32 s80, s80, s78
    v_lshrrev_b32 v5, 3, v0
    s_and_b32 s79, s3, 1
    v_xor_b32 v5, s79, v5
    v_add_u32 v5, s80, v5
    v_lshl_add_u32 v10, v5, 11, v7
    s_xor_b32 s80, s3, 1
    s_add_u32 s80, s78, s80
    s_sub_u32 s80, s80, 4
    s_lshl_b32 s80, s80, 11
    v_add_u32 v11, s80, v7
    s_mov_b32 s52, s26
    s_mov_b32 s53, s27
    s_mov_b32 s54, 0x1000000
    s_mov_b32 s55, 0x20000
    v_and_b32 v7, 7, v0
    s_lshl_b32 s79, s74, 7
    v_lshl_add_u32 v7, v7, 4, s79
    s_lshl_b32 s78, s75, 7
    v_bfe_u32 v5, v0, 3, 2
    v_lshrrev_b32 v6, 5, v0
    s_lshl_b32 s80, s3, 5
    v_lshlrev_b32 v8, 3, v5
    v_lshl_add_u32 v8, v6, 2, v8
    v_add_u32 v8, s80, v8
    v_and_b32 v35, 7, v0
    v_lshl_add_u32 v16, v35, 1, v6
    v_lshlrev_b32 v232, 5, v16
    v_lshlrev_b32 v16, 3, v16
    v_lshl_add_u32 v16, v5, 10, v16
    v_and_b32 v231, 1, v5
    v_lshl_add_u32 v16, v231, 7, v16
    s_lshl_b32 s79, s3, 12
    s_add_u32 s79, s79, 129024
    v_add_u32 v16, s79, v16
    v_xor_b32 v231, 128, v16
    v_lshrrev_b32 v35, 2, v35
    v_lshl_add_u32 v35, v35, 4, v232
    v_add_u32 v35, 162816, v35
    v_add_u32 v8, s78, v8
    v_lshl_add_u32 v9, v8, 11, v7
    v_lshl_add_u32 v13, v8, 12, v7
    v_bfe_u32 v8, v0, 2, 1
    v_lshlrev_b32 v8, 1, v8
    v_add_u32 v8, v8, v6
    v_lshlrev_b32 v8, 16, v8
    v_lshl_add_u32 v8, v5, 6, v8
    v_and_b32 v7, 3, v0
    v_lshl_add_u32 v8, v7, 4, v8
    s_add_u32 s78, s78, s80
    s_lshl_b32 s78, s78, 3
    s_lshl_b32 s79, s74, 18
    s_add_u32 s78, s78, s79
    v_add_u32 v12, s78, v8
    s_mov_b32 s48, s12
    s_mov_b32 s49, s13
    s_mov_b32 s50, 0x400000
    s_mov_b32 s51, 0x20000
    s_mov_b32 s56, s4
    s_mov_b32 s57, s5
    s_mov_b32 s58, 0x400000
    s_mov_b32 s59, 0x20000
    s_mov_b32 s64, s20
    s_mov_b32 s65, s21
    s_mov_b32 s66, 0x200000
    s_mov_b32 s67, 0x20000
    s_lshl_b32 s91, s74, 4
    s_add_u32 s91, s91, s75
    s_lshr_b32 s78, s91, 3
    s_lshl_b32 s78, s78, 5
    s_and_b32 s79, s91, 7
    s_add_u32 s78, s78, s79
    s_lshl_b32 s79, s3, 3
    s_add_u32 s90, s78, s79
    s_lshl_b32 s91, s91, 14
    s_mov_b32 s96, 4096
    s_mul_i32 s94, s3, 8320
    s_add_u32 s94, s94, 129024
    v_mov_b32 v229, 0
    s_mov_b64 s[4:5], s[64:65]
    s_mov_b32 s6, 0x0
    s_mov_b32 s7, 0x20000
    v_mov_b32 v228, 0x40000000
    s_bitcmp1_b32 s73, 2
    s_cbranch_scc1 LA_nh0
    s_mov_b64 s[4:5], s[28:29]
    s_mov_b32 s6, 0x400000
    v_mov_b32 v229, 0x40000000
    s_and_b32 s78, s73, 3
    s_cmp_eq_u32 s78, 3
    s_cbranch_scc1 LA_nh0
    s_add_u32 s78, s72, 1
    s_and_b32 s78, s78, 3
    s_bfe_u32 s80, s72, 0x10002
    s_lshl_b32 s81, s101, 2
    s_lshl_b32 s82, s78, 1
    s_cmp_lt_u32 s78, 2
    s_cselect_b32 s79, 12, 24
    s_cselect_b32 s82, s82, 0
    s_cselect_b32 s83, 6, 7
    s_add_u32 s81, s81, s83
    s_add_u32 s80, s80, s82
    s_lshl_b32 s80, s80, 2
    s_add_u32 s80, s80, s3
    s_mul_i32 s80, s80, s79
    s_add_u32 s82, s81, s78
    s_add_u32 s81, s81, s98
    s_and_b32 s81, s81, 15
    s_lshr_b32 s83, s81, 3
    s_xor_b32 s81, s81, s83
    s_mul_i32 s81, s81, 192
    s_add_u32 s80, s80, s81
    s_or_b32 s81, s73, 3
    s_lshl_b32 s81, s81, 7
    v_add_u32 v5, s80, v0
    v_lshl_add_u32 v5, v5, 11, s81
    v_cmp_gt_u32 vcc, s79, v0
    s_nop 1
    v_cndmask_b32 v228, v228, v5, vcc
    s_cmp_ge_u32 s78, 2
    s_cbranch_scc1 LA_nh0
    s_add_u32 s82, s82, s98
    s_and_b32 s82, s82, 15
    s_lshr_b32 s83, s82, 3
    s_xor_b32 s82, s82, s83
    s_lshl_b32 s78, s82, 7
    s_lshl_b32 s79, s72, 7
    s_mul_i32 s80, s3, 36
    s_add_u32 s79, s79, s80
    s_sub_u32 s79, s79, 16
    v_add_u32 v5, s79, v0
    v_lshl_add_u32 v5, v5, 11, s78
    v_cmp_gt_u32 vcc, 36, v0
    s_nop 1
    v_cndmask_b32 v229, v229, v5, vcc
LA_nh0:
    buffer_load_dwordx4 v241, s[28:31], s97 offen offset:1024  lds
    buffer_load_dwordx4 v242, s[28:31], s97 offen offset:2048  lds
    buffer_load_dwordx4 v243, s[28:31], s97 offen offset:3072  lds
    s_add_u32 m0, s88, 18432
    s_mov_b64 exec, 0xffffffff
    buffer_load_dwordx4 v3, s[28:31], s97 offen offset:0  lds
    s_mov_b64 exec, -1
    s_mul_i32 s16, s97, 3072
    s_add_u32 m0, s60, 24576
    s_add_u32 s99, s16, s62
    buffer_load_dwordx4 v244, s[32:35], s99 offen offset:0  lds
    buffer_load_dwordx4 v245, s[32:35], s99 offen offset:1024  lds
    buffer_load_dwordx4 v246, s[32:35], s99 offen offset:2048  lds
    s_add_u32 m0, s61, 36864
    s_add_u32 s16, s16, s63
    buffer_load_dwordx4 v244, s[32:35], s16 offen offset:0  lds
    buffer_load_dwordx4 v245, s[32:35], s16 offen offset:1024  lds
    buffer_load_dwordx4 v246, s[32:35], s16 offen offset:2048  lds
    s_waitcnt vmcnt(11)
    s_barrier
    s_add_u32 s97, s98, s0
    s_lshr_b64 s[0:1], s[0:1], 4
    s_and_b32 s97, s97, 15
    s_lshr_b32 s99, s97, 3
    s_xor_b32 s97, s97, s99
    s_add_u32 m0, s87, 36864
    s_lshl_b32 s97, s97, 7
    buffer_load_dwordx4 v240, s[28:31], s97 offen offset:0  lds
    buffer_load_dwordx4 v241, s[28:31], s97 offen offset:1024  lds
    buffer_load_dwordx4 v242, s[28:31], s97 offen offset:2048  lds
    buffer_load_dwordx4 v243, s[28:31], s97 offen offset:3072  lds
    s_add_u32 m0, s88, 36864
    s_mov_b64 exec, 0xffffffff
    buffer_load_dwordx4 v3, s[28:31], s97 offen offset:0  lds
    s_mov_b64 exec, -1
    s_cmp_eq_u32 s101, 1
    s_cbranch_scc1 LA_c1
    s_cmp_eq_u32 s101, 2
    s_cbranch_scc1 LA_c2
    s_cmp_eq_u32 s101, 3
    s_cbranch_scc1 LA_c3
LA_c0:
    s_waitcnt vmcnt(11)
    s_barrier
    s_mul_i32 s16, s97, 3072
    s_add_u32 m0, s60, 49152
    s_add_u32 s99, s16, s62
    buffer_load_dwordx4 v244, s[32:35], s99 offen offset:0  lds
    buffer_load_dwordx4 v245, s[32:35], s99 offen offset:1024  lds
    buffer_load_dwordx4 v246, s[32:35], s99 offen offset:2048  lds
    s_add_u32 m0, s61, 61440
    s_add_u32 s16, s16, s63
    buffer_load_dwordx4 v244, s[32:35], s16 offen offset:0  lds
    buffer_load_dwordx4 v245, s[32:35], s16 offen offset:1024  lds
    buffer_load_dwordx4 v246, s[32:35], s16 offen offset:2048  lds
    s_add_u32 s97, s98, s0
    s_lshr_b64 s[0:1], s[0:1], 4
    s_and_b32 s97, s97, 15
    s_lshr_b32 s99, s97, 3
    s_xor_b32 s97, s97, s99
    s_add_u32 m0, s87, 0
    s_lshl_b32 s97, s97, 7
    buffer_load_dwordx4 v240, s[28:31], s97 offen offset:0  lds
    buffer_load_dwordx4 v241, s[28:31], s97 offen offset:1024  lds
    buffer_load_dwordx4 v242, s[28:31], s97 offen offset:2048  lds
    buffer_load_dwordx4 v243, s[28:31], s97 offen offset:3072  lds
    s_add_u32 m0, s88, 0
    s_mov_b64 exec, 0xffffffff
    buffer_load_dwordx4 v3, s[28:31], s97 offen offset:0  lds
    s_mov_b64 exec, -1
    s_waitcnt vmcnt(11)
    s_barrier
    s_mul_i32 s16, s97, 3072
    s_add_u32 m0, s60, 0
    s_add_u32 s99, s16, s62
    buffer_load_dwordx4 v244, s[32:35], s99 offen offset:0  lds
    buffer_load_dwordx4 v245, s[32:35], s99 offen offset:1024  lds
    buffer_load_dwordx4 v246, s[32:35], s99 offen offset:2048  lds
    s_add_u32 m0, s61, 12288
    s_add_u32 s16, s16, s63
    buffer_load_dwordx4 v244, s[32:35], s16 offen offset:0  lds
    buffer_load_dwordx4 v245, s[32:35], s16 offen offset:1024  lds
    buffer_load_dwordx4 v246, s[32:35], s16 offen offset:2048  lds
    buffer_load_dword v230, v229, s[4:7], 0 offen
    buffer_load_dword v230, v228, s[32:35], 0 offen
    s_add_u32 m0, s86, 129536
    s_mov_b32 s89, 0
    buffer_load_dwordx4 v10, s[36:39], s89 offen nt lds
    s_add_u32 m0, s86, 145920
    s_mov_b32 s89, 0
    buffer_load_dwordx4 v10, s[40:43], s89 offen nt lds
    s_add_u32 m0, s86, 133632
    s_mov_b32 s89, 65536
    buffer_load_dwordx4 v10, s[36:39], s89 offen nt lds
    s_add_u32 m0, s86, 150016
    s_mov_b32 s89, 65536
    buffer_load_dwordx4 v10, s[40:43], s89 offen nt lds
    s_add_u32 m0, s86, 137728
    s_mov_b32 s89, 131072
    buffer_load_dwordx4 v10, s[36:39], s89 offen nt lds
    s_add_u32 m0, s86, 154112
    s_mov_b32 s89, 131072
    buffer_load_dwordx4 v10, s[40:43], s89 offen nt lds
    s_add_u32 m0, s86, 141824
    s_mov_b32 s89, 196608
    buffer_load_dwordx4 v10, s[36:39], s89 offen nt lds
    s_add_u32 m0, s86, 158208
    s_mov_b32 s89, 196608
    buffer_load_dwordx4 v10, s[40:43], s89 offen nt lds
    s_waitcnt vmcnt(16)
    s_barrier
    s_mov_b64 exec, 0xff
    s_lshl_b32 s82, s3, 7
    s_add_u32 m0, s82, 129024
    s_mov_b32 s89, 0
    buffer_load_dwordx4 v11, s[36:39], s89 offen nt lds
    s_lshl_b32 s83, s74, 9
    s_add_u32 s83, s83, s82
    s_and_b32 s89, s3, 2
    s_lshl_b32 s89, s89, 3
    s_add_u32 s82, s82, s89
    s_add_u32 m0, s82, 162816
    s_add_u32 s89, s83, 0
    buffer_load_dwordx4 v15, s[44:47], s89 offen  lds
    s_mov_b64 exec, -1
    s_add_u32 s97, s98, s0
    s_lshr_b64 s[0:1], s[0:1], 4
    s_and_b32 s97, s97, 15
    s_lshr_b32 s99, s97, 3
    s_xor_b32 s97, s97, s99
    s_add_u32 m0, s87, 18432
    s_lshl_b32 s97, s97, 7
    buffer_load_dwordx4 v240, s[28:31], s97 offen offset:0  lds
    buffer_load_dwordx4 v241, s[28:31], s97 offen offset:1024  lds
    buffer_load_dwordx4 v242, s[28:31], s97 offen offset:2048  lds
    buffer_load_dwordx4 v243, s[28:31], s97 offen offset:3072  lds
    s_add_u32 m0, s88, 18432
    s_mov_b64 exec, 0xffffffff
    buffer_load_dwordx4 v3, s[28:31], s97 offen offset:0  lds
    s_mov_b64 exec, -1
    s_mul_i32 s16, s97, 3072
    s_add_u32 m0, s60, 24576
    s_add_u32 s99, s16, s62
    buffer_load_dwordx4 v244, s[32:35], s99 offen offset:0  lds
    buffer_load_dwordx4 v245, s[32:35], s99 offen offset:1024  lds
    buffer_load_dwordx4 v246, s[32:35], s99 offen offset:2048  lds
    s_add_u32 m0, s61, 36864
    s_add_u32 s16, s16, s63
    buffer_load_dwordx4 v244, s[32:35], s16 offen offset:0  lds
    buffer_load_dwordx4 v245, s[32:35], s16 offen offset:1024  lds
    buffer_load_dwordx4 v246, s[32:35], s16 offen offset:2048  lds
    s_add_u32 s97, s98, s0
    s_lshr_b64 s[0:1], s[0:1], 4
    s_and_b32 s97, s97, 15
    s_lshr_b32 s99, s97, 3
    s_xor_b32 s97, s97, s99
    s_add_u32 m0, s87, 36864
    s_lshl_b32 s97, s97, 7
    buffer_load_dwordx4 v240, s[28:31], s97 offen offset:0  lds
    buffer_load_dwordx4 v241, s[28:31], s97 offen offset:1024  lds
    buffer_load_dwordx4 v242, s[28:31], s97 offen offset:2048  lds
    buffer_load_dwordx4 v243, s[28:31], s97 offen offset:3072  lds
    s_waitcnt vmcnt(10)
    s_barrier
    s_add_u32 m0, s88, 36864
    s_mov_b64 exec, 0xffffffff
    buffer_load_dwordx4 v3, s[28:31], s97 offen offset:0  lds
    s_mov_b64 exec, -1
    ds_read_b128 v[84:87], v35 offset:0
    ds_read_b128 v[88:91], v35 offset:16
    s_mul_i32 s16, s97, 3072
    s_add_u32 m0, s60, 49152
    s_add_u32 s99, s16, s62
    buffer_load_dwordx4 v244, s[32:35], s99 offen offset:0  lds
    ds_read_b64 v[40:41], v16 offset:0
    ds_read_b64 v[42:43], v231 offset:256
    buffer_load_dwordx4 v245, s[32:35], s99 offen offset:1024  lds
    ds_read_b64 v[44:45], v16 offset:256
    ds_read_b64 v[46:47], v16 offset:512
    buffer_load_dwordx4 v246, s[32:35], s99 offen offset:2048  lds
    ds_read_b64 v[48:49], v231 offset:512
    s_add_u32 m0, s61, 61440
    s_add_u32 s16, s16, s63
    buffer_load_dwordx4 v244, s[32:35], s16 offen offset:0  lds
    ds_read_b64 v[50:51], v16 offset:768
    ds_read_b64 v[52:53], v231 offset:768
    buffer_load_dwordx4 v245, s[32:35], s16 offen offset:1024  lds
    ds_read_b64 v[54:55], v16 offset:1024
    ds_read_b64 v[56:57], v231 offset:1024
    buffer_load_dwordx4 v246, s[32:35], s16 offen offset:2048  lds
    ds_read_b64 v[58:59], v16 offset:1280
    ds_read_b64 v[60:61], v231 offset:1280
    s_add_u32 s97, s98, s0
    s_lshr_b64 s[0:1], s[0:1], 4
    s_and_b32 s97, s97, 15
    s_lshr_b32 s99, s97, 3
    s_xor_b32 s97, s97, s99
    s_add_u32 m0, s87, 0
    s_lshl_b32 s97, s97, 7
    buffer_load_dwordx4 v240, s[28:31], s97 offen offset:0  lds
    ds_read_b64 v[68:69], v16 offset:16896
    buffer_load_dwordx4 v241, s[28:31], s97 offen offset:1024  lds
    ds_read_b64 v[70:71], v231 offset:16896
    ds_read_b64 v[72:73], v16 offset:17152
    buffer_load_dwordx4 v242, s[28:31], s97 offen offset:2048  lds
    ds_read_b64 v[74:75], v231 offset:17152
    ds_read_b64 v[76:77], v16 offset:17408
    buffer_load_dwordx4 v243, s[28:31], s97 offen offset:3072  lds
    ds_read_b64 v[78:79], v231 offset:17408
    ds_read_b64 v[80:81], v16 offset:17664
    s_add_u32 m0, s88, 0
    s_mov_b64 exec, 0xffffffff
    buffer_load_dwordx4 v3, s[28:31], s97 offen offset:0  lds
    s_mov_b64 exec, -1
    ds_read_b64 v[82:83], v231 offset:17664
    s_waitcnt vmcnt(11)
    s_waitcnt lgkmcnt(0)
    s_barrier
    s_mul_i32 s16, s97, 3072
    s_add_u32 m0, s60, 0
    s_add_u32 s99, s16, s62
    buffer_load_dwordx4 v244, s[32:35], s99 offen offset:0  lds
    v_lshlrev_b32 v160, 16, v40
    v_lshlrev_b32 v161, 16, v42
    v_lshlrev_b32 v162, 16, v44
    v_lshlrev_b32 v163, 16, v46
    v_lshlrev_b32 v164, 16, v48
    buffer_load_dwordx4 v245, s[32:35], s99 offen offset:1024  lds
    v_lshlrev_b32 v165, 16, v50
    v_lshlrev_b32 v166, 16, v52
    v_lshlrev_b32 v167, 16, v54
    v_lshlrev_b32 v168, 16, v56
    v_lshlrev_b32 v169, 16, v58
    buffer_load_dwordx4 v246, s[32:35], s99 offen offset:2048  lds
    v_lshlrev_b32 v170, 16, v60
    v_lshlrev_b32 v172, 16, v84
    v_and_b32 v173, 0xffff0000, v84
    v_lshlrev_b32 v174, 16, v85
    v_and_b32 v175, 0xffff0000, v85
    s_add_u32 m0, s61, 12288
    s_add_u32 s16, s16, s63
    buffer_load_dwordx4 v244, s[32:35], s16 offen offset:0  lds
    v_lshlrev_b32 v176, 16, v68
    v_lshlrev_b32 v177, 16, v70
    v_lshlrev_b32 v178, 16, v72
    v_lshlrev_b32 v179, 16, v74
    v_lshlrev_b32 v180, 16, v76
    buffer_load_dwordx4 v245, s[32:35], s16 offen offset:1024  lds
    v_lshlrev_b32 v181, 16, v78
    v_lshlrev_b32 v182, 16, v80
    v_lshlrev_b32 v183, 16, v82
    v_mul_f32 v184, v160, v175
    v_mul_f32 v185, v161, v175
    buffer_load_dwordx4 v246, s[32:35], s16 offen offset:2048  lds
    v_mul_f32 v186, v162, v175
    v_mul_f32 v187, v163, v175
    v_mul_f32 v188, v164, v175
    v_mul_f32 v189, v165, v175
    v_mul_f32 v190, v166, v175
    s_add_u32 s97, s98, s0
    s_lshr_b64 s[0:1], s[0:1], 4
    s_and_b32 s97, s97, 15
    s_lshr_b32 s99, s97, 3
    s_xor_b32 s97, s97, s99
    s_add_u32 m0, s87, 18432
    s_lshl_b32 s97, s97, 7
    buffer_load_dwordx4 v240, s[28:31], s97 offen offset:0  lds
    v_mul_f32 v191, v167, v175
    v_fmac_f32 v184, v161, v174
    v_fmac_f32 v185, v162, v174
    v_fmac_f32 v186, v163, v174
    v_fmac_f32 v187, v164, v174
    buffer_load_dwordx4 v241, s[28:31], s97 offen offset:1024  lds
    v_fmac_f32 v188, v165, v174
    v_fmac_f32 v189, v166, v174
    v_fmac_f32 v190, v167, v174
    v_fmac_f32 v191, v168, v174
    v_fmac_f32 v184, v162, v173
    buffer_load_dwordx4 v242, s[28:31], s97 offen offset:2048  lds
    v_fmac_f32 v185, v163, v173
    v_fmac_f32 v186, v164, v173
    v_fmac_f32 v187, v165, v173
    v_fmac_f32 v188, v166, v173
    v_fmac_f32 v189, v167, v173
    buffer_load_dwordx4 v243, s[28:31], s97 offen offset:3072  lds
    v_fmac_f32 v190, v168, v173
    v_fmac_f32 v191, v169, v173
    v_fmac_f32 v184, v163, v172
    v_fmac_f32 v185, v164, v172
    v_fmac_f32 v186, v165, v172
    s_add_u32 m0, s88, 18432
    s_mov_b64 exec, 0xffffffff
    buffer_load_dwordx4 v3, s[28:31], s97 offen offset:0  lds
    s_mov_b64 exec, -1
    v_fmac_f32 v187, v166, v172
    v_fmac_f32 v188, v167, v172
    v_fmac_f32 v189, v168, v172
    v_fmac_f32 v190, v169, v172
    v_fmac_f32 v191, v170, v172
    v_mul_f32 v184, v184, v176
    v_mul_f32 v185, v185, v177
    v_mul_f32 v186, v186, v178
    v_mul_f32 v187, v187, v179
    v_mul_f32 v188, v188, v180
    v_mul_f32 v189, v189, v181
    v_mul_f32 v190, v190, v182
    v_mul_f32 v191, v191, v183
    v_cvt_pk_bf16_f32 v100, v191, v190
    v_cvt_pk_bf16_f32 v101, v189, v188
    v_cvt_pk_bf16_f32 v102, v187, v186
    v_cvt_pk_bf16_f32 v103, v185, v184
    s_mov_b32 s89, 0
    buffer_store_dwordx4 v[100:103], v12, s[52:55], s89 offen sc1
    v_and_b32 v160, 0xffff0000, v40
    v_and_b32 v161, 0xffff0000, v42
    v_and_b32 v162, 0xffff0000, v44
    v_and_b32 v163, 0xffff0000, v46
    v_and_b32 v164, 0xffff0000, v48
    v_and_b32 v165, 0xffff0000, v50
    v_and_b32 v166, 0xffff0000, v52
    v_and_b32 v167, 0xffff0000, v54
    v_and_b32 v168, 0xffff0000, v56
    v_and_b32 v169, 0xffff0000, v58
    v_and_b32 v170, 0xffff0000, v60
    v_lshlrev_b32 v172, 16, v86
    v_and_b32 v173, 0xffff0000, v86
    v_lshlrev_b32 v174, 16, v87
    v_and_b32 v175, 0xffff0000, v87
    v_and_b32 v176, 0xffff0000, v68
    v_and_b32 v177, 0xffff0000, v70
    v_and_b32 v178, 0xffff0000, v72
    v_and_b32 v179, 0xffff0000, v74
    v_and_b32 v180, 0xffff0000, v76
    v_and_b32 v181, 0xffff0000, v78
    v_and_b32 v182, 0xffff0000, v80
    v_and_b32 v183, 0xffff0000, v82
    s_waitcnt vmcnt(12)
    s_barrier
    s_mul_i32 s16, s97, 3072
    s_add_u32 m0, s60, 24576
    s_add_u32 s99, s16, s62
    buffer_load_dwordx4 v244, s[32:35], s99 offen offset:0  lds
    v_mul_f32 v184, v160, v175
    v_mul_f32 v185, v161, v175
    v_mul_f32 v186, v162, v175
    v_mul_f32 v187, v163, v175
    v_mul_f32 v188, v164, v175
    buffer_load_dwordx4 v245, s[32:35], s99 offen offset:1024  lds
    v_mul_f32 v189, v165, v175
    v_mul_f32 v190, v166, v175
    v_mul_f32 v191, v167, v175
    v_fmac_f32 v184, v161, v174
    v_fmac_f32 v185, v162, v174
    buffer_load_dwordx4 v246, s[32:35], s99 offen offset:2048  lds
    v_fmac_f32 v186, v163, v174
    v_fmac_f32 v187, v164, v174
    v_fmac_f32 v188, v165, v174
    v_fmac_f32 v189, v166, v174
    v_fmac_f32 v190, v167, v174
    s_add_u32 m0, s61, 36864
    s_add_u32 s16, s16, s63
    buffer_load_dwordx4 v244, s[32:35], s16 offen offset:0  lds
    v_fmac_f32 v191, v168, v174
    v_fmac_f32 v184, v162, v173
    v_fmac_f32 v185, v163, v173
    v_fmac_f32 v186, v164, v173
    v_fmac_f32 v187, v165, v173
    buffer_load_dwordx4 v245, s[32:35], s16 offen offset:1024  lds
    v_fmac_f32 v188, v166, v173
    v_fmac_f32 v189, v167, v173
    v_fmac_f32 v190, v168, v173
    v_fmac_f32 v191, v169, v173
    v_fmac_f32 v184, v163, v172
    buffer_load_dwordx4 v246, s[32:35], s16 offen offset:2048  lds
    v_fmac_f32 v185, v164, v172
    v_fmac_f32 v186, v165, v172
    v_fmac_f32 v187, v166, v172
    v_fmac_f32 v188, v167, v172
    v_fmac_f32 v189, v168, v172
    s_add_u32 s97, s98, s0
    s_lshr_b64 s[0:1], s[0:1], 4
    s_and_b32 s97, s97, 15
    s_lshr_b32 s99, s97, 3
    s_xor_b32 s97, s97, s99
    s_add_u32 m0, s87, 36864
    s_lshl_b32 s97, s97, 7
    buffer_load_dwordx4 v240, s[28:31], s97 offen offset:0  lds
    v_fmac_f32 v190, v169, v172
    v_fmac_f32 v191, v170, v172
    v_mul_f32 v184, v184, v176
    v_mul_f32 v185, v185, v177
    v_mul_f32 v186, v186, v178
    buffer_load_dwordx4 v241, s[28:31], s97 offen offset:1024  lds
    v_mul_f32 v187, v187, v179
    v_mul_f32 v188, v188, v180
    v_mul_f32 v189, v189, v181
    v_mul_f32 v190, v190, v182
    v_mul_f32 v191, v191, v183
    buffer_load_dwordx4 v242, s[28:31], s97 offen offset:2048  lds
    v_cvt_pk_bf16_f32 v104, v191, v190
    v_cvt_pk_bf16_f32 v105, v189, v188
    v_cvt_pk_bf16_f32 v106, v187, v186
    v_cvt_pk_bf16_f32 v107, v185, v184
    s_mov_b32 s89, 16384
    buffer_store_dwordx4 v[104:107], v12, s[52:55], s89 offen sc1
    buffer_load_dwordx4 v243, s[28:31], s97 offen offset:3072  lds
    v_lshlrev_b32 v160, 16, v41
    v_lshlrev_b32 v161, 16, v43
    v_lshlrev_b32 v162, 16, v45
    v_lshlrev_b32 v163, 16, v47
    v_lshlrev_b32 v164, 16, v49
    s_add_u32 m0, s88, 36864
    s_mov_b64 exec, 0xffffffff
    buffer_load_dwordx4 v3, s[28:31], s97 offen offset:0  lds
    s_mov_b64 exec, -1
    v_lshlrev_b32 v165, 16, v51
    v_lshlrev_b32 v166, 16, v53
    v_lshlrev_b32 v167, 16, v55
    v_lshlrev_b32 v168, 16, v57
    v_lshlrev_b32 v169, 16, v59
    v_lshlrev_b32 v170, 16, v61
    v_lshlrev_b32 v172, 16, v88
    v_and_b32 v173, 0xffff0000, v88
    v_lshlrev_b32 v174, 16, v89
    v_and_b32 v175, 0xffff0000, v89
    v_lshlrev_b32 v176, 16, v69
    v_lshlrev_b32 v177, 16, v71
    v_lshlrev_b32 v178, 16, v73
    v_lshlrev_b32 v179, 16, v75
    v_lshlrev_b32 v180, 16, v77
    v_lshlrev_b32 v181, 16, v79
    v_lshlrev_b32 v182, 16, v81
    v_lshlrev_b32 v183, 16, v83
    v_mul_f32 v184, v160, v175
    v_mul_f32 v185, v161, v175
    v_mul_f32 v186, v162, v175
    v_mul_f32 v187, v163, v175
    v_mul_f32 v188, v164, v175
    v_mul_f32 v189, v165, v175
    v_mul_f32 v190, v166, v175
    v_mul_f32 v191, v167, v175
    v_fmac_f32 v184, v161, v174
    v_fmac_f32 v185, v162, v174
    v_fmac_f32 v186, v163, v174
    v_fmac_f32 v187, v164, v174
    v_fmac_f32 v188, v165, v174
    v_fmac_f32 v189, v166, v174
    v_fmac_f32 v190, v167, v174
    v_fmac_f32 v191, v168, v174
    v_fmac_f32 v184, v162, v173
    v_fmac_f32 v185, v163, v173
    v_fmac_f32 v186, v164, v173
    v_fmac_f32 v187, v165, v173
    v_fmac_f32 v188, v166, v173
    v_fmac_f32 v189, v167, v173
    v_fmac_f32 v190, v168, v173
    s_waitcnt vmcnt(13)
    s_barrier
    s_mul_i32 s16, s97, 3072
    s_add_u32 m0, s60, 49152
    s_add_u32 s99, s16, s62
    buffer_load_dwordx4 v244, s[32:35], s99 offen offset:0  lds
    v_fmac_f32 v191, v169, v173
    v_fmac_f32 v184, v163, v172
    v_fmac_f32 v185, v164, v172
    v_fmac_f32 v186, v165, v172
    v_fmac_f32 v187, v166, v172
    buffer_load_dwordx4 v245, s[32:35], s99 offen offset:1024  lds
    v_fmac_f32 v188, v167, v172
    v_fmac_f32 v189, v168, v172
    v_fmac_f32 v190, v169, v172
    v_fmac_f32 v191, v170, v172
    v_mul_f32 v184, v184, v176
    buffer_load_dwordx4 v246, s[32:35], s99 offen offset:2048  lds
    v_mul_f32 v185, v185, v177
    v_mul_f32 v186, v186, v178
    v_mul_f32 v187, v187, v179
    v_mul_f32 v188, v188, v180
    v_mul_f32 v189, v189, v181
    s_add_u32 m0, s61, 61440
    s_add_u32 s16, s16, s63
    buffer_load_dwordx4 v244, s[32:35], s16 offen offset:0  lds
    v_mul_f32 v190, v190, v182
    v_mul_f32 v191, v191, v183
    v_cvt_pk_bf16_f32 v108, v191, v190
    v_cvt_pk_bf16_f32 v109, v189, v188
    v_cvt_pk_bf16_f32 v110, v187, v186
    buffer_load_dwordx4 v245, s[32:35], s16 offen offset:1024  lds
    v_cvt_pk_bf16_f32 v111, v185, v184
    s_mov_b32 s89, 32768
    buffer_store_dwordx4 v[108:111], v12, s[52:55], s89 offen sc1
    v_and_b32 v160, 0xffff0000, v41
    v_and_b32 v161, 0xffff0000, v43
    v_and_b32 v162, 0xffff0000, v45
    buffer_load_dwordx4 v246, s[32:35], s16 offen offset:2048  lds
    v_and_b32 v163, 0xffff0000, v47
    v_and_b32 v164, 0xffff0000, v49
    v_and_b32 v165, 0xffff0000, v51
    v_and_b32 v166, 0xffff0000, v53
    v_and_b32 v167, 0xffff0000, v55
    s_add_u32 s97, s98, s0
    s_lshr_b64 s[0:1], s[0:1], 4
    s_and_b32 s97, s97, 15
    s_lshr_b32 s99, s97, 3
    s_xor_b32 s97, s97, s99
    s_add_u32 m0, s87, 0
    s_lshl_b32 s97, s97, 7
    buffer_load_dwordx4 v240, s[28:31], s97 offen offset:0  lds
    v_and_b32 v168, 0xffff0000, v57
    v_and_b32 v169, 0xffff0000, v59
    v_and_b32 v170, 0xffff0000, v61
    v_lshlrev_b32 v172, 16, v90
    v_and_b32 v173, 0xffff0000, v90
    buffer_load_dwordx4 v241, s[28:31], s97 offen offset:1024  lds
    v_lshlrev_b32 v174, 16, v91
    v_and_b32 v175, 0xffff0000, v91
    v_and_b32 v176, 0xffff0000, v69
    v_and_b32 v177, 0xffff0000, v71
    v_and_b32 v178, 0xffff0000, v73
    buffer_load_dwordx4 v242, s[28:31], s97 offen offset:2048  lds
    v_and_b32 v179, 0xffff0000, v75
    v_and_b32 v180, 0xffff0000, v77
    v_and_b32 v181, 0xffff0000, v79
    v_and_b32 v182, 0xffff0000, v81
    v_and_b32 v183, 0xffff0000, v83
    buffer_load_dwordx4 v243, s[28:31], s97 offen offset:3072  lds
    v_mul_f32 v184, v160, v175
    v_mul_f32 v185, v161, v175
    v_mul_f32 v186, v162, v175
    v_mul_f32 v187, v163, v175
    v_mul_f32 v188, v164, v175
    s_add_u32 m0, s88, 0
    s_mov_b64 exec, 0xffffffff
    buffer_load_dwordx4 v3, s[28:31], s97 offen offset:0  lds
    s_mov_b64 exec, -1
    v_mul_f32 v189, v165, v175
    v_mul_f32 v190, v166, v175
    v_mul_f32 v191, v167, v175
    v_fmac_f32 v184, v161, v174
    v_fmac_f32 v185, v162, v174
    v_fmac_f32 v186, v163, v174
    v_fmac_f32 v187, v164, v174
    v_fmac_f32 v188, v165, v174
    v_fmac_f32 v189, v166, v174
    v_fmac_f32 v190, v167, v174
    v_fmac_f32 v191, v168, v174
    v_fmac_f32 v184, v162, v173
    v_fmac_f32 v185, v163, v173
    v_fmac_f32 v186, v164, v173
    v_fmac_f32 v187, v165, v173
    v_fmac_f32 v188, v166, v173
    v_fmac_f32 v189, v167, v173
    v_fmac_f32 v190, v168, v173
    v_fmac_f32 v191, v169, v173
    v_fmac_f32 v184, v163, v172
    v_fmac_f32 v185, v164, v172
    v_fmac_f32 v186, v165, v172
    v_fmac_f32 v187, v166, v172
    v_fmac_f32 v188, v167, v172
    v_fmac_f32 v189, v168, v172
    v_fmac_f32 v190, v169, v172
    v_fmac_f32 v191, v170, v172
    v_mul_f32 v184, v184, v176
    v_mul_f32 v185, v185, v177
    v_mul_f32 v186, v186, v178
    v_mul_f32 v187, v187, v179
    v_mul_f32 v188, v188, v180
    v_mul_f32 v189, v189, v181
    v_mul_f32 v190, v190, v182
    v_mul_f32 v191, v191, v183
    v_cvt_pk_bf16_f32 v112, v191, v190
    v_cvt_pk_bf16_f32 v113, v189, v188
    v_cvt_pk_bf16_f32 v114, v187, v186
    v_cvt_pk_bf16_f32 v115, v185, v184
    s_mov_b32 s89, 49152
    buffer_store_dwordx4 v[112:115], v12, s[52:55], s89 offen sc1
    s_waitcnt vmcnt(13)
    s_barrier
    s_mul_i32 s16, s97, 3072
    s_add_u32 m0, s60, 0
    s_add_u32 s99, s16, s62
    buffer_load_dwordx4 v244, s[32:35], s99 offen offset:0  lds
    buffer_load_dwordx4 v245, s[32:35], s99 offen offset:1024  lds
    buffer_load_dwordx4 v246, s[32:35], s99 offen offset:2048  lds
    s_add_u32 m0, s61, 12288
    s_add_u32 s16, s16, s63
    buffer_load_dwordx4 v244, s[32:35], s16 offen offset:0  lds
    buffer_load_dwordx4 v245, s[32:35], s16 offen offset:1024  lds
    buffer_load_dwordx4 v246, s[32:35], s16 offen offset:2048  lds
    s_add_u32 s97, s98, s0
    s_lshr_b64 s[0:1], s[0:1], 4
    s_and_b32 s97, s97, 15
    s_lshr_b32 s99, s97, 3
    s_xor_b32 s97, s97, s99
    s_add_u32 m0, s87, 18432
    s_lshl_b32 s97, s97, 7
    buffer_load_dwordx4 v240, s[28:31], s97 offen offset:0  lds
    buffer_load_dwordx4 v241, s[28:31], s97 offen offset:1024  lds
    buffer_load_dwordx4 v242, s[28:31], s97 offen offset:2048  lds
    buffer_load_dwordx4 v243, s[28:31], s97 offen offset:3072  lds
    s_add_u32 m0, s88, 18432
    s_mov_b64 exec, 0xffffffff
    buffer_load_dwordx4 v3, s[28:31], s97 offen offset:0  lds
    s_mov_b64 exec, -1
    s_waitcnt vmcnt(12)
    s_barrier
    s_mul_i32 s16, s97, 3072
    s_add_u32 m0, s60, 24576
    s_add_u32 s99, s16, s62
    buffer_load_dwordx4 v244, s[32:35], s99 offen offset:0  lds
    buffer_load_dwordx4 v245, s[32:35], s99 offen offset:1024  lds
    buffer_load_dwordx4 v246, s[32:35], s99 offen offset:2048  lds
    s_add_u32 m0, s61, 36864
    s_add_u32 s16, s16, s63
    buffer_load_dwordx4 v244, s[32:35], s16 offen offset:0  lds
    buffer_load_dwordx4 v245, s[32:35], s16 offen offset:1024  lds
    buffer_load_dwordx4 v246, s[32:35], s16 offen offset:2048  lds
    s_add_u32 m0, s94, 32
    s_lshl_b32 s89, s90, 12
    buffer_load_dwordx4 v15, s[48:51], s89 offen offset:0 nt lds
    s_add_u32 m0, s94, 32
    s_lshl_b32 s89, s90, 12
    buffer_load_dwordx4 v15, s[48:51], s89 offen offset:1024 nt lds
    s_add_u32 m0, s94, 32
    s_lshl_b32 s89, s90, 12
    buffer_load_dwordx4 v15, s[48:51], s89 offen offset:2048 nt lds
    s_add_u32 m0, s94, 32
    s_lshl_b32 s89, s90, 12
    buffer_load_dwordx4 v15, s[48:51], s89 offen offset:3072 nt lds
    s_add_u32 s97, s98, s0
    s_lshr_b64 s[0:1], s[0:1], 4
    s_and_b32 s97, s97, 15
    s_lshr_b32 s99, s97, 3
    s_xor_b32 s97, s97, s99
    s_add_u32 m0, s87, 36864
    s_lshl_b32 s97, s97, 7
    buffer_load_dwordx4 v240, s[28:31], s97 offen offset:0  lds
    buffer_load_dwordx4 v241, s[28:31], s97 offen offset:1024  lds
    buffer_load_dwordx4 v242, s[28:31], s97 offen offset:2048  lds
    buffer_load_dwordx4 v243, s[28:31], s97 offen offset:3072  lds
    s_add_u32 m0, s88, 36864
    s_mov_b64 exec, 0xffffffff
    buffer_load_dwordx4 v3, s[28:31], s97 offen offset:0  lds
    s_mov_b64 exec, -1
    s_waitcnt vmcnt(15)
    s_barrier
    s_mul_i32 s16, s97, 3072
    s_add_u32 m0, s60, 49152
    s_add_u32 s99, s16, s62
    buffer_load_dwordx4 v244, s[32:35], s99 offen offset:0  lds
    s_mov_b32 s68, s24
    s_mov_b32 s69, s25
    s_mov_b32 s70, 0x100
    s_mov_b32 s71, 0x20000
    v_lshrrev_b32 v6, 5, v0
    buffer_load_dwordx4 v245, s[32:35], s99 offen offset:1024  lds
    v_and_b32 v7, 3, v0
    s_lshr_b32 s78, s90, 1
    s_lshl_b32 s78, s78, 2
    s_load_dword s92, s[14:15], s78
    v_bfe_u32 v5, v0, 2, 2
    buffer_load_dwordx4 v246, s[32:35], s99 offen offset:2048  lds
    v_lshlrev_b32 v5, 1, v5
    v_lshl_add_u32 v5, v6, 3, v5
    v_bfe_u32 v8, v0, 4, 1
    v_add_u32 v5, v5, v8
    s_and_b32 s78, s3, 1
    s_add_u32 m0, s61, 61440
    s_add_u32 s16, s16, s63
    buffer_load_dwordx4 v244, s[32:35], s16 offen offset:0  lds
    s_lshl_b32 s78, s78, 1
    v_add_u32 v8, s78, v6
    v_xor_b32 v8, v8, v7
    v_lshlrev_b32 v8, 4, v8
    buffer_load_dwordx4 v245, s[32:35], s16 offen offset:1024  lds
    v_lshl_add_u32 v5, v5, 6, v8
    v_add_u32 v14, s86, v5
    v_mov_b32 v18, 162304
    v_mov_b32 v19, 1
    v_and_b32 v5, 3, v0
    buffer_load_dwordx4 v246, s[32:35], s16 offen offset:2048  lds
    s_lshl_b32 s78, s74, 4
    s_add_u32 s78, s78, s3
    v_lshl_add_u32 v6, v5, 2, s78
    s_lshr_b32 s78, s76, 3
    s_lshl_b32 s79, s3, 1
    s_add_u32 s97, s98, s0
    s_lshr_b64 s[0:1], s[0:1], 4
    s_and_b32 s97, s97, 15
    s_lshr_b32 s99, s97, 3
    s_xor_b32 s97, s97, s99
    s_add_u32 m0, s87, 0
    s_lshl_b32 s97, s97, 7
    buffer_load_dwordx4 v240, s[28:31], s97 offen offset:0  lds
    s_add_u32 s78, s78, s79
    s_xor_b32 s78, s78, 2
    s_lshl_b32 s78, s78, 5
    s_add_u32 s79, s76, 0
    s_and_b32 s79, s79, 7
    buffer_load_dwordx4 v241, s[28:31], s97 offen offset:1024  lds
    s_lshl_b32 s79, s79, 1
    s_add_u32 s78, s78, s79
    v_mul_u32_u24 v7, 9, v5
    v_and_b32 v7, 17, v7
    buffer_load_dwordx4 v242, s[28:31], s97 offen offset:2048  lds
    v_add_u32 v7, s78, v7
    v_and_b32 v8, 4, v0
    v_cmp_eq_u32 vcc, 0, v8
    s_nop 1
    v_cndmask_b32 v6, v7, v6, vcc
    v_and_b32 v33, 0xf0, v6
    buffer_load_dwordx4 v243, s[28:31], s97 offen offset:3072  lds
    v_lshlrev_b32 v34, 8, v6
    v_add_u32 v34, 12582912, v34
    v_and_b32 v5, 15, v0
    v_lshrrev_b32 v6, 4, v0
    v_add_u32 v7, 9, v5
    s_add_u32 m0, s88, 0
    s_mov_b64 exec, 0xffffffff
    buffer_load_dwordx4 v3, s[28:31], s97 offen offset:0  lds
    s_mov_b64 exec, -1
    v_and_b32 v8, 1, v7
    v_mul_u32_u24 v8, 4160, v8
    v_lshrrev_b32 v7, 1, v7
    v_lshl_add_u32 v8, v7, 2, v8
    s_waitcnt vmcnt(11)
    s_barrier
    s_mul_i32 s16, s97, 3072
    s_add_u32 m0, s60, 0
    s_add_u32 s99, s16, s62
    buffer_load_dwordx4 v244, s[32:35], s99 offen offset:0  lds
    v_lshlrev_b32 v7, 4, v6
    v_sub_u32 v8, v8, v7
    s_add_u32 s78, s94, 32
    v_add_u32 v21, s78, v8
    v_add_u32 v22, 1024, v21
    buffer_load_dwordx4 v245, s[32:35], s99 offen offset:1024  lds
    v_add_u32 v23, 2048, v21
    v_add_u32 v24, 3072, v21
    v_lshl_add_u32 v7, v5, 1, v6
    v_add_u32 v7, 30, v7
    v_and_b32 v8, 1, v7
    buffer_load_dwordx4 v246, s[32:35], s99 offen offset:2048  lds
    v_bfe_u32 v136, v7, 1, 2
    v_lshl_add_u32 v136, v8, 2, v136
    v_lshlrev_b32 v136, 6, v136
    v_lshrrev_b32 v7, 3, v7
    v_lshl_add_u32 v136, v7, 9, v136
    s_add_u32 m0, s61, 12288
    s_add_u32 s16, s16, s63
    buffer_load_dwordx4 v244, s[32:35], s16 offen offset:0  lds
    v_bitop3_b32 v8, v7, 3, s3 bitop3:0x6a
    v_lshl_add_u32 v25, v8, 4, v136
    v_add_u32 v25, 92160, v25
    v_subrev_u32 v7, 1, v7
    buffer_load_dwordx4 v245, s[32:35], s16 offen offset:1024  lds
    v_bitop3_b32 v8, v7, 3, s3 bitop3:0x6a
    v_lshl_add_u32 v27, v8, 4, v136
    v_add_u32 v27, 91648, v27
    v_subrev_u32 v7, 1, v7
    v_bitop3_b32 v8, v7, 3, s3 bitop3:0x6a
    buffer_load_dwordx4 v246, s[32:35], s16 offen offset:2048  lds
    v_lshl_add_u32 v29, v8, 4, v136
    v_add_u32 v29, 91136, v29
    v_subrev_u32 v7, 1, v7
    v_bitop3_b32 v8, v7, 3, s3 bitop3:0x6a
    v_lshl_add_u32 v31, v8, 4, v136
    s_add_u32 s97, s98, s0
    s_lshr_b64 s[0:1], s[0:1], 4
    s_and_b32 s97, s97, 15
    s_lshr_b32 s99, s97, 3
    s_xor_b32 s97, s97, s99
    s_add_u32 m0, s87, 18432
    s_lshl_b32 s97, s97, 7
    buffer_load_dwordx4 v240, s[28:31], s97 offen offset:0  lds
    v_add_u32 v31, 90624, v31
    v_lshl_add_u32 v7, v5, 1, v6
    v_add_u32 v7, 26, v7
    v_and_b32 v8, 1, v7
    v_bfe_u32 v136, v7, 1, 2
    buffer_load_dwordx4 v241, s[28:31], s97 offen offset:1024  lds
    v_lshl_add_u32 v136, v8, 2, v136
    v_lshlrev_b32 v136, 6, v136
    v_lshrrev_b32 v7, 3, v7
    v_lshl_add_u32 v136, v7, 9, v136
    buffer_load_dwordx4 v242, s[28:31], s97 offen offset:2048  lds
    v_bitop3_b32 v8, v7, 3, s3 bitop3:0x6a
    v_lshl_add_u32 v26, v8, 4, v136
    v_add_u32 v26, 92160, v26
    v_subrev_u32 v7, 1, v7
    v_bitop3_b32 v8, v7, 3, s3 bitop3:0x6a
    buffer_load_dwordx4 v243, s[28:31], s97 offen offset:3072  lds
    v_lshl_add_u32 v28, v8, 4, v136
    v_add_u32 v28, 91648, v28
    v_subrev_u32 v7, 1, v7
    v_bitop3_b32 v8, v7, 3, s3 bitop3:0x6a
    v_lshl_add_u32 v30, v8, 4, v136
    s_add_u32 m0, s88, 18432
    s_mov_b64 exec, 0xffffffff
    buffer_load_dwordx4 v3, s[28:31], s97 offen offset:0  lds
    s_mov_b64 exec, -1
    v_add_u32 v30, 91136, v30
    v_subrev_u32 v7, 1, v7
    v_bitop3_b32 v8, v7, 3, s3 bitop3:0x6a
    v_lshl_add_u32 v32, v8, 4, v136
    s_waitcnt vmcnt(11)
    s_barrier
    s_mul_i32 s16, s97, 3072
    s_add_u32 m0, s60, 24576
    s_add_u32 s99, s16, s62
    buffer_load_dwordx4 v244, s[32:35], s99 offen offset:0  lds
    v_add_u32 v32, 90624, v32
    v_lshrrev_b32 v7, 1, v6
    v_lshl_add_u32 v7, v5, 1, v7
    v_add_u32 v7, 32, v7
    v_and_b32 v8, 1, v7
    buffer_load_dwordx4 v245, s[32:35], s99 offen offset:1024  lds
    v_bfe_u32 v136, v7, 1, 2
    v_lshl_add_u32 v136, v8, 2, v136
    v_lshlrev_b32 v136, 6, v136
    v_lshrrev_b32 v7, 3, v7
    buffer_load_dwordx4 v246, s[32:35], s99 offen offset:2048  lds
    v_lshl_add_u32 v136, v7, 9, v136
    v_bitop3_b32 v8, v7, 3, s3 bitop3:0x6a
    v_lshl_add_u32 v20, v8, 4, v136
    v_add_u32 v20, 92160, v20
    v_and_b32 v8, 1, v6
    s_add_u32 m0, s61, 36864
    s_add_u32 s16, s16, s63
    buffer_load_dwordx4 v244, s[32:35], s16 offen offset:0  lds
    v_xor_b32 v8, 1, v8
    v_lshl_add_u32 v20, v8, 3, v20
    s_waitcnt lgkmcnt(0)
    s_and_b32 s78, s92, 0xffff0000
    buffer_load_dwordx4 v245, s[32:35], s16 offen offset:1024  lds
    s_lshl_b32 s92, s92, 16
    s_bitcmp1_b32 s90, 0
    s_cselect_b32 s92, s78, s92
    v_lshlrev_b32 v7, 3, v6
    v_sub_u32 v7, v7, v5
    buffer_load_dwordx4 v246, s[32:35], s16 offen offset:2048  lds
    v_subrev_u32 v7, 9, v7
    v_and_b32 v8, 1, v7
    v_xor_b32 v8, 1, v8
    v_lshlrev_b32 v8, 4, v8
    v_lshrrev_b32 v8, v8, s92
    s_add_u32 s97, s98, s0
    s_lshr_b64 s[0:1], s[0:1], 4
    s_and_b32 s97, s97, 15
    s_lshr_b32 s99, s97, 3
    s_xor_b32 s97, s97, s99
    s_add_u32 m0, s87, 36864
    s_lshl_b32 s97, s97, 7
    buffer_load_dwordx4 v240, s[28:31], s97 offen offset:0  lds
    v_ashrrev_i32 v7, 1, v7
    v_cmp_eq_u32 vcc, 0, v7
    s_nop 1
    v_cndmask_b32 v236, 0, v8, vcc
    v_cmp_eq_u32 vcc, 1, v7
    buffer_load_dwordx4 v241, s[28:31], s97 offen offset:1024  lds
    s_nop 0
    v_cndmask_b32 v237, 0, v8, vcc
    v_cmp_eq_u32 vcc, 2, v7
    s_nop 1
    v_cndmask_b32 v238, 0, v8, vcc
    v_cmp_eq_u32 vcc, 3, v7
    buffer_load_dwordx4 v242, s[28:31], s97 offen offset:2048  lds
    s_nop 0
    v_cndmask_b32 v239, 0, v8, vcc
    s_and_b32 s78, s77, 7
    s_mov_b32 s95, 0x76543210
    s_cmp_eq_u32 s78, 1
    s_cselect_b32 s95, 0x76543201, s95
    s_cmp_eq_u32 s78, 2
    s_cselect_b32 s95, 0x76543120, s95
    s_cmp_eq_u32 s78, 3
    s_cselect_b32 s95, 0x76542310, s95
    s_cmp_eq_u32 s78, 4
    s_cselect_b32 s95, 0x76534210, s95
    s_cmp_eq_u32 s78, 5
    s_cselect_b32 s95, 0x76453210, s95
    s_cmp_eq_u32 s78, 6
    s_cselect_b32 s95, 0x75643210, s95
    s_cmp_eq_u32 s78, 7
    s_cselect_b32 s95, 0x67543210, s95
    s_and_b32 s78, s76, 3
    s_mul_i32 s78, s78, 0x22222222
    s_add_u32 s95, s95, s78
    s_bfe_u32 s100, s95, 0x3001c
    s_lshl_b32 s100, s100, 18
    s_bfe_u32 s95, s95, 0x30018
    s_lshl_b32 s95, s95, 18
    v_lshrrev_b32 v136, 4, v0
    v_lshlrev_b32 v136, 1, v136
    v_and_b32 v137, 7, v0
    buffer_load_dwordx4 v243, s[28:31], s97 offen offset:3072  lds
    v_xor_b32 v136, v136, v137
    v_lshlrev_b32 v136, 4, v136
    v_lshrrev_b32 v137, 3, v0
    v_lshl_add_u32 v136, v137, 11, v136
    s_add_u32 m0, s88, 36864
    s_mov_b64 exec, 0xffffffff
    buffer_load_dwordx4 v3, s[28:31], s97 offen offset:0  lds
    s_mov_b64 exec, -1
    s_lshl_b32 s78, s77, 7
    s_lshl_b32 s79, s3, 14
    s_add_u32 s78, s78, s79
    v_add_u32 v17, s78, v136
    s_waitcnt vmcnt(11)
    s_barrier
    s_mul_i32 s16, s97, 3072
    s_add_u32 m0, s60, 49152
    s_add_u32 s99, s16, s62
    buffer_load_dwordx4 v244, s[32:35], s99 offen offset:0  lds
    v_add_u32 v5, s94, v15
    ds_read_b128 v[140:143], v5 offset:32
    ds_read_b32 v156, v5 offset:48
    ds_read_b128 v[144:147], v5 offset:1056
    buffer_load_dwordx4 v245, s[32:35], s99 offen offset:1024  lds
    ds_read_b32 v157, v5 offset:1072
    ds_read_b128 v[148:151], v5 offset:2080
    ds_read_b32 v158, v5 offset:2096
    ds_read_b128 v[152:155], v5 offset:3104
    buffer_load_dwordx4 v246, s[32:35], s99 offen offset:2048  lds
    ds_read_b32 v159, v5 offset:3120
    v_lshrrev_b32 v6, 3, v0
    v_mul_u32_u24 v6, 4160, v6
    s_add_u32 m0, s61, 61440
    s_add_u32 s16, s16, s63
    buffer_load_dwordx4 v244, s[32:35], s16 offen offset:0  lds
    v_and_b32 v7, 7, v0
    v_lshl_add_u32 v6, v7, 2, v6
    v_add_u32 v6, s94, v6
    v_mov_b32 v7, 0
    buffer_load_dwordx4 v245, s[32:35], s16 offen offset:1024  lds
    s_waitcnt lgkmcnt(0)
    v_readfirstlane_b32 s93, v140
    s_nop 0
    s_lshl_b32 s93, s93, 16
    s_nop 1
    v_writelane_b32 v7, s93, 15
    buffer_load_dwordx4 v246, s[32:35], s16 offen offset:2048  lds
    v_alignbit_b32 v140, v141, v140, 16
    v_alignbit_b32 v141, v142, v141, 16
    v_alignbit_b32 v142, v143, v142, 16
    s_add_u32 s97, s98, s0
    s_lshr_b64 s[0:1], s[0:1], 4
    s_and_b32 s97, s97, 15
    s_lshr_b32 s99, s97, 3
    s_xor_b32 s97, s97, s99
    s_add_u32 m0, s87, 0
    s_lshl_b32 s97, s97, 7
    buffer_load_dwordx4 v240, s[28:31], s97 offen offset:0  lds
    v_alignbit_b32 v143, v156, v143, 16
    v_alignbit_b32 v144, v145, v144, 16
    v_alignbit_b32 v145, v146, v145, 16
    v_alignbit_b32 v146, v147, v146, 16
    buffer_load_dwordx4 v241, s[28:31], s97 offen offset:1024  lds
    v_alignbit_b32 v147, v157, v147, 16
    v_alignbit_b32 v148, v149, v148, 16
    v_alignbit_b32 v149, v150, v149, 16
    v_alignbit_b32 v150, v151, v150, 16
    buffer_load_dwordx4 v242, s[28:31], s97 offen offset:2048  lds
    v_alignbit_b32 v151, v158, v151, 16
    v_alignbit_b32 v152, v153, v152, 16
    v_alignbit_b32 v153, v154, v153, 16
    buffer_load_dwordx4 v243, s[28:31], s97 offen offset:3072  lds
    v_alignbit_b32 v154, v155, v154, 16
    v_alignbit_b32 v155, v159, v155, 16
    v_lshlrev_b32 v8, 3, v0
    s_add_u32 s78, s88, 18432
    s_add_u32 m0, s88, 0
    s_mov_b64 exec, 0xffffffff
    buffer_load_dwordx4 v3, s[28:31], s97 offen offset:0  lds
    s_mov_b64 exec, -1
    v_add_u32 v8, s78, v8
    v_mov_b32 v156, 0
    v_mov_b32 v157, 0
    s_waitcnt vmcnt(11)
    s_barrier
    s_mul_i32 s16, s97, 3072
    s_add_u32 m0, s60, 0
    s_add_u32 s99, s16, s62
    buffer_load_dwordx4 v244, s[32:35], s99 offen offset:0  lds
    buffer_load_dwordx4 v245, s[32:35], s99 offen offset:1024  lds
    buffer_load_dwordx4 v246, s[32:35], s99 offen offset:2048  lds
    s_add_u32 m0, s61, 12288
    s_add_u32 s16, s16, s63
    buffer_load_dwordx4 v244, s[32:35], s16 offen offset:0  lds
    buffer_load_dwordx4 v245, s[32:35], s16 offen offset:1024  lds
    buffer_load_dwordx4 v246, s[32:35], s16 offen offset:2048  lds
    s_mov_b64 exec, 0xff
    buffer_load_dword v136, v33, s[68:71], 0 offen sc1
    buffer_load_dword v137, v34, s[52:55], 0 offen sc1
    s_mov_b64 exec, -1
    buffer_load_dwordx4 v[212:215], v9, s[56:59], 0 offen offset:0 nt
    buffer_load_dwordx4 v[216:219], v9, s[56:59], 0 offen offset:2048 nt
    buffer_load_dwordx4 v[220:223], v9, s[56:59], s96 offen offset:0 nt
    buffer_load_dwordx4 v[224:227], v9, s[56:59], s96 offen offset:2048 nt
    s_waitcnt vmcnt(12)
    s_waitcnt vmcnt(6)
    s_barrier
    s_waitcnt vmcnt(4)
    s_branch LA_j
LA_c1:
    s_waitcnt vmcnt(11)
    s_barrier
    s_mul_i32 s16, s97, 3072
    s_add_u32 m0, s60, 49152
    s_add_u32 s99, s16, s62
    buffer_load_dwordx4 v244, s[32:35], s99 offen offset:0  lds
    buffer_load_dwordx4 v245, s[32:35], s99 offen offset:1024  lds
    buffer_load_dwordx4 v246, s[32:35], s99 offen offset:2048  lds
    s_add_u32 m0, s61, 61440
    s_add_u32 s16, s16, s63
    buffer_load_dwordx4 v244, s[32:35], s16 offen offset:0  lds
    buffer_load_dwordx4 v245, s[32:35], s16 offen offset:1024  lds
    buffer_load_dwordx4 v246, s[32:35], s16 offen offset:2048  lds
    s_add_u32 s97, s98, s0
    s_lshr_b64 s[0:1], s[0:1], 4
    s_and_b32 s97, s97, 15
    s_lshr_b32 s99, s97, 3
    s_xor_b32 s97, s97, s99
    s_add_u32 m0, s87, 0
    s_lshl_b32 s97, s97, 7
    buffer_load_dwordx4 v240, s[28:31], s97 offen offset:0  lds
    buffer_load_dwordx4 v241, s[28:31], s97 offen offset:1024  lds
    buffer_load_dwordx4 v242, s[28:31], s97 offen offset:2048  lds
    buffer_load_dwordx4 v243, s[28:31], s97 offen offset:3072  lds
    s_add_u32 m0, s88, 0
    s_mov_b64 exec, 0xffffffff
    buffer_load_dwordx4 v3, s[28:31], s97 offen offset:0  lds
    s_mov_b64 exec, -1
    s_waitcnt vmcnt(11)
    s_barrier
    s_mul_i32 s16, s97, 3072
    s_add_u32 m0, s60, 0
    s_add_u32 s99, s16, s62
    buffer_load_dwordx4 v244, s[32:35], s99 offen offset:0  lds
    buffer_load_dwordx4 v245, s[32:35], s99 offen offset:1024  lds
    buffer_load_dwordx4 v246, s[32:35], s99 offen offset:2048  lds
    s_add_u32 m0, s61, 12288
    s_add_u32 s16, s16, s63
    buffer_load_dwordx4 v244, s[32:35], s16 offen offset:0  lds
    buffer_load_dwordx4 v245, s[32:35], s16 offen offset:1024  lds
    buffer_load_dwordx4 v246, s[32:35], s16 offen offset:2048  lds
    s_add_u32 m0, s86, 129536
    s_mov_b32 s89, 0
    buffer_load_dwordx4 v10, s[36:39], s89 offen nt lds
    s_add_u32 m0, s86, 145920
    s_mov_b32 s89, 0
    buffer_load_dwordx4 v10, s[40:43], s89 offen nt lds
    s_add_u32 m0, s86, 133632
    s_mov_b32 s89, 65536
    buffer_load_dwordx4 v10, s[36:39], s89 offen nt lds
    s_add_u32 m0, s86, 150016
    s_mov_b32 s89, 65536
    buffer_load_dwordx4 v10, s[40:43], s89 offen nt lds
    s_add_u32 m0, s86, 137728
    s_mov_b32 s89, 131072
    buffer_load_dwordx4 v10, s[36:39], s89 offen nt lds
    s_add_u32 m0, s86, 154112
    s_mov_b32 s89, 131072
    buffer_load_dwordx4 v10, s[40:43], s89 offen nt lds
    s_add_u32 m0, s86, 141824
    s_mov_b32 s89, 196608
    buffer_load_dwordx4 v10, s[36:39], s89 offen nt lds
    s_add_u32 m0, s86, 158208
    s_mov_b32 s89, 196608
    buffer_load_dwordx4 v10, s[40:43], s89 offen nt lds
    s_mov_b64 exec, 0xff
    s_lshl_b32 s82, s3, 7
    s_add_u32 m0, s82, 129024
    s_mov_b32 s89, 0
    buffer_load_dwordx4 v11, s[36:39], s89 offen nt lds
    s_lshl_b32 s83, s74, 9
    s_add_u32 s83, s83, s82
    s_and_b32 s89, s3, 2
    s_lshl_b32 s89, s89, 3
    s_add_u32 s82, s82, s89
    s_add_u32 m0, s82, 162816
    s_add_u32 s89, s83, 0
    buffer_load_dwordx4 v15, s[44:47], s89 offen  lds
    s_mov_b64 exec, -1
    s_add_u32 s97, s98, s0
    s_lshr_b64 s[0:1], s[0:1], 4
    s_and_b32 s97, s97, 15
    s_lshr_b32 s99, s97, 3
    s_xor_b32 s97, s97, s99
    s_add_u32 m0, s87, 18432
    s_lshl_b32 s97, s97, 7
    buffer_load_dwordx4 v240, s[28:31], s97 offen offset:0  lds
    s_waitcnt vmcnt(17)
    s_barrier
    buffer_load_dwordx4 v241, s[28:31], s97 offen offset:1024  lds
    buffer_load_dwordx4 v242, s[28:31], s97 offen offset:2048  lds
    buffer_load_dwordx4 v243, s[28:31], s97 offen offset:3072  lds
    s_add_u32 m0, s88, 18432
    s_mov_b64 exec, 0xffffffff
    buffer_load_dwordx4 v3, s[28:31], s97 offen offset:0  lds
    s_mov_b64 exec, -1
    s_mul_i32 s16, s97, 3072
    s_add_u32 m0, s60, 24576
    s_add_u32 s99, s16, s62
    buffer_load_dwordx4 v244, s[32:35], s99 offen offset:0  lds
    buffer_load_dwordx4 v245, s[32:35], s99 offen offset:1024  lds
    buffer_load_dwordx4 v246, s[32:35], s99 offen offset:2048  lds
    s_add_u32 m0, s61, 36864
    s_add_u32 s16, s16, s63
    buffer_load_dwordx4 v244, s[32:35], s16 offen offset:0  lds
    buffer_load_dwordx4 v245, s[32:35], s16 offen offset:1024  lds
    buffer_load_dwordx4 v246, s[32:35], s16 offen offset:2048  lds
    s_add_u32 s97, s98, s0
    s_lshr_b64 s[0:1], s[0:1], 4
    s_and_b32 s97, s97, 15
    s_lshr_b32 s99, s97, 3
    s_xor_b32 s97, s97, s99
    s_add_u32 m0, s87, 36864
    s_lshl_b32 s97, s97, 7
    buffer_load_dwordx4 v240, s[28:31], s97 offen offset:0  lds
    buffer_load_dwordx4 v241, s[28:31], s97 offen offset:1024  lds
    buffer_load_dwordx4 v242, s[28:31], s97 offen offset:2048  lds
    buffer_load_dwordx4 v243, s[28:31], s97 offen offset:3072  lds
    s_add_u32 m0, s88, 36864
    s_mov_b64 exec, 0xffffffff
    buffer_load_dwordx4 v3, s[28:31], s97 offen offset:0  lds
    s_mov_b64 exec, -1
    s_waitcnt vmcnt(11)
    s_barrier
    s_mul_i32 s16, s97, 3072
    s_add_u32 m0, s60, 49152
    s_add_u32 s99, s16, s62
    buffer_load_dwordx4 v244, s[32:35], s99 offen offset:0  lds
    ds_read_b128 v[84:87], v35 offset:0
    ds_read_b128 v[88:91], v35 offset:16
    buffer_load_dwordx4 v245, s[32:35], s99 offen offset:1024  lds
    ds_read_b64 v[40:41], v16 offset:0
    ds_read_b64 v[42:43], v231 offset:256
    buffer_load_dwordx4 v246, s[32:35], s99 offen offset:2048  lds
    ds_read_b64 v[44:45], v16 offset:256
    ds_read_b64 v[46:47], v16 offset:512
    s_add_u32 m0, s61, 61440
    s_add_u32 s16, s16, s63
    buffer_load_dwordx4 v244, s[32:35], s16 offen offset:0  lds
    ds_read_b64 v[48:49], v231 offset:512
    ds_read_b64 v[50:51], v16 offset:768
    buffer_load_dwordx4 v245, s[32:35], s16 offen offset:1024  lds
    ds_read_b64 v[52:53], v231 offset:768
    ds_read_b64 v[54:55], v16 offset:1024
    buffer_load_dwordx4 v246, s[32:35], s16 offen offset:2048  lds
    ds_read_b64 v[56:57], v231 offset:1024
    ds_read_b64 v[58:59], v16 offset:1280
    s_add_u32 s97, s98, s0
    s_lshr_b64 s[0:1], s[0:1], 4
    s_and_b32 s97, s97, 15
    s_lshr_b32 s99, s97, 3
    s_xor_b32 s97, s97, s99
    s_add_u32 m0, s87, 0
    s_lshl_b32 s97, s97, 7
    buffer_load_dwordx4 v240, s[28:31], s97 offen offset:0  lds
    ds_read_b64 v[60:61], v231 offset:1280
    ds_read_b64 v[68:69], v16 offset:16896
    buffer_load_dwordx4 v241, s[28:31], s97 offen offset:1024  lds
    ds_read_b64 v[70:71], v231 offset:16896
    ds_read_b64 v[72:73], v16 offset:17152
    buffer_load_dwordx4 v242, s[28:31], s97 offen offset:2048  lds
    ds_read_b64 v[74:75], v231 offset:17152
    ds_read_b64 v[76:77], v16 offset:17408
    buffer_load_dwordx4 v243, s[28:31], s97 offen offset:3072  lds
    ds_read_b64 v[78:79], v231 offset:17408
    ds_read_b64 v[80:81], v16 offset:17664
    s_add_u32 m0, s88, 0
    s_mov_b64 exec, 0xffffffff
    buffer_load_dwordx4 v3, s[28:31], s97 offen offset:0  lds
    s_mov_b64 exec, -1
    ds_read_b64 v[82:83], v231 offset:17664
    s_waitcnt vmcnt(11)
    s_waitcnt lgkmcnt(0)
    s_barrier
    s_mul_i32 s16, s97, 3072
    s_add_u32 m0, s60, 0
    s_add_u32 s99, s16, s62
    buffer_load_dwordx4 v244, s[32:35], s99 offen offset:0  lds
    v_lshlrev_b32 v160, 16, v40
    v_lshlrev_b32 v161, 16, v42
    v_lshlrev_b32 v162, 16, v44
    v_lshlrev_b32 v163, 16, v46
    v_lshlrev_b32 v164, 16, v48
    buffer_load_dwordx4 v245, s[32:35], s99 offen offset:1024  lds
    v_lshlrev_b32 v165, 16, v50
    v_lshlrev_b32 v166, 16, v52
    v_lshlrev_b32 v167, 16, v54
    v_lshlrev_b32 v168, 16, v56
    v_lshlrev_b32 v169, 16, v58
    buffer_load_dwordx4 v246, s[32:35], s99 offen offset:2048  lds
    v_lshlrev_b32 v170, 16, v60
    v_lshlrev_b32 v172, 16, v84
    v_and_b32 v173, 0xffff0000, v84
    v_lshlrev_b32 v174, 16, v85
    v_and_b32 v175, 0xffff0000, v85
    s_add_u32 m0, s61, 12288
    s_add_u32 s16, s16, s63
    buffer_load_dwordx4 v244, s[32:35], s16 offen offset:0  lds
    v_lshlrev_b32 v176, 16, v68
    v_lshlrev_b32 v177, 16, v70
    v_lshlrev_b32 v178, 16, v72
    v_lshlrev_b32 v179, 16, v74
    v_lshlrev_b32 v180, 16, v76
    buffer_load_dwordx4 v245, s[32:35], s16 offen offset:1024  lds
    v_lshlrev_b32 v181, 16, v78
    v_lshlrev_b32 v182, 16, v80
    v_lshlrev_b32 v183, 16, v82
    v_mul_f32 v184, v160, v175
    v_mul_f32 v185, v161, v175
    buffer_load_dwordx4 v246, s[32:35], s16 offen offset:2048  lds
    v_mul_f32 v186, v162, v175
    v_mul_f32 v187, v163, v175
    v_mul_f32 v188, v164, v175
    v_mul_f32 v189, v165, v175
    v_mul_f32 v190, v166, v175
    buffer_load_dword v230, v229, s[4:7], 0 offen
    v_mul_f32 v191, v167, v175
    v_fmac_f32 v184, v161, v174
    v_fmac_f32 v185, v162, v174
    v_fmac_f32 v186, v163, v174
    v_fmac_f32 v187, v164, v174
    buffer_load_dword v230, v228, s[32:35], 0 offen
    v_fmac_f32 v188, v165, v174
    v_fmac_f32 v189, v166, v174
    v_fmac_f32 v190, v167, v174
    v_fmac_f32 v191, v168, v174
    v_fmac_f32 v184, v162, v173
    s_add_u32 s97, s98, s0
    s_lshr_b64 s[0:1], s[0:1], 4
    s_and_b32 s97, s97, 15
    s_lshr_b32 s99, s97, 3
    s_xor_b32 s97, s97, s99
    s_add_u32 m0, s87, 18432
    s_lshl_b32 s97, s97, 7
    buffer_load_dwordx4 v240, s[28:31], s97 offen offset:0  lds
    v_fmac_f32 v185, v163, v173
    v_fmac_f32 v186, v164, v173
    v_fmac_f32 v187, v165, v173
    v_fmac_f32 v188, v166, v173
    v_fmac_f32 v189, v167, v173
    buffer_load_dwordx4 v241, s[28:31], s97 offen offset:1024  lds
    v_fmac_f32 v190, v168, v173
    v_fmac_f32 v191, v169, v173
    v_fmac_f32 v184, v163, v172
    v_fmac_f32 v185, v164, v172
    v_fmac_f32 v186, v165, v172
    buffer_load_dwordx4 v242, s[28:31], s97 offen offset:2048  lds
    v_fmac_f32 v187, v166, v172
    v_fmac_f32 v188, v167, v172
    v_fmac_f32 v189, v168, v172
    v_fmac_f32 v190, v169, v172
    v_fmac_f32 v191, v170, v172
    buffer_load_dwordx4 v243, s[28:31], s97 offen offset:3072  lds
    v_mul_f32 v184, v184, v176
    v_mul_f32 v185, v185, v177
    v_mul_f32 v186, v186, v178
    v_mul_f32 v187, v187, v179
    v_mul_f32 v188, v188, v180
    s_add_u32 m0, s88, 18432
    s_mov_b64 exec, 0xffffffff
    buffer_load_dwordx4 v3, s[28:31], s97 offen offset:0  lds
    s_mov_b64 exec, -1
    v_mul_f32 v189, v189, v181
    v_mul_f32 v190, v190, v182
    v_mul_f32 v191, v191, v183
    v_cvt_pk_bf16_f32 v100, v191, v190
    v_cvt_pk_bf16_f32 v101, v189, v188
    v_cvt_pk_bf16_f32 v102, v187, v186
    v_cvt_pk_bf16_f32 v103, v185, v184
    s_mov_b32 s89, 0
    buffer_store_dwordx4 v[100:103], v12, s[52:55], s89 offen sc1
    v_and_b32 v160, 0xffff0000, v40
    v_and_b32 v161, 0xffff0000, v42
    v_and_b32 v162, 0xffff0000, v44
    v_and_b32 v163, 0xffff0000, v46
    v_and_b32 v164, 0xffff0000, v48
    v_and_b32 v165, 0xffff0000, v50
    v_and_b32 v166, 0xffff0000, v52
    v_and_b32 v167, 0xffff0000, v54
    v_and_b32 v168, 0xffff0000, v56
    v_and_b32 v169, 0xffff0000, v58
    v_and_b32 v170, 0xffff0000, v60
    v_lshlrev_b32 v172, 16, v86
    v_and_b32 v173, 0xffff0000, v86
    v_lshlrev_b32 v174, 16, v87
    v_and_b32 v175, 0xffff0000, v87
    v_and_b32 v176, 0xffff0000, v68
    v_and_b32 v177, 0xffff0000, v70
    v_and_b32 v178, 0xffff0000, v72
    v_and_b32 v179, 0xffff0000, v74
    v_and_b32 v180, 0xffff0000, v76
    v_and_b32 v181, 0xffff0000, v78
    v_and_b32 v182, 0xffff0000, v80
    v_and_b32 v183, 0xffff0000, v82
    s_waitcnt vmcnt(14)
    s_barrier
    s_mul_i32 s16, s97, 3072
    s_add_u32 m0, s60, 24576
    s_add_u32 s99, s16, s62
    buffer_load_dwordx4 v244, s[32:35], s99 offen offset:0  lds
    v_mul_f32 v184, v160, v175
    v_mul_f32 v185, v161, v175
    v_mul_f32 v186, v162, v175
    v_mul_f32 v187, v163, v175
    v_mul_f32 v188, v164, v175
    buffer_load_dwordx4 v245, s[32:35], s99 offen offset:1024  lds
    v_mul_f32 v189, v165, v175
    v_mul_f32 v190, v166, v175
    v_mul_f32 v191, v167, v175
    v_fmac_f32 v184, v161, v174
    v_fmac_f32 v185, v162, v174
    buffer_load_dwordx4 v246, s[32:35], s99 offen offset:2048  lds
    v_fmac_f32 v186, v163, v174
    v_fmac_f32 v187, v164, v174
    v_fmac_f32 v188, v165, v174
    v_fmac_f32 v189, v166, v174
    v_fmac_f32 v190, v167, v174
    s_add_u32 m0, s61, 36864
    s_add_u32 s16, s16, s63
    buffer_load_dwordx4 v244, s[32:35], s16 offen offset:0  lds
    v_fmac_f32 v191, v168, v174
    v_fmac_f32 v184, v162, v173
    v_fmac_f32 v185, v163, v173
    v_fmac_f32 v186, v164, v173
    v_fmac_f32 v187, v165, v173
    buffer_load_dwordx4 v245, s[32:35], s16 offen offset:1024  lds
    v_fmac_f32 v188, v166, v173
    v_fmac_f32 v189, v167, v173
    v_fmac_f32 v190, v168, v173
    v_fmac_f32 v191, v169, v173
    v_fmac_f32 v184, v163, v172
    buffer_load_dwordx4 v246, s[32:35], s16 offen offset:2048  lds
    v_fmac_f32 v185, v164, v172
    v_fmac_f32 v186, v165, v172
    v_fmac_f32 v187, v166, v172
    v_fmac_f32 v188, v167, v172
    v_fmac_f32 v189, v168, v172
    s_add_u32 s97, s98, s0
    s_lshr_b64 s[0:1], s[0:1], 4
    s_and_b32 s97, s97, 15
    s_lshr_b32 s99, s97, 3
    s_xor_b32 s97, s97, s99
    s_add_u32 m0, s87, 36864
    s_lshl_b32 s97, s97, 7
    buffer_load_dwordx4 v240, s[28:31], s97 offen offset:0  lds
    v_fmac_f32 v190, v169, v172
    v_fmac_f32 v191, v170, v172
    v_mul_f32 v184, v184, v176
    v_mul_f32 v185, v185, v177
    v_mul_f32 v186, v186, v178
    buffer_load_dwordx4 v241, s[28:31], s97 offen offset:1024  lds
    v_mul_f32 v187, v187, v179
    v_mul_f32 v188, v188, v180
    v_mul_f32 v189, v189, v181
    v_mul_f32 v190, v190, v182
    v_mul_f32 v191, v191, v183
    buffer_load_dwordx4 v242, s[28:31], s97 offen offset:2048  lds
    v_cvt_pk_bf16_f32 v104, v191, v190
    v_cvt_pk_bf16_f32 v105, v189, v188
    v_cvt_pk_bf16_f32 v106, v187, v186
    v_cvt_pk_bf16_f32 v107, v185, v184
    s_mov_b32 s89, 16384
    buffer_store_dwordx4 v[104:107], v12, s[52:55], s89 offen sc1
    buffer_load_dwordx4 v243, s[28:31], s97 offen offset:3072  lds
    v_lshlrev_b32 v160, 16, v41
    v_lshlrev_b32 v161, 16, v43
    v_lshlrev_b32 v162, 16, v45
    v_lshlrev_b32 v163, 16, v47
    v_lshlrev_b32 v164, 16, v49
    s_add_u32 m0, s88, 36864
    s_mov_b64 exec, 0xffffffff
    buffer_load_dwordx4 v3, s[28:31], s97 offen offset:0  lds
    s_mov_b64 exec, -1
    v_lshlrev_b32 v165, 16, v51
    v_lshlrev_b32 v166, 16, v53
    v_lshlrev_b32 v167, 16, v55
    v_lshlrev_b32 v168, 16, v57
    v_lshlrev_b32 v169, 16, v59
    v_lshlrev_b32 v170, 16, v61
    v_lshlrev_b32 v172, 16, v88
    v_and_b32 v173, 0xffff0000, v88
    v_lshlrev_b32 v174, 16, v89
    v_and_b32 v175, 0xffff0000, v89
    v_lshlrev_b32 v176, 16, v69
    v_lshlrev_b32 v177, 16, v71
    v_lshlrev_b32 v178, 16, v73
    v_lshlrev_b32 v179, 16, v75
    v_lshlrev_b32 v180, 16, v77
    v_lshlrev_b32 v181, 16, v79
    v_lshlrev_b32 v182, 16, v81
    v_lshlrev_b32 v183, 16, v83
    v_mul_f32 v184, v160, v175
    v_mul_f32 v185, v161, v175
    v_mul_f32 v186, v162, v175
    v_mul_f32 v187, v163, v175
    v_mul_f32 v188, v164, v175
    v_mul_f32 v189, v165, v175
    v_mul_f32 v190, v166, v175
    v_mul_f32 v191, v167, v175
    v_fmac_f32 v184, v161, v174
    v_fmac_f32 v185, v162, v174
    v_fmac_f32 v186, v163, v174
    v_fmac_f32 v187, v164, v174
    v_fmac_f32 v188, v165, v174
    v_fmac_f32 v189, v166, v174
    v_fmac_f32 v190, v167, v174
    v_fmac_f32 v191, v168, v174
    v_fmac_f32 v184, v162, v173
    v_fmac_f32 v185, v163, v173
    v_fmac_f32 v186, v164, v173
    v_fmac_f32 v187, v165, v173
    v_fmac_f32 v188, v166, v173
    v_fmac_f32 v189, v167, v173
    v_fmac_f32 v190, v168, v173
    s_waitcnt vmcnt(13)
    s_barrier
    s_mul_i32 s16, s97, 3072
    s_add_u32 m0, s60, 49152
    s_add_u32 s99, s16, s62
    buffer_load_dwordx4 v244, s[32:35], s99 offen offset:0  lds
    v_fmac_f32 v191, v169, v173
    v_fmac_f32 v184, v163, v172
    v_fmac_f32 v185, v164, v172
    v_fmac_f32 v186, v165, v172
    v_fmac_f32 v187, v166, v172
    buffer_load_dwordx4 v245, s[32:35], s99 offen offset:1024  lds
    v_fmac_f32 v188, v167, v172
    v_fmac_f32 v189, v168, v172
    v_fmac_f32 v190, v169, v172
    v_fmac_f32 v191, v170, v172
    v_mul_f32 v184, v184, v176
    buffer_load_dwordx4 v246, s[32:35], s99 offen offset:2048  lds
    v_mul_f32 v185, v185, v177
    v_mul_f32 v186, v186, v178
    v_mul_f32 v187, v187, v179
    v_mul_f32 v188, v188, v180
    v_mul_f32 v189, v189, v181
    s_add_u32 m0, s61, 61440
    s_add_u32 s16, s16, s63
    buffer_load_dwordx4 v244, s[32:35], s16 offen offset:0  lds
    v_mul_f32 v190, v190, v182
    v_mul_f32 v191, v191, v183
    v_cvt_pk_bf16_f32 v108, v191, v190
    v_cvt_pk_bf16_f32 v109, v189, v188
    v_cvt_pk_bf16_f32 v110, v187, v186
    buffer_load_dwordx4 v245, s[32:35], s16 offen offset:1024  lds
    v_cvt_pk_bf16_f32 v111, v185, v184
    s_mov_b32 s89, 32768
    buffer_store_dwordx4 v[108:111], v12, s[52:55], s89 offen sc1
    v_and_b32 v160, 0xffff0000, v41
    v_and_b32 v161, 0xffff0000, v43
    v_and_b32 v162, 0xffff0000, v45
    buffer_load_dwordx4 v246, s[32:35], s16 offen offset:2048  lds
    v_and_b32 v163, 0xffff0000, v47
    v_and_b32 v164, 0xffff0000, v49
    v_and_b32 v165, 0xffff0000, v51
    v_and_b32 v166, 0xffff0000, v53
    v_and_b32 v167, 0xffff0000, v55
    s_add_u32 s97, s98, s0
    s_lshr_b64 s[0:1], s[0:1], 4
    s_and_b32 s97, s97, 15
    s_lshr_b32 s99, s97, 3
    s_xor_b32 s97, s97, s99
    s_add_u32 m0, s87, 0
    s_lshl_b32 s97, s97, 7
    buffer_load_dwordx4 v240, s[28:31], s97 offen offset:0  lds
    v_and_b32 v168, 0xffff0000, v57
    v_and_b32 v169, 0xffff0000, v59
    v_and_b32 v170, 0xffff0000, v61
    v_lshlrev_b32 v172, 16, v90
    v_and_b32 v173, 0xffff0000, v90
    buffer_load_dwordx4 v241, s[28:31], s97 offen offset:1024  lds
    v_lshlrev_b32 v174, 16, v91
    v_and_b32 v175, 0xffff0000, v91
    v_and_b32 v176, 0xffff0000, v69
    v_and_b32 v177, 0xffff0000, v71
    v_and_b32 v178, 0xffff0000, v73
    buffer_load_dwordx4 v242, s[28:31], s97 offen offset:2048  lds
    v_and_b32 v179, 0xffff0000, v75
    v_and_b32 v180, 0xffff0000, v77
    v_and_b32 v181, 0xffff0000, v79
    v_and_b32 v182, 0xffff0000, v81
    v_and_b32 v183, 0xffff0000, v83
    buffer_load_dwordx4 v243, s[28:31], s97 offen offset:3072  lds
    v_mul_f32 v184, v160, v175
    v_mul_f32 v185, v161, v175
    v_mul_f32 v186, v162, v175
    v_mul_f32 v187, v163, v175
    v_mul_f32 v188, v164, v175
    s_add_u32 m0, s88, 0
    s_mov_b64 exec, 0xffffffff
    buffer_load_dwordx4 v3, s[28:31], s97 offen offset:0  lds
    s_mov_b64 exec, -1
    v_mul_f32 v189, v165, v175
    v_mul_f32 v190, v166, v175
    v_mul_f32 v191, v167, v175
    v_fmac_f32 v184, v161, v174
    v_fmac_f32 v185, v162, v174
    v_fmac_f32 v186, v163, v174
    v_fmac_f32 v187, v164, v174
    v_fmac_f32 v188, v165, v174
    v_fmac_f32 v189, v166, v174
    v_fmac_f32 v190, v167, v174
    v_fmac_f32 v191, v168, v174
    v_fmac_f32 v184, v162, v173
    v_fmac_f32 v185, v163, v173
    v_fmac_f32 v186, v164, v173
    v_fmac_f32 v187, v165, v173
    v_fmac_f32 v188, v166, v173
    v_fmac_f32 v189, v167, v173
    v_fmac_f32 v190, v168, v173
    v_fmac_f32 v191, v169, v173
    v_fmac_f32 v184, v163, v172
    v_fmac_f32 v185, v164, v172
    v_fmac_f32 v186, v165, v172
    v_fmac_f32 v187, v166, v172
    v_fmac_f32 v188, v167, v172
    v_fmac_f32 v189, v168, v172
    v_fmac_f32 v190, v169, v172
    v_fmac_f32 v191, v170, v172
    v_mul_f32 v184, v184, v176
    v_mul_f32 v185, v185, v177
    v_mul_f32 v186, v186, v178
    v_mul_f32 v187, v187, v179
    v_mul_f32 v188, v188, v180
    v_mul_f32 v189, v189, v181
    v_mul_f32 v190, v190, v182
    v_mul_f32 v191, v191, v183
    v_cvt_pk_bf16_f32 v112, v191, v190
    v_cvt_pk_bf16_f32 v113, v189, v188
    v_cvt_pk_bf16_f32 v114, v187, v186
    v_cvt_pk_bf16_f32 v115, v185, v184
    s_mov_b32 s89, 49152
    buffer_store_dwordx4 v[112:115], v12, s[52:55], s89 offen sc1
    s_waitcnt vmcnt(13)
    s_barrier
    s_mul_i32 s16, s97, 3072
    s_add_u32 m0, s60, 0
    s_add_u32 s99, s16, s62
    buffer_load_dwordx4 v244, s[32:35], s99 offen offset:0  lds
    buffer_load_dwordx4 v245, s[32:35], s99 offen offset:1024  lds
    buffer_load_dwordx4 v246, s[32:35], s99 offen offset:2048  lds
    s_add_u32 m0, s61, 12288
    s_add_u32 s16, s16, s63
    buffer_load_dwordx4 v244, s[32:35], s16 offen offset:0  lds
    buffer_load_dwordx4 v245, s[32:35], s16 offen offset:1024  lds
    buffer_load_dwordx4 v246, s[32:35], s16 offen offset:2048  lds
    s_add_u32 s97, s98, s0
    s_lshr_b64 s[0:1], s[0:1], 4
    s_and_b32 s97, s97, 15
    s_lshr_b32 s99, s97, 3
    s_xor_b32 s97, s97, s99
    s_add_u32 m0, s87, 18432
    s_lshl_b32 s97, s97, 7
    buffer_load_dwordx4 v240, s[28:31], s97 offen offset:0  lds
    buffer_load_dwordx4 v241, s[28:31], s97 offen offset:1024  lds
    buffer_load_dwordx4 v242, s[28:31], s97 offen offset:2048  lds
    buffer_load_dwordx4 v243, s[28:31], s97 offen offset:3072  lds
    s_add_u32 m0, s88, 18432
    s_mov_b64 exec, 0xffffffff
    buffer_load_dwordx4 v3, s[28:31], s97 offen offset:0  lds
    s_mov_b64 exec, -1
    s_waitcnt vmcnt(12)
    s_barrier
    s_mul_i32 s16, s97, 3072
    s_add_u32 m0, s60, 24576
    s_add_u32 s99, s16, s62
    buffer_load_dwordx4 v244, s[32:35], s99 offen offset:0  lds
    buffer_load_dwordx4 v245, s[32:35], s99 offen offset:1024  lds
    buffer_load_dwordx4 v246, s[32:35], s99 offen offset:2048  lds
    s_add_u32 m0, s61, 36864
    s_add_u32 s16, s16, s63
    buffer_load_dwordx4 v244, s[32:35], s16 offen offset:0  lds
    buffer_load_dwordx4 v245, s[32:35], s16 offen offset:1024  lds
    buffer_load_dwordx4 v246, s[32:35], s16 offen offset:2048  lds
    s_add_u32 s97, s98, s0
    s_lshr_b64 s[0:1], s[0:1], 4
    s_and_b32 s97, s97, 15
    s_lshr_b32 s99, s97, 3
    s_xor_b32 s97, s97, s99
    s_add_u32 m0, s87, 36864
    s_lshl_b32 s97, s97, 7
    buffer_load_dwordx4 v240, s[28:31], s97 offen offset:0  lds
    buffer_load_dwordx4 v241, s[28:31], s97 offen offset:1024  lds
    buffer_load_dwordx4 v242, s[28:31], s97 offen offset:2048  lds
    buffer_load_dwordx4 v243, s[28:31], s97 offen offset:3072  lds
    s_add_u32 m0, s88, 36864
    s_mov_b64 exec, 0xffffffff
    buffer_load_dwordx4 v3, s[28:31], s97 offen offset:0  lds
    s_mov_b64 exec, -1
    s_waitcnt vmcnt(11)
    s_barrier
    s_mul_i32 s16, s97, 3072
    s_add_u32 m0, s60, 49152
    s_add_u32 s99, s16, s62
    buffer_load_dwordx4 v244, s[32:35], s99 offen offset:0  lds
    s_mov_b32 s68, s24
    s_mov_b32 s69, s25
    s_mov_b32 s70, 0x100
    s_mov_b32 s71, 0x20000
    buffer_load_dwordx4 v245, s[32:35], s99 offen offset:1024  lds
    v_lshrrev_b32 v6, 5, v0
    v_and_b32 v7, 3, v0
    s_lshr_b32 s78, s90, 1
    buffer_load_dwordx4 v246, s[32:35], s99 offen offset:2048  lds
    s_lshl_b32 s78, s78, 2
    s_load_dword s92, s[14:15], s78
    v_bfe_u32 v5, v0, 2, 2
    v_lshlrev_b32 v5, 1, v5
    s_add_u32 m0, s61, 61440
    s_add_u32 s16, s16, s63
    buffer_load_dwordx4 v244, s[32:35], s16 offen offset:0  lds
    v_lshl_add_u32 v5, v6, 3, v5
    v_bfe_u32 v8, v0, 4, 1
    v_add_u32 v5, v5, v8
    buffer_load_dwordx4 v245, s[32:35], s16 offen offset:1024  lds
    s_and_b32 s78, s3, 1
    s_lshl_b32 s78, s78, 1
    v_add_u32 v8, s78, v6
    v_xor_b32 v8, v8, v7
    buffer_load_dwordx4 v246, s[32:35], s16 offen offset:2048  lds
    v_lshlrev_b32 v8, 4, v8
    v_lshl_add_u32 v5, v5, 6, v8
    v_add_u32 v14, s86, v5
    s_add_u32 m0, s94, 32
    s_lshl_b32 s89, s90, 12
    buffer_load_dwordx4 v15, s[48:51], s89 offen offset:0 nt lds
    v_mov_b32 v18, 162304
    v_mov_b32 v19, 1
    v_and_b32 v5, 3, v0
    s_lshl_b32 s78, s74, 4
    s_add_u32 m0, s94, 32
    s_lshl_b32 s89, s90, 12
    buffer_load_dwordx4 v15, s[48:51], s89 offen offset:1024 nt lds
    s_add_u32 s78, s78, s3
    v_lshl_add_u32 v6, v5, 2, s78
    s_lshr_b32 s78, s76, 3
    s_add_u32 m0, s94, 32
    s_lshl_b32 s89, s90, 12
    buffer_load_dwordx4 v15, s[48:51], s89 offen offset:2048 nt lds
    s_lshl_b32 s79, s3, 1
    s_add_u32 s78, s78, s79
    s_xor_b32 s78, s78, 2
    s_lshl_b32 s78, s78, 5
    s_add_u32 m0, s94, 32
    s_lshl_b32 s89, s90, 12
    buffer_load_dwordx4 v15, s[48:51], s89 offen offset:3072 nt lds
    s_add_u32 s79, s76, 0
    s_and_b32 s79, s79, 7
    s_lshl_b32 s79, s79, 1
    s_add_u32 s97, s98, s0
    s_lshr_b64 s[0:1], s[0:1], 4
    s_and_b32 s97, s97, 15
    s_lshr_b32 s99, s97, 3
    s_xor_b32 s97, s97, s99
    s_add_u32 m0, s87, 0
    s_lshl_b32 s97, s97, 7
    buffer_load_dwordx4 v240, s[28:31], s97 offen offset:0  lds
    s_add_u32 s78, s78, s79
    v_mul_u32_u24 v7, 9, v5
    v_and_b32 v7, 17, v7
    v_add_u32 v7, s78, v7
    buffer_load_dwordx4 v241, s[28:31], s97 offen offset:1024  lds
    v_and_b32 v8, 4, v0
    v_cmp_eq_u32 vcc, 0, v8
    s_nop 1
    v_cndmask_b32 v6, v7, v6, vcc
    buffer_load_dwordx4 v242, s[28:31], s97 offen offset:2048  lds
    v_and_b32 v33, 0xf0, v6
    v_lshlrev_b32 v34, 8, v6
    v_add_u32 v34, 12582912, v34
    v_and_b32 v5, 15, v0
    buffer_load_dwordx4 v243, s[28:31], s97 offen offset:3072  lds
    v_lshrrev_b32 v6, 4, v0
    v_add_u32 v7, 9, v5
    v_and_b32 v8, 1, v7
    s_add_u32 m0, s88, 0
    s_mov_b64 exec, 0xffffffff
    buffer_load_dwordx4 v3, s[28:31], s97 offen offset:0  lds
    s_mov_b64 exec, -1
    v_mul_u32_u24 v8, 4160, v8
    v_lshrrev_b32 v7, 1, v7
    v_lshl_add_u32 v8, v7, 2, v8
    s_waitcnt vmcnt(15)
    s_barrier
    s_mul_i32 s16, s97, 3072
    s_add_u32 m0, s60, 0
    s_add_u32 s99, s16, s62
    buffer_load_dwordx4 v244, s[32:35], s99 offen offset:0  lds
    v_lshlrev_b32 v7, 4, v6
    v_sub_u32 v8, v8, v7
    s_add_u32 s78, s94, 32
    v_add_u32 v21, s78, v8
    v_add_u32 v22, 1024, v21
    buffer_load_dwordx4 v245, s[32:35], s99 offen offset:1024  lds
    v_add_u32 v23, 2048, v21
    v_add_u32 v24, 3072, v21
    v_lshl_add_u32 v7, v5, 1, v6
    v_add_u32 v7, 30, v7
    v_and_b32 v8, 1, v7
    buffer_load_dwordx4 v246, s[32:35], s99 offen offset:2048  lds
    v_bfe_u32 v136, v7, 1, 2
    v_lshl_add_u32 v136, v8, 2, v136
    v_lshlrev_b32 v136, 6, v136
    v_lshrrev_b32 v7, 3, v7
    v_lshl_add_u32 v136, v7, 9, v136
    s_add_u32 m0, s61, 12288
    s_add_u32 s16, s16, s63
    buffer_load_dwordx4 v244, s[32:35], s16 offen offset:0  lds
    v_bitop3_b32 v8, v7, 3, s3 bitop3:0x6a
    v_lshl_add_u32 v25, v8, 4, v136
    v_add_u32 v25, 92160, v25
    v_subrev_u32 v7, 1, v7
    buffer_load_dwordx4 v245, s[32:35], s16 offen offset:1024  lds
    v_bitop3_b32 v8, v7, 3, s3 bitop3:0x6a
    v_lshl_add_u32 v27, v8, 4, v136
    v_add_u32 v27, 91648, v27
    v_subrev_u32 v7, 1, v7
    v_bitop3_b32 v8, v7, 3, s3 bitop3:0x6a
    buffer_load_dwordx4 v246, s[32:35], s16 offen offset:2048  lds
    v_lshl_add_u32 v29, v8, 4, v136
    v_add_u32 v29, 91136, v29
    v_subrev_u32 v7, 1, v7
    v_bitop3_b32 v8, v7, 3, s3 bitop3:0x6a
    v_lshl_add_u32 v31, v8, 4, v136
    s_add_u32 s97, s98, s0
    s_lshr_b64 s[0:1], s[0:1], 4
    s_and_b32 s97, s97, 15
    s_lshr_b32 s99, s97, 3
    s_xor_b32 s97, s97, s99
    s_add_u32 m0, s87, 18432
    s_lshl_b32 s97, s97, 7
    buffer_load_dwordx4 v240, s[28:31], s97 offen offset:0  lds
    v_add_u32 v31, 90624, v31
    v_lshl_add_u32 v7, v5, 1, v6
    v_add_u32 v7, 26, v7
    v_and_b32 v8, 1, v7
    v_bfe_u32 v136, v7, 1, 2
    buffer_load_dwordx4 v241, s[28:31], s97 offen offset:1024  lds
    v_lshl_add_u32 v136, v8, 2, v136
    v_lshlrev_b32 v136, 6, v136
    v_lshrrev_b32 v7, 3, v7
    v_lshl_add_u32 v136, v7, 9, v136
    buffer_load_dwordx4 v242, s[28:31], s97 offen offset:2048  lds
    v_bitop3_b32 v8, v7, 3, s3 bitop3:0x6a
    v_lshl_add_u32 v26, v8, 4, v136
    v_add_u32 v26, 92160, v26
    v_subrev_u32 v7, 1, v7
    v_bitop3_b32 v8, v7, 3, s3 bitop3:0x6a
    buffer_load_dwordx4 v243, s[28:31], s97 offen offset:3072  lds
    v_lshl_add_u32 v28, v8, 4, v136
    v_add_u32 v28, 91648, v28
    v_subrev_u32 v7, 1, v7
    v_bitop3_b32 v8, v7, 3, s3 bitop3:0x6a
    v_lshl_add_u32 v30, v8, 4, v136
    s_add_u32 m0, s88, 18432
    s_mov_b64 exec, 0xffffffff
    buffer_load_dwordx4 v3, s[28:31], s97 offen offset:0  lds
    s_mov_b64 exec, -1
    v_add_u32 v30, 91136, v30
    v_subrev_u32 v7, 1, v7
    v_bitop3_b32 v8, v7, 3, s3 bitop3:0x6a
    v_lshl_add_u32 v32, v8, 4, v136
    s_waitcnt vmcnt(11)
    s_barrier
    s_mul_i32 s16, s97, 3072
    s_add_u32 m0, s60, 24576
    s_add_u32 s99, s16, s62
    buffer_load_dwordx4 v244, s[32:35], s99 offen offset:0  lds
    v_add_u32 v32, 90624, v32
    v_lshrrev_b32 v7, 1, v6
    v_lshl_add_u32 v7, v5, 1, v7
    v_add_u32 v7, 32, v7
    v_and_b32 v8, 1, v7
    buffer_load_dwordx4 v245, s[32:35], s99 offen offset:1024  lds
    v_bfe_u32 v136, v7, 1, 2
    v_lshl_add_u32 v136, v8, 2, v136
    v_lshlrev_b32 v136, 6, v136
    v_lshrrev_b32 v7, 3, v7
    buffer_load_dwordx4 v246, s[32:35], s99 offen offset:2048  lds
    v_lshl_add_u32 v136, v7, 9, v136
    v_bitop3_b32 v8, v7, 3, s3 bitop3:0x6a
    v_lshl_add_u32 v20, v8, 4, v136
    v_add_u32 v20, 92160, v20
    v_and_b32 v8, 1, v6
    s_add_u32 m0, s61, 36864
    s_add_u32 s16, s16, s63
    buffer_load_dwordx4 v244, s[32:35], s16 offen offset:0  lds
    v_xor_b32 v8, 1, v8
    v_lshl_add_u32 v20, v8, 3, v20
    s_waitcnt lgkmcnt(0)
    s_and_b32 s78, s92, 0xffff0000
    buffer_load_dwordx4 v245, s[32:35], s16 offen offset:1024  lds
    s_lshl_b32 s92, s92, 16
    s_bitcmp1_b32 s90, 0
    s_cselect_b32 s92, s78, s92
    v_lshlrev_b32 v7, 3, v6
    v_sub_u32 v7, v7, v5
    buffer_load_dwordx4 v246, s[32:35], s16 offen offset:2048  lds
    v_subrev_u32 v7, 9, v7
    v_and_b32 v8, 1, v7
    v_xor_b32 v8, 1, v8
    v_lshlrev_b32 v8, 4, v8
    v_lshrrev_b32 v8, v8, s92
    s_add_u32 s97, s98, s0
    s_lshr_b64 s[0:1], s[0:1], 4
    s_and_b32 s97, s97, 15
    s_lshr_b32 s99, s97, 3
    s_xor_b32 s97, s97, s99
    s_add_u32 m0, s87, 36864
    s_lshl_b32 s97, s97, 7
    buffer_load_dwordx4 v240, s[28:31], s97 offen offset:0  lds
    v_ashrrev_i32 v7, 1, v7
    v_cmp_eq_u32 vcc, 0, v7
    s_nop 1
    v_cndmask_b32 v236, 0, v8, vcc
    v_cmp_eq_u32 vcc, 1, v7
    buffer_load_dwordx4 v241, s[28:31], s97 offen offset:1024  lds
    s_nop 0
    v_cndmask_b32 v237, 0, v8, vcc
    v_cmp_eq_u32 vcc, 2, v7
    s_nop 1
    v_cndmask_b32 v238, 0, v8, vcc
    v_cmp_eq_u32 vcc, 3, v7
    buffer_load_dwordx4 v242, s[28:31], s97 offen offset:2048  lds
    s_nop 0
    v_cndmask_b32 v239, 0, v8, vcc
    s_and_b32 s78, s77, 7
    s_mov_b32 s95, 0x76543210
    s_cmp_eq_u32 s78, 1
    s_cselect_b32 s95, 0x76543201, s95
    s_cmp_eq_u32 s78, 2
    s_cselect_b32 s95, 0x76543120, s95
    s_cmp_eq_u32 s78, 3
    s_cselect_b32 s95, 0x76542310, s95
    s_cmp_eq_u32 s78, 4
    s_cselect_b32 s95, 0x76534210, s95
    s_cmp_eq_u32 s78, 5
    s_cselect_b32 s95, 0x76453210, s95
    s_cmp_eq_u32 s78, 6
    s_cselect_b32 s95, 0x75643210, s95
    s_cmp_eq_u32 s78, 7
    s_cselect_b32 s95, 0x67543210, s95
    s_and_b32 s78, s76, 3
    s_mul_i32 s78, s78, 0x22222222
    s_add_u32 s95, s95, s78
    s_bfe_u32 s100, s95, 0x3001c
    s_lshl_b32 s100, s100, 18
    s_bfe_u32 s95, s95, 0x30018
    s_lshl_b32 s95, s95, 18
    v_lshrrev_b32 v136, 4, v0
    v_lshlrev_b32 v136, 1, v136
    v_and_b32 v137, 7, v0
    buffer_load_dwordx4 v243, s[28:31], s97 offen offset:3072  lds
    v_xor_b32 v136, v136, v137
    v_lshlrev_b32 v136, 4, v136
    v_lshrrev_b32 v137, 3, v0
    v_lshl_add_u32 v136, v137, 11, v136
    s_add_u32 m0, s88, 36864
    s_mov_b64 exec, 0xffffffff
    buffer_load_dwordx4 v3, s[28:31], s97 offen offset:0  lds
    s_mov_b64 exec, -1
    s_lshl_b32 s78, s77, 7
    s_lshl_b32 s79, s3, 14
    s_add_u32 s78, s78, s79
    v_add_u32 v17, s78, v136
    s_waitcnt vmcnt(11)
    s_barrier
    s_mul_i32 s16, s97, 3072
    s_add_u32 m0, s60, 49152
    s_add_u32 s99, s16, s62
    buffer_load_dwordx4 v244, s[32:35], s99 offen offset:0  lds
    v_add_u32 v5, s94, v15
    ds_read_b128 v[140:143], v5 offset:32
    ds_read_b32 v156, v5 offset:48
    ds_read_b128 v[144:147], v5 offset:1056
    buffer_load_dwordx4 v245, s[32:35], s99 offen offset:1024  lds
    ds_read_b32 v157, v5 offset:1072
    ds_read_b128 v[148:151], v5 offset:2080
    ds_read_b32 v158, v5 offset:2096
    ds_read_b128 v[152:155], v5 offset:3104
    buffer_load_dwordx4 v246, s[32:35], s99 offen offset:2048  lds
    ds_read_b32 v159, v5 offset:3120
    v_lshrrev_b32 v6, 3, v0
    v_mul_u32_u24 v6, 4160, v6
    s_add_u32 m0, s61, 61440
    s_add_u32 s16, s16, s63
    buffer_load_dwordx4 v244, s[32:35], s16 offen offset:0  lds
    v_and_b32 v7, 7, v0
    v_lshl_add_u32 v6, v7, 2, v6
    v_add_u32 v6, s94, v6
    v_mov_b32 v7, 0
    buffer_load_dwordx4 v245, s[32:35], s16 offen offset:1024  lds
    s_waitcnt lgkmcnt(0)
    v_readfirstlane_b32 s93, v140
    s_nop 0
    s_lshl_b32 s93, s93, 16
    s_nop 1
    v_writelane_b32 v7, s93, 15
    buffer_load_dwordx4 v246, s[32:35], s16 offen offset:2048  lds
    v_alignbit_b32 v140, v141, v140, 16
    v_alignbit_b32 v141, v142, v141, 16
    v_alignbit_b32 v142, v143, v142, 16
    s_add_u32 s97, s98, s0
    s_lshr_b64 s[0:1], s[0:1], 4
    s_and_b32 s97, s97, 15
    s_lshr_b32 s99, s97, 3
    s_xor_b32 s97, s97, s99
    s_add_u32 m0, s87, 0
    s_lshl_b32 s97, s97, 7
    buffer_load_dwordx4 v240, s[28:31], s97 offen offset:0  lds
    v_alignbit_b32 v143, v156, v143, 16
    v_alignbit_b32 v144, v145, v144, 16
    v_alignbit_b32 v145, v146, v145, 16
    v_alignbit_b32 v146, v147, v146, 16
    buffer_load_dwordx4 v241, s[28:31], s97 offen offset:1024  lds
    v_alignbit_b32 v147, v157, v147, 16
    v_alignbit_b32 v148, v149, v148, 16
    v_alignbit_b32 v149, v150, v149, 16
    v_alignbit_b32 v150, v151, v150, 16
    buffer_load_dwordx4 v242, s[28:31], s97 offen offset:2048  lds
    v_alignbit_b32 v151, v158, v151, 16
    v_alignbit_b32 v152, v153, v152, 16
    v_alignbit_b32 v153, v154, v153, 16
    buffer_load_dwordx4 v243, s[28:31], s97 offen offset:3072  lds
    v_alignbit_b32 v154, v155, v154, 16
    v_alignbit_b32 v155, v159, v155, 16
    v_lshlrev_b32 v8, 3, v0
    s_add_u32 s78, s88, 18432
    s_add_u32 m0, s88, 0
    s_mov_b64 exec, 0xffffffff
    buffer_load_dwordx4 v3, s[28:31], s97 offen offset:0  lds
    s_mov_b64 exec, -1
    v_add_u32 v8, s78, v8
    v_mov_b32 v156, 0
    v_mov_b32 v157, 0
    s_waitcnt vmcnt(11)
    s_barrier
    s_mul_i32 s16, s97, 3072
    s_add_u32 m0, s60, 0
    s_add_u32 s99, s16, s62
    buffer_load_dwordx4 v244, s[32:35], s99 offen offset:0  lds
    buffer_load_dwordx4 v245, s[32:35], s99 offen offset:1024  lds
    buffer_load_dwordx4 v246, s[32:35], s99 offen offset:2048  lds
    s_add_u32 m0, s61, 12288
    s_add_u32 s16, s16, s63
    buffer_load_dwordx4 v244, s[32:35], s16 offen offset:0  lds
    buffer_load_dwordx4 v245, s[32:35], s16 offen offset:1024  lds
    buffer_load_dwordx4 v246, s[32:35], s16 offen offset:2048  lds
    s_mov_b64 exec, 0xff
    buffer_load_dword v136, v33, s[68:71], 0 offen sc1
    buffer_load_dword v137, v34, s[52:55], 0 offen sc1
    s_mov_b64 exec, -1
    buffer_load_dwordx4 v[212:215], v9, s[56:59], 0 offen offset:0 nt
    buffer_load_dwordx4 v[216:219], v9, s[56:59], 0 offen offset:2048 nt
    buffer_load_dwordx4 v[220:223], v9, s[56:59], s96 offen offset:0 nt
    buffer_load_dwordx4 v[224:227], v9, s[56:59], s96 offen offset:2048 nt
    s_waitcnt vmcnt(12)
    s_waitcnt vmcnt(6)
    s_barrier
    s_waitcnt vmcnt(4)
    s_branch LA_j
LA_c2:
    s_waitcnt vmcnt(11)
    s_barrier
    s_mul_i32 s16, s97, 3072
    s_add_u32 m0, s60, 49152
    s_add_u32 s99, s16, s62
    buffer_load_dwordx4 v244, s[32:35], s99 offen offset:0  lds
    buffer_load_dwordx4 v245, s[32:35], s99 offen offset:1024  lds
    buffer_load_dwordx4 v246, s[32:35], s99 offen offset:2048  lds
    s_add_u32 m0, s61, 61440
    s_add_u32 s16, s16, s63
    buffer_load_dwordx4 v244, s[32:35], s16 offen offset:0  lds
    buffer_load_dwordx4 v245, s[32:35], s16 offen offset:1024  lds
    buffer_load_dwordx4 v246, s[32:35], s16 offen offset:2048  lds
    s_add_u32 s97, s98, s0
    s_lshr_b64 s[0:1], s[0:1], 4
    s_and_b32 s97, s97, 15
    s_lshr_b32 s99, s97, 3
    s_xor_b32 s97, s97, s99
    s_add_u32 m0, s87, 0
    s_lshl_b32 s97, s97, 7
    buffer_load_dwordx4 v240, s[28:31], s97 offen offset:0  lds
    buffer_load_dwordx4 v241, s[28:31], s97 offen offset:1024  lds
    buffer_load_dwordx4 v242, s[28:31], s97 offen offset:2048  lds
    buffer_load_dwordx4 v243, s[28:31], s97 offen offset:3072  lds
    s_add_u32 m0, s88, 0
    s_mov_b64 exec, 0xffffffff
    buffer_load_dwordx4 v3, s[28:31], s97 offen offset:0  lds
    s_mov_b64 exec, -1
    s_waitcnt vmcnt(11)
    s_barrier
    s_mul_i32 s16, s97, 3072
    s_add_u32 m0, s60, 0
    s_add_u32 s99, s16, s62
    buffer_load_dwordx4 v244, s[32:35], s99 offen offset:0  lds
    buffer_load_dwordx4 v245, s[32:35], s99 offen offset:1024  lds
    buffer_load_dwordx4 v246, s[32:35], s99 offen offset:2048  lds
    s_add_u32 m0, s61, 12288
    s_add_u32 s16, s16, s63
    buffer_load_dwordx4 v244, s[32:35], s16 offen offset:0  lds
    buffer_load_dwordx4 v245, s[32:35], s16 offen offset:1024  lds
    buffer_load_dwordx4 v246, s[32:35], s16 offen offset:2048  lds
    s_add_u32 s97, s98, s0
    s_lshr_b64 s[0:1], s[0:1], 4
    s_and_b32 s97, s97, 15
    s_lshr_b32 s99, s97, 3
    s_xor_b32 s97, s97, s99
    s_add_u32 m0, s87, 18432
    s_lshl_b32 s97, s97, 7
    buffer_load_dwordx4 v240, s[28:31], s97 offen offset:0  lds
    buffer_load_dwordx4 v241, s[28:31], s97 offen offset:1024  lds
    buffer_load_dwordx4 v242, s[28:31], s97 offen offset:2048  lds
    buffer_load_dwordx4 v243, s[28:31], s97 offen offset:3072  lds
    s_add_u32 m0, s88, 18432
    s_mov_b64 exec, 0xffffffff
    buffer_load_dwordx4 v3, s[28:31], s97 offen offset:0  lds
    s_mov_b64 exec, -1
    s_waitcnt vmcnt(11)
    s_barrier
    s_mul_i32 s16, s97, 3072
    s_add_u32 m0, s60, 24576
    s_add_u32 s99, s16, s62
    buffer_load_dwordx4 v244, s[32:35], s99 offen offset:0  lds
    buffer_load_dwordx4 v245, s[32:35], s99 offen offset:1024  lds
    buffer_load_dwordx4 v246, s[32:35], s99 offen offset:2048  lds
    s_add_u32 m0, s61, 36864
    s_add_u32 s16, s16, s63
    buffer_load_dwordx4 v244, s[32:35], s16 offen offset:0  lds
    buffer_load_dwordx4 v245, s[32:35], s16 offen offset:1024  lds
    buffer_load_dwordx4 v246, s[32:35], s16 offen offset:2048  lds
    s_add_u32 m0, s86, 129536
    s_mov_b32 s89, 0
    buffer_load_dwordx4 v10, s[36:39], s89 offen nt lds
    s_add_u32 m0, s86, 145920
    s_mov_b32 s89, 0
    buffer_load_dwordx4 v10, s[40:43], s89 offen nt lds
    s_add_u32 m0, s86, 133632
    s_mov_b32 s89, 65536
    buffer_load_dwordx4 v10, s[36:39], s89 offen nt lds
    s_add_u32 m0, s86, 150016
    s_mov_b32 s89, 65536
    buffer_load_dwordx4 v10, s[40:43], s89 offen nt lds
    s_add_u32 m0, s86, 137728
    s_mov_b32 s89, 131072
    buffer_load_dwordx4 v10, s[36:39], s89 offen nt lds
    s_add_u32 m0, s86, 154112
    s_mov_b32 s89, 131072
    buffer_load_dwordx4 v10, s[40:43], s89 offen nt lds
    s_add_u32 m0, s86, 141824
    s_mov_b32 s89, 196608
    buffer_load_dwordx4 v10, s[36:39], s89 offen nt lds
    s_add_u32 m0, s86, 158208
    s_mov_b32 s89, 196608
    buffer_load_dwordx4 v10, s[40:43], s89 offen nt lds
    s_mov_b64 exec, 0xff
    s_lshl_b32 s82, s3, 7
    s_add_u32 m0, s82, 129024
    s_mov_b32 s89, 0
    buffer_load_dwordx4 v11, s[36:39], s89 offen nt lds
    s_lshl_b32 s83, s74, 9
    s_add_u32 s83, s83, s82
    s_and_b32 s89, s3, 2
    s_lshl_b32 s89, s89, 3
    s_add_u32 s82, s82, s89
    s_add_u32 m0, s82, 162816
    s_add_u32 s89, s83, 0
    buffer_load_dwordx4 v15, s[44:47], s89 offen  lds
    s_mov_b64 exec, -1
    s_add_u32 s97, s98, s0
    s_lshr_b64 s[0:1], s[0:1], 4
    s_and_b32 s97, s97, 15
    s_lshr_b32 s99, s97, 3
    s_xor_b32 s97, s97, s99
    s_add_u32 m0, s87, 36864
    s_lshl_b32 s97, s97, 7
    buffer_load_dwordx4 v240, s[28:31], s97 offen offset:0  lds
    s_waitcnt vmcnt(17)
    s_barrier
    buffer_load_dwordx4 v241, s[28:31], s97 offen offset:1024  lds
    buffer_load_dwordx4 v242, s[28:31], s97 offen offset:2048  lds
    buffer_load_dwordx4 v243, s[28:31], s97 offen offset:3072  lds
    s_add_u32 m0, s88, 36864
    s_mov_b64 exec, 0xffffffff
    buffer_load_dwordx4 v3, s[28:31], s97 offen offset:0  lds
    s_mov_b64 exec, -1
    s_mul_i32 s16, s97, 3072
    s_add_u32 m0, s60, 49152
    s_add_u32 s99, s16, s62
    buffer_load_dwordx4 v244, s[32:35], s99 offen offset:0  lds
    buffer_load_dwordx4 v245, s[32:35], s99 offen offset:1024  lds
    buffer_load_dwordx4 v246, s[32:35], s99 offen offset:2048  lds
    s_add_u32 m0, s61, 61440
    s_add_u32 s16, s16, s63
    buffer_load_dwordx4 v244, s[32:35], s16 offen offset:0  lds
    buffer_load_dwordx4 v245, s[32:35], s16 offen offset:1024  lds
    buffer_load_dwordx4 v246, s[32:35], s16 offen offset:2048  lds
    s_add_u32 s97, s98, s0
    s_lshr_b64 s[0:1], s[0:1], 4
    s_and_b32 s97, s97, 15
    s_lshr_b32 s99, s97, 3
    s_xor_b32 s97, s97, s99
    s_add_u32 m0, s87, 0
    s_lshl_b32 s97, s97, 7
    buffer_load_dwordx4 v240, s[28:31], s97 offen offset:0  lds
    buffer_load_dwordx4 v241, s[28:31], s97 offen offset:1024  lds
    buffer_load_dwordx4 v242, s[28:31], s97 offen offset:2048  lds
    buffer_load_dwordx4 v243, s[28:31], s97 offen offset:3072  lds
    s_add_u32 m0, s88, 0
    s_mov_b64 exec, 0xffffffff
    buffer_load_dwordx4 v3, s[28:31], s97 offen offset:0  lds
    s_mov_b64 exec, -1
    s_waitcnt vmcnt(11)
    s_barrier
    s_mul_i32 s16, s97, 3072
    s_add_u32 m0, s60, 0
    s_add_u32 s99, s16, s62
    buffer_load_dwordx4 v244, s[32:35], s99 offen offset:0  lds
    ds_read_b128 v[84:87], v35 offset:0
    ds_read_b128 v[88:91], v35 offset:16
    buffer_load_dwordx4 v245, s[32:35], s99 offen offset:1024  lds
    ds_read_b64 v[40:41], v16 offset:0
    ds_read_b64 v[42:43], v231 offset:256
    buffer_load_dwordx4 v246, s[32:35], s99 offen offset:2048  lds
    ds_read_b64 v[44:45], v16 offset:256
    ds_read_b64 v[46:47], v16 offset:512
    s_add_u32 m0, s61, 12288
    s_add_u32 s16, s16, s63
    buffer_load_dwordx4 v244, s[32:35], s16 offen offset:0  lds
    ds_read_b64 v[48:49], v231 offset:512
    ds_read_b64 v[50:51], v16 offset:768
    buffer_load_dwordx4 v245, s[32:35], s16 offen offset:1024  lds
    ds_read_b64 v[52:53], v231 offset:768
    ds_read_b64 v[54:55], v16 offset:1024
    buffer_load_dwordx4 v246, s[32:35], s16 offen offset:2048  lds
    ds_read_b64 v[56:57], v231 offset:1024
    ds_read_b64 v[58:59], v16 offset:1280
    s_add_u32 s97, s98, s0
    s_lshr_b64 s[0:1], s[0:1], 4
    s_and_b32 s97, s97, 15
    s_lshr_b32 s99, s97, 3
    s_xor_b32 s97, s97, s99
    s_add_u32 m0, s87, 18432
    s_lshl_b32 s97, s97, 7
    buffer_load_dwordx4 v240, s[28:31], s97 offen offset:0  lds
    ds_read_b64 v[60:61], v231 offset:1280
    ds_read_b64 v[68:69], v16 offset:16896
    buffer_load_dwordx4 v241, s[28:31], s97 offen offset:1024  lds
    ds_read_b64 v[70:71], v231 offset:16896
    ds_read_b64 v[72:73], v16 offset:17152
    buffer_load_dwordx4 v242, s[28:31], s97 offen offset:2048  lds
    ds_read_b64 v[74:75], v231 offset:17152
    ds_read_b64 v[76:77], v16 offset:17408
    buffer_load_dwordx4 v243, s[28:31], s97 offen offset:3072  lds
    ds_read_b64 v[78:79], v231 offset:17408
    ds_read_b64 v[80:81], v16 offset:17664
    s_add_u32 m0, s88, 18432
    s_mov_b64 exec, 0xffffffff
    buffer_load_dwordx4 v3, s[28:31], s97 offen offset:0  lds
    s_mov_b64 exec, -1
    ds_read_b64 v[82:83], v231 offset:17664
    s_waitcnt vmcnt(11)
    s_waitcnt lgkmcnt(0)
    s_barrier
    s_mul_i32 s16, s97, 3072
    s_add_u32 m0, s60, 24576
    s_add_u32 s99, s16, s62
    buffer_load_dwordx4 v244, s[32:35], s99 offen offset:0  lds
    v_lshlrev_b32 v160, 16, v40
    v_lshlrev_b32 v161, 16, v42
    v_lshlrev_b32 v162, 16, v44
    v_lshlrev_b32 v163, 16, v46
    v_lshlrev_b32 v164, 16, v48
    buffer_load_dwordx4 v245, s[32:35], s99 offen offset:1024  lds
    v_lshlrev_b32 v165, 16, v50
    v_lshlrev_b32 v166, 16, v52
    v_lshlrev_b32 v167, 16, v54
    v_lshlrev_b32 v168, 16, v56
    v_lshlrev_b32 v169, 16, v58
    buffer_load_dwordx4 v246, s[32:35], s99 offen offset:2048  lds
    v_lshlrev_b32 v170, 16, v60
    v_lshlrev_b32 v172, 16, v84
    v_and_b32 v173, 0xffff0000, v84
    v_lshlrev_b32 v174, 16, v85
    v_and_b32 v175, 0xffff0000, v85
    s_add_u32 m0, s61, 36864
    s_add_u32 s16, s16, s63
    buffer_load_dwordx4 v244, s[32:35], s16 offen offset:0  lds
    v_lshlrev_b32 v176, 16, v68
    v_lshlrev_b32 v177, 16, v70
    v_lshlrev_b32 v178, 16, v72
    v_lshlrev_b32 v179, 16, v74
    v_lshlrev_b32 v180, 16, v76
    buffer_load_dwordx4 v245, s[32:35], s16 offen offset:1024  lds
    v_lshlrev_b32 v181, 16, v78
    v_lshlrev_b32 v182, 16, v80
    v_lshlrev_b32 v183, 16, v82
    v_mul_f32 v184, v160, v175
    v_mul_f32 v185, v161, v175
    buffer_load_dwordx4 v246, s[32:35], s16 offen offset:2048  lds
    v_mul_f32 v186, v162, v175
    v_mul_f32 v187, v163, v175
    v_mul_f32 v188, v164, v175
    v_mul_f32 v189, v165, v175
    v_mul_f32 v190, v166, v175
    s_add_u32 s97, s98, s0
    s_lshr_b64 s[0:1], s[0:1], 4
    s_and_b32 s97, s97, 15
    s_lshr_b32 s99, s97, 3
    s_xor_b32 s97, s97, s99
    s_add_u32 m0, s87, 36864
    s_lshl_b32 s97, s97, 7
    buffer_load_dwordx4 v240, s[28:31], s97 offen offset:0  lds
    v_mul_f32 v191, v167, v175
    v_fmac_f32 v184, v161, v174
    v_fmac_f32 v185, v162, v174
    v_fmac_f32 v186, v163, v174
    v_fmac_f32 v187, v164, v174
    buffer_load_dwordx4 v241, s[28:31], s97 offen offset:1024  lds
    v_fmac_f32 v188, v165, v174
    v_fmac_f32 v189, v166, v174
    v_fmac_f32 v190, v167, v174
    v_fmac_f32 v191, v168, v174
    v_fmac_f32 v184, v162, v173
    buffer_load_dwordx4 v242, s[28:31], s97 offen offset:2048  lds
    v_fmac_f32 v185, v163, v173
    v_fmac_f32 v186, v164, v173
    v_fmac_f32 v187, v165, v173
    v_fmac_f32 v188, v166, v173
    v_fmac_f32 v189, v167, v173
    buffer_load_dwordx4 v243, s[28:31], s97 offen offset:3072  lds
    v_fmac_f32 v190, v168, v173
    v_fmac_f32 v191, v169, v173
    v_fmac_f32 v184, v163, v172
    v_fmac_f32 v185, v164, v172
    v_fmac_f32 v186, v165, v172
    s_add_u32 m0, s88, 36864
    s_mov_b64 exec, 0xffffffff
    buffer_load_dwordx4 v3, s[28:31], s97 offen offset:0  lds
    s_mov_b64 exec, -1
    v_fmac_f32 v187, v166, v172
    v_fmac_f32 v188, v167, v172
    v_fmac_f32 v189, v168, v172
    v_fmac_f32 v190, v169, v172
    v_fmac_f32 v191, v170, v172
    v_mul_f32 v184, v184, v176
    v_mul_f32 v185, v185, v177
    v_mul_f32 v186, v186, v178
    v_mul_f32 v187, v187, v179
    v_mul_f32 v188, v188, v180
    v_mul_f32 v189, v189, v181
    v_mul_f32 v190, v190, v182
    v_mul_f32 v191, v191, v183
    v_cvt_pk_bf16_f32 v100, v191, v190
    v_cvt_pk_bf16_f32 v101, v189, v188
    v_cvt_pk_bf16_f32 v102, v187, v186
    v_cvt_pk_bf16_f32 v103, v185, v184
    s_mov_b32 s89, 0
    buffer_store_dwordx4 v[100:103], v12, s[52:55], s89 offen sc1
    v_and_b32 v160, 0xffff0000, v40
    v_and_b32 v161, 0xffff0000, v42
    v_and_b32 v162, 0xffff0000, v44
    v_and_b32 v163, 0xffff0000, v46
    v_and_b32 v164, 0xffff0000, v48
    v_and_b32 v165, 0xffff0000, v50
    v_and_b32 v166, 0xffff0000, v52
    v_and_b32 v167, 0xffff0000, v54
    v_and_b32 v168, 0xffff0000, v56
    v_and_b32 v169, 0xffff0000, v58
    v_and_b32 v170, 0xffff0000, v60
    v_lshlrev_b32 v172, 16, v86
    v_and_b32 v173, 0xffff0000, v86
    v_lshlrev_b32 v174, 16, v87
    v_and_b32 v175, 0xffff0000, v87
    v_and_b32 v176, 0xffff0000, v68
    v_and_b32 v177, 0xffff0000, v70
    v_and_b32 v178, 0xffff0000, v72
    v_and_b32 v179, 0xffff0000, v74
    v_and_b32 v180, 0xffff0000, v76
    v_and_b32 v181, 0xffff0000, v78
    v_and_b32 v182, 0xffff0000, v80
    v_and_b32 v183, 0xffff0000, v82
    s_waitcnt vmcnt(12)
    s_barrier
    s_mul_i32 s16, s97, 3072
    s_add_u32 m0, s60, 49152
    s_add_u32 s99, s16, s62
    buffer_load_dwordx4 v244, s[32:35], s99 offen offset:0  lds
    v_mul_f32 v184, v160, v175
    v_mul_f32 v185, v161, v175
    v_mul_f32 v186, v162, v175
    v_mul_f32 v187, v163, v175
    v_mul_f32 v188, v164, v175
    buffer_load_dwordx4 v245, s[32:35], s99 offen offset:1024  lds
    v_mul_f32 v189, v165, v175
    v_mul_f32 v190, v166, v175
    v_mul_f32 v191, v167, v175
    v_fmac_f32 v184, v161, v174
    v_fmac_f32 v185, v162, v174
    buffer_load_dwordx4 v246, s[32:35], s99 offen offset:2048  lds
    v_fmac_f32 v186, v163, v174
    v_fmac_f32 v187, v164, v174
    v_fmac_f32 v188, v165, v174
    v_fmac_f32 v189, v166, v174
    v_fmac_f32 v190, v167, v174
    s_add_u32 m0, s61, 61440
    s_add_u32 s16, s16, s63
    buffer_load_dwordx4 v244, s[32:35], s16 offen offset:0  lds
    v_fmac_f32 v191, v168, v174
    v_fmac_f32 v184, v162, v173
    v_fmac_f32 v185, v163, v173
    v_fmac_f32 v186, v164, v173
    v_fmac_f32 v187, v165, v173
    buffer_load_dwordx4 v245, s[32:35], s16 offen offset:1024  lds
    v_fmac_f32 v188, v166, v173
    v_fmac_f32 v189, v167, v173
    v_fmac_f32 v190, v168, v173
    v_fmac_f32 v191, v169, v173
    v_fmac_f32 v184, v163, v172
    buffer_load_dwordx4 v246, s[32:35], s16 offen offset:2048  lds
    v_fmac_f32 v185, v164, v172
    v_fmac_f32 v186, v165, v172
    v_fmac_f32 v187, v166, v172
    v_fmac_f32 v188, v167, v172
    v_fmac_f32 v189, v168, v172
    s_add_u32 s97, s98, s0
    s_lshr_b64 s[0:1], s[0:1], 4
    s_and_b32 s97, s97, 15
    s_lshr_b32 s99, s97, 3
    s_xor_b32 s97, s97, s99
    s_add_u32 m0, s87, 0
    s_lshl_b32 s97, s97, 7
    buffer_load_dwordx4 v240, s[28:31], s97 offen offset:0  lds
    v_fmac_f32 v190, v169, v172
    v_fmac_f32 v191, v170, v172
    v_mul_f32 v184, v184, v176
    v_mul_f32 v185, v185, v177
    v_mul_f32 v186, v186, v178
    buffer_load_dwordx4 v241, s[28:31], s97 offen offset:1024  lds
    v_mul_f32 v187, v187, v179
    v_mul_f32 v188, v188, v180
    v_mul_f32 v189, v189, v181
    v_mul_f32 v190, v190, v182
    v_mul_f32 v191, v191, v183
    buffer_load_dwordx4 v242, s[28:31], s97 offen offset:2048  lds
    v_cvt_pk_bf16_f32 v104, v191, v190
    v_cvt_pk_bf16_f32 v105, v189, v188
    v_cvt_pk_bf16_f32 v106, v187, v186
    v_cvt_pk_bf16_f32 v107, v185, v184
    s_mov_b32 s89, 16384
    buffer_store_dwordx4 v[104:107], v12, s[52:55], s89 offen sc1
    buffer_load_dwordx4 v243, s[28:31], s97 offen offset:3072  lds
    v_lshlrev_b32 v160, 16, v41
    v_lshlrev_b32 v161, 16, v43
    v_lshlrev_b32 v162, 16, v45
    v_lshlrev_b32 v163, 16, v47
    v_lshlrev_b32 v164, 16, v49
    s_add_u32 m0, s88, 0
    s_mov_b64 exec, 0xffffffff
    buffer_load_dwordx4 v3, s[28:31], s97 offen offset:0  lds
    s_mov_b64 exec, -1
    v_lshlrev_b32 v165, 16, v51
    v_lshlrev_b32 v166, 16, v53
    v_lshlrev_b32 v167, 16, v55
    v_lshlrev_b32 v168, 16, v57
    v_lshlrev_b32 v169, 16, v59
    v_lshlrev_b32 v170, 16, v61
    v_lshlrev_b32 v172, 16, v88
    v_and_b32 v173, 0xffff0000, v88
    v_lshlrev_b32 v174, 16, v89
    v_and_b32 v175, 0xffff0000, v89
    v_lshlrev_b32 v176, 16, v69
    v_lshlrev_b32 v177, 16, v71
    v_lshlrev_b32 v178, 16, v73
    v_lshlrev_b32 v179, 16, v75
    v_lshlrev_b32 v180, 16, v77
    v_lshlrev_b32 v181, 16, v79
    v_lshlrev_b32 v182, 16, v81
    v_lshlrev_b32 v183, 16, v83
    v_mul_f32 v184, v160, v175
    v_mul_f32 v185, v161, v175
    v_mul_f32 v186, v162, v175
    v_mul_f32 v187, v163, v175
    v_mul_f32 v188, v164, v175
    v_mul_f32 v189, v165, v175
    v_mul_f32 v190, v166, v175
    v_mul_f32 v191, v167, v175
    v_fmac_f32 v184, v161, v174
    v_fmac_f32 v185, v162, v174
    v_fmac_f32 v186, v163, v174
    v_fmac_f32 v187, v164, v174
    v_fmac_f32 v188, v165, v174
    v_fmac_f32 v189, v166, v174
    v_fmac_f32 v190, v167, v174
    v_fmac_f32 v191, v168, v174
    v_fmac_f32 v184, v162, v173
    v_fmac_f32 v185, v163, v173
    v_fmac_f32 v186, v164, v173
    v_fmac_f32 v187, v165, v173
    v_fmac_f32 v188, v166, v173
    v_fmac_f32 v189, v167, v173
    v_fmac_f32 v190, v168, v173
    s_waitcnt vmcnt(13)
    s_barrier
    s_mul_i32 s16, s97, 3072
    s_add_u32 m0, s60, 0
    s_add_u32 s99, s16, s62
    buffer_load_dwordx4 v244, s[32:35], s99 offen offset:0  lds
    v_fmac_f32 v191, v169, v173
    v_fmac_f32 v184, v163, v172
    v_fmac_f32 v185, v164, v172
    v_fmac_f32 v186, v165, v172
    v_fmac_f32 v187, v166, v172
    buffer_load_dwordx4 v245, s[32:35], s99 offen offset:1024  lds
    v_fmac_f32 v188, v167, v172
    v_fmac_f32 v189, v168, v172
    v_fmac_f32 v190, v169, v172
    v_fmac_f32 v191, v170, v172
    v_mul_f32 v184, v184, v176
    buffer_load_dwordx4 v246, s[32:35], s99 offen offset:2048  lds
    v_mul_f32 v185, v185, v177
    v_mul_f32 v186, v186, v178
    v_mul_f32 v187, v187, v179
    v_mul_f32 v188, v188, v180
    v_mul_f32 v189, v189, v181
    s_add_u32 m0, s61, 12288
    s_add_u32 s16, s16, s63
    buffer_load_dwordx4 v244, s[32:35], s16 offen offset:0  lds
    v_mul_f32 v190, v190, v182
    v_mul_f32 v191, v191, v183
    v_cvt_pk_bf16_f32 v108, v191, v190
    v_cvt_pk_bf16_f32 v109, v189, v188
    v_cvt_pk_bf16_f32 v110, v187, v186
    buffer_load_dwordx4 v245, s[32:35], s16 offen offset:1024  lds
    v_cvt_pk_bf16_f32 v111, v185, v184
    s_mov_b32 s89, 32768
    buffer_store_dwordx4 v[108:111], v12, s[52:55], s89 offen sc1
    v_and_b32 v160, 0xffff0000, v41
    v_and_b32 v161, 0xffff0000, v43
    v_and_b32 v162, 0xffff0000, v45
    buffer_load_dwordx4 v246, s[32:35], s16 offen offset:2048  lds
    v_and_b32 v163, 0xffff0000, v47
    v_and_b32 v164, 0xffff0000, v49
    v_and_b32 v165, 0xffff0000, v51
    v_and_b32 v166, 0xffff0000, v53
    v_and_b32 v167, 0xffff0000, v55
    s_add_u32 s97, s98, s0
    s_lshr_b64 s[0:1], s[0:1], 4
    s_and_b32 s97, s97, 15
    s_lshr_b32 s99, s97, 3
    s_xor_b32 s97, s97, s99
    s_add_u32 m0, s87, 18432
    s_lshl_b32 s97, s97, 7
    buffer_load_dwordx4 v240, s[28:31], s97 offen offset:0  lds
    v_and_b32 v168, 0xffff0000, v57
    v_and_b32 v169, 0xffff0000, v59
    v_and_b32 v170, 0xffff0000, v61
    v_lshlrev_b32 v172, 16, v90
    v_and_b32 v173, 0xffff0000, v90
    buffer_load_dwordx4 v241, s[28:31], s97 offen offset:1024  lds
    v_lshlrev_b32 v174, 16, v91
    v_and_b32 v175, 0xffff0000, v91
    v_and_b32 v176, 0xffff0000, v69
    v_and_b32 v177, 0xffff0000, v71
    v_and_b32 v178, 0xffff0000, v73
    buffer_load_dwordx4 v242, s[28:31], s97 offen offset:2048  lds
    v_and_b32 v179, 0xffff0000, v75
    v_and_b32 v180, 0xffff0000, v77
    v_and_b32 v181, 0xffff0000, v79
    v_and_b32 v182, 0xffff0000, v81
    v_and_b32 v183, 0xffff0000, v83
    buffer_load_dwordx4 v243, s[28:31], s97 offen offset:3072  lds
    v_mul_f32 v184, v160, v175
    v_mul_f32 v185, v161, v175
    v_mul_f32 v186, v162, v175
    v_mul_f32 v187, v163, v175
    v_mul_f32 v188, v164, v175
    s_add_u32 m0, s88, 18432
    s_mov_b64 exec, 0xffffffff
    buffer_load_dwordx4 v3, s[28:31], s97 offen offset:0  lds
    s_mov_b64 exec, -1
    v_mul_f32 v189, v165, v175
    v_mul_f32 v190, v166, v175
    v_mul_f32 v191, v167, v175
    v_fmac_f32 v184, v161, v174
    v_fmac_f32 v185, v162, v174
    v_fmac_f32 v186, v163, v174
    v_fmac_f32 v187, v164, v174
    v_fmac_f32 v188, v165, v174
    v_fmac_f32 v189, v166, v174
    v_fmac_f32 v190, v167, v174
    v_fmac_f32 v191, v168, v174
    v_fmac_f32 v184, v162, v173
    v_fmac_f32 v185, v163, v173
    v_fmac_f32 v186, v164, v173
    v_fmac_f32 v187, v165, v173
    v_fmac_f32 v188, v166, v173
    v_fmac_f32 v189, v167, v173
    v_fmac_f32 v190, v168, v173
    v_fmac_f32 v191, v169, v173
    v_fmac_f32 v184, v163, v172
    v_fmac_f32 v185, v164, v172
    v_fmac_f32 v186, v165, v172
    v_fmac_f32 v187, v166, v172
    v_fmac_f32 v188, v167, v172
    v_fmac_f32 v189, v168, v172
    v_fmac_f32 v190, v169, v172
    v_fmac_f32 v191, v170, v172
    v_mul_f32 v184, v184, v176
    v_mul_f32 v185, v185, v177
    v_mul_f32 v186, v186, v178
    v_mul_f32 v187, v187, v179
    v_mul_f32 v188, v188, v180
    v_mul_f32 v189, v189, v181
    v_mul_f32 v190, v190, v182
    v_mul_f32 v191, v191, v183
    v_cvt_pk_bf16_f32 v112, v191, v190
    v_cvt_pk_bf16_f32 v113, v189, v188
    v_cvt_pk_bf16_f32 v114, v187, v186
    v_cvt_pk_bf16_f32 v115, v185, v184
    s_mov_b32 s89, 49152
    buffer_store_dwordx4 v[112:115], v12, s[52:55], s89 offen sc1
    s_waitcnt vmcnt(13)
    s_barrier
    s_mul_i32 s16, s97, 3072
    s_add_u32 m0, s60, 24576
    s_add_u32 s99, s16, s62
    buffer_load_dwordx4 v244, s[32:35], s99 offen offset:0  lds
    buffer_load_dwordx4 v245, s[32:35], s99 offen offset:1024  lds
    buffer_load_dwordx4 v246, s[32:35], s99 offen offset:2048  lds
    s_add_u32 m0, s61, 36864
    s_add_u32 s16, s16, s63
    buffer_load_dwordx4 v244, s[32:35], s16 offen offset:0  lds
    buffer_load_dwordx4 v245, s[32:35], s16 offen offset:1024  lds
    buffer_load_dwordx4 v246, s[32:35], s16 offen offset:2048  lds
    s_add_u32 s97, s98, s0
    s_lshr_b64 s[0:1], s[0:1], 4
    s_and_b32 s97, s97, 15
    s_lshr_b32 s99, s97, 3
    s_xor_b32 s97, s97, s99
    s_add_u32 m0, s87, 36864
    s_lshl_b32 s97, s97, 7
    buffer_load_dwordx4 v240, s[28:31], s97 offen offset:0  lds
    buffer_load_dwordx4 v241, s[28:31], s97 offen offset:1024  lds
    buffer_load_dwordx4 v242, s[28:31], s97 offen offset:2048  lds
    buffer_load_dwordx4 v243, s[28:31], s97 offen offset:3072  lds
    s_add_u32 m0, s88, 36864
    s_mov_b64 exec, 0xffffffff
    buffer_load_dwordx4 v3, s[28:31], s97 offen offset:0  lds
    s_mov_b64 exec, -1
    s_waitcnt vmcnt(12)
    s_waitcnt vmcnt(11)
    s_barrier
    s_mul_i32 s16, s97, 3072
    s_add_u32 m0, s60, 49152
    s_add_u32 s99, s16, s62
    buffer_load_dwordx4 v244, s[32:35], s99 offen offset:0  lds
    s_mov_b32 s68, s24
    s_mov_b32 s69, s25
    s_mov_b32 s70, 0x100
    s_mov_b32 s71, 0x20000
    v_lshrrev_b32 v6, 5, v0
    buffer_load_dwordx4 v245, s[32:35], s99 offen offset:1024  lds
    v_and_b32 v7, 3, v0
    s_lshr_b32 s78, s90, 1
    s_lshl_b32 s78, s78, 2
    s_load_dword s92, s[14:15], s78
    v_bfe_u32 v5, v0, 2, 2
    buffer_load_dwordx4 v246, s[32:35], s99 offen offset:2048  lds
    v_lshlrev_b32 v5, 1, v5
    v_lshl_add_u32 v5, v6, 3, v5
    v_bfe_u32 v8, v0, 4, 1
    v_add_u32 v5, v5, v8
    s_and_b32 s78, s3, 1
    s_add_u32 m0, s61, 61440
    s_add_u32 s16, s16, s63
    buffer_load_dwordx4 v244, s[32:35], s16 offen offset:0  lds
    s_lshl_b32 s78, s78, 1
    v_add_u32 v8, s78, v6
    v_xor_b32 v8, v8, v7
    v_lshlrev_b32 v8, 4, v8
    buffer_load_dwordx4 v245, s[32:35], s16 offen offset:1024  lds
    v_lshl_add_u32 v5, v5, 6, v8
    v_add_u32 v14, s86, v5
    v_mov_b32 v18, 162304
    v_mov_b32 v19, 1
    v_and_b32 v5, 3, v0
    buffer_load_dwordx4 v246, s[32:35], s16 offen offset:2048  lds
    s_lshl_b32 s78, s74, 4
    s_add_u32 s78, s78, s3
    v_lshl_add_u32 v6, v5, 2, s78
    s_lshr_b32 s78, s76, 3
    s_lshl_b32 s79, s3, 1
    s_add_u32 s97, s98, s0
    s_lshr_b64 s[0:1], s[0:1], 4
    s_and_b32 s97, s97, 15
    s_lshr_b32 s99, s97, 3
    s_xor_b32 s97, s97, s99
    s_add_u32 m0, s87, 0
    s_lshl_b32 s97, s97, 7
    buffer_load_dwordx4 v240, s[28:31], s97 offen offset:0  lds
    s_add_u32 s78, s78, s79
    s_xor_b32 s78, s78, 2
    s_lshl_b32 s78, s78, 5
    s_add_u32 s79, s76, 0
    s_and_b32 s79, s79, 7
    buffer_load_dwordx4 v241, s[28:31], s97 offen offset:1024  lds
    s_lshl_b32 s79, s79, 1
    s_add_u32 s78, s78, s79
    v_mul_u32_u24 v7, 9, v5
    v_and_b32 v7, 17, v7
    buffer_load_dwordx4 v242, s[28:31], s97 offen offset:2048  lds
    v_add_u32 v7, s78, v7
    v_and_b32 v8, 4, v0
    v_cmp_eq_u32 vcc, 0, v8
    s_nop 1
    v_cndmask_b32 v6, v7, v6, vcc
    v_and_b32 v33, 0xf0, v6
    buffer_load_dwordx4 v243, s[28:31], s97 offen offset:3072  lds
    v_lshlrev_b32 v34, 8, v6
    v_add_u32 v34, 12582912, v34
    v_and_b32 v5, 15, v0
    v_lshrrev_b32 v6, 4, v0
    v_add_u32 v7, 9, v5
    s_add_u32 m0, s88, 0
    s_mov_b64 exec, 0xffffffff
    buffer_load_dwordx4 v3, s[28:31], s97 offen offset:0  lds
    s_mov_b64 exec, -1
    v_and_b32 v8, 1, v7
    v_mul_u32_u24 v8, 4160, v8
    v_lshrrev_b32 v7, 1, v7
    v_lshl_add_u32 v8, v7, 2, v8
    s_waitcnt vmcnt(11)
    s_barrier
    s_mul_i32 s16, s97, 3072
    s_add_u32 m0, s60, 0
    s_add_u32 s99, s16, s62
    buffer_load_dwordx4 v244, s[32:35], s99 offen offset:0  lds
    v_lshlrev_b32 v7, 4, v6
    v_sub_u32 v8, v8, v7
    s_add_u32 s78, s94, 32
    v_add_u32 v21, s78, v8
    buffer_load_dwordx4 v245, s[32:35], s99 offen offset:1024  lds
    v_add_u32 v22, 1024, v21
    v_add_u32 v23, 2048, v21
    v_add_u32 v24, 3072, v21
    buffer_load_dwordx4 v246, s[32:35], s99 offen offset:2048  lds
    v_lshl_add_u32 v7, v5, 1, v6
    v_add_u32 v7, 30, v7
    v_and_b32 v8, 1, v7
    v_bfe_u32 v136, v7, 1, 2
    s_add_u32 m0, s61, 12288
    s_add_u32 s16, s16, s63
    buffer_load_dwordx4 v244, s[32:35], s16 offen offset:0  lds
    v_lshl_add_u32 v136, v8, 2, v136
    v_lshlrev_b32 v136, 6, v136
    v_lshrrev_b32 v7, 3, v7
    buffer_load_dwordx4 v245, s[32:35], s16 offen offset:1024  lds
    v_lshl_add_u32 v136, v7, 9, v136
    v_bitop3_b32 v8, v7, 3, s3 bitop3:0x6a
    v_lshl_add_u32 v25, v8, 4, v136
    v_add_u32 v25, 92160, v25
    buffer_load_dwordx4 v246, s[32:35], s16 offen offset:2048  lds
    v_subrev_u32 v7, 1, v7
    v_bitop3_b32 v8, v7, 3, s3 bitop3:0x6a
    v_lshl_add_u32 v27, v8, 4, v136
    s_add_u32 m0, s94, 32
    s_lshl_b32 s89, s90, 12
    buffer_load_dwordx4 v15, s[48:51], s89 offen offset:0 nt lds
    v_add_u32 v27, 91648, v27
    v_subrev_u32 v7, 1, v7
    v_bitop3_b32 v8, v7, 3, s3 bitop3:0x6a
    v_lshl_add_u32 v29, v8, 4, v136
    s_add_u32 m0, s94, 32
    s_lshl_b32 s89, s90, 12
    buffer_load_dwordx4 v15, s[48:51], s89 offen offset:1024 nt lds
    v_add_u32 v29, 91136, v29
    v_subrev_u32 v7, 1, v7
    v_bitop3_b32 v8, v7, 3, s3 bitop3:0x6a
    s_add_u32 m0, s94, 32
    s_lshl_b32 s89, s90, 12
    buffer_load_dwordx4 v15, s[48:51], s89 offen offset:2048 nt lds
    v_lshl_add_u32 v31, v8, 4, v136
    v_add_u32 v31, 90624, v31
    v_lshl_add_u32 v7, v5, 1, v6
    v_add_u32 v7, 26, v7
    s_add_u32 m0, s94, 32
    s_lshl_b32 s89, s90, 12
    buffer_load_dwordx4 v15, s[48:51], s89 offen offset:3072 nt lds
    v_and_b32 v8, 1, v7
    v_bfe_u32 v136, v7, 1, 2
    v_lshl_add_u32 v136, v8, 2, v136
    s_add_u32 s97, s98, s0
    s_lshr_b64 s[0:1], s[0:1], 4
    s_and_b32 s97, s97, 15
    s_lshr_b32 s99, s97, 3
    s_xor_b32 s97, s97, s99
    s_add_u32 m0, s87, 18432
    s_lshl_b32 s97, s97, 7
    buffer_load_dwordx4 v240, s[28:31], s97 offen offset:0  lds
    v_lshlrev_b32 v136, 6, v136
    v_lshrrev_b32 v7, 3, v7
    v_lshl_add_u32 v136, v7, 9, v136
    v_bitop3_b32 v8, v7, 3, s3 bitop3:0x6a
    buffer_load_dwordx4 v241, s[28:31], s97 offen offset:1024  lds
    v_lshl_add_u32 v26, v8, 4, v136
    v_add_u32 v26, 92160, v26
    v_subrev_u32 v7, 1, v7
    buffer_load_dwordx4 v242, s[28:31], s97 offen offset:2048  lds
    v_bitop3_b32 v8, v7, 3, s3 bitop3:0x6a
    v_lshl_add_u32 v28, v8, 4, v136
    v_add_u32 v28, 91648, v28
    v_subrev_u32 v7, 1, v7
    buffer_load_dwordx4 v243, s[28:31], s97 offen offset:3072  lds
    v_bitop3_b32 v8, v7, 3, s3 bitop3:0x6a
    v_lshl_add_u32 v30, v8, 4, v136
    v_add_u32 v30, 91136, v30
    s_add_u32 m0, s88, 18432
    s_mov_b64 exec, 0xffffffff
    buffer_load_dwordx4 v3, s[28:31], s97 offen offset:0  lds
    s_mov_b64 exec, -1
    v_subrev_u32 v7, 1, v7
    v_bitop3_b32 v8, v7, 3, s3 bitop3:0x6a
    v_lshl_add_u32 v32, v8, 4, v136
    s_waitcnt vmcnt(15)
    s_barrier
    s_mul_i32 s16, s97, 3072
    s_add_u32 m0, s60, 24576
    s_add_u32 s99, s16, s62
    buffer_load_dwordx4 v244, s[32:35], s99 offen offset:0  lds
    v_add_u32 v32, 90624, v32
    v_lshrrev_b32 v7, 1, v6
    v_lshl_add_u32 v7, v5, 1, v7
    v_add_u32 v7, 32, v7
    v_and_b32 v8, 1, v7
    buffer_load_dwordx4 v245, s[32:35], s99 offen offset:1024  lds
    v_bfe_u32 v136, v7, 1, 2
    v_lshl_add_u32 v136, v8, 2, v136
    v_lshlrev_b32 v136, 6, v136
    v_lshrrev_b32 v7, 3, v7
    buffer_load_dwordx4 v246, s[32:35], s99 offen offset:2048  lds
    v_lshl_add_u32 v136, v7, 9, v136
    v_bitop3_b32 v8, v7, 3, s3 bitop3:0x6a
    v_lshl_add_u32 v20, v8, 4, v136
    v_add_u32 v20, 92160, v20
    v_and_b32 v8, 1, v6
    s_add_u32 m0, s61, 36864
    s_add_u32 s16, s16, s63
    buffer_load_dwordx4 v244, s[32:35], s16 offen offset:0  lds
    v_xor_b32 v8, 1, v8
    v_lshl_add_u32 v20, v8, 3, v20
    s_waitcnt lgkmcnt(0)
    s_and_b32 s78, s92, 0xffff0000
    buffer_load_dwordx4 v245, s[32:35], s16 offen offset:1024  lds
    s_lshl_b32 s92, s92, 16
    s_bitcmp1_b32 s90, 0
    s_cselect_b32 s92, s78, s92
    v_lshlrev_b32 v7, 3, v6
    v_sub_u32 v7, v7, v5
    buffer_load_dwordx4 v246, s[32:35], s16 offen offset:2048  lds
    v_subrev_u32 v7, 9, v7
    v_and_b32 v8, 1, v7
    v_xor_b32 v8, 1, v8
    v_lshlrev_b32 v8, 4, v8
    v_lshrrev_b32 v8, v8, s92
    s_add_u32 s97, s98, s0
    s_lshr_b64 s[0:1], s[0:1], 4
    s_and_b32 s97, s97, 15
    s_lshr_b32 s99, s97, 3
    s_xor_b32 s97, s97, s99
    s_add_u32 m0, s87, 36864
    s_lshl_b32 s97, s97, 7
    buffer_load_dwordx4 v240, s[28:31], s97 offen offset:0  lds
    v_ashrrev_i32 v7, 1, v7
    v_cmp_eq_u32 vcc, 0, v7
    s_nop 1
    v_cndmask_b32 v236, 0, v8, vcc
    v_cmp_eq_u32 vcc, 1, v7
    buffer_load_dwordx4 v241, s[28:31], s97 offen offset:1024  lds
    s_nop 0
    v_cndmask_b32 v237, 0, v8, vcc
    v_cmp_eq_u32 vcc, 2, v7
    s_nop 1
    v_cndmask_b32 v238, 0, v8, vcc
    v_cmp_eq_u32 vcc, 3, v7
    buffer_load_dwordx4 v242, s[28:31], s97 offen offset:2048  lds
    s_nop 0
    v_cndmask_b32 v239, 0, v8, vcc
    s_and_b32 s78, s77, 7
    s_mov_b32 s95, 0x76543210
    s_cmp_eq_u32 s78, 1
    s_cselect_b32 s95, 0x76543201, s95
    s_cmp_eq_u32 s78, 2
    s_cselect_b32 s95, 0x76543120, s95
    s_cmp_eq_u32 s78, 3
    s_cselect_b32 s95, 0x76542310, s95
    s_cmp_eq_u32 s78, 4
    s_cselect_b32 s95, 0x76534210, s95
    s_cmp_eq_u32 s78, 5
    s_cselect_b32 s95, 0x76453210, s95
    s_cmp_eq_u32 s78, 6
    s_cselect_b32 s95, 0x75643210, s95
    s_cmp_eq_u32 s78, 7
    s_cselect_b32 s95, 0x67543210, s95
    s_and_b32 s78, s76, 3
    s_mul_i32 s78, s78, 0x22222222
    s_add_u32 s95, s95, s78
    s_bfe_u32 s100, s95, 0x3001c
    s_lshl_b32 s100, s100, 18
    s_bfe_u32 s95, s95, 0x30018
    s_lshl_b32 s95, s95, 18
    v_lshrrev_b32 v136, 4, v0
    v_lshlrev_b32 v136, 1, v136
    v_and_b32 v137, 7, v0
    buffer_load_dwordx4 v243, s[28:31], s97 offen offset:3072  lds
    v_xor_b32 v136, v136, v137
    v_lshlrev_b32 v136, 4, v136
    v_lshrrev_b32 v137, 3, v0
    v_lshl_add_u32 v136, v137, 11, v136
    s_add_u32 m0, s88, 36864
    s_mov_b64 exec, 0xffffffff
    buffer_load_dwordx4 v3, s[28:31], s97 offen offset:0  lds
    s_mov_b64 exec, -1
    s_lshl_b32 s78, s77, 7
    s_lshl_b32 s79, s3, 14
    s_add_u32 s78, s78, s79
    v_add_u32 v17, s78, v136
    s_waitcnt vmcnt(11)
    s_barrier
    s_mul_i32 s16, s97, 3072
    s_add_u32 m0, s60, 49152
    s_add_u32 s99, s16, s62
    buffer_load_dwordx4 v244, s[32:35], s99 offen offset:0  lds
    v_add_u32 v5, s94, v15
    ds_read_b128 v[140:143], v5 offset:32
    ds_read_b32 v156, v5 offset:48
    ds_read_b128 v[144:147], v5 offset:1056
    buffer_load_dwordx4 v245, s[32:35], s99 offen offset:1024  lds
    ds_read_b32 v157, v5 offset:1072
    ds_read_b128 v[148:151], v5 offset:2080
    ds_read_b32 v158, v5 offset:2096
    ds_read_b128 v[152:155], v5 offset:3104
    buffer_load_dwordx4 v246, s[32:35], s99 offen offset:2048  lds
    ds_read_b32 v159, v5 offset:3120
    v_lshrrev_b32 v6, 3, v0
    v_mul_u32_u24 v6, 4160, v6
    s_add_u32 m0, s61, 61440
    s_add_u32 s16, s16, s63
    buffer_load_dwordx4 v244, s[32:35], s16 offen offset:0  lds
    v_and_b32 v7, 7, v0
    v_lshl_add_u32 v6, v7, 2, v6
    v_add_u32 v6, s94, v6
    v_mov_b32 v7, 0
    buffer_load_dwordx4 v245, s[32:35], s16 offen offset:1024  lds
    s_waitcnt lgkmcnt(0)
    v_readfirstlane_b32 s93, v140
    s_nop 0
    s_lshl_b32 s93, s93, 16
    s_nop 1
    v_writelane_b32 v7, s93, 15
    buffer_load_dwordx4 v246, s[32:35], s16 offen offset:2048  lds
    v_alignbit_b32 v140, v141, v140, 16
    v_alignbit_b32 v141, v142, v141, 16
    v_alignbit_b32 v142, v143, v142, 16
    s_add_u32 s97, s98, s0
    s_lshr_b64 s[0:1], s[0:1], 4
    s_and_b32 s97, s97, 15
    s_lshr_b32 s99, s97, 3
    s_xor_b32 s97, s97, s99
    s_add_u32 m0, s87, 0
    s_lshl_b32 s97, s97, 7
    buffer_load_dwordx4 v240, s[28:31], s97 offen offset:0  lds
    v_alignbit_b32 v143, v156, v143, 16
    v_alignbit_b32 v144, v145, v144, 16
    v_alignbit_b32 v145, v146, v145, 16
    v_alignbit_b32 v146, v147, v146, 16
    buffer_load_dwordx4 v241, s[28:31], s97 offen offset:1024  lds
    v_alignbit_b32 v147, v157, v147, 16
    v_alignbit_b32 v148, v149, v148, 16
    v_alignbit_b32 v149, v150, v149, 16
    v_alignbit_b32 v150, v151, v150, 16
    buffer_load_dwordx4 v242, s[28:31], s97 offen offset:2048  lds
    v_alignbit_b32 v151, v158, v151, 16
    v_alignbit_b32 v152, v153, v152, 16
    v_alignbit_b32 v153, v154, v153, 16
    buffer_load_dwordx4 v243, s[28:31], s97 offen offset:3072  lds
    v_alignbit_b32 v154, v155, v154, 16
    v_alignbit_b32 v155, v159, v155, 16
    v_lshlrev_b32 v8, 3, v0
    s_add_u32 s78, s88, 18432
    s_add_u32 m0, s88, 0
    s_mov_b64 exec, 0xffffffff
    buffer_load_dwordx4 v3, s[28:31], s97 offen offset:0  lds
    s_mov_b64 exec, -1
    v_add_u32 v8, s78, v8
    v_mov_b32 v156, 0
    v_mov_b32 v157, 0
    s_waitcnt vmcnt(11)
    s_barrier
    s_mul_i32 s16, s97, 3072
    s_add_u32 m0, s60, 0
    s_add_u32 s99, s16, s62
    buffer_load_dwordx4 v244, s[32:35], s99 offen offset:0  lds
    buffer_load_dwordx4 v245, s[32:35], s99 offen offset:1024  lds
    buffer_load_dwordx4 v246, s[32:35], s99 offen offset:2048  lds
    s_add_u32 m0, s61, 12288
    s_add_u32 s16, s16, s63
    buffer_load_dwordx4 v244, s[32:35], s16 offen offset:0  lds
    buffer_load_dwordx4 v245, s[32:35], s16 offen offset:1024  lds
    buffer_load_dwordx4 v246, s[32:35], s16 offen offset:2048  lds
    s_mov_b64 exec, 0xff
    buffer_load_dword v136, v33, s[68:71], 0 offen sc1
    buffer_load_dword v137, v34, s[52:55], 0 offen sc1
    s_mov_b64 exec, -1
    buffer_load_dwordx4 v[212:215], v9, s[56:59], 0 offen offset:0 nt
    buffer_load_dwordx4 v[216:219], v9, s[56:59], 0 offen offset:2048 nt
    buffer_load_dwordx4 v[220:223], v9, s[56:59], s96 offen offset:0 nt
    buffer_load_dwordx4 v[224:227], v9, s[56:59], s96 offen offset:2048 nt
    s_waitcnt vmcnt(12)
    s_waitcnt vmcnt(6)
    s_barrier
    s_waitcnt vmcnt(4)
    s_branch LA_j
LA_c3:
    s_waitcnt vmcnt(11)
    s_barrier
    s_mul_i32 s16, s97, 3072
    s_add_u32 m0, s60, 49152
    s_add_u32 s99, s16, s62
    buffer_load_dwordx4 v244, s[32:35], s99 offen offset:0  lds
    buffer_load_dwordx4 v245, s[32:35], s99 offen offset:1024  lds
    buffer_load_dwordx4 v246, s[32:35], s99 offen offset:2048  lds
    s_add_u32 m0, s61, 61440
    s_add_u32 s16, s16, s63
    buffer_load_dwordx4 v244, s[32:35], s16 offen offset:0  lds
    buffer_load_dwordx4 v245, s[32:35], s16 offen offset:1024  lds
    buffer_load_dwordx4 v246, s[32:35], s16 offen offset:2048  lds
    s_add_u32 s97, s98, s0
    s_lshr_b64 s[0:1], s[0:1], 4
    s_and_b32 s97, s97, 15
    s_lshr_b32 s99, s97, 3
    s_xor_b32 s97, s97, s99
    s_add_u32 m0, s87, 0
    s_lshl_b32 s97, s97, 7
    buffer_load_dwordx4 v240, s[28:31], s97 offen offset:0  lds
    buffer_load_dwordx4 v241, s[28:31], s97 offen offset:1024  lds
    buffer_load_dwordx4 v242, s[28:31], s97 offen offset:2048  lds
    buffer_load_dwordx4 v243, s[28:31], s97 offen offset:3072  lds
    s_add_u32 m0, s88, 0
    s_mov_b64 exec, 0xffffffff
    buffer_load_dwordx4 v3, s[28:31], s97 offen offset:0  lds
    s_mov_b64 exec, -1
    s_waitcnt vmcnt(11)
    s_barrier
    s_mul_i32 s16, s97, 3072
    s_add_u32 m0, s60, 0
    s_add_u32 s99, s16, s62
    buffer_load_dwordx4 v244, s[32:35], s99 offen offset:0  lds
    buffer_load_dwordx4 v245, s[32:35], s99 offen offset:1024  lds
    buffer_load_dwordx4 v246, s[32:35], s99 offen offset:2048  lds
    s_add_u32 m0, s61, 12288
    s_add_u32 s16, s16, s63
    buffer_load_dwordx4 v244, s[32:35], s16 offen offset:0  lds
    buffer_load_dwordx4 v245, s[32:35], s16 offen offset:1024  lds
    buffer_load_dwordx4 v246, s[32:35], s16 offen offset:2048  lds
    s_add_u32 s97, s98, s0
    s_lshr_b64 s[0:1], s[0:1], 4
    s_and_b32 s97, s97, 15
    s_lshr_b32 s99, s97, 3
    s_xor_b32 s97, s97, s99
    s_add_u32 m0, s87, 18432
    s_lshl_b32 s97, s97, 7
    buffer_load_dwordx4 v240, s[28:31], s97 offen offset:0  lds
    buffer_load_dwordx4 v241, s[28:31], s97 offen offset:1024  lds
    buffer_load_dwordx4 v242, s[28:31], s97 offen offset:2048  lds
    buffer_load_dwordx4 v243, s[28:31], s97 offen offset:3072  lds
    s_add_u32 m0, s88, 18432
    s_mov_b64 exec, 0xffffffff
    buffer_load_dwordx4 v3, s[28:31], s97 offen offset:0  lds
    s_mov_b64 exec, -1
    s_waitcnt vmcnt(11)
    s_barrier
    s_mul_i32 s16, s97, 3072
    s_add_u32 m0, s60, 24576
    s_add_u32 s99, s16, s62
    buffer_load_dwordx4 v244, s[32:35], s99 offen offset:0  lds
    buffer_load_dwordx4 v245, s[32:35], s99 offen offset:1024  lds
    buffer_load_dwordx4 v246, s[32:35], s99 offen offset:2048  lds
    s_add_u32 m0, s61, 36864
    s_add_u32 s16, s16, s63
    buffer_load_dwordx4 v244, s[32:35], s16 offen offset:0  lds
    buffer_load_dwordx4 v245, s[32:35], s16 offen offset:1024  lds
    buffer_load_dwordx4 v246, s[32:35], s16 offen offset:2048  lds
    s_add_u32 m0, s86, 129536
    s_mov_b32 s89, 0
    buffer_load_dwordx4 v10, s[36:39], s89 offen nt lds
    s_add_u32 m0, s86, 145920
    s_mov_b32 s89, 0
    buffer_load_dwordx4 v10, s[40:43], s89 offen nt lds
    s_add_u32 m0, s86, 133632
    s_mov_b32 s89, 65536
    buffer_load_dwordx4 v10, s[36:39], s89 offen nt lds
    s_add_u32 m0, s86, 150016
    s_mov_b32 s89, 65536
    buffer_load_dwordx4 v10, s[40:43], s89 offen nt lds
    s_add_u32 m0, s86, 137728
    s_mov_b32 s89, 131072
    buffer_load_dwordx4 v10, s[36:39], s89 offen nt lds
    s_add_u32 m0, s86, 154112
    s_mov_b32 s89, 131072
    buffer_load_dwordx4 v10, s[40:43], s89 offen nt lds
    s_add_u32 m0, s86, 141824
    s_mov_b32 s89, 196608
    buffer_load_dwordx4 v10, s[36:39], s89 offen nt lds
    s_add_u32 m0, s86, 158208
    s_mov_b32 s89, 196608
    buffer_load_dwordx4 v10, s[40:43], s89 offen nt lds
    s_mov_b64 exec, 0xff
    s_lshl_b32 s82, s3, 7
    s_add_u32 m0, s82, 129024
    s_mov_b32 s89, 0
    buffer_load_dwordx4 v11, s[36:39], s89 offen nt lds
    s_lshl_b32 s83, s74, 9
    s_add_u32 s83, s83, s82
    s_and_b32 s89, s3, 2
    s_lshl_b32 s89, s89, 3
    s_add_u32 s82, s82, s89
    s_add_u32 m0, s82, 162816
    s_add_u32 s89, s83, 0
    buffer_load_dwordx4 v15, s[44:47], s89 offen  lds
    s_mov_b64 exec, -1
    s_add_u32 s97, s98, s0
    s_lshr_b64 s[0:1], s[0:1], 4
    s_and_b32 s97, s97, 15
    s_lshr_b32 s99, s97, 3
    s_xor_b32 s97, s97, s99
    s_add_u32 m0, s87, 36864
    s_lshl_b32 s97, s97, 7
    buffer_load_dwordx4 v240, s[28:31], s97 offen offset:0  lds
    s_waitcnt vmcnt(17)
    s_barrier
    buffer_load_dwordx4 v241, s[28:31], s97 offen offset:1024  lds
    buffer_load_dwordx4 v242, s[28:31], s97 offen offset:2048  lds
    buffer_load_dwordx4 v243, s[28:31], s97 offen offset:3072  lds
    s_add_u32 m0, s88, 36864
    s_mov_b64 exec, 0xffffffff
    buffer_load_dwordx4 v3, s[28:31], s97 offen offset:0  lds
    s_mov_b64 exec, -1
    s_mul_i32 s16, s97, 3072
    s_add_u32 m0, s60, 49152
    s_add_u32 s99, s16, s62
    buffer_load_dwordx4 v244, s[32:35], s99 offen offset:0  lds
    buffer_load_dwordx4 v245, s[32:35], s99 offen offset:1024  lds
    buffer_load_dwordx4 v246, s[32:35], s99 offen offset:2048  lds
    s_add_u32 m0, s61, 61440
    s_add_u32 s16, s16, s63
    buffer_load_dwordx4 v244, s[32:35], s16 offen offset:0  lds
    buffer_load_dwordx4 v245, s[32:35], s16 offen offset:1024  lds
    buffer_load_dwordx4 v246, s[32:35], s16 offen offset:2048  lds
    s_add_u32 s97, s98, s0
    s_lshr_b64 s[0:1], s[0:1], 4
    s_and_b32 s97, s97, 15
    s_lshr_b32 s99, s97, 3
    s_xor_b32 s97, s97, s99
    s_add_u32 m0, s87, 0
    s_lshl_b32 s97, s97, 7
    buffer_load_dwordx4 v240, s[28:31], s97 offen offset:0  lds
    buffer_load_dwordx4 v241, s[28:31], s97 offen offset:1024  lds
    buffer_load_dwordx4 v242, s[28:31], s97 offen offset:2048  lds
    buffer_load_dwordx4 v243, s[28:31], s97 offen offset:3072  lds
    s_add_u32 m0, s88, 0
    s_mov_b64 exec, 0xffffffff
    buffer_load_dwordx4 v3, s[28:31], s97 offen offset:0  lds
    s_mov_b64 exec, -1
    s_waitcnt vmcnt(11)
    s_barrier
    s_mul_i32 s16, s97, 3072
    s_add_u32 m0, s60, 0
    s_add_u32 s99, s16, s62
    buffer_load_dwordx4 v244, s[32:35], s99 offen offset:0  lds
    ds_read_b128 v[84:87], v35 offset:0
    ds_read_b128 v[88:91], v35 offset:16
    buffer_load_dwordx4 v245, s[32:35], s99 offen offset:1024  lds
    ds_read_b64 v[40:41], v16 offset:0
    ds_read_b64 v[42:43], v231 offset:256
    buffer_load_dwordx4 v246, s[32:35], s99 offen offset:2048  lds
    ds_read_b64 v[44:45], v16 offset:256
    ds_read_b64 v[46:47], v16 offset:512
    s_add_u32 m0, s61, 12288
    s_add_u32 s16, s16, s63
    buffer_load_dwordx4 v244, s[32:35], s16 offen offset:0  lds
    ds_read_b64 v[48:49], v231 offset:512
    ds_read_b64 v[50:51], v16 offset:768
    buffer_load_dwordx4 v245, s[32:35], s16 offen offset:1024  lds
    ds_read_b64 v[52:53], v231 offset:768
    ds_read_b64 v[54:55], v16 offset:1024
    buffer_load_dwordx4 v246, s[32:35], s16 offen offset:2048  lds
    ds_read_b64 v[56:57], v231 offset:1024
    ds_read_b64 v[58:59], v16 offset:1280
    s_add_u32 s97, s98, s0
    s_lshr_b64 s[0:1], s[0:1], 4
    s_and_b32 s97, s97, 15
    s_lshr_b32 s99, s97, 3
    s_xor_b32 s97, s97, s99
    s_add_u32 m0, s87, 18432
    s_lshl_b32 s97, s97, 7
    buffer_load_dwordx4 v240, s[28:31], s97 offen offset:0  lds
    ds_read_b64 v[60:61], v231 offset:1280
    ds_read_b64 v[68:69], v16 offset:16896
    buffer_load_dwordx4 v241, s[28:31], s97 offen offset:1024  lds
    ds_read_b64 v[70:71], v231 offset:16896
    ds_read_b64 v[72:73], v16 offset:17152
    buffer_load_dwordx4 v242, s[28:31], s97 offen offset:2048  lds
    ds_read_b64 v[74:75], v231 offset:17152
    ds_read_b64 v[76:77], v16 offset:17408
    buffer_load_dwordx4 v243, s[28:31], s97 offen offset:3072  lds
    ds_read_b64 v[78:79], v231 offset:17408
    ds_read_b64 v[80:81], v16 offset:17664
    s_add_u32 m0, s88, 18432
    s_mov_b64 exec, 0xffffffff
    buffer_load_dwordx4 v3, s[28:31], s97 offen offset:0  lds
    s_mov_b64 exec, -1
    ds_read_b64 v[82:83], v231 offset:17664
    s_waitcnt vmcnt(11)
    s_waitcnt lgkmcnt(0)
    s_barrier
    s_mul_i32 s16, s97, 3072
    s_add_u32 m0, s60, 24576
    s_add_u32 s99, s16, s62
    buffer_load_dwordx4 v244, s[32:35], s99 offen offset:0  lds
    v_lshlrev_b32 v160, 16, v40
    v_lshlrev_b32 v161, 16, v42
    v_lshlrev_b32 v162, 16, v44
    v_lshlrev_b32 v163, 16, v46
    v_lshlrev_b32 v164, 16, v48
    buffer_load_dwordx4 v245, s[32:35], s99 offen offset:1024  lds
    v_lshlrev_b32 v165, 16, v50
    v_lshlrev_b32 v166, 16, v52
    v_lshlrev_b32 v167, 16, v54
    v_lshlrev_b32 v168, 16, v56
    v_lshlrev_b32 v169, 16, v58
    buffer_load_dwordx4 v246, s[32:35], s99 offen offset:2048  lds
    v_lshlrev_b32 v170, 16, v60
    v_lshlrev_b32 v172, 16, v84
    v_and_b32 v173, 0xffff0000, v84
    v_lshlrev_b32 v174, 16, v85
    v_and_b32 v175, 0xffff0000, v85
    s_add_u32 m0, s61, 36864
    s_add_u32 s16, s16, s63
    buffer_load_dwordx4 v244, s[32:35], s16 offen offset:0  lds
    v_lshlrev_b32 v176, 16, v68
    v_lshlrev_b32 v177, 16, v70
    v_lshlrev_b32 v178, 16, v72
    v_lshlrev_b32 v179, 16, v74
    v_lshlrev_b32 v180, 16, v76
    buffer_load_dwordx4 v245, s[32:35], s16 offen offset:1024  lds
    v_lshlrev_b32 v181, 16, v78
    v_lshlrev_b32 v182, 16, v80
    v_lshlrev_b32 v183, 16, v82
    v_mul_f32 v184, v160, v175
    v_mul_f32 v185, v161, v175
    buffer_load_dwordx4 v246, s[32:35], s16 offen offset:2048  lds
    v_mul_f32 v186, v162, v175
    v_mul_f32 v187, v163, v175
    v_mul_f32 v188, v164, v175
    v_mul_f32 v189, v165, v175
    v_mul_f32 v190, v166, v175
    s_add_u32 s97, s98, s0
    s_lshr_b64 s[0:1], s[0:1], 4
    s_and_b32 s97, s97, 15
    s_lshr_b32 s99, s97, 3
    s_xor_b32 s97, s97, s99
    s_add_u32 m0, s87, 36864
    s_lshl_b32 s97, s97, 7
    buffer_load_dwordx4 v240, s[28:31], s97 offen offset:0  lds
    v_mul_f32 v191, v167, v175
    v_fmac_f32 v184, v161, v174
    v_fmac_f32 v185, v162, v174
    v_fmac_f32 v186, v163, v174
    v_fmac_f32 v187, v164, v174
    buffer_load_dwordx4 v241, s[28:31], s97 offen offset:1024  lds
    v_fmac_f32 v188, v165, v174
    v_fmac_f32 v189, v166, v174
    v_fmac_f32 v190, v167, v174
    v_fmac_f32 v191, v168, v174
    v_fmac_f32 v184, v162, v173
    buffer_load_dwordx4 v242, s[28:31], s97 offen offset:2048  lds
    v_fmac_f32 v185, v163, v173
    v_fmac_f32 v186, v164, v173
    v_fmac_f32 v187, v165, v173
    v_fmac_f32 v188, v166, v173
    v_fmac_f32 v189, v167, v173
    buffer_load_dwordx4 v243, s[28:31], s97 offen offset:3072  lds
    v_fmac_f32 v190, v168, v173
    v_fmac_f32 v191, v169, v173
    v_fmac_f32 v184, v163, v172
    v_fmac_f32 v185, v164, v172
    v_fmac_f32 v186, v165, v172
    s_add_u32 m0, s88, 36864
    s_mov_b64 exec, 0xffffffff
    buffer_load_dwordx4 v3, s[28:31], s97 offen offset:0  lds
    s_mov_b64 exec, -1
    v_fmac_f32 v187, v166, v172
    v_fmac_f32 v188, v167, v172
    v_fmac_f32 v189, v168, v172
    v_fmac_f32 v190, v169, v172
    v_fmac_f32 v191, v170, v172
    v_mul_f32 v184, v184, v176
    v_mul_f32 v185, v185, v177
    v_mul_f32 v186, v186, v178
    v_mul_f32 v187, v187, v179
    v_mul_f32 v188, v188, v180
    v_mul_f32 v189, v189, v181
    v_mul_f32 v190, v190, v182
    v_mul_f32 v191, v191, v183
    v_cvt_pk_bf16_f32 v100, v191, v190
    v_cvt_pk_bf16_f32 v101, v189, v188
    v_cvt_pk_bf16_f32 v102, v187, v186
    v_cvt_pk_bf16_f32 v103, v185, v184
    s_mov_b32 s89, 0
    buffer_store_dwordx4 v[100:103], v12, s[52:55], s89 offen sc1
    v_and_b32 v160, 0xffff0000, v40
    v_and_b32 v161, 0xffff0000, v42
    v_and_b32 v162, 0xffff0000, v44
    v_and_b32 v163, 0xffff0000, v46
    v_and_b32 v164, 0xffff0000, v48
    v_and_b32 v165, 0xffff0000, v50
    v_and_b32 v166, 0xffff0000, v52
    v_and_b32 v167, 0xffff0000, v54
    v_and_b32 v168, 0xffff0000, v56
    v_and_b32 v169, 0xffff0000, v58
    v_and_b32 v170, 0xffff0000, v60
    v_lshlrev_b32 v172, 16, v86
    v_and_b32 v173, 0xffff0000, v86
    v_lshlrev_b32 v174, 16, v87
    v_and_b32 v175, 0xffff0000, v87
    v_and_b32 v176, 0xffff0000, v68
    v_and_b32 v177, 0xffff0000, v70
    v_and_b32 v178, 0xffff0000, v72
    v_and_b32 v179, 0xffff0000, v74
    v_and_b32 v180, 0xffff0000, v76
    v_and_b32 v181, 0xffff0000, v78
    v_and_b32 v182, 0xffff0000, v80
    v_and_b32 v183, 0xffff0000, v82
    s_waitcnt vmcnt(12)
    s_barrier
    s_mul_i32 s16, s97, 3072
    s_add_u32 m0, s60, 49152
    s_add_u32 s99, s16, s62
    buffer_load_dwordx4 v244, s[32:35], s99 offen offset:0  lds
    v_mul_f32 v184, v160, v175
    v_mul_f32 v185, v161, v175
    v_mul_f32 v186, v162, v175
    v_mul_f32 v187, v163, v175
    v_mul_f32 v188, v164, v175
    buffer_load_dwordx4 v245, s[32:35], s99 offen offset:1024  lds
    v_mul_f32 v189, v165, v175
    v_mul_f32 v190, v166, v175
    v_mul_f32 v191, v167, v175
    v_fmac_f32 v184, v161, v174
    v_fmac_f32 v185, v162, v174
    buffer_load_dwordx4 v246, s[32:35], s99 offen offset:2048  lds
    v_fmac_f32 v186, v163, v174
    v_fmac_f32 v187, v164, v174
    v_fmac_f32 v188, v165, v174
    v_fmac_f32 v189, v166, v174
    v_fmac_f32 v190, v167, v174
    s_add_u32 m0, s61, 61440
    s_add_u32 s16, s16, s63
    buffer_load_dwordx4 v244, s[32:35], s16 offen offset:0  lds
    v_fmac_f32 v191, v168, v174
    v_fmac_f32 v184, v162, v173
    v_fmac_f32 v185, v163, v173
    v_fmac_f32 v186, v164, v173
    v_fmac_f32 v187, v165, v173
    buffer_load_dwordx4 v245, s[32:35], s16 offen offset:1024  lds
    v_fmac_f32 v188, v166, v173
    v_fmac_f32 v189, v167, v173
    v_fmac_f32 v190, v168, v173
    v_fmac_f32 v191, v169, v173
    v_fmac_f32 v184, v163, v172
    buffer_load_dwordx4 v246, s[32:35], s16 offen offset:2048  lds
    v_fmac_f32 v185, v164, v172
    v_fmac_f32 v186, v165, v172
    v_fmac_f32 v187, v166, v172
    v_fmac_f32 v188, v167, v172
    v_fmac_f32 v189, v168, v172
    s_add_u32 s97, s98, s0
    s_lshr_b64 s[0:1], s[0:1], 4
    s_and_b32 s97, s97, 15
    s_lshr_b32 s99, s97, 3
    s_xor_b32 s97, s97, s99
    s_add_u32 m0, s87, 0
    s_lshl_b32 s97, s97, 7
    buffer_load_dwordx4 v240, s[28:31], s97 offen offset:0  lds
    v_fmac_f32 v190, v169, v172
    v_fmac_f32 v191, v170, v172
    v_mul_f32 v184, v184, v176
    v_mul_f32 v185, v185, v177
    v_mul_f32 v186, v186, v178
    buffer_load_dwordx4 v241, s[28:31], s97 offen offset:1024  lds
    v_mul_f32 v187, v187, v179
    v_mul_f32 v188, v188, v180
    v_mul_f32 v189, v189, v181
    v_mul_f32 v190, v190, v182
    v_mul_f32 v191, v191, v183
    buffer_load_dwordx4 v242, s[28:31], s97 offen offset:2048  lds
    v_cvt_pk_bf16_f32 v104, v191, v190
    v_cvt_pk_bf16_f32 v105, v189, v188
    v_cvt_pk_bf16_f32 v106, v187, v186
    v_cvt_pk_bf16_f32 v107, v185, v184
    s_mov_b32 s89, 16384
    buffer_store_dwordx4 v[104:107], v12, s[52:55], s89 offen sc1
    buffer_load_dwordx4 v243, s[28:31], s97 offen offset:3072  lds
    v_lshlrev_b32 v160, 16, v41
    v_lshlrev_b32 v161, 16, v43
    v_lshlrev_b32 v162, 16, v45
    v_lshlrev_b32 v163, 16, v47
    v_lshlrev_b32 v164, 16, v49
    s_add_u32 m0, s88, 0
    s_mov_b64 exec, 0xffffffff
    buffer_load_dwordx4 v3, s[28:31], s97 offen offset:0  lds
    s_mov_b64 exec, -1
    v_lshlrev_b32 v165, 16, v51
    v_lshlrev_b32 v166, 16, v53
    v_lshlrev_b32 v167, 16, v55
    v_lshlrev_b32 v168, 16, v57
    v_lshlrev_b32 v169, 16, v59
    v_lshlrev_b32 v170, 16, v61
    v_lshlrev_b32 v172, 16, v88
    v_and_b32 v173, 0xffff0000, v88
    v_lshlrev_b32 v174, 16, v89
    v_and_b32 v175, 0xffff0000, v89
    v_lshlrev_b32 v176, 16, v69
    v_lshlrev_b32 v177, 16, v71
    v_lshlrev_b32 v178, 16, v73
    v_lshlrev_b32 v179, 16, v75
    v_lshlrev_b32 v180, 16, v77
    v_lshlrev_b32 v181, 16, v79
    v_lshlrev_b32 v182, 16, v81
    v_lshlrev_b32 v183, 16, v83
    v_mul_f32 v184, v160, v175
    v_mul_f32 v185, v161, v175
    v_mul_f32 v186, v162, v175
    v_mul_f32 v187, v163, v175
    v_mul_f32 v188, v164, v175
    v_mul_f32 v189, v165, v175
    v_mul_f32 v190, v166, v175
    v_mul_f32 v191, v167, v175
    v_fmac_f32 v184, v161, v174
    v_fmac_f32 v185, v162, v174
    v_fmac_f32 v186, v163, v174
    v_fmac_f32 v187, v164, v174
    v_fmac_f32 v188, v165, v174
    v_fmac_f32 v189, v166, v174
    v_fmac_f32 v190, v167, v174
    v_fmac_f32 v191, v168, v174
    v_fmac_f32 v184, v162, v173
    v_fmac_f32 v185, v163, v173
    v_fmac_f32 v186, v164, v173
    v_fmac_f32 v187, v165, v173
    v_fmac_f32 v188, v166, v173
    v_fmac_f32 v189, v167, v173
    v_fmac_f32 v190, v168, v173
    s_waitcnt vmcnt(13)
    s_barrier
    s_mul_i32 s16, s97, 3072
    s_add_u32 m0, s60, 0
    s_add_u32 s99, s16, s62
    buffer_load_dwordx4 v244, s[32:35], s99 offen offset:0  lds
    v_fmac_f32 v191, v169, v173
    v_fmac_f32 v184, v163, v172
    v_fmac_f32 v185, v164, v172
    v_fmac_f32 v186, v165, v172
    v_fmac_f32 v187, v166, v172
    buffer_load_dwordx4 v245, s[32:35], s99 offen offset:1024  lds
    v_fmac_f32 v188, v167, v172
    v_fmac_f32 v189, v168, v172
    v_fmac_f32 v190, v169, v172
    v_fmac_f32 v191, v170, v172
    v_mul_f32 v184, v184, v176
    buffer_load_dwordx4 v246, s[32:35], s99 offen offset:2048  lds
    v_mul_f32 v185, v185, v177
    v_mul_f32 v186, v186, v178
    v_mul_f32 v187, v187, v179
    v_mul_f32 v188, v188, v180
    v_mul_f32 v189, v189, v181
    s_add_u32 m0, s61, 12288
    s_add_u32 s16, s16, s63
    buffer_load_dwordx4 v244, s[32:35], s16 offen offset:0  lds
    v_mul_f32 v190, v190, v182
    v_mul_f32 v191, v191, v183
    v_cvt_pk_bf16_f32 v108, v191, v190
    v_cvt_pk_bf16_f32 v109, v189, v188
    v_cvt_pk_bf16_f32 v110, v187, v186
    buffer_load_dwordx4 v245, s[32:35], s16 offen offset:1024  lds
    v_cvt_pk_bf16_f32 v111, v185, v184
    s_mov_b32 s89, 32768
    buffer_store_dwordx4 v[108:111], v12, s[52:55], s89 offen sc1
    v_and_b32 v160, 0xffff0000, v41
    v_and_b32 v161, 0xffff0000, v43
    v_and_b32 v162, 0xffff0000, v45
    buffer_load_dwordx4 v246, s[32:35], s16 offen offset:2048  lds
    v_and_b32 v163, 0xffff0000, v47
    v_and_b32 v164, 0xffff0000, v49
    v_and_b32 v165, 0xffff0000, v51
    v_and_b32 v166, 0xffff0000, v53
    v_and_b32 v167, 0xffff0000, v55
    s_add_u32 m0, s94, 32
    s_lshl_b32 s89, s90, 12
    buffer_load_dwordx4 v15, s[48:51], s89 offen offset:0 nt lds
    v_and_b32 v168, 0xffff0000, v57
    v_and_b32 v169, 0xffff0000, v59
    v_and_b32 v170, 0xffff0000, v61
    v_lshlrev_b32 v172, 16, v90
    v_and_b32 v173, 0xffff0000, v90
    s_add_u32 m0, s94, 32
    s_lshl_b32 s89, s90, 12
    buffer_load_dwordx4 v15, s[48:51], s89 offen offset:1024 nt lds
    v_lshlrev_b32 v174, 16, v91
    v_and_b32 v175, 0xffff0000, v91
    v_and_b32 v176, 0xffff0000, v69
    v_and_b32 v177, 0xffff0000, v71
    v_and_b32 v178, 0xffff0000, v73
    s_add_u32 m0, s94, 32
    s_lshl_b32 s89, s90, 12
    buffer_load_dwordx4 v15, s[48:51], s89 offen offset:2048 nt lds
    v_and_b32 v179, 0xffff0000, v75
    v_and_b32 v180, 0xffff0000, v77
    v_and_b32 v181, 0xffff0000, v79
    v_and_b32 v182, 0xffff0000, v81
    v_and_b32 v183, 0xffff0000, v83
    s_add_u32 m0, s94, 32
    s_lshl_b32 s89, s90, 12
    buffer_load_dwordx4 v15, s[48:51], s89 offen offset:3072 nt lds
    v_mul_f32 v184, v160, v175
    v_mul_f32 v185, v161, v175
    v_mul_f32 v186, v162, v175
    v_mul_f32 v187, v163, v175
    v_mul_f32 v188, v164, v175
    s_add_u32 s97, s98, s0
    s_lshr_b64 s[0:1], s[0:1], 4
    s_and_b32 s97, s97, 15
    s_lshr_b32 s99, s97, 3
    s_xor_b32 s97, s97, s99
    s_add_u32 m0, s87, 18432
    s_lshl_b32 s97, s97, 7
    buffer_load_dwordx4 v240, s[28:31], s97 offen offset:0  lds
    v_mul_f32 v189, v165, v175
    v_mul_f32 v190, v166, v175
    v_mul_f32 v191, v167, v175
    v_fmac_f32 v184, v161, v174
    v_fmac_f32 v185, v162, v174
    buffer_load_dwordx4 v241, s[28:31], s97 offen offset:1024  lds
    v_fmac_f32 v186, v163, v174
    v_fmac_f32 v187, v164, v174
    v_fmac_f32 v188, v165, v174
    v_fmac_f32 v189, v166, v174
    v_fmac_f32 v190, v167, v174
    buffer_load_dwordx4 v242, s[28:31], s97 offen offset:2048  lds
    v_fmac_f32 v191, v168, v174
    v_fmac_f32 v184, v162, v173
    v_fmac_f32 v185, v163, v173
    v_fmac_f32 v186, v164, v173
    v_fmac_f32 v187, v165, v173
    buffer_load_dwordx4 v243, s[28:31], s97 offen offset:3072  lds
    v_fmac_f32 v188, v166, v173
    v_fmac_f32 v189, v167, v173
    v_fmac_f32 v190, v168, v173
    v_fmac_f32 v191, v169, v173
    v_fmac_f32 v184, v163, v172
    s_add_u32 m0, s88, 18432
    s_mov_b64 exec, 0xffffffff
    buffer_load_dwordx4 v3, s[28:31], s97 offen offset:0  lds
    s_mov_b64 exec, -1
    v_fmac_f32 v185, v164, v172
    v_fmac_f32 v186, v165, v172
    v_fmac_f32 v187, v166, v172
    v_fmac_f32 v188, v167, v172
    v_fmac_f32 v189, v168, v172
    v_fmac_f32 v190, v169, v172
    v_fmac_f32 v191, v170, v172
    v_mul_f32 v184, v184, v176
    v_mul_f32 v185, v185, v177
    v_mul_f32 v186, v186, v178
    v_mul_f32 v187, v187, v179
    v_mul_f32 v188, v188, v180
    v_mul_f32 v189, v189, v181
    v_mul_f32 v190, v190, v182
    v_mul_f32 v191, v191, v183
    v_cvt_pk_bf16_f32 v112, v191, v190
    v_cvt_pk_bf16_f32 v113, v189, v188
    v_cvt_pk_bf16_f32 v114, v187, v186
    v_cvt_pk_bf16_f32 v115, v185, v184
    s_mov_b32 s89, 49152
    buffer_store_dwordx4 v[112:115], v12, s[52:55], s89 offen sc1
    s_waitcnt vmcnt(17)
    s_barrier
    s_mul_i32 s16, s97, 3072
    s_add_u32 m0, s60, 24576
    s_add_u32 s99, s16, s62
    buffer_load_dwordx4 v244, s[32:35], s99 offen offset:0  lds
    buffer_load_dwordx4 v245, s[32:35], s99 offen offset:1024  lds
    buffer_load_dwordx4 v246, s[32:35], s99 offen offset:2048  lds
    s_add_u32 m0, s61, 36864
    s_add_u32 s16, s16, s63
    buffer_load_dwordx4 v244, s[32:35], s16 offen offset:0  lds
    buffer_load_dwordx4 v245, s[32:35], s16 offen offset:1024  lds
    buffer_load_dwordx4 v246, s[32:35], s16 offen offset:2048  lds
    s_add_u32 s97, s98, s0
    s_lshr_b64 s[0:1], s[0:1], 4
    s_and_b32 s97, s97, 15
    s_lshr_b32 s99, s97, 3
    s_xor_b32 s97, s97, s99
    s_add_u32 m0, s87, 36864
    s_lshl_b32 s97, s97, 7
    buffer_load_dwordx4 v240, s[28:31], s97 offen offset:0  lds
    buffer_load_dwordx4 v241, s[28:31], s97 offen offset:1024  lds
    buffer_load_dwordx4 v242, s[28:31], s97 offen offset:2048  lds
    buffer_load_dwordx4 v243, s[28:31], s97 offen offset:3072  lds
    s_add_u32 m0, s88, 36864
    s_mov_b64 exec, 0xffffffff
    buffer_load_dwordx4 v3, s[28:31], s97 offen offset:0  lds
    s_mov_b64 exec, -1
    s_waitcnt vmcnt(12)
    s_waitcnt vmcnt(11)
    s_barrier
    s_mul_i32 s16, s97, 3072
    s_add_u32 m0, s60, 49152
    s_add_u32 s99, s16, s62
    buffer_load_dwordx4 v244, s[32:35], s99 offen offset:0  lds
    s_mov_b32 s68, s24
    s_mov_b32 s69, s25
    s_mov_b32 s70, 0x100
    s_mov_b32 s71, 0x20000
    v_lshrrev_b32 v6, 5, v0
    buffer_load_dwordx4 v245, s[32:35], s99 offen offset:1024  lds
    v_and_b32 v7, 3, v0
    s_lshr_b32 s78, s90, 1
    s_lshl_b32 s78, s78, 2
    s_load_dword s92, s[14:15], s78
    v_bfe_u32 v5, v0, 2, 2
    buffer_load_dwordx4 v246, s[32:35], s99 offen offset:2048  lds
    v_lshlrev_b32 v5, 1, v5
    v_lshl_add_u32 v5, v6, 3, v5
    v_bfe_u32 v8, v0, 4, 1
    v_add_u32 v5, v5, v8
    s_and_b32 s78, s3, 1
    s_add_u32 m0, s61, 61440
    s_add_u32 s16, s16, s63
    buffer_load_dwordx4 v244, s[32:35], s16 offen offset:0  lds
    s_lshl_b32 s78, s78, 1
    v_add_u32 v8, s78, v6
    v_xor_b32 v8, v8, v7
    v_lshlrev_b32 v8, 4, v8
    buffer_load_dwordx4 v245, s[32:35], s16 offen offset:1024  lds
    v_lshl_add_u32 v5, v5, 6, v8
    v_add_u32 v14, s86, v5
    v_mov_b32 v18, 162304
    v_mov_b32 v19, 1
    v_and_b32 v5, 3, v0
    buffer_load_dwordx4 v246, s[32:35], s16 offen offset:2048  lds
    s_lshl_b32 s78, s74, 4
    s_add_u32 s78, s78, s3
    v_lshl_add_u32 v6, v5, 2, s78
    s_lshr_b32 s78, s76, 3
    s_lshl_b32 s79, s3, 1
    s_add_u32 s97, s98, s0
    s_lshr_b64 s[0:1], s[0:1], 4
    s_and_b32 s97, s97, 15
    s_lshr_b32 s99, s97, 3
    s_xor_b32 s97, s97, s99
    s_add_u32 m0, s87, 0
    s_lshl_b32 s97, s97, 7
    buffer_load_dwordx4 v240, s[28:31], s97 offen offset:0  lds
    s_add_u32 s78, s78, s79
    s_xor_b32 s78, s78, 2
    s_lshl_b32 s78, s78, 5
    s_add_u32 s79, s76, 0
    s_and_b32 s79, s79, 7
    buffer_load_dwordx4 v241, s[28:31], s97 offen offset:1024  lds
    s_lshl_b32 s79, s79, 1
    s_add_u32 s78, s78, s79
    v_mul_u32_u24 v7, 9, v5
    v_and_b32 v7, 17, v7
    buffer_load_dwordx4 v242, s[28:31], s97 offen offset:2048  lds
    v_add_u32 v7, s78, v7
    v_and_b32 v8, 4, v0
    v_cmp_eq_u32 vcc, 0, v8
    s_nop 1
    v_cndmask_b32 v6, v7, v6, vcc
    v_and_b32 v33, 0xf0, v6
    buffer_load_dwordx4 v243, s[28:31], s97 offen offset:3072  lds
    v_lshlrev_b32 v34, 8, v6
    v_add_u32 v34, 12582912, v34
    v_and_b32 v5, 15, v0
    v_lshrrev_b32 v6, 4, v0
    v_add_u32 v7, 9, v5
    s_add_u32 m0, s88, 0
    s_mov_b64 exec, 0xffffffff
    buffer_load_dwordx4 v3, s[28:31], s97 offen offset:0  lds
    s_mov_b64 exec, -1
    v_and_b32 v8, 1, v7
    v_mul_u32_u24 v8, 4160, v8
    v_lshrrev_b32 v7, 1, v7
    v_lshl_add_u32 v8, v7, 2, v8
    s_waitcnt vmcnt(11)
    s_barrier
    s_mul_i32 s16, s97, 3072
    s_add_u32 m0, s60, 0
    s_add_u32 s99, s16, s62
    buffer_load_dwordx4 v244, s[32:35], s99 offen offset:0  lds
    v_lshlrev_b32 v7, 4, v6
    v_sub_u32 v8, v8, v7
    s_add_u32 s78, s94, 32
    v_add_u32 v21, s78, v8
    v_add_u32 v22, 1024, v21
    buffer_load_dwordx4 v245, s[32:35], s99 offen offset:1024  lds
    v_add_u32 v23, 2048, v21
    v_add_u32 v24, 3072, v21
    v_lshl_add_u32 v7, v5, 1, v6
    v_add_u32 v7, 30, v7
    v_and_b32 v8, 1, v7
    buffer_load_dwordx4 v246, s[32:35], s99 offen offset:2048  lds
    v_bfe_u32 v136, v7, 1, 2
    v_lshl_add_u32 v136, v8, 2, v136
    v_lshlrev_b32 v136, 6, v136
    v_lshrrev_b32 v7, 3, v7
    v_lshl_add_u32 v136, v7, 9, v136
    s_add_u32 m0, s61, 12288
    s_add_u32 s16, s16, s63
    buffer_load_dwordx4 v244, s[32:35], s16 offen offset:0  lds
    v_bitop3_b32 v8, v7, 3, s3 bitop3:0x6a
    v_lshl_add_u32 v25, v8, 4, v136
    v_add_u32 v25, 92160, v25
    v_subrev_u32 v7, 1, v7
    buffer_load_dwordx4 v245, s[32:35], s16 offen offset:1024  lds
    v_bitop3_b32 v8, v7, 3, s3 bitop3:0x6a
    v_lshl_add_u32 v27, v8, 4, v136
    v_add_u32 v27, 91648, v27
    v_subrev_u32 v7, 1, v7
    v_bitop3_b32 v8, v7, 3, s3 bitop3:0x6a
    buffer_load_dwordx4 v246, s[32:35], s16 offen offset:2048  lds
    v_lshl_add_u32 v29, v8, 4, v136
    v_add_u32 v29, 91136, v29
    v_subrev_u32 v7, 1, v7
    v_bitop3_b32 v8, v7, 3, s3 bitop3:0x6a
    v_lshl_add_u32 v31, v8, 4, v136
    s_add_u32 s97, s98, s0
    s_lshr_b64 s[0:1], s[0:1], 4
    s_and_b32 s97, s97, 15
    s_lshr_b32 s99, s97, 3
    s_xor_b32 s97, s97, s99
    s_add_u32 m0, s87, 18432
    s_lshl_b32 s97, s97, 7
    buffer_load_dwordx4 v240, s[28:31], s97 offen offset:0  lds
    v_add_u32 v31, 90624, v31
    v_lshl_add_u32 v7, v5, 1, v6
    v_add_u32 v7, 26, v7
    v_and_b32 v8, 1, v7
    v_bfe_u32 v136, v7, 1, 2
    buffer_load_dwordx4 v241, s[28:31], s97 offen offset:1024  lds
    v_lshl_add_u32 v136, v8, 2, v136
    v_lshlrev_b32 v136, 6, v136
    v_lshrrev_b32 v7, 3, v7
    v_lshl_add_u32 v136, v7, 9, v136
    buffer_load_dwordx4 v242, s[28:31], s97 offen offset:2048  lds
    v_bitop3_b32 v8, v7, 3, s3 bitop3:0x6a
    v_lshl_add_u32 v26, v8, 4, v136
    v_add_u32 v26, 92160, v26
    v_subrev_u32 v7, 1, v7
    v_bitop3_b32 v8, v7, 3, s3 bitop3:0x6a
    buffer_load_dwordx4 v243, s[28:31], s97 offen offset:3072  lds
    v_lshl_add_u32 v28, v8, 4, v136
    v_add_u32 v28, 91648, v28
    v_subrev_u32 v7, 1, v7
    v_bitop3_b32 v8, v7, 3, s3 bitop3:0x6a
    v_lshl_add_u32 v30, v8, 4, v136
    s_add_u32 m0, s88, 18432
    s_mov_b64 exec, 0xffffffff
    buffer_load_dwordx4 v3, s[28:31], s97 offen offset:0  lds
    s_mov_b64 exec, -1
    v_add_u32 v30, 91136, v30
    v_subrev_u32 v7, 1, v7
    v_bitop3_b32 v8, v7, 3, s3 bitop3:0x6a
    v_lshl_add_u32 v32, v8, 4, v136
    s_waitcnt vmcnt(11)
    s_barrier
    s_mul_i32 s16, s97, 3072
    s_add_u32 m0, s60, 24576
    s_add_u32 s99, s16, s62
    buffer_load_dwordx4 v244, s[32:35], s99 offen offset:0  lds
    v_add_u32 v32, 90624, v32
    v_lshrrev_b32 v7, 1, v6
    v_lshl_add_u32 v7, v5, 1, v7
    v_add_u32 v7, 32, v7
    v_and_b32 v8, 1, v7
    buffer_load_dwordx4 v245, s[32:35], s99 offen offset:1024  lds
    v_bfe_u32 v136, v7, 1, 2
    v_lshl_add_u32 v136, v8, 2, v136
    v_lshlrev_b32 v136, 6, v136
    v_lshrrev_b32 v7, 3, v7
    buffer_load_dwordx4 v246, s[32:35], s99 offen offset:2048  lds
    v_lshl_add_u32 v136, v7, 9, v136
    v_bitop3_b32 v8, v7, 3, s3 bitop3:0x6a
    v_lshl_add_u32 v20, v8, 4, v136
    v_add_u32 v20, 92160, v20
    v_and_b32 v8, 1, v6
    s_add_u32 m0, s61, 36864
    s_add_u32 s16, s16, s63
    buffer_load_dwordx4 v244, s[32:35], s16 offen offset:0  lds
    v_xor_b32 v8, 1, v8
    v_lshl_add_u32 v20, v8, 3, v20
    s_waitcnt lgkmcnt(0)
    s_and_b32 s78, s92, 0xffff0000
    buffer_load_dwordx4 v245, s[32:35], s16 offen offset:1024  lds
    s_lshl_b32 s92, s92, 16
    s_bitcmp1_b32 s90, 0
    s_cselect_b32 s92, s78, s92
    v_lshlrev_b32 v7, 3, v6
    v_sub_u32 v7, v7, v5
    buffer_load_dwordx4 v246, s[32:35], s16 offen offset:2048  lds
    v_subrev_u32 v7, 9, v7
    v_and_b32 v8, 1, v7
    v_xor_b32 v8, 1, v8
    v_lshlrev_b32 v8, 4, v8
    v_lshrrev_b32 v8, v8, s92
    s_add_u32 s97, s98, s0
    s_lshr_b64 s[0:1], s[0:1], 4
    s_and_b32 s97, s97, 15
    s_lshr_b32 s99, s97, 3
    s_xor_b32 s97, s97, s99
    s_add_u32 m0, s87, 36864
    s_lshl_b32 s97, s97, 7
    buffer_load_dwordx4 v240, s[28:31], s97 offen offset:0  lds
    v_ashrrev_i32 v7, 1, v7
    v_cmp_eq_u32 vcc, 0, v7
    s_nop 1
    v_cndmask_b32 v236, 0, v8, vcc
    v_cmp_eq_u32 vcc, 1, v7
    buffer_load_dwordx4 v241, s[28:31], s97 offen offset:1024  lds
    s_nop 0
    v_cndmask_b32 v237, 0, v8, vcc
    v_cmp_eq_u32 vcc, 2, v7
    s_nop 1
    v_cndmask_b32 v238, 0, v8, vcc
    v_cmp_eq_u32 vcc, 3, v7
    buffer_load_dwordx4 v242, s[28:31], s97 offen offset:2048  lds
    s_nop 0
    v_cndmask_b32 v239, 0, v8, vcc
    s_and_b32 s78, s77, 7
    s_mov_b32 s95, 0x76543210
    s_cmp_eq_u32 s78, 1
    s_cselect_b32 s95, 0x76543201, s95
    s_cmp_eq_u32 s78, 2
    s_cselect_b32 s95, 0x76543120, s95
    s_cmp_eq_u32 s78, 3
    s_cselect_b32 s95, 0x76542310, s95
    s_cmp_eq_u32 s78, 4
    s_cselect_b32 s95, 0x76534210, s95
    s_cmp_eq_u32 s78, 5
    s_cselect_b32 s95, 0x76453210, s95
    s_cmp_eq_u32 s78, 6
    s_cselect_b32 s95, 0x75643210, s95
    s_cmp_eq_u32 s78, 7
    s_cselect_b32 s95, 0x67543210, s95
    s_and_b32 s78, s76, 3
    s_mul_i32 s78, s78, 0x22222222
    s_add_u32 s95, s95, s78
    s_bfe_u32 s100, s95, 0x3001c
    s_lshl_b32 s100, s100, 18
    s_bfe_u32 s95, s95, 0x30018
    s_lshl_b32 s95, s95, 18
    v_lshrrev_b32 v136, 4, v0
    v_lshlrev_b32 v136, 1, v136
    v_and_b32 v137, 7, v0
    buffer_load_dwordx4 v243, s[28:31], s97 offen offset:3072  lds
    v_xor_b32 v136, v136, v137
    v_lshlrev_b32 v136, 4, v136
    v_lshrrev_b32 v137, 3, v0
    v_lshl_add_u32 v136, v137, 11, v136
    s_add_u32 m0, s88, 36864
    s_mov_b64 exec, 0xffffffff
    buffer_load_dwordx4 v3, s[28:31], s97 offen offset:0  lds
    s_mov_b64 exec, -1
    s_lshl_b32 s78, s77, 7
    s_lshl_b32 s79, s3, 14
    s_add_u32 s78, s78, s79
    v_add_u32 v17, s78, v136
    s_waitcnt vmcnt(11)
    s_barrier
    s_mul_i32 s16, s97, 3072
    s_add_u32 m0, s60, 49152
    s_add_u32 s99, s16, s62
    buffer_load_dwordx4 v244, s[32:35], s99 offen offset:0  lds
    v_add_u32 v5, s94, v15
    ds_read_b128 v[140:143], v5 offset:32
    ds_read_b32 v156, v5 offset:48
    ds_read_b128 v[144:147], v5 offset:1056
    buffer_load_dwordx4 v245, s[32:35], s99 offen offset:1024  lds
    ds_read_b32 v157, v5 offset:1072
    ds_read_b128 v[148:151], v5 offset:2080
    ds_read_b32 v158, v5 offset:2096
    ds_read_b128 v[152:155], v5 offset:3104
    buffer_load_dwordx4 v246, s[32:35], s99 offen offset:2048  lds
    ds_read_b32 v159, v5 offset:3120
    v_lshrrev_b32 v6, 3, v0
    v_mul_u32_u24 v6, 4160, v6
    s_add_u32 m0, s61, 61440
    s_add_u32 s16, s16, s63
    buffer_load_dwordx4 v244, s[32:35], s16 offen offset:0  lds
    v_and_b32 v7, 7, v0
    v_lshl_add_u32 v6, v7, 2, v6
    v_add_u32 v6, s94, v6
    v_mov_b32 v7, 0
    buffer_load_dwordx4 v245, s[32:35], s16 offen offset:1024  lds
    s_waitcnt lgkmcnt(0)
    v_readfirstlane_b32 s93, v140
    s_nop 0
    s_lshl_b32 s93, s93, 16
    s_nop 1
    v_writelane_b32 v7, s93, 15
    buffer_load_dwordx4 v246, s[32:35], s16 offen offset:2048  lds
    v_alignbit_b32 v140, v141, v140, 16
    v_alignbit_b32 v141, v142, v141, 16
    v_alignbit_b32 v142, v143, v142, 16
    s_add_u32 s97, s98, s0
    s_lshr_b64 s[0:1], s[0:1], 4
    s_and_b32 s97, s97, 15
    s_lshr_b32 s99, s97, 3
    s_xor_b32 s97, s97, s99
    s_add_u32 m0, s87, 0
    s_lshl_b32 s97, s97, 7
    buffer_load_dwordx4 v240, s[28:31], s97 offen offset:0  lds
    v_alignbit_b32 v143, v156, v143, 16
    v_alignbit_b32 v144, v145, v144, 16
    v_alignbit_b32 v145, v146, v145, 16
    v_alignbit_b32 v146, v147, v146, 16
    buffer_load_dwordx4 v241, s[28:31], s97 offen offset:1024  lds
    v_alignbit_b32 v147, v157, v147, 16
    v_alignbit_b32 v148, v149, v148, 16
    v_alignbit_b32 v149, v150, v149, 16
    v_alignbit_b32 v150, v151, v150, 16
    buffer_load_dwordx4 v242, s[28:31], s97 offen offset:2048  lds
    v_alignbit_b32 v151, v158, v151, 16
    v_alignbit_b32 v152, v153, v152, 16
    v_alignbit_b32 v153, v154, v153, 16
    buffer_load_dwordx4 v243, s[28:31], s97 offen offset:3072  lds
    v_alignbit_b32 v154, v155, v154, 16
    v_alignbit_b32 v155, v159, v155, 16
    v_lshlrev_b32 v8, 3, v0
    s_add_u32 s78, s88, 18432
    s_add_u32 m0, s88, 0
    s_mov_b64 exec, 0xffffffff
    buffer_load_dwordx4 v3, s[28:31], s97 offen offset:0  lds
    s_mov_b64 exec, -1
    v_add_u32 v8, s78, v8
    v_mov_b32 v156, 0
    v_mov_b32 v157, 0
    s_waitcnt vmcnt(11)
    s_barrier
    s_mul_i32 s16, s97, 3072
    s_add_u32 m0, s60, 0
    s_add_u32 s99, s16, s62
    buffer_load_dwordx4 v244, s[32:35], s99 offen offset:0  lds
    buffer_load_dwordx4 v245, s[32:35], s99 offen offset:1024  lds
    buffer_load_dwordx4 v246, s[32:35], s99 offen offset:2048  lds
    s_add_u32 m0, s61, 12288
    s_add_u32 s16, s16, s63
    buffer_load_dwordx4 v244, s[32:35], s16 offen offset:0  lds
    buffer_load_dwordx4 v245, s[32:35], s16 offen offset:1024  lds
    buffer_load_dwordx4 v246, s[32:35], s16 offen offset:2048  lds
    s_mov_b64 exec, 0xff
    buffer_load_dword v136, v33, s[68:71], 0 offen sc1
    buffer_load_dword v137, v34, s[52:55], 0 offen sc1
    s_mov_b64 exec, -1
    buffer_load_dwordx4 v[212:215], v9, s[56:59], 0 offen offset:0 nt
    buffer_load_dwordx4 v[216:219], v9, s[56:59], 0 offen offset:2048 nt
    buffer_load_dwordx4 v[220:223], v9, s[56:59], s96 offen offset:0 nt
    buffer_load_dwordx4 v[224:227], v9, s[56:59], s96 offen offset:2048 nt
    s_waitcnt vmcnt(12)
    s_waitcnt vmcnt(6)
    s_barrier
    s_waitcnt vmcnt(4)
LA_j:
    s_mov_b64 exec, 0xff
    v_cmp_ne_u32 vcc, v136, v137
    v_cmp_gt_u32 s[80:81], s96, v136
    s_nop 0
    s_or_b64 vcc, vcc, s[80:81]
    s_cbranch_vccnz LA_slow
LA_back:
    s_mov_b64 exec, -1
    s_add_u32 m0, s86, 94208
    s_add_u32 s89, s91, 0
    buffer_load_dwordx4 v14, s[52:55], s89 offen sc1 lds
    s_add_u32 m0, s86, 98304
    s_add_u32 s89, s91, 4096
    buffer_load_dwordx4 v14, s[52:55], s89 offen sc1 lds
    s_add_u32 m0, s86, 102400
    s_add_u32 s89, s91, 8192
    buffer_load_dwordx4 v14, s[52:55], s89 offen sc1 lds
    s_add_u32 m0, s86, 106496
    s_add_u32 s89, s91, 12288
    buffer_load_dwordx4 v14, s[52:55], s89 offen sc1 lds
    s_add_u32 s89, s95, 131072
    buffer_load_dwordx4 v[228:231], v17, s[64:67], s89 offen
    s_add_u32 s89, s95, 196608
    buffer_load_dwordx4 v[232:235], v17, s[64:67], s89 offen
    s_add_u32 s89, s100, 0
    buffer_load_dwordx4 v[240:243], v17, s[64:67], s89 offen
    s_add_u32 s89, s100, 65536
    buffer_load_dwordx4 v[244:247], v17, s[64:67], s89 offen
    s_add_u32 s89, s100, 131072
    buffer_load_dwordx4 v[248:251], v17, s[64:67], s89 offen
    s_add_u32 s89, s100, 196608
    buffer_load_dwordx4 v[196:199], v17, s[64:67], s89 offen
    s_mov_b64 exec, 0xffff
    ds_write_b32 v6, v7
    s_mov_b64 exec, -1
    ds_write_b128 v5, v[140:143] offset:4192
    ds_write_b128 v5, v[144:147] offset:5216
    ds_write_b128 v5, v[148:151] offset:6240
    ds_write_b128 v5, v[152:155] offset:7264
    ds_write_b64 v8, v[156:157]
    ds_read2_b32 v[68:69], v21 offset0:0 offset1:1
    ds_read2_b32 v[70:71], v21 offset0:2 offset1:3
    ds_read2_b32 v[72:73], v21 offset0:128 offset1:129
    ds_read2_b32 v[74:75], v21 offset0:130 offset1:131
    ds_read2_b32 v[76:77], v22 offset0:0 offset1:1
    ds_read2_b32 v[78:79], v22 offset0:2 offset1:3
    ds_read2_b32 v[80:81], v22 offset0:128 offset1:129
    ds_read2_b32 v[82:83], v22 offset0:130 offset1:131
    ds_read2_b32 v[84:85], v23 offset0:0 offset1:1
    ds_read2_b32 v[86:87], v23 offset0:2 offset1:3
    ds_read2_b32 v[88:89], v23 offset0:128 offset1:129
    ds_read2_b32 v[90:91], v23 offset0:130 offset1:131
    ds_read2_b32 v[92:93], v24 offset0:0 offset1:1
    ds_read2_b32 v[94:95], v24 offset0:2 offset1:3
    ds_read2_b32 v[96:97], v24 offset0:128 offset1:129
    ds_read2_b32 v[98:99], v24 offset0:130 offset1:131
    s_waitcnt vmcnt(6)
    s_mov_b64 exec, 1
    ds_add_u32 v18, v19 offset:20
    s_mov_b64 exec, -1
    s_branch LA_s5_in
LA_s5:
    s_sleep 1
LA_s5_in:
    ds_read_b32 v6, v18 offset:20
    s_waitcnt lgkmcnt(0)
    v_readfirstlane_b32 s78, v6
    s_nop 0
    s_cmp_ge_u32 s78, 4
    s_cbranch_scc0 LA_s5
    s_mov_b64 exec, 1
    ds_add_u32 v18, v19 offset:8
    s_mov_b64 exec, -1
    ds_read_b128 v[100:103], v25 offset:0
    ds_read_b128 v[104:107], v25 offset:2048
    ds_read_b128 v[108:111], v25 offset:4096
    ds_read_b128 v[112:115], v25 offset:6144
    ds_read_b128 v[116:119], v25 offset:8192
    ds_read_b128 v[120:123], v25 offset:10240
    ds_read_b128 v[124:127], v25 offset:12288
    ds_read_b128 v[128:131], v25 offset:14336
    s_setprio 2
    s_waitcnt lgkmcnt(7)
    v_mfma_f32_16x16x32_bf16 v[36:39], v[236:239], v[100:103], 0
    ds_read2_b32 v[132:133], v21 offset0:16 offset1:17
    v_mfma_f32_16x16x32_bf16 v[36:39], v[68:71], v[100:103], v[36:39]
    ds_read2_b32 v[134:135], v21 offset0:18 offset1:19
    s_waitcnt lgkmcnt(8)
    v_mfma_f32_16x16x32_bf16 v[40:43], v[236:239], v[104:107], 0
    v_mfma_f32_16x16x32_bf16 v[40:43], v[68:71], v[104:107], v[40:43]
    ds_read_b128 v[164:167], v26 offset:0
    v_mfma_f32_16x16x32_bf16 v[40:43], v[72:75], v[100:103], v[40:43]
    s_waitcnt lgkmcnt(8)
    v_mfma_f32_16x16x32_bf16 v[44:47], v[236:239], v[108:111], 0
    ds_read2_b32 v[136:137], v21 offset0:144 offset1:145
    v_mfma_f32_16x16x32_bf16 v[44:47], v[68:71], v[108:111], v[44:47]
    ds_read2_b32 v[138:139], v21 offset0:146 offset1:147
    v_mfma_f32_16x16x32_bf16 v[44:47], v[72:75], v[104:107], v[44:47]
    v_mfma_f32_16x16x32_bf16 v[44:47], v[76:79], v[100:103], v[44:47]
    ds_read_b128 v[168:171], v26 offset:2048
    s_waitcnt lgkmcnt(10)
    v_mfma_f32_16x16x32_bf16 v[48:51], v[236:239], v[112:115], 0
    v_mfma_f32_16x16x32_bf16 v[48:51], v[68:71], v[112:115], v[48:51]
    ds_read2_b32 v[140:141], v22 offset0:16 offset1:17
    v_mfma_f32_16x16x32_bf16 v[48:51], v[72:75], v[108:111], v[48:51]
    ds_read2_b32 v[142:143], v22 offset0:18 offset1:19
    v_mfma_f32_16x16x32_bf16 v[48:51], v[76:79], v[104:107], v[48:51]
    v_mfma_f32_16x16x32_bf16 v[48:51], v[80:83], v[100:103], v[48:51]
    ds_read_b128 v[172:175], v26 offset:4096
    s_waitcnt lgkmcnt(12)
    v_mfma_f32_16x16x32_bf16 v[52:55], v[236:239], v[116:119], 0
    v_mfma_f32_16x16x32_bf16 v[52:55], v[68:71], v[116:119], v[52:55]
    ds_read2_b32 v[144:145], v22 offset0:144 offset1:145
    v_mfma_f32_16x16x32_bf16 v[52:55], v[72:75], v[112:115], v[52:55]
    ds_read2_b32 v[146:147], v22 offset0:146 offset1:147
    v_mfma_f32_16x16x32_bf16 v[52:55], v[76:79], v[108:111], v[52:55]
    v_mfma_f32_16x16x32_bf16 v[52:55], v[80:83], v[104:107], v[52:55]
    ds_read_b128 v[176:179], v26 offset:6144
    v_mfma_f32_16x16x32_bf16 v[52:55], v[84:87], v[100:103], v[52:55]
    s_waitcnt lgkmcnt(14)
    v_mfma_f32_16x16x32_bf16 v[56:59], v[236:239], v[120:123], 0
    ds_read2_b32 v[148:149], v23 offset0:16 offset1:17
    v_mfma_f32_16x16x32_bf16 v[56:59], v[68:71], v[120:123], v[56:59]
    ds_read2_b32 v[150:151], v23 offset0:18 offset1:19
    v_mfma_f32_16x16x32_bf16 v[56:59], v[72:75], v[116:119], v[56:59]
    v_mfma_f32_16x16x32_bf16 v[56:59], v[76:79], v[112:115], v[56:59]
    ds_read_b128 v[180:183], v26 offset:8192
    v_mfma_f32_16x16x32_bf16 v[56:59], v[80:83], v[108:111], v[56:59]
    v_mfma_f32_16x16x32_bf16 v[56:59], v[84:87], v[104:107], v[56:59]
    ds_read2_b32 v[152:153], v23 offset0:144 offset1:145
    v_mfma_f32_16x16x32_bf16 v[56:59], v[88:91], v[100:103], v[56:59]
    ds_read2_b32 v[154:155], v23 offset0:146 offset1:147
    s_waitcnt lgkmcnt(14)
    v_mfma_f32_16x16x32_bf16 v[60:63], v[236:239], v[124:127], 0
    v_mfma_f32_16x16x32_bf16 v[60:63], v[68:71], v[124:127], v[60:63]
    ds_read_b128 v[184:187], v26 offset:10240
    v_mfma_f32_16x16x32_bf16 v[60:63], v[72:75], v[120:123], v[60:63]
    v_mfma_f32_16x16x32_bf16 v[60:63], v[76:79], v[116:119], v[60:63]
    ds_read2_b32 v[156:157], v24 offset0:16 offset1:17
    v_mfma_f32_16x16x32_bf16 v[60:63], v[80:83], v[112:115], v[60:63]
    ds_read2_b32 v[158:159], v24 offset0:18 offset1:19
    v_mfma_f32_16x16x32_bf16 v[60:63], v[84:87], v[108:111], v[60:63]
    v_mfma_f32_16x16x32_bf16 v[60:63], v[88:91], v[104:107], v[60:63]
    ds_read_b128 v[188:191], v26 offset:12288
    v_mfma_f32_16x16x32_bf16 v[60:63], v[92:95], v[100:103], v[60:63]
    v_mfma_f32_16x16x32_bf16 v[64:67], v[236:239], v[128:131], 0
    ds_read2_b32 v[160:161], v24 offset0:144 offset1:145
    v_mfma_f32_16x16x32_bf16 v[64:67], v[68:71], v[128:131], v[64:67]
    ds_read2_b32 v[162:163], v24 offset0:146 offset1:147
    v_mfma_f32_16x16x32_bf16 v[64:67], v[72:75], v[124:127], v[64:67]
    v_mfma_f32_16x16x32_bf16 v[64:67], v[76:79], v[120:123], v[64:67]
    ds_read_b128 v[192:195], v26 offset:14336
    v_mfma_f32_16x16x32_bf16 v[64:67], v[80:83], v[116:119], v[64:67]
    v_mfma_f32_16x16x32_bf16 v[64:67], v[84:87], v[112:115], v[64:67]
    v_mfma_f32_16x16x32_bf16 v[64:67], v[88:91], v[108:111], v[64:67]
    v_mfma_f32_16x16x32_bf16 v[64:67], v[92:95], v[104:107], v[64:67]
    v_mfma_f32_16x16x32_bf16 v[64:67], v[96:99], v[100:103], v[64:67]
    v_mfma_f32_16x16x32_bf16 v[36:39], v[132:135], v[164:167], v[36:39]
    ds_read2_b32 v[68:69], v21 offset0:32 offset1:33
    s_waitcnt lgkmcnt(14)
    v_mfma_f32_16x16x32_bf16 v[40:43], v[136:139], v[164:167], v[40:43]
    ds_read2_b32 v[70:71], v21 offset0:34 offset1:35
    v_mfma_f32_16x16x32_bf16 v[40:43], v[132:135], v[168:171], v[40:43]
    ds_read_b128 v[100:103], v27 offset:0
    v_mfma_f32_16x16x32_bf16 v[44:47], v[132:135], v[172:175], v[44:47]
    v_mfma_f32_16x16x32_bf16 v[44:47], v[136:139], v[168:171], v[44:47]
    ds_read2_b32 v[72:73], v21 offset0:160 offset1:161
    v_mfma_f32_16x16x32_bf16 v[44:47], v[140:143], v[164:167], v[44:47]
    ds_read2_b32 v[74:75], v21 offset0:162 offset1:163
    v_mfma_f32_16x16x32_bf16 v[48:51], v[144:147], v[164:167], v[48:51]
    ds_read_b128 v[104:107], v27 offset:2048
    v_mfma_f32_16x16x32_bf16 v[48:51], v[140:143], v[168:171], v[48:51]
    v_mfma_f32_16x16x32_bf16 v[48:51], v[136:139], v[172:175], v[48:51]
    ds_read2_b32 v[76:77], v22 offset0:32 offset1:33
    s_waitcnt lgkmcnt(14)
    v_mfma_f32_16x16x32_bf16 v[48:51], v[132:135], v[176:179], v[48:51]
    ds_read2_b32 v[78:79], v22 offset0:34 offset1:35
    v_mfma_f32_16x16x32_bf16 v[52:55], v[132:135], v[180:183], v[52:55]
    ds_read_b128 v[108:111], v27 offset:4096
    v_mfma_f32_16x16x32_bf16 v[52:55], v[136:139], v[176:179], v[52:55]
    v_mfma_f32_16x16x32_bf16 v[52:55], v[140:143], v[172:175], v[52:55]
    ds_read2_b32 v[80:81], v22 offset0:160 offset1:161
    v_mfma_f32_16x16x32_bf16 v[52:55], v[144:147], v[168:171], v[52:55]
    ds_read2_b32 v[82:83], v22 offset0:162 offset1:163
    v_mfma_f32_16x16x32_bf16 v[52:55], v[148:151], v[164:167], v[52:55]
    ds_read_b128 v[112:115], v27 offset:6144
    v_mfma_f32_16x16x32_bf16 v[56:59], v[152:155], v[164:167], v[56:59]
    v_mfma_f32_16x16x32_bf16 v[56:59], v[148:151], v[168:171], v[56:59]
    ds_read2_b32 v[84:85], v23 offset0:32 offset1:33
    v_mfma_f32_16x16x32_bf16 v[56:59], v[144:147], v[172:175], v[56:59]
    ds_read2_b32 v[86:87], v23 offset0:34 offset1:35
    v_mfma_f32_16x16x32_bf16 v[56:59], v[140:143], v[176:179], v[56:59]
    ds_read_b128 v[116:119], v27 offset:8192
    v_mfma_f32_16x16x32_bf16 v[56:59], v[136:139], v[180:183], v[56:59]
    s_waitcnt lgkmcnt(14)
    v_mfma_f32_16x16x32_bf16 v[56:59], v[132:135], v[184:187], v[56:59]
    ds_read2_b32 v[88:89], v23 offset0:160 offset1:161
    v_mfma_f32_16x16x32_bf16 v[60:63], v[132:135], v[188:191], v[60:63]
    ds_read2_b32 v[90:91], v23 offset0:162 offset1:163
    v_mfma_f32_16x16x32_bf16 v[60:63], v[136:139], v[184:187], v[60:63]
    ds_read_b128 v[120:123], v27 offset:10240
    v_mfma_f32_16x16x32_bf16 v[60:63], v[140:143], v[180:183], v[60:63]
    v_mfma_f32_16x16x32_bf16 v[60:63], v[144:147], v[176:179], v[60:63]
    ds_read2_b32 v[92:93], v24 offset0:32 offset1:33
    v_mfma_f32_16x16x32_bf16 v[60:63], v[148:151], v[172:175], v[60:63]
    ds_read2_b32 v[94:95], v24 offset0:34 offset1:35
    v_mfma_f32_16x16x32_bf16 v[60:63], v[152:155], v[168:171], v[60:63]
    ds_read_b128 v[124:127], v27 offset:12288
    v_mfma_f32_16x16x32_bf16 v[60:63], v[156:159], v[164:167], v[60:63]
    v_mfma_f32_16x16x32_bf16 v[64:67], v[160:163], v[164:167], v[64:67]
    ds_read2_b32 v[96:97], v24 offset0:160 offset1:161
    v_mfma_f32_16x16x32_bf16 v[64:67], v[156:159], v[168:171], v[64:67]
    ds_read2_b32 v[98:99], v24 offset0:162 offset1:163
    v_mfma_f32_16x16x32_bf16 v[64:67], v[152:155], v[172:175], v[64:67]
    ds_read_b128 v[128:131], v27 offset:14336
    v_mfma_f32_16x16x32_bf16 v[64:67], v[148:151], v[176:179], v[64:67]
    v_mfma_f32_16x16x32_bf16 v[64:67], v[144:147], v[180:183], v[64:67]
    v_mfma_f32_16x16x32_bf16 v[64:67], v[140:143], v[184:187], v[64:67]
    v_mfma_f32_16x16x32_bf16 v[64:67], v[136:139], v[188:191], v[64:67]
    v_mfma_f32_16x16x32_bf16 v[64:67], v[132:135], v[192:195], v[64:67]
    s_waitcnt lgkmcnt(14)
    v_mfma_f32_16x16x32_bf16 v[36:39], v[68:71], v[100:103], v[36:39]
    ds_read2_b32 v[132:133], v21 offset0:48 offset1:49
    v_mfma_f32_16x16x32_bf16 v[40:43], v[72:75], v[100:103], v[40:43]
    ds_read2_b32 v[134:135], v21 offset0:50 offset1:51
    v_mfma_f32_16x16x32_bf16 v[40:43], v[68:71], v[104:107], v[40:43]
    ds_read_b128 v[164:167], v28 offset:0
    v_mfma_f32_16x16x32_bf16 v[44:47], v[68:71], v[108:111], v[44:47]
    v_mfma_f32_16x16x32_bf16 v[44:47], v[72:75], v[104:107], v[44:47]
    ds_read2_b32 v[136:137], v21 offset0:176 offset1:177
    v_mfma_f32_16x16x32_bf16 v[44:47], v[76:79], v[100:103], v[44:47]
    ds_read2_b32 v[138:139], v21 offset0:178 offset1:179
    s_waitcnt lgkmcnt(14)
    v_mfma_f32_16x16x32_bf16 v[48:51], v[80:83], v[100:103], v[48:51]
    ds_read_b128 v[168:171], v28 offset:2048
    v_mfma_f32_16x16x32_bf16 v[48:51], v[76:79], v[104:107], v[48:51]
    v_mfma_f32_16x16x32_bf16 v[48:51], v[72:75], v[108:111], v[48:51]
    ds_read2_b32 v[140:141], v22 offset0:48 offset1:49
    v_mfma_f32_16x16x32_bf16 v[48:51], v[68:71], v[112:115], v[48:51]
    ds_read2_b32 v[142:143], v22 offset0:50 offset1:51
    v_mfma_f32_16x16x32_bf16 v[52:55], v[68:71], v[116:119], v[52:55]
    ds_read_b128 v[172:175], v28 offset:4096
    v_mfma_f32_16x16x32_bf16 v[52:55], v[72:75], v[112:115], v[52:55]
    v_mfma_f32_16x16x32_bf16 v[52:55], v[76:79], v[108:111], v[52:55]
    ds_read2_b32 v[144:145], v22 offset0:176 offset1:177
    v_mfma_f32_16x16x32_bf16 v[52:55], v[80:83], v[104:107], v[52:55]
    ds_read2_b32 v[146:147], v22 offset0:178 offset1:179
    v_mfma_f32_16x16x32_bf16 v[52:55], v[84:87], v[100:103], v[52:55]
    ds_read_b128 v[176:179], v28 offset:6144
    s_waitcnt lgkmcnt(14)
    v_mfma_f32_16x16x32_bf16 v[56:59], v[88:91], v[100:103], v[56:59]
    v_mfma_f32_16x16x32_bf16 v[56:59], v[84:87], v[104:107], v[56:59]
    ds_read2_b32 v[148:149], v23 offset0:48 offset1:49
    v_mfma_f32_16x16x32_bf16 v[56:59], v[80:83], v[108:111], v[56:59]
    ds_read2_b32 v[150:151], v23 offset0:50 offset1:51
    v_mfma_f32_16x16x32_bf16 v[56:59], v[76:79], v[112:115], v[56:59]
    ds_read_b128 v[180:183], v28 offset:8192
    v_mfma_f32_16x16x32_bf16 v[56:59], v[72:75], v[116:119], v[56:59]
    v_mfma_f32_16x16x32_bf16 v[56:59], v[68:71], v[120:123], v[56:59]
    ds_read2_b32 v[152:153], v23 offset0:176 offset1:177
    v_mfma_f32_16x16x32_bf16 v[60:63], v[68:71], v[124:127], v[60:63]
    ds_read2_b32 v[154:155], v23 offset0:178 offset1:179
    v_mfma_f32_16x16x32_bf16 v[60:63], v[72:75], v[120:123], v[60:63]
    ds_read_b128 v[184:187], v28 offset:10240
    v_mfma_f32_16x16x32_bf16 v[60:63], v[76:79], v[116:119], v[60:63]
    v_mfma_f32_16x16x32_bf16 v[60:63], v[80:83], v[112:115], v[60:63]
    ds_read2_b32 v[156:157], v24 offset0:48 offset1:49
    v_mfma_f32_16x16x32_bf16 v[60:63], v[84:87], v[108:111], v[60:63]
    ds_read2_b32 v[158:159], v24 offset0:50 offset1:51
    v_mfma_f32_16x16x32_bf16 v[60:63], v[88:91], v[104:107], v[60:63]
    ds_read_b128 v[188:191], v28 offset:12288
    v_mfma_f32_16x16x32_bf16 v[60:63], v[92:95], v[100:103], v[60:63]
    s_waitcnt lgkmcnt(14)
    v_mfma_f32_16x16x32_bf16 v[64:67], v[96:99], v[100:103], v[64:67]
    ds_read2_b32 v[160:161], v24 offset0:176 offset1:177
    v_mfma_f32_16x16x32_bf16 v[64:67], v[92:95], v[104:107], v[64:67]
    ds_read2_b32 v[162:163], v24 offset0:178 offset1:179
    v_mfma_f32_16x16x32_bf16 v[64:67], v[88:91], v[108:111], v[64:67]
    ds_read_b128 v[192:195], v28 offset:14336
    v_mfma_f32_16x16x32_bf16 v[64:67], v[84:87], v[112:115], v[64:67]
    v_mfma_f32_16x16x32_bf16 v[64:67], v[80:83], v[116:119], v[64:67]
    v_mfma_f32_16x16x32_bf16 v[64:67], v[76:79], v[120:123], v[64:67]
    v_mfma_f32_16x16x32_bf16 v[64:67], v[72:75], v[124:127], v[64:67]
    v_mfma_f32_16x16x32_bf16 v[64:67], v[68:71], v[128:131], v[64:67]
    v_mfma_f32_16x16x32_bf16 v[36:39], v[132:135], v[164:167], v[36:39]
    ds_read2_b32 v[68:69], v21 offset0:64 offset1:65
    v_mfma_f32_16x16x32_bf16 v[40:43], v[136:139], v[164:167], v[40:43]
    ds_read2_b32 v[70:71], v21 offset0:66 offset1:67
    v_mfma_f32_16x16x32_bf16 v[40:43], v[132:135], v[168:171], v[40:43]
    ds_read_b128 v[100:103], v29 offset:0
    s_waitcnt lgkmcnt(14)
    v_mfma_f32_16x16x32_bf16 v[44:47], v[132:135], v[172:175], v[44:47]
    v_mfma_f32_16x16x32_bf16 v[44:47], v[136:139], v[168:171], v[44:47]
    ds_read2_b32 v[72:73], v21 offset0:192 offset1:193
    v_mfma_f32_16x16x32_bf16 v[44:47], v[140:143], v[164:167], v[44:47]
    ds_read2_b32 v[74:75], v21 offset0:194 offset1:195
    v_mfma_f32_16x16x32_bf16 v[48:51], v[144:147], v[164:167], v[48:51]
    ds_read_b128 v[104:107], v29 offset:2048
    v_mfma_f32_16x16x32_bf16 v[48:51], v[140:143], v[168:171], v[48:51]
    v_mfma_f32_16x16x32_bf16 v[48:51], v[136:139], v[172:175], v[48:51]
    ds_read2_b32 v[76:77], v22 offset0:64 offset1:65
    v_mfma_f32_16x16x32_bf16 v[48:51], v[132:135], v[176:179], v[48:51]
    ds_read2_b32 v[78:79], v22 offset0:66 offset1:67
    s_waitcnt lgkmcnt(14)
    v_mfma_f32_16x16x32_bf16 v[52:55], v[132:135], v[180:183], v[52:55]
    ds_read_b128 v[108:111], v29 offset:4096
    v_mfma_f32_16x16x32_bf16 v[52:55], v[136:139], v[176:179], v[52:55]
    v_mfma_f32_16x16x32_bf16 v[52:55], v[140:143], v[172:175], v[52:55]
    ds_read2_b32 v[80:81], v22 offset0:192 offset1:193
    v_mfma_f32_16x16x32_bf16 v[52:55], v[144:147], v[168:171], v[52:55]
    ds_read2_b32 v[82:83], v22 offset0:194 offset1:195
    v_mfma_f32_16x16x32_bf16 v[52:55], v[148:151], v[164:167], v[52:55]
    ds_read_b128 v[112:115], v29 offset:6144
    v_mfma_f32_16x16x32_bf16 v[56:59], v[152:155], v[164:167], v[56:59]
    v_mfma_f32_16x16x32_bf16 v[56:59], v[148:151], v[168:171], v[56:59]
    ds_read2_b32 v[84:85], v23 offset0:64 offset1:65
    v_mfma_f32_16x16x32_bf16 v[56:59], v[144:147], v[172:175], v[56:59]
    ds_read2_b32 v[86:87], v23 offset0:66 offset1:67
    v_mfma_f32_16x16x32_bf16 v[56:59], v[140:143], v[176:179], v[56:59]
    ds_read_b128 v[116:119], v29 offset:8192
    v_mfma_f32_16x16x32_bf16 v[56:59], v[136:139], v[180:183], v[56:59]
    v_mfma_f32_16x16x32_bf16 v[56:59], v[132:135], v[184:187], v[56:59]
    ds_read2_b32 v[88:89], v23 offset0:192 offset1:193
    s_waitcnt lgkmcnt(14)
    v_mfma_f32_16x16x32_bf16 v[60:63], v[132:135], v[188:191], v[60:63]
    ds_read2_b32 v[90:91], v23 offset0:194 offset1:195
    v_mfma_f32_16x16x32_bf16 v[60:63], v[136:139], v[184:187], v[60:63]
    ds_read_b128 v[120:123], v29 offset:10240
    v_mfma_f32_16x16x32_bf16 v[60:63], v[140:143], v[180:183], v[60:63]
    v_mfma_f32_16x16x32_bf16 v[60:63], v[144:147], v[176:179], v[60:63]
    ds_read2_b32 v[92:93], v24 offset0:64 offset1:65
    v_mfma_f32_16x16x32_bf16 v[60:63], v[148:151], v[172:175], v[60:63]
    ds_read2_b32 v[94:95], v24 offset0:66 offset1:67
    v_mfma_f32_16x16x32_bf16 v[60:63], v[152:155], v[168:171], v[60:63]
    ds_read_b128 v[124:127], v29 offset:12288
    v_mfma_f32_16x16x32_bf16 v[60:63], v[156:159], v[164:167], v[60:63]
    v_mfma_f32_16x16x32_bf16 v[64:67], v[160:163], v[164:167], v[64:67]
    ds_read2_b32 v[96:97], v24 offset0:192 offset1:193
    v_mfma_f32_16x16x32_bf16 v[64:67], v[156:159], v[168:171], v[64:67]
    ds_read2_b32 v[98:99], v24 offset0:194 offset1:195
    v_mfma_f32_16x16x32_bf16 v[64:67], v[152:155], v[172:175], v[64:67]
    ds_read_b128 v[128:131], v29 offset:14336
    v_mfma_f32_16x16x32_bf16 v[64:67], v[148:151], v[176:179], v[64:67]
    v_mfma_f32_16x16x32_bf16 v[64:67], v[144:147], v[180:183], v[64:67]
    v_mfma_f32_16x16x32_bf16 v[64:67], v[140:143], v[184:187], v[64:67]
    v_mfma_f32_16x16x32_bf16 v[64:67], v[136:139], v[188:191], v[64:67]
    v_mfma_f32_16x16x32_bf16 v[64:67], v[132:135], v[192:195], v[64:67]
    s_waitcnt lgkmcnt(14)
    v_mfma_f32_16x16x32_bf16 v[36:39], v[68:71], v[100:103], v[36:39]
    ds_read2_b32 v[132:133], v21 offset0:80 offset1:81
    v_mfma_f32_16x16x32_bf16 v[40:43], v[72:75], v[100:103], v[40:43]
    ds_read2_b32 v[134:135], v21 offset0:82 offset1:83
    v_mfma_f32_16x16x32_bf16 v[40:43], v[68:71], v[104:107], v[40:43]
    ds_read_b128 v[164:167], v30 offset:0
    v_mfma_f32_16x16x32_bf16 v[44:47], v[68:71], v[108:111], v[44:47]
    v_mfma_f32_16x16x32_bf16 v[44:47], v[72:75], v[104:107], v[44:47]
    ds_read2_b32 v[136:137], v21 offset0:208 offset1:209
    v_mfma_f32_16x16x32_bf16 v[44:47], v[76:79], v[100:103], v[44:47]
    ds_read2_b32 v[138:139], v21 offset0:210 offset1:211
    s_waitcnt lgkmcnt(14)
    v_mfma_f32_16x16x32_bf16 v[48:51], v[80:83], v[100:103], v[48:51]
    ds_read_b128 v[168:171], v30 offset:2048
    v_mfma_f32_16x16x32_bf16 v[48:51], v[76:79], v[104:107], v[48:51]
    v_mfma_f32_16x16x32_bf16 v[48:51], v[72:75], v[108:111], v[48:51]
    ds_read2_b32 v[140:141], v22 offset0:80 offset1:81
    v_mfma_f32_16x16x32_bf16 v[48:51], v[68:71], v[112:115], v[48:51]
    ds_read2_b32 v[142:143], v22 offset0:82 offset1:83
    v_mfma_f32_16x16x32_bf16 v[52:55], v[68:71], v[116:119], v[52:55]
    ds_read_b128 v[172:175], v30 offset:4096
    v_mfma_f32_16x16x32_bf16 v[52:55], v[72:75], v[112:115], v[52:55]
    v_mfma_f32_16x16x32_bf16 v[52:55], v[76:79], v[108:111], v[52:55]
    ds_read2_b32 v[144:145], v22 offset0:208 offset1:209
    v_mfma_f32_16x16x32_bf16 v[52:55], v[80:83], v[104:107], v[52:55]
    ds_read2_b32 v[146:147], v22 offset0:210 offset1:211
    v_mfma_f32_16x16x32_bf16 v[52:55], v[84:87], v[100:103], v[52:55]
    ds_read_b128 v[176:179], v30 offset:6144
    s_waitcnt lgkmcnt(14)
    v_mfma_f32_16x16x32_bf16 v[56:59], v[88:91], v[100:103], v[56:59]
    v_mfma_f32_16x16x32_bf16 v[56:59], v[84:87], v[104:107], v[56:59]
    ds_read2_b32 v[148:149], v23 offset0:80 offset1:81
    v_mfma_f32_16x16x32_bf16 v[56:59], v[80:83], v[108:111], v[56:59]
    ds_read2_b32 v[150:151], v23 offset0:82 offset1:83
    v_mfma_f32_16x16x32_bf16 v[56:59], v[76:79], v[112:115], v[56:59]
    ds_read_b128 v[180:183], v30 offset:8192
    v_mfma_f32_16x16x32_bf16 v[56:59], v[72:75], v[116:119], v[56:59]
    v_mfma_f32_16x16x32_bf16 v[56:59], v[68:71], v[120:123], v[56:59]
    ds_read2_b32 v[152:153], v23 offset0:208 offset1:209
    v_mfma_f32_16x16x32_bf16 v[60:63], v[68:71], v[124:127], v[60:63]
    ds_read2_b32 v[154:155], v23 offset0:210 offset1:211
    v_mfma_f32_16x16x32_bf16 v[60:63], v[72:75], v[120:123], v[60:63]
    ds_read_b128 v[184:187], v30 offset:10240
    v_mfma_f32_16x16x32_bf16 v[60:63], v[76:79], v[116:119], v[60:63]
    v_mfma_f32_16x16x32_bf16 v[60:63], v[80:83], v[112:115], v[60:63]
    ds_read2_b32 v[156:157], v24 offset0:80 offset1:81
    v_mfma_f32_16x16x32_bf16 v[60:63], v[84:87], v[108:111], v[60:63]
    ds_read2_b32 v[158:159], v24 offset0:82 offset1:83
    v_mfma_f32_16x16x32_bf16 v[60:63], v[88:91], v[104:107], v[60:63]
    ds_read_b128 v[188:191], v30 offset:12288
    v_mfma_f32_16x16x32_bf16 v[60:63], v[92:95], v[100:103], v[60:63]
    s_waitcnt lgkmcnt(14)
    v_mfma_f32_16x16x32_bf16 v[64:67], v[96:99], v[100:103], v[64:67]
    ds_read2_b32 v[160:161], v24 offset0:208 offset1:209
    v_mfma_f32_16x16x32_bf16 v[64:67], v[92:95], v[104:107], v[64:67]
    ds_read2_b32 v[162:163], v24 offset0:210 offset1:211
    v_mfma_f32_16x16x32_bf16 v[64:67], v[88:91], v[108:111], v[64:67]
    ds_read_b128 v[192:195], v30 offset:14336
    v_mfma_f32_16x16x32_bf16 v[64:67], v[84:87], v[112:115], v[64:67]
    v_mfma_f32_16x16x32_bf16 v[64:67], v[80:83], v[116:119], v[64:67]
    v_mfma_f32_16x16x32_bf16 v[64:67], v[76:79], v[120:123], v[64:67]
    v_mfma_f32_16x16x32_bf16 v[64:67], v[72:75], v[124:127], v[64:67]
    v_mfma_f32_16x16x32_bf16 v[64:67], v[68:71], v[128:131], v[64:67]
    v_mfma_f32_16x16x32_bf16 v[36:39], v[132:135], v[164:167], v[36:39]
    ds_read2_b32 v[68:69], v21 offset0:96 offset1:97
    v_mfma_f32_16x16x32_bf16 v[40:43], v[136:139], v[164:167], v[40:43]
    ds_read2_b32 v[70:71], v21 offset0:98 offset1:99
    v_mfma_f32_16x16x32_bf16 v[40:43], v[132:135], v[168:171], v[40:43]
    ds_read_b128 v[100:103], v31 offset:0
    s_waitcnt lgkmcnt(14)
    v_mfma_f32_16x16x32_bf16 v[44:47], v[132:135], v[172:175], v[44:47]
    v_mfma_f32_16x16x32_bf16 v[44:47], v[136:139], v[168:171], v[44:47]
    ds_read2_b32 v[72:73], v21 offset0:224 offset1:225
    v_mfma_f32_16x16x32_bf16 v[44:47], v[140:143], v[164:167], v[44:47]
    ds_read2_b32 v[74:75], v21 offset0:226 offset1:227
    v_mfma_f32_16x16x32_bf16 v[48:51], v[144:147], v[164:167], v[48:51]
    ds_read_b128 v[104:107], v31 offset:2048
    v_mfma_f32_16x16x32_bf16 v[48:51], v[140:143], v[168:171], v[48:51]
    v_mfma_f32_16x16x32_bf16 v[48:51], v[136:139], v[172:175], v[48:51]
    ds_read2_b32 v[76:77], v22 offset0:96 offset1:97
    v_mfma_f32_16x16x32_bf16 v[48:51], v[132:135], v[176:179], v[48:51]
    ds_read2_b32 v[78:79], v22 offset0:98 offset1:99
    s_waitcnt lgkmcnt(14)
    v_mfma_f32_16x16x32_bf16 v[52:55], v[132:135], v[180:183], v[52:55]
    ds_read_b128 v[108:111], v31 offset:4096
    v_mfma_f32_16x16x32_bf16 v[52:55], v[136:139], v[176:179], v[52:55]
    v_mfma_f32_16x16x32_bf16 v[52:55], v[140:143], v[172:175], v[52:55]
    ds_read2_b32 v[80:81], v22 offset0:224 offset1:225
    v_mfma_f32_16x16x32_bf16 v[52:55], v[144:147], v[168:171], v[52:55]
    ds_read2_b32 v[82:83], v22 offset0:226 offset1:227
    v_mfma_f32_16x16x32_bf16 v[52:55], v[148:151], v[164:167], v[52:55]
    ds_read_b128 v[112:115], v31 offset:6144
    v_mfma_f32_16x16x32_bf16 v[56:59], v[152:155], v[164:167], v[56:59]
    v_mfma_f32_16x16x32_bf16 v[56:59], v[148:151], v[168:171], v[56:59]
    ds_read2_b32 v[84:85], v23 offset0:96 offset1:97
    v_mfma_f32_16x16x32_bf16 v[56:59], v[144:147], v[172:175], v[56:59]
    ds_read2_b32 v[86:87], v23 offset0:98 offset1:99
    v_mfma_f32_16x16x32_bf16 v[56:59], v[140:143], v[176:179], v[56:59]
    ds_read_b128 v[116:119], v31 offset:8192
    v_mfma_f32_16x16x32_bf16 v[56:59], v[136:139], v[180:183], v[56:59]
    v_mfma_f32_16x16x32_bf16 v[56:59], v[132:135], v[184:187], v[56:59]
    ds_read2_b32 v[88:89], v23 offset0:224 offset1:225
    s_waitcnt lgkmcnt(14)
    v_mfma_f32_16x16x32_bf16 v[60:63], v[132:135], v[188:191], v[60:63]
    ds_read2_b32 v[90:91], v23 offset0:226 offset1:227
    v_mfma_f32_16x16x32_bf16 v[60:63], v[136:139], v[184:187], v[60:63]
    ds_read_b128 v[120:123], v31 offset:10240
    v_mfma_f32_16x16x32_bf16 v[60:63], v[140:143], v[180:183], v[60:63]
    v_mfma_f32_16x16x32_bf16 v[60:63], v[144:147], v[176:179], v[60:63]
    ds_read2_b32 v[92:93], v24 offset0:96 offset1:97
    v_mfma_f32_16x16x32_bf16 v[60:63], v[148:151], v[172:175], v[60:63]
    ds_read2_b32 v[94:95], v24 offset0:98 offset1:99
    v_mfma_f32_16x16x32_bf16 v[60:63], v[152:155], v[168:171], v[60:63]
    ds_read_b128 v[124:127], v31 offset:12288
    v_mfma_f32_16x16x32_bf16 v[60:63], v[156:159], v[164:167], v[60:63]
    v_mfma_f32_16x16x32_bf16 v[64:67], v[160:163], v[164:167], v[64:67]
    ds_read2_b32 v[96:97], v24 offset0:224 offset1:225
    v_mfma_f32_16x16x32_bf16 v[64:67], v[156:159], v[168:171], v[64:67]
    ds_read2_b32 v[98:99], v24 offset0:226 offset1:227
    v_mfma_f32_16x16x32_bf16 v[64:67], v[152:155], v[172:175], v[64:67]
    ds_read_b128 v[128:131], v31 offset:14336
    v_mfma_f32_16x16x32_bf16 v[64:67], v[148:151], v[176:179], v[64:67]
    v_mfma_f32_16x16x32_bf16 v[64:67], v[144:147], v[180:183], v[64:67]
    v_mfma_f32_16x16x32_bf16 v[64:67], v[140:143], v[184:187], v[64:67]
    v_mfma_f32_16x16x32_bf16 v[64:67], v[136:139], v[188:191], v[64:67]
    v_mfma_f32_16x16x32_bf16 v[64:67], v[132:135], v[192:195], v[64:67]
    s_waitcnt lgkmcnt(14)
    v_mfma_f32_16x16x32_bf16 v[36:39], v[68:71], v[100:103], v[36:39]
    ds_read2_b32 v[132:133], v21 offset0:112 offset1:113
    v_mfma_f32_16x16x32_bf16 v[40:43], v[72:75], v[100:103], v[40:43]
    ds_read2_b32 v[134:135], v21 offset0:114 offset1:115
    v_mfma_f32_16x16x32_bf16 v[40:43], v[68:71], v[104:107], v[40:43]
    ds_read_b128 v[164:167], v32 offset:0
    v_mfma_f32_16x16x32_bf16 v[44:47], v[68:71], v[108:111], v[44:47]
    v_mfma_f32_16x16x32_bf16 v[44:47], v[72:75], v[104:107], v[44:47]
    ds_read2_b32 v[136:137], v21 offset0:240 offset1:241
    v_mfma_f32_16x16x32_bf16 v[44:47], v[76:79], v[100:103], v[44:47]
    ds_read2_b32 v[138:139], v21 offset0:242 offset1:243
    s_waitcnt lgkmcnt(14)
    v_mfma_f32_16x16x32_bf16 v[48:51], v[80:83], v[100:103], v[48:51]
    ds_read_b128 v[168:171], v32 offset:2048
    v_mfma_f32_16x16x32_bf16 v[48:51], v[76:79], v[104:107], v[48:51]
    v_mfma_f32_16x16x32_bf16 v[48:51], v[72:75], v[108:111], v[48:51]
    ds_read2_b32 v[140:141], v22 offset0:112 offset1:113
    v_mfma_f32_16x16x32_bf16 v[48:51], v[68:71], v[112:115], v[48:51]
    ds_read2_b32 v[142:143], v22 offset0:114 offset1:115
    v_mfma_f32_16x16x32_bf16 v[52:55], v[68:71], v[116:119], v[52:55]
    ds_read_b128 v[172:175], v32 offset:4096
    v_mfma_f32_16x16x32_bf16 v[52:55], v[72:75], v[112:115], v[52:55]
    v_mfma_f32_16x16x32_bf16 v[52:55], v[76:79], v[108:111], v[52:55]
    ds_read2_b32 v[144:145], v22 offset0:240 offset1:241
    v_mfma_f32_16x16x32_bf16 v[52:55], v[80:83], v[104:107], v[52:55]
    ds_read2_b32 v[146:147], v22 offset0:242 offset1:243
    v_mfma_f32_16x16x32_bf16 v[52:55], v[84:87], v[100:103], v[52:55]
    ds_read_b128 v[176:179], v32 offset:6144
    s_waitcnt lgkmcnt(14)
    v_mfma_f32_16x16x32_bf16 v[56:59], v[88:91], v[100:103], v[56:59]
    v_mfma_f32_16x16x32_bf16 v[56:59], v[84:87], v[104:107], v[56:59]
    ds_read2_b32 v[148:149], v23 offset0:112 offset1:113
    v_mfma_f32_16x16x32_bf16 v[56:59], v[80:83], v[108:111], v[56:59]
    ds_read2_b32 v[150:151], v23 offset0:114 offset1:115
    v_mfma_f32_16x16x32_bf16 v[56:59], v[76:79], v[112:115], v[56:59]
    ds_read_b128 v[180:183], v32 offset:8192
    v_mfma_f32_16x16x32_bf16 v[56:59], v[72:75], v[116:119], v[56:59]
    v_mfma_f32_16x16x32_bf16 v[56:59], v[68:71], v[120:123], v[56:59]
    ds_read2_b32 v[152:153], v23 offset0:240 offset1:241
    v_mfma_f32_16x16x32_bf16 v[60:63], v[68:71], v[124:127], v[60:63]
    ds_read2_b32 v[154:155], v23 offset0:242 offset1:243
    v_mfma_f32_16x16x32_bf16 v[60:63], v[72:75], v[120:123], v[60:63]
    ds_read_b128 v[184:187], v32 offset:10240
    v_mfma_f32_16x16x32_bf16 v[60:63], v[76:79], v[116:119], v[60:63]
    v_mfma_f32_16x16x32_bf16 v[60:63], v[80:83], v[112:115], v[60:63]
    ds_read2_b32 v[156:157], v24 offset0:112 offset1:113
    v_mfma_f32_16x16x32_bf16 v[60:63], v[84:87], v[108:111], v[60:63]
    ds_read2_b32 v[158:159], v24 offset0:114 offset1:115
    v_mfma_f32_16x16x32_bf16 v[60:63], v[88:91], v[104:107], v[60:63]
    ds_read_b128 v[188:191], v32 offset:12288
    v_mfma_f32_16x16x32_bf16 v[60:63], v[92:95], v[100:103], v[60:63]
    s_waitcnt lgkmcnt(14)
    v_mfma_f32_16x16x32_bf16 v[64:67], v[96:99], v[100:103], v[64:67]
    ds_read2_b32 v[160:161], v24 offset0:240 offset1:241
    v_mfma_f32_16x16x32_bf16 v[64:67], v[92:95], v[104:107], v[64:67]
    ds_read2_b32 v[162:163], v24 offset0:242 offset1:243
    v_mfma_f32_16x16x32_bf16 v[64:67], v[88:91], v[108:111], v[64:67]
    ds_read_b128 v[192:195], v32 offset:14336
    v_mfma_f32_16x16x32_bf16 v[64:67], v[84:87], v[112:115], v[64:67]
    v_mfma_f32_16x16x32_bf16 v[64:67], v[80:83], v[116:119], v[64:67]
    v_mfma_f32_16x16x32_bf16 v[64:67], v[76:79], v[120:123], v[64:67]
    v_mfma_f32_16x16x32_bf16 v[64:67], v[72:75], v[124:127], v[64:67]
    v_mfma_f32_16x16x32_bf16 v[64:67], v[68:71], v[128:131], v[64:67]
    v_mfma_f32_16x16x32_bf16 v[36:39], v[132:135], v[164:167], v[36:39]
    v_mfma_f32_16x16x32_bf16 v[40:43], v[136:139], v[164:167], v[40:43]
    v_mfma_f32_16x16x32_bf16 v[40:43], v[132:135], v[168:171], v[40:43]
    s_waitcnt lgkmcnt(14)
    v_mfma_f32_16x16x32_bf16 v[44:47], v[132:135], v[172:175], v[44:47]
    v_mfma_f32_16x16x32_bf16 v[44:47], v[136:139], v[168:171], v[44:47]
    v_mfma_f32_16x16x32_bf16 v[44:47], v[140:143], v[164:167], v[44:47]
    s_waitcnt lgkmcnt(13)
    v_mfma_f32_16x16x32_bf16 v[48:51], v[144:147], v[164:167], v[48:51]
    v_mfma_f32_16x16x32_bf16 v[48:51], v[140:143], v[168:171], v[48:51]
    s_waitcnt lgkmcnt(0)
    v_cvt_pk_bf16_f32 v68, v39, v38
    v_cvt_pk_bf16_f32 v69, v37, v36
    v_mfma_f32_16x16x32_bf16 v[48:51], v[136:139], v[172:175], v[48:51]
    ds_write_b64 v20, v[68:69] offset:0
    v_cvt_pk_bf16_f32 v70, v43, v42
    v_mfma_f32_16x16x32_bf16 v[48:51], v[132:135], v[176:179], v[48:51]
    v_cvt_pk_bf16_f32 v71, v41, v40
    ds_write_b64 v20, v[70:71] offset:2048
    v_mfma_f32_16x16x32_bf16 v[52:55], v[132:135], v[180:183], v[52:55]
    v_mfma_f32_16x16x32_bf16 v[52:55], v[136:139], v[176:179], v[52:55]
    v_cvt_pk_bf16_f32 v72, v47, v46
    v_cvt_pk_bf16_f32 v73, v45, v44
    v_mfma_f32_16x16x32_bf16 v[52:55], v[140:143], v[172:175], v[52:55]
    ds_write_b64 v20, v[72:73] offset:4096
    v_mfma_f32_16x16x32_bf16 v[52:55], v[144:147], v[168:171], v[52:55]
    v_mfma_f32_16x16x32_bf16 v[52:55], v[148:151], v[164:167], v[52:55]
    v_mfma_f32_16x16x32_bf16 v[56:59], v[152:155], v[164:167], v[56:59]
    v_cvt_pk_bf16_f32 v74, v51, v50
    v_cvt_pk_bf16_f32 v75, v49, v48
    v_mfma_f32_16x16x32_bf16 v[56:59], v[148:151], v[168:171], v[56:59]
    ds_write_b64 v20, v[74:75] offset:6144
    v_mfma_f32_16x16x32_bf16 v[56:59], v[144:147], v[172:175], v[56:59]
    v_mfma_f32_16x16x32_bf16 v[56:59], v[140:143], v[176:179], v[56:59]
    v_mfma_f32_16x16x32_bf16 v[56:59], v[136:139], v[180:183], v[56:59]
    v_mfma_f32_16x16x32_bf16 v[56:59], v[132:135], v[184:187], v[56:59]
    v_cvt_pk_bf16_f32 v76, v55, v54
    v_cvt_pk_bf16_f32 v77, v53, v52
    v_mfma_f32_16x16x32_bf16 v[60:63], v[132:135], v[188:191], v[60:63]
    ds_write_b64 v20, v[76:77] offset:8192
    v_mfma_f32_16x16x32_bf16 v[60:63], v[136:139], v[184:187], v[60:63]
    v_mfma_f32_16x16x32_bf16 v[60:63], v[140:143], v[180:183], v[60:63]
    v_mfma_f32_16x16x32_bf16 v[60:63], v[144:147], v[176:179], v[60:63]
    v_mfma_f32_16x16x32_bf16 v[60:63], v[148:151], v[172:175], v[60:63]
    v_mfma_f32_16x16x32_bf16 v[60:63], v[152:155], v[168:171], v[60:63]
    v_cvt_pk_bf16_f32 v78, v59, v58
    v_cvt_pk_bf16_f32 v79, v57, v56
    v_mfma_f32_16x16x32_bf16 v[60:63], v[156:159], v[164:167], v[60:63]
    ds_write_b64 v20, v[78:79] offset:10240
    v_mfma_f32_16x16x32_bf16 v[64:67], v[160:163], v[164:167], v[64:67]
    v_mfma_f32_16x16x32_bf16 v[64:67], v[156:159], v[168:171], v[64:67]
    v_mfma_f32_16x16x32_bf16 v[64:67], v[152:155], v[172:175], v[64:67]
    v_mfma_f32_16x16x32_bf16 v[64:67], v[148:151], v[176:179], v[64:67]
    v_mfma_f32_16x16x32_bf16 v[64:67], v[144:147], v[180:183], v[64:67]
    v_mfma_f32_16x16x32_bf16 v[64:67], v[140:143], v[184:187], v[64:67]
    s_nop 0
    v_cvt_pk_bf16_f32 v80, v63, v62
    v_cvt_pk_bf16_f32 v81, v61, v60
    v_mfma_f32_16x16x32_bf16 v[64:67], v[136:139], v[188:191], v[64:67]
    ds_write_b64 v20, v[80:81] offset:12288
    v_mfma_f32_16x16x32_bf16 v[64:67], v[132:135], v[192:195], v[64:67]
    s_nop 7
    v_cvt_pk_bf16_f32 v82, v67, v66
    v_cvt_pk_bf16_f32 v83, v65, v64
    ds_write_b64 v20, v[82:83] offset:14336
    s_mov_b64 exec, 1
    ds_add_u32 v18, v19 offset:12
    s_mov_b64 exec, -1
    s_add_u32 s80, s86, 94208
    v_add_u32 v5, s80, v15
    s_branch LA_s3_in
LA_s3:
    s_sleep 1
LA_s3_in:
    ds_read_b32 v6, v18 offset:12
    ds_read_b128 v[84:87], v5 offset:0
    ds_read_b128 v[88:91], v5 offset:4096
    ds_read_b128 v[92:95], v5 offset:8192
    ds_read_b128 v[96:99], v5 offset:12288
    s_waitcnt lgkmcnt(0)
    v_readfirstlane_b32 s78, v6
    s_nop 0
    s_cmp_ge_u32 s78, 4
    s_cbranch_scc0 LA_s3
    s_add_u32 s89, s91, 4194304
    buffer_store_dwordx4 v[84:87], v14, s[52:55], s89 offen sc1
    s_add_u32 s89, s91, 4198400
    buffer_store_dwordx4 v[88:91], v14, s[52:55], s89 offen sc1
    s_add_u32 s89, s91, 4202496
    buffer_store_dwordx4 v[92:95], v14, s[52:55], s89 offen sc1
    s_add_u32 s89, s91, 4206592
    buffer_store_dwordx4 v[96:99], v14, s[52:55], s89 offen sc1
    s_add_u32 s80, s86, 129024
    v_add_u32 v5, s80, v15
    s_waitcnt vmcnt(9)
    ds_write_b128 v5, v[228:231] offset:0
    s_waitcnt vmcnt(8)
    ds_write_b128 v5, v[232:235] offset:4096
    s_waitcnt vmcnt(7)
    ds_write_b128 v5, v[240:243] offset:8192
    s_waitcnt vmcnt(6)
    ds_write_b128 v5, v[244:247] offset:12288
    s_waitcnt vmcnt(5)
    ds_write_b128 v5, v[248:251] offset:16384
    s_waitcnt vmcnt(4)
    ds_write_b128 v5, v[196:199] offset:20480
    s_mov_b64 exec, 1
    ds_add_u32 v18, v19 offset:32
    s_mov_b64 exec, -1
    s_setprio 0
    s_mov_b32 s60, s22
    s_mov_b32 s61, s23
    s_mov_b32 s62, 0x800000
    s_mov_b32 s63, 0x20000
    s_lshr_b32 s81, s91, 4
    s_lshl_b32 s82, s3, 8
    s_add_u32 s81, s81, s82
    s_add_u32 s81, s81, 12648448
    s_lshl_b32 s80, s74, 14
    s_and_b32 s82, s75, 3
    s_lshl_b32 s82, s82, 8
    s_add_u32 s80, s80, s82
    s_add_u32 s80, s80, 12648448
    v_mov_b32 v5, 0
    v_lshlrev_b32 v7, 10, v0
    v_lshlrev_b32 v132, 16, v212
    v_and_b32 v133, 0xffff0000, v212
    v_lshlrev_b32 v134, 16, v213
    v_and_b32 v135, 0xffff0000, v213
    v_lshlrev_b32 v136, 16, v214
    v_and_b32 v137, 0xffff0000, v214
    v_lshlrev_b32 v138, 16, v215
    v_and_b32 v139, 0xffff0000, v215
    v_lshlrev_b32 v140, 16, v216
    v_and_b32 v141, 0xffff0000, v216
    v_lshlrev_b32 v142, 16, v217
    v_and_b32 v143, 0xffff0000, v217
    v_lshlrev_b32 v144, 16, v218
    v_and_b32 v145, 0xffff0000, v218
    v_lshlrev_b32 v146, 16, v219
    v_and_b32 v147, 0xffff0000, v219
    v_lshlrev_b32 v148, 16, v220
    v_and_b32 v149, 0xffff0000, v220
    v_lshlrev_b32 v150, 16, v221
    v_and_b32 v151, 0xffff0000, v221
    v_lshlrev_b32 v152, 16, v222
    v_and_b32 v153, 0xffff0000, v222
    v_lshlrev_b32 v154, 16, v223
    v_and_b32 v155, 0xffff0000, v223
    v_lshlrev_b32 v156, 16, v224
    v_and_b32 v157, 0xffff0000, v224
    v_lshlrev_b32 v158, 16, v225
    v_and_b32 v159, 0xffff0000, v225
    v_lshlrev_b32 v160, 16, v226
    v_and_b32 v161, 0xffff0000, v226
    v_lshlrev_b32 v162, 16, v227
    v_and_b32 v163, 0xffff0000, v227
    s_waitcnt vmcnt(0)
    s_mov_b64 exec, 1
    buffer_store_dword v19, v5, s[52:55], s81 offen sc1
    s_mov_b64 exec, 0xffff
    s_waitcnt vmcnt(0)
    s_branch LA_s7a_in
LA_s7a:
    s_sleep 1
LA_s7a_in:
    ds_read_b32 v6, v18 offset:28
    s_waitcnt lgkmcnt(0)
    v_readfirstlane_b32 s78, v6
    s_nop 0
    s_cmp_ge_u32 s78, 4
    s_cbranch_scc0 LA_s7a
    s_setprio 2
    s_mov_b32 s79, 0
LA_py:
    buffer_load_dword v6, v7, s[52:55], s80 offen sc1
    s_add_u32 s79, s79, 1
    s_cmp_gt_u32 s79, 200000
    s_cbranch_scc1 LA_py_x
    s_waitcnt vmcnt(0)
    v_cmp_ne_u32 vcc, 1, v6
    s_cbranch_vccz LA_py_x
    s_mov_b64 exec, vcc
    s_sleep 8
    s_branch LA_py
LA_py_x:
    s_waitcnt vmcnt(0)
    s_mov_b64 exec, -1
    s_mov_b32 s89, 4194304
    buffer_load_dwordx4 v[100:103], v12, s[52:55], s89 offen sc1
    s_mov_b32 s89, 4210688
    buffer_load_dwordx4 v[104:107], v12, s[52:55], s89 offen sc1
    s_mov_b32 s89, 4227072
    buffer_load_dwordx4 v[108:111], v12, s[52:55], s89 offen sc1
    s_mov_b32 s89, 4243456
    buffer_load_dwordx4 v[112:115], v12, s[52:55], s89 offen sc1
    s_waitcnt vmcnt(3)
    v_permlane32_swap_b32 v102, v100
    v_permlane32_swap_b32 v103, v101
    s_waitcnt vmcnt(2)
    v_permlane32_swap_b32 v106, v104
    v_permlane32_swap_b32 v107, v105
    s_waitcnt vmcnt(1)
    v_permlane32_swap_b32 v110, v108
    v_permlane32_swap_b32 v111, v109
    s_waitcnt vmcnt(0)
    v_permlane32_swap_b32 v114, v112
    v_permlane32_swap_b32 v115, v113
    v_and_b32 v68, 0xffff0000, v103
    v_and_b32 v69, 0xffff0000, v107
    v_and_b32 v70, 0xffff0000, v111
    v_and_b32 v71, 0xffff0000, v115
    v_and_b32 v72, 0xffff0000, v101
    v_and_b32 v73, 0xffff0000, v105
    v_and_b32 v74, 0xffff0000, v109
    v_and_b32 v75, 0xffff0000, v113
    v_mul_f32 v68, v68, v132
    v_mul_f32 v69, v69, v133
    v_mul_f32 v70, v70, v134
    v_mul_f32 v71, v71, v135
    v_mul_f32 v72, v72, v136
    v_mul_f32 v73, v73, v137
    v_mul_f32 v74, v74, v138
    v_mul_f32 v75, v75, v139
    v_cvt_pk_bf16_f32 v36, v68, v69
    v_cvt_pk_bf16_f32 v37, v70, v71
    v_cvt_pk_bf16_f32 v38, v72, v73
    v_cvt_pk_bf16_f32 v39, v74, v75
    s_mov_b32 s89, 0
    buffer_store_dwordx4 v[36:39], v13, s[60:63], s89 offen nt sc1
    v_lshlrev_b32 v68, 16, v103
    v_lshlrev_b32 v69, 16, v107
    v_lshlrev_b32 v70, 16, v111
    v_lshlrev_b32 v71, 16, v115
    v_lshlrev_b32 v72, 16, v101
    v_lshlrev_b32 v73, 16, v105
    v_lshlrev_b32 v74, 16, v109
    v_lshlrev_b32 v75, 16, v113
    v_mul_f32 v68, v68, v140
    v_mul_f32 v69, v69, v141
    v_mul_f32 v70, v70, v142
    v_mul_f32 v71, v71, v143
    v_mul_f32 v72, v72, v144
    v_mul_f32 v73, v73, v145
    v_mul_f32 v74, v74, v146
    v_mul_f32 v75, v75, v147
    v_cvt_pk_bf16_f32 v40, v68, v69
    v_cvt_pk_bf16_f32 v41, v70, v71
    v_cvt_pk_bf16_f32 v42, v72, v73
    v_cvt_pk_bf16_f32 v43, v74, v75
    s_mov_b32 s89, 4096
    buffer_store_dwordx4 v[40:43], v13, s[60:63], s89 offen nt sc1
    v_and_b32 v68, 0xffff0000, v102
    v_and_b32 v69, 0xffff0000, v106
    v_and_b32 v70, 0xffff0000, v110
    v_and_b32 v71, 0xffff0000, v114
    v_and_b32 v72, 0xffff0000, v100
    v_and_b32 v73, 0xffff0000, v104
    v_and_b32 v74, 0xffff0000, v108
    v_and_b32 v75, 0xffff0000, v112
    v_mul_f32 v68, v68, v148
    v_mul_f32 v69, v69, v149
    v_mul_f32 v70, v70, v150
    v_mul_f32 v71, v71, v151
    v_mul_f32 v72, v72, v152
    v_mul_f32 v73, v73, v153
    v_mul_f32 v74, v74, v154
    v_mul_f32 v75, v75, v155
    v_cvt_pk_bf16_f32 v44, v68, v69
    v_cvt_pk_bf16_f32 v45, v70, v71
    v_cvt_pk_bf16_f32 v46, v72, v73
    v_cvt_pk_bf16_f32 v47, v74, v75
    s_mov_b32 s89, 8192
    buffer_store_dwordx4 v[44:47], v13, s[60:63], s89 offen nt sc1
    v_lshlrev_b32 v68, 16, v102
    v_lshlrev_b32 v69, 16, v106
    v_lshlrev_b32 v70, 16, v110
    v_lshlrev_b32 v71, 16, v114
    v_lshlrev_b32 v72, 16, v100
    v_lshlrev_b32 v73, 16, v104
    v_lshlrev_b32 v74, 16, v108
    v_lshlrev_b32 v75, 16, v112
    v_mul_f32 v68, v68, v156
    v_mul_f32 v69, v69, v157
    v_mul_f32 v70, v70, v158
    v_mul_f32 v71, v71, v159
    v_mul_f32 v72, v72, v160
    v_mul_f32 v73, v73, v161
    v_mul_f32 v74, v74, v162
    v_mul_f32 v75, v75, v163
    v_cvt_pk_bf16_f32 v48, v68, v69
    v_cvt_pk_bf16_f32 v49, v70, v71
    v_cvt_pk_bf16_f32 v50, v72, v73
    v_cvt_pk_bf16_f32 v51, v74, v75
    s_mov_b32 s89, 12288
    buffer_store_dwordx4 v[48:51], v13, s[60:63], s89 offen nt sc1
    s_endpgm
L_B:
    s_setprio 3
    s_and_b32 s3, s3, 3
    s_add_u32 s79, s72, s73
    s_add_u32 s78, s72, 0
    s_and_b32 s78, s78, 7
    s_lshl_b32 s78, s78, 1
    s_and_b32 s75, s79, 1
    s_add_u32 s78, s78, s75
    s_andn2_b32 s79, 2, s79
    s_lshl_b32 s79, s79, 3
    s_add_u32 s78, s78, s79
    s_and_b32 s76, s78, 3
    s_and_b32 s79, s73, 12
    s_add_u32 s76, s76, s79
    s_lshr_b32 s74, s78, 4
    s_add_u32 s74, s74, s79
    s_and_b32 s79, s72, 8
    s_lshr_b32 s77, s78, 2
    s_add_u32 s77, s77, s79
    s_lshr_b32 s79, s79, 2
    s_add_u32 s74, s74, s79
    s_xor_b32 s74, s74, 4
    s_and_b32 s75, s78, 15
    s_lshr_b32 s86, s3, 1
    s_and_b32 s87, s3, 1
    v_mov_b32 v10, 162304
    v_mov_b32 v11, 1
    v_lshlrev_b32 v12, 4, v0
    v_lshl_add_u32 v13, v0, 2, v10
    v_mov_b32 v14, 0
    ds_write_b32 v13, v14
    s_lshl_b32 s78, s74, 4
    s_add_u32 s78, s78, s75
    s_lshl_b32 s96, s78, 8
    s_add_u32 s96, s96, 12582912
    s_lshl_b32 s78, s78, 2
    s_add_u32 s78, s78, s3
    s_lshl_b32 s78, s78, 8
    s_add_u32 s80, s78, 12648448
    s_lshl_b32 s81, s72, 1
    s_add_u32 s81, s81, s86
    s_lshl_b32 s97, s81, 4
    s_add_u32 s97, s97, s73
    s_lshl_b32 s97, s97, 8
    s_add_u32 s97, s97, 12910464
    v_mov_b32 v15, s80
    v_mov_b32 v223, s97
    v_cmp_gt_u32 vcc, 8, v0
    s_nop 1
    v_cndmask_b32 v15, v223, v15, vcc
    v_add_u32 v221, v15, v12
    s_lshl_b32 s78, s87, 2
    s_add_u32 s78, s78, 128
    s_add_u32 s97, s97, s78
    s_lshl_b32 s82, s73, 1
    s_add_u32 s82, s82, s87
    s_lshl_b32 s78, s81, 7
    s_add_u32 s78, s78, s82
    s_lshl_b32 s94, s78, 10
    s_add_u32 s94, s94, 8388608
    v_mov_b32 v212, 0
    v_mov_b32 v213, 0
    v_mov_b32 v214, 0
    v_mov_b32 v215, 0
    v_mov_b32 v220, 0
    s_waitcnt lgkmcnt(0)
    s_mov_b32 s52, s26
    s_mov_b32 s53, s27
    s_mov_b32 s54, 0x1000000
    s_mov_b32 s55, 0x20000
    s_mov_b32 s68, s24
    s_mov_b32 s69, s25
    s_mov_b32 s70, 0x100
    s_mov_b32 s71, 0x20000
    s_lshl_b32 s98, s74, 4
    s_or_b32 s78, s75, s3
    s_cmp_lg_u32 s78, 0
    s_cbranch_scc1 LB_notag
    s_mov_b64 exec, 0xffff
    v_lshlrev_b32 v15, 8, v0
    buffer_load_dword v251, v15, s[52:55], s96 offen sc1
LB_notag:
    s_lshl_b32 s78, s87, 3
    s_lshr_b32 exec_lo, 0xffff, s78
    s_mov_b32 exec_hi, 0
    buffer_store_dwordx4 v[212:215], v221, s[52:55], 0 offen sc1
    s_mov_b64 exec, -1
    v_and_b32 v13, 15, v0
    v_lshrrev_b32 v14, 4, v0
    v_lshrrev_b32 v15, 1, v13
    v_xor_b32 v15, v15, v14
    v_lshlrev_b32 v15, 4, v15
    v_lshl_add_u32 v15, v13, 7, v15
    v_add_u32 v2, 73728, v15
    v_xor_b32 v3, 64, v2
    s_lshl_b32 s78, s86, 13
    s_add_u32 s78, s78, 2048
    v_add_u32 v4, s78, v2
    v_add_u32 v5, s78, v3
    v_bfe_u32 v15, v0, 3, 2
    s_lshl_b32 s78, s87, 1
    s_add_u32 s78, s78, s86
    v_xor_b32 v15, s78, v15
    v_lshlrev_b32 v15, 5, v15
    v_and_b32 v223, 3, v0
    v_lshl_add_u32 v15, v223, 3, v15
    v_bfe_u32 v223, v0, 2, 2
    v_lshl_add_u32 v15, v223, 7, v15
    v_mul_u32_u24 v223, 3072, v14
    v_add_u32 v6, v223, v15
    v_xor_b32 v7, 32, v6
    s_mov_b32 s60, s22
    s_mov_b32 s61, s23
    s_mov_b32 s62, 0x800000
    s_mov_b32 s63, 0x20000
    v_and_b32 v15, 1, v13
    v_cmp_eq_u32 s[88:89], 1, v15
    v_lshl_add_u32 v15, v14, 2, v15
    v_cmp_le_u32 s[90:91], v15, v13
    v_add_u32 v15, 2, v15
    v_cmp_le_u32 s[92:93], v15, v13
    v_mov_b32 v212, 0x0c0c0c0c
    v_mov_b32 v15, 0xc0c0100
    v_mov_b32 v223, 0x1000c0c
    v_cndmask_b32 v15, v15, v223, s[88:89]
    v_cndmask_b32 v208, v15, v212, s[90:91]
    v_cndmask_b32 v210, v212, v15, s[90:91]
    v_mov_b32 v15, 0xc0c0302
    v_mov_b32 v223, 0x3020c0c
    v_cndmask_b32 v15, v15, v223, s[88:89]
    v_cndmask_b32 v209, v15, v212, s[92:93]
    v_cndmask_b32 v211, v212, v15, s[92:93]
    s_or_b32 s78, s72, s86
    s_cmp_eq_u32 s78, 0
    s_cselect_b32 s78, 0xf149f2ca, 0
    v_mov_b32 v212, s78
    v_mov_b32 v213, s78
    v_mov_b32 v214, s78
    v_mov_b32 v215, s78
    s_lshl_b32 s78, s87, 12
    s_add_u32 s78, s78, 24576
    s_lshl_b32 s79, s86, 9
    s_add_u32 s79, s79, s78
    v_lshlrev_b32 v15, 3, v0
    v_add_u32 v216, s79, v15
    s_lshl_b32 s80, s86, 11
    v_add_u32 v218, s80, v216
    v_xor_b32 v219, 512, v218
    s_add_u32 s78, s78, 2048
    s_cmp_eq_u32 s86, 0
    s_cselect_b32 s78, s78, 32768
    v_add_u32 v217, s78, v15
    v_bfe_u32 v14, v0, 3, 2
    v_lshlrev_b32 v14, 5, v14
    v_and_b32 v15, 3, v0
    v_lshl_add_u32 v14, v15, 3, v14
    v_lshrrev_b32 v15, 2, v0
    v_lshl_add_u32 v14, v15, 7, v14
    s_lshl_b32 s78, s86, 11
    v_add_u32 v244, s78, v14
    s_mov_b32 s64, s20
    s_mov_b32 s65, s21
    s_mov_b32 s66, 0x200000
    s_mov_b32 s67, 0x20000
    v_lshrrev_b32 v14, 4, v0
    v_lshlrev_b32 v14, 1, v14
    v_and_b32 v15, 7, v0
    v_xor_b32 v14, v14, v15
    v_lshlrev_b32 v14, 4, v14
    v_lshrrev_b32 v15, 3, v0
    v_lshl_add_u32 v14, v15, 11, v14
    s_lshl_b32 s78, s77, 7
    s_lshl_b32 s79, s3, 14
    s_add_u32 s78, s78, s79
    v_add_u32 v245, s78, v14
    v_and_b32 v14, 15, v0
    s_lshl_b32 s78, s76, 2
    s_add_u32 s78, s78, s3
    s_lshl_b32 s79, s78, 5
    v_add_u32 v14, s79, v14
    v_lshlrev_b32 v14, 12, v14
    v_bfe_u32 v15, v0, 4, 1
    v_lshl_add_u32 v14, v15, 5, v14
    v_lshrrev_b32 v15, 5, v0
    v_lshl_add_u32 v14, v15, 4, v14
    s_lshl_b32 s79, s77, 7
    s_add_u32 s79, s79, 2048
    v_add_u32 v246, s79, v14
    s_lshl_b32 s28, s78, 16
    s_add_u32 s28, s28, 8388608
    s_lshl_b32 s30, s76, 1
    s_add_u32 s30, s30, s86
    s_lshl_b32 s30, s30, 12
    s_add_u32 s30, s30, 12910592
    v_lshrrev_b32 v15, 1, v0
    v_lshlrev_b32 v15, 8, v15
    v_and_b32 v14, 1, v0
    v_lshl_add_u32 v247, v14, 2, v15
    s_and_b32 s78, s77, 7
    s_mov_b32 s79, 0x76543210
    s_cmp_eq_u32 s78, 1
    s_cselect_b32 s79, 0x76543201, s79
    s_cmp_eq_u32 s78, 2
    s_cselect_b32 s79, 0x76543120, s79
    s_cmp_eq_u32 s78, 3
    s_cselect_b32 s79, 0x76542310, s79
    s_cmp_eq_u32 s78, 4
    s_cselect_b32 s79, 0x76534210, s79
    s_cmp_eq_u32 s78, 5
    s_cselect_b32 s79, 0x76453210, s79
    s_cmp_eq_u32 s78, 6
    s_cselect_b32 s79, 0x75643210, s79
    s_cmp_eq_u32 s78, 7
    s_cselect_b32 s79, 0x67543210, s79
    s_and_b32 s78, s76, 3
    s_mul_i32 s78, s78, 0x22222222
    s_add_u32 s79, s79, s78
    s_bfe_u32 s78, s79, 0x30000
    s_lshl_b32 s44, s78, 18
    s_lshl_b32 s78, s78, 12
    s_add_u32 s36, s78, s28
    s_bfe_u32 s78, s79, 0x30004
    s_lshl_b32 s45, s78, 18
    s_lshl_b32 s78, s78, 12
    s_add_u32 s37, s78, s28
    s_bfe_u32 s78, s79, 0x30008
    s_lshl_b32 s46, s78, 18
    s_lshl_b32 s78, s78, 12
    s_add_u32 s38, s78, s28
    s_bfe_u32 s78, s79, 0x3000c
    s_lshl_b32 s47, s78, 18
    s_lshl_b32 s78, s78, 12
    s_add_u32 s39, s78, s28
    s_bfe_u32 s78, s79, 0x30010
    s_lshl_b32 s48, s78, 18
    s_lshl_b32 s78, s78, 12
    s_add_u32 s40, s78, s28
    s_bfe_u32 s78, s79, 0x30014
    s_lshl_b32 s49, s78, 18
    s_lshl_b32 s78, s78, 12
    s_add_u32 s41, s78, s28
    s_bfe_u32 s78, s79, 0x30018
    s_lshl_b32 s50, s78, 18
    s_lshl_b32 s78, s78, 12
    s_add_u32 s42, s78, s28
    s_bfe_u32 s78, s79, 0x3001c
    s_lshl_b32 s51, s78, 18
    s_lshl_b32 s78, s78, 12
    s_add_u32 s43, s78, s28
    s_lshl_b32 s34, s3, 10
    v_bfe_u32 v14, v0, 4, 1
    v_lshrrev_b32 v15, 5, v0
    v_lshl_add_u32 v14, v14, 1, v15
    v_and_b32 v15, 7, v0
    v_xor_b32 v14, v14, v15
    v_lshlrev_b32 v14, 4, v14
    v_and_b32 v223, 15, v0
    v_lshl_add_u32 v14, v223, 7, v14
    s_lshl_b32 s78, s3, 12
    v_add_u32 v248, s78, v14
    v_xor_b32 v249, 64, v248
    v_add_u32 v250, s78, v12
    v_lshrrev_b32 v14, 3, v0
    v_xor_b32 v15, v15, v14
    v_lshlrev_b32 v15, 4, v15
    v_lshl_add_u32 v14, v14, 12, v15
    s_lshl_b32 s78, s76, 2
    s_add_u32 s78, s78, s3
    s_lshl_b32 s78, s78, 17
    s_lshl_b32 s79, s77, 7
    s_add_u32 s78, s78, s79
    s_add_u32 s78, s78, 2048
    v_add_u32 v246, s78, v14
    s_waitcnt lgkmcnt(0)
    s_barrier
    ds_read_b64_tr_b16 v[200:201], v6 offset:1024
    ds_read_b64_tr_b16 v[202:203], v6 offset:1536
    ds_read_b64_tr_b16 v[204:205], v6 offset:13312
    ds_read_b64_tr_b16 v[206:207], v6 offset:13824
    ds_read_b128 v[152:155], v2 offset:0
    ds_read_b128 v[156:159], v3 offset:0
    ds_read_b128 v[144:147], v4 offset:6144
    ds_read_b128 v[148:151], v5 offset:6144
    ds_read_b128 v[136:139], v4 offset:4096
    ds_read_b128 v[140:143], v5 offset:4096
    ds_read_b128 v[128:131], v4 offset:2048
    ds_read_b128 v[132:135], v5 offset:2048
    ds_read_b128 v[120:123], v4 offset:0
    ds_read_b128 v[124:127], v5 offset:0
    ds_read_b64_tr_b16 v[224:225], v7 offset:1024
    ds_read_b64_tr_b16 v[226:227], v7 offset:1536
    ds_read_b64_tr_b16 v[228:229], v7 offset:13312
    ds_read_b64_tr_b16 v[230:231], v7 offset:13824
    s_waitcnt lgkmcnt(13)
    v_mfma_f32_16x16x32_bf16 v[112:115], v[200:203], v[152:155], 0
    ds_read_b64_tr_b16 v[232:233], v6 offset:0
    s_waitcnt lgkmcnt(13)
    v_mfma_f32_16x16x32_bf16 v[112:115], v[204:207], v[156:159], v[112:115]
    ds_read_b64_tr_b16 v[234:235], v6 offset:512
    s_waitcnt lgkmcnt(12)
    v_mfma_f32_16x16x32_bf16 v[72:75], v[204:207], v[148:151], 0
    ds_read_b64_tr_b16 v[236:237], v6 offset:12288
    v_mfma_f32_16x16x32_bf16 v[72:75], v[200:203], v[144:147], v[72:75]
    ds_read_b64_tr_b16 v[238:239], v6 offset:12800
    s_waitcnt lgkmcnt(13)
    v_mfma_f32_16x16x32_bf16 v[64:67], v[200:203], v[136:139], 0
    s_waitcnt lgkmcnt(12)
    v_mfma_f32_16x16x32_bf16 v[64:67], v[204:207], v[140:143], v[64:67]
    s_waitcnt lgkmcnt(10)
    v_mfma_f32_16x16x32_bf16 v[56:59], v[204:207], v[132:135], 0
    v_mfma_f32_16x16x32_bf16 v[56:59], v[200:203], v[128:131], v[56:59]
    s_waitcnt lgkmcnt(9)
    v_mfma_f32_16x16x32_bf16 v[48:51], v[200:203], v[120:123], 0
    s_waitcnt lgkmcnt(8)
    v_mfma_f32_16x16x32_bf16 v[48:51], v[204:207], v[124:127], v[48:51]
    s_waitcnt lgkmcnt(4)
    v_mfma_f32_16x16x32_bf16 v[52:55], v[228:231], v[124:127], 0
    ds_read_b64_tr_b16 v[200:201], v7 offset:0
    v_mfma_f32_16x16x32_bf16 v[52:55], v[224:227], v[120:123], v[52:55]
    ds_read_b64_tr_b16 v[202:203], v7 offset:512
    v_mfma_f32_16x16x32_bf16 v[60:63], v[224:227], v[128:131], 0
    ds_read_b64_tr_b16 v[204:205], v7 offset:12288
    v_mfma_f32_16x16x32_bf16 v[60:63], v[228:231], v[132:135], v[60:63]
    ds_read_b64_tr_b16 v[206:207], v7 offset:12800
    v_mfma_f32_16x16x32_bf16 v[68:71], v[228:231], v[140:143], 0
    v_mfma_f32_16x16x32_bf16 v[68:71], v[224:227], v[136:139], v[68:71]
    v_mfma_f32_16x16x32_bf16 v[76:79], v[224:227], v[144:147], 0
    v_mfma_f32_16x16x32_bf16 v[76:79], v[228:231], v[148:151], v[76:79]
    s_barrier
    s_waitcnt lgkmcnt(4)
    v_mfma_f32_16x16x32_bf16 v[40:43], v[236:239], v[148:151], 0
    ds_read_b64_tr_b16 v[224:225], v6 offset:2048
    ds_read_b64_tr_b16 v[226:227], v6 offset:2560
    v_mfma_f32_16x16x32_bf16 v[40:43], v[232:235], v[144:147], v[40:43]
    ds_read_b64_tr_b16 v[228:229], v6 offset:14336
    ds_read_b64_tr_b16 v[230:231], v6 offset:14848
    v_mfma_f32_16x16x32_bf16 v[32:35], v[232:235], v[136:139], 0
    ds_read_b128 v[192:195], v2 offset:18432
    ds_read_b128 v[196:199], v3 offset:18432
    v_mfma_f32_16x16x32_bf16 v[32:35], v[236:239], v[140:143], v[32:35]
    ds_read_b128 v[184:187], v4 offset:24576
    ds_read_b128 v[188:191], v5 offset:24576
    v_mfma_f32_16x16x32_bf16 v[24:27], v[236:239], v[132:135], 0
    ds_read_b128 v[176:179], v4 offset:22528
    v_mfma_f32_16x16x32_bf16 v[24:27], v[232:235], v[128:131], v[24:27]
    v_mfma_f32_16x16x32_bf16 v[16:19], v[232:235], v[120:123], 0
    v_mfma_f32_16x16x32_bf16 v[16:19], v[236:239], v[124:127], v[16:19]
    s_waitcnt lgkmcnt(9)
    v_mfma_f32_16x16x32_bf16 v[20:23], v[204:207], v[124:127], 0
    ds_read_b64_tr_b16 v[232:233], v7 offset:2048
    ds_read_b64_tr_b16 v[234:235], v7 offset:2560
    v_mfma_f32_16x16x32_bf16 v[20:23], v[200:203], v[120:123], v[20:23]
    ds_read_b64_tr_b16 v[236:237], v7 offset:14336
    ds_read_b64_tr_b16 v[238:239], v7 offset:14848
    v_mfma_f32_16x16x32_bf16 v[28:31], v[200:203], v[128:131], 0
    ds_read_b128 v[180:183], v5 offset:22528
    ds_read_b128 v[168:171], v4 offset:20480
    v_mfma_f32_16x16x32_bf16 v[28:31], v[204:207], v[132:135], v[28:31]
    ds_read_b128 v[172:175], v5 offset:20480
    ds_read_b128 v[160:163], v4 offset:18432
    v_mfma_f32_16x16x32_bf16 v[36:39], v[204:207], v[140:143], 0
    ds_read_b128 v[164:167], v5 offset:18432
    v_mfma_f32_16x16x32_bf16 v[36:39], v[200:203], v[136:139], v[36:39]
    v_mfma_f32_16x16x32_bf16 v[44:47], v[200:203], v[144:147], 0
    v_mfma_f32_16x16x32_bf16 v[44:47], v[204:207], v[148:151], v[44:47]
    s_waitcnt lgkmcnt(14)
    v_mfma_f32_16x16x32_bf16 v[116:119], v[156:159], v[228:231], 0
    v_mfma_f32_16x16x32_bf16 v[116:119], v[152:155], v[224:227], v[116:119]
    v_mfma_f32_16x16x32_bf16 v[104:107], v[144:147], v[224:227], 0
    v_mfma_f32_16x16x32_bf16 v[104:107], v[148:151], v[228:231], v[104:107]
    v_mfma_f32_16x16x32_bf16 v[96:99], v[140:143], v[228:231], 0
    v_mfma_f32_16x16x32_bf16 v[96:99], v[136:139], v[224:227], v[96:99]
    s_waitcnt vmcnt(0) lgkmcnt(0)
    s_barrier
    s_or_b32 s78, s75, s3
    s_cbranch_scc0 LB_tag
LB_tagb:
    v_mfma_f32_16x16x32_bf16 v[88:91], v[128:131], v[224:227], 0
    ds_read_b64_tr_b16 v[200:201], v6 offset:25600
    v_mfma_f32_16x16x32_bf16 v[88:91], v[132:135], v[228:231], v[88:91]
    ds_read_b64_tr_b16 v[202:203], v6 offset:26112
    v_mfma_f32_16x16x32_bf16 v[80:83], v[124:127], v[228:231], 0
    ds_read_b64_tr_b16 v[204:205], v6 offset:37888
    v_mfma_f32_16x16x32_bf16 v[80:83], v[120:123], v[224:227], v[80:83]
    ds_read_b64_tr_b16 v[206:207], v6 offset:38400
    v_mfma_f32_16x16x32_bf16 v[84:87], v[120:123], v[232:235], 0
    ds_read_b64_tr_b16 v[224:225], v7 offset:25600
    v_mfma_f32_16x16x32_bf16 v[84:87], v[124:127], v[236:239], v[84:87]
    ds_read_b64_tr_b16 v[226:227], v7 offset:26112
    v_mfma_f32_16x16x32_bf16 v[92:95], v[132:135], v[236:239], 0
    ds_read_b64_tr_b16 v[228:229], v7 offset:37888
    v_mfma_f32_16x16x32_bf16 v[92:95], v[128:131], v[232:235], v[92:95]
    ds_read_b64_tr_b16 v[230:231], v7 offset:38400
    v_mfma_f32_16x16x32_bf16 v[100:103], v[136:139], v[232:235], 0
    v_mfma_f32_16x16x32_bf16 v[100:103], v[140:143], v[236:239], v[100:103]
    v_mfma_f32_16x16x32_bf16 v[108:111], v[148:151], v[236:239], 0
    v_mfma_f32_16x16x32_bf16 v[108:111], v[144:147], v[232:235], v[108:111]
    s_waitcnt lgkmcnt(4)
    v_mfma_f32_16x16x32_bf16 v[112:115], v[200:203], v[192:195], v[112:115]
    ds_read_b64_tr_b16 v[232:233], v6 offset:24576
    v_mfma_f32_16x16x32_bf16 v[112:115], v[204:207], v[196:199], v[112:115]
    ds_read_b64_tr_b16 v[234:235], v6 offset:25088
    v_mfma_f32_16x16x32_bf16 v[72:75], v[204:207], v[188:191], v[72:75]
    ds_read_b64_tr_b16 v[236:237], v6 offset:36864
    v_mfma_f32_16x16x32_bf16 v[72:75], v[200:203], v[184:187], v[72:75]
    ds_read_b64_tr_b16 v[238:239], v6 offset:37376
    v_mfma_f32_16x16x32_bf16 v[64:67], v[200:203], v[176:179], v[64:67]
    ds_read_b128 v[152:155], v2 offset:36864
    v_mfma_f32_16x16x32_bf16 v[64:67], v[204:207], v[180:183], v[64:67]
    ds_read_b128 v[156:159], v3 offset:36864
    v_mfma_f32_16x16x32_bf16 v[56:59], v[204:207], v[172:175], v[56:59]
    ds_read_b128 v[144:147], v4 offset:43008
    v_mfma_f32_16x16x32_bf16 v[56:59], v[200:203], v[168:171], v[56:59]
    ds_read_b128 v[148:151], v5 offset:43008
    v_mfma_f32_16x16x32_bf16 v[48:51], v[200:203], v[160:163], v[48:51]
    v_mfma_f32_16x16x32_bf16 v[48:51], v[204:207], v[164:167], v[48:51]
    s_waitcnt lgkmcnt(8)
    v_mfma_f32_16x16x32_bf16 v[52:55], v[228:231], v[164:167], v[52:55]
    ds_read_b64_tr_b16 v[200:201], v7 offset:24576
    v_mfma_f32_16x16x32_bf16 v[52:55], v[224:227], v[160:163], v[52:55]
    ds_read_b64_tr_b16 v[202:203], v7 offset:25088
    v_mfma_f32_16x16x32_bf16 v[60:63], v[224:227], v[168:171], v[60:63]
    ds_read_b64_tr_b16 v[204:205], v7 offset:36864
    v_mfma_f32_16x16x32_bf16 v[60:63], v[228:231], v[172:175], v[60:63]
    ds_read_b64_tr_b16 v[206:207], v7 offset:37376
    v_mfma_f32_16x16x32_bf16 v[68:71], v[228:231], v[180:183], v[68:71]
    ds_read_b128 v[136:139], v4 offset:40960
    v_mfma_f32_16x16x32_bf16 v[68:71], v[224:227], v[176:179], v[68:71]
    ds_read_b128 v[140:143], v5 offset:40960
    v_mfma_f32_16x16x32_bf16 v[76:79], v[224:227], v[184:187], v[76:79]
    ds_read_b128 v[128:131], v4 offset:38912
    v_mfma_f32_16x16x32_bf16 v[76:79], v[228:231], v[188:191], v[76:79]
    s_waitcnt lgkmcnt(11)
    v_mfma_f32_16x16x32_bf16 v[40:43], v[236:239], v[188:191], v[40:43]
    ds_read_b64_tr_b16 v[224:225], v6 offset:26624
    v_mfma_f32_16x16x32_bf16 v[40:43], v[232:235], v[184:187], v[40:43]
    ds_read_b64_tr_b16 v[226:227], v6 offset:27136
    v_mfma_f32_16x16x32_bf16 v[32:35], v[232:235], v[176:179], v[32:35]
    ds_read_b64_tr_b16 v[228:229], v6 offset:38912
    v_mfma_f32_16x16x32_bf16 v[32:35], v[236:239], v[180:183], v[32:35]
    ds_read_b64_tr_b16 v[230:231], v6 offset:39424
    v_mfma_f32_16x16x32_bf16 v[24:27], v[236:239], v[172:175], v[24:27]
    ds_read_b128 v[132:135], v5 offset:38912
    v_mfma_f32_16x16x32_bf16 v[24:27], v[232:235], v[168:171], v[24:27]
    ds_read_b128 v[120:123], v4 offset:36864
    v_mfma_f32_16x16x32_bf16 v[16:19], v[232:235], v[160:163], v[16:19]
    ds_read_b128 v[124:127], v5 offset:36864
    v_mfma_f32_16x16x32_bf16 v[16:19], v[236:239], v[164:167], v[16:19]
    s_waitcnt lgkmcnt(10)
    v_mfma_f32_16x16x32_bf16 v[20:23], v[204:207], v[164:167], v[20:23]
    ds_read_b64_tr_b16 v[232:233], v7 offset:26624
    v_mfma_f32_16x16x32_bf16 v[20:23], v[200:203], v[160:163], v[20:23]
    ds_read_b64_tr_b16 v[234:235], v7 offset:27136
    v_mfma_f32_16x16x32_bf16 v[28:31], v[200:203], v[168:171], v[28:31]
    ds_read_b64_tr_b16 v[236:237], v7 offset:38912
    v_mfma_f32_16x16x32_bf16 v[28:31], v[204:207], v[172:175], v[28:31]
    ds_read_b64_tr_b16 v[238:239], v7 offset:39424
    v_mfma_f32_16x16x32_bf16 v[36:39], v[204:207], v[180:183], v[36:39]
    v_mfma_f32_16x16x32_bf16 v[36:39], v[200:203], v[176:179], v[36:39]
    v_mfma_f32_16x16x32_bf16 v[44:47], v[200:203], v[184:187], v[44:47]
    v_mfma_f32_16x16x32_bf16 v[44:47], v[204:207], v[188:191], v[44:47]
    s_waitcnt lgkmcnt(7)
    v_mfma_f32_16x16x32_bf16 v[116:119], v[196:199], v[228:231], v[116:119]
    v_mfma_f32_16x16x32_bf16 v[116:119], v[192:195], v[224:227], v[116:119]
    v_mfma_f32_16x16x32_bf16 v[104:107], v[184:187], v[224:227], v[104:107]
    v_mfma_f32_16x16x32_bf16 v[104:107], v[188:191], v[228:231], v[104:107]
    v_mfma_f32_16x16x32_bf16 v[96:99], v[180:183], v[228:231], v[96:99]
    v_mfma_f32_16x16x32_bf16 v[96:99], v[176:179], v[224:227], v[96:99]
    s_waitcnt lgkmcnt(0)
    s_barrier
    v_mfma_f32_16x16x32_bf16 v[88:91], v[168:171], v[224:227], v[88:91]
    ds_read_b64_tr_b16 v[200:201], v6 offset:50176
    v_mfma_f32_16x16x32_bf16 v[88:91], v[172:175], v[228:231], v[88:91]
    ds_read_b64_tr_b16 v[202:203], v6 offset:50688
    v_mfma_f32_16x16x32_bf16 v[80:83], v[164:167], v[228:231], v[80:83]
    ds_read_b64_tr_b16 v[204:205], v6 offset:62464
    v_mfma_f32_16x16x32_bf16 v[80:83], v[160:163], v[224:227], v[80:83]
    ds_read_b64_tr_b16 v[206:207], v6 offset:62976
    v_mfma_f32_16x16x32_bf16 v[84:87], v[160:163], v[232:235], v[84:87]
    ds_read_b64_tr_b16 v[224:225], v7 offset:50176
    v_mfma_f32_16x16x32_bf16 v[84:87], v[164:167], v[236:239], v[84:87]
    ds_read_b64_tr_b16 v[226:227], v7 offset:50688
    v_mfma_f32_16x16x32_bf16 v[92:95], v[172:175], v[236:239], v[92:95]
    ds_read_b64_tr_b16 v[228:229], v7 offset:62464
    v_mfma_f32_16x16x32_bf16 v[92:95], v[168:171], v[232:235], v[92:95]
    ds_read_b64_tr_b16 v[230:231], v7 offset:62976
    v_mfma_f32_16x16x32_bf16 v[100:103], v[176:179], v[232:235], v[100:103]
    v_mfma_f32_16x16x32_bf16 v[100:103], v[180:183], v[236:239], v[100:103]
    v_mfma_f32_16x16x32_bf16 v[108:111], v[188:191], v[236:239], v[108:111]
    v_mfma_f32_16x16x32_bf16 v[108:111], v[184:187], v[232:235], v[108:111]
    s_waitcnt lgkmcnt(4)
    v_mfma_f32_16x16x32_bf16 v[112:115], v[200:203], v[152:155], v[112:115]
    ds_read_b64_tr_b16 v[232:233], v6 offset:49152
    v_mfma_f32_16x16x32_bf16 v[112:115], v[204:207], v[156:159], v[112:115]
    ds_read_b64_tr_b16 v[234:235], v6 offset:49664
    v_mfma_f32_16x16x32_bf16 v[72:75], v[204:207], v[148:151], v[72:75]
    ds_read_b64_tr_b16 v[236:237], v6 offset:61440
    v_mfma_f32_16x16x32_bf16 v[72:75], v[200:203], v[144:147], v[72:75]
    ds_read_b64_tr_b16 v[238:239], v6 offset:61952
    v_mfma_f32_16x16x32_bf16 v[64:67], v[200:203], v[136:139], v[64:67]
    ds_read_b128 v[192:195], v2 offset:0
    v_mfma_f32_16x16x32_bf16 v[64:67], v[204:207], v[140:143], v[64:67]
    ds_read_b128 v[196:199], v3 offset:0
    v_mfma_f32_16x16x32_bf16 v[56:59], v[204:207], v[132:135], v[56:59]
    ds_read_b128 v[184:187], v4 offset:6144
    v_mfma_f32_16x16x32_bf16 v[56:59], v[200:203], v[128:131], v[56:59]
    ds_read_b128 v[188:191], v5 offset:6144
    v_mfma_f32_16x16x32_bf16 v[48:51], v[200:203], v[120:123], v[48:51]
    v_mfma_f32_16x16x32_bf16 v[48:51], v[204:207], v[124:127], v[48:51]
    s_waitcnt lgkmcnt(8)
    v_mfma_f32_16x16x32_bf16 v[52:55], v[228:231], v[124:127], v[52:55]
    ds_read_b64_tr_b16 v[200:201], v7 offset:49152
    v_mfma_f32_16x16x32_bf16 v[52:55], v[224:227], v[120:123], v[52:55]
    ds_read_b64_tr_b16 v[202:203], v7 offset:49664
    v_mfma_f32_16x16x32_bf16 v[60:63], v[224:227], v[128:131], v[60:63]
    ds_read_b64_tr_b16 v[204:205], v7 offset:61440
    v_mfma_f32_16x16x32_bf16 v[60:63], v[228:231], v[132:135], v[60:63]
    ds_read_b64_tr_b16 v[206:207], v7 offset:61952
    v_mfma_f32_16x16x32_bf16 v[68:71], v[228:231], v[140:143], v[68:71]
    ds_read_b128 v[176:179], v4 offset:4096
    v_mfma_f32_16x16x32_bf16 v[68:71], v[224:227], v[136:139], v[68:71]
    ds_read_b128 v[180:183], v5 offset:4096
    v_mfma_f32_16x16x32_bf16 v[76:79], v[224:227], v[144:147], v[76:79]
    ds_read_b128 v[168:171], v4 offset:2048
    v_mfma_f32_16x16x32_bf16 v[76:79], v[228:231], v[148:151], v[76:79]
    s_waitcnt lgkmcnt(11)
    v_mfma_f32_16x16x32_bf16 v[40:43], v[236:239], v[148:151], v[40:43]
    ds_read_b64_tr_b16 v[224:225], v6 offset:51200
    v_mfma_f32_16x16x32_bf16 v[40:43], v[232:235], v[144:147], v[40:43]
    ds_read_b64_tr_b16 v[226:227], v6 offset:51712
    v_mfma_f32_16x16x32_bf16 v[32:35], v[232:235], v[136:139], v[32:35]
    ds_read_b64_tr_b16 v[228:229], v6 offset:63488
    v_mfma_f32_16x16x32_bf16 v[32:35], v[236:239], v[140:143], v[32:35]
    ds_read_b64_tr_b16 v[230:231], v6 offset:64000
    v_mfma_f32_16x16x32_bf16 v[24:27], v[236:239], v[132:135], v[24:27]
    ds_read_b128 v[172:175], v5 offset:2048
    v_mfma_f32_16x16x32_bf16 v[24:27], v[232:235], v[128:131], v[24:27]
    ds_read_b128 v[160:163], v4 offset:0
    v_mfma_f32_16x16x32_bf16 v[16:19], v[232:235], v[120:123], v[16:19]
    ds_read_b128 v[164:167], v5 offset:0
    v_mfma_f32_16x16x32_bf16 v[16:19], v[236:239], v[124:127], v[16:19]
    s_waitcnt lgkmcnt(10)
    v_mfma_f32_16x16x32_bf16 v[20:23], v[204:207], v[124:127], v[20:23]
    ds_read_b64_tr_b16 v[232:233], v7 offset:51200
    v_mfma_f32_16x16x32_bf16 v[20:23], v[200:203], v[120:123], v[20:23]
    ds_read_b64_tr_b16 v[234:235], v7 offset:51712
    v_mfma_f32_16x16x32_bf16 v[28:31], v[200:203], v[128:131], v[28:31]
    ds_read_b64_tr_b16 v[236:237], v7 offset:63488
    v_mfma_f32_16x16x32_bf16 v[28:31], v[204:207], v[132:135], v[28:31]
    ds_read_b64_tr_b16 v[238:239], v7 offset:64000
    v_mfma_f32_16x16x32_bf16 v[36:39], v[204:207], v[140:143], v[36:39]
    v_mfma_f32_16x16x32_bf16 v[36:39], v[200:203], v[136:139], v[36:39]
    v_mfma_f32_16x16x32_bf16 v[44:47], v[200:203], v[144:147], v[44:47]
    v_mfma_f32_16x16x32_bf16 v[44:47], v[204:207], v[148:151], v[44:47]
    s_waitcnt lgkmcnt(7)
    v_mfma_f32_16x16x32_bf16 v[116:119], v[156:159], v[228:231], v[116:119]
    v_mfma_f32_16x16x32_bf16 v[116:119], v[152:155], v[224:227], v[116:119]
    v_mfma_f32_16x16x32_bf16 v[104:107], v[144:147], v[224:227], v[104:107]
    v_mfma_f32_16x16x32_bf16 v[104:107], v[148:151], v[228:231], v[104:107]
    v_mfma_f32_16x16x32_bf16 v[96:99], v[140:143], v[228:231], v[96:99]
    v_mfma_f32_16x16x32_bf16 v[96:99], v[136:139], v[224:227], v[96:99]
    s_waitcnt lgkmcnt(0)
    s_barrier
    v_mfma_f32_16x16x32_bf16 v[88:91], v[128:131], v[224:227], v[88:91]
    ds_read_b64_tr_b16 v[200:201], v6 offset:1024
    v_mfma_f32_16x16x32_bf16 v[88:91], v[132:135], v[228:231], v[88:91]
    ds_read_b64_tr_b16 v[202:203], v6 offset:1536
    v_mfma_f32_16x16x32_bf16 v[80:83], v[124:127], v[228:231], v[80:83]
    ds_read_b64_tr_b16 v[204:205], v6 offset:13312
    v_mfma_f32_16x16x32_bf16 v[80:83], v[120:123], v[224:227], v[80:83]
    ds_read_b64_tr_b16 v[206:207], v6 offset:13824
    v_mfma_f32_16x16x32_bf16 v[84:87], v[120:123], v[232:235], v[84:87]
    ds_read_b64_tr_b16 v[224:225], v7 offset:1024
    v_mfma_f32_16x16x32_bf16 v[84:87], v[124:127], v[236:239], v[84:87]
    ds_read_b64_tr_b16 v[226:227], v7 offset:1536
    v_mfma_f32_16x16x32_bf16 v[92:95], v[132:135], v[236:239], v[92:95]
    ds_read_b64_tr_b16 v[228:229], v7 offset:13312
    v_mfma_f32_16x16x32_bf16 v[92:95], v[128:131], v[232:235], v[92:95]
    ds_read_b64_tr_b16 v[230:231], v7 offset:13824
    v_mfma_f32_16x16x32_bf16 v[100:103], v[136:139], v[232:235], v[100:103]
    v_mfma_f32_16x16x32_bf16 v[100:103], v[140:143], v[236:239], v[100:103]
    v_mfma_f32_16x16x32_bf16 v[108:111], v[148:151], v[236:239], v[108:111]
    v_mfma_f32_16x16x32_bf16 v[108:111], v[144:147], v[232:235], v[108:111]
    s_waitcnt lgkmcnt(4)
    v_mfma_f32_16x16x32_bf16 v[112:115], v[200:203], v[192:195], v[112:115]
    ds_read_b64_tr_b16 v[232:233], v6 offset:0
    v_mfma_f32_16x16x32_bf16 v[112:115], v[204:207], v[196:199], v[112:115]
    ds_read_b64_tr_b16 v[234:235], v6 offset:512
    v_mfma_f32_16x16x32_bf16 v[72:75], v[204:207], v[188:191], v[72:75]
    ds_read_b64_tr_b16 v[236:237], v6 offset:12288
    v_mfma_f32_16x16x32_bf16 v[72:75], v[200:203], v[184:187], v[72:75]
    ds_read_b64_tr_b16 v[238:239], v6 offset:12800
    v_mfma_f32_16x16x32_bf16 v[64:67], v[200:203], v[176:179], v[64:67]
    ds_read_b128 v[152:155], v2 offset:18432
    v_mfma_f32_16x16x32_bf16 v[64:67], v[204:207], v[180:183], v[64:67]
    ds_read_b128 v[156:159], v3 offset:18432
    v_mfma_f32_16x16x32_bf16 v[56:59], v[204:207], v[172:175], v[56:59]
    ds_read_b128 v[144:147], v4 offset:24576
    v_mfma_f32_16x16x32_bf16 v[56:59], v[200:203], v[168:171], v[56:59]
    ds_read_b128 v[148:151], v5 offset:24576
    v_mfma_f32_16x16x32_bf16 v[48:51], v[200:203], v[160:163], v[48:51]
    v_mfma_f32_16x16x32_bf16 v[48:51], v[204:207], v[164:167], v[48:51]
    s_waitcnt lgkmcnt(8)
    v_mfma_f32_16x16x32_bf16 v[52:55], v[228:231], v[164:167], v[52:55]
    ds_read_b64_tr_b16 v[200:201], v7 offset:0
    v_mfma_f32_16x16x32_bf16 v[52:55], v[224:227], v[160:163], v[52:55]
    ds_read_b64_tr_b16 v[202:203], v7 offset:512
    v_mfma_f32_16x16x32_bf16 v[60:63], v[224:227], v[168:171], v[60:63]
    ds_read_b64_tr_b16 v[204:205], v7 offset:12288
    v_mfma_f32_16x16x32_bf16 v[60:63], v[228:231], v[172:175], v[60:63]
    ds_read_b64_tr_b16 v[206:207], v7 offset:12800
    v_mfma_f32_16x16x32_bf16 v[68:71], v[228:231], v[180:183], v[68:71]
    ds_read_b128 v[136:139], v4 offset:22528
    v_mfma_f32_16x16x32_bf16 v[68:71], v[224:227], v[176:179], v[68:71]
    ds_read_b128 v[140:143], v5 offset:22528
    v_mfma_f32_16x16x32_bf16 v[76:79], v[224:227], v[184:187], v[76:79]
    ds_read_b128 v[128:131], v4 offset:20480
    v_mfma_f32_16x16x32_bf16 v[76:79], v[228:231], v[188:191], v[76:79]
    s_waitcnt lgkmcnt(11)
    v_mfma_f32_16x16x32_bf16 v[40:43], v[236:239], v[188:191], v[40:43]
    ds_read_b64_tr_b16 v[224:225], v6 offset:2048
    v_mfma_f32_16x16x32_bf16 v[40:43], v[232:235], v[184:187], v[40:43]
    ds_read_b64_tr_b16 v[226:227], v6 offset:2560
    v_mfma_f32_16x16x32_bf16 v[32:35], v[232:235], v[176:179], v[32:35]
    ds_read_b64_tr_b16 v[228:229], v6 offset:14336
    v_mfma_f32_16x16x32_bf16 v[32:35], v[236:239], v[180:183], v[32:35]
    ds_read_b64_tr_b16 v[230:231], v6 offset:14848
    v_mfma_f32_16x16x32_bf16 v[24:27], v[236:239], v[172:175], v[24:27]
    ds_read_b128 v[132:135], v5 offset:20480
    v_mfma_f32_16x16x32_bf16 v[24:27], v[232:235], v[168:171], v[24:27]
    ds_read_b128 v[120:123], v4 offset:18432
    v_mfma_f32_16x16x32_bf16 v[16:19], v[232:235], v[160:163], v[16:19]
    ds_read_b128 v[124:127], v5 offset:18432
    v_mfma_f32_16x16x32_bf16 v[16:19], v[236:239], v[164:167], v[16:19]
    s_waitcnt lgkmcnt(10)
    v_mfma_f32_16x16x32_bf16 v[20:23], v[204:207], v[164:167], v[20:23]
    ds_read_b64_tr_b16 v[232:233], v7 offset:2048
    v_mfma_f32_16x16x32_bf16 v[20:23], v[200:203], v[160:163], v[20:23]
    ds_read_b64_tr_b16 v[234:235], v7 offset:2560
    v_mfma_f32_16x16x32_bf16 v[28:31], v[200:203], v[168:171], v[28:31]
    ds_read_b64_tr_b16 v[236:237], v7 offset:14336
    v_mfma_f32_16x16x32_bf16 v[28:31], v[204:207], v[172:175], v[28:31]
    ds_read_b64_tr_b16 v[238:239], v7 offset:14848
    v_mfma_f32_16x16x32_bf16 v[36:39], v[204:207], v[180:183], v[36:39]
    v_mfma_f32_16x16x32_bf16 v[36:39], v[200:203], v[176:179], v[36:39]
    v_mfma_f32_16x16x32_bf16 v[44:47], v[200:203], v[184:187], v[44:47]
    v_mfma_f32_16x16x32_bf16 v[44:47], v[204:207], v[188:191], v[44:47]
    s_waitcnt lgkmcnt(7)
    v_mfma_f32_16x16x32_bf16 v[116:119], v[196:199], v[228:231], v[116:119]
    v_mfma_f32_16x16x32_bf16 v[116:119], v[192:195], v[224:227], v[116:119]
    v_mfma_f32_16x16x32_bf16 v[104:107], v[184:187], v[224:227], v[104:107]
    v_mfma_f32_16x16x32_bf16 v[104:107], v[188:191], v[228:231], v[104:107]
    v_mfma_f32_16x16x32_bf16 v[96:99], v[180:183], v[228:231], v[96:99]
    v_mfma_f32_16x16x32_bf16 v[96:99], v[176:179], v[224:227], v[96:99]
    s_waitcnt lgkmcnt(0)
    s_barrier
    v_mfma_f32_16x16x32_bf16 v[88:91], v[168:171], v[224:227], v[88:91]
    ds_read_b64_tr_b16 v[200:201], v6 offset:25600
    v_mfma_f32_16x16x32_bf16 v[88:91], v[172:175], v[228:231], v[88:91]
    ds_read_b64_tr_b16 v[202:203], v6 offset:26112
    v_mfma_f32_16x16x32_bf16 v[80:83], v[164:167], v[228:231], v[80:83]
    ds_read_b64_tr_b16 v[204:205], v6 offset:37888
    v_mfma_f32_16x16x32_bf16 v[80:83], v[160:163], v[224:227], v[80:83]
    ds_read_b64_tr_b16 v[206:207], v6 offset:38400
    v_mfma_f32_16x16x32_bf16 v[84:87], v[160:163], v[232:235], v[84:87]
    ds_read_b64_tr_b16 v[224:225], v7 offset:25600
    v_mfma_f32_16x16x32_bf16 v[84:87], v[164:167], v[236:239], v[84:87]
    ds_read_b64_tr_b16 v[226:227], v7 offset:26112
    v_mfma_f32_16x16x32_bf16 v[92:95], v[172:175], v[236:239], v[92:95]
    ds_read_b64_tr_b16 v[228:229], v7 offset:37888
    v_mfma_f32_16x16x32_bf16 v[92:95], v[168:171], v[232:235], v[92:95]
    ds_read_b64_tr_b16 v[230:231], v7 offset:38400
    v_mfma_f32_16x16x32_bf16 v[100:103], v[176:179], v[232:235], v[100:103]
    v_mfma_f32_16x16x32_bf16 v[100:103], v[180:183], v[236:239], v[100:103]
    v_mfma_f32_16x16x32_bf16 v[108:111], v[188:191], v[236:239], v[108:111]
    v_mfma_f32_16x16x32_bf16 v[108:111], v[184:187], v[232:235], v[108:111]
    s_waitcnt lgkmcnt(4)
    v_mfma_f32_16x16x32_bf16 v[112:115], v[200:203], v[152:155], v[112:115]
    ds_read_b64_tr_b16 v[232:233], v6 offset:24576
    v_mfma_f32_16x16x32_bf16 v[112:115], v[204:207], v[156:159], v[112:115]
    ds_read_b64_tr_b16 v[234:235], v6 offset:25088
    v_mfma_f32_16x16x32_bf16 v[72:75], v[204:207], v[148:151], v[72:75]
    ds_read_b64_tr_b16 v[236:237], v6 offset:36864
    v_mfma_f32_16x16x32_bf16 v[72:75], v[200:203], v[144:147], v[72:75]
    ds_read_b64_tr_b16 v[238:239], v6 offset:37376
    v_mfma_f32_16x16x32_bf16 v[64:67], v[200:203], v[136:139], v[64:67]
    ds_read_b128 v[192:195], v2 offset:36864
    v_mfma_f32_16x16x32_bf16 v[64:67], v[204:207], v[140:143], v[64:67]
    ds_read_b128 v[196:199], v3 offset:36864
    v_mfma_f32_16x16x32_bf16 v[56:59], v[204:207], v[132:135], v[56:59]
    ds_read_b128 v[184:187], v4 offset:43008
    v_mfma_f32_16x16x32_bf16 v[56:59], v[200:203], v[128:131], v[56:59]
    ds_read_b128 v[188:191], v5 offset:43008
    v_mfma_f32_16x16x32_bf16 v[48:51], v[200:203], v[120:123], v[48:51]
    v_mfma_f32_16x16x32_bf16 v[48:51], v[204:207], v[124:127], v[48:51]
    s_waitcnt lgkmcnt(8)
    v_mfma_f32_16x16x32_bf16 v[52:55], v[228:231], v[124:127], v[52:55]
    ds_read_b64_tr_b16 v[200:201], v7 offset:24576
    v_mfma_f32_16x16x32_bf16 v[52:55], v[224:227], v[120:123], v[52:55]
    ds_read_b64_tr_b16 v[202:203], v7 offset:25088
    v_mfma_f32_16x16x32_bf16 v[60:63], v[224:227], v[128:131], v[60:63]
    ds_read_b64_tr_b16 v[204:205], v7 offset:36864
    v_mfma_f32_16x16x32_bf16 v[60:63], v[228:231], v[132:135], v[60:63]
    ds_read_b64_tr_b16 v[206:207], v7 offset:37376
    v_mfma_f32_16x16x32_bf16 v[68:71], v[228:231], v[140:143], v[68:71]
    ds_read_b128 v[176:179], v4 offset:40960
    v_mfma_f32_16x16x32_bf16 v[68:71], v[224:227], v[136:139], v[68:71]
    ds_read_b128 v[180:183], v5 offset:40960
    v_mfma_f32_16x16x32_bf16 v[76:79], v[224:227], v[144:147], v[76:79]
    ds_read_b128 v[168:171], v4 offset:38912
    v_mfma_f32_16x16x32_bf16 v[76:79], v[228:231], v[148:151], v[76:79]
    s_waitcnt lgkmcnt(11)
    v_mfma_f32_16x16x32_bf16 v[40:43], v[236:239], v[148:151], v[40:43]
    ds_read_b64_tr_b16 v[224:225], v6 offset:26624
    v_mfma_f32_16x16x32_bf16 v[40:43], v[232:235], v[144:147], v[40:43]
    ds_read_b64_tr_b16 v[226:227], v6 offset:27136
    v_mfma_f32_16x16x32_bf16 v[32:35], v[232:235], v[136:139], v[32:35]
    ds_read_b64_tr_b16 v[228:229], v6 offset:38912
    v_mfma_f32_16x16x32_bf16 v[32:35], v[236:239], v[140:143], v[32:35]
    ds_read_b64_tr_b16 v[230:231], v6 offset:39424
    v_mfma_f32_16x16x32_bf16 v[24:27], v[236:239], v[132:135], v[24:27]
    ds_read_b128 v[172:175], v5 offset:38912
    v_mfma_f32_16x16x32_bf16 v[24:27], v[232:235], v[128:131], v[24:27]
    ds_read_b128 v[160:163], v4 offset:36864
    v_mfma_f32_16x16x32_bf16 v[16:19], v[232:235], v[120:123], v[16:19]
    ds_read_b128 v[164:167], v5 offset:36864
    v_mfma_f32_16x16x32_bf16 v[16:19], v[236:239], v[124:127], v[16:19]
    s_waitcnt lgkmcnt(10)
    v_mfma_f32_16x16x32_bf16 v[20:23], v[204:207], v[124:127], v[20:23]
    ds_read_b64_tr_b16 v[232:233], v7 offset:26624
    v_mfma_f32_16x16x32_bf16 v[20:23], v[200:203], v[120:123], v[20:23]
    ds_read_b64_tr_b16 v[234:235], v7 offset:27136
    v_mfma_f32_16x16x32_bf16 v[28:31], v[200:203], v[128:131], v[28:31]
    ds_read_b64_tr_b16 v[236:237], v7 offset:38912
    v_mfma_f32_16x16x32_bf16 v[28:31], v[204:207], v[132:135], v[28:31]
    ds_read_b64_tr_b16 v[238:239], v7 offset:39424
    v_mfma_f32_16x16x32_bf16 v[36:39], v[204:207], v[140:143], v[36:39]
    v_mfma_f32_16x16x32_bf16 v[36:39], v[200:203], v[136:139], v[36:39]
    v_mfma_f32_16x16x32_bf16 v[44:47], v[200:203], v[144:147], v[44:47]
    v_mfma_f32_16x16x32_bf16 v[44:47], v[204:207], v[148:151], v[44:47]
    s_waitcnt lgkmcnt(7)
    v_mfma_f32_16x16x32_bf16 v[116:119], v[156:159], v[228:231], v[116:119]
    v_mfma_f32_16x16x32_bf16 v[116:119], v[152:155], v[224:227], v[116:119]
    v_mfma_f32_16x16x32_bf16 v[104:107], v[144:147], v[224:227], v[104:107]
    v_mfma_f32_16x16x32_bf16 v[104:107], v[148:151], v[228:231], v[104:107]
    v_mfma_f32_16x16x32_bf16 v[96:99], v[140:143], v[228:231], v[96:99]
    v_mfma_f32_16x16x32_bf16 v[96:99], v[136:139], v[224:227], v[96:99]
    s_waitcnt lgkmcnt(0)
    s_barrier
    v_mfma_f32_16x16x32_bf16 v[88:91], v[128:131], v[224:227], v[88:91]
    ds_read_b64_tr_b16 v[200:201], v6 offset:50176
    v_mfma_f32_16x16x32_bf16 v[88:91], v[132:135], v[228:231], v[88:91]
    ds_read_b64_tr_b16 v[202:203], v6 offset:50688
    v_mfma_f32_16x16x32_bf16 v[80:83], v[124:127], v[228:231], v[80:83]
    ds_read_b64_tr_b16 v[204:205], v6 offset:62464
    v_mfma_f32_16x16x32_bf16 v[80:83], v[120:123], v[224:227], v[80:83]
    ds_read_b64_tr_b16 v[206:207], v6 offset:62976
    v_mfma_f32_16x16x32_bf16 v[84:87], v[120:123], v[232:235], v[84:87]
    ds_read_b64_tr_b16 v[224:225], v7 offset:50176
    v_mfma_f32_16x16x32_bf16 v[84:87], v[124:127], v[236:239], v[84:87]
    ds_read_b64_tr_b16 v[226:227], v7 offset:50688
    v_mfma_f32_16x16x32_bf16 v[92:95], v[132:135], v[236:239], v[92:95]
    ds_read_b64_tr_b16 v[228:229], v7 offset:62464
    v_mfma_f32_16x16x32_bf16 v[92:95], v[128:131], v[232:235], v[92:95]
    ds_read_b64_tr_b16 v[230:231], v7 offset:62976
    v_mfma_f32_16x16x32_bf16 v[100:103], v[136:139], v[232:235], v[100:103]
    v_mfma_f32_16x16x32_bf16 v[100:103], v[140:143], v[236:239], v[100:103]
    v_mfma_f32_16x16x32_bf16 v[108:111], v[148:151], v[236:239], v[108:111]
    v_mfma_f32_16x16x32_bf16 v[108:111], v[144:147], v[232:235], v[108:111]
    s_waitcnt lgkmcnt(4)
    v_mfma_f32_16x16x32_bf16 v[112:115], v[200:203], v[192:195], v[112:115]
    ds_read_b64_tr_b16 v[232:233], v6 offset:49152
    v_mfma_f32_16x16x32_bf16 v[112:115], v[204:207], v[196:199], v[112:115]
    ds_read_b64_tr_b16 v[234:235], v6 offset:49664
    v_mfma_f32_16x16x32_bf16 v[72:75], v[204:207], v[188:191], v[72:75]
    ds_read_b64_tr_b16 v[236:237], v6 offset:61440
    v_mfma_f32_16x16x32_bf16 v[72:75], v[200:203], v[184:187], v[72:75]
    ds_read_b64_tr_b16 v[238:239], v6 offset:61952
    v_mfma_f32_16x16x32_bf16 v[64:67], v[200:203], v[176:179], v[64:67]
    ds_read_b128 v[152:155], v2 offset:0
    v_mfma_f32_16x16x32_bf16 v[64:67], v[204:207], v[180:183], v[64:67]
    ds_read_b128 v[156:159], v3 offset:0
    v_mfma_f32_16x16x32_bf16 v[56:59], v[204:207], v[172:175], v[56:59]
    ds_read_b128 v[144:147], v4 offset:6144
    v_mfma_f32_16x16x32_bf16 v[56:59], v[200:203], v[168:171], v[56:59]
    ds_read_b128 v[148:151], v5 offset:6144
    v_mfma_f32_16x16x32_bf16 v[48:51], v[200:203], v[160:163], v[48:51]
    v_mfma_f32_16x16x32_bf16 v[48:51], v[204:207], v[164:167], v[48:51]
    s_waitcnt lgkmcnt(8)
    v_mfma_f32_16x16x32_bf16 v[52:55], v[228:231], v[164:167], v[52:55]
    ds_read_b64_tr_b16 v[200:201], v7 offset:49152
    v_mfma_f32_16x16x32_bf16 v[52:55], v[224:227], v[160:163], v[52:55]
    ds_read_b64_tr_b16 v[202:203], v7 offset:49664
    v_mfma_f32_16x16x32_bf16 v[60:63], v[224:227], v[168:171], v[60:63]
    ds_read_b64_tr_b16 v[204:205], v7 offset:61440
    v_mfma_f32_16x16x32_bf16 v[60:63], v[228:231], v[172:175], v[60:63]
    ds_read_b64_tr_b16 v[206:207], v7 offset:61952
    v_mfma_f32_16x16x32_bf16 v[68:71], v[228:231], v[180:183], v[68:71]
    ds_read_b128 v[136:139], v4 offset:4096
    v_mfma_f32_16x16x32_bf16 v[68:71], v[224:227], v[176:179], v[68:71]
    ds_read_b128 v[140:143], v5 offset:4096
    v_mfma_f32_16x16x32_bf16 v[76:79], v[224:227], v[184:187], v[76:79]
    ds_read_b128 v[128:131], v4 offset:2048
    v_mfma_f32_16x16x32_bf16 v[76:79], v[228:231], v[188:191], v[76:79]
    s_waitcnt lgkmcnt(11)
    v_mfma_f32_16x16x32_bf16 v[40:43], v[236:239], v[188:191], v[40:43]
    ds_read_b64_tr_b16 v[224:225], v6 offset:51200
    v_mfma_f32_16x16x32_bf16 v[40:43], v[232:235], v[184:187], v[40:43]
    ds_read_b64_tr_b16 v[226:227], v6 offset:51712
    v_mfma_f32_16x16x32_bf16 v[32:35], v[232:235], v[176:179], v[32:35]
    ds_read_b64_tr_b16 v[228:229], v6 offset:63488
    v_mfma_f32_16x16x32_bf16 v[32:35], v[236:239], v[180:183], v[32:35]
    ds_read_b64_tr_b16 v[230:231], v6 offset:64000
    v_mfma_f32_16x16x32_bf16 v[24:27], v[236:239], v[172:175], v[24:27]
    ds_read_b128 v[132:135], v5 offset:2048
    v_mfma_f32_16x16x32_bf16 v[24:27], v[232:235], v[168:171], v[24:27]
    ds_read_b128 v[120:123], v4 offset:0
    v_mfma_f32_16x16x32_bf16 v[16:19], v[232:235], v[160:163], v[16:19]
    ds_read_b128 v[124:127], v5 offset:0
    v_mfma_f32_16x16x32_bf16 v[16:19], v[236:239], v[164:167], v[16:19]
    s_waitcnt lgkmcnt(10)
    v_mfma_f32_16x16x32_bf16 v[20:23], v[204:207], v[164:167], v[20:23]
    ds_read_b64_tr_b16 v[232:233], v7 offset:51200
    v_mfma_f32_16x16x32_bf16 v[20:23], v[200:203], v[160:163], v[20:23]
    ds_read_b64_tr_b16 v[234:235], v7 offset:51712
    v_mfma_f32_16x16x32_bf16 v[28:31], v[200:203], v[168:171], v[28:31]
    ds_read_b64_tr_b16 v[236:237], v7 offset:63488
    v_mfma_f32_16x16x32_bf16 v[28:31], v[204:207], v[172:175], v[28:31]
    ds_read_b64_tr_b16 v[238:239], v7 offset:64000
    v_mfma_f32_16x16x32_bf16 v[36:39], v[204:207], v[180:183], v[36:39]
    v_mfma_f32_16x16x32_bf16 v[36:39], v[200:203], v[176:179], v[36:39]
    v_mfma_f32_16x16x32_bf16 v[44:47], v[200:203], v[184:187], v[44:47]
    v_mfma_f32_16x16x32_bf16 v[44:47], v[204:207], v[188:191], v[44:47]
    s_waitcnt lgkmcnt(7)
    v_mfma_f32_16x16x32_bf16 v[116:119], v[196:199], v[228:231], v[116:119]
    v_mfma_f32_16x16x32_bf16 v[116:119], v[192:195], v[224:227], v[116:119]
    v_mfma_f32_16x16x32_bf16 v[104:107], v[184:187], v[224:227], v[104:107]
    v_mfma_f32_16x16x32_bf16 v[104:107], v[188:191], v[228:231], v[104:107]
    v_mfma_f32_16x16x32_bf16 v[96:99], v[180:183], v[228:231], v[96:99]
    v_mfma_f32_16x16x32_bf16 v[96:99], v[176:179], v[224:227], v[96:99]
    s_waitcnt lgkmcnt(0)
    s_barrier
    v_mfma_f32_16x16x32_bf16 v[88:91], v[168:171], v[224:227], v[88:91]
    ds_read_b64_tr_b16 v[200:201], v6 offset:1024
    v_mfma_f32_16x16x32_bf16 v[88:91], v[172:175], v[228:231], v[88:91]
    ds_read_b64_tr_b16 v[202:203], v6 offset:1536
    v_mfma_f32_16x16x32_bf16 v[80:83], v[164:167], v[228:231], v[80:83]
    ds_read_b64_tr_b16 v[204:205], v6 offset:13312
    v_mfma_f32_16x16x32_bf16 v[80:83], v[160:163], v[224:227], v[80:83]
    ds_read_b64_tr_b16 v[206:207], v6 offset:13824
    v_mfma_f32_16x16x32_bf16 v[84:87], v[160:163], v[232:235], v[84:87]
    ds_read_b64_tr_b16 v[224:225], v7 offset:1024
    v_mfma_f32_16x16x32_bf16 v[84:87], v[164:167], v[236:239], v[84:87]
    ds_read_b64_tr_b16 v[226:227], v7 offset:1536
    v_mfma_f32_16x16x32_bf16 v[92:95], v[172:175], v[236:239], v[92:95]
    ds_read_b64_tr_b16 v[228:229], v7 offset:13312
    v_mfma_f32_16x16x32_bf16 v[92:95], v[168:171], v[232:235], v[92:95]
    ds_read_b64_tr_b16 v[230:231], v7 offset:13824
    v_mfma_f32_16x16x32_bf16 v[100:103], v[176:179], v[232:235], v[100:103]
    v_mfma_f32_16x16x32_bf16 v[100:103], v[180:183], v[236:239], v[100:103]
    v_mfma_f32_16x16x32_bf16 v[108:111], v[188:191], v[236:239], v[108:111]
    v_mfma_f32_16x16x32_bf16 v[108:111], v[184:187], v[232:235], v[108:111]
    s_waitcnt lgkmcnt(4)
    v_mfma_f32_16x16x32_bf16 v[112:115], v[200:203], v[152:155], v[112:115]
    ds_read_b64_tr_b16 v[232:233], v6 offset:0
    v_mfma_f32_16x16x32_bf16 v[112:115], v[204:207], v[156:159], v[112:115]
    ds_read_b64_tr_b16 v[234:235], v6 offset:512
    v_mfma_f32_16x16x32_bf16 v[72:75], v[204:207], v[148:151], v[72:75]
    ds_read_b64_tr_b16 v[236:237], v6 offset:12288
    v_mfma_f32_16x16x32_bf16 v[72:75], v[200:203], v[144:147], v[72:75]
    ds_read_b64_tr_b16 v[238:239], v6 offset:12800
    v_mfma_f32_16x16x32_bf16 v[64:67], v[200:203], v[136:139], v[64:67]
    ds_read_b128 v[192:195], v2 offset:18432
    v_mfma_f32_16x16x32_bf16 v[64:67], v[204:207], v[140:143], v[64:67]
    ds_read_b128 v[196:199], v3 offset:18432
    v_mfma_f32_16x16x32_bf16 v[56:59], v[204:207], v[132:135], v[56:59]
    ds_read_b128 v[184:187], v4 offset:24576
    v_mfma_f32_16x16x32_bf16 v[56:59], v[200:203], v[128:131], v[56:59]
    ds_read_b128 v[188:191], v5 offset:24576
    v_mfma_f32_16x16x32_bf16 v[48:51], v[200:203], v[120:123], v[48:51]
    v_mfma_f32_16x16x32_bf16 v[48:51], v[204:207], v[124:127], v[48:51]
    s_waitcnt lgkmcnt(8)
    v_mfma_f32_16x16x32_bf16 v[52:55], v[228:231], v[124:127], v[52:55]
    ds_read_b64_tr_b16 v[200:201], v7 offset:0
    v_mfma_f32_16x16x32_bf16 v[52:55], v[224:227], v[120:123], v[52:55]
    ds_read_b64_tr_b16 v[202:203], v7 offset:512
    v_mfma_f32_16x16x32_bf16 v[60:63], v[224:227], v[128:131], v[60:63]
    ds_read_b64_tr_b16 v[204:205], v7 offset:12288
    v_mfma_f32_16x16x32_bf16 v[60:63], v[228:231], v[132:135], v[60:63]
    ds_read_b64_tr_b16 v[206:207], v7 offset:12800
    v_mfma_f32_16x16x32_bf16 v[68:71], v[228:231], v[140:143], v[68:71]
    ds_read_b128 v[176:179], v4 offset:22528
    v_mfma_f32_16x16x32_bf16 v[68:71], v[224:227], v[136:139], v[68:71]
    ds_read_b128 v[180:183], v5 offset:22528
    v_mfma_f32_16x16x32_bf16 v[76:79], v[224:227], v[144:147], v[76:79]
    ds_read_b128 v[168:171], v4 offset:20480
    v_mfma_f32_16x16x32_bf16 v[76:79], v[228:231], v[148:151], v[76:79]
    s_waitcnt lgkmcnt(11)
    v_mfma_f32_16x16x32_bf16 v[40:43], v[236:239], v[148:151], v[40:43]
    ds_read_b64_tr_b16 v[224:225], v6 offset:2048
    v_mfma_f32_16x16x32_bf16 v[40:43], v[232:235], v[144:147], v[40:43]
    ds_read_b64_tr_b16 v[226:227], v6 offset:2560
    v_mfma_f32_16x16x32_bf16 v[32:35], v[232:235], v[136:139], v[32:35]
    ds_read_b64_tr_b16 v[228:229], v6 offset:14336
    v_mfma_f32_16x16x32_bf16 v[32:35], v[236:239], v[140:143], v[32:35]
    ds_read_b64_tr_b16 v[230:231], v6 offset:14848
    v_mfma_f32_16x16x32_bf16 v[24:27], v[236:239], v[132:135], v[24:27]
    ds_read_b128 v[172:175], v5 offset:20480
    v_mfma_f32_16x16x32_bf16 v[24:27], v[232:235], v[128:131], v[24:27]
    ds_read_b128 v[160:163], v4 offset:18432
    v_mfma_f32_16x16x32_bf16 v[16:19], v[232:235], v[120:123], v[16:19]
    ds_read_b128 v[164:167], v5 offset:18432
    v_mfma_f32_16x16x32_bf16 v[16:19], v[236:239], v[124:127], v[16:19]
    s_waitcnt lgkmcnt(10)
    v_mfma_f32_16x16x32_bf16 v[20:23], v[204:207], v[124:127], v[20:23]
    ds_read_b64_tr_b16 v[232:233], v7 offset:2048
    v_mfma_f32_16x16x32_bf16 v[20:23], v[200:203], v[120:123], v[20:23]
    ds_read_b64_tr_b16 v[234:235], v7 offset:2560
    v_mfma_f32_16x16x32_bf16 v[28:31], v[200:203], v[128:131], v[28:31]
    ds_read_b64_tr_b16 v[236:237], v7 offset:14336
    v_mfma_f32_16x16x32_bf16 v[28:31], v[204:207], v[132:135], v[28:31]
    ds_read_b64_tr_b16 v[238:239], v7 offset:14848
    v_mfma_f32_16x16x32_bf16 v[36:39], v[204:207], v[140:143], v[36:39]
    buffer_load_dword v222, v220, s[68:71], s98 offen sc1
    v_mfma_f32_16x16x32_bf16 v[36:39], v[200:203], v[136:139], v[36:39]
    v_mfma_f32_16x16x32_bf16 v[44:47], v[200:203], v[144:147], v[44:47]
    v_mfma_f32_16x16x32_bf16 v[44:47], v[204:207], v[148:151], v[44:47]
    s_waitcnt lgkmcnt(7)
    v_mfma_f32_16x16x32_bf16 v[116:119], v[156:159], v[228:231], v[116:119]
    v_mfma_f32_16x16x32_bf16 v[116:119], v[152:155], v[224:227], v[116:119]
    v_mfma_f32_16x16x32_bf16 v[104:107], v[144:147], v[224:227], v[104:107]
    v_mfma_f32_16x16x32_bf16 v[104:107], v[148:151], v[228:231], v[104:107]
    v_mfma_f32_16x16x32_bf16 v[96:99], v[140:143], v[228:231], v[96:99]
    v_mfma_f32_16x16x32_bf16 v[96:99], v[136:139], v[224:227], v[96:99]
    s_waitcnt lgkmcnt(0)
    s_barrier
    v_mfma_f32_16x16x32_bf16 v[88:91], v[128:131], v[224:227], v[88:91]
    ds_read_b64_tr_b16 v[200:201], v6 offset:25600
    v_mfma_f32_16x16x32_bf16 v[88:91], v[132:135], v[228:231], v[88:91]
    ds_read_b64_tr_b16 v[202:203], v6 offset:26112
    v_mfma_f32_16x16x32_bf16 v[80:83], v[124:127], v[228:231], v[80:83]
    ds_read_b64_tr_b16 v[204:205], v6 offset:37888
    v_mfma_f32_16x16x32_bf16 v[80:83], v[120:123], v[224:227], v[80:83]
    ds_read_b64_tr_b16 v[206:207], v6 offset:38400
    v_mfma_f32_16x16x32_bf16 v[84:87], v[120:123], v[232:235], v[84:87]
    ds_read_b64_tr_b16 v[224:225], v7 offset:25600
    v_mfma_f32_16x16x32_bf16 v[84:87], v[124:127], v[236:239], v[84:87]
    ds_read_b64_tr_b16 v[226:227], v7 offset:26112
    v_mfma_f32_16x16x32_bf16 v[92:95], v[132:135], v[236:239], v[92:95]
    ds_read_b64_tr_b16 v[228:229], v7 offset:37888
    v_mfma_f32_16x16x32_bf16 v[92:95], v[128:131], v[232:235], v[92:95]
    ds_read_b64_tr_b16 v[230:231], v7 offset:38400
    v_mfma_f32_16x16x32_bf16 v[100:103], v[136:139], v[232:235], v[100:103]
    v_mfma_f32_16x16x32_bf16 v[100:103], v[140:143], v[236:239], v[100:103]
    v_mfma_f32_16x16x32_bf16 v[108:111], v[148:151], v[236:239], v[108:111]
    v_mfma_f32_16x16x32_bf16 v[108:111], v[144:147], v[232:235], v[108:111]
    s_waitcnt lgkmcnt(4)
    v_mfma_f32_16x16x32_bf16 v[112:115], v[200:203], v[192:195], v[112:115]
    ds_read_b64_tr_b16 v[232:233], v6 offset:24576
    v_mfma_f32_16x16x32_bf16 v[112:115], v[204:207], v[196:199], v[112:115]
    ds_read_b64_tr_b16 v[234:235], v6 offset:25088
    v_mfma_f32_16x16x32_bf16 v[72:75], v[204:207], v[188:191], v[72:75]
    ds_read_b64_tr_b16 v[236:237], v6 offset:36864
    v_mfma_f32_16x16x32_bf16 v[72:75], v[200:203], v[184:187], v[72:75]
    ds_read_b64_tr_b16 v[238:239], v6 offset:37376
    v_mfma_f32_16x16x32_bf16 v[64:67], v[200:203], v[176:179], v[64:67]
    ds_read_b128 v[152:155], v2 offset:36864
    v_mfma_f32_16x16x32_bf16 v[64:67], v[204:207], v[180:183], v[64:67]
    ds_read_b128 v[156:159], v3 offset:36864
    v_mfma_f32_16x16x32_bf16 v[56:59], v[204:207], v[172:175], v[56:59]
    ds_read_b128 v[144:147], v4 offset:43008
    v_mfma_f32_16x16x32_bf16 v[56:59], v[200:203], v[168:171], v[56:59]
    ds_read_b128 v[148:151], v5 offset:43008
    v_mfma_f32_16x16x32_bf16 v[48:51], v[200:203], v[160:163], v[48:51]
    v_mfma_f32_16x16x32_bf16 v[48:51], v[204:207], v[164:167], v[48:51]
    s_waitcnt lgkmcnt(8)
    v_mfma_f32_16x16x32_bf16 v[52:55], v[228:231], v[164:167], v[52:55]
    ds_read_b64_tr_b16 v[200:201], v7 offset:24576
    v_mfma_f32_16x16x32_bf16 v[52:55], v[224:227], v[160:163], v[52:55]
    ds_read_b64_tr_b16 v[202:203], v7 offset:25088
    v_mfma_f32_16x16x32_bf16 v[60:63], v[224:227], v[168:171], v[60:63]
    ds_read_b64_tr_b16 v[204:205], v7 offset:36864
    v_mfma_f32_16x16x32_bf16 v[60:63], v[228:231], v[172:175], v[60:63]
    ds_read_b64_tr_b16 v[206:207], v7 offset:37376
    v_mfma_f32_16x16x32_bf16 v[68:71], v[228:231], v[180:183], v[68:71]
    ds_read_b128 v[136:139], v4 offset:40960
    v_mfma_f32_16x16x32_bf16 v[68:71], v[224:227], v[176:179], v[68:71]
    ds_read_b128 v[140:143], v5 offset:40960
    v_mfma_f32_16x16x32_bf16 v[76:79], v[224:227], v[184:187], v[76:79]
    ds_read_b128 v[128:131], v4 offset:38912
    v_mfma_f32_16x16x32_bf16 v[76:79], v[228:231], v[188:191], v[76:79]
    s_waitcnt lgkmcnt(11)
    v_mfma_f32_16x16x32_bf16 v[40:43], v[236:239], v[188:191], v[40:43]
    ds_read_b64_tr_b16 v[224:225], v6 offset:26624
    v_mfma_f32_16x16x32_bf16 v[40:43], v[232:235], v[184:187], v[40:43]
    ds_read_b64_tr_b16 v[226:227], v6 offset:27136
    v_mfma_f32_16x16x32_bf16 v[32:35], v[232:235], v[176:179], v[32:35]
    ds_read_b64_tr_b16 v[228:229], v6 offset:38912
    v_mfma_f32_16x16x32_bf16 v[32:35], v[236:239], v[180:183], v[32:35]
    ds_read_b64_tr_b16 v[230:231], v6 offset:39424
    v_mfma_f32_16x16x32_bf16 v[24:27], v[236:239], v[172:175], v[24:27]
    ds_read_b128 v[132:135], v5 offset:38912
    v_mfma_f32_16x16x32_bf16 v[24:27], v[232:235], v[168:171], v[24:27]
    ds_read_b128 v[120:123], v4 offset:36864
    v_mfma_f32_16x16x32_bf16 v[16:19], v[232:235], v[160:163], v[16:19]
    ds_read_b128 v[124:127], v5 offset:36864
    v_mfma_f32_16x16x32_bf16 v[16:19], v[236:239], v[164:167], v[16:19]
    s_waitcnt lgkmcnt(10)
    v_mfma_f32_16x16x32_bf16 v[20:23], v[204:207], v[164:167], v[20:23]
    ds_read_b64_tr_b16 v[232:233], v7 offset:26624
    v_mfma_f32_16x16x32_bf16 v[20:23], v[200:203], v[160:163], v[20:23]
    ds_read_b64_tr_b16 v[234:235], v7 offset:27136
    v_mfma_f32_16x16x32_bf16 v[28:31], v[200:203], v[168:171], v[28:31]
    ds_read_b64_tr_b16 v[236:237], v7 offset:38912
    v_mfma_f32_16x16x32_bf16 v[28:31], v[204:207], v[172:175], v[28:31]
    ds_read_b64_tr_b16 v[238:239], v7 offset:39424
    v_mfma_f32_16x16x32_bf16 v[36:39], v[204:207], v[180:183], v[36:39]
    v_mfma_f32_16x16x32_bf16 v[36:39], v[200:203], v[176:179], v[36:39]
    v_mfma_f32_16x16x32_bf16 v[44:47], v[200:203], v[184:187], v[44:47]
    v_mfma_f32_16x16x32_bf16 v[44:47], v[204:207], v[188:191], v[44:47]
    s_waitcnt lgkmcnt(7)
    v_mfma_f32_16x16x32_bf16 v[116:119], v[196:199], v[228:231], v[116:119]
    v_mfma_f32_16x16x32_bf16 v[116:119], v[192:195], v[224:227], v[116:119]
    v_mfma_f32_16x16x32_bf16 v[104:107], v[184:187], v[224:227], v[104:107]
    v_mfma_f32_16x16x32_bf16 v[104:107], v[188:191], v[228:231], v[104:107]
    v_mfma_f32_16x16x32_bf16 v[96:99], v[180:183], v[228:231], v[96:99]
    v_mfma_f32_16x16x32_bf16 v[96:99], v[176:179], v[224:227], v[96:99]
    s_waitcnt lgkmcnt(0)
    s_barrier
    v_mfma_f32_16x16x32_bf16 v[88:91], v[168:171], v[224:227], v[88:91]
    ds_read_b64_tr_b16 v[200:201], v6 offset:50176
    v_mfma_f32_16x16x32_bf16 v[88:91], v[172:175], v[228:231], v[88:91]
    ds_read_b64_tr_b16 v[202:203], v6 offset:50688
    v_mfma_f32_16x16x32_bf16 v[80:83], v[164:167], v[228:231], v[80:83]
    ds_read_b64_tr_b16 v[204:205], v6 offset:62464
    v_mfma_f32_16x16x32_bf16 v[80:83], v[160:163], v[224:227], v[80:83]
    ds_read_b64_tr_b16 v[206:207], v6 offset:62976
    v_mfma_f32_16x16x32_bf16 v[84:87], v[160:163], v[232:235], v[84:87]
    ds_read_b64_tr_b16 v[224:225], v7 offset:50176
    v_mfma_f32_16x16x32_bf16 v[84:87], v[164:167], v[236:239], v[84:87]
    ds_read_b64_tr_b16 v[226:227], v7 offset:50688
    v_mfma_f32_16x16x32_bf16 v[92:95], v[172:175], v[236:239], v[92:95]
    ds_read_b64_tr_b16 v[228:229], v7 offset:62464
    v_mfma_f32_16x16x32_bf16 v[92:95], v[168:171], v[232:235], v[92:95]
    ds_read_b64_tr_b16 v[230:231], v7 offset:62976
    v_mfma_f32_16x16x32_bf16 v[100:103], v[176:179], v[232:235], v[100:103]
    v_mfma_f32_16x16x32_bf16 v[100:103], v[180:183], v[236:239], v[100:103]
    v_mfma_f32_16x16x32_bf16 v[108:111], v[188:191], v[236:239], v[108:111]
    v_mfma_f32_16x16x32_bf16 v[108:111], v[184:187], v[232:235], v[108:111]
    s_waitcnt lgkmcnt(4)
    v_mfma_f32_16x16x32_bf16 v[112:115], v[200:203], v[152:155], v[112:115]
    ds_read_b64_tr_b16 v[232:233], v6 offset:49152
    v_mfma_f32_16x16x32_bf16 v[112:115], v[204:207], v[156:159], v[112:115]
    ds_read_b64_tr_b16 v[234:235], v6 offset:49664
    v_mfma_f32_16x16x32_bf16 v[72:75], v[204:207], v[148:151], v[72:75]
    ds_read_b64_tr_b16 v[236:237], v6 offset:61440
    v_mfma_f32_16x16x32_bf16 v[72:75], v[200:203], v[144:147], v[72:75]
    ds_read_b64_tr_b16 v[238:239], v6 offset:61952
    v_mfma_f32_16x16x32_bf16 v[64:67], v[200:203], v[136:139], v[64:67]
    ds_read_b128 v[192:195], v2 offset:0
    v_mfma_f32_16x16x32_bf16 v[64:67], v[204:207], v[140:143], v[64:67]
    ds_read_b128 v[196:199], v3 offset:0
    v_mfma_f32_16x16x32_bf16 v[56:59], v[204:207], v[132:135], v[56:59]
    ds_read_b128 v[184:187], v4 offset:6144
    v_mfma_f32_16x16x32_bf16 v[56:59], v[200:203], v[128:131], v[56:59]
    ds_read_b128 v[188:191], v5 offset:6144
    v_mfma_f32_16x16x32_bf16 v[48:51], v[200:203], v[120:123], v[48:51]
    v_mfma_f32_16x16x32_bf16 v[48:51], v[204:207], v[124:127], v[48:51]
    s_waitcnt lgkmcnt(8)
    v_mfma_f32_16x16x32_bf16 v[52:55], v[228:231], v[124:127], v[52:55]
    ds_read_b64_tr_b16 v[200:201], v7 offset:49152
    v_mfma_f32_16x16x32_bf16 v[52:55], v[224:227], v[120:123], v[52:55]
    ds_read_b64_tr_b16 v[202:203], v7 offset:49664
    v_mfma_f32_16x16x32_bf16 v[60:63], v[224:227], v[128:131], v[60:63]
    ds_read_b64_tr_b16 v[204:205], v7 offset:61440
    v_mfma_f32_16x16x32_bf16 v[60:63], v[228:231], v[132:135], v[60:63]
    ds_read_b64_tr_b16 v[206:207], v7 offset:61952
    v_mfma_f32_16x16x32_bf16 v[68:71], v[228:231], v[140:143], v[68:71]
    ds_read_b128 v[176:179], v4 offset:4096
    v_mfma_f32_16x16x32_bf16 v[68:71], v[224:227], v[136:139], v[68:71]
    ds_read_b128 v[180:183], v5 offset:4096
    v_mfma_f32_16x16x32_bf16 v[76:79], v[224:227], v[144:147], v[76:79]
    ds_read_b128 v[168:171], v4 offset:2048
    v_mfma_f32_16x16x32_bf16 v[76:79], v[228:231], v[148:151], v[76:79]
    s_waitcnt lgkmcnt(11)
    v_mfma_f32_16x16x32_bf16 v[40:43], v[236:239], v[148:151], v[40:43]
    ds_read_b64_tr_b16 v[224:225], v6 offset:51200
    v_mfma_f32_16x16x32_bf16 v[40:43], v[232:235], v[144:147], v[40:43]
    ds_read_b64_tr_b16 v[226:227], v6 offset:51712
    v_mfma_f32_16x16x32_bf16 v[32:35], v[232:235], v[136:139], v[32:35]
    ds_read_b64_tr_b16 v[228:229], v6 offset:63488
    v_mfma_f32_16x16x32_bf16 v[32:35], v[236:239], v[140:143], v[32:35]
    ds_read_b64_tr_b16 v[230:231], v6 offset:64000
    v_mfma_f32_16x16x32_bf16 v[24:27], v[236:239], v[132:135], v[24:27]
    ds_read_b128 v[172:175], v5 offset:2048
    v_mfma_f32_16x16x32_bf16 v[24:27], v[232:235], v[128:131], v[24:27]
    ds_read_b128 v[160:163], v4 offset:0
    v_mfma_f32_16x16x32_bf16 v[16:19], v[232:235], v[120:123], v[16:19]
    ds_read_b128 v[164:167], v5 offset:0
    v_mfma_f32_16x16x32_bf16 v[16:19], v[236:239], v[124:127], v[16:19]
    s_waitcnt lgkmcnt(10)
    v_mfma_f32_16x16x32_bf16 v[20:23], v[204:207], v[124:127], v[20:23]
    ds_read_b64_tr_b16 v[232:233], v7 offset:51200
    v_mfma_f32_16x16x32_bf16 v[20:23], v[200:203], v[120:123], v[20:23]
    ds_read_b64_tr_b16 v[234:235], v7 offset:51712
    v_mfma_f32_16x16x32_bf16 v[28:31], v[200:203], v[128:131], v[28:31]
    ds_read_b64_tr_b16 v[236:237], v7 offset:63488
    v_mfma_f32_16x16x32_bf16 v[28:31], v[204:207], v[132:135], v[28:31]
    ds_read_b64_tr_b16 v[238:239], v7 offset:64000
    v_mfma_f32_16x16x32_bf16 v[36:39], v[204:207], v[140:143], v[36:39]
    v_mfma_f32_16x16x32_bf16 v[36:39], v[200:203], v[136:139], v[36:39]
    v_mfma_f32_16x16x32_bf16 v[44:47], v[200:203], v[144:147], v[44:47]
    v_mfma_f32_16x16x32_bf16 v[44:47], v[204:207], v[148:151], v[44:47]
    s_waitcnt lgkmcnt(7)
    v_mfma_f32_16x16x32_bf16 v[116:119], v[156:159], v[228:231], v[116:119]
    v_mfma_f32_16x16x32_bf16 v[116:119], v[152:155], v[224:227], v[116:119]
    v_mfma_f32_16x16x32_bf16 v[104:107], v[144:147], v[224:227], v[104:107]
    v_mfma_f32_16x16x32_bf16 v[104:107], v[148:151], v[228:231], v[104:107]
    v_mfma_f32_16x16x32_bf16 v[96:99], v[140:143], v[228:231], v[96:99]
    v_mfma_f32_16x16x32_bf16 v[96:99], v[136:139], v[224:227], v[96:99]
    s_waitcnt lgkmcnt(0)
    s_barrier
    s_cmp_lg_u32 s3, 0
    s_cbranch_scc1 LB_sk
    s_waitcnt vmcnt(0)
    v_cmp_eq_u32 vcc, 0, v222
    s_cbranch_vccnz LB_slow
LB_back:
    s_mov_b64 exec, 1
    buffer_store_dword v222, v220, s[52:55], s96 offen sc1
    s_mov_b64 exec, -1
LB_sk:
    v_mfma_f32_16x16x32_bf16 v[88:91], v[128:131], v[224:227], v[88:91]
    ds_read_b64_tr_b16 v[200:201], v6 offset:1024
    v_mfma_f32_16x16x32_bf16 v[88:91], v[132:135], v[228:231], v[88:91]
    ds_read_b64_tr_b16 v[202:203], v6 offset:1536
    v_mfma_f32_16x16x32_bf16 v[80:83], v[124:127], v[228:231], v[80:83]
    ds_read_b64_tr_b16 v[204:205], v6 offset:13312
    v_mfma_f32_16x16x32_bf16 v[80:83], v[120:123], v[224:227], v[80:83]
    ds_read_b64_tr_b16 v[206:207], v6 offset:13824
    v_mfma_f32_16x16x32_bf16 v[84:87], v[120:123], v[232:235], v[84:87]
    ds_read_b64_tr_b16 v[224:225], v7 offset:1024
    v_mfma_f32_16x16x32_bf16 v[84:87], v[124:127], v[236:239], v[84:87]
    ds_read_b64_tr_b16 v[226:227], v7 offset:1536
    v_mfma_f32_16x16x32_bf16 v[92:95], v[132:135], v[236:239], v[92:95]
    ds_read_b64_tr_b16 v[228:229], v7 offset:13312
    v_mfma_f32_16x16x32_bf16 v[92:95], v[128:131], v[232:235], v[92:95]
    ds_read_b64_tr_b16 v[230:231], v7 offset:13824
    v_mfma_f32_16x16x32_bf16 v[100:103], v[136:139], v[232:235], v[100:103]
    v_mfma_f32_16x16x32_bf16 v[100:103], v[140:143], v[236:239], v[100:103]
    v_mfma_f32_16x16x32_bf16 v[108:111], v[148:151], v[236:239], v[108:111]
    v_mfma_f32_16x16x32_bf16 v[108:111], v[144:147], v[232:235], v[108:111]
    s_waitcnt lgkmcnt(4)
    v_mfma_f32_16x16x32_bf16 v[112:115], v[200:203], v[192:195], v[112:115]
    ds_read_b64_tr_b16 v[232:233], v6 offset:0
    v_mfma_f32_16x16x32_bf16 v[112:115], v[204:207], v[196:199], v[112:115]
    ds_read_b64_tr_b16 v[234:235], v6 offset:512
    v_mfma_f32_16x16x32_bf16 v[72:75], v[204:207], v[188:191], v[72:75]
    ds_read_b64_tr_b16 v[236:237], v6 offset:12288
    v_mfma_f32_16x16x32_bf16 v[72:75], v[200:203], v[184:187], v[72:75]
    ds_read_b64_tr_b16 v[238:239], v6 offset:12800
    v_mfma_f32_16x16x32_bf16 v[64:67], v[200:203], v[176:179], v[64:67]
    ds_read_b128 v[152:155], v2 offset:18432
    v_mfma_f32_16x16x32_bf16 v[64:67], v[204:207], v[180:183], v[64:67]
    ds_read_b128 v[156:159], v3 offset:18432
    v_mfma_f32_16x16x32_bf16 v[56:59], v[204:207], v[172:175], v[56:59]
    ds_read_b128 v[144:147], v4 offset:24576
    v_mfma_f32_16x16x32_bf16 v[56:59], v[200:203], v[168:171], v[56:59]
    ds_read_b128 v[148:151], v5 offset:24576
    v_mfma_f32_16x16x32_bf16 v[48:51], v[200:203], v[160:163], v[48:51]
    v_mfma_f32_16x16x32_bf16 v[48:51], v[204:207], v[164:167], v[48:51]
    s_waitcnt lgkmcnt(8)
    v_mfma_f32_16x16x32_bf16 v[52:55], v[228:231], v[164:167], v[52:55]
    ds_read_b64_tr_b16 v[200:201], v7 offset:0
    v_mfma_f32_16x16x32_bf16 v[52:55], v[224:227], v[160:163], v[52:55]
    ds_read_b64_tr_b16 v[202:203], v7 offset:512
    v_mfma_f32_16x16x32_bf16 v[60:63], v[224:227], v[168:171], v[60:63]
    ds_read_b64_tr_b16 v[204:205], v7 offset:12288
    v_mfma_f32_16x16x32_bf16 v[60:63], v[228:231], v[172:175], v[60:63]
    ds_read_b64_tr_b16 v[206:207], v7 offset:12800
    v_mfma_f32_16x16x32_bf16 v[68:71], v[228:231], v[180:183], v[68:71]
    ds_read_b128 v[136:139], v4 offset:22528
    v_mfma_f32_16x16x32_bf16 v[68:71], v[224:227], v[176:179], v[68:71]
    ds_read_b128 v[140:143], v5 offset:22528
    v_mfma_f32_16x16x32_bf16 v[76:79], v[224:227], v[184:187], v[76:79]
    ds_read_b128 v[128:131], v4 offset:20480
    v_mfma_f32_16x16x32_bf16 v[76:79], v[228:231], v[188:191], v[76:79]
    s_waitcnt lgkmcnt(11)
    v_mfma_f32_16x16x32_bf16 v[40:43], v[236:239], v[188:191], v[40:43]
    ds_read_b64_tr_b16 v[224:225], v6 offset:2048
    v_mfma_f32_16x16x32_bf16 v[40:43], v[232:235], v[184:187], v[40:43]
    ds_read_b64_tr_b16 v[226:227], v6 offset:2560
    v_mfma_f32_16x16x32_bf16 v[32:35], v[232:235], v[176:179], v[32:35]
    ds_read_b64_tr_b16 v[228:229], v6 offset:14336
    v_mfma_f32_16x16x32_bf16 v[32:35], v[236:239], v[180:183], v[32:35]
    ds_read_b64_tr_b16 v[230:231], v6 offset:14848
    v_mfma_f32_16x16x32_bf16 v[24:27], v[236:239], v[172:175], v[24:27]
    ds_read_b128 v[132:135], v5 offset:20480
    v_mfma_f32_16x16x32_bf16 v[24:27], v[232:235], v[168:171], v[24:27]
    ds_read_b128 v[120:123], v4 offset:18432
    v_mfma_f32_16x16x32_bf16 v[16:19], v[232:235], v[160:163], v[16:19]
    ds_read_b128 v[124:127], v5 offset:18432
    v_mfma_f32_16x16x32_bf16 v[16:19], v[236:239], v[164:167], v[16:19]
    s_waitcnt lgkmcnt(10)
    v_mfma_f32_16x16x32_bf16 v[20:23], v[204:207], v[164:167], v[20:23]
    ds_read_b64_tr_b16 v[232:233], v7 offset:2048
    v_mfma_f32_16x16x32_bf16 v[20:23], v[200:203], v[160:163], v[20:23]
    ds_read_b64_tr_b16 v[234:235], v7 offset:2560
    v_mfma_f32_16x16x32_bf16 v[28:31], v[200:203], v[168:171], v[28:31]
    ds_read_b64_tr_b16 v[236:237], v7 offset:14336
    v_mfma_f32_16x16x32_bf16 v[28:31], v[204:207], v[172:175], v[28:31]
    ds_read_b64_tr_b16 v[238:239], v7 offset:14848
    v_mfma_f32_16x16x32_bf16 v[36:39], v[204:207], v[180:183], v[36:39]
    v_mfma_f32_16x16x32_bf16 v[36:39], v[200:203], v[176:179], v[36:39]
    v_mfma_f32_16x16x32_bf16 v[44:47], v[200:203], v[184:187], v[44:47]
    v_mfma_f32_16x16x32_bf16 v[44:47], v[204:207], v[188:191], v[44:47]
    s_waitcnt lgkmcnt(7)
    v_mfma_f32_16x16x32_bf16 v[116:119], v[196:199], v[228:231], v[116:119]
    v_mfma_f32_16x16x32_bf16 v[116:119], v[192:195], v[224:227], v[116:119]
    v_mfma_f32_16x16x32_bf16 v[104:107], v[184:187], v[224:227], v[104:107]
    v_mfma_f32_16x16x32_bf16 v[104:107], v[188:191], v[228:231], v[104:107]
    v_mfma_f32_16x16x32_bf16 v[96:99], v[180:183], v[228:231], v[96:99]
    v_mfma_f32_16x16x32_bf16 v[96:99], v[176:179], v[224:227], v[96:99]
    s_waitcnt lgkmcnt(0)
    s_barrier
    v_mfma_f32_16x16x32_bf16 v[88:91], v[168:171], v[224:227], v[88:91]
    ds_read_b64_tr_b16 v[200:201], v6 offset:25600
    v_mfma_f32_16x16x32_bf16 v[88:91], v[172:175], v[228:231], v[88:91]
    ds_read_b64_tr_b16 v[202:203], v6 offset:26112
    v_mfma_f32_16x16x32_bf16 v[80:83], v[164:167], v[228:231], v[80:83]
    ds_read_b64_tr_b16 v[204:205], v6 offset:37888
    v_mfma_f32_16x16x32_bf16 v[80:83], v[160:163], v[224:227], v[80:83]
    ds_read_b64_tr_b16 v[206:207], v6 offset:38400
    v_mfma_f32_16x16x32_bf16 v[84:87], v[160:163], v[232:235], v[84:87]
    ds_read_b64_tr_b16 v[224:225], v7 offset:25600
    v_mfma_f32_16x16x32_bf16 v[84:87], v[164:167], v[236:239], v[84:87]
    ds_read_b64_tr_b16 v[226:227], v7 offset:26112
    v_mfma_f32_16x16x32_bf16 v[92:95], v[172:175], v[236:239], v[92:95]
    ds_read_b64_tr_b16 v[228:229], v7 offset:37888
    v_mfma_f32_16x16x32_bf16 v[92:95], v[168:171], v[232:235], v[92:95]
    ds_read_b64_tr_b16 v[230:231], v7 offset:38400
    v_mfma_f32_16x16x32_bf16 v[100:103], v[176:179], v[232:235], v[100:103]
    v_mfma_f32_16x16x32_bf16 v[100:103], v[180:183], v[236:239], v[100:103]
    v_mfma_f32_16x16x32_bf16 v[108:111], v[188:191], v[236:239], v[108:111]
    v_mfma_f32_16x16x32_bf16 v[108:111], v[184:187], v[232:235], v[108:111]
    s_waitcnt lgkmcnt(4)
    v_mfma_f32_16x16x32_bf16 v[112:115], v[200:203], v[152:155], v[112:115]
    ds_read_b64_tr_b16 v[232:233], v6 offset:24576
    v_mfma_f32_16x16x32_bf16 v[112:115], v[204:207], v[156:159], v[112:115]
    ds_read_b64_tr_b16 v[234:235], v6 offset:25088
    v_mfma_f32_16x16x32_bf16 v[72:75], v[204:207], v[148:151], v[72:75]
    ds_read_b64_tr_b16 v[236:237], v6 offset:36864
    v_mfma_f32_16x16x32_bf16 v[72:75], v[200:203], v[144:147], v[72:75]
    ds_read_b64_tr_b16 v[238:239], v6 offset:37376
    v_mfma_f32_16x16x32_bf16 v[64:67], v[200:203], v[136:139], v[64:67]
    ds_read_b128 v[192:195], v2 offset:36864
    v_mfma_f32_16x16x32_bf16 v[64:67], v[204:207], v[140:143], v[64:67]
    ds_read_b128 v[196:199], v3 offset:36864
    v_mfma_f32_16x16x32_bf16 v[56:59], v[204:207], v[132:135], v[56:59]
    ds_read_b128 v[184:187], v4 offset:43008
    v_mfma_f32_16x16x32_bf16 v[56:59], v[200:203], v[128:131], v[56:59]
    ds_read_b128 v[188:191], v5 offset:43008
    v_mfma_f32_16x16x32_bf16 v[48:51], v[200:203], v[120:123], v[48:51]
    v_mfma_f32_16x16x32_bf16 v[48:51], v[204:207], v[124:127], v[48:51]
    s_waitcnt lgkmcnt(8)
    v_mfma_f32_16x16x32_bf16 v[52:55], v[228:231], v[124:127], v[52:55]
    ds_read_b64_tr_b16 v[200:201], v7 offset:24576
    v_mfma_f32_16x16x32_bf16 v[52:55], v[224:227], v[120:123], v[52:55]
    ds_read_b64_tr_b16 v[202:203], v7 offset:25088
    v_mfma_f32_16x16x32_bf16 v[60:63], v[224:227], v[128:131], v[60:63]
    ds_read_b64_tr_b16 v[204:205], v7 offset:36864
    v_mfma_f32_16x16x32_bf16 v[60:63], v[228:231], v[132:135], v[60:63]
    ds_read_b64_tr_b16 v[206:207], v7 offset:37376
    v_mfma_f32_16x16x32_bf16 v[68:71], v[228:231], v[140:143], v[68:71]
    ds_read_b128 v[176:179], v4 offset:40960
    v_mfma_f32_16x16x32_bf16 v[68:71], v[224:227], v[136:139], v[68:71]
    ds_read_b128 v[180:183], v5 offset:40960
    v_mfma_f32_16x16x32_bf16 v[76:79], v[224:227], v[144:147], v[76:79]
    ds_read_b128 v[168:171], v4 offset:38912
    v_mfma_f32_16x16x32_bf16 v[76:79], v[228:231], v[148:151], v[76:79]
    s_waitcnt lgkmcnt(11)
    v_mfma_f32_16x16x32_bf16 v[40:43], v[236:239], v[148:151], v[40:43]
    ds_read_b64_tr_b16 v[224:225], v6 offset:26624
    v_mfma_f32_16x16x32_bf16 v[40:43], v[232:235], v[144:147], v[40:43]
    ds_read_b64_tr_b16 v[226:227], v6 offset:27136
    v_mfma_f32_16x16x32_bf16 v[32:35], v[232:235], v[136:139], v[32:35]
    ds_read_b64_tr_b16 v[228:229], v6 offset:38912
    v_mfma_f32_16x16x32_bf16 v[32:35], v[236:239], v[140:143], v[32:35]
    ds_read_b64_tr_b16 v[230:231], v6 offset:39424
    v_mfma_f32_16x16x32_bf16 v[24:27], v[236:239], v[132:135], v[24:27]
    ds_read_b128 v[172:175], v5 offset:38912
    v_mfma_f32_16x16x32_bf16 v[24:27], v[232:235], v[128:131], v[24:27]
    ds_read_b128 v[160:163], v4 offset:36864
    v_mfma_f32_16x16x32_bf16 v[16:19], v[232:235], v[120:123], v[16:19]
    ds_read_b128 v[164:167], v5 offset:36864
    v_mfma_f32_16x16x32_bf16 v[16:19], v[236:239], v[124:127], v[16:19]
    s_waitcnt lgkmcnt(10)
    v_mfma_f32_16x16x32_bf16 v[20:23], v[204:207], v[124:127], v[20:23]
    ds_read_b64_tr_b16 v[232:233], v7 offset:26624
    v_mfma_f32_16x16x32_bf16 v[20:23], v[200:203], v[120:123], v[20:23]
    ds_read_b64_tr_b16 v[234:235], v7 offset:27136
    v_mfma_f32_16x16x32_bf16 v[28:31], v[200:203], v[128:131], v[28:31]
    ds_read_b64_tr_b16 v[236:237], v7 offset:38912
    v_mfma_f32_16x16x32_bf16 v[28:31], v[204:207], v[132:135], v[28:31]
    ds_read_b64_tr_b16 v[238:239], v7 offset:39424
    v_mfma_f32_16x16x32_bf16 v[36:39], v[204:207], v[140:143], v[36:39]
    v_mfma_f32_16x16x32_bf16 v[36:39], v[200:203], v[136:139], v[36:39]
    v_mfma_f32_16x16x32_bf16 v[44:47], v[200:203], v[144:147], v[44:47]
    v_mfma_f32_16x16x32_bf16 v[44:47], v[204:207], v[148:151], v[44:47]
    s_waitcnt lgkmcnt(7)
    v_mfma_f32_16x16x32_bf16 v[116:119], v[156:159], v[228:231], v[116:119]
    v_mfma_f32_16x16x32_bf16 v[116:119], v[152:155], v[224:227], v[116:119]
    v_mfma_f32_16x16x32_bf16 v[104:107], v[144:147], v[224:227], v[104:107]
    v_mfma_f32_16x16x32_bf16 v[104:107], v[148:151], v[228:231], v[104:107]
    v_mfma_f32_16x16x32_bf16 v[96:99], v[140:143], v[228:231], v[96:99]
    v_mfma_f32_16x16x32_bf16 v[96:99], v[136:139], v[224:227], v[96:99]
    s_waitcnt lgkmcnt(0)
    s_barrier
    v_mfma_f32_16x16x32_bf16 v[88:91], v[128:131], v[224:227], v[88:91]
    ds_read_b64_tr_b16 v[200:201], v6 offset:50176
    v_mfma_f32_16x16x32_bf16 v[88:91], v[132:135], v[228:231], v[88:91]
    ds_read_b64_tr_b16 v[202:203], v6 offset:50688
    v_mfma_f32_16x16x32_bf16 v[80:83], v[124:127], v[228:231], v[80:83]
    ds_read_b64_tr_b16 v[204:205], v6 offset:62464
    v_mfma_f32_16x16x32_bf16 v[80:83], v[120:123], v[224:227], v[80:83]
    ds_read_b64_tr_b16 v[206:207], v6 offset:62976
    v_mfma_f32_16x16x32_bf16 v[84:87], v[120:123], v[232:235], v[84:87]
    ds_read_b64_tr_b16 v[224:225], v7 offset:50176
    v_mfma_f32_16x16x32_bf16 v[84:87], v[124:127], v[236:239], v[84:87]
    ds_read_b64_tr_b16 v[226:227], v7 offset:50688
    v_mfma_f32_16x16x32_bf16 v[92:95], v[132:135], v[236:239], v[92:95]
    ds_read_b64_tr_b16 v[228:229], v7 offset:62464
    v_mfma_f32_16x16x32_bf16 v[92:95], v[128:131], v[232:235], v[92:95]
    ds_read_b64_tr_b16 v[230:231], v7 offset:62976
    v_mfma_f32_16x16x32_bf16 v[100:103], v[136:139], v[232:235], v[100:103]
    v_mfma_f32_16x16x32_bf16 v[100:103], v[140:143], v[236:239], v[100:103]
    v_mfma_f32_16x16x32_bf16 v[108:111], v[148:151], v[236:239], v[108:111]
    v_mfma_f32_16x16x32_bf16 v[108:111], v[144:147], v[232:235], v[108:111]
    s_waitcnt lgkmcnt(4)
    v_mfma_f32_16x16x32_bf16 v[112:115], v[200:203], v[192:195], v[112:115]
    ds_read_b64_tr_b16 v[232:233], v6 offset:49152
    v_mfma_f32_16x16x32_bf16 v[112:115], v[204:207], v[196:199], v[112:115]
    ds_read_b64_tr_b16 v[234:235], v6 offset:49664
    v_mfma_f32_16x16x32_bf16 v[72:75], v[204:207], v[188:191], v[72:75]
    ds_read_b64_tr_b16 v[236:237], v6 offset:61440
    v_mfma_f32_16x16x32_bf16 v[72:75], v[200:203], v[184:187], v[72:75]
    ds_read_b64_tr_b16 v[238:239], v6 offset:61952
    v_mfma_f32_16x16x32_bf16 v[64:67], v[200:203], v[176:179], v[64:67]
    ds_read_b128 v[152:155], v2 offset:0
    v_mfma_f32_16x16x32_bf16 v[64:67], v[204:207], v[180:183], v[64:67]
    ds_read_b128 v[156:159], v3 offset:0
    v_mfma_f32_16x16x32_bf16 v[56:59], v[204:207], v[172:175], v[56:59]
    ds_read_b128 v[144:147], v4 offset:6144
    v_mfma_f32_16x16x32_bf16 v[56:59], v[200:203], v[168:171], v[56:59]
    ds_read_b128 v[148:151], v5 offset:6144
    v_mfma_f32_16x16x32_bf16 v[48:51], v[200:203], v[160:163], v[48:51]
    v_mfma_f32_16x16x32_bf16 v[48:51], v[204:207], v[164:167], v[48:51]
    s_waitcnt lgkmcnt(8)
    v_mfma_f32_16x16x32_bf16 v[52:55], v[228:231], v[164:167], v[52:55]
    ds_read_b64_tr_b16 v[200:201], v7 offset:49152
    v_mfma_f32_16x16x32_bf16 v[52:55], v[224:227], v[160:163], v[52:55]
    ds_read_b64_tr_b16 v[202:203], v7 offset:49664
    v_mfma_f32_16x16x32_bf16 v[60:63], v[224:227], v[168:171], v[60:63]
    ds_read_b64_tr_b16 v[204:205], v7 offset:61440
    v_mfma_f32_16x16x32_bf16 v[60:63], v[228:231], v[172:175], v[60:63]
    ds_read_b64_tr_b16 v[206:207], v7 offset:61952
    v_mfma_f32_16x16x32_bf16 v[68:71], v[228:231], v[180:183], v[68:71]
    ds_read_b128 v[136:139], v4 offset:4096
    v_mfma_f32_16x16x32_bf16 v[68:71], v[224:227], v[176:179], v[68:71]
    ds_read_b128 v[140:143], v5 offset:4096
    v_mfma_f32_16x16x32_bf16 v[76:79], v[224:227], v[184:187], v[76:79]
    ds_read_b128 v[128:131], v4 offset:2048
    v_mfma_f32_16x16x32_bf16 v[76:79], v[228:231], v[188:191], v[76:79]
    s_waitcnt lgkmcnt(11)
    v_mfma_f32_16x16x32_bf16 v[40:43], v[236:239], v[188:191], v[40:43]
    ds_read_b64_tr_b16 v[224:225], v6 offset:51200
    v_mfma_f32_16x16x32_bf16 v[40:43], v[232:235], v[184:187], v[40:43]
    ds_read_b64_tr_b16 v[226:227], v6 offset:51712
    v_mfma_f32_16x16x32_bf16 v[32:35], v[232:235], v[176:179], v[32:35]
    ds_read_b64_tr_b16 v[228:229], v6 offset:63488
    v_mfma_f32_16x16x32_bf16 v[32:35], v[236:239], v[180:183], v[32:35]
    ds_read_b64_tr_b16 v[230:231], v6 offset:64000
    v_mfma_f32_16x16x32_bf16 v[24:27], v[236:239], v[172:175], v[24:27]
    ds_read_b128 v[132:135], v5 offset:2048
    v_mfma_f32_16x16x32_bf16 v[24:27], v[232:235], v[168:171], v[24:27]
    ds_read_b128 v[120:123], v4 offset:0
    v_mfma_f32_16x16x32_bf16 v[16:19], v[232:235], v[160:163], v[16:19]
    ds_read_b128 v[124:127], v5 offset:0
    v_mfma_f32_16x16x32_bf16 v[16:19], v[236:239], v[164:167], v[16:19]
    s_waitcnt lgkmcnt(10)
    v_mfma_f32_16x16x32_bf16 v[20:23], v[204:207], v[164:167], v[20:23]
    ds_read_b64_tr_b16 v[232:233], v7 offset:51200
    v_mfma_f32_16x16x32_bf16 v[20:23], v[200:203], v[160:163], v[20:23]
    ds_read_b64_tr_b16 v[234:235], v7 offset:51712
    v_mfma_f32_16x16x32_bf16 v[28:31], v[200:203], v[168:171], v[28:31]
    ds_read_b64_tr_b16 v[236:237], v7 offset:63488
    v_mfma_f32_16x16x32_bf16 v[28:31], v[204:207], v[172:175], v[28:31]
    ds_read_b64_tr_b16 v[238:239], v7 offset:64000
    v_mfma_f32_16x16x32_bf16 v[36:39], v[204:207], v[180:183], v[36:39]
    v_mfma_f32_16x16x32_bf16 v[36:39], v[200:203], v[176:179], v[36:39]
    v_mfma_f32_16x16x32_bf16 v[44:47], v[200:203], v[184:187], v[44:47]
    v_mfma_f32_16x16x32_bf16 v[44:47], v[204:207], v[188:191], v[44:47]
    s_waitcnt lgkmcnt(7)
    v_mfma_f32_16x16x32_bf16 v[116:119], v[196:199], v[228:231], v[116:119]
    v_mfma_f32_16x16x32_bf16 v[116:119], v[192:195], v[224:227], v[116:119]
    v_mfma_f32_16x16x32_bf16 v[104:107], v[184:187], v[224:227], v[104:107]
    v_mfma_f32_16x16x32_bf16 v[104:107], v[188:191], v[228:231], v[104:107]
    v_mfma_f32_16x16x32_bf16 v[96:99], v[180:183], v[228:231], v[96:99]
    v_mfma_f32_16x16x32_bf16 v[96:99], v[176:179], v[224:227], v[96:99]
    s_waitcnt lgkmcnt(0)
    s_barrier
    v_mfma_f32_16x16x32_bf16 v[88:91], v[168:171], v[224:227], v[88:91]
    ds_read_b64_tr_b16 v[200:201], v6 offset:1024
    v_mfma_f32_16x16x32_bf16 v[88:91], v[172:175], v[228:231], v[88:91]
    ds_read_b64_tr_b16 v[202:203], v6 offset:1536
    v_mfma_f32_16x16x32_bf16 v[80:83], v[164:167], v[228:231], v[80:83]
    ds_read_b64_tr_b16 v[204:205], v6 offset:13312
    v_mfma_f32_16x16x32_bf16 v[80:83], v[160:163], v[224:227], v[80:83]
    ds_read_b64_tr_b16 v[206:207], v6 offset:13824
    v_mfma_f32_16x16x32_bf16 v[84:87], v[160:163], v[232:235], v[84:87]
    ds_read_b64_tr_b16 v[224:225], v7 offset:1024
    v_mfma_f32_16x16x32_bf16 v[84:87], v[164:167], v[236:239], v[84:87]
    ds_read_b64_tr_b16 v[226:227], v7 offset:1536
    v_mfma_f32_16x16x32_bf16 v[92:95], v[172:175], v[236:239], v[92:95]
    ds_read_b64_tr_b16 v[228:229], v7 offset:13312
    v_mfma_f32_16x16x32_bf16 v[92:95], v[168:171], v[232:235], v[92:95]
    ds_read_b64_tr_b16 v[230:231], v7 offset:13824
    v_mfma_f32_16x16x32_bf16 v[100:103], v[176:179], v[232:235], v[100:103]
    v_mfma_f32_16x16x32_bf16 v[100:103], v[180:183], v[236:239], v[100:103]
    v_mfma_f32_16x16x32_bf16 v[108:111], v[188:191], v[236:239], v[108:111]
    v_mfma_f32_16x16x32_bf16 v[108:111], v[184:187], v[232:235], v[108:111]
    s_waitcnt lgkmcnt(4)
    v_mfma_f32_16x16x32_bf16 v[112:115], v[200:203], v[152:155], v[112:115]
    ds_read_b64_tr_b16 v[232:233], v6 offset:0
    v_mfma_f32_16x16x32_bf16 v[112:115], v[204:207], v[156:159], v[112:115]
    ds_read_b64_tr_b16 v[234:235], v6 offset:512
    v_mfma_f32_16x16x32_bf16 v[72:75], v[204:207], v[148:151], v[72:75]
    ds_read_b64_tr_b16 v[236:237], v6 offset:12288
    v_mfma_f32_16x16x32_bf16 v[72:75], v[200:203], v[144:147], v[72:75]
    ds_read_b64_tr_b16 v[238:239], v6 offset:12800
    v_mfma_f32_16x16x32_bf16 v[64:67], v[200:203], v[136:139], v[64:67]
    ds_read_b128 v[192:195], v2 offset:18432
    v_mfma_f32_16x16x32_bf16 v[64:67], v[204:207], v[140:143], v[64:67]
    ds_read_b128 v[196:199], v3 offset:18432
    v_mfma_f32_16x16x32_bf16 v[56:59], v[204:207], v[132:135], v[56:59]
    ds_read_b128 v[184:187], v4 offset:24576
    v_mfma_f32_16x16x32_bf16 v[56:59], v[200:203], v[128:131], v[56:59]
    ds_read_b128 v[188:191], v5 offset:24576
    v_mfma_f32_16x16x32_bf16 v[48:51], v[200:203], v[120:123], v[48:51]
    v_mfma_f32_16x16x32_bf16 v[48:51], v[204:207], v[124:127], v[48:51]
    s_waitcnt lgkmcnt(8)
    v_mfma_f32_16x16x32_bf16 v[52:55], v[228:231], v[124:127], v[52:55]
    ds_read_b64_tr_b16 v[200:201], v7 offset:0
    v_mfma_f32_16x16x32_bf16 v[52:55], v[224:227], v[120:123], v[52:55]
    ds_read_b64_tr_b16 v[202:203], v7 offset:512
    v_mfma_f32_16x16x32_bf16 v[60:63], v[224:227], v[128:131], v[60:63]
    ds_read_b64_tr_b16 v[204:205], v7 offset:12288
    v_mfma_f32_16x16x32_bf16 v[60:63], v[228:231], v[132:135], v[60:63]
    ds_read_b64_tr_b16 v[206:207], v7 offset:12800
    v_mfma_f32_16x16x32_bf16 v[68:71], v[228:231], v[140:143], v[68:71]
    ds_read_b128 v[176:179], v4 offset:22528
    v_mfma_f32_16x16x32_bf16 v[68:71], v[224:227], v[136:139], v[68:71]
    ds_read_b128 v[180:183], v5 offset:22528
    v_mfma_f32_16x16x32_bf16 v[76:79], v[224:227], v[144:147], v[76:79]
    ds_read_b128 v[168:171], v4 offset:20480
    v_mfma_f32_16x16x32_bf16 v[76:79], v[228:231], v[148:151], v[76:79]
    s_waitcnt lgkmcnt(11)
    v_mfma_f32_16x16x32_bf16 v[40:43], v[236:239], v[148:151], v[40:43]
    ds_read_b64_tr_b16 v[224:225], v6 offset:2048
    v_mfma_f32_16x16x32_bf16 v[40:43], v[232:235], v[144:147], v[40:43]
    ds_read_b64_tr_b16 v[226:227], v6 offset:2560
    v_mfma_f32_16x16x32_bf16 v[32:35], v[232:235], v[136:139], v[32:35]
    ds_read_b64_tr_b16 v[228:229], v6 offset:14336
    v_mfma_f32_16x16x32_bf16 v[32:35], v[236:239], v[140:143], v[32:35]
    ds_read_b64_tr_b16 v[230:231], v6 offset:14848
    v_mfma_f32_16x16x32_bf16 v[24:27], v[236:239], v[132:135], v[24:27]
    ds_read_b128 v[172:175], v5 offset:20480
    v_mfma_f32_16x16x32_bf16 v[24:27], v[232:235], v[128:131], v[24:27]
    ds_read_b128 v[160:163], v4 offset:18432
    v_mfma_f32_16x16x32_bf16 v[16:19], v[232:235], v[120:123], v[16:19]
    ds_read_b128 v[164:167], v5 offset:18432
    v_mfma_f32_16x16x32_bf16 v[16:19], v[236:239], v[124:127], v[16:19]
    s_waitcnt lgkmcnt(10)
    v_mfma_f32_16x16x32_bf16 v[20:23], v[204:207], v[124:127], v[20:23]
    ds_read_b64_tr_b16 v[232:233], v7 offset:2048
    v_mfma_f32_16x16x32_bf16 v[20:23], v[200:203], v[120:123], v[20:23]
    ds_read_b64_tr_b16 v[234:235], v7 offset:2560
    v_mfma_f32_16x16x32_bf16 v[28:31], v[200:203], v[128:131], v[28:31]
    ds_read_b64_tr_b16 v[236:237], v7 offset:14336
    v_mfma_f32_16x16x32_bf16 v[28:31], v[204:207], v[132:135], v[28:31]
    ds_read_b64_tr_b16 v[238:239], v7 offset:14848
    v_mfma_f32_16x16x32_bf16 v[36:39], v[204:207], v[140:143], v[36:39]
    v_mfma_f32_16x16x32_bf16 v[36:39], v[200:203], v[136:139], v[36:39]
    v_mfma_f32_16x16x32_bf16 v[44:47], v[200:203], v[144:147], v[44:47]
    v_mfma_f32_16x16x32_bf16 v[44:47], v[204:207], v[148:151], v[44:47]
    s_waitcnt lgkmcnt(7)
    v_mfma_f32_16x16x32_bf16 v[116:119], v[156:159], v[228:231], v[116:119]
    v_mfma_f32_16x16x32_bf16 v[116:119], v[152:155], v[224:227], v[116:119]
    v_mfma_f32_16x16x32_bf16 v[104:107], v[144:147], v[224:227], v[104:107]
    v_mfma_f32_16x16x32_bf16 v[104:107], v[148:151], v[228:231], v[104:107]
    v_mfma_f32_16x16x32_bf16 v[96:99], v[140:143], v[228:231], v[96:99]
    v_mfma_f32_16x16x32_bf16 v[96:99], v[136:139], v[224:227], v[96:99]
    s_waitcnt lgkmcnt(0)
    s_barrier
    v_mfma_f32_16x16x32_bf16 v[88:91], v[128:131], v[224:227], v[88:91]
    ds_read_b64_tr_b16 v[200:201], v6 offset:25600
    v_mfma_f32_16x16x32_bf16 v[88:91], v[132:135], v[228:231], v[88:91]
    ds_read_b64_tr_b16 v[202:203], v6 offset:26112
    v_mfma_f32_16x16x32_bf16 v[80:83], v[124:127], v[228:231], v[80:83]
    ds_read_b64_tr_b16 v[204:205], v6 offset:37888
    v_mfma_f32_16x16x32_bf16 v[80:83], v[120:123], v[224:227], v[80:83]
    ds_read_b64_tr_b16 v[206:207], v6 offset:38400
    v_mfma_f32_16x16x32_bf16 v[84:87], v[120:123], v[232:235], v[84:87]
    ds_read_b64_tr_b16 v[224:225], v7 offset:25600
    v_mfma_f32_16x16x32_bf16 v[84:87], v[124:127], v[236:239], v[84:87]
    ds_read_b64_tr_b16 v[226:227], v7 offset:26112
    v_mfma_f32_16x16x32_bf16 v[92:95], v[132:135], v[236:239], v[92:95]
    ds_read_b64_tr_b16 v[228:229], v7 offset:37888
    v_mfma_f32_16x16x32_bf16 v[92:95], v[128:131], v[232:235], v[92:95]
    ds_read_b64_tr_b16 v[230:231], v7 offset:38400
    v_mfma_f32_16x16x32_bf16 v[100:103], v[136:139], v[232:235], v[100:103]
    v_mfma_f32_16x16x32_bf16 v[100:103], v[140:143], v[236:239], v[100:103]
    v_mfma_f32_16x16x32_bf16 v[108:111], v[148:151], v[236:239], v[108:111]
    v_mfma_f32_16x16x32_bf16 v[108:111], v[144:147], v[232:235], v[108:111]
    s_waitcnt lgkmcnt(4)
    v_mfma_f32_16x16x32_bf16 v[112:115], v[200:203], v[192:195], v[112:115]
    ds_read_b64_tr_b16 v[232:233], v6 offset:24576
    v_mfma_f32_16x16x32_bf16 v[112:115], v[204:207], v[196:199], v[112:115]
    ds_read_b64_tr_b16 v[234:235], v6 offset:25088
    v_mfma_f32_16x16x32_bf16 v[72:75], v[204:207], v[188:191], v[72:75]
    ds_read_b64_tr_b16 v[236:237], v6 offset:36864
    v_mfma_f32_16x16x32_bf16 v[72:75], v[200:203], v[184:187], v[72:75]
    ds_read_b64_tr_b16 v[238:239], v6 offset:37376
    v_mfma_f32_16x16x32_bf16 v[64:67], v[200:203], v[176:179], v[64:67]
    ds_read_b128 v[152:155], v2 offset:36864
    v_mfma_f32_16x16x32_bf16 v[64:67], v[204:207], v[180:183], v[64:67]
    ds_read_b128 v[156:159], v3 offset:36864
    v_mfma_f32_16x16x32_bf16 v[56:59], v[204:207], v[172:175], v[56:59]
    ds_read_b128 v[144:147], v4 offset:43008
    v_mfma_f32_16x16x32_bf16 v[56:59], v[200:203], v[168:171], v[56:59]
    ds_read_b128 v[148:151], v5 offset:43008
    v_mfma_f32_16x16x32_bf16 v[48:51], v[200:203], v[160:163], v[48:51]
    v_mfma_f32_16x16x32_bf16 v[48:51], v[204:207], v[164:167], v[48:51]
    s_waitcnt lgkmcnt(8)
    v_mfma_f32_16x16x32_bf16 v[52:55], v[228:231], v[164:167], v[52:55]
    ds_read_b64_tr_b16 v[200:201], v7 offset:24576
    v_mfma_f32_16x16x32_bf16 v[52:55], v[224:227], v[160:163], v[52:55]
    ds_read_b64_tr_b16 v[202:203], v7 offset:25088
    v_mfma_f32_16x16x32_bf16 v[60:63], v[224:227], v[168:171], v[60:63]
    ds_read_b64_tr_b16 v[204:205], v7 offset:36864
    v_mfma_f32_16x16x32_bf16 v[60:63], v[228:231], v[172:175], v[60:63]
    ds_read_b64_tr_b16 v[206:207], v7 offset:37376
    v_mfma_f32_16x16x32_bf16 v[68:71], v[228:231], v[180:183], v[68:71]
    ds_read_b128 v[136:139], v4 offset:40960
    v_mfma_f32_16x16x32_bf16 v[68:71], v[224:227], v[176:179], v[68:71]
    ds_read_b128 v[140:143], v5 offset:40960
    v_mfma_f32_16x16x32_bf16 v[76:79], v[224:227], v[184:187], v[76:79]
    ds_read_b128 v[128:131], v4 offset:38912
    v_mfma_f32_16x16x32_bf16 v[76:79], v[228:231], v[188:191], v[76:79]
    s_waitcnt lgkmcnt(11)
    v_mfma_f32_16x16x32_bf16 v[40:43], v[236:239], v[188:191], v[40:43]
    ds_read_b64_tr_b16 v[224:225], v6 offset:26624
    v_mfma_f32_16x16x32_bf16 v[40:43], v[232:235], v[184:187], v[40:43]
    ds_read_b64_tr_b16 v[226:227], v6 offset:27136
    v_mfma_f32_16x16x32_bf16 v[32:35], v[232:235], v[176:179], v[32:35]
    ds_read_b64_tr_b16 v[228:229], v6 offset:38912
    v_mfma_f32_16x16x32_bf16 v[32:35], v[236:239], v[180:183], v[32:35]
    ds_read_b64_tr_b16 v[230:231], v6 offset:39424
    v_mfma_f32_16x16x32_bf16 v[24:27], v[236:239], v[172:175], v[24:27]
    ds_read_b128 v[132:135], v5 offset:38912
    v_mfma_f32_16x16x32_bf16 v[24:27], v[232:235], v[168:171], v[24:27]
    ds_read_b128 v[120:123], v4 offset:36864
    v_mfma_f32_16x16x32_bf16 v[16:19], v[232:235], v[160:163], v[16:19]
    ds_read_b128 v[124:127], v5 offset:36864
    v_mfma_f32_16x16x32_bf16 v[16:19], v[236:239], v[164:167], v[16:19]
    s_waitcnt lgkmcnt(10)
    v_mfma_f32_16x16x32_bf16 v[20:23], v[204:207], v[164:167], v[20:23]
    ds_read_b64_tr_b16 v[232:233], v7 offset:26624
    v_mfma_f32_16x16x32_bf16 v[20:23], v[200:203], v[160:163], v[20:23]
    ds_read_b64_tr_b16 v[234:235], v7 offset:27136
    v_mfma_f32_16x16x32_bf16 v[28:31], v[200:203], v[168:171], v[28:31]
    ds_read_b64_tr_b16 v[236:237], v7 offset:38912
    v_mfma_f32_16x16x32_bf16 v[28:31], v[204:207], v[172:175], v[28:31]
    ds_read_b64_tr_b16 v[238:239], v7 offset:39424
    v_mfma_f32_16x16x32_bf16 v[36:39], v[204:207], v[180:183], v[36:39]
    v_mfma_f32_16x16x32_bf16 v[36:39], v[200:203], v[176:179], v[36:39]
    v_mfma_f32_16x16x32_bf16 v[44:47], v[200:203], v[184:187], v[44:47]
    v_mfma_f32_16x16x32_bf16 v[44:47], v[204:207], v[188:191], v[44:47]
    s_waitcnt lgkmcnt(7)
    v_mfma_f32_16x16x32_bf16 v[116:119], v[196:199], v[228:231], v[116:119]
    v_mfma_f32_16x16x32_bf16 v[116:119], v[192:195], v[224:227], v[116:119]
    v_mfma_f32_16x16x32_bf16 v[104:107], v[184:187], v[224:227], v[104:107]
    v_mfma_f32_16x16x32_bf16 v[104:107], v[188:191], v[228:231], v[104:107]
    v_mfma_f32_16x16x32_bf16 v[96:99], v[180:183], v[228:231], v[96:99]
    v_mfma_f32_16x16x32_bf16 v[96:99], v[176:179], v[224:227], v[96:99]
    s_waitcnt lgkmcnt(0)
    s_barrier
    v_mfma_f32_16x16x32_bf16 v[88:91], v[168:171], v[224:227], v[88:91]
    ds_read_b64_tr_b16 v[200:201], v6 offset:50176
    v_mfma_f32_16x16x32_bf16 v[88:91], v[172:175], v[228:231], v[88:91]
    ds_read_b64_tr_b16 v[202:203], v6 offset:50688
    v_mfma_f32_16x16x32_bf16 v[80:83], v[164:167], v[228:231], v[80:83]
    ds_read_b64_tr_b16 v[204:205], v6 offset:62464
    v_mfma_f32_16x16x32_bf16 v[80:83], v[160:163], v[224:227], v[80:83]
    ds_read_b64_tr_b16 v[206:207], v6 offset:62976
    v_mfma_f32_16x16x32_bf16 v[84:87], v[160:163], v[232:235], v[84:87]
    ds_read_b64_tr_b16 v[224:225], v7 offset:50176
    v_mfma_f32_16x16x32_bf16 v[84:87], v[164:167], v[236:239], v[84:87]
    ds_read_b64_tr_b16 v[226:227], v7 offset:50688
    v_mfma_f32_16x16x32_bf16 v[92:95], v[172:175], v[236:239], v[92:95]
    ds_read_b64_tr_b16 v[228:229], v7 offset:62464
    v_mfma_f32_16x16x32_bf16 v[92:95], v[168:171], v[232:235], v[92:95]
    ds_read_b64_tr_b16 v[230:231], v7 offset:62976
    v_mfma_f32_16x16x32_bf16 v[100:103], v[176:179], v[232:235], v[100:103]
    v_mfma_f32_16x16x32_bf16 v[100:103], v[180:183], v[236:239], v[100:103]
    v_mfma_f32_16x16x32_bf16 v[108:111], v[188:191], v[236:239], v[108:111]
    v_mfma_f32_16x16x32_bf16 v[108:111], v[184:187], v[232:235], v[108:111]
    s_waitcnt lgkmcnt(4)
    v_mfma_f32_16x16x32_bf16 v[112:115], v[200:203], v[152:155], v[112:115]
    ds_read_b64_tr_b16 v[232:233], v6 offset:49152
    v_mfma_f32_16x16x32_bf16 v[112:115], v[204:207], v[156:159], v[112:115]
    ds_read_b64_tr_b16 v[234:235], v6 offset:49664
    v_mfma_f32_16x16x32_bf16 v[72:75], v[204:207], v[148:151], v[72:75]
    ds_read_b64_tr_b16 v[236:237], v6 offset:61440
    v_mfma_f32_16x16x32_bf16 v[72:75], v[200:203], v[144:147], v[72:75]
    ds_read_b64_tr_b16 v[238:239], v6 offset:61952
    v_mfma_f32_16x16x32_bf16 v[64:67], v[200:203], v[136:139], v[64:67]
    ds_read_b128 v[192:195], v2 offset:0
    v_mfma_f32_16x16x32_bf16 v[64:67], v[204:207], v[140:143], v[64:67]
    ds_read_b128 v[196:199], v3 offset:0
    v_mfma_f32_16x16x32_bf16 v[56:59], v[204:207], v[132:135], v[56:59]
    ds_read_b128 v[184:187], v4 offset:6144
    v_mfma_f32_16x16x32_bf16 v[56:59], v[200:203], v[128:131], v[56:59]
    ds_read_b128 v[188:191], v5 offset:6144
    v_mfma_f32_16x16x32_bf16 v[48:51], v[200:203], v[120:123], v[48:51]
    v_mfma_f32_16x16x32_bf16 v[48:51], v[204:207], v[124:127], v[48:51]
    s_waitcnt lgkmcnt(8)
    v_mfma_f32_16x16x32_bf16 v[52:55], v[228:231], v[124:127], v[52:55]
    ds_read_b64_tr_b16 v[200:201], v7 offset:49152
    v_mfma_f32_16x16x32_bf16 v[52:55], v[224:227], v[120:123], v[52:55]
    ds_read_b64_tr_b16 v[202:203], v7 offset:49664
    v_mfma_f32_16x16x32_bf16 v[60:63], v[224:227], v[128:131], v[60:63]
    ds_read_b64_tr_b16 v[204:205], v7 offset:61440
    v_mfma_f32_16x16x32_bf16 v[60:63], v[228:231], v[132:135], v[60:63]
    ds_read_b64_tr_b16 v[206:207], v7 offset:61952
    v_mfma_f32_16x16x32_bf16 v[68:71], v[228:231], v[140:143], v[68:71]
    ds_read_b128 v[176:179], v4 offset:4096
    v_mfma_f32_16x16x32_bf16 v[68:71], v[224:227], v[136:139], v[68:71]
    ds_read_b128 v[180:183], v5 offset:4096
    v_mfma_f32_16x16x32_bf16 v[76:79], v[224:227], v[144:147], v[76:79]
    ds_read_b128 v[168:171], v4 offset:2048
    v_mfma_f32_16x16x32_bf16 v[76:79], v[228:231], v[148:151], v[76:79]
    s_waitcnt lgkmcnt(11)
    v_mfma_f32_16x16x32_bf16 v[40:43], v[236:239], v[148:151], v[40:43]
    ds_read_b64_tr_b16 v[224:225], v6 offset:51200
    v_mfma_f32_16x16x32_bf16 v[40:43], v[232:235], v[144:147], v[40:43]
    ds_read_b64_tr_b16 v[226:227], v6 offset:51712
    v_mfma_f32_16x16x32_bf16 v[32:35], v[232:235], v[136:139], v[32:35]
    ds_read_b64_tr_b16 v[228:229], v6 offset:63488
    v_mfma_f32_16x16x32_bf16 v[32:35], v[236:239], v[140:143], v[32:35]
    ds_read_b64_tr_b16 v[230:231], v6 offset:64000
    v_mfma_f32_16x16x32_bf16 v[24:27], v[236:239], v[132:135], v[24:27]
    ds_read_b128 v[172:175], v5 offset:2048
    v_mfma_f32_16x16x32_bf16 v[24:27], v[232:235], v[128:131], v[24:27]
    ds_read_b128 v[160:163], v4 offset:0
    v_mfma_f32_16x16x32_bf16 v[16:19], v[232:235], v[120:123], v[16:19]
    ds_read_b128 v[164:167], v5 offset:0
    v_mfma_f32_16x16x32_bf16 v[16:19], v[236:239], v[124:127], v[16:19]
    s_waitcnt lgkmcnt(10)
    v_mfma_f32_16x16x32_bf16 v[20:23], v[204:207], v[124:127], v[20:23]
    ds_read_b64_tr_b16 v[232:233], v7 offset:51200
    v_mfma_f32_16x16x32_bf16 v[20:23], v[200:203], v[120:123], v[20:23]
    ds_read_b64_tr_b16 v[234:235], v7 offset:51712
    v_mfma_f32_16x16x32_bf16 v[28:31], v[200:203], v[128:131], v[28:31]
    ds_read_b64_tr_b16 v[236:237], v7 offset:63488
    v_mfma_f32_16x16x32_bf16 v[28:31], v[204:207], v[132:135], v[28:31]
    ds_read_b64_tr_b16 v[238:239], v7 offset:64000
    v_mfma_f32_16x16x32_bf16 v[36:39], v[204:207], v[140:143], v[36:39]
    v_mfma_f32_16x16x32_bf16 v[36:39], v[200:203], v[136:139], v[36:39]
    v_mfma_f32_16x16x32_bf16 v[44:47], v[200:203], v[144:147], v[44:47]
    v_mfma_f32_16x16x32_bf16 v[44:47], v[204:207], v[148:151], v[44:47]
    s_waitcnt lgkmcnt(7)
    v_mfma_f32_16x16x32_bf16 v[116:119], v[156:159], v[228:231], v[116:119]
    ds_read_b64_tr_b16 v[200:201], v6 offset:1024
    v_mfma_f32_16x16x32_bf16 v[116:119], v[152:155], v[224:227], v[116:119]
    ds_read_b64_tr_b16 v[202:203], v6 offset:1536
    v_mfma_f32_16x16x32_bf16 v[104:107], v[144:147], v[224:227], v[104:107]
    ds_read_b64_tr_b16 v[204:205], v6 offset:13312
    v_mfma_f32_16x16x32_bf16 v[104:107], v[148:151], v[228:231], v[104:107]
    ds_read_b64_tr_b16 v[206:207], v6 offset:13824
    v_mfma_f32_16x16x32_bf16 v[96:99], v[140:143], v[228:231], v[96:99]
    v_mfma_f32_16x16x32_bf16 v[96:99], v[136:139], v[224:227], v[96:99]
    v_mfma_f32_16x16x32_bf16 v[88:91], v[128:131], v[224:227], v[88:91]
    v_mfma_f32_16x16x32_bf16 v[88:91], v[132:135], v[228:231], v[88:91]
    v_mfma_f32_16x16x32_bf16 v[80:83], v[124:127], v[228:231], v[80:83]
    v_mfma_f32_16x16x32_bf16 v[80:83], v[120:123], v[224:227], v[80:83]
    s_waitcnt lgkmcnt(4)
    v_mfma_f32_16x16x32_bf16 v[84:87], v[120:123], v[232:235], v[84:87]
    ds_read_b64_tr_b16 v[224:225], v7 offset:1024
    v_mfma_f32_16x16x32_bf16 v[84:87], v[124:127], v[236:239], v[84:87]
    ds_read_b64_tr_b16 v[226:227], v7 offset:1536
    v_mfma_f32_16x16x32_bf16 v[92:95], v[132:135], v[236:239], v[92:95]
    ds_read_b64_tr_b16 v[228:229], v7 offset:13312
    v_mfma_f32_16x16x32_bf16 v[92:95], v[128:131], v[232:235], v[92:95]
    ds_read_b64_tr_b16 v[230:231], v7 offset:13824
    v_mfma_f32_16x16x32_bf16 v[100:103], v[136:139], v[232:235], v[100:103]
    v_mfma_f32_16x16x32_bf16 v[100:103], v[140:143], v[236:239], v[100:103]
    v_mfma_f32_16x16x32_bf16 v[108:111], v[148:151], v[236:239], v[108:111]
    v_mfma_f32_16x16x32_bf16 v[108:111], v[144:147], v[232:235], v[108:111]
    s_waitcnt lgkmcnt(6)
    v_mfma_f32_16x16x32_bf16 v[112:115], v[200:203], v[192:195], v[112:115]
    ds_read_b64_tr_b16 v[120:121], v6 offset:0
    ds_read_b64_tr_b16 v[122:123], v6 offset:512
    s_waitcnt lgkmcnt(6)
    v_mfma_f32_16x16x32_bf16 v[112:115], v[204:207], v[196:199], v[112:115]
    ds_read_b64_tr_b16 v[124:125], v6 offset:12288
    ds_read_b64_tr_b16 v[126:127], v6 offset:12800
    v_mfma_f32_16x16x32_bf16 v[72:75], v[204:207], v[188:191], v[72:75]
    ds_read_b64_tr_b16 v[128:129], v7 offset:0
    ds_read_b64_tr_b16 v[130:131], v7 offset:512
    v_mfma_f32_16x16x32_bf16 v[72:75], v[200:203], v[184:187], v[72:75]
    ds_read_b64_tr_b16 v[132:133], v7 offset:12288
    ds_read_b64_tr_b16 v[134:135], v7 offset:12800
    v_mfma_f32_16x16x32_bf16 v[64:67], v[200:203], v[176:179], v[64:67]
    ds_read_b64_tr_b16 v[136:137], v6 offset:2048
    ds_read_b64_tr_b16 v[138:139], v6 offset:2560
    v_mfma_f32_16x16x32_bf16 v[64:67], v[204:207], v[180:183], v[64:67]
    ds_read_b64_tr_b16 v[140:141], v6 offset:14336
    ds_read_b64_tr_b16 v[142:143], v6 offset:14848
    v_mfma_f32_16x16x32_bf16 v[56:59], v[204:207], v[172:175], v[56:59]
    ds_read_b64_tr_b16 v[144:145], v7 offset:2048
    ds_read_b64_tr_b16 v[146:147], v7 offset:2560
    v_mfma_f32_16x16x32_bf16 v[56:59], v[200:203], v[168:171], v[56:59]
    ds_read_b64_tr_b16 v[148:149], v7 offset:14336
    ds_read_b64_tr_b16 v[150:151], v7 offset:14848
    v_mfma_f32_16x16x32_bf16 v[48:51], v[200:203], v[160:163], v[48:51]
    v_cvt_pk_bf16_f32 v72, v72, v73
    v_cvt_pk_bf16_f32 v73, v74, v75
    v_mfma_f32_16x16x32_bf16 v[48:51], v[204:207], v[164:167], v[48:51]
    v_cvt_pk_bf16_f32 v64, v64, v65
    v_cvt_pk_bf16_f32 v65, v66, v67
    s_waitcnt lgkmcnt(14)
    v_mfma_f32_16x16x32_bf16 v[76:79], v[228:231], v[188:191], v[76:79]
    v_cvt_pk_bf16_f32 v56, v56, v57
    v_cvt_pk_bf16_f32 v57, v58, v59
    v_mfma_f32_16x16x32_bf16 v[76:79], v[224:227], v[184:187], v[76:79]
    v_cvt_pk_bf16_f32 v200, v112, v113
    v_cvt_pk_bf16_f32 v201, v114, v115
    v_mfma_f32_16x16x32_bf16 v[68:71], v[224:227], v[176:179], v[68:71]
    ds_write_b64 v216, v[200:201]
    ds_write_b64 v217, v[72:73]
    v_mfma_f32_16x16x32_bf16 v[68:71], v[228:231], v[180:183], v[68:71]
    v_cvt_pk_bf16_f32 v48, v48, v49
    v_cvt_pk_bf16_f32 v49, v50, v51
    v_mfma_f32_16x16x32_bf16 v[60:63], v[228:231], v[172:175], v[60:63]
    v_cvt_pk_bf16_f32 v74, v76, v77
    v_cvt_pk_bf16_f32 v75, v78, v79
    v_mfma_f32_16x16x32_bf16 v[60:63], v[224:227], v[168:171], v[60:63]
    ds_write_b64 v217, v[74:75] offset:512
    s_mov_b64 exec, 1
    ds_add_u32 v10, v11 offset:0
    s_mov_b64 exec, -1
    v_mfma_f32_16x16x32_bf16 v[52:55], v[224:227], v[160:163], v[52:55]
    v_cvt_pk_bf16_f32 v66, v68, v69
    v_cvt_pk_bf16_f32 v67, v70, v71
    v_mfma_f32_16x16x32_bf16 v[52:55], v[228:231], v[164:167], v[52:55]
    v_cvt_pk_bf16_f32 v58, v60, v61
    v_cvt_pk_bf16_f32 v59, v62, v63
    s_waitcnt lgkmcnt(14)
    v_mfma_f32_16x16x32_bf16 v[40:43], v[124:127], v[188:191], v[40:43]
    s_nop 1
    v_mfma_f32_16x16x32_bf16 v[40:43], v[120:123], v[184:187], v[40:43]
    s_nop 1
    v_mfma_f32_16x16x32_bf16 v[32:35], v[120:123], v[176:179], v[32:35]
    v_cvt_pk_bf16_f32 v50, v52, v53
    v_cvt_pk_bf16_f32 v51, v54, v55
    v_mfma_f32_16x16x32_bf16 v[32:35], v[124:127], v[180:183], v[32:35]
    s_nop 1
    v_mfma_f32_16x16x32_bf16 v[24:27], v[124:127], v[172:175], v[24:27]
    v_cvt_pk_bf16_f32 v40, v40, v41
    v_cvt_pk_bf16_f32 v41, v42, v43
    v_mfma_f32_16x16x32_bf16 v[24:27], v[120:123], v[168:171], v[24:27]
    s_nop 1
    v_mfma_f32_16x16x32_bf16 v[16:19], v[120:123], v[160:163], v[16:19]
    v_cvt_pk_bf16_f32 v32, v32, v33
    v_cvt_pk_bf16_f32 v33, v34, v35
    v_mfma_f32_16x16x32_bf16 v[16:19], v[124:127], v[164:167], v[16:19]
    s_nop 1
    s_waitcnt lgkmcnt(12)
    v_mfma_f32_16x16x32_bf16 v[44:47], v[132:135], v[188:191], v[44:47]
    v_cvt_pk_bf16_f32 v24, v24, v25
    v_cvt_pk_bf16_f32 v25, v26, v27
    v_mfma_f32_16x16x32_bf16 v[44:47], v[128:131], v[184:187], v[44:47]
    s_nop 1
    v_mfma_f32_16x16x32_bf16 v[36:39], v[128:131], v[176:179], v[36:39]
    v_cvt_pk_bf16_f32 v16, v16, v17
    v_cvt_pk_bf16_f32 v17, v18, v19
    v_mfma_f32_16x16x32_bf16 v[36:39], v[132:135], v[180:183], v[36:39]
    s_nop 1
    v_mfma_f32_16x16x32_bf16 v[28:31], v[132:135], v[172:175], v[28:31]
    v_cvt_pk_bf16_f32 v42, v44, v45
    v_cvt_pk_bf16_f32 v43, v46, v47
    v_mfma_f32_16x16x32_bf16 v[28:31], v[128:131], v[168:171], v[28:31]
    ds_read_b32 v223, v10 offset:0
    ds_read_b64 v[204:205], v218
    v_mfma_f32_16x16x32_bf16 v[20:23], v[128:131], v[160:163], v[20:23]
    ds_read_b64 v[206:207], v219
    v_cvt_pk_bf16_f32 v34, v36, v37
    v_mfma_f32_16x16x32_bf16 v[20:23], v[132:135], v[164:167], v[20:23]
    v_cvt_pk_bf16_f32 v35, v38, v39
    s_nop 0
    s_waitcnt lgkmcnt(11)
    v_mfma_f32_16x16x32_bf16 v[116:119], v[196:199], v[140:143], v[116:119]
    v_cvt_pk_bf16_f32 v26, v28, v29
    v_cvt_pk_bf16_f32 v27, v30, v31
    v_mfma_f32_16x16x32_bf16 v[116:119], v[192:195], v[136:139], v[116:119]
    s_nop 1
    v_mfma_f32_16x16x32_bf16 v[104:107], v[184:187], v[136:139], v[104:107]
    v_cvt_pk_bf16_f32 v18, v20, v21
    v_cvt_pk_bf16_f32 v19, v22, v23
    v_mfma_f32_16x16x32_bf16 v[104:107], v[188:191], v[140:143], v[104:107]
    s_nop 1
    v_mfma_f32_16x16x32_bf16 v[44:47], v[72:75], v[40:43], 0
    v_cvt_pk_bf16_f32 v202, v116, v117
    v_cvt_pk_bf16_f32 v203, v118, v119
    v_mfma_f32_16x16x32_bf16 v[76:79], v[64:67], v[40:43], 0
    s_nop 1
    v_mfma_f32_16x16x32_bf16 v[36:39], v[64:67], v[32:35], 0
    v_cvt_pk_bf16_f32 v232, v104, v105
    v_cvt_pk_bf16_f32 v233, v106, v107
    v_mfma_f32_16x16x32_bf16 v[68:71], v[56:59], v[32:35], 0
    ds_write_b64 v216, v[202:203] offset:1024
    ds_write_b64 v217, v[232:233] offset:1024
    v_mfma_f32_16x16x32_bf16 v[96:99], v[180:183], v[140:143], v[96:99]
    s_waitcnt lgkmcnt(4)
    v_cmp_gt_u32 vcc, 4, v223
    s_cbranch_vccnz LB_w1
LB_g1:
    v_mfma_f32_16x16x32_bf16 v[96:99], v[176:179], v[136:139], v[96:99]
    v_cndmask_b32 v124, v44, v45, s[88:89]
    v_cndmask_b32 v125, v76, v77, s[88:89]
    v_mfma_f32_16x16x32_bf16 v[28:31], v[56:59], v[24:27], 0
    v_cndmask_b32 v158, v125, v124, s[90:91]
    v_cndmask_b32 v126, v46, v47, s[88:89]
    v_mfma_f32_16x16x32_bf16 v[60:63], v[48:51], v[24:27], 0
    v_cndmask_b32 v127, v78, v79, s[88:89]
    v_cndmask_b32 v159, v127, v126, s[92:93]
    v_mfma_f32_16x16x32_bf16 v[20:23], v[48:51], v[16:19], 0
    v_max_f32 v123, v158, v159
    v_cndmask_b32 v124, v36, v37, s[88:89]
    v_mfma_f32_16x16x32_bf16 v[88:91], v[168:171], v[136:139], v[88:91]
    v_cndmask_b32 v125, v68, v69, s[88:89]
    v_cndmask_b32 v156, v125, v124, s[90:91]
    v_mfma_f32_16x16x32_bf16 v[88:91], v[172:175], v[140:143], v[88:91]
    v_cndmask_b32 v126, v38, v39, s[88:89]
    v_cndmask_b32 v127, v70, v71, s[88:89]
    s_waitcnt lgkmcnt(2)
    v_mfma_f32_16x16x32_bf16 v[52:55], v[204:207], v[16:19], v[212:215]
    v_cndmask_b32 v157, v127, v126, s[92:93]
    v_max_f32 v122, v156, v157
    v_mfma_f32_16x16x32_bf16 v[80:83], v[164:167], v[140:143], v[80:83]
    v_cndmask_b32 v124, v28, v29, s[88:89]
    v_cndmask_b32 v125, v60, v61, s[88:89]
    v_mfma_f32_16x16x32_bf16 v[80:83], v[160:163], v[136:139], v[80:83]
    v_cndmask_b32 v154, v125, v124, s[90:91]
    v_cndmask_b32 v126, v30, v31, s[88:89]
    v_mfma_f32_16x16x32_bf16 v[108:111], v[184:187], v[144:147], v[108:111]
    v_cndmask_b32 v127, v62, v63, s[88:89]
    v_cndmask_b32 v155, v127, v126, s[92:93]
    v_mfma_f32_16x16x32_bf16 v[108:111], v[188:191], v[148:151], v[108:111]
    v_max_f32 v121, v154, v155
    s_nop 0
    v_mfma_f32_16x16x32_bf16 v[100:103], v[180:183], v[148:151], v[100:103]
    s_nop 1
    v_mfma_f32_16x16x32_bf16 v[100:103], v[176:179], v[144:147], v[100:103]
    s_nop 1
    v_mfma_f32_16x16x32_bf16 v[92:95], v[168:171], v[144:147], v[92:95]
    v_cvt_pk_bf16_f32 v242, v108, v109
    v_cvt_pk_bf16_f32 v243, v110, v111
    v_mfma_f32_16x16x32_bf16 v[92:95], v[172:175], v[148:151], v[92:95]
    ds_write_b64 v217, v[242:243] offset:1536
    s_mov_b64 exec, 1
    ds_add_u32 v10, v11 offset:24
    s_mov_b64 exec, -1
    v_mfma_f32_16x16x32_bf16 v[84:87], v[164:167], v[148:151], v[84:87]
    v_cndmask_b32 v124, v20, v21, s[88:89]
    v_cndmask_b32 v125, v52, v53, s[88:89]
    v_mfma_f32_16x16x32_bf16 v[84:87], v[160:163], v[144:147], v[84:87]
    v_cndmask_b32 v152, v125, v124, s[90:91]
    v_cndmask_b32 v126, v22, v23, s[88:89]
    v_cndmask_b32 v127, v54, v55, s[88:89]
    v_cndmask_b32 v153, v127, v126, s[92:93]
    v_max_f32 v120, v152, v153
    s_mov_b32 s80, 0x3e8293ee
    s_add_u32 m0, s34, 36864
    s_add_u32 s35, s44, 0
    buffer_load_dwordx4 v245, s[64:67], s35 offen  lds
    v_cvt_pk_bf16_f32 v230, v96, v97
    v_permlane32_swap_b32 v122, v123
    v_permlane32_swap_b32 v120, v121
    v_max_f32 v122, v122, v123
    v_max_f32 v120, v120, v121
    v_cvt_pk_bf16_f32 v231, v98, v99
    v_cvt_pk_bf16_f32 v240, v100, v101
    v_permlane16_swap_b32 v120, v122
    v_max_f32 v120, v120, v122
    v_mul_f32 v120, s80, v120
    v_mov_b32 v122, v120
    v_cvt_pk_bf16_f32 v241, v102, v103
    v_cvt_pk_bf16_f32 v228, v88, v89
    v_permlane16_swap_b32 v120, v122
    v_mov_b32 v121, v120
    v_mov_b32 v123, v122
    s_add_u32 m0, s34, 40960
    s_add_u32 s35, s44, 65536
    buffer_load_dwordx4 v245, s[64:67], s35 offen  lds
    v_cvt_pk_bf16_f32 v229, v90, v91
    v_permlane32_swap_b32 v120, v121
    v_permlane32_swap_b32 v122, v123
    v_fma_f32 v152, v152, s80, -v120
    v_fma_f32 v153, v153, s80, -v120
    v_fma_f32 v154, v154, s80, -v121
    v_fma_f32 v155, v155, s80, -v121
    v_fma_f32 v156, v156, s80, -v122
    v_fma_f32 v157, v157, s80, -v122
    v_fma_f32 v158, v158, s80, -v123
    v_fma_f32 v159, v159, s80, -v123
    ds_read_b32 v223, v10 offset:24
    ds_read_b64 v[224:225], v218 offset:1024
    ds_read_b64 v[234:235], v219 offset:1024
    v_exp_f32 v152, v152
    v_exp_f32 v153, v153
    v_exp_f32 v154, v154
    s_add_u32 m0, s34, 45056
    s_add_u32 s35, s44, 131072
    buffer_load_dwordx4 v245, s[64:67], s35 offen  lds
    v_exp_f32 v155, v155
    v_exp_f32 v156, v156
    v_exp_f32 v157, v157
    v_exp_f32 v158, v158
    v_exp_f32 v159, v159
    v_add_f32 v120, v152, v153
    v_add_f32 v121, v154, v155
    v_add_f32 v122, v156, v157
    v_add_f32 v123, v158, v159
    v_cvt_pk_bf16_f32 v238, v92, v93
    s_nop 0
    v_permlane32_swap_b32 v122, v123
    v_permlane32_swap_b32 v120, v121
    v_add_f32 v122, v122, v123
    v_add_f32 v120, v120, v121
    v_cvt_pk_bf16_f32 v239, v94, v95
    v_cvt_pk_bf16_f32 v226, v80, v81
    s_add_u32 m0, s34, 49152
    s_add_u32 s35, s44, 196608
    buffer_load_dwordx4 v245, s[64:67], s35 offen  lds
    v_permlane16_swap_b32 v120, v122
    v_add_f32 v120, v120, v122
    v_rcp_f32 v120, v120
    s_nop 0
    v_mov_b32 v122, v120
    v_cvt_pk_bf16_f32 v227, v82, v83
    v_cvt_pk_bf16_f32 v236, v84, v85
    v_permlane16_swap_b32 v120, v122
    v_mov_b32 v121, v120
    v_mov_b32 v123, v122
    v_cvt_pk_bf16_f32 v237, v86, v87
    v_permlane32_swap_b32 v120, v121
    v_permlane32_swap_b32 v122, v123
    s_waitcnt lgkmcnt(2)
    v_cmp_gt_u32 vcc, 4, v223
    s_cbranch_vccnz LB_w6
LB_g6:
    v_mul_f32 v152, v152, v120
    v_mul_f32 v153, v153, v120
    v_cvt_pk_bf16_f32 v152, v152, v153
    v_perm_b32 v160, v152, v152, v208
    s_add_u32 m0, s34, 53248
    s_add_u32 s35, s45, 0
    buffer_load_dwordx4 v245, s[64:67], s35 offen  lds
    v_perm_b32 v161, v152, v152, v209
    v_perm_b32 v162, v152, v152, v210
    v_perm_b32 v163, v152, v152, v211
    v_mul_f32 v154, v154, v121
    v_mul_f32 v155, v155, v121
    v_cvt_pk_bf16_f32 v154, v154, v155
    v_perm_b32 v164, v154, v154, v208
    v_perm_b32 v165, v154, v154, v209
    v_perm_b32 v166, v154, v154, v210
    v_perm_b32 v167, v154, v154, v211
    s_waitcnt lgkmcnt(1)
    v_mfma_f32_16x16x32_bf16 v[16:19], v[224:227], v[160:163], 0
    s_waitcnt lgkmcnt(0)
    v_mfma_f32_16x16x32_bf16 v[20:23], v[234:237], v[160:163], 0
    v_mul_f32 v156, v156, v122
    v_mul_f32 v157, v157, v122
    v_cvt_pk_bf16_f32 v156, v156, v157
    v_perm_b32 v168, v156, v156, v208
    s_add_u32 m0, s34, 57344
    s_add_u32 s35, s45, 65536
    buffer_load_dwordx4 v245, s[64:67], s35 offen  lds
    v_perm_b32 v169, v156, v156, v209
    v_perm_b32 v170, v156, v156, v210
    v_perm_b32 v171, v156, v156, v211
    v_mfma_f32_16x16x32_bf16 v[24:27], v[226:229], v[164:167], 0
    v_mfma_f32_16x16x32_bf16 v[28:31], v[236:239], v[164:167], 0
    v_mul_f32 v158, v158, v123
    v_mul_f32 v159, v159, v123
    v_cvt_pk_bf16_f32 v158, v158, v159
    v_perm_b32 v172, v158, v158, v208
    v_perm_b32 v173, v158, v158, v209
    v_perm_b32 v174, v158, v158, v210
    v_perm_b32 v175, v158, v158, v211
    v_mfma_f32_16x16x32_bf16 v[32:35], v[228:231], v[168:171], 0
    v_mfma_f32_16x16x32_bf16 v[36:39], v[238:241], v[168:171], 0
    v_mfma_f32_16x16x32_bf16 v[40:43], v[230:233], v[172:175], 0
    v_mfma_f32_16x16x32_bf16 v[44:47], v[240:243], v[172:175], 0
    v_cvt_pk_bf16_f32 v80, v16, v17
    v_cvt_pk_bf16_f32 v81, v18, v19
    v_cvt_pk_bf16_f32 v82, v20, v21
    v_cvt_pk_bf16_f32 v83, v22, v23
    s_add_u32 s95, s94, 0
    buffer_store_dwordx4 v[80:83], v12, s[52:55], s95 offen sc1
    v_cvt_pk_bf16_f32 v84, v24, v25
    v_cvt_pk_bf16_f32 v85, v26, v27
    v_cvt_pk_bf16_f32 v86, v28, v29
    v_cvt_pk_bf16_f32 v87, v30, v31
    s_add_u32 s95, s94, 32768
    buffer_store_dwordx4 v[84:87], v12, s[52:55], s95 offen sc1
    v_cvt_pk_bf16_f32 v88, v32, v33
    v_cvt_pk_bf16_f32 v89, v34, v35
    v_cvt_pk_bf16_f32 v90, v36, v37
    v_cvt_pk_bf16_f32 v91, v38, v39
    s_add_u32 s95, s94, 65536
    buffer_store_dwordx4 v[88:91], v12, s[52:55], s95 offen sc1
    v_cvt_pk_bf16_f32 v92, v40, v41
    v_cvt_pk_bf16_f32 v93, v42, v43
    v_cvt_pk_bf16_f32 v94, v44, v45
    v_cvt_pk_bf16_f32 v95, v46, v47
    s_add_u32 s95, s94, 98304
    buffer_store_dwordx4 v[92:95], v12, s[52:55], s95 offen sc1
    s_add_u32 m0, s34, 61440
    s_add_u32 s35, s45, 131072
    buffer_load_dwordx4 v245, s[64:67], s35 offen  lds
    v_xor_b32 v2, 0, v244
    v_xor_b32 v3, 32, v244
    v_xor_b32 v4, 64, v244
    v_xor_b32 v5, 96, v244
    s_add_u32 m0, s34, 65536
    s_add_u32 s35, s45, 196608
    buffer_load_dwordx4 v245, s[64:67], s35 offen  lds
    v_xor_b32 v6, 2048, v244
    v_xor_b32 v7, 2080, v244
    v_xor_b32 v8, 2112, v244
    v_xor_b32 v9, 2144, v244
    s_waitcnt vmcnt(6)
    s_mov_b64 exec, 1
    ds_add_u32 v10, v11 offset:8
    s_mov_b64 exec, -1
    s_add_u32 m0, s34, 69632
    s_add_u32 s35, s46, 0
    buffer_load_dwordx4 v245, s[64:67], s35 offen  lds
    v_add_u32 v224, 65536, v2
    v_add_u32 v225, 65536, v3
    v_add_u32 v226, 65536, v4
    v_add_u32 v227, 65536, v5
    v_add_u32 v228, 65536, v6
    v_add_u32 v229, 65536, v7
    s_add_u32 m0, s34, 73728
    s_add_u32 s35, s46, 65536
    buffer_load_dwordx4 v245, s[64:67], s35 offen  lds
    v_add_u32 v230, 65536, v8
    v_add_u32 v231, 65536, v9
    v_add_u32 v15, 32768, v12
    v_add_u32 v232, 129024, v2
    v_add_u32 v233, 129024, v3
    v_add_u32 v234, 129024, v4
    s_add_u32 m0, s34, 77824
    s_add_u32 s35, s46, 131072
    buffer_load_dwordx4 v245, s[64:67], s35 offen  lds
    v_add_u32 v235, 129024, v5
    v_add_u32 v236, 129024, v6
    v_add_u32 v237, 129024, v7
    v_add_u32 v238, 129024, v8
    v_add_u32 v239, 129024, v9
    s_waitcnt vmcnt(5)
    s_mov_b64 exec, 1
    buffer_store_dword v11, v220, s[52:55], s97 offen sc1
    s_mov_b64 exec, -1
    s_branch LB_s2_in
LB_s2:
    s_sleep 1
LB_s2_in:
    ds_read_b32 v14, v10 offset:8
    s_waitcnt lgkmcnt(0)
    v_readfirstlane_b32 s78, v14
    s_nop 0
    s_cmp_ge_u32 s78, 8
    s_cbranch_scc0 LB_s2
    s_add_u32 m0, s34, 81920
    s_add_u32 s35, s46, 196608
    buffer_load_dwordx4 v245, s[64:67], s35 offen  lds
    ds_read_b64_tr_b16 v[48:49], v2 offset:36864
    ds_read_b64_tr_b16 v[50:51], v6 offset:36864
    s_add_u32 m0, s34, 86016
    s_add_u32 s35, s47, 0
    buffer_load_dwordx4 v245, s[64:67], s35 offen  lds
    ds_read_b64_tr_b16 v[52:53], v2 offset:40960
    s_add_u32 m0, s34, 0
    s_add_u32 s35, s47, 65536
    buffer_load_dwordx4 v245, s[64:67], s35 offen  lds
    ds_read_b64_tr_b16 v[54:55], v6 offset:40960
    s_add_u32 m0, s34, 4096
    s_add_u32 s35, s47, 131072
    buffer_load_dwordx4 v245, s[64:67], s35 offen  lds
    ds_read_b64_tr_b16 v[56:57], v2 offset:45056
    s_add_u32 m0, s34, 8192
    s_add_u32 s35, s47, 196608
    buffer_load_dwordx4 v245, s[64:67], s35 offen  lds
    ds_read_b64_tr_b16 v[58:59], v6 offset:45056
    s_add_u32 m0, s34, 12288
    s_add_u32 s35, s48, 0
    buffer_load_dwordx4 v245, s[64:67], s35 offen  lds
    ds_read_b64_tr_b16 v[60:61], v2 offset:49152
    s_add_u32 m0, s34, 16384
    s_add_u32 s35, s48, 65536
    buffer_load_dwordx4 v245, s[64:67], s35 offen  lds
    ds_read_b64_tr_b16 v[62:63], v6 offset:49152
    s_add_u32 m0, s34, 20480
    s_add_u32 s35, s48, 131072
    buffer_load_dwordx4 v245, s[64:67], s35 offen  lds
    ds_read_b64_tr_b16 v[64:65], v3 offset:36864
    s_add_u32 m0, s34, 110592
    s_add_u32 s35, s48, 196608
    buffer_load_dwordx4 v245, s[64:67], s35 offen  lds
    ds_read_b64_tr_b16 v[66:67], v7 offset:36864
    s_add_u32 m0, s34, 114688
    s_add_u32 s35, s49, 0
    buffer_load_dwordx4 v245, s[64:67], s35 offen  lds
    ds_read_b64_tr_b16 v[68:69], v3 offset:40960
    s_add_u32 m0, s34, 118784
    s_add_u32 s35, s49, 65536
    buffer_load_dwordx4 v245, s[64:67], s35 offen  lds
    ds_read_b64_tr_b16 v[70:71], v7 offset:40960
    s_add_u32 m0, s34, 122880
    s_add_u32 s35, s49, 131072
    buffer_load_dwordx4 v245, s[64:67], s35 offen  lds
    ds_read_b64_tr_b16 v[72:73], v3 offset:45056
    s_add_u32 m0, s34, 24576
    s_add_u32 s35, s49, 196608
    buffer_load_dwordx4 v245, s[64:67], s35 offen  lds
    ds_read_b64_tr_b16 v[74:75], v7 offset:45056
    s_add_u32 m0, s34, 28672
    s_add_u32 s35, s50, 0
    buffer_load_dwordx4 v245, s[64:67], s35 offen  lds
    ds_read_b64_tr_b16 v[76:77], v3 offset:49152
    s_add_u32 m0, s34, 32768
    s_add_u32 s35, s50, 65536
    buffer_load_dwordx4 v245, s[64:67], s35 offen  lds
    ds_read_b64_tr_b16 v[78:79], v7 offset:49152
    s_waitcnt vmcnt(0)
    s_mov_b64 exec, 1
    ds_add_u32 v10, v11 offset:16
    s_mov_b64 exec, -1
    s_mov_b64 exec, 0xffffffff
    s_mov_b32 s79, 0
LB_po:
    buffer_load_dword v14, v247, s[52:55], s30 offen sc1
    s_add_u32 s79, s79, 1
    s_cmp_gt_u32 s79, 200000
    s_cbranch_scc1 LB_po_x
    s_waitcnt vmcnt(0)
    v_cmp_ne_u32 vcc, 1, v14
    s_cbranch_vccz LB_po_x
    s_mov_b64 exec, vcc
    s_sleep 4
    s_branch LB_po
LB_po_x:
    s_waitcnt vmcnt(0)
    s_mov_b64 exec, -1
    ds_read_b32 v222, v10 offset:16
    buffer_load_dwordx4 v[96:99], v12, s[52:55], s36 offen offset:0 sc1
    buffer_load_dwordx4 v[100:103], v12, s[52:55], s36 offen offset:1024 sc1
    buffer_load_dwordx4 v[104:107], v12, s[52:55], s36 offen offset:2048 sc1
    buffer_load_dwordx4 v[108:111], v12, s[52:55], s36 offen offset:3072 sc1
    buffer_load_dwordx4 v[112:115], v15, s[52:55], s36 offen offset:0 sc1
    buffer_load_dwordx4 v[116:119], v15, s[52:55], s36 offen offset:1024 sc1
    buffer_load_dwordx4 v[120:123], v15, s[52:55], s36 offen offset:2048 sc1
    buffer_load_dwordx4 v[124:127], v15, s[52:55], s36 offen offset:3072 sc1
    buffer_load_dwordx4 v[128:131], v12, s[52:55], s37 offen offset:0 sc1
    buffer_load_dwordx4 v[132:135], v12, s[52:55], s37 offen offset:1024 sc1
    s_setprio 1
    s_waitcnt lgkmcnt(0)
    v_cmp_gt_u32 vcc, 4, v222
    s_cbranch_vccnz LB_w4
LB_g4:
    s_waitcnt vmcnt(9)
    v_mfma_f32_16x16x32_bf16 v[16:19], v[48:51], v[96:99], 0
    buffer_load_dwordx4 v[136:139], v12, s[52:55], s37 offen offset:2048 sc1
    buffer_load_dwordx4 v[140:143], v12, s[52:55], s37 offen offset:3072 sc1
    s_waitcnt vmcnt(10)
    v_mfma_f32_16x16x32_bf16 v[16:19], v[52:55], v[100:103], v[16:19]
    buffer_load_dwordx4 v[144:147], v15, s[52:55], s37 offen offset:0 sc1
    s_waitcnt vmcnt(10)
    v_mfma_f32_16x16x32_bf16 v[16:19], v[56:59], v[104:107], v[16:19]
    buffer_load_dwordx4 v[148:151], v15, s[52:55], s37 offen offset:1024 sc1
    ds_read_b64_tr_b16 v[80:81], v4 offset:36864
    s_waitcnt vmcnt(10)
    v_mfma_f32_16x16x32_bf16 v[16:19], v[60:63], v[108:111], v[16:19]
    ds_read_b64_tr_b16 v[82:83], v8 offset:36864
    s_waitcnt vmcnt(6)
    v_mfma_f32_16x16x32_bf16 v[32:35], v[60:63], v[124:127], 0
    ds_read_b64_tr_b16 v[84:85], v4 offset:40960
    ds_read_b64_tr_b16 v[86:87], v8 offset:40960
    v_mfma_f32_16x16x32_bf16 v[32:35], v[56:59], v[120:123], v[32:35]
    ds_read_b64_tr_b16 v[88:89], v4 offset:45056
    v_mfma_f32_16x16x32_bf16 v[32:35], v[52:55], v[116:119], v[32:35]
    ds_read_b64_tr_b16 v[90:91], v8 offset:45056
    ds_read_b64_tr_b16 v[92:93], v4 offset:49152
    v_mfma_f32_16x16x32_bf16 v[32:35], v[48:51], v[112:115], v[32:35]
    ds_read_b64_tr_b16 v[94:95], v8 offset:49152
    v_mfma_f32_16x16x32_bf16 v[36:39], v[64:67], v[112:115], 0
    buffer_load_dwordx4 v[152:155], v15, s[52:55], s37 offen offset:2048 sc1
    buffer_load_dwordx4 v[156:159], v15, s[52:55], s37 offen offset:3072 sc1
    v_mfma_f32_16x16x32_bf16 v[36:39], v[68:71], v[116:119], v[36:39]
    buffer_load_dwordx4 v[160:163], v12, s[52:55], s38 offen offset:0 sc1
    v_mfma_f32_16x16x32_bf16 v[36:39], v[72:75], v[120:123], v[36:39]
    buffer_load_dwordx4 v[164:167], v12, s[52:55], s38 offen offset:1024 sc1
    ds_read_b64_tr_b16 v[48:49], v5 offset:36864
    v_mfma_f32_16x16x32_bf16 v[36:39], v[76:79], v[124:127], v[36:39]
    ds_read_b64_tr_b16 v[50:51], v9 offset:36864
    v_mfma_f32_16x16x32_bf16 v[20:23], v[76:79], v[108:111], 0
    ds_read_b64_tr_b16 v[52:53], v5 offset:40960
    ds_read_b64_tr_b16 v[54:55], v9 offset:40960
    v_mfma_f32_16x16x32_bf16 v[20:23], v[72:75], v[104:107], v[20:23]
    ds_read_b64_tr_b16 v[56:57], v5 offset:45056
    v_mfma_f32_16x16x32_bf16 v[20:23], v[68:71], v[100:103], v[20:23]
    ds_read_b64_tr_b16 v[58:59], v9 offset:45056
    ds_read_b64_tr_b16 v[60:61], v5 offset:49152
    v_mfma_f32_16x16x32_bf16 v[20:23], v[64:67], v[96:99], v[20:23]
    ds_read_b64_tr_b16 v[62:63], v9 offset:49152
    s_waitcnt lgkmcnt(14)
    v_mfma_f32_16x16x32_bf16 v[24:27], v[80:83], v[96:99], 0
    buffer_load_dwordx4 v[168:171], v12, s[52:55], s38 offen offset:2048 sc1
    buffer_load_dwordx4 v[172:175], v12, s[52:55], s38 offen offset:3072 sc1
    s_waitcnt lgkmcnt(12)
    v_mfma_f32_16x16x32_bf16 v[24:27], v[84:87], v[100:103], v[24:27]
    buffer_load_dwordx4 v[176:179], v15, s[52:55], s38 offen offset:0 sc1
    s_waitcnt lgkmcnt(10)
    v_mfma_f32_16x16x32_bf16 v[24:27], v[88:91], v[104:107], v[24:27]
    buffer_load_dwordx4 v[180:183], v15, s[52:55], s38 offen offset:1024 sc1
    ds_read_b64_tr_b16 v[64:65], v2 offset:53248
    s_waitcnt lgkmcnt(9)
    v_mfma_f32_16x16x32_bf16 v[24:27], v[92:95], v[108:111], v[24:27]
    ds_read_b64_tr_b16 v[66:67], v6 offset:53248
    v_mfma_f32_16x16x32_bf16 v[40:43], v[92:95], v[124:127], 0
    ds_read_b64_tr_b16 v[68:69], v2 offset:57344
    ds_read_b64_tr_b16 v[70:71], v6 offset:57344
    v_mfma_f32_16x16x32_bf16 v[40:43], v[88:91], v[120:123], v[40:43]
    ds_read_b64_tr_b16 v[72:73], v2 offset:61440
    v_mfma_f32_16x16x32_bf16 v[40:43], v[84:87], v[116:119], v[40:43]
    ds_read_b64_tr_b16 v[74:75], v6 offset:61440
    ds_read_b64_tr_b16 v[76:77], v224 offset:0
    v_mfma_f32_16x16x32_bf16 v[40:43], v[80:83], v[112:115], v[40:43]
    ds_read_b64_tr_b16 v[78:79], v228 offset:0
    s_waitcnt lgkmcnt(14)
    v_mfma_f32_16x16x32_bf16 v[44:47], v[48:51], v[112:115], 0
    buffer_load_dwordx4 v[184:187], v15, s[52:55], s38 offen offset:2048 sc1
    buffer_load_dwordx4 v[188:191], v15, s[52:55], s38 offen offset:3072 sc1
    s_waitcnt lgkmcnt(12)
    v_mfma_f32_16x16x32_bf16 v[44:47], v[52:55], v[116:119], v[44:47]
    ds_read_b64_tr_b16 v[80:81], v3 offset:53248
    s_waitcnt lgkmcnt(11)
    v_mfma_f32_16x16x32_bf16 v[44:47], v[56:59], v[120:123], v[44:47]
    ds_read_b64_tr_b16 v[82:83], v7 offset:53248
    s_waitcnt lgkmcnt(10)
    v_mfma_f32_16x16x32_bf16 v[44:47], v[60:63], v[124:127], v[44:47]
    ds_read_b64_tr_b16 v[84:85], v3 offset:57344
    v_mfma_f32_16x16x32_bf16 v[28:31], v[60:63], v[108:111], 0
    ds_read_b64_tr_b16 v[86:87], v7 offset:57344
    ds_read_b64_tr_b16 v[88:89], v3 offset:61440
    v_mfma_f32_16x16x32_bf16 v[28:31], v[56:59], v[104:107], v[28:31]
    ds_read_b64_tr_b16 v[90:91], v7 offset:61440
    v_mfma_f32_16x16x32_bf16 v[28:31], v[52:55], v[100:103], v[28:31]
    ds_read_b64_tr_b16 v[92:93], v225 offset:0
    v_mfma_f32_16x16x32_bf16 v[28:31], v[48:51], v[96:99], v[28:31]
    ds_read_b64_tr_b16 v[94:95], v229 offset:0
    s_waitcnt vmcnt(8) lgkmcnt(8)
    v_mfma_f32_16x16x32_bf16 v[16:19], v[64:67], v[128:131], v[16:19]
    buffer_load_dwordx4 v[96:99], v12, s[52:55], s39 offen offset:0 sc1
    buffer_load_dwordx4 v[100:103], v12, s[52:55], s39 offen offset:1024 sc1
    v_mfma_f32_16x16x32_bf16 v[16:19], v[68:71], v[132:135], v[16:19]
    ds_read_b64_tr_b16 v[48:49], v4 offset:53248
    v_mfma_f32_16x16x32_bf16 v[16:19], v[72:75], v[136:139], v[16:19]
    ds_read_b64_tr_b16 v[50:51], v8 offset:53248
    v_mfma_f32_16x16x32_bf16 v[16:19], v[76:79], v[140:143], v[16:19]
    ds_read_b64_tr_b16 v[52:53], v4 offset:57344
    v_mfma_f32_16x16x32_bf16 v[32:35], v[76:79], v[156:159], v[32:35]
    ds_read_b64_tr_b16 v[54:55], v8 offset:57344
    ds_read_b64_tr_b16 v[56:57], v4 offset:61440
    v_mfma_f32_16x16x32_bf16 v[32:35], v[72:75], v[152:155], v[32:35]
    ds_read_b64_tr_b16 v[58:59], v8 offset:61440
    v_mfma_f32_16x16x32_bf16 v[32:35], v[68:71], v[148:151], v[32:35]
    ds_read_b64_tr_b16 v[60:61], v226 offset:0
    v_mfma_f32_16x16x32_bf16 v[32:35], v[64:67], v[144:147], v[32:35]
    ds_read_b64_tr_b16 v[62:63], v230 offset:0
    s_waitcnt lgkmcnt(8)
    v_mfma_f32_16x16x32_bf16 v[36:39], v[80:83], v[144:147], v[36:39]
    buffer_load_dwordx4 v[104:107], v12, s[52:55], s39 offen offset:2048 sc1
    buffer_load_dwordx4 v[108:111], v12, s[52:55], s39 offen offset:3072 sc1
    v_mfma_f32_16x16x32_bf16 v[36:39], v[84:87], v[148:151], v[36:39]
    ds_read_b64_tr_b16 v[64:65], v5 offset:53248
    v_mfma_f32_16x16x32_bf16 v[36:39], v[88:91], v[152:155], v[36:39]
    ds_read_b64_tr_b16 v[66:67], v9 offset:53248
    v_mfma_f32_16x16x32_bf16 v[36:39], v[92:95], v[156:159], v[36:39]
    ds_read_b64_tr_b16 v[68:69], v5 offset:57344
    v_mfma_f32_16x16x32_bf16 v[20:23], v[92:95], v[140:143], v[20:23]
    ds_read_b64_tr_b16 v[70:71], v9 offset:57344
    ds_read_b64_tr_b16 v[72:73], v5 offset:61440
    v_mfma_f32_16x16x32_bf16 v[20:23], v[88:91], v[136:139], v[20:23]
    ds_read_b64_tr_b16 v[74:75], v9 offset:61440
    v_mfma_f32_16x16x32_bf16 v[20:23], v[84:87], v[132:135], v[20:23]
    ds_read_b64_tr_b16 v[76:77], v227 offset:0
    v_mfma_f32_16x16x32_bf16 v[20:23], v[80:83], v[128:131], v[20:23]
    ds_read_b64_tr_b16 v[78:79], v231 offset:0
    s_waitcnt lgkmcnt(8)
    v_mfma_f32_16x16x32_bf16 v[24:27], v[48:51], v[128:131], v[24:27]
    buffer_load_dwordx4 v[112:115], v15, s[52:55], s39 offen offset:0 sc1
    buffer_load_dwordx4 v[116:119], v15, s[52:55], s39 offen offset:1024 sc1
    v_mfma_f32_16x16x32_bf16 v[24:27], v[52:55], v[132:135], v[24:27]
    ds_read_b64_tr_b16 v[80:81], v224 offset:4096
    v_mfma_f32_16x16x32_bf16 v[24:27], v[56:59], v[136:139], v[24:27]
    ds_read_b64_tr_b16 v[82:83], v228 offset:4096
    v_mfma_f32_16x16x32_bf16 v[24:27], v[60:63], v[140:143], v[24:27]
    ds_read_b64_tr_b16 v[84:85], v224 offset:8192
    v_mfma_f32_16x16x32_bf16 v[40:43], v[60:63], v[156:159], v[40:43]
    ds_read_b64_tr_b16 v[86:87], v228 offset:8192
    ds_read_b64_tr_b16 v[88:89], v224 offset:12288
    v_mfma_f32_16x16x32_bf16 v[40:43], v[56:59], v[152:155], v[40:43]
    ds_read_b64_tr_b16 v[90:91], v228 offset:12288
    v_mfma_f32_16x16x32_bf16 v[40:43], v[52:55], v[148:151], v[40:43]
    ds_read_b64_tr_b16 v[92:93], v224 offset:16384
    v_mfma_f32_16x16x32_bf16 v[40:43], v[48:51], v[144:147], v[40:43]
    ds_read_b64_tr_b16 v[94:95], v228 offset:16384
    s_waitcnt lgkmcnt(8)
    v_mfma_f32_16x16x32_bf16 v[44:47], v[64:67], v[144:147], v[44:47]
    buffer_load_dwordx4 v[120:123], v15, s[52:55], s39 offen offset:2048 sc1
    buffer_load_dwordx4 v[124:127], v15, s[52:55], s39 offen offset:3072 sc1
    v_mfma_f32_16x16x32_bf16 v[44:47], v[68:71], v[148:151], v[44:47]
    ds_read_b64_tr_b16 v[48:49], v225 offset:4096
    v_mfma_f32_16x16x32_bf16 v[44:47], v[72:75], v[152:155], v[44:47]
    ds_read_b64_tr_b16 v[50:51], v229 offset:4096
    v_mfma_f32_16x16x32_bf16 v[44:47], v[76:79], v[156:159], v[44:47]
    ds_read_b64_tr_b16 v[52:53], v225 offset:8192
    v_mfma_f32_16x16x32_bf16 v[28:31], v[76:79], v[140:143], v[28:31]
    ds_read_b64_tr_b16 v[54:55], v229 offset:8192
    ds_read_b64_tr_b16 v[56:57], v225 offset:12288
    v_mfma_f32_16x16x32_bf16 v[28:31], v[72:75], v[136:139], v[28:31]
    ds_read_b64_tr_b16 v[58:59], v229 offset:12288
    v_mfma_f32_16x16x32_bf16 v[28:31], v[68:71], v[132:135], v[28:31]
    ds_read_b64_tr_b16 v[60:61], v225 offset:16384
    v_mfma_f32_16x16x32_bf16 v[28:31], v[64:67], v[128:131], v[28:31]
    ds_read_b64_tr_b16 v[62:63], v229 offset:16384
    s_waitcnt vmcnt(8) lgkmcnt(8)
    v_mfma_f32_16x16x32_bf16 v[16:19], v[80:83], v[160:163], v[16:19]
    buffer_load_dwordx4 v[128:131], v12, s[52:55], s40 offen offset:0 sc1
    buffer_load_dwordx4 v[132:135], v12, s[52:55], s40 offen offset:1024 sc1
    v_mfma_f32_16x16x32_bf16 v[16:19], v[84:87], v[164:167], v[16:19]
    ds_read_b64_tr_b16 v[64:65], v226 offset:4096
    v_mfma_f32_16x16x32_bf16 v[16:19], v[88:91], v[168:171], v[16:19]
    ds_read_b64_tr_b16 v[66:67], v230 offset:4096
    v_mfma_f32_16x16x32_bf16 v[16:19], v[92:95], v[172:175], v[16:19]
    ds_read_b64_tr_b16 v[68:69], v226 offset:8192
    v_mfma_f32_16x16x32_bf16 v[32:35], v[92:95], v[188:191], v[32:35]
    ds_read_b64_tr_b16 v[70:71], v230 offset:8192
    ds_read_b64_tr_b16 v[72:73], v226 offset:12288
    v_mfma_f32_16x16x32_bf16 v[32:35], v[88:91], v[184:187], v[32:35]
    ds_read_b64_tr_b16 v[74:75], v230 offset:12288
    v_mfma_f32_16x16x32_bf16 v[32:35], v[84:87], v[180:183], v[32:35]
    ds_read_b64_tr_b16 v[76:77], v226 offset:16384
    v_mfma_f32_16x16x32_bf16 v[32:35], v[80:83], v[176:179], v[32:35]
    ds_read_b64_tr_b16 v[78:79], v230 offset:16384
    s_waitcnt lgkmcnt(8)
    v_mfma_f32_16x16x32_bf16 v[36:39], v[48:51], v[176:179], v[36:39]
    buffer_load_dwordx4 v[136:139], v12, s[52:55], s40 offen offset:2048 sc1
    buffer_load_dwordx4 v[140:143], v12, s[52:55], s40 offen offset:3072 sc1
    v_mfma_f32_16x16x32_bf16 v[36:39], v[52:55], v[180:183], v[36:39]
    ds_read_b64_tr_b16 v[80:81], v227 offset:4096
    v_mfma_f32_16x16x32_bf16 v[36:39], v[56:59], v[184:187], v[36:39]
    ds_read_b64_tr_b16 v[82:83], v231 offset:4096
    v_mfma_f32_16x16x32_bf16 v[36:39], v[60:63], v[188:191], v[36:39]
    ds_read_b64_tr_b16 v[84:85], v227 offset:8192
    v_mfma_f32_16x16x32_bf16 v[20:23], v[60:63], v[172:175], v[20:23]
    ds_read_b64_tr_b16 v[86:87], v231 offset:8192
    ds_read_b64_tr_b16 v[88:89], v227 offset:12288
    v_mfma_f32_16x16x32_bf16 v[20:23], v[56:59], v[168:171], v[20:23]
    ds_read_b64_tr_b16 v[90:91], v231 offset:12288
    v_mfma_f32_16x16x32_bf16 v[20:23], v[52:55], v[164:167], v[20:23]
    ds_read_b64_tr_b16 v[92:93], v227 offset:16384
    v_mfma_f32_16x16x32_bf16 v[20:23], v[48:51], v[160:163], v[20:23]
    ds_read_b64_tr_b16 v[94:95], v231 offset:16384
    s_waitcnt lgkmcnt(8)
    v_mfma_f32_16x16x32_bf16 v[24:27], v[64:67], v[160:163], v[24:27]
    buffer_load_dwordx4 v[144:147], v15, s[52:55], s40 offen offset:0 sc1
    buffer_load_dwordx4 v[148:151], v15, s[52:55], s40 offen offset:1024 sc1
    v_mfma_f32_16x16x32_bf16 v[24:27], v[68:71], v[164:167], v[24:27]
    ds_read_b64_tr_b16 v[48:49], v224 offset:20480
    v_mfma_f32_16x16x32_bf16 v[24:27], v[72:75], v[168:171], v[24:27]
    ds_read_b64_tr_b16 v[50:51], v228 offset:20480
    v_mfma_f32_16x16x32_bf16 v[24:27], v[76:79], v[172:175], v[24:27]
    ds_read_b64_tr_b16 v[52:53], v2 offset:0
    v_mfma_f32_16x16x32_bf16 v[40:43], v[76:79], v[188:191], v[40:43]
    ds_read_b64_tr_b16 v[54:55], v6 offset:0
    ds_read_b64_tr_b16 v[56:57], v2 offset:4096
    v_mfma_f32_16x16x32_bf16 v[40:43], v[72:75], v[184:187], v[40:43]
    ds_read_b64_tr_b16 v[58:59], v6 offset:4096
    v_mfma_f32_16x16x32_bf16 v[40:43], v[68:71], v[180:183], v[40:43]
    ds_read_b64_tr_b16 v[60:61], v2 offset:8192
    v_mfma_f32_16x16x32_bf16 v[40:43], v[64:67], v[176:179], v[40:43]
    ds_read_b64_tr_b16 v[62:63], v6 offset:8192
    s_waitcnt lgkmcnt(8)
    v_mfma_f32_16x16x32_bf16 v[44:47], v[80:83], v[176:179], v[44:47]
    buffer_load_dwordx4 v[152:155], v15, s[52:55], s40 offen offset:2048 sc1
    buffer_load_dwordx4 v[156:159], v15, s[52:55], s40 offen offset:3072 sc1
    v_mfma_f32_16x16x32_bf16 v[44:47], v[84:87], v[180:183], v[44:47]
    ds_read_b64_tr_b16 v[64:65], v225 offset:20480
    v_mfma_f32_16x16x32_bf16 v[44:47], v[88:91], v[184:187], v[44:47]
    ds_read_b64_tr_b16 v[66:67], v229 offset:20480
    v_mfma_f32_16x16x32_bf16 v[44:47], v[92:95], v[188:191], v[44:47]
    ds_read_b64_tr_b16 v[68:69], v3 offset:0
    v_mfma_f32_16x16x32_bf16 v[28:31], v[92:95], v[172:175], v[28:31]
    ds_read_b64_tr_b16 v[70:71], v7 offset:0
    ds_read_b64_tr_b16 v[72:73], v3 offset:4096
    v_mfma_f32_16x16x32_bf16 v[28:31], v[88:91], v[168:171], v[28:31]
    ds_read_b64_tr_b16 v[74:75], v7 offset:4096
    v_mfma_f32_16x16x32_bf16 v[28:31], v[84:87], v[164:167], v[28:31]
    ds_read_b64_tr_b16 v[76:77], v3 offset:8192
    v_mfma_f32_16x16x32_bf16 v[28:31], v[80:83], v[160:163], v[28:31]
    ds_read_b64_tr_b16 v[78:79], v7 offset:8192
    s_waitcnt vmcnt(8) lgkmcnt(8)
    v_mfma_f32_16x16x32_bf16 v[16:19], v[48:51], v[96:99], v[16:19]
    buffer_load_dwordx4 v[160:163], v12, s[52:55], s41 offen offset:0 sc1
    buffer_load_dwordx4 v[164:167], v12, s[52:55], s41 offen offset:1024 sc1
    v_mfma_f32_16x16x32_bf16 v[16:19], v[52:55], v[100:103], v[16:19]
    ds_read_b64_tr_b16 v[80:81], v226 offset:20480
    v_mfma_f32_16x16x32_bf16 v[16:19], v[56:59], v[104:107], v[16:19]
    ds_read_b64_tr_b16 v[82:83], v230 offset:20480
    v_mfma_f32_16x16x32_bf16 v[16:19], v[60:63], v[108:111], v[16:19]
    ds_read_b64_tr_b16 v[84:85], v4 offset:0
    v_mfma_f32_16x16x32_bf16 v[32:35], v[60:63], v[124:127], v[32:35]
    ds_read_b64_tr_b16 v[86:87], v8 offset:0
    ds_read_b64_tr_b16 v[88:89], v4 offset:4096
    v_mfma_f32_16x16x32_bf16 v[32:35], v[56:59], v[120:123], v[32:35]
    ds_read_b64_tr_b16 v[90:91], v8 offset:4096
    v_mfma_f32_16x16x32_bf16 v[32:35], v[52:55], v[116:119], v[32:35]
    ds_read_b64_tr_b16 v[92:93], v4 offset:8192
    v_mfma_f32_16x16x32_bf16 v[32:35], v[48:51], v[112:115], v[32:35]
    ds_read_b64_tr_b16 v[94:95], v8 offset:8192
    s_waitcnt lgkmcnt(8)
    v_mfma_f32_16x16x32_bf16 v[36:39], v[64:67], v[112:115], v[36:39]
    buffer_load_dwordx4 v[168:171], v12, s[52:55], s41 offen offset:2048 sc1
    buffer_load_dwordx4 v[172:175], v12, s[52:55], s41 offen offset:3072 sc1
    v_mfma_f32_16x16x32_bf16 v[36:39], v[68:71], v[116:119], v[36:39]
    ds_read_b64_tr_b16 v[48:49], v227 offset:20480
    v_mfma_f32_16x16x32_bf16 v[36:39], v[72:75], v[120:123], v[36:39]
    ds_read_b64_tr_b16 v[50:51], v231 offset:20480
    v_mfma_f32_16x16x32_bf16 v[36:39], v[76:79], v[124:127], v[36:39]
    ds_read_b64_tr_b16 v[52:53], v5 offset:0
    v_mfma_f32_16x16x32_bf16 v[20:23], v[76:79], v[108:111], v[20:23]
    ds_read_b64_tr_b16 v[54:55], v9 offset:0
    ds_read_b64_tr_b16 v[56:57], v5 offset:4096
    v_mfma_f32_16x16x32_bf16 v[20:23], v[72:75], v[104:107], v[20:23]
    ds_read_b64_tr_b16 v[58:59], v9 offset:4096
    v_mfma_f32_16x16x32_bf16 v[20:23], v[68:71], v[100:103], v[20:23]
    ds_read_b64_tr_b16 v[60:61], v5 offset:8192
    v_mfma_f32_16x16x32_bf16 v[20:23], v[64:67], v[96:99], v[20:23]
    ds_read_b64_tr_b16 v[62:63], v9 offset:8192
    s_waitcnt lgkmcnt(8)
    v_mfma_f32_16x16x32_bf16 v[24:27], v[80:83], v[96:99], v[24:27]
    buffer_load_dwordx4 v[176:179], v15, s[52:55], s41 offen offset:0 sc1
    buffer_load_dwordx4 v[180:183], v15, s[52:55], s41 offen offset:1024 sc1
    v_mfma_f32_16x16x32_bf16 v[24:27], v[84:87], v[100:103], v[24:27]
    ds_read_b64_tr_b16 v[64:65], v2 offset:12288
    v_mfma_f32_16x16x32_bf16 v[24:27], v[88:91], v[104:107], v[24:27]
    ds_read_b64_tr_b16 v[66:67], v6 offset:12288
    v_mfma_f32_16x16x32_bf16 v[24:27], v[92:95], v[108:111], v[24:27]
    ds_read_b64_tr_b16 v[68:69], v2 offset:16384
    v_mfma_f32_16x16x32_bf16 v[40:43], v[92:95], v[124:127], v[40:43]
    ds_read_b64_tr_b16 v[70:71], v6 offset:16384
    ds_read_b64_tr_b16 v[72:73], v2 offset:20480
    v_mfma_f32_16x16x32_bf16 v[40:43], v[88:91], v[120:123], v[40:43]
    ds_read_b64_tr_b16 v[74:75], v6 offset:20480
    v_mfma_f32_16x16x32_bf16 v[40:43], v[84:87], v[116:119], v[40:43]
    ds_read_b64_tr_b16 v[76:77], v224 offset:45056
    v_mfma_f32_16x16x32_bf16 v[40:43], v[80:83], v[112:115], v[40:43]
    ds_read_b64_tr_b16 v[78:79], v228 offset:45056
    s_mov_b64 exec, 1
    ds_add_u32 v10, v11 offset:28
    s_mov_b64 exec, -1
    s_waitcnt lgkmcnt(9)
    v_mfma_f32_16x16x32_bf16 v[44:47], v[48:51], v[112:115], v[44:47]
    buffer_load_dwordx4 v[184:187], v15, s[52:55], s41 offen offset:2048 sc1
    buffer_load_dwordx4 v[188:191], v15, s[52:55], s41 offen offset:3072 sc1
    v_mfma_f32_16x16x32_bf16 v[44:47], v[52:55], v[116:119], v[44:47]
    ds_read_b64_tr_b16 v[80:81], v3 offset:12288
    v_mfma_f32_16x16x32_bf16 v[44:47], v[56:59], v[120:123], v[44:47]
    ds_read_b64_tr_b16 v[82:83], v7 offset:12288
    v_mfma_f32_16x16x32_bf16 v[44:47], v[60:63], v[124:127], v[44:47]
    ds_read_b64_tr_b16 v[84:85], v3 offset:16384
    v_mfma_f32_16x16x32_bf16 v[28:31], v[60:63], v[108:111], v[28:31]
    ds_read_b64_tr_b16 v[86:87], v7 offset:16384
    ds_read_b64_tr_b16 v[88:89], v3 offset:20480
    v_mfma_f32_16x16x32_bf16 v[28:31], v[56:59], v[104:107], v[28:31]
    ds_read_b64_tr_b16 v[90:91], v7 offset:20480
    v_mfma_f32_16x16x32_bf16 v[28:31], v[52:55], v[100:103], v[28:31]
    ds_read_b64_tr_b16 v[92:93], v225 offset:45056
    v_mfma_f32_16x16x32_bf16 v[28:31], v[48:51], v[96:99], v[28:31]
    ds_read_b64_tr_b16 v[94:95], v229 offset:45056
    s_waitcnt vmcnt(8) lgkmcnt(9)
    v_mfma_f32_16x16x32_bf16 v[16:19], v[64:67], v[128:131], v[16:19]
    buffer_load_dwordx4 v[96:99], v12, s[52:55], s42 offen offset:0 sc1
    buffer_load_dwordx4 v[100:103], v12, s[52:55], s42 offen offset:1024 sc1
    v_mfma_f32_16x16x32_bf16 v[16:19], v[68:71], v[132:135], v[16:19]
    ds_read_b64_tr_b16 v[48:49], v4 offset:12288
    v_mfma_f32_16x16x32_bf16 v[16:19], v[72:75], v[136:139], v[16:19]
    ds_read_b64_tr_b16 v[50:51], v8 offset:12288
    v_mfma_f32_16x16x32_bf16 v[16:19], v[76:79], v[140:143], v[16:19]
    ds_read_b64_tr_b16 v[52:53], v4 offset:16384
    v_mfma_f32_16x16x32_bf16 v[32:35], v[76:79], v[156:159], v[32:35]
    ds_read_b64_tr_b16 v[54:55], v8 offset:16384
    ds_read_b64_tr_b16 v[56:57], v4 offset:20480
    v_mfma_f32_16x16x32_bf16 v[32:35], v[72:75], v[152:155], v[32:35]
    ds_read_b64_tr_b16 v[58:59], v8 offset:20480
    v_mfma_f32_16x16x32_bf16 v[32:35], v[68:71], v[148:151], v[32:35]
    ds_read_b64_tr_b16 v[60:61], v226 offset:45056
    v_mfma_f32_16x16x32_bf16 v[32:35], v[64:67], v[144:147], v[32:35]
    ds_read_b64_tr_b16 v[62:63], v230 offset:45056
    s_waitcnt lgkmcnt(8)
    v_mfma_f32_16x16x32_bf16 v[36:39], v[80:83], v[144:147], v[36:39]
    buffer_load_dwordx4 v[104:107], v12, s[52:55], s42 offen offset:2048 sc1
    buffer_load_dwordx4 v[108:111], v12, s[52:55], s42 offen offset:3072 sc1
    v_mfma_f32_16x16x32_bf16 v[36:39], v[84:87], v[148:151], v[36:39]
    ds_read_b64_tr_b16 v[64:65], v5 offset:12288
    v_mfma_f32_16x16x32_bf16 v[36:39], v[88:91], v[152:155], v[36:39]
    ds_read_b64_tr_b16 v[66:67], v9 offset:12288
    v_mfma_f32_16x16x32_bf16 v[36:39], v[92:95], v[156:159], v[36:39]
    ds_read_b64_tr_b16 v[68:69], v5 offset:16384
    v_mfma_f32_16x16x32_bf16 v[20:23], v[92:95], v[140:143], v[20:23]
    ds_read_b64_tr_b16 v[70:71], v9 offset:16384
    ds_read_b64_tr_b16 v[72:73], v5 offset:20480
    v_mfma_f32_16x16x32_bf16 v[20:23], v[88:91], v[136:139], v[20:23]
    ds_read_b64_tr_b16 v[74:75], v9 offset:20480
    v_mfma_f32_16x16x32_bf16 v[20:23], v[84:87], v[132:135], v[20:23]
    ds_read_b64_tr_b16 v[76:77], v227 offset:45056
    v_mfma_f32_16x16x32_bf16 v[20:23], v[80:83], v[128:131], v[20:23]
    ds_read_b64_tr_b16 v[78:79], v231 offset:45056
    s_waitcnt lgkmcnt(8)
    v_mfma_f32_16x16x32_bf16 v[24:27], v[48:51], v[128:131], v[24:27]
    buffer_load_dwordx4 v[112:115], v15, s[52:55], s42 offen offset:0 sc1
    buffer_load_dwordx4 v[116:119], v15, s[52:55], s42 offen offset:1024 sc1
    v_mfma_f32_16x16x32_bf16 v[24:27], v[52:55], v[132:135], v[24:27]
    ds_read_b64_tr_b16 v[80:81], v224 offset:49152
    v_mfma_f32_16x16x32_bf16 v[24:27], v[56:59], v[136:139], v[24:27]
    ds_read_b64_tr_b16 v[82:83], v228 offset:49152
    v_mfma_f32_16x16x32_bf16 v[24:27], v[60:63], v[140:143], v[24:27]
    ds_read_b64_tr_b16 v[84:85], v224 offset:53248
    v_mfma_f32_16x16x32_bf16 v[40:43], v[60:63], v[156:159], v[40:43]
    ds_read_b64_tr_b16 v[86:87], v228 offset:53248
    ds_read_b64_tr_b16 v[88:89], v224 offset:57344
    v_mfma_f32_16x16x32_bf16 v[40:43], v[56:59], v[152:155], v[40:43]
    ds_read_b64_tr_b16 v[90:91], v228 offset:57344
    v_mfma_f32_16x16x32_bf16 v[40:43], v[52:55], v[148:151], v[40:43]
    ds_read_b64_tr_b16 v[92:93], v2 offset:24576
    v_mfma_f32_16x16x32_bf16 v[40:43], v[48:51], v[144:147], v[40:43]
    ds_read_b64_tr_b16 v[94:95], v6 offset:24576
    s_waitcnt lgkmcnt(8)
    v_mfma_f32_16x16x32_bf16 v[44:47], v[64:67], v[144:147], v[44:47]
    buffer_load_dwordx4 v[120:123], v15, s[52:55], s42 offen offset:2048 sc1
    buffer_load_dwordx4 v[124:127], v15, s[52:55], s42 offen offset:3072 sc1
    v_mfma_f32_16x16x32_bf16 v[44:47], v[68:71], v[148:151], v[44:47]
    ds_read_b64_tr_b16 v[48:49], v225 offset:49152
    v_mfma_f32_16x16x32_bf16 v[44:47], v[72:75], v[152:155], v[44:47]
    ds_read_b64_tr_b16 v[50:51], v229 offset:49152
    v_mfma_f32_16x16x32_bf16 v[44:47], v[76:79], v[156:159], v[44:47]
    ds_read_b64_tr_b16 v[52:53], v225 offset:53248
    v_mfma_f32_16x16x32_bf16 v[28:31], v[76:79], v[140:143], v[28:31]
    ds_read_b64_tr_b16 v[54:55], v229 offset:53248
    ds_read_b64_tr_b16 v[56:57], v225 offset:57344
    v_mfma_f32_16x16x32_bf16 v[28:31], v[72:75], v[136:139], v[28:31]
    ds_read_b64_tr_b16 v[58:59], v229 offset:57344
    v_mfma_f32_16x16x32_bf16 v[28:31], v[68:71], v[132:135], v[28:31]
    ds_read_b64_tr_b16 v[60:61], v3 offset:24576
    v_mfma_f32_16x16x32_bf16 v[28:31], v[64:67], v[128:131], v[28:31]
    ds_read_b64_tr_b16 v[62:63], v7 offset:24576
    s_waitcnt vmcnt(8) lgkmcnt(8)
    v_mfma_f32_16x16x32_bf16 v[16:19], v[80:83], v[160:163], v[16:19]
    buffer_load_dwordx4 v[128:131], v12, s[52:55], s43 offen offset:0 sc1
    buffer_load_dwordx4 v[132:135], v12, s[52:55], s43 offen offset:1024 sc1
    v_mfma_f32_16x16x32_bf16 v[16:19], v[84:87], v[164:167], v[16:19]
    ds_read_b64_tr_b16 v[64:65], v226 offset:49152
    v_mfma_f32_16x16x32_bf16 v[16:19], v[88:91], v[168:171], v[16:19]
    ds_read_b64_tr_b16 v[66:67], v230 offset:49152
    v_mfma_f32_16x16x32_bf16 v[16:19], v[92:95], v[172:175], v[16:19]
    ds_read_b64_tr_b16 v[68:69], v226 offset:53248
    v_mfma_f32_16x16x32_bf16 v[32:35], v[92:95], v[188:191], v[32:35]
    ds_read_b64_tr_b16 v[70:71], v230 offset:53248
    ds_read_b64_tr_b16 v[72:73], v226 offset:57344
    v_mfma_f32_16x16x32_bf16 v[32:35], v[88:91], v[184:187], v[32:35]
    ds_read_b64_tr_b16 v[74:75], v230 offset:57344
    v_mfma_f32_16x16x32_bf16 v[32:35], v[84:87], v[180:183], v[32:35]
    ds_read_b64_tr_b16 v[76:77], v4 offset:24576
    v_mfma_f32_16x16x32_bf16 v[32:35], v[80:83], v[176:179], v[32:35]
    ds_read_b64_tr_b16 v[78:79], v8 offset:24576
    s_mov_b64 exec, 1
    ds_add_u32 v10, v11 offset:40
    s_mov_b64 exec, -1
    s_waitcnt lgkmcnt(9)
    v_mfma_f32_16x16x32_bf16 v[36:39], v[48:51], v[176:179], v[36:39]
    buffer_load_dwordx4 v[136:139], v12, s[52:55], s43 offen offset:2048 sc1
    buffer_load_dwordx4 v[140:143], v12, s[52:55], s43 offen offset:3072 sc1
    v_mfma_f32_16x16x32_bf16 v[36:39], v[52:55], v[180:183], v[36:39]
    ds_read_b32 v223, v10 offset:32
    v_mfma_f32_16x16x32_bf16 v[36:39], v[56:59], v[184:187], v[36:39]
    ds_read_b64_tr_b16 v[80:81], v227 offset:49152
    ds_read_b64_tr_b16 v[82:83], v231 offset:49152
    v_mfma_f32_16x16x32_bf16 v[36:39], v[60:63], v[188:191], v[36:39]
    ds_read_b64_tr_b16 v[84:85], v227 offset:53248
    v_mfma_f32_16x16x32_bf16 v[20:23], v[60:63], v[172:175], v[20:23]
    ds_read_b64_tr_b16 v[86:87], v231 offset:53248
    v_mfma_f32_16x16x32_bf16 v[20:23], v[56:59], v[168:171], v[20:23]
    ds_read_b64_tr_b16 v[88:89], v227 offset:57344
    ds_read_b64_tr_b16 v[90:91], v231 offset:57344
    v_mfma_f32_16x16x32_bf16 v[20:23], v[52:55], v[164:167], v[20:23]
    ds_read_b64_tr_b16 v[92:93], v5 offset:24576
    v_mfma_f32_16x16x32_bf16 v[20:23], v[48:51], v[160:163], v[20:23]
    ds_read_b64_tr_b16 v[94:95], v9 offset:24576
    s_waitcnt lgkmcnt(8)
    v_cmp_gt_u32 vcc, 4, v223
    s_cbranch_vccnz LB_w8
LB_g8:
    v_mfma_f32_16x16x32_bf16 v[24:27], v[64:67], v[160:163], v[24:27]
    buffer_load_dwordx4 v[144:147], v15, s[52:55], s43 offen offset:0 sc1
    buffer_load_dwordx4 v[148:151], v15, s[52:55], s43 offen offset:1024 sc1
    v_mfma_f32_16x16x32_bf16 v[24:27], v[68:71], v[164:167], v[24:27]
    ds_read_b64_tr_b16 v[48:49], v2 offset:28672
    v_mfma_f32_16x16x32_bf16 v[24:27], v[72:75], v[168:171], v[24:27]
    ds_read_b64_tr_b16 v[50:51], v6 offset:28672
    v_mfma_f32_16x16x32_bf16 v[24:27], v[76:79], v[172:175], v[24:27]
    ds_read_b64_tr_b16 v[52:53], v2 offset:32768
    v_mfma_f32_16x16x32_bf16 v[40:43], v[76:79], v[188:191], v[40:43]
    ds_read_b64_tr_b16 v[54:55], v6 offset:32768
    ds_read_b64_tr_b16 v[56:57], v232 offset:0
    v_mfma_f32_16x16x32_bf16 v[40:43], v[72:75], v[184:187], v[40:43]
    ds_read_b64_tr_b16 v[58:59], v236 offset:0
    v_mfma_f32_16x16x32_bf16 v[40:43], v[68:71], v[180:183], v[40:43]
    ds_read_b64_tr_b16 v[60:61], v232 offset:4096
    v_mfma_f32_16x16x32_bf16 v[40:43], v[64:67], v[176:179], v[40:43]
    ds_read_b64_tr_b16 v[62:63], v236 offset:4096
    s_waitcnt lgkmcnt(8)
    v_mfma_f32_16x16x32_bf16 v[44:47], v[80:83], v[176:179], v[44:47]
    buffer_load_dwordx4 v[152:155], v15, s[52:55], s43 offen offset:2048 sc1
    buffer_load_dwordx4 v[156:159], v15, s[52:55], s43 offen offset:3072 sc1
    v_mfma_f32_16x16x32_bf16 v[44:47], v[84:87], v[180:183], v[44:47]
    ds_read_b64_tr_b16 v[64:65], v3 offset:28672
    v_mfma_f32_16x16x32_bf16 v[44:47], v[88:91], v[184:187], v[44:47]
    ds_read_b64_tr_b16 v[66:67], v7 offset:28672
    v_mfma_f32_16x16x32_bf16 v[44:47], v[92:95], v[188:191], v[44:47]
    ds_read_b64_tr_b16 v[68:69], v3 offset:32768
    v_mfma_f32_16x16x32_bf16 v[28:31], v[92:95], v[172:175], v[28:31]
    ds_read_b64_tr_b16 v[70:71], v7 offset:32768
    ds_read_b64_tr_b16 v[72:73], v233 offset:0
    v_mfma_f32_16x16x32_bf16 v[28:31], v[88:91], v[168:171], v[28:31]
    ds_read_b64_tr_b16 v[74:75], v237 offset:0
    v_mfma_f32_16x16x32_bf16 v[28:31], v[84:87], v[164:167], v[28:31]
    ds_read_b64_tr_b16 v[76:77], v233 offset:4096
    v_mfma_f32_16x16x32_bf16 v[28:31], v[80:83], v[160:163], v[28:31]
    ds_read_b64_tr_b16 v[78:79], v237 offset:4096
    s_waitcnt vmcnt(8) lgkmcnt(8)
    v_mfma_f32_16x16x32_bf16 v[16:19], v[48:51], v[96:99], v[16:19]
    ds_read_b64_tr_b16 v[80:81], v4 offset:28672
    v_mfma_f32_16x16x32_bf16 v[16:19], v[52:55], v[100:103], v[16:19]
    ds_read_b64_tr_b16 v[82:83], v8 offset:28672
    v_mfma_f32_16x16x32_bf16 v[16:19], v[56:59], v[104:107], v[16:19]
    ds_read_b64_tr_b16 v[84:85], v4 offset:32768
    v_mfma_f32_16x16x32_bf16 v[16:19], v[60:63], v[108:111], v[16:19]
    ds_read_b64_tr_b16 v[86:87], v8 offset:32768
    v_mfma_f32_16x16x32_bf16 v[32:35], v[60:63], v[124:127], v[32:35]
    ds_read_b64_tr_b16 v[88:89], v234 offset:0
    v_mfma_f32_16x16x32_bf16 v[32:35], v[56:59], v[120:123], v[32:35]
    ds_read_b64_tr_b16 v[90:91], v238 offset:0
    v_mfma_f32_16x16x32_bf16 v[32:35], v[52:55], v[116:119], v[32:35]
    ds_read_b64_tr_b16 v[92:93], v234 offset:4096
    v_mfma_f32_16x16x32_bf16 v[32:35], v[48:51], v[112:115], v[32:35]
    ds_read_b64_tr_b16 v[94:95], v238 offset:4096
    s_waitcnt lgkmcnt(8)
    v_mfma_f32_16x16x32_bf16 v[36:39], v[64:67], v[112:115], v[36:39]
    ds_read_b64_tr_b16 v[48:49], v5 offset:28672
    v_mfma_f32_16x16x32_bf16 v[36:39], v[68:71], v[116:119], v[36:39]
    ds_read_b64_tr_b16 v[50:51], v9 offset:28672
    v_mfma_f32_16x16x32_bf16 v[36:39], v[72:75], v[120:123], v[36:39]
    ds_read_b64_tr_b16 v[52:53], v5 offset:32768
    v_mfma_f32_16x16x32_bf16 v[36:39], v[76:79], v[124:127], v[36:39]
    ds_read_b64_tr_b16 v[54:55], v9 offset:32768
    v_mfma_f32_16x16x32_bf16 v[20:23], v[76:79], v[108:111], v[20:23]
    ds_read_b64_tr_b16 v[56:57], v235 offset:0
    v_mfma_f32_16x16x32_bf16 v[20:23], v[72:75], v[104:107], v[20:23]
    ds_read_b64_tr_b16 v[58:59], v239 offset:0
    v_mfma_f32_16x16x32_bf16 v[20:23], v[68:71], v[100:103], v[20:23]
    ds_read_b64_tr_b16 v[60:61], v235 offset:4096
    v_mfma_f32_16x16x32_bf16 v[20:23], v[64:67], v[96:99], v[20:23]
    ds_read_b64_tr_b16 v[62:63], v239 offset:4096
    s_waitcnt lgkmcnt(8)
    v_mfma_f32_16x16x32_bf16 v[24:27], v[80:83], v[96:99], v[24:27]
    ds_read_b64_tr_b16 v[64:65], v232 offset:8192
    v_mfma_f32_16x16x32_bf16 v[24:27], v[84:87], v[100:103], v[24:27]
    ds_read_b64_tr_b16 v[66:67], v236 offset:8192
    v_mfma_f32_16x16x32_bf16 v[24:27], v[88:91], v[104:107], v[24:27]
    ds_read_b64_tr_b16 v[68:69], v232 offset:12288
    v_mfma_f32_16x16x32_bf16 v[24:27], v[92:95], v[108:111], v[24:27]
    ds_read_b64_tr_b16 v[70:71], v236 offset:12288
    v_mfma_f32_16x16x32_bf16 v[40:43], v[92:95], v[124:127], v[40:43]
    ds_read_b64_tr_b16 v[72:73], v232 offset:16384
    v_mfma_f32_16x16x32_bf16 v[40:43], v[88:91], v[120:123], v[40:43]
    ds_read_b64_tr_b16 v[74:75], v236 offset:16384
    v_mfma_f32_16x16x32_bf16 v[40:43], v[84:87], v[116:119], v[40:43]
    ds_read_b64_tr_b16 v[76:77], v232 offset:20480
    v_mfma_f32_16x16x32_bf16 v[40:43], v[80:83], v[112:115], v[40:43]
    ds_read_b64_tr_b16 v[78:79], v236 offset:20480
    s_waitcnt lgkmcnt(8)
    v_mfma_f32_16x16x32_bf16 v[44:47], v[48:51], v[112:115], v[44:47]
    ds_read_b64_tr_b16 v[80:81], v233 offset:8192
    v_mfma_f32_16x16x32_bf16 v[44:47], v[52:55], v[116:119], v[44:47]
    ds_read_b64_tr_b16 v[82:83], v237 offset:8192
    v_mfma_f32_16x16x32_bf16 v[44:47], v[56:59], v[120:123], v[44:47]
    ds_read_b64_tr_b16 v[84:85], v233 offset:12288
    v_mfma_f32_16x16x32_bf16 v[44:47], v[60:63], v[124:127], v[44:47]
    ds_read_b64_tr_b16 v[86:87], v237 offset:12288
    v_mfma_f32_16x16x32_bf16 v[28:31], v[60:63], v[108:111], v[28:31]
    ds_read_b64_tr_b16 v[88:89], v233 offset:16384
    v_mfma_f32_16x16x32_bf16 v[28:31], v[56:59], v[104:107], v[28:31]
    ds_read_b64_tr_b16 v[90:91], v237 offset:16384
    v_mfma_f32_16x16x32_bf16 v[28:31], v[52:55], v[100:103], v[28:31]
    ds_read_b64_tr_b16 v[92:93], v233 offset:20480
    v_mfma_f32_16x16x32_bf16 v[28:31], v[48:51], v[96:99], v[28:31]
    ds_read_b64_tr_b16 v[94:95], v237 offset:20480
    s_waitcnt vmcnt(0) lgkmcnt(8)
    v_mfma_f32_16x16x32_bf16 v[16:19], v[64:67], v[128:131], v[16:19]
    ds_read_b32 v223, v10 offset:40
    ds_read_b64_tr_b16 v[48:49], v234 offset:8192
    v_mfma_f32_16x16x32_bf16 v[16:19], v[68:71], v[132:135], v[16:19]
    ds_read_b64_tr_b16 v[50:51], v238 offset:8192
    v_mfma_f32_16x16x32_bf16 v[16:19], v[72:75], v[136:139], v[16:19]
    ds_read_b64_tr_b16 v[52:53], v234 offset:12288
    v_mfma_f32_16x16x32_bf16 v[16:19], v[76:79], v[140:143], v[16:19]
    ds_read_b64_tr_b16 v[54:55], v238 offset:12288
    v_mfma_f32_16x16x32_bf16 v[32:35], v[76:79], v[156:159], v[32:35]
    ds_read_b64_tr_b16 v[56:57], v234 offset:16384
    v_mfma_f32_16x16x32_bf16 v[32:35], v[72:75], v[152:155], v[32:35]
    ds_read_b64_tr_b16 v[58:59], v238 offset:16384
    v_mfma_f32_16x16x32_bf16 v[32:35], v[68:71], v[148:151], v[32:35]
    ds_read_b64_tr_b16 v[60:61], v234 offset:20480
    v_mfma_f32_16x16x32_bf16 v[32:35], v[64:67], v[144:147], v[32:35]
    ds_read_b64_tr_b16 v[62:63], v238 offset:20480
    s_waitcnt lgkmcnt(9)
    v_mfma_f32_16x16x32_bf16 v[36:39], v[80:83], v[144:147], v[36:39]
    ds_read_b64_tr_b16 v[64:65], v235 offset:8192
    v_mfma_f32_16x16x32_bf16 v[36:39], v[84:87], v[148:151], v[36:39]
    ds_read_b64_tr_b16 v[66:67], v239 offset:8192
    v_mfma_f32_16x16x32_bf16 v[36:39], v[88:91], v[152:155], v[36:39]
    ds_read_b64_tr_b16 v[68:69], v235 offset:12288
    v_mfma_f32_16x16x32_bf16 v[36:39], v[92:95], v[156:159], v[36:39]
    ds_read_b64_tr_b16 v[70:71], v239 offset:12288
    v_mfma_f32_16x16x32_bf16 v[20:23], v[92:95], v[140:143], v[20:23]
    ds_read_b64_tr_b16 v[72:73], v235 offset:16384
    v_mfma_f32_16x16x32_bf16 v[20:23], v[88:91], v[136:139], v[20:23]
    ds_read_b64_tr_b16 v[74:75], v239 offset:16384
    v_mfma_f32_16x16x32_bf16 v[20:23], v[84:87], v[132:135], v[20:23]
    ds_read_b64_tr_b16 v[76:77], v235 offset:20480
    v_mfma_f32_16x16x32_bf16 v[20:23], v[80:83], v[128:131], v[20:23]
    ds_read_b64_tr_b16 v[78:79], v239 offset:20480
    s_waitcnt lgkmcnt(8)
    v_cmp_gt_u32 vcc, 4, v223
    s_cbranch_vccnz LB_w7
LB_g7:
    v_mfma_f32_16x16x32_bf16 v[24:27], v[48:51], v[128:131], v[24:27]
    v_mfma_f32_16x16x32_bf16 v[24:27], v[52:55], v[132:135], v[24:27]
    v_mfma_f32_16x16x32_bf16 v[24:27], v[56:59], v[136:139], v[24:27]
    v_cvt_pk_bf16_f32 v200, v32, v33
    v_mfma_f32_16x16x32_bf16 v[24:27], v[60:63], v[140:143], v[24:27]
    v_cvt_pk_bf16_f32 v201, v34, v35
    v_mfma_f32_16x16x32_bf16 v[40:43], v[60:63], v[156:159], v[40:43]
    v_cvt_pk_bf16_f32 v202, v36, v37
    v_mfma_f32_16x16x32_bf16 v[40:43], v[56:59], v[152:155], v[40:43]
    v_cvt_pk_bf16_f32 v203, v38, v39
    v_permlane16_swap_b32 v200, v202
    v_mfma_f32_16x16x32_bf16 v[40:43], v[52:55], v[148:151], v[40:43]
    v_permlane16_swap_b32 v201, v203
    v_mfma_f32_16x16x32_bf16 v[40:43], v[48:51], v[144:147], v[40:43]
    ds_write_b128 v248, v[200:203] offset:2048
    s_waitcnt lgkmcnt(1)
    v_mfma_f32_16x16x32_bf16 v[44:47], v[64:67], v[144:147], v[44:47]
    v_cvt_pk_bf16_f32 v192, v16, v17
    v_mfma_f32_16x16x32_bf16 v[44:47], v[68:71], v[148:151], v[44:47]
    v_cvt_pk_bf16_f32 v193, v18, v19
    v_mfma_f32_16x16x32_bf16 v[44:47], v[72:75], v[152:155], v[44:47]
    v_cvt_pk_bf16_f32 v194, v20, v21
    v_mfma_f32_16x16x32_bf16 v[44:47], v[76:79], v[156:159], v[44:47]
    v_cvt_pk_bf16_f32 v195, v22, v23
    v_mfma_f32_16x16x32_bf16 v[28:31], v[76:79], v[140:143], v[28:31]
    v_permlane16_swap_b32 v192, v194
    v_mfma_f32_16x16x32_bf16 v[28:31], v[72:75], v[136:139], v[28:31]
    v_permlane16_swap_b32 v193, v195
    v_mfma_f32_16x16x32_bf16 v[28:31], v[68:71], v[132:135], v[28:31]
    ds_write_b128 v248, v[192:195] offset:0
    v_mfma_f32_16x16x32_bf16 v[28:31], v[64:67], v[128:131], v[28:31]
    v_cvt_pk_bf16_f32 v204, v40, v41
    v_cvt_pk_bf16_f32 v205, v42, v43
    v_cvt_pk_bf16_f32 v206, v44, v45
    v_cvt_pk_bf16_f32 v207, v46, v47
    s_nop 0
    v_permlane16_swap_b32 v204, v206
    v_permlane16_swap_b32 v205, v207
    ds_write_b128 v249, v[204:207] offset:2048
    ds_read_b128 v[56:59], v250 offset:2048
    ds_read_b128 v[60:63], v250 offset:3072
    v_cvt_pk_bf16_f32 v196, v24, v25
    v_cvt_pk_bf16_f32 v197, v26, v27
    v_cvt_pk_bf16_f32 v198, v28, v29
    v_cvt_pk_bf16_f32 v199, v30, v31
    s_nop 0
    v_permlane16_swap_b32 v196, v198
    v_permlane16_swap_b32 v197, v199
    ds_write_b128 v249, v[196:199] offset:0
    ds_read_b128 v[48:51], v250 offset:0
    ds_read_b128 v[52:55], v250 offset:1024
    s_mov_b32 s95, 65536
    s_waitcnt lgkmcnt(4)
    buffer_store_dwordx4 v[56:59], v246, s[60:63], s95 offen nt sc1
    s_mov_b32 s95, 98304
    s_waitcnt lgkmcnt(3)
    buffer_store_dwordx4 v[60:63], v246, s[60:63], s95 offen nt sc1
    s_mov_b32 s95, 0
    s_waitcnt lgkmcnt(1)
    buffer_store_dwordx4 v[48:51], v246, s[60:63], s95 offen nt sc1
    s_mov_b32 s95, 32768
    s_waitcnt lgkmcnt(0)
    buffer_store_dwordx4 v[52:55], v246, s[60:63], s95 offen nt sc1
    s_endpgm
LA_slow:
    s_mov_b32 s79, 0
LA_slow1:
    s_mov_b64 exec, vcc
    s_sleep 8
    buffer_load_dword v136, v33, s[68:71], 0 offen sc1
    buffer_load_dword v137, v34, s[52:55], 0 offen sc1
    s_add_u32 s79, s79, 1
    s_cmp_gt_u32 s79, 200000
    s_waitcnt vmcnt(0)
    s_cbranch_scc1 LA_back
    v_cmp_ne_u32 vcc, v136, v137
    v_cmp_gt_u32 s[80:81], s96, v136
    s_nop 0
    s_or_b64 vcc, vcc, s[80:81]
    s_cbranch_vccnz LA_slow1
    s_branch LA_back
LB_tag:
    s_mov_b64 exec, 0xffff
    s_waitcnt vmcnt(0)
    v_lshrrev_b32 v251, v0, v251
    v_and_b32 v251, 1, v251
    v_cmp_eq_u32 vcc, 0, v251
    s_nop 1
    s_or_b32 s83, vcc_lo, 0x10000
    s_mov_b64 exec, 1
    v_mov_b32 v251, s83
    buffer_store_dword v251, v220, s[68:71], s98 offen sc1
    s_mov_b64 exec, -1
    s_branch LB_tagb
LB_slow:
    s_mov_b32 s79, 0
LB_pt:
    buffer_load_dword v222, v220, s[68:71], s98 offen sc1
    s_add_u32 s79, s79, 1
    s_cmp_gt_u32 s79, 200000
    s_cbranch_scc1 LB_pt_x
    s_waitcnt vmcnt(0)
    v_cmp_gt_u32 vcc, 4096, v222
    s_cbranch_vccz LB_pt_x
    s_mov_b64 exec, vcc
    s_sleep 8
    s_branch LB_pt
LB_pt_x:
    s_waitcnt vmcnt(0)
    s_branch LB_back
LB_w1:
    s_branch LB_s1_in
LB_s1:
    s_sleep 1
LB_s1_in:
    ds_read_b32 v223, v10 offset:0
    ds_read_b64 v[204:205], v218
    ds_read_b64 v[206:207], v219
    s_waitcnt lgkmcnt(0)
    v_readfirstlane_b32 s78, v223
    s_nop 0
    s_cmp_ge_u32 s78, 4
    s_cbranch_scc0 LB_s1
    s_branch LB_g1
LB_w6:
    s_branch LB_s6_in
LB_s6:
    s_sleep 1
LB_s6_in:
    ds_read_b32 v223, v10 offset:24
    ds_read_b64 v[224:225], v218 offset:1024
    ds_read_b64 v[234:235], v219 offset:1024
    s_waitcnt lgkmcnt(0)
    v_readfirstlane_b32 s78, v223
    s_nop 0
    s_cmp_ge_u32 s78, 4
    s_cbranch_scc0 LB_s6
    s_branch LB_g6
LB_w4:
    s_branch LB_s4_in
LB_s4:
    s_sleep 1
LB_s4_in:
    ds_read_b32 v222, v10 offset:16
    s_waitcnt lgkmcnt(0)
    v_readfirstlane_b32 s78, v222
    s_nop 0
    s_cmp_ge_u32 s78, 4
    s_cbranch_scc0 LB_s4
    s_branch LB_g4
LB_w8:
    s_branch LB_s8_in
LB_s8:
    s_sleep 1
LB_s8_in:
    ds_read_b32 v223, v10 offset:32
    s_waitcnt lgkmcnt(0)
    v_readfirstlane_b32 s78, v223
    s_nop 0
    s_cmp_ge_u32 s78, 4
    s_cbranch_scc0 LB_s8
    s_branch LB_g8
LB_w7:
    s_branch LB_s7_in
LB_s7:
    s_sleep 1
LB_s7_in:
    ds_read_b32 v223, v10 offset:40
    s_waitcnt lgkmcnt(0)
    v_readfirstlane_b32 s78, v223
    s_nop 0
    s_cmp_ge_u32 s78, 4
    s_cbranch_scc0 LB_s7
    s_branch LB_g7
L_end:
    s_endpgm
.section .rodata,"a"
.p2align 6
.amdhsa_kernel concat_heads__ssm_conv_h3__sliding_local_dilated__prompt_kernel
  .amdhsa_next_free_vgpr 256
  .amdhsa_next_free_sgpr 102
  .amdhsa_accum_offset 256
  .amdhsa_group_segment_fixed_size 0
  .amdhsa_kernarg_size 96
  .amdhsa_user_sgpr_count 2
  .amdhsa_user_sgpr_kernarg_segment_ptr 1
  .amdhsa_system_sgpr_workgroup_id_x 1
.end_amdhsa_kernel
```

```asm
; @launch grid=(256,1,1) block=(512,1,1) lds=163840
.amdgcn_target "amdgcn-amd-amdhsa--gfx950"
.text
.globl concat_heads__ssm_conv_h3__sliding_local_dilated__prompt_kernel
.p2align 8
.type concat_heads__ssm_conv_h3__sliding_local_dilated__prompt_kernel,@function
concat_heads__ssm_conv_h3__sliding_local_dilated__prompt_kernel:
    s_cmp_ge_u32 s2, 256
    s_cbranch_scc1 L_end
    s_load_dwordx2 s[28:29], s[0:1], 48
    s_load_dwordx2 s[32:33], s[0:1], 56
    s_load_dwordx8 s[4:11], s[0:1], 0
    s_load_dwordx4 s[12:15], s[0:1], 32
    s_load_dwordx8 s[20:27], s[0:1], 64
    v_lshrrev_b32 v1, 6, v0
    v_and_b32 v0, 63, v0
    v_readfirstlane_b32 s3, v1
    s_nop 0
    s_cmp_lg_u32 s3, 4
    s_cbranch_scc1 L_nopf
    s_getpc_b64 s[80:81]
L_pc:
    s_bfe_u32 s78, s2, 0x40003
    v_lshl_add_u32 v1, v0, 4, s78
    v_lshlrev_b32 v1, 7, v1
    v_cmp_gt_u32 vcc, L_end-L_pc, v1
    s_nop 0
    s_and_saveexec_b64 s[82:83], vcc
    global_load_dword v222, v1, s[80:81]
    s_mov_b64 exec, -1
L_nopf:
    s_and_b32 s78, s2, 7
    s_lshr_b32 s79, s2, 3
    s_and_b32 s80, s78, 1
    s_lshl_b32 s80, s80, 3
    s_lshr_b32 s81, s78, 1
    s_lshl_b32 s81, s81, 2
    s_and_b32 s72, s79, 7
    s_add_u32 s72, s72, s80
    s_lshr_b32 s73, s79, 3
    s_xor_b32 s73, s73, 3
    s_add_u32 s73, s73, s81
    s_cmp_ge_u32 s3, 4
    s_cbranch_scc1 L_B
    v_lshrrev_b32 v5, 3, v0
    v_and_b32 v6, 7, v0
    v_lshrrev_b32 v7, 4, v0
    s_lshl_b32 s79, s72, 7
    s_lshl_b32 s80, s3, 5
    s_add_u32 s81, s79, s80
    v_xor_b32 v8, v7, v6
    v_lshlrev_b32 v8, 4, v8
    v_add_u32 v240, s81, v5
    v_lshl_add_u32 v240, v240, 11, v8
    v_xor_b32 v241, 64, v240
    v_add_u32 v241, 15360, v241
    v_add_u32 v242, 30720, v240
    v_add_u32 v243, 30720, v241
    s_lshl_b32 s87, s3, 12
    s_add_u32 s87, s87, 75776
    s_and_b32 s98, s73, 12
    s_and_b32 s78, s72, 8
    s_add_u32 s98, s98, s78
    s_add_u32 s101, s72, s73
    s_and_b32 s101, s101, 3
    s_lshl_b32 s78, s101, 2
    s_lshr_b32 s97, 0x101, s78
    s_add_u32 s97, s97, s98
    s_and_b32 s97, s97, 15
    s_mov_b32 m0, s87
    s_lshl_b32 s97, s97, 7
    s_mov_b32 s30, 0x400000
    s_mov_b32 s31, 0x20000
    s_waitcnt lgkmcnt(0)
    buffer_load_dwordx4 v240, s[28:31], s97 offen offset:0  lds
    s_and_b32 s78, s3, 1
    s_lshl_b32 s78, s78, 2
    s_lshl_b32 s80, s3, 3
    v_and_b32 v8, 1, v7
    v_lshl_or_b32 v8, v8, 1, s78
    v_xor_b32 v8, v8, v6
    buffer_load_dwordx4 v241, s[28:31], s97 offen offset:1024  lds
    v_lshlrev_b32 v8, 4, v8
    v_add_u32 v244, s80, v5
    v_mul_u32_u24 v244, 6144, v244
    s_lshl_b32 s82, s73, 7
    v_add3_u32 v244, v244, v8, s82
    buffer_load_dwordx4 v242, s[28:31], s97 offen offset:2048  lds
    v_add_u32 v245, 1024, v244
    v_add_u32 v246, 2048, v244
    s_bfe_u32 s62, s72, 0x10002
    s_mul_i32 s78, s62, 12288
    s_mul_i32 s80, s3, 3072
    s_add_u32 s60, s80, s78
    buffer_load_dwordx4 v243, s[28:31], s97 offen offset:3072  lds
    s_sub_u32 s61, s80, s78
    s_mul_i32 s62, s62, 196608
    s_sub_u32 s63, 196608, s62
    s_mov_b32 s34, 0x600000
    s_mov_b32 s35, 0x20000
    s_mul_i32 s16, s97, 3072
    s_add_u32 m0, s60, 0
    s_add_u32 s99, s16, s62
    buffer_load_dwordx4 v244, s[32:35], s99 offen offset:0  lds
    s_lshl_b32 s78, s3, 1
    s_lshl_b32 s80, s3, 2
    s_add_u32 s79, s79, s80
    s_sub_u32 s79, s79, 16
    v_add_u32 v8, s78, v7
    buffer_load_dwordx4 v245, s[32:35], s99 offen offset:1024  lds
    v_xor_b32 v8, v8, v6
    v_and_b32 v8, 7, v8
    v_lshlrev_b32 v8, 4, v8
    v_add_u32 v3, s79, v5
    buffer_load_dwordx4 v246, s[32:35], s99 offen offset:2048  lds
    v_lshl_add_u32 v3, v3, 11, v8
    s_lshl_b32 s86, s3, 10
    s_lshl_b32 s88, s3, 9
    s_add_u32 s88, s88, 73728
    s_add_u32 m0, s88, 0
    s_mov_b64 exec, 0xffffffff
    buffer_load_dwordx4 v3, s[28:31], s97 offen offset:0  lds
    s_mov_b64 exec, -1
    s_add_u32 m0, s61, 12288
    s_add_u32 s16, s16, s63
    buffer_load_dwordx4 v244, s[32:35], s16 offen offset:0  lds
    buffer_load_dwordx4 v245, s[32:35], s16 offen offset:1024  lds
    buffer_load_dwordx4 v246, s[32:35], s16 offen offset:2048  lds
    s_mov_b32 s0, 0x76583240
    s_mov_b32 s1, 0xfedba9c
    s_cmp_eq_u32 s101, 1
    s_cselect_b32 s0, 0x76943251, s0
    s_cselect_b32 s1, 0xfecbad8, s1
    s_cmp_eq_u32 s101, 2
    s_cselect_b32 s0, 0x7a543620, s0
    s_cselect_b32 s1, 0xfdcbe98, s1
    s_cmp_eq_u32 s101, 3
    s_cselect_b32 s0, 0xb6547231, s0
    s_cselect_b32 s1, 0xedcfa98, s1
    s_and_b32 s78, s73, 7
    s_cmp_lg_u32 s78, 3
    s_cbranch_scc1 LA_nb
    s_cmp_eq_u32 s101, 2
    s_cselect_b32 s0, 0x87654320, s0
    s_cselect_b32 s1, 0xfdcbea9, s1
    s_cmp_eq_u32 s101, 3
    s_cselect_b32 s0, 0x87654231, s0
    s_cselect_b32 s1, 0xedcfba9, s1
LA_nb:
    s_add_u32 s79, s72, s73
    s_add_u32 s78, s72, 5
    s_and_b32 s78, s78, 7
    s_lshl_b32 s78, s78, 1
    s_and_b32 s75, s79, 1
    s_add_u32 s78, s78, s75
    s_andn2_b32 s79, 2, s79
    s_lshl_b32 s79, s79, 3
    s_add_u32 s78, s78, s79
    s_and_b32 s76, s78, 3
    s_and_b32 s79, s73, 12
    s_add_u32 s76, s76, s79
    s_lshr_b32 s74, s78, 4
    s_add_u32 s74, s74, s79
    s_and_b32 s79, s72, 8
    s_lshr_b32 s77, s78, 2
    s_add_u32 s77, s77, s79
    s_lshr_b32 s79, s79, 2
    s_add_u32 s74, s74, s79
    s_xor_b32 s74, s74, 4
    s_and_b32 s75, s78, 15
    s_add_u32 s97, s98, s0
    s_lshr_b64 s[0:1], s[0:1], 4
    s_and_b32 s97, s97, 15
    s_add_u32 m0, s87, 18432
    s_lshl_b32 s97, s97, 7
    buffer_load_dwordx4 v240, s[28:31], s97 offen offset:0  lds
    s_mov_b32 s36, s6
    s_mov_b32 s37, s7
    s_mov_b32 s38, 0x400000
    s_mov_b32 s39, 0x20000
    s_mov_b32 s40, s8
    s_mov_b32 s41, s9
    s_mov_b32 s42, 0x400000
    s_mov_b32 s43, 0x20000
    s_mov_b32 s44, s10
    s_mov_b32 s45, s11
    s_mov_b32 s46, 0x2000
    s_mov_b32 s47, 0x20000
    v_lshlrev_b32 v15, 4, v0
    v_and_b32 v7, 7, v0
    s_lshl_b32 s79, s74, 7
    v_lshl_add_u32 v7, v7, 4, s79
    s_lshl_b32 s78, s75, 7
    s_lshl_b32 s80, s3, 3
    s_add_u32 s80, s80, s78
    v_lshrrev_b32 v5, 3, v0
    s_and_b32 s79, s3, 1
    v_xor_b32 v5, s79, v5
    v_add_u32 v5, s80, v5
    v_lshl_add_u32 v10, v5, 11, v7
    s_xor_b32 s80, s3, 1
    s_add_u32 s80, s78, s80
    s_sub_u32 s80, s80, 4
    s_lshl_b32 s80, s80, 11
    v_add_u32 v11, s80, v7
    s_mov_b32 s52, s26
    s_mov_b32 s53, s27
    s_mov_b32 s54, 0x1000000
    s_mov_b32 s55, 0x20000
    v_and_b32 v7, 7, v0
    s_lshl_b32 s79, s74, 7
    v_lshl_add_u32 v7, v7, 4, s79
    s_lshl_b32 s78, s75, 7
    v_bfe_u32 v5, v0, 3, 2
    v_lshrrev_b32 v6, 5, v0
    s_lshl_b32 s80, s3, 5
    v_lshlrev_b32 v8, 3, v5
    v_lshl_add_u32 v8, v6, 2, v8
    v_add_u32 v8, s80, v8
    v_and_b32 v35, 7, v0
    v_lshl_add_u32 v16, v35, 1, v6
    v_lshlrev_b32 v232, 5, v16
    v_lshlrev_b32 v16, 3, v16
    v_lshl_add_u32 v16, v5, 10, v16
    v_and_b32 v231, 1, v5
    v_lshl_add_u32 v16, v231, 7, v16
    s_lshl_b32 s79, s3, 12
    s_add_u32 s79, s79, 129024
    v_add_u32 v16, s79, v16
    v_xor_b32 v231, 128, v16
    v_lshrrev_b32 v35, 2, v35
    v_lshl_add_u32 v35, v35, 4, v232
    v_add_u32 v35, 162816, v35
    v_add_u32 v8, s78, v8
    v_lshl_add_u32 v9, v8, 11, v7
    v_lshl_add_u32 v13, v8, 12, v7
    v_bfe_u32 v8, v0, 2, 1
    v_lshlrev_b32 v8, 1, v8
    v_add_u32 v8, v8, v6
    v_lshlrev_b32 v8, 16, v8
    v_lshl_add_u32 v8, v5, 6, v8
    v_and_b32 v7, 3, v0
    v_lshl_add_u32 v8, v7, 4, v8
    s_add_u32 s78, s78, s80
    s_lshl_b32 s78, s78, 3
    s_lshl_b32 s79, s74, 18
    s_add_u32 s78, s78, s79
    v_add_u32 v12, s78, v8
    s_mov_b32 s48, s12
    s_mov_b32 s49, s13
    s_mov_b32 s50, 0x400000
    s_mov_b32 s51, 0x20000
    s_mov_b32 s56, s4
    s_mov_b32 s57, s5
    s_mov_b32 s58, 0x400000
    s_mov_b32 s59, 0x20000
    s_mov_b32 s64, s20
    s_mov_b32 s65, s21
    s_mov_b32 s66, 0x200000
    s_mov_b32 s67, 0x20000
    s_lshl_b32 s91, s74, 4
    s_add_u32 s91, s91, s75
    s_lshr_b32 s78, s91, 3
    s_lshl_b32 s78, s78, 5
    s_and_b32 s79, s91, 7
    s_add_u32 s78, s78, s79
    s_lshl_b32 s79, s3, 3
    s_add_u32 s90, s78, s79
    s_lshl_b32 s91, s91, 14
    s_mov_b32 s96, 4096
    s_mul_i32 s94, s3, 8320
    s_add_u32 s94, s94, 129024
    v_mov_b32 v229, 0
    s_mov_b64 s[4:5], s[64:65]
    s_mov_b32 s6, 0x0
    s_mov_b32 s7, 0x20000
    v_mov_b32 v228, 0x40000000
    s_bitcmp1_b32 s73, 2
    s_cbranch_scc1 LA_nh0
    s_mov_b64 s[4:5], s[28:29]
    s_mov_b32 s6, 0x400000
    v_mov_b32 v229, 0x40000000
    s_and_b32 s78, s73, 3
    s_cmp_eq_u32 s78, 3
    s_cbranch_scc1 LA_nh0
    s_and_b32 s79, s101, 2
    s_add_u32 s78, s72, 1
    s_add_u32 s78, s78, s79
    s_and_b32 s78, s78, 3
    s_bfe_u32 s80, s72, 0x10002
    s_and_b32 s81, s101, 1
    s_lshl_b32 s81, s81, 2
    s_add_u32 s81, s81, s79
    s_lshl_b32 s82, s78, 1
    s_cmp_lt_u32 s78, 2
    s_cselect_b32 s79, 12, 24
    s_cselect_b32 s82, s82, 0
    s_cselect_b32 s83, 6, 7
    s_add_u32 s81, s81, s83
    s_add_u32 s80, s80, s82
    s_lshl_b32 s80, s80, 2
    s_add_u32 s80, s80, s3
    s_mul_i32 s80, s80, s79
    s_add_u32 s82, s81, s78
    s_add_u32 s81, s81, s98
    s_and_b32 s81, s81, 15
    s_mul_i32 s81, s81, 192
    s_add_u32 s80, s80, s81
    s_or_b32 s81, s73, 3
    s_lshl_b32 s81, s81, 7
    v_add_u32 v5, s80, v0
    v_lshl_add_u32 v5, v5, 11, s81
    v_cmp_gt_u32 vcc, s79, v0
    s_nop 1
    v_cndmask_b32 v228, v228, v5, vcc
    s_cmp_ge_u32 s78, 2
    s_cbranch_scc1 LA_nh0
    s_add_u32 s82, s82, s98
    s_and_b32 s82, s82, 15
    s_lshl_b32 s78, s82, 7
    s_lshl_b32 s79, s72, 7
    s_mul_i32 s80, s3, 36
    s_add_u32 s79, s79, s80
    s_sub_u32 s79, s79, 16
    v_add_u32 v5, s79, v0
    v_lshl_add_u32 v5, v5, 11, s78
    v_cmp_gt_u32 vcc, 36, v0
    s_nop 1
    v_cndmask_b32 v229, v229, v5, vcc
LA_nh0:
    buffer_load_dwordx4 v241, s[28:31], s97 offen offset:1024  lds
    buffer_load_dwordx4 v242, s[28:31], s97 offen offset:2048  lds
    buffer_load_dwordx4 v243, s[28:31], s97 offen offset:3072  lds
    s_add_u32 m0, s88, 18432
    s_mov_b64 exec, 0xffffffff
    buffer_load_dwordx4 v3, s[28:31], s97 offen offset:0  lds
    s_mov_b64 exec, -1
    s_mul_i32 s16, s97, 3072
    s_add_u32 m0, s60, 24576
    s_add_u32 s99, s16, s62
    buffer_load_dwordx4 v244, s[32:35], s99 offen offset:0  lds
    buffer_load_dwordx4 v245, s[32:35], s99 offen offset:1024  lds
    buffer_load_dwordx4 v246, s[32:35], s99 offen offset:2048  lds
    s_add_u32 m0, s61, 36864
    s_add_u32 s16, s16, s63
    buffer_load_dwordx4 v244, s[32:35], s16 offen offset:0  lds
    buffer_load_dwordx4 v245, s[32:35], s16 offen offset:1024  lds
    buffer_load_dwordx4 v246, s[32:35], s16 offen offset:2048  lds
    s_waitcnt vmcnt(11)
    s_barrier
    s_add_u32 s97, s98, s0
    s_lshr_b64 s[0:1], s[0:1], 4
    s_and_b32 s97, s97, 15
    s_add_u32 m0, s87, 36864
    s_lshl_b32 s97, s97, 7
    buffer_load_dwordx4 v240, s[28:31], s97 offen offset:0  lds
    buffer_load_dwordx4 v241, s[28:31], s97 offen offset:1024  lds
    s_cmp_eq_u32 s101, 1
    s_cbranch_scc1 LA_c1
    s_cmp_eq_u32 s101, 2
    s_cbranch_scc1 LA_c2
    s_cmp_eq_u32 s101, 3
    s_cbranch_scc1 LA_c3
LA_c0:
    s_waitcnt vmcnt(8)
    s_barrier
    buffer_load_dwordx4 v242, s[28:31], s97 offen offset:2048  lds
    buffer_load_dwordx4 v243, s[28:31], s97 offen offset:3072  lds
    s_add_u32 m0, s88, 36864
    s_mov_b64 exec, 0xffffffff
    buffer_load_dwordx4 v3, s[28:31], s97 offen offset:0  lds
    s_mov_b64 exec, -1
    s_mul_i32 s16, s97, 3072
    s_add_u32 m0, s60, 49152
    s_add_u32 s99, s16, s62
    buffer_load_dwordx4 v244, s[32:35], s99 offen offset:0  lds
    buffer_load_dwordx4 v245, s[32:35], s99 offen offset:1024  lds
    buffer_load_dwordx4 v246, s[32:35], s99 offen offset:2048  lds
    s_add_u32 m0, s61, 61440
    s_add_u32 s16, s16, s63
    buffer_load_dwordx4 v244, s[32:35], s16 offen offset:0  lds
    buffer_load_dwordx4 v245, s[32:35], s16 offen offset:1024  lds
    buffer_load_dwordx4 v246, s[32:35], s16 offen offset:2048  lds
    s_add_u32 s97, s98, s0
    s_lshr_b64 s[0:1], s[0:1], 4
    s_and_b32 s97, s97, 15
    s_add_u32 m0, s87, 0
    s_lshl_b32 s97, s97, 7
    buffer_load_dwordx4 v240, s[28:31], s97 offen offset:0  lds
    buffer_load_dwordx4 v241, s[28:31], s97 offen offset:1024  lds
    buffer_load_dwordx4 v242, s[28:31], s97 offen offset:2048  lds
    buffer_load_dwordx4 v243, s[28:31], s97 offen offset:3072  lds
    s_add_u32 m0, s88, 0
    s_mov_b64 exec, 0xffffffff
    buffer_load_dwordx4 v3, s[28:31], s97 offen offset:0  lds
    s_mov_b64 exec, -1
    s_waitcnt vmcnt(11)
    s_barrier
    s_mul_i32 s16, s97, 3072
    s_add_u32 m0, s60, 0
    s_add_u32 s99, s16, s62
    buffer_load_dwordx4 v244, s[32:35], s99 offen offset:0  lds
    buffer_load_dwordx4 v245, s[32:35], s99 offen offset:1024  lds
    buffer_load_dwordx4 v246, s[32:35], s99 offen offset:2048  lds
    s_add_u32 m0, s61, 12288
    s_add_u32 s16, s16, s63
    buffer_load_dwordx4 v244, s[32:35], s16 offen offset:0  lds
    buffer_load_dwordx4 v245, s[32:35], s16 offen offset:1024  lds
    buffer_load_dwordx4 v246, s[32:35], s16 offen offset:2048  lds
    buffer_load_dword v230, v229, s[4:7], 0 offen
    buffer_load_dword v230, v228, s[32:35], 0 offen
    s_add_u32 m0, s86, 129536
    s_mov_b32 s89, 0
    buffer_load_dwordx4 v10, s[36:39], s89 offen nt lds
    s_add_u32 m0, s86, 145920
    s_mov_b32 s89, 0
    buffer_load_dwordx4 v10, s[40:43], s89 offen nt lds
    s_add_u32 m0, s86, 133632
    s_mov_b32 s89, 65536
    buffer_load_dwordx4 v10, s[36:39], s89 offen nt lds
    s_add_u32 m0, s86, 150016
    s_mov_b32 s89, 65536
    buffer_load_dwordx4 v10, s[40:43], s89 offen nt lds
    s_add_u32 m0, s86, 137728
    s_mov_b32 s89, 131072
    buffer_load_dwordx4 v10, s[36:39], s89 offen nt lds
    s_add_u32 m0, s86, 154112
    s_mov_b32 s89, 131072
    buffer_load_dwordx4 v10, s[40:43], s89 offen nt lds
    s_add_u32 m0, s86, 141824
    s_mov_b32 s89, 196608
    buffer_load_dwordx4 v10, s[36:39], s89 offen nt lds
    s_add_u32 m0, s86, 158208
    s_mov_b32 s89, 196608
    buffer_load_dwordx4 v10, s[40:43], s89 offen nt lds
    s_waitcnt vmcnt(16)
    s_barrier
    s_mov_b64 exec, 0xff
    s_lshl_b32 s82, s3, 7
    s_add_u32 m0, s82, 129024
    s_mov_b32 s89, 0
    buffer_load_dwordx4 v11, s[36:39], s89 offen nt lds
    s_lshl_b32 s83, s74, 9
    s_add_u32 s83, s83, s82
    s_and_b32 s89, s3, 2
    s_lshl_b32 s89, s89, 3
    s_add_u32 s82, s82, s89
    s_add_u32 m0, s82, 162816
    s_add_u32 s89, s83, 0
    buffer_load_dwordx4 v15, s[44:47], s89 offen  lds
    s_mov_b64 exec, -1
    s_add_u32 s97, s98, s0
    s_lshr_b64 s[0:1], s[0:1], 4
    s_and_b32 s97, s97, 15
    s_add_u32 m0, s87, 18432
    s_lshl_b32 s97, s97, 7
    buffer_load_dwordx4 v240, s[28:31], s97 offen offset:0  lds
    buffer_load_dwordx4 v241, s[28:31], s97 offen offset:1024  lds
    buffer_load_dwordx4 v242, s[28:31], s97 offen offset:2048  lds
    buffer_load_dwordx4 v243, s[28:31], s97 offen offset:3072  lds
    s_add_u32 m0, s88, 18432
    s_mov_b64 exec, 0xffffffff
    buffer_load_dwordx4 v3, s[28:31], s97 offen offset:0  lds
    s_mov_b64 exec, -1
    s_mul_i32 s16, s97, 3072
    s_add_u32 m0, s60, 24576
    s_add_u32 s99, s16, s62
    buffer_load_dwordx4 v244, s[32:35], s99 offen offset:0  lds
    buffer_load_dwordx4 v245, s[32:35], s99 offen offset:1024  lds
    buffer_load_dwordx4 v246, s[32:35], s99 offen offset:2048  lds
    s_add_u32 m0, s61, 36864
    s_add_u32 s16, s16, s63
    buffer_load_dwordx4 v244, s[32:35], s16 offen offset:0  lds
    buffer_load_dwordx4 v245, s[32:35], s16 offen offset:1024  lds
    buffer_load_dwordx4 v246, s[32:35], s16 offen offset:2048  lds
    s_add_u32 s97, s98, s0
    s_lshr_b64 s[0:1], s[0:1], 4
    s_and_b32 s97, s97, 15
    s_add_u32 m0, s87, 36864
    s_lshl_b32 s97, s97, 7
    buffer_load_dwordx4 v240, s[28:31], s97 offen offset:0  lds
    buffer_load_dwordx4 v241, s[28:31], s97 offen offset:1024  lds
    buffer_load_dwordx4 v242, s[28:31], s97 offen offset:2048  lds
    buffer_load_dwordx4 v243, s[28:31], s97 offen offset:3072  lds
    s_waitcnt vmcnt(10)
    s_barrier
    s_add_u32 m0, s88, 36864
    s_mov_b64 exec, 0xffffffff
    buffer_load_dwordx4 v3, s[28:31], s97 offen offset:0  lds
    s_mov_b64 exec, -1
    ds_read_b128 v[84:87], v35 offset:0
    ds_read_b128 v[88:91], v35 offset:16
    s_mul_i32 s16, s97, 3072
    s_add_u32 m0, s60, 49152
    s_add_u32 s99, s16, s62
    buffer_load_dwordx4 v244, s[32:35], s99 offen offset:0  lds
    ds_read_b64 v[40:41], v16 offset:0
    ds_read_b64 v[42:43], v231 offset:256
    buffer_load_dwordx4 v245, s[32:35], s99 offen offset:1024  lds
    ds_read_b64 v[44:45], v16 offset:256
    ds_read_b64 v[46:47], v16 offset:512
    buffer_load_dwordx4 v246, s[32:35], s99 offen offset:2048  lds
    ds_read_b64 v[48:49], v231 offset:512
    s_add_u32 m0, s61, 61440
    s_add_u32 s16, s16, s63
    buffer_load_dwordx4 v244, s[32:35], s16 offen offset:0  lds
    ds_read_b64 v[50:51], v16 offset:768
    ds_read_b64 v[52:53], v231 offset:768
    buffer_load_dwordx4 v245, s[32:35], s16 offen offset:1024  lds
    ds_read_b64 v[54:55], v16 offset:1024
    ds_read_b64 v[56:57], v231 offset:1024
    buffer_load_dwordx4 v246, s[32:35], s16 offen offset:2048  lds
    ds_read_b64 v[58:59], v16 offset:1280
    ds_read_b64 v[60:61], v231 offset:1280
    s_add_u32 s97, s98, s0
    s_lshr_b64 s[0:1], s[0:1], 4
    s_and_b32 s97, s97, 15
    s_add_u32 m0, s87, 0
    s_lshl_b32 s97, s97, 7
    buffer_load_dwordx4 v240, s[28:31], s97 offen offset:0  lds
    ds_read_b64 v[68:69], v16 offset:16896
    buffer_load_dwordx4 v241, s[28:31], s97 offen offset:1024  lds
    ds_read_b64 v[70:71], v231 offset:16896
    ds_read_b64 v[72:73], v16 offset:17152
    buffer_load_dwordx4 v242, s[28:31], s97 offen offset:2048  lds
    ds_read_b64 v[74:75], v231 offset:17152
    ds_read_b64 v[76:77], v16 offset:17408
    buffer_load_dwordx4 v243, s[28:31], s97 offen offset:3072  lds
    ds_read_b64 v[78:79], v231 offset:17408
    ds_read_b64 v[80:81], v16 offset:17664
    s_add_u32 m0, s88, 0
    s_mov_b64 exec, 0xffffffff
    buffer_load_dwordx4 v3, s[28:31], s97 offen offset:0  lds
    s_mov_b64 exec, -1
    ds_read_b64 v[82:83], v231 offset:17664
    s_waitcnt vmcnt(11)
    s_waitcnt lgkmcnt(0)
    s_barrier
    s_mul_i32 s16, s97, 3072
    s_add_u32 m0, s60, 0
    s_add_u32 s99, s16, s62
    buffer_load_dwordx4 v244, s[32:35], s99 offen offset:0  lds
    v_lshlrev_b32 v160, 16, v40
    v_lshlrev_b32 v161, 16, v42
    v_lshlrev_b32 v162, 16, v44
    v_lshlrev_b32 v163, 16, v46
    v_lshlrev_b32 v164, 16, v48
    buffer_load_dwordx4 v245, s[32:35], s99 offen offset:1024  lds
    v_lshlrev_b32 v165, 16, v50
    v_lshlrev_b32 v166, 16, v52
    v_lshlrev_b32 v167, 16, v54
    v_lshlrev_b32 v168, 16, v56
    v_lshlrev_b32 v169, 16, v58
    buffer_load_dwordx4 v246, s[32:35], s99 offen offset:2048  lds
    v_lshlrev_b32 v170, 16, v60
    v_lshlrev_b32 v172, 16, v84
    v_and_b32 v173, 0xffff0000, v84
    v_lshlrev_b32 v174, 16, v85
    v_and_b32 v175, 0xffff0000, v85
    s_add_u32 m0, s61, 12288
    s_add_u32 s16, s16, s63
    buffer_load_dwordx4 v244, s[32:35], s16 offen offset:0  lds
    v_lshlrev_b32 v176, 16, v68
    v_lshlrev_b32 v177, 16, v70
    v_lshlrev_b32 v178, 16, v72
    v_lshlrev_b32 v179, 16, v74
    v_lshlrev_b32 v180, 16, v76
    buffer_load_dwordx4 v245, s[32:35], s16 offen offset:1024  lds
    v_lshlrev_b32 v181, 16, v78
    v_lshlrev_b32 v182, 16, v80
    v_lshlrev_b32 v183, 16, v82
    v_mul_f32 v184, v160, v175
    v_mul_f32 v185, v161, v175
    buffer_load_dwordx4 v246, s[32:35], s16 offen offset:2048  lds
    v_mul_f32 v186, v162, v175
    v_mul_f32 v187, v163, v175
    v_mul_f32 v188, v164, v175
    v_mul_f32 v189, v165, v175
    v_mul_f32 v190, v166, v175
    s_add_u32 s97, s98, s0
    s_lshr_b64 s[0:1], s[0:1], 4
    s_and_b32 s97, s97, 15
    s_add_u32 m0, s87, 18432
    s_lshl_b32 s97, s97, 7
    buffer_load_dwordx4 v240, s[28:31], s97 offen offset:0  lds
    v_mul_f32 v191, v167, v175
    v_fmac_f32 v184, v161, v174
    v_fmac_f32 v185, v162, v174
    v_fmac_f32 v186, v163, v174
    v_fmac_f32 v187, v164, v174
    buffer_load_dwordx4 v241, s[28:31], s97 offen offset:1024  lds
    v_fmac_f32 v188, v165, v174
    v_fmac_f32 v189, v166, v174
    v_fmac_f32 v190, v167, v174
    v_fmac_f32 v191, v168, v174
    v_fmac_f32 v184, v162, v173
    buffer_load_dwordx4 v242, s[28:31], s97 offen offset:2048  lds
    v_fmac_f32 v185, v163, v173
    v_fmac_f32 v186, v164, v173
    v_fmac_f32 v187, v165, v173
    v_fmac_f32 v188, v166, v173
    v_fmac_f32 v189, v167, v173
    buffer_load_dwordx4 v243, s[28:31], s97 offen offset:3072  lds
    v_fmac_f32 v190, v168, v173
    v_fmac_f32 v191, v169, v173
    v_fmac_f32 v184, v163, v172
    v_fmac_f32 v185, v164, v172
    v_fmac_f32 v186, v165, v172
    s_add_u32 m0, s88, 18432
    s_mov_b64 exec, 0xffffffff
    buffer_load_dwordx4 v3, s[28:31], s97 offen offset:0  lds
    s_mov_b64 exec, -1
    v_fmac_f32 v187, v166, v172
    v_fmac_f32 v188, v167, v172
    v_fmac_f32 v189, v168, v172
    v_fmac_f32 v190, v169, v172
    v_fmac_f32 v191, v170, v172
    v_mul_f32 v184, v184, v176
    v_mul_f32 v185, v185, v177
    v_mul_f32 v186, v186, v178
    v_mul_f32 v187, v187, v179
    v_mul_f32 v188, v188, v180
    v_mul_f32 v189, v189, v181
    v_mul_f32 v190, v190, v182
    v_mul_f32 v191, v191, v183
    v_cvt_pk_bf16_f32 v100, v191, v190
    v_cvt_pk_bf16_f32 v101, v189, v188
    v_cvt_pk_bf16_f32 v102, v187, v186
    v_cvt_pk_bf16_f32 v103, v185, v184
    s_mov_b32 s89, 0
    buffer_store_dwordx4 v[100:103], v12, s[52:55], s89 offen sc1
    v_and_b32 v160, 0xffff0000, v40
    v_and_b32 v161, 0xffff0000, v42
    v_and_b32 v162, 0xffff0000, v44
    v_and_b32 v163, 0xffff0000, v46
    v_and_b32 v164, 0xffff0000, v48
    v_and_b32 v165, 0xffff0000, v50
    v_and_b32 v166, 0xffff0000, v52
    v_and_b32 v167, 0xffff0000, v54
    v_and_b32 v168, 0xffff0000, v56
    v_and_b32 v169, 0xffff0000, v58
    v_and_b32 v170, 0xffff0000, v60
    v_lshlrev_b32 v172, 16, v86
    v_and_b32 v173, 0xffff0000, v86
    v_lshlrev_b32 v174, 16, v87
    v_and_b32 v175, 0xffff0000, v87
    v_and_b32 v176, 0xffff0000, v68
    v_and_b32 v177, 0xffff0000, v70
    v_and_b32 v178, 0xffff0000, v72
    v_and_b32 v179, 0xffff0000, v74
    v_and_b32 v180, 0xffff0000, v76
    v_and_b32 v181, 0xffff0000, v78
    v_and_b32 v182, 0xffff0000, v80
    v_and_b32 v183, 0xffff0000, v82
    s_waitcnt vmcnt(12)
    s_barrier
    s_mul_i32 s16, s97, 3072
    s_add_u32 m0, s60, 24576
    s_add_u32 s99, s16, s62
    buffer_load_dwordx4 v244, s[32:35], s99 offen offset:0  lds
    v_mul_f32 v184, v160, v175
    v_mul_f32 v185, v161, v175
    v_mul_f32 v186, v162, v175
    v_mul_f32 v187, v163, v175
    v_mul_f32 v188, v164, v175
    buffer_load_dwordx4 v245, s[32:35], s99 offen offset:1024  lds
    v_mul_f32 v189, v165, v175
    v_mul_f32 v190, v166, v175
    v_mul_f32 v191, v167, v175
    v_fmac_f32 v184, v161, v174
    v_fmac_f32 v185, v162, v174
    buffer_load_dwordx4 v246, s[32:35], s99 offen offset:2048  lds
    v_fmac_f32 v186, v163, v174
    v_fmac_f32 v187, v164, v174
    v_fmac_f32 v188, v165, v174
    v_fmac_f32 v189, v166, v174
    v_fmac_f32 v190, v167, v174
    s_add_u32 m0, s61, 36864
    s_add_u32 s16, s16, s63
    buffer_load_dwordx4 v244, s[32:35], s16 offen offset:0  lds
    v_fmac_f32 v191, v168, v174
    v_fmac_f32 v184, v162, v173
    v_fmac_f32 v185, v163, v173
    v_fmac_f32 v186, v164, v173
    v_fmac_f32 v187, v165, v173
    buffer_load_dwordx4 v245, s[32:35], s16 offen offset:1024  lds
    v_fmac_f32 v188, v166, v173
    v_fmac_f32 v189, v167, v173
    v_fmac_f32 v190, v168, v173
    v_fmac_f32 v191, v169, v173
    v_fmac_f32 v184, v163, v172
    buffer_load_dwordx4 v246, s[32:35], s16 offen offset:2048  lds
    v_fmac_f32 v185, v164, v172
    v_fmac_f32 v186, v165, v172
    v_fmac_f32 v187, v166, v172
    v_fmac_f32 v188, v167, v172
    v_fmac_f32 v189, v168, v172
    s_add_u32 s97, s98, s0
    s_lshr_b64 s[0:1], s[0:1], 4
    s_and_b32 s97, s97, 15
    s_add_u32 m0, s87, 36864
    s_lshl_b32 s97, s97, 7
    buffer_load_dwordx4 v240, s[28:31], s97 offen offset:0  lds
    v_fmac_f32 v190, v169, v172
    v_fmac_f32 v191, v170, v172
    v_mul_f32 v184, v184, v176
    v_mul_f32 v185, v185, v177
    v_mul_f32 v186, v186, v178
    buffer_load_dwordx4 v241, s[28:31], s97 offen offset:1024  lds
    v_mul_f32 v187, v187, v179
    v_mul_f32 v188, v188, v180
    v_mul_f32 v189, v189, v181
    v_mul_f32 v190, v190, v182
    v_mul_f32 v191, v191, v183
    buffer_load_dwordx4 v242, s[28:31], s97 offen offset:2048  lds
    v_cvt_pk_bf16_f32 v104, v191, v190
    v_cvt_pk_bf16_f32 v105, v189, v188
    v_cvt_pk_bf16_f32 v106, v187, v186
    v_cvt_pk_bf16_f32 v107, v185, v184
    s_mov_b32 s89, 16384
    buffer_store_dwordx4 v[104:107], v12, s[52:55], s89 offen sc1
    buffer_load_dwordx4 v243, s[28:31], s97 offen offset:3072  lds
    v_lshlrev_b32 v160, 16, v41
    v_lshlrev_b32 v161, 16, v43
    v_lshlrev_b32 v162, 16, v45
    v_lshlrev_b32 v163, 16, v47
    v_lshlrev_b32 v164, 16, v49
    s_add_u32 m0, s88, 36864
    s_mov_b64 exec, 0xffffffff
    buffer_load_dwordx4 v3, s[28:31], s97 offen offset:0  lds
    s_mov_b64 exec, -1
    v_lshlrev_b32 v165, 16, v51
    v_lshlrev_b32 v166, 16, v53
    v_lshlrev_b32 v167, 16, v55
    v_lshlrev_b32 v168, 16, v57
    v_lshlrev_b32 v169, 16, v59
    v_lshlrev_b32 v170, 16, v61
    v_lshlrev_b32 v172, 16, v88
    v_and_b32 v173, 0xffff0000, v88
    v_lshlrev_b32 v174, 16, v89
    v_and_b32 v175, 0xffff0000, v89
    v_lshlrev_b32 v176, 16, v69
    v_lshlrev_b32 v177, 16, v71
    v_lshlrev_b32 v178, 16, v73
    v_lshlrev_b32 v179, 16, v75
    v_lshlrev_b32 v180, 16, v77
    v_lshlrev_b32 v181, 16, v79
    v_lshlrev_b32 v182, 16, v81
    v_lshlrev_b32 v183, 16, v83
    v_mul_f32 v184, v160, v175
    v_mul_f32 v185, v161, v175
    v_mul_f32 v186, v162, v175
    v_mul_f32 v187, v163, v175
    v_mul_f32 v188, v164, v175
    v_mul_f32 v189, v165, v175
    v_mul_f32 v190, v166, v175
    v_mul_f32 v191, v167, v175
    v_fmac_f32 v184, v161, v174
    v_fmac_f32 v185, v162, v174
    v_fmac_f32 v186, v163, v174
    v_fmac_f32 v187, v164, v174
    v_fmac_f32 v188, v165, v174
    v_fmac_f32 v189, v166, v174
    v_fmac_f32 v190, v167, v174
    v_fmac_f32 v191, v168, v174
    v_fmac_f32 v184, v162, v173
    v_fmac_f32 v185, v163, v173
    v_fmac_f32 v186, v164, v173
    v_fmac_f32 v187, v165, v173
    v_fmac_f32 v188, v166, v173
    v_fmac_f32 v189, v167, v173
    v_fmac_f32 v190, v168, v173
    s_waitcnt vmcnt(13)
    s_barrier
    s_mul_i32 s16, s97, 3072
    s_add_u32 m0, s60, 49152
    s_add_u32 s99, s16, s62
    buffer_load_dwordx4 v244, s[32:35], s99 offen offset:0  lds
    v_fmac_f32 v191, v169, v173
    v_fmac_f32 v184, v163, v172
    v_fmac_f32 v185, v164, v172
    v_fmac_f32 v186, v165, v172
    v_fmac_f32 v187, v166, v172
    buffer_load_dwordx4 v245, s[32:35], s99 offen offset:1024  lds
    v_fmac_f32 v188, v167, v172
    v_fmac_f32 v189, v168, v172
    v_fmac_f32 v190, v169, v172
    v_fmac_f32 v191, v170, v172
    v_mul_f32 v184, v184, v176
    buffer_load_dwordx4 v246, s[32:35], s99 offen offset:2048  lds
    v_mul_f32 v185, v185, v177
    v_mul_f32 v186, v186, v178
    v_mul_f32 v187, v187, v179
    v_mul_f32 v188, v188, v180
    v_mul_f32 v189, v189, v181
    s_add_u32 m0, s61, 61440
    s_add_u32 s16, s16, s63
    buffer_load_dwordx4 v244, s[32:35], s16 offen offset:0  lds
    v_mul_f32 v190, v190, v182
    v_mul_f32 v191, v191, v183
    v_cvt_pk_bf16_f32 v108, v191, v190
    v_cvt_pk_bf16_f32 v109, v189, v188
    v_cvt_pk_bf16_f32 v110, v187, v186
    buffer_load_dwordx4 v245, s[32:35], s16 offen offset:1024  lds
    v_cvt_pk_bf16_f32 v111, v185, v184
    s_mov_b32 s89, 32768
    buffer_store_dwordx4 v[108:111], v12, s[52:55], s89 offen sc1
    v_and_b32 v160, 0xffff0000, v41
    v_and_b32 v161, 0xffff0000, v43
    v_and_b32 v162, 0xffff0000, v45
    buffer_load_dwordx4 v246, s[32:35], s16 offen offset:2048  lds
    v_and_b32 v163, 0xffff0000, v47
    v_and_b32 v164, 0xffff0000, v49
    v_and_b32 v165, 0xffff0000, v51
    v_and_b32 v166, 0xffff0000, v53
    v_and_b32 v167, 0xffff0000, v55
    s_add_u32 s97, s98, s0
    s_lshr_b64 s[0:1], s[0:1], 4
    s_and_b32 s97, s97, 15
    s_add_u32 m0, s87, 0
    s_lshl_b32 s97, s97, 7
    buffer_load_dwordx4 v240, s[28:31], s97 offen offset:0  lds
    v_and_b32 v168, 0xffff0000, v57
    v_and_b32 v169, 0xffff0000, v59
    v_and_b32 v170, 0xffff0000, v61
    v_lshlrev_b32 v172, 16, v90
    v_and_b32 v173, 0xffff0000, v90
    buffer_load_dwordx4 v241, s[28:31], s97 offen offset:1024  lds
    v_lshlrev_b32 v174, 16, v91
    v_and_b32 v175, 0xffff0000, v91
    v_and_b32 v176, 0xffff0000, v69
    v_and_b32 v177, 0xffff0000, v71
    v_and_b32 v178, 0xffff0000, v73
    buffer_load_dwordx4 v242, s[28:31], s97 offen offset:2048  lds
    v_and_b32 v179, 0xffff0000, v75
    v_and_b32 v180, 0xffff0000, v77
    v_and_b32 v181, 0xffff0000, v79
    v_and_b32 v182, 0xffff0000, v81
    v_and_b32 v183, 0xffff0000, v83
    buffer_load_dwordx4 v243, s[28:31], s97 offen offset:3072  lds
    v_mul_f32 v184, v160, v175
    v_mul_f32 v185, v161, v175
    v_mul_f32 v186, v162, v175
    v_mul_f32 v187, v163, v175
    v_mul_f32 v188, v164, v175
    s_add_u32 m0, s88, 0
    s_mov_b64 exec, 0xffffffff
    buffer_load_dwordx4 v3, s[28:31], s97 offen offset:0  lds
    s_mov_b64 exec, -1
    v_mul_f32 v189, v165, v175
    v_mul_f32 v190, v166, v175
    v_mul_f32 v191, v167, v175
    v_fmac_f32 v184, v161, v174
    v_fmac_f32 v185, v162, v174
    v_fmac_f32 v186, v163, v174
    v_fmac_f32 v187, v164, v174
    v_fmac_f32 v188, v165, v174
    v_fmac_f32 v189, v166, v174
    v_fmac_f32 v190, v167, v174
    v_fmac_f32 v191, v168, v174
    v_fmac_f32 v184, v162, v173
    v_fmac_f32 v185, v163, v173
    v_fmac_f32 v186, v164, v173
    v_fmac_f32 v187, v165, v173
    v_fmac_f32 v188, v166, v173
    v_fmac_f32 v189, v167, v173
    v_fmac_f32 v190, v168, v173
    v_fmac_f32 v191, v169, v173
    v_fmac_f32 v184, v163, v172
    v_fmac_f32 v185, v164, v172
    v_fmac_f32 v186, v165, v172
    v_fmac_f32 v187, v166, v172
    v_fmac_f32 v188, v167, v172
    v_fmac_f32 v189, v168, v172
    v_fmac_f32 v190, v169, v172
    v_fmac_f32 v191, v170, v172
    v_mul_f32 v184, v184, v176
    v_mul_f32 v185, v185, v177
    v_mul_f32 v186, v186, v178
    v_mul_f32 v187, v187, v179
    v_mul_f32 v188, v188, v180
    v_mul_f32 v189, v189, v181
    v_mul_f32 v190, v190, v182
    v_mul_f32 v191, v191, v183
    v_cvt_pk_bf16_f32 v112, v191, v190
    v_cvt_pk_bf16_f32 v113, v189, v188
    v_cvt_pk_bf16_f32 v114, v187, v186
    v_cvt_pk_bf16_f32 v115, v185, v184
    s_mov_b32 s89, 49152
    buffer_store_dwordx4 v[112:115], v12, s[52:55], s89 offen sc1
    s_waitcnt vmcnt(13)
    s_barrier
    s_mul_i32 s16, s97, 3072
    s_add_u32 m0, s60, 0
    s_add_u32 s99, s16, s62
    buffer_load_dwordx4 v244, s[32:35], s99 offen offset:0  lds
    buffer_load_dwordx4 v245, s[32:35], s99 offen offset:1024  lds
    buffer_load_dwordx4 v246, s[32:35], s99 offen offset:2048  lds
    s_add_u32 m0, s61, 12288
    s_add_u32 s16, s16, s63
    buffer_load_dwordx4 v244, s[32:35], s16 offen offset:0  lds
    buffer_load_dwordx4 v245, s[32:35], s16 offen offset:1024  lds
    buffer_load_dwordx4 v246, s[32:35], s16 offen offset:2048  lds
    s_add_u32 m0, s94, 32
    s_lshl_b32 s89, s90, 12
    buffer_load_dwordx4 v15, s[48:51], s89 offen offset:0 nt lds
    s_add_u32 m0, s94, 32
    s_lshl_b32 s89, s90, 12
    buffer_load_dwordx4 v15, s[48:51], s89 offen offset:1024 nt lds
    s_add_u32 m0, s94, 32
    s_lshl_b32 s89, s90, 12
    buffer_load_dwordx4 v15, s[48:51], s89 offen offset:2048 nt lds
    s_add_u32 m0, s94, 32
    s_lshl_b32 s89, s90, 12
    buffer_load_dwordx4 v15, s[48:51], s89 offen offset:3072 nt lds
    s_add_u32 s97, s98, s0
    s_lshr_b64 s[0:1], s[0:1], 4
    s_and_b32 s97, s97, 15
    s_add_u32 m0, s87, 18432
    s_lshl_b32 s97, s97, 7
    buffer_load_dwordx4 v240, s[28:31], s97 offen offset:0  lds
    buffer_load_dwordx4 v241, s[28:31], s97 offen offset:1024  lds
    buffer_load_dwordx4 v242, s[28:31], s97 offen offset:2048  lds
    buffer_load_dwordx4 v243, s[28:31], s97 offen offset:3072  lds
    s_add_u32 m0, s88, 18432
    s_mov_b64 exec, 0xffffffff
    buffer_load_dwordx4 v3, s[28:31], s97 offen offset:0  lds
    s_mov_b64 exec, -1
    s_waitcnt vmcnt(16)
    s_barrier
    s_mul_i32 s16, s97, 3072
    s_add_u32 m0, s60, 24576
    s_add_u32 s99, s16, s62
    buffer_load_dwordx4 v244, s[32:35], s99 offen offset:0  lds
    buffer_load_dwordx4 v245, s[32:35], s99 offen offset:1024  lds
    buffer_load_dwordx4 v246, s[32:35], s99 offen offset:2048  lds
    s_add_u32 m0, s61, 36864
    s_add_u32 s16, s16, s63
    buffer_load_dwordx4 v244, s[32:35], s16 offen offset:0  lds
    buffer_load_dwordx4 v245, s[32:35], s16 offen offset:1024  lds
    buffer_load_dwordx4 v246, s[32:35], s16 offen offset:2048  lds
    s_add_u32 s97, s98, s0
    s_lshr_b64 s[0:1], s[0:1], 4
    s_and_b32 s97, s97, 15
    s_add_u32 m0, s87, 36864
    s_lshl_b32 s97, s97, 7
    buffer_load_dwordx4 v240, s[28:31], s97 offen offset:0  lds
    buffer_load_dwordx4 v241, s[28:31], s97 offen offset:1024  lds
    buffer_load_dwordx4 v242, s[28:31], s97 offen offset:2048  lds
    buffer_load_dwordx4 v243, s[28:31], s97 offen offset:3072  lds
    s_add_u32 m0, s88, 36864
    s_mov_b64 exec, 0xffffffff
    buffer_load_dwordx4 v3, s[28:31], s97 offen offset:0  lds
    s_mov_b64 exec, -1
    s_waitcnt vmcnt(11)
    s_barrier
    s_mul_i32 s16, s97, 3072
    s_add_u32 m0, s60, 49152
    s_add_u32 s99, s16, s62
    buffer_load_dwordx4 v244, s[32:35], s99 offen offset:0  lds
    s_mov_b32 s68, s24
    s_mov_b32 s69, s25
    s_mov_b32 s70, 0x100
    s_mov_b32 s71, 0x20000
    v_lshrrev_b32 v6, 5, v0
    buffer_load_dwordx4 v245, s[32:35], s99 offen offset:1024  lds
    v_and_b32 v7, 3, v0
    s_lshr_b32 s78, s90, 1
    s_lshl_b32 s78, s78, 2
    s_load_dword s92, s[14:15], s78
    v_bfe_u32 v5, v0, 2, 2
    buffer_load_dwordx4 v246, s[32:35], s99 offen offset:2048  lds
    v_lshlrev_b32 v5, 1, v5
    v_lshl_add_u32 v5, v6, 3, v5
    v_bfe_u32 v8, v0, 4, 1
    v_add_u32 v5, v5, v8
    s_and_b32 s78, s3, 1
    s_add_u32 m0, s61, 61440
    s_add_u32 s16, s16, s63
    buffer_load_dwordx4 v244, s[32:35], s16 offen offset:0  lds
    s_lshl_b32 s78, s78, 1
    v_add_u32 v8, s78, v6
    v_xor_b32 v8, v8, v7
    v_lshlrev_b32 v8, 4, v8
    buffer_load_dwordx4 v245, s[32:35], s16 offen offset:1024  lds
    v_lshl_add_u32 v5, v5, 6, v8
    v_add_u32 v14, s86, v5
    v_mov_b32 v18, 162304
    v_mov_b32 v19, 1
    v_and_b32 v5, 3, v0
    buffer_load_dwordx4 v246, s[32:35], s16 offen offset:2048  lds
    s_lshl_b32 s78, s74, 4
    s_add_u32 s78, s78, s3
    v_lshl_add_u32 v6, v5, 2, s78
    s_lshr_b32 s78, s76, 3
    s_lshl_b32 s79, s3, 1
    s_add_u32 s97, s98, s0
    s_lshr_b64 s[0:1], s[0:1], 4
    s_and_b32 s97, s97, 15
    s_add_u32 m0, s87, 0
    s_lshl_b32 s97, s97, 7
    buffer_load_dwordx4 v240, s[28:31], s97 offen offset:0  lds
    s_add_u32 s78, s78, s79
    s_xor_b32 s78, s78, 2
    s_lshl_b32 s78, s78, 5
    s_add_u32 s79, s76, 5
    s_and_b32 s79, s79, 7
    buffer_load_dwordx4 v241, s[28:31], s97 offen offset:1024  lds
    s_lshl_b32 s79, s79, 1
    s_add_u32 s78, s78, s79
    v_mul_u32_u24 v7, 9, v5
    v_and_b32 v7, 17, v7
    buffer_load_dwordx4 v242, s[28:31], s97 offen offset:2048  lds
    v_add_u32 v7, s78, v7
    v_and_b32 v8, 4, v0
    v_cmp_eq_u32 vcc, 0, v8
    s_nop 1
    v_cndmask_b32 v6, v7, v6, vcc
    v_and_b32 v33, 0xf0, v6
    buffer_load_dwordx4 v243, s[28:31], s97 offen offset:3072  lds
    v_lshlrev_b32 v34, 8, v6
    v_add_u32 v34, 12582912, v34
    v_and_b32 v5, 15, v0
    v_lshrrev_b32 v6, 4, v0
    v_add_u32 v7, 9, v5
    s_add_u32 m0, s88, 0
    s_mov_b64 exec, 0xffffffff
    buffer_load_dwordx4 v3, s[28:31], s97 offen offset:0  lds
    s_mov_b64 exec, -1
    v_and_b32 v8, 1, v7
    v_mul_u32_u24 v8, 4160, v8
    v_lshrrev_b32 v7, 1, v7
    v_lshl_add_u32 v8, v7, 2, v8
    s_waitcnt vmcnt(11)
    s_barrier
    s_mul_i32 s16, s97, 3072
    s_add_u32 m0, s60, 0
    s_add_u32 s99, s16, s62
    buffer_load_dwordx4 v244, s[32:35], s99 offen offset:0  lds
    v_lshlrev_b32 v7, 4, v6
    v_sub_u32 v8, v8, v7
    s_add_u32 s78, s94, 32
    v_add_u32 v21, s78, v8
    v_add_u32 v22, 1024, v21
    buffer_load_dwordx4 v245, s[32:35], s99 offen offset:1024  lds
    v_add_u32 v23, 2048, v21
    v_add_u32 v24, 3072, v21
    v_lshl_add_u32 v7, v5, 1, v6
    v_add_u32 v7, 30, v7
    v_and_b32 v8, 1, v7
    buffer_load_dwordx4 v246, s[32:35], s99 offen offset:2048  lds
    v_bfe_u32 v136, v7, 1, 2
    v_lshl_add_u32 v136, v8, 2, v136
    v_lshlrev_b32 v136, 6, v136
    v_lshrrev_b32 v7, 3, v7
    v_lshl_add_u32 v136, v7, 9, v136
    s_add_u32 m0, s61, 12288
    s_add_u32 s16, s16, s63
    buffer_load_dwordx4 v244, s[32:35], s16 offen offset:0  lds
    v_bitop3_b32 v8, v7, 3, s3 bitop3:0x6a
    v_lshl_add_u32 v25, v8, 4, v136
    v_add_u32 v25, 92160, v25
    v_subrev_u32 v7, 1, v7
    buffer_load_dwordx4 v245, s[32:35], s16 offen offset:1024  lds
    v_bitop3_b32 v8, v7, 3, s3 bitop3:0x6a
    v_lshl_add_u32 v27, v8, 4, v136
    v_add_u32 v27, 91648, v27
    v_subrev_u32 v7, 1, v7
    v_bitop3_b32 v8, v7, 3, s3 bitop3:0x6a
    buffer_load_dwordx4 v246, s[32:35], s16 offen offset:2048  lds
    v_lshl_add_u32 v29, v8, 4, v136
    v_add_u32 v29, 91136, v29
    v_subrev_u32 v7, 1, v7
    v_bitop3_b32 v8, v7, 3, s3 bitop3:0x6a
    v_lshl_add_u32 v31, v8, 4, v136
    s_add_u32 s97, s98, s0
    s_lshr_b64 s[0:1], s[0:1], 4
    s_and_b32 s97, s97, 15
    s_add_u32 m0, s87, 18432
    s_lshl_b32 s97, s97, 7
    buffer_load_dwordx4 v240, s[28:31], s97 offen offset:0  lds
    v_add_u32 v31, 90624, v31
    v_lshl_add_u32 v7, v5, 1, v6
    v_add_u32 v7, 26, v7
    v_and_b32 v8, 1, v7
    v_bfe_u32 v136, v7, 1, 2
    buffer_load_dwordx4 v241, s[28:31], s97 offen offset:1024  lds
    v_lshl_add_u32 v136, v8, 2, v136
    v_lshlrev_b32 v136, 6, v136
    v_lshrrev_b32 v7, 3, v7
    v_lshl_add_u32 v136, v7, 9, v136
    buffer_load_dwordx4 v242, s[28:31], s97 offen offset:2048  lds
    v_bitop3_b32 v8, v7, 3, s3 bitop3:0x6a
    v_lshl_add_u32 v26, v8, 4, v136
    v_add_u32 v26, 92160, v26
    v_subrev_u32 v7, 1, v7
    v_bitop3_b32 v8, v7, 3, s3 bitop3:0x6a
    buffer_load_dwordx4 v243, s[28:31], s97 offen offset:3072  lds
    v_lshl_add_u32 v28, v8, 4, v136
    v_add_u32 v28, 91648, v28
    v_subrev_u32 v7, 1, v7
    v_bitop3_b32 v8, v7, 3, s3 bitop3:0x6a
    v_lshl_add_u32 v30, v8, 4, v136
    s_add_u32 m0, s88, 18432
    s_mov_b64 exec, 0xffffffff
    buffer_load_dwordx4 v3, s[28:31], s97 offen offset:0  lds
    s_mov_b64 exec, -1
    v_add_u32 v30, 91136, v30
    v_subrev_u32 v7, 1, v7
    v_bitop3_b32 v8, v7, 3, s3 bitop3:0x6a
    v_lshl_add_u32 v32, v8, 4, v136
    s_waitcnt vmcnt(11)
    s_barrier
    s_mul_i32 s16, s97, 3072
    s_add_u32 m0, s60, 24576
    s_add_u32 s99, s16, s62
    buffer_load_dwordx4 v244, s[32:35], s99 offen offset:0  lds
    v_add_u32 v32, 90624, v32
    v_lshrrev_b32 v7, 1, v6
    v_lshl_add_u32 v7, v5, 1, v7
    v_add_u32 v7, 32, v7
    v_and_b32 v8, 1, v7
    buffer_load_dwordx4 v245, s[32:35], s99 offen offset:1024  lds
    v_bfe_u32 v136, v7, 1, 2
    v_lshl_add_u32 v136, v8, 2, v136
    v_lshlrev_b32 v136, 6, v136
    v_lshrrev_b32 v7, 3, v7
    buffer_load_dwordx4 v246, s[32:35], s99 offen offset:2048  lds
    v_lshl_add_u32 v136, v7, 9, v136
    v_bitop3_b32 v8, v7, 3, s3 bitop3:0x6a
    v_lshl_add_u32 v20, v8, 4, v136
    v_add_u32 v20, 92160, v20
    v_and_b32 v8, 1, v6
    s_add_u32 m0, s61, 36864
    s_add_u32 s16, s16, s63
    buffer_load_dwordx4 v244, s[32:35], s16 offen offset:0  lds
    v_xor_b32 v8, 1, v8
    v_lshl_add_u32 v20, v8, 3, v20
    s_waitcnt lgkmcnt(0)
    s_and_b32 s78, s92, 0xffff0000
    buffer_load_dwordx4 v245, s[32:35], s16 offen offset:1024  lds
    s_lshl_b32 s92, s92, 16
    s_bitcmp1_b32 s90, 0
    s_cselect_b32 s92, s78, s92
    v_lshlrev_b32 v7, 3, v6
    v_sub_u32 v7, v7, v5
    buffer_load_dwordx4 v246, s[32:35], s16 offen offset:2048  lds
    v_subrev_u32 v7, 9, v7
    v_and_b32 v8, 1, v7
    v_xor_b32 v8, 1, v8
    v_lshlrev_b32 v8, 4, v8
    v_lshrrev_b32 v8, v8, s92
    s_add_u32 s97, s98, s0
    s_lshr_b64 s[0:1], s[0:1], 4
    s_and_b32 s97, s97, 15
    s_add_u32 m0, s87, 36864
    s_lshl_b32 s97, s97, 7
    buffer_load_dwordx4 v240, s[28:31], s97 offen offset:0  lds
    v_ashrrev_i32 v7, 1, v7
    v_cmp_eq_u32 vcc, 0, v7
    s_nop 1
    v_cndmask_b32 v236, 0, v8, vcc
    v_cmp_eq_u32 vcc, 1, v7
    buffer_load_dwordx4 v241, s[28:31], s97 offen offset:1024  lds
    s_nop 0
    v_cndmask_b32 v237, 0, v8, vcc
    v_cmp_eq_u32 vcc, 2, v7
    s_nop 1
    v_cndmask_b32 v238, 0, v8, vcc
    v_cmp_eq_u32 vcc, 3, v7
    buffer_load_dwordx4 v242, s[28:31], s97 offen offset:2048  lds
    s_nop 0
    v_cndmask_b32 v239, 0, v8, vcc
    s_and_b32 s78, s77, 7
    s_mov_b32 s95, 0x76543210
    s_cmp_eq_u32 s78, 1
    s_cselect_b32 s95, 0x76543201, s95
    s_cmp_eq_u32 s78, 2
    s_cselect_b32 s95, 0x76543120, s95
    s_cmp_eq_u32 s78, 3
    s_cselect_b32 s95, 0x76542310, s95
    s_cmp_eq_u32 s78, 4
    s_cselect_b32 s95, 0x76534210, s95
    s_cmp_eq_u32 s78, 5
    s_cselect_b32 s95, 0x76453210, s95
    s_cmp_eq_u32 s78, 6
    s_cselect_b32 s95, 0x75643210, s95
    s_cmp_eq_u32 s78, 7
    s_cselect_b32 s95, 0x67543210, s95
    s_and_b32 s78, s76, 3
    s_mul_i32 s78, s78, 0x22222222
    s_add_u32 s95, s95, s78
    s_bfe_u32 s100, s95, 0x3001c
    s_lshl_b32 s100, s100, 18
    s_bfe_u32 s95, s95, 0x30018
    s_lshl_b32 s95, s95, 18
    v_lshrrev_b32 v136, 4, v0
    v_lshlrev_b32 v136, 1, v136
    v_and_b32 v137, 7, v0
    buffer_load_dwordx4 v243, s[28:31], s97 offen offset:3072  lds
    v_xor_b32 v136, v136, v137
    v_lshlrev_b32 v136, 4, v136
    v_lshrrev_b32 v137, 3, v0
    v_lshl_add_u32 v136, v137, 11, v136
    s_add_u32 m0, s88, 36864
    s_mov_b64 exec, 0xffffffff
    buffer_load_dwordx4 v3, s[28:31], s97 offen offset:0  lds
    s_mov_b64 exec, -1
    s_lshl_b32 s78, s77, 7
    s_lshl_b32 s79, s3, 14
    s_add_u32 s78, s78, s79
    v_add_u32 v17, s78, v136
    s_waitcnt vmcnt(11)
    s_barrier
    s_mul_i32 s16, s97, 3072
    s_add_u32 m0, s60, 49152
    s_add_u32 s99, s16, s62
    buffer_load_dwordx4 v244, s[32:35], s99 offen offset:0  lds
    v_add_u32 v5, s94, v15
    ds_read_b128 v[140:143], v5 offset:32
    ds_read_b32 v156, v5 offset:48
    ds_read_b128 v[144:147], v5 offset:1056
    buffer_load_dwordx4 v245, s[32:35], s99 offen offset:1024  lds
    ds_read_b32 v157, v5 offset:1072
    ds_read_b128 v[148:151], v5 offset:2080
    ds_read_b32 v158, v5 offset:2096
    ds_read_b128 v[152:155], v5 offset:3104
    buffer_load_dwordx4 v246, s[32:35], s99 offen offset:2048  lds
    ds_read_b32 v159, v5 offset:3120
    v_lshrrev_b32 v6, 3, v0
    v_mul_u32_u24 v6, 4160, v6
    s_add_u32 m0, s61, 61440
    s_add_u32 s16, s16, s63
    buffer_load_dwordx4 v244, s[32:35], s16 offen offset:0  lds
    v_and_b32 v7, 7, v0
    v_lshl_add_u32 v6, v7, 2, v6
    v_add_u32 v6, s94, v6
    v_mov_b32 v7, 0
    buffer_load_dwordx4 v245, s[32:35], s16 offen offset:1024  lds
    s_waitcnt lgkmcnt(0)
    v_readfirstlane_b32 s93, v140
    s_nop 0
    s_lshl_b32 s93, s93, 16
    s_nop 1
    v_writelane_b32 v7, s93, 15
    buffer_load_dwordx4 v246, s[32:35], s16 offen offset:2048  lds
    v_alignbit_b32 v140, v141, v140, 16
    v_alignbit_b32 v141, v142, v141, 16
    v_alignbit_b32 v142, v143, v142, 16
    s_add_u32 s97, s98, s0
    s_lshr_b64 s[0:1], s[0:1], 4
    s_and_b32 s97, s97, 15
    s_add_u32 m0, s87, 0
    s_lshl_b32 s97, s97, 7
    buffer_load_dwordx4 v240, s[28:31], s97 offen offset:0  lds
    v_alignbit_b32 v143, v156, v143, 16
    v_alignbit_b32 v144, v145, v144, 16
    v_alignbit_b32 v145, v146, v145, 16
    v_alignbit_b32 v146, v147, v146, 16
    buffer_load_dwordx4 v241, s[28:31], s97 offen offset:1024  lds
    v_alignbit_b32 v147, v157, v147, 16
    v_alignbit_b32 v148, v149, v148, 16
    v_alignbit_b32 v149, v150, v149, 16
    v_alignbit_b32 v150, v151, v150, 16
    buffer_load_dwordx4 v242, s[28:31], s97 offen offset:2048  lds
    v_alignbit_b32 v151, v158, v151, 16
    v_alignbit_b32 v152, v153, v152, 16
    v_alignbit_b32 v153, v154, v153, 16
    buffer_load_dwordx4 v243, s[28:31], s97 offen offset:3072  lds
    v_alignbit_b32 v154, v155, v154, 16
    v_alignbit_b32 v155, v159, v155, 16
    v_lshlrev_b32 v8, 3, v0
    s_add_u32 s78, s88, 18432
    s_add_u32 m0, s88, 0
    s_mov_b64 exec, 0xffffffff
    buffer_load_dwordx4 v3, s[28:31], s97 offen offset:0  lds
    s_mov_b64 exec, -1
    v_add_u32 v8, s78, v8
    v_mov_b32 v156, 0
    v_mov_b32 v157, 0
    s_waitcnt vmcnt(11)
    s_barrier
    s_mul_i32 s16, s97, 3072
    s_add_u32 m0, s60, 0
    s_add_u32 s99, s16, s62
    buffer_load_dwordx4 v244, s[32:35], s99 offen offset:0  lds
    buffer_load_dwordx4 v245, s[32:35], s99 offen offset:1024  lds
    buffer_load_dwordx4 v246, s[32:35], s99 offen offset:2048  lds
    s_add_u32 m0, s61, 12288
    s_add_u32 s16, s16, s63
    buffer_load_dwordx4 v244, s[32:35], s16 offen offset:0  lds
    buffer_load_dwordx4 v245, s[32:35], s16 offen offset:1024  lds
    buffer_load_dwordx4 v246, s[32:35], s16 offen offset:2048  lds
    s_mov_b64 exec, 0xff
    buffer_load_dword v136, v33, s[68:71], 0 offen sc1
    buffer_load_dword v137, v34, s[52:55], 0 offen sc1
    s_mov_b64 exec, -1
    buffer_load_dwordx4 v[212:215], v9, s[56:59], 0 offen offset:0 nt
    buffer_load_dwordx4 v[216:219], v9, s[56:59], 0 offen offset:2048 nt
    buffer_load_dwordx4 v[220:223], v9, s[56:59], s96 offen offset:0 nt
    buffer_load_dwordx4 v[224:227], v9, s[56:59], s96 offen offset:2048 nt
    s_waitcnt vmcnt(12)
    s_waitcnt vmcnt(6)
    s_barrier
    s_waitcnt vmcnt(4)
    s_branch LA_j
LA_c1:
    s_waitcnt vmcnt(8)
    s_barrier
    buffer_load_dwordx4 v242, s[28:31], s97 offen offset:2048  lds
    buffer_load_dwordx4 v243, s[28:31], s97 offen offset:3072  lds
    s_add_u32 m0, s88, 36864
    s_mov_b64 exec, 0xffffffff
    buffer_load_dwordx4 v3, s[28:31], s97 offen offset:0  lds
    s_mov_b64 exec, -1
    s_mul_i32 s16, s97, 3072
    s_add_u32 m0, s60, 49152
    s_add_u32 s99, s16, s62
    buffer_load_dwordx4 v244, s[32:35], s99 offen offset:0  lds
    buffer_load_dwordx4 v245, s[32:35], s99 offen offset:1024  lds
    buffer_load_dwordx4 v246, s[32:35], s99 offen offset:2048  lds
    s_add_u32 m0, s61, 61440
    s_add_u32 s16, s16, s63
    buffer_load_dwordx4 v244, s[32:35], s16 offen offset:0  lds
    buffer_load_dwordx4 v245, s[32:35], s16 offen offset:1024  lds
    buffer_load_dwordx4 v246, s[32:35], s16 offen offset:2048  lds
    s_add_u32 s97, s98, s0
    s_lshr_b64 s[0:1], s[0:1], 4
    s_and_b32 s97, s97, 15
    s_add_u32 m0, s87, 0
    s_lshl_b32 s97, s97, 7
    buffer_load_dwordx4 v240, s[28:31], s97 offen offset:0  lds
    buffer_load_dwordx4 v241, s[28:31], s97 offen offset:1024  lds
    buffer_load_dwordx4 v242, s[28:31], s97 offen offset:2048  lds
    buffer_load_dwordx4 v243, s[28:31], s97 offen offset:3072  lds
    s_add_u32 m0, s88, 0
    s_mov_b64 exec, 0xffffffff
    buffer_load_dwordx4 v3, s[28:31], s97 offen offset:0  lds
    s_mov_b64 exec, -1
    s_waitcnt vmcnt(11)
    s_barrier
    s_mul_i32 s16, s97, 3072
    s_add_u32 m0, s60, 0
    s_add_u32 s99, s16, s62
    buffer_load_dwordx4 v244, s[32:35], s99 offen offset:0  lds
    buffer_load_dwordx4 v245, s[32:35], s99 offen offset:1024  lds
    buffer_load_dwordx4 v246, s[32:35], s99 offen offset:2048  lds
    s_add_u32 m0, s61, 12288
    s_add_u32 s16, s16, s63
    buffer_load_dwordx4 v244, s[32:35], s16 offen offset:0  lds
    buffer_load_dwordx4 v245, s[32:35], s16 offen offset:1024  lds
    buffer_load_dwordx4 v246, s[32:35], s16 offen offset:2048  lds
    s_add_u32 m0, s86, 129536
    s_mov_b32 s89, 0
    buffer_load_dwordx4 v10, s[36:39], s89 offen nt lds
    s_add_u32 m0, s86, 145920
    s_mov_b32 s89, 0
    buffer_load_dwordx4 v10, s[40:43], s89 offen nt lds
    s_add_u32 m0, s86, 133632
    s_mov_b32 s89, 65536
    buffer_load_dwordx4 v10, s[36:39], s89 offen nt lds
    s_add_u32 m0, s86, 150016
    s_mov_b32 s89, 65536
    buffer_load_dwordx4 v10, s[40:43], s89 offen nt lds
    s_add_u32 m0, s86, 137728
    s_mov_b32 s89, 131072
    buffer_load_dwordx4 v10, s[36:39], s89 offen nt lds
    s_add_u32 m0, s86, 154112
    s_mov_b32 s89, 131072
    buffer_load_dwordx4 v10, s[40:43], s89 offen nt lds
    s_add_u32 m0, s86, 141824
    s_mov_b32 s89, 196608
    buffer_load_dwordx4 v10, s[36:39], s89 offen nt lds
    s_add_u32 m0, s86, 158208
    s_mov_b32 s89, 196608
    buffer_load_dwordx4 v10, s[40:43], s89 offen nt lds
    s_mov_b64 exec, 0xff
    s_lshl_b32 s82, s3, 7
    s_add_u32 m0, s82, 129024
    s_mov_b32 s89, 0
    buffer_load_dwordx4 v11, s[36:39], s89 offen nt lds
    s_lshl_b32 s83, s74, 9
    s_add_u32 s83, s83, s82
    s_and_b32 s89, s3, 2
    s_lshl_b32 s89, s89, 3
    s_add_u32 s82, s82, s89
    s_add_u32 m0, s82, 162816
    s_add_u32 s89, s83, 0
    buffer_load_dwordx4 v15, s[44:47], s89 offen  lds
    s_mov_b64 exec, -1
    s_add_u32 s97, s98, s0
    s_lshr_b64 s[0:1], s[0:1], 4
    s_and_b32 s97, s97, 15
    s_add_u32 m0, s87, 18432
    s_lshl_b32 s97, s97, 7
    buffer_load_dwordx4 v240, s[28:31], s97 offen offset:0  lds
    s_waitcnt vmcnt(17)
    s_barrier
    buffer_load_dwordx4 v241, s[28:31], s97 offen offset:1024  lds
    buffer_load_dwordx4 v242, s[28:31], s97 offen offset:2048  lds
    buffer_load_dwordx4 v243, s[28:31], s97 offen offset:3072  lds
    s_add_u32 m0, s88, 18432
    s_mov_b64 exec, 0xffffffff
    buffer_load_dwordx4 v3, s[28:31], s97 offen offset:0  lds
    s_mov_b64 exec, -1
    s_mul_i32 s16, s97, 3072
    s_add_u32 m0, s60, 24576
    s_add_u32 s99, s16, s62
    buffer_load_dwordx4 v244, s[32:35], s99 offen offset:0  lds
    buffer_load_dwordx4 v245, s[32:35], s99 offen offset:1024  lds
    buffer_load_dwordx4 v246, s[32:35], s99 offen offset:2048  lds
    s_add_u32 m0, s61, 36864
    s_add_u32 s16, s16, s63
    buffer_load_dwordx4 v244, s[32:35], s16 offen offset:0  lds
    buffer_load_dwordx4 v245, s[32:35], s16 offen offset:1024  lds
    buffer_load_dwordx4 v246, s[32:35], s16 offen offset:2048  lds
    s_add_u32 s97, s98, s0
    s_lshr_b64 s[0:1], s[0:1], 4
    s_and_b32 s97, s97, 15
    s_add_u32 m0, s87, 36864
    s_lshl_b32 s97, s97, 7
    buffer_load_dwordx4 v240, s[28:31], s97 offen offset:0  lds
    buffer_load_dwordx4 v241, s[28:31], s97 offen offset:1024  lds
    buffer_load_dwordx4 v242, s[28:31], s97 offen offset:2048  lds
    buffer_load_dwordx4 v243, s[28:31], s97 offen offset:3072  lds
    s_add_u32 m0, s88, 36864
    s_mov_b64 exec, 0xffffffff
    buffer_load_dwordx4 v3, s[28:31], s97 offen offset:0  lds
    s_mov_b64 exec, -1
    s_waitcnt vmcnt(11)
    s_barrier
    s_mul_i32 s16, s97, 3072
    s_add_u32 m0, s60, 49152
    s_add_u32 s99, s16, s62
    buffer_load_dwordx4 v244, s[32:35], s99 offen offset:0  lds
    ds_read_b128 v[84:87], v35 offset:0
    ds_read_b128 v[88:91], v35 offset:16
    buffer_load_dwordx4 v245, s[32:35], s99 offen offset:1024  lds
    ds_read_b64 v[40:41], v16 offset:0
    ds_read_b64 v[42:43], v231 offset:256
    buffer_load_dwordx4 v246, s[32:35], s99 offen offset:2048  lds
    ds_read_b64 v[44:45], v16 offset:256
    ds_read_b64 v[46:47], v16 offset:512
    s_add_u32 m0, s61, 61440
    s_add_u32 s16, s16, s63
    buffer_load_dwordx4 v244, s[32:35], s16 offen offset:0  lds
    ds_read_b64 v[48:49], v231 offset:512
    ds_read_b64 v[50:51], v16 offset:768
    buffer_load_dwordx4 v245, s[32:35], s16 offen offset:1024  lds
    ds_read_b64 v[52:53], v231 offset:768
    ds_read_b64 v[54:55], v16 offset:1024
    buffer_load_dwordx4 v246, s[32:35], s16 offen offset:2048  lds
    ds_read_b64 v[56:57], v231 offset:1024
    ds_read_b64 v[58:59], v16 offset:1280
    s_add_u32 s97, s98, s0
    s_lshr_b64 s[0:1], s[0:1], 4
    s_and_b32 s97, s97, 15
    s_add_u32 m0, s87, 0
    s_lshl_b32 s97, s97, 7
    buffer_load_dwordx4 v240, s[28:31], s97 offen offset:0  lds
    ds_read_b64 v[60:61], v231 offset:1280
    ds_read_b64 v[68:69], v16 offset:16896
    buffer_load_dwordx4 v241, s[28:31], s97 offen offset:1024  lds
    ds_read_b64 v[70:71], v231 offset:16896
    ds_read_b64 v[72:73], v16 offset:17152
    buffer_load_dwordx4 v242, s[28:31], s97 offen offset:2048  lds
    ds_read_b64 v[74:75], v231 offset:17152
    ds_read_b64 v[76:77], v16 offset:17408
    buffer_load_dwordx4 v243, s[28:31], s97 offen offset:3072  lds
    ds_read_b64 v[78:79], v231 offset:17408
    ds_read_b64 v[80:81], v16 offset:17664
    s_add_u32 m0, s88, 0
    s_mov_b64 exec, 0xffffffff
    buffer_load_dwordx4 v3, s[28:31], s97 offen offset:0  lds
    s_mov_b64 exec, -1
    ds_read_b64 v[82:83], v231 offset:17664
    s_waitcnt vmcnt(11)
    s_waitcnt lgkmcnt(0)
    s_barrier
    s_mul_i32 s16, s97, 3072
    s_add_u32 m0, s60, 0
    s_add_u32 s99, s16, s62
    buffer_load_dwordx4 v244, s[32:35], s99 offen offset:0  lds
    v_lshlrev_b32 v160, 16, v40
    v_lshlrev_b32 v161, 16, v42
    v_lshlrev_b32 v162, 16, v44
    v_lshlrev_b32 v163, 16, v46
    v_lshlrev_b32 v164, 16, v48
    buffer_load_dwordx4 v245, s[32:35], s99 offen offset:1024  lds
    v_lshlrev_b32 v165, 16, v50
    v_lshlrev_b32 v166, 16, v52
    v_lshlrev_b32 v167, 16, v54
    v_lshlrev_b32 v168, 16, v56
    v_lshlrev_b32 v169, 16, v58
    buffer_load_dwordx4 v246, s[32:35], s99 offen offset:2048  lds
    v_lshlrev_b32 v170, 16, v60
    v_lshlrev_b32 v172, 16, v84
    v_and_b32 v173, 0xffff0000, v84
    v_lshlrev_b32 v174, 16, v85
    v_and_b32 v175, 0xffff0000, v85
    s_add_u32 m0, s61, 12288
    s_add_u32 s16, s16, s63
    buffer_load_dwordx4 v244, s[32:35], s16 offen offset:0  lds
    v_lshlrev_b32 v176, 16, v68
    v_lshlrev_b32 v177, 16, v70
    v_lshlrev_b32 v178, 16, v72
    v_lshlrev_b32 v179, 16, v74
    v_lshlrev_b32 v180, 16, v76
    buffer_load_dwordx4 v245, s[32:35], s16 offen offset:1024  lds
    v_lshlrev_b32 v181, 16, v78
    v_lshlrev_b32 v182, 16, v80
    v_lshlrev_b32 v183, 16, v82
    v_mul_f32 v184, v160, v175
    v_mul_f32 v185, v161, v175
    buffer_load_dwordx4 v246, s[32:35], s16 offen offset:2048  lds
    v_mul_f32 v186, v162, v175
    v_mul_f32 v187, v163, v175
    v_mul_f32 v188, v164, v175
    v_mul_f32 v189, v165, v175
    v_mul_f32 v190, v166, v175
    buffer_load_dword v230, v229, s[4:7], 0 offen
    v_mul_f32 v191, v167, v175
    v_fmac_f32 v184, v161, v174
    v_fmac_f32 v185, v162, v174
    v_fmac_f32 v186, v163, v174
    v_fmac_f32 v187, v164, v174
    buffer_load_dword v230, v228, s[32:35], 0 offen
    v_fmac_f32 v188, v165, v174
    v_fmac_f32 v189, v166, v174
    v_fmac_f32 v190, v167, v174
    v_fmac_f32 v191, v168, v174
    v_fmac_f32 v184, v162, v173
    s_add_u32 s97, s98, s0
    s_lshr_b64 s[0:1], s[0:1], 4
    s_and_b32 s97, s97, 15
    s_add_u32 m0, s87, 18432
    s_lshl_b32 s97, s97, 7
    buffer_load_dwordx4 v240, s[28:31], s97 offen offset:0  lds
    v_fmac_f32 v185, v163, v173
    v_fmac_f32 v186, v164, v173
    v_fmac_f32 v187, v165, v173
    v_fmac_f32 v188, v166, v173
    v_fmac_f32 v189, v167, v173
    buffer_load_dwordx4 v241, s[28:31], s97 offen offset:1024  lds
    v_fmac_f32 v190, v168, v173
    v_fmac_f32 v191, v169, v173
    v_fmac_f32 v184, v163, v172
    v_fmac_f32 v185, v164, v172
    v_fmac_f32 v186, v165, v172
    buffer_load_dwordx4 v242, s[28:31], s97 offen offset:2048  lds
    v_fmac_f32 v187, v166, v172
    v_fmac_f32 v188, v167, v172
    v_fmac_f32 v189, v168, v172
    v_fmac_f32 v190, v169, v172
    v_fmac_f32 v191, v170, v172
    buffer_load_dwordx4 v243, s[28:31], s97 offen offset:3072  lds
    v_mul_f32 v184, v184, v176
    v_mul_f32 v185, v185, v177
    v_mul_f32 v186, v186, v178
    v_mul_f32 v187, v187, v179
    v_mul_f32 v188, v188, v180
    s_add_u32 m0, s88, 18432
    s_mov_b64 exec, 0xffffffff
    buffer_load_dwordx4 v3, s[28:31], s97 offen offset:0  lds
    s_mov_b64 exec, -1
    v_mul_f32 v189, v189, v181
    v_mul_f32 v190, v190, v182
    v_mul_f32 v191, v191, v183
    v_cvt_pk_bf16_f32 v100, v191, v190
    v_cvt_pk_bf16_f32 v101, v189, v188
    v_cvt_pk_bf16_f32 v102, v187, v186
    v_cvt_pk_bf16_f32 v103, v185, v184
    s_mov_b32 s89, 0
    buffer_store_dwordx4 v[100:103], v12, s[52:55], s89 offen sc1
    v_and_b32 v160, 0xffff0000, v40
    v_and_b32 v161, 0xffff0000, v42
    v_and_b32 v162, 0xffff0000, v44
    v_and_b32 v163, 0xffff0000, v46
    v_and_b32 v164, 0xffff0000, v48
    v_and_b32 v165, 0xffff0000, v50
    v_and_b32 v166, 0xffff0000, v52
    v_and_b32 v167, 0xffff0000, v54
    v_and_b32 v168, 0xffff0000, v56
    v_and_b32 v169, 0xffff0000, v58
    v_and_b32 v170, 0xffff0000, v60
    v_lshlrev_b32 v172, 16, v86
    v_and_b32 v173, 0xffff0000, v86
    v_lshlrev_b32 v174, 16, v87
    v_and_b32 v175, 0xffff0000, v87
    v_and_b32 v176, 0xffff0000, v68
    v_and_b32 v177, 0xffff0000, v70
    v_and_b32 v178, 0xffff0000, v72
    v_and_b32 v179, 0xffff0000, v74
    v_and_b32 v180, 0xffff0000, v76
    v_and_b32 v181, 0xffff0000, v78
    v_and_b32 v182, 0xffff0000, v80
    v_and_b32 v183, 0xffff0000, v82
    s_waitcnt vmcnt(14)
    s_barrier
    s_mul_i32 s16, s97, 3072
    s_add_u32 m0, s60, 24576
    s_add_u32 s99, s16, s62
    buffer_load_dwordx4 v244, s[32:35], s99 offen offset:0  lds
    v_mul_f32 v184, v160, v175
    v_mul_f32 v185, v161, v175
    v_mul_f32 v186, v162, v175
    v_mul_f32 v187, v163, v175
    v_mul_f32 v188, v164, v175
    buffer_load_dwordx4 v245, s[32:35], s99 offen offset:1024  lds
    v_mul_f32 v189, v165, v175
    v_mul_f32 v190, v166, v175
    v_mul_f32 v191, v167, v175
    v_fmac_f32 v184, v161, v174
    v_fmac_f32 v185, v162, v174
    buffer_load_dwordx4 v246, s[32:35], s99 offen offset:2048  lds
    v_fmac_f32 v186, v163, v174
    v_fmac_f32 v187, v164, v174
    v_fmac_f32 v188, v165, v174
    v_fmac_f32 v189, v166, v174
    v_fmac_f32 v190, v167, v174
    s_add_u32 m0, s61, 36864
    s_add_u32 s16, s16, s63
    buffer_load_dwordx4 v244, s[32:35], s16 offen offset:0  lds
    v_fmac_f32 v191, v168, v174
    v_fmac_f32 v184, v162, v173
    v_fmac_f32 v185, v163, v173
    v_fmac_f32 v186, v164, v173
    v_fmac_f32 v187, v165, v173
    buffer_load_dwordx4 v245, s[32:35], s16 offen offset:1024  lds
    v_fmac_f32 v188, v166, v173
    v_fmac_f32 v189, v167, v173
    v_fmac_f32 v190, v168, v173
    v_fmac_f32 v191, v169, v173
    v_fmac_f32 v184, v163, v172
    buffer_load_dwordx4 v246, s[32:35], s16 offen offset:2048  lds
    v_fmac_f32 v185, v164, v172
    v_fmac_f32 v186, v165, v172
    v_fmac_f32 v187, v166, v172
    v_fmac_f32 v188, v167, v172
    v_fmac_f32 v189, v168, v172
    s_add_u32 s97, s98, s0
    s_lshr_b64 s[0:1], s[0:1], 4
    s_and_b32 s97, s97, 15
    s_add_u32 m0, s87, 36864
    s_lshl_b32 s97, s97, 7
    buffer_load_dwordx4 v240, s[28:31], s97 offen offset:0  lds
    v_fmac_f32 v190, v169, v172
    v_fmac_f32 v191, v170, v172
    v_mul_f32 v184, v184, v176
    v_mul_f32 v185, v185, v177
    v_mul_f32 v186, v186, v178
    buffer_load_dwordx4 v241, s[28:31], s97 offen offset:1024  lds
    v_mul_f32 v187, v187, v179
    v_mul_f32 v188, v188, v180
    v_mul_f32 v189, v189, v181
    v_mul_f32 v190, v190, v182
    v_mul_f32 v191, v191, v183
    buffer_load_dwordx4 v242, s[28:31], s97 offen offset:2048  lds
    v_cvt_pk_bf16_f32 v104, v191, v190
    v_cvt_pk_bf16_f32 v105, v189, v188
    v_cvt_pk_bf16_f32 v106, v187, v186
    v_cvt_pk_bf16_f32 v107, v185, v184
    s_mov_b32 s89, 16384
    buffer_store_dwordx4 v[104:107], v12, s[52:55], s89 offen sc1
    buffer_load_dwordx4 v243, s[28:31], s97 offen offset:3072  lds
    v_lshlrev_b32 v160, 16, v41
    v_lshlrev_b32 v161, 16, v43
    v_lshlrev_b32 v162, 16, v45
    v_lshlrev_b32 v163, 16, v47
    v_lshlrev_b32 v164, 16, v49
    s_add_u32 m0, s88, 36864
    s_mov_b64 exec, 0xffffffff
    buffer_load_dwordx4 v3, s[28:31], s97 offen offset:0  lds
    s_mov_b64 exec, -1
    v_lshlrev_b32 v165, 16, v51
    v_lshlrev_b32 v166, 16, v53
    v_lshlrev_b32 v167, 16, v55
    v_lshlrev_b32 v168, 16, v57
    v_lshlrev_b32 v169, 16, v59
    v_lshlrev_b32 v170, 16, v61
    v_lshlrev_b32 v172, 16, v88
    v_and_b32 v173, 0xffff0000, v88
    v_lshlrev_b32 v174, 16, v89
    v_and_b32 v175, 0xffff0000, v89
    v_lshlrev_b32 v176, 16, v69
    v_lshlrev_b32 v177, 16, v71
    v_lshlrev_b32 v178, 16, v73
    v_lshlrev_b32 v179, 16, v75
    v_lshlrev_b32 v180, 16, v77
    v_lshlrev_b32 v181, 16, v79
    v_lshlrev_b32 v182, 16, v81
    v_lshlrev_b32 v183, 16, v83
    v_mul_f32 v184, v160, v175
    v_mul_f32 v185, v161, v175
    v_mul_f32 v186, v162, v175
    v_mul_f32 v187, v163, v175
    v_mul_f32 v188, v164, v175
    v_mul_f32 v189, v165, v175
    v_mul_f32 v190, v166, v175
    v_mul_f32 v191, v167, v175
    v_fmac_f32 v184, v161, v174
    v_fmac_f32 v185, v162, v174
    v_fmac_f32 v186, v163, v174
    v_fmac_f32 v187, v164, v174
    v_fmac_f32 v188, v165, v174
    v_fmac_f32 v189, v166, v174
    v_fmac_f32 v190, v167, v174
    v_fmac_f32 v191, v168, v174
    v_fmac_f32 v184, v162, v173
    v_fmac_f32 v185, v163, v173
    v_fmac_f32 v186, v164, v173
    v_fmac_f32 v187, v165, v173
    v_fmac_f32 v188, v166, v173
    v_fmac_f32 v189, v167, v173
    v_fmac_f32 v190, v168, v173
    s_waitcnt vmcnt(13)
    s_barrier
    s_mul_i32 s16, s97, 3072
    s_add_u32 m0, s60, 49152
    s_add_u32 s99, s16, s62
    buffer_load_dwordx4 v244, s[32:35], s99 offen offset:0  lds
    v_fmac_f32 v191, v169, v173
    v_fmac_f32 v184, v163, v172
    v_fmac_f32 v185, v164, v172
    v_fmac_f32 v186, v165, v172
    v_fmac_f32 v187, v166, v172
    buffer_load_dwordx4 v245, s[32:35], s99 offen offset:1024  lds
    v_fmac_f32 v188, v167, v172
    v_fmac_f32 v189, v168, v172
    v_fmac_f32 v190, v169, v172
    v_fmac_f32 v191, v170, v172
    v_mul_f32 v184, v184, v176
    buffer_load_dwordx4 v246, s[32:35], s99 offen offset:2048  lds
    v_mul_f32 v185, v185, v177
    v_mul_f32 v186, v186, v178
    v_mul_f32 v187, v187, v179
    v_mul_f32 v188, v188, v180
    v_mul_f32 v189, v189, v181
    s_add_u32 m0, s61, 61440
    s_add_u32 s16, s16, s63
    buffer_load_dwordx4 v244, s[32:35], s16 offen offset:0  lds
    v_mul_f32 v190, v190, v182
    v_mul_f32 v191, v191, v183
    v_cvt_pk_bf16_f32 v108, v191, v190
    v_cvt_pk_bf16_f32 v109, v189, v188
    v_cvt_pk_bf16_f32 v110, v187, v186
    buffer_load_dwordx4 v245, s[32:35], s16 offen offset:1024  lds
    v_cvt_pk_bf16_f32 v111, v185, v184
    s_mov_b32 s89, 32768
    buffer_store_dwordx4 v[108:111], v12, s[52:55], s89 offen sc1
    v_and_b32 v160, 0xffff0000, v41
    v_and_b32 v161, 0xffff0000, v43
    v_and_b32 v162, 0xffff0000, v45
    buffer_load_dwordx4 v246, s[32:35], s16 offen offset:2048  lds
    v_and_b32 v163, 0xffff0000, v47
    v_and_b32 v164, 0xffff0000, v49
    v_and_b32 v165, 0xffff0000, v51
    v_and_b32 v166, 0xffff0000, v53
    v_and_b32 v167, 0xffff0000, v55
    s_add_u32 s97, s98, s0
    s_lshr_b64 s[0:1], s[0:1], 4
    s_and_b32 s97, s97, 15
    s_add_u32 m0, s87, 0
    s_lshl_b32 s97, s97, 7
    buffer_load_dwordx4 v240, s[28:31], s97 offen offset:0  lds
    v_and_b32 v168, 0xffff0000, v57
    v_and_b32 v169, 0xffff0000, v59
    v_and_b32 v170, 0xffff0000, v61
    v_lshlrev_b32 v172, 16, v90
    v_and_b32 v173, 0xffff0000, v90
    buffer_load_dwordx4 v241, s[28:31], s97 offen offset:1024  lds
    v_lshlrev_b32 v174, 16, v91
    v_and_b32 v175, 0xffff0000, v91
    v_and_b32 v176, 0xffff0000, v69
    v_and_b32 v177, 0xffff0000, v71
    v_and_b32 v178, 0xffff0000, v73
    buffer_load_dwordx4 v242, s[28:31], s97 offen offset:2048  lds
    v_and_b32 v179, 0xffff0000, v75
    v_and_b32 v180, 0xffff0000, v77
    v_and_b32 v181, 0xffff0000, v79
    v_and_b32 v182, 0xffff0000, v81
    v_and_b32 v183, 0xffff0000, v83
    buffer_load_dwordx4 v243, s[28:31], s97 offen offset:3072  lds
    v_mul_f32 v184, v160, v175
    v_mul_f32 v185, v161, v175
    v_mul_f32 v186, v162, v175
    v_mul_f32 v187, v163, v175
    v_mul_f32 v188, v164, v175
    s_add_u32 m0, s88, 0
    s_mov_b64 exec, 0xffffffff
    buffer_load_dwordx4 v3, s[28:31], s97 offen offset:0  lds
    s_mov_b64 exec, -1
    v_mul_f32 v189, v165, v175
    v_mul_f32 v190, v166, v175
    v_mul_f32 v191, v167, v175
    v_fmac_f32 v184, v161, v174
    v_fmac_f32 v185, v162, v174
    v_fmac_f32 v186, v163, v174
    v_fmac_f32 v187, v164, v174
    v_fmac_f32 v188, v165, v174
    v_fmac_f32 v189, v166, v174
    v_fmac_f32 v190, v167, v174
    v_fmac_f32 v191, v168, v174
    v_fmac_f32 v184, v162, v173
    v_fmac_f32 v185, v163, v173
    v_fmac_f32 v186, v164, v173
    v_fmac_f32 v187, v165, v173
    v_fmac_f32 v188, v166, v173
    v_fmac_f32 v189, v167, v173
    v_fmac_f32 v190, v168, v173
    v_fmac_f32 v191, v169, v173
    v_fmac_f32 v184, v163, v172
    v_fmac_f32 v185, v164, v172
    v_fmac_f32 v186, v165, v172
    v_fmac_f32 v187, v166, v172
    v_fmac_f32 v188, v167, v172
    v_fmac_f32 v189, v168, v172
    v_fmac_f32 v190, v169, v172
    v_fmac_f32 v191, v170, v172
    v_mul_f32 v184, v184, v176
    v_mul_f32 v185, v185, v177
    v_mul_f32 v186, v186, v178
    v_mul_f32 v187, v187, v179
    v_mul_f32 v188, v188, v180
    v_mul_f32 v189, v189, v181
    v_mul_f32 v190, v190, v182
    v_mul_f32 v191, v191, v183
    v_cvt_pk_bf16_f32 v112, v191, v190
    v_cvt_pk_bf16_f32 v113, v189, v188
    v_cvt_pk_bf16_f32 v114, v187, v186
    v_cvt_pk_bf16_f32 v115, v185, v184
    s_mov_b32 s89, 49152
    buffer_store_dwordx4 v[112:115], v12, s[52:55], s89 offen sc1
    s_waitcnt vmcnt(13)
    s_barrier
    s_mul_i32 s16, s97, 3072
    s_add_u32 m0, s60, 0
    s_add_u32 s99, s16, s62
    buffer_load_dwordx4 v244, s[32:35], s99 offen offset:0  lds
    buffer_load_dwordx4 v245, s[32:35], s99 offen offset:1024  lds
    buffer_load_dwordx4 v246, s[32:35], s99 offen offset:2048  lds
    s_add_u32 m0, s61, 12288
    s_add_u32 s16, s16, s63
    buffer_load_dwordx4 v244, s[32:35], s16 offen offset:0  lds
    buffer_load_dwordx4 v245, s[32:35], s16 offen offset:1024  lds
    buffer_load_dwordx4 v246, s[32:35], s16 offen offset:2048  lds
    s_add_u32 s97, s98, s0
    s_lshr_b64 s[0:1], s[0:1], 4
    s_and_b32 s97, s97, 15
    s_add_u32 m0, s87, 18432
    s_lshl_b32 s97, s97, 7
    buffer_load_dwordx4 v240, s[28:31], s97 offen offset:0  lds
    buffer_load_dwordx4 v241, s[28:31], s97 offen offset:1024  lds
    buffer_load_dwordx4 v242, s[28:31], s97 offen offset:2048  lds
    buffer_load_dwordx4 v243, s[28:31], s97 offen offset:3072  lds
    s_add_u32 m0, s88, 18432
    s_mov_b64 exec, 0xffffffff
    buffer_load_dwordx4 v3, s[28:31], s97 offen offset:0  lds
    s_mov_b64 exec, -1
    s_waitcnt vmcnt(12)
    s_barrier
    s_mul_i32 s16, s97, 3072
    s_add_u32 m0, s60, 24576
    s_add_u32 s99, s16, s62
    buffer_load_dwordx4 v244, s[32:35], s99 offen offset:0  lds
    buffer_load_dwordx4 v245, s[32:35], s99 offen offset:1024  lds
    buffer_load_dwordx4 v246, s[32:35], s99 offen offset:2048  lds
    s_add_u32 m0, s61, 36864
    s_add_u32 s16, s16, s63
    buffer_load_dwordx4 v244, s[32:35], s16 offen offset:0  lds
    buffer_load_dwordx4 v245, s[32:35], s16 offen offset:1024  lds
    buffer_load_dwordx4 v246, s[32:35], s16 offen offset:2048  lds
    s_add_u32 m0, s94, 32
    s_lshl_b32 s89, s90, 12
    buffer_load_dwordx4 v15, s[48:51], s89 offen offset:0 nt lds
    s_add_u32 m0, s94, 32
    s_lshl_b32 s89, s90, 12
    buffer_load_dwordx4 v15, s[48:51], s89 offen offset:1024 nt lds
    s_add_u32 m0, s94, 32
    s_lshl_b32 s89, s90, 12
    buffer_load_dwordx4 v15, s[48:51], s89 offen offset:2048 nt lds
    s_add_u32 m0, s94, 32
    s_lshl_b32 s89, s90, 12
    buffer_load_dwordx4 v15, s[48:51], s89 offen offset:3072 nt lds
    s_add_u32 s97, s98, s0
    s_lshr_b64 s[0:1], s[0:1], 4
    s_and_b32 s97, s97, 15
    s_add_u32 m0, s87, 36864
    s_lshl_b32 s97, s97, 7
    buffer_load_dwordx4 v240, s[28:31], s97 offen offset:0  lds
    buffer_load_dwordx4 v241, s[28:31], s97 offen offset:1024  lds
    buffer_load_dwordx4 v242, s[28:31], s97 offen offset:2048  lds
    buffer_load_dwordx4 v243, s[28:31], s97 offen offset:3072  lds
    s_add_u32 m0, s88, 36864
    s_mov_b64 exec, 0xffffffff
    buffer_load_dwordx4 v3, s[28:31], s97 offen offset:0  lds
    s_mov_b64 exec, -1
    s_waitcnt vmcnt(15)
    s_barrier
    s_mul_i32 s16, s97, 3072
    s_add_u32 m0, s60, 49152
    s_add_u32 s99, s16, s62
    buffer_load_dwordx4 v244, s[32:35], s99 offen offset:0  lds
    s_mov_b32 s68, s24
    s_mov_b32 s69, s25
    s_mov_b32 s70, 0x100
    s_mov_b32 s71, 0x20000
    v_lshrrev_b32 v6, 5, v0
    buffer_load_dwordx4 v245, s[32:35], s99 offen offset:1024  lds
    v_and_b32 v7, 3, v0
    s_lshr_b32 s78, s90, 1
    s_lshl_b32 s78, s78, 2
    s_load_dword s92, s[14:15], s78
    v_bfe_u32 v5, v0, 2, 2
    buffer_load_dwordx4 v246, s[32:35], s99 offen offset:2048  lds
    v_lshlrev_b32 v5, 1, v5
    v_lshl_add_u32 v5, v6, 3, v5
    v_bfe_u32 v8, v0, 4, 1
    v_add_u32 v5, v5, v8
    s_and_b32 s78, s3, 1
    s_add_u32 m0, s61, 61440
    s_add_u32 s16, s16, s63
    buffer_load_dwordx4 v244, s[32:35], s16 offen offset:0  lds
    s_lshl_b32 s78, s78, 1
    v_add_u32 v8, s78, v6
    v_xor_b32 v8, v8, v7
    v_lshlrev_b32 v8, 4, v8
    buffer_load_dwordx4 v245, s[32:35], s16 offen offset:1024  lds
    v_lshl_add_u32 v5, v5, 6, v8
    v_add_u32 v14, s86, v5
    v_mov_b32 v18, 162304
    v_mov_b32 v19, 1
    v_and_b32 v5, 3, v0
    buffer_load_dwordx4 v246, s[32:35], s16 offen offset:2048  lds
    s_lshl_b32 s78, s74, 4
    s_add_u32 s78, s78, s3
    v_lshl_add_u32 v6, v5, 2, s78
    s_lshr_b32 s78, s76, 3
    s_lshl_b32 s79, s3, 1
    s_add_u32 s97, s98, s0
    s_lshr_b64 s[0:1], s[0:1], 4
    s_and_b32 s97, s97, 15
    s_add_u32 m0, s87, 0
    s_lshl_b32 s97, s97, 7
    buffer_load_dwordx4 v240, s[28:31], s97 offen offset:0  lds
    s_add_u32 s78, s78, s79
    s_xor_b32 s78, s78, 2
    s_lshl_b32 s78, s78, 5
    s_add_u32 s79, s76, 5
    s_and_b32 s79, s79, 7
    buffer_load_dwordx4 v241, s[28:31], s97 offen offset:1024  lds
    s_lshl_b32 s79, s79, 1
    s_add_u32 s78, s78, s79
    v_mul_u32_u24 v7, 9, v5
    v_and_b32 v7, 17, v7
    buffer_load_dwordx4 v242, s[28:31], s97 offen offset:2048  lds
    v_add_u32 v7, s78, v7
    v_and_b32 v8, 4, v0
    v_cmp_eq_u32 vcc, 0, v8
    s_nop 1
    v_cndmask_b32 v6, v7, v6, vcc
    v_and_b32 v33, 0xf0, v6
    buffer_load_dwordx4 v243, s[28:31], s97 offen offset:3072  lds
    v_lshlrev_b32 v34, 8, v6
    v_add_u32 v34, 12582912, v34
    v_and_b32 v5, 15, v0
    v_lshrrev_b32 v6, 4, v0
    v_add_u32 v7, 9, v5
    s_add_u32 m0, s88, 0
    s_mov_b64 exec, 0xffffffff
    buffer_load_dwordx4 v3, s[28:31], s97 offen offset:0  lds
    s_mov_b64 exec, -1
    v_and_b32 v8, 1, v7
    v_mul_u32_u24 v8, 4160, v8
    v_lshrrev_b32 v7, 1, v7
    v_lshl_add_u32 v8, v7, 2, v8
    s_waitcnt vmcnt(11)
    s_barrier
    s_mul_i32 s16, s97, 3072
    s_add_u32 m0, s60, 0
    s_add_u32 s99, s16, s62
    buffer_load_dwordx4 v244, s[32:35], s99 offen offset:0  lds
    v_lshlrev_b32 v7, 4, v6
    v_sub_u32 v8, v8, v7
    s_add_u32 s78, s94, 32
    v_add_u32 v21, s78, v8
    v_add_u32 v22, 1024, v21
    buffer_load_dwordx4 v245, s[32:35], s99 offen offset:1024  lds
    v_add_u32 v23, 2048, v21
    v_add_u32 v24, 3072, v21
    v_lshl_add_u32 v7, v5, 1, v6
    v_add_u32 v7, 30, v7
    v_and_b32 v8, 1, v7
    buffer_load_dwordx4 v246, s[32:35], s99 offen offset:2048  lds
    v_bfe_u32 v136, v7, 1, 2
    v_lshl_add_u32 v136, v8, 2, v136
    v_lshlrev_b32 v136, 6, v136
    v_lshrrev_b32 v7, 3, v7
    v_lshl_add_u32 v136, v7, 9, v136
    s_add_u32 m0, s61, 12288
    s_add_u32 s16, s16, s63
    buffer_load_dwordx4 v244, s[32:35], s16 offen offset:0  lds
    v_bitop3_b32 v8, v7, 3, s3 bitop3:0x6a
    v_lshl_add_u32 v25, v8, 4, v136
    v_add_u32 v25, 92160, v25
    v_subrev_u32 v7, 1, v7
    buffer_load_dwordx4 v245, s[32:35], s16 offen offset:1024  lds
    v_bitop3_b32 v8, v7, 3, s3 bitop3:0x6a
    v_lshl_add_u32 v27, v8, 4, v136
    v_add_u32 v27, 91648, v27
    v_subrev_u32 v7, 1, v7
    v_bitop3_b32 v8, v7, 3, s3 bitop3:0x6a
    buffer_load_dwordx4 v246, s[32:35], s16 offen offset:2048  lds
    v_lshl_add_u32 v29, v8, 4, v136
    v_add_u32 v29, 91136, v29
    v_subrev_u32 v7, 1, v7
    v_bitop3_b32 v8, v7, 3, s3 bitop3:0x6a
    v_lshl_add_u32 v31, v8, 4, v136
    s_add_u32 s97, s98, s0
    s_lshr_b64 s[0:1], s[0:1], 4
    s_and_b32 s97, s97, 15
    s_add_u32 m0, s87, 18432
    s_lshl_b32 s97, s97, 7
    buffer_load_dwordx4 v240, s[28:31], s97 offen offset:0  lds
    v_add_u32 v31, 90624, v31
    v_lshl_add_u32 v7, v5, 1, v6
    v_add_u32 v7, 26, v7
    v_and_b32 v8, 1, v7
    v_bfe_u32 v136, v7, 1, 2
    buffer_load_dwordx4 v241, s[28:31], s97 offen offset:1024  lds
    v_lshl_add_u32 v136, v8, 2, v136
    v_lshlrev_b32 v136, 6, v136
    v_lshrrev_b32 v7, 3, v7
    v_lshl_add_u32 v136, v7, 9, v136
    buffer_load_dwordx4 v242, s[28:31], s97 offen offset:2048  lds
    v_bitop3_b32 v8, v7, 3, s3 bitop3:0x6a
    v_lshl_add_u32 v26, v8, 4, v136
    v_add_u32 v26, 92160, v26
    v_subrev_u32 v7, 1, v7
    v_bitop3_b32 v8, v7, 3, s3 bitop3:0x6a
    buffer_load_dwordx4 v243, s[28:31], s97 offen offset:3072  lds
    v_lshl_add_u32 v28, v8, 4, v136
    v_add_u32 v28, 91648, v28
    v_subrev_u32 v7, 1, v7
    v_bitop3_b32 v8, v7, 3, s3 bitop3:0x6a
    v_lshl_add_u32 v30, v8, 4, v136
    s_add_u32 m0, s88, 18432
    s_mov_b64 exec, 0xffffffff
    buffer_load_dwordx4 v3, s[28:31], s97 offen offset:0  lds
    s_mov_b64 exec, -1
    v_add_u32 v30, 91136, v30
    v_subrev_u32 v7, 1, v7
    v_bitop3_b32 v8, v7, 3, s3 bitop3:0x6a
    v_lshl_add_u32 v32, v8, 4, v136
    s_waitcnt vmcnt(11)
    s_barrier
    s_mul_i32 s16, s97, 3072
    s_add_u32 m0, s60, 24576
    s_add_u32 s99, s16, s62
    buffer_load_dwordx4 v244, s[32:35], s99 offen offset:0  lds
    v_add_u32 v32, 90624, v32
    v_lshrrev_b32 v7, 1, v6
    v_lshl_add_u32 v7, v5, 1, v7
    v_add_u32 v7, 32, v7
    v_and_b32 v8, 1, v7
    buffer_load_dwordx4 v245, s[32:35], s99 offen offset:1024  lds
    v_bfe_u32 v136, v7, 1, 2
    v_lshl_add_u32 v136, v8, 2, v136
    v_lshlrev_b32 v136, 6, v136
    v_lshrrev_b32 v7, 3, v7
    buffer_load_dwordx4 v246, s[32:35], s99 offen offset:2048  lds
    v_lshl_add_u32 v136, v7, 9, v136
    v_bitop3_b32 v8, v7, 3, s3 bitop3:0x6a
    v_lshl_add_u32 v20, v8, 4, v136
    v_add_u32 v20, 92160, v20
    v_and_b32 v8, 1, v6
    s_add_u32 m0, s61, 36864
    s_add_u32 s16, s16, s63
    buffer_load_dwordx4 v244, s[32:35], s16 offen offset:0  lds
    v_xor_b32 v8, 1, v8
    v_lshl_add_u32 v20, v8, 3, v20
    s_waitcnt lgkmcnt(0)
    s_and_b32 s78, s92, 0xffff0000
    buffer_load_dwordx4 v245, s[32:35], s16 offen offset:1024  lds
    s_lshl_b32 s92, s92, 16
    s_bitcmp1_b32 s90, 0
    s_cselect_b32 s92, s78, s92
    v_lshlrev_b32 v7, 3, v6
    v_sub_u32 v7, v7, v5
    buffer_load_dwordx4 v246, s[32:35], s16 offen offset:2048  lds
    v_subrev_u32 v7, 9, v7
    v_and_b32 v8, 1, v7
    v_xor_b32 v8, 1, v8
    v_lshlrev_b32 v8, 4, v8
    v_lshrrev_b32 v8, v8, s92
    s_add_u32 s97, s98, s0
    s_lshr_b64 s[0:1], s[0:1], 4
    s_and_b32 s97, s97, 15
    s_add_u32 m0, s87, 36864
    s_lshl_b32 s97, s97, 7
    buffer_load_dwordx4 v240, s[28:31], s97 offen offset:0  lds
    v_ashrrev_i32 v7, 1, v7
    v_cmp_eq_u32 vcc, 0, v7
    s_nop 1
    v_cndmask_b32 v236, 0, v8, vcc
    v_cmp_eq_u32 vcc, 1, v7
    buffer_load_dwordx4 v241, s[28:31], s97 offen offset:1024  lds
    s_nop 0
    v_cndmask_b32 v237, 0, v8, vcc
    v_cmp_eq_u32 vcc, 2, v7
    s_nop 1
    v_cndmask_b32 v238, 0, v8, vcc
    v_cmp_eq_u32 vcc, 3, v7
    buffer_load_dwordx4 v242, s[28:31], s97 offen offset:2048  lds
    s_nop 0
    v_cndmask_b32 v239, 0, v8, vcc
    s_and_b32 s78, s77, 7
    s_mov_b32 s95, 0x76543210
    s_cmp_eq_u32 s78, 1
    s_cselect_b32 s95, 0x76543201, s95
    s_cmp_eq_u32 s78, 2
    s_cselect_b32 s95, 0x76543120, s95
    s_cmp_eq_u32 s78, 3
    s_cselect_b32 s95, 0x76542310, s95
    s_cmp_eq_u32 s78, 4
    s_cselect_b32 s95, 0x76534210, s95
    s_cmp_eq_u32 s78, 5
    s_cselect_b32 s95, 0x76453210, s95
    s_cmp_eq_u32 s78, 6
    s_cselect_b32 s95, 0x75643210, s95
    s_cmp_eq_u32 s78, 7
    s_cselect_b32 s95, 0x67543210, s95
    s_and_b32 s78, s76, 3
    s_mul_i32 s78, s78, 0x22222222
    s_add_u32 s95, s95, s78
    s_bfe_u32 s100, s95, 0x3001c
    s_lshl_b32 s100, s100, 18
    s_bfe_u32 s95, s95, 0x30018
    s_lshl_b32 s95, s95, 18
    v_lshrrev_b32 v136, 4, v0
    v_lshlrev_b32 v136, 1, v136
    v_and_b32 v137, 7, v0
    buffer_load_dwordx4 v243, s[28:31], s97 offen offset:3072  lds
    v_xor_b32 v136, v136, v137
    v_lshlrev_b32 v136, 4, v136
    v_lshrrev_b32 v137, 3, v0
    v_lshl_add_u32 v136, v137, 11, v136
    s_add_u32 m0, s88, 36864
    s_mov_b64 exec, 0xffffffff
    buffer_load_dwordx4 v3, s[28:31], s97 offen offset:0  lds
    s_mov_b64 exec, -1
    s_lshl_b32 s78, s77, 7
    s_lshl_b32 s79, s3, 14
    s_add_u32 s78, s78, s79
    v_add_u32 v17, s78, v136
    s_waitcnt vmcnt(11)
    s_barrier
    s_mul_i32 s16, s97, 3072
    s_add_u32 m0, s60, 49152
    s_add_u32 s99, s16, s62
    buffer_load_dwordx4 v244, s[32:35], s99 offen offset:0  lds
    v_add_u32 v5, s94, v15
    ds_read_b128 v[140:143], v5 offset:32
    ds_read_b32 v156, v5 offset:48
    ds_read_b128 v[144:147], v5 offset:1056
    buffer_load_dwordx4 v245, s[32:35], s99 offen offset:1024  lds
    ds_read_b32 v157, v5 offset:1072
    ds_read_b128 v[148:151], v5 offset:2080
    ds_read_b32 v158, v5 offset:2096
    ds_read_b128 v[152:155], v5 offset:3104
    buffer_load_dwordx4 v246, s[32:35], s99 offen offset:2048  lds
    ds_read_b32 v159, v5 offset:3120
    v_lshrrev_b32 v6, 3, v0
    v_mul_u32_u24 v6, 4160, v6
    s_add_u32 m0, s61, 61440
    s_add_u32 s16, s16, s63
    buffer_load_dwordx4 v244, s[32:35], s16 offen offset:0  lds
    v_and_b32 v7, 7, v0
    v_lshl_add_u32 v6, v7, 2, v6
    v_add_u32 v6, s94, v6
    v_mov_b32 v7, 0
    buffer_load_dwordx4 v245, s[32:35], s16 offen offset:1024  lds
    s_waitcnt lgkmcnt(0)
    v_readfirstlane_b32 s93, v140
    s_nop 0
    s_lshl_b32 s93, s93, 16
    s_nop 1
    v_writelane_b32 v7, s93, 15
    buffer_load_dwordx4 v246, s[32:35], s16 offen offset:2048  lds
    v_alignbit_b32 v140, v141, v140, 16
    v_alignbit_b32 v141, v142, v141, 16
    v_alignbit_b32 v142, v143, v142, 16
    s_add_u32 s97, s98, s0
    s_lshr_b64 s[0:1], s[0:1], 4
    s_and_b32 s97, s97, 15
    s_add_u32 m0, s87, 0
    s_lshl_b32 s97, s97, 7
    buffer_load_dwordx4 v240, s[28:31], s97 offen offset:0  lds
    v_alignbit_b32 v143, v156, v143, 16
    v_alignbit_b32 v144, v145, v144, 16
    v_alignbit_b32 v145, v146, v145, 16
    v_alignbit_b32 v146, v147, v146, 16
    buffer_load_dwordx4 v241, s[28:31], s97 offen offset:1024  lds
    v_alignbit_b32 v147, v157, v147, 16
    v_alignbit_b32 v148, v149, v148, 16
    v_alignbit_b32 v149, v150, v149, 16
    v_alignbit_b32 v150, v151, v150, 16
    buffer_load_dwordx4 v242, s[28:31], s97 offen offset:2048  lds
    v_alignbit_b32 v151, v158, v151, 16
    v_alignbit_b32 v152, v153, v152, 16
    v_alignbit_b32 v153, v154, v153, 16
    buffer_load_dwordx4 v243, s[28:31], s97 offen offset:3072  lds
    v_alignbit_b32 v154, v155, v154, 16
    v_alignbit_b32 v155, v159, v155, 16
    v_lshlrev_b32 v8, 3, v0
    s_add_u32 s78, s88, 18432
    s_add_u32 m0, s88, 0
    s_mov_b64 exec, 0xffffffff
    buffer_load_dwordx4 v3, s[28:31], s97 offen offset:0  lds
    s_mov_b64 exec, -1
    v_add_u32 v8, s78, v8
    v_mov_b32 v156, 0
    v_mov_b32 v157, 0
    s_waitcnt vmcnt(11)
    s_barrier
    s_mul_i32 s16, s97, 3072
    s_add_u32 m0, s60, 0
    s_add_u32 s99, s16, s62
    buffer_load_dwordx4 v244, s[32:35], s99 offen offset:0  lds
    buffer_load_dwordx4 v245, s[32:35], s99 offen offset:1024  lds
    buffer_load_dwordx4 v246, s[32:35], s99 offen offset:2048  lds
    s_add_u32 m0, s61, 12288
    s_add_u32 s16, s16, s63
    buffer_load_dwordx4 v244, s[32:35], s16 offen offset:0  lds
    buffer_load_dwordx4 v245, s[32:35], s16 offen offset:1024  lds
    buffer_load_dwordx4 v246, s[32:35], s16 offen offset:2048  lds
    s_mov_b64 exec, 0xff
    buffer_load_dword v136, v33, s[68:71], 0 offen sc1
    buffer_load_dword v137, v34, s[52:55], 0 offen sc1
    s_mov_b64 exec, -1
    buffer_load_dwordx4 v[212:215], v9, s[56:59], 0 offen offset:0 nt
    buffer_load_dwordx4 v[216:219], v9, s[56:59], 0 offen offset:2048 nt
    buffer_load_dwordx4 v[220:223], v9, s[56:59], s96 offen offset:0 nt
    buffer_load_dwordx4 v[224:227], v9, s[56:59], s96 offen offset:2048 nt
    s_waitcnt vmcnt(12)
    s_waitcnt vmcnt(6)
    s_barrier
    s_waitcnt vmcnt(4)
    s_branch LA_j
LA_c2:
    s_waitcnt vmcnt(8)
    s_barrier
    buffer_load_dwordx4 v242, s[28:31], s97 offen offset:2048  lds
    buffer_load_dwordx4 v243, s[28:31], s97 offen offset:3072  lds
    s_add_u32 m0, s88, 36864
    s_mov_b64 exec, 0xffffffff
    buffer_load_dwordx4 v3, s[28:31], s97 offen offset:0  lds
    s_mov_b64 exec, -1
    s_mul_i32 s16, s97, 3072
    s_add_u32 m0, s60, 49152
    s_add_u32 s99, s16, s62
    buffer_load_dwordx4 v244, s[32:35], s99 offen offset:0  lds
    buffer_load_dwordx4 v245, s[32:35], s99 offen offset:1024  lds
    buffer_load_dwordx4 v246, s[32:35], s99 offen offset:2048  lds
    s_add_u32 m0, s61, 61440
    s_add_u32 s16, s16, s63
    buffer_load_dwordx4 v244, s[32:35], s16 offen offset:0  lds
    buffer_load_dwordx4 v245, s[32:35], s16 offen offset:1024  lds
    buffer_load_dwordx4 v246, s[32:35], s16 offen offset:2048  lds
    s_add_u32 s97, s98, s0
    s_lshr_b64 s[0:1], s[0:1], 4
    s_and_b32 s97, s97, 15
    s_add_u32 m0, s87, 0
    s_lshl_b32 s97, s97, 7
    buffer_load_dwordx4 v240, s[28:31], s97 offen offset:0  lds
    buffer_load_dwordx4 v241, s[28:31], s97 offen offset:1024  lds
    buffer_load_dwordx4 v242, s[28:31], s97 offen offset:2048  lds
    buffer_load_dwordx4 v243, s[28:31], s97 offen offset:3072  lds
    s_add_u32 m0, s88, 0
    s_mov_b64 exec, 0xffffffff
    buffer_load_dwordx4 v3, s[28:31], s97 offen offset:0  lds
    s_mov_b64 exec, -1
    s_waitcnt vmcnt(11)
    s_barrier
    s_mul_i32 s16, s97, 3072
    s_add_u32 m0, s60, 0
    s_add_u32 s99, s16, s62
    buffer_load_dwordx4 v244, s[32:35], s99 offen offset:0  lds
    buffer_load_dwordx4 v245, s[32:35], s99 offen offset:1024  lds
    buffer_load_dwordx4 v246, s[32:35], s99 offen offset:2048  lds
    s_add_u32 m0, s61, 12288
    s_add_u32 s16, s16, s63
    buffer_load_dwordx4 v244, s[32:35], s16 offen offset:0  lds
    buffer_load_dwordx4 v245, s[32:35], s16 offen offset:1024  lds
    buffer_load_dwordx4 v246, s[32:35], s16 offen offset:2048  lds
    s_add_u32 s97, s98, s0
    s_lshr_b64 s[0:1], s[0:1], 4
    s_and_b32 s97, s97, 15
    s_add_u32 m0, s87, 18432
    s_lshl_b32 s97, s97, 7
    buffer_load_dwordx4 v240, s[28:31], s97 offen offset:0  lds
    buffer_load_dwordx4 v241, s[28:31], s97 offen offset:1024  lds
    buffer_load_dwordx4 v242, s[28:31], s97 offen offset:2048  lds
    buffer_load_dwordx4 v243, s[28:31], s97 offen offset:3072  lds
    s_add_u32 m0, s88, 18432
    s_mov_b64 exec, 0xffffffff
    buffer_load_dwordx4 v3, s[28:31], s97 offen offset:0  lds
    s_mov_b64 exec, -1
    s_waitcnt vmcnt(11)
    s_barrier
    s_mul_i32 s16, s97, 3072
    s_add_u32 m0, s60, 24576
    s_add_u32 s99, s16, s62
    buffer_load_dwordx4 v244, s[32:35], s99 offen offset:0  lds
    buffer_load_dwordx4 v245, s[32:35], s99 offen offset:1024  lds
    buffer_load_dwordx4 v246, s[32:35], s99 offen offset:2048  lds
    s_add_u32 m0, s61, 36864
    s_add_u32 s16, s16, s63
    buffer_load_dwordx4 v244, s[32:35], s16 offen offset:0  lds
    buffer_load_dwordx4 v245, s[32:35], s16 offen offset:1024  lds
    buffer_load_dwordx4 v246, s[32:35], s16 offen offset:2048  lds
    s_add_u32 m0, s86, 129536
    s_mov_b32 s89, 0
    buffer_load_dwordx4 v10, s[36:39], s89 offen nt lds
    s_add_u32 m0, s86, 145920
    s_mov_b32 s89, 0
    buffer_load_dwordx4 v10, s[40:43], s89 offen nt lds
    s_add_u32 m0, s86, 133632
    s_mov_b32 s89, 65536
    buffer_load_dwordx4 v10, s[36:39], s89 offen nt lds
    s_add_u32 m0, s86, 150016
    s_mov_b32 s89, 65536
    buffer_load_dwordx4 v10, s[40:43], s89 offen nt lds
    s_add_u32 m0, s86, 137728
    s_mov_b32 s89, 131072
    buffer_load_dwordx4 v10, s[36:39], s89 offen nt lds
    s_add_u32 m0, s86, 154112
    s_mov_b32 s89, 131072
    buffer_load_dwordx4 v10, s[40:43], s89 offen nt lds
    s_add_u32 m0, s86, 141824
    s_mov_b32 s89, 196608
    buffer_load_dwordx4 v10, s[36:39], s89 offen nt lds
    s_add_u32 m0, s86, 158208
    s_mov_b32 s89, 196608
    buffer_load_dwordx4 v10, s[40:43], s89 offen nt lds
    s_mov_b64 exec, 0xff
    s_lshl_b32 s82, s3, 7
    s_add_u32 m0, s82, 129024
    s_mov_b32 s89, 0
    buffer_load_dwordx4 v11, s[36:39], s89 offen nt lds
    s_lshl_b32 s83, s74, 9
    s_add_u32 s83, s83, s82
    s_and_b32 s89, s3, 2
    s_lshl_b32 s89, s89, 3
    s_add_u32 s82, s82, s89
    s_add_u32 m0, s82, 162816
    s_add_u32 s89, s83, 0
    buffer_load_dwordx4 v15, s[44:47], s89 offen  lds
    s_mov_b64 exec, -1
    s_add_u32 s97, s98, s0
    s_lshr_b64 s[0:1], s[0:1], 4
    s_and_b32 s97, s97, 15
    s_add_u32 m0, s87, 36864
    s_lshl_b32 s97, s97, 7
    buffer_load_dwordx4 v240, s[28:31], s97 offen offset:0  lds
    s_waitcnt vmcnt(17)
    s_barrier
    buffer_load_dwordx4 v241, s[28:31], s97 offen offset:1024  lds
    buffer_load_dwordx4 v242, s[28:31], s97 offen offset:2048  lds
    buffer_load_dwordx4 v243, s[28:31], s97 offen offset:3072  lds
    s_add_u32 m0, s88, 36864
    s_mov_b64 exec, 0xffffffff
    buffer_load_dwordx4 v3, s[28:31], s97 offen offset:0  lds
    s_mov_b64 exec, -1
    s_mul_i32 s16, s97, 3072
    s_add_u32 m0, s60, 49152
    s_add_u32 s99, s16, s62
    buffer_load_dwordx4 v244, s[32:35], s99 offen offset:0  lds
    buffer_load_dwordx4 v245, s[32:35], s99 offen offset:1024  lds
    buffer_load_dwordx4 v246, s[32:35], s99 offen offset:2048  lds
    s_add_u32 m0, s61, 61440
    s_add_u32 s16, s16, s63
    buffer_load_dwordx4 v244, s[32:35], s16 offen offset:0  lds
    buffer_load_dwordx4 v245, s[32:35], s16 offen offset:1024  lds
    buffer_load_dwordx4 v246, s[32:35], s16 offen offset:2048  lds
    s_add_u32 s97, s98, s0
    s_lshr_b64 s[0:1], s[0:1], 4
    s_and_b32 s97, s97, 15
    s_add_u32 m0, s87, 0
    s_lshl_b32 s97, s97, 7
    buffer_load_dwordx4 v240, s[28:31], s97 offen offset:0  lds
    buffer_load_dwordx4 v241, s[28:31], s97 offen offset:1024  lds
    buffer_load_dwordx4 v242, s[28:31], s97 offen offset:2048  lds
    buffer_load_dwordx4 v243, s[28:31], s97 offen offset:3072  lds
    s_add_u32 m0, s88, 0
    s_mov_b64 exec, 0xffffffff
    buffer_load_dwordx4 v3, s[28:31], s97 offen offset:0  lds
    s_mov_b64 exec, -1
    s_waitcnt vmcnt(11)
    s_barrier
    s_mul_i32 s16, s97, 3072
    s_add_u32 m0, s60, 0
    s_add_u32 s99, s16, s62
    buffer_load_dwordx4 v244, s[32:35], s99 offen offset:0  lds
    ds_read_b128 v[84:87], v35 offset:0
    ds_read_b128 v[88:91], v35 offset:16
    buffer_load_dwordx4 v245, s[32:35], s99 offen offset:1024  lds
    ds_read_b64 v[40:41], v16 offset:0
    ds_read_b64 v[42:43], v231 offset:256
    buffer_load_dwordx4 v246, s[32:35], s99 offen offset:2048  lds
    ds_read_b64 v[44:45], v16 offset:256
    ds_read_b64 v[46:47], v16 offset:512
    s_add_u32 m0, s61, 12288
    s_add_u32 s16, s16, s63
    buffer_load_dwordx4 v244, s[32:35], s16 offen offset:0  lds
    ds_read_b64 v[48:49], v231 offset:512
    ds_read_b64 v[50:51], v16 offset:768
    buffer_load_dwordx4 v245, s[32:35], s16 offen offset:1024  lds
    ds_read_b64 v[52:53], v231 offset:768
    ds_read_b64 v[54:55], v16 offset:1024
    buffer_load_dwordx4 v246, s[32:35], s16 offen offset:2048  lds
    ds_read_b64 v[56:57], v231 offset:1024
    ds_read_b64 v[58:59], v16 offset:1280
    s_add_u32 s97, s98, s0
    s_lshr_b64 s[0:1], s[0:1], 4
    s_and_b32 s97, s97, 15
    s_add_u32 m0, s87, 18432
    s_lshl_b32 s97, s97, 7
    buffer_load_dwordx4 v240, s[28:31], s97 offen offset:0  lds
    ds_read_b64 v[60:61], v231 offset:1280
    ds_read_b64 v[68:69], v16 offset:16896
    buffer_load_dwordx4 v241, s[28:31], s97 offen offset:1024  lds
    ds_read_b64 v[70:71], v231 offset:16896
    ds_read_b64 v[72:73], v16 offset:17152
    buffer_load_dwordx4 v242, s[28:31], s97 offen offset:2048  lds
    ds_read_b64 v[74:75], v231 offset:17152
    ds_read_b64 v[76:77], v16 offset:17408
    buffer_load_dwordx4 v243, s[28:31], s97 offen offset:3072  lds
    ds_read_b64 v[78:79], v231 offset:17408
    ds_read_b64 v[80:81], v16 offset:17664
    s_add_u32 m0, s88, 18432
    s_mov_b64 exec, 0xffffffff
    buffer_load_dwordx4 v3, s[28:31], s97 offen offset:0  lds
    s_mov_b64 exec, -1
    ds_read_b64 v[82:83], v231 offset:17664
    s_waitcnt vmcnt(11)
    s_waitcnt lgkmcnt(0)
    s_barrier
    s_mul_i32 s16, s97, 3072
    s_add_u32 m0, s60, 24576
    s_add_u32 s99, s16, s62
    buffer_load_dwordx4 v244, s[32:35], s99 offen offset:0  lds
    v_lshlrev_b32 v160, 16, v40
    v_lshlrev_b32 v161, 16, v42
    v_lshlrev_b32 v162, 16, v44
    v_lshlrev_b32 v163, 16, v46
    v_lshlrev_b32 v164, 16, v48
    buffer_load_dwordx4 v245, s[32:35], s99 offen offset:1024  lds
    v_lshlrev_b32 v165, 16, v50
    v_lshlrev_b32 v166, 16, v52
    v_lshlrev_b32 v167, 16, v54
    v_lshlrev_b32 v168, 16, v56
    v_lshlrev_b32 v169, 16, v58
    buffer_load_dwordx4 v246, s[32:35], s99 offen offset:2048  lds
    v_lshlrev_b32 v170, 16, v60
    v_lshlrev_b32 v172, 16, v84
    v_and_b32 v173, 0xffff0000, v84
    v_lshlrev_b32 v174, 16, v85
    v_and_b32 v175, 0xffff0000, v85
    s_add_u32 m0, s61, 36864
    s_add_u32 s16, s16, s63
    buffer_load_dwordx4 v244, s[32:35], s16 offen offset:0  lds
    v_lshlrev_b32 v176, 16, v68
    v_lshlrev_b32 v177, 16, v70
    v_lshlrev_b32 v178, 16, v72
    v_lshlrev_b32 v179, 16, v74
    v_lshlrev_b32 v180, 16, v76
    buffer_load_dwordx4 v245, s[32:35], s16 offen offset:1024  lds
    v_lshlrev_b32 v181, 16, v78
    v_lshlrev_b32 v182, 16, v80
    v_lshlrev_b32 v183, 16, v82
    v_mul_f32 v184, v160, v175
    v_mul_f32 v185, v161, v175
    buffer_load_dwordx4 v246, s[32:35], s16 offen offset:2048  lds
    v_mul_f32 v186, v162, v175
    v_mul_f32 v187, v163, v175
    v_mul_f32 v188, v164, v175
    v_mul_f32 v189, v165, v175
    v_mul_f32 v190, v166, v175
    s_add_u32 s97, s98, s0
    s_lshr_b64 s[0:1], s[0:1], 4
    s_and_b32 s97, s97, 15
    s_add_u32 m0, s87, 36864
    s_lshl_b32 s97, s97, 7
    buffer_load_dwordx4 v240, s[28:31], s97 offen offset:0  lds
    v_mul_f32 v191, v167, v175
    v_fmac_f32 v184, v161, v174
    v_fmac_f32 v185, v162, v174
    v_fmac_f32 v186, v163, v174
    v_fmac_f32 v187, v164, v174
    buffer_load_dwordx4 v241, s[28:31], s97 offen offset:1024  lds
    v_fmac_f32 v188, v165, v174
    v_fmac_f32 v189, v166, v174
    v_fmac_f32 v190, v167, v174
    v_fmac_f32 v191, v168, v174
    v_fmac_f32 v184, v162, v173
    buffer_load_dwordx4 v242, s[28:31], s97 offen offset:2048  lds
    v_fmac_f32 v185, v163, v173
    v_fmac_f32 v186, v164, v173
    v_fmac_f32 v187, v165, v173
    v_fmac_f32 v188, v166, v173
    v_fmac_f32 v189, v167, v173
    buffer_load_dwordx4 v243, s[28:31], s97 offen offset:3072  lds
    v_fmac_f32 v190, v168, v173
    v_fmac_f32 v191, v169, v173
    v_fmac_f32 v184, v163, v172
    v_fmac_f32 v185, v164, v172
    v_fmac_f32 v186, v165, v172
    s_add_u32 m0, s88, 36864
    s_mov_b64 exec, 0xffffffff
    buffer_load_dwordx4 v3, s[28:31], s97 offen offset:0  lds
    s_mov_b64 exec, -1
    v_fmac_f32 v187, v166, v172
    v_fmac_f32 v188, v167, v172
    v_fmac_f32 v189, v168, v172
    v_fmac_f32 v190, v169, v172
    v_fmac_f32 v191, v170, v172
    v_mul_f32 v184, v184, v176
    v_mul_f32 v185, v185, v177
    v_mul_f32 v186, v186, v178
    v_mul_f32 v187, v187, v179
    v_mul_f32 v188, v188, v180
    v_mul_f32 v189, v189, v181
    v_mul_f32 v190, v190, v182
    v_mul_f32 v191, v191, v183
    v_cvt_pk_bf16_f32 v100, v191, v190
    v_cvt_pk_bf16_f32 v101, v189, v188
    v_cvt_pk_bf16_f32 v102, v187, v186
    v_cvt_pk_bf16_f32 v103, v185, v184
    s_mov_b32 s89, 0
    buffer_store_dwordx4 v[100:103], v12, s[52:55], s89 offen sc1
    v_and_b32 v160, 0xffff0000, v40
    v_and_b32 v161, 0xffff0000, v42
    v_and_b32 v162, 0xffff0000, v44
    v_and_b32 v163, 0xffff0000, v46
    v_and_b32 v164, 0xffff0000, v48
    v_and_b32 v165, 0xffff0000, v50
    v_and_b32 v166, 0xffff0000, v52
    v_and_b32 v167, 0xffff0000, v54
    v_and_b32 v168, 0xffff0000, v56
    v_and_b32 v169, 0xffff0000, v58
    v_and_b32 v170, 0xffff0000, v60
    v_lshlrev_b32 v172, 16, v86
    v_and_b32 v173, 0xffff0000, v86
    v_lshlrev_b32 v174, 16, v87
    v_and_b32 v175, 0xffff0000, v87
    v_and_b32 v176, 0xffff0000, v68
    v_and_b32 v177, 0xffff0000, v70
    v_and_b32 v178, 0xffff0000, v72
    v_and_b32 v179, 0xffff0000, v74
    v_and_b32 v180, 0xffff0000, v76
    v_and_b32 v181, 0xffff0000, v78
    v_and_b32 v182, 0xffff0000, v80
    v_and_b32 v183, 0xffff0000, v82
    s_waitcnt vmcnt(12)
    s_barrier
    s_mul_i32 s16, s97, 3072
    s_add_u32 m0, s60, 49152
    s_add_u32 s99, s16, s62
    buffer_load_dwordx4 v244, s[32:35], s99 offen offset:0  lds
    v_mul_f32 v184, v160, v175
    v_mul_f32 v185, v161, v175
    v_mul_f32 v186, v162, v175
    v_mul_f32 v187, v163, v175
    v_mul_f32 v188, v164, v175
    buffer_load_dwordx4 v245, s[32:35], s99 offen offset:1024  lds
    v_mul_f32 v189, v165, v175
    v_mul_f32 v190, v166, v175
    v_mul_f32 v191, v167, v175
    v_fmac_f32 v184, v161, v174
    v_fmac_f32 v185, v162, v174
    buffer_load_dwordx4 v246, s[32:35], s99 offen offset:2048  lds
    v_fmac_f32 v186, v163, v174
    v_fmac_f32 v187, v164, v174
    v_fmac_f32 v188, v165, v174
    v_fmac_f32 v189, v166, v174
    v_fmac_f32 v190, v167, v174
    s_add_u32 m0, s61, 61440
    s_add_u32 s16, s16, s63
    buffer_load_dwordx4 v244, s[32:35], s16 offen offset:0  lds
    v_fmac_f32 v191, v168, v174
    v_fmac_f32 v184, v162, v173
    v_fmac_f32 v185, v163, v173
    v_fmac_f32 v186, v164, v173
    v_fmac_f32 v187, v165, v173
    buffer_load_dwordx4 v245, s[32:35], s16 offen offset:1024  lds
    v_fmac_f32 v188, v166, v173
    v_fmac_f32 v189, v167, v173
    v_fmac_f32 v190, v168, v173
    v_fmac_f32 v191, v169, v173
    v_fmac_f32 v184, v163, v172
    buffer_load_dwordx4 v246, s[32:35], s16 offen offset:2048  lds
    v_fmac_f32 v185, v164, v172
    v_fmac_f32 v186, v165, v172
    v_fmac_f32 v187, v166, v172
    v_fmac_f32 v188, v167, v172
    v_fmac_f32 v189, v168, v172
    s_add_u32 s97, s98, s0
    s_lshr_b64 s[0:1], s[0:1], 4
    s_and_b32 s97, s97, 15
    s_add_u32 m0, s87, 0
    s_lshl_b32 s97, s97, 7
    buffer_load_dwordx4 v240, s[28:31], s97 offen offset:0  lds
    v_fmac_f32 v190, v169, v172
    v_fmac_f32 v191, v170, v172
    v_mul_f32 v184, v184, v176
    v_mul_f32 v185, v185, v177
    v_mul_f32 v186, v186, v178
    buffer_load_dwordx4 v241, s[28:31], s97 offen offset:1024  lds
    v_mul_f32 v187, v187, v179
    v_mul_f32 v188, v188, v180
    v_mul_f32 v189, v189, v181
    v_mul_f32 v190, v190, v182
    v_mul_f32 v191, v191, v183
    buffer_load_dwordx4 v242, s[28:31], s97 offen offset:2048  lds
    v_cvt_pk_bf16_f32 v104, v191, v190
    v_cvt_pk_bf16_f32 v105, v189, v188
    v_cvt_pk_bf16_f32 v106, v187, v186
    v_cvt_pk_bf16_f32 v107, v185, v184
    s_mov_b32 s89, 16384
    buffer_store_dwordx4 v[104:107], v12, s[52:55], s89 offen sc1
    buffer_load_dwordx4 v243, s[28:31], s97 offen offset:3072  lds
    v_lshlrev_b32 v160, 16, v41
    v_lshlrev_b32 v161, 16, v43
    v_lshlrev_b32 v162, 16, v45
    v_lshlrev_b32 v163, 16, v47
    v_lshlrev_b32 v164, 16, v49
    s_add_u32 m0, s88, 0
    s_mov_b64 exec, 0xffffffff
    buffer_load_dwordx4 v3, s[28:31], s97 offen offset:0  lds
    s_mov_b64 exec, -1
    v_lshlrev_b32 v165, 16, v51
    v_lshlrev_b32 v166, 16, v53
    v_lshlrev_b32 v167, 16, v55
    v_lshlrev_b32 v168, 16, v57
    v_lshlrev_b32 v169, 16, v59
    v_lshlrev_b32 v170, 16, v61
    v_lshlrev_b32 v172, 16, v88
    v_and_b32 v173, 0xffff0000, v88
    v_lshlrev_b32 v174, 16, v89
    v_and_b32 v175, 0xffff0000, v89
    v_lshlrev_b32 v176, 16, v69
    v_lshlrev_b32 v177, 16, v71
    v_lshlrev_b32 v178, 16, v73
    v_lshlrev_b32 v179, 16, v75
    v_lshlrev_b32 v180, 16, v77
    v_lshlrev_b32 v181, 16, v79
    v_lshlrev_b32 v182, 16, v81
    v_lshlrev_b32 v183, 16, v83
    v_mul_f32 v184, v160, v175
    v_mul_f32 v185, v161, v175
    v_mul_f32 v186, v162, v175
    v_mul_f32 v187, v163, v175
    v_mul_f32 v188, v164, v175
    v_mul_f32 v189, v165, v175
    v_mul_f32 v190, v166, v175
    v_mul_f32 v191, v167, v175
    v_fmac_f32 v184, v161, v174
    v_fmac_f32 v185, v162, v174
    v_fmac_f32 v186, v163, v174
    v_fmac_f32 v187, v164, v174
    v_fmac_f32 v188, v165, v174
    v_fmac_f32 v189, v166, v174
    v_fmac_f32 v190, v167, v174
    v_fmac_f32 v191, v168, v174
    v_fmac_f32 v184, v162, v173
    v_fmac_f32 v185, v163, v173
    v_fmac_f32 v186, v164, v173
    v_fmac_f32 v187, v165, v173
    v_fmac_f32 v188, v166, v173
    v_fmac_f32 v189, v167, v173
    v_fmac_f32 v190, v168, v173
    s_waitcnt vmcnt(13)
    s_barrier
    s_mul_i32 s16, s97, 3072
    s_add_u32 m0, s60, 0
    s_add_u32 s99, s16, s62
    buffer_load_dwordx4 v244, s[32:35], s99 offen offset:0  lds
    v_fmac_f32 v191, v169, v173
    v_fmac_f32 v184, v163, v172
    v_fmac_f32 v185, v164, v172
    v_fmac_f32 v186, v165, v172
    v_fmac_f32 v187, v166, v172
    buffer_load_dwordx4 v245, s[32:35], s99 offen offset:1024  lds
    v_fmac_f32 v188, v167, v172
    v_fmac_f32 v189, v168, v172
    v_fmac_f32 v190, v169, v172
    v_fmac_f32 v191, v170, v172
    v_mul_f32 v184, v184, v176
    buffer_load_dwordx4 v246, s[32:35], s99 offen offset:2048  lds
    v_mul_f32 v185, v185, v177
    v_mul_f32 v186, v186, v178
    v_mul_f32 v187, v187, v179
    v_mul_f32 v188, v188, v180
    v_mul_f32 v189, v189, v181
    s_add_u32 m0, s61, 12288
    s_add_u32 s16, s16, s63
    buffer_load_dwordx4 v244, s[32:35], s16 offen offset:0  lds
    v_mul_f32 v190, v190, v182
    v_mul_f32 v191, v191, v183
    v_cvt_pk_bf16_f32 v108, v191, v190
    v_cvt_pk_bf16_f32 v109, v189, v188
    v_cvt_pk_bf16_f32 v110, v187, v186
    buffer_load_dwordx4 v245, s[32:35], s16 offen offset:1024  lds
    v_cvt_pk_bf16_f32 v111, v185, v184
    s_mov_b32 s89, 32768
    buffer_store_dwordx4 v[108:111], v12, s[52:55], s89 offen sc1
    v_and_b32 v160, 0xffff0000, v41
    v_and_b32 v161, 0xffff0000, v43
    v_and_b32 v162, 0xffff0000, v45
    buffer_load_dwordx4 v246, s[32:35], s16 offen offset:2048  lds
    v_and_b32 v163, 0xffff0000, v47
    v_and_b32 v164, 0xffff0000, v49
    v_and_b32 v165, 0xffff0000, v51
    v_and_b32 v166, 0xffff0000, v53
    v_and_b32 v167, 0xffff0000, v55
    s_add_u32 s97, s98, s0
    s_lshr_b64 s[0:1], s[0:1], 4
    s_and_b32 s97, s97, 15
    s_add_u32 m0, s87, 18432
    s_lshl_b32 s97, s97, 7
    buffer_load_dwordx4 v240, s[28:31], s97 offen offset:0  lds
    v_and_b32 v168, 0xffff0000, v57
    v_and_b32 v169, 0xffff0000, v59
    v_and_b32 v170, 0xffff0000, v61
    v_lshlrev_b32 v172, 16, v90
    v_and_b32 v173, 0xffff0000, v90
    buffer_load_dwordx4 v241, s[28:31], s97 offen offset:1024  lds
    v_lshlrev_b32 v174, 16, v91
    v_and_b32 v175, 0xffff0000, v91
    v_and_b32 v176, 0xffff0000, v69
    v_and_b32 v177, 0xffff0000, v71
    v_and_b32 v178, 0xffff0000, v73
    buffer_load_dwordx4 v242, s[28:31], s97 offen offset:2048  lds
    v_and_b32 v179, 0xffff0000, v75
    v_and_b32 v180, 0xffff0000, v77
    v_and_b32 v181, 0xffff0000, v79
    v_and_b32 v182, 0xffff0000, v81
    v_and_b32 v183, 0xffff0000, v83
    buffer_load_dwordx4 v243, s[28:31], s97 offen offset:3072  lds
    v_mul_f32 v184, v160, v175
    v_mul_f32 v185, v161, v175
    v_mul_f32 v186, v162, v175
    v_mul_f32 v187, v163, v175
    v_mul_f32 v188, v164, v175
    s_add_u32 m0, s88, 18432
    s_mov_b64 exec, 0xffffffff
    buffer_load_dwordx4 v3, s[28:31], s97 offen offset:0  lds
    s_mov_b64 exec, -1
    v_mul_f32 v189, v165, v175
    v_mul_f32 v190, v166, v175
    v_mul_f32 v191, v167, v175
    v_fmac_f32 v184, v161, v174
    v_fmac_f32 v185, v162, v174
    v_fmac_f32 v186, v163, v174
    v_fmac_f32 v187, v164, v174
    v_fmac_f32 v188, v165, v174
    v_fmac_f32 v189, v166, v174
    v_fmac_f32 v190, v167, v174
    v_fmac_f32 v191, v168, v174
    v_fmac_f32 v184, v162, v173
    v_fmac_f32 v185, v163, v173
    v_fmac_f32 v186, v164, v173
    v_fmac_f32 v187, v165, v173
    v_fmac_f32 v188, v166, v173
    v_fmac_f32 v189, v167, v173
    v_fmac_f32 v190, v168, v173
    v_fmac_f32 v191, v169, v173
    v_fmac_f32 v184, v163, v172
    v_fmac_f32 v185, v164, v172
    v_fmac_f32 v186, v165, v172
    v_fmac_f32 v187, v166, v172
    v_fmac_f32 v188, v167, v172
    v_fmac_f32 v189, v168, v172
    v_fmac_f32 v190, v169, v172
    v_fmac_f32 v191, v170, v172
    v_mul_f32 v184, v184, v176
    v_mul_f32 v185, v185, v177
    v_mul_f32 v186, v186, v178
    v_mul_f32 v187, v187, v179
    v_mul_f32 v188, v188, v180
    v_mul_f32 v189, v189, v181
    v_mul_f32 v190, v190, v182
    v_mul_f32 v191, v191, v183
    v_cvt_pk_bf16_f32 v112, v191, v190
    v_cvt_pk_bf16_f32 v113, v189, v188
    v_cvt_pk_bf16_f32 v114, v187, v186
    v_cvt_pk_bf16_f32 v115, v185, v184
    s_mov_b32 s89, 49152
    buffer_store_dwordx4 v[112:115], v12, s[52:55], s89 offen sc1
    s_waitcnt vmcnt(13)
    s_barrier
    s_mul_i32 s16, s97, 3072
    s_add_u32 m0, s60, 24576
    s_add_u32 s99, s16, s62
    buffer_load_dwordx4 v244, s[32:35], s99 offen offset:0  lds
    buffer_load_dwordx4 v245, s[32:35], s99 offen offset:1024  lds
    buffer_load_dwordx4 v246, s[32:35], s99 offen offset:2048  lds
    s_add_u32 m0, s61, 36864
    s_add_u32 s16, s16, s63
    buffer_load_dwordx4 v244, s[32:35], s16 offen offset:0  lds
    buffer_load_dwordx4 v245, s[32:35], s16 offen offset:1024  lds
    buffer_load_dwordx4 v246, s[32:35], s16 offen offset:2048  lds
    s_add_u32 s97, s98, s0
    s_lshr_b64 s[0:1], s[0:1], 4
    s_and_b32 s97, s97, 15
    s_add_u32 m0, s87, 36864
    s_lshl_b32 s97, s97, 7
    buffer_load_dwordx4 v240, s[28:31], s97 offen offset:0  lds
    buffer_load_dwordx4 v241, s[28:31], s97 offen offset:1024  lds
    buffer_load_dwordx4 v242, s[28:31], s97 offen offset:2048  lds
    buffer_load_dwordx4 v243, s[28:31], s97 offen offset:3072  lds
    s_add_u32 m0, s88, 36864
    s_mov_b64 exec, 0xffffffff
    buffer_load_dwordx4 v3, s[28:31], s97 offen offset:0  lds
    s_mov_b64 exec, -1
    s_waitcnt vmcnt(12)
    s_waitcnt vmcnt(11)
    s_barrier
    s_mul_i32 s16, s97, 3072
    s_add_u32 m0, s60, 49152
    s_add_u32 s99, s16, s62
    buffer_load_dwordx4 v244, s[32:35], s99 offen offset:0  lds
    s_mov_b32 s68, s24
    s_mov_b32 s69, s25
    s_mov_b32 s70, 0x100
    s_mov_b32 s71, 0x20000
    buffer_load_dwordx4 v245, s[32:35], s99 offen offset:1024  lds
    v_lshrrev_b32 v6, 5, v0
    v_and_b32 v7, 3, v0
    s_lshr_b32 s78, s90, 1
    buffer_load_dwordx4 v246, s[32:35], s99 offen offset:2048  lds
    s_lshl_b32 s78, s78, 2
    s_load_dword s92, s[14:15], s78
    v_bfe_u32 v5, v0, 2, 2
    v_lshlrev_b32 v5, 1, v5
    s_add_u32 m0, s61, 61440
    s_add_u32 s16, s16, s63
    buffer_load_dwordx4 v244, s[32:35], s16 offen offset:0  lds
    v_lshl_add_u32 v5, v6, 3, v5
    v_bfe_u32 v8, v0, 4, 1
    v_add_u32 v5, v5, v8
    buffer_load_dwordx4 v245, s[32:35], s16 offen offset:1024  lds
    s_and_b32 s78, s3, 1
    s_lshl_b32 s78, s78, 1
    v_add_u32 v8, s78, v6
    v_xor_b32 v8, v8, v7
    buffer_load_dwordx4 v246, s[32:35], s16 offen offset:2048  lds
    v_lshlrev_b32 v8, 4, v8
    v_lshl_add_u32 v5, v5, 6, v8
    v_add_u32 v14, s86, v5
    s_add_u32 m0, s94, 32
    s_lshl_b32 s89, s90, 12
    buffer_load_dwordx4 v15, s[48:51], s89 offen offset:0 nt lds
    v_mov_b32 v18, 162304
    v_mov_b32 v19, 1
    v_and_b32 v5, 3, v0
    s_lshl_b32 s78, s74, 4
    s_add_u32 m0, s94, 32
    s_lshl_b32 s89, s90, 12
    buffer_load_dwordx4 v15, s[48:51], s89 offen offset:1024 nt lds
    s_add_u32 s78, s78, s3
    v_lshl_add_u32 v6, v5, 2, s78
    s_lshr_b32 s78, s76, 3
    s_add_u32 m0, s94, 32
    s_lshl_b32 s89, s90, 12
    buffer_load_dwordx4 v15, s[48:51], s89 offen offset:2048 nt lds
    s_lshl_b32 s79, s3, 1
    s_add_u32 s78, s78, s79
    s_xor_b32 s78, s78, 2
    s_lshl_b32 s78, s78, 5
    s_add_u32 m0, s94, 32
    s_lshl_b32 s89, s90, 12
    buffer_load_dwordx4 v15, s[48:51], s89 offen offset:3072 nt lds
    s_add_u32 s79, s76, 5
    s_and_b32 s79, s79, 7
    s_lshl_b32 s79, s79, 1
    s_add_u32 s97, s98, s0
    s_lshr_b64 s[0:1], s[0:1], 4
    s_and_b32 s97, s97, 15
    s_add_u32 m0, s87, 0
    s_lshl_b32 s97, s97, 7
    buffer_load_dwordx4 v240, s[28:31], s97 offen offset:0  lds
    s_add_u32 s78, s78, s79
    v_mul_u32_u24 v7, 9, v5
    v_and_b32 v7, 17, v7
    v_add_u32 v7, s78, v7
    buffer_load_dwordx4 v241, s[28:31], s97 offen offset:1024  lds
    v_and_b32 v8, 4, v0
    v_cmp_eq_u32 vcc, 0, v8
    s_nop 1
    v_cndmask_b32 v6, v7, v6, vcc
    buffer_load_dwordx4 v242, s[28:31], s97 offen offset:2048  lds
    v_and_b32 v33, 0xf0, v6
    v_lshlrev_b32 v34, 8, v6
    v_add_u32 v34, 12582912, v34
    v_and_b32 v5, 15, v0
    buffer_load_dwordx4 v243, s[28:31], s97 offen offset:3072  lds
    v_lshrrev_b32 v6, 4, v0
    v_add_u32 v7, 9, v5
    v_and_b32 v8, 1, v7
    s_add_u32 m0, s88, 0
    s_mov_b64 exec, 0xffffffff
    buffer_load_dwordx4 v3, s[28:31], s97 offen offset:0  lds
    s_mov_b64 exec, -1
    v_mul_u32_u24 v8, 4160, v8
    v_lshrrev_b32 v7, 1, v7
    v_lshl_add_u32 v8, v7, 2, v8
    s_waitcnt vmcnt(15)
    s_barrier
    s_mul_i32 s16, s97, 3072
    s_add_u32 m0, s60, 0
    s_add_u32 s99, s16, s62
    buffer_load_dwordx4 v244, s[32:35], s99 offen offset:0  lds
    v_lshlrev_b32 v7, 4, v6
    v_sub_u32 v8, v8, v7
    s_add_u32 s78, s94, 32
    v_add_u32 v21, s78, v8
    v_add_u32 v22, 1024, v21
    buffer_load_dwordx4 v245, s[32:35], s99 offen offset:1024  lds
    v_add_u32 v23, 2048, v21
    v_add_u32 v24, 3072, v21
    v_lshl_add_u32 v7, v5, 1, v6
    v_add_u32 v7, 30, v7
    v_and_b32 v8, 1, v7
    buffer_load_dwordx4 v246, s[32:35], s99 offen offset:2048  lds
    v_bfe_u32 v136, v7, 1, 2
    v_lshl_add_u32 v136, v8, 2, v136
    v_lshlrev_b32 v136, 6, v136
    v_lshrrev_b32 v7, 3, v7
    v_lshl_add_u32 v136, v7, 9, v136
    s_add_u32 m0, s61, 12288
    s_add_u32 s16, s16, s63
    buffer_load_dwordx4 v244, s[32:35], s16 offen offset:0  lds
    v_bitop3_b32 v8, v7, 3, s3 bitop3:0x6a
    v_lshl_add_u32 v25, v8, 4, v136
    v_add_u32 v25, 92160, v25
    v_subrev_u32 v7, 1, v7
    buffer_load_dwordx4 v245, s[32:35], s16 offen offset:1024  lds
    v_bitop3_b32 v8, v7, 3, s3 bitop3:0x6a
    v_lshl_add_u32 v27, v8, 4, v136
    v_add_u32 v27, 91648, v27
    v_subrev_u32 v7, 1, v7
    v_bitop3_b32 v8, v7, 3, s3 bitop3:0x6a
    buffer_load_dwordx4 v246, s[32:35], s16 offen offset:2048  lds
    v_lshl_add_u32 v29, v8, 4, v136
    v_add_u32 v29, 91136, v29
    v_subrev_u32 v7, 1, v7
    v_bitop3_b32 v8, v7, 3, s3 bitop3:0x6a
    v_lshl_add_u32 v31, v8, 4, v136
    s_add_u32 s97, s98, s0
    s_lshr_b64 s[0:1], s[0:1], 4
    s_and_b32 s97, s97, 15
    s_add_u32 m0, s87, 18432
    s_lshl_b32 s97, s97, 7
    buffer_load_dwordx4 v240, s[28:31], s97 offen offset:0  lds
    v_add_u32 v31, 90624, v31
    v_lshl_add_u32 v7, v5, 1, v6
    v_add_u32 v7, 26, v7
    v_and_b32 v8, 1, v7
    v_bfe_u32 v136, v7, 1, 2
    buffer_load_dwordx4 v241, s[28:31], s97 offen offset:1024  lds
    v_lshl_add_u32 v136, v8, 2, v136
    v_lshlrev_b32 v136, 6, v136
    v_lshrrev_b32 v7, 3, v7
    v_lshl_add_u32 v136, v7, 9, v136
    buffer_load_dwordx4 v242, s[28:31], s97 offen offset:2048  lds
    v_bitop3_b32 v8, v7, 3, s3 bitop3:0x6a
    v_lshl_add_u32 v26, v8, 4, v136
    v_add_u32 v26, 92160, v26
    v_subrev_u32 v7, 1, v7
    v_bitop3_b32 v8, v7, 3, s3 bitop3:0x6a
    buffer_load_dwordx4 v243, s[28:31], s97 offen offset:3072  lds
    v_lshl_add_u32 v28, v8, 4, v136
    v_add_u32 v28, 91648, v28
    v_subrev_u32 v7, 1, v7
    v_bitop3_b32 v8, v7, 3, s3 bitop3:0x6a
    v_lshl_add_u32 v30, v8, 4, v136
    s_add_u32 m0, s88, 18432
    s_mov_b64 exec, 0xffffffff
    buffer_load_dwordx4 v3, s[28:31], s97 offen offset:0  lds
    s_mov_b64 exec, -1
    v_add_u32 v30, 91136, v30
    v_subrev_u32 v7, 1, v7
    v_bitop3_b32 v8, v7, 3, s3 bitop3:0x6a
    v_lshl_add_u32 v32, v8, 4, v136
    s_waitcnt vmcnt(11)
    s_barrier
    s_mul_i32 s16, s97, 3072
    s_add_u32 m0, s60, 24576
    s_add_u32 s99, s16, s62
    buffer_load_dwordx4 v244, s[32:35], s99 offen offset:0  lds
    v_add_u32 v32, 90624, v32
    v_lshrrev_b32 v7, 1, v6
    v_lshl_add_u32 v7, v5, 1, v7
    v_add_u32 v7, 32, v7
    v_and_b32 v8, 1, v7
    buffer_load_dwordx4 v245, s[32:35], s99 offen offset:1024  lds
    v_bfe_u32 v136, v7, 1, 2
    v_lshl_add_u32 v136, v8, 2, v136
    v_lshlrev_b32 v136, 6, v136
    v_lshrrev_b32 v7, 3, v7
    buffer_load_dwordx4 v246, s[32:35], s99 offen offset:2048  lds
    v_lshl_add_u32 v136, v7, 9, v136
    v_bitop3_b32 v8, v7, 3, s3 bitop3:0x6a
    v_lshl_add_u32 v20, v8, 4, v136
    v_add_u32 v20, 92160, v20
    v_and_b32 v8, 1, v6
    s_add_u32 m0, s61, 36864
    s_add_u32 s16, s16, s63
    buffer_load_dwordx4 v244, s[32:35], s16 offen offset:0  lds
    v_xor_b32 v8, 1, v8
    v_lshl_add_u32 v20, v8, 3, v20
    s_waitcnt lgkmcnt(0)
    s_and_b32 s78, s92, 0xffff0000
    buffer_load_dwordx4 v245, s[32:35], s16 offen offset:1024  lds
    s_lshl_b32 s92, s92, 16
    s_bitcmp1_b32 s90, 0
    s_cselect_b32 s92, s78, s92
    v_lshlrev_b32 v7, 3, v6
    v_sub_u32 v7, v7, v5
    buffer_load_dwordx4 v246, s[32:35], s16 offen offset:2048  lds
    v_subrev_u32 v7, 9, v7
    v_and_b32 v8, 1, v7
    v_xor_b32 v8, 1, v8
    v_lshlrev_b32 v8, 4, v8
    v_lshrrev_b32 v8, v8, s92
    s_add_u32 s97, s98, s0
    s_lshr_b64 s[0:1], s[0:1], 4
    s_and_b32 s97, s97, 15
    s_add_u32 m0, s87, 36864
    s_lshl_b32 s97, s97, 7
    buffer_load_dwordx4 v240, s[28:31], s97 offen offset:0  lds
    v_ashrrev_i32 v7, 1, v7
    v_cmp_eq_u32 vcc, 0, v7
    s_nop 1
    v_cndmask_b32 v236, 0, v8, vcc
    v_cmp_eq_u32 vcc, 1, v7
    buffer_load_dwordx4 v241, s[28:31], s97 offen offset:1024  lds
    s_nop 0
    v_cndmask_b32 v237, 0, v8, vcc
    v_cmp_eq_u32 vcc, 2, v7
    s_nop 1
    v_cndmask_b32 v238, 0, v8, vcc
    v_cmp_eq_u32 vcc, 3, v7
    buffer_load_dwordx4 v242, s[28:31], s97 offen offset:2048  lds
    s_nop 0
    v_cndmask_b32 v239, 0, v8, vcc
    s_and_b32 s78, s77, 7
    s_mov_b32 s95, 0x76543210
    s_cmp_eq_u32 s78, 1
    s_cselect_b32 s95, 0x76543201, s95
    s_cmp_eq_u32 s78, 2
    s_cselect_b32 s95, 0x76543120, s95
    s_cmp_eq_u32 s78, 3
    s_cselect_b32 s95, 0x76542310, s95
    s_cmp_eq_u32 s78, 4
    s_cselect_b32 s95, 0x76534210, s95
    s_cmp_eq_u32 s78, 5
    s_cselect_b32 s95, 0x76453210, s95
    s_cmp_eq_u32 s78, 6
    s_cselect_b32 s95, 0x75643210, s95
    s_cmp_eq_u32 s78, 7
    s_cselect_b32 s95, 0x67543210, s95
    s_and_b32 s78, s76, 3
    s_mul_i32 s78, s78, 0x22222222
    s_add_u32 s95, s95, s78
    s_bfe_u32 s100, s95, 0x3001c
    s_lshl_b32 s100, s100, 18
    s_bfe_u32 s95, s95, 0x30018
    s_lshl_b32 s95, s95, 18
    v_lshrrev_b32 v136, 4, v0
    v_lshlrev_b32 v136, 1, v136
    v_and_b32 v137, 7, v0
    buffer_load_dwordx4 v243, s[28:31], s97 offen offset:3072  lds
    v_xor_b32 v136, v136, v137
    v_lshlrev_b32 v136, 4, v136
    v_lshrrev_b32 v137, 3, v0
    v_lshl_add_u32 v136, v137, 11, v136
    s_add_u32 m0, s88, 36864
    s_mov_b64 exec, 0xffffffff
    buffer_load_dwordx4 v3, s[28:31], s97 offen offset:0  lds
    s_mov_b64 exec, -1
    s_lshl_b32 s78, s77, 7
    s_lshl_b32 s79, s3, 14
    s_add_u32 s78, s78, s79
    v_add_u32 v17, s78, v136
    s_waitcnt vmcnt(11)
    s_barrier
    s_mul_i32 s16, s97, 3072
    s_add_u32 m0, s60, 49152
    s_add_u32 s99, s16, s62
    buffer_load_dwordx4 v244, s[32:35], s99 offen offset:0  lds
    v_add_u32 v5, s94, v15
    ds_read_b128 v[140:143], v5 offset:32
    ds_read_b32 v156, v5 offset:48
    ds_read_b128 v[144:147], v5 offset:1056
    buffer_load_dwordx4 v245, s[32:35], s99 offen offset:1024  lds
    ds_read_b32 v157, v5 offset:1072
    ds_read_b128 v[148:151], v5 offset:2080
    ds_read_b32 v158, v5 offset:2096
    ds_read_b128 v[152:155], v5 offset:3104
    buffer_load_dwordx4 v246, s[32:35], s99 offen offset:2048  lds
    ds_read_b32 v159, v5 offset:3120
    v_lshrrev_b32 v6, 3, v0
    v_mul_u32_u24 v6, 4160, v6
    s_add_u32 m0, s61, 61440
    s_add_u32 s16, s16, s63
    buffer_load_dwordx4 v244, s[32:35], s16 offen offset:0  lds
    v_and_b32 v7, 7, v0
    v_lshl_add_u32 v6, v7, 2, v6
    v_add_u32 v6, s94, v6
    v_mov_b32 v7, 0
    buffer_load_dwordx4 v245, s[32:35], s16 offen offset:1024  lds
    s_waitcnt lgkmcnt(0)
    v_readfirstlane_b32 s93, v140
    s_nop 0
    s_lshl_b32 s93, s93, 16
    s_nop 1
    v_writelane_b32 v7, s93, 15
    buffer_load_dwordx4 v246, s[32:35], s16 offen offset:2048  lds
    v_alignbit_b32 v140, v141, v140, 16
    v_alignbit_b32 v141, v142, v141, 16
    v_alignbit_b32 v142, v143, v142, 16
    s_add_u32 s97, s98, s0
    s_lshr_b64 s[0:1], s[0:1], 4
    s_and_b32 s97, s97, 15
    s_add_u32 m0, s87, 0
    s_lshl_b32 s97, s97, 7
    buffer_load_dwordx4 v240, s[28:31], s97 offen offset:0  lds
    v_alignbit_b32 v143, v156, v143, 16
    v_alignbit_b32 v144, v145, v144, 16
    v_alignbit_b32 v145, v146, v145, 16
    v_alignbit_b32 v146, v147, v146, 16
    buffer_load_dwordx4 v241, s[28:31], s97 offen offset:1024  lds
    v_alignbit_b32 v147, v157, v147, 16
    v_alignbit_b32 v148, v149, v148, 16
    v_alignbit_b32 v149, v150, v149, 16
    v_alignbit_b32 v150, v151, v150, 16
    buffer_load_dwordx4 v242, s[28:31], s97 offen offset:2048  lds
    v_alignbit_b32 v151, v158, v151, 16
    v_alignbit_b32 v152, v153, v152, 16
    v_alignbit_b32 v153, v154, v153, 16
    buffer_load_dwordx4 v243, s[28:31], s97 offen offset:3072  lds
    v_alignbit_b32 v154, v155, v154, 16
    v_alignbit_b32 v155, v159, v155, 16
    v_lshlrev_b32 v8, 3, v0
    s_add_u32 s78, s88, 18432
    s_add_u32 m0, s88, 0
    s_mov_b64 exec, 0xffffffff
    buffer_load_dwordx4 v3, s[28:31], s97 offen offset:0  lds
    s_mov_b64 exec, -1
    v_add_u32 v8, s78, v8
    v_mov_b32 v156, 0
    v_mov_b32 v157, 0
    s_waitcnt vmcnt(11)
    s_barrier
    s_mul_i32 s16, s97, 3072
    s_add_u32 m0, s60, 0
    s_add_u32 s99, s16, s62
    buffer_load_dwordx4 v244, s[32:35], s99 offen offset:0  lds
    buffer_load_dwordx4 v245, s[32:35], s99 offen offset:1024  lds
    buffer_load_dwordx4 v246, s[32:35], s99 offen offset:2048  lds
    s_add_u32 m0, s61, 12288
    s_add_u32 s16, s16, s63
    buffer_load_dwordx4 v244, s[32:35], s16 offen offset:0  lds
    buffer_load_dwordx4 v245, s[32:35], s16 offen offset:1024  lds
    buffer_load_dwordx4 v246, s[32:35], s16 offen offset:2048  lds
    s_mov_b64 exec, 0xff
    buffer_load_dword v136, v33, s[68:71], 0 offen sc1
    buffer_load_dword v137, v34, s[52:55], 0 offen sc1
    s_mov_b64 exec, -1
    buffer_load_dwordx4 v[212:215], v9, s[56:59], 0 offen offset:0 nt
    buffer_load_dwordx4 v[216:219], v9, s[56:59], 0 offen offset:2048 nt
    buffer_load_dwordx4 v[220:223], v9, s[56:59], s96 offen offset:0 nt
    buffer_load_dwordx4 v[224:227], v9, s[56:59], s96 offen offset:2048 nt
    s_waitcnt vmcnt(12)
    s_waitcnt vmcnt(6)
    s_barrier
    s_waitcnt vmcnt(4)
    s_branch LA_j
LA_c3:
    s_waitcnt vmcnt(8)
    s_barrier
    buffer_load_dwordx4 v242, s[28:31], s97 offen offset:2048  lds
    buffer_load_dwordx4 v243, s[28:31], s97 offen offset:3072  lds
    s_add_u32 m0, s88, 36864
    s_mov_b64 exec, 0xffffffff
    buffer_load_dwordx4 v3, s[28:31], s97 offen offset:0  lds
    s_mov_b64 exec, -1
    s_mul_i32 s16, s97, 3072
    s_add_u32 m0, s60, 49152
    s_add_u32 s99, s16, s62
    buffer_load_dwordx4 v244, s[32:35], s99 offen offset:0  lds
    buffer_load_dwordx4 v245, s[32:35], s99 offen offset:1024  lds
    buffer_load_dwordx4 v246, s[32:35], s99 offen offset:2048  lds
    s_add_u32 m0, s61, 61440
    s_add_u32 s16, s16, s63
    buffer_load_dwordx4 v244, s[32:35], s16 offen offset:0  lds
    buffer_load_dwordx4 v245, s[32:35], s16 offen offset:1024  lds
    buffer_load_dwordx4 v246, s[32:35], s16 offen offset:2048  lds
    s_add_u32 s97, s98, s0
    s_lshr_b64 s[0:1], s[0:1], 4
    s_and_b32 s97, s97, 15
    s_add_u32 m0, s87, 0
    s_lshl_b32 s97, s97, 7
    buffer_load_dwordx4 v240, s[28:31], s97 offen offset:0  lds
    buffer_load_dwordx4 v241, s[28:31], s97 offen offset:1024  lds
    buffer_load_dwordx4 v242, s[28:31], s97 offen offset:2048  lds
    buffer_load_dwordx4 v243, s[28:31], s97 offen offset:3072  lds
    s_add_u32 m0, s88, 0
    s_mov_b64 exec, 0xffffffff
    buffer_load_dwordx4 v3, s[28:31], s97 offen offset:0  lds
    s_mov_b64 exec, -1
    s_waitcnt vmcnt(11)
    s_barrier
    s_mul_i32 s16, s97, 3072
    s_add_u32 m0, s60, 0
    s_add_u32 s99, s16, s62
    buffer_load_dwordx4 v244, s[32:35], s99 offen offset:0  lds
    buffer_load_dwordx4 v245, s[32:35], s99 offen offset:1024  lds
    buffer_load_dwordx4 v246, s[32:35], s99 offen offset:2048  lds
    s_add_u32 m0, s61, 12288
    s_add_u32 s16, s16, s63
    buffer_load_dwordx4 v244, s[32:35], s16 offen offset:0  lds
    buffer_load_dwordx4 v245, s[32:35], s16 offen offset:1024  lds
    buffer_load_dwordx4 v246, s[32:35], s16 offen offset:2048  lds
    s_add_u32 s97, s98, s0
    s_lshr_b64 s[0:1], s[0:1], 4
    s_and_b32 s97, s97, 15
    s_add_u32 m0, s87, 18432
    s_lshl_b32 s97, s97, 7
    buffer_load_dwordx4 v240, s[28:31], s97 offen offset:0  lds
    buffer_load_dwordx4 v241, s[28:31], s97 offen offset:1024  lds
    buffer_load_dwordx4 v242, s[28:31], s97 offen offset:2048  lds
    buffer_load_dwordx4 v243, s[28:31], s97 offen offset:3072  lds
    s_add_u32 m0, s88, 18432
    s_mov_b64 exec, 0xffffffff
    buffer_load_dwordx4 v3, s[28:31], s97 offen offset:0  lds
    s_mov_b64 exec, -1
    s_waitcnt vmcnt(11)
    s_barrier
    s_mul_i32 s16, s97, 3072
    s_add_u32 m0, s60, 24576
    s_add_u32 s99, s16, s62
    buffer_load_dwordx4 v244, s[32:35], s99 offen offset:0  lds
    buffer_load_dwordx4 v245, s[32:35], s99 offen offset:1024  lds
    buffer_load_dwordx4 v246, s[32:35], s99 offen offset:2048  lds
    s_add_u32 m0, s61, 36864
    s_add_u32 s16, s16, s63
    buffer_load_dwordx4 v244, s[32:35], s16 offen offset:0  lds
    buffer_load_dwordx4 v245, s[32:35], s16 offen offset:1024  lds
    buffer_load_dwordx4 v246, s[32:35], s16 offen offset:2048  lds
    s_add_u32 m0, s86, 129536
    s_mov_b32 s89, 0
    buffer_load_dwordx4 v10, s[36:39], s89 offen nt lds
    s_add_u32 m0, s86, 145920
    s_mov_b32 s89, 0
    buffer_load_dwordx4 v10, s[40:43], s89 offen nt lds
    s_add_u32 m0, s86, 133632
    s_mov_b32 s89, 65536
    buffer_load_dwordx4 v10, s[36:39], s89 offen nt lds
    s_add_u32 m0, s86, 150016
    s_mov_b32 s89, 65536
    buffer_load_dwordx4 v10, s[40:43], s89 offen nt lds
    s_add_u32 m0, s86, 137728
    s_mov_b32 s89, 131072
    buffer_load_dwordx4 v10, s[36:39], s89 offen nt lds
    s_add_u32 m0, s86, 154112
    s_mov_b32 s89, 131072
    buffer_load_dwordx4 v10, s[40:43], s89 offen nt lds
    s_add_u32 m0, s86, 141824
    s_mov_b32 s89, 196608
    buffer_load_dwordx4 v10, s[36:39], s89 offen nt lds
    s_add_u32 m0, s86, 158208
    s_mov_b32 s89, 196608
    buffer_load_dwordx4 v10, s[40:43], s89 offen nt lds
    s_mov_b64 exec, 0xff
    s_lshl_b32 s82, s3, 7
    s_add_u32 m0, s82, 129024
    s_mov_b32 s89, 0
    buffer_load_dwordx4 v11, s[36:39], s89 offen nt lds
    s_lshl_b32 s83, s74, 9
    s_add_u32 s83, s83, s82
    s_and_b32 s89, s3, 2
    s_lshl_b32 s89, s89, 3
    s_add_u32 s82, s82, s89
    s_add_u32 m0, s82, 162816
    s_add_u32 s89, s83, 0
    buffer_load_dwordx4 v15, s[44:47], s89 offen  lds
    s_mov_b64 exec, -1
    s_add_u32 s97, s98, s0
    s_lshr_b64 s[0:1], s[0:1], 4
    s_and_b32 s97, s97, 15
    s_add_u32 m0, s87, 36864
    s_lshl_b32 s97, s97, 7
    buffer_load_dwordx4 v240, s[28:31], s97 offen offset:0  lds
    s_waitcnt vmcnt(17)
    s_barrier
    buffer_load_dwordx4 v241, s[28:31], s97 offen offset:1024  lds
    buffer_load_dwordx4 v242, s[28:31], s97 offen offset:2048  lds
    buffer_load_dwordx4 v243, s[28:31], s97 offen offset:3072  lds
    s_add_u32 m0, s88, 36864
    s_mov_b64 exec, 0xffffffff
    buffer_load_dwordx4 v3, s[28:31], s97 offen offset:0  lds
    s_mov_b64 exec, -1
    s_mul_i32 s16, s97, 3072
    s_add_u32 m0, s60, 49152
    s_add_u32 s99, s16, s62
    buffer_load_dwordx4 v244, s[32:35], s99 offen offset:0  lds
    buffer_load_dwordx4 v245, s[32:35], s99 offen offset:1024  lds
    buffer_load_dwordx4 v246, s[32:35], s99 offen offset:2048  lds
    s_add_u32 m0, s61, 61440
    s_add_u32 s16, s16, s63
    buffer_load_dwordx4 v244, s[32:35], s16 offen offset:0  lds
    buffer_load_dwordx4 v245, s[32:35], s16 offen offset:1024  lds
    buffer_load_dwordx4 v246, s[32:35], s16 offen offset:2048  lds
    s_add_u32 s97, s98, s0
    s_lshr_b64 s[0:1], s[0:1], 4
    s_and_b32 s97, s97, 15
    s_add_u32 m0, s87, 0
    s_lshl_b32 s97, s97, 7
    buffer_load_dwordx4 v240, s[28:31], s97 offen offset:0  lds
    buffer_load_dwordx4 v241, s[28:31], s97 offen offset:1024  lds
    buffer_load_dwordx4 v242, s[28:31], s97 offen offset:2048  lds
    buffer_load_dwordx4 v243, s[28:31], s97 offen offset:3072  lds
    s_add_u32 m0, s88, 0
    s_mov_b64 exec, 0xffffffff
    buffer_load_dwordx4 v3, s[28:31], s97 offen offset:0  lds
    s_mov_b64 exec, -1
    s_waitcnt vmcnt(11)
    s_barrier
    s_mul_i32 s16, s97, 3072
    s_add_u32 m0, s60, 0
    s_add_u32 s99, s16, s62
    buffer_load_dwordx4 v244, s[32:35], s99 offen offset:0  lds
    ds_read_b128 v[84:87], v35 offset:0
    ds_read_b128 v[88:91], v35 offset:16
    buffer_load_dwordx4 v245, s[32:35], s99 offen offset:1024  lds
    ds_read_b64 v[40:41], v16 offset:0
    ds_read_b64 v[42:43], v231 offset:256
    buffer_load_dwordx4 v246, s[32:35], s99 offen offset:2048  lds
    ds_read_b64 v[44:45], v16 offset:256
    ds_read_b64 v[46:47], v16 offset:512
    s_add_u32 m0, s61, 12288
    s_add_u32 s16, s16, s63
    buffer_load_dwordx4 v244, s[32:35], s16 offen offset:0  lds
    ds_read_b64 v[48:49], v231 offset:512
    ds_read_b64 v[50:51], v16 offset:768
    buffer_load_dwordx4 v245, s[32:35], s16 offen offset:1024  lds
    ds_read_b64 v[52:53], v231 offset:768
    ds_read_b64 v[54:55], v16 offset:1024
    buffer_load_dwordx4 v246, s[32:35], s16 offen offset:2048  lds
    ds_read_b64 v[56:57], v231 offset:1024
    ds_read_b64 v[58:59], v16 offset:1280
    s_add_u32 s97, s98, s0
    s_lshr_b64 s[0:1], s[0:1], 4
    s_and_b32 s97, s97, 15
    s_add_u32 m0, s87, 18432
    s_lshl_b32 s97, s97, 7
    buffer_load_dwordx4 v240, s[28:31], s97 offen offset:0  lds
    ds_read_b64 v[60:61], v231 offset:1280
    ds_read_b64 v[68:69], v16 offset:16896
    buffer_load_dwordx4 v241, s[28:31], s97 offen offset:1024  lds
    ds_read_b64 v[70:71], v231 offset:16896
    ds_read_b64 v[72:73], v16 offset:17152
    buffer_load_dwordx4 v242, s[28:31], s97 offen offset:2048  lds
    ds_read_b64 v[74:75], v231 offset:17152
    ds_read_b64 v[76:77], v16 offset:17408
    buffer_load_dwordx4 v243, s[28:31], s97 offen offset:3072  lds
    ds_read_b64 v[78:79], v231 offset:17408
    ds_read_b64 v[80:81], v16 offset:17664
    s_add_u32 m0, s88, 18432
    s_mov_b64 exec, 0xffffffff
    buffer_load_dwordx4 v3, s[28:31], s97 offen offset:0  lds
    s_mov_b64 exec, -1
    ds_read_b64 v[82:83], v231 offset:17664
    s_waitcnt vmcnt(11)
    s_waitcnt lgkmcnt(0)
    s_barrier
    s_mul_i32 s16, s97, 3072
    s_add_u32 m0, s60, 24576
    s_add_u32 s99, s16, s62
    buffer_load_dwordx4 v244, s[32:35], s99 offen offset:0  lds
    v_lshlrev_b32 v160, 16, v40
    v_lshlrev_b32 v161, 16, v42
    v_lshlrev_b32 v162, 16, v44
    v_lshlrev_b32 v163, 16, v46
    v_lshlrev_b32 v164, 16, v48
    buffer_load_dwordx4 v245, s[32:35], s99 offen offset:1024  lds
    v_lshlrev_b32 v165, 16, v50
    v_lshlrev_b32 v166, 16, v52
    v_lshlrev_b32 v167, 16, v54
    v_lshlrev_b32 v168, 16, v56
    v_lshlrev_b32 v169, 16, v58
    buffer_load_dwordx4 v246, s[32:35], s99 offen offset:2048  lds
    v_lshlrev_b32 v170, 16, v60
    v_lshlrev_b32 v172, 16, v84
    v_and_b32 v173, 0xffff0000, v84
    v_lshlrev_b32 v174, 16, v85
    v_and_b32 v175, 0xffff0000, v85
    s_add_u32 m0, s61, 36864
    s_add_u32 s16, s16, s63
    buffer_load_dwordx4 v244, s[32:35], s16 offen offset:0  lds
    v_lshlrev_b32 v176, 16, v68
    v_lshlrev_b32 v177, 16, v70
    v_lshlrev_b32 v178, 16, v72
    v_lshlrev_b32 v179, 16, v74
    v_lshlrev_b32 v180, 16, v76
    buffer_load_dwordx4 v245, s[32:35], s16 offen offset:1024  lds
    v_lshlrev_b32 v181, 16, v78
    v_lshlrev_b32 v182, 16, v80
    v_lshlrev_b32 v183, 16, v82
    v_mul_f32 v184, v160, v175
    v_mul_f32 v185, v161, v175
    buffer_load_dwordx4 v246, s[32:35], s16 offen offset:2048  lds
    v_mul_f32 v186, v162, v175
    v_mul_f32 v187, v163, v175
    v_mul_f32 v188, v164, v175
    v_mul_f32 v189, v165, v175
    v_mul_f32 v190, v166, v175
    s_add_u32 s97, s98, s0
    s_lshr_b64 s[0:1], s[0:1], 4
    s_and_b32 s97, s97, 15
    s_add_u32 m0, s87, 36864
    s_lshl_b32 s97, s97, 7
    buffer_load_dwordx4 v240, s[28:31], s97 offen offset:0  lds
    v_mul_f32 v191, v167, v175
    v_fmac_f32 v184, v161, v174
    v_fmac_f32 v185, v162, v174
    v_fmac_f32 v186, v163, v174
    v_fmac_f32 v187, v164, v174
    buffer_load_dwordx4 v241, s[28:31], s97 offen offset:1024  lds
    v_fmac_f32 v188, v165, v174
    v_fmac_f32 v189, v166, v174
    v_fmac_f32 v190, v167, v174
    v_fmac_f32 v191, v168, v174
    v_fmac_f32 v184, v162, v173
    buffer_load_dwordx4 v242, s[28:31], s97 offen offset:2048  lds
    v_fmac_f32 v185, v163, v173
    v_fmac_f32 v186, v164, v173
    v_fmac_f32 v187, v165, v173
    v_fmac_f32 v188, v166, v173
    v_fmac_f32 v189, v167, v173
    buffer_load_dwordx4 v243, s[28:31], s97 offen offset:3072  lds
    v_fmac_f32 v190, v168, v173
    v_fmac_f32 v191, v169, v173
    v_fmac_f32 v184, v163, v172
    v_fmac_f32 v185, v164, v172
    v_fmac_f32 v186, v165, v172
    s_add_u32 m0, s88, 36864
    s_mov_b64 exec, 0xffffffff
    buffer_load_dwordx4 v3, s[28:31], s97 offen offset:0  lds
    s_mov_b64 exec, -1
    v_fmac_f32 v187, v166, v172
    v_fmac_f32 v188, v167, v172
    v_fmac_f32 v189, v168, v172
    v_fmac_f32 v190, v169, v172
    v_fmac_f32 v191, v170, v172
    v_mul_f32 v184, v184, v176
    v_mul_f32 v185, v185, v177
    v_mul_f32 v186, v186, v178
    v_mul_f32 v187, v187, v179
    v_mul_f32 v188, v188, v180
    v_mul_f32 v189, v189, v181
    v_mul_f32 v190, v190, v182
    v_mul_f32 v191, v191, v183
    v_cvt_pk_bf16_f32 v100, v191, v190
    v_cvt_pk_bf16_f32 v101, v189, v188
    v_cvt_pk_bf16_f32 v102, v187, v186
    v_cvt_pk_bf16_f32 v103, v185, v184
    s_mov_b32 s89, 0
    buffer_store_dwordx4 v[100:103], v12, s[52:55], s89 offen sc1
    v_and_b32 v160, 0xffff0000, v40
    v_and_b32 v161, 0xffff0000, v42
    v_and_b32 v162, 0xffff0000, v44
    v_and_b32 v163, 0xffff0000, v46
    v_and_b32 v164, 0xffff0000, v48
    v_and_b32 v165, 0xffff0000, v50
    v_and_b32 v166, 0xffff0000, v52
    v_and_b32 v167, 0xffff0000, v54
    v_and_b32 v168, 0xffff0000, v56
    v_and_b32 v169, 0xffff0000, v58
    v_and_b32 v170, 0xffff0000, v60
    v_lshlrev_b32 v172, 16, v86
    v_and_b32 v173, 0xffff0000, v86
    v_lshlrev_b32 v174, 16, v87
    v_and_b32 v175, 0xffff0000, v87
    v_and_b32 v176, 0xffff0000, v68
    v_and_b32 v177, 0xffff0000, v70
    v_and_b32 v178, 0xffff0000, v72
    v_and_b32 v179, 0xffff0000, v74
    v_and_b32 v180, 0xffff0000, v76
    v_and_b32 v181, 0xffff0000, v78
    v_and_b32 v182, 0xffff0000, v80
    v_and_b32 v183, 0xffff0000, v82
    s_waitcnt vmcnt(12)
    s_barrier
    s_mul_i32 s16, s97, 3072
    s_add_u32 m0, s60, 49152
    s_add_u32 s99, s16, s62
    buffer_load_dwordx4 v244, s[32:35], s99 offen offset:0  lds
    v_mul_f32 v184, v160, v175
    v_mul_f32 v185, v161, v175
    v_mul_f32 v186, v162, v175
    v_mul_f32 v187, v163, v175
    v_mul_f32 v188, v164, v175
    buffer_load_dwordx4 v245, s[32:35], s99 offen offset:1024  lds
    v_mul_f32 v189, v165, v175
    v_mul_f32 v190, v166, v175
    v_mul_f32 v191, v167, v175
    v_fmac_f32 v184, v161, v174
    v_fmac_f32 v185, v162, v174
    buffer_load_dwordx4 v246, s[32:35], s99 offen offset:2048  lds
    v_fmac_f32 v186, v163, v174
    v_fmac_f32 v187, v164, v174
    v_fmac_f32 v188, v165, v174
    v_fmac_f32 v189, v166, v174
    v_fmac_f32 v190, v167, v174
    s_add_u32 m0, s61, 61440
    s_add_u32 s16, s16, s63
    buffer_load_dwordx4 v244, s[32:35], s16 offen offset:0  lds
    v_fmac_f32 v191, v168, v174
    v_fmac_f32 v184, v162, v173
    v_fmac_f32 v185, v163, v173
    v_fmac_f32 v186, v164, v173
    v_fmac_f32 v187, v165, v173
    buffer_load_dwordx4 v245, s[32:35], s16 offen offset:1024  lds
    v_fmac_f32 v188, v166, v173
    v_fmac_f32 v189, v167, v173
    v_fmac_f32 v190, v168, v173
    v_fmac_f32 v191, v169, v173
    v_fmac_f32 v184, v163, v172
    buffer_load_dwordx4 v246, s[32:35], s16 offen offset:2048  lds
    v_fmac_f32 v185, v164, v172
    v_fmac_f32 v186, v165, v172
    v_fmac_f32 v187, v166, v172
    v_fmac_f32 v188, v167, v172
    v_fmac_f32 v189, v168, v172
    s_add_u32 s97, s98, s0
    s_lshr_b64 s[0:1], s[0:1], 4
    s_and_b32 s97, s97, 15
    s_add_u32 m0, s87, 0
    s_lshl_b32 s97, s97, 7
    buffer_load_dwordx4 v240, s[28:31], s97 offen offset:0  lds
    v_fmac_f32 v190, v169, v172
    v_fmac_f32 v191, v170, v172
    v_mul_f32 v184, v184, v176
    v_mul_f32 v185, v185, v177
    v_mul_f32 v186, v186, v178
    buffer_load_dwordx4 v241, s[28:31], s97 offen offset:1024  lds
    v_mul_f32 v187, v187, v179
    v_mul_f32 v188, v188, v180
    v_mul_f32 v189, v189, v181
    v_mul_f32 v190, v190, v182
    v_mul_f32 v191, v191, v183
    buffer_load_dwordx4 v242, s[28:31], s97 offen offset:2048  lds
    v_cvt_pk_bf16_f32 v104, v191, v190
    v_cvt_pk_bf16_f32 v105, v189, v188
    v_cvt_pk_bf16_f32 v106, v187, v186
    v_cvt_pk_bf16_f32 v107, v185, v184
    s_mov_b32 s89, 16384
    buffer_store_dwordx4 v[104:107], v12, s[52:55], s89 offen sc1
    buffer_load_dwordx4 v243, s[28:31], s97 offen offset:3072  lds
    v_lshlrev_b32 v160, 16, v41
    v_lshlrev_b32 v161, 16, v43
    v_lshlrev_b32 v162, 16, v45
    v_lshlrev_b32 v163, 16, v47
    v_lshlrev_b32 v164, 16, v49
    s_add_u32 m0, s88, 0
    s_mov_b64 exec, 0xffffffff
    buffer_load_dwordx4 v3, s[28:31], s97 offen offset:0  lds
    s_mov_b64 exec, -1
    v_lshlrev_b32 v165, 16, v51
    v_lshlrev_b32 v166, 16, v53
    v_lshlrev_b32 v167, 16, v55
    v_lshlrev_b32 v168, 16, v57
    v_lshlrev_b32 v169, 16, v59
    v_lshlrev_b32 v170, 16, v61
    v_lshlrev_b32 v172, 16, v88
    v_and_b32 v173, 0xffff0000, v88
    v_lshlrev_b32 v174, 16, v89
    v_and_b32 v175, 0xffff0000, v89
    v_lshlrev_b32 v176, 16, v69
    v_lshlrev_b32 v177, 16, v71
    v_lshlrev_b32 v178, 16, v73
    v_lshlrev_b32 v179, 16, v75
    v_lshlrev_b32 v180, 16, v77
    v_lshlrev_b32 v181, 16, v79
    v_lshlrev_b32 v182, 16, v81
    v_lshlrev_b32 v183, 16, v83
    v_mul_f32 v184, v160, v175
    v_mul_f32 v185, v161, v175
    v_mul_f32 v186, v162, v175
    v_mul_f32 v187, v163, v175
    v_mul_f32 v188, v164, v175
    v_mul_f32 v189, v165, v175
    v_mul_f32 v190, v166, v175
    v_mul_f32 v191, v167, v175
    v_fmac_f32 v184, v161, v174
    v_fmac_f32 v185, v162, v174
    v_fmac_f32 v186, v163, v174
    v_fmac_f32 v187, v164, v174
    v_fmac_f32 v188, v165, v174
    v_fmac_f32 v189, v166, v174
    v_fmac_f32 v190, v167, v174
    v_fmac_f32 v191, v168, v174
    v_fmac_f32 v184, v162, v173
    v_fmac_f32 v185, v163, v173
    v_fmac_f32 v186, v164, v173
    v_fmac_f32 v187, v165, v173
    v_fmac_f32 v188, v166, v173
    v_fmac_f32 v189, v167, v173
    v_fmac_f32 v190, v168, v173
    s_waitcnt vmcnt(13)
    s_barrier
    s_mul_i32 s16, s97, 3072
    s_add_u32 m0, s60, 0
    s_add_u32 s99, s16, s62
    buffer_load_dwordx4 v244, s[32:35], s99 offen offset:0  lds
    v_fmac_f32 v191, v169, v173
    v_fmac_f32 v184, v163, v172
    v_fmac_f32 v185, v164, v172
    v_fmac_f32 v186, v165, v172
    v_fmac_f32 v187, v166, v172
    buffer_load_dwordx4 v245, s[32:35], s99 offen offset:1024  lds
    v_fmac_f32 v188, v167, v172
    v_fmac_f32 v189, v168, v172
    v_fmac_f32 v190, v169, v172
    v_fmac_f32 v191, v170, v172
    v_mul_f32 v184, v184, v176
    buffer_load_dwordx4 v246, s[32:35], s99 offen offset:2048  lds
    v_mul_f32 v185, v185, v177
    v_mul_f32 v186, v186, v178
    v_mul_f32 v187, v187, v179
    v_mul_f32 v188, v188, v180
    v_mul_f32 v189, v189, v181
    s_add_u32 m0, s61, 12288
    s_add_u32 s16, s16, s63
    buffer_load_dwordx4 v244, s[32:35], s16 offen offset:0  lds
    v_mul_f32 v190, v190, v182
    v_mul_f32 v191, v191, v183
    v_cvt_pk_bf16_f32 v108, v191, v190
    v_cvt_pk_bf16_f32 v109, v189, v188
    v_cvt_pk_bf16_f32 v110, v187, v186
    buffer_load_dwordx4 v245, s[32:35], s16 offen offset:1024  lds
    v_cvt_pk_bf16_f32 v111, v185, v184
    s_mov_b32 s89, 32768
    buffer_store_dwordx4 v[108:111], v12, s[52:55], s89 offen sc1
    v_and_b32 v160, 0xffff0000, v41
    v_and_b32 v161, 0xffff0000, v43
    v_and_b32 v162, 0xffff0000, v45
    buffer_load_dwordx4 v246, s[32:35], s16 offen offset:2048  lds
    v_and_b32 v163, 0xffff0000, v47
    v_and_b32 v164, 0xffff0000, v49
    v_and_b32 v165, 0xffff0000, v51
    v_and_b32 v166, 0xffff0000, v53
    v_and_b32 v167, 0xffff0000, v55
    s_add_u32 s97, s98, s0
    s_lshr_b64 s[0:1], s[0:1], 4
    s_and_b32 s97, s97, 15
    s_add_u32 m0, s87, 18432
    s_lshl_b32 s97, s97, 7
    buffer_load_dwordx4 v240, s[28:31], s97 offen offset:0  lds
    v_and_b32 v168, 0xffff0000, v57
    v_and_b32 v169, 0xffff0000, v59
    v_and_b32 v170, 0xffff0000, v61
    v_lshlrev_b32 v172, 16, v90
    v_and_b32 v173, 0xffff0000, v90
    buffer_load_dwordx4 v241, s[28:31], s97 offen offset:1024  lds
    v_lshlrev_b32 v174, 16, v91
    v_and_b32 v175, 0xffff0000, v91
    v_and_b32 v176, 0xffff0000, v69
    v_and_b32 v177, 0xffff0000, v71
    v_and_b32 v178, 0xffff0000, v73
    buffer_load_dwordx4 v242, s[28:31], s97 offen offset:2048  lds
    v_and_b32 v179, 0xffff0000, v75
    v_and_b32 v180, 0xffff0000, v77
    v_and_b32 v181, 0xffff0000, v79
    v_and_b32 v182, 0xffff0000, v81
    v_and_b32 v183, 0xffff0000, v83
    buffer_load_dwordx4 v243, s[28:31], s97 offen offset:3072  lds
    v_mul_f32 v184, v160, v175
    v_mul_f32 v185, v161, v175
    v_mul_f32 v186, v162, v175
    v_mul_f32 v187, v163, v175
    v_mul_f32 v188, v164, v175
    s_add_u32 m0, s88, 18432
    s_mov_b64 exec, 0xffffffff
    buffer_load_dwordx4 v3, s[28:31], s97 offen offset:0  lds
    s_mov_b64 exec, -1
    v_mul_f32 v189, v165, v175
    v_mul_f32 v190, v166, v175
    v_mul_f32 v191, v167, v175
    v_fmac_f32 v184, v161, v174
    v_fmac_f32 v185, v162, v174
    v_fmac_f32 v186, v163, v174
    v_fmac_f32 v187, v164, v174
    v_fmac_f32 v188, v165, v174
    v_fmac_f32 v189, v166, v174
    v_fmac_f32 v190, v167, v174
    v_fmac_f32 v191, v168, v174
    v_fmac_f32 v184, v162, v173
    v_fmac_f32 v185, v163, v173
    v_fmac_f32 v186, v164, v173
    v_fmac_f32 v187, v165, v173
    v_fmac_f32 v188, v166, v173
    v_fmac_f32 v189, v167, v173
    v_fmac_f32 v190, v168, v173
    v_fmac_f32 v191, v169, v173
    v_fmac_f32 v184, v163, v172
    v_fmac_f32 v185, v164, v172
    v_fmac_f32 v186, v165, v172
    v_fmac_f32 v187, v166, v172
    v_fmac_f32 v188, v167, v172
    v_fmac_f32 v189, v168, v172
    v_fmac_f32 v190, v169, v172
    v_fmac_f32 v191, v170, v172
    v_mul_f32 v184, v184, v176
    v_mul_f32 v185, v185, v177
    v_mul_f32 v186, v186, v178
    v_mul_f32 v187, v187, v179
    v_mul_f32 v188, v188, v180
    v_mul_f32 v189, v189, v181
    v_mul_f32 v190, v190, v182
    v_mul_f32 v191, v191, v183
    v_cvt_pk_bf16_f32 v112, v191, v190
    v_cvt_pk_bf16_f32 v113, v189, v188
    v_cvt_pk_bf16_f32 v114, v187, v186
    v_cvt_pk_bf16_f32 v115, v185, v184
    s_mov_b32 s89, 49152
    buffer_store_dwordx4 v[112:115], v12, s[52:55], s89 offen sc1
    s_waitcnt vmcnt(13)
    s_barrier
    s_mul_i32 s16, s97, 3072
    s_add_u32 m0, s60, 24576
    s_add_u32 s99, s16, s62
    buffer_load_dwordx4 v244, s[32:35], s99 offen offset:0  lds
    buffer_load_dwordx4 v245, s[32:35], s99 offen offset:1024  lds
    buffer_load_dwordx4 v246, s[32:35], s99 offen offset:2048  lds
    s_add_u32 m0, s61, 36864
    s_add_u32 s16, s16, s63
    buffer_load_dwordx4 v244, s[32:35], s16 offen offset:0  lds
    buffer_load_dwordx4 v245, s[32:35], s16 offen offset:1024  lds
    buffer_load_dwordx4 v246, s[32:35], s16 offen offset:2048  lds
    s_add_u32 s97, s98, s0
    s_lshr_b64 s[0:1], s[0:1], 4
    s_and_b32 s97, s97, 15
    s_add_u32 m0, s87, 36864
    s_lshl_b32 s97, s97, 7
    buffer_load_dwordx4 v240, s[28:31], s97 offen offset:0  lds
    buffer_load_dwordx4 v241, s[28:31], s97 offen offset:1024  lds
    buffer_load_dwordx4 v242, s[28:31], s97 offen offset:2048  lds
    buffer_load_dwordx4 v243, s[28:31], s97 offen offset:3072  lds
    s_add_u32 m0, s88, 36864
    s_mov_b64 exec, 0xffffffff
    buffer_load_dwordx4 v3, s[28:31], s97 offen offset:0  lds
    s_mov_b64 exec, -1
    s_waitcnt vmcnt(12)
    s_waitcnt vmcnt(11)
    s_barrier
    s_mul_i32 s16, s97, 3072
    s_add_u32 m0, s60, 49152
    s_add_u32 s99, s16, s62
    buffer_load_dwordx4 v244, s[32:35], s99 offen offset:0  lds
    s_mov_b32 s68, s24
    s_mov_b32 s69, s25
    s_mov_b32 s70, 0x100
    s_mov_b32 s71, 0x20000
    v_lshrrev_b32 v6, 5, v0
    buffer_load_dwordx4 v245, s[32:35], s99 offen offset:1024  lds
    v_and_b32 v7, 3, v0
    s_lshr_b32 s78, s90, 1
    s_lshl_b32 s78, s78, 2
    s_load_dword s92, s[14:15], s78
    v_bfe_u32 v5, v0, 2, 2
    buffer_load_dwordx4 v246, s[32:35], s99 offen offset:2048  lds
    v_lshlrev_b32 v5, 1, v5
    v_lshl_add_u32 v5, v6, 3, v5
    v_bfe_u32 v8, v0, 4, 1
    v_add_u32 v5, v5, v8
    s_and_b32 s78, s3, 1
    s_add_u32 m0, s61, 61440
    s_add_u32 s16, s16, s63
    buffer_load_dwordx4 v244, s[32:35], s16 offen offset:0  lds
    s_lshl_b32 s78, s78, 1
    v_add_u32 v8, s78, v6
    v_xor_b32 v8, v8, v7
    v_lshlrev_b32 v8, 4, v8
    buffer_load_dwordx4 v245, s[32:35], s16 offen offset:1024  lds
    v_lshl_add_u32 v5, v5, 6, v8
    v_add_u32 v14, s86, v5
    v_mov_b32 v18, 162304
    v_mov_b32 v19, 1
    v_and_b32 v5, 3, v0
    buffer_load_dwordx4 v246, s[32:35], s16 offen offset:2048  lds
    s_lshl_b32 s78, s74, 4
    s_add_u32 s78, s78, s3
    v_lshl_add_u32 v6, v5, 2, s78
    s_lshr_b32 s78, s76, 3
    s_lshl_b32 s79, s3, 1
    s_add_u32 s97, s98, s0
    s_lshr_b64 s[0:1], s[0:1], 4
    s_and_b32 s97, s97, 15
    s_add_u32 m0, s87, 0
    s_lshl_b32 s97, s97, 7
    buffer_load_dwordx4 v240, s[28:31], s97 offen offset:0  lds
    s_add_u32 s78, s78, s79
    s_xor_b32 s78, s78, 2
    s_lshl_b32 s78, s78, 5
    s_add_u32 s79, s76, 5
    s_and_b32 s79, s79, 7
    buffer_load_dwordx4 v241, s[28:31], s97 offen offset:1024  lds
    s_lshl_b32 s79, s79, 1
    s_add_u32 s78, s78, s79
    v_mul_u32_u24 v7, 9, v5
    v_and_b32 v7, 17, v7
    buffer_load_dwordx4 v242, s[28:31], s97 offen offset:2048  lds
    v_add_u32 v7, s78, v7
    v_and_b32 v8, 4, v0
    v_cmp_eq_u32 vcc, 0, v8
    s_nop 1
    v_cndmask_b32 v6, v7, v6, vcc
    v_and_b32 v33, 0xf0, v6
    buffer_load_dwordx4 v243, s[28:31], s97 offen offset:3072  lds
    v_lshlrev_b32 v34, 8, v6
    v_add_u32 v34, 12582912, v34
    v_and_b32 v5, 15, v0
    v_lshrrev_b32 v6, 4, v0
    v_add_u32 v7, 9, v5
    s_add_u32 m0, s88, 0
    s_mov_b64 exec, 0xffffffff
    buffer_load_dwordx4 v3, s[28:31], s97 offen offset:0  lds
    s_mov_b64 exec, -1
    v_and_b32 v8, 1, v7
    v_mul_u32_u24 v8, 4160, v8
    v_lshrrev_b32 v7, 1, v7
    v_lshl_add_u32 v8, v7, 2, v8
    s_waitcnt vmcnt(11)
    s_barrier
    s_mul_i32 s16, s97, 3072
    s_add_u32 m0, s60, 0
    s_add_u32 s99, s16, s62
    buffer_load_dwordx4 v244, s[32:35], s99 offen offset:0  lds
    v_lshlrev_b32 v7, 4, v6
    v_sub_u32 v8, v8, v7
    s_add_u32 s78, s94, 32
    v_add_u32 v21, s78, v8
    buffer_load_dwordx4 v245, s[32:35], s99 offen offset:1024  lds
    v_add_u32 v22, 1024, v21
    v_add_u32 v23, 2048, v21
    v_add_u32 v24, 3072, v21
    buffer_load_dwordx4 v246, s[32:35], s99 offen offset:2048  lds
    v_lshl_add_u32 v7, v5, 1, v6
    v_add_u32 v7, 30, v7
    v_and_b32 v8, 1, v7
    v_bfe_u32 v136, v7, 1, 2
    s_add_u32 m0, s61, 12288
    s_add_u32 s16, s16, s63
    buffer_load_dwordx4 v244, s[32:35], s16 offen offset:0  lds
    v_lshl_add_u32 v136, v8, 2, v136
    v_lshlrev_b32 v136, 6, v136
    v_lshrrev_b32 v7, 3, v7
    buffer_load_dwordx4 v245, s[32:35], s16 offen offset:1024  lds
    v_lshl_add_u32 v136, v7, 9, v136
    v_bitop3_b32 v8, v7, 3, s3 bitop3:0x6a
    v_lshl_add_u32 v25, v8, 4, v136
    v_add_u32 v25, 92160, v25
    buffer_load_dwordx4 v246, s[32:35], s16 offen offset:2048  lds
    v_subrev_u32 v7, 1, v7
    v_bitop3_b32 v8, v7, 3, s3 bitop3:0x6a
    v_lshl_add_u32 v27, v8, 4, v136
    s_add_u32 m0, s94, 32
    s_lshl_b32 s89, s90, 12
    buffer_load_dwordx4 v15, s[48:51], s89 offen offset:0 nt lds
    v_add_u32 v27, 91648, v27
    v_subrev_u32 v7, 1, v7
    v_bitop3_b32 v8, v7, 3, s3 bitop3:0x6a
    v_lshl_add_u32 v29, v8, 4, v136
    s_add_u32 m0, s94, 32
    s_lshl_b32 s89, s90, 12
    buffer_load_dwordx4 v15, s[48:51], s89 offen offset:1024 nt lds
    v_add_u32 v29, 91136, v29
    v_subrev_u32 v7, 1, v7
    v_bitop3_b32 v8, v7, 3, s3 bitop3:0x6a
    s_add_u32 m0, s94, 32
    s_lshl_b32 s89, s90, 12
    buffer_load_dwordx4 v15, s[48:51], s89 offen offset:2048 nt lds
    v_lshl_add_u32 v31, v8, 4, v136
    v_add_u32 v31, 90624, v31
    v_lshl_add_u32 v7, v5, 1, v6
    v_add_u32 v7, 26, v7
    s_add_u32 m0, s94, 32
    s_lshl_b32 s89, s90, 12
    buffer_load_dwordx4 v15, s[48:51], s89 offen offset:3072 nt lds
    v_and_b32 v8, 1, v7
    v_bfe_u32 v136, v7, 1, 2
    v_lshl_add_u32 v136, v8, 2, v136
    s_add_u32 s97, s98, s0
    s_lshr_b64 s[0:1], s[0:1], 4
    s_and_b32 s97, s97, 15
    s_add_u32 m0, s87, 18432
    s_lshl_b32 s97, s97, 7
    buffer_load_dwordx4 v240, s[28:31], s97 offen offset:0  lds
    v_lshlrev_b32 v136, 6, v136
    v_lshrrev_b32 v7, 3, v7
    v_lshl_add_u32 v136, v7, 9, v136
    v_bitop3_b32 v8, v7, 3, s3 bitop3:0x6a
    buffer_load_dwordx4 v241, s[28:31], s97 offen offset:1024  lds
    v_lshl_add_u32 v26, v8, 4, v136
    v_add_u32 v26, 92160, v26
    v_subrev_u32 v7, 1, v7
    buffer_load_dwordx4 v242, s[28:31], s97 offen offset:2048  lds
    v_bitop3_b32 v8, v7, 3, s3 bitop3:0x6a
    v_lshl_add_u32 v28, v8, 4, v136
    v_add_u32 v28, 91648, v28
    v_subrev_u32 v7, 1, v7
    buffer_load_dwordx4 v243, s[28:31], s97 offen offset:3072  lds
    v_bitop3_b32 v8, v7, 3, s3 bitop3:0x6a
    v_lshl_add_u32 v30, v8, 4, v136
    v_add_u32 v30, 91136, v30
    s_add_u32 m0, s88, 18432
    s_mov_b64 exec, 0xffffffff
    buffer_load_dwordx4 v3, s[28:31], s97 offen offset:0  lds
    s_mov_b64 exec, -1
    v_subrev_u32 v7, 1, v7
    v_bitop3_b32 v8, v7, 3, s3 bitop3:0x6a
    v_lshl_add_u32 v32, v8, 4, v136
    s_waitcnt vmcnt(15)
    s_barrier
    s_mul_i32 s16, s97, 3072
    s_add_u32 m0, s60, 24576
    s_add_u32 s99, s16, s62
    buffer_load_dwordx4 v244, s[32:35], s99 offen offset:0  lds
    v_add_u32 v32, 90624, v32
    v_lshrrev_b32 v7, 1, v6
    v_lshl_add_u32 v7, v5, 1, v7
    v_add_u32 v7, 32, v7
    v_and_b32 v8, 1, v7
    buffer_load_dwordx4 v245, s[32:35], s99 offen offset:1024  lds
    v_bfe_u32 v136, v7, 1, 2
    v_lshl_add_u32 v136, v8, 2, v136
    v_lshlrev_b32 v136, 6, v136
    v_lshrrev_b32 v7, 3, v7
    buffer_load_dwordx4 v246, s[32:35], s99 offen offset:2048  lds
    v_lshl_add_u32 v136, v7, 9, v136
    v_bitop3_b32 v8, v7, 3, s3 bitop3:0x6a
    v_lshl_add_u32 v20, v8, 4, v136
    v_add_u32 v20, 92160, v20
    v_and_b32 v8, 1, v6
    s_add_u32 m0, s61, 36864
    s_add_u32 s16, s16, s63
    buffer_load_dwordx4 v244, s[32:35], s16 offen offset:0  lds
    v_xor_b32 v8, 1, v8
    v_lshl_add_u32 v20, v8, 3, v20
    s_waitcnt lgkmcnt(0)
    s_and_b32 s78, s92, 0xffff0000
    buffer_load_dwordx4 v245, s[32:35], s16 offen offset:1024  lds
    s_lshl_b32 s92, s92, 16
    s_bitcmp1_b32 s90, 0
    s_cselect_b32 s92, s78, s92
    v_lshlrev_b32 v7, 3, v6
    v_sub_u32 v7, v7, v5
    buffer_load_dwordx4 v246, s[32:35], s16 offen offset:2048  lds
    v_subrev_u32 v7, 9, v7
    v_and_b32 v8, 1, v7
    v_xor_b32 v8, 1, v8
    v_lshlrev_b32 v8, 4, v8
    v_lshrrev_b32 v8, v8, s92
    s_add_u32 s97, s98, s0
    s_lshr_b64 s[0:1], s[0:1], 4
    s_and_b32 s97, s97, 15
    s_add_u32 m0, s87, 36864
    s_lshl_b32 s97, s97, 7
    buffer_load_dwordx4 v240, s[28:31], s97 offen offset:0  lds
    v_ashrrev_i32 v7, 1, v7
    v_cmp_eq_u32 vcc, 0, v7
    s_nop 1
    v_cndmask_b32 v236, 0, v8, vcc
    v_cmp_eq_u32 vcc, 1, v7
    buffer_load_dwordx4 v241, s[28:31], s97 offen offset:1024  lds
    s_nop 0
    v_cndmask_b32 v237, 0, v8, vcc
    v_cmp_eq_u32 vcc, 2, v7
    s_nop 1
    v_cndmask_b32 v238, 0, v8, vcc
    v_cmp_eq_u32 vcc, 3, v7
    buffer_load_dwordx4 v242, s[28:31], s97 offen offset:2048  lds
    s_nop 0
    v_cndmask_b32 v239, 0, v8, vcc
    s_and_b32 s78, s77, 7
    s_mov_b32 s95, 0x76543210
    s_cmp_eq_u32 s78, 1
    s_cselect_b32 s95, 0x76543201, s95
    s_cmp_eq_u32 s78, 2
    s_cselect_b32 s95, 0x76543120, s95
    s_cmp_eq_u32 s78, 3
    s_cselect_b32 s95, 0x76542310, s95
    s_cmp_eq_u32 s78, 4
    s_cselect_b32 s95, 0x76534210, s95
    s_cmp_eq_u32 s78, 5
    s_cselect_b32 s95, 0x76453210, s95
    s_cmp_eq_u32 s78, 6
    s_cselect_b32 s95, 0x75643210, s95
    s_cmp_eq_u32 s78, 7
    s_cselect_b32 s95, 0x67543210, s95
    s_and_b32 s78, s76, 3
    s_mul_i32 s78, s78, 0x22222222
    s_add_u32 s95, s95, s78
    s_bfe_u32 s100, s95, 0x3001c
    s_lshl_b32 s100, s100, 18
    s_bfe_u32 s95, s95, 0x30018
    s_lshl_b32 s95, s95, 18
    v_lshrrev_b32 v136, 4, v0
    v_lshlrev_b32 v136, 1, v136
    v_and_b32 v137, 7, v0
    buffer_load_dwordx4 v243, s[28:31], s97 offen offset:3072  lds
    v_xor_b32 v136, v136, v137
    v_lshlrev_b32 v136, 4, v136
    v_lshrrev_b32 v137, 3, v0
    v_lshl_add_u32 v136, v137, 11, v136
    s_add_u32 m0, s88, 36864
    s_mov_b64 exec, 0xffffffff
    buffer_load_dwordx4 v3, s[28:31], s97 offen offset:0  lds
    s_mov_b64 exec, -1
    s_lshl_b32 s78, s77, 7
    s_lshl_b32 s79, s3, 14
    s_add_u32 s78, s78, s79
    v_add_u32 v17, s78, v136
    s_waitcnt vmcnt(11)
    s_barrier
    s_mul_i32 s16, s97, 3072
    s_add_u32 m0, s60, 49152
    s_add_u32 s99, s16, s62
    buffer_load_dwordx4 v244, s[32:35], s99 offen offset:0  lds
    v_add_u32 v5, s94, v15
    ds_read_b128 v[140:143], v5 offset:32
    ds_read_b32 v156, v5 offset:48
    ds_read_b128 v[144:147], v5 offset:1056
    buffer_load_dwordx4 v245, s[32:35], s99 offen offset:1024  lds
    ds_read_b32 v157, v5 offset:1072
    ds_read_b128 v[148:151], v5 offset:2080
    ds_read_b32 v158, v5 offset:2096
    ds_read_b128 v[152:155], v5 offset:3104
    buffer_load_dwordx4 v246, s[32:35], s99 offen offset:2048  lds
    ds_read_b32 v159, v5 offset:3120
    v_lshrrev_b32 v6, 3, v0
    v_mul_u32_u24 v6, 4160, v6
    s_add_u32 m0, s61, 61440
    s_add_u32 s16, s16, s63
    buffer_load_dwordx4 v244, s[32:35], s16 offen offset:0  lds
    v_and_b32 v7, 7, v0
    v_lshl_add_u32 v6, v7, 2, v6
    v_add_u32 v6, s94, v6
    v_mov_b32 v7, 0
    buffer_load_dwordx4 v245, s[32:35], s16 offen offset:1024  lds
    s_waitcnt lgkmcnt(0)
    v_readfirstlane_b32 s93, v140
    s_nop 0
    s_lshl_b32 s93, s93, 16
    s_nop 1
    v_writelane_b32 v7, s93, 15
    buffer_load_dwordx4 v246, s[32:35], s16 offen offset:2048  lds
    v_alignbit_b32 v140, v141, v140, 16
    v_alignbit_b32 v141, v142, v141, 16
    v_alignbit_b32 v142, v143, v142, 16
    s_add_u32 s97, s98, s0
    s_lshr_b64 s[0:1], s[0:1], 4
    s_and_b32 s97, s97, 15
    s_add_u32 m0, s87, 0
    s_lshl_b32 s97, s97, 7
    buffer_load_dwordx4 v240, s[28:31], s97 offen offset:0  lds
    v_alignbit_b32 v143, v156, v143, 16
    v_alignbit_b32 v144, v145, v144, 16
    v_alignbit_b32 v145, v146, v145, 16
    v_alignbit_b32 v146, v147, v146, 16
    buffer_load_dwordx4 v241, s[28:31], s97 offen offset:1024  lds
    v_alignbit_b32 v147, v157, v147, 16
    v_alignbit_b32 v148, v149, v148, 16
    v_alignbit_b32 v149, v150, v149, 16
    v_alignbit_b32 v150, v151, v150, 16
    buffer_load_dwordx4 v242, s[28:31], s97 offen offset:2048  lds
    v_alignbit_b32 v151, v158, v151, 16
    v_alignbit_b32 v152, v153, v152, 16
    v_alignbit_b32 v153, v154, v153, 16
    buffer_load_dwordx4 v243, s[28:31], s97 offen offset:3072  lds
    v_alignbit_b32 v154, v155, v154, 16
    v_alignbit_b32 v155, v159, v155, 16
    v_lshlrev_b32 v8, 3, v0
    s_add_u32 s78, s88, 18432
    s_add_u32 m0, s88, 0
    s_mov_b64 exec, 0xffffffff
    buffer_load_dwordx4 v3, s[28:31], s97 offen offset:0  lds
    s_mov_b64 exec, -1
    v_add_u32 v8, s78, v8
    v_mov_b32 v156, 0
    v_mov_b32 v157, 0
    s_waitcnt vmcnt(11)
    s_barrier
    s_mul_i32 s16, s97, 3072
    s_add_u32 m0, s60, 0
    s_add_u32 s99, s16, s62
    buffer_load_dwordx4 v244, s[32:35], s99 offen offset:0  lds
    buffer_load_dwordx4 v245, s[32:35], s99 offen offset:1024  lds
    buffer_load_dwordx4 v246, s[32:35], s99 offen offset:2048  lds
    s_add_u32 m0, s61, 12288
    s_add_u32 s16, s16, s63
    buffer_load_dwordx4 v244, s[32:35], s16 offen offset:0  lds
    buffer_load_dwordx4 v245, s[32:35], s16 offen offset:1024  lds
    buffer_load_dwordx4 v246, s[32:35], s16 offen offset:2048  lds
    s_mov_b64 exec, 0xff
    buffer_load_dword v136, v33, s[68:71], 0 offen sc1
    buffer_load_dword v137, v34, s[52:55], 0 offen sc1
    s_mov_b64 exec, -1
    buffer_load_dwordx4 v[212:215], v9, s[56:59], 0 offen offset:0 nt
    buffer_load_dwordx4 v[216:219], v9, s[56:59], 0 offen offset:2048 nt
    buffer_load_dwordx4 v[220:223], v9, s[56:59], s96 offen offset:0 nt
    buffer_load_dwordx4 v[224:227], v9, s[56:59], s96 offen offset:2048 nt
    s_waitcnt vmcnt(12)
    s_waitcnt vmcnt(6)
    s_barrier
    s_waitcnt vmcnt(4)
LA_j:
    s_mov_b64 exec, 0xff
    v_cmp_ne_u32 vcc, v136, v137
    v_cmp_gt_u32 s[80:81], s96, v136
    s_nop 0
    s_or_b64 vcc, vcc, s[80:81]
    s_cbranch_vccnz LA_slow
LA_back:
    s_mov_b64 exec, -1
    s_add_u32 m0, s86, 94208
    s_add_u32 s89, s91, 0
    buffer_load_dwordx4 v14, s[52:55], s89 offen sc1 lds
    s_add_u32 m0, s86, 98304
    s_add_u32 s89, s91, 4096
    buffer_load_dwordx4 v14, s[52:55], s89 offen sc1 lds
    s_add_u32 m0, s86, 102400
    s_add_u32 s89, s91, 8192
    buffer_load_dwordx4 v14, s[52:55], s89 offen sc1 lds
    s_add_u32 m0, s86, 106496
    s_add_u32 s89, s91, 12288
    buffer_load_dwordx4 v14, s[52:55], s89 offen sc1 lds
    s_add_u32 s89, s95, 131072
    buffer_load_dwordx4 v[228:231], v17, s[64:67], s89 offen
    s_add_u32 s89, s95, 196608
    buffer_load_dwordx4 v[232:235], v17, s[64:67], s89 offen
    s_add_u32 s89, s100, 0
    buffer_load_dwordx4 v[240:243], v17, s[64:67], s89 offen
    s_add_u32 s89, s100, 65536
    buffer_load_dwordx4 v[244:247], v17, s[64:67], s89 offen
    s_add_u32 s89, s100, 131072
    buffer_load_dwordx4 v[248:251], v17, s[64:67], s89 offen
    s_add_u32 s89, s100, 196608
    buffer_load_dwordx4 v[196:199], v17, s[64:67], s89 offen
    s_mov_b64 exec, 0xffff
    ds_write_b32 v6, v7
    s_mov_b64 exec, -1
    ds_write_b128 v5, v[140:143] offset:4192
    ds_write_b128 v5, v[144:147] offset:5216
    ds_write_b128 v5, v[148:151] offset:6240
    ds_write_b128 v5, v[152:155] offset:7264
    ds_write_b64 v8, v[156:157]
    ds_read2_b32 v[68:69], v21 offset0:0 offset1:1
    ds_read2_b32 v[70:71], v21 offset0:2 offset1:3
    ds_read2_b32 v[72:73], v21 offset0:128 offset1:129
    ds_read2_b32 v[74:75], v21 offset0:130 offset1:131
    ds_read2_b32 v[76:77], v22 offset0:0 offset1:1
    ds_read2_b32 v[78:79], v22 offset0:2 offset1:3
    ds_read2_b32 v[80:81], v22 offset0:128 offset1:129
    ds_read2_b32 v[82:83], v22 offset0:130 offset1:131
    ds_read2_b32 v[84:85], v23 offset0:0 offset1:1
    ds_read2_b32 v[86:87], v23 offset0:2 offset1:3
    ds_read2_b32 v[88:89], v23 offset0:128 offset1:129
    ds_read2_b32 v[90:91], v23 offset0:130 offset1:131
    ds_read2_b32 v[92:93], v24 offset0:0 offset1:1
    ds_read2_b32 v[94:95], v24 offset0:2 offset1:3
    ds_read2_b32 v[96:97], v24 offset0:128 offset1:129
    ds_read2_b32 v[98:99], v24 offset0:130 offset1:131
    s_waitcnt vmcnt(6)
    s_mov_b64 exec, 1
    ds_add_u32 v18, v19 offset:20
    s_mov_b64 exec, -1
    s_branch LA_s5_in
LA_s5:
    s_sleep 1
LA_s5_in:
    ds_read_b32 v6, v18 offset:20
    s_waitcnt lgkmcnt(0)
    v_readfirstlane_b32 s78, v6
    s_nop 0
    s_cmp_ge_u32 s78, 4
    s_cbranch_scc0 LA_s5
    s_mov_b64 exec, 1
    ds_add_u32 v18, v19 offset:8
    s_mov_b64 exec, -1
    ds_read_b128 v[100:103], v25 offset:0
    ds_read_b128 v[104:107], v25 offset:2048
    ds_read_b128 v[108:111], v25 offset:4096
    ds_read_b128 v[112:115], v25 offset:6144
    ds_read_b128 v[116:119], v25 offset:8192
    ds_read_b128 v[120:123], v25 offset:10240
    ds_read_b128 v[124:127], v25 offset:12288
    ds_read_b128 v[128:131], v25 offset:14336
    s_setprio 2
    s_waitcnt lgkmcnt(7)
    v_mfma_f32_16x16x32_bf16 v[36:39], v[236:239], v[100:103], 0
    ds_read2_b32 v[132:133], v21 offset0:16 offset1:17
    v_mfma_f32_16x16x32_bf16 v[36:39], v[68:71], v[100:103], v[36:39]
    ds_read2_b32 v[134:135], v21 offset0:18 offset1:19
    s_waitcnt lgkmcnt(8)
    v_mfma_f32_16x16x32_bf16 v[40:43], v[236:239], v[104:107], 0
    v_mfma_f32_16x16x32_bf16 v[40:43], v[68:71], v[104:107], v[40:43]
    ds_read_b128 v[164:167], v26 offset:0
    v_mfma_f32_16x16x32_bf16 v[40:43], v[72:75], v[100:103], v[40:43]
    s_waitcnt lgkmcnt(8)
    v_mfma_f32_16x16x32_bf16 v[44:47], v[236:239], v[108:111], 0
    ds_read2_b32 v[136:137], v21 offset0:144 offset1:145
    v_mfma_f32_16x16x32_bf16 v[44:47], v[68:71], v[108:111], v[44:47]
    ds_read2_b32 v[138:139], v21 offset0:146 offset1:147
    v_mfma_f32_16x16x32_bf16 v[44:47], v[72:75], v[104:107], v[44:47]
    v_mfma_f32_16x16x32_bf16 v[44:47], v[76:79], v[100:103], v[44:47]
    ds_read_b128 v[168:171], v26 offset:2048
    s_waitcnt lgkmcnt(10)
    v_mfma_f32_16x16x32_bf16 v[48:51], v[236:239], v[112:115], 0
    v_mfma_f32_16x16x32_bf16 v[48:51], v[68:71], v[112:115], v[48:51]
    ds_read2_b32 v[140:141], v22 offset0:16 offset1:17
    v_mfma_f32_16x16x32_bf16 v[48:51], v[72:75], v[108:111], v[48:51]
    ds_read2_b32 v[142:143], v22 offset0:18 offset1:19
    v_mfma_f32_16x16x32_bf16 v[48:51], v[76:79], v[104:107], v[48:51]
    v_mfma_f32_16x16x32_bf16 v[48:51], v[80:83], v[100:103], v[48:51]
    ds_read_b128 v[172:175], v26 offset:4096
    s_waitcnt lgkmcnt(12)
    v_mfma_f32_16x16x32_bf16 v[52:55], v[236:239], v[116:119], 0
    v_mfma_f32_16x16x32_bf16 v[52:55], v[68:71], v[116:119], v[52:55]
    ds_read2_b32 v[144:145], v22 offset0:144 offset1:145
    v_mfma_f32_16x16x32_bf16 v[52:55], v[72:75], v[112:115], v[52:55]
    ds_read2_b32 v[146:147], v22 offset0:146 offset1:147
    v_mfma_f32_16x16x32_bf16 v[52:55], v[76:79], v[108:111], v[52:55]
    v_mfma_f32_16x16x32_bf16 v[52:55], v[80:83], v[104:107], v[52:55]
    ds_read_b128 v[176:179], v26 offset:6144
    v_mfma_f32_16x16x32_bf16 v[52:55], v[84:87], v[100:103], v[52:55]
    s_waitcnt lgkmcnt(14)
    v_mfma_f32_16x16x32_bf16 v[56:59], v[236:239], v[120:123], 0
    ds_read2_b32 v[148:149], v23 offset0:16 offset1:17
    v_mfma_f32_16x16x32_bf16 v[56:59], v[68:71], v[120:123], v[56:59]
    ds_read2_b32 v[150:151], v23 offset0:18 offset1:19
    v_mfma_f32_16x16x32_bf16 v[56:59], v[72:75], v[116:119], v[56:59]
    v_mfma_f32_16x16x32_bf16 v[56:59], v[76:79], v[112:115], v[56:59]
    ds_read_b128 v[180:183], v26 offset:8192
    v_mfma_f32_16x16x32_bf16 v[56:59], v[80:83], v[108:111], v[56:59]
    v_mfma_f32_16x16x32_bf16 v[56:59], v[84:87], v[104:107], v[56:59]
    ds_read2_b32 v[152:153], v23 offset0:144 offset1:145
    v_mfma_f32_16x16x32_bf16 v[56:59], v[88:91], v[100:103], v[56:59]
    ds_read2_b32 v[154:155], v23 offset0:146 offset1:147
    s_waitcnt lgkmcnt(14)
    v_mfma_f32_16x16x32_bf16 v[60:63], v[236:239], v[124:127], 0
    v_mfma_f32_16x16x32_bf16 v[60:63], v[68:71], v[124:127], v[60:63]
    ds_read_b128 v[184:187], v26 offset:10240
    v_mfma_f32_16x16x32_bf16 v[60:63], v[72:75], v[120:123], v[60:63]
    v_mfma_f32_16x16x32_bf16 v[60:63], v[76:79], v[116:119], v[60:63]
    ds_read2_b32 v[156:157], v24 offset0:16 offset1:17
    v_mfma_f32_16x16x32_bf16 v[60:63], v[80:83], v[112:115], v[60:63]
    ds_read2_b32 v[158:159], v24 offset0:18 offset1:19
    v_mfma_f32_16x16x32_bf16 v[60:63], v[84:87], v[108:111], v[60:63]
    v_mfma_f32_16x16x32_bf16 v[60:63], v[88:91], v[104:107], v[60:63]
    ds_read_b128 v[188:191], v26 offset:12288
    v_mfma_f32_16x16x32_bf16 v[60:63], v[92:95], v[100:103], v[60:63]
    v_mfma_f32_16x16x32_bf16 v[64:67], v[236:239], v[128:131], 0
    ds_read2_b32 v[160:161], v24 offset0:144 offset1:145
    v_mfma_f32_16x16x32_bf16 v[64:67], v[68:71], v[128:131], v[64:67]
    ds_read2_b32 v[162:163], v24 offset0:146 offset1:147
    v_mfma_f32_16x16x32_bf16 v[64:67], v[72:75], v[124:127], v[64:67]
    v_mfma_f32_16x16x32_bf16 v[64:67], v[76:79], v[120:123], v[64:67]
    ds_read_b128 v[192:195], v26 offset:14336
    v_mfma_f32_16x16x32_bf16 v[64:67], v[80:83], v[116:119], v[64:67]
    v_mfma_f32_16x16x32_bf16 v[64:67], v[84:87], v[112:115], v[64:67]
    v_mfma_f32_16x16x32_bf16 v[64:67], v[88:91], v[108:111], v[64:67]
    v_mfma_f32_16x16x32_bf16 v[64:67], v[92:95], v[104:107], v[64:67]
    v_mfma_f32_16x16x32_bf16 v[64:67], v[96:99], v[100:103], v[64:67]
    v_mfma_f32_16x16x32_bf16 v[36:39], v[132:135], v[164:167], v[36:39]
    ds_read2_b32 v[68:69], v21 offset0:32 offset1:33
    s_waitcnt lgkmcnt(14)
    v_mfma_f32_16x16x32_bf16 v[40:43], v[136:139], v[164:167], v[40:43]
    ds_read2_b32 v[70:71], v21 offset0:34 offset1:35
    v_mfma_f32_16x16x32_bf16 v[40:43], v[132:135], v[168:171], v[40:43]
    ds_read_b128 v[100:103], v27 offset:0
    v_mfma_f32_16x16x32_bf16 v[44:47], v[132:135], v[172:175], v[44:47]
    v_mfma_f32_16x16x32_bf16 v[44:47], v[136:139], v[168:171], v[44:47]
    ds_read2_b32 v[72:73], v21 offset0:160 offset1:161
    v_mfma_f32_16x16x32_bf16 v[44:47], v[140:143], v[164:167], v[44:47]
    ds_read2_b32 v[74:75], v21 offset0:162 offset1:163
    v_mfma_f32_16x16x32_bf16 v[48:51], v[144:147], v[164:167], v[48:51]
    ds_read_b128 v[104:107], v27 offset:2048
    v_mfma_f32_16x16x32_bf16 v[48:51], v[140:143], v[168:171], v[48:51]
    v_mfma_f32_16x16x32_bf16 v[48:51], v[136:139], v[172:175], v[48:51]
    ds_read2_b32 v[76:77], v22 offset0:32 offset1:33
    s_waitcnt lgkmcnt(14)
    v_mfma_f32_16x16x32_bf16 v[48:51], v[132:135], v[176:179], v[48:51]
    ds_read2_b32 v[78:79], v22 offset0:34 offset1:35
    v_mfma_f32_16x16x32_bf16 v[52:55], v[132:135], v[180:183], v[52:55]
    ds_read_b128 v[108:111], v27 offset:4096
    v_mfma_f32_16x16x32_bf16 v[52:55], v[136:139], v[176:179], v[52:55]
    v_mfma_f32_16x16x32_bf16 v[52:55], v[140:143], v[172:175], v[52:55]
    ds_read2_b32 v[80:81], v22 offset0:160 offset1:161
    v_mfma_f32_16x16x32_bf16 v[52:55], v[144:147], v[168:171], v[52:55]
    ds_read2_b32 v[82:83], v22 offset0:162 offset1:163
    v_mfma_f32_16x16x32_bf16 v[52:55], v[148:151], v[164:167], v[52:55]
    ds_read_b128 v[112:115], v27 offset:6144
    v_mfma_f32_16x16x32_bf16 v[56:59], v[152:155], v[164:167], v[56:59]
    v_mfma_f32_16x16x32_bf16 v[56:59], v[148:151], v[168:171], v[56:59]
    ds_read2_b32 v[84:85], v23 offset0:32 offset1:33
    v_mfma_f32_16x16x32_bf16 v[56:59], v[144:147], v[172:175], v[56:59]
    ds_read2_b32 v[86:87], v23 offset0:34 offset1:35
    v_mfma_f32_16x16x32_bf16 v[56:59], v[140:143], v[176:179], v[56:59]
    ds_read_b128 v[116:119], v27 offset:8192
    v_mfma_f32_16x16x32_bf16 v[56:59], v[136:139], v[180:183], v[56:59]
    s_waitcnt lgkmcnt(14)
    v_mfma_f32_16x16x32_bf16 v[56:59], v[132:135], v[184:187], v[56:59]
    ds_read2_b32 v[88:89], v23 offset0:160 offset1:161
    v_mfma_f32_16x16x32_bf16 v[60:63], v[132:135], v[188:191], v[60:63]
    ds_read2_b32 v[90:91], v23 offset0:162 offset1:163
    v_mfma_f32_16x16x32_bf16 v[60:63], v[136:139], v[184:187], v[60:63]
    ds_read_b128 v[120:123], v27 offset:10240
    v_mfma_f32_16x16x32_bf16 v[60:63], v[140:143], v[180:183], v[60:63]
    v_mfma_f32_16x16x32_bf16 v[60:63], v[144:147], v[176:179], v[60:63]
    ds_read2_b32 v[92:93], v24 offset0:32 offset1:33
    v_mfma_f32_16x16x32_bf16 v[60:63], v[148:151], v[172:175], v[60:63]
    ds_read2_b32 v[94:95], v24 offset0:34 offset1:35
    v_mfma_f32_16x16x32_bf16 v[60:63], v[152:155], v[168:171], v[60:63]
    ds_read_b128 v[124:127], v27 offset:12288
    v_mfma_f32_16x16x32_bf16 v[60:63], v[156:159], v[164:167], v[60:63]
    v_mfma_f32_16x16x32_bf16 v[64:67], v[160:163], v[164:167], v[64:67]
    ds_read2_b32 v[96:97], v24 offset0:160 offset1:161
    v_mfma_f32_16x16x32_bf16 v[64:67], v[156:159], v[168:171], v[64:67]
    ds_read2_b32 v[98:99], v24 offset0:162 offset1:163
    v_mfma_f32_16x16x32_bf16 v[64:67], v[152:155], v[172:175], v[64:67]
    ds_read_b128 v[128:131], v27 offset:14336
    v_mfma_f32_16x16x32_bf16 v[64:67], v[148:151], v[176:179], v[64:67]
    v_mfma_f32_16x16x32_bf16 v[64:67], v[144:147], v[180:183], v[64:67]
    v_mfma_f32_16x16x32_bf16 v[64:67], v[140:143], v[184:187], v[64:67]
    v_mfma_f32_16x16x32_bf16 v[64:67], v[136:139], v[188:191], v[64:67]
    v_mfma_f32_16x16x32_bf16 v[64:67], v[132:135], v[192:195], v[64:67]
    s_waitcnt lgkmcnt(14)
    v_mfma_f32_16x16x32_bf16 v[36:39], v[68:71], v[100:103], v[36:39]
    ds_read2_b32 v[132:133], v21 offset0:48 offset1:49
    v_mfma_f32_16x16x32_bf16 v[40:43], v[72:75], v[100:103], v[40:43]
    ds_read2_b32 v[134:135], v21 offset0:50 offset1:51
    v_mfma_f32_16x16x32_bf16 v[40:43], v[68:71], v[104:107], v[40:43]
    ds_read_b128 v[164:167], v28 offset:0
    v_mfma_f32_16x16x32_bf16 v[44:47], v[68:71], v[108:111], v[44:47]
    v_mfma_f32_16x16x32_bf16 v[44:47], v[72:75], v[104:107], v[44:47]
    ds_read2_b32 v[136:137], v21 offset0:176 offset1:177
    v_mfma_f32_16x16x32_bf16 v[44:47], v[76:79], v[100:103], v[44:47]
    ds_read2_b32 v[138:139], v21 offset0:178 offset1:179
    s_waitcnt lgkmcnt(14)
    v_mfma_f32_16x16x32_bf16 v[48:51], v[80:83], v[100:103], v[48:51]
    ds_read_b128 v[168:171], v28 offset:2048
    v_mfma_f32_16x16x32_bf16 v[48:51], v[76:79], v[104:107], v[48:51]
    v_mfma_f32_16x16x32_bf16 v[48:51], v[72:75], v[108:111], v[48:51]
    ds_read2_b32 v[140:141], v22 offset0:48 offset1:49
    v_mfma_f32_16x16x32_bf16 v[48:51], v[68:71], v[112:115], v[48:51]
    ds_read2_b32 v[142:143], v22 offset0:50 offset1:51
    v_mfma_f32_16x16x32_bf16 v[52:55], v[68:71], v[116:119], v[52:55]
    ds_read_b128 v[172:175], v28 offset:4096
    v_mfma_f32_16x16x32_bf16 v[52:55], v[72:75], v[112:115], v[52:55]
    v_mfma_f32_16x16x32_bf16 v[52:55], v[76:79], v[108:111], v[52:55]
    ds_read2_b32 v[144:145], v22 offset0:176 offset1:177
    v_mfma_f32_16x16x32_bf16 v[52:55], v[80:83], v[104:107], v[52:55]
    ds_read2_b32 v[146:147], v22 offset0:178 offset1:179
    v_mfma_f32_16x16x32_bf16 v[52:55], v[84:87], v[100:103], v[52:55]
    ds_read_b128 v[176:179], v28 offset:6144
    s_waitcnt lgkmcnt(14)
    v_mfma_f32_16x16x32_bf16 v[56:59], v[88:91], v[100:103], v[56:59]
    v_mfma_f32_16x16x32_bf16 v[56:59], v[84:87], v[104:107], v[56:59]
    ds_read2_b32 v[148:149], v23 offset0:48 offset1:49
    v_mfma_f32_16x16x32_bf16 v[56:59], v[80:83], v[108:111], v[56:59]
    ds_read2_b32 v[150:151], v23 offset0:50 offset1:51
    v_mfma_f32_16x16x32_bf16 v[56:59], v[76:79], v[112:115], v[56:59]
    ds_read_b128 v[180:183], v28 offset:8192
    v_mfma_f32_16x16x32_bf16 v[56:59], v[72:75], v[116:119], v[56:59]
    v_mfma_f32_16x16x32_bf16 v[56:59], v[68:71], v[120:123], v[56:59]
    ds_read2_b32 v[152:153], v23 offset0:176 offset1:177
    v_mfma_f32_16x16x32_bf16 v[60:63], v[68:71], v[124:127], v[60:63]
    ds_read2_b32 v[154:155], v23 offset0:178 offset1:179
    v_mfma_f32_16x16x32_bf16 v[60:63], v[72:75], v[120:123], v[60:63]
    ds_read_b128 v[184:187], v28 offset:10240
    v_mfma_f32_16x16x32_bf16 v[60:63], v[76:79], v[116:119], v[60:63]
    v_mfma_f32_16x16x32_bf16 v[60:63], v[80:83], v[112:115], v[60:63]
    ds_read2_b32 v[156:157], v24 offset0:48 offset1:49
    v_mfma_f32_16x16x32_bf16 v[60:63], v[84:87], v[108:111], v[60:63]
    ds_read2_b32 v[158:159], v24 offset0:50 offset1:51
    v_mfma_f32_16x16x32_bf16 v[60:63], v[88:91], v[104:107], v[60:63]
    ds_read_b128 v[188:191], v28 offset:12288
    v_mfma_f32_16x16x32_bf16 v[60:63], v[92:95], v[100:103], v[60:63]
    s_waitcnt lgkmcnt(14)
    v_mfma_f32_16x16x32_bf16 v[64:67], v[96:99], v[100:103], v[64:67]
    ds_read2_b32 v[160:161], v24 offset0:176 offset1:177
    v_mfma_f32_16x16x32_bf16 v[64:67], v[92:95], v[104:107], v[64:67]
    ds_read2_b32 v[162:163], v24 offset0:178 offset1:179
    v_mfma_f32_16x16x32_bf16 v[64:67], v[88:91], v[108:111], v[64:67]
    ds_read_b128 v[192:195], v28 offset:14336
    v_mfma_f32_16x16x32_bf16 v[64:67], v[84:87], v[112:115], v[64:67]
    v_mfma_f32_16x16x32_bf16 v[64:67], v[80:83], v[116:119], v[64:67]
    v_mfma_f32_16x16x32_bf16 v[64:67], v[76:79], v[120:123], v[64:67]
    v_mfma_f32_16x16x32_bf16 v[64:67], v[72:75], v[124:127], v[64:67]
    v_mfma_f32_16x16x32_bf16 v[64:67], v[68:71], v[128:131], v[64:67]
    v_mfma_f32_16x16x32_bf16 v[36:39], v[132:135], v[164:167], v[36:39]
    ds_read2_b32 v[68:69], v21 offset0:64 offset1:65
    v_mfma_f32_16x16x32_bf16 v[40:43], v[136:139], v[164:167], v[40:43]
    ds_read2_b32 v[70:71], v21 offset0:66 offset1:67
    v_mfma_f32_16x16x32_bf16 v[40:43], v[132:135], v[168:171], v[40:43]
    ds_read_b128 v[100:103], v29 offset:0
    s_waitcnt lgkmcnt(14)
    v_mfma_f32_16x16x32_bf16 v[44:47], v[132:135], v[172:175], v[44:47]
    v_mfma_f32_16x16x32_bf16 v[44:47], v[136:139], v[168:171], v[44:47]
    ds_read2_b32 v[72:73], v21 offset0:192 offset1:193
    v_mfma_f32_16x16x32_bf16 v[44:47], v[140:143], v[164:167], v[44:47]
    ds_read2_b32 v[74:75], v21 offset0:194 offset1:195
    v_mfma_f32_16x16x32_bf16 v[48:51], v[144:147], v[164:167], v[48:51]
    ds_read_b128 v[104:107], v29 offset:2048
    v_mfma_f32_16x16x32_bf16 v[48:51], v[140:143], v[168:171], v[48:51]
    v_mfma_f32_16x16x32_bf16 v[48:51], v[136:139], v[172:175], v[48:51]
    ds_read2_b32 v[76:77], v22 offset0:64 offset1:65
    v_mfma_f32_16x16x32_bf16 v[48:51], v[132:135], v[176:179], v[48:51]
    ds_read2_b32 v[78:79], v22 offset0:66 offset1:67
    s_waitcnt lgkmcnt(14)
    v_mfma_f32_16x16x32_bf16 v[52:55], v[132:135], v[180:183], v[52:55]
    ds_read_b128 v[108:111], v29 offset:4096
    v_mfma_f32_16x16x32_bf16 v[52:55], v[136:139], v[176:179], v[52:55]
    v_mfma_f32_16x16x32_bf16 v[52:55], v[140:143], v[172:175], v[52:55]
    ds_read2_b32 v[80:81], v22 offset0:192 offset1:193
    v_mfma_f32_16x16x32_bf16 v[52:55], v[144:147], v[168:171], v[52:55]
    ds_read2_b32 v[82:83], v22 offset0:194 offset1:195
    v_mfma_f32_16x16x32_bf16 v[52:55], v[148:151], v[164:167], v[52:55]
    ds_read_b128 v[112:115], v29 offset:6144
    v_mfma_f32_16x16x32_bf16 v[56:59], v[152:155], v[164:167], v[56:59]
    v_mfma_f32_16x16x32_bf16 v[56:59], v[148:151], v[168:171], v[56:59]
    ds_read2_b32 v[84:85], v23 offset0:64 offset1:65
    v_mfma_f32_16x16x32_bf16 v[56:59], v[144:147], v[172:175], v[56:59]
    ds_read2_b32 v[86:87], v23 offset0:66 offset1:67
    v_mfma_f32_16x16x32_bf16 v[56:59], v[140:143], v[176:179], v[56:59]
    ds_read_b128 v[116:119], v29 offset:8192
    v_mfma_f32_16x16x32_bf16 v[56:59], v[136:139], v[180:183], v[56:59]
    v_mfma_f32_16x16x32_bf16 v[56:59], v[132:135], v[184:187], v[56:59]
    ds_read2_b32 v[88:89], v23 offset0:192 offset1:193
    s_waitcnt lgkmcnt(14)
    v_mfma_f32_16x16x32_bf16 v[60:63], v[132:135], v[188:191], v[60:63]
    ds_read2_b32 v[90:91], v23 offset0:194 offset1:195
    v_mfma_f32_16x16x32_bf16 v[60:63], v[136:139], v[184:187], v[60:63]
    ds_read_b128 v[120:123], v29 offset:10240
    v_mfma_f32_16x16x32_bf16 v[60:63], v[140:143], v[180:183], v[60:63]
    v_mfma_f32_16x16x32_bf16 v[60:63], v[144:147], v[176:179], v[60:63]
    ds_read2_b32 v[92:93], v24 offset0:64 offset1:65
    v_mfma_f32_16x16x32_bf16 v[60:63], v[148:151], v[172:175], v[60:63]
    ds_read2_b32 v[94:95], v24 offset0:66 offset1:67
    v_mfma_f32_16x16x32_bf16 v[60:63], v[152:155], v[168:171], v[60:63]
    ds_read_b128 v[124:127], v29 offset:12288
    v_mfma_f32_16x16x32_bf16 v[60:63], v[156:159], v[164:167], v[60:63]
    v_mfma_f32_16x16x32_bf16 v[64:67], v[160:163], v[164:167], v[64:67]
    ds_read2_b32 v[96:97], v24 offset0:192 offset1:193
    v_mfma_f32_16x16x32_bf16 v[64:67], v[156:159], v[168:171], v[64:67]
    ds_read2_b32 v[98:99], v24 offset0:194 offset1:195
    v_mfma_f32_16x16x32_bf16 v[64:67], v[152:155], v[172:175], v[64:67]
    ds_read_b128 v[128:131], v29 offset:14336
    v_mfma_f32_16x16x32_bf16 v[64:67], v[148:151], v[176:179], v[64:67]
    v_mfma_f32_16x16x32_bf16 v[64:67], v[144:147], v[180:183], v[64:67]
    v_mfma_f32_16x16x32_bf16 v[64:67], v[140:143], v[184:187], v[64:67]
    v_mfma_f32_16x16x32_bf16 v[64:67], v[136:139], v[188:191], v[64:67]
    v_mfma_f32_16x16x32_bf16 v[64:67], v[132:135], v[192:195], v[64:67]
    s_waitcnt lgkmcnt(14)
    v_mfma_f32_16x16x32_bf16 v[36:39], v[68:71], v[100:103], v[36:39]
    ds_read2_b32 v[132:133], v21 offset0:80 offset1:81
    v_mfma_f32_16x16x32_bf16 v[40:43], v[72:75], v[100:103], v[40:43]
    ds_read2_b32 v[134:135], v21 offset0:82 offset1:83
    v_mfma_f32_16x16x32_bf16 v[40:43], v[68:71], v[104:107], v[40:43]
    ds_read_b128 v[164:167], v30 offset:0
    v_mfma_f32_16x16x32_bf16 v[44:47], v[68:71], v[108:111], v[44:47]
    v_mfma_f32_16x16x32_bf16 v[44:47], v[72:75], v[104:107], v[44:47]
    ds_read2_b32 v[136:137], v21 offset0:208 offset1:209
    v_mfma_f32_16x16x32_bf16 v[44:47], v[76:79], v[100:103], v[44:47]
    ds_read2_b32 v[138:139], v21 offset0:210 offset1:211
    s_waitcnt lgkmcnt(14)
    v_mfma_f32_16x16x32_bf16 v[48:51], v[80:83], v[100:103], v[48:51]
    ds_read_b128 v[168:171], v30 offset:2048
    v_mfma_f32_16x16x32_bf16 v[48:51], v[76:79], v[104:107], v[48:51]
    v_mfma_f32_16x16x32_bf16 v[48:51], v[72:75], v[108:111], v[48:51]
    ds_read2_b32 v[140:141], v22 offset0:80 offset1:81
    v_mfma_f32_16x16x32_bf16 v[48:51], v[68:71], v[112:115], v[48:51]
    ds_read2_b32 v[142:143], v22 offset0:82 offset1:83
    v_mfma_f32_16x16x32_bf16 v[52:55], v[68:71], v[116:119], v[52:55]
    ds_read_b128 v[172:175], v30 offset:4096
    v_mfma_f32_16x16x32_bf16 v[52:55], v[72:75], v[112:115], v[52:55]
    v_mfma_f32_16x16x32_bf16 v[52:55], v[76:79], v[108:111], v[52:55]
    ds_read2_b32 v[144:145], v22 offset0:208 offset1:209
    v_mfma_f32_16x16x32_bf16 v[52:55], v[80:83], v[104:107], v[52:55]
    ds_read2_b32 v[146:147], v22 offset0:210 offset1:211
    v_mfma_f32_16x16x32_bf16 v[52:55], v[84:87], v[100:103], v[52:55]
    ds_read_b128 v[176:179], v30 offset:6144
    s_waitcnt lgkmcnt(14)
    v_mfma_f32_16x16x32_bf16 v[56:59], v[88:91], v[100:103], v[56:59]
    v_mfma_f32_16x16x32_bf16 v[56:59], v[84:87], v[104:107], v[56:59]
    ds_read2_b32 v[148:149], v23 offset0:80 offset1:81
    v_mfma_f32_16x16x32_bf16 v[56:59], v[80:83], v[108:111], v[56:59]
    ds_read2_b32 v[150:151], v23 offset0:82 offset1:83
    v_mfma_f32_16x16x32_bf16 v[56:59], v[76:79], v[112:115], v[56:59]
    ds_read_b128 v[180:183], v30 offset:8192
    v_mfma_f32_16x16x32_bf16 v[56:59], v[72:75], v[116:119], v[56:59]
    v_mfma_f32_16x16x32_bf16 v[56:59], v[68:71], v[120:123], v[56:59]
    ds_read2_b32 v[152:153], v23 offset0:208 offset1:209
    v_mfma_f32_16x16x32_bf16 v[60:63], v[68:71], v[124:127], v[60:63]
    ds_read2_b32 v[154:155], v23 offset0:210 offset1:211
    v_mfma_f32_16x16x32_bf16 v[60:63], v[72:75], v[120:123], v[60:63]
    ds_read_b128 v[184:187], v30 offset:10240
    v_mfma_f32_16x16x32_bf16 v[60:63], v[76:79], v[116:119], v[60:63]
    v_mfma_f32_16x16x32_bf16 v[60:63], v[80:83], v[112:115], v[60:63]
    ds_read2_b32 v[156:157], v24 offset0:80 offset1:81
    v_mfma_f32_16x16x32_bf16 v[60:63], v[84:87], v[108:111], v[60:63]
    ds_read2_b32 v[158:159], v24 offset0:82 offset1:83
    v_mfma_f32_16x16x32_bf16 v[60:63], v[88:91], v[104:107], v[60:63]
    ds_read_b128 v[188:191], v30 offset:12288
    v_mfma_f32_16x16x32_bf16 v[60:63], v[92:95], v[100:103], v[60:63]
    s_waitcnt lgkmcnt(14)
    v_mfma_f32_16x16x32_bf16 v[64:67], v[96:99], v[100:103], v[64:67]
    ds_read2_b32 v[160:161], v24 offset0:208 offset1:209
    v_mfma_f32_16x16x32_bf16 v[64:67], v[92:95], v[104:107], v[64:67]
    ds_read2_b32 v[162:163], v24 offset0:210 offset1:211
    v_mfma_f32_16x16x32_bf16 v[64:67], v[88:91], v[108:111], v[64:67]
    ds_read_b128 v[192:195], v30 offset:14336
    v_mfma_f32_16x16x32_bf16 v[64:67], v[84:87], v[112:115], v[64:67]
    v_mfma_f32_16x16x32_bf16 v[64:67], v[80:83], v[116:119], v[64:67]
    v_mfma_f32_16x16x32_bf16 v[64:67], v[76:79], v[120:123], v[64:67]
    v_mfma_f32_16x16x32_bf16 v[64:67], v[72:75], v[124:127], v[64:67]
    v_mfma_f32_16x16x32_bf16 v[64:67], v[68:71], v[128:131], v[64:67]
    v_mfma_f32_16x16x32_bf16 v[36:39], v[132:135], v[164:167], v[36:39]
    ds_read2_b32 v[68:69], v21 offset0:96 offset1:97
    v_mfma_f32_16x16x32_bf16 v[40:43], v[136:139], v[164:167], v[40:43]
    ds_read2_b32 v[70:71], v21 offset0:98 offset1:99
    v_mfma_f32_16x16x32_bf16 v[40:43], v[132:135], v[168:171], v[40:43]
    ds_read_b128 v[100:103], v31 offset:0
    s_waitcnt lgkmcnt(14)
    v_mfma_f32_16x16x32_bf16 v[44:47], v[132:135], v[172:175], v[44:47]
    v_mfma_f32_16x16x32_bf16 v[44:47], v[136:139], v[168:171], v[44:47]
    ds_read2_b32 v[72:73], v21 offset0:224 offset1:225
    v_mfma_f32_16x16x32_bf16 v[44:47], v[140:143], v[164:167], v[44:47]
    ds_read2_b32 v[74:75], v21 offset0:226 offset1:227
    v_mfma_f32_16x16x32_bf16 v[48:51], v[144:147], v[164:167], v[48:51]
    ds_read_b128 v[104:107], v31 offset:2048
    v_mfma_f32_16x16x32_bf16 v[48:51], v[140:143], v[168:171], v[48:51]
    v_mfma_f32_16x16x32_bf16 v[48:51], v[136:139], v[172:175], v[48:51]
    ds_read2_b32 v[76:77], v22 offset0:96 offset1:97
    v_mfma_f32_16x16x32_bf16 v[48:51], v[132:135], v[176:179], v[48:51]
    ds_read2_b32 v[78:79], v22 offset0:98 offset1:99
    s_waitcnt lgkmcnt(14)
    v_mfma_f32_16x16x32_bf16 v[52:55], v[132:135], v[180:183], v[52:55]
    ds_read_b128 v[108:111], v31 offset:4096
    v_mfma_f32_16x16x32_bf16 v[52:55], v[136:139], v[176:179], v[52:55]
    v_mfma_f32_16x16x32_bf16 v[52:55], v[140:143], v[172:175], v[52:55]
    ds_read2_b32 v[80:81], v22 offset0:224 offset1:225
    v_mfma_f32_16x16x32_bf16 v[52:55], v[144:147], v[168:171], v[52:55]
    ds_read2_b32 v[82:83], v22 offset0:226 offset1:227
    v_mfma_f32_16x16x32_bf16 v[52:55], v[148:151], v[164:167], v[52:55]
    ds_read_b128 v[112:115], v31 offset:6144
    v_mfma_f32_16x16x32_bf16 v[56:59], v[152:155], v[164:167], v[56:59]
    v_mfma_f32_16x16x32_bf16 v[56:59], v[148:151], v[168:171], v[56:59]
    ds_read2_b32 v[84:85], v23 offset0:96 offset1:97
    v_mfma_f32_16x16x32_bf16 v[56:59], v[144:147], v[172:175], v[56:59]
    ds_read2_b32 v[86:87], v23 offset0:98 offset1:99
    v_mfma_f32_16x16x32_bf16 v[56:59], v[140:143], v[176:179], v[56:59]
    ds_read_b128 v[116:119], v31 offset:8192
    v_mfma_f32_16x16x32_bf16 v[56:59], v[136:139], v[180:183], v[56:59]
    v_mfma_f32_16x16x32_bf16 v[56:59], v[132:135], v[184:187], v[56:59]
    ds_read2_b32 v[88:89], v23 offset0:224 offset1:225
    s_waitcnt lgkmcnt(14)
    v_mfma_f32_16x16x32_bf16 v[60:63], v[132:135], v[188:191], v[60:63]
    ds_read2_b32 v[90:91], v23 offset0:226 offset1:227
    v_mfma_f32_16x16x32_bf16 v[60:63], v[136:139], v[184:187], v[60:63]
    ds_read_b128 v[120:123], v31 offset:10240
    v_mfma_f32_16x16x32_bf16 v[60:63], v[140:143], v[180:183], v[60:63]
    v_mfma_f32_16x16x32_bf16 v[60:63], v[144:147], v[176:179], v[60:63]
    ds_read2_b32 v[92:93], v24 offset0:96 offset1:97
    v_mfma_f32_16x16x32_bf16 v[60:63], v[148:151], v[172:175], v[60:63]
    ds_read2_b32 v[94:95], v24 offset0:98 offset1:99
    v_mfma_f32_16x16x32_bf16 v[60:63], v[152:155], v[168:171], v[60:63]
    ds_read_b128 v[124:127], v31 offset:12288
    v_mfma_f32_16x16x32_bf16 v[60:63], v[156:159], v[164:167], v[60:63]
    v_mfma_f32_16x16x32_bf16 v[64:67], v[160:163], v[164:167], v[64:67]
    ds_read2_b32 v[96:97], v24 offset0:224 offset1:225
    v_mfma_f32_16x16x32_bf16 v[64:67], v[156:159], v[168:171], v[64:67]
    ds_read2_b32 v[98:99], v24 offset0:226 offset1:227
    v_mfma_f32_16x16x32_bf16 v[64:67], v[152:155], v[172:175], v[64:67]
    ds_read_b128 v[128:131], v31 offset:14336
    v_mfma_f32_16x16x32_bf16 v[64:67], v[148:151], v[176:179], v[64:67]
    v_mfma_f32_16x16x32_bf16 v[64:67], v[144:147], v[180:183], v[64:67]
    v_mfma_f32_16x16x32_bf16 v[64:67], v[140:143], v[184:187], v[64:67]
    v_mfma_f32_16x16x32_bf16 v[64:67], v[136:139], v[188:191], v[64:67]
    v_mfma_f32_16x16x32_bf16 v[64:67], v[132:135], v[192:195], v[64:67]
    s_waitcnt lgkmcnt(14)
    v_mfma_f32_16x16x32_bf16 v[36:39], v[68:71], v[100:103], v[36:39]
    ds_read2_b32 v[132:133], v21 offset0:112 offset1:113
    v_mfma_f32_16x16x32_bf16 v[40:43], v[72:75], v[100:103], v[40:43]
    ds_read2_b32 v[134:135], v21 offset0:114 offset1:115
    v_mfma_f32_16x16x32_bf16 v[40:43], v[68:71], v[104:107], v[40:43]
    ds_read_b128 v[164:167], v32 offset:0
    v_mfma_f32_16x16x32_bf16 v[44:47], v[68:71], v[108:111], v[44:47]
    v_mfma_f32_16x16x32_bf16 v[44:47], v[72:75], v[104:107], v[44:47]
    ds_read2_b32 v[136:137], v21 offset0:240 offset1:241
    v_mfma_f32_16x16x32_bf16 v[44:47], v[76:79], v[100:103], v[44:47]
    ds_read2_b32 v[138:139], v21 offset0:242 offset1:243
    s_waitcnt lgkmcnt(14)
    v_mfma_f32_16x16x32_bf16 v[48:51], v[80:83], v[100:103], v[48:51]
    ds_read_b128 v[168:171], v32 offset:2048
    v_mfma_f32_16x16x32_bf16 v[48:51], v[76:79], v[104:107], v[48:51]
    v_mfma_f32_16x16x32_bf16 v[48:51], v[72:75], v[108:111], v[48:51]
    ds_read2_b32 v[140:141], v22 offset0:112 offset1:113
    v_mfma_f32_16x16x32_bf16 v[48:51], v[68:71], v[112:115], v[48:51]
    ds_read2_b32 v[142:143], v22 offset0:114 offset1:115
    v_mfma_f32_16x16x32_bf16 v[52:55], v[68:71], v[116:119], v[52:55]
    ds_read_b128 v[172:175], v32 offset:4096
    v_mfma_f32_16x16x32_bf16 v[52:55], v[72:75], v[112:115], v[52:55]
    v_mfma_f32_16x16x32_bf16 v[52:55], v[76:79], v[108:111], v[52:55]
    ds_read2_b32 v[144:145], v22 offset0:240 offset1:241
    v_mfma_f32_16x16x32_bf16 v[52:55], v[80:83], v[104:107], v[52:55]
    ds_read2_b32 v[146:147], v22 offset0:242 offset1:243
    v_mfma_f32_16x16x32_bf16 v[52:55], v[84:87], v[100:103], v[52:55]
    ds_read_b128 v[176:179], v32 offset:6144
    s_waitcnt lgkmcnt(14)
    v_mfma_f32_16x16x32_bf16 v[56:59], v[88:91], v[100:103], v[56:59]
    v_mfma_f32_16x16x32_bf16 v[56:59], v[84:87], v[104:107], v[56:59]
    ds_read2_b32 v[148:149], v23 offset0:112 offset1:113
    v_mfma_f32_16x16x32_bf16 v[56:59], v[80:83], v[108:111], v[56:59]
    ds_read2_b32 v[150:151], v23 offset0:114 offset1:115
    v_mfma_f32_16x16x32_bf16 v[56:59], v[76:79], v[112:115], v[56:59]
    ds_read_b128 v[180:183], v32 offset:8192
    v_mfma_f32_16x16x32_bf16 v[56:59], v[72:75], v[116:119], v[56:59]
    v_mfma_f32_16x16x32_bf16 v[56:59], v[68:71], v[120:123], v[56:59]
    ds_read2_b32 v[152:153], v23 offset0:240 offset1:241
    v_mfma_f32_16x16x32_bf16 v[60:63], v[68:71], v[124:127], v[60:63]
    ds_read2_b32 v[154:155], v23 offset0:242 offset1:243
    v_mfma_f32_16x16x32_bf16 v[60:63], v[72:75], v[120:123], v[60:63]
    ds_read_b128 v[184:187], v32 offset:10240
    v_mfma_f32_16x16x32_bf16 v[60:63], v[76:79], v[116:119], v[60:63]
    v_mfma_f32_16x16x32_bf16 v[60:63], v[80:83], v[112:115], v[60:63]
    ds_read2_b32 v[156:157], v24 offset0:112 offset1:113
    v_mfma_f32_16x16x32_bf16 v[60:63], v[84:87], v[108:111], v[60:63]
    ds_read2_b32 v[158:159], v24 offset0:114 offset1:115
    v_mfma_f32_16x16x32_bf16 v[60:63], v[88:91], v[104:107], v[60:63]
    ds_read_b128 v[188:191], v32 offset:12288
    v_mfma_f32_16x16x32_bf16 v[60:63], v[92:95], v[100:103], v[60:63]
    s_waitcnt lgkmcnt(14)
    v_mfma_f32_16x16x32_bf16 v[64:67], v[96:99], v[100:103], v[64:67]
    ds_read2_b32 v[160:161], v24 offset0:240 offset1:241
    v_mfma_f32_16x16x32_bf16 v[64:67], v[92:95], v[104:107], v[64:67]
    ds_read2_b32 v[162:163], v24 offset0:242 offset1:243
    v_mfma_f32_16x16x32_bf16 v[64:67], v[88:91], v[108:111], v[64:67]
    ds_read_b128 v[192:195], v32 offset:14336
    v_mfma_f32_16x16x32_bf16 v[64:67], v[84:87], v[112:115], v[64:67]
    v_mfma_f32_16x16x32_bf16 v[64:67], v[80:83], v[116:119], v[64:67]
    v_mfma_f32_16x16x32_bf16 v[64:67], v[76:79], v[120:123], v[64:67]
    v_mfma_f32_16x16x32_bf16 v[64:67], v[72:75], v[124:127], v[64:67]
    v_mfma_f32_16x16x32_bf16 v[64:67], v[68:71], v[128:131], v[64:67]
    v_mfma_f32_16x16x32_bf16 v[36:39], v[132:135], v[164:167], v[36:39]
    v_mfma_f32_16x16x32_bf16 v[40:43], v[136:139], v[164:167], v[40:43]
    v_mfma_f32_16x16x32_bf16 v[40:43], v[132:135], v[168:171], v[40:43]
    s_waitcnt lgkmcnt(14)
    v_mfma_f32_16x16x32_bf16 v[44:47], v[132:135], v[172:175], v[44:47]
    v_mfma_f32_16x16x32_bf16 v[44:47], v[136:139], v[168:171], v[44:47]
    v_mfma_f32_16x16x32_bf16 v[44:47], v[140:143], v[164:167], v[44:47]
    s_waitcnt lgkmcnt(13)
    v_mfma_f32_16x16x32_bf16 v[48:51], v[144:147], v[164:167], v[48:51]
    v_mfma_f32_16x16x32_bf16 v[48:51], v[140:143], v[168:171], v[48:51]
    s_waitcnt lgkmcnt(0)
    v_cvt_pk_bf16_f32 v68, v39, v38
    v_cvt_pk_bf16_f32 v69, v37, v36
    v_mfma_f32_16x16x32_bf16 v[48:51], v[136:139], v[172:175], v[48:51]
    ds_write_b64 v20, v[68:69] offset:0
    v_cvt_pk_bf16_f32 v70, v43, v42
    v_mfma_f32_16x16x32_bf16 v[48:51], v[132:135], v[176:179], v[48:51]
    v_cvt_pk_bf16_f32 v71, v41, v40
    ds_write_b64 v20, v[70:71] offset:2048
    v_mfma_f32_16x16x32_bf16 v[52:55], v[132:135], v[180:183], v[52:55]
    v_mfma_f32_16x16x32_bf16 v[52:55], v[136:139], v[176:179], v[52:55]
    v_cvt_pk_bf16_f32 v72, v47, v46
    v_cvt_pk_bf16_f32 v73, v45, v44
    v_mfma_f32_16x16x32_bf16 v[52:55], v[140:143], v[172:175], v[52:55]
    ds_write_b64 v20, v[72:73] offset:4096
    v_mfma_f32_16x16x32_bf16 v[52:55], v[144:147], v[168:171], v[52:55]
    v_mfma_f32_16x16x32_bf16 v[52:55], v[148:151], v[164:167], v[52:55]
    v_mfma_f32_16x16x32_bf16 v[56:59], v[152:155], v[164:167], v[56:59]
    v_cvt_pk_bf16_f32 v74, v51, v50
    v_cvt_pk_bf16_f32 v75, v49, v48
    v_mfma_f32_16x16x32_bf16 v[56:59], v[148:151], v[168:171], v[56:59]
    ds_write_b64 v20, v[74:75] offset:6144
    v_mfma_f32_16x16x32_bf16 v[56:59], v[144:147], v[172:175], v[56:59]
    v_mfma_f32_16x16x32_bf16 v[56:59], v[140:143], v[176:179], v[56:59]
    v_mfma_f32_16x16x32_bf16 v[56:59], v[136:139], v[180:183], v[56:59]
    v_mfma_f32_16x16x32_bf16 v[56:59], v[132:135], v[184:187], v[56:59]
    v_cvt_pk_bf16_f32 v76, v55, v54
    v_cvt_pk_bf16_f32 v77, v53, v52
    v_mfma_f32_16x16x32_bf16 v[60:63], v[132:135], v[188:191], v[60:63]
    ds_write_b64 v20, v[76:77] offset:8192
    v_mfma_f32_16x16x32_bf16 v[60:63], v[136:139], v[184:187], v[60:63]
    v_mfma_f32_16x16x32_bf16 v[60:63], v[140:143], v[180:183], v[60:63]
    v_mfma_f32_16x16x32_bf16 v[60:63], v[144:147], v[176:179], v[60:63]
    v_mfma_f32_16x16x32_bf16 v[60:63], v[148:151], v[172:175], v[60:63]
    v_mfma_f32_16x16x32_bf16 v[60:63], v[152:155], v[168:171], v[60:63]
    v_cvt_pk_bf16_f32 v78, v59, v58
    v_cvt_pk_bf16_f32 v79, v57, v56
    v_mfma_f32_16x16x32_bf16 v[60:63], v[156:159], v[164:167], v[60:63]
    ds_write_b64 v20, v[78:79] offset:10240
    v_mfma_f32_16x16x32_bf16 v[64:67], v[160:163], v[164:167], v[64:67]
    v_mfma_f32_16x16x32_bf16 v[64:67], v[156:159], v[168:171], v[64:67]
    v_mfma_f32_16x16x32_bf16 v[64:67], v[152:155], v[172:175], v[64:67]
    v_mfma_f32_16x16x32_bf16 v[64:67], v[148:151], v[176:179], v[64:67]
    v_mfma_f32_16x16x32_bf16 v[64:67], v[144:147], v[180:183], v[64:67]
    v_mfma_f32_16x16x32_bf16 v[64:67], v[140:143], v[184:187], v[64:67]
    s_nop 0
    v_cvt_pk_bf16_f32 v80, v63, v62
    v_cvt_pk_bf16_f32 v81, v61, v60
    v_mfma_f32_16x16x32_bf16 v[64:67], v[136:139], v[188:191], v[64:67]
    ds_write_b64 v20, v[80:81] offset:12288
    v_mfma_f32_16x16x32_bf16 v[64:67], v[132:135], v[192:195], v[64:67]
    s_nop 7
    v_cvt_pk_bf16_f32 v82, v67, v66
    v_cvt_pk_bf16_f32 v83, v65, v64
    ds_write_b64 v20, v[82:83] offset:14336
    s_mov_b64 exec, 1
    ds_add_u32 v18, v19 offset:12
    s_mov_b64 exec, -1
    s_add_u32 s80, s86, 94208
    v_add_u32 v5, s80, v15
    s_branch LA_s3_in
LA_s3:
    s_sleep 1
LA_s3_in:
    ds_read_b32 v6, v18 offset:12
    ds_read_b128 v[84:87], v5 offset:0
    ds_read_b128 v[88:91], v5 offset:4096
    ds_read_b128 v[92:95], v5 offset:8192
    ds_read_b128 v[96:99], v5 offset:12288
    s_waitcnt lgkmcnt(0)
    v_readfirstlane_b32 s78, v6
    s_nop 0
    s_cmp_ge_u32 s78, 4
    s_cbranch_scc0 LA_s3
    s_add_u32 s89, s91, 4194304
    buffer_store_dwordx4 v[84:87], v14, s[52:55], s89 offen sc1
    s_add_u32 s89, s91, 4198400
    buffer_store_dwordx4 v[88:91], v14, s[52:55], s89 offen sc1
    s_add_u32 s89, s91, 4202496
    buffer_store_dwordx4 v[92:95], v14, s[52:55], s89 offen sc1
    s_add_u32 s89, s91, 4206592
    buffer_store_dwordx4 v[96:99], v14, s[52:55], s89 offen sc1
    s_add_u32 s80, s86, 129024
    v_add_u32 v5, s80, v15
    s_waitcnt vmcnt(9)
    ds_write_b128 v5, v[228:231] offset:0
    s_waitcnt vmcnt(8)
    ds_write_b128 v5, v[232:235] offset:4096
    s_waitcnt vmcnt(7)
    ds_write_b128 v5, v[240:243] offset:8192
    s_waitcnt vmcnt(6)
    ds_write_b128 v5, v[244:247] offset:12288
    s_waitcnt vmcnt(5)
    ds_write_b128 v5, v[248:251] offset:16384
    s_waitcnt vmcnt(4)
    ds_write_b128 v5, v[196:199] offset:20480
    s_mov_b64 exec, 1
    ds_add_u32 v18, v19 offset:32
    s_mov_b64 exec, -1
    s_setprio 0
    s_mov_b32 s60, s22
    s_mov_b32 s61, s23
    s_mov_b32 s62, 0x800000
    s_mov_b32 s63, 0x20000
    s_lshr_b32 s81, s91, 4
    s_lshl_b32 s82, s3, 8
    s_add_u32 s81, s81, s82
    s_add_u32 s81, s81, 12648448
    s_lshl_b32 s80, s74, 14
    s_and_b32 s82, s75, 3
    s_lshl_b32 s82, s82, 8
    s_add_u32 s80, s80, s82
    s_add_u32 s80, s80, 12648448
    v_mov_b32 v5, 0
    v_lshlrev_b32 v7, 10, v0
    v_lshlrev_b32 v132, 16, v212
    v_and_b32 v133, 0xffff0000, v212
    v_lshlrev_b32 v134, 16, v213
    v_and_b32 v135, 0xffff0000, v213
    v_lshlrev_b32 v136, 16, v214
    v_and_b32 v137, 0xffff0000, v214
    v_lshlrev_b32 v138, 16, v215
    v_and_b32 v139, 0xffff0000, v215
    v_lshlrev_b32 v140, 16, v216
    v_and_b32 v141, 0xffff0000, v216
    v_lshlrev_b32 v142, 16, v217
    v_and_b32 v143, 0xffff0000, v217
    v_lshlrev_b32 v144, 16, v218
    v_and_b32 v145, 0xffff0000, v218
    v_lshlrev_b32 v146, 16, v219
    v_and_b32 v147, 0xffff0000, v219
    v_lshlrev_b32 v148, 16, v220
    v_and_b32 v149, 0xffff0000, v220
    v_lshlrev_b32 v150, 16, v221
    v_and_b32 v151, 0xffff0000, v221
    v_lshlrev_b32 v152, 16, v222
    v_and_b32 v153, 0xffff0000, v222
    v_lshlrev_b32 v154, 16, v223
    v_and_b32 v155, 0xffff0000, v223
    v_lshlrev_b32 v156, 16, v224
    v_and_b32 v157, 0xffff0000, v224
    v_lshlrev_b32 v158, 16, v225
    v_and_b32 v159, 0xffff0000, v225
    v_lshlrev_b32 v160, 16, v226
    v_and_b32 v161, 0xffff0000, v226
    v_lshlrev_b32 v162, 16, v227
    v_and_b32 v163, 0xffff0000, v227
    s_waitcnt vmcnt(0)
    s_mov_b64 exec, 1
    buffer_store_dword v19, v5, s[52:55], s81 offen sc1
    s_mov_b64 exec, 0xffff
    s_waitcnt vmcnt(0)
    s_branch LA_s7a_in
LA_s7a:
    s_sleep 1
LA_s7a_in:
    ds_read_b32 v6, v18 offset:28
    s_waitcnt lgkmcnt(0)
    v_readfirstlane_b32 s78, v6
    s_nop 0
    s_cmp_ge_u32 s78, 4
    s_cbranch_scc0 LA_s7a
    s_setprio 2
    s_mov_b32 s79, 0
LA_py:
    buffer_load_dword v6, v7, s[52:55], s80 offen sc1
    s_add_u32 s79, s79, 1
    s_cmp_gt_u32 s79, 200000
    s_cbranch_scc1 LA_py_x
    s_waitcnt vmcnt(0)
    v_cmp_ne_u32 vcc, 1, v6
    s_cbranch_vccz LA_py_x
    s_mov_b64 exec, vcc
    s_sleep 8
    s_branch LA_py
LA_py_x:
    s_waitcnt vmcnt(0)
    s_mov_b64 exec, -1
    s_mov_b32 s89, 4194304
    buffer_load_dwordx4 v[100:103], v12, s[52:55], s89 offen sc1
    s_mov_b32 s89, 4210688
    buffer_load_dwordx4 v[104:107], v12, s[52:55], s89 offen sc1
    s_mov_b32 s89, 4227072
    buffer_load_dwordx4 v[108:111], v12, s[52:55], s89 offen sc1
    s_mov_b32 s89, 4243456
    buffer_load_dwordx4 v[112:115], v12, s[52:55], s89 offen sc1
    s_waitcnt vmcnt(3)
    v_permlane32_swap_b32 v102, v100
    v_permlane32_swap_b32 v103, v101
    s_waitcnt vmcnt(2)
    v_permlane32_swap_b32 v106, v104
    v_permlane32_swap_b32 v107, v105
    s_waitcnt vmcnt(1)
    v_permlane32_swap_b32 v110, v108
    v_permlane32_swap_b32 v111, v109
    s_waitcnt vmcnt(0)
    v_permlane32_swap_b32 v114, v112
    v_permlane32_swap_b32 v115, v113
    v_and_b32 v68, 0xffff0000, v103
    v_and_b32 v69, 0xffff0000, v107
    v_and_b32 v70, 0xffff0000, v111
    v_and_b32 v71, 0xffff0000, v115
    v_and_b32 v72, 0xffff0000, v101
    v_and_b32 v73, 0xffff0000, v105
    v_and_b32 v74, 0xffff0000, v109
    v_and_b32 v75, 0xffff0000, v113
    v_mul_f32 v68, v68, v132
    v_mul_f32 v69, v69, v133
    v_mul_f32 v70, v70, v134
    v_mul_f32 v71, v71, v135
    v_mul_f32 v72, v72, v136
    v_mul_f32 v73, v73, v137
    v_mul_f32 v74, v74, v138
    v_mul_f32 v75, v75, v139
    v_cvt_pk_bf16_f32 v36, v68, v69
    v_cvt_pk_bf16_f32 v37, v70, v71
    v_cvt_pk_bf16_f32 v38, v72, v73
    v_cvt_pk_bf16_f32 v39, v74, v75
    s_mov_b32 s89, 0
    buffer_store_dwordx4 v[36:39], v13, s[60:63], s89 offen nt sc1
    v_lshlrev_b32 v68, 16, v103
    v_lshlrev_b32 v69, 16, v107
    v_lshlrev_b32 v70, 16, v111
    v_lshlrev_b32 v71, 16, v115
    v_lshlrev_b32 v72, 16, v101
    v_lshlrev_b32 v73, 16, v105
    v_lshlrev_b32 v74, 16, v109
    v_lshlrev_b32 v75, 16, v113
    v_mul_f32 v68, v68, v140
    v_mul_f32 v69, v69, v141
    v_mul_f32 v70, v70, v142
    v_mul_f32 v71, v71, v143
    v_mul_f32 v72, v72, v144
    v_mul_f32 v73, v73, v145
    v_mul_f32 v74, v74, v146
    v_mul_f32 v75, v75, v147
    v_cvt_pk_bf16_f32 v40, v68, v69
    v_cvt_pk_bf16_f32 v41, v70, v71
    v_cvt_pk_bf16_f32 v42, v72, v73
    v_cvt_pk_bf16_f32 v43, v74, v75
    s_mov_b32 s89, 4096
    buffer_store_dwordx4 v[40:43], v13, s[60:63], s89 offen nt sc1
    v_and_b32 v68, 0xffff0000, v102
    v_and_b32 v69, 0xffff0000, v106
    v_and_b32 v70, 0xffff0000, v110
    v_and_b32 v71, 0xffff0000, v114
    v_and_b32 v72, 0xffff0000, v100
    v_and_b32 v73, 0xffff0000, v104
    v_and_b32 v74, 0xffff0000, v108
    v_and_b32 v75, 0xffff0000, v112
    v_mul_f32 v68, v68, v148
    v_mul_f32 v69, v69, v149
    v_mul_f32 v70, v70, v150
    v_mul_f32 v71, v71, v151
    v_mul_f32 v72, v72, v152
    v_mul_f32 v73, v73, v153
    v_mul_f32 v74, v74, v154
    v_mul_f32 v75, v75, v155
    v_cvt_pk_bf16_f32 v44, v68, v69
    v_cvt_pk_bf16_f32 v45, v70, v71
    v_cvt_pk_bf16_f32 v46, v72, v73
    v_cvt_pk_bf16_f32 v47, v74, v75
    s_mov_b32 s89, 8192
    buffer_store_dwordx4 v[44:47], v13, s[60:63], s89 offen nt sc1
    v_lshlrev_b32 v68, 16, v102
    v_lshlrev_b32 v69, 16, v106
    v_lshlrev_b32 v70, 16, v110
    v_lshlrev_b32 v71, 16, v114
    v_lshlrev_b32 v72, 16, v100
    v_lshlrev_b32 v73, 16, v104
    v_lshlrev_b32 v74, 16, v108
    v_lshlrev_b32 v75, 16, v112
    v_mul_f32 v68, v68, v156
    v_mul_f32 v69, v69, v157
    v_mul_f32 v70, v70, v158
    v_mul_f32 v71, v71, v159
    v_mul_f32 v72, v72, v160
    v_mul_f32 v73, v73, v161
    v_mul_f32 v74, v74, v162
    v_mul_f32 v75, v75, v163
    v_cvt_pk_bf16_f32 v48, v68, v69
    v_cvt_pk_bf16_f32 v49, v70, v71
    v_cvt_pk_bf16_f32 v50, v72, v73
    v_cvt_pk_bf16_f32 v51, v74, v75
    s_mov_b32 s89, 12288
    buffer_store_dwordx4 v[48:51], v13, s[60:63], s89 offen nt sc1
    s_endpgm
L_B:
    s_setprio 3
    s_and_b32 s3, s3, 3
    s_add_u32 s79, s72, s73
    s_add_u32 s78, s72, 5
    s_and_b32 s78, s78, 7
    s_lshl_b32 s78, s78, 1
    s_and_b32 s75, s79, 1
    s_add_u32 s78, s78, s75
    s_andn2_b32 s79, 2, s79
    s_lshl_b32 s79, s79, 3
    s_add_u32 s78, s78, s79
    s_and_b32 s76, s78, 3
    s_and_b32 s79, s73, 12
    s_add_u32 s76, s76, s79
    s_lshr_b32 s74, s78, 4
    s_add_u32 s74, s74, s79
    s_and_b32 s79, s72, 8
    s_lshr_b32 s77, s78, 2
    s_add_u32 s77, s77, s79
    s_lshr_b32 s79, s79, 2
    s_add_u32 s74, s74, s79
    s_xor_b32 s74, s74, 4
    s_and_b32 s75, s78, 15
    s_lshr_b32 s86, s3, 1
    s_and_b32 s87, s3, 1
    v_mov_b32 v10, 162304
    v_mov_b32 v11, 1
    v_lshlrev_b32 v12, 4, v0
    v_lshl_add_u32 v13, v0, 2, v10
    v_mov_b32 v14, 0
    ds_write_b32 v13, v14
    s_lshl_b32 s78, s74, 4
    s_add_u32 s78, s78, s75
    s_lshl_b32 s96, s78, 8
    s_add_u32 s96, s96, 12582912
    s_lshl_b32 s78, s78, 2
    s_add_u32 s78, s78, s3
    s_lshl_b32 s78, s78, 8
    s_add_u32 s80, s78, 12648448
    s_lshl_b32 s81, s72, 1
    s_add_u32 s81, s81, s86
    s_lshl_b32 s97, s81, 4
    s_add_u32 s97, s97, s73
    s_lshl_b32 s97, s97, 8
    s_add_u32 s97, s97, 12910464
    v_mov_b32 v15, s80
    v_mov_b32 v223, s97
    v_cmp_gt_u32 vcc, 8, v0
    s_nop 1
    v_cndmask_b32 v15, v223, v15, vcc
    v_add_u32 v221, v15, v12
    s_lshl_b32 s78, s87, 2
    s_add_u32 s78, s78, 128
    s_add_u32 s97, s97, s78
    s_lshl_b32 s82, s73, 1
    s_add_u32 s82, s82, s87
    s_lshl_b32 s78, s81, 7
    s_add_u32 s78, s78, s82
    s_lshl_b32 s94, s78, 10
    s_add_u32 s94, s94, 8388608
    v_mov_b32 v212, 0
    v_mov_b32 v213, 0
    v_mov_b32 v214, 0
    v_mov_b32 v215, 0
    v_mov_b32 v220, 0
    s_waitcnt lgkmcnt(0)
    s_mov_b32 s52, s26
    s_mov_b32 s53, s27
    s_mov_b32 s54, 0x1000000
    s_mov_b32 s55, 0x20000
    s_mov_b32 s68, s24
    s_mov_b32 s69, s25
    s_mov_b32 s70, 0x100
    s_mov_b32 s71, 0x20000
    s_lshl_b32 s98, s74, 4
    s_or_b32 s78, s75, s3
    s_cmp_lg_u32 s78, 0
    s_cbranch_scc1 LB_notag
    s_mov_b64 exec, 0xffff
    v_lshlrev_b32 v15, 8, v0
    buffer_load_dword v251, v15, s[52:55], s96 offen sc1
LB_notag:
    s_lshl_b32 s78, s87, 3
    s_lshr_b32 exec_lo, 0xffff, s78
    s_mov_b32 exec_hi, 0
    buffer_store_dwordx4 v[212:215], v221, s[52:55], 0 offen sc1
    s_mov_b64 exec, -1
    v_and_b32 v13, 15, v0
    v_lshrrev_b32 v14, 4, v0
    v_lshrrev_b32 v15, 1, v13
    v_xor_b32 v15, v15, v14
    v_lshlrev_b32 v15, 4, v15
    v_lshl_add_u32 v15, v13, 7, v15
    v_add_u32 v2, 73728, v15
    v_xor_b32 v3, 64, v2
    s_lshl_b32 s78, s86, 13
    s_add_u32 s78, s78, 2048
    v_add_u32 v4, s78, v2
    v_add_u32 v5, s78, v3
    v_bfe_u32 v15, v0, 3, 2
    s_lshl_b32 s78, s87, 1
    s_add_u32 s78, s78, s86
    v_xor_b32 v15, s78, v15
    v_lshlrev_b32 v15, 5, v15
    v_and_b32 v223, 3, v0
    v_lshl_add_u32 v15, v223, 3, v15
    v_bfe_u32 v223, v0, 2, 2
    v_lshl_add_u32 v15, v223, 7, v15
    v_mul_u32_u24 v223, 3072, v14
    v_add_u32 v6, v223, v15
    v_xor_b32 v7, 32, v6
    s_mov_b32 s60, s22
    s_mov_b32 s61, s23
    s_mov_b32 s62, 0x800000
    s_mov_b32 s63, 0x20000
    v_and_b32 v15, 1, v13
    v_cmp_eq_u32 s[88:89], 1, v15
    v_lshl_add_u32 v15, v14, 2, v15
    v_cmp_le_u32 s[90:91], v15, v13
    v_add_u32 v15, 2, v15
    v_cmp_le_u32 s[92:93], v15, v13
    v_mov_b32 v212, 0x0c0c0c0c
    v_mov_b32 v15, 0xc0c0100
    v_mov_b32 v223, 0x1000c0c
    v_cndmask_b32 v15, v15, v223, s[88:89]
    v_cndmask_b32 v208, v15, v212, s[90:91]
    v_cndmask_b32 v210, v212, v15, s[90:91]
    v_mov_b32 v15, 0xc0c0302
    v_mov_b32 v223, 0x3020c0c
    v_cndmask_b32 v15, v15, v223, s[88:89]
    v_cndmask_b32 v209, v15, v212, s[92:93]
    v_cndmask_b32 v211, v212, v15, s[92:93]
    s_or_b32 s78, s72, s86
    s_cmp_eq_u32 s78, 0
    s_cselect_b32 s78, 0xf149f2ca, 0
    v_mov_b32 v212, s78
    v_mov_b32 v213, s78
    v_mov_b32 v214, s78
    v_mov_b32 v215, s78
    s_lshl_b32 s78, s87, 12
    s_add_u32 s78, s78, 24576
    s_lshl_b32 s79, s86, 9
    s_add_u32 s79, s79, s78
    v_lshlrev_b32 v15, 3, v0
    v_add_u32 v216, s79, v15
    s_lshl_b32 s80, s86, 11
    v_add_u32 v218, s80, v216
    v_xor_b32 v219, 512, v218
    s_add_u32 s78, s78, 2048
    s_cmp_eq_u32 s86, 0
    s_cselect_b32 s78, s78, 32768
    v_add_u32 v217, s78, v15
    v_bfe_u32 v14, v0, 3, 2
    v_lshlrev_b32 v14, 5, v14
    v_and_b32 v15, 3, v0
    v_lshl_add_u32 v14, v15, 3, v14
    v_lshrrev_b32 v15, 2, v0
    v_lshl_add_u32 v14, v15, 7, v14
    s_lshl_b32 s78, s86, 11
    v_add_u32 v244, s78, v14
    s_mov_b32 s64, s20
    s_mov_b32 s65, s21
    s_mov_b32 s66, 0x200000
    s_mov_b32 s67, 0x20000
    v_lshrrev_b32 v14, 4, v0
    v_lshlrev_b32 v14, 1, v14
    v_and_b32 v15, 7, v0
    v_xor_b32 v14, v14, v15
    v_lshlrev_b32 v14, 4, v14
    v_lshrrev_b32 v15, 3, v0
    v_lshl_add_u32 v14, v15, 11, v14
    s_lshl_b32 s78, s77, 7
    s_lshl_b32 s79, s3, 14
    s_add_u32 s78, s78, s79
    v_add_u32 v245, s78, v14
    v_and_b32 v14, 15, v0
    s_lshl_b32 s78, s76, 2
    s_add_u32 s78, s78, s3
    s_lshl_b32 s79, s78, 5
    v_add_u32 v14, s79, v14
    v_lshlrev_b32 v14, 12, v14
    v_bfe_u32 v15, v0, 4, 1
    v_lshl_add_u32 v14, v15, 5, v14
    v_lshrrev_b32 v15, 5, v0
    v_lshl_add_u32 v14, v15, 4, v14
    s_lshl_b32 s79, s77, 7
    s_add_u32 s79, s79, 2048
    v_add_u32 v246, s79, v14
    s_lshl_b32 s28, s78, 16
    s_add_u32 s28, s28, 8388608
    s_lshl_b32 s30, s76, 1
    s_add_u32 s30, s30, s86
    s_lshl_b32 s30, s30, 12
    s_add_u32 s30, s30, 12910592
    v_lshrrev_b32 v15, 1, v0
    v_lshlrev_b32 v15, 8, v15
    v_and_b32 v14, 1, v0
    v_lshl_add_u32 v247, v14, 2, v15
    s_and_b32 s78, s77, 7
    s_mov_b32 s79, 0x76543210
    s_cmp_eq_u32 s78, 1
    s_cselect_b32 s79, 0x76543201, s79
    s_cmp_eq_u32 s78, 2
    s_cselect_b32 s79, 0x76543120, s79
    s_cmp_eq_u32 s78, 3
    s_cselect_b32 s79, 0x76542310, s79
    s_cmp_eq_u32 s78, 4
    s_cselect_b32 s79, 0x76534210, s79
    s_cmp_eq_u32 s78, 5
    s_cselect_b32 s79, 0x76453210, s79
    s_cmp_eq_u32 s78, 6
    s_cselect_b32 s79, 0x75643210, s79
    s_cmp_eq_u32 s78, 7
    s_cselect_b32 s79, 0x67543210, s79
    s_and_b32 s78, s76, 3
    s_mul_i32 s78, s78, 0x22222222
    s_add_u32 s79, s79, s78
    s_bfe_u32 s78, s79, 0x30000
    s_lshl_b32 s44, s78, 18
    s_lshl_b32 s78, s78, 12
    s_add_u32 s36, s78, s28
    s_bfe_u32 s78, s79, 0x30004
    s_lshl_b32 s45, s78, 18
    s_lshl_b32 s78, s78, 12
    s_add_u32 s37, s78, s28
    s_bfe_u32 s78, s79, 0x30008
    s_lshl_b32 s46, s78, 18
    s_lshl_b32 s78, s78, 12
    s_add_u32 s38, s78, s28
    s_bfe_u32 s78, s79, 0x3000c
    s_lshl_b32 s47, s78, 18
    s_lshl_b32 s78, s78, 12
    s_add_u32 s39, s78, s28
    s_bfe_u32 s78, s79, 0x30010
    s_lshl_b32 s48, s78, 18
    s_lshl_b32 s78, s78, 12
    s_add_u32 s40, s78, s28
    s_bfe_u32 s78, s79, 0x30014
    s_lshl_b32 s49, s78, 18
    s_lshl_b32 s78, s78, 12
    s_add_u32 s41, s78, s28
    s_bfe_u32 s78, s79, 0x30018
    s_lshl_b32 s50, s78, 18
    s_lshl_b32 s78, s78, 12
    s_add_u32 s42, s78, s28
    s_bfe_u32 s78, s79, 0x3001c
    s_lshl_b32 s51, s78, 18
    s_lshl_b32 s78, s78, 12
    s_add_u32 s43, s78, s28
    s_lshl_b32 s34, s3, 10
    v_bfe_u32 v14, v0, 4, 1
    v_lshrrev_b32 v15, 5, v0
    v_lshl_add_u32 v14, v14, 1, v15
    v_and_b32 v15, 7, v0
    v_xor_b32 v14, v14, v15
    v_lshlrev_b32 v14, 4, v14
    v_and_b32 v223, 15, v0
    v_lshl_add_u32 v14, v223, 7, v14
    s_lshl_b32 s78, s3, 12
    v_add_u32 v248, s78, v14
    v_xor_b32 v249, 64, v248
    v_add_u32 v250, s78, v12
    v_lshrrev_b32 v14, 3, v0
    v_xor_b32 v15, v15, v14
    v_lshlrev_b32 v15, 4, v15
    v_lshl_add_u32 v14, v14, 12, v15
    s_lshl_b32 s78, s76, 2
    s_add_u32 s78, s78, s3
    s_lshl_b32 s78, s78, 17
    s_lshl_b32 s79, s77, 7
    s_add_u32 s78, s78, s79
    s_add_u32 s78, s78, 2048
    v_add_u32 v246, s78, v14
    s_waitcnt lgkmcnt(0)
    s_barrier
    ds_read_b64_tr_b16 v[200:201], v6 offset:1024
    ds_read_b64_tr_b16 v[202:203], v6 offset:1536
    ds_read_b64_tr_b16 v[204:205], v6 offset:13312
    ds_read_b64_tr_b16 v[206:207], v6 offset:13824
    ds_read_b128 v[152:155], v2 offset:0
    ds_read_b128 v[156:159], v3 offset:0
    ds_read_b128 v[144:147], v4 offset:6144
    ds_read_b128 v[148:151], v5 offset:6144
    ds_read_b128 v[136:139], v4 offset:4096
    ds_read_b128 v[140:143], v5 offset:4096
    ds_read_b128 v[128:131], v4 offset:2048
    ds_read_b128 v[132:135], v5 offset:2048
    ds_read_b128 v[120:123], v4 offset:0
    ds_read_b128 v[124:127], v5 offset:0
    ds_read_b64_tr_b16 v[224:225], v7 offset:1024
    ds_read_b64_tr_b16 v[226:227], v7 offset:1536
    ds_read_b64_tr_b16 v[228:229], v7 offset:13312
    ds_read_b64_tr_b16 v[230:231], v7 offset:13824
    s_waitcnt lgkmcnt(13)
    v_mfma_f32_16x16x32_bf16 v[112:115], v[200:203], v[152:155], 0
    ds_read_b64_tr_b16 v[232:233], v6 offset:0
    s_waitcnt lgkmcnt(13)
    v_mfma_f32_16x16x32_bf16 v[112:115], v[204:207], v[156:159], v[112:115]
    ds_read_b64_tr_b16 v[234:235], v6 offset:512
    s_waitcnt lgkmcnt(12)
    v_mfma_f32_16x16x32_bf16 v[72:75], v[204:207], v[148:151], 0
    ds_read_b64_tr_b16 v[236:237], v6 offset:12288
    v_mfma_f32_16x16x32_bf16 v[72:75], v[200:203], v[144:147], v[72:75]
    ds_read_b64_tr_b16 v[238:239], v6 offset:12800
    s_waitcnt lgkmcnt(13)
    v_mfma_f32_16x16x32_bf16 v[64:67], v[200:203], v[136:139], 0
    s_waitcnt lgkmcnt(12)
    v_mfma_f32_16x16x32_bf16 v[64:67], v[204:207], v[140:143], v[64:67]
    s_waitcnt lgkmcnt(10)
    v_mfma_f32_16x16x32_bf16 v[56:59], v[204:207], v[132:135], 0
    v_mfma_f32_16x16x32_bf16 v[56:59], v[200:203], v[128:131], v[56:59]
    s_waitcnt lgkmcnt(9)
    v_mfma_f32_16x16x32_bf16 v[48:51], v[200:203], v[120:123], 0
    s_waitcnt lgkmcnt(8)
    v_mfma_f32_16x16x32_bf16 v[48:51], v[204:207], v[124:127], v[48:51]
    s_waitcnt lgkmcnt(4)
    v_mfma_f32_16x16x32_bf16 v[52:55], v[228:231], v[124:127], 0
    ds_read_b64_tr_b16 v[200:201], v7 offset:0
    v_mfma_f32_16x16x32_bf16 v[52:55], v[224:227], v[120:123], v[52:55]
    ds_read_b64_tr_b16 v[202:203], v7 offset:512
    v_mfma_f32_16x16x32_bf16 v[60:63], v[224:227], v[128:131], 0
    ds_read_b64_tr_b16 v[204:205], v7 offset:12288
    v_mfma_f32_16x16x32_bf16 v[60:63], v[228:231], v[132:135], v[60:63]
    ds_read_b64_tr_b16 v[206:207], v7 offset:12800
    v_mfma_f32_16x16x32_bf16 v[68:71], v[228:231], v[140:143], 0
    v_mfma_f32_16x16x32_bf16 v[68:71], v[224:227], v[136:139], v[68:71]
    v_mfma_f32_16x16x32_bf16 v[76:79], v[224:227], v[144:147], 0
    v_mfma_f32_16x16x32_bf16 v[76:79], v[228:231], v[148:151], v[76:79]
    s_barrier
    s_waitcnt lgkmcnt(4)
    v_mfma_f32_16x16x32_bf16 v[40:43], v[236:239], v[148:151], 0
    ds_read_b64_tr_b16 v[224:225], v6 offset:2048
    ds_read_b64_tr_b16 v[226:227], v6 offset:2560
    v_mfma_f32_16x16x32_bf16 v[40:43], v[232:235], v[144:147], v[40:43]
    ds_read_b64_tr_b16 v[228:229], v6 offset:14336
    ds_read_b64_tr_b16 v[230:231], v6 offset:14848
    v_mfma_f32_16x16x32_bf16 v[32:35], v[232:235], v[136:139], 0
    ds_read_b128 v[192:195], v2 offset:18432
    ds_read_b128 v[196:199], v3 offset:18432
    v_mfma_f32_16x16x32_bf16 v[32:35], v[236:239], v[140:143], v[32:35]
    ds_read_b128 v[184:187], v4 offset:24576
    ds_read_b128 v[188:191], v5 offset:24576
    v_mfma_f32_16x16x32_bf16 v[24:27], v[236:239], v[132:135], 0
    ds_read_b128 v[176:179], v4 offset:22528
    v_mfma_f32_16x16x32_bf16 v[24:27], v[232:235], v[128:131], v[24:27]
    v_mfma_f32_16x16x32_bf16 v[16:19], v[232:235], v[120:123], 0
    v_mfma_f32_16x16x32_bf16 v[16:19], v[236:239], v[124:127], v[16:19]
    s_waitcnt lgkmcnt(9)
    v_mfma_f32_16x16x32_bf16 v[20:23], v[204:207], v[124:127], 0
    ds_read_b64_tr_b16 v[232:233], v7 offset:2048
    ds_read_b64_tr_b16 v[234:235], v7 offset:2560
    v_mfma_f32_16x16x32_bf16 v[20:23], v[200:203], v[120:123], v[20:23]
    ds_read_b64_tr_b16 v[236:237], v7 offset:14336
    ds_read_b64_tr_b16 v[238:239], v7 offset:14848
    v_mfma_f32_16x16x32_bf16 v[28:31], v[200:203], v[128:131], 0
    ds_read_b128 v[180:183], v5 offset:22528
    ds_read_b128 v[168:171], v4 offset:20480
    v_mfma_f32_16x16x32_bf16 v[28:31], v[204:207], v[132:135], v[28:31]
    ds_read_b128 v[172:175], v5 offset:20480
    ds_read_b128 v[160:163], v4 offset:18432
    v_mfma_f32_16x16x32_bf16 v[36:39], v[204:207], v[140:143], 0
    ds_read_b128 v[164:167], v5 offset:18432
    v_mfma_f32_16x16x32_bf16 v[36:39], v[200:203], v[136:139], v[36:39]
    v_mfma_f32_16x16x32_bf16 v[44:47], v[200:203], v[144:147], 0
    v_mfma_f32_16x16x32_bf16 v[44:47], v[204:207], v[148:151], v[44:47]
    s_waitcnt lgkmcnt(14)
    v_mfma_f32_16x16x32_bf16 v[116:119], v[156:159], v[228:231], 0
    v_mfma_f32_16x16x32_bf16 v[116:119], v[152:155], v[224:227], v[116:119]
    v_mfma_f32_16x16x32_bf16 v[104:107], v[144:147], v[224:227], 0
    v_mfma_f32_16x16x32_bf16 v[104:107], v[148:151], v[228:231], v[104:107]
    v_mfma_f32_16x16x32_bf16 v[96:99], v[140:143], v[228:231], 0
    v_mfma_f32_16x16x32_bf16 v[96:99], v[136:139], v[224:227], v[96:99]
    s_waitcnt vmcnt(0) lgkmcnt(0)
    s_barrier
    s_or_b32 s78, s75, s3
    s_cbranch_scc0 LB_tag
LB_tagb:
    v_mfma_f32_16x16x32_bf16 v[88:91], v[128:131], v[224:227], 0
    ds_read_b64_tr_b16 v[200:201], v6 offset:25600
    v_mfma_f32_16x16x32_bf16 v[88:91], v[132:135], v[228:231], v[88:91]
    ds_read_b64_tr_b16 v[202:203], v6 offset:26112
    v_mfma_f32_16x16x32_bf16 v[80:83], v[124:127], v[228:231], 0
    ds_read_b64_tr_b16 v[204:205], v6 offset:37888
    v_mfma_f32_16x16x32_bf16 v[80:83], v[120:123], v[224:227], v[80:83]
    ds_read_b64_tr_b16 v[206:207], v6 offset:38400
    v_mfma_f32_16x16x32_bf16 v[84:87], v[120:123], v[232:235], 0
    ds_read_b64_tr_b16 v[224:225], v7 offset:25600
    v_mfma_f32_16x16x32_bf16 v[84:87], v[124:127], v[236:239], v[84:87]
    ds_read_b64_tr_b16 v[226:227], v7 offset:26112
    v_mfma_f32_16x16x32_bf16 v[92:95], v[132:135], v[236:239], 0
    ds_read_b64_tr_b16 v[228:229], v7 offset:37888
    v_mfma_f32_16x16x32_bf16 v[92:95], v[128:131], v[232:235], v[92:95]
    ds_read_b64_tr_b16 v[230:231], v7 offset:38400
    v_mfma_f32_16x16x32_bf16 v[100:103], v[136:139], v[232:235], 0
    v_mfma_f32_16x16x32_bf16 v[100:103], v[140:143], v[236:239], v[100:103]
    v_mfma_f32_16x16x32_bf16 v[108:111], v[148:151], v[236:239], 0
    v_mfma_f32_16x16x32_bf16 v[108:111], v[144:147], v[232:235], v[108:111]
    s_waitcnt lgkmcnt(4)
    v_mfma_f32_16x16x32_bf16 v[112:115], v[200:203], v[192:195], v[112:115]
    ds_read_b64_tr_b16 v[232:233], v6 offset:24576
    v_mfma_f32_16x16x32_bf16 v[112:115], v[204:207], v[196:199], v[112:115]
    ds_read_b64_tr_b16 v[234:235], v6 offset:25088
    v_mfma_f32_16x16x32_bf16 v[72:75], v[204:207], v[188:191], v[72:75]
    ds_read_b64_tr_b16 v[236:237], v6 offset:36864
    v_mfma_f32_16x16x32_bf16 v[72:75], v[200:203], v[184:187], v[72:75]
    ds_read_b64_tr_b16 v[238:239], v6 offset:37376
    v_mfma_f32_16x16x32_bf16 v[64:67], v[200:203], v[176:179], v[64:67]
    ds_read_b128 v[152:155], v2 offset:36864
    v_mfma_f32_16x16x32_bf16 v[64:67], v[204:207], v[180:183], v[64:67]
    ds_read_b128 v[156:159], v3 offset:36864
    v_mfma_f32_16x16x32_bf16 v[56:59], v[204:207], v[172:175], v[56:59]
    ds_read_b128 v[144:147], v4 offset:43008
    v_mfma_f32_16x16x32_bf16 v[56:59], v[200:203], v[168:171], v[56:59]
    ds_read_b128 v[148:151], v5 offset:43008
    v_mfma_f32_16x16x32_bf16 v[48:51], v[200:203], v[160:163], v[48:51]
    v_mfma_f32_16x16x32_bf16 v[48:51], v[204:207], v[164:167], v[48:51]
    s_waitcnt lgkmcnt(8)
    v_mfma_f32_16x16x32_bf16 v[52:55], v[228:231], v[164:167], v[52:55]
    ds_read_b64_tr_b16 v[200:201], v7 offset:24576
    v_mfma_f32_16x16x32_bf16 v[52:55], v[224:227], v[160:163], v[52:55]
    ds_read_b64_tr_b16 v[202:203], v7 offset:25088
    v_mfma_f32_16x16x32_bf16 v[60:63], v[224:227], v[168:171], v[60:63]
    ds_read_b64_tr_b16 v[204:205], v7 offset:36864
    v_mfma_f32_16x16x32_bf16 v[60:63], v[228:231], v[172:175], v[60:63]
    ds_read_b64_tr_b16 v[206:207], v7 offset:37376
    v_mfma_f32_16x16x32_bf16 v[68:71], v[228:231], v[180:183], v[68:71]
    ds_read_b128 v[136:139], v4 offset:40960
    v_mfma_f32_16x16x32_bf16 v[68:71], v[224:227], v[176:179], v[68:71]
    ds_read_b128 v[140:143], v5 offset:40960
    v_mfma_f32_16x16x32_bf16 v[76:79], v[224:227], v[184:187], v[76:79]
    ds_read_b128 v[128:131], v4 offset:38912
    v_mfma_f32_16x16x32_bf16 v[76:79], v[228:231], v[188:191], v[76:79]
    s_waitcnt lgkmcnt(11)
    v_mfma_f32_16x16x32_bf16 v[40:43], v[236:239], v[188:191], v[40:43]
    ds_read_b64_tr_b16 v[224:225], v6 offset:26624
    v_mfma_f32_16x16x32_bf16 v[40:43], v[232:235], v[184:187], v[40:43]
    ds_read_b64_tr_b16 v[226:227], v6 offset:27136
    v_mfma_f32_16x16x32_bf16 v[32:35], v[232:235], v[176:179], v[32:35]
    ds_read_b64_tr_b16 v[228:229], v6 offset:38912
    v_mfma_f32_16x16x32_bf16 v[32:35], v[236:239], v[180:183], v[32:35]
    ds_read_b64_tr_b16 v[230:231], v6 offset:39424
    v_mfma_f32_16x16x32_bf16 v[24:27], v[236:239], v[172:175], v[24:27]
    ds_read_b128 v[132:135], v5 offset:38912
    v_mfma_f32_16x16x32_bf16 v[24:27], v[232:235], v[168:171], v[24:27]
    ds_read_b128 v[120:123], v4 offset:36864
    v_mfma_f32_16x16x32_bf16 v[16:19], v[232:235], v[160:163], v[16:19]
    ds_read_b128 v[124:127], v5 offset:36864
    v_mfma_f32_16x16x32_bf16 v[16:19], v[236:239], v[164:167], v[16:19]
    s_waitcnt lgkmcnt(10)
    v_mfma_f32_16x16x32_bf16 v[20:23], v[204:207], v[164:167], v[20:23]
    ds_read_b64_tr_b16 v[232:233], v7 offset:26624
    v_mfma_f32_16x16x32_bf16 v[20:23], v[200:203], v[160:163], v[20:23]
    ds_read_b64_tr_b16 v[234:235], v7 offset:27136
    v_mfma_f32_16x16x32_bf16 v[28:31], v[200:203], v[168:171], v[28:31]
    ds_read_b64_tr_b16 v[236:237], v7 offset:38912
    v_mfma_f32_16x16x32_bf16 v[28:31], v[204:207], v[172:175], v[28:31]
    ds_read_b64_tr_b16 v[238:239], v7 offset:39424
    v_mfma_f32_16x16x32_bf16 v[36:39], v[204:207], v[180:183], v[36:39]
    v_mfma_f32_16x16x32_bf16 v[36:39], v[200:203], v[176:179], v[36:39]
    v_mfma_f32_16x16x32_bf16 v[44:47], v[200:203], v[184:187], v[44:47]
    v_mfma_f32_16x16x32_bf16 v[44:47], v[204:207], v[188:191], v[44:47]
    s_waitcnt lgkmcnt(7)
    v_mfma_f32_16x16x32_bf16 v[116:119], v[196:199], v[228:231], v[116:119]
    v_mfma_f32_16x16x32_bf16 v[116:119], v[192:195], v[224:227], v[116:119]
    v_mfma_f32_16x16x32_bf16 v[104:107], v[184:187], v[224:227], v[104:107]
    v_mfma_f32_16x16x32_bf16 v[104:107], v[188:191], v[228:231], v[104:107]
    v_mfma_f32_16x16x32_bf16 v[96:99], v[180:183], v[228:231], v[96:99]
    v_mfma_f32_16x16x32_bf16 v[96:99], v[176:179], v[224:227], v[96:99]
    s_waitcnt lgkmcnt(0)
    s_barrier
    v_mfma_f32_16x16x32_bf16 v[88:91], v[168:171], v[224:227], v[88:91]
    ds_read_b64_tr_b16 v[200:201], v6 offset:50176
    v_mfma_f32_16x16x32_bf16 v[88:91], v[172:175], v[228:231], v[88:91]
    ds_read_b64_tr_b16 v[202:203], v6 offset:50688
    v_mfma_f32_16x16x32_bf16 v[80:83], v[164:167], v[228:231], v[80:83]
    ds_read_b64_tr_b16 v[204:205], v6 offset:62464
    v_mfma_f32_16x16x32_bf16 v[80:83], v[160:163], v[224:227], v[80:83]
    ds_read_b64_tr_b16 v[206:207], v6 offset:62976
    v_mfma_f32_16x16x32_bf16 v[84:87], v[160:163], v[232:235], v[84:87]
    ds_read_b64_tr_b16 v[224:225], v7 offset:50176
    v_mfma_f32_16x16x32_bf16 v[84:87], v[164:167], v[236:239], v[84:87]
    ds_read_b64_tr_b16 v[226:227], v7 offset:50688
    v_mfma_f32_16x16x32_bf16 v[92:95], v[172:175], v[236:239], v[92:95]
    ds_read_b64_tr_b16 v[228:229], v7 offset:62464
    v_mfma_f32_16x16x32_bf16 v[92:95], v[168:171], v[232:235], v[92:95]
    ds_read_b64_tr_b16 v[230:231], v7 offset:62976
    v_mfma_f32_16x16x32_bf16 v[100:103], v[176:179], v[232:235], v[100:103]
    v_mfma_f32_16x16x32_bf16 v[100:103], v[180:183], v[236:239], v[100:103]
    v_mfma_f32_16x16x32_bf16 v[108:111], v[188:191], v[236:239], v[108:111]
    v_mfma_f32_16x16x32_bf16 v[108:111], v[184:187], v[232:235], v[108:111]
    s_waitcnt lgkmcnt(4)
    v_mfma_f32_16x16x32_bf16 v[112:115], v[200:203], v[152:155], v[112:115]
    ds_read_b64_tr_b16 v[232:233], v6 offset:49152
    v_mfma_f32_16x16x32_bf16 v[112:115], v[204:207], v[156:159], v[112:115]
    ds_read_b64_tr_b16 v[234:235], v6 offset:49664
    v_mfma_f32_16x16x32_bf16 v[72:75], v[204:207], v[148:151], v[72:75]
    ds_read_b64_tr_b16 v[236:237], v6 offset:61440
    v_mfma_f32_16x16x32_bf16 v[72:75], v[200:203], v[144:147], v[72:75]
    ds_read_b64_tr_b16 v[238:239], v6 offset:61952
    v_mfma_f32_16x16x32_bf16 v[64:67], v[200:203], v[136:139], v[64:67]
    ds_read_b128 v[192:195], v2 offset:0
    v_mfma_f32_16x16x32_bf16 v[64:67], v[204:207], v[140:143], v[64:67]
    ds_read_b128 v[196:199], v3 offset:0
    v_mfma_f32_16x16x32_bf16 v[56:59], v[204:207], v[132:135], v[56:59]
    ds_read_b128 v[184:187], v4 offset:6144
    v_mfma_f32_16x16x32_bf16 v[56:59], v[200:203], v[128:131], v[56:59]
    ds_read_b128 v[188:191], v5 offset:6144
    v_mfma_f32_16x16x32_bf16 v[48:51], v[200:203], v[120:123], v[48:51]
    v_mfma_f32_16x16x32_bf16 v[48:51], v[204:207], v[124:127], v[48:51]
    s_waitcnt lgkmcnt(8)
    v_mfma_f32_16x16x32_bf16 v[52:55], v[228:231], v[124:127], v[52:55]
    ds_read_b64_tr_b16 v[200:201], v7 offset:49152
    v_mfma_f32_16x16x32_bf16 v[52:55], v[224:227], v[120:123], v[52:55]
    ds_read_b64_tr_b16 v[202:203], v7 offset:49664
    v_mfma_f32_16x16x32_bf16 v[60:63], v[224:227], v[128:131], v[60:63]
    ds_read_b64_tr_b16 v[204:205], v7 offset:61440
    v_mfma_f32_16x16x32_bf16 v[60:63], v[228:231], v[132:135], v[60:63]
    ds_read_b64_tr_b16 v[206:207], v7 offset:61952
    v_mfma_f32_16x16x32_bf16 v[68:71], v[228:231], v[140:143], v[68:71]
    ds_read_b128 v[176:179], v4 offset:4096
    v_mfma_f32_16x16x32_bf16 v[68:71], v[224:227], v[136:139], v[68:71]
    ds_read_b128 v[180:183], v5 offset:4096
    v_mfma_f32_16x16x32_bf16 v[76:79], v[224:227], v[144:147], v[76:79]
    ds_read_b128 v[168:171], v4 offset:2048
    v_mfma_f32_16x16x32_bf16 v[76:79], v[228:231], v[148:151], v[76:79]
    s_waitcnt lgkmcnt(11)
    v_mfma_f32_16x16x32_bf16 v[40:43], v[236:239], v[148:151], v[40:43]
    ds_read_b64_tr_b16 v[224:225], v6 offset:51200
    v_mfma_f32_16x16x32_bf16 v[40:43], v[232:235], v[144:147], v[40:43]
    ds_read_b64_tr_b16 v[226:227], v6 offset:51712
    v_mfma_f32_16x16x32_bf16 v[32:35], v[232:235], v[136:139], v[32:35]
    ds_read_b64_tr_b16 v[228:229], v6 offset:63488
    v_mfma_f32_16x16x32_bf16 v[32:35], v[236:239], v[140:143], v[32:35]
    ds_read_b64_tr_b16 v[230:231], v6 offset:64000
    v_mfma_f32_16x16x32_bf16 v[24:27], v[236:239], v[132:135], v[24:27]
    ds_read_b128 v[172:175], v5 offset:2048
    v_mfma_f32_16x16x32_bf16 v[24:27], v[232:235], v[128:131], v[24:27]
    ds_read_b128 v[160:163], v4 offset:0
    v_mfma_f32_16x16x32_bf16 v[16:19], v[232:235], v[120:123], v[16:19]
    ds_read_b128 v[164:167], v5 offset:0
    v_mfma_f32_16x16x32_bf16 v[16:19], v[236:239], v[124:127], v[16:19]
    s_waitcnt lgkmcnt(10)
    v_mfma_f32_16x16x32_bf16 v[20:23], v[204:207], v[124:127], v[20:23]
    ds_read_b64_tr_b16 v[232:233], v7 offset:51200
    v_mfma_f32_16x16x32_bf16 v[20:23], v[200:203], v[120:123], v[20:23]
    ds_read_b64_tr_b16 v[234:235], v7 offset:51712
    v_mfma_f32_16x16x32_bf16 v[28:31], v[200:203], v[128:131], v[28:31]
    ds_read_b64_tr_b16 v[236:237], v7 offset:63488
    v_mfma_f32_16x16x32_bf16 v[28:31], v[204:207], v[132:135], v[28:31]
    ds_read_b64_tr_b16 v[238:239], v7 offset:64000
    v_mfma_f32_16x16x32_bf16 v[36:39], v[204:207], v[140:143], v[36:39]
    v_mfma_f32_16x16x32_bf16 v[36:39], v[200:203], v[136:139], v[36:39]
    v_mfma_f32_16x16x32_bf16 v[44:47], v[200:203], v[144:147], v[44:47]
    v_mfma_f32_16x16x32_bf16 v[44:47], v[204:207], v[148:151], v[44:47]
    s_waitcnt lgkmcnt(7)
    v_mfma_f32_16x16x32_bf16 v[116:119], v[156:159], v[228:231], v[116:119]
    v_mfma_f32_16x16x32_bf16 v[116:119], v[152:155], v[224:227], v[116:119]
    v_mfma_f32_16x16x32_bf16 v[104:107], v[144:147], v[224:227], v[104:107]
    v_mfma_f32_16x16x32_bf16 v[104:107], v[148:151], v[228:231], v[104:107]
    v_mfma_f32_16x16x32_bf16 v[96:99], v[140:143], v[228:231], v[96:99]
    v_mfma_f32_16x16x32_bf16 v[96:99], v[136:139], v[224:227], v[96:99]
    s_waitcnt lgkmcnt(0)
    s_barrier
    v_mfma_f32_16x16x32_bf16 v[88:91], v[128:131], v[224:227], v[88:91]
    ds_read_b64_tr_b16 v[200:201], v6 offset:1024
    v_mfma_f32_16x16x32_bf16 v[88:91], v[132:135], v[228:231], v[88:91]
    ds_read_b64_tr_b16 v[202:203], v6 offset:1536
    v_mfma_f32_16x16x32_bf16 v[80:83], v[124:127], v[228:231], v[80:83]
    ds_read_b64_tr_b16 v[204:205], v6 offset:13312
    v_mfma_f32_16x16x32_bf16 v[80:83], v[120:123], v[224:227], v[80:83]
    ds_read_b64_tr_b16 v[206:207], v6 offset:13824
    v_mfma_f32_16x16x32_bf16 v[84:87], v[120:123], v[232:235], v[84:87]
    ds_read_b64_tr_b16 v[224:225], v7 offset:1024
    v_mfma_f32_16x16x32_bf16 v[84:87], v[124:127], v[236:239], v[84:87]
    ds_read_b64_tr_b16 v[226:227], v7 offset:1536
    v_mfma_f32_16x16x32_bf16 v[92:95], v[132:135], v[236:239], v[92:95]
    ds_read_b64_tr_b16 v[228:229], v7 offset:13312
    v_mfma_f32_16x16x32_bf16 v[92:95], v[128:131], v[232:235], v[92:95]
    ds_read_b64_tr_b16 v[230:231], v7 offset:13824
    v_mfma_f32_16x16x32_bf16 v[100:103], v[136:139], v[232:235], v[100:103]
    v_mfma_f32_16x16x32_bf16 v[100:103], v[140:143], v[236:239], v[100:103]
    v_mfma_f32_16x16x32_bf16 v[108:111], v[148:151], v[236:239], v[108:111]
    v_mfma_f32_16x16x32_bf16 v[108:111], v[144:147], v[232:235], v[108:111]
    s_waitcnt lgkmcnt(4)
    v_mfma_f32_16x16x32_bf16 v[112:115], v[200:203], v[192:195], v[112:115]
    ds_read_b64_tr_b16 v[232:233], v6 offset:0
    v_mfma_f32_16x16x32_bf16 v[112:115], v[204:207], v[196:199], v[112:115]
    ds_read_b64_tr_b16 v[234:235], v6 offset:512
    v_mfma_f32_16x16x32_bf16 v[72:75], v[204:207], v[188:191], v[72:75]
    ds_read_b64_tr_b16 v[236:237], v6 offset:12288
    v_mfma_f32_16x16x32_bf16 v[72:75], v[200:203], v[184:187], v[72:75]
    ds_read_b64_tr_b16 v[238:239], v6 offset:12800
    v_mfma_f32_16x16x32_bf16 v[64:67], v[200:203], v[176:179], v[64:67]
    ds_read_b128 v[152:155], v2 offset:18432
    v_mfma_f32_16x16x32_bf16 v[64:67], v[204:207], v[180:183], v[64:67]
    ds_read_b128 v[156:159], v3 offset:18432
    v_mfma_f32_16x16x32_bf16 v[56:59], v[204:207], v[172:175], v[56:59]
    ds_read_b128 v[144:147], v4 offset:24576
    v_mfma_f32_16x16x32_bf16 v[56:59], v[200:203], v[168:171], v[56:59]
    ds_read_b128 v[148:151], v5 offset:24576
    v_mfma_f32_16x16x32_bf16 v[48:51], v[200:203], v[160:163], v[48:51]
    v_mfma_f32_16x16x32_bf16 v[48:51], v[204:207], v[164:167], v[48:51]
    s_waitcnt lgkmcnt(8)
    v_mfma_f32_16x16x32_bf16 v[52:55], v[228:231], v[164:167], v[52:55]
    ds_read_b64_tr_b16 v[200:201], v7 offset:0
    v_mfma_f32_16x16x32_bf16 v[52:55], v[224:227], v[160:163], v[52:55]
    ds_read_b64_tr_b16 v[202:203], v7 offset:512
    v_mfma_f32_16x16x32_bf16 v[60:63], v[224:227], v[168:171], v[60:63]
    ds_read_b64_tr_b16 v[204:205], v7 offset:12288
    v_mfma_f32_16x16x32_bf16 v[60:63], v[228:231], v[172:175], v[60:63]
    ds_read_b64_tr_b16 v[206:207], v7 offset:12800
    v_mfma_f32_16x16x32_bf16 v[68:71], v[228:231], v[180:183], v[68:71]
    ds_read_b128 v[136:139], v4 offset:22528
    v_mfma_f32_16x16x32_bf16 v[68:71], v[224:227], v[176:179], v[68:71]
    ds_read_b128 v[140:143], v5 offset:22528
    v_mfma_f32_16x16x32_bf16 v[76:79], v[224:227], v[184:187], v[76:79]
    ds_read_b128 v[128:131], v4 offset:20480
    v_mfma_f32_16x16x32_bf16 v[76:79], v[228:231], v[188:191], v[76:79]
    s_waitcnt lgkmcnt(11)
    v_mfma_f32_16x16x32_bf16 v[40:43], v[236:239], v[188:191], v[40:43]
    ds_read_b64_tr_b16 v[224:225], v6 offset:2048
    v_mfma_f32_16x16x32_bf16 v[40:43], v[232:235], v[184:187], v[40:43]
    ds_read_b64_tr_b16 v[226:227], v6 offset:2560
    v_mfma_f32_16x16x32_bf16 v[32:35], v[232:235], v[176:179], v[32:35]
    ds_read_b64_tr_b16 v[228:229], v6 offset:14336
    v_mfma_f32_16x16x32_bf16 v[32:35], v[236:239], v[180:183], v[32:35]
    ds_read_b64_tr_b16 v[230:231], v6 offset:14848
    v_mfma_f32_16x16x32_bf16 v[24:27], v[236:239], v[172:175], v[24:27]
    ds_read_b128 v[132:135], v5 offset:20480
    v_mfma_f32_16x16x32_bf16 v[24:27], v[232:235], v[168:171], v[24:27]
    ds_read_b128 v[120:123], v4 offset:18432
    v_mfma_f32_16x16x32_bf16 v[16:19], v[232:235], v[160:163], v[16:19]
    ds_read_b128 v[124:127], v5 offset:18432
    v_mfma_f32_16x16x32_bf16 v[16:19], v[236:239], v[164:167], v[16:19]
    s_waitcnt lgkmcnt(10)
    v_mfma_f32_16x16x32_bf16 v[20:23], v[204:207], v[164:167], v[20:23]
    ds_read_b64_tr_b16 v[232:233], v7 offset:2048
    v_mfma_f32_16x16x32_bf16 v[20:23], v[200:203], v[160:163], v[20:23]
    ds_read_b64_tr_b16 v[234:235], v7 offset:2560
    v_mfma_f32_16x16x32_bf16 v[28:31], v[200:203], v[168:171], v[28:31]
    ds_read_b64_tr_b16 v[236:237], v7 offset:14336
    v_mfma_f32_16x16x32_bf16 v[28:31], v[204:207], v[172:175], v[28:31]
    ds_read_b64_tr_b16 v[238:239], v7 offset:14848
    v_mfma_f32_16x16x32_bf16 v[36:39], v[204:207], v[180:183], v[36:39]
    v_mfma_f32_16x16x32_bf16 v[36:39], v[200:203], v[176:179], v[36:39]
    v_mfma_f32_16x16x32_bf16 v[44:47], v[200:203], v[184:187], v[44:47]
    v_mfma_f32_16x16x32_bf16 v[44:47], v[204:207], v[188:191], v[44:47]
    s_waitcnt lgkmcnt(7)
    v_mfma_f32_16x16x32_bf16 v[116:119], v[196:199], v[228:231], v[116:119]
    v_mfma_f32_16x16x32_bf16 v[116:119], v[192:195], v[224:227], v[116:119]
    v_mfma_f32_16x16x32_bf16 v[104:107], v[184:187], v[224:227], v[104:107]
    v_mfma_f32_16x16x32_bf16 v[104:107], v[188:191], v[228:231], v[104:107]
    v_mfma_f32_16x16x32_bf16 v[96:99], v[180:183], v[228:231], v[96:99]
    v_mfma_f32_16x16x32_bf16 v[96:99], v[176:179], v[224:227], v[96:99]
    s_waitcnt lgkmcnt(0)
    s_barrier
    v_mfma_f32_16x16x32_bf16 v[88:91], v[168:171], v[224:227], v[88:91]
    ds_read_b64_tr_b16 v[200:201], v6 offset:25600
    v_mfma_f32_16x16x32_bf16 v[88:91], v[172:175], v[228:231], v[88:91]
    ds_read_b64_tr_b16 v[202:203], v6 offset:26112
    v_mfma_f32_16x16x32_bf16 v[80:83], v[164:167], v[228:231], v[80:83]
    ds_read_b64_tr_b16 v[204:205], v6 offset:37888
    v_mfma_f32_16x16x32_bf16 v[80:83], v[160:163], v[224:227], v[80:83]
    ds_read_b64_tr_b16 v[206:207], v6 offset:38400
    v_mfma_f32_16x16x32_bf16 v[84:87], v[160:163], v[232:235], v[84:87]
    ds_read_b64_tr_b16 v[224:225], v7 offset:25600
    v_mfma_f32_16x16x32_bf16 v[84:87], v[164:167], v[236:239], v[84:87]
    ds_read_b64_tr_b16 v[226:227], v7 offset:26112
    v_mfma_f32_16x16x32_bf16 v[92:95], v[172:175], v[236:239], v[92:95]
    ds_read_b64_tr_b16 v[228:229], v7 offset:37888
    v_mfma_f32_16x16x32_bf16 v[92:95], v[168:171], v[232:235], v[92:95]
    ds_read_b64_tr_b16 v[230:231], v7 offset:38400
    v_mfma_f32_16x16x32_bf16 v[100:103], v[176:179], v[232:235], v[100:103]
    v_mfma_f32_16x16x32_bf16 v[100:103], v[180:183], v[236:239], v[100:103]
    v_mfma_f32_16x16x32_bf16 v[108:111], v[188:191], v[236:239], v[108:111]
    v_mfma_f32_16x16x32_bf16 v[108:111], v[184:187], v[232:235], v[108:111]
    s_waitcnt lgkmcnt(4)
    v_mfma_f32_16x16x32_bf16 v[112:115], v[200:203], v[152:155], v[112:115]
    ds_read_b64_tr_b16 v[232:233], v6 offset:24576
    v_mfma_f32_16x16x32_bf16 v[112:115], v[204:207], v[156:159], v[112:115]
    ds_read_b64_tr_b16 v[234:235], v6 offset:25088
    v_mfma_f32_16x16x32_bf16 v[72:75], v[204:207], v[148:151], v[72:75]
    ds_read_b64_tr_b16 v[236:237], v6 offset:36864
    v_mfma_f32_16x16x32_bf16 v[72:75], v[200:203], v[144:147], v[72:75]
    ds_read_b64_tr_b16 v[238:239], v6 offset:37376
    v_mfma_f32_16x16x32_bf16 v[64:67], v[200:203], v[136:139], v[64:67]
    ds_read_b128 v[192:195], v2 offset:36864
    v_mfma_f32_16x16x32_bf16 v[64:67], v[204:207], v[140:143], v[64:67]
    ds_read_b128 v[196:199], v3 offset:36864
    v_mfma_f32_16x16x32_bf16 v[56:59], v[204:207], v[132:135], v[56:59]
    ds_read_b128 v[184:187], v4 offset:43008
    v_mfma_f32_16x16x32_bf16 v[56:59], v[200:203], v[128:131], v[56:59]
    ds_read_b128 v[188:191], v5 offset:43008
    v_mfma_f32_16x16x32_bf16 v[48:51], v[200:203], v[120:123], v[48:51]
    v_mfma_f32_16x16x32_bf16 v[48:51], v[204:207], v[124:127], v[48:51]
    s_waitcnt lgkmcnt(8)
    v_mfma_f32_16x16x32_bf16 v[52:55], v[228:231], v[124:127], v[52:55]
    ds_read_b64_tr_b16 v[200:201], v7 offset:24576
    v_mfma_f32_16x16x32_bf16 v[52:55], v[224:227], v[120:123], v[52:55]
    ds_read_b64_tr_b16 v[202:203], v7 offset:25088
    v_mfma_f32_16x16x32_bf16 v[60:63], v[224:227], v[128:131], v[60:63]
    ds_read_b64_tr_b16 v[204:205], v7 offset:36864
    v_mfma_f32_16x16x32_bf16 v[60:63], v[228:231], v[132:135], v[60:63]
    ds_read_b64_tr_b16 v[206:207], v7 offset:37376
    v_mfma_f32_16x16x32_bf16 v[68:71], v[228:231], v[140:143], v[68:71]
    ds_read_b128 v[176:179], v4 offset:40960
    v_mfma_f32_16x16x32_bf16 v[68:71], v[224:227], v[136:139], v[68:71]
    ds_read_b128 v[180:183], v5 offset:40960
    v_mfma_f32_16x16x32_bf16 v[76:79], v[224:227], v[144:147], v[76:79]
    ds_read_b128 v[168:171], v4 offset:38912
    v_mfma_f32_16x16x32_bf16 v[76:79], v[228:231], v[148:151], v[76:79]
    s_waitcnt lgkmcnt(11)
    v_mfma_f32_16x16x32_bf16 v[40:43], v[236:239], v[148:151], v[40:43]
    ds_read_b64_tr_b16 v[224:225], v6 offset:26624
    v_mfma_f32_16x16x32_bf16 v[40:43], v[232:235], v[144:147], v[40:43]
    ds_read_b64_tr_b16 v[226:227], v6 offset:27136
    v_mfma_f32_16x16x32_bf16 v[32:35], v[232:235], v[136:139], v[32:35]
    ds_read_b64_tr_b16 v[228:229], v6 offset:38912
    v_mfma_f32_16x16x32_bf16 v[32:35], v[236:239], v[140:143], v[32:35]
    ds_read_b64_tr_b16 v[230:231], v6 offset:39424
    v_mfma_f32_16x16x32_bf16 v[24:27], v[236:239], v[132:135], v[24:27]
    ds_read_b128 v[172:175], v5 offset:38912
    v_mfma_f32_16x16x32_bf16 v[24:27], v[232:235], v[128:131], v[24:27]
    ds_read_b128 v[160:163], v4 offset:36864
    v_mfma_f32_16x16x32_bf16 v[16:19], v[232:235], v[120:123], v[16:19]
    ds_read_b128 v[164:167], v5 offset:36864
    v_mfma_f32_16x16x32_bf16 v[16:19], v[236:239], v[124:127], v[16:19]
    s_waitcnt lgkmcnt(10)
    v_mfma_f32_16x16x32_bf16 v[20:23], v[204:207], v[124:127], v[20:23]
    ds_read_b64_tr_b16 v[232:233], v7 offset:26624
    v_mfma_f32_16x16x32_bf16 v[20:23], v[200:203], v[120:123], v[20:23]
    ds_read_b64_tr_b16 v[234:235], v7 offset:27136
    v_mfma_f32_16x16x32_bf16 v[28:31], v[200:203], v[128:131], v[28:31]
    ds_read_b64_tr_b16 v[236:237], v7 offset:38912
    v_mfma_f32_16x16x32_bf16 v[28:31], v[204:207], v[132:135], v[28:31]
    ds_read_b64_tr_b16 v[238:239], v7 offset:39424
    v_mfma_f32_16x16x32_bf16 v[36:39], v[204:207], v[140:143], v[36:39]
    v_mfma_f32_16x16x32_bf16 v[36:39], v[200:203], v[136:139], v[36:39]
    v_mfma_f32_16x16x32_bf16 v[44:47], v[200:203], v[144:147], v[44:47]
    v_mfma_f32_16x16x32_bf16 v[44:47], v[204:207], v[148:151], v[44:47]
    s_waitcnt lgkmcnt(7)
    v_mfma_f32_16x16x32_bf16 v[116:119], v[156:159], v[228:231], v[116:119]
    v_mfma_f32_16x16x32_bf16 v[116:119], v[152:155], v[224:227], v[116:119]
    v_mfma_f32_16x16x32_bf16 v[104:107], v[144:147], v[224:227], v[104:107]
    v_mfma_f32_16x16x32_bf16 v[104:107], v[148:151], v[228:231], v[104:107]
    v_mfma_f32_16x16x32_bf16 v[96:99], v[140:143], v[228:231], v[96:99]
    v_mfma_f32_16x16x32_bf16 v[96:99], v[136:139], v[224:227], v[96:99]
    s_waitcnt lgkmcnt(0)
    s_barrier
    v_mfma_f32_16x16x32_bf16 v[88:91], v[128:131], v[224:227], v[88:91]
    ds_read_b64_tr_b16 v[200:201], v6 offset:50176
    v_mfma_f32_16x16x32_bf16 v[88:91], v[132:135], v[228:231], v[88:91]
    ds_read_b64_tr_b16 v[202:203], v6 offset:50688
    v_mfma_f32_16x16x32_bf16 v[80:83], v[124:127], v[228:231], v[80:83]
    ds_read_b64_tr_b16 v[204:205], v6 offset:62464
    v_mfma_f32_16x16x32_bf16 v[80:83], v[120:123], v[224:227], v[80:83]
    ds_read_b64_tr_b16 v[206:207], v6 offset:62976
    v_mfma_f32_16x16x32_bf16 v[84:87], v[120:123], v[232:235], v[84:87]
    ds_read_b64_tr_b16 v[224:225], v7 offset:50176
    v_mfma_f32_16x16x32_bf16 v[84:87], v[124:127], v[236:239], v[84:87]
    ds_read_b64_tr_b16 v[226:227], v7 offset:50688
    v_mfma_f32_16x16x32_bf16 v[92:95], v[132:135], v[236:239], v[92:95]
    ds_read_b64_tr_b16 v[228:229], v7 offset:62464
    v_mfma_f32_16x16x32_bf16 v[92:95], v[128:131], v[232:235], v[92:95]
    ds_read_b64_tr_b16 v[230:231], v7 offset:62976
    v_mfma_f32_16x16x32_bf16 v[100:103], v[136:139], v[232:235], v[100:103]
    v_mfma_f32_16x16x32_bf16 v[100:103], v[140:143], v[236:239], v[100:103]
    v_mfma_f32_16x16x32_bf16 v[108:111], v[148:151], v[236:239], v[108:111]
    v_mfma_f32_16x16x32_bf16 v[108:111], v[144:147], v[232:235], v[108:111]
    s_waitcnt lgkmcnt(4)
    v_mfma_f32_16x16x32_bf16 v[112:115], v[200:203], v[192:195], v[112:115]
    ds_read_b64_tr_b16 v[232:233], v6 offset:49152
    v_mfma_f32_16x16x32_bf16 v[112:115], v[204:207], v[196:199], v[112:115]
    ds_read_b64_tr_b16 v[234:235], v6 offset:49664
    v_mfma_f32_16x16x32_bf16 v[72:75], v[204:207], v[188:191], v[72:75]
    ds_read_b64_tr_b16 v[236:237], v6 offset:61440
    v_mfma_f32_16x16x32_bf16 v[72:75], v[200:203], v[184:187], v[72:75]
    ds_read_b64_tr_b16 v[238:239], v6 offset:61952
    v_mfma_f32_16x16x32_bf16 v[64:67], v[200:203], v[176:179], v[64:67]
    ds_read_b128 v[152:155], v2 offset:0
    v_mfma_f32_16x16x32_bf16 v[64:67], v[204:207], v[180:183], v[64:67]
    ds_read_b128 v[156:159], v3 offset:0
    v_mfma_f32_16x16x32_bf16 v[56:59], v[204:207], v[172:175], v[56:59]
    ds_read_b128 v[144:147], v4 offset:6144
    v_mfma_f32_16x16x32_bf16 v[56:59], v[200:203], v[168:171], v[56:59]
    ds_read_b128 v[148:151], v5 offset:6144
    v_mfma_f32_16x16x32_bf16 v[48:51], v[200:203], v[160:163], v[48:51]
    v_mfma_f32_16x16x32_bf16 v[48:51], v[204:207], v[164:167], v[48:51]
    s_waitcnt lgkmcnt(8)
    v_mfma_f32_16x16x32_bf16 v[52:55], v[228:231], v[164:167], v[52:55]
    ds_read_b64_tr_b16 v[200:201], v7 offset:49152
    v_mfma_f32_16x16x32_bf16 v[52:55], v[224:227], v[160:163], v[52:55]
    ds_read_b64_tr_b16 v[202:203], v7 offset:49664
    v_mfma_f32_16x16x32_bf16 v[60:63], v[224:227], v[168:171], v[60:63]
    ds_read_b64_tr_b16 v[204:205], v7 offset:61440
    v_mfma_f32_16x16x32_bf16 v[60:63], v[228:231], v[172:175], v[60:63]
    ds_read_b64_tr_b16 v[206:207], v7 offset:61952
    v_mfma_f32_16x16x32_bf16 v[68:71], v[228:231], v[180:183], v[68:71]
    ds_read_b128 v[136:139], v4 offset:4096
    v_mfma_f32_16x16x32_bf16 v[68:71], v[224:227], v[176:179], v[68:71]
    ds_read_b128 v[140:143], v5 offset:4096
    v_mfma_f32_16x16x32_bf16 v[76:79], v[224:227], v[184:187], v[76:79]
    ds_read_b128 v[128:131], v4 offset:2048
    v_mfma_f32_16x16x32_bf16 v[76:79], v[228:231], v[188:191], v[76:79]
    s_waitcnt lgkmcnt(11)
    v_mfma_f32_16x16x32_bf16 v[40:43], v[236:239], v[188:191], v[40:43]
    ds_read_b64_tr_b16 v[224:225], v6 offset:51200
    v_mfma_f32_16x16x32_bf16 v[40:43], v[232:235], v[184:187], v[40:43]
    ds_read_b64_tr_b16 v[226:227], v6 offset:51712
    v_mfma_f32_16x16x32_bf16 v[32:35], v[232:235], v[176:179], v[32:35]
    ds_read_b64_tr_b16 v[228:229], v6 offset:63488
    v_mfma_f32_16x16x32_bf16 v[32:35], v[236:239], v[180:183], v[32:35]
    ds_read_b64_tr_b16 v[230:231], v6 offset:64000
    v_mfma_f32_16x16x32_bf16 v[24:27], v[236:239], v[172:175], v[24:27]
    ds_read_b128 v[132:135], v5 offset:2048
    v_mfma_f32_16x16x32_bf16 v[24:27], v[232:235], v[168:171], v[24:27]
    ds_read_b128 v[120:123], v4 offset:0
    v_mfma_f32_16x16x32_bf16 v[16:19], v[232:235], v[160:163], v[16:19]
    ds_read_b128 v[124:127], v5 offset:0
    v_mfma_f32_16x16x32_bf16 v[16:19], v[236:239], v[164:167], v[16:19]
    s_waitcnt lgkmcnt(10)
    v_mfma_f32_16x16x32_bf16 v[20:23], v[204:207], v[164:167], v[20:23]
    ds_read_b64_tr_b16 v[232:233], v7 offset:51200
    v_mfma_f32_16x16x32_bf16 v[20:23], v[200:203], v[160:163], v[20:23]
    ds_read_b64_tr_b16 v[234:235], v7 offset:51712
    v_mfma_f32_16x16x32_bf16 v[28:31], v[200:203], v[168:171], v[28:31]
    ds_read_b64_tr_b16 v[236:237], v7 offset:63488
    v_mfma_f32_16x16x32_bf16 v[28:31], v[204:207], v[172:175], v[28:31]
    ds_read_b64_tr_b16 v[238:239], v7 offset:64000
    v_mfma_f32_16x16x32_bf16 v[36:39], v[204:207], v[180:183], v[36:39]
    v_mfma_f32_16x16x32_bf16 v[36:39], v[200:203], v[176:179], v[36:39]
    v_mfma_f32_16x16x32_bf16 v[44:47], v[200:203], v[184:187], v[44:47]
    v_mfma_f32_16x16x32_bf16 v[44:47], v[204:207], v[188:191], v[44:47]
    s_waitcnt lgkmcnt(7)
    v_mfma_f32_16x16x32_bf16 v[116:119], v[196:199], v[228:231], v[116:119]
    v_mfma_f32_16x16x32_bf16 v[116:119], v[192:195], v[224:227], v[116:119]
    v_mfma_f32_16x16x32_bf16 v[104:107], v[184:187], v[224:227], v[104:107]
    v_mfma_f32_16x16x32_bf16 v[104:107], v[188:191], v[228:231], v[104:107]
    v_mfma_f32_16x16x32_bf16 v[96:99], v[180:183], v[228:231], v[96:99]
    v_mfma_f32_16x16x32_bf16 v[96:99], v[176:179], v[224:227], v[96:99]
    s_waitcnt lgkmcnt(0)
    s_barrier
    v_mfma_f32_16x16x32_bf16 v[88:91], v[168:171], v[224:227], v[88:91]
    ds_read_b64_tr_b16 v[200:201], v6 offset:1024
    v_mfma_f32_16x16x32_bf16 v[88:91], v[172:175], v[228:231], v[88:91]
    ds_read_b64_tr_b16 v[202:203], v6 offset:1536
    v_mfma_f32_16x16x32_bf16 v[80:83], v[164:167], v[228:231], v[80:83]
    ds_read_b64_tr_b16 v[204:205], v6 offset:13312
    v_mfma_f32_16x16x32_bf16 v[80:83], v[160:163], v[224:227], v[80:83]
    ds_read_b64_tr_b16 v[206:207], v6 offset:13824
    v_mfma_f32_16x16x32_bf16 v[84:87], v[160:163], v[232:235], v[84:87]
    ds_read_b64_tr_b16 v[224:225], v7 offset:1024
    v_mfma_f32_16x16x32_bf16 v[84:87], v[164:167], v[236:239], v[84:87]
    ds_read_b64_tr_b16 v[226:227], v7 offset:1536
    v_mfma_f32_16x16x32_bf16 v[92:95], v[172:175], v[236:239], v[92:95]
    ds_read_b64_tr_b16 v[228:229], v7 offset:13312
    v_mfma_f32_16x16x32_bf16 v[92:95], v[168:171], v[232:235], v[92:95]
    ds_read_b64_tr_b16 v[230:231], v7 offset:13824
    v_mfma_f32_16x16x32_bf16 v[100:103], v[176:179], v[232:235], v[100:103]
    v_mfma_f32_16x16x32_bf16 v[100:103], v[180:183], v[236:239], v[100:103]
    v_mfma_f32_16x16x32_bf16 v[108:111], v[188:191], v[236:239], v[108:111]
    v_mfma_f32_16x16x32_bf16 v[108:111], v[184:187], v[232:235], v[108:111]
    s_waitcnt lgkmcnt(4)
    v_mfma_f32_16x16x32_bf16 v[112:115], v[200:203], v[152:155], v[112:115]
    ds_read_b64_tr_b16 v[232:233], v6 offset:0
    v_mfma_f32_16x16x32_bf16 v[112:115], v[204:207], v[156:159], v[112:115]
    ds_read_b64_tr_b16 v[234:235], v6 offset:512
    v_mfma_f32_16x16x32_bf16 v[72:75], v[204:207], v[148:151], v[72:75]
    ds_read_b64_tr_b16 v[236:237], v6 offset:12288
    v_mfma_f32_16x16x32_bf16 v[72:75], v[200:203], v[144:147], v[72:75]
    ds_read_b64_tr_b16 v[238:239], v6 offset:12800
    v_mfma_f32_16x16x32_bf16 v[64:67], v[200:203], v[136:139], v[64:67]
    ds_read_b128 v[192:195], v2 offset:18432
    v_mfma_f32_16x16x32_bf16 v[64:67], v[204:207], v[140:143], v[64:67]
    ds_read_b128 v[196:199], v3 offset:18432
    v_mfma_f32_16x16x32_bf16 v[56:59], v[204:207], v[132:135], v[56:59]
    ds_read_b128 v[184:187], v4 offset:24576
    v_mfma_f32_16x16x32_bf16 v[56:59], v[200:203], v[128:131], v[56:59]
    ds_read_b128 v[188:191], v5 offset:24576
    v_mfma_f32_16x16x32_bf16 v[48:51], v[200:203], v[120:123], v[48:51]
    v_mfma_f32_16x16x32_bf16 v[48:51], v[204:207], v[124:127], v[48:51]
    s_waitcnt lgkmcnt(8)
    v_mfma_f32_16x16x32_bf16 v[52:55], v[228:231], v[124:127], v[52:55]
    ds_read_b64_tr_b16 v[200:201], v7 offset:0
    v_mfma_f32_16x16x32_bf16 v[52:55], v[224:227], v[120:123], v[52:55]
    ds_read_b64_tr_b16 v[202:203], v7 offset:512
    v_mfma_f32_16x16x32_bf16 v[60:63], v[224:227], v[128:131], v[60:63]
    ds_read_b64_tr_b16 v[204:205], v7 offset:12288
    v_mfma_f32_16x16x32_bf16 v[60:63], v[228:231], v[132:135], v[60:63]
    ds_read_b64_tr_b16 v[206:207], v7 offset:12800
    v_mfma_f32_16x16x32_bf16 v[68:71], v[228:231], v[140:143], v[68:71]
    ds_read_b128 v[176:179], v4 offset:22528
    v_mfma_f32_16x16x32_bf16 v[68:71], v[224:227], v[136:139], v[68:71]
    ds_read_b128 v[180:183], v5 offset:22528
    v_mfma_f32_16x16x32_bf16 v[76:79], v[224:227], v[144:147], v[76:79]
    ds_read_b128 v[168:171], v4 offset:20480
    v_mfma_f32_16x16x32_bf16 v[76:79], v[228:231], v[148:151], v[76:79]
    s_waitcnt lgkmcnt(11)
    v_mfma_f32_16x16x32_bf16 v[40:43], v[236:239], v[148:151], v[40:43]
    ds_read_b64_tr_b16 v[224:225], v6 offset:2048
    v_mfma_f32_16x16x32_bf16 v[40:43], v[232:235], v[144:147], v[40:43]
    ds_read_b64_tr_b16 v[226:227], v6 offset:2560
    v_mfma_f32_16x16x32_bf16 v[32:35], v[232:235], v[136:139], v[32:35]
    ds_read_b64_tr_b16 v[228:229], v6 offset:14336
    v_mfma_f32_16x16x32_bf16 v[32:35], v[236:239], v[140:143], v[32:35]
    ds_read_b64_tr_b16 v[230:231], v6 offset:14848
    v_mfma_f32_16x16x32_bf16 v[24:27], v[236:239], v[132:135], v[24:27]
    ds_read_b128 v[172:175], v5 offset:20480
    v_mfma_f32_16x16x32_bf16 v[24:27], v[232:235], v[128:131], v[24:27]
    ds_read_b128 v[160:163], v4 offset:18432
    v_mfma_f32_16x16x32_bf16 v[16:19], v[232:235], v[120:123], v[16:19]
    ds_read_b128 v[164:167], v5 offset:18432
    v_mfma_f32_16x16x32_bf16 v[16:19], v[236:239], v[124:127], v[16:19]
    s_waitcnt lgkmcnt(10)
    v_mfma_f32_16x16x32_bf16 v[20:23], v[204:207], v[124:127], v[20:23]
    ds_read_b64_tr_b16 v[232:233], v7 offset:2048
    v_mfma_f32_16x16x32_bf16 v[20:23], v[200:203], v[120:123], v[20:23]
    ds_read_b64_tr_b16 v[234:235], v7 offset:2560
    v_mfma_f32_16x16x32_bf16 v[28:31], v[200:203], v[128:131], v[28:31]
    ds_read_b64_tr_b16 v[236:237], v7 offset:14336
    v_mfma_f32_16x16x32_bf16 v[28:31], v[204:207], v[132:135], v[28:31]
    ds_read_b64_tr_b16 v[238:239], v7 offset:14848
    v_mfma_f32_16x16x32_bf16 v[36:39], v[204:207], v[140:143], v[36:39]
    buffer_load_dword v222, v220, s[68:71], s98 offen sc1
    v_mfma_f32_16x16x32_bf16 v[36:39], v[200:203], v[136:139], v[36:39]
    v_mfma_f32_16x16x32_bf16 v[44:47], v[200:203], v[144:147], v[44:47]
    v_mfma_f32_16x16x32_bf16 v[44:47], v[204:207], v[148:151], v[44:47]
    s_waitcnt lgkmcnt(7)
    v_mfma_f32_16x16x32_bf16 v[116:119], v[156:159], v[228:231], v[116:119]
    v_mfma_f32_16x16x32_bf16 v[116:119], v[152:155], v[224:227], v[116:119]
    v_mfma_f32_16x16x32_bf16 v[104:107], v[144:147], v[224:227], v[104:107]
    v_mfma_f32_16x16x32_bf16 v[104:107], v[148:151], v[228:231], v[104:107]
    v_mfma_f32_16x16x32_bf16 v[96:99], v[140:143], v[228:231], v[96:99]
    v_mfma_f32_16x16x32_bf16 v[96:99], v[136:139], v[224:227], v[96:99]
    s_waitcnt lgkmcnt(0)
    s_barrier
    v_mfma_f32_16x16x32_bf16 v[88:91], v[128:131], v[224:227], v[88:91]
    ds_read_b64_tr_b16 v[200:201], v6 offset:25600
    v_mfma_f32_16x16x32_bf16 v[88:91], v[132:135], v[228:231], v[88:91]
    ds_read_b64_tr_b16 v[202:203], v6 offset:26112
    v_mfma_f32_16x16x32_bf16 v[80:83], v[124:127], v[228:231], v[80:83]
    ds_read_b64_tr_b16 v[204:205], v6 offset:37888
    v_mfma_f32_16x16x32_bf16 v[80:83], v[120:123], v[224:227], v[80:83]
    ds_read_b64_tr_b16 v[206:207], v6 offset:38400
    v_mfma_f32_16x16x32_bf16 v[84:87], v[120:123], v[232:235], v[84:87]
    ds_read_b64_tr_b16 v[224:225], v7 offset:25600
    v_mfma_f32_16x16x32_bf16 v[84:87], v[124:127], v[236:239], v[84:87]
    ds_read_b64_tr_b16 v[226:227], v7 offset:26112
    v_mfma_f32_16x16x32_bf16 v[92:95], v[132:135], v[236:239], v[92:95]
    ds_read_b64_tr_b16 v[228:229], v7 offset:37888
    v_mfma_f32_16x16x32_bf16 v[92:95], v[128:131], v[232:235], v[92:95]
    ds_read_b64_tr_b16 v[230:231], v7 offset:38400
    v_mfma_f32_16x16x32_bf16 v[100:103], v[136:139], v[232:235], v[100:103]
    v_mfma_f32_16x16x32_bf16 v[100:103], v[140:143], v[236:239], v[100:103]
    v_mfma_f32_16x16x32_bf16 v[108:111], v[148:151], v[236:239], v[108:111]
    v_mfma_f32_16x16x32_bf16 v[108:111], v[144:147], v[232:235], v[108:111]
    s_waitcnt lgkmcnt(4)
    v_mfma_f32_16x16x32_bf16 v[112:115], v[200:203], v[192:195], v[112:115]
    ds_read_b64_tr_b16 v[232:233], v6 offset:24576
    v_mfma_f32_16x16x32_bf16 v[112:115], v[204:207], v[196:199], v[112:115]
    ds_read_b64_tr_b16 v[234:235], v6 offset:25088
    v_mfma_f32_16x16x32_bf16 v[72:75], v[204:207], v[188:191], v[72:75]
    ds_read_b64_tr_b16 v[236:237], v6 offset:36864
    v_mfma_f32_16x16x32_bf16 v[72:75], v[200:203], v[184:187], v[72:75]
    ds_read_b64_tr_b16 v[238:239], v6 offset:37376
    v_mfma_f32_16x16x32_bf16 v[64:67], v[200:203], v[176:179], v[64:67]
    ds_read_b128 v[152:155], v2 offset:36864
    v_mfma_f32_16x16x32_bf16 v[64:67], v[204:207], v[180:183], v[64:67]
    ds_read_b128 v[156:159], v3 offset:36864
    v_mfma_f32_16x16x32_bf16 v[56:59], v[204:207], v[172:175], v[56:59]
    ds_read_b128 v[144:147], v4 offset:43008
    v_mfma_f32_16x16x32_bf16 v[56:59], v[200:203], v[168:171], v[56:59]
    ds_read_b128 v[148:151], v5 offset:43008
    v_mfma_f32_16x16x32_bf16 v[48:51], v[200:203], v[160:163], v[48:51]
    v_mfma_f32_16x16x32_bf16 v[48:51], v[204:207], v[164:167], v[48:51]
    s_waitcnt lgkmcnt(8)
    v_mfma_f32_16x16x32_bf16 v[52:55], v[228:231], v[164:167], v[52:55]
    ds_read_b64_tr_b16 v[200:201], v7 offset:24576
    v_mfma_f32_16x16x32_bf16 v[52:55], v[224:227], v[160:163], v[52:55]
    ds_read_b64_tr_b16 v[202:203], v7 offset:25088
    v_mfma_f32_16x16x32_bf16 v[60:63], v[224:227], v[168:171], v[60:63]
    ds_read_b64_tr_b16 v[204:205], v7 offset:36864
    v_mfma_f32_16x16x32_bf16 v[60:63], v[228:231], v[172:175], v[60:63]
    ds_read_b64_tr_b16 v[206:207], v7 offset:37376
    v_mfma_f32_16x16x32_bf16 v[68:71], v[228:231], v[180:183], v[68:71]
    ds_read_b128 v[136:139], v4 offset:40960
    v_mfma_f32_16x16x32_bf16 v[68:71], v[224:227], v[176:179], v[68:71]
    ds_read_b128 v[140:143], v5 offset:40960
    v_mfma_f32_16x16x32_bf16 v[76:79], v[224:227], v[184:187], v[76:79]
    ds_read_b128 v[128:131], v4 offset:38912
    v_mfma_f32_16x16x32_bf16 v[76:79], v[228:231], v[188:191], v[76:79]
    s_waitcnt lgkmcnt(11)
    v_mfma_f32_16x16x32_bf16 v[40:43], v[236:239], v[188:191], v[40:43]
    ds_read_b64_tr_b16 v[224:225], v6 offset:26624
    v_mfma_f32_16x16x32_bf16 v[40:43], v[232:235], v[184:187], v[40:43]
    ds_read_b64_tr_b16 v[226:227], v6 offset:27136
    v_mfma_f32_16x16x32_bf16 v[32:35], v[232:235], v[176:179], v[32:35]
    ds_read_b64_tr_b16 v[228:229], v6 offset:38912
    v_mfma_f32_16x16x32_bf16 v[32:35], v[236:239], v[180:183], v[32:35]
    ds_read_b64_tr_b16 v[230:231], v6 offset:39424
    v_mfma_f32_16x16x32_bf16 v[24:27], v[236:239], v[172:175], v[24:27]
    ds_read_b128 v[132:135], v5 offset:38912
    v_mfma_f32_16x16x32_bf16 v[24:27], v[232:235], v[168:171], v[24:27]
    ds_read_b128 v[120:123], v4 offset:36864
    v_mfma_f32_16x16x32_bf16 v[16:19], v[232:235], v[160:163], v[16:19]
    ds_read_b128 v[124:127], v5 offset:36864
    v_mfma_f32_16x16x32_bf16 v[16:19], v[236:239], v[164:167], v[16:19]
    s_waitcnt lgkmcnt(10)
    v_mfma_f32_16x16x32_bf16 v[20:23], v[204:207], v[164:167], v[20:23]
    ds_read_b64_tr_b16 v[232:233], v7 offset:26624
    v_mfma_f32_16x16x32_bf16 v[20:23], v[200:203], v[160:163], v[20:23]
    ds_read_b64_tr_b16 v[234:235], v7 offset:27136
    v_mfma_f32_16x16x32_bf16 v[28:31], v[200:203], v[168:171], v[28:31]
    ds_read_b64_tr_b16 v[236:237], v7 offset:38912
    v_mfma_f32_16x16x32_bf16 v[28:31], v[204:207], v[172:175], v[28:31]
    ds_read_b64_tr_b16 v[238:239], v7 offset:39424
    v_mfma_f32_16x16x32_bf16 v[36:39], v[204:207], v[180:183], v[36:39]
    v_mfma_f32_16x16x32_bf16 v[36:39], v[200:203], v[176:179], v[36:39]
    v_mfma_f32_16x16x32_bf16 v[44:47], v[200:203], v[184:187], v[44:47]
    v_mfma_f32_16x16x32_bf16 v[44:47], v[204:207], v[188:191], v[44:47]
    s_waitcnt lgkmcnt(7)
    v_mfma_f32_16x16x32_bf16 v[116:119], v[196:199], v[228:231], v[116:119]
    v_mfma_f32_16x16x32_bf16 v[116:119], v[192:195], v[224:227], v[116:119]
    v_mfma_f32_16x16x32_bf16 v[104:107], v[184:187], v[224:227], v[104:107]
    v_mfma_f32_16x16x32_bf16 v[104:107], v[188:191], v[228:231], v[104:107]
    v_mfma_f32_16x16x32_bf16 v[96:99], v[180:183], v[228:231], v[96:99]
    v_mfma_f32_16x16x32_bf16 v[96:99], v[176:179], v[224:227], v[96:99]
    s_waitcnt lgkmcnt(0)
    s_barrier
    v_mfma_f32_16x16x32_bf16 v[88:91], v[168:171], v[224:227], v[88:91]
    ds_read_b64_tr_b16 v[200:201], v6 offset:50176
    v_mfma_f32_16x16x32_bf16 v[88:91], v[172:175], v[228:231], v[88:91]
    ds_read_b64_tr_b16 v[202:203], v6 offset:50688
    v_mfma_f32_16x16x32_bf16 v[80:83], v[164:167], v[228:231], v[80:83]
    ds_read_b64_tr_b16 v[204:205], v6 offset:62464
    v_mfma_f32_16x16x32_bf16 v[80:83], v[160:163], v[224:227], v[80:83]
    ds_read_b64_tr_b16 v[206:207], v6 offset:62976
    v_mfma_f32_16x16x32_bf16 v[84:87], v[160:163], v[232:235], v[84:87]
    ds_read_b64_tr_b16 v[224:225], v7 offset:50176
    v_mfma_f32_16x16x32_bf16 v[84:87], v[164:167], v[236:239], v[84:87]
    ds_read_b64_tr_b16 v[226:227], v7 offset:50688
    v_mfma_f32_16x16x32_bf16 v[92:95], v[172:175], v[236:239], v[92:95]
    ds_read_b64_tr_b16 v[228:229], v7 offset:62464
    v_mfma_f32_16x16x32_bf16 v[92:95], v[168:171], v[232:235], v[92:95]
    ds_read_b64_tr_b16 v[230:231], v7 offset:62976
    v_mfma_f32_16x16x32_bf16 v[100:103], v[176:179], v[232:235], v[100:103]
    v_mfma_f32_16x16x32_bf16 v[100:103], v[180:183], v[236:239], v[100:103]
    v_mfma_f32_16x16x32_bf16 v[108:111], v[188:191], v[236:239], v[108:111]
    v_mfma_f32_16x16x32_bf16 v[108:111], v[184:187], v[232:235], v[108:111]
    s_waitcnt lgkmcnt(4)
    v_mfma_f32_16x16x32_bf16 v[112:115], v[200:203], v[152:155], v[112:115]
    ds_read_b64_tr_b16 v[232:233], v6 offset:49152
    v_mfma_f32_16x16x32_bf16 v[112:115], v[204:207], v[156:159], v[112:115]
    ds_read_b64_tr_b16 v[234:235], v6 offset:49664
    v_mfma_f32_16x16x32_bf16 v[72:75], v[204:207], v[148:151], v[72:75]
    ds_read_b64_tr_b16 v[236:237], v6 offset:61440
    v_mfma_f32_16x16x32_bf16 v[72:75], v[200:203], v[144:147], v[72:75]
    ds_read_b64_tr_b16 v[238:239], v6 offset:61952
    v_mfma_f32_16x16x32_bf16 v[64:67], v[200:203], v[136:139], v[64:67]
    ds_read_b128 v[192:195], v2 offset:0
    v_mfma_f32_16x16x32_bf16 v[64:67], v[204:207], v[140:143], v[64:67]
    ds_read_b128 v[196:199], v3 offset:0
    v_mfma_f32_16x16x32_bf16 v[56:59], v[204:207], v[132:135], v[56:59]
    ds_read_b128 v[184:187], v4 offset:6144
    v_mfma_f32_16x16x32_bf16 v[56:59], v[200:203], v[128:131], v[56:59]
    ds_read_b128 v[188:191], v5 offset:6144
    v_mfma_f32_16x16x32_bf16 v[48:51], v[200:203], v[120:123], v[48:51]
    v_mfma_f32_16x16x32_bf16 v[48:51], v[204:207], v[124:127], v[48:51]
    s_waitcnt lgkmcnt(8)
    v_mfma_f32_16x16x32_bf16 v[52:55], v[228:231], v[124:127], v[52:55]
    ds_read_b64_tr_b16 v[200:201], v7 offset:49152
    v_mfma_f32_16x16x32_bf16 v[52:55], v[224:227], v[120:123], v[52:55]
    ds_read_b64_tr_b16 v[202:203], v7 offset:49664
    v_mfma_f32_16x16x32_bf16 v[60:63], v[224:227], v[128:131], v[60:63]
    ds_read_b64_tr_b16 v[204:205], v7 offset:61440
    v_mfma_f32_16x16x32_bf16 v[60:63], v[228:231], v[132:135], v[60:63]
    ds_read_b64_tr_b16 v[206:207], v7 offset:61952
    v_mfma_f32_16x16x32_bf16 v[68:71], v[228:231], v[140:143], v[68:71]
    ds_read_b128 v[176:179], v4 offset:4096
    v_mfma_f32_16x16x32_bf16 v[68:71], v[224:227], v[136:139], v[68:71]
    ds_read_b128 v[180:183], v5 offset:4096
    v_mfma_f32_16x16x32_bf16 v[76:79], v[224:227], v[144:147], v[76:79]
    ds_read_b128 v[168:171], v4 offset:2048
    v_mfma_f32_16x16x32_bf16 v[76:79], v[228:231], v[148:151], v[76:79]
    s_waitcnt lgkmcnt(11)
    v_mfma_f32_16x16x32_bf16 v[40:43], v[236:239], v[148:151], v[40:43]
    ds_read_b64_tr_b16 v[224:225], v6 offset:51200
    v_mfma_f32_16x16x32_bf16 v[40:43], v[232:235], v[144:147], v[40:43]
    ds_read_b64_tr_b16 v[226:227], v6 offset:51712
    v_mfma_f32_16x16x32_bf16 v[32:35], v[232:235], v[136:139], v[32:35]
    ds_read_b64_tr_b16 v[228:229], v6 offset:63488
    v_mfma_f32_16x16x32_bf16 v[32:35], v[236:239], v[140:143], v[32:35]
    ds_read_b64_tr_b16 v[230:231], v6 offset:64000
    v_mfma_f32_16x16x32_bf16 v[24:27], v[236:239], v[132:135], v[24:27]
    ds_read_b128 v[172:175], v5 offset:2048
    v_mfma_f32_16x16x32_bf16 v[24:27], v[232:235], v[128:131], v[24:27]
    ds_read_b128 v[160:163], v4 offset:0
    v_mfma_f32_16x16x32_bf16 v[16:19], v[232:235], v[120:123], v[16:19]
    ds_read_b128 v[164:167], v5 offset:0
    v_mfma_f32_16x16x32_bf16 v[16:19], v[236:239], v[124:127], v[16:19]
    s_waitcnt lgkmcnt(10)
    v_mfma_f32_16x16x32_bf16 v[20:23], v[204:207], v[124:127], v[20:23]
    ds_read_b64_tr_b16 v[232:233], v7 offset:51200
    v_mfma_f32_16x16x32_bf16 v[20:23], v[200:203], v[120:123], v[20:23]
    ds_read_b64_tr_b16 v[234:235], v7 offset:51712
    v_mfma_f32_16x16x32_bf16 v[28:31], v[200:203], v[128:131], v[28:31]
    ds_read_b64_tr_b16 v[236:237], v7 offset:63488
    v_mfma_f32_16x16x32_bf16 v[28:31], v[204:207], v[132:135], v[28:31]
    ds_read_b64_tr_b16 v[238:239], v7 offset:64000
    v_mfma_f32_16x16x32_bf16 v[36:39], v[204:207], v[140:143], v[36:39]
    v_mfma_f32_16x16x32_bf16 v[36:39], v[200:203], v[136:139], v[36:39]
    v_mfma_f32_16x16x32_bf16 v[44:47], v[200:203], v[144:147], v[44:47]
    v_mfma_f32_16x16x32_bf16 v[44:47], v[204:207], v[148:151], v[44:47]
    s_waitcnt lgkmcnt(7)
    v_mfma_f32_16x16x32_bf16 v[116:119], v[156:159], v[228:231], v[116:119]
    v_mfma_f32_16x16x32_bf16 v[116:119], v[152:155], v[224:227], v[116:119]
    v_mfma_f32_16x16x32_bf16 v[104:107], v[144:147], v[224:227], v[104:107]
    v_mfma_f32_16x16x32_bf16 v[104:107], v[148:151], v[228:231], v[104:107]
    v_mfma_f32_16x16x32_bf16 v[96:99], v[140:143], v[228:231], v[96:99]
    v_mfma_f32_16x16x32_bf16 v[96:99], v[136:139], v[224:227], v[96:99]
    s_waitcnt lgkmcnt(0)
    s_barrier
    s_cmp_lg_u32 s3, 0
    s_cbranch_scc1 LB_sk
    s_waitcnt vmcnt(0)
    v_cmp_eq_u32 vcc, 0, v222
    s_cbranch_vccnz LB_slow
LB_back:
    s_mov_b64 exec, 1
    buffer_store_dword v222, v220, s[52:55], s96 offen sc1
    s_mov_b64 exec, -1
LB_sk:
    v_mfma_f32_16x16x32_bf16 v[88:91], v[128:131], v[224:227], v[88:91]
    ds_read_b64_tr_b16 v[200:201], v6 offset:1024
    v_mfma_f32_16x16x32_bf16 v[88:91], v[132:135], v[228:231], v[88:91]
    ds_read_b64_tr_b16 v[202:203], v6 offset:1536
    v_mfma_f32_16x16x32_bf16 v[80:83], v[124:127], v[228:231], v[80:83]
    ds_read_b64_tr_b16 v[204:205], v6 offset:13312
    v_mfma_f32_16x16x32_bf16 v[80:83], v[120:123], v[224:227], v[80:83]
    ds_read_b64_tr_b16 v[206:207], v6 offset:13824
    v_mfma_f32_16x16x32_bf16 v[84:87], v[120:123], v[232:235], v[84:87]
    ds_read_b64_tr_b16 v[224:225], v7 offset:1024
    v_mfma_f32_16x16x32_bf16 v[84:87], v[124:127], v[236:239], v[84:87]
    ds_read_b64_tr_b16 v[226:227], v7 offset:1536
    v_mfma_f32_16x16x32_bf16 v[92:95], v[132:135], v[236:239], v[92:95]
    ds_read_b64_tr_b16 v[228:229], v7 offset:13312
    v_mfma_f32_16x16x32_bf16 v[92:95], v[128:131], v[232:235], v[92:95]
    ds_read_b64_tr_b16 v[230:231], v7 offset:13824
    v_mfma_f32_16x16x32_bf16 v[100:103], v[136:139], v[232:235], v[100:103]
    v_mfma_f32_16x16x32_bf16 v[100:103], v[140:143], v[236:239], v[100:103]
    v_mfma_f32_16x16x32_bf16 v[108:111], v[148:151], v[236:239], v[108:111]
    v_mfma_f32_16x16x32_bf16 v[108:111], v[144:147], v[232:235], v[108:111]
    s_waitcnt lgkmcnt(4)
    v_mfma_f32_16x16x32_bf16 v[112:115], v[200:203], v[192:195], v[112:115]
    ds_read_b64_tr_b16 v[232:233], v6 offset:0
    v_mfma_f32_16x16x32_bf16 v[112:115], v[204:207], v[196:199], v[112:115]
    ds_read_b64_tr_b16 v[234:235], v6 offset:512
    v_mfma_f32_16x16x32_bf16 v[72:75], v[204:207], v[188:191], v[72:75]
    ds_read_b64_tr_b16 v[236:237], v6 offset:12288
    v_mfma_f32_16x16x32_bf16 v[72:75], v[200:203], v[184:187], v[72:75]
    ds_read_b64_tr_b16 v[238:239], v6 offset:12800
    v_mfma_f32_16x16x32_bf16 v[64:67], v[200:203], v[176:179], v[64:67]
    ds_read_b128 v[152:155], v2 offset:18432
    v_mfma_f32_16x16x32_bf16 v[64:67], v[204:207], v[180:183], v[64:67]
    ds_read_b128 v[156:159], v3 offset:18432
    v_mfma_f32_16x16x32_bf16 v[56:59], v[204:207], v[172:175], v[56:59]
    ds_read_b128 v[144:147], v4 offset:24576
    v_mfma_f32_16x16x32_bf16 v[56:59], v[200:203], v[168:171], v[56:59]
    ds_read_b128 v[148:151], v5 offset:24576
    v_mfma_f32_16x16x32_bf16 v[48:51], v[200:203], v[160:163], v[48:51]
    v_mfma_f32_16x16x32_bf16 v[48:51], v[204:207], v[164:167], v[48:51]
    s_waitcnt lgkmcnt(8)
    v_mfma_f32_16x16x32_bf16 v[52:55], v[228:231], v[164:167], v[52:55]
    ds_read_b64_tr_b16 v[200:201], v7 offset:0
    v_mfma_f32_16x16x32_bf16 v[52:55], v[224:227], v[160:163], v[52:55]
    ds_read_b64_tr_b16 v[202:203], v7 offset:512
    v_mfma_f32_16x16x32_bf16 v[60:63], v[224:227], v[168:171], v[60:63]
    ds_read_b64_tr_b16 v[204:205], v7 offset:12288
    v_mfma_f32_16x16x32_bf16 v[60:63], v[228:231], v[172:175], v[60:63]
    ds_read_b64_tr_b16 v[206:207], v7 offset:12800
    v_mfma_f32_16x16x32_bf16 v[68:71], v[228:231], v[180:183], v[68:71]
    ds_read_b128 v[136:139], v4 offset:22528
    v_mfma_f32_16x16x32_bf16 v[68:71], v[224:227], v[176:179], v[68:71]
    ds_read_b128 v[140:143], v5 offset:22528
    v_mfma_f32_16x16x32_bf16 v[76:79], v[224:227], v[184:187], v[76:79]
    ds_read_b128 v[128:131], v4 offset:20480
    v_mfma_f32_16x16x32_bf16 v[76:79], v[228:231], v[188:191], v[76:79]
    s_waitcnt lgkmcnt(11)
    v_mfma_f32_16x16x32_bf16 v[40:43], v[236:239], v[188:191], v[40:43]
    ds_read_b64_tr_b16 v[224:225], v6 offset:2048
    v_mfma_f32_16x16x32_bf16 v[40:43], v[232:235], v[184:187], v[40:43]
    ds_read_b64_tr_b16 v[226:227], v6 offset:2560
    v_mfma_f32_16x16x32_bf16 v[32:35], v[232:235], v[176:179], v[32:35]
    ds_read_b64_tr_b16 v[228:229], v6 offset:14336
    v_mfma_f32_16x16x32_bf16 v[32:35], v[236:239], v[180:183], v[32:35]
    ds_read_b64_tr_b16 v[230:231], v6 offset:14848
    v_mfma_f32_16x16x32_bf16 v[24:27], v[236:239], v[172:175], v[24:27]
    ds_read_b128 v[132:135], v5 offset:20480
    v_mfma_f32_16x16x32_bf16 v[24:27], v[232:235], v[168:171], v[24:27]
    ds_read_b128 v[120:123], v4 offset:18432
    v_mfma_f32_16x16x32_bf16 v[16:19], v[232:235], v[160:163], v[16:19]
    ds_read_b128 v[124:127], v5 offset:18432
    v_mfma_f32_16x16x32_bf16 v[16:19], v[236:239], v[164:167], v[16:19]
    s_waitcnt lgkmcnt(10)
    v_mfma_f32_16x16x32_bf16 v[20:23], v[204:207], v[164:167], v[20:23]
    ds_read_b64_tr_b16 v[232:233], v7 offset:2048
    v_mfma_f32_16x16x32_bf16 v[20:23], v[200:203], v[160:163], v[20:23]
    ds_read_b64_tr_b16 v[234:235], v7 offset:2560
    v_mfma_f32_16x16x32_bf16 v[28:31], v[200:203], v[168:171], v[28:31]
    ds_read_b64_tr_b16 v[236:237], v7 offset:14336
    v_mfma_f32_16x16x32_bf16 v[28:31], v[204:207], v[172:175], v[28:31]
    ds_read_b64_tr_b16 v[238:239], v7 offset:14848
    v_mfma_f32_16x16x32_bf16 v[36:39], v[204:207], v[180:183], v[36:39]
    v_mfma_f32_16x16x32_bf16 v[36:39], v[200:203], v[176:179], v[36:39]
    v_mfma_f32_16x16x32_bf16 v[44:47], v[200:203], v[184:187], v[44:47]
    v_mfma_f32_16x16x32_bf16 v[44:47], v[204:207], v[188:191], v[44:47]
    s_waitcnt lgkmcnt(7)
    v_mfma_f32_16x16x32_bf16 v[116:119], v[196:199], v[228:231], v[116:119]
    v_mfma_f32_16x16x32_bf16 v[116:119], v[192:195], v[224:227], v[116:119]
    v_mfma_f32_16x16x32_bf16 v[104:107], v[184:187], v[224:227], v[104:107]
    v_mfma_f32_16x16x32_bf16 v[104:107], v[188:191], v[228:231], v[104:107]
    v_mfma_f32_16x16x32_bf16 v[96:99], v[180:183], v[228:231], v[96:99]
    v_mfma_f32_16x16x32_bf16 v[96:99], v[176:179], v[224:227], v[96:99]
    s_waitcnt lgkmcnt(0)
    s_barrier
    v_mfma_f32_16x16x32_bf16 v[88:91], v[168:171], v[224:227], v[88:91]
    ds_read_b64_tr_b16 v[200:201], v6 offset:25600
    v_mfma_f32_16x16x32_bf16 v[88:91], v[172:175], v[228:231], v[88:91]
    ds_read_b64_tr_b16 v[202:203], v6 offset:26112
    v_mfma_f32_16x16x32_bf16 v[80:83], v[164:167], v[228:231], v[80:83]
    ds_read_b64_tr_b16 v[204:205], v6 offset:37888
    v_mfma_f32_16x16x32_bf16 v[80:83], v[160:163], v[224:227], v[80:83]
    ds_read_b64_tr_b16 v[206:207], v6 offset:38400
    v_mfma_f32_16x16x32_bf16 v[84:87], v[160:163], v[232:235], v[84:87]
    ds_read_b64_tr_b16 v[224:225], v7 offset:25600
    v_mfma_f32_16x16x32_bf16 v[84:87], v[164:167], v[236:239], v[84:87]
    ds_read_b64_tr_b16 v[226:227], v7 offset:26112
    v_mfma_f32_16x16x32_bf16 v[92:95], v[172:175], v[236:239], v[92:95]
    ds_read_b64_tr_b16 v[228:229], v7 offset:37888
    v_mfma_f32_16x16x32_bf16 v[92:95], v[168:171], v[232:235], v[92:95]
    ds_read_b64_tr_b16 v[230:231], v7 offset:38400
    v_mfma_f32_16x16x32_bf16 v[100:103], v[176:179], v[232:235], v[100:103]
    v_mfma_f32_16x16x32_bf16 v[100:103], v[180:183], v[236:239], v[100:103]
    v_mfma_f32_16x16x32_bf16 v[108:111], v[188:191], v[236:239], v[108:111]
    v_mfma_f32_16x16x32_bf16 v[108:111], v[184:187], v[232:235], v[108:111]
    s_waitcnt lgkmcnt(4)
    v_mfma_f32_16x16x32_bf16 v[112:115], v[200:203], v[152:155], v[112:115]
    ds_read_b64_tr_b16 v[232:233], v6 offset:24576
    v_mfma_f32_16x16x32_bf16 v[112:115], v[204:207], v[156:159], v[112:115]
    ds_read_b64_tr_b16 v[234:235], v6 offset:25088
    v_mfma_f32_16x16x32_bf16 v[72:75], v[204:207], v[148:151], v[72:75]
    ds_read_b64_tr_b16 v[236:237], v6 offset:36864
    v_mfma_f32_16x16x32_bf16 v[72:75], v[200:203], v[144:147], v[72:75]
    ds_read_b64_tr_b16 v[238:239], v6 offset:37376
    v_mfma_f32_16x16x32_bf16 v[64:67], v[200:203], v[136:139], v[64:67]
    ds_read_b128 v[192:195], v2 offset:36864
    v_mfma_f32_16x16x32_bf16 v[64:67], v[204:207], v[140:143], v[64:67]
    ds_read_b128 v[196:199], v3 offset:36864
    v_mfma_f32_16x16x32_bf16 v[56:59], v[204:207], v[132:135], v[56:59]
    ds_read_b128 v[184:187], v4 offset:43008
    v_mfma_f32_16x16x32_bf16 v[56:59], v[200:203], v[128:131], v[56:59]
    ds_read_b128 v[188:191], v5 offset:43008
    v_mfma_f32_16x16x32_bf16 v[48:51], v[200:203], v[120:123], v[48:51]
    v_mfma_f32_16x16x32_bf16 v[48:51], v[204:207], v[124:127], v[48:51]
    s_waitcnt lgkmcnt(8)
    v_mfma_f32_16x16x32_bf16 v[52:55], v[228:231], v[124:127], v[52:55]
    ds_read_b64_tr_b16 v[200:201], v7 offset:24576
    v_mfma_f32_16x16x32_bf16 v[52:55], v[224:227], v[120:123], v[52:55]
    ds_read_b64_tr_b16 v[202:203], v7 offset:25088
    v_mfma_f32_16x16x32_bf16 v[60:63], v[224:227], v[128:131], v[60:63]
    ds_read_b64_tr_b16 v[204:205], v7 offset:36864
    v_mfma_f32_16x16x32_bf16 v[60:63], v[228:231], v[132:135], v[60:63]
    ds_read_b64_tr_b16 v[206:207], v7 offset:37376
    v_mfma_f32_16x16x32_bf16 v[68:71], v[228:231], v[140:143], v[68:71]
    ds_read_b128 v[176:179], v4 offset:40960
    v_mfma_f32_16x16x32_bf16 v[68:71], v[224:227], v[136:139], v[68:71]
    ds_read_b128 v[180:183], v5 offset:40960
    v_mfma_f32_16x16x32_bf16 v[76:79], v[224:227], v[144:147], v[76:79]
    ds_read_b128 v[168:171], v4 offset:38912
    v_mfma_f32_16x16x32_bf16 v[76:79], v[228:231], v[148:151], v[76:79]
    s_waitcnt lgkmcnt(11)
    v_mfma_f32_16x16x32_bf16 v[40:43], v[236:239], v[148:151], v[40:43]
    ds_read_b64_tr_b16 v[224:225], v6 offset:26624
    v_mfma_f32_16x16x32_bf16 v[40:43], v[232:235], v[144:147], v[40:43]
    ds_read_b64_tr_b16 v[226:227], v6 offset:27136
    v_mfma_f32_16x16x32_bf16 v[32:35], v[232:235], v[136:139], v[32:35]
    ds_read_b64_tr_b16 v[228:229], v6 offset:38912
    v_mfma_f32_16x16x32_bf16 v[32:35], v[236:239], v[140:143], v[32:35]
    ds_read_b64_tr_b16 v[230:231], v6 offset:39424
    v_mfma_f32_16x16x32_bf16 v[24:27], v[236:239], v[132:135], v[24:27]
    ds_read_b128 v[172:175], v5 offset:38912
    v_mfma_f32_16x16x32_bf16 v[24:27], v[232:235], v[128:131], v[24:27]
    ds_read_b128 v[160:163], v4 offset:36864
    v_mfma_f32_16x16x32_bf16 v[16:19], v[232:235], v[120:123], v[16:19]
    ds_read_b128 v[164:167], v5 offset:36864
    v_mfma_f32_16x16x32_bf16 v[16:19], v[236:239], v[124:127], v[16:19]
    s_waitcnt lgkmcnt(10)
    v_mfma_f32_16x16x32_bf16 v[20:23], v[204:207], v[124:127], v[20:23]
    ds_read_b64_tr_b16 v[232:233], v7 offset:26624
    v_mfma_f32_16x16x32_bf16 v[20:23], v[200:203], v[120:123], v[20:23]
    ds_read_b64_tr_b16 v[234:235], v7 offset:27136
    v_mfma_f32_16x16x32_bf16 v[28:31], v[200:203], v[128:131], v[28:31]
    ds_read_b64_tr_b16 v[236:237], v7 offset:38912
    v_mfma_f32_16x16x32_bf16 v[28:31], v[204:207], v[132:135], v[28:31]
    ds_read_b64_tr_b16 v[238:239], v7 offset:39424
    v_mfma_f32_16x16x32_bf16 v[36:39], v[204:207], v[140:143], v[36:39]
    v_mfma_f32_16x16x32_bf16 v[36:39], v[200:203], v[136:139], v[36:39]
    v_mfma_f32_16x16x32_bf16 v[44:47], v[200:203], v[144:147], v[44:47]
    v_mfma_f32_16x16x32_bf16 v[44:47], v[204:207], v[148:151], v[44:47]
    s_waitcnt lgkmcnt(7)
    v_mfma_f32_16x16x32_bf16 v[116:119], v[156:159], v[228:231], v[116:119]
    v_mfma_f32_16x16x32_bf16 v[116:119], v[152:155], v[224:227], v[116:119]
    v_mfma_f32_16x16x32_bf16 v[104:107], v[144:147], v[224:227], v[104:107]
    v_mfma_f32_16x16x32_bf16 v[104:107], v[148:151], v[228:231], v[104:107]
    v_mfma_f32_16x16x32_bf16 v[96:99], v[140:143], v[228:231], v[96:99]
    v_mfma_f32_16x16x32_bf16 v[96:99], v[136:139], v[224:227], v[96:99]
    s_waitcnt lgkmcnt(0)
    s_barrier
    v_mfma_f32_16x16x32_bf16 v[88:91], v[128:131], v[224:227], v[88:91]
    ds_read_b64_tr_b16 v[200:201], v6 offset:50176
    v_mfma_f32_16x16x32_bf16 v[88:91], v[132:135], v[228:231], v[88:91]
    ds_read_b64_tr_b16 v[202:203], v6 offset:50688
    v_mfma_f32_16x16x32_bf16 v[80:83], v[124:127], v[228:231], v[80:83]
    ds_read_b64_tr_b16 v[204:205], v6 offset:62464
    v_mfma_f32_16x16x32_bf16 v[80:83], v[120:123], v[224:227], v[80:83]
    ds_read_b64_tr_b16 v[206:207], v6 offset:62976
    v_mfma_f32_16x16x32_bf16 v[84:87], v[120:123], v[232:235], v[84:87]
    ds_read_b64_tr_b16 v[224:225], v7 offset:50176
    v_mfma_f32_16x16x32_bf16 v[84:87], v[124:127], v[236:239], v[84:87]
    ds_read_b64_tr_b16 v[226:227], v7 offset:50688
    v_mfma_f32_16x16x32_bf16 v[92:95], v[132:135], v[236:239], v[92:95]
    ds_read_b64_tr_b16 v[228:229], v7 offset:62464
    v_mfma_f32_16x16x32_bf16 v[92:95], v[128:131], v[232:235], v[92:95]
    ds_read_b64_tr_b16 v[230:231], v7 offset:62976
    v_mfma_f32_16x16x32_bf16 v[100:103], v[136:139], v[232:235], v[100:103]
    v_mfma_f32_16x16x32_bf16 v[100:103], v[140:143], v[236:239], v[100:103]
    v_mfma_f32_16x16x32_bf16 v[108:111], v[148:151], v[236:239], v[108:111]
    v_mfma_f32_16x16x32_bf16 v[108:111], v[144:147], v[232:235], v[108:111]
    s_waitcnt lgkmcnt(4)
    v_mfma_f32_16x16x32_bf16 v[112:115], v[200:203], v[192:195], v[112:115]
    ds_read_b64_tr_b16 v[232:233], v6 offset:49152
    v_mfma_f32_16x16x32_bf16 v[112:115], v[204:207], v[196:199], v[112:115]
    ds_read_b64_tr_b16 v[234:235], v6 offset:49664
    v_mfma_f32_16x16x32_bf16 v[72:75], v[204:207], v[188:191], v[72:75]
    ds_read_b64_tr_b16 v[236:237], v6 offset:61440
    v_mfma_f32_16x16x32_bf16 v[72:75], v[200:203], v[184:187], v[72:75]
    ds_read_b64_tr_b16 v[238:239], v6 offset:61952
    v_mfma_f32_16x16x32_bf16 v[64:67], v[200:203], v[176:179], v[64:67]
    ds_read_b128 v[152:155], v2 offset:0
    v_mfma_f32_16x16x32_bf16 v[64:67], v[204:207], v[180:183], v[64:67]
    ds_read_b128 v[156:159], v3 offset:0
    v_mfma_f32_16x16x32_bf16 v[56:59], v[204:207], v[172:175], v[56:59]
    ds_read_b128 v[144:147], v4 offset:6144
    v_mfma_f32_16x16x32_bf16 v[56:59], v[200:203], v[168:171], v[56:59]
    ds_read_b128 v[148:151], v5 offset:6144
    v_mfma_f32_16x16x32_bf16 v[48:51], v[200:203], v[160:163], v[48:51]
    v_mfma_f32_16x16x32_bf16 v[48:51], v[204:207], v[164:167], v[48:51]
    s_waitcnt lgkmcnt(8)
    v_mfma_f32_16x16x32_bf16 v[52:55], v[228:231], v[164:167], v[52:55]
    ds_read_b64_tr_b16 v[200:201], v7 offset:49152
    v_mfma_f32_16x16x32_bf16 v[52:55], v[224:227], v[160:163], v[52:55]
    ds_read_b64_tr_b16 v[202:203], v7 offset:49664
    v_mfma_f32_16x16x32_bf16 v[60:63], v[224:227], v[168:171], v[60:63]
    ds_read_b64_tr_b16 v[204:205], v7 offset:61440
    v_mfma_f32_16x16x32_bf16 v[60:63], v[228:231], v[172:175], v[60:63]
    ds_read_b64_tr_b16 v[206:207], v7 offset:61952
    v_mfma_f32_16x16x32_bf16 v[68:71], v[228:231], v[180:183], v[68:71]
    ds_read_b128 v[136:139], v4 offset:4096
    v_mfma_f32_16x16x32_bf16 v[68:71], v[224:227], v[176:179], v[68:71]
    ds_read_b128 v[140:143], v5 offset:4096
    v_mfma_f32_16x16x32_bf16 v[76:79], v[224:227], v[184:187], v[76:79]
    ds_read_b128 v[128:131], v4 offset:2048
    v_mfma_f32_16x16x32_bf16 v[76:79], v[228:231], v[188:191], v[76:79]
    s_waitcnt lgkmcnt(11)
    v_mfma_f32_16x16x32_bf16 v[40:43], v[236:239], v[188:191], v[40:43]
    ds_read_b64_tr_b16 v[224:225], v6 offset:51200
    v_mfma_f32_16x16x32_bf16 v[40:43], v[232:235], v[184:187], v[40:43]
    ds_read_b64_tr_b16 v[226:227], v6 offset:51712
    v_mfma_f32_16x16x32_bf16 v[32:35], v[232:235], v[176:179], v[32:35]
    ds_read_b64_tr_b16 v[228:229], v6 offset:63488
    v_mfma_f32_16x16x32_bf16 v[32:35], v[236:239], v[180:183], v[32:35]
    ds_read_b64_tr_b16 v[230:231], v6 offset:64000
    v_mfma_f32_16x16x32_bf16 v[24:27], v[236:239], v[172:175], v[24:27]
    ds_read_b128 v[132:135], v5 offset:2048
    v_mfma_f32_16x16x32_bf16 v[24:27], v[232:235], v[168:171], v[24:27]
    ds_read_b128 v[120:123], v4 offset:0
    v_mfma_f32_16x16x32_bf16 v[16:19], v[232:235], v[160:163], v[16:19]
    ds_read_b128 v[124:127], v5 offset:0
    v_mfma_f32_16x16x32_bf16 v[16:19], v[236:239], v[164:167], v[16:19]
    s_waitcnt lgkmcnt(10)
    v_mfma_f32_16x16x32_bf16 v[20:23], v[204:207], v[164:167], v[20:23]
    ds_read_b64_tr_b16 v[232:233], v7 offset:51200
    v_mfma_f32_16x16x32_bf16 v[20:23], v[200:203], v[160:163], v[20:23]
    ds_read_b64_tr_b16 v[234:235], v7 offset:51712
    v_mfma_f32_16x16x32_bf16 v[28:31], v[200:203], v[168:171], v[28:31]
    ds_read_b64_tr_b16 v[236:237], v7 offset:63488
    v_mfma_f32_16x16x32_bf16 v[28:31], v[204:207], v[172:175], v[28:31]
    ds_read_b64_tr_b16 v[238:239], v7 offset:64000
    v_mfma_f32_16x16x32_bf16 v[36:39], v[204:207], v[180:183], v[36:39]
    v_mfma_f32_16x16x32_bf16 v[36:39], v[200:203], v[176:179], v[36:39]
    v_mfma_f32_16x16x32_bf16 v[44:47], v[200:203], v[184:187], v[44:47]
    v_mfma_f32_16x16x32_bf16 v[44:47], v[204:207], v[188:191], v[44:47]
    s_waitcnt lgkmcnt(7)
    v_mfma_f32_16x16x32_bf16 v[116:119], v[196:199], v[228:231], v[116:119]
    v_mfma_f32_16x16x32_bf16 v[116:119], v[192:195], v[224:227], v[116:119]
    v_mfma_f32_16x16x32_bf16 v[104:107], v[184:187], v[224:227], v[104:107]
    v_mfma_f32_16x16x32_bf16 v[104:107], v[188:191], v[228:231], v[104:107]
    v_mfma_f32_16x16x32_bf16 v[96:99], v[180:183], v[228:231], v[96:99]
    v_mfma_f32_16x16x32_bf16 v[96:99], v[176:179], v[224:227], v[96:99]
    s_waitcnt lgkmcnt(0)
    s_barrier
    v_mfma_f32_16x16x32_bf16 v[88:91], v[168:171], v[224:227], v[88:91]
    ds_read_b64_tr_b16 v[200:201], v6 offset:1024
    v_mfma_f32_16x16x32_bf16 v[88:91], v[172:175], v[228:231], v[88:91]
    ds_read_b64_tr_b16 v[202:203], v6 offset:1536
    v_mfma_f32_16x16x32_bf16 v[80:83], v[164:167], v[228:231], v[80:83]
    ds_read_b64_tr_b16 v[204:205], v6 offset:13312
    v_mfma_f32_16x16x32_bf16 v[80:83], v[160:163], v[224:227], v[80:83]
    ds_read_b64_tr_b16 v[206:207], v6 offset:13824
    v_mfma_f32_16x16x32_bf16 v[84:87], v[160:163], v[232:235], v[84:87]
    ds_read_b64_tr_b16 v[224:225], v7 offset:1024
    v_mfma_f32_16x16x32_bf16 v[84:87], v[164:167], v[236:239], v[84:87]
    ds_read_b64_tr_b16 v[226:227], v7 offset:1536
    v_mfma_f32_16x16x32_bf16 v[92:95], v[172:175], v[236:239], v[92:95]
    ds_read_b64_tr_b16 v[228:229], v7 offset:13312
    v_mfma_f32_16x16x32_bf16 v[92:95], v[168:171], v[232:235], v[92:95]
    ds_read_b64_tr_b16 v[230:231], v7 offset:13824
    v_mfma_f32_16x16x32_bf16 v[100:103], v[176:179], v[232:235], v[100:103]
    v_mfma_f32_16x16x32_bf16 v[100:103], v[180:183], v[236:239], v[100:103]
    v_mfma_f32_16x16x32_bf16 v[108:111], v[188:191], v[236:239], v[108:111]
    v_mfma_f32_16x16x32_bf16 v[108:111], v[184:187], v[232:235], v[108:111]
    s_waitcnt lgkmcnt(4)
    v_mfma_f32_16x16x32_bf16 v[112:115], v[200:203], v[152:155], v[112:115]
    ds_read_b64_tr_b16 v[232:233], v6 offset:0
    v_mfma_f32_16x16x32_bf16 v[112:115], v[204:207], v[156:159], v[112:115]
    ds_read_b64_tr_b16 v[234:235], v6 offset:512
    v_mfma_f32_16x16x32_bf16 v[72:75], v[204:207], v[148:151], v[72:75]
    ds_read_b64_tr_b16 v[236:237], v6 offset:12288
    v_mfma_f32_16x16x32_bf16 v[72:75], v[200:203], v[144:147], v[72:75]
    ds_read_b64_tr_b16 v[238:239], v6 offset:12800
    v_mfma_f32_16x16x32_bf16 v[64:67], v[200:203], v[136:139], v[64:67]
    ds_read_b128 v[192:195], v2 offset:18432
    v_mfma_f32_16x16x32_bf16 v[64:67], v[204:207], v[140:143], v[64:67]
    ds_read_b128 v[196:199], v3 offset:18432
    v_mfma_f32_16x16x32_bf16 v[56:59], v[204:207], v[132:135], v[56:59]
    ds_read_b128 v[184:187], v4 offset:24576
    v_mfma_f32_16x16x32_bf16 v[56:59], v[200:203], v[128:131], v[56:59]
    ds_read_b128 v[188:191], v5 offset:24576
    v_mfma_f32_16x16x32_bf16 v[48:51], v[200:203], v[120:123], v[48:51]
    v_mfma_f32_16x16x32_bf16 v[48:51], v[204:207], v[124:127], v[48:51]
    s_waitcnt lgkmcnt(8)
    v_mfma_f32_16x16x32_bf16 v[52:55], v[228:231], v[124:127], v[52:55]
    ds_read_b64_tr_b16 v[200:201], v7 offset:0
    v_mfma_f32_16x16x32_bf16 v[52:55], v[224:227], v[120:123], v[52:55]
    ds_read_b64_tr_b16 v[202:203], v7 offset:512
    v_mfma_f32_16x16x32_bf16 v[60:63], v[224:227], v[128:131], v[60:63]
    ds_read_b64_tr_b16 v[204:205], v7 offset:12288
    v_mfma_f32_16x16x32_bf16 v[60:63], v[228:231], v[132:135], v[60:63]
    ds_read_b64_tr_b16 v[206:207], v7 offset:12800
    v_mfma_f32_16x16x32_bf16 v[68:71], v[228:231], v[140:143], v[68:71]
    ds_read_b128 v[176:179], v4 offset:22528
    v_mfma_f32_16x16x32_bf16 v[68:71], v[224:227], v[136:139], v[68:71]
    ds_read_b128 v[180:183], v5 offset:22528
    v_mfma_f32_16x16x32_bf16 v[76:79], v[224:227], v[144:147], v[76:79]
    ds_read_b128 v[168:171], v4 offset:20480
    v_mfma_f32_16x16x32_bf16 v[76:79], v[228:231], v[148:151], v[76:79]
    s_waitcnt lgkmcnt(11)
    v_mfma_f32_16x16x32_bf16 v[40:43], v[236:239], v[148:151], v[40:43]
    ds_read_b64_tr_b16 v[224:225], v6 offset:2048
    v_mfma_f32_16x16x32_bf16 v[40:43], v[232:235], v[144:147], v[40:43]
    ds_read_b64_tr_b16 v[226:227], v6 offset:2560
    v_mfma_f32_16x16x32_bf16 v[32:35], v[232:235], v[136:139], v[32:35]
    ds_read_b64_tr_b16 v[228:229], v6 offset:14336
    v_mfma_f32_16x16x32_bf16 v[32:35], v[236:239], v[140:143], v[32:35]
    ds_read_b64_tr_b16 v[230:231], v6 offset:14848
    v_mfma_f32_16x16x32_bf16 v[24:27], v[236:239], v[132:135], v[24:27]
    ds_read_b128 v[172:175], v5 offset:20480
    v_mfma_f32_16x16x32_bf16 v[24:27], v[232:235], v[128:131], v[24:27]
    ds_read_b128 v[160:163], v4 offset:18432
    v_mfma_f32_16x16x32_bf16 v[16:19], v[232:235], v[120:123], v[16:19]
    ds_read_b128 v[164:167], v5 offset:18432
    v_mfma_f32_16x16x32_bf16 v[16:19], v[236:239], v[124:127], v[16:19]
    s_waitcnt lgkmcnt(10)
    v_mfma_f32_16x16x32_bf16 v[20:23], v[204:207], v[124:127], v[20:23]
    ds_read_b64_tr_b16 v[232:233], v7 offset:2048
    v_mfma_f32_16x16x32_bf16 v[20:23], v[200:203], v[120:123], v[20:23]
    ds_read_b64_tr_b16 v[234:235], v7 offset:2560
    v_mfma_f32_16x16x32_bf16 v[28:31], v[200:203], v[128:131], v[28:31]
    ds_read_b64_tr_b16 v[236:237], v7 offset:14336
    v_mfma_f32_16x16x32_bf16 v[28:31], v[204:207], v[132:135], v[28:31]
    ds_read_b64_tr_b16 v[238:239], v7 offset:14848
    v_mfma_f32_16x16x32_bf16 v[36:39], v[204:207], v[140:143], v[36:39]
    v_mfma_f32_16x16x32_bf16 v[36:39], v[200:203], v[136:139], v[36:39]
    v_mfma_f32_16x16x32_bf16 v[44:47], v[200:203], v[144:147], v[44:47]
    v_mfma_f32_16x16x32_bf16 v[44:47], v[204:207], v[148:151], v[44:47]
    s_waitcnt lgkmcnt(7)
    v_mfma_f32_16x16x32_bf16 v[116:119], v[156:159], v[228:231], v[116:119]
    v_mfma_f32_16x16x32_bf16 v[116:119], v[152:155], v[224:227], v[116:119]
    v_mfma_f32_16x16x32_bf16 v[104:107], v[144:147], v[224:227], v[104:107]
    v_mfma_f32_16x16x32_bf16 v[104:107], v[148:151], v[228:231], v[104:107]
    v_mfma_f32_16x16x32_bf16 v[96:99], v[140:143], v[228:231], v[96:99]
    v_mfma_f32_16x16x32_bf16 v[96:99], v[136:139], v[224:227], v[96:99]
    s_waitcnt lgkmcnt(0)
    s_barrier
    v_mfma_f32_16x16x32_bf16 v[88:91], v[128:131], v[224:227], v[88:91]
    ds_read_b64_tr_b16 v[200:201], v6 offset:25600
    v_mfma_f32_16x16x32_bf16 v[88:91], v[132:135], v[228:231], v[88:91]
    ds_read_b64_tr_b16 v[202:203], v6 offset:26112
    v_mfma_f32_16x16x32_bf16 v[80:83], v[124:127], v[228:231], v[80:83]
    ds_read_b64_tr_b16 v[204:205], v6 offset:37888
    v_mfma_f32_16x16x32_bf16 v[80:83], v[120:123], v[224:227], v[80:83]
    ds_read_b64_tr_b16 v[206:207], v6 offset:38400
    v_mfma_f32_16x16x32_bf16 v[84:87], v[120:123], v[232:235], v[84:87]
    ds_read_b64_tr_b16 v[224:225], v7 offset:25600
    v_mfma_f32_16x16x32_bf16 v[84:87], v[124:127], v[236:239], v[84:87]
    ds_read_b64_tr_b16 v[226:227], v7 offset:26112
    v_mfma_f32_16x16x32_bf16 v[92:95], v[132:135], v[236:239], v[92:95]
    ds_read_b64_tr_b16 v[228:229], v7 offset:37888
    v_mfma_f32_16x16x32_bf16 v[92:95], v[128:131], v[232:235], v[92:95]
    ds_read_b64_tr_b16 v[230:231], v7 offset:38400
    v_mfma_f32_16x16x32_bf16 v[100:103], v[136:139], v[232:235], v[100:103]
    v_mfma_f32_16x16x32_bf16 v[100:103], v[140:143], v[236:239], v[100:103]
    v_mfma_f32_16x16x32_bf16 v[108:111], v[148:151], v[236:239], v[108:111]
    v_mfma_f32_16x16x32_bf16 v[108:111], v[144:147], v[232:235], v[108:111]
    s_waitcnt lgkmcnt(4)
    v_mfma_f32_16x16x32_bf16 v[112:115], v[200:203], v[192:195], v[112:115]
    ds_read_b64_tr_b16 v[232:233], v6 offset:24576
    v_mfma_f32_16x16x32_bf16 v[112:115], v[204:207], v[196:199], v[112:115]
    ds_read_b64_tr_b16 v[234:235], v6 offset:25088
    v_mfma_f32_16x16x32_bf16 v[72:75], v[204:207], v[188:191], v[72:75]
    ds_read_b64_tr_b16 v[236:237], v6 offset:36864
    v_mfma_f32_16x16x32_bf16 v[72:75], v[200:203], v[184:187], v[72:75]
    ds_read_b64_tr_b16 v[238:239], v6 offset:37376
    v_mfma_f32_16x16x32_bf16 v[64:67], v[200:203], v[176:179], v[64:67]
    ds_read_b128 v[152:155], v2 offset:36864
    v_mfma_f32_16x16x32_bf16 v[64:67], v[204:207], v[180:183], v[64:67]
    ds_read_b128 v[156:159], v3 offset:36864
    v_mfma_f32_16x16x32_bf16 v[56:59], v[204:207], v[172:175], v[56:59]
    ds_read_b128 v[144:147], v4 offset:43008
    v_mfma_f32_16x16x32_bf16 v[56:59], v[200:203], v[168:171], v[56:59]
    ds_read_b128 v[148:151], v5 offset:43008
    v_mfma_f32_16x16x32_bf16 v[48:51], v[200:203], v[160:163], v[48:51]
    v_mfma_f32_16x16x32_bf16 v[48:51], v[204:207], v[164:167], v[48:51]
    s_waitcnt lgkmcnt(8)
    v_mfma_f32_16x16x32_bf16 v[52:55], v[228:231], v[164:167], v[52:55]
    ds_read_b64_tr_b16 v[200:201], v7 offset:24576
    v_mfma_f32_16x16x32_bf16 v[52:55], v[224:227], v[160:163], v[52:55]
    ds_read_b64_tr_b16 v[202:203], v7 offset:25088
    v_mfma_f32_16x16x32_bf16 v[60:63], v[224:227], v[168:171], v[60:63]
    ds_read_b64_tr_b16 v[204:205], v7 offset:36864
    v_mfma_f32_16x16x32_bf16 v[60:63], v[228:231], v[172:175], v[60:63]
    ds_read_b64_tr_b16 v[206:207], v7 offset:37376
    v_mfma_f32_16x16x32_bf16 v[68:71], v[228:231], v[180:183], v[68:71]
    ds_read_b128 v[136:139], v4 offset:40960
    v_mfma_f32_16x16x32_bf16 v[68:71], v[224:227], v[176:179], v[68:71]
    ds_read_b128 v[140:143], v5 offset:40960
    v_mfma_f32_16x16x32_bf16 v[76:79], v[224:227], v[184:187], v[76:79]
    ds_read_b128 v[128:131], v4 offset:38912
    v_mfma_f32_16x16x32_bf16 v[76:79], v[228:231], v[188:191], v[76:79]
    s_waitcnt lgkmcnt(11)
    v_mfma_f32_16x16x32_bf16 v[40:43], v[236:239], v[188:191], v[40:43]
    ds_read_b64_tr_b16 v[224:225], v6 offset:26624
    v_mfma_f32_16x16x32_bf16 v[40:43], v[232:235], v[184:187], v[40:43]
    ds_read_b64_tr_b16 v[226:227], v6 offset:27136
    v_mfma_f32_16x16x32_bf16 v[32:35], v[232:235], v[176:179], v[32:35]
    ds_read_b64_tr_b16 v[228:229], v6 offset:38912
    v_mfma_f32_16x16x32_bf16 v[32:35], v[236:239], v[180:183], v[32:35]
    ds_read_b64_tr_b16 v[230:231], v6 offset:39424
    v_mfma_f32_16x16x32_bf16 v[24:27], v[236:239], v[172:175], v[24:27]
    ds_read_b128 v[132:135], v5 offset:38912
    v_mfma_f32_16x16x32_bf16 v[24:27], v[232:235], v[168:171], v[24:27]
    ds_read_b128 v[120:123], v4 offset:36864
    v_mfma_f32_16x16x32_bf16 v[16:19], v[232:235], v[160:163], v[16:19]
    ds_read_b128 v[124:127], v5 offset:36864
    v_mfma_f32_16x16x32_bf16 v[16:19], v[236:239], v[164:167], v[16:19]
    s_waitcnt lgkmcnt(10)
    v_mfma_f32_16x16x32_bf16 v[20:23], v[204:207], v[164:167], v[20:23]
    ds_read_b64_tr_b16 v[232:233], v7 offset:26624
    v_mfma_f32_16x16x32_bf16 v[20:23], v[200:203], v[160:163], v[20:23]
    ds_read_b64_tr_b16 v[234:235], v7 offset:27136
    v_mfma_f32_16x16x32_bf16 v[28:31], v[200:203], v[168:171], v[28:31]
    ds_read_b64_tr_b16 v[236:237], v7 offset:38912
    v_mfma_f32_16x16x32_bf16 v[28:31], v[204:207], v[172:175], v[28:31]
    ds_read_b64_tr_b16 v[238:239], v7 offset:39424
    v_mfma_f32_16x16x32_bf16 v[36:39], v[204:207], v[180:183], v[36:39]
    v_mfma_f32_16x16x32_bf16 v[36:39], v[200:203], v[176:179], v[36:39]
    v_mfma_f32_16x16x32_bf16 v[44:47], v[200:203], v[184:187], v[44:47]
    v_mfma_f32_16x16x32_bf16 v[44:47], v[204:207], v[188:191], v[44:47]
    s_waitcnt lgkmcnt(7)
    v_mfma_f32_16x16x32_bf16 v[116:119], v[196:199], v[228:231], v[116:119]
    v_mfma_f32_16x16x32_bf16 v[116:119], v[192:195], v[224:227], v[116:119]
    v_mfma_f32_16x16x32_bf16 v[104:107], v[184:187], v[224:227], v[104:107]
    v_mfma_f32_16x16x32_bf16 v[104:107], v[188:191], v[228:231], v[104:107]
    v_mfma_f32_16x16x32_bf16 v[96:99], v[180:183], v[228:231], v[96:99]
    v_mfma_f32_16x16x32_bf16 v[96:99], v[176:179], v[224:227], v[96:99]
    s_waitcnt lgkmcnt(0)
    s_barrier
    v_mfma_f32_16x16x32_bf16 v[88:91], v[168:171], v[224:227], v[88:91]
    ds_read_b64_tr_b16 v[200:201], v6 offset:50176
    v_mfma_f32_16x16x32_bf16 v[88:91], v[172:175], v[228:231], v[88:91]
    ds_read_b64_tr_b16 v[202:203], v6 offset:50688
    v_mfma_f32_16x16x32_bf16 v[80:83], v[164:167], v[228:231], v[80:83]
    ds_read_b64_tr_b16 v[204:205], v6 offset:62464
    v_mfma_f32_16x16x32_bf16 v[80:83], v[160:163], v[224:227], v[80:83]
    ds_read_b64_tr_b16 v[206:207], v6 offset:62976
    v_mfma_f32_16x16x32_bf16 v[84:87], v[160:163], v[232:235], v[84:87]
    ds_read_b64_tr_b16 v[224:225], v7 offset:50176
    v_mfma_f32_16x16x32_bf16 v[84:87], v[164:167], v[236:239], v[84:87]
    ds_read_b64_tr_b16 v[226:227], v7 offset:50688
    v_mfma_f32_16x16x32_bf16 v[92:95], v[172:175], v[236:239], v[92:95]
    ds_read_b64_tr_b16 v[228:229], v7 offset:62464
    v_mfma_f32_16x16x32_bf16 v[92:95], v[168:171], v[232:235], v[92:95]
    ds_read_b64_tr_b16 v[230:231], v7 offset:62976
    v_mfma_f32_16x16x32_bf16 v[100:103], v[176:179], v[232:235], v[100:103]
    v_mfma_f32_16x16x32_bf16 v[100:103], v[180:183], v[236:239], v[100:103]
    v_mfma_f32_16x16x32_bf16 v[108:111], v[188:191], v[236:239], v[108:111]
    v_mfma_f32_16x16x32_bf16 v[108:111], v[184:187], v[232:235], v[108:111]
    s_waitcnt lgkmcnt(4)
    v_mfma_f32_16x16x32_bf16 v[112:115], v[200:203], v[152:155], v[112:115]
    ds_read_b64_tr_b16 v[232:233], v6 offset:49152
    v_mfma_f32_16x16x32_bf16 v[112:115], v[204:207], v[156:159], v[112:115]
    ds_read_b64_tr_b16 v[234:235], v6 offset:49664
    v_mfma_f32_16x16x32_bf16 v[72:75], v[204:207], v[148:151], v[72:75]
    ds_read_b64_tr_b16 v[236:237], v6 offset:61440
    v_mfma_f32_16x16x32_bf16 v[72:75], v[200:203], v[144:147], v[72:75]
    ds_read_b64_tr_b16 v[238:239], v6 offset:61952
    v_mfma_f32_16x16x32_bf16 v[64:67], v[200:203], v[136:139], v[64:67]
    ds_read_b128 v[192:195], v2 offset:0
    v_mfma_f32_16x16x32_bf16 v[64:67], v[204:207], v[140:143], v[64:67]
    ds_read_b128 v[196:199], v3 offset:0
    v_mfma_f32_16x16x32_bf16 v[56:59], v[204:207], v[132:135], v[56:59]
    ds_read_b128 v[184:187], v4 offset:6144
    v_mfma_f32_16x16x32_bf16 v[56:59], v[200:203], v[128:131], v[56:59]
    ds_read_b128 v[188:191], v5 offset:6144
    v_mfma_f32_16x16x32_bf16 v[48:51], v[200:203], v[120:123], v[48:51]
    v_mfma_f32_16x16x32_bf16 v[48:51], v[204:207], v[124:127], v[48:51]
    s_waitcnt lgkmcnt(8)
    v_mfma_f32_16x16x32_bf16 v[52:55], v[228:231], v[124:127], v[52:55]
    ds_read_b64_tr_b16 v[200:201], v7 offset:49152
    v_mfma_f32_16x16x32_bf16 v[52:55], v[224:227], v[120:123], v[52:55]
    ds_read_b64_tr_b16 v[202:203], v7 offset:49664
    v_mfma_f32_16x16x32_bf16 v[60:63], v[224:227], v[128:131], v[60:63]
    ds_read_b64_tr_b16 v[204:205], v7 offset:61440
    v_mfma_f32_16x16x32_bf16 v[60:63], v[228:231], v[132:135], v[60:63]
    ds_read_b64_tr_b16 v[206:207], v7 offset:61952
    v_mfma_f32_16x16x32_bf16 v[68:71], v[228:231], v[140:143], v[68:71]
    ds_read_b128 v[176:179], v4 offset:4096
    v_mfma_f32_16x16x32_bf16 v[68:71], v[224:227], v[136:139], v[68:71]
    ds_read_b128 v[180:183], v5 offset:4096
    v_mfma_f32_16x16x32_bf16 v[76:79], v[224:227], v[144:147], v[76:79]
    ds_read_b128 v[168:171], v4 offset:2048
    v_mfma_f32_16x16x32_bf16 v[76:79], v[228:231], v[148:151], v[76:79]
    s_waitcnt lgkmcnt(11)
    v_mfma_f32_16x16x32_bf16 v[40:43], v[236:239], v[148:151], v[40:43]
    ds_read_b64_tr_b16 v[224:225], v6 offset:51200
    v_mfma_f32_16x16x32_bf16 v[40:43], v[232:235], v[144:147], v[40:43]
    ds_read_b64_tr_b16 v[226:227], v6 offset:51712
    v_mfma_f32_16x16x32_bf16 v[32:35], v[232:235], v[136:139], v[32:35]
    ds_read_b64_tr_b16 v[228:229], v6 offset:63488
    v_mfma_f32_16x16x32_bf16 v[32:35], v[236:239], v[140:143], v[32:35]
    ds_read_b64_tr_b16 v[230:231], v6 offset:64000
    v_mfma_f32_16x16x32_bf16 v[24:27], v[236:239], v[132:135], v[24:27]
    ds_read_b128 v[172:175], v5 offset:2048
    v_mfma_f32_16x16x32_bf16 v[24:27], v[232:235], v[128:131], v[24:27]
    ds_read_b128 v[160:163], v4 offset:0
    v_mfma_f32_16x16x32_bf16 v[16:19], v[232:235], v[120:123], v[16:19]
    ds_read_b128 v[164:167], v5 offset:0
    v_mfma_f32_16x16x32_bf16 v[16:19], v[236:239], v[124:127], v[16:19]
    s_waitcnt lgkmcnt(10)
    v_mfma_f32_16x16x32_bf16 v[20:23], v[204:207], v[124:127], v[20:23]
    ds_read_b64_tr_b16 v[232:233], v7 offset:51200
    v_mfma_f32_16x16x32_bf16 v[20:23], v[200:203], v[120:123], v[20:23]
    ds_read_b64_tr_b16 v[234:235], v7 offset:51712
    v_mfma_f32_16x16x32_bf16 v[28:31], v[200:203], v[128:131], v[28:31]
    ds_read_b64_tr_b16 v[236:237], v7 offset:63488
    v_mfma_f32_16x16x32_bf16 v[28:31], v[204:207], v[132:135], v[28:31]
    ds_read_b64_tr_b16 v[238:239], v7 offset:64000
    v_mfma_f32_16x16x32_bf16 v[36:39], v[204:207], v[140:143], v[36:39]
    v_mfma_f32_16x16x32_bf16 v[36:39], v[200:203], v[136:139], v[36:39]
    v_mfma_f32_16x16x32_bf16 v[44:47], v[200:203], v[144:147], v[44:47]
    v_mfma_f32_16x16x32_bf16 v[44:47], v[204:207], v[148:151], v[44:47]
    s_waitcnt lgkmcnt(7)
    v_mfma_f32_16x16x32_bf16 v[116:119], v[156:159], v[228:231], v[116:119]
    ds_read_b64_tr_b16 v[200:201], v6 offset:1024
    v_mfma_f32_16x16x32_bf16 v[116:119], v[152:155], v[224:227], v[116:119]
    ds_read_b64_tr_b16 v[202:203], v6 offset:1536
    v_mfma_f32_16x16x32_bf16 v[104:107], v[144:147], v[224:227], v[104:107]
    ds_read_b64_tr_b16 v[204:205], v6 offset:13312
    v_mfma_f32_16x16x32_bf16 v[104:107], v[148:151], v[228:231], v[104:107]
    ds_read_b64_tr_b16 v[206:207], v6 offset:13824
    v_mfma_f32_16x16x32_bf16 v[96:99], v[140:143], v[228:231], v[96:99]
    v_mfma_f32_16x16x32_bf16 v[96:99], v[136:139], v[224:227], v[96:99]
    v_mfma_f32_16x16x32_bf16 v[88:91], v[128:131], v[224:227], v[88:91]
    v_mfma_f32_16x16x32_bf16 v[88:91], v[132:135], v[228:231], v[88:91]
    v_mfma_f32_16x16x32_bf16 v[80:83], v[124:127], v[228:231], v[80:83]
    v_mfma_f32_16x16x32_bf16 v[80:83], v[120:123], v[224:227], v[80:83]
    s_waitcnt lgkmcnt(4)
    v_mfma_f32_16x16x32_bf16 v[84:87], v[120:123], v[232:235], v[84:87]
    ds_read_b64_tr_b16 v[224:225], v7 offset:1024
    v_mfma_f32_16x16x32_bf16 v[84:87], v[124:127], v[236:239], v[84:87]
    ds_read_b64_tr_b16 v[226:227], v7 offset:1536
    v_mfma_f32_16x16x32_bf16 v[92:95], v[132:135], v[236:239], v[92:95]
    ds_read_b64_tr_b16 v[228:229], v7 offset:13312
    v_mfma_f32_16x16x32_bf16 v[92:95], v[128:131], v[232:235], v[92:95]
    ds_read_b64_tr_b16 v[230:231], v7 offset:13824
    v_mfma_f32_16x16x32_bf16 v[100:103], v[136:139], v[232:235], v[100:103]
    v_mfma_f32_16x16x32_bf16 v[100:103], v[140:143], v[236:239], v[100:103]
    v_mfma_f32_16x16x32_bf16 v[108:111], v[148:151], v[236:239], v[108:111]
    v_mfma_f32_16x16x32_bf16 v[108:111], v[144:147], v[232:235], v[108:111]
    s_waitcnt lgkmcnt(6)
    v_mfma_f32_16x16x32_bf16 v[112:115], v[200:203], v[192:195], v[112:115]
    ds_read_b64_tr_b16 v[120:121], v6 offset:0
    ds_read_b64_tr_b16 v[122:123], v6 offset:512
    s_waitcnt lgkmcnt(6)
    v_mfma_f32_16x16x32_bf16 v[112:115], v[204:207], v[196:199], v[112:115]
    ds_read_b64_tr_b16 v[124:125], v6 offset:12288
    ds_read_b64_tr_b16 v[126:127], v6 offset:12800
    v_mfma_f32_16x16x32_bf16 v[72:75], v[204:207], v[188:191], v[72:75]
    ds_read_b64_tr_b16 v[128:129], v7 offset:0
    ds_read_b64_tr_b16 v[130:131], v7 offset:512
    v_mfma_f32_16x16x32_bf16 v[72:75], v[200:203], v[184:187], v[72:75]
    ds_read_b64_tr_b16 v[132:133], v7 offset:12288
    ds_read_b64_tr_b16 v[134:135], v7 offset:12800
    v_mfma_f32_16x16x32_bf16 v[64:67], v[200:203], v[176:179], v[64:67]
    ds_read_b64_tr_b16 v[136:137], v6 offset:2048
    ds_read_b64_tr_b16 v[138:139], v6 offset:2560
    v_mfma_f32_16x16x32_bf16 v[64:67], v[204:207], v[180:183], v[64:67]
    ds_read_b64_tr_b16 v[140:141], v6 offset:14336
    ds_read_b64_tr_b16 v[142:143], v6 offset:14848
    v_mfma_f32_16x16x32_bf16 v[56:59], v[204:207], v[172:175], v[56:59]
    ds_read_b64_tr_b16 v[144:145], v7 offset:2048
    ds_read_b64_tr_b16 v[146:147], v7 offset:2560
    v_mfma_f32_16x16x32_bf16 v[56:59], v[200:203], v[168:171], v[56:59]
    ds_read_b64_tr_b16 v[148:149], v7 offset:14336
    ds_read_b64_tr_b16 v[150:151], v7 offset:14848
    v_mfma_f32_16x16x32_bf16 v[48:51], v[200:203], v[160:163], v[48:51]
    v_cvt_pk_bf16_f32 v72, v72, v73
    v_cvt_pk_bf16_f32 v73, v74, v75
    v_mfma_f32_16x16x32_bf16 v[48:51], v[204:207], v[164:167], v[48:51]
    v_cvt_pk_bf16_f32 v64, v64, v65
    v_cvt_pk_bf16_f32 v65, v66, v67
    s_waitcnt lgkmcnt(14)
    v_mfma_f32_16x16x32_bf16 v[76:79], v[228:231], v[188:191], v[76:79]
    v_cvt_pk_bf16_f32 v56, v56, v57
    v_cvt_pk_bf16_f32 v57, v58, v59
    v_mfma_f32_16x16x32_bf16 v[76:79], v[224:227], v[184:187], v[76:79]
    v_cvt_pk_bf16_f32 v200, v112, v113
    v_cvt_pk_bf16_f32 v201, v114, v115
    v_mfma_f32_16x16x32_bf16 v[68:71], v[224:227], v[176:179], v[68:71]
    ds_write_b64 v216, v[200:201]
    ds_write_b64 v217, v[72:73]
    v_mfma_f32_16x16x32_bf16 v[68:71], v[228:231], v[180:183], v[68:71]
    v_cvt_pk_bf16_f32 v48, v48, v49
    v_cvt_pk_bf16_f32 v49, v50, v51
    v_mfma_f32_16x16x32_bf16 v[60:63], v[228:231], v[172:175], v[60:63]
    v_cvt_pk_bf16_f32 v74, v76, v77
    v_cvt_pk_bf16_f32 v75, v78, v79
    v_mfma_f32_16x16x32_bf16 v[60:63], v[224:227], v[168:171], v[60:63]
    ds_write_b64 v217, v[74:75] offset:512
    s_mov_b64 exec, 1
    ds_add_u32 v10, v11 offset:0
    s_mov_b64 exec, -1
    v_mfma_f32_16x16x32_bf16 v[52:55], v[224:227], v[160:163], v[52:55]
    v_cvt_pk_bf16_f32 v66, v68, v69
    v_cvt_pk_bf16_f32 v67, v70, v71
    v_mfma_f32_16x16x32_bf16 v[52:55], v[228:231], v[164:167], v[52:55]
    v_cvt_pk_bf16_f32 v58, v60, v61
    v_cvt_pk_bf16_f32 v59, v62, v63
    s_waitcnt lgkmcnt(14)
    v_mfma_f32_16x16x32_bf16 v[40:43], v[124:127], v[188:191], v[40:43]
    s_nop 1
    v_mfma_f32_16x16x32_bf16 v[40:43], v[120:123], v[184:187], v[40:43]
    s_nop 1
    v_mfma_f32_16x16x32_bf16 v[32:35], v[120:123], v[176:179], v[32:35]
    v_cvt_pk_bf16_f32 v50, v52, v53
    v_cvt_pk_bf16_f32 v51, v54, v55
    v_mfma_f32_16x16x32_bf16 v[32:35], v[124:127], v[180:183], v[32:35]
    s_nop 1
    v_mfma_f32_16x16x32_bf16 v[24:27], v[124:127], v[172:175], v[24:27]
    v_cvt_pk_bf16_f32 v40, v40, v41
    v_cvt_pk_bf16_f32 v41, v42, v43
    v_mfma_f32_16x16x32_bf16 v[24:27], v[120:123], v[168:171], v[24:27]
    s_nop 1
    v_mfma_f32_16x16x32_bf16 v[16:19], v[120:123], v[160:163], v[16:19]
    v_cvt_pk_bf16_f32 v32, v32, v33
    v_cvt_pk_bf16_f32 v33, v34, v35
    v_mfma_f32_16x16x32_bf16 v[16:19], v[124:127], v[164:167], v[16:19]
    s_nop 1
    s_waitcnt lgkmcnt(12)
    v_mfma_f32_16x16x32_bf16 v[44:47], v[132:135], v[188:191], v[44:47]
    v_cvt_pk_bf16_f32 v24, v24, v25
    v_cvt_pk_bf16_f32 v25, v26, v27
    v_mfma_f32_16x16x32_bf16 v[44:47], v[128:131], v[184:187], v[44:47]
    s_nop 1
    v_mfma_f32_16x16x32_bf16 v[36:39], v[128:131], v[176:179], v[36:39]
    v_cvt_pk_bf16_f32 v16, v16, v17
    v_cvt_pk_bf16_f32 v17, v18, v19
    v_mfma_f32_16x16x32_bf16 v[36:39], v[132:135], v[180:183], v[36:39]
    s_nop 1
    v_mfma_f32_16x16x32_bf16 v[28:31], v[132:135], v[172:175], v[28:31]
    v_cvt_pk_bf16_f32 v42, v44, v45
    v_cvt_pk_bf16_f32 v43, v46, v47
    v_mfma_f32_16x16x32_bf16 v[28:31], v[128:131], v[168:171], v[28:31]
    ds_read_b32 v223, v10 offset:0
    ds_read_b64 v[204:205], v218
    v_mfma_f32_16x16x32_bf16 v[20:23], v[128:131], v[160:163], v[20:23]
    ds_read_b64 v[206:207], v219
    v_cvt_pk_bf16_f32 v34, v36, v37
    v_mfma_f32_16x16x32_bf16 v[20:23], v[132:135], v[164:167], v[20:23]
    v_cvt_pk_bf16_f32 v35, v38, v39
    s_nop 0
    s_waitcnt lgkmcnt(11)
    v_mfma_f32_16x16x32_bf16 v[116:119], v[196:199], v[140:143], v[116:119]
    v_cvt_pk_bf16_f32 v26, v28, v29
    v_cvt_pk_bf16_f32 v27, v30, v31
    v_mfma_f32_16x16x32_bf16 v[116:119], v[192:195], v[136:139], v[116:119]
    s_nop 1
    v_mfma_f32_16x16x32_bf16 v[104:107], v[184:187], v[136:139], v[104:107]
    v_cvt_pk_bf16_f32 v18, v20, v21
    v_cvt_pk_bf16_f32 v19, v22, v23
    v_mfma_f32_16x16x32_bf16 v[104:107], v[188:191], v[140:143], v[104:107]
    s_nop 1
    v_mfma_f32_16x16x32_bf16 v[44:47], v[72:75], v[40:43], 0
    v_cvt_pk_bf16_f32 v202, v116, v117
    v_cvt_pk_bf16_f32 v203, v118, v119
    v_mfma_f32_16x16x32_bf16 v[76:79], v[64:67], v[40:43], 0
    s_nop 1
    v_mfma_f32_16x16x32_bf16 v[36:39], v[64:67], v[32:35], 0
    v_cvt_pk_bf16_f32 v232, v104, v105
    v_cvt_pk_bf16_f32 v233, v106, v107
    v_mfma_f32_16x16x32_bf16 v[68:71], v[56:59], v[32:35], 0
    ds_write_b64 v216, v[202:203] offset:1024
    ds_write_b64 v217, v[232:233] offset:1024
    v_mfma_f32_16x16x32_bf16 v[96:99], v[180:183], v[140:143], v[96:99]
    s_waitcnt lgkmcnt(4)
    v_cmp_gt_u32 vcc, 4, v223
    s_cbranch_vccnz LB_w1
LB_g1:
    v_mfma_f32_16x16x32_bf16 v[96:99], v[176:179], v[136:139], v[96:99]
    v_cndmask_b32 v124, v44, v45, s[88:89]
    v_cndmask_b32 v125, v76, v77, s[88:89]
    v_mfma_f32_16x16x32_bf16 v[28:31], v[56:59], v[24:27], 0
    v_cndmask_b32 v158, v125, v124, s[90:91]
    v_cndmask_b32 v126, v46, v47, s[88:89]
    v_mfma_f32_16x16x32_bf16 v[60:63], v[48:51], v[24:27], 0
    v_cndmask_b32 v127, v78, v79, s[88:89]
    v_cndmask_b32 v159, v127, v126, s[92:93]
    v_mfma_f32_16x16x32_bf16 v[20:23], v[48:51], v[16:19], 0
    v_max_f32 v123, v158, v159
    v_cndmask_b32 v124, v36, v37, s[88:89]
    v_mfma_f32_16x16x32_bf16 v[88:91], v[168:171], v[136:139], v[88:91]
    v_cndmask_b32 v125, v68, v69, s[88:89]
    v_cndmask_b32 v156, v125, v124, s[90:91]
    v_mfma_f32_16x16x32_bf16 v[88:91], v[172:175], v[140:143], v[88:91]
    v_cndmask_b32 v126, v38, v39, s[88:89]
    v_cndmask_b32 v127, v70, v71, s[88:89]
    s_waitcnt lgkmcnt(2)
    v_mfma_f32_16x16x32_bf16 v[52:55], v[204:207], v[16:19], v[212:215]
    v_cndmask_b32 v157, v127, v126, s[92:93]
    v_max_f32 v122, v156, v157
    v_mfma_f32_16x16x32_bf16 v[80:83], v[164:167], v[140:143], v[80:83]
    v_cndmask_b32 v124, v28, v29, s[88:89]
    v_cndmask_b32 v125, v60, v61, s[88:89]
    v_mfma_f32_16x16x32_bf16 v[80:83], v[160:163], v[136:139], v[80:83]
    v_cndmask_b32 v154, v125, v124, s[90:91]
    v_cndmask_b32 v126, v30, v31, s[88:89]
    v_mfma_f32_16x16x32_bf16 v[108:111], v[184:187], v[144:147], v[108:111]
    v_cndmask_b32 v127, v62, v63, s[88:89]
    v_cndmask_b32 v155, v127, v126, s[92:93]
    v_mfma_f32_16x16x32_bf16 v[108:111], v[188:191], v[148:151], v[108:111]
    v_max_f32 v121, v154, v155
    s_nop 0
    v_mfma_f32_16x16x32_bf16 v[100:103], v[180:183], v[148:151], v[100:103]
    s_nop 1
    v_mfma_f32_16x16x32_bf16 v[100:103], v[176:179], v[144:147], v[100:103]
    s_nop 1
    v_mfma_f32_16x16x32_bf16 v[92:95], v[168:171], v[144:147], v[92:95]
    v_cvt_pk_bf16_f32 v242, v108, v109
    v_cvt_pk_bf16_f32 v243, v110, v111
    v_mfma_f32_16x16x32_bf16 v[92:95], v[172:175], v[148:151], v[92:95]
    ds_write_b64 v217, v[242:243] offset:1536
    s_mov_b64 exec, 1
    ds_add_u32 v10, v11 offset:24
    s_mov_b64 exec, -1
    v_mfma_f32_16x16x32_bf16 v[84:87], v[164:167], v[148:151], v[84:87]
    v_cndmask_b32 v124, v20, v21, s[88:89]
    v_cndmask_b32 v125, v52, v53, s[88:89]
    v_mfma_f32_16x16x32_bf16 v[84:87], v[160:163], v[144:147], v[84:87]
    v_cndmask_b32 v152, v125, v124, s[90:91]
    v_cndmask_b32 v126, v22, v23, s[88:89]
    v_cndmask_b32 v127, v54, v55, s[88:89]
    v_cndmask_b32 v153, v127, v126, s[92:93]
    v_max_f32 v120, v152, v153
    s_mov_b32 s80, 0x3e8293ee
    s_add_u32 m0, s34, 36864
    s_add_u32 s35, s44, 0
    buffer_load_dwordx4 v245, s[64:67], s35 offen  lds
    v_cvt_pk_bf16_f32 v230, v96, v97
    v_permlane32_swap_b32 v122, v123
    v_permlane32_swap_b32 v120, v121
    v_max_f32 v122, v122, v123
    v_max_f32 v120, v120, v121
    v_cvt_pk_bf16_f32 v231, v98, v99
    v_cvt_pk_bf16_f32 v240, v100, v101
    v_permlane16_swap_b32 v120, v122
    v_max_f32 v120, v120, v122
    v_mul_f32 v120, s80, v120
    v_mov_b32 v122, v120
    v_cvt_pk_bf16_f32 v241, v102, v103
    v_cvt_pk_bf16_f32 v228, v88, v89
    v_permlane16_swap_b32 v120, v122
    v_mov_b32 v121, v120
    v_mov_b32 v123, v122
    s_add_u32 m0, s34, 40960
    s_add_u32 s35, s44, 65536
    buffer_load_dwordx4 v245, s[64:67], s35 offen  lds
    v_cvt_pk_bf16_f32 v229, v90, v91
    v_permlane32_swap_b32 v120, v121
    v_permlane32_swap_b32 v122, v123
    v_fma_f32 v152, v152, s80, -v120
    v_fma_f32 v153, v153, s80, -v120
    v_fma_f32 v154, v154, s80, -v121
    v_fma_f32 v155, v155, s80, -v121
    v_fma_f32 v156, v156, s80, -v122
    v_fma_f32 v157, v157, s80, -v122
    v_fma_f32 v158, v158, s80, -v123
    v_fma_f32 v159, v159, s80, -v123
    ds_read_b32 v223, v10 offset:24
    ds_read_b64 v[224:225], v218 offset:1024
    ds_read_b64 v[234:235], v219 offset:1024
    v_exp_f32 v152, v152
    v_exp_f32 v153, v153
    v_exp_f32 v154, v154
    s_add_u32 m0, s34, 45056
    s_add_u32 s35, s44, 131072
    buffer_load_dwordx4 v245, s[64:67], s35 offen  lds
    v_exp_f32 v155, v155
    v_exp_f32 v156, v156
    v_exp_f32 v157, v157
    v_exp_f32 v158, v158
    v_exp_f32 v159, v159
    v_add_f32 v120, v152, v153
    v_add_f32 v121, v154, v155
    v_add_f32 v122, v156, v157
    v_add_f32 v123, v158, v159
    v_cvt_pk_bf16_f32 v238, v92, v93
    s_nop 0
    v_permlane32_swap_b32 v122, v123
    v_permlane32_swap_b32 v120, v121
    v_add_f32 v122, v122, v123
    v_add_f32 v120, v120, v121
    v_cvt_pk_bf16_f32 v239, v94, v95
    v_cvt_pk_bf16_f32 v226, v80, v81
    s_add_u32 m0, s34, 49152
    s_add_u32 s35, s44, 196608
    buffer_load_dwordx4 v245, s[64:67], s35 offen  lds
    v_permlane16_swap_b32 v120, v122
    v_add_f32 v120, v120, v122
    v_rcp_f32 v120, v120
    s_nop 0
    v_mov_b32 v122, v120
    v_cvt_pk_bf16_f32 v227, v82, v83
    v_cvt_pk_bf16_f32 v236, v84, v85
    v_permlane16_swap_b32 v120, v122
    v_mov_b32 v121, v120
    v_mov_b32 v123, v122
    v_cvt_pk_bf16_f32 v237, v86, v87
    v_permlane32_swap_b32 v120, v121
    v_permlane32_swap_b32 v122, v123
    s_waitcnt lgkmcnt(2)
    v_cmp_gt_u32 vcc, 4, v223
    s_cbranch_vccnz LB_w6
LB_g6:
    v_mul_f32 v152, v152, v120
    v_mul_f32 v153, v153, v120
    v_cvt_pk_bf16_f32 v152, v152, v153
    v_perm_b32 v160, v152, v152, v208
    s_add_u32 m0, s34, 53248
    s_add_u32 s35, s45, 0
    buffer_load_dwordx4 v245, s[64:67], s35 offen  lds
    v_perm_b32 v161, v152, v152, v209
    v_perm_b32 v162, v152, v152, v210
    v_perm_b32 v163, v152, v152, v211
    v_mul_f32 v154, v154, v121
    v_mul_f32 v155, v155, v121
    v_cvt_pk_bf16_f32 v154, v154, v155
    v_perm_b32 v164, v154, v154, v208
    v_perm_b32 v165, v154, v154, v209
    v_perm_b32 v166, v154, v154, v210
    v_perm_b32 v167, v154, v154, v211
    s_waitcnt lgkmcnt(1)
    v_mfma_f32_16x16x32_bf16 v[16:19], v[224:227], v[160:163], 0
    s_waitcnt lgkmcnt(0)
    v_mfma_f32_16x16x32_bf16 v[20:23], v[234:237], v[160:163], 0
    v_mul_f32 v156, v156, v122
    v_mul_f32 v157, v157, v122
    v_cvt_pk_bf16_f32 v156, v156, v157
    v_perm_b32 v168, v156, v156, v208
    s_add_u32 m0, s34, 57344
    s_add_u32 s35, s45, 65536
    buffer_load_dwordx4 v245, s[64:67], s35 offen  lds
    v_perm_b32 v169, v156, v156, v209
    v_perm_b32 v170, v156, v156, v210
    v_perm_b32 v171, v156, v156, v211
    v_mfma_f32_16x16x32_bf16 v[24:27], v[226:229], v[164:167], 0
    v_mfma_f32_16x16x32_bf16 v[28:31], v[236:239], v[164:167], 0
    v_mul_f32 v158, v158, v123
    v_mul_f32 v159, v159, v123
    v_cvt_pk_bf16_f32 v158, v158, v159
    v_perm_b32 v172, v158, v158, v208
    v_perm_b32 v173, v158, v158, v209
    v_perm_b32 v174, v158, v158, v210
    v_perm_b32 v175, v158, v158, v211
    v_mfma_f32_16x16x32_bf16 v[32:35], v[228:231], v[168:171], 0
    v_mfma_f32_16x16x32_bf16 v[36:39], v[238:241], v[168:171], 0
    v_mfma_f32_16x16x32_bf16 v[40:43], v[230:233], v[172:175], 0
    v_mfma_f32_16x16x32_bf16 v[44:47], v[240:243], v[172:175], 0
    v_cvt_pk_bf16_f32 v80, v16, v17
    v_cvt_pk_bf16_f32 v81, v18, v19
    v_cvt_pk_bf16_f32 v82, v20, v21
    v_cvt_pk_bf16_f32 v83, v22, v23
    s_add_u32 s95, s94, 0
    buffer_store_dwordx4 v[80:83], v12, s[52:55], s95 offen sc1
    v_cvt_pk_bf16_f32 v84, v24, v25
    v_cvt_pk_bf16_f32 v85, v26, v27
    v_cvt_pk_bf16_f32 v86, v28, v29
    v_cvt_pk_bf16_f32 v87, v30, v31
    s_add_u32 s95, s94, 32768
    buffer_store_dwordx4 v[84:87], v12, s[52:55], s95 offen sc1
    v_cvt_pk_bf16_f32 v88, v32, v33
    v_cvt_pk_bf16_f32 v89, v34, v35
    v_cvt_pk_bf16_f32 v90, v36, v37
    v_cvt_pk_bf16_f32 v91, v38, v39
    s_add_u32 s95, s94, 65536
    buffer_store_dwordx4 v[88:91], v12, s[52:55], s95 offen sc1
    v_cvt_pk_bf16_f32 v92, v40, v41
    v_cvt_pk_bf16_f32 v93, v42, v43
    v_cvt_pk_bf16_f32 v94, v44, v45
    v_cvt_pk_bf16_f32 v95, v46, v47
    s_add_u32 s95, s94, 98304
    buffer_store_dwordx4 v[92:95], v12, s[52:55], s95 offen sc1
    s_add_u32 m0, s34, 61440
    s_add_u32 s35, s45, 131072
    buffer_load_dwordx4 v245, s[64:67], s35 offen  lds
    v_xor_b32 v2, 0, v244
    v_xor_b32 v3, 32, v244
    v_xor_b32 v4, 64, v244
    v_xor_b32 v5, 96, v244
    s_add_u32 m0, s34, 65536
    s_add_u32 s35, s45, 196608
    buffer_load_dwordx4 v245, s[64:67], s35 offen  lds
    v_xor_b32 v6, 2048, v244
    v_xor_b32 v7, 2080, v244
    v_xor_b32 v8, 2112, v244
    v_xor_b32 v9, 2144, v244
    s_waitcnt vmcnt(6)
    s_mov_b64 exec, 1
    ds_add_u32 v10, v11 offset:8
    s_mov_b64 exec, -1
    s_add_u32 m0, s34, 69632
    s_add_u32 s35, s46, 0
    buffer_load_dwordx4 v245, s[64:67], s35 offen  lds
    v_add_u32 v224, 65536, v2
    v_add_u32 v225, 65536, v3
    v_add_u32 v226, 65536, v4
    v_add_u32 v227, 65536, v5
    v_add_u32 v228, 65536, v6
    v_add_u32 v229, 65536, v7
    s_add_u32 m0, s34, 73728
    s_add_u32 s35, s46, 65536
    buffer_load_dwordx4 v245, s[64:67], s35 offen  lds
    v_add_u32 v230, 65536, v8
    v_add_u32 v231, 65536, v9
    v_add_u32 v15, 32768, v12
    v_add_u32 v232, 129024, v2
    v_add_u32 v233, 129024, v3
    v_add_u32 v234, 129024, v4
    s_add_u32 m0, s34, 77824
    s_add_u32 s35, s46, 131072
    buffer_load_dwordx4 v245, s[64:67], s35 offen  lds
    v_add_u32 v235, 129024, v5
    v_add_u32 v236, 129024, v6
    v_add_u32 v237, 129024, v7
    v_add_u32 v238, 129024, v8
    v_add_u32 v239, 129024, v9
    s_waitcnt vmcnt(5)
    s_mov_b64 exec, 1
    buffer_store_dword v11, v220, s[52:55], s97 offen sc1
    s_mov_b64 exec, -1
    s_branch LB_s2_in
LB_s2:
    s_sleep 1
LB_s2_in:
    ds_read_b32 v14, v10 offset:8
    s_waitcnt lgkmcnt(0)
    v_readfirstlane_b32 s78, v14
    s_nop 0
    s_cmp_ge_u32 s78, 8
    s_cbranch_scc0 LB_s2
    s_add_u32 m0, s34, 81920
    s_add_u32 s35, s46, 196608
    buffer_load_dwordx4 v245, s[64:67], s35 offen  lds
    ds_read_b64_tr_b16 v[48:49], v2 offset:36864
    ds_read_b64_tr_b16 v[50:51], v6 offset:36864
    s_add_u32 m0, s34, 86016
    s_add_u32 s35, s47, 0
    buffer_load_dwordx4 v245, s[64:67], s35 offen  lds
    ds_read_b64_tr_b16 v[52:53], v2 offset:40960
    s_add_u32 m0, s34, 0
    s_add_u32 s35, s47, 65536
    buffer_load_dwordx4 v245, s[64:67], s35 offen  lds
    ds_read_b64_tr_b16 v[54:55], v6 offset:40960
    s_add_u32 m0, s34, 4096
    s_add_u32 s35, s47, 131072
    buffer_load_dwordx4 v245, s[64:67], s35 offen  lds
    ds_read_b64_tr_b16 v[56:57], v2 offset:45056
    s_add_u32 m0, s34, 8192
    s_add_u32 s35, s47, 196608
    buffer_load_dwordx4 v245, s[64:67], s35 offen  lds
    ds_read_b64_tr_b16 v[58:59], v6 offset:45056
    s_add_u32 m0, s34, 12288
    s_add_u32 s35, s48, 0
    buffer_load_dwordx4 v245, s[64:67], s35 offen  lds
    ds_read_b64_tr_b16 v[60:61], v2 offset:49152
    s_add_u32 m0, s34, 16384
    s_add_u32 s35, s48, 65536
    buffer_load_dwordx4 v245, s[64:67], s35 offen  lds
    ds_read_b64_tr_b16 v[62:63], v6 offset:49152
    s_add_u32 m0, s34, 20480
    s_add_u32 s35, s48, 131072
    buffer_load_dwordx4 v245, s[64:67], s35 offen  lds
    ds_read_b64_tr_b16 v[64:65], v3 offset:36864
    s_add_u32 m0, s34, 110592
    s_add_u32 s35, s48, 196608
    buffer_load_dwordx4 v245, s[64:67], s35 offen  lds
    ds_read_b64_tr_b16 v[66:67], v7 offset:36864
    s_add_u32 m0, s34, 114688
    s_add_u32 s35, s49, 0
    buffer_load_dwordx4 v245, s[64:67], s35 offen  lds
    ds_read_b64_tr_b16 v[68:69], v3 offset:40960
    s_add_u32 m0, s34, 118784
    s_add_u32 s35, s49, 65536
    buffer_load_dwordx4 v245, s[64:67], s35 offen  lds
    ds_read_b64_tr_b16 v[70:71], v7 offset:40960
    s_add_u32 m0, s34, 122880
    s_add_u32 s35, s49, 131072
    buffer_load_dwordx4 v245, s[64:67], s35 offen  lds
    ds_read_b64_tr_b16 v[72:73], v3 offset:45056
    s_add_u32 m0, s34, 24576
    s_add_u32 s35, s49, 196608
    buffer_load_dwordx4 v245, s[64:67], s35 offen  lds
    ds_read_b64_tr_b16 v[74:75], v7 offset:45056
    s_add_u32 m0, s34, 28672
    s_add_u32 s35, s50, 0
    buffer_load_dwordx4 v245, s[64:67], s35 offen  lds
    ds_read_b64_tr_b16 v[76:77], v3 offset:49152
    s_add_u32 m0, s34, 32768
    s_add_u32 s35, s50, 65536
    buffer_load_dwordx4 v245, s[64:67], s35 offen  lds
    ds_read_b64_tr_b16 v[78:79], v7 offset:49152
    s_waitcnt vmcnt(0)
    s_mov_b64 exec, 1
    ds_add_u32 v10, v11 offset:16
    s_mov_b64 exec, -1
    s_mov_b64 exec, 0xffffffff
    s_mov_b32 s79, 0
LB_po:
    buffer_load_dword v14, v247, s[52:55], s30 offen sc1
    s_add_u32 s79, s79, 1
    s_cmp_gt_u32 s79, 200000
    s_cbranch_scc1 LB_po_x
    s_waitcnt vmcnt(0)
    v_cmp_ne_u32 vcc, 1, v14
    s_cbranch_vccz LB_po_x
    s_mov_b64 exec, vcc
    s_sleep 4
    s_branch LB_po
LB_po_x:
    s_waitcnt vmcnt(0)
    s_mov_b64 exec, -1
    ds_read_b32 v222, v10 offset:16
    buffer_load_dwordx4 v[96:99], v12, s[52:55], s36 offen offset:0 sc1
    buffer_load_dwordx4 v[100:103], v12, s[52:55], s36 offen offset:1024 sc1
    buffer_load_dwordx4 v[104:107], v12, s[52:55], s36 offen offset:2048 sc1
    buffer_load_dwordx4 v[108:111], v12, s[52:55], s36 offen offset:3072 sc1
    buffer_load_dwordx4 v[112:115], v15, s[52:55], s36 offen offset:0 sc1
    buffer_load_dwordx4 v[116:119], v15, s[52:55], s36 offen offset:1024 sc1
    buffer_load_dwordx4 v[120:123], v15, s[52:55], s36 offen offset:2048 sc1
    buffer_load_dwordx4 v[124:127], v15, s[52:55], s36 offen offset:3072 sc1
    buffer_load_dwordx4 v[128:131], v12, s[52:55], s37 offen offset:0 sc1
    buffer_load_dwordx4 v[132:135], v12, s[52:55], s37 offen offset:1024 sc1
    s_setprio 1
    s_waitcnt lgkmcnt(0)
    v_cmp_gt_u32 vcc, 4, v222
    s_cbranch_vccnz LB_w4
LB_g4:
    s_waitcnt vmcnt(9)
    v_mfma_f32_16x16x32_bf16 v[16:19], v[48:51], v[96:99], 0
    buffer_load_dwordx4 v[136:139], v12, s[52:55], s37 offen offset:2048 sc1
    buffer_load_dwordx4 v[140:143], v12, s[52:55], s37 offen offset:3072 sc1
    s_waitcnt vmcnt(10)
    v_mfma_f32_16x16x32_bf16 v[16:19], v[52:55], v[100:103], v[16:19]
    buffer_load_dwordx4 v[144:147], v15, s[52:55], s37 offen offset:0 sc1
    s_waitcnt vmcnt(10)
    v_mfma_f32_16x16x32_bf16 v[16:19], v[56:59], v[104:107], v[16:19]
    buffer_load_dwordx4 v[148:151], v15, s[52:55], s37 offen offset:1024 sc1
    ds_read_b64_tr_b16 v[80:81], v4 offset:36864
    s_waitcnt vmcnt(10)
    v_mfma_f32_16x16x32_bf16 v[16:19], v[60:63], v[108:111], v[16:19]
    ds_read_b64_tr_b16 v[82:83], v8 offset:36864
    s_waitcnt vmcnt(6)
    v_mfma_f32_16x16x32_bf16 v[32:35], v[60:63], v[124:127], 0
    ds_read_b64_tr_b16 v[84:85], v4 offset:40960
    ds_read_b64_tr_b16 v[86:87], v8 offset:40960
    v_mfma_f32_16x16x32_bf16 v[32:35], v[56:59], v[120:123], v[32:35]
    ds_read_b64_tr_b16 v[88:89], v4 offset:45056
    v_mfma_f32_16x16x32_bf16 v[32:35], v[52:55], v[116:119], v[32:35]
    ds_read_b64_tr_b16 v[90:91], v8 offset:45056
    ds_read_b64_tr_b16 v[92:93], v4 offset:49152
    v_mfma_f32_16x16x32_bf16 v[32:35], v[48:51], v[112:115], v[32:35]
    ds_read_b64_tr_b16 v[94:95], v8 offset:49152
    v_mfma_f32_16x16x32_bf16 v[36:39], v[64:67], v[112:115], 0
    buffer_load_dwordx4 v[152:155], v15, s[52:55], s37 offen offset:2048 sc1
    buffer_load_dwordx4 v[156:159], v15, s[52:55], s37 offen offset:3072 sc1
    v_mfma_f32_16x16x32_bf16 v[36:39], v[68:71], v[116:119], v[36:39]
    buffer_load_dwordx4 v[160:163], v12, s[52:55], s38 offen offset:0 sc1
    v_mfma_f32_16x16x32_bf16 v[36:39], v[72:75], v[120:123], v[36:39]
    buffer_load_dwordx4 v[164:167], v12, s[52:55], s38 offen offset:1024 sc1
    ds_read_b64_tr_b16 v[48:49], v5 offset:36864
    v_mfma_f32_16x16x32_bf16 v[36:39], v[76:79], v[124:127], v[36:39]
    ds_read_b64_tr_b16 v[50:51], v9 offset:36864
    v_mfma_f32_16x16x32_bf16 v[20:23], v[76:79], v[108:111], 0
    ds_read_b64_tr_b16 v[52:53], v5 offset:40960
    ds_read_b64_tr_b16 v[54:55], v9 offset:40960
    v_mfma_f32_16x16x32_bf16 v[20:23], v[72:75], v[104:107], v[20:23]
    ds_read_b64_tr_b16 v[56:57], v5 offset:45056
    v_mfma_f32_16x16x32_bf16 v[20:23], v[68:71], v[100:103], v[20:23]
    ds_read_b64_tr_b16 v[58:59], v9 offset:45056
    ds_read_b64_tr_b16 v[60:61], v5 offset:49152
    v_mfma_f32_16x16x32_bf16 v[20:23], v[64:67], v[96:99], v[20:23]
    ds_read_b64_tr_b16 v[62:63], v9 offset:49152
    s_waitcnt lgkmcnt(14)
    v_mfma_f32_16x16x32_bf16 v[24:27], v[80:83], v[96:99], 0
    buffer_load_dwordx4 v[168:171], v12, s[52:55], s38 offen offset:2048 sc1
    buffer_load_dwordx4 v[172:175], v12, s[52:55], s38 offen offset:3072 sc1
    s_waitcnt lgkmcnt(12)
    v_mfma_f32_16x16x32_bf16 v[24:27], v[84:87], v[100:103], v[24:27]
    buffer_load_dwordx4 v[176:179], v15, s[52:55], s38 offen offset:0 sc1
    s_waitcnt lgkmcnt(10)
    v_mfma_f32_16x16x32_bf16 v[24:27], v[88:91], v[104:107], v[24:27]
    buffer_load_dwordx4 v[180:183], v15, s[52:55], s38 offen offset:1024 sc1
    ds_read_b64_tr_b16 v[64:65], v2 offset:53248
    s_waitcnt lgkmcnt(9)
    v_mfma_f32_16x16x32_bf16 v[24:27], v[92:95], v[108:111], v[24:27]
    ds_read_b64_tr_b16 v[66:67], v6 offset:53248
    v_mfma_f32_16x16x32_bf16 v[40:43], v[92:95], v[124:127], 0
    ds_read_b64_tr_b16 v[68:69], v2 offset:57344
    ds_read_b64_tr_b16 v[70:71], v6 offset:57344
    v_mfma_f32_16x16x32_bf16 v[40:43], v[88:91], v[120:123], v[40:43]
    ds_read_b64_tr_b16 v[72:73], v2 offset:61440
    v_mfma_f32_16x16x32_bf16 v[40:43], v[84:87], v[116:119], v[40:43]
    ds_read_b64_tr_b16 v[74:75], v6 offset:61440
    ds_read_b64_tr_b16 v[76:77], v224 offset:0
    v_mfma_f32_16x16x32_bf16 v[40:43], v[80:83], v[112:115], v[40:43]
    ds_read_b64_tr_b16 v[78:79], v228 offset:0
    s_waitcnt lgkmcnt(14)
    v_mfma_f32_16x16x32_bf16 v[44:47], v[48:51], v[112:115], 0
    buffer_load_dwordx4 v[184:187], v15, s[52:55], s38 offen offset:2048 sc1
    buffer_load_dwordx4 v[188:191], v15, s[52:55], s38 offen offset:3072 sc1
    s_waitcnt lgkmcnt(12)
    v_mfma_f32_16x16x32_bf16 v[44:47], v[52:55], v[116:119], v[44:47]
    ds_read_b64_tr_b16 v[80:81], v3 offset:53248
    s_waitcnt lgkmcnt(11)
    v_mfma_f32_16x16x32_bf16 v[44:47], v[56:59], v[120:123], v[44:47]
    ds_read_b64_tr_b16 v[82:83], v7 offset:53248
    s_waitcnt lgkmcnt(10)
    v_mfma_f32_16x16x32_bf16 v[44:47], v[60:63], v[124:127], v[44:47]
    ds_read_b64_tr_b16 v[84:85], v3 offset:57344
    v_mfma_f32_16x16x32_bf16 v[28:31], v[60:63], v[108:111], 0
    ds_read_b64_tr_b16 v[86:87], v7 offset:57344
    ds_read_b64_tr_b16 v[88:89], v3 offset:61440
    v_mfma_f32_16x16x32_bf16 v[28:31], v[56:59], v[104:107], v[28:31]
    ds_read_b64_tr_b16 v[90:91], v7 offset:61440
    v_mfma_f32_16x16x32_bf16 v[28:31], v[52:55], v[100:103], v[28:31]
    ds_read_b64_tr_b16 v[92:93], v225 offset:0
    v_mfma_f32_16x16x32_bf16 v[28:31], v[48:51], v[96:99], v[28:31]
    ds_read_b64_tr_b16 v[94:95], v229 offset:0
    s_waitcnt vmcnt(8) lgkmcnt(8)
    v_mfma_f32_16x16x32_bf16 v[16:19], v[64:67], v[128:131], v[16:19]
    buffer_load_dwordx4 v[96:99], v12, s[52:55], s39 offen offset:0 sc1
    buffer_load_dwordx4 v[100:103], v12, s[52:55], s39 offen offset:1024 sc1
    v_mfma_f32_16x16x32_bf16 v[16:19], v[68:71], v[132:135], v[16:19]
    ds_read_b64_tr_b16 v[48:49], v4 offset:53248
    v_mfma_f32_16x16x32_bf16 v[16:19], v[72:75], v[136:139], v[16:19]
    ds_read_b64_tr_b16 v[50:51], v8 offset:53248
    v_mfma_f32_16x16x32_bf16 v[16:19], v[76:79], v[140:143], v[16:19]
    ds_read_b64_tr_b16 v[52:53], v4 offset:57344
    v_mfma_f32_16x16x32_bf16 v[32:35], v[76:79], v[156:159], v[32:35]
    ds_read_b64_tr_b16 v[54:55], v8 offset:57344
    ds_read_b64_tr_b16 v[56:57], v4 offset:61440
    v_mfma_f32_16x16x32_bf16 v[32:35], v[72:75], v[152:155], v[32:35]
    ds_read_b64_tr_b16 v[58:59], v8 offset:61440
    v_mfma_f32_16x16x32_bf16 v[32:35], v[68:71], v[148:151], v[32:35]
    ds_read_b64_tr_b16 v[60:61], v226 offset:0
    v_mfma_f32_16x16x32_bf16 v[32:35], v[64:67], v[144:147], v[32:35]
    ds_read_b64_tr_b16 v[62:63], v230 offset:0
    s_waitcnt lgkmcnt(8)
    v_mfma_f32_16x16x32_bf16 v[36:39], v[80:83], v[144:147], v[36:39]
    buffer_load_dwordx4 v[104:107], v12, s[52:55], s39 offen offset:2048 sc1
    buffer_load_dwordx4 v[108:111], v12, s[52:55], s39 offen offset:3072 sc1
    v_mfma_f32_16x16x32_bf16 v[36:39], v[84:87], v[148:151], v[36:39]
    ds_read_b64_tr_b16 v[64:65], v5 offset:53248
    v_mfma_f32_16x16x32_bf16 v[36:39], v[88:91], v[152:155], v[36:39]
    ds_read_b64_tr_b16 v[66:67], v9 offset:53248
    v_mfma_f32_16x16x32_bf16 v[36:39], v[92:95], v[156:159], v[36:39]
    ds_read_b64_tr_b16 v[68:69], v5 offset:57344
    v_mfma_f32_16x16x32_bf16 v[20:23], v[92:95], v[140:143], v[20:23]
    ds_read_b64_tr_b16 v[70:71], v9 offset:57344
    ds_read_b64_tr_b16 v[72:73], v5 offset:61440
    v_mfma_f32_16x16x32_bf16 v[20:23], v[88:91], v[136:139], v[20:23]
    ds_read_b64_tr_b16 v[74:75], v9 offset:61440
    v_mfma_f32_16x16x32_bf16 v[20:23], v[84:87], v[132:135], v[20:23]
    ds_read_b64_tr_b16 v[76:77], v227 offset:0
    v_mfma_f32_16x16x32_bf16 v[20:23], v[80:83], v[128:131], v[20:23]
    ds_read_b64_tr_b16 v[78:79], v231 offset:0
    s_waitcnt lgkmcnt(8)
    v_mfma_f32_16x16x32_bf16 v[24:27], v[48:51], v[128:131], v[24:27]
    buffer_load_dwordx4 v[112:115], v15, s[52:55], s39 offen offset:0 sc1
    buffer_load_dwordx4 v[116:119], v15, s[52:55], s39 offen offset:1024 sc1
    v_mfma_f32_16x16x32_bf16 v[24:27], v[52:55], v[132:135], v[24:27]
    ds_read_b64_tr_b16 v[80:81], v224 offset:4096
    v_mfma_f32_16x16x32_bf16 v[24:27], v[56:59], v[136:139], v[24:27]
    ds_read_b64_tr_b16 v[82:83], v228 offset:4096
    v_mfma_f32_16x16x32_bf16 v[24:27], v[60:63], v[140:143], v[24:27]
    ds_read_b64_tr_b16 v[84:85], v224 offset:8192
    v_mfma_f32_16x16x32_bf16 v[40:43], v[60:63], v[156:159], v[40:43]
    ds_read_b64_tr_b16 v[86:87], v228 offset:8192
    ds_read_b64_tr_b16 v[88:89], v224 offset:12288
    v_mfma_f32_16x16x32_bf16 v[40:43], v[56:59], v[152:155], v[40:43]
    ds_read_b64_tr_b16 v[90:91], v228 offset:12288
    v_mfma_f32_16x16x32_bf16 v[40:43], v[52:55], v[148:151], v[40:43]
    ds_read_b64_tr_b16 v[92:93], v224 offset:16384
    v_mfma_f32_16x16x32_bf16 v[40:43], v[48:51], v[144:147], v[40:43]
    ds_read_b64_tr_b16 v[94:95], v228 offset:16384
    s_waitcnt lgkmcnt(8)
    v_mfma_f32_16x16x32_bf16 v[44:47], v[64:67], v[144:147], v[44:47]
    buffer_load_dwordx4 v[120:123], v15, s[52:55], s39 offen offset:2048 sc1
    buffer_load_dwordx4 v[124:127], v15, s[52:55], s39 offen offset:3072 sc1
    v_mfma_f32_16x16x32_bf16 v[44:47], v[68:71], v[148:151], v[44:47]
    ds_read_b64_tr_b16 v[48:49], v225 offset:4096
    v_mfma_f32_16x16x32_bf16 v[44:47], v[72:75], v[152:155], v[44:47]
    ds_read_b64_tr_b16 v[50:51], v229 offset:4096
    v_mfma_f32_16x16x32_bf16 v[44:47], v[76:79], v[156:159], v[44:47]
    ds_read_b64_tr_b16 v[52:53], v225 offset:8192
    v_mfma_f32_16x16x32_bf16 v[28:31], v[76:79], v[140:143], v[28:31]
    ds_read_b64_tr_b16 v[54:55], v229 offset:8192
    ds_read_b64_tr_b16 v[56:57], v225 offset:12288
    v_mfma_f32_16x16x32_bf16 v[28:31], v[72:75], v[136:139], v[28:31]
    ds_read_b64_tr_b16 v[58:59], v229 offset:12288
    v_mfma_f32_16x16x32_bf16 v[28:31], v[68:71], v[132:135], v[28:31]
    ds_read_b64_tr_b16 v[60:61], v225 offset:16384
    v_mfma_f32_16x16x32_bf16 v[28:31], v[64:67], v[128:131], v[28:31]
    ds_read_b64_tr_b16 v[62:63], v229 offset:16384
    s_waitcnt vmcnt(8) lgkmcnt(8)
    v_mfma_f32_16x16x32_bf16 v[16:19], v[80:83], v[160:163], v[16:19]
    buffer_load_dwordx4 v[128:131], v12, s[52:55], s40 offen offset:0 sc1
    buffer_load_dwordx4 v[132:135], v12, s[52:55], s40 offen offset:1024 sc1
    v_mfma_f32_16x16x32_bf16 v[16:19], v[84:87], v[164:167], v[16:19]
    ds_read_b64_tr_b16 v[64:65], v226 offset:4096
    v_mfma_f32_16x16x32_bf16 v[16:19], v[88:91], v[168:171], v[16:19]
    ds_read_b64_tr_b16 v[66:67], v230 offset:4096
    v_mfma_f32_16x16x32_bf16 v[16:19], v[92:95], v[172:175], v[16:19]
    ds_read_b64_tr_b16 v[68:69], v226 offset:8192
    v_mfma_f32_16x16x32_bf16 v[32:35], v[92:95], v[188:191], v[32:35]
    ds_read_b64_tr_b16 v[70:71], v230 offset:8192
    ds_read_b64_tr_b16 v[72:73], v226 offset:12288
    v_mfma_f32_16x16x32_bf16 v[32:35], v[88:91], v[184:187], v[32:35]
    ds_read_b64_tr_b16 v[74:75], v230 offset:12288
    v_mfma_f32_16x16x32_bf16 v[32:35], v[84:87], v[180:183], v[32:35]
    ds_read_b64_tr_b16 v[76:77], v226 offset:16384
    v_mfma_f32_16x16x32_bf16 v[32:35], v[80:83], v[176:179], v[32:35]
    ds_read_b64_tr_b16 v[78:79], v230 offset:16384
    s_waitcnt lgkmcnt(8)
    v_mfma_f32_16x16x32_bf16 v[36:39], v[48:51], v[176:179], v[36:39]
    buffer_load_dwordx4 v[136:139], v12, s[52:55], s40 offen offset:2048 sc1
    buffer_load_dwordx4 v[140:143], v12, s[52:55], s40 offen offset:3072 sc1
    v_mfma_f32_16x16x32_bf16 v[36:39], v[52:55], v[180:183], v[36:39]
    ds_read_b64_tr_b16 v[80:81], v227 offset:4096
    v_mfma_f32_16x16x32_bf16 v[36:39], v[56:59], v[184:187], v[36:39]
    ds_read_b64_tr_b16 v[82:83], v231 offset:4096
    v_mfma_f32_16x16x32_bf16 v[36:39], v[60:63], v[188:191], v[36:39]
    ds_read_b64_tr_b16 v[84:85], v227 offset:8192
    v_mfma_f32_16x16x32_bf16 v[20:23], v[60:63], v[172:175], v[20:23]
    ds_read_b64_tr_b16 v[86:87], v231 offset:8192
    ds_read_b64_tr_b16 v[88:89], v227 offset:12288
    v_mfma_f32_16x16x32_bf16 v[20:23], v[56:59], v[168:171], v[20:23]
    ds_read_b64_tr_b16 v[90:91], v231 offset:12288
    v_mfma_f32_16x16x32_bf16 v[20:23], v[52:55], v[164:167], v[20:23]
    ds_read_b64_tr_b16 v[92:93], v227 offset:16384
    v_mfma_f32_16x16x32_bf16 v[20:23], v[48:51], v[160:163], v[20:23]
    ds_read_b64_tr_b16 v[94:95], v231 offset:16384
    s_waitcnt lgkmcnt(8)
    v_mfma_f32_16x16x32_bf16 v[24:27], v[64:67], v[160:163], v[24:27]
    buffer_load_dwordx4 v[144:147], v15, s[52:55], s40 offen offset:0 sc1
    buffer_load_dwordx4 v[148:151], v15, s[52:55], s40 offen offset:1024 sc1
    v_mfma_f32_16x16x32_bf16 v[24:27], v[68:71], v[164:167], v[24:27]
    ds_read_b64_tr_b16 v[48:49], v224 offset:20480
    v_mfma_f32_16x16x32_bf16 v[24:27], v[72:75], v[168:171], v[24:27]
    ds_read_b64_tr_b16 v[50:51], v228 offset:20480
    v_mfma_f32_16x16x32_bf16 v[24:27], v[76:79], v[172:175], v[24:27]
    ds_read_b64_tr_b16 v[52:53], v2 offset:0
    v_mfma_f32_16x16x32_bf16 v[40:43], v[76:79], v[188:191], v[40:43]
    ds_read_b64_tr_b16 v[54:55], v6 offset:0
    ds_read_b64_tr_b16 v[56:57], v2 offset:4096
    v_mfma_f32_16x16x32_bf16 v[40:43], v[72:75], v[184:187], v[40:43]
    ds_read_b64_tr_b16 v[58:59], v6 offset:4096
    v_mfma_f32_16x16x32_bf16 v[40:43], v[68:71], v[180:183], v[40:43]
    ds_read_b64_tr_b16 v[60:61], v2 offset:8192
    v_mfma_f32_16x16x32_bf16 v[40:43], v[64:67], v[176:179], v[40:43]
    ds_read_b64_tr_b16 v[62:63], v6 offset:8192
    s_waitcnt lgkmcnt(8)
    v_mfma_f32_16x16x32_bf16 v[44:47], v[80:83], v[176:179], v[44:47]
    buffer_load_dwordx4 v[152:155], v15, s[52:55], s40 offen offset:2048 sc1
    buffer_load_dwordx4 v[156:159], v15, s[52:55], s40 offen offset:3072 sc1
    v_mfma_f32_16x16x32_bf16 v[44:47], v[84:87], v[180:183], v[44:47]
    ds_read_b64_tr_b16 v[64:65], v225 offset:20480
    v_mfma_f32_16x16x32_bf16 v[44:47], v[88:91], v[184:187], v[44:47]
    ds_read_b64_tr_b16 v[66:67], v229 offset:20480
    v_mfma_f32_16x16x32_bf16 v[44:47], v[92:95], v[188:191], v[44:47]
    ds_read_b64_tr_b16 v[68:69], v3 offset:0
    v_mfma_f32_16x16x32_bf16 v[28:31], v[92:95], v[172:175], v[28:31]
    ds_read_b64_tr_b16 v[70:71], v7 offset:0
    ds_read_b64_tr_b16 v[72:73], v3 offset:4096
    v_mfma_f32_16x16x32_bf16 v[28:31], v[88:91], v[168:171], v[28:31]
    ds_read_b64_tr_b16 v[74:75], v7 offset:4096
    v_mfma_f32_16x16x32_bf16 v[28:31], v[84:87], v[164:167], v[28:31]
    ds_read_b64_tr_b16 v[76:77], v3 offset:8192
    v_mfma_f32_16x16x32_bf16 v[28:31], v[80:83], v[160:163], v[28:31]
    ds_read_b64_tr_b16 v[78:79], v7 offset:8192
    s_waitcnt vmcnt(8) lgkmcnt(8)
    v_mfma_f32_16x16x32_bf16 v[16:19], v[48:51], v[96:99], v[16:19]
    buffer_load_dwordx4 v[160:163], v12, s[52:55], s41 offen offset:0 sc1
    buffer_load_dwordx4 v[164:167], v12, s[52:55], s41 offen offset:1024 sc1
    v_mfma_f32_16x16x32_bf16 v[16:19], v[52:55], v[100:103], v[16:19]
    ds_read_b64_tr_b16 v[80:81], v226 offset:20480
    v_mfma_f32_16x16x32_bf16 v[16:19], v[56:59], v[104:107], v[16:19]
    ds_read_b64_tr_b16 v[82:83], v230 offset:20480
    v_mfma_f32_16x16x32_bf16 v[16:19], v[60:63], v[108:111], v[16:19]
    ds_read_b64_tr_b16 v[84:85], v4 offset:0
    v_mfma_f32_16x16x32_bf16 v[32:35], v[60:63], v[124:127], v[32:35]
    ds_read_b64_tr_b16 v[86:87], v8 offset:0
    ds_read_b64_tr_b16 v[88:89], v4 offset:4096
    v_mfma_f32_16x16x32_bf16 v[32:35], v[56:59], v[120:123], v[32:35]
    ds_read_b64_tr_b16 v[90:91], v8 offset:4096
    v_mfma_f32_16x16x32_bf16 v[32:35], v[52:55], v[116:119], v[32:35]
    ds_read_b64_tr_b16 v[92:93], v4 offset:8192
    v_mfma_f32_16x16x32_bf16 v[32:35], v[48:51], v[112:115], v[32:35]
    ds_read_b64_tr_b16 v[94:95], v8 offset:8192
    s_waitcnt lgkmcnt(8)
    v_mfma_f32_16x16x32_bf16 v[36:39], v[64:67], v[112:115], v[36:39]
    buffer_load_dwordx4 v[168:171], v12, s[52:55], s41 offen offset:2048 sc1
    buffer_load_dwordx4 v[172:175], v12, s[52:55], s41 offen offset:3072 sc1
    v_mfma_f32_16x16x32_bf16 v[36:39], v[68:71], v[116:119], v[36:39]
    ds_read_b64_tr_b16 v[48:49], v227 offset:20480
    v_mfma_f32_16x16x32_bf16 v[36:39], v[72:75], v[120:123], v[36:39]
    ds_read_b64_tr_b16 v[50:51], v231 offset:20480
    v_mfma_f32_16x16x32_bf16 v[36:39], v[76:79], v[124:127], v[36:39]
    ds_read_b64_tr_b16 v[52:53], v5 offset:0
    v_mfma_f32_16x16x32_bf16 v[20:23], v[76:79], v[108:111], v[20:23]
    ds_read_b64_tr_b16 v[54:55], v9 offset:0
    ds_read_b64_tr_b16 v[56:57], v5 offset:4096
    v_mfma_f32_16x16x32_bf16 v[20:23], v[72:75], v[104:107], v[20:23]
    ds_read_b64_tr_b16 v[58:59], v9 offset:4096
    v_mfma_f32_16x16x32_bf16 v[20:23], v[68:71], v[100:103], v[20:23]
    ds_read_b64_tr_b16 v[60:61], v5 offset:8192
    v_mfma_f32_16x16x32_bf16 v[20:23], v[64:67], v[96:99], v[20:23]
    ds_read_b64_tr_b16 v[62:63], v9 offset:8192
    s_waitcnt lgkmcnt(8)
    v_mfma_f32_16x16x32_bf16 v[24:27], v[80:83], v[96:99], v[24:27]
    buffer_load_dwordx4 v[176:179], v15, s[52:55], s41 offen offset:0 sc1
    buffer_load_dwordx4 v[180:183], v15, s[52:55], s41 offen offset:1024 sc1
    v_mfma_f32_16x16x32_bf16 v[24:27], v[84:87], v[100:103], v[24:27]
    ds_read_b64_tr_b16 v[64:65], v2 offset:12288
    v_mfma_f32_16x16x32_bf16 v[24:27], v[88:91], v[104:107], v[24:27]
    ds_read_b64_tr_b16 v[66:67], v6 offset:12288
    v_mfma_f32_16x16x32_bf16 v[24:27], v[92:95], v[108:111], v[24:27]
    ds_read_b64_tr_b16 v[68:69], v2 offset:16384
    v_mfma_f32_16x16x32_bf16 v[40:43], v[92:95], v[124:127], v[40:43]
    ds_read_b64_tr_b16 v[70:71], v6 offset:16384
    ds_read_b64_tr_b16 v[72:73], v2 offset:20480
    v_mfma_f32_16x16x32_bf16 v[40:43], v[88:91], v[120:123], v[40:43]
    ds_read_b64_tr_b16 v[74:75], v6 offset:20480
    v_mfma_f32_16x16x32_bf16 v[40:43], v[84:87], v[116:119], v[40:43]
    ds_read_b64_tr_b16 v[76:77], v224 offset:45056
    v_mfma_f32_16x16x32_bf16 v[40:43], v[80:83], v[112:115], v[40:43]
    ds_read_b64_tr_b16 v[78:79], v228 offset:45056
    s_mov_b64 exec, 1
    ds_add_u32 v10, v11 offset:28
    s_mov_b64 exec, -1
    s_waitcnt lgkmcnt(9)
    v_mfma_f32_16x16x32_bf16 v[44:47], v[48:51], v[112:115], v[44:47]
    buffer_load_dwordx4 v[184:187], v15, s[52:55], s41 offen offset:2048 sc1
    buffer_load_dwordx4 v[188:191], v15, s[52:55], s41 offen offset:3072 sc1
    v_mfma_f32_16x16x32_bf16 v[44:47], v[52:55], v[116:119], v[44:47]
    ds_read_b64_tr_b16 v[80:81], v3 offset:12288
    v_mfma_f32_16x16x32_bf16 v[44:47], v[56:59], v[120:123], v[44:47]
    ds_read_b64_tr_b16 v[82:83], v7 offset:12288
    v_mfma_f32_16x16x32_bf16 v[44:47], v[60:63], v[124:127], v[44:47]
    ds_read_b64_tr_b16 v[84:85], v3 offset:16384
    v_mfma_f32_16x16x32_bf16 v[28:31], v[60:63], v[108:111], v[28:31]
    ds_read_b64_tr_b16 v[86:87], v7 offset:16384
    ds_read_b64_tr_b16 v[88:89], v3 offset:20480
    v_mfma_f32_16x16x32_bf16 v[28:31], v[56:59], v[104:107], v[28:31]
    ds_read_b64_tr_b16 v[90:91], v7 offset:20480
    v_mfma_f32_16x16x32_bf16 v[28:31], v[52:55], v[100:103], v[28:31]
    ds_read_b64_tr_b16 v[92:93], v225 offset:45056
    v_mfma_f32_16x16x32_bf16 v[28:31], v[48:51], v[96:99], v[28:31]
    ds_read_b64_tr_b16 v[94:95], v229 offset:45056
    s_waitcnt vmcnt(8) lgkmcnt(9)
    v_mfma_f32_16x16x32_bf16 v[16:19], v[64:67], v[128:131], v[16:19]
    buffer_load_dwordx4 v[96:99], v12, s[52:55], s42 offen offset:0 sc1
    buffer_load_dwordx4 v[100:103], v12, s[52:55], s42 offen offset:1024 sc1
    v_mfma_f32_16x16x32_bf16 v[16:19], v[68:71], v[132:135], v[16:19]
    ds_read_b64_tr_b16 v[48:49], v4 offset:12288
    v_mfma_f32_16x16x32_bf16 v[16:19], v[72:75], v[136:139], v[16:19]
    ds_read_b64_tr_b16 v[50:51], v8 offset:12288
    v_mfma_f32_16x16x32_bf16 v[16:19], v[76:79], v[140:143], v[16:19]
    ds_read_b64_tr_b16 v[52:53], v4 offset:16384
    v_mfma_f32_16x16x32_bf16 v[32:35], v[76:79], v[156:159], v[32:35]
    ds_read_b64_tr_b16 v[54:55], v8 offset:16384
    ds_read_b64_tr_b16 v[56:57], v4 offset:20480
    v_mfma_f32_16x16x32_bf16 v[32:35], v[72:75], v[152:155], v[32:35]
    ds_read_b64_tr_b16 v[58:59], v8 offset:20480
    v_mfma_f32_16x16x32_bf16 v[32:35], v[68:71], v[148:151], v[32:35]
    ds_read_b64_tr_b16 v[60:61], v226 offset:45056
    v_mfma_f32_16x16x32_bf16 v[32:35], v[64:67], v[144:147], v[32:35]
    ds_read_b64_tr_b16 v[62:63], v230 offset:45056
    s_waitcnt lgkmcnt(8)
    v_mfma_f32_16x16x32_bf16 v[36:39], v[80:83], v[144:147], v[36:39]
    buffer_load_dwordx4 v[104:107], v12, s[52:55], s42 offen offset:2048 sc1
    buffer_load_dwordx4 v[108:111], v12, s[52:55], s42 offen offset:3072 sc1
    v_mfma_f32_16x16x32_bf16 v[36:39], v[84:87], v[148:151], v[36:39]
    ds_read_b64_tr_b16 v[64:65], v5 offset:12288
    v_mfma_f32_16x16x32_bf16 v[36:39], v[88:91], v[152:155], v[36:39]
    ds_read_b64_tr_b16 v[66:67], v9 offset:12288
    v_mfma_f32_16x16x32_bf16 v[36:39], v[92:95], v[156:159], v[36:39]
    ds_read_b64_tr_b16 v[68:69], v5 offset:16384
    v_mfma_f32_16x16x32_bf16 v[20:23], v[92:95], v[140:143], v[20:23]
    ds_read_b64_tr_b16 v[70:71], v9 offset:16384
    ds_read_b64_tr_b16 v[72:73], v5 offset:20480
    v_mfma_f32_16x16x32_bf16 v[20:23], v[88:91], v[136:139], v[20:23]
    ds_read_b64_tr_b16 v[74:75], v9 offset:20480
    v_mfma_f32_16x16x32_bf16 v[20:23], v[84:87], v[132:135], v[20:23]
    ds_read_b64_tr_b16 v[76:77], v227 offset:45056
    v_mfma_f32_16x16x32_bf16 v[20:23], v[80:83], v[128:131], v[20:23]
    ds_read_b64_tr_b16 v[78:79], v231 offset:45056
    s_waitcnt lgkmcnt(8)
    v_mfma_f32_16x16x32_bf16 v[24:27], v[48:51], v[128:131], v[24:27]
    buffer_load_dwordx4 v[112:115], v15, s[52:55], s42 offen offset:0 sc1
    buffer_load_dwordx4 v[116:119], v15, s[52:55], s42 offen offset:1024 sc1
    v_mfma_f32_16x16x32_bf16 v[24:27], v[52:55], v[132:135], v[24:27]
    ds_read_b64_tr_b16 v[80:81], v224 offset:49152
    v_mfma_f32_16x16x32_bf16 v[24:27], v[56:59], v[136:139], v[24:27]
    ds_read_b64_tr_b16 v[82:83], v228 offset:49152
    v_mfma_f32_16x16x32_bf16 v[24:27], v[60:63], v[140:143], v[24:27]
    ds_read_b64_tr_b16 v[84:85], v224 offset:53248
    v_mfma_f32_16x16x32_bf16 v[40:43], v[60:63], v[156:159], v[40:43]
    ds_read_b64_tr_b16 v[86:87], v228 offset:53248
    ds_read_b64_tr_b16 v[88:89], v224 offset:57344
    v_mfma_f32_16x16x32_bf16 v[40:43], v[56:59], v[152:155], v[40:43]
    ds_read_b64_tr_b16 v[90:91], v228 offset:57344
    v_mfma_f32_16x16x32_bf16 v[40:43], v[52:55], v[148:151], v[40:43]
    ds_read_b64_tr_b16 v[92:93], v2 offset:24576
    v_mfma_f32_16x16x32_bf16 v[40:43], v[48:51], v[144:147], v[40:43]
    ds_read_b64_tr_b16 v[94:95], v6 offset:24576
    s_waitcnt lgkmcnt(8)
    v_mfma_f32_16x16x32_bf16 v[44:47], v[64:67], v[144:147], v[44:47]
    buffer_load_dwordx4 v[120:123], v15, s[52:55], s42 offen offset:2048 sc1
    buffer_load_dwordx4 v[124:127], v15, s[52:55], s42 offen offset:3072 sc1
    v_mfma_f32_16x16x32_bf16 v[44:47], v[68:71], v[148:151], v[44:47]
    ds_read_b64_tr_b16 v[48:49], v225 offset:49152
    v_mfma_f32_16x16x32_bf16 v[44:47], v[72:75], v[152:155], v[44:47]
    ds_read_b64_tr_b16 v[50:51], v229 offset:49152
    v_mfma_f32_16x16x32_bf16 v[44:47], v[76:79], v[156:159], v[44:47]
    ds_read_b64_tr_b16 v[52:53], v225 offset:53248
    v_mfma_f32_16x16x32_bf16 v[28:31], v[76:79], v[140:143], v[28:31]
    ds_read_b64_tr_b16 v[54:55], v229 offset:53248
    ds_read_b64_tr_b16 v[56:57], v225 offset:57344
    v_mfma_f32_16x16x32_bf16 v[28:31], v[72:75], v[136:139], v[28:31]
    ds_read_b64_tr_b16 v[58:59], v229 offset:57344
    v_mfma_f32_16x16x32_bf16 v[28:31], v[68:71], v[132:135], v[28:31]
    ds_read_b64_tr_b16 v[60:61], v3 offset:24576
    v_mfma_f32_16x16x32_bf16 v[28:31], v[64:67], v[128:131], v[28:31]
    ds_read_b64_tr_b16 v[62:63], v7 offset:24576
    s_waitcnt vmcnt(8) lgkmcnt(8)
    v_mfma_f32_16x16x32_bf16 v[16:19], v[80:83], v[160:163], v[16:19]
    buffer_load_dwordx4 v[128:131], v12, s[52:55], s43 offen offset:0 sc1
    buffer_load_dwordx4 v[132:135], v12, s[52:55], s43 offen offset:1024 sc1
    v_mfma_f32_16x16x32_bf16 v[16:19], v[84:87], v[164:167], v[16:19]
    ds_read_b64_tr_b16 v[64:65], v226 offset:49152
    v_mfma_f32_16x16x32_bf16 v[16:19], v[88:91], v[168:171], v[16:19]
    ds_read_b64_tr_b16 v[66:67], v230 offset:49152
    v_mfma_f32_16x16x32_bf16 v[16:19], v[92:95], v[172:175], v[16:19]
    ds_read_b64_tr_b16 v[68:69], v226 offset:53248
    v_mfma_f32_16x16x32_bf16 v[32:35], v[92:95], v[188:191], v[32:35]
    ds_read_b64_tr_b16 v[70:71], v230 offset:53248
    ds_read_b64_tr_b16 v[72:73], v226 offset:57344
    v_mfma_f32_16x16x32_bf16 v[32:35], v[88:91], v[184:187], v[32:35]
    ds_read_b64_tr_b16 v[74:75], v230 offset:57344
    v_mfma_f32_16x16x32_bf16 v[32:35], v[84:87], v[180:183], v[32:35]
    ds_read_b64_tr_b16 v[76:77], v4 offset:24576
    v_mfma_f32_16x16x32_bf16 v[32:35], v[80:83], v[176:179], v[32:35]
    ds_read_b64_tr_b16 v[78:79], v8 offset:24576
    s_mov_b64 exec, 1
    ds_add_u32 v10, v11 offset:40
    s_mov_b64 exec, -1
    s_waitcnt lgkmcnt(9)
    v_mfma_f32_16x16x32_bf16 v[36:39], v[48:51], v[176:179], v[36:39]
    buffer_load_dwordx4 v[136:139], v12, s[52:55], s43 offen offset:2048 sc1
    buffer_load_dwordx4 v[140:143], v12, s[52:55], s43 offen offset:3072 sc1
    v_mfma_f32_16x16x32_bf16 v[36:39], v[52:55], v[180:183], v[36:39]
    ds_read_b32 v223, v10 offset:32
    v_mfma_f32_16x16x32_bf16 v[36:39], v[56:59], v[184:187], v[36:39]
    ds_read_b64_tr_b16 v[80:81], v227 offset:49152
    ds_read_b64_tr_b16 v[82:83], v231 offset:49152
    v_mfma_f32_16x16x32_bf16 v[36:39], v[60:63], v[188:191], v[36:39]
    ds_read_b64_tr_b16 v[84:85], v227 offset:53248
    v_mfma_f32_16x16x32_bf16 v[20:23], v[60:63], v[172:175], v[20:23]
    ds_read_b64_tr_b16 v[86:87], v231 offset:53248
    v_mfma_f32_16x16x32_bf16 v[20:23], v[56:59], v[168:171], v[20:23]
    ds_read_b64_tr_b16 v[88:89], v227 offset:57344
    ds_read_b64_tr_b16 v[90:91], v231 offset:57344
    v_mfma_f32_16x16x32_bf16 v[20:23], v[52:55], v[164:167], v[20:23]
    ds_read_b64_tr_b16 v[92:93], v5 offset:24576
    v_mfma_f32_16x16x32_bf16 v[20:23], v[48:51], v[160:163], v[20:23]
    ds_read_b64_tr_b16 v[94:95], v9 offset:24576
    s_waitcnt lgkmcnt(8)
    v_cmp_gt_u32 vcc, 4, v223
    s_cbranch_vccnz LB_w8
LB_g8:
    v_mfma_f32_16x16x32_bf16 v[24:27], v[64:67], v[160:163], v[24:27]
    buffer_load_dwordx4 v[144:147], v15, s[52:55], s43 offen offset:0 sc1
    buffer_load_dwordx4 v[148:151], v15, s[52:55], s43 offen offset:1024 sc1
    v_mfma_f32_16x16x32_bf16 v[24:27], v[68:71], v[164:167], v[24:27]
    ds_read_b64_tr_b16 v[48:49], v2 offset:28672
    v_mfma_f32_16x16x32_bf16 v[24:27], v[72:75], v[168:171], v[24:27]
    ds_read_b64_tr_b16 v[50:51], v6 offset:28672
    v_mfma_f32_16x16x32_bf16 v[24:27], v[76:79], v[172:175], v[24:27]
    ds_read_b64_tr_b16 v[52:53], v2 offset:32768
    v_mfma_f32_16x16x32_bf16 v[40:43], v[76:79], v[188:191], v[40:43]
    ds_read_b64_tr_b16 v[54:55], v6 offset:32768
    ds_read_b64_tr_b16 v[56:57], v232 offset:0
    v_mfma_f32_16x16x32_bf16 v[40:43], v[72:75], v[184:187], v[40:43]
    ds_read_b64_tr_b16 v[58:59], v236 offset:0
    v_mfma_f32_16x16x32_bf16 v[40:43], v[68:71], v[180:183], v[40:43]
    ds_read_b64_tr_b16 v[60:61], v232 offset:4096
    v_mfma_f32_16x16x32_bf16 v[40:43], v[64:67], v[176:179], v[40:43]
    ds_read_b64_tr_b16 v[62:63], v236 offset:4096
    s_waitcnt lgkmcnt(8)
    v_mfma_f32_16x16x32_bf16 v[44:47], v[80:83], v[176:179], v[44:47]
    buffer_load_dwordx4 v[152:155], v15, s[52:55], s43 offen offset:2048 sc1
    buffer_load_dwordx4 v[156:159], v15, s[52:55], s43 offen offset:3072 sc1
    v_mfma_f32_16x16x32_bf16 v[44:47], v[84:87], v[180:183], v[44:47]
    ds_read_b64_tr_b16 v[64:65], v3 offset:28672
    v_mfma_f32_16x16x32_bf16 v[44:47], v[88:91], v[184:187], v[44:47]
    ds_read_b64_tr_b16 v[66:67], v7 offset:28672
    v_mfma_f32_16x16x32_bf16 v[44:47], v[92:95], v[188:191], v[44:47]
    ds_read_b64_tr_b16 v[68:69], v3 offset:32768
    v_mfma_f32_16x16x32_bf16 v[28:31], v[92:95], v[172:175], v[28:31]
    ds_read_b64_tr_b16 v[70:71], v7 offset:32768
    ds_read_b64_tr_b16 v[72:73], v233 offset:0
    v_mfma_f32_16x16x32_bf16 v[28:31], v[88:91], v[168:171], v[28:31]
    ds_read_b64_tr_b16 v[74:75], v237 offset:0
    v_mfma_f32_16x16x32_bf16 v[28:31], v[84:87], v[164:167], v[28:31]
    ds_read_b64_tr_b16 v[76:77], v233 offset:4096
    v_mfma_f32_16x16x32_bf16 v[28:31], v[80:83], v[160:163], v[28:31]
    ds_read_b64_tr_b16 v[78:79], v237 offset:4096
    s_waitcnt vmcnt(8) lgkmcnt(8)
    v_mfma_f32_16x16x32_bf16 v[16:19], v[48:51], v[96:99], v[16:19]
    ds_read_b64_tr_b16 v[80:81], v4 offset:28672
    v_mfma_f32_16x16x32_bf16 v[16:19], v[52:55], v[100:103], v[16:19]
    ds_read_b64_tr_b16 v[82:83], v8 offset:28672
    v_mfma_f32_16x16x32_bf16 v[16:19], v[56:59], v[104:107], v[16:19]
    ds_read_b64_tr_b16 v[84:85], v4 offset:32768
    v_mfma_f32_16x16x32_bf16 v[16:19], v[60:63], v[108:111], v[16:19]
    ds_read_b64_tr_b16 v[86:87], v8 offset:32768
    v_mfma_f32_16x16x32_bf16 v[32:35], v[60:63], v[124:127], v[32:35]
    ds_read_b64_tr_b16 v[88:89], v234 offset:0
    v_mfma_f32_16x16x32_bf16 v[32:35], v[56:59], v[120:123], v[32:35]
    ds_read_b64_tr_b16 v[90:91], v238 offset:0
    v_mfma_f32_16x16x32_bf16 v[32:35], v[52:55], v[116:119], v[32:35]
    ds_read_b64_tr_b16 v[92:93], v234 offset:4096
    v_mfma_f32_16x16x32_bf16 v[32:35], v[48:51], v[112:115], v[32:35]
    ds_read_b64_tr_b16 v[94:95], v238 offset:4096
    s_waitcnt lgkmcnt(8)
    v_mfma_f32_16x16x32_bf16 v[36:39], v[64:67], v[112:115], v[36:39]
    ds_read_b64_tr_b16 v[48:49], v5 offset:28672
    v_mfma_f32_16x16x32_bf16 v[36:39], v[68:71], v[116:119], v[36:39]
    ds_read_b64_tr_b16 v[50:51], v9 offset:28672
    v_mfma_f32_16x16x32_bf16 v[36:39], v[72:75], v[120:123], v[36:39]
    ds_read_b64_tr_b16 v[52:53], v5 offset:32768
    v_mfma_f32_16x16x32_bf16 v[36:39], v[76:79], v[124:127], v[36:39]
    ds_read_b64_tr_b16 v[54:55], v9 offset:32768
    v_mfma_f32_16x16x32_bf16 v[20:23], v[76:79], v[108:111], v[20:23]
    ds_read_b64_tr_b16 v[56:57], v235 offset:0
    v_mfma_f32_16x16x32_bf16 v[20:23], v[72:75], v[104:107], v[20:23]
    ds_read_b64_tr_b16 v[58:59], v239 offset:0
    v_mfma_f32_16x16x32_bf16 v[20:23], v[68:71], v[100:103], v[20:23]
    ds_read_b64_tr_b16 v[60:61], v235 offset:4096
    v_mfma_f32_16x16x32_bf16 v[20:23], v[64:67], v[96:99], v[20:23]
    ds_read_b64_tr_b16 v[62:63], v239 offset:4096
    s_waitcnt lgkmcnt(8)
    v_mfma_f32_16x16x32_bf16 v[24:27], v[80:83], v[96:99], v[24:27]
    ds_read_b64_tr_b16 v[64:65], v232 offset:8192
    v_mfma_f32_16x16x32_bf16 v[24:27], v[84:87], v[100:103], v[24:27]
    ds_read_b64_tr_b16 v[66:67], v236 offset:8192
    v_mfma_f32_16x16x32_bf16 v[24:27], v[88:91], v[104:107], v[24:27]
    ds_read_b64_tr_b16 v[68:69], v232 offset:12288
    v_mfma_f32_16x16x32_bf16 v[24:27], v[92:95], v[108:111], v[24:27]
    ds_read_b64_tr_b16 v[70:71], v236 offset:12288
    v_mfma_f32_16x16x32_bf16 v[40:43], v[92:95], v[124:127], v[40:43]
    ds_read_b64_tr_b16 v[72:73], v232 offset:16384
    v_mfma_f32_16x16x32_bf16 v[40:43], v[88:91], v[120:123], v[40:43]
    ds_read_b64_tr_b16 v[74:75], v236 offset:16384
    v_mfma_f32_16x16x32_bf16 v[40:43], v[84:87], v[116:119], v[40:43]
    ds_read_b64_tr_b16 v[76:77], v232 offset:20480
    v_mfma_f32_16x16x32_bf16 v[40:43], v[80:83], v[112:115], v[40:43]
    ds_read_b64_tr_b16 v[78:79], v236 offset:20480
    s_waitcnt lgkmcnt(8)
    v_mfma_f32_16x16x32_bf16 v[44:47], v[48:51], v[112:115], v[44:47]
    ds_read_b64_tr_b16 v[80:81], v233 offset:8192
    v_mfma_f32_16x16x32_bf16 v[44:47], v[52:55], v[116:119], v[44:47]
    ds_read_b64_tr_b16 v[82:83], v237 offset:8192
    v_mfma_f32_16x16x32_bf16 v[44:47], v[56:59], v[120:123], v[44:47]
    ds_read_b64_tr_b16 v[84:85], v233 offset:12288
    v_mfma_f32_16x16x32_bf16 v[44:47], v[60:63], v[124:127], v[44:47]
    ds_read_b64_tr_b16 v[86:87], v237 offset:12288
    v_mfma_f32_16x16x32_bf16 v[28:31], v[60:63], v[108:111], v[28:31]
    ds_read_b64_tr_b16 v[88:89], v233 offset:16384
    v_mfma_f32_16x16x32_bf16 v[28:31], v[56:59], v[104:107], v[28:31]
    ds_read_b64_tr_b16 v[90:91], v237 offset:16384
    v_mfma_f32_16x16x32_bf16 v[28:31], v[52:55], v[100:103], v[28:31]
    ds_read_b64_tr_b16 v[92:93], v233 offset:20480
    v_mfma_f32_16x16x32_bf16 v[28:31], v[48:51], v[96:99], v[28:31]
    ds_read_b64_tr_b16 v[94:95], v237 offset:20480
    s_waitcnt vmcnt(0) lgkmcnt(8)
    v_mfma_f32_16x16x32_bf16 v[16:19], v[64:67], v[128:131], v[16:19]
    ds_read_b32 v223, v10 offset:40
    ds_read_b64_tr_b16 v[48:49], v234 offset:8192
    v_mfma_f32_16x16x32_bf16 v[16:19], v[68:71], v[132:135], v[16:19]
    ds_read_b64_tr_b16 v[50:51], v238 offset:8192
    v_mfma_f32_16x16x32_bf16 v[16:19], v[72:75], v[136:139], v[16:19]
    ds_read_b64_tr_b16 v[52:53], v234 offset:12288
    v_mfma_f32_16x16x32_bf16 v[16:19], v[76:79], v[140:143], v[16:19]
    ds_read_b64_tr_b16 v[54:55], v238 offset:12288
    v_mfma_f32_16x16x32_bf16 v[32:35], v[76:79], v[156:159], v[32:35]
    ds_read_b64_tr_b16 v[56:57], v234 offset:16384
    v_mfma_f32_16x16x32_bf16 v[32:35], v[72:75], v[152:155], v[32:35]
    ds_read_b64_tr_b16 v[58:59], v238 offset:16384
    v_mfma_f32_16x16x32_bf16 v[32:35], v[68:71], v[148:151], v[32:35]
    ds_read_b64_tr_b16 v[60:61], v234 offset:20480
    v_mfma_f32_16x16x32_bf16 v[32:35], v[64:67], v[144:147], v[32:35]
    ds_read_b64_tr_b16 v[62:63], v238 offset:20480
    s_waitcnt lgkmcnt(9)
    v_mfma_f32_16x16x32_bf16 v[36:39], v[80:83], v[144:147], v[36:39]
    ds_read_b64_tr_b16 v[64:65], v235 offset:8192
    v_mfma_f32_16x16x32_bf16 v[36:39], v[84:87], v[148:151], v[36:39]
    ds_read_b64_tr_b16 v[66:67], v239 offset:8192
    v_mfma_f32_16x16x32_bf16 v[36:39], v[88:91], v[152:155], v[36:39]
    ds_read_b64_tr_b16 v[68:69], v235 offset:12288
    v_mfma_f32_16x16x32_bf16 v[36:39], v[92:95], v[156:159], v[36:39]
    ds_read_b64_tr_b16 v[70:71], v239 offset:12288
    v_mfma_f32_16x16x32_bf16 v[20:23], v[92:95], v[140:143], v[20:23]
    ds_read_b64_tr_b16 v[72:73], v235 offset:16384
    v_mfma_f32_16x16x32_bf16 v[20:23], v[88:91], v[136:139], v[20:23]
    ds_read_b64_tr_b16 v[74:75], v239 offset:16384
    v_mfma_f32_16x16x32_bf16 v[20:23], v[84:87], v[132:135], v[20:23]
    ds_read_b64_tr_b16 v[76:77], v235 offset:20480
    v_mfma_f32_16x16x32_bf16 v[20:23], v[80:83], v[128:131], v[20:23]
    ds_read_b64_tr_b16 v[78:79], v239 offset:20480
    s_waitcnt lgkmcnt(8)
    v_cmp_gt_u32 vcc, 4, v223
    s_cbranch_vccnz LB_w7
LB_g7:
    v_mfma_f32_16x16x32_bf16 v[24:27], v[48:51], v[128:131], v[24:27]
    v_mfma_f32_16x16x32_bf16 v[24:27], v[52:55], v[132:135], v[24:27]
    v_mfma_f32_16x16x32_bf16 v[24:27], v[56:59], v[136:139], v[24:27]
    v_cvt_pk_bf16_f32 v200, v32, v33
    v_mfma_f32_16x16x32_bf16 v[24:27], v[60:63], v[140:143], v[24:27]
    v_cvt_pk_bf16_f32 v201, v34, v35
    v_mfma_f32_16x16x32_bf16 v[40:43], v[60:63], v[156:159], v[40:43]
    v_cvt_pk_bf16_f32 v202, v36, v37
    v_mfma_f32_16x16x32_bf16 v[40:43], v[56:59], v[152:155], v[40:43]
    v_cvt_pk_bf16_f32 v203, v38, v39
    v_permlane16_swap_b32 v200, v202
    v_mfma_f32_16x16x32_bf16 v[40:43], v[52:55], v[148:151], v[40:43]
    v_permlane16_swap_b32 v201, v203
    v_mfma_f32_16x16x32_bf16 v[40:43], v[48:51], v[144:147], v[40:43]
    ds_write_b128 v248, v[200:203] offset:2048
    s_waitcnt lgkmcnt(1)
    v_mfma_f32_16x16x32_bf16 v[44:47], v[64:67], v[144:147], v[44:47]
    v_cvt_pk_bf16_f32 v192, v16, v17
    v_mfma_f32_16x16x32_bf16 v[44:47], v[68:71], v[148:151], v[44:47]
    v_cvt_pk_bf16_f32 v193, v18, v19
    v_mfma_f32_16x16x32_bf16 v[44:47], v[72:75], v[152:155], v[44:47]
    v_cvt_pk_bf16_f32 v194, v20, v21
    v_mfma_f32_16x16x32_bf16 v[44:47], v[76:79], v[156:159], v[44:47]
    v_cvt_pk_bf16_f32 v195, v22, v23
    v_mfma_f32_16x16x32_bf16 v[28:31], v[76:79], v[140:143], v[28:31]
    v_permlane16_swap_b32 v192, v194
    v_mfma_f32_16x16x32_bf16 v[28:31], v[72:75], v[136:139], v[28:31]
    v_permlane16_swap_b32 v193, v195
    v_mfma_f32_16x16x32_bf16 v[28:31], v[68:71], v[132:135], v[28:31]
    ds_write_b128 v248, v[192:195] offset:0
    v_mfma_f32_16x16x32_bf16 v[28:31], v[64:67], v[128:131], v[28:31]
    v_cvt_pk_bf16_f32 v204, v40, v41
    v_cvt_pk_bf16_f32 v205, v42, v43
    v_cvt_pk_bf16_f32 v206, v44, v45
    v_cvt_pk_bf16_f32 v207, v46, v47
    s_nop 0
    v_permlane16_swap_b32 v204, v206
    v_permlane16_swap_b32 v205, v207
    ds_write_b128 v249, v[204:207] offset:2048
    ds_read_b128 v[56:59], v250 offset:2048
    ds_read_b128 v[60:63], v250 offset:3072
    v_cvt_pk_bf16_f32 v196, v24, v25
    v_cvt_pk_bf16_f32 v197, v26, v27
    v_cvt_pk_bf16_f32 v198, v28, v29
    v_cvt_pk_bf16_f32 v199, v30, v31
    s_nop 0
    v_permlane16_swap_b32 v196, v198
    v_permlane16_swap_b32 v197, v199
    ds_write_b128 v249, v[196:199] offset:0
    ds_read_b128 v[48:51], v250 offset:0
    ds_read_b128 v[52:55], v250 offset:1024
    s_mov_b32 s95, 65536
    s_waitcnt lgkmcnt(4)
    buffer_store_dwordx4 v[56:59], v246, s[60:63], s95 offen nt sc1
    s_mov_b32 s95, 98304
    s_waitcnt lgkmcnt(3)
    buffer_store_dwordx4 v[60:63], v246, s[60:63], s95 offen nt sc1
    s_mov_b32 s95, 0
    s_waitcnt lgkmcnt(1)
    buffer_store_dwordx4 v[48:51], v246, s[60:63], s95 offen nt sc1
    s_mov_b32 s95, 32768
    s_waitcnt lgkmcnt(0)
    buffer_store_dwordx4 v[52:55], v246, s[60:63], s95 offen nt sc1
    s_endpgm
LA_slow:
    s_mov_b32 s79, 0
LA_slow1:
    s_mov_b64 exec, vcc
    s_sleep 8
    buffer_load_dword v136, v33, s[68:71], 0 offen sc1
    buffer_load_dword v137, v34, s[52:55], 0 offen sc1
    s_add_u32 s79, s79, 1
    s_cmp_gt_u32 s79, 200000
    s_waitcnt vmcnt(0)
    s_cbranch_scc1 LA_back
    v_cmp_ne_u32 vcc, v136, v137
    v_cmp_gt_u32 s[80:81], s96, v136
    s_nop 0
    s_or_b64 vcc, vcc, s[80:81]
    s_cbranch_vccnz LA_slow1
    s_branch LA_back
LB_tag:
    s_mov_b64 exec, 0xffff
    s_waitcnt vmcnt(0)
    v_lshrrev_b32 v251, v0, v251
    v_and_b32 v251, 1, v251
    v_cmp_eq_u32 vcc, 0, v251
    s_nop 1
    s_or_b32 s83, vcc_lo, 0x10000
    s_mov_b64 exec, 1
    v_mov_b32 v251, s83
    buffer_store_dword v251, v220, s[68:71], s98 offen sc1
    s_mov_b64 exec, -1
    s_branch LB_tagb
LB_slow:
    s_mov_b32 s79, 0
LB_pt:
    buffer_load_dword v222, v220, s[68:71], s98 offen sc1
    s_add_u32 s79, s79, 1
    s_cmp_gt_u32 s79, 200000
    s_cbranch_scc1 LB_pt_x
    s_waitcnt vmcnt(0)
    v_cmp_gt_u32 vcc, 4096, v222
    s_cbranch_vccz LB_pt_x
    s_mov_b64 exec, vcc
    s_sleep 8
    s_branch LB_pt
LB_pt_x:
    s_waitcnt vmcnt(0)
    s_branch LB_back
LB_w1:
    s_branch LB_s1_in
LB_s1:
    s_sleep 1
LB_s1_in:
    ds_read_b32 v223, v10 offset:0
    ds_read_b64 v[204:205], v218
    ds_read_b64 v[206:207], v219
    s_waitcnt lgkmcnt(0)
    v_readfirstlane_b32 s78, v223
    s_nop 0
    s_cmp_ge_u32 s78, 4
    s_cbranch_scc0 LB_s1
    s_branch LB_g1
LB_w6:
    s_branch LB_s6_in
LB_s6:
    s_sleep 1
LB_s6_in:
    ds_read_b32 v223, v10 offset:24
    ds_read_b64 v[224:225], v218 offset:1024
    ds_read_b64 v[234:235], v219 offset:1024
    s_waitcnt lgkmcnt(0)
    v_readfirstlane_b32 s78, v223
    s_nop 0
    s_cmp_ge_u32 s78, 4
    s_cbranch_scc0 LB_s6
    s_branch LB_g6
LB_w4:
    s_branch LB_s4_in
LB_s4:
    s_sleep 1
LB_s4_in:
    ds_read_b32 v222, v10 offset:16
    s_waitcnt lgkmcnt(0)
    v_readfirstlane_b32 s78, v222
    s_nop 0
    s_cmp_ge_u32 s78, 4
    s_cbranch_scc0 LB_s4
    s_branch LB_g4
LB_w8:
    s_branch LB_s8_in
LB_s8:
    s_sleep 1
LB_s8_in:
    ds_read_b32 v223, v10 offset:32
    s_waitcnt lgkmcnt(0)
    v_readfirstlane_b32 s78, v223
    s_nop 0
    s_cmp_ge_u32 s78, 4
    s_cbranch_scc0 LB_s8
    s_branch LB_g8
LB_w7:
    s_branch LB_s7_in
LB_s7:
    s_sleep 1
LB_s7_in:
    ds_read_b32 v223, v10 offset:40
    s_waitcnt lgkmcnt(0)
    v_readfirstlane_b32 s78, v223
    s_nop 0
    s_cmp_ge_u32 s78, 4
    s_cbranch_scc0 LB_s7
    s_branch LB_g7
L_end:
    s_endpgm
.section .rodata,"a"
.p2align 6
.amdhsa_kernel concat_heads__ssm_conv_h3__sliding_local_dilated__prompt_kernel
  .amdhsa_next_free_vgpr 256
  .amdhsa_next_free_sgpr 102
  .amdhsa_accum_offset 256
  .amdhsa_group_segment_fixed_size 0
  .amdhsa_kernarg_size 96
  .amdhsa_user_sgpr_count 2
  .amdhsa_user_sgpr_kernarg_segment_ptr 1
  .amdhsa_system_sgpr_workgroup_id_x 1
.end_amdhsa_kernel
```

```asm
; @launch grid=(256,1,1) block=(512,1,1) lds=163840
.amdgcn_target "amdgcn-amd-amdhsa--gfx950"
.text
.globl concat_heads__ssm_conv_h3__sliding_local_dilated__prompt_kernel
.p2align 8
.type concat_heads__ssm_conv_h3__sliding_local_dilated__prompt_kernel,@function
concat_heads__ssm_conv_h3__sliding_local_dilated__prompt_kernel:
    s_cmp_ge_u32 s2, 256
    s_cbranch_scc1 L_end
    s_load_dwordx2 s[28:29], s[0:1], 48
    s_load_dwordx2 s[32:33], s[0:1], 56
    s_load_dwordx8 s[4:11], s[0:1], 0
    s_load_dwordx4 s[12:15], s[0:1], 32
    s_load_dwordx8 s[20:27], s[0:1], 64
    v_lshrrev_b32 v1, 6, v0
    v_and_b32 v0, 63, v0
    v_readfirstlane_b32 s3, v1
    s_nop 0
    s_cmp_lg_u32 s3, 4
    s_cbranch_scc1 L_nopf
    s_getpc_b64 s[80:81]
L_pc:
    s_bfe_u32 s78, s2, 0x40003
    v_lshl_add_u32 v1, v0, 4, s78
    v_lshlrev_b32 v1, 7, v1
    v_cmp_gt_u32 vcc, L_end-L_pc, v1
    s_nop 0
    s_and_saveexec_b64 s[82:83], vcc
    global_load_dword v222, v1, s[80:81]
    s_mov_b64 exec, -1
L_nopf:
    s_and_b32 s78, s2, 7
    s_lshr_b32 s79, s2, 3
    s_and_b32 s80, s78, 1
    s_lshl_b32 s80, s80, 3
    s_lshr_b32 s81, s78, 1
    s_lshl_b32 s81, s81, 2
    s_and_b32 s72, s79, 7
    s_add_u32 s72, s72, s80
    s_lshr_b32 s73, s79, 3
    s_xor_b32 s73, s73, 3
    s_add_u32 s73, s73, s81
    s_cmp_ge_u32 s3, 4
    s_cbranch_scc1 L_B
    v_lshrrev_b32 v5, 3, v0
    v_and_b32 v6, 7, v0
    v_lshrrev_b32 v7, 4, v0
    s_lshl_b32 s79, s72, 7
    s_lshl_b32 s80, s3, 5
    s_add_u32 s81, s79, s80
    v_xor_b32 v8, v7, v6
    v_lshlrev_b32 v8, 4, v8
    v_add_u32 v240, s81, v5
    v_lshl_add_u32 v240, v240, 11, v8
    v_xor_b32 v241, 64, v240
    v_add_u32 v241, 15360, v241
    v_add_u32 v242, 30720, v240
    v_add_u32 v243, 30720, v241
    s_lshl_b32 s87, s3, 12
    s_add_u32 s87, s87, 75776
    s_and_b32 s98, s73, 12
    s_and_b32 s78, s72, 8
    s_add_u32 s98, s98, s78
    s_add_u32 s101, s72, s73
    s_and_b32 s101, s101, 3
    s_lshl_b32 s78, s101, 2
    s_lshr_b32 s97, 0x101, s78
    s_add_u32 s97, s97, s98
    s_and_b32 s97, s97, 15
    s_mov_b32 m0, s87
    s_lshl_b32 s97, s97, 7
    s_mov_b32 s30, 0x400000
    s_mov_b32 s31, 0x20000
    s_waitcnt lgkmcnt(0)
    buffer_load_dwordx4 v240, s[28:31], s97 offen offset:0  lds
    s_and_b32 s78, s3, 1
    s_lshl_b32 s78, s78, 2
    s_lshl_b32 s80, s3, 3
    v_and_b32 v8, 1, v7
    v_lshl_or_b32 v8, v8, 1, s78
    v_xor_b32 v8, v8, v6
    buffer_load_dwordx4 v241, s[28:31], s97 offen offset:1024  lds
    v_lshlrev_b32 v8, 4, v8
    v_add_u32 v244, s80, v5
    v_mul_u32_u24 v244, 6144, v244
    s_lshl_b32 s82, s73, 7
    v_add3_u32 v244, v244, v8, s82
    buffer_load_dwordx4 v242, s[28:31], s97 offen offset:2048  lds
    v_add_u32 v245, 1024, v244
    v_add_u32 v246, 2048, v244
    s_bfe_u32 s62, s72, 0x10002
    s_mul_i32 s78, s62, 12288
    s_mul_i32 s80, s3, 3072
    s_add_u32 s60, s80, s78
    buffer_load_dwordx4 v243, s[28:31], s97 offen offset:3072  lds
    s_sub_u32 s61, s80, s78
    s_mul_i32 s62, s62, 196608
    s_sub_u32 s63, 196608, s62
    s_mov_b32 s34, 0x600000
    s_mov_b32 s35, 0x20000
    s_mul_i32 s16, s97, 3072
    s_add_u32 m0, s60, 0
    s_add_u32 s99, s16, s62
    buffer_load_dwordx4 v244, s[32:35], s99 offen offset:0  lds
    s_lshl_b32 s78, s3, 1
    s_lshl_b32 s80, s3, 2
    s_add_u32 s79, s79, s80
    s_sub_u32 s79, s79, 16
    v_add_u32 v8, s78, v7
    buffer_load_dwordx4 v245, s[32:35], s99 offen offset:1024  lds
    v_xor_b32 v8, v8, v6
    v_and_b32 v8, 7, v8
    v_lshlrev_b32 v8, 4, v8
    v_add_u32 v3, s79, v5
    buffer_load_dwordx4 v246, s[32:35], s99 offen offset:2048  lds
    v_lshl_add_u32 v3, v3, 11, v8
    s_lshl_b32 s86, s3, 10
    s_lshl_b32 s88, s3, 9
    s_add_u32 s88, s88, 73728
    s_add_u32 m0, s88, 0
    s_mov_b64 exec, 0xffffffff
    buffer_load_dwordx4 v3, s[28:31], s97 offen offset:0  lds
    s_mov_b64 exec, -1
    s_add_u32 m0, s61, 12288
    s_add_u32 s16, s16, s63
    buffer_load_dwordx4 v244, s[32:35], s16 offen offset:0  lds
    buffer_load_dwordx4 v245, s[32:35], s16 offen offset:1024  lds
    buffer_load_dwordx4 v246, s[32:35], s16 offen offset:2048  lds
    s_mov_b32 s0, 0x76583240
    s_mov_b32 s1, 0xfedba9c
    s_cmp_eq_u32 s101, 1
    s_cselect_b32 s0, 0x76943251, s0
    s_cselect_b32 s1, 0xfecbad8, s1
    s_cmp_eq_u32 s101, 2
    s_cselect_b32 s0, 0x7a543620, s0
    s_cselect_b32 s1, 0xfdcbe98, s1
    s_cmp_eq_u32 s101, 3
    s_cselect_b32 s0, 0xb6547231, s0
    s_cselect_b32 s1, 0xedcfa98, s1
    s_and_b32 s78, s73, 7
    s_cmp_lg_u32 s78, 3
    s_cbranch_scc1 LA_nb
    s_cmp_eq_u32 s101, 2
    s_cselect_b32 s0, 0x87654320, s0
    s_cselect_b32 s1, 0xfdcbea9, s1
    s_cmp_eq_u32 s101, 3
    s_cselect_b32 s0, 0x87654231, s0
    s_cselect_b32 s1, 0xedcfba9, s1
LA_nb:
    s_add_u32 s79, s72, s73
    s_add_u32 s78, s72, 5
    s_and_b32 s78, s78, 7
    s_lshl_b32 s78, s78, 1
    s_and_b32 s75, s79, 1
    s_add_u32 s78, s78, s75
    s_andn2_b32 s79, 2, s79
    s_lshl_b32 s79, s79, 3
    s_add_u32 s78, s78, s79
    s_and_b32 s76, s78, 3
    s_and_b32 s79, s73, 12
    s_add_u32 s76, s76, s79
    s_lshr_b32 s74, s78, 4
    s_add_u32 s74, s74, s79
    s_and_b32 s79, s72, 8
    s_lshr_b32 s77, s78, 2
    s_add_u32 s77, s77, s79
    s_lshr_b32 s79, s79, 2
    s_add_u32 s74, s74, s79
    s_xor_b32 s74, s74, 4
    s_and_b32 s75, s78, 15
    s_add_u32 s97, s98, s0
    s_lshr_b64 s[0:1], s[0:1], 4
    s_and_b32 s97, s97, 15
    s_add_u32 m0, s87, 18432
    s_lshl_b32 s97, s97, 7
    buffer_load_dwordx4 v240, s[28:31], s97 offen offset:0  lds
    s_mov_b32 s36, s6
    s_mov_b32 s37, s7
    s_mov_b32 s38, 0x400000
    s_mov_b32 s39, 0x20000
    s_mov_b32 s40, s8
    s_mov_b32 s41, s9
    s_mov_b32 s42, 0x400000
    s_mov_b32 s43, 0x20000
    s_mov_b32 s44, s10
    s_mov_b32 s45, s11
    s_mov_b32 s46, 0x2000
    s_mov_b32 s47, 0x20000
    v_lshlrev_b32 v15, 4, v0
    v_and_b32 v7, 7, v0
    s_lshl_b32 s79, s74, 7
    v_lshl_add_u32 v7, v7, 4, s79
    s_lshl_b32 s78, s75, 7
    s_lshl_b32 s80, s3, 3
    s_add_u32 s80, s80, s78
    v_lshrrev_b32 v5, 3, v0
    s_and_b32 s79, s3, 1
    v_xor_b32 v5, s79, v5
    v_add_u32 v5, s80, v5
    v_lshl_add_u32 v10, v5, 11, v7
    s_xor_b32 s80, s3, 1
    s_add_u32 s80, s78, s80
    s_sub_u32 s80, s80, 4
    s_lshl_b32 s80, s80, 11
    v_add_u32 v11, s80, v7
    s_mov_b32 s52, s26
    s_mov_b32 s53, s27
    s_mov_b32 s54, 0x1000000
    s_mov_b32 s55, 0x20000
    v_and_b32 v7, 7, v0
    s_lshl_b32 s79, s74, 7
    v_lshl_add_u32 v7, v7, 4, s79
    s_lshl_b32 s78, s75, 7
    v_bfe_u32 v5, v0, 3, 2
    v_lshrrev_b32 v6, 5, v0
    s_lshl_b32 s80, s3, 5
    v_lshlrev_b32 v8, 3, v5
    v_lshl_add_u32 v8, v6, 2, v8
    v_add_u32 v8, s80, v8
    v_and_b32 v35, 7, v0
    v_lshl_add_u32 v16, v35, 1, v6
    v_lshlrev_b32 v232, 5, v16
    v_lshlrev_b32 v16, 3, v16
    v_lshl_add_u32 v16, v5, 10, v16
    v_and_b32 v231, 1, v5
    v_lshl_add_u32 v16, v231, 7, v16
    s_lshl_b32 s79, s3, 12
    s_add_u32 s79, s79, 129024
    v_add_u32 v16, s79, v16
    v_xor_b32 v231, 128, v16
    v_lshrrev_b32 v35, 2, v35
    v_lshl_add_u32 v35, v35, 4, v232
    v_add_u32 v35, 162816, v35
    v_add_u32 v8, s78, v8
    v_lshl_add_u32 v9, v8, 11, v7
    v_lshl_add_u32 v13, v8, 12, v7
    v_bfe_u32 v8, v0, 2, 1
    v_lshlrev_b32 v8, 1, v8
    v_add_u32 v8, v8, v6
    v_lshlrev_b32 v8, 16, v8
    v_lshl_add_u32 v8, v5, 6, v8
    v_and_b32 v7, 3, v0
    v_lshl_add_u32 v8, v7, 4, v8
    s_add_u32 s78, s78, s80
    s_lshl_b32 s78, s78, 3
    s_lshl_b32 s79, s74, 18
    s_add_u32 s78, s78, s79
    v_add_u32 v12, s78, v8
    s_mov_b32 s48, s12
    s_mov_b32 s49, s13
    s_mov_b32 s50, 0x400000
    s_mov_b32 s51, 0x20000
    s_mov_b32 s56, s4
    s_mov_b32 s57, s5
    s_mov_b32 s58, 0x400000
    s_mov_b32 s59, 0x20000
    s_mov_b32 s64, s20
    s_mov_b32 s65, s21
    s_mov_b32 s66, 0x200000
    s_mov_b32 s67, 0x20000
    s_lshl_b32 s91, s74, 4
    s_add_u32 s91, s91, s75
    s_lshr_b32 s78, s91, 3
    s_lshl_b32 s78, s78, 5
    s_and_b32 s79, s91, 7
    s_add_u32 s78, s78, s79
    s_lshl_b32 s79, s3, 3
    s_add_u32 s90, s78, s79
    s_lshl_b32 s91, s91, 14
    s_mov_b32 s96, 4096
    s_mul_i32 s94, s3, 8320
    s_add_u32 s94, s94, 129024
    v_mov_b32 v229, 0
    s_mov_b64 s[4:5], s[64:65]
    s_mov_b32 s6, 0x0
    s_mov_b32 s7, 0x20000
    v_mov_b32 v228, 0x40000000
    s_bitcmp1_b32 s73, 2
    s_cbranch_scc1 LA_nh0
    s_mov_b64 s[4:5], s[28:29]
    s_mov_b32 s6, 0x400000
    v_mov_b32 v229, 0x40000000
    s_and_b32 s78, s73, 3
    s_cmp_eq_u32 s78, 3
    s_cbranch_scc1 LA_nh0
    s_and_b32 s79, s101, 2
    s_add_u32 s78, s72, 1
    s_add_u32 s78, s78, s79
    s_and_b32 s78, s78, 3
    s_bfe_u32 s80, s72, 0x10002
    s_and_b32 s81, s101, 1
    s_lshl_b32 s81, s81, 2
    s_add_u32 s81, s81, s79
    s_lshl_b32 s82, s78, 1
    s_cmp_lt_u32 s78, 2
    s_cselect_b32 s79, 12, 24
    s_cselect_b32 s82, s82, 0
    s_cselect_b32 s83, 6, 7
    s_add_u32 s81, s81, s83
    s_add_u32 s80, s80, s82
    s_lshl_b32 s80, s80, 2
    s_add_u32 s80, s80, s3
    s_mul_i32 s80, s80, s79
    s_add_u32 s82, s81, s78
    s_add_u32 s81, s81, s98
    s_and_b32 s81, s81, 15
    s_mul_i32 s81, s81, 192
    s_add_u32 s80, s80, s81
    s_or_b32 s81, s73, 3
    s_lshl_b32 s81, s81, 7
    v_add_u32 v5, s80, v0
    v_lshl_add_u32 v5, v5, 11, s81
    v_cmp_gt_u32 vcc, s79, v0
    s_nop 1
    v_cndmask_b32 v228, v228, v5, vcc
    s_cmp_ge_u32 s78, 2
    s_cbranch_scc1 LA_nh0
    s_add_u32 s82, s82, s98
    s_and_b32 s82, s82, 15
    s_lshl_b32 s78, s82, 7
    s_lshl_b32 s79, s72, 7
    s_mul_i32 s80, s3, 36
    s_add_u32 s79, s79, s80
    s_sub_u32 s79, s79, 16
    v_add_u32 v5, s79, v0
    v_lshl_add_u32 v5, v5, 11, s78
    v_cmp_gt_u32 vcc, 36, v0
    s_nop 1
    v_cndmask_b32 v229, v229, v5, vcc
LA_nh0:
    buffer_load_dwordx4 v241, s[28:31], s97 offen offset:1024  lds
    buffer_load_dwordx4 v242, s[28:31], s97 offen offset:2048  lds
    buffer_load_dwordx4 v243, s[28:31], s97 offen offset:3072  lds
    s_add_u32 m0, s88, 18432
    s_mov_b64 exec, 0xffffffff
    buffer_load_dwordx4 v3, s[28:31], s97 offen offset:0  lds
    s_mov_b64 exec, -1
    s_mul_i32 s16, s97, 3072
    s_add_u32 m0, s60, 24576
    s_add_u32 s99, s16, s62
    buffer_load_dwordx4 v244, s[32:35], s99 offen offset:0  lds
    buffer_load_dwordx4 v245, s[32:35], s99 offen offset:1024  lds
    buffer_load_dwordx4 v246, s[32:35], s99 offen offset:2048  lds
    s_add_u32 m0, s61, 36864
    s_add_u32 s16, s16, s63
    buffer_load_dwordx4 v244, s[32:35], s16 offen offset:0  lds
    buffer_load_dwordx4 v245, s[32:35], s16 offen offset:1024  lds
    buffer_load_dwordx4 v246, s[32:35], s16 offen offset:2048  lds
    s_waitcnt vmcnt(11)
    s_barrier
    s_add_u32 s97, s98, s0
    s_lshr_b64 s[0:1], s[0:1], 4
    s_and_b32 s97, s97, 15
    s_add_u32 m0, s87, 36864
    s_lshl_b32 s97, s97, 7
    buffer_load_dwordx4 v240, s[28:31], s97 offen offset:0  lds
    buffer_load_dwordx4 v241, s[28:31], s97 offen offset:1024  lds
    s_cmp_eq_u32 s101, 1
    s_cbranch_scc1 LA_c1
    s_cmp_eq_u32 s101, 2
    s_cbranch_scc1 LA_c2
    s_cmp_eq_u32 s101, 3
    s_cbranch_scc1 LA_c3
LA_c0:
    s_waitcnt vmcnt(8)
    s_barrier
    buffer_load_dwordx4 v242, s[28:31], s97 offen offset:2048  lds
    buffer_load_dwordx4 v243, s[28:31], s97 offen offset:3072  lds
    s_add_u32 m0, s88, 36864
    s_mov_b64 exec, 0xffffffff
    buffer_load_dwordx4 v3, s[28:31], s97 offen offset:0  lds
    s_mov_b64 exec, -1
    s_mul_i32 s16, s97, 3072
    s_add_u32 m0, s60, 49152
    s_add_u32 s99, s16, s62
    buffer_load_dwordx4 v244, s[32:35], s99 offen offset:0  lds
    buffer_load_dwordx4 v245, s[32:35], s99 offen offset:1024  lds
    buffer_load_dwordx4 v246, s[32:35], s99 offen offset:2048  lds
    s_add_u32 m0, s61, 61440
    s_add_u32 s16, s16, s63
    buffer_load_dwordx4 v244, s[32:35], s16 offen offset:0  lds
    buffer_load_dwordx4 v245, s[32:35], s16 offen offset:1024  lds
    buffer_load_dwordx4 v246, s[32:35], s16 offen offset:2048  lds
    s_add_u32 s97, s98, s0
    s_lshr_b64 s[0:1], s[0:1], 4
    s_and_b32 s97, s97, 15
    s_add_u32 m0, s87, 0
    s_lshl_b32 s97, s97, 7
    buffer_load_dwordx4 v240, s[28:31], s97 offen offset:0  lds
    buffer_load_dwordx4 v241, s[28:31], s97 offen offset:1024  lds
    buffer_load_dwordx4 v242, s[28:31], s97 offen offset:2048  lds
    buffer_load_dwordx4 v243, s[28:31], s97 offen offset:3072  lds
    s_add_u32 m0, s88, 0
    s_mov_b64 exec, 0xffffffff
    buffer_load_dwordx4 v3, s[28:31], s97 offen offset:0  lds
    s_mov_b64 exec, -1
    s_waitcnt vmcnt(11)
    s_barrier
    s_mul_i32 s16, s97, 3072
    s_add_u32 m0, s60, 0
    s_add_u32 s99, s16, s62
    buffer_load_dwordx4 v244, s[32:35], s99 offen offset:0  lds
    buffer_load_dwordx4 v245, s[32:35], s99 offen offset:1024  lds
    buffer_load_dwordx4 v246, s[32:35], s99 offen offset:2048  lds
    s_add_u32 m0, s61, 12288
    s_add_u32 s16, s16, s63
    buffer_load_dwordx4 v244, s[32:35], s16 offen offset:0  lds
    buffer_load_dwordx4 v245, s[32:35], s16 offen offset:1024  lds
    buffer_load_dwordx4 v246, s[32:35], s16 offen offset:2048  lds
    buffer_load_dword v230, v229, s[4:7], 0 offen
    buffer_load_dword v230, v228, s[32:35], 0 offen
    s_add_u32 m0, s86, 129536
    s_mov_b32 s89, 0
    buffer_load_dwordx4 v10, s[36:39], s89 offen nt lds
    s_add_u32 m0, s86, 145920
    s_mov_b32 s89, 0
    buffer_load_dwordx4 v10, s[40:43], s89 offen nt lds
    s_add_u32 m0, s86, 133632
    s_mov_b32 s89, 65536
    buffer_load_dwordx4 v10, s[36:39], s89 offen nt lds
    s_add_u32 m0, s86, 150016
    s_mov_b32 s89, 65536
    buffer_load_dwordx4 v10, s[40:43], s89 offen nt lds
    s_add_u32 m0, s86, 137728
    s_mov_b32 s89, 131072
    buffer_load_dwordx4 v10, s[36:39], s89 offen nt lds
    s_add_u32 m0, s86, 154112
    s_mov_b32 s89, 131072
    buffer_load_dwordx4 v10, s[40:43], s89 offen nt lds
    s_add_u32 m0, s86, 141824
    s_mov_b32 s89, 196608
    buffer_load_dwordx4 v10, s[36:39], s89 offen nt lds
    s_add_u32 m0, s86, 158208
    s_mov_b32 s89, 196608
    buffer_load_dwordx4 v10, s[40:43], s89 offen nt lds
    s_waitcnt vmcnt(16)
    s_barrier
    s_mov_b64 exec, 0xff
    s_lshl_b32 s82, s3, 7
    s_add_u32 m0, s82, 129024
    s_mov_b32 s89, 0
    buffer_load_dwordx4 v11, s[36:39], s89 offen nt lds
    s_lshl_b32 s83, s74, 9
    s_add_u32 s83, s83, s82
    s_and_b32 s89, s3, 2
    s_lshl_b32 s89, s89, 3
    s_add_u32 s82, s82, s89
    s_add_u32 m0, s82, 162816
    s_add_u32 s89, s83, 0
    buffer_load_dwordx4 v15, s[44:47], s89 offen  lds
    s_mov_b64 exec, -1
    s_add_u32 s97, s98, s0
    s_lshr_b64 s[0:1], s[0:1], 4
    s_and_b32 s97, s97, 15
    s_add_u32 m0, s87, 18432
    s_lshl_b32 s97, s97, 7
    buffer_load_dwordx4 v240, s[28:31], s97 offen offset:0  lds
    buffer_load_dwordx4 v241, s[28:31], s97 offen offset:1024  lds
    buffer_load_dwordx4 v242, s[28:31], s97 offen offset:2048  lds
    buffer_load_dwordx4 v243, s[28:31], s97 offen offset:3072  lds
    s_add_u32 m0, s88, 18432
    s_mov_b64 exec, 0xffffffff
    buffer_load_dwordx4 v3, s[28:31], s97 offen offset:0  lds
    s_mov_b64 exec, -1
    s_mul_i32 s16, s97, 3072
    s_add_u32 m0, s60, 24576
    s_add_u32 s99, s16, s62
    buffer_load_dwordx4 v244, s[32:35], s99 offen offset:0  lds
    buffer_load_dwordx4 v245, s[32:35], s99 offen offset:1024  lds
    buffer_load_dwordx4 v246, s[32:35], s99 offen offset:2048  lds
    s_add_u32 m0, s61, 36864
    s_add_u32 s16, s16, s63
    buffer_load_dwordx4 v244, s[32:35], s16 offen offset:0  lds
    buffer_load_dwordx4 v245, s[32:35], s16 offen offset:1024  lds
    buffer_load_dwordx4 v246, s[32:35], s16 offen offset:2048  lds
    s_add_u32 s97, s98, s0
    s_lshr_b64 s[0:1], s[0:1], 4
    s_and_b32 s97, s97, 15
    s_add_u32 m0, s87, 36864
    s_lshl_b32 s97, s97, 7
    buffer_load_dwordx4 v240, s[28:31], s97 offen offset:0  lds
    buffer_load_dwordx4 v241, s[28:31], s97 offen offset:1024  lds
    buffer_load_dwordx4 v242, s[28:31], s97 offen offset:2048  lds
    buffer_load_dwordx4 v243, s[28:31], s97 offen offset:3072  lds
    s_waitcnt vmcnt(10)
    s_barrier
    s_add_u32 m0, s88, 36864
    s_mov_b64 exec, 0xffffffff
    buffer_load_dwordx4 v3, s[28:31], s97 offen offset:0  lds
    s_mov_b64 exec, -1
    ds_read_b128 v[84:87], v35 offset:0
    ds_read_b128 v[88:91], v35 offset:16
    s_mul_i32 s16, s97, 3072
    s_add_u32 m0, s60, 49152
    s_add_u32 s99, s16, s62
    buffer_load_dwordx4 v244, s[32:35], s99 offen offset:0  lds
    ds_read_b64 v[40:41], v16 offset:0
    ds_read_b64 v[42:43], v231 offset:256
    buffer_load_dwordx4 v245, s[32:35], s99 offen offset:1024  lds
    ds_read_b64 v[44:45], v16 offset:256
    ds_read_b64 v[46:47], v16 offset:512
    buffer_load_dwordx4 v246, s[32:35], s99 offen offset:2048  lds
    ds_read_b64 v[48:49], v231 offset:512
    s_add_u32 m0, s61, 61440
    s_add_u32 s16, s16, s63
    buffer_load_dwordx4 v244, s[32:35], s16 offen offset:0  lds
    ds_read_b64 v[50:51], v16 offset:768
    ds_read_b64 v[52:53], v231 offset:768
    buffer_load_dwordx4 v245, s[32:35], s16 offen offset:1024  lds
    ds_read_b64 v[54:55], v16 offset:1024
    ds_read_b64 v[56:57], v231 offset:1024
    buffer_load_dwordx4 v246, s[32:35], s16 offen offset:2048  lds
    ds_read_b64 v[58:59], v16 offset:1280
    ds_read_b64 v[60:61], v231 offset:1280
    s_add_u32 s97, s98, s0
    s_lshr_b64 s[0:1], s[0:1], 4
    s_and_b32 s97, s97, 15
    s_add_u32 m0, s87, 0
    s_lshl_b32 s97, s97, 7
    buffer_load_dwordx4 v240, s[28:31], s97 offen offset:0  lds
    ds_read_b64 v[68:69], v16 offset:16896
    buffer_load_dwordx4 v241, s[28:31], s97 offen offset:1024  lds
    ds_read_b64 v[70:71], v231 offset:16896
    ds_read_b64 v[72:73], v16 offset:17152
    buffer_load_dwordx4 v242, s[28:31], s97 offen offset:2048  lds
    ds_read_b64 v[74:75], v231 offset:17152
    ds_read_b64 v[76:77], v16 offset:17408
    buffer_load_dwordx4 v243, s[28:31], s97 offen offset:3072  lds
    ds_read_b64 v[78:79], v231 offset:17408
    ds_read_b64 v[80:81], v16 offset:17664
    s_add_u32 m0, s88, 0
    s_mov_b64 exec, 0xffffffff
    buffer_load_dwordx4 v3, s[28:31], s97 offen offset:0  lds
    s_mov_b64 exec, -1
    ds_read_b64 v[82:83], v231 offset:17664
    s_waitcnt vmcnt(11)
    s_waitcnt lgkmcnt(0)
    s_barrier
    s_mul_i32 s16, s97, 3072
    s_add_u32 m0, s60, 0
    s_add_u32 s99, s16, s62
    buffer_load_dwordx4 v244, s[32:35], s99 offen offset:0  lds
    v_lshlrev_b32 v160, 16, v40
    v_lshlrev_b32 v161, 16, v42
    v_lshlrev_b32 v162, 16, v44
    v_lshlrev_b32 v163, 16, v46
    v_lshlrev_b32 v164, 16, v48
    buffer_load_dwordx4 v245, s[32:35], s99 offen offset:1024  lds
    v_lshlrev_b32 v165, 16, v50
    v_lshlrev_b32 v166, 16, v52
    v_lshlrev_b32 v167, 16, v54
    v_lshlrev_b32 v168, 16, v56
    v_lshlrev_b32 v169, 16, v58
    buffer_load_dwordx4 v246, s[32:35], s99 offen offset:2048  lds
    v_lshlrev_b32 v170, 16, v60
    v_lshlrev_b32 v172, 16, v84
    v_and_b32 v173, 0xffff0000, v84
    v_lshlrev_b32 v174, 16, v85
    v_and_b32 v175, 0xffff0000, v85
    s_add_u32 m0, s61, 12288
    s_add_u32 s16, s16, s63
    buffer_load_dwordx4 v244, s[32:35], s16 offen offset:0  lds
    v_lshlrev_b32 v176, 16, v68
    v_lshlrev_b32 v177, 16, v70
    v_lshlrev_b32 v178, 16, v72
    v_lshlrev_b32 v179, 16, v74
    v_lshlrev_b32 v180, 16, v76
    buffer_load_dwordx4 v245, s[32:35], s16 offen offset:1024  lds
    v_lshlrev_b32 v181, 16, v78
    v_lshlrev_b32 v182, 16, v80
    v_lshlrev_b32 v183, 16, v82
    v_mul_f32 v184, v160, v175
    v_mul_f32 v185, v161, v175
    buffer_load_dwordx4 v246, s[32:35], s16 offen offset:2048  lds
    v_mul_f32 v186, v162, v175
    v_mul_f32 v187, v163, v175
    v_mul_f32 v188, v164, v175
    v_mul_f32 v189, v165, v175
    v_mul_f32 v190, v166, v175
    s_add_u32 s97, s98, s0
    s_lshr_b64 s[0:1], s[0:1], 4
    s_and_b32 s97, s97, 15
    s_add_u32 m0, s87, 18432
    s_lshl_b32 s97, s97, 7
    buffer_load_dwordx4 v240, s[28:31], s97 offen offset:0  lds
    v_mul_f32 v191, v167, v175
    v_fmac_f32 v184, v161, v174
    v_fmac_f32 v185, v162, v174
    v_fmac_f32 v186, v163, v174
    v_fmac_f32 v187, v164, v174
    buffer_load_dwordx4 v241, s[28:31], s97 offen offset:1024  lds
    v_fmac_f32 v188, v165, v174
    v_fmac_f32 v189, v166, v174
    v_fmac_f32 v190, v167, v174
    v_fmac_f32 v191, v168, v174
    v_fmac_f32 v184, v162, v173
    buffer_load_dwordx4 v242, s[28:31], s97 offen offset:2048  lds
    v_fmac_f32 v185, v163, v173
    v_fmac_f32 v186, v164, v173
    v_fmac_f32 v187, v165, v173
    v_fmac_f32 v188, v166, v173
    v_fmac_f32 v189, v167, v173
    buffer_load_dwordx4 v243, s[28:31], s97 offen offset:3072  lds
    v_fmac_f32 v190, v168, v173
    v_fmac_f32 v191, v169, v173
    v_fmac_f32 v184, v163, v172
    v_fmac_f32 v185, v164, v172
    v_fmac_f32 v186, v165, v172
    s_add_u32 m0, s88, 18432
    s_mov_b64 exec, 0xffffffff
    buffer_load_dwordx4 v3, s[28:31], s97 offen offset:0  lds
    s_mov_b64 exec, -1
    v_fmac_f32 v187, v166, v172
    v_fmac_f32 v188, v167, v172
    v_fmac_f32 v189, v168, v172
    v_fmac_f32 v190, v169, v172
    v_fmac_f32 v191, v170, v172
    v_mul_f32 v184, v184, v176
    v_mul_f32 v185, v185, v177
    v_mul_f32 v186, v186, v178
    v_mul_f32 v187, v187, v179
    v_mul_f32 v188, v188, v180
    v_mul_f32 v189, v189, v181
    v_mul_f32 v190, v190, v182
    v_mul_f32 v191, v191, v183
    v_cvt_pk_bf16_f32 v100, v191, v190
    v_cvt_pk_bf16_f32 v101, v189, v188
    v_cvt_pk_bf16_f32 v102, v187, v186
    v_cvt_pk_bf16_f32 v103, v185, v184
    s_mov_b32 s89, 0
    buffer_store_dwordx4 v[100:103], v12, s[52:55], s89 offen sc1
    v_and_b32 v160, 0xffff0000, v40
    v_and_b32 v161, 0xffff0000, v42
    v_and_b32 v162, 0xffff0000, v44
    v_and_b32 v163, 0xffff0000, v46
    v_and_b32 v164, 0xffff0000, v48
    v_and_b32 v165, 0xffff0000, v50
    v_and_b32 v166, 0xffff0000, v52
    v_and_b32 v167, 0xffff0000, v54
    v_and_b32 v168, 0xffff0000, v56
    v_and_b32 v169, 0xffff0000, v58
    v_and_b32 v170, 0xffff0000, v60
    v_lshlrev_b32 v172, 16, v86
    v_and_b32 v173, 0xffff0000, v86
    v_lshlrev_b32 v174, 16, v87
    v_and_b32 v175, 0xffff0000, v87
    v_and_b32 v176, 0xffff0000, v68
    v_and_b32 v177, 0xffff0000, v70
    v_and_b32 v178, 0xffff0000, v72
    v_and_b32 v179, 0xffff0000, v74
    v_and_b32 v180, 0xffff0000, v76
    v_and_b32 v181, 0xffff0000, v78
    v_and_b32 v182, 0xffff0000, v80
    v_and_b32 v183, 0xffff0000, v82
    s_waitcnt vmcnt(12)
    s_barrier
    s_mul_i32 s16, s97, 3072
    s_add_u32 m0, s60, 24576
    s_add_u32 s99, s16, s62
    buffer_load_dwordx4 v244, s[32:35], s99 offen offset:0  lds
    v_mul_f32 v184, v160, v175
    v_mul_f32 v185, v161, v175
    v_mul_f32 v186, v162, v175
    v_mul_f32 v187, v163, v175
    v_mul_f32 v188, v164, v175
    buffer_load_dwordx4 v245, s[32:35], s99 offen offset:1024  lds
    v_mul_f32 v189, v165, v175
    v_mul_f32 v190, v166, v175
    v_mul_f32 v191, v167, v175
    v_fmac_f32 v184, v161, v174
    v_fmac_f32 v185, v162, v174
    buffer_load_dwordx4 v246, s[32:35], s99 offen offset:2048  lds
    v_fmac_f32 v186, v163, v174
    v_fmac_f32 v187, v164, v174
    v_fmac_f32 v188, v165, v174
    v_fmac_f32 v189, v166, v174
    v_fmac_f32 v190, v167, v174
    s_add_u32 m0, s61, 36864
    s_add_u32 s16, s16, s63
    buffer_load_dwordx4 v244, s[32:35], s16 offen offset:0  lds
    v_fmac_f32 v191, v168, v174
    v_fmac_f32 v184, v162, v173
    v_fmac_f32 v185, v163, v173
    v_fmac_f32 v186, v164, v173
    v_fmac_f32 v187, v165, v173
    buffer_load_dwordx4 v245, s[32:35], s16 offen offset:1024  lds
    v_fmac_f32 v188, v166, v173
    v_fmac_f32 v189, v167, v173
    v_fmac_f32 v190, v168, v173
    v_fmac_f32 v191, v169, v173
    v_fmac_f32 v184, v163, v172
    buffer_load_dwordx4 v246, s[32:35], s16 offen offset:2048  lds
    v_fmac_f32 v185, v164, v172
    v_fmac_f32 v186, v165, v172
    v_fmac_f32 v187, v166, v172
    v_fmac_f32 v188, v167, v172
    v_fmac_f32 v189, v168, v172
    s_add_u32 s97, s98, s0
    s_lshr_b64 s[0:1], s[0:1], 4
    s_and_b32 s97, s97, 15
    s_add_u32 m0, s87, 36864
    s_lshl_b32 s97, s97, 7
    buffer_load_dwordx4 v240, s[28:31], s97 offen offset:0  lds
    v_fmac_f32 v190, v169, v172
    v_fmac_f32 v191, v170, v172
    v_mul_f32 v184, v184, v176
    v_mul_f32 v185, v185, v177
    v_mul_f32 v186, v186, v178
    buffer_load_dwordx4 v241, s[28:31], s97 offen offset:1024  lds
    v_mul_f32 v187, v187, v179
    v_mul_f32 v188, v188, v180
    v_mul_f32 v189, v189, v181
    v_mul_f32 v190, v190, v182
    v_mul_f32 v191, v191, v183
    buffer_load_dwordx4 v242, s[28:31], s97 offen offset:2048  lds
    v_cvt_pk_bf16_f32 v104, v191, v190
    v_cvt_pk_bf16_f32 v105, v189, v188
    v_cvt_pk_bf16_f32 v106, v187, v186
    v_cvt_pk_bf16_f32 v107, v185, v184
    s_mov_b32 s89, 16384
    buffer_store_dwordx4 v[104:107], v12, s[52:55], s89 offen sc1
    buffer_load_dwordx4 v243, s[28:31], s97 offen offset:3072  lds
    v_lshlrev_b32 v160, 16, v41
    v_lshlrev_b32 v161, 16, v43
    v_lshlrev_b32 v162, 16, v45
    v_lshlrev_b32 v163, 16, v47
    v_lshlrev_b32 v164, 16, v49
    s_add_u32 m0, s88, 36864
    s_mov_b64 exec, 0xffffffff
    buffer_load_dwordx4 v3, s[28:31], s97 offen offset:0  lds
    s_mov_b64 exec, -1
    v_lshlrev_b32 v165, 16, v51
    v_lshlrev_b32 v166, 16, v53
    v_lshlrev_b32 v167, 16, v55
    v_lshlrev_b32 v168, 16, v57
    v_lshlrev_b32 v169, 16, v59
    v_lshlrev_b32 v170, 16, v61
    v_lshlrev_b32 v172, 16, v88
    v_and_b32 v173, 0xffff0000, v88
    v_lshlrev_b32 v174, 16, v89
    v_and_b32 v175, 0xffff0000, v89
    v_lshlrev_b32 v176, 16, v69
    v_lshlrev_b32 v177, 16, v71
    v_lshlrev_b32 v178, 16, v73
    v_lshlrev_b32 v179, 16, v75
    v_lshlrev_b32 v180, 16, v77
    v_lshlrev_b32 v181, 16, v79
    v_lshlrev_b32 v182, 16, v81
    v_lshlrev_b32 v183, 16, v83
    v_mul_f32 v184, v160, v175
    v_mul_f32 v185, v161, v175
    v_mul_f32 v186, v162, v175
    v_mul_f32 v187, v163, v175
    v_mul_f32 v188, v164, v175
    v_mul_f32 v189, v165, v175
    v_mul_f32 v190, v166, v175
    v_mul_f32 v191, v167, v175
    v_fmac_f32 v184, v161, v174
    v_fmac_f32 v185, v162, v174
    v_fmac_f32 v186, v163, v174
    v_fmac_f32 v187, v164, v174
    v_fmac_f32 v188, v165, v174
    v_fmac_f32 v189, v166, v174
    v_fmac_f32 v190, v167, v174
    v_fmac_f32 v191, v168, v174
    v_fmac_f32 v184, v162, v173
    v_fmac_f32 v185, v163, v173
    v_fmac_f32 v186, v164, v173
    v_fmac_f32 v187, v165, v173
    v_fmac_f32 v188, v166, v173
    v_fmac_f32 v189, v167, v173
    v_fmac_f32 v190, v168, v173
    s_waitcnt vmcnt(13)
    s_barrier
    s_mul_i32 s16, s97, 3072
    s_add_u32 m0, s60, 49152
    s_add_u32 s99, s16, s62
    buffer_load_dwordx4 v244, s[32:35], s99 offen offset:0  lds
    v_fmac_f32 v191, v169, v173
    v_fmac_f32 v184, v163, v172
    v_fmac_f32 v185, v164, v172
    v_fmac_f32 v186, v165, v172
    v_fmac_f32 v187, v166, v172
    buffer_load_dwordx4 v245, s[32:35], s99 offen offset:1024  lds
    v_fmac_f32 v188, v167, v172
    v_fmac_f32 v189, v168, v172
    v_fmac_f32 v190, v169, v172
    v_fmac_f32 v191, v170, v172
    v_mul_f32 v184, v184, v176
    buffer_load_dwordx4 v246, s[32:35], s99 offen offset:2048  lds
    v_mul_f32 v185, v185, v177
    v_mul_f32 v186, v186, v178
    v_mul_f32 v187, v187, v179
    v_mul_f32 v188, v188, v180
    v_mul_f32 v189, v189, v181
    s_add_u32 m0, s61, 61440
    s_add_u32 s16, s16, s63
    buffer_load_dwordx4 v244, s[32:35], s16 offen offset:0  lds
    v_mul_f32 v190, v190, v182
    v_mul_f32 v191, v191, v183
    v_cvt_pk_bf16_f32 v108, v191, v190
    v_cvt_pk_bf16_f32 v109, v189, v188
    v_cvt_pk_bf16_f32 v110, v187, v186
    buffer_load_dwordx4 v245, s[32:35], s16 offen offset:1024  lds
    v_cvt_pk_bf16_f32 v111, v185, v184
    s_mov_b32 s89, 32768
    buffer_store_dwordx4 v[108:111], v12, s[52:55], s89 offen sc1
    v_and_b32 v160, 0xffff0000, v41
    v_and_b32 v161, 0xffff0000, v43
    v_and_b32 v162, 0xffff0000, v45
    buffer_load_dwordx4 v246, s[32:35], s16 offen offset:2048  lds
    v_and_b32 v163, 0xffff0000, v47
    v_and_b32 v164, 0xffff0000, v49
    v_and_b32 v165, 0xffff0000, v51
    v_and_b32 v166, 0xffff0000, v53
    v_and_b32 v167, 0xffff0000, v55
    s_add_u32 s97, s98, s0
    s_lshr_b64 s[0:1], s[0:1], 4
    s_and_b32 s97, s97, 15
    s_add_u32 m0, s87, 0
    s_lshl_b32 s97, s97, 7
    buffer_load_dwordx4 v240, s[28:31], s97 offen offset:0  lds
    v_and_b32 v168, 0xffff0000, v57
    v_and_b32 v169, 0xffff0000, v59
    v_and_b32 v170, 0xffff0000, v61
    v_lshlrev_b32 v172, 16, v90
    v_and_b32 v173, 0xffff0000, v90
    buffer_load_dwordx4 v241, s[28:31], s97 offen offset:1024  lds
    v_lshlrev_b32 v174, 16, v91
    v_and_b32 v175, 0xffff0000, v91
    v_and_b32 v176, 0xffff0000, v69
    v_and_b32 v177, 0xffff0000, v71
    v_and_b32 v178, 0xffff0000, v73
    buffer_load_dwordx4 v242, s[28:31], s97 offen offset:2048  lds
    v_and_b32 v179, 0xffff0000, v75
    v_and_b32 v180, 0xffff0000, v77
    v_and_b32 v181, 0xffff0000, v79
    v_and_b32 v182, 0xffff0000, v81
    v_and_b32 v183, 0xffff0000, v83
    buffer_load_dwordx4 v243, s[28:31], s97 offen offset:3072  lds
    v_mul_f32 v184, v160, v175
    v_mul_f32 v185, v161, v175
    v_mul_f32 v186, v162, v175
    v_mul_f32 v187, v163, v175
    v_mul_f32 v188, v164, v175
    s_add_u32 m0, s88, 0
    s_mov_b64 exec, 0xffffffff
    buffer_load_dwordx4 v3, s[28:31], s97 offen offset:0  lds
    s_mov_b64 exec, -1
    v_mul_f32 v189, v165, v175
    v_mul_f32 v190, v166, v175
    v_mul_f32 v191, v167, v175
    v_fmac_f32 v184, v161, v174
    v_fmac_f32 v185, v162, v174
    v_fmac_f32 v186, v163, v174
    v_fmac_f32 v187, v164, v174
    v_fmac_f32 v188, v165, v174
    v_fmac_f32 v189, v166, v174
    v_fmac_f32 v190, v167, v174
    v_fmac_f32 v191, v168, v174
    v_fmac_f32 v184, v162, v173
    v_fmac_f32 v185, v163, v173
    v_fmac_f32 v186, v164, v173
    v_fmac_f32 v187, v165, v173
    v_fmac_f32 v188, v166, v173
    v_fmac_f32 v189, v167, v173
    v_fmac_f32 v190, v168, v173
    v_fmac_f32 v191, v169, v173
    v_fmac_f32 v184, v163, v172
    v_fmac_f32 v185, v164, v172
    v_fmac_f32 v186, v165, v172
    v_fmac_f32 v187, v166, v172
    v_fmac_f32 v188, v167, v172
    v_fmac_f32 v189, v168, v172
    v_fmac_f32 v190, v169, v172
    v_fmac_f32 v191, v170, v172
    v_mul_f32 v184, v184, v176
    v_mul_f32 v185, v185, v177
    v_mul_f32 v186, v186, v178
    v_mul_f32 v187, v187, v179
    v_mul_f32 v188, v188, v180
    v_mul_f32 v189, v189, v181
    v_mul_f32 v190, v190, v182
    v_mul_f32 v191, v191, v183
    v_cvt_pk_bf16_f32 v112, v191, v190
    v_cvt_pk_bf16_f32 v113, v189, v188
    v_cvt_pk_bf16_f32 v114, v187, v186
    v_cvt_pk_bf16_f32 v115, v185, v184
    s_mov_b32 s89, 49152
    buffer_store_dwordx4 v[112:115], v12, s[52:55], s89 offen sc1
    s_waitcnt vmcnt(13)
    s_barrier
    s_mul_i32 s16, s97, 3072
    s_add_u32 m0, s60, 0
    s_add_u32 s99, s16, s62
    buffer_load_dwordx4 v244, s[32:35], s99 offen offset:0  lds
    buffer_load_dwordx4 v245, s[32:35], s99 offen offset:1024  lds
    buffer_load_dwordx4 v246, s[32:35], s99 offen offset:2048  lds
    s_add_u32 m0, s61, 12288
    s_add_u32 s16, s16, s63
    buffer_load_dwordx4 v244, s[32:35], s16 offen offset:0  lds
    buffer_load_dwordx4 v245, s[32:35], s16 offen offset:1024  lds
    buffer_load_dwordx4 v246, s[32:35], s16 offen offset:2048  lds
    s_add_u32 m0, s94, 32
    s_lshl_b32 s89, s90, 12
    buffer_load_dwordx4 v15, s[48:51], s89 offen offset:0 nt lds
    s_add_u32 m0, s94, 32
    s_lshl_b32 s89, s90, 12
    buffer_load_dwordx4 v15, s[48:51], s89 offen offset:1024 nt lds
    s_add_u32 m0, s94, 32
    s_lshl_b32 s89, s90, 12
    buffer_load_dwordx4 v15, s[48:51], s89 offen offset:2048 nt lds
    s_add_u32 m0, s94, 32
    s_lshl_b32 s89, s90, 12
    buffer_load_dwordx4 v15, s[48:51], s89 offen offset:3072 nt lds
    s_add_u32 s97, s98, s0
    s_lshr_b64 s[0:1], s[0:1], 4
    s_and_b32 s97, s97, 15
    s_add_u32 m0, s87, 18432
    s_lshl_b32 s97, s97, 7
    buffer_load_dwordx4 v240, s[28:31], s97 offen offset:0  lds
    buffer_load_dwordx4 v241, s[28:31], s97 offen offset:1024  lds
    buffer_load_dwordx4 v242, s[28:31], s97 offen offset:2048  lds
    buffer_load_dwordx4 v243, s[28:31], s97 offen offset:3072  lds
    s_add_u32 m0, s88, 18432
    s_mov_b64 exec, 0xffffffff
    buffer_load_dwordx4 v3, s[28:31], s97 offen offset:0  lds
    s_mov_b64 exec, -1
    s_waitcnt vmcnt(16)
    s_barrier
    s_mul_i32 s16, s97, 3072
    s_add_u32 m0, s60, 24576
    s_add_u32 s99, s16, s62
    buffer_load_dwordx4 v244, s[32:35], s99 offen offset:0  lds
    buffer_load_dwordx4 v245, s[32:35], s99 offen offset:1024  lds
    buffer_load_dwordx4 v246, s[32:35], s99 offen offset:2048  lds
    s_add_u32 m0, s61, 36864
    s_add_u32 s16, s16, s63
    buffer_load_dwordx4 v244, s[32:35], s16 offen offset:0  lds
    buffer_load_dwordx4 v245, s[32:35], s16 offen offset:1024  lds
    buffer_load_dwordx4 v246, s[32:35], s16 offen offset:2048  lds
    s_add_u32 s97, s98, s0
    s_lshr_b64 s[0:1], s[0:1], 4
    s_and_b32 s97, s97, 15
    s_add_u32 m0, s87, 36864
    s_lshl_b32 s97, s97, 7
    buffer_load_dwordx4 v240, s[28:31], s97 offen offset:0  lds
    buffer_load_dwordx4 v241, s[28:31], s97 offen offset:1024  lds
    buffer_load_dwordx4 v242, s[28:31], s97 offen offset:2048  lds
    buffer_load_dwordx4 v243, s[28:31], s97 offen offset:3072  lds
    s_add_u32 m0, s88, 36864
    s_mov_b64 exec, 0xffffffff
    buffer_load_dwordx4 v3, s[28:31], s97 offen offset:0  lds
    s_mov_b64 exec, -1
    s_waitcnt vmcnt(11)
    s_barrier
    s_mul_i32 s16, s97, 3072
    s_add_u32 m0, s60, 49152
    s_add_u32 s99, s16, s62
    buffer_load_dwordx4 v244, s[32:35], s99 offen offset:0  lds
    s_mov_b32 s68, s24
    s_mov_b32 s69, s25
    s_mov_b32 s70, 0x100
    s_mov_b32 s71, 0x20000
    v_lshrrev_b32 v6, 5, v0
    buffer_load_dwordx4 v245, s[32:35], s99 offen offset:1024  lds
    v_and_b32 v7, 3, v0
    s_lshr_b32 s78, s90, 1
    s_lshl_b32 s78, s78, 2
    s_load_dword s92, s[14:15], s78
    v_bfe_u32 v5, v0, 2, 2
    buffer_load_dwordx4 v246, s[32:35], s99 offen offset:2048  lds
    v_lshlrev_b32 v5, 1, v5
    v_lshl_add_u32 v5, v6, 3, v5
    v_bfe_u32 v8, v0, 4, 1
    v_add_u32 v5, v5, v8
    s_and_b32 s78, s3, 1
    s_add_u32 m0, s61, 61440
    s_add_u32 s16, s16, s63
    buffer_load_dwordx4 v244, s[32:35], s16 offen offset:0  lds
    s_lshl_b32 s78, s78, 1
    v_add_u32 v8, s78, v6
    v_xor_b32 v8, v8, v7
    v_lshlrev_b32 v8, 4, v8
    buffer_load_dwordx4 v245, s[32:35], s16 offen offset:1024  lds
    v_lshl_add_u32 v5, v5, 6, v8
    v_add_u32 v14, s86, v5
    v_mov_b32 v18, 162304
    v_mov_b32 v19, 1
    v_and_b32 v5, 3, v0
    buffer_load_dwordx4 v246, s[32:35], s16 offen offset:2048  lds
    s_lshl_b32 s78, s74, 4
    s_add_u32 s78, s78, s3
    v_lshl_add_u32 v6, v5, 2, s78
    s_lshr_b32 s78, s76, 3
    s_lshl_b32 s79, s3, 1
    s_add_u32 s97, s98, s0
    s_lshr_b64 s[0:1], s[0:1], 4
    s_and_b32 s97, s97, 15
    s_add_u32 m0, s87, 0
    s_lshl_b32 s97, s97, 7
    buffer_load_dwordx4 v240, s[28:31], s97 offen offset:0  lds
    s_add_u32 s78, s78, s79
    s_xor_b32 s78, s78, 2
    s_lshl_b32 s78, s78, 5
    s_add_u32 s79, s76, 5
    s_and_b32 s79, s79, 7
    buffer_load_dwordx4 v241, s[28:31], s97 offen offset:1024  lds
    s_lshl_b32 s79, s79, 1
    s_add_u32 s78, s78, s79
    v_mul_u32_u24 v7, 9, v5
    v_and_b32 v7, 17, v7
    buffer_load_dwordx4 v242, s[28:31], s97 offen offset:2048  lds
    v_add_u32 v7, s78, v7
    v_and_b32 v8, 4, v0
    v_cmp_eq_u32 vcc, 0, v8
    s_nop 1
    v_cndmask_b32 v6, v7, v6, vcc
    v_and_b32 v33, 0xf0, v6
    buffer_load_dwordx4 v243, s[28:31], s97 offen offset:3072  lds
    v_lshlrev_b32 v34, 8, v6
    v_add_u32 v34, 12582912, v34
    v_and_b32 v5, 15, v0
    v_lshrrev_b32 v6, 4, v0
    v_add_u32 v7, 9, v5
    s_add_u32 m0, s88, 0
    s_mov_b64 exec, 0xffffffff
    buffer_load_dwordx4 v3, s[28:31], s97 offen offset:0  lds
    s_mov_b64 exec, -1
    v_and_b32 v8, 1, v7
    v_mul_u32_u24 v8, 4160, v8
    v_lshrrev_b32 v7, 1, v7
    v_lshl_add_u32 v8, v7, 2, v8
    s_waitcnt vmcnt(11)
    s_barrier
    s_mul_i32 s16, s97, 3072
    s_add_u32 m0, s60, 0
    s_add_u32 s99, s16, s62
    buffer_load_dwordx4 v244, s[32:35], s99 offen offset:0  lds
    v_lshlrev_b32 v7, 4, v6
    v_sub_u32 v8, v8, v7
    s_add_u32 s78, s94, 32
    v_add_u32 v21, s78, v8
    v_add_u32 v22, 1024, v21
    buffer_load_dwordx4 v245, s[32:35], s99 offen offset:1024  lds
    v_add_u32 v23, 2048, v21
    v_add_u32 v24, 3072, v21
    v_lshl_add_u32 v7, v5, 1, v6
    v_add_u32 v7, 30, v7
    v_and_b32 v8, 1, v7
    buffer_load_dwordx4 v246, s[32:35], s99 offen offset:2048  lds
    v_bfe_u32 v136, v7, 1, 2
    v_lshl_add_u32 v136, v8, 2, v136
    v_lshlrev_b32 v136, 6, v136
    v_lshrrev_b32 v7, 3, v7
    v_lshl_add_u32 v136, v7, 9, v136
    s_add_u32 m0, s61, 12288
    s_add_u32 s16, s16, s63
    buffer_load_dwordx4 v244, s[32:35], s16 offen offset:0  lds
    v_bitop3_b32 v8, v7, 3, s3 bitop3:0x6a
    v_lshl_add_u32 v25, v8, 4, v136
    v_add_u32 v25, 92160, v25
    v_subrev_u32 v7, 1, v7
    buffer_load_dwordx4 v245, s[32:35], s16 offen offset:1024  lds
    v_bitop3_b32 v8, v7, 3, s3 bitop3:0x6a
    v_lshl_add_u32 v27, v8, 4, v136
    v_add_u32 v27, 91648, v27
    v_subrev_u32 v7, 1, v7
    v_bitop3_b32 v8, v7, 3, s3 bitop3:0x6a
    buffer_load_dwordx4 v246, s[32:35], s16 offen offset:2048  lds
    v_lshl_add_u32 v29, v8, 4, v136
    v_add_u32 v29, 91136, v29
    v_subrev_u32 v7, 1, v7
    v_bitop3_b32 v8, v7, 3, s3 bitop3:0x6a
    v_lshl_add_u32 v31, v8, 4, v136
    s_add_u32 s97, s98, s0
    s_lshr_b64 s[0:1], s[0:1], 4
    s_and_b32 s97, s97, 15
    s_add_u32 m0, s87, 18432
    s_lshl_b32 s97, s97, 7
    buffer_load_dwordx4 v240, s[28:31], s97 offen offset:0  lds
    v_add_u32 v31, 90624, v31
    v_lshl_add_u32 v7, v5, 1, v6
    v_add_u32 v7, 26, v7
    v_and_b32 v8, 1, v7
    v_bfe_u32 v136, v7, 1, 2
    buffer_load_dwordx4 v241, s[28:31], s97 offen offset:1024  lds
    v_lshl_add_u32 v136, v8, 2, v136
    v_lshlrev_b32 v136, 6, v136
    v_lshrrev_b32 v7, 3, v7
    v_lshl_add_u32 v136, v7, 9, v136
    buffer_load_dwordx4 v242, s[28:31], s97 offen offset:2048  lds
    v_bitop3_b32 v8, v7, 3, s3 bitop3:0x6a
    v_lshl_add_u32 v26, v8, 4, v136
    v_add_u32 v26, 92160, v26
    v_subrev_u32 v7, 1, v7
    v_bitop3_b32 v8, v7, 3, s3 bitop3:0x6a
    buffer_load_dwordx4 v243, s[28:31], s97 offen offset:3072  lds
    v_lshl_add_u32 v28, v8, 4, v136
    v_add_u32 v28, 91648, v28
    v_subrev_u32 v7, 1, v7
    v_bitop3_b32 v8, v7, 3, s3 bitop3:0x6a
    v_lshl_add_u32 v30, v8, 4, v136
    s_add_u32 m0, s88, 18432
    s_mov_b64 exec, 0xffffffff
    buffer_load_dwordx4 v3, s[28:31], s97 offen offset:0  lds
    s_mov_b64 exec, -1
    v_add_u32 v30, 91136, v30
    v_subrev_u32 v7, 1, v7
    v_bitop3_b32 v8, v7, 3, s3 bitop3:0x6a
    v_lshl_add_u32 v32, v8, 4, v136
    s_waitcnt vmcnt(11)
    s_barrier
    s_mul_i32 s16, s97, 3072
    s_add_u32 m0, s60, 24576
    s_add_u32 s99, s16, s62
    buffer_load_dwordx4 v244, s[32:35], s99 offen offset:0  lds
    v_add_u32 v32, 90624, v32
    v_lshrrev_b32 v7, 1, v6
    v_lshl_add_u32 v7, v5, 1, v7
    v_add_u32 v7, 32, v7
    v_and_b32 v8, 1, v7
    buffer_load_dwordx4 v245, s[32:35], s99 offen offset:1024  lds
    v_bfe_u32 v136, v7, 1, 2
    v_lshl_add_u32 v136, v8, 2, v136
    v_lshlrev_b32 v136, 6, v136
    v_lshrrev_b32 v7, 3, v7
    buffer_load_dwordx4 v246, s[32:35], s99 offen offset:2048  lds
    v_lshl_add_u32 v136, v7, 9, v136
    v_bitop3_b32 v8, v7, 3, s3 bitop3:0x6a
    v_lshl_add_u32 v20, v8, 4, v136
    v_add_u32 v20, 92160, v20
    v_and_b32 v8, 1, v6
    s_add_u32 m0, s61, 36864
    s_add_u32 s16, s16, s63
    buffer_load_dwordx4 v244, s[32:35], s16 offen offset:0  lds
    v_xor_b32 v8, 1, v8
    v_lshl_add_u32 v20, v8, 3, v20
    s_waitcnt lgkmcnt(0)
    s_and_b32 s78, s92, 0xffff0000
    buffer_load_dwordx4 v245, s[32:35], s16 offen offset:1024  lds
    s_lshl_b32 s92, s92, 16
    s_bitcmp1_b32 s90, 0
    s_cselect_b32 s92, s78, s92
    v_lshlrev_b32 v7, 3, v6
    v_sub_u32 v7, v7, v5
    buffer_load_dwordx4 v246, s[32:35], s16 offen offset:2048  lds
    v_subrev_u32 v7, 9, v7
    v_and_b32 v8, 1, v7
    v_xor_b32 v8, 1, v8
    v_lshlrev_b32 v8, 4, v8
    v_lshrrev_b32 v8, v8, s92
    s_add_u32 s97, s98, s0
    s_lshr_b64 s[0:1], s[0:1], 4
    s_and_b32 s97, s97, 15
    s_add_u32 m0, s87, 36864
    s_lshl_b32 s97, s97, 7
    buffer_load_dwordx4 v240, s[28:31], s97 offen offset:0  lds
    v_ashrrev_i32 v7, 1, v7
    v_cmp_eq_u32 vcc, 0, v7
    s_nop 1
    v_cndmask_b32 v236, 0, v8, vcc
    v_cmp_eq_u32 vcc, 1, v7
    buffer_load_dwordx4 v241, s[28:31], s97 offen offset:1024  lds
    s_nop 0
    v_cndmask_b32 v237, 0, v8, vcc
    v_cmp_eq_u32 vcc, 2, v7
    s_nop 1
    v_cndmask_b32 v238, 0, v8, vcc
    v_cmp_eq_u32 vcc, 3, v7
    buffer_load_dwordx4 v242, s[28:31], s97 offen offset:2048  lds
    s_nop 0
    v_cndmask_b32 v239, 0, v8, vcc
    s_and_b32 s78, s77, 7
    s_mov_b32 s95, 0x76543210
    s_and_b32 s78, s76, 3
    s_mul_i32 s78, s78, 0x22222222
    s_add_u32 s95, s95, s78
    s_bfe_u32 s100, s95, 0x3001c
    s_lshl_b32 s100, s100, 18
    s_bfe_u32 s95, s95, 0x30018
    s_lshl_b32 s95, s95, 18
    v_lshrrev_b32 v136, 4, v0
    v_lshlrev_b32 v136, 1, v136
    v_and_b32 v137, 7, v0
    buffer_load_dwordx4 v243, s[28:31], s97 offen offset:3072  lds
    v_xor_b32 v136, v136, v137
    v_lshlrev_b32 v136, 4, v136
    v_lshrrev_b32 v137, 3, v0
    v_lshl_add_u32 v136, v137, 11, v136
    s_add_u32 m0, s88, 36864
    s_mov_b64 exec, 0xffffffff
    buffer_load_dwordx4 v3, s[28:31], s97 offen offset:0  lds
    s_mov_b64 exec, -1
    s_lshl_b32 s78, s77, 7
    s_lshl_b32 s79, s3, 14
    s_add_u32 s78, s78, s79
    v_add_u32 v17, s78, v136
    s_waitcnt vmcnt(11)
    s_barrier
    s_mul_i32 s16, s97, 3072
    s_add_u32 m0, s60, 49152
    s_add_u32 s99, s16, s62
    buffer_load_dwordx4 v244, s[32:35], s99 offen offset:0  lds
    v_add_u32 v5, s94, v15
    ds_read_b128 v[140:143], v5 offset:32
    ds_read_b32 v156, v5 offset:48
    ds_read_b128 v[144:147], v5 offset:1056
    buffer_load_dwordx4 v245, s[32:35], s99 offen offset:1024  lds
    ds_read_b32 v157, v5 offset:1072
    ds_read_b128 v[148:151], v5 offset:2080
    ds_read_b32 v158, v5 offset:2096
    ds_read_b128 v[152:155], v5 offset:3104
    buffer_load_dwordx4 v246, s[32:35], s99 offen offset:2048  lds
    ds_read_b32 v159, v5 offset:3120
    v_lshrrev_b32 v6, 3, v0
    v_mul_u32_u24 v6, 4160, v6
    s_add_u32 m0, s61, 61440
    s_add_u32 s16, s16, s63
    buffer_load_dwordx4 v244, s[32:35], s16 offen offset:0  lds
    v_and_b32 v7, 7, v0
    v_lshl_add_u32 v6, v7, 2, v6
    v_add_u32 v6, s94, v6
    v_mov_b32 v7, 0
    buffer_load_dwordx4 v245, s[32:35], s16 offen offset:1024  lds
    s_waitcnt lgkmcnt(0)
    v_readfirstlane_b32 s93, v140
    s_nop 0
    s_lshl_b32 s93, s93, 16
    s_nop 1
    v_writelane_b32 v7, s93, 15
    buffer_load_dwordx4 v246, s[32:35], s16 offen offset:2048  lds
    v_alignbit_b32 v140, v141, v140, 16
    v_alignbit_b32 v141, v142, v141, 16
    v_alignbit_b32 v142, v143, v142, 16
    s_add_u32 s97, s98, s0
    s_lshr_b64 s[0:1], s[0:1], 4
    s_and_b32 s97, s97, 15
    s_add_u32 m0, s87, 0
    s_lshl_b32 s97, s97, 7
    buffer_load_dwordx4 v240, s[28:31], s97 offen offset:0  lds
    v_alignbit_b32 v143, v156, v143, 16
    v_alignbit_b32 v144, v145, v144, 16
    v_alignbit_b32 v145, v146, v145, 16
    v_alignbit_b32 v146, v147, v146, 16
    buffer_load_dwordx4 v241, s[28:31], s97 offen offset:1024  lds
    v_alignbit_b32 v147, v157, v147, 16
    v_alignbit_b32 v148, v149, v148, 16
    v_alignbit_b32 v149, v150, v149, 16
    v_alignbit_b32 v150, v151, v150, 16
    buffer_load_dwordx4 v242, s[28:31], s97 offen offset:2048  lds
    v_alignbit_b32 v151, v158, v151, 16
    v_alignbit_b32 v152, v153, v152, 16
    v_alignbit_b32 v153, v154, v153, 16
    buffer_load_dwordx4 v243, s[28:31], s97 offen offset:3072  lds
    v_alignbit_b32 v154, v155, v154, 16
    v_alignbit_b32 v155, v159, v155, 16
    v_lshlrev_b32 v8, 3, v0
    s_add_u32 s78, s88, 18432
    s_add_u32 m0, s88, 0
    s_mov_b64 exec, 0xffffffff
    buffer_load_dwordx4 v3, s[28:31], s97 offen offset:0  lds
    s_mov_b64 exec, -1
    v_add_u32 v8, s78, v8
    v_mov_b32 v156, 0
    v_mov_b32 v157, 0
    s_waitcnt vmcnt(11)
    s_barrier
    s_mul_i32 s16, s97, 3072
    s_add_u32 m0, s60, 0
    s_add_u32 s99, s16, s62
    buffer_load_dwordx4 v244, s[32:35], s99 offen offset:0  lds
    buffer_load_dwordx4 v245, s[32:35], s99 offen offset:1024  lds
    buffer_load_dwordx4 v246, s[32:35], s99 offen offset:2048  lds
    s_add_u32 m0, s61, 12288
    s_add_u32 s16, s16, s63
    buffer_load_dwordx4 v244, s[32:35], s16 offen offset:0  lds
    buffer_load_dwordx4 v245, s[32:35], s16 offen offset:1024  lds
    buffer_load_dwordx4 v246, s[32:35], s16 offen offset:2048  lds
    s_mov_b64 exec, 0xff
    buffer_load_dword v136, v33, s[68:71], 0 offen sc1
    buffer_load_dword v137, v34, s[52:55], 0 offen sc1
    s_mov_b64 exec, -1
    buffer_load_dwordx4 v[212:215], v9, s[56:59], 0 offen offset:0 nt
    buffer_load_dwordx4 v[216:219], v9, s[56:59], 0 offen offset:2048 nt
    buffer_load_dwordx4 v[220:223], v9, s[56:59], s96 offen offset:0 nt
    buffer_load_dwordx4 v[224:227], v9, s[56:59], s96 offen offset:2048 nt
    s_waitcnt vmcnt(12)
    s_waitcnt vmcnt(6)
    s_barrier
    s_waitcnt vmcnt(4)
    s_branch LA_j
LA_c1:
    s_waitcnt vmcnt(8)
    s_barrier
    buffer_load_dwordx4 v242, s[28:31], s97 offen offset:2048  lds
    buffer_load_dwordx4 v243, s[28:31], s97 offen offset:3072  lds
    s_add_u32 m0, s88, 36864
    s_mov_b64 exec, 0xffffffff
    buffer_load_dwordx4 v3, s[28:31], s97 offen offset:0  lds
    s_mov_b64 exec, -1
    s_mul_i32 s16, s97, 3072
    s_add_u32 m0, s60, 49152
    s_add_u32 s99, s16, s62
    buffer_load_dwordx4 v244, s[32:35], s99 offen offset:0  lds
    buffer_load_dwordx4 v245, s[32:35], s99 offen offset:1024  lds
    buffer_load_dwordx4 v246, s[32:35], s99 offen offset:2048  lds
    s_add_u32 m0, s61, 61440
    s_add_u32 s16, s16, s63
    buffer_load_dwordx4 v244, s[32:35], s16 offen offset:0  lds
    buffer_load_dwordx4 v245, s[32:35], s16 offen offset:1024  lds
    buffer_load_dwordx4 v246, s[32:35], s16 offen offset:2048  lds
    s_add_u32 s97, s98, s0
    s_lshr_b64 s[0:1], s[0:1], 4
    s_and_b32 s97, s97, 15
    s_add_u32 m0, s87, 0
    s_lshl_b32 s97, s97, 7
    buffer_load_dwordx4 v240, s[28:31], s97 offen offset:0  lds
    buffer_load_dwordx4 v241, s[28:31], s97 offen offset:1024  lds
    buffer_load_dwordx4 v242, s[28:31], s97 offen offset:2048  lds
    buffer_load_dwordx4 v243, s[28:31], s97 offen offset:3072  lds
    s_add_u32 m0, s88, 0
    s_mov_b64 exec, 0xffffffff
    buffer_load_dwordx4 v3, s[28:31], s97 offen offset:0  lds
    s_mov_b64 exec, -1
    s_waitcnt vmcnt(11)
    s_barrier
    s_mul_i32 s16, s97, 3072
    s_add_u32 m0, s60, 0
    s_add_u32 s99, s16, s62
    buffer_load_dwordx4 v244, s[32:35], s99 offen offset:0  lds
    buffer_load_dwordx4 v245, s[32:35], s99 offen offset:1024  lds
    buffer_load_dwordx4 v246, s[32:35], s99 offen offset:2048  lds
    s_add_u32 m0, s61, 12288
    s_add_u32 s16, s16, s63
    buffer_load_dwordx4 v244, s[32:35], s16 offen offset:0  lds
    buffer_load_dwordx4 v245, s[32:35], s16 offen offset:1024  lds
    buffer_load_dwordx4 v246, s[32:35], s16 offen offset:2048  lds
    s_add_u32 m0, s86, 129536
    s_mov_b32 s89, 0
    buffer_load_dwordx4 v10, s[36:39], s89 offen nt lds
    s_add_u32 m0, s86, 145920
    s_mov_b32 s89, 0
    buffer_load_dwordx4 v10, s[40:43], s89 offen nt lds
    s_add_u32 m0, s86, 133632
    s_mov_b32 s89, 65536
    buffer_load_dwordx4 v10, s[36:39], s89 offen nt lds
    s_add_u32 m0, s86, 150016
    s_mov_b32 s89, 65536
    buffer_load_dwordx4 v10, s[40:43], s89 offen nt lds
    s_add_u32 m0, s86, 137728
    s_mov_b32 s89, 131072
    buffer_load_dwordx4 v10, s[36:39], s89 offen nt lds
    s_add_u32 m0, s86, 154112
    s_mov_b32 s89, 131072
    buffer_load_dwordx4 v10, s[40:43], s89 offen nt lds
    s_add_u32 m0, s86, 141824
    s_mov_b32 s89, 196608
    buffer_load_dwordx4 v10, s[36:39], s89 offen nt lds
    s_add_u32 m0, s86, 158208
    s_mov_b32 s89, 196608
    buffer_load_dwordx4 v10, s[40:43], s89 offen nt lds
    s_mov_b64 exec, 0xff
    s_lshl_b32 s82, s3, 7
    s_add_u32 m0, s82, 129024
    s_mov_b32 s89, 0
    buffer_load_dwordx4 v11, s[36:39], s89 offen nt lds
    s_lshl_b32 s83, s74, 9
    s_add_u32 s83, s83, s82
    s_and_b32 s89, s3, 2
    s_lshl_b32 s89, s89, 3
    s_add_u32 s82, s82, s89
    s_add_u32 m0, s82, 162816
    s_add_u32 s89, s83, 0
    buffer_load_dwordx4 v15, s[44:47], s89 offen  lds
    s_mov_b64 exec, -1
    s_add_u32 s97, s98, s0
    s_lshr_b64 s[0:1], s[0:1], 4
    s_and_b32 s97, s97, 15
    s_add_u32 m0, s87, 18432
    s_lshl_b32 s97, s97, 7
    buffer_load_dwordx4 v240, s[28:31], s97 offen offset:0  lds
    s_waitcnt vmcnt(17)
    s_barrier
    buffer_load_dwordx4 v241, s[28:31], s97 offen offset:1024  lds
    buffer_load_dwordx4 v242, s[28:31], s97 offen offset:2048  lds
    buffer_load_dwordx4 v243, s[28:31], s97 offen offset:3072  lds
    s_add_u32 m0, s88, 18432
    s_mov_b64 exec, 0xffffffff
    buffer_load_dwordx4 v3, s[28:31], s97 offen offset:0  lds
    s_mov_b64 exec, -1
    s_mul_i32 s16, s97, 3072
    s_add_u32 m0, s60, 24576
    s_add_u32 s99, s16, s62
    buffer_load_dwordx4 v244, s[32:35], s99 offen offset:0  lds
    buffer_load_dwordx4 v245, s[32:35], s99 offen offset:1024  lds
    buffer_load_dwordx4 v246, s[32:35], s99 offen offset:2048  lds
    s_add_u32 m0, s61, 36864
    s_add_u32 s16, s16, s63
    buffer_load_dwordx4 v244, s[32:35], s16 offen offset:0  lds
    buffer_load_dwordx4 v245, s[32:35], s16 offen offset:1024  lds
    buffer_load_dwordx4 v246, s[32:35], s16 offen offset:2048  lds
    s_add_u32 s97, s98, s0
    s_lshr_b64 s[0:1], s[0:1], 4
    s_and_b32 s97, s97, 15
    s_add_u32 m0, s87, 36864
    s_lshl_b32 s97, s97, 7
    buffer_load_dwordx4 v240, s[28:31], s97 offen offset:0  lds
    buffer_load_dwordx4 v241, s[28:31], s97 offen offset:1024  lds
    buffer_load_dwordx4 v242, s[28:31], s97 offen offset:2048  lds
    buffer_load_dwordx4 v243, s[28:31], s97 offen offset:3072  lds
    s_add_u32 m0, s88, 36864
    s_mov_b64 exec, 0xffffffff
    buffer_load_dwordx4 v3, s[28:31], s97 offen offset:0  lds
    s_mov_b64 exec, -1
    s_waitcnt vmcnt(11)
    s_barrier
    s_mul_i32 s16, s97, 3072
    s_add_u32 m0, s60, 49152
    s_add_u32 s99, s16, s62
    buffer_load_dwordx4 v244, s[32:35], s99 offen offset:0  lds
    ds_read_b128 v[84:87], v35 offset:0
    ds_read_b128 v[88:91], v35 offset:16
    buffer_load_dwordx4 v245, s[32:35], s99 offen offset:1024  lds
    ds_read_b64 v[40:41], v16 offset:0
    ds_read_b64 v[42:43], v231 offset:256
    buffer_load_dwordx4 v246, s[32:35], s99 offen offset:2048  lds
    ds_read_b64 v[44:45], v16 offset:256
    ds_read_b64 v[46:47], v16 offset:512
    s_add_u32 m0, s61, 61440
    s_add_u32 s16, s16, s63
    buffer_load_dwordx4 v244, s[32:35], s16 offen offset:0  lds
    ds_read_b64 v[48:49], v231 offset:512
    ds_read_b64 v[50:51], v16 offset:768
    buffer_load_dwordx4 v245, s[32:35], s16 offen offset:1024  lds
    ds_read_b64 v[52:53], v231 offset:768
    ds_read_b64 v[54:55], v16 offset:1024
    buffer_load_dwordx4 v246, s[32:35], s16 offen offset:2048  lds
    ds_read_b64 v[56:57], v231 offset:1024
    ds_read_b64 v[58:59], v16 offset:1280
    s_add_u32 s97, s98, s0
    s_lshr_b64 s[0:1], s[0:1], 4
    s_and_b32 s97, s97, 15
    s_add_u32 m0, s87, 0
    s_lshl_b32 s97, s97, 7
    buffer_load_dwordx4 v240, s[28:31], s97 offen offset:0  lds
    ds_read_b64 v[60:61], v231 offset:1280
    ds_read_b64 v[68:69], v16 offset:16896
    buffer_load_dwordx4 v241, s[28:31], s97 offen offset:1024  lds
    ds_read_b64 v[70:71], v231 offset:16896
    ds_read_b64 v[72:73], v16 offset:17152
    buffer_load_dwordx4 v242, s[28:31], s97 offen offset:2048  lds
    ds_read_b64 v[74:75], v231 offset:17152
    ds_read_b64 v[76:77], v16 offset:17408
    buffer_load_dwordx4 v243, s[28:31], s97 offen offset:3072  lds
    ds_read_b64 v[78:79], v231 offset:17408
    ds_read_b64 v[80:81], v16 offset:17664
    s_add_u32 m0, s88, 0
    s_mov_b64 exec, 0xffffffff
    buffer_load_dwordx4 v3, s[28:31], s97 offen offset:0  lds
    s_mov_b64 exec, -1
    ds_read_b64 v[82:83], v231 offset:17664
    s_waitcnt vmcnt(11)
    s_waitcnt lgkmcnt(0)
    s_barrier
    s_mul_i32 s16, s97, 3072
    s_add_u32 m0, s60, 0
    s_add_u32 s99, s16, s62
    buffer_load_dwordx4 v244, s[32:35], s99 offen offset:0  lds
    v_lshlrev_b32 v160, 16, v40
    v_lshlrev_b32 v161, 16, v42
    v_lshlrev_b32 v162, 16, v44
    v_lshlrev_b32 v163, 16, v46
    v_lshlrev_b32 v164, 16, v48
    buffer_load_dwordx4 v245, s[32:35], s99 offen offset:1024  lds
    v_lshlrev_b32 v165, 16, v50
    v_lshlrev_b32 v166, 16, v52
    v_lshlrev_b32 v167, 16, v54
    v_lshlrev_b32 v168, 16, v56
    v_lshlrev_b32 v169, 16, v58
    buffer_load_dwordx4 v246, s[32:35], s99 offen offset:2048  lds
    v_lshlrev_b32 v170, 16, v60
    v_lshlrev_b32 v172, 16, v84
    v_and_b32 v173, 0xffff0000, v84
    v_lshlrev_b32 v174, 16, v85
    v_and_b32 v175, 0xffff0000, v85
    s_add_u32 m0, s61, 12288
    s_add_u32 s16, s16, s63
    buffer_load_dwordx4 v244, s[32:35], s16 offen offset:0  lds
    v_lshlrev_b32 v176, 16, v68
    v_lshlrev_b32 v177, 16, v70
    v_lshlrev_b32 v178, 16, v72
    v_lshlrev_b32 v179, 16, v74
    v_lshlrev_b32 v180, 16, v76
    buffer_load_dwordx4 v245, s[32:35], s16 offen offset:1024  lds
    v_lshlrev_b32 v181, 16, v78
    v_lshlrev_b32 v182, 16, v80
    v_lshlrev_b32 v183, 16, v82
    v_mul_f32 v184, v160, v175
    v_mul_f32 v185, v161, v175
    buffer_load_dwordx4 v246, s[32:35], s16 offen offset:2048  lds
    v_mul_f32 v186, v162, v175
    v_mul_f32 v187, v163, v175
    v_mul_f32 v188, v164, v175
    v_mul_f32 v189, v165, v175
    v_mul_f32 v190, v166, v175
    buffer_load_dword v230, v229, s[4:7], 0 offen
    v_mul_f32 v191, v167, v175
    v_fmac_f32 v184, v161, v174
    v_fmac_f32 v185, v162, v174
    v_fmac_f32 v186, v163, v174
    v_fmac_f32 v187, v164, v174
    buffer_load_dword v230, v228, s[32:35], 0 offen
    v_fmac_f32 v188, v165, v174
    v_fmac_f32 v189, v166, v174
    v_fmac_f32 v190, v167, v174
    v_fmac_f32 v191, v168, v174
    v_fmac_f32 v184, v162, v173
    s_add_u32 s97, s98, s0
    s_lshr_b64 s[0:1], s[0:1], 4
    s_and_b32 s97, s97, 15
    s_add_u32 m0, s87, 18432
    s_lshl_b32 s97, s97, 7
    buffer_load_dwordx4 v240, s[28:31], s97 offen offset:0  lds
    v_fmac_f32 v185, v163, v173
    v_fmac_f32 v186, v164, v173
    v_fmac_f32 v187, v165, v173
    v_fmac_f32 v188, v166, v173
    v_fmac_f32 v189, v167, v173
    buffer_load_dwordx4 v241, s[28:31], s97 offen offset:1024  lds
    v_fmac_f32 v190, v168, v173
    v_fmac_f32 v191, v169, v173
    v_fmac_f32 v184, v163, v172
    v_fmac_f32 v185, v164, v172
    v_fmac_f32 v186, v165, v172
    buffer_load_dwordx4 v242, s[28:31], s97 offen offset:2048  lds
    v_fmac_f32 v187, v166, v172
    v_fmac_f32 v188, v167, v172
    v_fmac_f32 v189, v168, v172
    v_fmac_f32 v190, v169, v172
    v_fmac_f32 v191, v170, v172
    buffer_load_dwordx4 v243, s[28:31], s97 offen offset:3072  lds
    v_mul_f32 v184, v184, v176
    v_mul_f32 v185, v185, v177
    v_mul_f32 v186, v186, v178
    v_mul_f32 v187, v187, v179
    v_mul_f32 v188, v188, v180
    s_add_u32 m0, s88, 18432
    s_mov_b64 exec, 0xffffffff
    buffer_load_dwordx4 v3, s[28:31], s97 offen offset:0  lds
    s_mov_b64 exec, -1
    v_mul_f32 v189, v189, v181
    v_mul_f32 v190, v190, v182
    v_mul_f32 v191, v191, v183
    v_cvt_pk_bf16_f32 v100, v191, v190
    v_cvt_pk_bf16_f32 v101, v189, v188
    v_cvt_pk_bf16_f32 v102, v187, v186
    v_cvt_pk_bf16_f32 v103, v185, v184
    s_mov_b32 s89, 0
    buffer_store_dwordx4 v[100:103], v12, s[52:55], s89 offen sc1
    v_and_b32 v160, 0xffff0000, v40
    v_and_b32 v161, 0xffff0000, v42
    v_and_b32 v162, 0xffff0000, v44
    v_and_b32 v163, 0xffff0000, v46
    v_and_b32 v164, 0xffff0000, v48
    v_and_b32 v165, 0xffff0000, v50
    v_and_b32 v166, 0xffff0000, v52
    v_and_b32 v167, 0xffff0000, v54
    v_and_b32 v168, 0xffff0000, v56
    v_and_b32 v169, 0xffff0000, v58
    v_and_b32 v170, 0xffff0000, v60
    v_lshlrev_b32 v172, 16, v86
    v_and_b32 v173, 0xffff0000, v86
    v_lshlrev_b32 v174, 16, v87
    v_and_b32 v175, 0xffff0000, v87
    v_and_b32 v176, 0xffff0000, v68
    v_and_b32 v177, 0xffff0000, v70
    v_and_b32 v178, 0xffff0000, v72
    v_and_b32 v179, 0xffff0000, v74
    v_and_b32 v180, 0xffff0000, v76
    v_and_b32 v181, 0xffff0000, v78
    v_and_b32 v182, 0xffff0000, v80
    v_and_b32 v183, 0xffff0000, v82
    s_waitcnt vmcnt(14)
    s_barrier
    s_mul_i32 s16, s97, 3072
    s_add_u32 m0, s60, 24576
    s_add_u32 s99, s16, s62
    buffer_load_dwordx4 v244, s[32:35], s99 offen offset:0  lds
    v_mul_f32 v184, v160, v175
    v_mul_f32 v185, v161, v175
    v_mul_f32 v186, v162, v175
    v_mul_f32 v187, v163, v175
    v_mul_f32 v188, v164, v175
    buffer_load_dwordx4 v245, s[32:35], s99 offen offset:1024  lds
    v_mul_f32 v189, v165, v175
    v_mul_f32 v190, v166, v175
    v_mul_f32 v191, v167, v175
    v_fmac_f32 v184, v161, v174
    v_fmac_f32 v185, v162, v174
    buffer_load_dwordx4 v246, s[32:35], s99 offen offset:2048  lds
    v_fmac_f32 v186, v163, v174
    v_fmac_f32 v187, v164, v174
    v_fmac_f32 v188, v165, v174
    v_fmac_f32 v189, v166, v174
    v_fmac_f32 v190, v167, v174
    s_add_u32 m0, s61, 36864
    s_add_u32 s16, s16, s63
    buffer_load_dwordx4 v244, s[32:35], s16 offen offset:0  lds
    v_fmac_f32 v191, v168, v174
    v_fmac_f32 v184, v162, v173
    v_fmac_f32 v185, v163, v173
    v_fmac_f32 v186, v164, v173
    v_fmac_f32 v187, v165, v173
    buffer_load_dwordx4 v245, s[32:35], s16 offen offset:1024  lds
    v_fmac_f32 v188, v166, v173
    v_fmac_f32 v189, v167, v173
    v_fmac_f32 v190, v168, v173
    v_fmac_f32 v191, v169, v173
    v_fmac_f32 v184, v163, v172
    buffer_load_dwordx4 v246, s[32:35], s16 offen offset:2048  lds
    v_fmac_f32 v185, v164, v172
    v_fmac_f32 v186, v165, v172
    v_fmac_f32 v187, v166, v172
    v_fmac_f32 v188, v167, v172
    v_fmac_f32 v189, v168, v172
    s_add_u32 s97, s98, s0
    s_lshr_b64 s[0:1], s[0:1], 4
    s_and_b32 s97, s97, 15
    s_add_u32 m0, s87, 36864
    s_lshl_b32 s97, s97, 7
    buffer_load_dwordx4 v240, s[28:31], s97 offen offset:0  lds
    v_fmac_f32 v190, v169, v172
    v_fmac_f32 v191, v170, v172
    v_mul_f32 v184, v184, v176
    v_mul_f32 v185, v185, v177
    v_mul_f32 v186, v186, v178
    buffer_load_dwordx4 v241, s[28:31], s97 offen offset:1024  lds
    v_mul_f32 v187, v187, v179
    v_mul_f32 v188, v188, v180
    v_mul_f32 v189, v189, v181
    v_mul_f32 v190, v190, v182
    v_mul_f32 v191, v191, v183
    buffer_load_dwordx4 v242, s[28:31], s97 offen offset:2048  lds
    v_cvt_pk_bf16_f32 v104, v191, v190
    v_cvt_pk_bf16_f32 v105, v189, v188
    v_cvt_pk_bf16_f32 v106, v187, v186
    v_cvt_pk_bf16_f32 v107, v185, v184
    s_mov_b32 s89, 16384
    buffer_store_dwordx4 v[104:107], v12, s[52:55], s89 offen sc1
    buffer_load_dwordx4 v243, s[28:31], s97 offen offset:3072  lds
    v_lshlrev_b32 v160, 16, v41
    v_lshlrev_b32 v161, 16, v43
    v_lshlrev_b32 v162, 16, v45
    v_lshlrev_b32 v163, 16, v47
    v_lshlrev_b32 v164, 16, v49
    s_add_u32 m0, s88, 36864
    s_mov_b64 exec, 0xffffffff
    buffer_load_dwordx4 v3, s[28:31], s97 offen offset:0  lds
    s_mov_b64 exec, -1
    v_lshlrev_b32 v165, 16, v51
    v_lshlrev_b32 v166, 16, v53
    v_lshlrev_b32 v167, 16, v55
    v_lshlrev_b32 v168, 16, v57
    v_lshlrev_b32 v169, 16, v59
    v_lshlrev_b32 v170, 16, v61
    v_lshlrev_b32 v172, 16, v88
    v_and_b32 v173, 0xffff0000, v88
    v_lshlrev_b32 v174, 16, v89
    v_and_b32 v175, 0xffff0000, v89
    v_lshlrev_b32 v176, 16, v69
    v_lshlrev_b32 v177, 16, v71
    v_lshlrev_b32 v178, 16, v73
    v_lshlrev_b32 v179, 16, v75
    v_lshlrev_b32 v180, 16, v77
    v_lshlrev_b32 v181, 16, v79
    v_lshlrev_b32 v182, 16, v81
    v_lshlrev_b32 v183, 16, v83
    v_mul_f32 v184, v160, v175
    v_mul_f32 v185, v161, v175
    v_mul_f32 v186, v162, v175
    v_mul_f32 v187, v163, v175
    v_mul_f32 v188, v164, v175
    v_mul_f32 v189, v165, v175
    v_mul_f32 v190, v166, v175
    v_mul_f32 v191, v167, v175
    v_fmac_f32 v184, v161, v174
    v_fmac_f32 v185, v162, v174
    v_fmac_f32 v186, v163, v174
    v_fmac_f32 v187, v164, v174
    v_fmac_f32 v188, v165, v174
    v_fmac_f32 v189, v166, v174
    v_fmac_f32 v190, v167, v174
    v_fmac_f32 v191, v168, v174
    v_fmac_f32 v184, v162, v173
    v_fmac_f32 v185, v163, v173
    v_fmac_f32 v186, v164, v173
    v_fmac_f32 v187, v165, v173
    v_fmac_f32 v188, v166, v173
    v_fmac_f32 v189, v167, v173
    v_fmac_f32 v190, v168, v173
    s_waitcnt vmcnt(13)
    s_barrier
    s_mul_i32 s16, s97, 3072
    s_add_u32 m0, s60, 49152
    s_add_u32 s99, s16, s62
    buffer_load_dwordx4 v244, s[32:35], s99 offen offset:0  lds
    v_fmac_f32 v191, v169, v173
    v_fmac_f32 v184, v163, v172
    v_fmac_f32 v185, v164, v172
    v_fmac_f32 v186, v165, v172
    v_fmac_f32 v187, v166, v172
    buffer_load_dwordx4 v245, s[32:35], s99 offen offset:1024  lds
    v_fmac_f32 v188, v167, v172
    v_fmac_f32 v189, v168, v172
    v_fmac_f32 v190, v169, v172
    v_fmac_f32 v191, v170, v172
    v_mul_f32 v184, v184, v176
    buffer_load_dwordx4 v246, s[32:35], s99 offen offset:2048  lds
    v_mul_f32 v185, v185, v177
    v_mul_f32 v186, v186, v178
    v_mul_f32 v187, v187, v179
    v_mul_f32 v188, v188, v180
    v_mul_f32 v189, v189, v181
    s_add_u32 m0, s61, 61440
    s_add_u32 s16, s16, s63
    buffer_load_dwordx4 v244, s[32:35], s16 offen offset:0  lds
    v_mul_f32 v190, v190, v182
    v_mul_f32 v191, v191, v183
    v_cvt_pk_bf16_f32 v108, v191, v190
    v_cvt_pk_bf16_f32 v109, v189, v188
    v_cvt_pk_bf16_f32 v110, v187, v186
    buffer_load_dwordx4 v245, s[32:35], s16 offen offset:1024  lds
    v_cvt_pk_bf16_f32 v111, v185, v184
    s_mov_b32 s89, 32768
    buffer_store_dwordx4 v[108:111], v12, s[52:55], s89 offen sc1
    v_and_b32 v160, 0xffff0000, v41
    v_and_b32 v161, 0xffff0000, v43
    v_and_b32 v162, 0xffff0000, v45
    buffer_load_dwordx4 v246, s[32:35], s16 offen offset:2048  lds
    v_and_b32 v163, 0xffff0000, v47
    v_and_b32 v164, 0xffff0000, v49
    v_and_b32 v165, 0xffff0000, v51
    v_and_b32 v166, 0xffff0000, v53
    v_and_b32 v167, 0xffff0000, v55
    s_add_u32 s97, s98, s0
    s_lshr_b64 s[0:1], s[0:1], 4
    s_and_b32 s97, s97, 15
    s_add_u32 m0, s87, 0
    s_lshl_b32 s97, s97, 7
    buffer_load_dwordx4 v240, s[28:31], s97 offen offset:0  lds
    v_and_b32 v168, 0xffff0000, v57
    v_and_b32 v169, 0xffff0000, v59
    v_and_b32 v170, 0xffff0000, v61
    v_lshlrev_b32 v172, 16, v90
    v_and_b32 v173, 0xffff0000, v90
    buffer_load_dwordx4 v241, s[28:31], s97 offen offset:1024  lds
    v_lshlrev_b32 v174, 16, v91
    v_and_b32 v175, 0xffff0000, v91
    v_and_b32 v176, 0xffff0000, v69
    v_and_b32 v177, 0xffff0000, v71
    v_and_b32 v178, 0xffff0000, v73
    buffer_load_dwordx4 v242, s[28:31], s97 offen offset:2048  lds
    v_and_b32 v179, 0xffff0000, v75
    v_and_b32 v180, 0xffff0000, v77
    v_and_b32 v181, 0xffff0000, v79
    v_and_b32 v182, 0xffff0000, v81
    v_and_b32 v183, 0xffff0000, v83
    buffer_load_dwordx4 v243, s[28:31], s97 offen offset:3072  lds
    v_mul_f32 v184, v160, v175
    v_mul_f32 v185, v161, v175
    v_mul_f32 v186, v162, v175
    v_mul_f32 v187, v163, v175
    v_mul_f32 v188, v164, v175
    s_add_u32 m0, s88, 0
    s_mov_b64 exec, 0xffffffff
    buffer_load_dwordx4 v3, s[28:31], s97 offen offset:0  lds
    s_mov_b64 exec, -1
    v_mul_f32 v189, v165, v175
    v_mul_f32 v190, v166, v175
    v_mul_f32 v191, v167, v175
    v_fmac_f32 v184, v161, v174
    v_fmac_f32 v185, v162, v174
    v_fmac_f32 v186, v163, v174
    v_fmac_f32 v187, v164, v174
    v_fmac_f32 v188, v165, v174
    v_fmac_f32 v189, v166, v174
    v_fmac_f32 v190, v167, v174
    v_fmac_f32 v191, v168, v174
    v_fmac_f32 v184, v162, v173
    v_fmac_f32 v185, v163, v173
    v_fmac_f32 v186, v164, v173
    v_fmac_f32 v187, v165, v173
    v_fmac_f32 v188, v166, v173
    v_fmac_f32 v189, v167, v173
    v_fmac_f32 v190, v168, v173
    v_fmac_f32 v191, v169, v173
    v_fmac_f32 v184, v163, v172
    v_fmac_f32 v185, v164, v172
    v_fmac_f32 v186, v165, v172
    v_fmac_f32 v187, v166, v172
    v_fmac_f32 v188, v167, v172
    v_fmac_f32 v189, v168, v172
    v_fmac_f32 v190, v169, v172
    v_fmac_f32 v191, v170, v172
    v_mul_f32 v184, v184, v176
    v_mul_f32 v185, v185, v177
    v_mul_f32 v186, v186, v178
    v_mul_f32 v187, v187, v179
    v_mul_f32 v188, v188, v180
    v_mul_f32 v189, v189, v181
    v_mul_f32 v190, v190, v182
    v_mul_f32 v191, v191, v183
    v_cvt_pk_bf16_f32 v112, v191, v190
    v_cvt_pk_bf16_f32 v113, v189, v188
    v_cvt_pk_bf16_f32 v114, v187, v186
    v_cvt_pk_bf16_f32 v115, v185, v184
    s_mov_b32 s89, 49152
    buffer_store_dwordx4 v[112:115], v12, s[52:55], s89 offen sc1
    s_waitcnt vmcnt(13)
    s_barrier
    s_mul_i32 s16, s97, 3072
    s_add_u32 m0, s60, 0
    s_add_u32 s99, s16, s62
    buffer_load_dwordx4 v244, s[32:35], s99 offen offset:0  lds
    buffer_load_dwordx4 v245, s[32:35], s99 offen offset:1024  lds
    buffer_load_dwordx4 v246, s[32:35], s99 offen offset:2048  lds
    s_add_u32 m0, s61, 12288
    s_add_u32 s16, s16, s63
    buffer_load_dwordx4 v244, s[32:35], s16 offen offset:0  lds
    buffer_load_dwordx4 v245, s[32:35], s16 offen offset:1024  lds
    buffer_load_dwordx4 v246, s[32:35], s16 offen offset:2048  lds
    s_add_u32 s97, s98, s0
    s_lshr_b64 s[0:1], s[0:1], 4
    s_and_b32 s97, s97, 15
    s_add_u32 m0, s87, 18432
    s_lshl_b32 s97, s97, 7
    buffer_load_dwordx4 v240, s[28:31], s97 offen offset:0  lds
    buffer_load_dwordx4 v241, s[28:31], s97 offen offset:1024  lds
    buffer_load_dwordx4 v242, s[28:31], s97 offen offset:2048  lds
    buffer_load_dwordx4 v243, s[28:31], s97 offen offset:3072  lds
    s_add_u32 m0, s88, 18432
    s_mov_b64 exec, 0xffffffff
    buffer_load_dwordx4 v3, s[28:31], s97 offen offset:0  lds
    s_mov_b64 exec, -1
    s_waitcnt vmcnt(12)
    s_barrier
    s_mul_i32 s16, s97, 3072
    s_add_u32 m0, s60, 24576
    s_add_u32 s99, s16, s62
    buffer_load_dwordx4 v244, s[32:35], s99 offen offset:0  lds
    buffer_load_dwordx4 v245, s[32:35], s99 offen offset:1024  lds
    buffer_load_dwordx4 v246, s[32:35], s99 offen offset:2048  lds
    s_add_u32 m0, s61, 36864
    s_add_u32 s16, s16, s63
    buffer_load_dwordx4 v244, s[32:35], s16 offen offset:0  lds
    buffer_load_dwordx4 v245, s[32:35], s16 offen offset:1024  lds
    buffer_load_dwordx4 v246, s[32:35], s16 offen offset:2048  lds
    s_add_u32 m0, s94, 32
    s_lshl_b32 s89, s90, 12
    buffer_load_dwordx4 v15, s[48:51], s89 offen offset:0 nt lds
    s_add_u32 m0, s94, 32
    s_lshl_b32 s89, s90, 12
    buffer_load_dwordx4 v15, s[48:51], s89 offen offset:1024 nt lds
    s_add_u32 m0, s94, 32
    s_lshl_b32 s89, s90, 12
    buffer_load_dwordx4 v15, s[48:51], s89 offen offset:2048 nt lds
    s_add_u32 m0, s94, 32
    s_lshl_b32 s89, s90, 12
    buffer_load_dwordx4 v15, s[48:51], s89 offen offset:3072 nt lds
    s_add_u32 s97, s98, s0
    s_lshr_b64 s[0:1], s[0:1], 4
    s_and_b32 s97, s97, 15
    s_add_u32 m0, s87, 36864
    s_lshl_b32 s97, s97, 7
    buffer_load_dwordx4 v240, s[28:31], s97 offen offset:0  lds
    buffer_load_dwordx4 v241, s[28:31], s97 offen offset:1024  lds
    buffer_load_dwordx4 v242, s[28:31], s97 offen offset:2048  lds
    buffer_load_dwordx4 v243, s[28:31], s97 offen offset:3072  lds
    s_add_u32 m0, s88, 36864
    s_mov_b64 exec, 0xffffffff
    buffer_load_dwordx4 v3, s[28:31], s97 offen offset:0  lds
    s_mov_b64 exec, -1
    s_waitcnt vmcnt(15)
    s_barrier
    s_mul_i32 s16, s97, 3072
    s_add_u32 m0, s60, 49152
    s_add_u32 s99, s16, s62
    buffer_load_dwordx4 v244, s[32:35], s99 offen offset:0  lds
    s_mov_b32 s68, s24
    s_mov_b32 s69, s25
    s_mov_b32 s70, 0x100
    s_mov_b32 s71, 0x20000
    v_lshrrev_b32 v6, 5, v0
    buffer_load_dwordx4 v245, s[32:35], s99 offen offset:1024  lds
    v_and_b32 v7, 3, v0
    s_lshr_b32 s78, s90, 1
    s_lshl_b32 s78, s78, 2
    s_load_dword s92, s[14:15], s78
    v_bfe_u32 v5, v0, 2, 2
    buffer_load_dwordx4 v246, s[32:35], s99 offen offset:2048  lds
    v_lshlrev_b32 v5, 1, v5
    v_lshl_add_u32 v5, v6, 3, v5
    v_bfe_u32 v8, v0, 4, 1
    v_add_u32 v5, v5, v8
    s_and_b32 s78, s3, 1
    s_add_u32 m0, s61, 61440
    s_add_u32 s16, s16, s63
    buffer_load_dwordx4 v244, s[32:35], s16 offen offset:0  lds
    s_lshl_b32 s78, s78, 1
    v_add_u32 v8, s78, v6
    v_xor_b32 v8, v8, v7
    v_lshlrev_b32 v8, 4, v8
    buffer_load_dwordx4 v245, s[32:35], s16 offen offset:1024  lds
    v_lshl_add_u32 v5, v5, 6, v8
    v_add_u32 v14, s86, v5
    v_mov_b32 v18, 162304
    v_mov_b32 v19, 1
    v_and_b32 v5, 3, v0
    buffer_load_dwordx4 v246, s[32:35], s16 offen offset:2048  lds
    s_lshl_b32 s78, s74, 4
    s_add_u32 s78, s78, s3
    v_lshl_add_u32 v6, v5, 2, s78
    s_lshr_b32 s78, s76, 3
    s_lshl_b32 s79, s3, 1
    s_add_u32 s97, s98, s0
    s_lshr_b64 s[0:1], s[0:1], 4
    s_and_b32 s97, s97, 15
    s_add_u32 m0, s87, 0
    s_lshl_b32 s97, s97, 7
    buffer_load_dwordx4 v240, s[28:31], s97 offen offset:0  lds
    s_add_u32 s78, s78, s79
    s_xor_b32 s78, s78, 2
    s_lshl_b32 s78, s78, 5
    s_add_u32 s79, s76, 5
    s_and_b32 s79, s79, 7
    buffer_load_dwordx4 v241, s[28:31], s97 offen offset:1024  lds
    s_lshl_b32 s79, s79, 1
    s_add_u32 s78, s78, s79
    v_mul_u32_u24 v7, 9, v5
    v_and_b32 v7, 17, v7
    buffer_load_dwordx4 v242, s[28:31], s97 offen offset:2048  lds
    v_add_u32 v7, s78, v7
    v_and_b32 v8, 4, v0
    v_cmp_eq_u32 vcc, 0, v8
    s_nop 1
    v_cndmask_b32 v6, v7, v6, vcc
    v_and_b32 v33, 0xf0, v6
    buffer_load_dwordx4 v243, s[28:31], s97 offen offset:3072  lds
    v_lshlrev_b32 v34, 8, v6
    v_add_u32 v34, 12582912, v34
    v_and_b32 v5, 15, v0
    v_lshrrev_b32 v6, 4, v0
    v_add_u32 v7, 9, v5
    s_add_u32 m0, s88, 0
    s_mov_b64 exec, 0xffffffff
    buffer_load_dwordx4 v3, s[28:31], s97 offen offset:0  lds
    s_mov_b64 exec, -1
    v_and_b32 v8, 1, v7
    v_mul_u32_u24 v8, 4160, v8
    v_lshrrev_b32 v7, 1, v7
    v_lshl_add_u32 v8, v7, 2, v8
    s_waitcnt vmcnt(11)
    s_barrier
    s_mul_i32 s16, s97, 3072
    s_add_u32 m0, s60, 0
    s_add_u32 s99, s16, s62
    buffer_load_dwordx4 v244, s[32:35], s99 offen offset:0  lds
    v_lshlrev_b32 v7, 4, v6
    v_sub_u32 v8, v8, v7
    s_add_u32 s78, s94, 32
    v_add_u32 v21, s78, v8
    v_add_u32 v22, 1024, v21
    buffer_load_dwordx4 v245, s[32:35], s99 offen offset:1024  lds
    v_add_u32 v23, 2048, v21
    v_add_u32 v24, 3072, v21
    v_lshl_add_u32 v7, v5, 1, v6
    v_add_u32 v7, 30, v7
    v_and_b32 v8, 1, v7
    buffer_load_dwordx4 v246, s[32:35], s99 offen offset:2048  lds
    v_bfe_u32 v136, v7, 1, 2
    v_lshl_add_u32 v136, v8, 2, v136
    v_lshlrev_b32 v136, 6, v136
    v_lshrrev_b32 v7, 3, v7
    v_lshl_add_u32 v136, v7, 9, v136
    s_add_u32 m0, s61, 12288
    s_add_u32 s16, s16, s63
    buffer_load_dwordx4 v244, s[32:35], s16 offen offset:0  lds
    v_bitop3_b32 v8, v7, 3, s3 bitop3:0x6a
    v_lshl_add_u32 v25, v8, 4, v136
    v_add_u32 v25, 92160, v25
    v_subrev_u32 v7, 1, v7
    buffer_load_dwordx4 v245, s[32:35], s16 offen offset:1024  lds
    v_bitop3_b32 v8, v7, 3, s3 bitop3:0x6a
    v_lshl_add_u32 v27, v8, 4, v136
    v_add_u32 v27, 91648, v27
    v_subrev_u32 v7, 1, v7
    v_bitop3_b32 v8, v7, 3, s3 bitop3:0x6a
    buffer_load_dwordx4 v246, s[32:35], s16 offen offset:2048  lds
    v_lshl_add_u32 v29, v8, 4, v136
    v_add_u32 v29, 91136, v29
    v_subrev_u32 v7, 1, v7
    v_bitop3_b32 v8, v7, 3, s3 bitop3:0x6a
    v_lshl_add_u32 v31, v8, 4, v136
    s_add_u32 s97, s98, s0
    s_lshr_b64 s[0:1], s[0:1], 4
    s_and_b32 s97, s97, 15
    s_add_u32 m0, s87, 18432
    s_lshl_b32 s97, s97, 7
    buffer_load_dwordx4 v240, s[28:31], s97 offen offset:0  lds
    v_add_u32 v31, 90624, v31
    v_lshl_add_u32 v7, v5, 1, v6
    v_add_u32 v7, 26, v7
    v_and_b32 v8, 1, v7
    v_bfe_u32 v136, v7, 1, 2
    buffer_load_dwordx4 v241, s[28:31], s97 offen offset:1024  lds
    v_lshl_add_u32 v136, v8, 2, v136
    v_lshlrev_b32 v136, 6, v136
    v_lshrrev_b32 v7, 3, v7
    v_lshl_add_u32 v136, v7, 9, v136
    buffer_load_dwordx4 v242, s[28:31], s97 offen offset:2048  lds
    v_bitop3_b32 v8, v7, 3, s3 bitop3:0x6a
    v_lshl_add_u32 v26, v8, 4, v136
    v_add_u32 v26, 92160, v26
    v_subrev_u32 v7, 1, v7
    v_bitop3_b32 v8, v7, 3, s3 bitop3:0x6a
    buffer_load_dwordx4 v243, s[28:31], s97 offen offset:3072  lds
    v_lshl_add_u32 v28, v8, 4, v136
    v_add_u32 v28, 91648, v28
    v_subrev_u32 v7, 1, v7
    v_bitop3_b32 v8, v7, 3, s3 bitop3:0x6a
    v_lshl_add_u32 v30, v8, 4, v136
    s_add_u32 m0, s88, 18432
    s_mov_b64 exec, 0xffffffff
    buffer_load_dwordx4 v3, s[28:31], s97 offen offset:0  lds
    s_mov_b64 exec, -1
    v_add_u32 v30, 91136, v30
    v_subrev_u32 v7, 1, v7
    v_bitop3_b32 v8, v7, 3, s3 bitop3:0x6a
    v_lshl_add_u32 v32, v8, 4, v136
    s_waitcnt vmcnt(11)
    s_barrier
    s_mul_i32 s16, s97, 3072
    s_add_u32 m0, s60, 24576
    s_add_u32 s99, s16, s62
    buffer_load_dwordx4 v244, s[32:35], s99 offen offset:0  lds
    v_add_u32 v32, 90624, v32
    v_lshrrev_b32 v7, 1, v6
    v_lshl_add_u32 v7, v5, 1, v7
    v_add_u32 v7, 32, v7
    v_and_b32 v8, 1, v7
    buffer_load_dwordx4 v245, s[32:35], s99 offen offset:1024  lds
    v_bfe_u32 v136, v7, 1, 2
    v_lshl_add_u32 v136, v8, 2, v136
    v_lshlrev_b32 v136, 6, v136
    v_lshrrev_b32 v7, 3, v7
    buffer_load_dwordx4 v246, s[32:35], s99 offen offset:2048  lds
    v_lshl_add_u32 v136, v7, 9, v136
    v_bitop3_b32 v8, v7, 3, s3 bitop3:0x6a
    v_lshl_add_u32 v20, v8, 4, v136
    v_add_u32 v20, 92160, v20
    v_and_b32 v8, 1, v6
    s_add_u32 m0, s61, 36864
    s_add_u32 s16, s16, s63
    buffer_load_dwordx4 v244, s[32:35], s16 offen offset:0  lds
    v_xor_b32 v8, 1, v8
    v_lshl_add_u32 v20, v8, 3, v20
    s_waitcnt lgkmcnt(0)
    s_and_b32 s78, s92, 0xffff0000
    buffer_load_dwordx4 v245, s[32:35], s16 offen offset:1024  lds
    s_lshl_b32 s92, s92, 16
    s_bitcmp1_b32 s90, 0
    s_cselect_b32 s92, s78, s92
    v_lshlrev_b32 v7, 3, v6
    v_sub_u32 v7, v7, v5
    buffer_load_dwordx4 v246, s[32:35], s16 offen offset:2048  lds
    v_subrev_u32 v7, 9, v7
    v_and_b32 v8, 1, v7
    v_xor_b32 v8, 1, v8
    v_lshlrev_b32 v8, 4, v8
    v_lshrrev_b32 v8, v8, s92
    s_add_u32 s97, s98, s0
    s_lshr_b64 s[0:1], s[0:1], 4
    s_and_b32 s97, s97, 15
    s_add_u32 m0, s87, 36864
    s_lshl_b32 s97, s97, 7
    buffer_load_dwordx4 v240, s[28:31], s97 offen offset:0  lds
    v_ashrrev_i32 v7, 1, v7
    v_cmp_eq_u32 vcc, 0, v7
    s_nop 1
    v_cndmask_b32 v236, 0, v8, vcc
    v_cmp_eq_u32 vcc, 1, v7
    buffer_load_dwordx4 v241, s[28:31], s97 offen offset:1024  lds
    s_nop 0
    v_cndmask_b32 v237, 0, v8, vcc
    v_cmp_eq_u32 vcc, 2, v7
    s_nop 1
    v_cndmask_b32 v238, 0, v8, vcc
    v_cmp_eq_u32 vcc, 3, v7
    buffer_load_dwordx4 v242, s[28:31], s97 offen offset:2048  lds
    s_nop 0
    v_cndmask_b32 v239, 0, v8, vcc
    s_and_b32 s78, s77, 7
    s_mov_b32 s95, 0x76543210
    s_and_b32 s78, s76, 3
    s_mul_i32 s78, s78, 0x22222222
    s_add_u32 s95, s95, s78
    s_bfe_u32 s100, s95, 0x3001c
    s_lshl_b32 s100, s100, 18
    s_bfe_u32 s95, s95, 0x30018
    s_lshl_b32 s95, s95, 18
    v_lshrrev_b32 v136, 4, v0
    v_lshlrev_b32 v136, 1, v136
    v_and_b32 v137, 7, v0
    buffer_load_dwordx4 v243, s[28:31], s97 offen offset:3072  lds
    v_xor_b32 v136, v136, v137
    v_lshlrev_b32 v136, 4, v136
    v_lshrrev_b32 v137, 3, v0
    v_lshl_add_u32 v136, v137, 11, v136
    s_add_u32 m0, s88, 36864
    s_mov_b64 exec, 0xffffffff
    buffer_load_dwordx4 v3, s[28:31], s97 offen offset:0  lds
    s_mov_b64 exec, -1
    s_lshl_b32 s78, s77, 7
    s_lshl_b32 s79, s3, 14
    s_add_u32 s78, s78, s79
    v_add_u32 v17, s78, v136
    s_waitcnt vmcnt(11)
    s_barrier
    s_mul_i32 s16, s97, 3072
    s_add_u32 m0, s60, 49152
    s_add_u32 s99, s16, s62
    buffer_load_dwordx4 v244, s[32:35], s99 offen offset:0  lds
    v_add_u32 v5, s94, v15
    ds_read_b128 v[140:143], v5 offset:32
    ds_read_b32 v156, v5 offset:48
    ds_read_b128 v[144:147], v5 offset:1056
    buffer_load_dwordx4 v245, s[32:35], s99 offen offset:1024  lds
    ds_read_b32 v157, v5 offset:1072
    ds_read_b128 v[148:151], v5 offset:2080
    ds_read_b32 v158, v5 offset:2096
    ds_read_b128 v[152:155], v5 offset:3104
    buffer_load_dwordx4 v246, s[32:35], s99 offen offset:2048  lds
    ds_read_b32 v159, v5 offset:3120
    v_lshrrev_b32 v6, 3, v0
    v_mul_u32_u24 v6, 4160, v6
    s_add_u32 m0, s61, 61440
    s_add_u32 s16, s16, s63
    buffer_load_dwordx4 v244, s[32:35], s16 offen offset:0  lds
    v_and_b32 v7, 7, v0
    v_lshl_add_u32 v6, v7, 2, v6
    v_add_u32 v6, s94, v6
    v_mov_b32 v7, 0
    buffer_load_dwordx4 v245, s[32:35], s16 offen offset:1024  lds
    s_waitcnt lgkmcnt(0)
    v_readfirstlane_b32 s93, v140
    s_nop 0
    s_lshl_b32 s93, s93, 16
    s_nop 1
    v_writelane_b32 v7, s93, 15
    buffer_load_dwordx4 v246, s[32:35], s16 offen offset:2048  lds
    v_alignbit_b32 v140, v141, v140, 16
    v_alignbit_b32 v141, v142, v141, 16
    v_alignbit_b32 v142, v143, v142, 16
    s_add_u32 s97, s98, s0
    s_lshr_b64 s[0:1], s[0:1], 4
    s_and_b32 s97, s97, 15
    s_add_u32 m0, s87, 0
    s_lshl_b32 s97, s97, 7
    buffer_load_dwordx4 v240, s[28:31], s97 offen offset:0  lds
    v_alignbit_b32 v143, v156, v143, 16
    v_alignbit_b32 v144, v145, v144, 16
    v_alignbit_b32 v145, v146, v145, 16
    v_alignbit_b32 v146, v147, v146, 16
    buffer_load_dwordx4 v241, s[28:31], s97 offen offset:1024  lds
    v_alignbit_b32 v147, v157, v147, 16
    v_alignbit_b32 v148, v149, v148, 16
    v_alignbit_b32 v149, v150, v149, 16
    v_alignbit_b32 v150, v151, v150, 16
    buffer_load_dwordx4 v242, s[28:31], s97 offen offset:2048  lds
    v_alignbit_b32 v151, v158, v151, 16
    v_alignbit_b32 v152, v153, v152, 16
    v_alignbit_b32 v153, v154, v153, 16
    buffer_load_dwordx4 v243, s[28:31], s97 offen offset:3072  lds
    v_alignbit_b32 v154, v155, v154, 16
    v_alignbit_b32 v155, v159, v155, 16
    v_lshlrev_b32 v8, 3, v0
    s_add_u32 s78, s88, 18432
    s_add_u32 m0, s88, 0
    s_mov_b64 exec, 0xffffffff
    buffer_load_dwordx4 v3, s[28:31], s97 offen offset:0  lds
    s_mov_b64 exec, -1
    v_add_u32 v8, s78, v8
    v_mov_b32 v156, 0
    v_mov_b32 v157, 0
    s_waitcnt vmcnt(11)
    s_barrier
    s_mul_i32 s16, s97, 3072
    s_add_u32 m0, s60, 0
    s_add_u32 s99, s16, s62
    buffer_load_dwordx4 v244, s[32:35], s99 offen offset:0  lds
    buffer_load_dwordx4 v245, s[32:35], s99 offen offset:1024  lds
    buffer_load_dwordx4 v246, s[32:35], s99 offen offset:2048  lds
    s_add_u32 m0, s61, 12288
    s_add_u32 s16, s16, s63
    buffer_load_dwordx4 v244, s[32:35], s16 offen offset:0  lds
    buffer_load_dwordx4 v245, s[32:35], s16 offen offset:1024  lds
    buffer_load_dwordx4 v246, s[32:35], s16 offen offset:2048  lds
    s_mov_b64 exec, 0xff
    buffer_load_dword v136, v33, s[68:71], 0 offen sc1
    buffer_load_dword v137, v34, s[52:55], 0 offen sc1
    s_mov_b64 exec, -1
    buffer_load_dwordx4 v[212:215], v9, s[56:59], 0 offen offset:0 nt
    buffer_load_dwordx4 v[216:219], v9, s[56:59], 0 offen offset:2048 nt
    buffer_load_dwordx4 v[220:223], v9, s[56:59], s96 offen offset:0 nt
    buffer_load_dwordx4 v[224:227], v9, s[56:59], s96 offen offset:2048 nt
    s_waitcnt vmcnt(12)
    s_waitcnt vmcnt(6)
    s_barrier
    s_waitcnt vmcnt(4)
    s_branch LA_j
LA_c2:
    s_waitcnt vmcnt(8)
    s_barrier
    buffer_load_dwordx4 v242, s[28:31], s97 offen offset:2048  lds
    buffer_load_dwordx4 v243, s[28:31], s97 offen offset:3072  lds
    s_add_u32 m0, s88, 36864
    s_mov_b64 exec, 0xffffffff
    buffer_load_dwordx4 v3, s[28:31], s97 offen offset:0  lds
    s_mov_b64 exec, -1
    s_mul_i32 s16, s97, 3072
    s_add_u32 m0, s60, 49152
    s_add_u32 s99, s16, s62
    buffer_load_dwordx4 v244, s[32:35], s99 offen offset:0  lds
    buffer_load_dwordx4 v245, s[32:35], s99 offen offset:1024  lds
    buffer_load_dwordx4 v246, s[32:35], s99 offen offset:2048  lds
    s_add_u32 m0, s61, 61440
    s_add_u32 s16, s16, s63
    buffer_load_dwordx4 v244, s[32:35], s16 offen offset:0  lds
    buffer_load_dwordx4 v245, s[32:35], s16 offen offset:1024  lds
    buffer_load_dwordx4 v246, s[32:35], s16 offen offset:2048  lds
    s_add_u32 s97, s98, s0
    s_lshr_b64 s[0:1], s[0:1], 4
    s_and_b32 s97, s97, 15
    s_add_u32 m0, s87, 0
    s_lshl_b32 s97, s97, 7
    buffer_load_dwordx4 v240, s[28:31], s97 offen offset:0  lds
    buffer_load_dwordx4 v241, s[28:31], s97 offen offset:1024  lds
    buffer_load_dwordx4 v242, s[28:31], s97 offen offset:2048  lds
    buffer_load_dwordx4 v243, s[28:31], s97 offen offset:3072  lds
    s_add_u32 m0, s88, 0
    s_mov_b64 exec, 0xffffffff
    buffer_load_dwordx4 v3, s[28:31], s97 offen offset:0  lds
    s_mov_b64 exec, -1
    s_waitcnt vmcnt(11)
    s_barrier
    s_mul_i32 s16, s97, 3072
    s_add_u32 m0, s60, 0
    s_add_u32 s99, s16, s62
    buffer_load_dwordx4 v244, s[32:35], s99 offen offset:0  lds
    buffer_load_dwordx4 v245, s[32:35], s99 offen offset:1024  lds
    buffer_load_dwordx4 v246, s[32:35], s99 offen offset:2048  lds
    s_add_u32 m0, s61, 12288
    s_add_u32 s16, s16, s63
    buffer_load_dwordx4 v244, s[32:35], s16 offen offset:0  lds
    buffer_load_dwordx4 v245, s[32:35], s16 offen offset:1024  lds
    buffer_load_dwordx4 v246, s[32:35], s16 offen offset:2048  lds
    s_add_u32 s97, s98, s0
    s_lshr_b64 s[0:1], s[0:1], 4
    s_and_b32 s97, s97, 15
    s_add_u32 m0, s87, 18432
    s_lshl_b32 s97, s97, 7
    buffer_load_dwordx4 v240, s[28:31], s97 offen offset:0  lds
    buffer_load_dwordx4 v241, s[28:31], s97 offen offset:1024  lds
    buffer_load_dwordx4 v242, s[28:31], s97 offen offset:2048  lds
    buffer_load_dwordx4 v243, s[28:31], s97 offen offset:3072  lds
    s_add_u32 m0, s88, 18432
    s_mov_b64 exec, 0xffffffff
    buffer_load_dwordx4 v3, s[28:31], s97 offen offset:0  lds
    s_mov_b64 exec, -1
    s_waitcnt vmcnt(11)
    s_barrier
    s_mul_i32 s16, s97, 3072
    s_add_u32 m0, s60, 24576
    s_add_u32 s99, s16, s62
    buffer_load_dwordx4 v244, s[32:35], s99 offen offset:0  lds
    buffer_load_dwordx4 v245, s[32:35], s99 offen offset:1024  lds
    buffer_load_dwordx4 v246, s[32:35], s99 offen offset:2048  lds
    s_add_u32 m0, s61, 36864
    s_add_u32 s16, s16, s63
    buffer_load_dwordx4 v244, s[32:35], s16 offen offset:0  lds
    buffer_load_dwordx4 v245, s[32:35], s16 offen offset:1024  lds
    buffer_load_dwordx4 v246, s[32:35], s16 offen offset:2048  lds
    s_add_u32 m0, s86, 129536
    s_mov_b32 s89, 0
    buffer_load_dwordx4 v10, s[36:39], s89 offen nt lds
    s_add_u32 m0, s86, 145920
    s_mov_b32 s89, 0
    buffer_load_dwordx4 v10, s[40:43], s89 offen nt lds
    s_add_u32 m0, s86, 133632
    s_mov_b32 s89, 65536
    buffer_load_dwordx4 v10, s[36:39], s89 offen nt lds
    s_add_u32 m0, s86, 150016
    s_mov_b32 s89, 65536
    buffer_load_dwordx4 v10, s[40:43], s89 offen nt lds
    s_add_u32 m0, s86, 137728
    s_mov_b32 s89, 131072
    buffer_load_dwordx4 v10, s[36:39], s89 offen nt lds
    s_add_u32 m0, s86, 154112
    s_mov_b32 s89, 131072
    buffer_load_dwordx4 v10, s[40:43], s89 offen nt lds
    s_add_u32 m0, s86, 141824
    s_mov_b32 s89, 196608
    buffer_load_dwordx4 v10, s[36:39], s89 offen nt lds
    s_add_u32 m0, s86, 158208
    s_mov_b32 s89, 196608
    buffer_load_dwordx4 v10, s[40:43], s89 offen nt lds
    s_mov_b64 exec, 0xff
    s_lshl_b32 s82, s3, 7
    s_add_u32 m0, s82, 129024
    s_mov_b32 s89, 0
    buffer_load_dwordx4 v11, s[36:39], s89 offen nt lds
    s_lshl_b32 s83, s74, 9
    s_add_u32 s83, s83, s82
    s_and_b32 s89, s3, 2
    s_lshl_b32 s89, s89, 3
    s_add_u32 s82, s82, s89
    s_add_u32 m0, s82, 162816
    s_add_u32 s89, s83, 0
    buffer_load_dwordx4 v15, s[44:47], s89 offen  lds
    s_mov_b64 exec, -1
    s_add_u32 s97, s98, s0
    s_lshr_b64 s[0:1], s[0:1], 4
    s_and_b32 s97, s97, 15
    s_add_u32 m0, s87, 36864
    s_lshl_b32 s97, s97, 7
    buffer_load_dwordx4 v240, s[28:31], s97 offen offset:0  lds
    s_waitcnt vmcnt(17)
    s_barrier
    buffer_load_dwordx4 v241, s[28:31], s97 offen offset:1024  lds
    buffer_load_dwordx4 v242, s[28:31], s97 offen offset:2048  lds
    buffer_load_dwordx4 v243, s[28:31], s97 offen offset:3072  lds
    s_add_u32 m0, s88, 36864
    s_mov_b64 exec, 0xffffffff
    buffer_load_dwordx4 v3, s[28:31], s97 offen offset:0  lds
    s_mov_b64 exec, -1
    s_mul_i32 s16, s97, 3072
    s_add_u32 m0, s60, 49152
    s_add_u32 s99, s16, s62
    buffer_load_dwordx4 v244, s[32:35], s99 offen offset:0  lds
    buffer_load_dwordx4 v245, s[32:35], s99 offen offset:1024  lds
    buffer_load_dwordx4 v246, s[32:35], s99 offen offset:2048  lds
    s_add_u32 m0, s61, 61440
    s_add_u32 s16, s16, s63
    buffer_load_dwordx4 v244, s[32:35], s16 offen offset:0  lds
    buffer_load_dwordx4 v245, s[32:35], s16 offen offset:1024  lds
    buffer_load_dwordx4 v246, s[32:35], s16 offen offset:2048  lds
    s_add_u32 s97, s98, s0
    s_lshr_b64 s[0:1], s[0:1], 4
    s_and_b32 s97, s97, 15
    s_add_u32 m0, s87, 0
    s_lshl_b32 s97, s97, 7
    buffer_load_dwordx4 v240, s[28:31], s97 offen offset:0  lds
    buffer_load_dwordx4 v241, s[28:31], s97 offen offset:1024  lds
    buffer_load_dwordx4 v242, s[28:31], s97 offen offset:2048  lds
    buffer_load_dwordx4 v243, s[28:31], s97 offen offset:3072  lds
    s_add_u32 m0, s88, 0
    s_mov_b64 exec, 0xffffffff
    buffer_load_dwordx4 v3, s[28:31], s97 offen offset:0  lds
    s_mov_b64 exec, -1
    s_waitcnt vmcnt(11)
    s_barrier
    s_mul_i32 s16, s97, 3072
    s_add_u32 m0, s60, 0
    s_add_u32 s99, s16, s62
    buffer_load_dwordx4 v244, s[32:35], s99 offen offset:0  lds
    ds_read_b128 v[84:87], v35 offset:0
    ds_read_b128 v[88:91], v35 offset:16
    buffer_load_dwordx4 v245, s[32:35], s99 offen offset:1024  lds
    ds_read_b64 v[40:41], v16 offset:0
    ds_read_b64 v[42:43], v231 offset:256
    buffer_load_dwordx4 v246, s[32:35], s99 offen offset:2048  lds
    ds_read_b64 v[44:45], v16 offset:256
    ds_read_b64 v[46:47], v16 offset:512
    s_add_u32 m0, s61, 12288
    s_add_u32 s16, s16, s63
    buffer_load_dwordx4 v244, s[32:35], s16 offen offset:0  lds
    ds_read_b64 v[48:49], v231 offset:512
    ds_read_b64 v[50:51], v16 offset:768
    buffer_load_dwordx4 v245, s[32:35], s16 offen offset:1024  lds
    ds_read_b64 v[52:53], v231 offset:768
    ds_read_b64 v[54:55], v16 offset:1024
    buffer_load_dwordx4 v246, s[32:35], s16 offen offset:2048  lds
    ds_read_b64 v[56:57], v231 offset:1024
    ds_read_b64 v[58:59], v16 offset:1280
    s_add_u32 s97, s98, s0
    s_lshr_b64 s[0:1], s[0:1], 4
    s_and_b32 s97, s97, 15
    s_add_u32 m0, s87, 18432
    s_lshl_b32 s97, s97, 7
    buffer_load_dwordx4 v240, s[28:31], s97 offen offset:0  lds
    ds_read_b64 v[60:61], v231 offset:1280
    ds_read_b64 v[68:69], v16 offset:16896
    buffer_load_dwordx4 v241, s[28:31], s97 offen offset:1024  lds
    ds_read_b64 v[70:71], v231 offset:16896
    ds_read_b64 v[72:73], v16 offset:17152
    buffer_load_dwordx4 v242, s[28:31], s97 offen offset:2048  lds
    ds_read_b64 v[74:75], v231 offset:17152
    ds_read_b64 v[76:77], v16 offset:17408
    buffer_load_dwordx4 v243, s[28:31], s97 offen offset:3072  lds
    ds_read_b64 v[78:79], v231 offset:17408
    ds_read_b64 v[80:81], v16 offset:17664
    s_add_u32 m0, s88, 18432
    s_mov_b64 exec, 0xffffffff
    buffer_load_dwordx4 v3, s[28:31], s97 offen offset:0  lds
    s_mov_b64 exec, -1
    ds_read_b64 v[82:83], v231 offset:17664
    s_waitcnt vmcnt(11)
    s_waitcnt lgkmcnt(0)
    s_barrier
    s_mul_i32 s16, s97, 3072
    s_add_u32 m0, s60, 24576
    s_add_u32 s99, s16, s62
    buffer_load_dwordx4 v244, s[32:35], s99 offen offset:0  lds
    v_lshlrev_b32 v160, 16, v40
    v_lshlrev_b32 v161, 16, v42
    v_lshlrev_b32 v162, 16, v44
    v_lshlrev_b32 v163, 16, v46
    v_lshlrev_b32 v164, 16, v48
    buffer_load_dwordx4 v245, s[32:35], s99 offen offset:1024  lds
    v_lshlrev_b32 v165, 16, v50
    v_lshlrev_b32 v166, 16, v52
    v_lshlrev_b32 v167, 16, v54
    v_lshlrev_b32 v168, 16, v56
    v_lshlrev_b32 v169, 16, v58
    buffer_load_dwordx4 v246, s[32:35], s99 offen offset:2048  lds
    v_lshlrev_b32 v170, 16, v60
    v_lshlrev_b32 v172, 16, v84
    v_and_b32 v173, 0xffff0000, v84
    v_lshlrev_b32 v174, 16, v85
    v_and_b32 v175, 0xffff0000, v85
    s_add_u32 m0, s61, 36864
    s_add_u32 s16, s16, s63
    buffer_load_dwordx4 v244, s[32:35], s16 offen offset:0  lds
    v_lshlrev_b32 v176, 16, v68
    v_lshlrev_b32 v177, 16, v70
    v_lshlrev_b32 v178, 16, v72
    v_lshlrev_b32 v179, 16, v74
    v_lshlrev_b32 v180, 16, v76
    buffer_load_dwordx4 v245, s[32:35], s16 offen offset:1024  lds
    v_lshlrev_b32 v181, 16, v78
    v_lshlrev_b32 v182, 16, v80
    v_lshlrev_b32 v183, 16, v82
    v_mul_f32 v184, v160, v175
    v_mul_f32 v185, v161, v175
    buffer_load_dwordx4 v246, s[32:35], s16 offen offset:2048  lds
    v_mul_f32 v186, v162, v175
    v_mul_f32 v187, v163, v175
    v_mul_f32 v188, v164, v175
    v_mul_f32 v189, v165, v175
    v_mul_f32 v190, v166, v175
    s_add_u32 s97, s98, s0
    s_lshr_b64 s[0:1], s[0:1], 4
    s_and_b32 s97, s97, 15
    s_add_u32 m0, s87, 36864
    s_lshl_b32 s97, s97, 7
    buffer_load_dwordx4 v240, s[28:31], s97 offen offset:0  lds
    v_mul_f32 v191, v167, v175
    v_fmac_f32 v184, v161, v174
    v_fmac_f32 v185, v162, v174
    v_fmac_f32 v186, v163, v174
    v_fmac_f32 v187, v164, v174
    buffer_load_dwordx4 v241, s[28:31], s97 offen offset:1024  lds
    v_fmac_f32 v188, v165, v174
    v_fmac_f32 v189, v166, v174
    v_fmac_f32 v190, v167, v174
    v_fmac_f32 v191, v168, v174
    v_fmac_f32 v184, v162, v173
    buffer_load_dwordx4 v242, s[28:31], s97 offen offset:2048  lds
    v_fmac_f32 v185, v163, v173
    v_fmac_f32 v186, v164, v173
    v_fmac_f32 v187, v165, v173
    v_fmac_f32 v188, v166, v173
    v_fmac_f32 v189, v167, v173
    buffer_load_dwordx4 v243, s[28:31], s97 offen offset:3072  lds
    v_fmac_f32 v190, v168, v173
    v_fmac_f32 v191, v169, v173
    v_fmac_f32 v184, v163, v172
    v_fmac_f32 v185, v164, v172
    v_fmac_f32 v186, v165, v172
    s_add_u32 m0, s88, 36864
    s_mov_b64 exec, 0xffffffff
    buffer_load_dwordx4 v3, s[28:31], s97 offen offset:0  lds
    s_mov_b64 exec, -1
    v_fmac_f32 v187, v166, v172
    v_fmac_f32 v188, v167, v172
    v_fmac_f32 v189, v168, v172
    v_fmac_f32 v190, v169, v172
    v_fmac_f32 v191, v170, v172
    v_mul_f32 v184, v184, v176
    v_mul_f32 v185, v185, v177
    v_mul_f32 v186, v186, v178
    v_mul_f32 v187, v187, v179
    v_mul_f32 v188, v188, v180
    v_mul_f32 v189, v189, v181
    v_mul_f32 v190, v190, v182
    v_mul_f32 v191, v191, v183
    v_cvt_pk_bf16_f32 v100, v191, v190
    v_cvt_pk_bf16_f32 v101, v189, v188
    v_cvt_pk_bf16_f32 v102, v187, v186
    v_cvt_pk_bf16_f32 v103, v185, v184
    s_mov_b32 s89, 0
    buffer_store_dwordx4 v[100:103], v12, s[52:55], s89 offen sc1
    v_and_b32 v160, 0xffff0000, v40
    v_and_b32 v161, 0xffff0000, v42
    v_and_b32 v162, 0xffff0000, v44
    v_and_b32 v163, 0xffff0000, v46
    v_and_b32 v164, 0xffff0000, v48
    v_and_b32 v165, 0xffff0000, v50
    v_and_b32 v166, 0xffff0000, v52
    v_and_b32 v167, 0xffff0000, v54
    v_and_b32 v168, 0xffff0000, v56
    v_and_b32 v169, 0xffff0000, v58
    v_and_b32 v170, 0xffff0000, v60
    v_lshlrev_b32 v172, 16, v86
    v_and_b32 v173, 0xffff0000, v86
    v_lshlrev_b32 v174, 16, v87
    v_and_b32 v175, 0xffff0000, v87
    v_and_b32 v176, 0xffff0000, v68
    v_and_b32 v177, 0xffff0000, v70
    v_and_b32 v178, 0xffff0000, v72
    v_and_b32 v179, 0xffff0000, v74
    v_and_b32 v180, 0xffff0000, v76
    v_and_b32 v181, 0xffff0000, v78
    v_and_b32 v182, 0xffff0000, v80
    v_and_b32 v183, 0xffff0000, v82
    s_waitcnt vmcnt(12)
    s_barrier
    s_mul_i32 s16, s97, 3072
    s_add_u32 m0, s60, 49152
    s_add_u32 s99, s16, s62
    buffer_load_dwordx4 v244, s[32:35], s99 offen offset:0  lds
    v_mul_f32 v184, v160, v175
    v_mul_f32 v185, v161, v175
    v_mul_f32 v186, v162, v175
    v_mul_f32 v187, v163, v175
    v_mul_f32 v188, v164, v175
    buffer_load_dwordx4 v245, s[32:35], s99 offen offset:1024  lds
    v_mul_f32 v189, v165, v175
    v_mul_f32 v190, v166, v175
    v_mul_f32 v191, v167, v175
    v_fmac_f32 v184, v161, v174
    v_fmac_f32 v185, v162, v174
    buffer_load_dwordx4 v246, s[32:35], s99 offen offset:2048  lds
    v_fmac_f32 v186, v163, v174
    v_fmac_f32 v187, v164, v174
    v_fmac_f32 v188, v165, v174
    v_fmac_f32 v189, v166, v174
    v_fmac_f32 v190, v167, v174
    s_add_u32 m0, s61, 61440
    s_add_u32 s16, s16, s63
    buffer_load_dwordx4 v244, s[32:35], s16 offen offset:0  lds
    v_fmac_f32 v191, v168, v174
    v_fmac_f32 v184, v162, v173
    v_fmac_f32 v185, v163, v173
    v_fmac_f32 v186, v164, v173
    v_fmac_f32 v187, v165, v173
    buffer_load_dwordx4 v245, s[32:35], s16 offen offset:1024  lds
    v_fmac_f32 v188, v166, v173
    v_fmac_f32 v189, v167, v173
    v_fmac_f32 v190, v168, v173
    v_fmac_f32 v191, v169, v173
    v_fmac_f32 v184, v163, v172
    buffer_load_dwordx4 v246, s[32:35], s16 offen offset:2048  lds
    v_fmac_f32 v185, v164, v172
    v_fmac_f32 v186, v165, v172
    v_fmac_f32 v187, v166, v172
    v_fmac_f32 v188, v167, v172
    v_fmac_f32 v189, v168, v172
    s_add_u32 s97, s98, s0
    s_lshr_b64 s[0:1], s[0:1], 4
    s_and_b32 s97, s97, 15
    s_add_u32 m0, s87, 0
    s_lshl_b32 s97, s97, 7
    buffer_load_dwordx4 v240, s[28:31], s97 offen offset:0  lds
    v_fmac_f32 v190, v169, v172
    v_fmac_f32 v191, v170, v172
    v_mul_f32 v184, v184, v176
    v_mul_f32 v185, v185, v177
    v_mul_f32 v186, v186, v178
    buffer_load_dwordx4 v241, s[28:31], s97 offen offset:1024  lds
    v_mul_f32 v187, v187, v179
    v_mul_f32 v188, v188, v180
    v_mul_f32 v189, v189, v181
    v_mul_f32 v190, v190, v182
    v_mul_f32 v191, v191, v183
    buffer_load_dwordx4 v242, s[28:31], s97 offen offset:2048  lds
    v_cvt_pk_bf16_f32 v104, v191, v190
    v_cvt_pk_bf16_f32 v105, v189, v188
    v_cvt_pk_bf16_f32 v106, v187, v186
    v_cvt_pk_bf16_f32 v107, v185, v184
    s_mov_b32 s89, 16384
    buffer_store_dwordx4 v[104:107], v12, s[52:55], s89 offen sc1
    buffer_load_dwordx4 v243, s[28:31], s97 offen offset:3072  lds
    v_lshlrev_b32 v160, 16, v41
    v_lshlrev_b32 v161, 16, v43
    v_lshlrev_b32 v162, 16, v45
    v_lshlrev_b32 v163, 16, v47
    v_lshlrev_b32 v164, 16, v49
    s_add_u32 m0, s88, 0
    s_mov_b64 exec, 0xffffffff
    buffer_load_dwordx4 v3, s[28:31], s97 offen offset:0  lds
    s_mov_b64 exec, -1
    v_lshlrev_b32 v165, 16, v51
    v_lshlrev_b32 v166, 16, v53
    v_lshlrev_b32 v167, 16, v55
    v_lshlrev_b32 v168, 16, v57
    v_lshlrev_b32 v169, 16, v59
    v_lshlrev_b32 v170, 16, v61
    v_lshlrev_b32 v172, 16, v88
    v_and_b32 v173, 0xffff0000, v88
    v_lshlrev_b32 v174, 16, v89
    v_and_b32 v175, 0xffff0000, v89
    v_lshlrev_b32 v176, 16, v69
    v_lshlrev_b32 v177, 16, v71
    v_lshlrev_b32 v178, 16, v73
    v_lshlrev_b32 v179, 16, v75
    v_lshlrev_b32 v180, 16, v77
    v_lshlrev_b32 v181, 16, v79
    v_lshlrev_b32 v182, 16, v81
    v_lshlrev_b32 v183, 16, v83
    v_mul_f32 v184, v160, v175
    v_mul_f32 v185, v161, v175
    v_mul_f32 v186, v162, v175
    v_mul_f32 v187, v163, v175
    v_mul_f32 v188, v164, v175
    v_mul_f32 v189, v165, v175
    v_mul_f32 v190, v166, v175
    v_mul_f32 v191, v167, v175
    v_fmac_f32 v184, v161, v174
    v_fmac_f32 v185, v162, v174
    v_fmac_f32 v186, v163, v174
    v_fmac_f32 v187, v164, v174
    v_fmac_f32 v188, v165, v174
    v_fmac_f32 v189, v166, v174
    v_fmac_f32 v190, v167, v174
    v_fmac_f32 v191, v168, v174
    v_fmac_f32 v184, v162, v173
    v_fmac_f32 v185, v163, v173
    v_fmac_f32 v186, v164, v173
    v_fmac_f32 v187, v165, v173
    v_fmac_f32 v188, v166, v173
    v_fmac_f32 v189, v167, v173
    v_fmac_f32 v190, v168, v173
    s_waitcnt vmcnt(13)
    s_barrier
    s_mul_i32 s16, s97, 3072
    s_add_u32 m0, s60, 0
    s_add_u32 s99, s16, s62
    buffer_load_dwordx4 v244, s[32:35], s99 offen offset:0  lds
    v_fmac_f32 v191, v169, v173
    v_fmac_f32 v184, v163, v172
    v_fmac_f32 v185, v164, v172
    v_fmac_f32 v186, v165, v172
    v_fmac_f32 v187, v166, v172
    buffer_load_dwordx4 v245, s[32:35], s99 offen offset:1024  lds
    v_fmac_f32 v188, v167, v172
    v_fmac_f32 v189, v168, v172
    v_fmac_f32 v190, v169, v172
    v_fmac_f32 v191, v170, v172
    v_mul_f32 v184, v184, v176
    buffer_load_dwordx4 v246, s[32:35], s99 offen offset:2048  lds
    v_mul_f32 v185, v185, v177
    v_mul_f32 v186, v186, v178
    v_mul_f32 v187, v187, v179
    v_mul_f32 v188, v188, v180
    v_mul_f32 v189, v189, v181
    s_add_u32 m0, s61, 12288
    s_add_u32 s16, s16, s63
    buffer_load_dwordx4 v244, s[32:35], s16 offen offset:0  lds
    v_mul_f32 v190, v190, v182
    v_mul_f32 v191, v191, v183
    v_cvt_pk_bf16_f32 v108, v191, v190
    v_cvt_pk_bf16_f32 v109, v189, v188
    v_cvt_pk_bf16_f32 v110, v187, v186
    buffer_load_dwordx4 v245, s[32:35], s16 offen offset:1024  lds
    v_cvt_pk_bf16_f32 v111, v185, v184
    s_mov_b32 s89, 32768
    buffer_store_dwordx4 v[108:111], v12, s[52:55], s89 offen sc1
    v_and_b32 v160, 0xffff0000, v41
    v_and_b32 v161, 0xffff0000, v43
    v_and_b32 v162, 0xffff0000, v45
    buffer_load_dwordx4 v246, s[32:35], s16 offen offset:2048  lds
    v_and_b32 v163, 0xffff0000, v47
    v_and_b32 v164, 0xffff0000, v49
    v_and_b32 v165, 0xffff0000, v51
    v_and_b32 v166, 0xffff0000, v53
    v_and_b32 v167, 0xffff0000, v55
    s_add_u32 s97, s98, s0
    s_lshr_b64 s[0:1], s[0:1], 4
    s_and_b32 s97, s97, 15
    s_add_u32 m0, s87, 18432
    s_lshl_b32 s97, s97, 7
    buffer_load_dwordx4 v240, s[28:31], s97 offen offset:0  lds
    v_and_b32 v168, 0xffff0000, v57
    v_and_b32 v169, 0xffff0000, v59
    v_and_b32 v170, 0xffff0000, v61
    v_lshlrev_b32 v172, 16, v90
    v_and_b32 v173, 0xffff0000, v90
    buffer_load_dwordx4 v241, s[28:31], s97 offen offset:1024  lds
    v_lshlrev_b32 v174, 16, v91
    v_and_b32 v175, 0xffff0000, v91
    v_and_b32 v176, 0xffff0000, v69
    v_and_b32 v177, 0xffff0000, v71
    v_and_b32 v178, 0xffff0000, v73
    buffer_load_dwordx4 v242, s[28:31], s97 offen offset:2048  lds
    v_and_b32 v179, 0xffff0000, v75
    v_and_b32 v180, 0xffff0000, v77
    v_and_b32 v181, 0xffff0000, v79
    v_and_b32 v182, 0xffff0000, v81
    v_and_b32 v183, 0xffff0000, v83
    buffer_load_dwordx4 v243, s[28:31], s97 offen offset:3072  lds
    v_mul_f32 v184, v160, v175
    v_mul_f32 v185, v161, v175
    v_mul_f32 v186, v162, v175
    v_mul_f32 v187, v163, v175
    v_mul_f32 v188, v164, v175
    s_add_u32 m0, s88, 18432
    s_mov_b64 exec, 0xffffffff
    buffer_load_dwordx4 v3, s[28:31], s97 offen offset:0  lds
    s_mov_b64 exec, -1
    v_mul_f32 v189, v165, v175
    v_mul_f32 v190, v166, v175
    v_mul_f32 v191, v167, v175
    v_fmac_f32 v184, v161, v174
    v_fmac_f32 v185, v162, v174
    v_fmac_f32 v186, v163, v174
    v_fmac_f32 v187, v164, v174
    v_fmac_f32 v188, v165, v174
    v_fmac_f32 v189, v166, v174
    v_fmac_f32 v190, v167, v174
    v_fmac_f32 v191, v168, v174
    v_fmac_f32 v184, v162, v173
    v_fmac_f32 v185, v163, v173
    v_fmac_f32 v186, v164, v173
    v_fmac_f32 v187, v165, v173
    v_fmac_f32 v188, v166, v173
    v_fmac_f32 v189, v167, v173
    v_fmac_f32 v190, v168, v173
    v_fmac_f32 v191, v169, v173
    v_fmac_f32 v184, v163, v172
    v_fmac_f32 v185, v164, v172
    v_fmac_f32 v186, v165, v172
    v_fmac_f32 v187, v166, v172
    v_fmac_f32 v188, v167, v172
    v_fmac_f32 v189, v168, v172
    v_fmac_f32 v190, v169, v172
    v_fmac_f32 v191, v170, v172
    v_mul_f32 v184, v184, v176
    v_mul_f32 v185, v185, v177
    v_mul_f32 v186, v186, v178
    v_mul_f32 v187, v187, v179
    v_mul_f32 v188, v188, v180
    v_mul_f32 v189, v189, v181
    v_mul_f32 v190, v190, v182
    v_mul_f32 v191, v191, v183
    v_cvt_pk_bf16_f32 v112, v191, v190
    v_cvt_pk_bf16_f32 v113, v189, v188
    v_cvt_pk_bf16_f32 v114, v187, v186
    v_cvt_pk_bf16_f32 v115, v185, v184
    s_mov_b32 s89, 49152
    buffer_store_dwordx4 v[112:115], v12, s[52:55], s89 offen sc1
    s_waitcnt vmcnt(13)
    s_barrier
    s_mul_i32 s16, s97, 3072
    s_add_u32 m0, s60, 24576
    s_add_u32 s99, s16, s62
    buffer_load_dwordx4 v244, s[32:35], s99 offen offset:0  lds
    buffer_load_dwordx4 v245, s[32:35], s99 offen offset:1024  lds
    buffer_load_dwordx4 v246, s[32:35], s99 offen offset:2048  lds
    s_add_u32 m0, s61, 36864
    s_add_u32 s16, s16, s63
    buffer_load_dwordx4 v244, s[32:35], s16 offen offset:0  lds
    buffer_load_dwordx4 v245, s[32:35], s16 offen offset:1024  lds
    buffer_load_dwordx4 v246, s[32:35], s16 offen offset:2048  lds
    s_add_u32 s97, s98, s0
    s_lshr_b64 s[0:1], s[0:1], 4
    s_and_b32 s97, s97, 15
    s_add_u32 m0, s87, 36864
    s_lshl_b32 s97, s97, 7
    buffer_load_dwordx4 v240, s[28:31], s97 offen offset:0  lds
    buffer_load_dwordx4 v241, s[28:31], s97 offen offset:1024  lds
    buffer_load_dwordx4 v242, s[28:31], s97 offen offset:2048  lds
    buffer_load_dwordx4 v243, s[28:31], s97 offen offset:3072  lds
    s_add_u32 m0, s88, 36864
    s_mov_b64 exec, 0xffffffff
    buffer_load_dwordx4 v3, s[28:31], s97 offen offset:0  lds
    s_mov_b64 exec, -1
    s_waitcnt vmcnt(12)
    s_waitcnt vmcnt(11)
    s_barrier
    s_mul_i32 s16, s97, 3072
    s_add_u32 m0, s60, 49152
    s_add_u32 s99, s16, s62
    buffer_load_dwordx4 v244, s[32:35], s99 offen offset:0  lds
    s_mov_b32 s68, s24
    s_mov_b32 s69, s25
    s_mov_b32 s70, 0x100
    s_mov_b32 s71, 0x20000
    buffer_load_dwordx4 v245, s[32:35], s99 offen offset:1024  lds
    v_lshrrev_b32 v6, 5, v0
    v_and_b32 v7, 3, v0
    s_lshr_b32 s78, s90, 1
    buffer_load_dwordx4 v246, s[32:35], s99 offen offset:2048  lds
    s_lshl_b32 s78, s78, 2
    s_load_dword s92, s[14:15], s78
    v_bfe_u32 v5, v0, 2, 2
    v_lshlrev_b32 v5, 1, v5
    s_add_u32 m0, s61, 61440
    s_add_u32 s16, s16, s63
    buffer_load_dwordx4 v244, s[32:35], s16 offen offset:0  lds
    v_lshl_add_u32 v5, v6, 3, v5
    v_bfe_u32 v8, v0, 4, 1
    v_add_u32 v5, v5, v8
    buffer_load_dwordx4 v245, s[32:35], s16 offen offset:1024  lds
    s_and_b32 s78, s3, 1
    s_lshl_b32 s78, s78, 1
    v_add_u32 v8, s78, v6
    v_xor_b32 v8, v8, v7
    buffer_load_dwordx4 v246, s[32:35], s16 offen offset:2048  lds
    v_lshlrev_b32 v8, 4, v8
    v_lshl_add_u32 v5, v5, 6, v8
    v_add_u32 v14, s86, v5
    s_add_u32 m0, s94, 32
    s_lshl_b32 s89, s90, 12
    buffer_load_dwordx4 v15, s[48:51], s89 offen offset:0 nt lds
    v_mov_b32 v18, 162304
    v_mov_b32 v19, 1
    v_and_b32 v5, 3, v0
    s_lshl_b32 s78, s74, 4
    s_add_u32 m0, s94, 32
    s_lshl_b32 s89, s90, 12
    buffer_load_dwordx4 v15, s[48:51], s89 offen offset:1024 nt lds
    s_add_u32 s78, s78, s3
    v_lshl_add_u32 v6, v5, 2, s78
    s_lshr_b32 s78, s76, 3
    s_add_u32 m0, s94, 32
    s_lshl_b32 s89, s90, 12
    buffer_load_dwordx4 v15, s[48:51], s89 offen offset:2048 nt lds
    s_lshl_b32 s79, s3, 1
    s_add_u32 s78, s78, s79
    s_xor_b32 s78, s78, 2
    s_lshl_b32 s78, s78, 5
    s_add_u32 m0, s94, 32
    s_lshl_b32 s89, s90, 12
    buffer_load_dwordx4 v15, s[48:51], s89 offen offset:3072 nt lds
    s_add_u32 s79, s76, 5
    s_and_b32 s79, s79, 7
    s_lshl_b32 s79, s79, 1
    s_add_u32 s97, s98, s0
    s_lshr_b64 s[0:1], s[0:1], 4
    s_and_b32 s97, s97, 15
    s_add_u32 m0, s87, 0
    s_lshl_b32 s97, s97, 7
    buffer_load_dwordx4 v240, s[28:31], s97 offen offset:0  lds
    s_add_u32 s78, s78, s79
    v_mul_u32_u24 v7, 9, v5
    v_and_b32 v7, 17, v7
    v_add_u32 v7, s78, v7
    buffer_load_dwordx4 v241, s[28:31], s97 offen offset:1024  lds
    v_and_b32 v8, 4, v0
    v_cmp_eq_u32 vcc, 0, v8
    s_nop 1
    v_cndmask_b32 v6, v7, v6, vcc
    buffer_load_dwordx4 v242, s[28:31], s97 offen offset:2048  lds
    v_and_b32 v33, 0xf0, v6
    v_lshlrev_b32 v34, 8, v6
    v_add_u32 v34, 12582912, v34
    v_and_b32 v5, 15, v0
    buffer_load_dwordx4 v243, s[28:31], s97 offen offset:3072  lds
    v_lshrrev_b32 v6, 4, v0
    v_add_u32 v7, 9, v5
    v_and_b32 v8, 1, v7
    s_add_u32 m0, s88, 0
    s_mov_b64 exec, 0xffffffff
    buffer_load_dwordx4 v3, s[28:31], s97 offen offset:0  lds
    s_mov_b64 exec, -1
    v_mul_u32_u24 v8, 4160, v8
    v_lshrrev_b32 v7, 1, v7
    v_lshl_add_u32 v8, v7, 2, v8
    s_waitcnt vmcnt(15)
    s_barrier
    s_mul_i32 s16, s97, 3072
    s_add_u32 m0, s60, 0
    s_add_u32 s99, s16, s62
    buffer_load_dwordx4 v244, s[32:35], s99 offen offset:0  lds
    v_lshlrev_b32 v7, 4, v6
    v_sub_u32 v8, v8, v7
    s_add_u32 s78, s94, 32
    v_add_u32 v21, s78, v8
    v_add_u32 v22, 1024, v21
    buffer_load_dwordx4 v245, s[32:35], s99 offen offset:1024  lds
    v_add_u32 v23, 2048, v21
    v_add_u32 v24, 3072, v21
    v_lshl_add_u32 v7, v5, 1, v6
    v_add_u32 v7, 30, v7
    v_and_b32 v8, 1, v7
    buffer_load_dwordx4 v246, s[32:35], s99 offen offset:2048  lds
    v_bfe_u32 v136, v7, 1, 2
    v_lshl_add_u32 v136, v8, 2, v136
    v_lshlrev_b32 v136, 6, v136
    v_lshrrev_b32 v7, 3, v7
    v_lshl_add_u32 v136, v7, 9, v136
    s_add_u32 m0, s61, 12288
    s_add_u32 s16, s16, s63
    buffer_load_dwordx4 v244, s[32:35], s16 offen offset:0  lds
    v_bitop3_b32 v8, v7, 3, s3 bitop3:0x6a
    v_lshl_add_u32 v25, v8, 4, v136
    v_add_u32 v25, 92160, v25
    v_subrev_u32 v7, 1, v7
    buffer_load_dwordx4 v245, s[32:35], s16 offen offset:1024  lds
    v_bitop3_b32 v8, v7, 3, s3 bitop3:0x6a
    v_lshl_add_u32 v27, v8, 4, v136
    v_add_u32 v27, 91648, v27
    v_subrev_u32 v7, 1, v7
    v_bitop3_b32 v8, v7, 3, s3 bitop3:0x6a
    buffer_load_dwordx4 v246, s[32:35], s16 offen offset:2048  lds
    v_lshl_add_u32 v29, v8, 4, v136
    v_add_u32 v29, 91136, v29
    v_subrev_u32 v7, 1, v7
    v_bitop3_b32 v8, v7, 3, s3 bitop3:0x6a
    v_lshl_add_u32 v31, v8, 4, v136
    s_add_u32 s97, s98, s0
    s_lshr_b64 s[0:1], s[0:1], 4
    s_and_b32 s97, s97, 15
    s_add_u32 m0, s87, 18432
    s_lshl_b32 s97, s97, 7
    buffer_load_dwordx4 v240, s[28:31], s97 offen offset:0  lds
    v_add_u32 v31, 90624, v31
    v_lshl_add_u32 v7, v5, 1, v6
    v_add_u32 v7, 26, v7
    v_and_b32 v8, 1, v7
    v_bfe_u32 v136, v7, 1, 2
    buffer_load_dwordx4 v241, s[28:31], s97 offen offset:1024  lds
    v_lshl_add_u32 v136, v8, 2, v136
    v_lshlrev_b32 v136, 6, v136
    v_lshrrev_b32 v7, 3, v7
    v_lshl_add_u32 v136, v7, 9, v136
    buffer_load_dwordx4 v242, s[28:31], s97 offen offset:2048  lds
    v_bitop3_b32 v8, v7, 3, s3 bitop3:0x6a
    v_lshl_add_u32 v26, v8, 4, v136
    v_add_u32 v26, 92160, v26
    v_subrev_u32 v7, 1, v7
    v_bitop3_b32 v8, v7, 3, s3 bitop3:0x6a
    buffer_load_dwordx4 v243, s[28:31], s97 offen offset:3072  lds
    v_lshl_add_u32 v28, v8, 4, v136
    v_add_u32 v28, 91648, v28
    v_subrev_u32 v7, 1, v7
    v_bitop3_b32 v8, v7, 3, s3 bitop3:0x6a
    v_lshl_add_u32 v30, v8, 4, v136
    s_add_u32 m0, s88, 18432
    s_mov_b64 exec, 0xffffffff
    buffer_load_dwordx4 v3, s[28:31], s97 offen offset:0  lds
    s_mov_b64 exec, -1
    v_add_u32 v30, 91136, v30
    v_subrev_u32 v7, 1, v7
    v_bitop3_b32 v8, v7, 3, s3 bitop3:0x6a
    v_lshl_add_u32 v32, v8, 4, v136
    s_waitcnt vmcnt(11)
    s_barrier
    s_mul_i32 s16, s97, 3072
    s_add_u32 m0, s60, 24576
    s_add_u32 s99, s16, s62
    buffer_load_dwordx4 v244, s[32:35], s99 offen offset:0  lds
    v_add_u32 v32, 90624, v32
    v_lshrrev_b32 v7, 1, v6
    v_lshl_add_u32 v7, v5, 1, v7
    v_add_u32 v7, 32, v7
    v_and_b32 v8, 1, v7
    buffer_load_dwordx4 v245, s[32:35], s99 offen offset:1024  lds
    v_bfe_u32 v136, v7, 1, 2
    v_lshl_add_u32 v136, v8, 2, v136
    v_lshlrev_b32 v136, 6, v136
    v_lshrrev_b32 v7, 3, v7
    buffer_load_dwordx4 v246, s[32:35], s99 offen offset:2048  lds
    v_lshl_add_u32 v136, v7, 9, v136
    v_bitop3_b32 v8, v7, 3, s3 bitop3:0x6a
    v_lshl_add_u32 v20, v8, 4, v136
    v_add_u32 v20, 92160, v20
    v_and_b32 v8, 1, v6
    s_add_u32 m0, s61, 36864
    s_add_u32 s16, s16, s63
    buffer_load_dwordx4 v244, s[32:35], s16 offen offset:0  lds
    v_xor_b32 v8, 1, v8
    v_lshl_add_u32 v20, v8, 3, v20
    s_waitcnt lgkmcnt(0)
    s_and_b32 s78, s92, 0xffff0000
    buffer_load_dwordx4 v245, s[32:35], s16 offen offset:1024  lds
    s_lshl_b32 s92, s92, 16
    s_bitcmp1_b32 s90, 0
    s_cselect_b32 s92, s78, s92
    v_lshlrev_b32 v7, 3, v6
    v_sub_u32 v7, v7, v5
    buffer_load_dwordx4 v246, s[32:35], s16 offen offset:2048  lds
    v_subrev_u32 v7, 9, v7
    v_and_b32 v8, 1, v7
    v_xor_b32 v8, 1, v8
    v_lshlrev_b32 v8, 4, v8
    v_lshrrev_b32 v8, v8, s92
    s_add_u32 s97, s98, s0
    s_lshr_b64 s[0:1], s[0:1], 4
    s_and_b32 s97, s97, 15
    s_add_u32 m0, s87, 36864
    s_lshl_b32 s97, s97, 7
    buffer_load_dwordx4 v240, s[28:31], s97 offen offset:0  lds
    v_ashrrev_i32 v7, 1, v7
    v_cmp_eq_u32 vcc, 0, v7
    s_nop 1
    v_cndmask_b32 v236, 0, v8, vcc
    v_cmp_eq_u32 vcc, 1, v7
    buffer_load_dwordx4 v241, s[28:31], s97 offen offset:1024  lds
    s_nop 0
    v_cndmask_b32 v237, 0, v8, vcc
    v_cmp_eq_u32 vcc, 2, v7
    s_nop 1
    v_cndmask_b32 v238, 0, v8, vcc
    v_cmp_eq_u32 vcc, 3, v7
    buffer_load_dwordx4 v242, s[28:31], s97 offen offset:2048  lds
    s_nop 0
    v_cndmask_b32 v239, 0, v8, vcc
    s_and_b32 s78, s77, 7
    s_mov_b32 s95, 0x76543210
    s_and_b32 s78, s76, 3
    s_mul_i32 s78, s78, 0x22222222
    s_add_u32 s95, s95, s78
    s_bfe_u32 s100, s95, 0x3001c
    s_lshl_b32 s100, s100, 18
    s_bfe_u32 s95, s95, 0x30018
    s_lshl_b32 s95, s95, 18
    v_lshrrev_b32 v136, 4, v0
    v_lshlrev_b32 v136, 1, v136
    v_and_b32 v137, 7, v0
    buffer_load_dwordx4 v243, s[28:31], s97 offen offset:3072  lds
    v_xor_b32 v136, v136, v137
    v_lshlrev_b32 v136, 4, v136
    v_lshrrev_b32 v137, 3, v0
    v_lshl_add_u32 v136, v137, 11, v136
    s_add_u32 m0, s88, 36864
    s_mov_b64 exec, 0xffffffff
    buffer_load_dwordx4 v3, s[28:31], s97 offen offset:0  lds
    s_mov_b64 exec, -1
    s_lshl_b32 s78, s77, 7
    s_lshl_b32 s79, s3, 14
    s_add_u32 s78, s78, s79
    v_add_u32 v17, s78, v136
    s_waitcnt vmcnt(11)
    s_barrier
    s_mul_i32 s16, s97, 3072
    s_add_u32 m0, s60, 49152
    s_add_u32 s99, s16, s62
    buffer_load_dwordx4 v244, s[32:35], s99 offen offset:0  lds
    v_add_u32 v5, s94, v15
    ds_read_b128 v[140:143], v5 offset:32
    ds_read_b32 v156, v5 offset:48
    ds_read_b128 v[144:147], v5 offset:1056
    buffer_load_dwordx4 v245, s[32:35], s99 offen offset:1024  lds
    ds_read_b32 v157, v5 offset:1072
    ds_read_b128 v[148:151], v5 offset:2080
    ds_read_b32 v158, v5 offset:2096
    ds_read_b128 v[152:155], v5 offset:3104
    buffer_load_dwordx4 v246, s[32:35], s99 offen offset:2048  lds
    ds_read_b32 v159, v5 offset:3120
    v_lshrrev_b32 v6, 3, v0
    v_mul_u32_u24 v6, 4160, v6
    s_add_u32 m0, s61, 61440
    s_add_u32 s16, s16, s63
    buffer_load_dwordx4 v244, s[32:35], s16 offen offset:0  lds
    v_and_b32 v7, 7, v0
    v_lshl_add_u32 v6, v7, 2, v6
    v_add_u32 v6, s94, v6
    v_mov_b32 v7, 0
    buffer_load_dwordx4 v245, s[32:35], s16 offen offset:1024  lds
    s_waitcnt lgkmcnt(0)
    v_readfirstlane_b32 s93, v140
    s_nop 0
    s_lshl_b32 s93, s93, 16
    s_nop 1
    v_writelane_b32 v7, s93, 15
    buffer_load_dwordx4 v246, s[32:35], s16 offen offset:2048  lds
    v_alignbit_b32 v140, v141, v140, 16
    v_alignbit_b32 v141, v142, v141, 16
    v_alignbit_b32 v142, v143, v142, 16
    s_add_u32 s97, s98, s0
    s_lshr_b64 s[0:1], s[0:1], 4
    s_and_b32 s97, s97, 15
    s_add_u32 m0, s87, 0
    s_lshl_b32 s97, s97, 7
    buffer_load_dwordx4 v240, s[28:31], s97 offen offset:0  lds
    v_alignbit_b32 v143, v156, v143, 16
    v_alignbit_b32 v144, v145, v144, 16
    v_alignbit_b32 v145, v146, v145, 16
    v_alignbit_b32 v146, v147, v146, 16
    buffer_load_dwordx4 v241, s[28:31], s97 offen offset:1024  lds
    v_alignbit_b32 v147, v157, v147, 16
    v_alignbit_b32 v148, v149, v148, 16
    v_alignbit_b32 v149, v150, v149, 16
    v_alignbit_b32 v150, v151, v150, 16
    buffer_load_dwordx4 v242, s[28:31], s97 offen offset:2048  lds
    v_alignbit_b32 v151, v158, v151, 16
    v_alignbit_b32 v152, v153, v152, 16
    v_alignbit_b32 v153, v154, v153, 16
    buffer_load_dwordx4 v243, s[28:31], s97 offen offset:3072  lds
    v_alignbit_b32 v154, v155, v154, 16
    v_alignbit_b32 v155, v159, v155, 16
    v_lshlrev_b32 v8, 3, v0
    s_add_u32 s78, s88, 18432
    s_add_u32 m0, s88, 0
    s_mov_b64 exec, 0xffffffff
    buffer_load_dwordx4 v3, s[28:31], s97 offen offset:0  lds
    s_mov_b64 exec, -1
    v_add_u32 v8, s78, v8
    v_mov_b32 v156, 0
    v_mov_b32 v157, 0
    s_waitcnt vmcnt(11)
    s_barrier
    s_mul_i32 s16, s97, 3072
    s_add_u32 m0, s60, 0
    s_add_u32 s99, s16, s62
    buffer_load_dwordx4 v244, s[32:35], s99 offen offset:0  lds
    buffer_load_dwordx4 v245, s[32:35], s99 offen offset:1024  lds
    buffer_load_dwordx4 v246, s[32:35], s99 offen offset:2048  lds
    s_add_u32 m0, s61, 12288
    s_add_u32 s16, s16, s63
    buffer_load_dwordx4 v244, s[32:35], s16 offen offset:0  lds
    buffer_load_dwordx4 v245, s[32:35], s16 offen offset:1024  lds
    buffer_load_dwordx4 v246, s[32:35], s16 offen offset:2048  lds
    s_mov_b64 exec, 0xff
    buffer_load_dword v136, v33, s[68:71], 0 offen sc1
    buffer_load_dword v137, v34, s[52:55], 0 offen sc1
    s_mov_b64 exec, -1
    buffer_load_dwordx4 v[212:215], v9, s[56:59], 0 offen offset:0 nt
    buffer_load_dwordx4 v[216:219], v9, s[56:59], 0 offen offset:2048 nt
    buffer_load_dwordx4 v[220:223], v9, s[56:59], s96 offen offset:0 nt
    buffer_load_dwordx4 v[224:227], v9, s[56:59], s96 offen offset:2048 nt
    s_waitcnt vmcnt(12)
    s_waitcnt vmcnt(6)
    s_barrier
    s_waitcnt vmcnt(4)
    s_branch LA_j
LA_c3:
    s_waitcnt vmcnt(8)
    s_barrier
    buffer_load_dwordx4 v242, s[28:31], s97 offen offset:2048  lds
    buffer_load_dwordx4 v243, s[28:31], s97 offen offset:3072  lds
    s_add_u32 m0, s88, 36864
    s_mov_b64 exec, 0xffffffff
    buffer_load_dwordx4 v3, s[28:31], s97 offen offset:0  lds
    s_mov_b64 exec, -1
    s_mul_i32 s16, s97, 3072
    s_add_u32 m0, s60, 49152
    s_add_u32 s99, s16, s62
    buffer_load_dwordx4 v244, s[32:35], s99 offen offset:0  lds
    buffer_load_dwordx4 v245, s[32:35], s99 offen offset:1024  lds
    buffer_load_dwordx4 v246, s[32:35], s99 offen offset:2048  lds
    s_add_u32 m0, s61, 61440
    s_add_u32 s16, s16, s63
    buffer_load_dwordx4 v244, s[32:35], s16 offen offset:0  lds
    buffer_load_dwordx4 v245, s[32:35], s16 offen offset:1024  lds
    buffer_load_dwordx4 v246, s[32:35], s16 offen offset:2048  lds
    s_add_u32 s97, s98, s0
    s_lshr_b64 s[0:1], s[0:1], 4
    s_and_b32 s97, s97, 15
    s_add_u32 m0, s87, 0
    s_lshl_b32 s97, s97, 7
    buffer_load_dwordx4 v240, s[28:31], s97 offen offset:0  lds
    buffer_load_dwordx4 v241, s[28:31], s97 offen offset:1024  lds
    buffer_load_dwordx4 v242, s[28:31], s97 offen offset:2048  lds
    buffer_load_dwordx4 v243, s[28:31], s97 offen offset:3072  lds
    s_add_u32 m0, s88, 0
    s_mov_b64 exec, 0xffffffff
    buffer_load_dwordx4 v3, s[28:31], s97 offen offset:0  lds
    s_mov_b64 exec, -1
    s_waitcnt vmcnt(11)
    s_barrier
    s_mul_i32 s16, s97, 3072
    s_add_u32 m0, s60, 0
    s_add_u32 s99, s16, s62
    buffer_load_dwordx4 v244, s[32:35], s99 offen offset:0  lds
    buffer_load_dwordx4 v245, s[32:35], s99 offen offset:1024  lds
    buffer_load_dwordx4 v246, s[32:35], s99 offen offset:2048  lds
    s_add_u32 m0, s61, 12288
    s_add_u32 s16, s16, s63
    buffer_load_dwordx4 v244, s[32:35], s16 offen offset:0  lds
    buffer_load_dwordx4 v245, s[32:35], s16 offen offset:1024  lds
    buffer_load_dwordx4 v246, s[32:35], s16 offen offset:2048  lds
    s_add_u32 s97, s98, s0
    s_lshr_b64 s[0:1], s[0:1], 4
    s_and_b32 s97, s97, 15
    s_add_u32 m0, s87, 18432
    s_lshl_b32 s97, s97, 7
    buffer_load_dwordx4 v240, s[28:31], s97 offen offset:0  lds
    buffer_load_dwordx4 v241, s[28:31], s97 offen offset:1024  lds
    buffer_load_dwordx4 v242, s[28:31], s97 offen offset:2048  lds
    buffer_load_dwordx4 v243, s[28:31], s97 offen offset:3072  lds
    s_add_u32 m0, s88, 18432
    s_mov_b64 exec, 0xffffffff
    buffer_load_dwordx4 v3, s[28:31], s97 offen offset:0  lds
    s_mov_b64 exec, -1
    s_waitcnt vmcnt(11)
    s_barrier
    s_mul_i32 s16, s97, 3072
    s_add_u32 m0, s60, 24576
    s_add_u32 s99, s16, s62
    buffer_load_dwordx4 v244, s[32:35], s99 offen offset:0  lds
    buffer_load_dwordx4 v245, s[32:35], s99 offen offset:1024  lds
    buffer_load_dwordx4 v246, s[32:35], s99 offen offset:2048  lds
    s_add_u32 m0, s61, 36864
    s_add_u32 s16, s16, s63
    buffer_load_dwordx4 v244, s[32:35], s16 offen offset:0  lds
    buffer_load_dwordx4 v245, s[32:35], s16 offen offset:1024  lds
    buffer_load_dwordx4 v246, s[32:35], s16 offen offset:2048  lds
    s_add_u32 m0, s86, 129536
    s_mov_b32 s89, 0
    buffer_load_dwordx4 v10, s[36:39], s89 offen nt lds
    s_add_u32 m0, s86, 145920
    s_mov_b32 s89, 0
    buffer_load_dwordx4 v10, s[40:43], s89 offen nt lds
    s_add_u32 m0, s86, 133632
    s_mov_b32 s89, 65536
    buffer_load_dwordx4 v10, s[36:39], s89 offen nt lds
    s_add_u32 m0, s86, 150016
    s_mov_b32 s89, 65536
    buffer_load_dwordx4 v10, s[40:43], s89 offen nt lds
    s_add_u32 m0, s86, 137728
    s_mov_b32 s89, 131072
    buffer_load_dwordx4 v10, s[36:39], s89 offen nt lds
    s_add_u32 m0, s86, 154112
    s_mov_b32 s89, 131072
    buffer_load_dwordx4 v10, s[40:43], s89 offen nt lds
    s_add_u32 m0, s86, 141824
    s_mov_b32 s89, 196608
    buffer_load_dwordx4 v10, s[36:39], s89 offen nt lds
    s_add_u32 m0, s86, 158208
    s_mov_b32 s89, 196608
    buffer_load_dwordx4 v10, s[40:43], s89 offen nt lds
    s_mov_b64 exec, 0xff
    s_lshl_b32 s82, s3, 7
    s_add_u32 m0, s82, 129024
    s_mov_b32 s89, 0
    buffer_load_dwordx4 v11, s[36:39], s89 offen nt lds
    s_lshl_b32 s83, s74, 9
    s_add_u32 s83, s83, s82
    s_and_b32 s89, s3, 2
    s_lshl_b32 s89, s89, 3
    s_add_u32 s82, s82, s89
    s_add_u32 m0, s82, 162816
    s_add_u32 s89, s83, 0
    buffer_load_dwordx4 v15, s[44:47], s89 offen  lds
    s_mov_b64 exec, -1
    s_add_u32 s97, s98, s0
    s_lshr_b64 s[0:1], s[0:1], 4
    s_and_b32 s97, s97, 15
    s_add_u32 m0, s87, 36864
    s_lshl_b32 s97, s97, 7
    buffer_load_dwordx4 v240, s[28:31], s97 offen offset:0  lds
    s_waitcnt vmcnt(17)
    s_barrier
    buffer_load_dwordx4 v241, s[28:31], s97 offen offset:1024  lds
    buffer_load_dwordx4 v242, s[28:31], s97 offen offset:2048  lds
    buffer_load_dwordx4 v243, s[28:31], s97 offen offset:3072  lds
    s_add_u32 m0, s88, 36864
    s_mov_b64 exec, 0xffffffff
    buffer_load_dwordx4 v3, s[28:31], s97 offen offset:0  lds
    s_mov_b64 exec, -1
    s_mul_i32 s16, s97, 3072
    s_add_u32 m0, s60, 49152
    s_add_u32 s99, s16, s62
    buffer_load_dwordx4 v244, s[32:35], s99 offen offset:0  lds
    buffer_load_dwordx4 v245, s[32:35], s99 offen offset:1024  lds
    buffer_load_dwordx4 v246, s[32:35], s99 offen offset:2048  lds
    s_add_u32 m0, s61, 61440
    s_add_u32 s16, s16, s63
    buffer_load_dwordx4 v244, s[32:35], s16 offen offset:0  lds
    buffer_load_dwordx4 v245, s[32:35], s16 offen offset:1024  lds
    buffer_load_dwordx4 v246, s[32:35], s16 offen offset:2048  lds
    s_add_u32 s97, s98, s0
    s_lshr_b64 s[0:1], s[0:1], 4
    s_and_b32 s97, s97, 15
    s_add_u32 m0, s87, 0
    s_lshl_b32 s97, s97, 7
    buffer_load_dwordx4 v240, s[28:31], s97 offen offset:0  lds
    buffer_load_dwordx4 v241, s[28:31], s97 offen offset:1024  lds
    buffer_load_dwordx4 v242, s[28:31], s97 offen offset:2048  lds
    buffer_load_dwordx4 v243, s[28:31], s97 offen offset:3072  lds
    s_add_u32 m0, s88, 0
    s_mov_b64 exec, 0xffffffff
    buffer_load_dwordx4 v3, s[28:31], s97 offen offset:0  lds
    s_mov_b64 exec, -1
    s_waitcnt vmcnt(11)
    s_barrier
    s_mul_i32 s16, s97, 3072
    s_add_u32 m0, s60, 0
    s_add_u32 s99, s16, s62
    buffer_load_dwordx4 v244, s[32:35], s99 offen offset:0  lds
    ds_read_b128 v[84:87], v35 offset:0
    ds_read_b128 v[88:91], v35 offset:16
    buffer_load_dwordx4 v245, s[32:35], s99 offen offset:1024  lds
    ds_read_b64 v[40:41], v16 offset:0
    ds_read_b64 v[42:43], v231 offset:256
    buffer_load_dwordx4 v246, s[32:35], s99 offen offset:2048  lds
    ds_read_b64 v[44:45], v16 offset:256
    ds_read_b64 v[46:47], v16 offset:512
    s_add_u32 m0, s61, 12288
    s_add_u32 s16, s16, s63
    buffer_load_dwordx4 v244, s[32:35], s16 offen offset:0  lds
    ds_read_b64 v[48:49], v231 offset:512
    ds_read_b64 v[50:51], v16 offset:768
    buffer_load_dwordx4 v245, s[32:35], s16 offen offset:1024  lds
    ds_read_b64 v[52:53], v231 offset:768
    ds_read_b64 v[54:55], v16 offset:1024
    buffer_load_dwordx4 v246, s[32:35], s16 offen offset:2048  lds
    ds_read_b64 v[56:57], v231 offset:1024
    ds_read_b64 v[58:59], v16 offset:1280
    s_add_u32 s97, s98, s0
    s_lshr_b64 s[0:1], s[0:1], 4
    s_and_b32 s97, s97, 15
    s_add_u32 m0, s87, 18432
    s_lshl_b32 s97, s97, 7
    buffer_load_dwordx4 v240, s[28:31], s97 offen offset:0  lds
    ds_read_b64 v[60:61], v231 offset:1280
    ds_read_b64 v[68:69], v16 offset:16896
    buffer_load_dwordx4 v241, s[28:31], s97 offen offset:1024  lds
    ds_read_b64 v[70:71], v231 offset:16896
    ds_read_b64 v[72:73], v16 offset:17152
    buffer_load_dwordx4 v242, s[28:31], s97 offen offset:2048  lds
    ds_read_b64 v[74:75], v231 offset:17152
    ds_read_b64 v[76:77], v16 offset:17408
    buffer_load_dwordx4 v243, s[28:31], s97 offen offset:3072  lds
    ds_read_b64 v[78:79], v231 offset:17408
    ds_read_b64 v[80:81], v16 offset:17664
    s_add_u32 m0, s88, 18432
    s_mov_b64 exec, 0xffffffff
    buffer_load_dwordx4 v3, s[28:31], s97 offen offset:0  lds
    s_mov_b64 exec, -1
    ds_read_b64 v[82:83], v231 offset:17664
    s_waitcnt vmcnt(11)
    s_waitcnt lgkmcnt(0)
    s_barrier
    s_mul_i32 s16, s97, 3072
    s_add_u32 m0, s60, 24576
    s_add_u32 s99, s16, s62
    buffer_load_dwordx4 v244, s[32:35], s99 offen offset:0  lds
    v_lshlrev_b32 v160, 16, v40
    v_lshlrev_b32 v161, 16, v42
    v_lshlrev_b32 v162, 16, v44
    v_lshlrev_b32 v163, 16, v46
    v_lshlrev_b32 v164, 16, v48
    buffer_load_dwordx4 v245, s[32:35], s99 offen offset:1024  lds
    v_lshlrev_b32 v165, 16, v50
    v_lshlrev_b32 v166, 16, v52
    v_lshlrev_b32 v167, 16, v54
    v_lshlrev_b32 v168, 16, v56
    v_lshlrev_b32 v169, 16, v58
    buffer_load_dwordx4 v246, s[32:35], s99 offen offset:2048  lds
    v_lshlrev_b32 v170, 16, v60
    v_lshlrev_b32 v172, 16, v84
    v_and_b32 v173, 0xffff0000, v84
    v_lshlrev_b32 v174, 16, v85
    v_and_b32 v175, 0xffff0000, v85
    s_add_u32 m0, s61, 36864
    s_add_u32 s16, s16, s63
    buffer_load_dwordx4 v244, s[32:35], s16 offen offset:0  lds
    v_lshlrev_b32 v176, 16, v68
    v_lshlrev_b32 v177, 16, v70
    v_lshlrev_b32 v178, 16, v72
    v_lshlrev_b32 v179, 16, v74
    v_lshlrev_b32 v180, 16, v76
    buffer_load_dwordx4 v245, s[32:35], s16 offen offset:1024  lds
    v_lshlrev_b32 v181, 16, v78
    v_lshlrev_b32 v182, 16, v80
    v_lshlrev_b32 v183, 16, v82
    v_mul_f32 v184, v160, v175
    v_mul_f32 v185, v161, v175
    buffer_load_dwordx4 v246, s[32:35], s16 offen offset:2048  lds
    v_mul_f32 v186, v162, v175
    v_mul_f32 v187, v163, v175
    v_mul_f32 v188, v164, v175
    v_mul_f32 v189, v165, v175
    v_mul_f32 v190, v166, v175
    s_add_u32 s97, s98, s0
    s_lshr_b64 s[0:1], s[0:1], 4
    s_and_b32 s97, s97, 15
    s_add_u32 m0, s87, 36864
    s_lshl_b32 s97, s97, 7
    buffer_load_dwordx4 v240, s[28:31], s97 offen offset:0  lds
    v_mul_f32 v191, v167, v175
    v_fmac_f32 v184, v161, v174
    v_fmac_f32 v185, v162, v174
    v_fmac_f32 v186, v163, v174
    v_fmac_f32 v187, v164, v174
    buffer_load_dwordx4 v241, s[28:31], s97 offen offset:1024  lds
    v_fmac_f32 v188, v165, v174
    v_fmac_f32 v189, v166, v174
    v_fmac_f32 v190, v167, v174
    v_fmac_f32 v191, v168, v174
    v_fmac_f32 v184, v162, v173
    buffer_load_dwordx4 v242, s[28:31], s97 offen offset:2048  lds
    v_fmac_f32 v185, v163, v173
    v_fmac_f32 v186, v164, v173
    v_fmac_f32 v187, v165, v173
    v_fmac_f32 v188, v166, v173
    v_fmac_f32 v189, v167, v173
    buffer_load_dwordx4 v243, s[28:31], s97 offen offset:3072  lds
    v_fmac_f32 v190, v168, v173
    v_fmac_f32 v191, v169, v173
    v_fmac_f32 v184, v163, v172
    v_fmac_f32 v185, v164, v172
    v_fmac_f32 v186, v165, v172
    s_add_u32 m0, s88, 36864
    s_mov_b64 exec, 0xffffffff
    buffer_load_dwordx4 v3, s[28:31], s97 offen offset:0  lds
    s_mov_b64 exec, -1
    v_fmac_f32 v187, v166, v172
    v_fmac_f32 v188, v167, v172
    v_fmac_f32 v189, v168, v172
    v_fmac_f32 v190, v169, v172
    v_fmac_f32 v191, v170, v172
    v_mul_f32 v184, v184, v176
    v_mul_f32 v185, v185, v177
    v_mul_f32 v186, v186, v178
    v_mul_f32 v187, v187, v179
    v_mul_f32 v188, v188, v180
    v_mul_f32 v189, v189, v181
    v_mul_f32 v190, v190, v182
    v_mul_f32 v191, v191, v183
    v_cvt_pk_bf16_f32 v100, v191, v190
    v_cvt_pk_bf16_f32 v101, v189, v188
    v_cvt_pk_bf16_f32 v102, v187, v186
    v_cvt_pk_bf16_f32 v103, v185, v184
    s_mov_b32 s89, 0
    buffer_store_dwordx4 v[100:103], v12, s[52:55], s89 offen sc1
    v_and_b32 v160, 0xffff0000, v40
    v_and_b32 v161, 0xffff0000, v42
    v_and_b32 v162, 0xffff0000, v44
    v_and_b32 v163, 0xffff0000, v46
    v_and_b32 v164, 0xffff0000, v48
    v_and_b32 v165, 0xffff0000, v50
    v_and_b32 v166, 0xffff0000, v52
    v_and_b32 v167, 0xffff0000, v54
    v_and_b32 v168, 0xffff0000, v56
    v_and_b32 v169, 0xffff0000, v58
    v_and_b32 v170, 0xffff0000, v60
    v_lshlrev_b32 v172, 16, v86
    v_and_b32 v173, 0xffff0000, v86
    v_lshlrev_b32 v174, 16, v87
    v_and_b32 v175, 0xffff0000, v87
    v_and_b32 v176, 0xffff0000, v68
    v_and_b32 v177, 0xffff0000, v70
    v_and_b32 v178, 0xffff0000, v72
    v_and_b32 v179, 0xffff0000, v74
    v_and_b32 v180, 0xffff0000, v76
    v_and_b32 v181, 0xffff0000, v78
    v_and_b32 v182, 0xffff0000, v80
    v_and_b32 v183, 0xffff0000, v82
    s_waitcnt vmcnt(12)
    s_barrier
    s_mul_i32 s16, s97, 3072
    s_add_u32 m0, s60, 49152
    s_add_u32 s99, s16, s62
    buffer_load_dwordx4 v244, s[32:35], s99 offen offset:0  lds
    v_mul_f32 v184, v160, v175
    v_mul_f32 v185, v161, v175
    v_mul_f32 v186, v162, v175
    v_mul_f32 v187, v163, v175
    v_mul_f32 v188, v164, v175
    buffer_load_dwordx4 v245, s[32:35], s99 offen offset:1024  lds
    v_mul_f32 v189, v165, v175
    v_mul_f32 v190, v166, v175
    v_mul_f32 v191, v167, v175
    v_fmac_f32 v184, v161, v174
    v_fmac_f32 v185, v162, v174
    buffer_load_dwordx4 v246, s[32:35], s99 offen offset:2048  lds
    v_fmac_f32 v186, v163, v174
    v_fmac_f32 v187, v164, v174
    v_fmac_f32 v188, v165, v174
    v_fmac_f32 v189, v166, v174
    v_fmac_f32 v190, v167, v174
    s_add_u32 m0, s61, 61440
    s_add_u32 s16, s16, s63
    buffer_load_dwordx4 v244, s[32:35], s16 offen offset:0  lds
    v_fmac_f32 v191, v168, v174
    v_fmac_f32 v184, v162, v173
    v_fmac_f32 v185, v163, v173
    v_fmac_f32 v186, v164, v173
    v_fmac_f32 v187, v165, v173
    buffer_load_dwordx4 v245, s[32:35], s16 offen offset:1024  lds
    v_fmac_f32 v188, v166, v173
    v_fmac_f32 v189, v167, v173
    v_fmac_f32 v190, v168, v173
    v_fmac_f32 v191, v169, v173
    v_fmac_f32 v184, v163, v172
    buffer_load_dwordx4 v246, s[32:35], s16 offen offset:2048  lds
    v_fmac_f32 v185, v164, v172
    v_fmac_f32 v186, v165, v172
    v_fmac_f32 v187, v166, v172
    v_fmac_f32 v188, v167, v172
    v_fmac_f32 v189, v168, v172
    s_add_u32 s97, s98, s0
    s_lshr_b64 s[0:1], s[0:1], 4
    s_and_b32 s97, s97, 15
    s_add_u32 m0, s87, 0
    s_lshl_b32 s97, s97, 7
    buffer_load_dwordx4 v240, s[28:31], s97 offen offset:0  lds
    v_fmac_f32 v190, v169, v172
    v_fmac_f32 v191, v170, v172
    v_mul_f32 v184, v184, v176
    v_mul_f32 v185, v185, v177
    v_mul_f32 v186, v186, v178
    buffer_load_dwordx4 v241, s[28:31], s97 offen offset:1024  lds
    v_mul_f32 v187, v187, v179
    v_mul_f32 v188, v188, v180
    v_mul_f32 v189, v189, v181
    v_mul_f32 v190, v190, v182
    v_mul_f32 v191, v191, v183
    buffer_load_dwordx4 v242, s[28:31], s97 offen offset:2048  lds
    v_cvt_pk_bf16_f32 v104, v191, v190
    v_cvt_pk_bf16_f32 v105, v189, v188
    v_cvt_pk_bf16_f32 v106, v187, v186
    v_cvt_pk_bf16_f32 v107, v185, v184
    s_mov_b32 s89, 16384
    buffer_store_dwordx4 v[104:107], v12, s[52:55], s89 offen sc1
    buffer_load_dwordx4 v243, s[28:31], s97 offen offset:3072  lds
    v_lshlrev_b32 v160, 16, v41
    v_lshlrev_b32 v161, 16, v43
    v_lshlrev_b32 v162, 16, v45
    v_lshlrev_b32 v163, 16, v47
    v_lshlrev_b32 v164, 16, v49
    s_add_u32 m0, s88, 0
    s_mov_b64 exec, 0xffffffff
    buffer_load_dwordx4 v3, s[28:31], s97 offen offset:0  lds
    s_mov_b64 exec, -1
    v_lshlrev_b32 v165, 16, v51
    v_lshlrev_b32 v166, 16, v53
    v_lshlrev_b32 v167, 16, v55
    v_lshlrev_b32 v168, 16, v57
    v_lshlrev_b32 v169, 16, v59
    v_lshlrev_b32 v170, 16, v61
    v_lshlrev_b32 v172, 16, v88
    v_and_b32 v173, 0xffff0000, v88
    v_lshlrev_b32 v174, 16, v89
    v_and_b32 v175, 0xffff0000, v89
    v_lshlrev_b32 v176, 16, v69
    v_lshlrev_b32 v177, 16, v71
    v_lshlrev_b32 v178, 16, v73
    v_lshlrev_b32 v179, 16, v75
    v_lshlrev_b32 v180, 16, v77
    v_lshlrev_b32 v181, 16, v79
    v_lshlrev_b32 v182, 16, v81
    v_lshlrev_b32 v183, 16, v83
    v_mul_f32 v184, v160, v175
    v_mul_f32 v185, v161, v175
    v_mul_f32 v186, v162, v175
    v_mul_f32 v187, v163, v175
    v_mul_f32 v188, v164, v175
    v_mul_f32 v189, v165, v175
    v_mul_f32 v190, v166, v175
    v_mul_f32 v191, v167, v175
    v_fmac_f32 v184, v161, v174
    v_fmac_f32 v185, v162, v174
    v_fmac_f32 v186, v163, v174
    v_fmac_f32 v187, v164, v174
    v_fmac_f32 v188, v165, v174
    v_fmac_f32 v189, v166, v174
    v_fmac_f32 v190, v167, v174
    v_fmac_f32 v191, v168, v174
    v_fmac_f32 v184, v162, v173
    v_fmac_f32 v185, v163, v173
    v_fmac_f32 v186, v164, v173
    v_fmac_f32 v187, v165, v173
    v_fmac_f32 v188, v166, v173
    v_fmac_f32 v189, v167, v173
    v_fmac_f32 v190, v168, v173
    s_waitcnt vmcnt(13)
    s_barrier
    s_mul_i32 s16, s97, 3072
    s_add_u32 m0, s60, 0
    s_add_u32 s99, s16, s62
    buffer_load_dwordx4 v244, s[32:35], s99 offen offset:0  lds
    v_fmac_f32 v191, v169, v173
    v_fmac_f32 v184, v163, v172
    v_fmac_f32 v185, v164, v172
    v_fmac_f32 v186, v165, v172
    v_fmac_f32 v187, v166, v172
    buffer_load_dwordx4 v245, s[32:35], s99 offen offset:1024  lds
    v_fmac_f32 v188, v167, v172
    v_fmac_f32 v189, v168, v172
    v_fmac_f32 v190, v169, v172
    v_fmac_f32 v191, v170, v172
    v_mul_f32 v184, v184, v176
    buffer_load_dwordx4 v246, s[32:35], s99 offen offset:2048  lds
    v_mul_f32 v185, v185, v177
    v_mul_f32 v186, v186, v178
    v_mul_f32 v187, v187, v179
    v_mul_f32 v188, v188, v180
    v_mul_f32 v189, v189, v181
    s_add_u32 m0, s61, 12288
    s_add_u32 s16, s16, s63
    buffer_load_dwordx4 v244, s[32:35], s16 offen offset:0  lds
    v_mul_f32 v190, v190, v182
    v_mul_f32 v191, v191, v183
    v_cvt_pk_bf16_f32 v108, v191, v190
    v_cvt_pk_bf16_f32 v109, v189, v188
    v_cvt_pk_bf16_f32 v110, v187, v186
    buffer_load_dwordx4 v245, s[32:35], s16 offen offset:1024  lds
    v_cvt_pk_bf16_f32 v111, v185, v184
    s_mov_b32 s89, 32768
    buffer_store_dwordx4 v[108:111], v12, s[52:55], s89 offen sc1
    v_and_b32 v160, 0xffff0000, v41
    v_and_b32 v161, 0xffff0000, v43
    v_and_b32 v162, 0xffff0000, v45
    buffer_load_dwordx4 v246, s[32:35], s16 offen offset:2048  lds
    v_and_b32 v163, 0xffff0000, v47
    v_and_b32 v164, 0xffff0000, v49
    v_and_b32 v165, 0xffff0000, v51
    v_and_b32 v166, 0xffff0000, v53
    v_and_b32 v167, 0xffff0000, v55
    s_add_u32 s97, s98, s0
    s_lshr_b64 s[0:1], s[0:1], 4
    s_and_b32 s97, s97, 15
    s_add_u32 m0, s87, 18432
    s_lshl_b32 s97, s97, 7
    buffer_load_dwordx4 v240, s[28:31], s97 offen offset:0  lds
    v_and_b32 v168, 0xffff0000, v57
    v_and_b32 v169, 0xffff0000, v59
    v_and_b32 v170, 0xffff0000, v61
    v_lshlrev_b32 v172, 16, v90
    v_and_b32 v173, 0xffff0000, v90
    buffer_load_dwordx4 v241, s[28:31], s97 offen offset:1024  lds
    v_lshlrev_b32 v174, 16, v91
    v_and_b32 v175, 0xffff0000, v91
    v_and_b32 v176, 0xffff0000, v69
    v_and_b32 v177, 0xffff0000, v71
    v_and_b32 v178, 0xffff0000, v73
    buffer_load_dwordx4 v242, s[28:31], s97 offen offset:2048  lds
    v_and_b32 v179, 0xffff0000, v75
    v_and_b32 v180, 0xffff0000, v77
    v_and_b32 v181, 0xffff0000, v79
    v_and_b32 v182, 0xffff0000, v81
    v_and_b32 v183, 0xffff0000, v83
    buffer_load_dwordx4 v243, s[28:31], s97 offen offset:3072  lds
    v_mul_f32 v184, v160, v175
    v_mul_f32 v185, v161, v175
    v_mul_f32 v186, v162, v175
    v_mul_f32 v187, v163, v175
    v_mul_f32 v188, v164, v175
    s_add_u32 m0, s88, 18432
    s_mov_b64 exec, 0xffffffff
    buffer_load_dwordx4 v3, s[28:31], s97 offen offset:0  lds
    s_mov_b64 exec, -1
    v_mul_f32 v189, v165, v175
    v_mul_f32 v190, v166, v175
    v_mul_f32 v191, v167, v175
    v_fmac_f32 v184, v161, v174
    v_fmac_f32 v185, v162, v174
    v_fmac_f32 v186, v163, v174
    v_fmac_f32 v187, v164, v174
    v_fmac_f32 v188, v165, v174
    v_fmac_f32 v189, v166, v174
    v_fmac_f32 v190, v167, v174
    v_fmac_f32 v191, v168, v174
    v_fmac_f32 v184, v162, v173
    v_fmac_f32 v185, v163, v173
    v_fmac_f32 v186, v164, v173
    v_fmac_f32 v187, v165, v173
    v_fmac_f32 v188, v166, v173
    v_fmac_f32 v189, v167, v173
    v_fmac_f32 v190, v168, v173
    v_fmac_f32 v191, v169, v173
    v_fmac_f32 v184, v163, v172
    v_fmac_f32 v185, v164, v172
    v_fmac_f32 v186, v165, v172
    v_fmac_f32 v187, v166, v172
    v_fmac_f32 v188, v167, v172
    v_fmac_f32 v189, v168, v172
    v_fmac_f32 v190, v169, v172
    v_fmac_f32 v191, v170, v172
    v_mul_f32 v184, v184, v176
    v_mul_f32 v185, v185, v177
    v_mul_f32 v186, v186, v178
    v_mul_f32 v187, v187, v179
    v_mul_f32 v188, v188, v180
    v_mul_f32 v189, v189, v181
    v_mul_f32 v190, v190, v182
    v_mul_f32 v191, v191, v183
    v_cvt_pk_bf16_f32 v112, v191, v190
    v_cvt_pk_bf16_f32 v113, v189, v188
    v_cvt_pk_bf16_f32 v114, v187, v186
    v_cvt_pk_bf16_f32 v115, v185, v184
    s_mov_b32 s89, 49152
    buffer_store_dwordx4 v[112:115], v12, s[52:55], s89 offen sc1
    s_waitcnt vmcnt(13)
    s_barrier
    s_mul_i32 s16, s97, 3072
    s_add_u32 m0, s60, 24576
    s_add_u32 s99, s16, s62
    buffer_load_dwordx4 v244, s[32:35], s99 offen offset:0  lds
    buffer_load_dwordx4 v245, s[32:35], s99 offen offset:1024  lds
    buffer_load_dwordx4 v246, s[32:35], s99 offen offset:2048  lds
    s_add_u32 m0, s61, 36864
    s_add_u32 s16, s16, s63
    buffer_load_dwordx4 v244, s[32:35], s16 offen offset:0  lds
    buffer_load_dwordx4 v245, s[32:35], s16 offen offset:1024  lds
    buffer_load_dwordx4 v246, s[32:35], s16 offen offset:2048  lds
    s_add_u32 s97, s98, s0
    s_lshr_b64 s[0:1], s[0:1], 4
    s_and_b32 s97, s97, 15
    s_add_u32 m0, s87, 36864
    s_lshl_b32 s97, s97, 7
    buffer_load_dwordx4 v240, s[28:31], s97 offen offset:0  lds
    buffer_load_dwordx4 v241, s[28:31], s97 offen offset:1024  lds
    buffer_load_dwordx4 v242, s[28:31], s97 offen offset:2048  lds
    buffer_load_dwordx4 v243, s[28:31], s97 offen offset:3072  lds
    s_add_u32 m0, s88, 36864
    s_mov_b64 exec, 0xffffffff
    buffer_load_dwordx4 v3, s[28:31], s97 offen offset:0  lds
    s_mov_b64 exec, -1
    s_waitcnt vmcnt(12)
    s_waitcnt vmcnt(11)
    s_barrier
    s_mul_i32 s16, s97, 3072
    s_add_u32 m0, s60, 49152
    s_add_u32 s99, s16, s62
    buffer_load_dwordx4 v244, s[32:35], s99 offen offset:0  lds
    s_mov_b32 s68, s24
    s_mov_b32 s69, s25
    s_mov_b32 s70, 0x100
    s_mov_b32 s71, 0x20000
    v_lshrrev_b32 v6, 5, v0
    buffer_load_dwordx4 v245, s[32:35], s99 offen offset:1024  lds
    v_and_b32 v7, 3, v0
    s_lshr_b32 s78, s90, 1
    s_lshl_b32 s78, s78, 2
    s_load_dword s92, s[14:15], s78
    v_bfe_u32 v5, v0, 2, 2
    buffer_load_dwordx4 v246, s[32:35], s99 offen offset:2048  lds
    v_lshlrev_b32 v5, 1, v5
    v_lshl_add_u32 v5, v6, 3, v5
    v_bfe_u32 v8, v0, 4, 1
    v_add_u32 v5, v5, v8
    s_and_b32 s78, s3, 1
    s_add_u32 m0, s61, 61440
    s_add_u32 s16, s16, s63
    buffer_load_dwordx4 v244, s[32:35], s16 offen offset:0  lds
    s_lshl_b32 s78, s78, 1
    v_add_u32 v8, s78, v6
    v_xor_b32 v8, v8, v7
    v_lshlrev_b32 v8, 4, v8
    buffer_load_dwordx4 v245, s[32:35], s16 offen offset:1024  lds
    v_lshl_add_u32 v5, v5, 6, v8
    v_add_u32 v14, s86, v5
    v_mov_b32 v18, 162304
    v_mov_b32 v19, 1
    v_and_b32 v5, 3, v0
    buffer_load_dwordx4 v246, s[32:35], s16 offen offset:2048  lds
    s_lshl_b32 s78, s74, 4
    s_add_u32 s78, s78, s3
    v_lshl_add_u32 v6, v5, 2, s78
    s_lshr_b32 s78, s76, 3
    s_lshl_b32 s79, s3, 1
    s_add_u32 s97, s98, s0
    s_lshr_b64 s[0:1], s[0:1], 4
    s_and_b32 s97, s97, 15
    s_add_u32 m0, s87, 0
    s_lshl_b32 s97, s97, 7
    buffer_load_dwordx4 v240, s[28:31], s97 offen offset:0  lds
    s_add_u32 s78, s78, s79
    s_xor_b32 s78, s78, 2
    s_lshl_b32 s78, s78, 5
    s_add_u32 s79, s76, 5
    s_and_b32 s79, s79, 7
    buffer_load_dwordx4 v241, s[28:31], s97 offen offset:1024  lds
    s_lshl_b32 s79, s79, 1
    s_add_u32 s78, s78, s79
    v_mul_u32_u24 v7, 9, v5
    v_and_b32 v7, 17, v7
    buffer_load_dwordx4 v242, s[28:31], s97 offen offset:2048  lds
    v_add_u32 v7, s78, v7
    v_and_b32 v8, 4, v0
    v_cmp_eq_u32 vcc, 0, v8
    s_nop 1
    v_cndmask_b32 v6, v7, v6, vcc
    v_and_b32 v33, 0xf0, v6
    buffer_load_dwordx4 v243, s[28:31], s97 offen offset:3072  lds
    v_lshlrev_b32 v34, 8, v6
    v_add_u32 v34, 12582912, v34
    v_and_b32 v5, 15, v0
    v_lshrrev_b32 v6, 4, v0
    v_add_u32 v7, 9, v5
    s_add_u32 m0, s88, 0
    s_mov_b64 exec, 0xffffffff
    buffer_load_dwordx4 v3, s[28:31], s97 offen offset:0  lds
    s_mov_b64 exec, -1
    v_and_b32 v8, 1, v7
    v_mul_u32_u24 v8, 4160, v8
    v_lshrrev_b32 v7, 1, v7
    v_lshl_add_u32 v8, v7, 2, v8
    s_waitcnt vmcnt(11)
    s_barrier
    s_mul_i32 s16, s97, 3072
    s_add_u32 m0, s60, 0
    s_add_u32 s99, s16, s62
    buffer_load_dwordx4 v244, s[32:35], s99 offen offset:0  lds
    v_lshlrev_b32 v7, 4, v6
    v_sub_u32 v8, v8, v7
    s_add_u32 s78, s94, 32
    v_add_u32 v21, s78, v8
    buffer_load_dwordx4 v245, s[32:35], s99 offen offset:1024  lds
    v_add_u32 v22, 1024, v21
    v_add_u32 v23, 2048, v21
    v_add_u32 v24, 3072, v21
    buffer_load_dwordx4 v246, s[32:35], s99 offen offset:2048  lds
    v_lshl_add_u32 v7, v5, 1, v6
    v_add_u32 v7, 30, v7
    v_and_b32 v8, 1, v7
    v_bfe_u32 v136, v7, 1, 2
    s_add_u32 m0, s61, 12288
    s_add_u32 s16, s16, s63
    buffer_load_dwordx4 v244, s[32:35], s16 offen offset:0  lds
    v_lshl_add_u32 v136, v8, 2, v136
    v_lshlrev_b32 v136, 6, v136
    v_lshrrev_b32 v7, 3, v7
    buffer_load_dwordx4 v245, s[32:35], s16 offen offset:1024  lds
    v_lshl_add_u32 v136, v7, 9, v136
    v_bitop3_b32 v8, v7, 3, s3 bitop3:0x6a
    v_lshl_add_u32 v25, v8, 4, v136
    v_add_u32 v25, 92160, v25
    buffer_load_dwordx4 v246, s[32:35], s16 offen offset:2048  lds
    v_subrev_u32 v7, 1, v7
    v_bitop3_b32 v8, v7, 3, s3 bitop3:0x6a
    v_lshl_add_u32 v27, v8, 4, v136
    s_add_u32 m0, s94, 32
    s_lshl_b32 s89, s90, 12
    buffer_load_dwordx4 v15, s[48:51], s89 offen offset:0 nt lds
    v_add_u32 v27, 91648, v27
    v_subrev_u32 v7, 1, v7
    v_bitop3_b32 v8, v7, 3, s3 bitop3:0x6a
    v_lshl_add_u32 v29, v8, 4, v136
    s_add_u32 m0, s94, 32
    s_lshl_b32 s89, s90, 12
    buffer_load_dwordx4 v15, s[48:51], s89 offen offset:1024 nt lds
    v_add_u32 v29, 91136, v29
    v_subrev_u32 v7, 1, v7
    v_bitop3_b32 v8, v7, 3, s3 bitop3:0x6a
    s_add_u32 m0, s94, 32
    s_lshl_b32 s89, s90, 12
    buffer_load_dwordx4 v15, s[48:51], s89 offen offset:2048 nt lds
    v_lshl_add_u32 v31, v8, 4, v136
    v_add_u32 v31, 90624, v31
    v_lshl_add_u32 v7, v5, 1, v6
    v_add_u32 v7, 26, v7
    s_add_u32 m0, s94, 32
    s_lshl_b32 s89, s90, 12
    buffer_load_dwordx4 v15, s[48:51], s89 offen offset:3072 nt lds
    v_and_b32 v8, 1, v7
    v_bfe_u32 v136, v7, 1, 2
    v_lshl_add_u32 v136, v8, 2, v136
    s_add_u32 s97, s98, s0
    s_lshr_b64 s[0:1], s[0:1], 4
    s_and_b32 s97, s97, 15
    s_add_u32 m0, s87, 18432
    s_lshl_b32 s97, s97, 7
    buffer_load_dwordx4 v240, s[28:31], s97 offen offset:0  lds
    v_lshlrev_b32 v136, 6, v136
    v_lshrrev_b32 v7, 3, v7
    v_lshl_add_u32 v136, v7, 9, v136
    v_bitop3_b32 v8, v7, 3, s3 bitop3:0x6a
    buffer_load_dwordx4 v241, s[28:31], s97 offen offset:1024  lds
    v_lshl_add_u32 v26, v8, 4, v136
    v_add_u32 v26, 92160, v26
    v_subrev_u32 v7, 1, v7
    buffer_load_dwordx4 v242, s[28:31], s97 offen offset:2048  lds
    v_bitop3_b32 v8, v7, 3, s3 bitop3:0x6a
    v_lshl_add_u32 v28, v8, 4, v136
    v_add_u32 v28, 91648, v28
    v_subrev_u32 v7, 1, v7
    buffer_load_dwordx4 v243, s[28:31], s97 offen offset:3072  lds
    v_bitop3_b32 v8, v7, 3, s3 bitop3:0x6a
    v_lshl_add_u32 v30, v8, 4, v136
    v_add_u32 v30, 91136, v30
    s_add_u32 m0, s88, 18432
    s_mov_b64 exec, 0xffffffff
    buffer_load_dwordx4 v3, s[28:31], s97 offen offset:0  lds
    s_mov_b64 exec, -1
    v_subrev_u32 v7, 1, v7
    v_bitop3_b32 v8, v7, 3, s3 bitop3:0x6a
    v_lshl_add_u32 v32, v8, 4, v136
    s_waitcnt vmcnt(15)
    s_barrier
    s_mul_i32 s16, s97, 3072
    s_add_u32 m0, s60, 24576
    s_add_u32 s99, s16, s62
    buffer_load_dwordx4 v244, s[32:35], s99 offen offset:0  lds
    v_add_u32 v32, 90624, v32
    v_lshrrev_b32 v7, 1, v6
    v_lshl_add_u32 v7, v5, 1, v7
    v_add_u32 v7, 32, v7
    v_and_b32 v8, 1, v7
    buffer_load_dwordx4 v245, s[32:35], s99 offen offset:1024  lds
    v_bfe_u32 v136, v7, 1, 2
    v_lshl_add_u32 v136, v8, 2, v136
    v_lshlrev_b32 v136, 6, v136
    v_lshrrev_b32 v7, 3, v7
    buffer_load_dwordx4 v246, s[32:35], s99 offen offset:2048  lds
    v_lshl_add_u32 v136, v7, 9, v136
    v_bitop3_b32 v8, v7, 3, s3 bitop3:0x6a
    v_lshl_add_u32 v20, v8, 4, v136
    v_add_u32 v20, 92160, v20
    v_and_b32 v8, 1, v6
    s_add_u32 m0, s61, 36864
    s_add_u32 s16, s16, s63
    buffer_load_dwordx4 v244, s[32:35], s16 offen offset:0  lds
    v_xor_b32 v8, 1, v8
    v_lshl_add_u32 v20, v8, 3, v20
    s_waitcnt lgkmcnt(0)
    s_and_b32 s78, s92, 0xffff0000
    buffer_load_dwordx4 v245, s[32:35], s16 offen offset:1024  lds
    s_lshl_b32 s92, s92, 16
    s_bitcmp1_b32 s90, 0
    s_cselect_b32 s92, s78, s92
    v_lshlrev_b32 v7, 3, v6
    v_sub_u32 v7, v7, v5
    buffer_load_dwordx4 v246, s[32:35], s16 offen offset:2048  lds
    v_subrev_u32 v7, 9, v7
    v_and_b32 v8, 1, v7
    v_xor_b32 v8, 1, v8
    v_lshlrev_b32 v8, 4, v8
    v_lshrrev_b32 v8, v8, s92
    s_add_u32 s97, s98, s0
    s_lshr_b64 s[0:1], s[0:1], 4
    s_and_b32 s97, s97, 15
    s_add_u32 m0, s87, 36864
    s_lshl_b32 s97, s97, 7
    buffer_load_dwordx4 v240, s[28:31], s97 offen offset:0  lds
    v_ashrrev_i32 v7, 1, v7
    v_cmp_eq_u32 vcc, 0, v7
    s_nop 1
    v_cndmask_b32 v236, 0, v8, vcc
    v_cmp_eq_u32 vcc, 1, v7
    buffer_load_dwordx4 v241, s[28:31], s97 offen offset:1024  lds
    s_nop 0
    v_cndmask_b32 v237, 0, v8, vcc
    v_cmp_eq_u32 vcc, 2, v7
    s_nop 1
    v_cndmask_b32 v238, 0, v8, vcc
    v_cmp_eq_u32 vcc, 3, v7
    buffer_load_dwordx4 v242, s[28:31], s97 offen offset:2048  lds
    s_nop 0
    v_cndmask_b32 v239, 0, v8, vcc
    s_and_b32 s78, s77, 7
    s_mov_b32 s95, 0x76543210
    s_and_b32 s78, s76, 3
    s_mul_i32 s78, s78, 0x22222222
    s_add_u32 s95, s95, s78
    s_bfe_u32 s100, s95, 0x3001c
    s_lshl_b32 s100, s100, 18
    s_bfe_u32 s95, s95, 0x30018
    s_lshl_b32 s95, s95, 18
    v_lshrrev_b32 v136, 4, v0
    v_lshlrev_b32 v136, 1, v136
    v_and_b32 v137, 7, v0
    buffer_load_dwordx4 v243, s[28:31], s97 offen offset:3072  lds
    v_xor_b32 v136, v136, v137
    v_lshlrev_b32 v136, 4, v136
    v_lshrrev_b32 v137, 3, v0
    v_lshl_add_u32 v136, v137, 11, v136
    s_add_u32 m0, s88, 36864
    s_mov_b64 exec, 0xffffffff
    buffer_load_dwordx4 v3, s[28:31], s97 offen offset:0  lds
    s_mov_b64 exec, -1
    s_lshl_b32 s78, s77, 7
    s_lshl_b32 s79, s3, 14
    s_add_u32 s78, s78, s79
    v_add_u32 v17, s78, v136
    s_waitcnt vmcnt(11)
    s_barrier
    s_mul_i32 s16, s97, 3072
    s_add_u32 m0, s60, 49152
    s_add_u32 s99, s16, s62
    buffer_load_dwordx4 v244, s[32:35], s99 offen offset:0  lds
    v_add_u32 v5, s94, v15
    ds_read_b128 v[140:143], v5 offset:32
    ds_read_b32 v156, v5 offset:48
    ds_read_b128 v[144:147], v5 offset:1056
    buffer_load_dwordx4 v245, s[32:35], s99 offen offset:1024  lds
    ds_read_b32 v157, v5 offset:1072
    ds_read_b128 v[148:151], v5 offset:2080
    ds_read_b32 v158, v5 offset:2096
    ds_read_b128 v[152:155], v5 offset:3104
    buffer_load_dwordx4 v246, s[32:35], s99 offen offset:2048  lds
    ds_read_b32 v159, v5 offset:3120
    v_lshrrev_b32 v6, 3, v0
    v_mul_u32_u24 v6, 4160, v6
    s_add_u32 m0, s61, 61440
    s_add_u32 s16, s16, s63
    buffer_load_dwordx4 v244, s[32:35], s16 offen offset:0  lds
    v_and_b32 v7, 7, v0
    v_lshl_add_u32 v6, v7, 2, v6
    v_add_u32 v6, s94, v6
    v_mov_b32 v7, 0
    buffer_load_dwordx4 v245, s[32:35], s16 offen offset:1024  lds
    s_waitcnt lgkmcnt(0)
    v_readfirstlane_b32 s93, v140
    s_nop 0
    s_lshl_b32 s93, s93, 16
    s_nop 1
    v_writelane_b32 v7, s93, 15
    buffer_load_dwordx4 v246, s[32:35], s16 offen offset:2048  lds
    v_alignbit_b32 v140, v141, v140, 16
    v_alignbit_b32 v141, v142, v141, 16
    v_alignbit_b32 v142, v143, v142, 16
    s_add_u32 s97, s98, s0
    s_lshr_b64 s[0:1], s[0:1], 4
    s_and_b32 s97, s97, 15
    s_add_u32 m0, s87, 0
    s_lshl_b32 s97, s97, 7
    buffer_load_dwordx4 v240, s[28:31], s97 offen offset:0  lds
    v_alignbit_b32 v143, v156, v143, 16
    v_alignbit_b32 v144, v145, v144, 16
    v_alignbit_b32 v145, v146, v145, 16
    v_alignbit_b32 v146, v147, v146, 16
    buffer_load_dwordx4 v241, s[28:31], s97 offen offset:1024  lds
    v_alignbit_b32 v147, v157, v147, 16
    v_alignbit_b32 v148, v149, v148, 16
    v_alignbit_b32 v149, v150, v149, 16
    v_alignbit_b32 v150, v151, v150, 16
    buffer_load_dwordx4 v242, s[28:31], s97 offen offset:2048  lds
    v_alignbit_b32 v151, v158, v151, 16
    v_alignbit_b32 v152, v153, v152, 16
    v_alignbit_b32 v153, v154, v153, 16
    buffer_load_dwordx4 v243, s[28:31], s97 offen offset:3072  lds
    v_alignbit_b32 v154, v155, v154, 16
    v_alignbit_b32 v155, v159, v155, 16
    v_lshlrev_b32 v8, 3, v0
    s_add_u32 s78, s88, 18432
    s_add_u32 m0, s88, 0
    s_mov_b64 exec, 0xffffffff
    buffer_load_dwordx4 v3, s[28:31], s97 offen offset:0  lds
    s_mov_b64 exec, -1
    v_add_u32 v8, s78, v8
    v_mov_b32 v156, 0
    v_mov_b32 v157, 0
    s_waitcnt vmcnt(11)
    s_barrier
    s_mul_i32 s16, s97, 3072
    s_add_u32 m0, s60, 0
    s_add_u32 s99, s16, s62
    buffer_load_dwordx4 v244, s[32:35], s99 offen offset:0  lds
    buffer_load_dwordx4 v245, s[32:35], s99 offen offset:1024  lds
    buffer_load_dwordx4 v246, s[32:35], s99 offen offset:2048  lds
    s_add_u32 m0, s61, 12288
    s_add_u32 s16, s16, s63
    buffer_load_dwordx4 v244, s[32:35], s16 offen offset:0  lds
    buffer_load_dwordx4 v245, s[32:35], s16 offen offset:1024  lds
    buffer_load_dwordx4 v246, s[32:35], s16 offen offset:2048  lds
    s_mov_b64 exec, 0xff
    buffer_load_dword v136, v33, s[68:71], 0 offen sc1
    buffer_load_dword v137, v34, s[52:55], 0 offen sc1
    s_mov_b64 exec, -1
    buffer_load_dwordx4 v[212:215], v9, s[56:59], 0 offen offset:0 nt
    buffer_load_dwordx4 v[216:219], v9, s[56:59], 0 offen offset:2048 nt
    buffer_load_dwordx4 v[220:223], v9, s[56:59], s96 offen offset:0 nt
    buffer_load_dwordx4 v[224:227], v9, s[56:59], s96 offen offset:2048 nt
    s_waitcnt vmcnt(12)
    s_waitcnt vmcnt(6)
    s_barrier
    s_waitcnt vmcnt(4)
LA_j:
    s_mov_b64 exec, 0xff
    v_cmp_ne_u32 vcc, v136, v137
    v_cmp_gt_u32 s[80:81], s96, v136
    s_nop 0
    s_or_b64 vcc, vcc, s[80:81]
    s_cbranch_vccnz LA_slow
LA_back:
    s_mov_b64 exec, -1
    s_add_u32 m0, s86, 94208
    s_add_u32 s89, s91, 0
    buffer_load_dwordx4 v14, s[52:55], s89 offen sc1 lds
    s_add_u32 m0, s86, 98304
    s_add_u32 s89, s91, 4096
    buffer_load_dwordx4 v14, s[52:55], s89 offen sc1 lds
    s_add_u32 m0, s86, 102400
    s_add_u32 s89, s91, 8192
    buffer_load_dwordx4 v14, s[52:55], s89 offen sc1 lds
    s_add_u32 m0, s86, 106496
    s_add_u32 s89, s91, 12288
    buffer_load_dwordx4 v14, s[52:55], s89 offen sc1 lds
    s_add_u32 s89, s95, 131072
    buffer_load_dwordx4 v[228:231], v17, s[64:67], s89 offen
    s_add_u32 s89, s95, 196608
    buffer_load_dwordx4 v[232:235], v17, s[64:67], s89 offen
    s_add_u32 s89, s100, 0
    buffer_load_dwordx4 v[240:243], v17, s[64:67], s89 offen
    s_add_u32 s89, s100, 65536
    buffer_load_dwordx4 v[244:247], v17, s[64:67], s89 offen
    s_add_u32 s89, s100, 131072
    buffer_load_dwordx4 v[248:251], v17, s[64:67], s89 offen
    s_add_u32 s89, s100, 196608
    buffer_load_dwordx4 v[196:199], v17, s[64:67], s89 offen
    s_mov_b64 exec, 0xffff
    ds_write_b32 v6, v7
    s_mov_b64 exec, -1
    ds_write_b128 v5, v[140:143] offset:4192
    ds_write_b128 v5, v[144:147] offset:5216
    ds_write_b128 v5, v[148:151] offset:6240
    ds_write_b128 v5, v[152:155] offset:7264
    ds_write_b64 v8, v[156:157]
    ds_read2_b32 v[68:69], v21 offset0:0 offset1:1
    ds_read2_b32 v[70:71], v21 offset0:2 offset1:3
    ds_read2_b32 v[72:73], v21 offset0:128 offset1:129
    ds_read2_b32 v[74:75], v21 offset0:130 offset1:131
    ds_read2_b32 v[76:77], v22 offset0:0 offset1:1
    ds_read2_b32 v[78:79], v22 offset0:2 offset1:3
    ds_read2_b32 v[80:81], v22 offset0:128 offset1:129
    ds_read2_b32 v[82:83], v22 offset0:130 offset1:131
    ds_read2_b32 v[84:85], v23 offset0:0 offset1:1
    ds_read2_b32 v[86:87], v23 offset0:2 offset1:3
    ds_read2_b32 v[88:89], v23 offset0:128 offset1:129
    ds_read2_b32 v[90:91], v23 offset0:130 offset1:131
    ds_read2_b32 v[92:93], v24 offset0:0 offset1:1
    ds_read2_b32 v[94:95], v24 offset0:2 offset1:3
    ds_read2_b32 v[96:97], v24 offset0:128 offset1:129
    ds_read2_b32 v[98:99], v24 offset0:130 offset1:131
    s_waitcnt vmcnt(6)
    s_mov_b64 exec, 1
    ds_add_u32 v18, v19 offset:20
    s_mov_b64 exec, -1
    s_branch LA_s5_in
LA_s5:
    s_sleep 1
LA_s5_in:
    ds_read_b32 v6, v18 offset:20
    s_waitcnt lgkmcnt(0)
    v_readfirstlane_b32 s78, v6
    s_nop 0
    s_cmp_ge_u32 s78, 4
    s_cbranch_scc0 LA_s5
    s_mov_b64 exec, 1
    ds_add_u32 v18, v19 offset:8
    s_mov_b64 exec, -1
    ds_read_b128 v[100:103], v25 offset:0
    ds_read_b128 v[104:107], v25 offset:2048
    ds_read_b128 v[108:111], v25 offset:4096
    ds_read_b128 v[112:115], v25 offset:6144
    ds_read_b128 v[116:119], v25 offset:8192
    ds_read_b128 v[120:123], v25 offset:10240
    ds_read_b128 v[124:127], v25 offset:12288
    ds_read_b128 v[128:131], v25 offset:14336
    s_setprio 2
    s_waitcnt lgkmcnt(7)
    v_mfma_f32_16x16x32_bf16 v[36:39], v[236:239], v[100:103], 0
    ds_read2_b32 v[132:133], v21 offset0:16 offset1:17
    v_mfma_f32_16x16x32_bf16 v[36:39], v[68:71], v[100:103], v[36:39]
    ds_read2_b32 v[134:135], v21 offset0:18 offset1:19
    s_waitcnt lgkmcnt(8)
    v_mfma_f32_16x16x32_bf16 v[40:43], v[236:239], v[104:107], 0
    v_mfma_f32_16x16x32_bf16 v[40:43], v[68:71], v[104:107], v[40:43]
    ds_read_b128 v[164:167], v26 offset:0
    v_mfma_f32_16x16x32_bf16 v[40:43], v[72:75], v[100:103], v[40:43]
    s_waitcnt lgkmcnt(8)
    v_mfma_f32_16x16x32_bf16 v[44:47], v[236:239], v[108:111], 0
    ds_read2_b32 v[136:137], v21 offset0:144 offset1:145
    v_mfma_f32_16x16x32_bf16 v[44:47], v[68:71], v[108:111], v[44:47]
    ds_read2_b32 v[138:139], v21 offset0:146 offset1:147
    v_mfma_f32_16x16x32_bf16 v[44:47], v[72:75], v[104:107], v[44:47]
    v_mfma_f32_16x16x32_bf16 v[44:47], v[76:79], v[100:103], v[44:47]
    ds_read_b128 v[168:171], v26 offset:2048
    s_waitcnt lgkmcnt(10)
    v_mfma_f32_16x16x32_bf16 v[48:51], v[236:239], v[112:115], 0
    v_mfma_f32_16x16x32_bf16 v[48:51], v[68:71], v[112:115], v[48:51]
    ds_read2_b32 v[140:141], v22 offset0:16 offset1:17
    v_mfma_f32_16x16x32_bf16 v[48:51], v[72:75], v[108:111], v[48:51]
    ds_read2_b32 v[142:143], v22 offset0:18 offset1:19
    v_mfma_f32_16x16x32_bf16 v[48:51], v[76:79], v[104:107], v[48:51]
    v_mfma_f32_16x16x32_bf16 v[48:51], v[80:83], v[100:103], v[48:51]
    ds_read_b128 v[172:175], v26 offset:4096
    s_waitcnt lgkmcnt(12)
    v_mfma_f32_16x16x32_bf16 v[52:55], v[236:239], v[116:119], 0
    v_mfma_f32_16x16x32_bf16 v[52:55], v[68:71], v[116:119], v[52:55]
    ds_read2_b32 v[144:145], v22 offset0:144 offset1:145
    v_mfma_f32_16x16x32_bf16 v[52:55], v[72:75], v[112:115], v[52:55]
    ds_read2_b32 v[146:147], v22 offset0:146 offset1:147
    v_mfma_f32_16x16x32_bf16 v[52:55], v[76:79], v[108:111], v[52:55]
    v_mfma_f32_16x16x32_bf16 v[52:55], v[80:83], v[104:107], v[52:55]
    ds_read_b128 v[176:179], v26 offset:6144
    v_mfma_f32_16x16x32_bf16 v[52:55], v[84:87], v[100:103], v[52:55]
    s_waitcnt lgkmcnt(14)
    v_mfma_f32_16x16x32_bf16 v[56:59], v[236:239], v[120:123], 0
    ds_read2_b32 v[148:149], v23 offset0:16 offset1:17
    v_mfma_f32_16x16x32_bf16 v[56:59], v[68:71], v[120:123], v[56:59]
    ds_read2_b32 v[150:151], v23 offset0:18 offset1:19
    v_mfma_f32_16x16x32_bf16 v[56:59], v[72:75], v[116:119], v[56:59]
    v_mfma_f32_16x16x32_bf16 v[56:59], v[76:79], v[112:115], v[56:59]
    ds_read_b128 v[180:183], v26 offset:8192
    v_mfma_f32_16x16x32_bf16 v[56:59], v[80:83], v[108:111], v[56:59]
    v_mfma_f32_16x16x32_bf16 v[56:59], v[84:87], v[104:107], v[56:59]
    ds_read2_b32 v[152:153], v23 offset0:144 offset1:145
    v_mfma_f32_16x16x32_bf16 v[56:59], v[88:91], v[100:103], v[56:59]
    ds_read2_b32 v[154:155], v23 offset0:146 offset1:147
    s_waitcnt lgkmcnt(14)
    v_mfma_f32_16x16x32_bf16 v[60:63], v[236:239], v[124:127], 0
    v_mfma_f32_16x16x32_bf16 v[60:63], v[68:71], v[124:127], v[60:63]
    ds_read_b128 v[184:187], v26 offset:10240
    v_mfma_f32_16x16x32_bf16 v[60:63], v[72:75], v[120:123], v[60:63]
    v_mfma_f32_16x16x32_bf16 v[60:63], v[76:79], v[116:119], v[60:63]
    ds_read2_b32 v[156:157], v24 offset0:16 offset1:17
    v_mfma_f32_16x16x32_bf16 v[60:63], v[80:83], v[112:115], v[60:63]
    ds_read2_b32 v[158:159], v24 offset0:18 offset1:19
    v_mfma_f32_16x16x32_bf16 v[60:63], v[84:87], v[108:111], v[60:63]
    v_mfma_f32_16x16x32_bf16 v[60:63], v[88:91], v[104:107], v[60:63]
    ds_read_b128 v[188:191], v26 offset:12288
    v_mfma_f32_16x16x32_bf16 v[60:63], v[92:95], v[100:103], v[60:63]
    v_mfma_f32_16x16x32_bf16 v[64:67], v[236:239], v[128:131], 0
    ds_read2_b32 v[160:161], v24 offset0:144 offset1:145
    v_mfma_f32_16x16x32_bf16 v[64:67], v[68:71], v[128:131], v[64:67]
    ds_read2_b32 v[162:163], v24 offset0:146 offset1:147
    v_mfma_f32_16x16x32_bf16 v[64:67], v[72:75], v[124:127], v[64:67]
    v_mfma_f32_16x16x32_bf16 v[64:67], v[76:79], v[120:123], v[64:67]
    ds_read_b128 v[192:195], v26 offset:14336
    v_mfma_f32_16x16x32_bf16 v[64:67], v[80:83], v[116:119], v[64:67]
    v_mfma_f32_16x16x32_bf16 v[64:67], v[84:87], v[112:115], v[64:67]
    v_mfma_f32_16x16x32_bf16 v[64:67], v[88:91], v[108:111], v[64:67]
    v_mfma_f32_16x16x32_bf16 v[64:67], v[92:95], v[104:107], v[64:67]
    v_mfma_f32_16x16x32_bf16 v[64:67], v[96:99], v[100:103], v[64:67]
    v_mfma_f32_16x16x32_bf16 v[36:39], v[132:135], v[164:167], v[36:39]
    ds_read2_b32 v[68:69], v21 offset0:32 offset1:33
    s_waitcnt lgkmcnt(14)
    v_mfma_f32_16x16x32_bf16 v[40:43], v[136:139], v[164:167], v[40:43]
    ds_read2_b32 v[70:71], v21 offset0:34 offset1:35
    v_mfma_f32_16x16x32_bf16 v[40:43], v[132:135], v[168:171], v[40:43]
    ds_read_b128 v[100:103], v27 offset:0
    v_mfma_f32_16x16x32_bf16 v[44:47], v[132:135], v[172:175], v[44:47]
    v_mfma_f32_16x16x32_bf16 v[44:47], v[136:139], v[168:171], v[44:47]
    ds_read2_b32 v[72:73], v21 offset0:160 offset1:161
    v_mfma_f32_16x16x32_bf16 v[44:47], v[140:143], v[164:167], v[44:47]
    ds_read2_b32 v[74:75], v21 offset0:162 offset1:163
    v_mfma_f32_16x16x32_bf16 v[48:51], v[144:147], v[164:167], v[48:51]
    ds_read_b128 v[104:107], v27 offset:2048
    v_mfma_f32_16x16x32_bf16 v[48:51], v[140:143], v[168:171], v[48:51]
    v_mfma_f32_16x16x32_bf16 v[48:51], v[136:139], v[172:175], v[48:51]
    ds_read2_b32 v[76:77], v22 offset0:32 offset1:33
    s_waitcnt lgkmcnt(14)
    v_mfma_f32_16x16x32_bf16 v[48:51], v[132:135], v[176:179], v[48:51]
    ds_read2_b32 v[78:79], v22 offset0:34 offset1:35
    v_mfma_f32_16x16x32_bf16 v[52:55], v[132:135], v[180:183], v[52:55]
    ds_read_b128 v[108:111], v27 offset:4096
    v_mfma_f32_16x16x32_bf16 v[52:55], v[136:139], v[176:179], v[52:55]
    v_mfma_f32_16x16x32_bf16 v[52:55], v[140:143], v[172:175], v[52:55]
    ds_read2_b32 v[80:81], v22 offset0:160 offset1:161
    v_mfma_f32_16x16x32_bf16 v[52:55], v[144:147], v[168:171], v[52:55]
    ds_read2_b32 v[82:83], v22 offset0:162 offset1:163
    v_mfma_f32_16x16x32_bf16 v[52:55], v[148:151], v[164:167], v[52:55]
    ds_read_b128 v[112:115], v27 offset:6144
    v_mfma_f32_16x16x32_bf16 v[56:59], v[152:155], v[164:167], v[56:59]
    v_mfma_f32_16x16x32_bf16 v[56:59], v[148:151], v[168:171], v[56:59]
    ds_read2_b32 v[84:85], v23 offset0:32 offset1:33
    v_mfma_f32_16x16x32_bf16 v[56:59], v[144:147], v[172:175], v[56:59]
    ds_read2_b32 v[86:87], v23 offset0:34 offset1:35
    v_mfma_f32_16x16x32_bf16 v[56:59], v[140:143], v[176:179], v[56:59]
    ds_read_b128 v[116:119], v27 offset:8192
    v_mfma_f32_16x16x32_bf16 v[56:59], v[136:139], v[180:183], v[56:59]
    s_waitcnt lgkmcnt(14)
    v_mfma_f32_16x16x32_bf16 v[56:59], v[132:135], v[184:187], v[56:59]
    ds_read2_b32 v[88:89], v23 offset0:160 offset1:161
    v_mfma_f32_16x16x32_bf16 v[60:63], v[132:135], v[188:191], v[60:63]
    ds_read2_b32 v[90:91], v23 offset0:162 offset1:163
    v_mfma_f32_16x16x32_bf16 v[60:63], v[136:139], v[184:187], v[60:63]
    ds_read_b128 v[120:123], v27 offset:10240
    v_mfma_f32_16x16x32_bf16 v[60:63], v[140:143], v[180:183], v[60:63]
    v_mfma_f32_16x16x32_bf16 v[60:63], v[144:147], v[176:179], v[60:63]
    ds_read2_b32 v[92:93], v24 offset0:32 offset1:33
    v_mfma_f32_16x16x32_bf16 v[60:63], v[148:151], v[172:175], v[60:63]
    ds_read2_b32 v[94:95], v24 offset0:34 offset1:35
    v_mfma_f32_16x16x32_bf16 v[60:63], v[152:155], v[168:171], v[60:63]
    ds_read_b128 v[124:127], v27 offset:12288
    v_mfma_f32_16x16x32_bf16 v[60:63], v[156:159], v[164:167], v[60:63]
    v_mfma_f32_16x16x32_bf16 v[64:67], v[160:163], v[164:167], v[64:67]
    ds_read2_b32 v[96:97], v24 offset0:160 offset1:161
    v_mfma_f32_16x16x32_bf16 v[64:67], v[156:159], v[168:171], v[64:67]
    ds_read2_b32 v[98:99], v24 offset0:162 offset1:163
    v_mfma_f32_16x16x32_bf16 v[64:67], v[152:155], v[172:175], v[64:67]
    ds_read_b128 v[128:131], v27 offset:14336
    v_mfma_f32_16x16x32_bf16 v[64:67], v[148:151], v[176:179], v[64:67]
    v_mfma_f32_16x16x32_bf16 v[64:67], v[144:147], v[180:183], v[64:67]
    v_mfma_f32_16x16x32_bf16 v[64:67], v[140:143], v[184:187], v[64:67]
    v_mfma_f32_16x16x32_bf16 v[64:67], v[136:139], v[188:191], v[64:67]
    v_mfma_f32_16x16x32_bf16 v[64:67], v[132:135], v[192:195], v[64:67]
    s_waitcnt lgkmcnt(14)
    v_mfma_f32_16x16x32_bf16 v[36:39], v[68:71], v[100:103], v[36:39]
    ds_read2_b32 v[132:133], v21 offset0:48 offset1:49
    v_mfma_f32_16x16x32_bf16 v[40:43], v[72:75], v[100:103], v[40:43]
    ds_read2_b32 v[134:135], v21 offset0:50 offset1:51
    v_mfma_f32_16x16x32_bf16 v[40:43], v[68:71], v[104:107], v[40:43]
    ds_read_b128 v[164:167], v28 offset:0
    v_mfma_f32_16x16x32_bf16 v[44:47], v[68:71], v[108:111], v[44:47]
    v_mfma_f32_16x16x32_bf16 v[44:47], v[72:75], v[104:107], v[44:47]
    ds_read2_b32 v[136:137], v21 offset0:176 offset1:177
    v_mfma_f32_16x16x32_bf16 v[44:47], v[76:79], v[100:103], v[44:47]
    ds_read2_b32 v[138:139], v21 offset0:178 offset1:179
    s_waitcnt lgkmcnt(14)
    v_mfma_f32_16x16x32_bf16 v[48:51], v[80:83], v[100:103], v[48:51]
    ds_read_b128 v[168:171], v28 offset:2048
    v_mfma_f32_16x16x32_bf16 v[48:51], v[76:79], v[104:107], v[48:51]
    v_mfma_f32_16x16x32_bf16 v[48:51], v[72:75], v[108:111], v[48:51]
    ds_read2_b32 v[140:141], v22 offset0:48 offset1:49
    v_mfma_f32_16x16x32_bf16 v[48:51], v[68:71], v[112:115], v[48:51]
    ds_read2_b32 v[142:143], v22 offset0:50 offset1:51
    v_mfma_f32_16x16x32_bf16 v[52:55], v[68:71], v[116:119], v[52:55]
    ds_read_b128 v[172:175], v28 offset:4096
    v_mfma_f32_16x16x32_bf16 v[52:55], v[72:75], v[112:115], v[52:55]
    v_mfma_f32_16x16x32_bf16 v[52:55], v[76:79], v[108:111], v[52:55]
    ds_read2_b32 v[144:145], v22 offset0:176 offset1:177
    v_mfma_f32_16x16x32_bf16 v[52:55], v[80:83], v[104:107], v[52:55]
    ds_read2_b32 v[146:147], v22 offset0:178 offset1:179
    v_mfma_f32_16x16x32_bf16 v[52:55], v[84:87], v[100:103], v[52:55]
    ds_read_b128 v[176:179], v28 offset:6144
    s_waitcnt lgkmcnt(14)
    v_mfma_f32_16x16x32_bf16 v[56:59], v[88:91], v[100:103], v[56:59]
    v_mfma_f32_16x16x32_bf16 v[56:59], v[84:87], v[104:107], v[56:59]
    ds_read2_b32 v[148:149], v23 offset0:48 offset1:49
    v_mfma_f32_16x16x32_bf16 v[56:59], v[80:83], v[108:111], v[56:59]
    ds_read2_b32 v[150:151], v23 offset0:50 offset1:51
    v_mfma_f32_16x16x32_bf16 v[56:59], v[76:79], v[112:115], v[56:59]
    ds_read_b128 v[180:183], v28 offset:8192
    v_mfma_f32_16x16x32_bf16 v[56:59], v[72:75], v[116:119], v[56:59]
    v_mfma_f32_16x16x32_bf16 v[56:59], v[68:71], v[120:123], v[56:59]
    ds_read2_b32 v[152:153], v23 offset0:176 offset1:177
    v_mfma_f32_16x16x32_bf16 v[60:63], v[68:71], v[124:127], v[60:63]
    ds_read2_b32 v[154:155], v23 offset0:178 offset1:179
    v_mfma_f32_16x16x32_bf16 v[60:63], v[72:75], v[120:123], v[60:63]
    ds_read_b128 v[184:187], v28 offset:10240
    v_mfma_f32_16x16x32_bf16 v[60:63], v[76:79], v[116:119], v[60:63]
    v_mfma_f32_16x16x32_bf16 v[60:63], v[80:83], v[112:115], v[60:63]
    ds_read2_b32 v[156:157], v24 offset0:48 offset1:49
    v_mfma_f32_16x16x32_bf16 v[60:63], v[84:87], v[108:111], v[60:63]
    ds_read2_b32 v[158:159], v24 offset0:50 offset1:51
    v_mfma_f32_16x16x32_bf16 v[60:63], v[88:91], v[104:107], v[60:63]
    ds_read_b128 v[188:191], v28 offset:12288
    v_mfma_f32_16x16x32_bf16 v[60:63], v[92:95], v[100:103], v[60:63]
    s_waitcnt lgkmcnt(14)
    v_mfma_f32_16x16x32_bf16 v[64:67], v[96:99], v[100:103], v[64:67]
    ds_read2_b32 v[160:161], v24 offset0:176 offset1:177
    v_mfma_f32_16x16x32_bf16 v[64:67], v[92:95], v[104:107], v[64:67]
    ds_read2_b32 v[162:163], v24 offset0:178 offset1:179
    v_mfma_f32_16x16x32_bf16 v[64:67], v[88:91], v[108:111], v[64:67]
    ds_read_b128 v[192:195], v28 offset:14336
    v_mfma_f32_16x16x32_bf16 v[64:67], v[84:87], v[112:115], v[64:67]
    v_mfma_f32_16x16x32_bf16 v[64:67], v[80:83], v[116:119], v[64:67]
    v_mfma_f32_16x16x32_bf16 v[64:67], v[76:79], v[120:123], v[64:67]
    v_mfma_f32_16x16x32_bf16 v[64:67], v[72:75], v[124:127], v[64:67]
    v_mfma_f32_16x16x32_bf16 v[64:67], v[68:71], v[128:131], v[64:67]
    v_mfma_f32_16x16x32_bf16 v[36:39], v[132:135], v[164:167], v[36:39]
    ds_read2_b32 v[68:69], v21 offset0:64 offset1:65
    v_mfma_f32_16x16x32_bf16 v[40:43], v[136:139], v[164:167], v[40:43]
    ds_read2_b32 v[70:71], v21 offset0:66 offset1:67
    v_mfma_f32_16x16x32_bf16 v[40:43], v[132:135], v[168:171], v[40:43]
    ds_read_b128 v[100:103], v29 offset:0
    s_waitcnt lgkmcnt(14)
    v_mfma_f32_16x16x32_bf16 v[44:47], v[132:135], v[172:175], v[44:47]
    v_mfma_f32_16x16x32_bf16 v[44:47], v[136:139], v[168:171], v[44:47]
    ds_read2_b32 v[72:73], v21 offset0:192 offset1:193
    v_mfma_f32_16x16x32_bf16 v[44:47], v[140:143], v[164:167], v[44:47]
    ds_read2_b32 v[74:75], v21 offset0:194 offset1:195
    v_mfma_f32_16x16x32_bf16 v[48:51], v[144:147], v[164:167], v[48:51]
    ds_read_b128 v[104:107], v29 offset:2048
    v_mfma_f32_16x16x32_bf16 v[48:51], v[140:143], v[168:171], v[48:51]
    v_mfma_f32_16x16x32_bf16 v[48:51], v[136:139], v[172:175], v[48:51]
    ds_read2_b32 v[76:77], v22 offset0:64 offset1:65
    v_mfma_f32_16x16x32_bf16 v[48:51], v[132:135], v[176:179], v[48:51]
    ds_read2_b32 v[78:79], v22 offset0:66 offset1:67
    s_waitcnt lgkmcnt(14)
    v_mfma_f32_16x16x32_bf16 v[52:55], v[132:135], v[180:183], v[52:55]
    ds_read_b128 v[108:111], v29 offset:4096
    v_mfma_f32_16x16x32_bf16 v[52:55], v[136:139], v[176:179], v[52:55]
    v_mfma_f32_16x16x32_bf16 v[52:55], v[140:143], v[172:175], v[52:55]
    ds_read2_b32 v[80:81], v22 offset0:192 offset1:193
    v_mfma_f32_16x16x32_bf16 v[52:55], v[144:147], v[168:171], v[52:55]
    ds_read2_b32 v[82:83], v22 offset0:194 offset1:195
    v_mfma_f32_16x16x32_bf16 v[52:55], v[148:151], v[164:167], v[52:55]
    ds_read_b128 v[112:115], v29 offset:6144
    v_mfma_f32_16x16x32_bf16 v[56:59], v[152:155], v[164:167], v[56:59]
    v_mfma_f32_16x16x32_bf16 v[56:59], v[148:151], v[168:171], v[56:59]
    ds_read2_b32 v[84:85], v23 offset0:64 offset1:65
    v_mfma_f32_16x16x32_bf16 v[56:59], v[144:147], v[172:175], v[56:59]
    ds_read2_b32 v[86:87], v23 offset0:66 offset1:67
    v_mfma_f32_16x16x32_bf16 v[56:59], v[140:143], v[176:179], v[56:59]
    ds_read_b128 v[116:119], v29 offset:8192
    v_mfma_f32_16x16x32_bf16 v[56:59], v[136:139], v[180:183], v[56:59]
    v_mfma_f32_16x16x32_bf16 v[56:59], v[132:135], v[184:187], v[56:59]
    ds_read2_b32 v[88:89], v23 offset0:192 offset1:193
    s_waitcnt lgkmcnt(14)
    v_mfma_f32_16x16x32_bf16 v[60:63], v[132:135], v[188:191], v[60:63]
    ds_read2_b32 v[90:91], v23 offset0:194 offset1:195
    v_mfma_f32_16x16x32_bf16 v[60:63], v[136:139], v[184:187], v[60:63]
    ds_read_b128 v[120:123], v29 offset:10240
    v_mfma_f32_16x16x32_bf16 v[60:63], v[140:143], v[180:183], v[60:63]
    v_mfma_f32_16x16x32_bf16 v[60:63], v[144:147], v[176:179], v[60:63]
    ds_read2_b32 v[92:93], v24 offset0:64 offset1:65
    v_mfma_f32_16x16x32_bf16 v[60:63], v[148:151], v[172:175], v[60:63]
    ds_read2_b32 v[94:95], v24 offset0:66 offset1:67
    v_mfma_f32_16x16x32_bf16 v[60:63], v[152:155], v[168:171], v[60:63]
    ds_read_b128 v[124:127], v29 offset:12288
    v_mfma_f32_16x16x32_bf16 v[60:63], v[156:159], v[164:167], v[60:63]
    v_mfma_f32_16x16x32_bf16 v[64:67], v[160:163], v[164:167], v[64:67]
    ds_read2_b32 v[96:97], v24 offset0:192 offset1:193
    v_mfma_f32_16x16x32_bf16 v[64:67], v[156:159], v[168:171], v[64:67]
    ds_read2_b32 v[98:99], v24 offset0:194 offset1:195
    v_mfma_f32_16x16x32_bf16 v[64:67], v[152:155], v[172:175], v[64:67]
    ds_read_b128 v[128:131], v29 offset:14336
    v_mfma_f32_16x16x32_bf16 v[64:67], v[148:151], v[176:179], v[64:67]
    v_mfma_f32_16x16x32_bf16 v[64:67], v[144:147], v[180:183], v[64:67]
    v_mfma_f32_16x16x32_bf16 v[64:67], v[140:143], v[184:187], v[64:67]
    v_mfma_f32_16x16x32_bf16 v[64:67], v[136:139], v[188:191], v[64:67]
    v_mfma_f32_16x16x32_bf16 v[64:67], v[132:135], v[192:195], v[64:67]
    s_waitcnt lgkmcnt(14)
    v_mfma_f32_16x16x32_bf16 v[36:39], v[68:71], v[100:103], v[36:39]
    ds_read2_b32 v[132:133], v21 offset0:80 offset1:81
    v_mfma_f32_16x16x32_bf16 v[40:43], v[72:75], v[100:103], v[40:43]
    ds_read2_b32 v[134:135], v21 offset0:82 offset1:83
    v_mfma_f32_16x16x32_bf16 v[40:43], v[68:71], v[104:107], v[40:43]
    ds_read_b128 v[164:167], v30 offset:0
    v_mfma_f32_16x16x32_bf16 v[44:47], v[68:71], v[108:111], v[44:47]
    v_mfma_f32_16x16x32_bf16 v[44:47], v[72:75], v[104:107], v[44:47]
    ds_read2_b32 v[136:137], v21 offset0:208 offset1:209
    v_mfma_f32_16x16x32_bf16 v[44:47], v[76:79], v[100:103], v[44:47]
    ds_read2_b32 v[138:139], v21 offset0:210 offset1:211
    s_waitcnt lgkmcnt(14)
    v_mfma_f32_16x16x32_bf16 v[48:51], v[80:83], v[100:103], v[48:51]
    ds_read_b128 v[168:171], v30 offset:2048
    v_mfma_f32_16x16x32_bf16 v[48:51], v[76:79], v[104:107], v[48:51]
    v_mfma_f32_16x16x32_bf16 v[48:51], v[72:75], v[108:111], v[48:51]
    ds_read2_b32 v[140:141], v22 offset0:80 offset1:81
    v_mfma_f32_16x16x32_bf16 v[48:51], v[68:71], v[112:115], v[48:51]
    ds_read2_b32 v[142:143], v22 offset0:82 offset1:83
    v_mfma_f32_16x16x32_bf16 v[52:55], v[68:71], v[116:119], v[52:55]
    ds_read_b128 v[172:175], v30 offset:4096
    v_mfma_f32_16x16x32_bf16 v[52:55], v[72:75], v[112:115], v[52:55]
    v_mfma_f32_16x16x32_bf16 v[52:55], v[76:79], v[108:111], v[52:55]
    ds_read2_b32 v[144:145], v22 offset0:208 offset1:209
    v_mfma_f32_16x16x32_bf16 v[52:55], v[80:83], v[104:107], v[52:55]
    ds_read2_b32 v[146:147], v22 offset0:210 offset1:211
    v_mfma_f32_16x16x32_bf16 v[52:55], v[84:87], v[100:103], v[52:55]
    ds_read_b128 v[176:179], v30 offset:6144
    s_waitcnt lgkmcnt(14)
    v_mfma_f32_16x16x32_bf16 v[56:59], v[88:91], v[100:103], v[56:59]
    v_mfma_f32_16x16x32_bf16 v[56:59], v[84:87], v[104:107], v[56:59]
    ds_read2_b32 v[148:149], v23 offset0:80 offset1:81
    v_mfma_f32_16x16x32_bf16 v[56:59], v[80:83], v[108:111], v[56:59]
    ds_read2_b32 v[150:151], v23 offset0:82 offset1:83
    v_mfma_f32_16x16x32_bf16 v[56:59], v[76:79], v[112:115], v[56:59]
    ds_read_b128 v[180:183], v30 offset:8192
    v_mfma_f32_16x16x32_bf16 v[56:59], v[72:75], v[116:119], v[56:59]
    v_mfma_f32_16x16x32_bf16 v[56:59], v[68:71], v[120:123], v[56:59]
    ds_read2_b32 v[152:153], v23 offset0:208 offset1:209
    v_mfma_f32_16x16x32_bf16 v[60:63], v[68:71], v[124:127], v[60:63]
    ds_read2_b32 v[154:155], v23 offset0:210 offset1:211
    v_mfma_f32_16x16x32_bf16 v[60:63], v[72:75], v[120:123], v[60:63]
    ds_read_b128 v[184:187], v30 offset:10240
    v_mfma_f32_16x16x32_bf16 v[60:63], v[76:79], v[116:119], v[60:63]
    v_mfma_f32_16x16x32_bf16 v[60:63], v[80:83], v[112:115], v[60:63]
    ds_read2_b32 v[156:157], v24 offset0:80 offset1:81
    v_mfma_f32_16x16x32_bf16 v[60:63], v[84:87], v[108:111], v[60:63]
    ds_read2_b32 v[158:159], v24 offset0:82 offset1:83
    v_mfma_f32_16x16x32_bf16 v[60:63], v[88:91], v[104:107], v[60:63]
    ds_read_b128 v[188:191], v30 offset:12288
    v_mfma_f32_16x16x32_bf16 v[60:63], v[92:95], v[100:103], v[60:63]
    s_waitcnt lgkmcnt(14)
    v_mfma_f32_16x16x32_bf16 v[64:67], v[96:99], v[100:103], v[64:67]
    ds_read2_b32 v[160:161], v24 offset0:208 offset1:209
    v_mfma_f32_16x16x32_bf16 v[64:67], v[92:95], v[104:107], v[64:67]
    ds_read2_b32 v[162:163], v24 offset0:210 offset1:211
    v_mfma_f32_16x16x32_bf16 v[64:67], v[88:91], v[108:111], v[64:67]
    ds_read_b128 v[192:195], v30 offset:14336
    v_mfma_f32_16x16x32_bf16 v[64:67], v[84:87], v[112:115], v[64:67]
    v_mfma_f32_16x16x32_bf16 v[64:67], v[80:83], v[116:119], v[64:67]
    v_mfma_f32_16x16x32_bf16 v[64:67], v[76:79], v[120:123], v[64:67]
    v_mfma_f32_16x16x32_bf16 v[64:67], v[72:75], v[124:127], v[64:67]
    v_mfma_f32_16x16x32_bf16 v[64:67], v[68:71], v[128:131], v[64:67]
    v_mfma_f32_16x16x32_bf16 v[36:39], v[132:135], v[164:167], v[36:39]
    ds_read2_b32 v[68:69], v21 offset0:96 offset1:97
    v_mfma_f32_16x16x32_bf16 v[40:43], v[136:139], v[164:167], v[40:43]
    ds_read2_b32 v[70:71], v21 offset0:98 offset1:99
    v_mfma_f32_16x16x32_bf16 v[40:43], v[132:135], v[168:171], v[40:43]
    ds_read_b128 v[100:103], v31 offset:0
    s_waitcnt lgkmcnt(14)
    v_mfma_f32_16x16x32_bf16 v[44:47], v[132:135], v[172:175], v[44:47]
    v_mfma_f32_16x16x32_bf16 v[44:47], v[136:139], v[168:171], v[44:47]
    ds_read2_b32 v[72:73], v21 offset0:224 offset1:225
    v_mfma_f32_16x16x32_bf16 v[44:47], v[140:143], v[164:167], v[44:47]
    ds_read2_b32 v[74:75], v21 offset0:226 offset1:227
    v_mfma_f32_16x16x32_bf16 v[48:51], v[144:147], v[164:167], v[48:51]
    ds_read_b128 v[104:107], v31 offset:2048
    v_mfma_f32_16x16x32_bf16 v[48:51], v[140:143], v[168:171], v[48:51]
    v_mfma_f32_16x16x32_bf16 v[48:51], v[136:139], v[172:175], v[48:51]
    ds_read2_b32 v[76:77], v22 offset0:96 offset1:97
    v_mfma_f32_16x16x32_bf16 v[48:51], v[132:135], v[176:179], v[48:51]
    ds_read2_b32 v[78:79], v22 offset0:98 offset1:99
    s_waitcnt lgkmcnt(14)
    v_mfma_f32_16x16x32_bf16 v[52:55], v[132:135], v[180:183], v[52:55]
    ds_read_b128 v[108:111], v31 offset:4096
    v_mfma_f32_16x16x32_bf16 v[52:55], v[136:139], v[176:179], v[52:55]
    v_mfma_f32_16x16x32_bf16 v[52:55], v[140:143], v[172:175], v[52:55]
    ds_read2_b32 v[80:81], v22 offset0:224 offset1:225
    v_mfma_f32_16x16x32_bf16 v[52:55], v[144:147], v[168:171], v[52:55]
    ds_read2_b32 v[82:83], v22 offset0:226 offset1:227
    v_mfma_f32_16x16x32_bf16 v[52:55], v[148:151], v[164:167], v[52:55]
    ds_read_b128 v[112:115], v31 offset:6144
    v_mfma_f32_16x16x32_bf16 v[56:59], v[152:155], v[164:167], v[56:59]
    v_mfma_f32_16x16x32_bf16 v[56:59], v[148:151], v[168:171], v[56:59]
    ds_read2_b32 v[84:85], v23 offset0:96 offset1:97
    v_mfma_f32_16x16x32_bf16 v[56:59], v[144:147], v[172:175], v[56:59]
    ds_read2_b32 v[86:87], v23 offset0:98 offset1:99
    v_mfma_f32_16x16x32_bf16 v[56:59], v[140:143], v[176:179], v[56:59]
    ds_read_b128 v[116:119], v31 offset:8192
    v_mfma_f32_16x16x32_bf16 v[56:59], v[136:139], v[180:183], v[56:59]
    v_mfma_f32_16x16x32_bf16 v[56:59], v[132:135], v[184:187], v[56:59]
    ds_read2_b32 v[88:89], v23 offset0:224 offset1:225
    s_waitcnt lgkmcnt(14)
    v_mfma_f32_16x16x32_bf16 v[60:63], v[132:135], v[188:191], v[60:63]
    ds_read2_b32 v[90:91], v23 offset0:226 offset1:227
    v_mfma_f32_16x16x32_bf16 v[60:63], v[136:139], v[184:187], v[60:63]
    ds_read_b128 v[120:123], v31 offset:10240
    v_mfma_f32_16x16x32_bf16 v[60:63], v[140:143], v[180:183], v[60:63]
    v_mfma_f32_16x16x32_bf16 v[60:63], v[144:147], v[176:179], v[60:63]
    ds_read2_b32 v[92:93], v24 offset0:96 offset1:97
    v_mfma_f32_16x16x32_bf16 v[60:63], v[148:151], v[172:175], v[60:63]
    ds_read2_b32 v[94:95], v24 offset0:98 offset1:99
    v_mfma_f32_16x16x32_bf16 v[60:63], v[152:155], v[168:171], v[60:63]
    ds_read_b128 v[124:127], v31 offset:12288
    v_mfma_f32_16x16x32_bf16 v[60:63], v[156:159], v[164:167], v[60:63]
    v_mfma_f32_16x16x32_bf16 v[64:67], v[160:163], v[164:167], v[64:67]
    ds_read2_b32 v[96:97], v24 offset0:224 offset1:225
    v_mfma_f32_16x16x32_bf16 v[64:67], v[156:159], v[168:171], v[64:67]
    ds_read2_b32 v[98:99], v24 offset0:226 offset1:227
    v_mfma_f32_16x16x32_bf16 v[64:67], v[152:155], v[172:175], v[64:67]
    ds_read_b128 v[128:131], v31 offset:14336
    v_mfma_f32_16x16x32_bf16 v[64:67], v[148:151], v[176:179], v[64:67]
    v_mfma_f32_16x16x32_bf16 v[64:67], v[144:147], v[180:183], v[64:67]
    v_mfma_f32_16x16x32_bf16 v[64:67], v[140:143], v[184:187], v[64:67]
    v_mfma_f32_16x16x32_bf16 v[64:67], v[136:139], v[188:191], v[64:67]
    v_mfma_f32_16x16x32_bf16 v[64:67], v[132:135], v[192:195], v[64:67]
    s_waitcnt lgkmcnt(14)
    v_mfma_f32_16x16x32_bf16 v[36:39], v[68:71], v[100:103], v[36:39]
    ds_read2_b32 v[132:133], v21 offset0:112 offset1:113
    v_mfma_f32_16x16x32_bf16 v[40:43], v[72:75], v[100:103], v[40:43]
    ds_read2_b32 v[134:135], v21 offset0:114 offset1:115
    v_mfma_f32_16x16x32_bf16 v[40:43], v[68:71], v[104:107], v[40:43]
    ds_read_b128 v[164:167], v32 offset:0
    v_mfma_f32_16x16x32_bf16 v[44:47], v[68:71], v[108:111], v[44:47]
    v_mfma_f32_16x16x32_bf16 v[44:47], v[72:75], v[104:107], v[44:47]
    ds_read2_b32 v[136:137], v21 offset0:240 offset1:241
    v_mfma_f32_16x16x32_bf16 v[44:47], v[76:79], v[100:103], v[44:47]
    ds_read2_b32 v[138:139], v21 offset0:242 offset1:243
    s_waitcnt lgkmcnt(14)
    v_mfma_f32_16x16x32_bf16 v[48:51], v[80:83], v[100:103], v[48:51]
    ds_read_b128 v[168:171], v32 offset:2048
    v_mfma_f32_16x16x32_bf16 v[48:51], v[76:79], v[104:107], v[48:51]
    v_mfma_f32_16x16x32_bf16 v[48:51], v[72:75], v[108:111], v[48:51]
    ds_read2_b32 v[140:141], v22 offset0:112 offset1:113
    v_mfma_f32_16x16x32_bf16 v[48:51], v[68:71], v[112:115], v[48:51]
    ds_read2_b32 v[142:143], v22 offset0:114 offset1:115
    v_mfma_f32_16x16x32_bf16 v[52:55], v[68:71], v[116:119], v[52:55]
    ds_read_b128 v[172:175], v32 offset:4096
    v_mfma_f32_16x16x32_bf16 v[52:55], v[72:75], v[112:115], v[52:55]
    v_mfma_f32_16x16x32_bf16 v[52:55], v[76:79], v[108:111], v[52:55]
    ds_read2_b32 v[144:145], v22 offset0:240 offset1:241
    v_mfma_f32_16x16x32_bf16 v[52:55], v[80:83], v[104:107], v[52:55]
    ds_read2_b32 v[146:147], v22 offset0:242 offset1:243
    v_mfma_f32_16x16x32_bf16 v[52:55], v[84:87], v[100:103], v[52:55]
    ds_read_b128 v[176:179], v32 offset:6144
    s_waitcnt lgkmcnt(14)
    v_mfma_f32_16x16x32_bf16 v[56:59], v[88:91], v[100:103], v[56:59]
    v_mfma_f32_16x16x32_bf16 v[56:59], v[84:87], v[104:107], v[56:59]
    ds_read2_b32 v[148:149], v23 offset0:112 offset1:113
    v_mfma_f32_16x16x32_bf16 v[56:59], v[80:83], v[108:111], v[56:59]
    ds_read2_b32 v[150:151], v23 offset0:114 offset1:115
    v_mfma_f32_16x16x32_bf16 v[56:59], v[76:79], v[112:115], v[56:59]
    ds_read_b128 v[180:183], v32 offset:8192
    v_mfma_f32_16x16x32_bf16 v[56:59], v[72:75], v[116:119], v[56:59]
    v_mfma_f32_16x16x32_bf16 v[56:59], v[68:71], v[120:123], v[56:59]
    ds_read2_b32 v[152:153], v23 offset0:240 offset1:241
    v_mfma_f32_16x16x32_bf16 v[60:63], v[68:71], v[124:127], v[60:63]
    ds_read2_b32 v[154:155], v23 offset0:242 offset1:243
    v_mfma_f32_16x16x32_bf16 v[60:63], v[72:75], v[120:123], v[60:63]
    ds_read_b128 v[184:187], v32 offset:10240
    v_mfma_f32_16x16x32_bf16 v[60:63], v[76:79], v[116:119], v[60:63]
    v_mfma_f32_16x16x32_bf16 v[60:63], v[80:83], v[112:115], v[60:63]
    ds_read2_b32 v[156:157], v24 offset0:112 offset1:113
    v_mfma_f32_16x16x32_bf16 v[60:63], v[84:87], v[108:111], v[60:63]
    ds_read2_b32 v[158:159], v24 offset0:114 offset1:115
    v_mfma_f32_16x16x32_bf16 v[60:63], v[88:91], v[104:107], v[60:63]
    ds_read_b128 v[188:191], v32 offset:12288
    v_mfma_f32_16x16x32_bf16 v[60:63], v[92:95], v[100:103], v[60:63]
    s_waitcnt lgkmcnt(14)
    v_mfma_f32_16x16x32_bf16 v[64:67], v[96:99], v[100:103], v[64:67]
    ds_read2_b32 v[160:161], v24 offset0:240 offset1:241
    v_mfma_f32_16x16x32_bf16 v[64:67], v[92:95], v[104:107], v[64:67]
    ds_read2_b32 v[162:163], v24 offset0:242 offset1:243
    v_mfma_f32_16x16x32_bf16 v[64:67], v[88:91], v[108:111], v[64:67]
    ds_read_b128 v[192:195], v32 offset:14336
    v_mfma_f32_16x16x32_bf16 v[64:67], v[84:87], v[112:115], v[64:67]
    v_mfma_f32_16x16x32_bf16 v[64:67], v[80:83], v[116:119], v[64:67]
    v_mfma_f32_16x16x32_bf16 v[64:67], v[76:79], v[120:123], v[64:67]
    v_mfma_f32_16x16x32_bf16 v[64:67], v[72:75], v[124:127], v[64:67]
    v_mfma_f32_16x16x32_bf16 v[64:67], v[68:71], v[128:131], v[64:67]
    v_mfma_f32_16x16x32_bf16 v[36:39], v[132:135], v[164:167], v[36:39]
    v_mfma_f32_16x16x32_bf16 v[40:43], v[136:139], v[164:167], v[40:43]
    v_mfma_f32_16x16x32_bf16 v[40:43], v[132:135], v[168:171], v[40:43]
    s_waitcnt lgkmcnt(14)
    v_mfma_f32_16x16x32_bf16 v[44:47], v[132:135], v[172:175], v[44:47]
    v_mfma_f32_16x16x32_bf16 v[44:47], v[136:139], v[168:171], v[44:47]
    v_mfma_f32_16x16x32_bf16 v[44:47], v[140:143], v[164:167], v[44:47]
    s_waitcnt lgkmcnt(13)
    v_mfma_f32_16x16x32_bf16 v[48:51], v[144:147], v[164:167], v[48:51]
    v_mfma_f32_16x16x32_bf16 v[48:51], v[140:143], v[168:171], v[48:51]
    s_waitcnt lgkmcnt(0)
    v_cvt_pk_bf16_f32 v68, v39, v38
    v_cvt_pk_bf16_f32 v69, v37, v36
    v_mfma_f32_16x16x32_bf16 v[48:51], v[136:139], v[172:175], v[48:51]
    ds_write_b64 v20, v[68:69] offset:0
    v_cvt_pk_bf16_f32 v70, v43, v42
    v_mfma_f32_16x16x32_bf16 v[48:51], v[132:135], v[176:179], v[48:51]
    v_cvt_pk_bf16_f32 v71, v41, v40
    ds_write_b64 v20, v[70:71] offset:2048
    v_mfma_f32_16x16x32_bf16 v[52:55], v[132:135], v[180:183], v[52:55]
    v_mfma_f32_16x16x32_bf16 v[52:55], v[136:139], v[176:179], v[52:55]
    v_cvt_pk_bf16_f32 v72, v47, v46
    v_cvt_pk_bf16_f32 v73, v45, v44
    v_mfma_f32_16x16x32_bf16 v[52:55], v[140:143], v[172:175], v[52:55]
    ds_write_b64 v20, v[72:73] offset:4096
    v_mfma_f32_16x16x32_bf16 v[52:55], v[144:147], v[168:171], v[52:55]
    v_mfma_f32_16x16x32_bf16 v[52:55], v[148:151], v[164:167], v[52:55]
    v_mfma_f32_16x16x32_bf16 v[56:59], v[152:155], v[164:167], v[56:59]
    v_cvt_pk_bf16_f32 v74, v51, v50
    v_cvt_pk_bf16_f32 v75, v49, v48
    v_mfma_f32_16x16x32_bf16 v[56:59], v[148:151], v[168:171], v[56:59]
    ds_write_b64 v20, v[74:75] offset:6144
    v_mfma_f32_16x16x32_bf16 v[56:59], v[144:147], v[172:175], v[56:59]
    v_mfma_f32_16x16x32_bf16 v[56:59], v[140:143], v[176:179], v[56:59]
    v_mfma_f32_16x16x32_bf16 v[56:59], v[136:139], v[180:183], v[56:59]
    v_mfma_f32_16x16x32_bf16 v[56:59], v[132:135], v[184:187], v[56:59]
    v_cvt_pk_bf16_f32 v76, v55, v54
    v_cvt_pk_bf16_f32 v77, v53, v52
    v_mfma_f32_16x16x32_bf16 v[60:63], v[132:135], v[188:191], v[60:63]
    ds_write_b64 v20, v[76:77] offset:8192
    v_mfma_f32_16x16x32_bf16 v[60:63], v[136:139], v[184:187], v[60:63]
    v_mfma_f32_16x16x32_bf16 v[60:63], v[140:143], v[180:183], v[60:63]
    v_mfma_f32_16x16x32_bf16 v[60:63], v[144:147], v[176:179], v[60:63]
    v_mfma_f32_16x16x32_bf16 v[60:63], v[148:151], v[172:175], v[60:63]
    v_mfma_f32_16x16x32_bf16 v[60:63], v[152:155], v[168:171], v[60:63]
    v_cvt_pk_bf16_f32 v78, v59, v58
    v_cvt_pk_bf16_f32 v79, v57, v56
    v_mfma_f32_16x16x32_bf16 v[60:63], v[156:159], v[164:167], v[60:63]
    ds_write_b64 v20, v[78:79] offset:10240
    v_mfma_f32_16x16x32_bf16 v[64:67], v[160:163], v[164:167], v[64:67]
    v_mfma_f32_16x16x32_bf16 v[64:67], v[156:159], v[168:171], v[64:67]
    v_mfma_f32_16x16x32_bf16 v[64:67], v[152:155], v[172:175], v[64:67]
    v_mfma_f32_16x16x32_bf16 v[64:67], v[148:151], v[176:179], v[64:67]
    v_mfma_f32_16x16x32_bf16 v[64:67], v[144:147], v[180:183], v[64:67]
    v_mfma_f32_16x16x32_bf16 v[64:67], v[140:143], v[184:187], v[64:67]
    s_nop 0
    v_cvt_pk_bf16_f32 v80, v63, v62
    v_cvt_pk_bf16_f32 v81, v61, v60
    v_mfma_f32_16x16x32_bf16 v[64:67], v[136:139], v[188:191], v[64:67]
    ds_write_b64 v20, v[80:81] offset:12288
    v_mfma_f32_16x16x32_bf16 v[64:67], v[132:135], v[192:195], v[64:67]
    s_nop 7
    v_cvt_pk_bf16_f32 v82, v67, v66
    v_cvt_pk_bf16_f32 v83, v65, v64
    ds_write_b64 v20, v[82:83] offset:14336
    s_mov_b64 exec, 1
    ds_add_u32 v18, v19 offset:12
    s_mov_b64 exec, -1
    s_add_u32 s80, s86, 94208
    v_add_u32 v5, s80, v15
    s_branch LA_s3_in
LA_s3:
    s_sleep 1
LA_s3_in:
    ds_read_b32 v6, v18 offset:12
    ds_read_b128 v[84:87], v5 offset:0
    ds_read_b128 v[88:91], v5 offset:4096
    ds_read_b128 v[92:95], v5 offset:8192
    ds_read_b128 v[96:99], v5 offset:12288
    s_waitcnt lgkmcnt(0)
    v_readfirstlane_b32 s78, v6
    s_nop 0
    s_cmp_ge_u32 s78, 4
    s_cbranch_scc0 LA_s3
    s_add_u32 s89, s91, 4194304
    buffer_store_dwordx4 v[84:87], v14, s[52:55], s89 offen sc1
    s_add_u32 s89, s91, 4198400
    buffer_store_dwordx4 v[88:91], v14, s[52:55], s89 offen sc1
    s_add_u32 s89, s91, 4202496
    buffer_store_dwordx4 v[92:95], v14, s[52:55], s89 offen sc1
    s_add_u32 s89, s91, 4206592
    buffer_store_dwordx4 v[96:99], v14, s[52:55], s89 offen sc1
    s_add_u32 s80, s86, 129024
    v_add_u32 v5, s80, v15
    s_waitcnt vmcnt(9)
    ds_write_b128 v5, v[228:231] offset:0
    s_waitcnt vmcnt(8)
    ds_write_b128 v5, v[232:235] offset:4096
    s_waitcnt vmcnt(7)
    ds_write_b128 v5, v[240:243] offset:8192
    s_waitcnt vmcnt(6)
    ds_write_b128 v5, v[244:247] offset:12288
    s_waitcnt vmcnt(5)
    ds_write_b128 v5, v[248:251] offset:16384
    s_waitcnt vmcnt(4)
    ds_write_b128 v5, v[196:199] offset:20480
    s_mov_b64 exec, 1
    ds_add_u32 v18, v19 offset:32
    s_mov_b64 exec, -1
    s_setprio 0
    s_mov_b32 s60, s22
    s_mov_b32 s61, s23
    s_mov_b32 s62, 0x800000
    s_mov_b32 s63, 0x20000
    s_lshr_b32 s81, s91, 4
    s_lshl_b32 s82, s3, 8
    s_add_u32 s81, s81, s82
    s_add_u32 s81, s81, 12648448
    s_lshl_b32 s80, s74, 14
    s_and_b32 s82, s75, 3
    s_lshl_b32 s82, s82, 8
    s_add_u32 s80, s80, s82
    s_add_u32 s80, s80, 12648448
    v_mov_b32 v5, 0
    v_lshlrev_b32 v7, 10, v0
    v_lshlrev_b32 v132, 16, v212
    v_and_b32 v133, 0xffff0000, v212
    v_lshlrev_b32 v134, 16, v213
    v_and_b32 v135, 0xffff0000, v213
    v_lshlrev_b32 v136, 16, v214
    v_and_b32 v137, 0xffff0000, v214
    v_lshlrev_b32 v138, 16, v215
    v_and_b32 v139, 0xffff0000, v215
    v_lshlrev_b32 v140, 16, v216
    v_and_b32 v141, 0xffff0000, v216
    v_lshlrev_b32 v142, 16, v217
    v_and_b32 v143, 0xffff0000, v217
    v_lshlrev_b32 v144, 16, v218
    v_and_b32 v145, 0xffff0000, v218
    v_lshlrev_b32 v146, 16, v219
    v_and_b32 v147, 0xffff0000, v219
    v_lshlrev_b32 v148, 16, v220
    v_and_b32 v149, 0xffff0000, v220
    v_lshlrev_b32 v150, 16, v221
    v_and_b32 v151, 0xffff0000, v221
    v_lshlrev_b32 v152, 16, v222
    v_and_b32 v153, 0xffff0000, v222
    v_lshlrev_b32 v154, 16, v223
    v_and_b32 v155, 0xffff0000, v223
    v_lshlrev_b32 v156, 16, v224
    v_and_b32 v157, 0xffff0000, v224
    v_lshlrev_b32 v158, 16, v225
    v_and_b32 v159, 0xffff0000, v225
    v_lshlrev_b32 v160, 16, v226
    v_and_b32 v161, 0xffff0000, v226
    v_lshlrev_b32 v162, 16, v227
    v_and_b32 v163, 0xffff0000, v227
    s_waitcnt vmcnt(0)
    s_mov_b64 exec, 1
    buffer_store_dword v19, v5, s[52:55], s81 offen sc1
    s_mov_b64 exec, 0xffff
    s_waitcnt vmcnt(0)
    s_branch LA_s7a_in
LA_s7a:
    s_sleep 1
LA_s7a_in:
    ds_read_b32 v6, v18 offset:28
    s_waitcnt lgkmcnt(0)
    v_readfirstlane_b32 s78, v6
    s_nop 0
    s_cmp_ge_u32 s78, 4
    s_cbranch_scc0 LA_s7a
    s_setprio 2
    s_mov_b32 s79, 0
LA_py:
    buffer_load_dword v6, v7, s[52:55], s80 offen sc1
    s_add_u32 s79, s79, 1
    s_cmp_gt_u32 s79, 200000
    s_cbranch_scc1 LA_py_x
    s_waitcnt vmcnt(0)
    v_cmp_ne_u32 vcc, 1, v6
    s_cbranch_vccz LA_py_x
    s_mov_b64 exec, vcc
    s_sleep 8
    s_branch LA_py
LA_py_x:
    s_waitcnt vmcnt(0)
    s_mov_b64 exec, -1
    s_mov_b32 s89, 4194304
    buffer_load_dwordx4 v[100:103], v12, s[52:55], s89 offen sc1
    s_mov_b32 s89, 4210688
    buffer_load_dwordx4 v[104:107], v12, s[52:55], s89 offen sc1
    s_mov_b32 s89, 4227072
    buffer_load_dwordx4 v[108:111], v12, s[52:55], s89 offen sc1
    s_mov_b32 s89, 4243456
    buffer_load_dwordx4 v[112:115], v12, s[52:55], s89 offen sc1
    s_waitcnt vmcnt(3)
    v_permlane32_swap_b32 v102, v100
    v_permlane32_swap_b32 v103, v101
    s_waitcnt vmcnt(2)
    v_permlane32_swap_b32 v106, v104
    v_permlane32_swap_b32 v107, v105
    s_waitcnt vmcnt(1)
    v_permlane32_swap_b32 v110, v108
    v_permlane32_swap_b32 v111, v109
    s_waitcnt vmcnt(0)
    v_permlane32_swap_b32 v114, v112
    v_permlane32_swap_b32 v115, v113
    v_and_b32 v68, 0xffff0000, v103
    v_and_b32 v69, 0xffff0000, v107
    v_and_b32 v70, 0xffff0000, v111
    v_and_b32 v71, 0xffff0000, v115
    v_and_b32 v72, 0xffff0000, v101
    v_and_b32 v73, 0xffff0000, v105
    v_and_b32 v74, 0xffff0000, v109
    v_and_b32 v75, 0xffff0000, v113
    v_mul_f32 v68, v68, v132
    v_mul_f32 v69, v69, v133
    v_mul_f32 v70, v70, v134
    v_mul_f32 v71, v71, v135
    v_mul_f32 v72, v72, v136
    v_mul_f32 v73, v73, v137
    v_mul_f32 v74, v74, v138
    v_mul_f32 v75, v75, v139
    v_cvt_pk_bf16_f32 v36, v68, v69
    v_cvt_pk_bf16_f32 v37, v70, v71
    v_cvt_pk_bf16_f32 v38, v72, v73
    v_cvt_pk_bf16_f32 v39, v74, v75
    s_mov_b32 s89, 0
    buffer_store_dwordx4 v[36:39], v13, s[60:63], s89 offen nt sc1
    v_lshlrev_b32 v68, 16, v103
    v_lshlrev_b32 v69, 16, v107
    v_lshlrev_b32 v70, 16, v111
    v_lshlrev_b32 v71, 16, v115
    v_lshlrev_b32 v72, 16, v101
    v_lshlrev_b32 v73, 16, v105
    v_lshlrev_b32 v74, 16, v109
    v_lshlrev_b32 v75, 16, v113
    v_mul_f32 v68, v68, v140
    v_mul_f32 v69, v69, v141
    v_mul_f32 v70, v70, v142
    v_mul_f32 v71, v71, v143
    v_mul_f32 v72, v72, v144
    v_mul_f32 v73, v73, v145
    v_mul_f32 v74, v74, v146
    v_mul_f32 v75, v75, v147
    v_cvt_pk_bf16_f32 v40, v68, v69
    v_cvt_pk_bf16_f32 v41, v70, v71
    v_cvt_pk_bf16_f32 v42, v72, v73
    v_cvt_pk_bf16_f32 v43, v74, v75
    s_mov_b32 s89, 4096
    buffer_store_dwordx4 v[40:43], v13, s[60:63], s89 offen nt sc1
    v_and_b32 v68, 0xffff0000, v102
    v_and_b32 v69, 0xffff0000, v106
    v_and_b32 v70, 0xffff0000, v110
    v_and_b32 v71, 0xffff0000, v114
    v_and_b32 v72, 0xffff0000, v100
    v_and_b32 v73, 0xffff0000, v104
    v_and_b32 v74, 0xffff0000, v108
    v_and_b32 v75, 0xffff0000, v112
    v_mul_f32 v68, v68, v148
    v_mul_f32 v69, v69, v149
    v_mul_f32 v70, v70, v150
    v_mul_f32 v71, v71, v151
    v_mul_f32 v72, v72, v152
    v_mul_f32 v73, v73, v153
    v_mul_f32 v74, v74, v154
    v_mul_f32 v75, v75, v155
    v_cvt_pk_bf16_f32 v44, v68, v69
    v_cvt_pk_bf16_f32 v45, v70, v71
    v_cvt_pk_bf16_f32 v46, v72, v73
    v_cvt_pk_bf16_f32 v47, v74, v75
    s_mov_b32 s89, 8192
    buffer_store_dwordx4 v[44:47], v13, s[60:63], s89 offen nt sc1
    v_lshlrev_b32 v68, 16, v102
    v_lshlrev_b32 v69, 16, v106
    v_lshlrev_b32 v70, 16, v110
    v_lshlrev_b32 v71, 16, v114
    v_lshlrev_b32 v72, 16, v100
    v_lshlrev_b32 v73, 16, v104
    v_lshlrev_b32 v74, 16, v108
    v_lshlrev_b32 v75, 16, v112
    v_mul_f32 v68, v68, v156
    v_mul_f32 v69, v69, v157
    v_mul_f32 v70, v70, v158
    v_mul_f32 v71, v71, v159
    v_mul_f32 v72, v72, v160
    v_mul_f32 v73, v73, v161
    v_mul_f32 v74, v74, v162
    v_mul_f32 v75, v75, v163
    v_cvt_pk_bf16_f32 v48, v68, v69
    v_cvt_pk_bf16_f32 v49, v70, v71
    v_cvt_pk_bf16_f32 v50, v72, v73
    v_cvt_pk_bf16_f32 v51, v74, v75
    s_mov_b32 s89, 12288
    buffer_store_dwordx4 v[48:51], v13, s[60:63], s89 offen nt sc1
    s_endpgm
L_B:
    s_setprio 3
    s_and_b32 s3, s3, 3
    s_add_u32 s79, s72, s73
    s_add_u32 s78, s72, 5
    s_and_b32 s78, s78, 7
    s_lshl_b32 s78, s78, 1
    s_and_b32 s75, s79, 1
    s_add_u32 s78, s78, s75
    s_andn2_b32 s79, 2, s79
    s_lshl_b32 s79, s79, 3
    s_add_u32 s78, s78, s79
    s_and_b32 s76, s78, 3
    s_and_b32 s79, s73, 12
    s_add_u32 s76, s76, s79
    s_lshr_b32 s74, s78, 4
    s_add_u32 s74, s74, s79
    s_and_b32 s79, s72, 8
    s_lshr_b32 s77, s78, 2
    s_add_u32 s77, s77, s79
    s_lshr_b32 s79, s79, 2
    s_add_u32 s74, s74, s79
    s_xor_b32 s74, s74, 4
    s_and_b32 s75, s78, 15
    s_lshr_b32 s86, s3, 1
    s_and_b32 s87, s3, 1
    v_mov_b32 v10, 162304
    v_mov_b32 v11, 1
    v_lshlrev_b32 v12, 4, v0
    v_lshl_add_u32 v13, v0, 2, v10
    v_mov_b32 v14, 0
    ds_write_b32 v13, v14
    s_lshl_b32 s78, s74, 4
    s_add_u32 s78, s78, s75
    s_lshl_b32 s96, s78, 8
    s_add_u32 s96, s96, 12582912
    s_lshl_b32 s78, s78, 2
    s_add_u32 s78, s78, s3
    s_lshl_b32 s78, s78, 8
    s_add_u32 s80, s78, 12648448
    s_lshl_b32 s81, s72, 1
    s_add_u32 s81, s81, s86
    s_lshl_b32 s97, s81, 4
    s_add_u32 s97, s97, s73
    s_lshl_b32 s97, s97, 8
    s_add_u32 s97, s97, 12910464
    v_mov_b32 v15, s80
    v_mov_b32 v223, s97
    v_cmp_gt_u32 vcc, 8, v0
    s_nop 1
    v_cndmask_b32 v15, v223, v15, vcc
    v_add_u32 v221, v15, v12
    s_lshl_b32 s78, s87, 2
    s_add_u32 s78, s78, 128
    s_add_u32 s97, s97, s78
    s_lshl_b32 s82, s73, 1
    s_add_u32 s82, s82, s87
    s_lshl_b32 s78, s81, 7
    s_add_u32 s78, s78, s82
    s_lshl_b32 s94, s78, 10
    s_add_u32 s94, s94, 8388608
    v_mov_b32 v212, 0
    v_mov_b32 v213, 0
    v_mov_b32 v214, 0
    v_mov_b32 v215, 0
    v_mov_b32 v220, 0
    s_waitcnt lgkmcnt(0)
    s_mov_b32 s52, s26
    s_mov_b32 s53, s27
    s_mov_b32 s54, 0x1000000
    s_mov_b32 s55, 0x20000
    s_mov_b32 s68, s24
    s_mov_b32 s69, s25
    s_mov_b32 s70, 0x100
    s_mov_b32 s71, 0x20000
    s_lshl_b32 s98, s74, 4
    s_or_b32 s78, s75, s3
    s_cmp_lg_u32 s78, 0
    s_cbranch_scc1 LB_notag
    s_mov_b64 exec, 0xffff
    v_lshlrev_b32 v15, 8, v0
    buffer_load_dword v251, v15, s[52:55], s96 offen sc1
LB_notag:
    s_lshl_b32 s78, s87, 3
    s_lshr_b32 exec_lo, 0xffff, s78
    s_mov_b32 exec_hi, 0
    buffer_store_dwordx4 v[212:215], v221, s[52:55], 0 offen sc1
    s_mov_b64 exec, -1
    v_and_b32 v13, 15, v0
    v_lshrrev_b32 v14, 4, v0
    v_lshrrev_b32 v15, 1, v13
    v_xor_b32 v15, v15, v14
    v_lshlrev_b32 v15, 4, v15
    v_lshl_add_u32 v15, v13, 7, v15
    v_add_u32 v2, 73728, v15
    v_xor_b32 v3, 64, v2
    s_lshl_b32 s78, s86, 13
    s_add_u32 s78, s78, 2048
    v_add_u32 v4, s78, v2
    v_add_u32 v5, s78, v3
    v_bfe_u32 v15, v0, 3, 2
    s_lshl_b32 s78, s87, 1
    s_add_u32 s78, s78, s86
    v_xor_b32 v15, s78, v15
    v_lshlrev_b32 v15, 5, v15
    v_and_b32 v223, 3, v0
    v_lshl_add_u32 v15, v223, 3, v15
    v_bfe_u32 v223, v0, 2, 2
    v_lshl_add_u32 v15, v223, 7, v15
    v_mul_u32_u24 v223, 3072, v14
    v_add_u32 v6, v223, v15
    v_xor_b32 v7, 32, v6
    s_mov_b32 s60, s22
    s_mov_b32 s61, s23
    s_mov_b32 s62, 0x800000
    s_mov_b32 s63, 0x20000
    v_and_b32 v15, 1, v13
    v_cmp_eq_u32 s[88:89], 1, v15
    v_lshl_add_u32 v15, v14, 2, v15
    v_cmp_le_u32 s[90:91], v15, v13
    v_add_u32 v15, 2, v15
    v_cmp_le_u32 s[92:93], v15, v13
    v_mov_b32 v212, 0x0c0c0c0c
    v_mov_b32 v15, 0xc0c0100
    v_mov_b32 v223, 0x1000c0c
    v_cndmask_b32 v15, v15, v223, s[88:89]
    v_cndmask_b32 v208, v15, v212, s[90:91]
    v_cndmask_b32 v210, v212, v15, s[90:91]
    v_mov_b32 v15, 0xc0c0302
    v_mov_b32 v223, 0x3020c0c
    v_cndmask_b32 v15, v15, v223, s[88:89]
    v_cndmask_b32 v209, v15, v212, s[92:93]
    v_cndmask_b32 v211, v212, v15, s[92:93]
    s_or_b32 s78, s72, s86
    s_cmp_eq_u32 s78, 0
    s_cselect_b32 s78, 0xf149f2ca, 0
    v_mov_b32 v212, s78
    v_mov_b32 v213, s78
    v_mov_b32 v214, s78
    v_mov_b32 v215, s78
    s_lshl_b32 s78, s87, 12
    s_add_u32 s78, s78, 24576
    s_lshl_b32 s79, s86, 9
    s_add_u32 s79, s79, s78
    v_lshlrev_b32 v15, 3, v0
    v_add_u32 v216, s79, v15
    s_lshl_b32 s80, s86, 11
    v_add_u32 v218, s80, v216
    v_xor_b32 v219, 512, v218
    s_add_u32 s78, s78, 2048
    s_cmp_eq_u32 s86, 0
    s_cselect_b32 s78, s78, 32768
    v_add_u32 v217, s78, v15
    v_bfe_u32 v14, v0, 3, 2
    v_lshlrev_b32 v14, 5, v14
    v_and_b32 v15, 3, v0
    v_lshl_add_u32 v14, v15, 3, v14
    v_lshrrev_b32 v15, 2, v0
    v_lshl_add_u32 v14, v15, 7, v14
    s_lshl_b32 s78, s86, 11
    v_add_u32 v244, s78, v14
    s_mov_b32 s64, s20
    s_mov_b32 s65, s21
    s_mov_b32 s66, 0x200000
    s_mov_b32 s67, 0x20000
    v_lshrrev_b32 v14, 4, v0
    v_lshlrev_b32 v14, 1, v14
    v_and_b32 v15, 7, v0
    v_xor_b32 v14, v14, v15
    v_lshlrev_b32 v14, 4, v14
    v_lshrrev_b32 v15, 3, v0
    v_lshl_add_u32 v14, v15, 11, v14
    s_lshl_b32 s78, s77, 7
    s_lshl_b32 s79, s3, 14
    s_add_u32 s78, s78, s79
    v_add_u32 v245, s78, v14
    v_and_b32 v14, 15, v0
    s_lshl_b32 s78, s76, 2
    s_add_u32 s78, s78, s3
    s_lshl_b32 s79, s78, 5
    v_add_u32 v14, s79, v14
    v_lshlrev_b32 v14, 12, v14
    v_bfe_u32 v15, v0, 4, 1
    v_lshl_add_u32 v14, v15, 5, v14
    v_lshrrev_b32 v15, 5, v0
    v_lshl_add_u32 v14, v15, 4, v14
    s_lshl_b32 s79, s77, 7
    s_add_u32 s79, s79, 2048
    v_add_u32 v246, s79, v14
    s_lshl_b32 s28, s78, 16
    s_add_u32 s28, s28, 8388608
    s_lshl_b32 s30, s76, 1
    s_add_u32 s30, s30, s86
    s_lshl_b32 s30, s30, 12
    s_add_u32 s30, s30, 12910592
    v_lshrrev_b32 v15, 1, v0
    v_lshlrev_b32 v15, 8, v15
    v_and_b32 v14, 1, v0
    v_lshl_add_u32 v247, v14, 2, v15
    s_and_b32 s78, s77, 7
    s_mov_b32 s79, 0x76543210
    s_and_b32 s78, s76, 3
    s_mul_i32 s78, s78, 0x22222222
    s_add_u32 s79, s79, s78
    s_bfe_u32 s78, s79, 0x30000
    s_lshl_b32 s44, s78, 18
    s_lshl_b32 s78, s78, 12
    s_add_u32 s36, s78, s28
    s_bfe_u32 s78, s79, 0x30004
    s_lshl_b32 s45, s78, 18
    s_lshl_b32 s78, s78, 12
    s_add_u32 s37, s78, s28
    s_bfe_u32 s78, s79, 0x30008
    s_lshl_b32 s46, s78, 18
    s_lshl_b32 s78, s78, 12
    s_add_u32 s38, s78, s28
    s_bfe_u32 s78, s79, 0x3000c
    s_lshl_b32 s47, s78, 18
    s_lshl_b32 s78, s78, 12
    s_add_u32 s39, s78, s28
    s_bfe_u32 s78, s79, 0x30010
    s_lshl_b32 s48, s78, 18
    s_lshl_b32 s78, s78, 12
    s_add_u32 s40, s78, s28
    s_bfe_u32 s78, s79, 0x30014
    s_lshl_b32 s49, s78, 18
    s_lshl_b32 s78, s78, 12
    s_add_u32 s41, s78, s28
    s_bfe_u32 s78, s79, 0x30018
    s_lshl_b32 s50, s78, 18
    s_lshl_b32 s78, s78, 12
    s_add_u32 s42, s78, s28
    s_bfe_u32 s78, s79, 0x3001c
    s_lshl_b32 s51, s78, 18
    s_lshl_b32 s78, s78, 12
    s_add_u32 s43, s78, s28
    s_lshl_b32 s34, s3, 10
    v_bfe_u32 v14, v0, 4, 1
    v_lshrrev_b32 v15, 5, v0
    v_lshl_add_u32 v14, v14, 1, v15
    v_and_b32 v15, 7, v0
    v_xor_b32 v14, v14, v15
    v_lshlrev_b32 v14, 4, v14
    v_and_b32 v223, 15, v0
    v_lshl_add_u32 v14, v223, 7, v14
    s_lshl_b32 s78, s3, 12
    v_add_u32 v248, s78, v14
    v_xor_b32 v249, 64, v248
    v_add_u32 v250, s78, v12
    v_lshrrev_b32 v14, 3, v0
    v_xor_b32 v15, v15, v14
    v_lshlrev_b32 v15, 4, v15
    v_lshl_add_u32 v14, v14, 12, v15
    s_lshl_b32 s78, s76, 2
    s_add_u32 s78, s78, s3
    s_lshl_b32 s78, s78, 17
    s_lshl_b32 s79, s77, 7
    s_add_u32 s78, s78, s79
    s_add_u32 s78, s78, 2048
    v_add_u32 v246, s78, v14
    s_waitcnt lgkmcnt(0)
    s_barrier
    ds_read_b64_tr_b16 v[200:201], v6 offset:1024
    ds_read_b64_tr_b16 v[202:203], v6 offset:1536
    ds_read_b64_tr_b16 v[204:205], v6 offset:13312
    ds_read_b64_tr_b16 v[206:207], v6 offset:13824
    ds_read_b128 v[152:155], v2 offset:0
    ds_read_b128 v[156:159], v3 offset:0
    ds_read_b128 v[144:147], v4 offset:6144
    ds_read_b128 v[148:151], v5 offset:6144
    ds_read_b128 v[136:139], v4 offset:4096
    ds_read_b128 v[140:143], v5 offset:4096
    ds_read_b128 v[128:131], v4 offset:2048
    ds_read_b128 v[132:135], v5 offset:2048
    ds_read_b128 v[120:123], v4 offset:0
    ds_read_b128 v[124:127], v5 offset:0
    ds_read_b64_tr_b16 v[224:225], v7 offset:1024
    ds_read_b64_tr_b16 v[226:227], v7 offset:1536
    ds_read_b64_tr_b16 v[228:229], v7 offset:13312
    ds_read_b64_tr_b16 v[230:231], v7 offset:13824
    s_waitcnt lgkmcnt(13)
    v_mfma_f32_16x16x32_bf16 v[112:115], v[200:203], v[152:155], 0
    ds_read_b64_tr_b16 v[232:233], v6 offset:0
    s_waitcnt lgkmcnt(13)
    v_mfma_f32_16x16x32_bf16 v[112:115], v[204:207], v[156:159], v[112:115]
    ds_read_b64_tr_b16 v[234:235], v6 offset:512
    s_waitcnt lgkmcnt(12)
    v_mfma_f32_16x16x32_bf16 v[72:75], v[204:207], v[148:151], 0
    ds_read_b64_tr_b16 v[236:237], v6 offset:12288
    v_mfma_f32_16x16x32_bf16 v[72:75], v[200:203], v[144:147], v[72:75]
    ds_read_b64_tr_b16 v[238:239], v6 offset:12800
    s_waitcnt lgkmcnt(13)
    v_mfma_f32_16x16x32_bf16 v[64:67], v[200:203], v[136:139], 0
    s_waitcnt lgkmcnt(12)
    v_mfma_f32_16x16x32_bf16 v[64:67], v[204:207], v[140:143], v[64:67]
    s_waitcnt lgkmcnt(10)
    v_mfma_f32_16x16x32_bf16 v[56:59], v[204:207], v[132:135], 0
    v_mfma_f32_16x16x32_bf16 v[56:59], v[200:203], v[128:131], v[56:59]
    s_waitcnt lgkmcnt(9)
    v_mfma_f32_16x16x32_bf16 v[48:51], v[200:203], v[120:123], 0
    s_waitcnt lgkmcnt(8)
    v_mfma_f32_16x16x32_bf16 v[48:51], v[204:207], v[124:127], v[48:51]
    s_waitcnt lgkmcnt(4)
    v_mfma_f32_16x16x32_bf16 v[52:55], v[228:231], v[124:127], 0
    ds_read_b64_tr_b16 v[200:201], v7 offset:0
    v_mfma_f32_16x16x32_bf16 v[52:55], v[224:227], v[120:123], v[52:55]
    ds_read_b64_tr_b16 v[202:203], v7 offset:512
    v_mfma_f32_16x16x32_bf16 v[60:63], v[224:227], v[128:131], 0
    ds_read_b64_tr_b16 v[204:205], v7 offset:12288
    v_mfma_f32_16x16x32_bf16 v[60:63], v[228:231], v[132:135], v[60:63]
    ds_read_b64_tr_b16 v[206:207], v7 offset:12800
    v_mfma_f32_16x16x32_bf16 v[68:71], v[228:231], v[140:143], 0
    v_mfma_f32_16x16x32_bf16 v[68:71], v[224:227], v[136:139], v[68:71]
    v_mfma_f32_16x16x32_bf16 v[76:79], v[224:227], v[144:147], 0
    v_mfma_f32_16x16x32_bf16 v[76:79], v[228:231], v[148:151], v[76:79]
    s_barrier
    s_waitcnt lgkmcnt(4)
    v_mfma_f32_16x16x32_bf16 v[40:43], v[236:239], v[148:151], 0
    ds_read_b64_tr_b16 v[224:225], v6 offset:2048
    ds_read_b64_tr_b16 v[226:227], v6 offset:2560
    v_mfma_f32_16x16x32_bf16 v[40:43], v[232:235], v[144:147], v[40:43]
    ds_read_b64_tr_b16 v[228:229], v6 offset:14336
    ds_read_b64_tr_b16 v[230:231], v6 offset:14848
    v_mfma_f32_16x16x32_bf16 v[32:35], v[232:235], v[136:139], 0
    ds_read_b128 v[192:195], v2 offset:18432
    ds_read_b128 v[196:199], v3 offset:18432
    v_mfma_f32_16x16x32_bf16 v[32:35], v[236:239], v[140:143], v[32:35]
    ds_read_b128 v[184:187], v4 offset:24576
    ds_read_b128 v[188:191], v5 offset:24576
    v_mfma_f32_16x16x32_bf16 v[24:27], v[236:239], v[132:135], 0
    ds_read_b128 v[176:179], v4 offset:22528
    v_mfma_f32_16x16x32_bf16 v[24:27], v[232:235], v[128:131], v[24:27]
    v_mfma_f32_16x16x32_bf16 v[16:19], v[232:235], v[120:123], 0
    v_mfma_f32_16x16x32_bf16 v[16:19], v[236:239], v[124:127], v[16:19]
    s_waitcnt lgkmcnt(9)
    v_mfma_f32_16x16x32_bf16 v[20:23], v[204:207], v[124:127], 0
    ds_read_b64_tr_b16 v[232:233], v7 offset:2048
    ds_read_b64_tr_b16 v[234:235], v7 offset:2560
    v_mfma_f32_16x16x32_bf16 v[20:23], v[200:203], v[120:123], v[20:23]
    ds_read_b64_tr_b16 v[236:237], v7 offset:14336
    ds_read_b64_tr_b16 v[238:239], v7 offset:14848
    v_mfma_f32_16x16x32_bf16 v[28:31], v[200:203], v[128:131], 0
    ds_read_b128 v[180:183], v5 offset:22528
    ds_read_b128 v[168:171], v4 offset:20480
    v_mfma_f32_16x16x32_bf16 v[28:31], v[204:207], v[132:135], v[28:31]
    ds_read_b128 v[172:175], v5 offset:20480
    ds_read_b128 v[160:163], v4 offset:18432
    v_mfma_f32_16x16x32_bf16 v[36:39], v[204:207], v[140:143], 0
    ds_read_b128 v[164:167], v5 offset:18432
    v_mfma_f32_16x16x32_bf16 v[36:39], v[200:203], v[136:139], v[36:39]
    v_mfma_f32_16x16x32_bf16 v[44:47], v[200:203], v[144:147], 0
    v_mfma_f32_16x16x32_bf16 v[44:47], v[204:207], v[148:151], v[44:47]
    s_waitcnt lgkmcnt(14)
    v_mfma_f32_16x16x32_bf16 v[116:119], v[156:159], v[228:231], 0
    v_mfma_f32_16x16x32_bf16 v[116:119], v[152:155], v[224:227], v[116:119]
    v_mfma_f32_16x16x32_bf16 v[104:107], v[144:147], v[224:227], 0
    v_mfma_f32_16x16x32_bf16 v[104:107], v[148:151], v[228:231], v[104:107]
    v_mfma_f32_16x16x32_bf16 v[96:99], v[140:143], v[228:231], 0
    s_waitcnt vmcnt(0) lgkmcnt(0)
    s_barrier
    s_or_b32 s78, s75, s3
    s_cbranch_scc0 LB_tag
LB_tagb:
    v_mfma_f32_16x16x32_bf16 v[96:99], v[136:139], v[224:227], v[96:99]
    ds_read_b64_tr_b16 v[200:201], v6 offset:25600
    v_mfma_f32_16x16x32_bf16 v[88:91], v[128:131], v[224:227], 0
    ds_read_b64_tr_b16 v[202:203], v6 offset:26112
    v_mfma_f32_16x16x32_bf16 v[88:91], v[132:135], v[228:231], v[88:91]
    ds_read_b64_tr_b16 v[204:205], v6 offset:37888
    v_mfma_f32_16x16x32_bf16 v[80:83], v[124:127], v[228:231], 0
    ds_read_b64_tr_b16 v[206:207], v6 offset:38400
    v_mfma_f32_16x16x32_bf16 v[80:83], v[120:123], v[224:227], v[80:83]
    v_mfma_f32_16x16x32_bf16 v[84:87], v[120:123], v[232:235], 0
    ds_read_b64_tr_b16 v[224:225], v7 offset:25600
    v_mfma_f32_16x16x32_bf16 v[84:87], v[124:127], v[236:239], v[84:87]
    ds_read_b64_tr_b16 v[226:227], v7 offset:26112
    v_mfma_f32_16x16x32_bf16 v[92:95], v[132:135], v[236:239], 0
    ds_read_b64_tr_b16 v[228:229], v7 offset:37888
    v_mfma_f32_16x16x32_bf16 v[92:95], v[128:131], v[232:235], v[92:95]
    ds_read_b64_tr_b16 v[230:231], v7 offset:38400
    v_mfma_f32_16x16x32_bf16 v[100:103], v[136:139], v[232:235], 0
    v_mfma_f32_16x16x32_bf16 v[100:103], v[140:143], v[236:239], v[100:103]
    v_mfma_f32_16x16x32_bf16 v[108:111], v[148:151], v[236:239], 0
    v_mfma_f32_16x16x32_bf16 v[108:111], v[144:147], v[232:235], v[108:111]
    s_waitcnt lgkmcnt(4)
    v_mfma_f32_16x16x32_bf16 v[112:115], v[200:203], v[192:195], v[112:115]
    ds_read_b64_tr_b16 v[232:233], v6 offset:24576
    v_mfma_f32_16x16x32_bf16 v[112:115], v[204:207], v[196:199], v[112:115]
    ds_read_b64_tr_b16 v[234:235], v6 offset:25088
    v_mfma_f32_16x16x32_bf16 v[72:75], v[204:207], v[188:191], v[72:75]
    ds_read_b64_tr_b16 v[236:237], v6 offset:36864
    v_mfma_f32_16x16x32_bf16 v[72:75], v[200:203], v[184:187], v[72:75]
    ds_read_b64_tr_b16 v[238:239], v6 offset:37376
    v_mfma_f32_16x16x32_bf16 v[64:67], v[200:203], v[176:179], v[64:67]
    ds_read_b128 v[152:155], v2 offset:36864
    v_mfma_f32_16x16x32_bf16 v[64:67], v[204:207], v[180:183], v[64:67]
    ds_read_b128 v[156:159], v3 offset:36864
    v_mfma_f32_16x16x32_bf16 v[56:59], v[204:207], v[172:175], v[56:59]
    ds_read_b128 v[144:147], v4 offset:43008
    v_mfma_f32_16x16x32_bf16 v[56:59], v[200:203], v[168:171], v[56:59]
    ds_read_b128 v[148:151], v5 offset:43008
    v_mfma_f32_16x16x32_bf16 v[48:51], v[200:203], v[160:163], v[48:51]
    v_mfma_f32_16x16x32_bf16 v[48:51], v[204:207], v[164:167], v[48:51]
    s_waitcnt lgkmcnt(8)
    v_mfma_f32_16x16x32_bf16 v[52:55], v[228:231], v[164:167], v[52:55]
    ds_read_b64_tr_b16 v[200:201], v7 offset:24576
    v_mfma_f32_16x16x32_bf16 v[52:55], v[224:227], v[160:163], v[52:55]
    ds_read_b64_tr_b16 v[202:203], v7 offset:25088
    v_mfma_f32_16x16x32_bf16 v[60:63], v[224:227], v[168:171], v[60:63]
    ds_read_b64_tr_b16 v[204:205], v7 offset:36864
    v_mfma_f32_16x16x32_bf16 v[60:63], v[228:231], v[172:175], v[60:63]
    ds_read_b64_tr_b16 v[206:207], v7 offset:37376
    v_mfma_f32_16x16x32_bf16 v[68:71], v[228:231], v[180:183], v[68:71]
    ds_read_b128 v[136:139], v4 offset:40960
    v_mfma_f32_16x16x32_bf16 v[68:71], v[224:227], v[176:179], v[68:71]
    ds_read_b128 v[140:143], v5 offset:40960
    v_mfma_f32_16x16x32_bf16 v[76:79], v[224:227], v[184:187], v[76:79]
    ds_read_b128 v[128:131], v4 offset:38912
    v_mfma_f32_16x16x32_bf16 v[76:79], v[228:231], v[188:191], v[76:79]
    s_waitcnt lgkmcnt(11)
    v_mfma_f32_16x16x32_bf16 v[40:43], v[236:239], v[188:191], v[40:43]
    ds_read_b64_tr_b16 v[224:225], v6 offset:26624
    v_mfma_f32_16x16x32_bf16 v[40:43], v[232:235], v[184:187], v[40:43]
    ds_read_b64_tr_b16 v[226:227], v6 offset:27136
    v_mfma_f32_16x16x32_bf16 v[32:35], v[232:235], v[176:179], v[32:35]
    ds_read_b64_tr_b16 v[228:229], v6 offset:38912
    v_mfma_f32_16x16x32_bf16 v[32:35], v[236:239], v[180:183], v[32:35]
    ds_read_b64_tr_b16 v[230:231], v6 offset:39424
    v_mfma_f32_16x16x32_bf16 v[24:27], v[236:239], v[172:175], v[24:27]
    ds_read_b128 v[132:135], v5 offset:38912
    v_mfma_f32_16x16x32_bf16 v[24:27], v[232:235], v[168:171], v[24:27]
    ds_read_b128 v[120:123], v4 offset:36864
    v_mfma_f32_16x16x32_bf16 v[16:19], v[232:235], v[160:163], v[16:19]
    ds_read_b128 v[124:127], v5 offset:36864
    v_mfma_f32_16x16x32_bf16 v[16:19], v[236:239], v[164:167], v[16:19]
    s_waitcnt lgkmcnt(10)
    v_mfma_f32_16x16x32_bf16 v[20:23], v[204:207], v[164:167], v[20:23]
    ds_read_b64_tr_b16 v[232:233], v7 offset:26624
    v_mfma_f32_16x16x32_bf16 v[20:23], v[200:203], v[160:163], v[20:23]
    ds_read_b64_tr_b16 v[234:235], v7 offset:27136
    v_mfma_f32_16x16x32_bf16 v[28:31], v[200:203], v[168:171], v[28:31]
    ds_read_b64_tr_b16 v[236:237], v7 offset:38912
    v_mfma_f32_16x16x32_bf16 v[28:31], v[204:207], v[172:175], v[28:31]
    ds_read_b64_tr_b16 v[238:239], v7 offset:39424
    v_mfma_f32_16x16x32_bf16 v[36:39], v[204:207], v[180:183], v[36:39]
    v_mfma_f32_16x16x32_bf16 v[36:39], v[200:203], v[176:179], v[36:39]
    v_mfma_f32_16x16x32_bf16 v[44:47], v[200:203], v[184:187], v[44:47]
    v_mfma_f32_16x16x32_bf16 v[44:47], v[204:207], v[188:191], v[44:47]
    s_waitcnt lgkmcnt(7)
    v_mfma_f32_16x16x32_bf16 v[116:119], v[196:199], v[228:231], v[116:119]
    v_mfma_f32_16x16x32_bf16 v[116:119], v[192:195], v[224:227], v[116:119]
    v_mfma_f32_16x16x32_bf16 v[104:107], v[184:187], v[224:227], v[104:107]
    v_mfma_f32_16x16x32_bf16 v[104:107], v[188:191], v[228:231], v[104:107]
    v_mfma_f32_16x16x32_bf16 v[96:99], v[180:183], v[228:231], v[96:99]
    s_waitcnt lgkmcnt(0)
    s_barrier
    v_mfma_f32_16x16x32_bf16 v[96:99], v[176:179], v[224:227], v[96:99]
    ds_read_b64_tr_b16 v[200:201], v6 offset:50176
    v_mfma_f32_16x16x32_bf16 v[88:91], v[168:171], v[224:227], v[88:91]
    ds_read_b64_tr_b16 v[202:203], v6 offset:50688
    v_mfma_f32_16x16x32_bf16 v[88:91], v[172:175], v[228:231], v[88:91]
    ds_read_b64_tr_b16 v[204:205], v6 offset:62464
    v_mfma_f32_16x16x32_bf16 v[80:83], v[164:167], v[228:231], v[80:83]
    ds_read_b64_tr_b16 v[206:207], v6 offset:62976
    v_mfma_f32_16x16x32_bf16 v[80:83], v[160:163], v[224:227], v[80:83]
    v_mfma_f32_16x16x32_bf16 v[84:87], v[160:163], v[232:235], v[84:87]
    ds_read_b64_tr_b16 v[224:225], v7 offset:50176
    v_mfma_f32_16x16x32_bf16 v[84:87], v[164:167], v[236:239], v[84:87]
    ds_read_b64_tr_b16 v[226:227], v7 offset:50688
    v_mfma_f32_16x16x32_bf16 v[92:95], v[172:175], v[236:239], v[92:95]
    ds_read_b64_tr_b16 v[228:229], v7 offset:62464
    v_mfma_f32_16x16x32_bf16 v[92:95], v[168:171], v[232:235], v[92:95]
    ds_read_b64_tr_b16 v[230:231], v7 offset:62976
    v_mfma_f32_16x16x32_bf16 v[100:103], v[176:179], v[232:235], v[100:103]
    v_mfma_f32_16x16x32_bf16 v[100:103], v[180:183], v[236:239], v[100:103]
    v_mfma_f32_16x16x32_bf16 v[108:111], v[188:191], v[236:239], v[108:111]
    v_mfma_f32_16x16x32_bf16 v[108:111], v[184:187], v[232:235], v[108:111]
    s_waitcnt lgkmcnt(4)
    v_mfma_f32_16x16x32_bf16 v[112:115], v[200:203], v[152:155], v[112:115]
    ds_read_b64_tr_b16 v[232:233], v6 offset:49152
    v_mfma_f32_16x16x32_bf16 v[112:115], v[204:207], v[156:159], v[112:115]
    ds_read_b64_tr_b16 v[234:235], v6 offset:49664
    v_mfma_f32_16x16x32_bf16 v[72:75], v[204:207], v[148:151], v[72:75]
    ds_read_b64_tr_b16 v[236:237], v6 offset:61440
    v_mfma_f32_16x16x32_bf16 v[72:75], v[200:203], v[144:147], v[72:75]
    ds_read_b64_tr_b16 v[238:239], v6 offset:61952
    v_mfma_f32_16x16x32_bf16 v[64:67], v[200:203], v[136:139], v[64:67]
    ds_read_b128 v[192:195], v2 offset:0
    v_mfma_f32_16x16x32_bf16 v[64:67], v[204:207], v[140:143], v[64:67]
    ds_read_b128 v[196:199], v3 offset:0
    v_mfma_f32_16x16x32_bf16 v[56:59], v[204:207], v[132:135], v[56:59]
    ds_read_b128 v[184:187], v4 offset:6144
    v_mfma_f32_16x16x32_bf16 v[56:59], v[200:203], v[128:131], v[56:59]
    ds_read_b128 v[188:191], v5 offset:6144
    v_mfma_f32_16x16x32_bf16 v[48:51], v[200:203], v[120:123], v[48:51]
    v_mfma_f32_16x16x32_bf16 v[48:51], v[204:207], v[124:127], v[48:51]
    s_waitcnt lgkmcnt(8)
    v_mfma_f32_16x16x32_bf16 v[52:55], v[228:231], v[124:127], v[52:55]
    ds_read_b64_tr_b16 v[200:201], v7 offset:49152
    v_mfma_f32_16x16x32_bf16 v[52:55], v[224:227], v[120:123], v[52:55]
    ds_read_b64_tr_b16 v[202:203], v7 offset:49664
    v_mfma_f32_16x16x32_bf16 v[60:63], v[224:227], v[128:131], v[60:63]
    ds_read_b64_tr_b16 v[204:205], v7 offset:61440
    v_mfma_f32_16x16x32_bf16 v[60:63], v[228:231], v[132:135], v[60:63]
    ds_read_b64_tr_b16 v[206:207], v7 offset:61952
    v_mfma_f32_16x16x32_bf16 v[68:71], v[228:231], v[140:143], v[68:71]
    ds_read_b128 v[176:179], v4 offset:4096
    v_mfma_f32_16x16x32_bf16 v[68:71], v[224:227], v[136:139], v[68:71]
    ds_read_b128 v[180:183], v5 offset:4096
    v_mfma_f32_16x16x32_bf16 v[76:79], v[224:227], v[144:147], v[76:79]
    ds_read_b128 v[168:171], v4 offset:2048
    v_mfma_f32_16x16x32_bf16 v[76:79], v[228:231], v[148:151], v[76:79]
    s_waitcnt lgkmcnt(11)
    v_mfma_f32_16x16x32_bf16 v[40:43], v[236:239], v[148:151], v[40:43]
    ds_read_b64_tr_b16 v[224:225], v6 offset:51200
    v_mfma_f32_16x16x32_bf16 v[40:43], v[232:235], v[144:147], v[40:43]
    ds_read_b64_tr_b16 v[226:227], v6 offset:51712
    v_mfma_f32_16x16x32_bf16 v[32:35], v[232:235], v[136:139], v[32:35]
    ds_read_b64_tr_b16 v[228:229], v6 offset:63488
    v_mfma_f32_16x16x32_bf16 v[32:35], v[236:239], v[140:143], v[32:35]
    ds_read_b64_tr_b16 v[230:231], v6 offset:64000
    v_mfma_f32_16x16x32_bf16 v[24:27], v[236:239], v[132:135], v[24:27]
    ds_read_b128 v[172:175], v5 offset:2048
    v_mfma_f32_16x16x32_bf16 v[24:27], v[232:235], v[128:131], v[24:27]
    ds_read_b128 v[160:163], v4 offset:0
    v_mfma_f32_16x16x32_bf16 v[16:19], v[232:235], v[120:123], v[16:19]
    ds_read_b128 v[164:167], v5 offset:0
    v_mfma_f32_16x16x32_bf16 v[16:19], v[236:239], v[124:127], v[16:19]
    s_waitcnt lgkmcnt(10)
    v_mfma_f32_16x16x32_bf16 v[20:23], v[204:207], v[124:127], v[20:23]
    ds_read_b64_tr_b16 v[232:233], v7 offset:51200
    v_mfma_f32_16x16x32_bf16 v[20:23], v[200:203], v[120:123], v[20:23]
    ds_read_b64_tr_b16 v[234:235], v7 offset:51712
    v_mfma_f32_16x16x32_bf16 v[28:31], v[200:203], v[128:131], v[28:31]
    ds_read_b64_tr_b16 v[236:237], v7 offset:63488
    v_mfma_f32_16x16x32_bf16 v[28:31], v[204:207], v[132:135], v[28:31]
    ds_read_b64_tr_b16 v[238:239], v7 offset:64000
    v_mfma_f32_16x16x32_bf16 v[36:39], v[204:207], v[140:143], v[36:39]
    v_mfma_f32_16x16x32_bf16 v[36:39], v[200:203], v[136:139], v[36:39]
    v_mfma_f32_16x16x32_bf16 v[44:47], v[200:203], v[144:147], v[44:47]
    v_mfma_f32_16x16x32_bf16 v[44:47], v[204:207], v[148:151], v[44:47]
    s_waitcnt lgkmcnt(7)
    v_mfma_f32_16x16x32_bf16 v[116:119], v[156:159], v[228:231], v[116:119]
    v_mfma_f32_16x16x32_bf16 v[116:119], v[152:155], v[224:227], v[116:119]
    v_mfma_f32_16x16x32_bf16 v[104:107], v[144:147], v[224:227], v[104:107]
    v_mfma_f32_16x16x32_bf16 v[104:107], v[148:151], v[228:231], v[104:107]
    v_mfma_f32_16x16x32_bf16 v[96:99], v[140:143], v[228:231], v[96:99]
    s_waitcnt lgkmcnt(0)
    s_barrier
    v_mfma_f32_16x16x32_bf16 v[96:99], v[136:139], v[224:227], v[96:99]
    ds_read_b64_tr_b16 v[200:201], v6 offset:1024
    v_mfma_f32_16x16x32_bf16 v[88:91], v[128:131], v[224:227], v[88:91]
    ds_read_b64_tr_b16 v[202:203], v6 offset:1536
    v_mfma_f32_16x16x32_bf16 v[88:91], v[132:135], v[228:231], v[88:91]
    ds_read_b64_tr_b16 v[204:205], v6 offset:13312
    v_mfma_f32_16x16x32_bf16 v[80:83], v[124:127], v[228:231], v[80:83]
    ds_read_b64_tr_b16 v[206:207], v6 offset:13824
    v_mfma_f32_16x16x32_bf16 v[80:83], v[120:123], v[224:227], v[80:83]
    v_mfma_f32_16x16x32_bf16 v[84:87], v[120:123], v[232:235], v[84:87]
    ds_read_b64_tr_b16 v[224:225], v7 offset:1024
    v_mfma_f32_16x16x32_bf16 v[84:87], v[124:127], v[236:239], v[84:87]
    ds_read_b64_tr_b16 v[226:227], v7 offset:1536
    v_mfma_f32_16x16x32_bf16 v[92:95], v[132:135], v[236:239], v[92:95]
    ds_read_b64_tr_b16 v[228:229], v7 offset:13312
    v_mfma_f32_16x16x32_bf16 v[92:95], v[128:131], v[232:235], v[92:95]
    ds_read_b64_tr_b16 v[230:231], v7 offset:13824
    v_mfma_f32_16x16x32_bf16 v[100:103], v[136:139], v[232:235], v[100:103]
    v_mfma_f32_16x16x32_bf16 v[100:103], v[140:143], v[236:239], v[100:103]
    v_mfma_f32_16x16x32_bf16 v[108:111], v[148:151], v[236:239], v[108:111]
    v_mfma_f32_16x16x32_bf16 v[108:111], v[144:147], v[232:235], v[108:111]
    s_waitcnt lgkmcnt(4)
    v_mfma_f32_16x16x32_bf16 v[112:115], v[200:203], v[192:195], v[112:115]
    ds_read_b64_tr_b16 v[232:233], v6 offset:0
    v_mfma_f32_16x16x32_bf16 v[112:115], v[204:207], v[196:199], v[112:115]
    ds_read_b64_tr_b16 v[234:235], v6 offset:512
    v_mfma_f32_16x16x32_bf16 v[72:75], v[204:207], v[188:191], v[72:75]
    ds_read_b64_tr_b16 v[236:237], v6 offset:12288
    v_mfma_f32_16x16x32_bf16 v[72:75], v[200:203], v[184:187], v[72:75]
    ds_read_b64_tr_b16 v[238:239], v6 offset:12800
    v_mfma_f32_16x16x32_bf16 v[64:67], v[200:203], v[176:179], v[64:67]
    ds_read_b128 v[152:155], v2 offset:18432
    v_mfma_f32_16x16x32_bf16 v[64:67], v[204:207], v[180:183], v[64:67]
    ds_read_b128 v[156:159], v3 offset:18432
    v_mfma_f32_16x16x32_bf16 v[56:59], v[204:207], v[172:175], v[56:59]
    ds_read_b128 v[144:147], v4 offset:24576
    v_mfma_f32_16x16x32_bf16 v[56:59], v[200:203], v[168:171], v[56:59]
    ds_read_b128 v[148:151], v5 offset:24576
    v_mfma_f32_16x16x32_bf16 v[48:51], v[200:203], v[160:163], v[48:51]
    v_mfma_f32_16x16x32_bf16 v[48:51], v[204:207], v[164:167], v[48:51]
    s_waitcnt lgkmcnt(8)
    v_mfma_f32_16x16x32_bf16 v[52:55], v[228:231], v[164:167], v[52:55]
    ds_read_b64_tr_b16 v[200:201], v7 offset:0
    v_mfma_f32_16x16x32_bf16 v[52:55], v[224:227], v[160:163], v[52:55]
    ds_read_b64_tr_b16 v[202:203], v7 offset:512
    v_mfma_f32_16x16x32_bf16 v[60:63], v[224:227], v[168:171], v[60:63]
    ds_read_b64_tr_b16 v[204:205], v7 offset:12288
    v_mfma_f32_16x16x32_bf16 v[60:63], v[228:231], v[172:175], v[60:63]
    ds_read_b64_tr_b16 v[206:207], v7 offset:12800
    v_mfma_f32_16x16x32_bf16 v[68:71], v[228:231], v[180:183], v[68:71]
    ds_read_b128 v[136:139], v4 offset:22528
    v_mfma_f32_16x16x32_bf16 v[68:71], v[224:227], v[176:179], v[68:71]
    ds_read_b128 v[140:143], v5 offset:22528
    v_mfma_f32_16x16x32_bf16 v[76:79], v[224:227], v[184:187], v[76:79]
    ds_read_b128 v[128:131], v4 offset:20480
    v_mfma_f32_16x16x32_bf16 v[76:79], v[228:231], v[188:191], v[76:79]
    s_waitcnt lgkmcnt(11)
    v_mfma_f32_16x16x32_bf16 v[40:43], v[236:239], v[188:191], v[40:43]
    ds_read_b64_tr_b16 v[224:225], v6 offset:2048
    v_mfma_f32_16x16x32_bf16 v[40:43], v[232:235], v[184:187], v[40:43]
    ds_read_b64_tr_b16 v[226:227], v6 offset:2560
    v_mfma_f32_16x16x32_bf16 v[32:35], v[232:235], v[176:179], v[32:35]
    ds_read_b64_tr_b16 v[228:229], v6 offset:14336
    v_mfma_f32_16x16x32_bf16 v[32:35], v[236:239], v[180:183], v[32:35]
    ds_read_b64_tr_b16 v[230:231], v6 offset:14848
    v_mfma_f32_16x16x32_bf16 v[24:27], v[236:239], v[172:175], v[24:27]
    ds_read_b128 v[132:135], v5 offset:20480
    v_mfma_f32_16x16x32_bf16 v[24:27], v[232:235], v[168:171], v[24:27]
    ds_read_b128 v[120:123], v4 offset:18432
    v_mfma_f32_16x16x32_bf16 v[16:19], v[232:235], v[160:163], v[16:19]
    ds_read_b128 v[124:127], v5 offset:18432
    v_mfma_f32_16x16x32_bf16 v[16:19], v[236:239], v[164:167], v[16:19]
    s_waitcnt lgkmcnt(10)
    v_mfma_f32_16x16x32_bf16 v[20:23], v[204:207], v[164:167], v[20:23]
    ds_read_b64_tr_b16 v[232:233], v7 offset:2048
    v_mfma_f32_16x16x32_bf16 v[20:23], v[200:203], v[160:163], v[20:23]
    ds_read_b64_tr_b16 v[234:235], v7 offset:2560
    v_mfma_f32_16x16x32_bf16 v[28:31], v[200:203], v[168:171], v[28:31]
    ds_read_b64_tr_b16 v[236:237], v7 offset:14336
    v_mfma_f32_16x16x32_bf16 v[28:31], v[204:207], v[172:175], v[28:31]
    ds_read_b64_tr_b16 v[238:239], v7 offset:14848
    v_mfma_f32_16x16x32_bf16 v[36:39], v[204:207], v[180:183], v[36:39]
    v_mfma_f32_16x16x32_bf16 v[36:39], v[200:203], v[176:179], v[36:39]
    v_mfma_f32_16x16x32_bf16 v[44:47], v[200:203], v[184:187], v[44:47]
    v_mfma_f32_16x16x32_bf16 v[44:47], v[204:207], v[188:191], v[44:47]
    s_waitcnt lgkmcnt(7)
    v_mfma_f32_16x16x32_bf16 v[116:119], v[196:199], v[228:231], v[116:119]
    v_mfma_f32_16x16x32_bf16 v[116:119], v[192:195], v[224:227], v[116:119]
    v_mfma_f32_16x16x32_bf16 v[104:107], v[184:187], v[224:227], v[104:107]
    v_mfma_f32_16x16x32_bf16 v[104:107], v[188:191], v[228:231], v[104:107]
    v_mfma_f32_16x16x32_bf16 v[96:99], v[180:183], v[228:231], v[96:99]
    s_waitcnt lgkmcnt(0)
    s_barrier
    v_mfma_f32_16x16x32_bf16 v[96:99], v[176:179], v[224:227], v[96:99]
    ds_read_b64_tr_b16 v[200:201], v6 offset:25600
    v_mfma_f32_16x16x32_bf16 v[88:91], v[168:171], v[224:227], v[88:91]
    ds_read_b64_tr_b16 v[202:203], v6 offset:26112
    v_mfma_f32_16x16x32_bf16 v[88:91], v[172:175], v[228:231], v[88:91]
    ds_read_b64_tr_b16 v[204:205], v6 offset:37888
    v_mfma_f32_16x16x32_bf16 v[80:83], v[164:167], v[228:231], v[80:83]
    ds_read_b64_tr_b16 v[206:207], v6 offset:38400
    v_mfma_f32_16x16x32_bf16 v[80:83], v[160:163], v[224:227], v[80:83]
    v_mfma_f32_16x16x32_bf16 v[84:87], v[160:163], v[232:235], v[84:87]
    ds_read_b64_tr_b16 v[224:225], v7 offset:25600
    v_mfma_f32_16x16x32_bf16 v[84:87], v[164:167], v[236:239], v[84:87]
    ds_read_b64_tr_b16 v[226:227], v7 offset:26112
    v_mfma_f32_16x16x32_bf16 v[92:95], v[172:175], v[236:239], v[92:95]
    ds_read_b64_tr_b16 v[228:229], v7 offset:37888
    v_mfma_f32_16x16x32_bf16 v[92:95], v[168:171], v[232:235], v[92:95]
    ds_read_b64_tr_b16 v[230:231], v7 offset:38400
    v_mfma_f32_16x16x32_bf16 v[100:103], v[176:179], v[232:235], v[100:103]
    v_mfma_f32_16x16x32_bf16 v[100:103], v[180:183], v[236:239], v[100:103]
    v_mfma_f32_16x16x32_bf16 v[108:111], v[188:191], v[236:239], v[108:111]
    v_mfma_f32_16x16x32_bf16 v[108:111], v[184:187], v[232:235], v[108:111]
    s_waitcnt lgkmcnt(4)
    v_mfma_f32_16x16x32_bf16 v[112:115], v[200:203], v[152:155], v[112:115]
    ds_read_b64_tr_b16 v[232:233], v6 offset:24576
    v_mfma_f32_16x16x32_bf16 v[112:115], v[204:207], v[156:159], v[112:115]
    ds_read_b64_tr_b16 v[234:235], v6 offset:25088
    v_mfma_f32_16x16x32_bf16 v[72:75], v[204:207], v[148:151], v[72:75]
    ds_read_b64_tr_b16 v[236:237], v6 offset:36864
    v_mfma_f32_16x16x32_bf16 v[72:75], v[200:203], v[144:147], v[72:75]
    ds_read_b64_tr_b16 v[238:239], v6 offset:37376
    v_mfma_f32_16x16x32_bf16 v[64:67], v[200:203], v[136:139], v[64:67]
    ds_read_b128 v[192:195], v2 offset:36864
    v_mfma_f32_16x16x32_bf16 v[64:67], v[204:207], v[140:143], v[64:67]
    ds_read_b128 v[196:199], v3 offset:36864
    v_mfma_f32_16x16x32_bf16 v[56:59], v[204:207], v[132:135], v[56:59]
    ds_read_b128 v[184:187], v4 offset:43008
    v_mfma_f32_16x16x32_bf16 v[56:59], v[200:203], v[128:131], v[56:59]
    ds_read_b128 v[188:191], v5 offset:43008
    v_mfma_f32_16x16x32_bf16 v[48:51], v[200:203], v[120:123], v[48:51]
    v_mfma_f32_16x16x32_bf16 v[48:51], v[204:207], v[124:127], v[48:51]
    s_waitcnt lgkmcnt(8)
    v_mfma_f32_16x16x32_bf16 v[52:55], v[228:231], v[124:127], v[52:55]
    ds_read_b64_tr_b16 v[200:201], v7 offset:24576
    v_mfma_f32_16x16x32_bf16 v[52:55], v[224:227], v[120:123], v[52:55]
    ds_read_b64_tr_b16 v[202:203], v7 offset:25088
    v_mfma_f32_16x16x32_bf16 v[60:63], v[224:227], v[128:131], v[60:63]
    ds_read_b64_tr_b16 v[204:205], v7 offset:36864
    v_mfma_f32_16x16x32_bf16 v[60:63], v[228:231], v[132:135], v[60:63]
    ds_read_b64_tr_b16 v[206:207], v7 offset:37376
    v_mfma_f32_16x16x32_bf16 v[68:71], v[228:231], v[140:143], v[68:71]
    ds_read_b128 v[176:179], v4 offset:40960
    v_mfma_f32_16x16x32_bf16 v[68:71], v[224:227], v[136:139], v[68:71]
    ds_read_b128 v[180:183], v5 offset:40960
    v_mfma_f32_16x16x32_bf16 v[76:79], v[224:227], v[144:147], v[76:79]
    ds_read_b128 v[168:171], v4 offset:38912
    v_mfma_f32_16x16x32_bf16 v[76:79], v[228:231], v[148:151], v[76:79]
    s_waitcnt lgkmcnt(11)
    v_mfma_f32_16x16x32_bf16 v[40:43], v[236:239], v[148:151], v[40:43]
    ds_read_b64_tr_b16 v[224:225], v6 offset:26624
    v_mfma_f32_16x16x32_bf16 v[40:43], v[232:235], v[144:147], v[40:43]
    ds_read_b64_tr_b16 v[226:227], v6 offset:27136
    v_mfma_f32_16x16x32_bf16 v[32:35], v[232:235], v[136:139], v[32:35]
    ds_read_b64_tr_b16 v[228:229], v6 offset:38912
    v_mfma_f32_16x16x32_bf16 v[32:35], v[236:239], v[140:143], v[32:35]
    ds_read_b64_tr_b16 v[230:231], v6 offset:39424
    v_mfma_f32_16x16x32_bf16 v[24:27], v[236:239], v[132:135], v[24:27]
    ds_read_b128 v[172:175], v5 offset:38912
    v_mfma_f32_16x16x32_bf16 v[24:27], v[232:235], v[128:131], v[24:27]
    ds_read_b128 v[160:163], v4 offset:36864
    v_mfma_f32_16x16x32_bf16 v[16:19], v[232:235], v[120:123], v[16:19]
    ds_read_b128 v[164:167], v5 offset:36864
    v_mfma_f32_16x16x32_bf16 v[16:19], v[236:239], v[124:127], v[16:19]
    s_waitcnt lgkmcnt(10)
    v_mfma_f32_16x16x32_bf16 v[20:23], v[204:207], v[124:127], v[20:23]
    ds_read_b64_tr_b16 v[232:233], v7 offset:26624
    v_mfma_f32_16x16x32_bf16 v[20:23], v[200:203], v[120:123], v[20:23]
    ds_read_b64_tr_b16 v[234:235], v7 offset:27136
    v_mfma_f32_16x16x32_bf16 v[28:31], v[200:203], v[128:131], v[28:31]
    ds_read_b64_tr_b16 v[236:237], v7 offset:38912
    v_mfma_f32_16x16x32_bf16 v[28:31], v[204:207], v[132:135], v[28:31]
    ds_read_b64_tr_b16 v[238:239], v7 offset:39424
    v_mfma_f32_16x16x32_bf16 v[36:39], v[204:207], v[140:143], v[36:39]
    v_mfma_f32_16x16x32_bf16 v[36:39], v[200:203], v[136:139], v[36:39]
    v_mfma_f32_16x16x32_bf16 v[44:47], v[200:203], v[144:147], v[44:47]
    v_mfma_f32_16x16x32_bf16 v[44:47], v[204:207], v[148:151], v[44:47]
    s_waitcnt lgkmcnt(7)
    v_mfma_f32_16x16x32_bf16 v[116:119], v[156:159], v[228:231], v[116:119]
    v_mfma_f32_16x16x32_bf16 v[116:119], v[152:155], v[224:227], v[116:119]
    v_mfma_f32_16x16x32_bf16 v[104:107], v[144:147], v[224:227], v[104:107]
    v_mfma_f32_16x16x32_bf16 v[104:107], v[148:151], v[228:231], v[104:107]
    v_mfma_f32_16x16x32_bf16 v[96:99], v[140:143], v[228:231], v[96:99]
    s_waitcnt lgkmcnt(0)
    s_barrier
    v_mfma_f32_16x16x32_bf16 v[96:99], v[136:139], v[224:227], v[96:99]
    ds_read_b64_tr_b16 v[200:201], v6 offset:50176
    v_mfma_f32_16x16x32_bf16 v[88:91], v[128:131], v[224:227], v[88:91]
    ds_read_b64_tr_b16 v[202:203], v6 offset:50688
    v_mfma_f32_16x16x32_bf16 v[88:91], v[132:135], v[228:231], v[88:91]
    ds_read_b64_tr_b16 v[204:205], v6 offset:62464
    v_mfma_f32_16x16x32_bf16 v[80:83], v[124:127], v[228:231], v[80:83]
    ds_read_b64_tr_b16 v[206:207], v6 offset:62976
    v_mfma_f32_16x16x32_bf16 v[80:83], v[120:123], v[224:227], v[80:83]
    v_mfma_f32_16x16x32_bf16 v[84:87], v[120:123], v[232:235], v[84:87]
    ds_read_b64_tr_b16 v[224:225], v7 offset:50176
    v_mfma_f32_16x16x32_bf16 v[84:87], v[124:127], v[236:239], v[84:87]
    ds_read_b64_tr_b16 v[226:227], v7 offset:50688
    v_mfma_f32_16x16x32_bf16 v[92:95], v[132:135], v[236:239], v[92:95]
    ds_read_b64_tr_b16 v[228:229], v7 offset:62464
    v_mfma_f32_16x16x32_bf16 v[92:95], v[128:131], v[232:235], v[92:95]
    ds_read_b64_tr_b16 v[230:231], v7 offset:62976
    v_mfma_f32_16x16x32_bf16 v[100:103], v[136:139], v[232:235], v[100:103]
    v_mfma_f32_16x16x32_bf16 v[100:103], v[140:143], v[236:239], v[100:103]
    v_mfma_f32_16x16x32_bf16 v[108:111], v[148:151], v[236:239], v[108:111]
    v_mfma_f32_16x16x32_bf16 v[108:111], v[144:147], v[232:235], v[108:111]
    s_waitcnt lgkmcnt(4)
    v_mfma_f32_16x16x32_bf16 v[112:115], v[200:203], v[192:195], v[112:115]
    ds_read_b64_tr_b16 v[232:233], v6 offset:49152
    v_mfma_f32_16x16x32_bf16 v[112:115], v[204:207], v[196:199], v[112:115]
    ds_read_b64_tr_b16 v[234:235], v6 offset:49664
    v_mfma_f32_16x16x32_bf16 v[72:75], v[204:207], v[188:191], v[72:75]
    ds_read_b64_tr_b16 v[236:237], v6 offset:61440
    v_mfma_f32_16x16x32_bf16 v[72:75], v[200:203], v[184:187], v[72:75]
    ds_read_b64_tr_b16 v[238:239], v6 offset:61952
    v_mfma_f32_16x16x32_bf16 v[64:67], v[200:203], v[176:179], v[64:67]
    ds_read_b128 v[152:155], v2 offset:0
    v_mfma_f32_16x16x32_bf16 v[64:67], v[204:207], v[180:183], v[64:67]
    ds_read_b128 v[156:159], v3 offset:0
    v_mfma_f32_16x16x32_bf16 v[56:59], v[204:207], v[172:175], v[56:59]
    ds_read_b128 v[144:147], v4 offset:6144
    v_mfma_f32_16x16x32_bf16 v[56:59], v[200:203], v[168:171], v[56:59]
    ds_read_b128 v[148:151], v5 offset:6144
    v_mfma_f32_16x16x32_bf16 v[48:51], v[200:203], v[160:163], v[48:51]
    v_mfma_f32_16x16x32_bf16 v[48:51], v[204:207], v[164:167], v[48:51]
    s_waitcnt lgkmcnt(8)
    v_mfma_f32_16x16x32_bf16 v[52:55], v[228:231], v[164:167], v[52:55]
    ds_read_b64_tr_b16 v[200:201], v7 offset:49152
    v_mfma_f32_16x16x32_bf16 v[52:55], v[224:227], v[160:163], v[52:55]
    ds_read_b64_tr_b16 v[202:203], v7 offset:49664
    v_mfma_f32_16x16x32_bf16 v[60:63], v[224:227], v[168:171], v[60:63]
    ds_read_b64_tr_b16 v[204:205], v7 offset:61440
    v_mfma_f32_16x16x32_bf16 v[60:63], v[228:231], v[172:175], v[60:63]
    ds_read_b64_tr_b16 v[206:207], v7 offset:61952
    v_mfma_f32_16x16x32_bf16 v[68:71], v[228:231], v[180:183], v[68:71]
    ds_read_b128 v[136:139], v4 offset:4096
    v_mfma_f32_16x16x32_bf16 v[68:71], v[224:227], v[176:179], v[68:71]
    ds_read_b128 v[140:143], v5 offset:4096
    v_mfma_f32_16x16x32_bf16 v[76:79], v[224:227], v[184:187], v[76:79]
    ds_read_b128 v[128:131], v4 offset:2048
    v_mfma_f32_16x16x32_bf16 v[76:79], v[228:231], v[188:191], v[76:79]
    s_waitcnt lgkmcnt(11)
    v_mfma_f32_16x16x32_bf16 v[40:43], v[236:239], v[188:191], v[40:43]
    ds_read_b64_tr_b16 v[224:225], v6 offset:51200
    v_mfma_f32_16x16x32_bf16 v[40:43], v[232:235], v[184:187], v[40:43]
    ds_read_b64_tr_b16 v[226:227], v6 offset:51712
    v_mfma_f32_16x16x32_bf16 v[32:35], v[232:235], v[176:179], v[32:35]
    ds_read_b64_tr_b16 v[228:229], v6 offset:63488
    v_mfma_f32_16x16x32_bf16 v[32:35], v[236:239], v[180:183], v[32:35]
    ds_read_b64_tr_b16 v[230:231], v6 offset:64000
    v_mfma_f32_16x16x32_bf16 v[24:27], v[236:239], v[172:175], v[24:27]
    ds_read_b128 v[132:135], v5 offset:2048
    v_mfma_f32_16x16x32_bf16 v[24:27], v[232:235], v[168:171], v[24:27]
    ds_read_b128 v[120:123], v4 offset:0
    v_mfma_f32_16x16x32_bf16 v[16:19], v[232:235], v[160:163], v[16:19]
    ds_read_b128 v[124:127], v5 offset:0
    v_mfma_f32_16x16x32_bf16 v[16:19], v[236:239], v[164:167], v[16:19]
    s_waitcnt lgkmcnt(10)
    v_mfma_f32_16x16x32_bf16 v[20:23], v[204:207], v[164:167], v[20:23]
    ds_read_b64_tr_b16 v[232:233], v7 offset:51200
    v_mfma_f32_16x16x32_bf16 v[20:23], v[200:203], v[160:163], v[20:23]
    ds_read_b64_tr_b16 v[234:235], v7 offset:51712
    v_mfma_f32_16x16x32_bf16 v[28:31], v[200:203], v[168:171], v[28:31]
    ds_read_b64_tr_b16 v[236:237], v7 offset:63488
    v_mfma_f32_16x16x32_bf16 v[28:31], v[204:207], v[172:175], v[28:31]
    ds_read_b64_tr_b16 v[238:239], v7 offset:64000
    v_mfma_f32_16x16x32_bf16 v[36:39], v[204:207], v[180:183], v[36:39]
    v_mfma_f32_16x16x32_bf16 v[36:39], v[200:203], v[176:179], v[36:39]
    v_mfma_f32_16x16x32_bf16 v[44:47], v[200:203], v[184:187], v[44:47]
    v_mfma_f32_16x16x32_bf16 v[44:47], v[204:207], v[188:191], v[44:47]
    s_waitcnt lgkmcnt(7)
    v_mfma_f32_16x16x32_bf16 v[116:119], v[196:199], v[228:231], v[116:119]
    v_mfma_f32_16x16x32_bf16 v[116:119], v[192:195], v[224:227], v[116:119]
    v_mfma_f32_16x16x32_bf16 v[104:107], v[184:187], v[224:227], v[104:107]
    v_mfma_f32_16x16x32_bf16 v[104:107], v[188:191], v[228:231], v[104:107]
    v_mfma_f32_16x16x32_bf16 v[96:99], v[180:183], v[228:231], v[96:99]
    s_waitcnt lgkmcnt(0)
    s_barrier
    v_mfma_f32_16x16x32_bf16 v[96:99], v[176:179], v[224:227], v[96:99]
    ds_read_b64_tr_b16 v[200:201], v6 offset:1024
    v_mfma_f32_16x16x32_bf16 v[88:91], v[168:171], v[224:227], v[88:91]
    ds_read_b64_tr_b16 v[202:203], v6 offset:1536
    v_mfma_f32_16x16x32_bf16 v[88:91], v[172:175], v[228:231], v[88:91]
    ds_read_b64_tr_b16 v[204:205], v6 offset:13312
    v_mfma_f32_16x16x32_bf16 v[80:83], v[164:167], v[228:231], v[80:83]
    ds_read_b64_tr_b16 v[206:207], v6 offset:13824
    v_mfma_f32_16x16x32_bf16 v[80:83], v[160:163], v[224:227], v[80:83]
    v_mfma_f32_16x16x32_bf16 v[84:87], v[160:163], v[232:235], v[84:87]
    ds_read_b64_tr_b16 v[224:225], v7 offset:1024
    v_mfma_f32_16x16x32_bf16 v[84:87], v[164:167], v[236:239], v[84:87]
    ds_read_b64_tr_b16 v[226:227], v7 offset:1536
    v_mfma_f32_16x16x32_bf16 v[92:95], v[172:175], v[236:239], v[92:95]
    ds_read_b64_tr_b16 v[228:229], v7 offset:13312
    v_mfma_f32_16x16x32_bf16 v[92:95], v[168:171], v[232:235], v[92:95]
    ds_read_b64_tr_b16 v[230:231], v7 offset:13824
    v_mfma_f32_16x16x32_bf16 v[100:103], v[176:179], v[232:235], v[100:103]
    v_mfma_f32_16x16x32_bf16 v[100:103], v[180:183], v[236:239], v[100:103]
    v_mfma_f32_16x16x32_bf16 v[108:111], v[188:191], v[236:239], v[108:111]
    v_mfma_f32_16x16x32_bf16 v[108:111], v[184:187], v[232:235], v[108:111]
    s_waitcnt lgkmcnt(4)
    v_mfma_f32_16x16x32_bf16 v[112:115], v[200:203], v[152:155], v[112:115]
    ds_read_b64_tr_b16 v[232:233], v6 offset:0
    v_mfma_f32_16x16x32_bf16 v[112:115], v[204:207], v[156:159], v[112:115]
    ds_read_b64_tr_b16 v[234:235], v6 offset:512
    v_mfma_f32_16x16x32_bf16 v[72:75], v[204:207], v[148:151], v[72:75]
    ds_read_b64_tr_b16 v[236:237], v6 offset:12288
    v_mfma_f32_16x16x32_bf16 v[72:75], v[200:203], v[144:147], v[72:75]
    ds_read_b64_tr_b16 v[238:239], v6 offset:12800
    v_mfma_f32_16x16x32_bf16 v[64:67], v[200:203], v[136:139], v[64:67]
    ds_read_b128 v[192:195], v2 offset:18432
    v_mfma_f32_16x16x32_bf16 v[64:67], v[204:207], v[140:143], v[64:67]
    ds_read_b128 v[196:199], v3 offset:18432
    v_mfma_f32_16x16x32_bf16 v[56:59], v[204:207], v[132:135], v[56:59]
    ds_read_b128 v[184:187], v4 offset:24576
    v_mfma_f32_16x16x32_bf16 v[56:59], v[200:203], v[128:131], v[56:59]
    ds_read_b128 v[188:191], v5 offset:24576
    v_mfma_f32_16x16x32_bf16 v[48:51], v[200:203], v[120:123], v[48:51]
    v_mfma_f32_16x16x32_bf16 v[48:51], v[204:207], v[124:127], v[48:51]
    s_waitcnt lgkmcnt(8)
    v_mfma_f32_16x16x32_bf16 v[52:55], v[228:231], v[124:127], v[52:55]
    ds_read_b64_tr_b16 v[200:201], v7 offset:0
    v_mfma_f32_16x16x32_bf16 v[52:55], v[224:227], v[120:123], v[52:55]
    ds_read_b64_tr_b16 v[202:203], v7 offset:512
    v_mfma_f32_16x16x32_bf16 v[60:63], v[224:227], v[128:131], v[60:63]
    ds_read_b64_tr_b16 v[204:205], v7 offset:12288
    v_mfma_f32_16x16x32_bf16 v[60:63], v[228:231], v[132:135], v[60:63]
    ds_read_b64_tr_b16 v[206:207], v7 offset:12800
    v_mfma_f32_16x16x32_bf16 v[68:71], v[228:231], v[140:143], v[68:71]
    ds_read_b128 v[176:179], v4 offset:22528
    v_mfma_f32_16x16x32_bf16 v[68:71], v[224:227], v[136:139], v[68:71]
    ds_read_b128 v[180:183], v5 offset:22528
    v_mfma_f32_16x16x32_bf16 v[76:79], v[224:227], v[144:147], v[76:79]
    ds_read_b128 v[168:171], v4 offset:20480
    v_mfma_f32_16x16x32_bf16 v[76:79], v[228:231], v[148:151], v[76:79]
    s_waitcnt lgkmcnt(11)
    v_mfma_f32_16x16x32_bf16 v[40:43], v[236:239], v[148:151], v[40:43]
    ds_read_b64_tr_b16 v[224:225], v6 offset:2048
    v_mfma_f32_16x16x32_bf16 v[40:43], v[232:235], v[144:147], v[40:43]
    ds_read_b64_tr_b16 v[226:227], v6 offset:2560
    v_mfma_f32_16x16x32_bf16 v[32:35], v[232:235], v[136:139], v[32:35]
    ds_read_b64_tr_b16 v[228:229], v6 offset:14336
    v_mfma_f32_16x16x32_bf16 v[32:35], v[236:239], v[140:143], v[32:35]
    ds_read_b64_tr_b16 v[230:231], v6 offset:14848
    v_mfma_f32_16x16x32_bf16 v[24:27], v[236:239], v[132:135], v[24:27]
    ds_read_b128 v[172:175], v5 offset:20480
    v_mfma_f32_16x16x32_bf16 v[24:27], v[232:235], v[128:131], v[24:27]
    ds_read_b128 v[160:163], v4 offset:18432
    v_mfma_f32_16x16x32_bf16 v[16:19], v[232:235], v[120:123], v[16:19]
    ds_read_b128 v[164:167], v5 offset:18432
    v_mfma_f32_16x16x32_bf16 v[16:19], v[236:239], v[124:127], v[16:19]
    s_waitcnt lgkmcnt(10)
    v_mfma_f32_16x16x32_bf16 v[20:23], v[204:207], v[124:127], v[20:23]
    ds_read_b64_tr_b16 v[232:233], v7 offset:2048
    v_mfma_f32_16x16x32_bf16 v[20:23], v[200:203], v[120:123], v[20:23]
    ds_read_b64_tr_b16 v[234:235], v7 offset:2560
    v_mfma_f32_16x16x32_bf16 v[28:31], v[200:203], v[128:131], v[28:31]
    ds_read_b64_tr_b16 v[236:237], v7 offset:14336
    v_mfma_f32_16x16x32_bf16 v[28:31], v[204:207], v[132:135], v[28:31]
    ds_read_b64_tr_b16 v[238:239], v7 offset:14848
    v_mfma_f32_16x16x32_bf16 v[36:39], v[204:207], v[140:143], v[36:39]
    buffer_load_dword v222, v220, s[68:71], s98 offen sc1
    v_mfma_f32_16x16x32_bf16 v[36:39], v[200:203], v[136:139], v[36:39]
    v_mfma_f32_16x16x32_bf16 v[44:47], v[200:203], v[144:147], v[44:47]
    v_mfma_f32_16x16x32_bf16 v[44:47], v[204:207], v[148:151], v[44:47]
    s_waitcnt lgkmcnt(7)
    v_mfma_f32_16x16x32_bf16 v[116:119], v[156:159], v[228:231], v[116:119]
    v_mfma_f32_16x16x32_bf16 v[116:119], v[152:155], v[224:227], v[116:119]
    v_mfma_f32_16x16x32_bf16 v[104:107], v[144:147], v[224:227], v[104:107]
    v_mfma_f32_16x16x32_bf16 v[104:107], v[148:151], v[228:231], v[104:107]
    v_mfma_f32_16x16x32_bf16 v[96:99], v[140:143], v[228:231], v[96:99]
    s_waitcnt lgkmcnt(0)
    s_barrier
    v_mfma_f32_16x16x32_bf16 v[96:99], v[136:139], v[224:227], v[96:99]
    ds_read_b64_tr_b16 v[200:201], v6 offset:25600
    v_mfma_f32_16x16x32_bf16 v[88:91], v[128:131], v[224:227], v[88:91]
    ds_read_b64_tr_b16 v[202:203], v6 offset:26112
    v_mfma_f32_16x16x32_bf16 v[88:91], v[132:135], v[228:231], v[88:91]
    ds_read_b64_tr_b16 v[204:205], v6 offset:37888
    v_mfma_f32_16x16x32_bf16 v[80:83], v[124:127], v[228:231], v[80:83]
    ds_read_b64_tr_b16 v[206:207], v6 offset:38400
    v_mfma_f32_16x16x32_bf16 v[80:83], v[120:123], v[224:227], v[80:83]
    v_mfma_f32_16x16x32_bf16 v[84:87], v[120:123], v[232:235], v[84:87]
    ds_read_b64_tr_b16 v[224:225], v7 offset:25600
    v_mfma_f32_16x16x32_bf16 v[84:87], v[124:127], v[236:239], v[84:87]
    ds_read_b64_tr_b16 v[226:227], v7 offset:26112
    v_mfma_f32_16x16x32_bf16 v[92:95], v[132:135], v[236:239], v[92:95]
    ds_read_b64_tr_b16 v[228:229], v7 offset:37888
    v_mfma_f32_16x16x32_bf16 v[92:95], v[128:131], v[232:235], v[92:95]
    ds_read_b64_tr_b16 v[230:231], v7 offset:38400
    v_mfma_f32_16x16x32_bf16 v[100:103], v[136:139], v[232:235], v[100:103]
    v_mfma_f32_16x16x32_bf16 v[100:103], v[140:143], v[236:239], v[100:103]
    v_mfma_f32_16x16x32_bf16 v[108:111], v[148:151], v[236:239], v[108:111]
    v_mfma_f32_16x16x32_bf16 v[108:111], v[144:147], v[232:235], v[108:111]
    s_waitcnt lgkmcnt(4)
    v_mfma_f32_16x16x32_bf16 v[112:115], v[200:203], v[192:195], v[112:115]
    ds_read_b64_tr_b16 v[232:233], v6 offset:24576
    v_mfma_f32_16x16x32_bf16 v[112:115], v[204:207], v[196:199], v[112:115]
    ds_read_b64_tr_b16 v[234:235], v6 offset:25088
    v_mfma_f32_16x16x32_bf16 v[72:75], v[204:207], v[188:191], v[72:75]
    ds_read_b64_tr_b16 v[236:237], v6 offset:36864
    v_mfma_f32_16x16x32_bf16 v[72:75], v[200:203], v[184:187], v[72:75]
    ds_read_b64_tr_b16 v[238:239], v6 offset:37376
    v_mfma_f32_16x16x32_bf16 v[64:67], v[200:203], v[176:179], v[64:67]
    ds_read_b128 v[152:155], v2 offset:36864
    v_mfma_f32_16x16x32_bf16 v[64:67], v[204:207], v[180:183], v[64:67]
    ds_read_b128 v[156:159], v3 offset:36864
    v_mfma_f32_16x16x32_bf16 v[56:59], v[204:207], v[172:175], v[56:59]
    ds_read_b128 v[144:147], v4 offset:43008
    v_mfma_f32_16x16x32_bf16 v[56:59], v[200:203], v[168:171], v[56:59]
    ds_read_b128 v[148:151], v5 offset:43008
    v_mfma_f32_16x16x32_bf16 v[48:51], v[200:203], v[160:163], v[48:51]
    v_mfma_f32_16x16x32_bf16 v[48:51], v[204:207], v[164:167], v[48:51]
    s_waitcnt lgkmcnt(8)
    v_mfma_f32_16x16x32_bf16 v[52:55], v[228:231], v[164:167], v[52:55]
    ds_read_b64_tr_b16 v[200:201], v7 offset:24576
    v_mfma_f32_16x16x32_bf16 v[52:55], v[224:227], v[160:163], v[52:55]
    ds_read_b64_tr_b16 v[202:203], v7 offset:25088
    v_mfma_f32_16x16x32_bf16 v[60:63], v[224:227], v[168:171], v[60:63]
    ds_read_b64_tr_b16 v[204:205], v7 offset:36864
    v_mfma_f32_16x16x32_bf16 v[60:63], v[228:231], v[172:175], v[60:63]
    ds_read_b64_tr_b16 v[206:207], v7 offset:37376
    v_mfma_f32_16x16x32_bf16 v[68:71], v[228:231], v[180:183], v[68:71]
    ds_read_b128 v[136:139], v4 offset:40960
    v_mfma_f32_16x16x32_bf16 v[68:71], v[224:227], v[176:179], v[68:71]
    ds_read_b128 v[140:143], v5 offset:40960
    v_mfma_f32_16x16x32_bf16 v[76:79], v[224:227], v[184:187], v[76:79]
    ds_read_b128 v[128:131], v4 offset:38912
    v_mfma_f32_16x16x32_bf16 v[76:79], v[228:231], v[188:191], v[76:79]
    s_waitcnt lgkmcnt(11)
    v_mfma_f32_16x16x32_bf16 v[40:43], v[236:239], v[188:191], v[40:43]
    ds_read_b64_tr_b16 v[224:225], v6 offset:26624
    v_mfma_f32_16x16x32_bf16 v[40:43], v[232:235], v[184:187], v[40:43]
    ds_read_b64_tr_b16 v[226:227], v6 offset:27136
    v_mfma_f32_16x16x32_bf16 v[32:35], v[232:235], v[176:179], v[32:35]
    ds_read_b64_tr_b16 v[228:229], v6 offset:38912
    v_mfma_f32_16x16x32_bf16 v[32:35], v[236:239], v[180:183], v[32:35]
    ds_read_b64_tr_b16 v[230:231], v6 offset:39424
    v_mfma_f32_16x16x32_bf16 v[24:27], v[236:239], v[172:175], v[24:27]
    ds_read_b128 v[132:135], v5 offset:38912
    v_mfma_f32_16x16x32_bf16 v[24:27], v[232:235], v[168:171], v[24:27]
    ds_read_b128 v[120:123], v4 offset:36864
    v_mfma_f32_16x16x32_bf16 v[16:19], v[232:235], v[160:163], v[16:19]
    ds_read_b128 v[124:127], v5 offset:36864
    v_mfma_f32_16x16x32_bf16 v[16:19], v[236:239], v[164:167], v[16:19]
    s_waitcnt lgkmcnt(10)
    v_mfma_f32_16x16x32_bf16 v[20:23], v[204:207], v[164:167], v[20:23]
    ds_read_b64_tr_b16 v[232:233], v7 offset:26624
    v_mfma_f32_16x16x32_bf16 v[20:23], v[200:203], v[160:163], v[20:23]
    ds_read_b64_tr_b16 v[234:235], v7 offset:27136
    v_mfma_f32_16x16x32_bf16 v[28:31], v[200:203], v[168:171], v[28:31]
    ds_read_b64_tr_b16 v[236:237], v7 offset:38912
    v_mfma_f32_16x16x32_bf16 v[28:31], v[204:207], v[172:175], v[28:31]
    ds_read_b64_tr_b16 v[238:239], v7 offset:39424
    v_mfma_f32_16x16x32_bf16 v[36:39], v[204:207], v[180:183], v[36:39]
    v_mfma_f32_16x16x32_bf16 v[36:39], v[200:203], v[176:179], v[36:39]
    v_mfma_f32_16x16x32_bf16 v[44:47], v[200:203], v[184:187], v[44:47]
    v_mfma_f32_16x16x32_bf16 v[44:47], v[204:207], v[188:191], v[44:47]
    s_waitcnt lgkmcnt(7)
    v_mfma_f32_16x16x32_bf16 v[116:119], v[196:199], v[228:231], v[116:119]
    v_mfma_f32_16x16x32_bf16 v[116:119], v[192:195], v[224:227], v[116:119]
    v_mfma_f32_16x16x32_bf16 v[104:107], v[184:187], v[224:227], v[104:107]
    v_mfma_f32_16x16x32_bf16 v[104:107], v[188:191], v[228:231], v[104:107]
    v_mfma_f32_16x16x32_bf16 v[96:99], v[180:183], v[228:231], v[96:99]
    s_waitcnt lgkmcnt(0)
    s_barrier
    v_mfma_f32_16x16x32_bf16 v[96:99], v[176:179], v[224:227], v[96:99]
    ds_read_b64_tr_b16 v[200:201], v6 offset:50176
    v_mfma_f32_16x16x32_bf16 v[88:91], v[168:171], v[224:227], v[88:91]
    ds_read_b64_tr_b16 v[202:203], v6 offset:50688
    v_mfma_f32_16x16x32_bf16 v[88:91], v[172:175], v[228:231], v[88:91]
    ds_read_b64_tr_b16 v[204:205], v6 offset:62464
    v_mfma_f32_16x16x32_bf16 v[80:83], v[164:167], v[228:231], v[80:83]
    ds_read_b64_tr_b16 v[206:207], v6 offset:62976
    v_mfma_f32_16x16x32_bf16 v[80:83], v[160:163], v[224:227], v[80:83]
    v_mfma_f32_16x16x32_bf16 v[84:87], v[160:163], v[232:235], v[84:87]
    ds_read_b64_tr_b16 v[224:225], v7 offset:50176
    v_mfma_f32_16x16x32_bf16 v[84:87], v[164:167], v[236:239], v[84:87]
    ds_read_b64_tr_b16 v[226:227], v7 offset:50688
    v_mfma_f32_16x16x32_bf16 v[92:95], v[172:175], v[236:239], v[92:95]
    ds_read_b64_tr_b16 v[228:229], v7 offset:62464
    v_mfma_f32_16x16x32_bf16 v[92:95], v[168:171], v[232:235], v[92:95]
    ds_read_b64_tr_b16 v[230:231], v7 offset:62976
    v_mfma_f32_16x16x32_bf16 v[100:103], v[176:179], v[232:235], v[100:103]
    v_mfma_f32_16x16x32_bf16 v[100:103], v[180:183], v[236:239], v[100:103]
    v_mfma_f32_16x16x32_bf16 v[108:111], v[188:191], v[236:239], v[108:111]
    v_mfma_f32_16x16x32_bf16 v[108:111], v[184:187], v[232:235], v[108:111]
    s_waitcnt lgkmcnt(4)
    v_mfma_f32_16x16x32_bf16 v[112:115], v[200:203], v[152:155], v[112:115]
    ds_read_b64_tr_b16 v[232:233], v6 offset:49152
    v_mfma_f32_16x16x32_bf16 v[112:115], v[204:207], v[156:159], v[112:115]
    ds_read_b64_tr_b16 v[234:235], v6 offset:49664
    v_mfma_f32_16x16x32_bf16 v[72:75], v[204:207], v[148:151], v[72:75]
    ds_read_b64_tr_b16 v[236:237], v6 offset:61440
    v_mfma_f32_16x16x32_bf16 v[72:75], v[200:203], v[144:147], v[72:75]
    ds_read_b64_tr_b16 v[238:239], v6 offset:61952
    v_mfma_f32_16x16x32_bf16 v[64:67], v[200:203], v[136:139], v[64:67]
    ds_read_b128 v[192:195], v2 offset:0
    v_mfma_f32_16x16x32_bf16 v[64:67], v[204:207], v[140:143], v[64:67]
    ds_read_b128 v[196:199], v3 offset:0
    v_mfma_f32_16x16x32_bf16 v[56:59], v[204:207], v[132:135], v[56:59]
    ds_read_b128 v[184:187], v4 offset:6144
    v_mfma_f32_16x16x32_bf16 v[56:59], v[200:203], v[128:131], v[56:59]
    ds_read_b128 v[188:191], v5 offset:6144
    v_mfma_f32_16x16x32_bf16 v[48:51], v[200:203], v[120:123], v[48:51]
    v_mfma_f32_16x16x32_bf16 v[48:51], v[204:207], v[124:127], v[48:51]
    s_waitcnt lgkmcnt(8)
    v_mfma_f32_16x16x32_bf16 v[52:55], v[228:231], v[124:127], v[52:55]
    ds_read_b64_tr_b16 v[200:201], v7 offset:49152
    v_mfma_f32_16x16x32_bf16 v[52:55], v[224:227], v[120:123], v[52:55]
    ds_read_b64_tr_b16 v[202:203], v7 offset:49664
    v_mfma_f32_16x16x32_bf16 v[60:63], v[224:227], v[128:131], v[60:63]
    ds_read_b64_tr_b16 v[204:205], v7 offset:61440
    v_mfma_f32_16x16x32_bf16 v[60:63], v[228:231], v[132:135], v[60:63]
    ds_read_b64_tr_b16 v[206:207], v7 offset:61952
    v_mfma_f32_16x16x32_bf16 v[68:71], v[228:231], v[140:143], v[68:71]
    ds_read_b128 v[176:179], v4 offset:4096
    v_mfma_f32_16x16x32_bf16 v[68:71], v[224:227], v[136:139], v[68:71]
    ds_read_b128 v[180:183], v5 offset:4096
    v_mfma_f32_16x16x32_bf16 v[76:79], v[224:227], v[144:147], v[76:79]
    ds_read_b128 v[168:171], v4 offset:2048
    v_mfma_f32_16x16x32_bf16 v[76:79], v[228:231], v[148:151], v[76:79]
    s_waitcnt lgkmcnt(11)
    v_mfma_f32_16x16x32_bf16 v[40:43], v[236:239], v[148:151], v[40:43]
    ds_read_b64_tr_b16 v[224:225], v6 offset:51200
    v_mfma_f32_16x16x32_bf16 v[40:43], v[232:235], v[144:147], v[40:43]
    ds_read_b64_tr_b16 v[226:227], v6 offset:51712
    v_mfma_f32_16x16x32_bf16 v[32:35], v[232:235], v[136:139], v[32:35]
    ds_read_b64_tr_b16 v[228:229], v6 offset:63488
    v_mfma_f32_16x16x32_bf16 v[32:35], v[236:239], v[140:143], v[32:35]
    ds_read_b64_tr_b16 v[230:231], v6 offset:64000
    v_mfma_f32_16x16x32_bf16 v[24:27], v[236:239], v[132:135], v[24:27]
    ds_read_b128 v[172:175], v5 offset:2048
    v_mfma_f32_16x16x32_bf16 v[24:27], v[232:235], v[128:131], v[24:27]
    ds_read_b128 v[160:163], v4 offset:0
    v_mfma_f32_16x16x32_bf16 v[16:19], v[232:235], v[120:123], v[16:19]
    ds_read_b128 v[164:167], v5 offset:0
    v_mfma_f32_16x16x32_bf16 v[16:19], v[236:239], v[124:127], v[16:19]
    s_waitcnt lgkmcnt(10)
    v_mfma_f32_16x16x32_bf16 v[20:23], v[204:207], v[124:127], v[20:23]
    ds_read_b64_tr_b16 v[232:233], v7 offset:51200
    v_mfma_f32_16x16x32_bf16 v[20:23], v[200:203], v[120:123], v[20:23]
    ds_read_b64_tr_b16 v[234:235], v7 offset:51712
    v_mfma_f32_16x16x32_bf16 v[28:31], v[200:203], v[128:131], v[28:31]
    ds_read_b64_tr_b16 v[236:237], v7 offset:63488
    v_mfma_f32_16x16x32_bf16 v[28:31], v[204:207], v[132:135], v[28:31]
    ds_read_b64_tr_b16 v[238:239], v7 offset:64000
    v_mfma_f32_16x16x32_bf16 v[36:39], v[204:207], v[140:143], v[36:39]
    v_mfma_f32_16x16x32_bf16 v[36:39], v[200:203], v[136:139], v[36:39]
    v_mfma_f32_16x16x32_bf16 v[44:47], v[200:203], v[144:147], v[44:47]
    v_mfma_f32_16x16x32_bf16 v[44:47], v[204:207], v[148:151], v[44:47]
    s_waitcnt lgkmcnt(7)
    v_mfma_f32_16x16x32_bf16 v[116:119], v[156:159], v[228:231], v[116:119]
    v_mfma_f32_16x16x32_bf16 v[116:119], v[152:155], v[224:227], v[116:119]
    v_mfma_f32_16x16x32_bf16 v[104:107], v[144:147], v[224:227], v[104:107]
    v_mfma_f32_16x16x32_bf16 v[104:107], v[148:151], v[228:231], v[104:107]
    v_mfma_f32_16x16x32_bf16 v[96:99], v[140:143], v[228:231], v[96:99]
    s_waitcnt lgkmcnt(0)
    s_barrier
    s_cmp_lg_u32 s3, 0
    s_cbranch_scc1 LB_sk
    s_waitcnt vmcnt(0)
    v_cmp_eq_u32 vcc, 0, v222
    s_cbranch_vccnz LB_slow
LB_back:
    s_mov_b64 exec, 1
    buffer_store_dword v222, v220, s[52:55], s96 offen sc1
    s_mov_b64 exec, -1
LB_sk:
    v_mfma_f32_16x16x32_bf16 v[96:99], v[136:139], v[224:227], v[96:99]
    ds_read_b64_tr_b16 v[200:201], v6 offset:1024
    v_mfma_f32_16x16x32_bf16 v[88:91], v[128:131], v[224:227], v[88:91]
    ds_read_b64_tr_b16 v[202:203], v6 offset:1536
    v_mfma_f32_16x16x32_bf16 v[88:91], v[132:135], v[228:231], v[88:91]
    ds_read_b64_tr_b16 v[204:205], v6 offset:13312
    v_mfma_f32_16x16x32_bf16 v[80:83], v[124:127], v[228:231], v[80:83]
    ds_read_b64_tr_b16 v[206:207], v6 offset:13824
    v_mfma_f32_16x16x32_bf16 v[80:83], v[120:123], v[224:227], v[80:83]
    v_mfma_f32_16x16x32_bf16 v[84:87], v[120:123], v[232:235], v[84:87]
    ds_read_b64_tr_b16 v[224:225], v7 offset:1024
    v_mfma_f32_16x16x32_bf16 v[84:87], v[124:127], v[236:239], v[84:87]
    ds_read_b64_tr_b16 v[226:227], v7 offset:1536
    v_mfma_f32_16x16x32_bf16 v[92:95], v[132:135], v[236:239], v[92:95]
    ds_read_b64_tr_b16 v[228:229], v7 offset:13312
    v_mfma_f32_16x16x32_bf16 v[92:95], v[128:131], v[232:235], v[92:95]
    ds_read_b64_tr_b16 v[230:231], v7 offset:13824
    v_mfma_f32_16x16x32_bf16 v[100:103], v[136:139], v[232:235], v[100:103]
    v_mfma_f32_16x16x32_bf16 v[100:103], v[140:143], v[236:239], v[100:103]
    v_mfma_f32_16x16x32_bf16 v[108:111], v[148:151], v[236:239], v[108:111]
    v_mfma_f32_16x16x32_bf16 v[108:111], v[144:147], v[232:235], v[108:111]
    s_waitcnt lgkmcnt(4)
    v_mfma_f32_16x16x32_bf16 v[112:115], v[200:203], v[192:195], v[112:115]
    ds_read_b64_tr_b16 v[232:233], v6 offset:0
    v_mfma_f32_16x16x32_bf16 v[112:115], v[204:207], v[196:199], v[112:115]
    ds_read_b64_tr_b16 v[234:235], v6 offset:512
    v_mfma_f32_16x16x32_bf16 v[72:75], v[204:207], v[188:191], v[72:75]
    ds_read_b64_tr_b16 v[236:237], v6 offset:12288
    v_mfma_f32_16x16x32_bf16 v[72:75], v[200:203], v[184:187], v[72:75]
    ds_read_b64_tr_b16 v[238:239], v6 offset:12800
    v_mfma_f32_16x16x32_bf16 v[64:67], v[200:203], v[176:179], v[64:67]
    ds_read_b128 v[152:155], v2 offset:18432
    v_mfma_f32_16x16x32_bf16 v[64:67], v[204:207], v[180:183], v[64:67]
    ds_read_b128 v[156:159], v3 offset:18432
    v_mfma_f32_16x16x32_bf16 v[56:59], v[204:207], v[172:175], v[56:59]
    ds_read_b128 v[144:147], v4 offset:24576
    v_mfma_f32_16x16x32_bf16 v[56:59], v[200:203], v[168:171], v[56:59]
    ds_read_b128 v[148:151], v5 offset:24576
    v_mfma_f32_16x16x32_bf16 v[48:51], v[200:203], v[160:163], v[48:51]
    v_mfma_f32_16x16x32_bf16 v[48:51], v[204:207], v[164:167], v[48:51]
    s_waitcnt lgkmcnt(8)
    v_mfma_f32_16x16x32_bf16 v[52:55], v[228:231], v[164:167], v[52:55]
    ds_read_b64_tr_b16 v[200:201], v7 offset:0
    v_mfma_f32_16x16x32_bf16 v[52:55], v[224:227], v[160:163], v[52:55]
    ds_read_b64_tr_b16 v[202:203], v7 offset:512
    v_mfma_f32_16x16x32_bf16 v[60:63], v[224:227], v[168:171], v[60:63]
    ds_read_b64_tr_b16 v[204:205], v7 offset:12288
    v_mfma_f32_16x16x32_bf16 v[60:63], v[228:231], v[172:175], v[60:63]
    ds_read_b64_tr_b16 v[206:207], v7 offset:12800
    v_mfma_f32_16x16x32_bf16 v[68:71], v[228:231], v[180:183], v[68:71]
    ds_read_b128 v[136:139], v4 offset:22528
    v_mfma_f32_16x16x32_bf16 v[68:71], v[224:227], v[176:179], v[68:71]
    ds_read_b128 v[140:143], v5 offset:22528
    v_mfma_f32_16x16x32_bf16 v[76:79], v[224:227], v[184:187], v[76:79]
    ds_read_b128 v[128:131], v4 offset:20480
    v_mfma_f32_16x16x32_bf16 v[76:79], v[228:231], v[188:191], v[76:79]
    s_waitcnt lgkmcnt(11)
    v_mfma_f32_16x16x32_bf16 v[40:43], v[236:239], v[188:191], v[40:43]
    ds_read_b64_tr_b16 v[224:225], v6 offset:2048
    v_mfma_f32_16x16x32_bf16 v[40:43], v[232:235], v[184:187], v[40:43]
    ds_read_b64_tr_b16 v[226:227], v6 offset:2560
    v_mfma_f32_16x16x32_bf16 v[32:35], v[232:235], v[176:179], v[32:35]
    ds_read_b64_tr_b16 v[228:229], v6 offset:14336
    v_mfma_f32_16x16x32_bf16 v[32:35], v[236:239], v[180:183], v[32:35]
    ds_read_b64_tr_b16 v[230:231], v6 offset:14848
    v_mfma_f32_16x16x32_bf16 v[24:27], v[236:239], v[172:175], v[24:27]
    ds_read_b128 v[132:135], v5 offset:20480
    v_mfma_f32_16x16x32_bf16 v[24:27], v[232:235], v[168:171], v[24:27]
    ds_read_b128 v[120:123], v4 offset:18432
    v_mfma_f32_16x16x32_bf16 v[16:19], v[232:235], v[160:163], v[16:19]
    ds_read_b128 v[124:127], v5 offset:18432
    v_mfma_f32_16x16x32_bf16 v[16:19], v[236:239], v[164:167], v[16:19]
    s_waitcnt lgkmcnt(10)
    v_mfma_f32_16x16x32_bf16 v[20:23], v[204:207], v[164:167], v[20:23]
    ds_read_b64_tr_b16 v[232:233], v7 offset:2048
    v_mfma_f32_16x16x32_bf16 v[20:23], v[200:203], v[160:163], v[20:23]
    ds_read_b64_tr_b16 v[234:235], v7 offset:2560
    v_mfma_f32_16x16x32_bf16 v[28:31], v[200:203], v[168:171], v[28:31]
    ds_read_b64_tr_b16 v[236:237], v7 offset:14336
    v_mfma_f32_16x16x32_bf16 v[28:31], v[204:207], v[172:175], v[28:31]
    ds_read_b64_tr_b16 v[238:239], v7 offset:14848
    v_mfma_f32_16x16x32_bf16 v[36:39], v[204:207], v[180:183], v[36:39]
    v_mfma_f32_16x16x32_bf16 v[36:39], v[200:203], v[176:179], v[36:39]
    v_mfma_f32_16x16x32_bf16 v[44:47], v[200:203], v[184:187], v[44:47]
    v_mfma_f32_16x16x32_bf16 v[44:47], v[204:207], v[188:191], v[44:47]
    s_waitcnt lgkmcnt(7)
    v_mfma_f32_16x16x32_bf16 v[116:119], v[196:199], v[228:231], v[116:119]
    v_mfma_f32_16x16x32_bf16 v[116:119], v[192:195], v[224:227], v[116:119]
    v_mfma_f32_16x16x32_bf16 v[104:107], v[184:187], v[224:227], v[104:107]
    v_mfma_f32_16x16x32_bf16 v[104:107], v[188:191], v[228:231], v[104:107]
    v_mfma_f32_16x16x32_bf16 v[96:99], v[180:183], v[228:231], v[96:99]
    s_waitcnt lgkmcnt(0)
    s_barrier
    v_mfma_f32_16x16x32_bf16 v[96:99], v[176:179], v[224:227], v[96:99]
    ds_read_b64_tr_b16 v[200:201], v6 offset:25600
    v_mfma_f32_16x16x32_bf16 v[88:91], v[168:171], v[224:227], v[88:91]
    ds_read_b64_tr_b16 v[202:203], v6 offset:26112
    v_mfma_f32_16x16x32_bf16 v[88:91], v[172:175], v[228:231], v[88:91]
    ds_read_b64_tr_b16 v[204:205], v6 offset:37888
    v_mfma_f32_16x16x32_bf16 v[80:83], v[164:167], v[228:231], v[80:83]
    ds_read_b64_tr_b16 v[206:207], v6 offset:38400
    v_mfma_f32_16x16x32_bf16 v[80:83], v[160:163], v[224:227], v[80:83]
    v_mfma_f32_16x16x32_bf16 v[84:87], v[160:163], v[232:235], v[84:87]
    ds_read_b64_tr_b16 v[224:225], v7 offset:25600
    v_mfma_f32_16x16x32_bf16 v[84:87], v[164:167], v[236:239], v[84:87]
    ds_read_b64_tr_b16 v[226:227], v7 offset:26112
    v_mfma_f32_16x16x32_bf16 v[92:95], v[172:175], v[236:239], v[92:95]
    ds_read_b64_tr_b16 v[228:229], v7 offset:37888
    v_mfma_f32_16x16x32_bf16 v[92:95], v[168:171], v[232:235], v[92:95]
    ds_read_b64_tr_b16 v[230:231], v7 offset:38400
    v_mfma_f32_16x16x32_bf16 v[100:103], v[176:179], v[232:235], v[100:103]
    v_mfma_f32_16x16x32_bf16 v[100:103], v[180:183], v[236:239], v[100:103]
    v_mfma_f32_16x16x32_bf16 v[108:111], v[188:191], v[236:239], v[108:111]
    v_mfma_f32_16x16x32_bf16 v[108:111], v[184:187], v[232:235], v[108:111]
    s_waitcnt lgkmcnt(4)
    v_mfma_f32_16x16x32_bf16 v[112:115], v[200:203], v[152:155], v[112:115]
    ds_read_b64_tr_b16 v[232:233], v6 offset:24576
    v_mfma_f32_16x16x32_bf16 v[112:115], v[204:207], v[156:159], v[112:115]
    ds_read_b64_tr_b16 v[234:235], v6 offset:25088
    v_mfma_f32_16x16x32_bf16 v[72:75], v[204:207], v[148:151], v[72:75]
    ds_read_b64_tr_b16 v[236:237], v6 offset:36864
    v_mfma_f32_16x16x32_bf16 v[72:75], v[200:203], v[144:147], v[72:75]
    ds_read_b64_tr_b16 v[238:239], v6 offset:37376
    v_mfma_f32_16x16x32_bf16 v[64:67], v[200:203], v[136:139], v[64:67]
    ds_read_b128 v[192:195], v2 offset:36864
    v_mfma_f32_16x16x32_bf16 v[64:67], v[204:207], v[140:143], v[64:67]
    ds_read_b128 v[196:199], v3 offset:36864
    v_mfma_f32_16x16x32_bf16 v[56:59], v[204:207], v[132:135], v[56:59]
    ds_read_b128 v[184:187], v4 offset:43008
    v_mfma_f32_16x16x32_bf16 v[56:59], v[200:203], v[128:131], v[56:59]
    ds_read_b128 v[188:191], v5 offset:43008
    v_mfma_f32_16x16x32_bf16 v[48:51], v[200:203], v[120:123], v[48:51]
    v_mfma_f32_16x16x32_bf16 v[48:51], v[204:207], v[124:127], v[48:51]
    s_waitcnt lgkmcnt(8)
    v_mfma_f32_16x16x32_bf16 v[52:55], v[228:231], v[124:127], v[52:55]
    ds_read_b64_tr_b16 v[200:201], v7 offset:24576
    v_mfma_f32_16x16x32_bf16 v[52:55], v[224:227], v[120:123], v[52:55]
    ds_read_b64_tr_b16 v[202:203], v7 offset:25088
    v_mfma_f32_16x16x32_bf16 v[60:63], v[224:227], v[128:131], v[60:63]
    ds_read_b64_tr_b16 v[204:205], v7 offset:36864
    v_mfma_f32_16x16x32_bf16 v[60:63], v[228:231], v[132:135], v[60:63]
    ds_read_b64_tr_b16 v[206:207], v7 offset:37376
    v_mfma_f32_16x16x32_bf16 v[68:71], v[228:231], v[140:143], v[68:71]
    ds_read_b128 v[176:179], v4 offset:40960
    v_mfma_f32_16x16x32_bf16 v[68:71], v[224:227], v[136:139], v[68:71]
    ds_read_b128 v[180:183], v5 offset:40960
    v_mfma_f32_16x16x32_bf16 v[76:79], v[224:227], v[144:147], v[76:79]
    ds_read_b128 v[168:171], v4 offset:38912
    v_mfma_f32_16x16x32_bf16 v[76:79], v[228:231], v[148:151], v[76:79]
    s_waitcnt lgkmcnt(11)
    v_mfma_f32_16x16x32_bf16 v[40:43], v[236:239], v[148:151], v[40:43]
    ds_read_b64_tr_b16 v[224:225], v6 offset:26624
    v_mfma_f32_16x16x32_bf16 v[40:43], v[232:235], v[144:147], v[40:43]
    ds_read_b64_tr_b16 v[226:227], v6 offset:27136
    v_mfma_f32_16x16x32_bf16 v[32:35], v[232:235], v[136:139], v[32:35]
    ds_read_b64_tr_b16 v[228:229], v6 offset:38912
    v_mfma_f32_16x16x32_bf16 v[32:35], v[236:239], v[140:143], v[32:35]
    ds_read_b64_tr_b16 v[230:231], v6 offset:39424
    v_mfma_f32_16x16x32_bf16 v[24:27], v[236:239], v[132:135], v[24:27]
    ds_read_b128 v[172:175], v5 offset:38912
    v_mfma_f32_16x16x32_bf16 v[24:27], v[232:235], v[128:131], v[24:27]
    ds_read_b128 v[160:163], v4 offset:36864
    v_mfma_f32_16x16x32_bf16 v[16:19], v[232:235], v[120:123], v[16:19]
    ds_read_b128 v[164:167], v5 offset:36864
    v_mfma_f32_16x16x32_bf16 v[16:19], v[236:239], v[124:127], v[16:19]
    s_waitcnt lgkmcnt(10)
    v_mfma_f32_16x16x32_bf16 v[20:23], v[204:207], v[124:127], v[20:23]
    ds_read_b64_tr_b16 v[232:233], v7 offset:26624
    v_mfma_f32_16x16x32_bf16 v[20:23], v[200:203], v[120:123], v[20:23]
    ds_read_b64_tr_b16 v[234:235], v7 offset:27136
    v_mfma_f32_16x16x32_bf16 v[28:31], v[200:203], v[128:131], v[28:31]
    ds_read_b64_tr_b16 v[236:237], v7 offset:38912
    v_mfma_f32_16x16x32_bf16 v[28:31], v[204:207], v[132:135], v[28:31]
    ds_read_b64_tr_b16 v[238:239], v7 offset:39424
    v_mfma_f32_16x16x32_bf16 v[36:39], v[204:207], v[140:143], v[36:39]
    v_mfma_f32_16x16x32_bf16 v[36:39], v[200:203], v[136:139], v[36:39]
    v_mfma_f32_16x16x32_bf16 v[44:47], v[200:203], v[144:147], v[44:47]
    v_mfma_f32_16x16x32_bf16 v[44:47], v[204:207], v[148:151], v[44:47]
    s_waitcnt lgkmcnt(7)
    v_mfma_f32_16x16x32_bf16 v[116:119], v[156:159], v[228:231], v[116:119]
    v_mfma_f32_16x16x32_bf16 v[116:119], v[152:155], v[224:227], v[116:119]
    v_mfma_f32_16x16x32_bf16 v[104:107], v[144:147], v[224:227], v[104:107]
    v_mfma_f32_16x16x32_bf16 v[104:107], v[148:151], v[228:231], v[104:107]
    v_mfma_f32_16x16x32_bf16 v[96:99], v[140:143], v[228:231], v[96:99]
    s_waitcnt lgkmcnt(0)
    s_barrier
    v_mfma_f32_16x16x32_bf16 v[96:99], v[136:139], v[224:227], v[96:99]
    ds_read_b64_tr_b16 v[200:201], v6 offset:50176
    v_mfma_f32_16x16x32_bf16 v[88:91], v[128:131], v[224:227], v[88:91]
    ds_read_b64_tr_b16 v[202:203], v6 offset:50688
    v_mfma_f32_16x16x32_bf16 v[88:91], v[132:135], v[228:231], v[88:91]
    ds_read_b64_tr_b16 v[204:205], v6 offset:62464
    v_mfma_f32_16x16x32_bf16 v[80:83], v[124:127], v[228:231], v[80:83]
    ds_read_b64_tr_b16 v[206:207], v6 offset:62976
    v_mfma_f32_16x16x32_bf16 v[80:83], v[120:123], v[224:227], v[80:83]
    v_mfma_f32_16x16x32_bf16 v[84:87], v[120:123], v[232:235], v[84:87]
    ds_read_b64_tr_b16 v[224:225], v7 offset:50176
    v_mfma_f32_16x16x32_bf16 v[84:87], v[124:127], v[236:239], v[84:87]
    ds_read_b64_tr_b16 v[226:227], v7 offset:50688
    v_mfma_f32_16x16x32_bf16 v[92:95], v[132:135], v[236:239], v[92:95]
    ds_read_b64_tr_b16 v[228:229], v7 offset:62464
    v_mfma_f32_16x16x32_bf16 v[92:95], v[128:131], v[232:235], v[92:95]
    ds_read_b64_tr_b16 v[230:231], v7 offset:62976
    v_mfma_f32_16x16x32_bf16 v[100:103], v[136:139], v[232:235], v[100:103]
    v_mfma_f32_16x16x32_bf16 v[100:103], v[140:143], v[236:239], v[100:103]
    v_mfma_f32_16x16x32_bf16 v[108:111], v[148:151], v[236:239], v[108:111]
    v_mfma_f32_16x16x32_bf16 v[108:111], v[144:147], v[232:235], v[108:111]
    s_waitcnt lgkmcnt(4)
    v_mfma_f32_16x16x32_bf16 v[112:115], v[200:203], v[192:195], v[112:115]
    ds_read_b64_tr_b16 v[232:233], v6 offset:49152
    v_mfma_f32_16x16x32_bf16 v[112:115], v[204:207], v[196:199], v[112:115]
    ds_read_b64_tr_b16 v[234:235], v6 offset:49664
    v_mfma_f32_16x16x32_bf16 v[72:75], v[204:207], v[188:191], v[72:75]
    ds_read_b64_tr_b16 v[236:237], v6 offset:61440
    v_mfma_f32_16x16x32_bf16 v[72:75], v[200:203], v[184:187], v[72:75]
    ds_read_b64_tr_b16 v[238:239], v6 offset:61952
    v_mfma_f32_16x16x32_bf16 v[64:67], v[200:203], v[176:179], v[64:67]
    ds_read_b128 v[152:155], v2 offset:0
    v_mfma_f32_16x16x32_bf16 v[64:67], v[204:207], v[180:183], v[64:67]
    ds_read_b128 v[156:159], v3 offset:0
    v_mfma_f32_16x16x32_bf16 v[56:59], v[204:207], v[172:175], v[56:59]
    ds_read_b128 v[144:147], v4 offset:6144
    v_mfma_f32_16x16x32_bf16 v[56:59], v[200:203], v[168:171], v[56:59]
    ds_read_b128 v[148:151], v5 offset:6144
    v_mfma_f32_16x16x32_bf16 v[48:51], v[200:203], v[160:163], v[48:51]
    v_mfma_f32_16x16x32_bf16 v[48:51], v[204:207], v[164:167], v[48:51]
    s_waitcnt lgkmcnt(8)
    v_mfma_f32_16x16x32_bf16 v[52:55], v[228:231], v[164:167], v[52:55]
    ds_read_b64_tr_b16 v[200:201], v7 offset:49152
    v_mfma_f32_16x16x32_bf16 v[52:55], v[224:227], v[160:163], v[52:55]
    ds_read_b64_tr_b16 v[202:203], v7 offset:49664
    v_mfma_f32_16x16x32_bf16 v[60:63], v[224:227], v[168:171], v[60:63]
    ds_read_b64_tr_b16 v[204:205], v7 offset:61440
    v_mfma_f32_16x16x32_bf16 v[60:63], v[228:231], v[172:175], v[60:63]
    ds_read_b64_tr_b16 v[206:207], v7 offset:61952
    v_mfma_f32_16x16x32_bf16 v[68:71], v[228:231], v[180:183], v[68:71]
    ds_read_b128 v[136:139], v4 offset:4096
    v_mfma_f32_16x16x32_bf16 v[68:71], v[224:227], v[176:179], v[68:71]
    ds_read_b128 v[140:143], v5 offset:4096
    v_mfma_f32_16x16x32_bf16 v[76:79], v[224:227], v[184:187], v[76:79]
    ds_read_b128 v[128:131], v4 offset:2048
    v_mfma_f32_16x16x32_bf16 v[76:79], v[228:231], v[188:191], v[76:79]
    s_waitcnt lgkmcnt(11)
    v_mfma_f32_16x16x32_bf16 v[40:43], v[236:239], v[188:191], v[40:43]
    ds_read_b64_tr_b16 v[224:225], v6 offset:51200
    v_mfma_f32_16x16x32_bf16 v[40:43], v[232:235], v[184:187], v[40:43]
    ds_read_b64_tr_b16 v[226:227], v6 offset:51712
    v_mfma_f32_16x16x32_bf16 v[32:35], v[232:235], v[176:179], v[32:35]
    ds_read_b64_tr_b16 v[228:229], v6 offset:63488
    v_mfma_f32_16x16x32_bf16 v[32:35], v[236:239], v[180:183], v[32:35]
    ds_read_b64_tr_b16 v[230:231], v6 offset:64000
    v_mfma_f32_16x16x32_bf16 v[24:27], v[236:239], v[172:175], v[24:27]
    ds_read_b128 v[132:135], v5 offset:2048
    v_mfma_f32_16x16x32_bf16 v[24:27], v[232:235], v[168:171], v[24:27]
    ds_read_b128 v[120:123], v4 offset:0
    v_mfma_f32_16x16x32_bf16 v[16:19], v[232:235], v[160:163], v[16:19]
    ds_read_b128 v[124:127], v5 offset:0
    v_mfma_f32_16x16x32_bf16 v[16:19], v[236:239], v[164:167], v[16:19]
    s_waitcnt lgkmcnt(10)
    v_mfma_f32_16x16x32_bf16 v[20:23], v[204:207], v[164:167], v[20:23]
    ds_read_b64_tr_b16 v[232:233], v7 offset:51200
    v_mfma_f32_16x16x32_bf16 v[20:23], v[200:203], v[160:163], v[20:23]
    ds_read_b64_tr_b16 v[234:235], v7 offset:51712
    v_mfma_f32_16x16x32_bf16 v[28:31], v[200:203], v[168:171], v[28:31]
    ds_read_b64_tr_b16 v[236:237], v7 offset:63488
    v_mfma_f32_16x16x32_bf16 v[28:31], v[204:207], v[172:175], v[28:31]
    ds_read_b64_tr_b16 v[238:239], v7 offset:64000
    v_mfma_f32_16x16x32_bf16 v[36:39], v[204:207], v[180:183], v[36:39]
    v_mfma_f32_16x16x32_bf16 v[36:39], v[200:203], v[176:179], v[36:39]
    v_mfma_f32_16x16x32_bf16 v[44:47], v[200:203], v[184:187], v[44:47]
    v_mfma_f32_16x16x32_bf16 v[44:47], v[204:207], v[188:191], v[44:47]
    s_waitcnt lgkmcnt(7)
    v_mfma_f32_16x16x32_bf16 v[116:119], v[196:199], v[228:231], v[116:119]
    v_mfma_f32_16x16x32_bf16 v[116:119], v[192:195], v[224:227], v[116:119]
    v_mfma_f32_16x16x32_bf16 v[104:107], v[184:187], v[224:227], v[104:107]
    v_mfma_f32_16x16x32_bf16 v[104:107], v[188:191], v[228:231], v[104:107]
    v_mfma_f32_16x16x32_bf16 v[96:99], v[180:183], v[228:231], v[96:99]
    s_waitcnt lgkmcnt(0)
    s_barrier
    v_mfma_f32_16x16x32_bf16 v[96:99], v[176:179], v[224:227], v[96:99]
    ds_read_b64_tr_b16 v[200:201], v6 offset:1024
    v_mfma_f32_16x16x32_bf16 v[88:91], v[168:171], v[224:227], v[88:91]
    ds_read_b64_tr_b16 v[202:203], v6 offset:1536
    v_mfma_f32_16x16x32_bf16 v[88:91], v[172:175], v[228:231], v[88:91]
    ds_read_b64_tr_b16 v[204:205], v6 offset:13312
    v_mfma_f32_16x16x32_bf16 v[80:83], v[164:167], v[228:231], v[80:83]
    ds_read_b64_tr_b16 v[206:207], v6 offset:13824
    v_mfma_f32_16x16x32_bf16 v[80:83], v[160:163], v[224:227], v[80:83]
    v_mfma_f32_16x16x32_bf16 v[84:87], v[160:163], v[232:235], v[84:87]
    ds_read_b64_tr_b16 v[224:225], v7 offset:1024
    v_mfma_f32_16x16x32_bf16 v[84:87], v[164:167], v[236:239], v[84:87]
    ds_read_b64_tr_b16 v[226:227], v7 offset:1536
    v_mfma_f32_16x16x32_bf16 v[92:95], v[172:175], v[236:239], v[92:95]
    ds_read_b64_tr_b16 v[228:229], v7 offset:13312
    v_mfma_f32_16x16x32_bf16 v[92:95], v[168:171], v[232:235], v[92:95]
    ds_read_b64_tr_b16 v[230:231], v7 offset:13824
    v_mfma_f32_16x16x32_bf16 v[100:103], v[176:179], v[232:235], v[100:103]
    v_mfma_f32_16x16x32_bf16 v[100:103], v[180:183], v[236:239], v[100:103]
    v_mfma_f32_16x16x32_bf16 v[108:111], v[188:191], v[236:239], v[108:111]
    v_mfma_f32_16x16x32_bf16 v[108:111], v[184:187], v[232:235], v[108:111]
    s_waitcnt lgkmcnt(4)
    v_mfma_f32_16x16x32_bf16 v[112:115], v[200:203], v[152:155], v[112:115]
    ds_read_b64_tr_b16 v[232:233], v6 offset:0
    v_mfma_f32_16x16x32_bf16 v[112:115], v[204:207], v[156:159], v[112:115]
    ds_read_b64_tr_b16 v[234:235], v6 offset:512
    v_mfma_f32_16x16x32_bf16 v[72:75], v[204:207], v[148:151], v[72:75]
    ds_read_b64_tr_b16 v[236:237], v6 offset:12288
    v_mfma_f32_16x16x32_bf16 v[72:75], v[200:203], v[144:147], v[72:75]
    ds_read_b64_tr_b16 v[238:239], v6 offset:12800
    v_mfma_f32_16x16x32_bf16 v[64:67], v[200:203], v[136:139], v[64:67]
    ds_read_b128 v[192:195], v2 offset:18432
    v_mfma_f32_16x16x32_bf16 v[64:67], v[204:207], v[140:143], v[64:67]
    ds_read_b128 v[196:199], v3 offset:18432
    v_mfma_f32_16x16x32_bf16 v[56:59], v[204:207], v[132:135], v[56:59]
    ds_read_b128 v[184:187], v4 offset:24576
    v_mfma_f32_16x16x32_bf16 v[56:59], v[200:203], v[128:131], v[56:59]
    ds_read_b128 v[188:191], v5 offset:24576
    v_mfma_f32_16x16x32_bf16 v[48:51], v[200:203], v[120:123], v[48:51]
    v_mfma_f32_16x16x32_bf16 v[48:51], v[204:207], v[124:127], v[48:51]
    s_waitcnt lgkmcnt(8)
    v_mfma_f32_16x16x32_bf16 v[52:55], v[228:231], v[124:127], v[52:55]
    ds_read_b64_tr_b16 v[200:201], v7 offset:0
    v_mfma_f32_16x16x32_bf16 v[52:55], v[224:227], v[120:123], v[52:55]
    ds_read_b64_tr_b16 v[202:203], v7 offset:512
    v_mfma_f32_16x16x32_bf16 v[60:63], v[224:227], v[128:131], v[60:63]
    ds_read_b64_tr_b16 v[204:205], v7 offset:12288
    v_mfma_f32_16x16x32_bf16 v[60:63], v[228:231], v[132:135], v[60:63]
    ds_read_b64_tr_b16 v[206:207], v7 offset:12800
    v_mfma_f32_16x16x32_bf16 v[68:71], v[228:231], v[140:143], v[68:71]
    ds_read_b128 v[176:179], v4 offset:22528
    v_mfma_f32_16x16x32_bf16 v[68:71], v[224:227], v[136:139], v[68:71]
    ds_read_b128 v[180:183], v5 offset:22528
    v_mfma_f32_16x16x32_bf16 v[76:79], v[224:227], v[144:147], v[76:79]
    ds_read_b128 v[168:171], v4 offset:20480
    v_mfma_f32_16x16x32_bf16 v[76:79], v[228:231], v[148:151], v[76:79]
    s_waitcnt lgkmcnt(11)
    v_mfma_f32_16x16x32_bf16 v[40:43], v[236:239], v[148:151], v[40:43]
    ds_read_b64_tr_b16 v[224:225], v6 offset:2048
    v_mfma_f32_16x16x32_bf16 v[40:43], v[232:235], v[144:147], v[40:43]
    ds_read_b64_tr_b16 v[226:227], v6 offset:2560
    v_mfma_f32_16x16x32_bf16 v[32:35], v[232:235], v[136:139], v[32:35]
    ds_read_b64_tr_b16 v[228:229], v6 offset:14336
    v_mfma_f32_16x16x32_bf16 v[32:35], v[236:239], v[140:143], v[32:35]
    ds_read_b64_tr_b16 v[230:231], v6 offset:14848
    v_mfma_f32_16x16x32_bf16 v[24:27], v[236:239], v[132:135], v[24:27]
    ds_read_b128 v[172:175], v5 offset:20480
    v_mfma_f32_16x16x32_bf16 v[24:27], v[232:235], v[128:131], v[24:27]
    ds_read_b128 v[160:163], v4 offset:18432
    v_mfma_f32_16x16x32_bf16 v[16:19], v[232:235], v[120:123], v[16:19]
    ds_read_b128 v[164:167], v5 offset:18432
    v_mfma_f32_16x16x32_bf16 v[16:19], v[236:239], v[124:127], v[16:19]
    s_waitcnt lgkmcnt(10)
    v_mfma_f32_16x16x32_bf16 v[20:23], v[204:207], v[124:127], v[20:23]
    ds_read_b64_tr_b16 v[232:233], v7 offset:2048
    v_mfma_f32_16x16x32_bf16 v[20:23], v[200:203], v[120:123], v[20:23]
    ds_read_b64_tr_b16 v[234:235], v7 offset:2560
    v_mfma_f32_16x16x32_bf16 v[28:31], v[200:203], v[128:131], v[28:31]
    ds_read_b64_tr_b16 v[236:237], v7 offset:14336
    v_mfma_f32_16x16x32_bf16 v[28:31], v[204:207], v[132:135], v[28:31]
    ds_read_b64_tr_b16 v[238:239], v7 offset:14848
    v_mfma_f32_16x16x32_bf16 v[36:39], v[204:207], v[140:143], v[36:39]
    v_mfma_f32_16x16x32_bf16 v[36:39], v[200:203], v[136:139], v[36:39]
    v_mfma_f32_16x16x32_bf16 v[44:47], v[200:203], v[144:147], v[44:47]
    v_mfma_f32_16x16x32_bf16 v[44:47], v[204:207], v[148:151], v[44:47]
    s_waitcnt lgkmcnt(7)
    v_mfma_f32_16x16x32_bf16 v[116:119], v[156:159], v[228:231], v[116:119]
    v_mfma_f32_16x16x32_bf16 v[116:119], v[152:155], v[224:227], v[116:119]
    v_mfma_f32_16x16x32_bf16 v[104:107], v[144:147], v[224:227], v[104:107]
    v_mfma_f32_16x16x32_bf16 v[104:107], v[148:151], v[228:231], v[104:107]
    v_mfma_f32_16x16x32_bf16 v[96:99], v[140:143], v[228:231], v[96:99]
    s_waitcnt lgkmcnt(0)
    s_barrier
    v_mfma_f32_16x16x32_bf16 v[96:99], v[136:139], v[224:227], v[96:99]
    ds_read_b64_tr_b16 v[200:201], v6 offset:25600
    v_mfma_f32_16x16x32_bf16 v[88:91], v[128:131], v[224:227], v[88:91]
    ds_read_b64_tr_b16 v[202:203], v6 offset:26112
    v_mfma_f32_16x16x32_bf16 v[88:91], v[132:135], v[228:231], v[88:91]
    ds_read_b64_tr_b16 v[204:205], v6 offset:37888
    v_mfma_f32_16x16x32_bf16 v[80:83], v[124:127], v[228:231], v[80:83]
    ds_read_b64_tr_b16 v[206:207], v6 offset:38400
    v_mfma_f32_16x16x32_bf16 v[80:83], v[120:123], v[224:227], v[80:83]
    v_mfma_f32_16x16x32_bf16 v[84:87], v[120:123], v[232:235], v[84:87]
    ds_read_b64_tr_b16 v[224:225], v7 offset:25600
    v_mfma_f32_16x16x32_bf16 v[84:87], v[124:127], v[236:239], v[84:87]
    ds_read_b64_tr_b16 v[226:227], v7 offset:26112
    v_mfma_f32_16x16x32_bf16 v[92:95], v[132:135], v[236:239], v[92:95]
    ds_read_b64_tr_b16 v[228:229], v7 offset:37888
    v_mfma_f32_16x16x32_bf16 v[92:95], v[128:131], v[232:235], v[92:95]
    ds_read_b64_tr_b16 v[230:231], v7 offset:38400
    v_mfma_f32_16x16x32_bf16 v[100:103], v[136:139], v[232:235], v[100:103]
    v_mfma_f32_16x16x32_bf16 v[100:103], v[140:143], v[236:239], v[100:103]
    v_mfma_f32_16x16x32_bf16 v[108:111], v[148:151], v[236:239], v[108:111]
    v_mfma_f32_16x16x32_bf16 v[108:111], v[144:147], v[232:235], v[108:111]
    s_waitcnt lgkmcnt(4)
    v_mfma_f32_16x16x32_bf16 v[112:115], v[200:203], v[192:195], v[112:115]
    ds_read_b64_tr_b16 v[232:233], v6 offset:24576
    v_mfma_f32_16x16x32_bf16 v[112:115], v[204:207], v[196:199], v[112:115]
    ds_read_b64_tr_b16 v[234:235], v6 offset:25088
    v_mfma_f32_16x16x32_bf16 v[72:75], v[204:207], v[188:191], v[72:75]
    ds_read_b64_tr_b16 v[236:237], v6 offset:36864
    v_mfma_f32_16x16x32_bf16 v[72:75], v[200:203], v[184:187], v[72:75]
    ds_read_b64_tr_b16 v[238:239], v6 offset:37376
    v_mfma_f32_16x16x32_bf16 v[64:67], v[200:203], v[176:179], v[64:67]
    ds_read_b128 v[152:155], v2 offset:36864
    v_mfma_f32_16x16x32_bf16 v[64:67], v[204:207], v[180:183], v[64:67]
    ds_read_b128 v[156:159], v3 offset:36864
    v_mfma_f32_16x16x32_bf16 v[56:59], v[204:207], v[172:175], v[56:59]
    ds_read_b128 v[144:147], v4 offset:43008
    v_mfma_f32_16x16x32_bf16 v[56:59], v[200:203], v[168:171], v[56:59]
    ds_read_b128 v[148:151], v5 offset:43008
    v_mfma_f32_16x16x32_bf16 v[48:51], v[200:203], v[160:163], v[48:51]
    v_mfma_f32_16x16x32_bf16 v[48:51], v[204:207], v[164:167], v[48:51]
    s_waitcnt lgkmcnt(8)
    v_mfma_f32_16x16x32_bf16 v[52:55], v[228:231], v[164:167], v[52:55]
    ds_read_b64_tr_b16 v[200:201], v7 offset:24576
    v_mfma_f32_16x16x32_bf16 v[52:55], v[224:227], v[160:163], v[52:55]
    ds_read_b64_tr_b16 v[202:203], v7 offset:25088
    v_mfma_f32_16x16x32_bf16 v[60:63], v[224:227], v[168:171], v[60:63]
    ds_read_b64_tr_b16 v[204:205], v7 offset:36864
    v_mfma_f32_16x16x32_bf16 v[60:63], v[228:231], v[172:175], v[60:63]
    ds_read_b64_tr_b16 v[206:207], v7 offset:37376
    v_mfma_f32_16x16x32_bf16 v[68:71], v[228:231], v[180:183], v[68:71]
    ds_read_b128 v[136:139], v4 offset:40960
    v_mfma_f32_16x16x32_bf16 v[68:71], v[224:227], v[176:179], v[68:71]
    ds_read_b128 v[140:143], v5 offset:40960
    v_mfma_f32_16x16x32_bf16 v[76:79], v[224:227], v[184:187], v[76:79]
    ds_read_b128 v[128:131], v4 offset:38912
    v_mfma_f32_16x16x32_bf16 v[76:79], v[228:231], v[188:191], v[76:79]
    s_waitcnt lgkmcnt(11)
    v_mfma_f32_16x16x32_bf16 v[40:43], v[236:239], v[188:191], v[40:43]
    ds_read_b64_tr_b16 v[224:225], v6 offset:26624
    v_mfma_f32_16x16x32_bf16 v[40:43], v[232:235], v[184:187], v[40:43]
    ds_read_b64_tr_b16 v[226:227], v6 offset:27136
    v_mfma_f32_16x16x32_bf16 v[32:35], v[232:235], v[176:179], v[32:35]
    ds_read_b64_tr_b16 v[228:229], v6 offset:38912
    v_mfma_f32_16x16x32_bf16 v[32:35], v[236:239], v[180:183], v[32:35]
    ds_read_b64_tr_b16 v[230:231], v6 offset:39424
    v_mfma_f32_16x16x32_bf16 v[24:27], v[236:239], v[172:175], v[24:27]
    ds_read_b128 v[132:135], v5 offset:38912
    v_mfma_f32_16x16x32_bf16 v[24:27], v[232:235], v[168:171], v[24:27]
    ds_read_b128 v[120:123], v4 offset:36864
    v_mfma_f32_16x16x32_bf16 v[16:19], v[232:235], v[160:163], v[16:19]
    ds_read_b128 v[124:127], v5 offset:36864
    v_mfma_f32_16x16x32_bf16 v[16:19], v[236:239], v[164:167], v[16:19]
    s_waitcnt lgkmcnt(10)
    v_mfma_f32_16x16x32_bf16 v[20:23], v[204:207], v[164:167], v[20:23]
    ds_read_b64_tr_b16 v[232:233], v7 offset:26624
    v_mfma_f32_16x16x32_bf16 v[20:23], v[200:203], v[160:163], v[20:23]
    ds_read_b64_tr_b16 v[234:235], v7 offset:27136
    v_mfma_f32_16x16x32_bf16 v[28:31], v[200:203], v[168:171], v[28:31]
    ds_read_b64_tr_b16 v[236:237], v7 offset:38912
    v_mfma_f32_16x16x32_bf16 v[28:31], v[204:207], v[172:175], v[28:31]
    ds_read_b64_tr_b16 v[238:239], v7 offset:39424
    v_mfma_f32_16x16x32_bf16 v[36:39], v[204:207], v[180:183], v[36:39]
    v_mfma_f32_16x16x32_bf16 v[36:39], v[200:203], v[176:179], v[36:39]
    v_mfma_f32_16x16x32_bf16 v[44:47], v[200:203], v[184:187], v[44:47]
    v_mfma_f32_16x16x32_bf16 v[44:47], v[204:207], v[188:191], v[44:47]
    s_waitcnt lgkmcnt(7)
    v_mfma_f32_16x16x32_bf16 v[116:119], v[196:199], v[228:231], v[116:119]
    v_mfma_f32_16x16x32_bf16 v[116:119], v[192:195], v[224:227], v[116:119]
    v_mfma_f32_16x16x32_bf16 v[104:107], v[184:187], v[224:227], v[104:107]
    v_mfma_f32_16x16x32_bf16 v[104:107], v[188:191], v[228:231], v[104:107]
    v_mfma_f32_16x16x32_bf16 v[96:99], v[180:183], v[228:231], v[96:99]
    s_waitcnt lgkmcnt(0)
    s_barrier
    v_mfma_f32_16x16x32_bf16 v[96:99], v[176:179], v[224:227], v[96:99]
    ds_read_b64_tr_b16 v[200:201], v6 offset:50176
    v_mfma_f32_16x16x32_bf16 v[88:91], v[168:171], v[224:227], v[88:91]
    ds_read_b64_tr_b16 v[202:203], v6 offset:50688
    v_mfma_f32_16x16x32_bf16 v[88:91], v[172:175], v[228:231], v[88:91]
    ds_read_b64_tr_b16 v[204:205], v6 offset:62464
    v_mfma_f32_16x16x32_bf16 v[80:83], v[164:167], v[228:231], v[80:83]
    ds_read_b64_tr_b16 v[206:207], v6 offset:62976
    v_mfma_f32_16x16x32_bf16 v[80:83], v[160:163], v[224:227], v[80:83]
    v_mfma_f32_16x16x32_bf16 v[84:87], v[160:163], v[232:235], v[84:87]
    ds_read_b64_tr_b16 v[224:225], v7 offset:50176
    v_mfma_f32_16x16x32_bf16 v[84:87], v[164:167], v[236:239], v[84:87]
    ds_read_b64_tr_b16 v[226:227], v7 offset:50688
    v_mfma_f32_16x16x32_bf16 v[92:95], v[172:175], v[236:239], v[92:95]
    ds_read_b64_tr_b16 v[228:229], v7 offset:62464
    v_mfma_f32_16x16x32_bf16 v[92:95], v[168:171], v[232:235], v[92:95]
    ds_read_b64_tr_b16 v[230:231], v7 offset:62976
    v_mfma_f32_16x16x32_bf16 v[100:103], v[176:179], v[232:235], v[100:103]
    v_mfma_f32_16x16x32_bf16 v[100:103], v[180:183], v[236:239], v[100:103]
    v_mfma_f32_16x16x32_bf16 v[108:111], v[188:191], v[236:239], v[108:111]
    v_mfma_f32_16x16x32_bf16 v[108:111], v[184:187], v[232:235], v[108:111]
    s_waitcnt lgkmcnt(4)
    v_mfma_f32_16x16x32_bf16 v[112:115], v[200:203], v[152:155], v[112:115]
    ds_read_b64_tr_b16 v[232:233], v6 offset:49152
    v_mfma_f32_16x16x32_bf16 v[112:115], v[204:207], v[156:159], v[112:115]
    ds_read_b64_tr_b16 v[234:235], v6 offset:49664
    v_mfma_f32_16x16x32_bf16 v[72:75], v[204:207], v[148:151], v[72:75]
    ds_read_b64_tr_b16 v[236:237], v6 offset:61440
    v_mfma_f32_16x16x32_bf16 v[72:75], v[200:203], v[144:147], v[72:75]
    ds_read_b64_tr_b16 v[238:239], v6 offset:61952
    v_mfma_f32_16x16x32_bf16 v[64:67], v[200:203], v[136:139], v[64:67]
    ds_read_b128 v[192:195], v2 offset:0
    v_mfma_f32_16x16x32_bf16 v[64:67], v[204:207], v[140:143], v[64:67]
    ds_read_b128 v[196:199], v3 offset:0
    v_mfma_f32_16x16x32_bf16 v[56:59], v[204:207], v[132:135], v[56:59]
    ds_read_b128 v[184:187], v4 offset:6144
    v_mfma_f32_16x16x32_bf16 v[56:59], v[200:203], v[128:131], v[56:59]
    ds_read_b128 v[188:191], v5 offset:6144
    v_mfma_f32_16x16x32_bf16 v[48:51], v[200:203], v[120:123], v[48:51]
    v_mfma_f32_16x16x32_bf16 v[48:51], v[204:207], v[124:127], v[48:51]
    s_waitcnt lgkmcnt(8)
    v_mfma_f32_16x16x32_bf16 v[52:55], v[228:231], v[124:127], v[52:55]
    ds_read_b64_tr_b16 v[200:201], v7 offset:49152
    v_mfma_f32_16x16x32_bf16 v[52:55], v[224:227], v[120:123], v[52:55]
    ds_read_b64_tr_b16 v[202:203], v7 offset:49664
    v_mfma_f32_16x16x32_bf16 v[60:63], v[224:227], v[128:131], v[60:63]
    ds_read_b64_tr_b16 v[204:205], v7 offset:61440
    v_mfma_f32_16x16x32_bf16 v[60:63], v[228:231], v[132:135], v[60:63]
    ds_read_b64_tr_b16 v[206:207], v7 offset:61952
    v_mfma_f32_16x16x32_bf16 v[68:71], v[228:231], v[140:143], v[68:71]
    ds_read_b128 v[176:179], v4 offset:4096
    v_mfma_f32_16x16x32_bf16 v[68:71], v[224:227], v[136:139], v[68:71]
    ds_read_b128 v[180:183], v5 offset:4096
    v_mfma_f32_16x16x32_bf16 v[76:79], v[224:227], v[144:147], v[76:79]
    ds_read_b128 v[168:171], v4 offset:2048
    v_mfma_f32_16x16x32_bf16 v[76:79], v[228:231], v[148:151], v[76:79]
    s_waitcnt lgkmcnt(11)
    v_mfma_f32_16x16x32_bf16 v[40:43], v[236:239], v[148:151], v[40:43]
    ds_read_b64_tr_b16 v[224:225], v6 offset:51200
    v_mfma_f32_16x16x32_bf16 v[40:43], v[232:235], v[144:147], v[40:43]
    ds_read_b64_tr_b16 v[226:227], v6 offset:51712
    v_mfma_f32_16x16x32_bf16 v[32:35], v[232:235], v[136:139], v[32:35]
    ds_read_b64_tr_b16 v[228:229], v6 offset:63488
    v_mfma_f32_16x16x32_bf16 v[32:35], v[236:239], v[140:143], v[32:35]
    ds_read_b64_tr_b16 v[230:231], v6 offset:64000
    v_mfma_f32_16x16x32_bf16 v[24:27], v[236:239], v[132:135], v[24:27]
    ds_read_b128 v[172:175], v5 offset:2048
    v_mfma_f32_16x16x32_bf16 v[24:27], v[232:235], v[128:131], v[24:27]
    ds_read_b128 v[160:163], v4 offset:0
    v_mfma_f32_16x16x32_bf16 v[16:19], v[232:235], v[120:123], v[16:19]
    ds_read_b128 v[164:167], v5 offset:0
    v_mfma_f32_16x16x32_bf16 v[16:19], v[236:239], v[124:127], v[16:19]
    s_waitcnt lgkmcnt(10)
    v_mfma_f32_16x16x32_bf16 v[20:23], v[204:207], v[124:127], v[20:23]
    ds_read_b64_tr_b16 v[232:233], v7 offset:51200
    v_mfma_f32_16x16x32_bf16 v[20:23], v[200:203], v[120:123], v[20:23]
    ds_read_b64_tr_b16 v[234:235], v7 offset:51712
    v_mfma_f32_16x16x32_bf16 v[28:31], v[200:203], v[128:131], v[28:31]
    ds_read_b64_tr_b16 v[236:237], v7 offset:63488
    v_mfma_f32_16x16x32_bf16 v[28:31], v[204:207], v[132:135], v[28:31]
    ds_read_b64_tr_b16 v[238:239], v7 offset:64000
    v_mfma_f32_16x16x32_bf16 v[36:39], v[204:207], v[140:143], v[36:39]
    v_mfma_f32_16x16x32_bf16 v[36:39], v[200:203], v[136:139], v[36:39]
    v_mfma_f32_16x16x32_bf16 v[44:47], v[200:203], v[144:147], v[44:47]
    v_mfma_f32_16x16x32_bf16 v[44:47], v[204:207], v[148:151], v[44:47]
    s_waitcnt lgkmcnt(7)
    v_mfma_f32_16x16x32_bf16 v[116:119], v[156:159], v[228:231], v[116:119]
    ds_read_b64_tr_b16 v[200:201], v6 offset:1024
    v_mfma_f32_16x16x32_bf16 v[116:119], v[152:155], v[224:227], v[116:119]
    ds_read_b64_tr_b16 v[202:203], v6 offset:1536
    v_mfma_f32_16x16x32_bf16 v[104:107], v[144:147], v[224:227], v[104:107]
    ds_read_b64_tr_b16 v[204:205], v6 offset:13312
    v_mfma_f32_16x16x32_bf16 v[104:107], v[148:151], v[228:231], v[104:107]
    ds_read_b64_tr_b16 v[206:207], v6 offset:13824
    v_mfma_f32_16x16x32_bf16 v[96:99], v[140:143], v[228:231], v[96:99]
    v_mfma_f32_16x16x32_bf16 v[96:99], v[136:139], v[224:227], v[96:99]
    v_mfma_f32_16x16x32_bf16 v[88:91], v[128:131], v[224:227], v[88:91]
    v_mfma_f32_16x16x32_bf16 v[88:91], v[132:135], v[228:231], v[88:91]
    v_mfma_f32_16x16x32_bf16 v[80:83], v[124:127], v[228:231], v[80:83]
    v_mfma_f32_16x16x32_bf16 v[80:83], v[120:123], v[224:227], v[80:83]
    s_waitcnt lgkmcnt(4)
    v_mfma_f32_16x16x32_bf16 v[84:87], v[120:123], v[232:235], v[84:87]
    ds_read_b64_tr_b16 v[224:225], v7 offset:1024
    v_mfma_f32_16x16x32_bf16 v[84:87], v[124:127], v[236:239], v[84:87]
    ds_read_b64_tr_b16 v[226:227], v7 offset:1536
    v_mfma_f32_16x16x32_bf16 v[92:95], v[132:135], v[236:239], v[92:95]
    ds_read_b64_tr_b16 v[228:229], v7 offset:13312
    v_mfma_f32_16x16x32_bf16 v[92:95], v[128:131], v[232:235], v[92:95]
    ds_read_b64_tr_b16 v[230:231], v7 offset:13824
    v_mfma_f32_16x16x32_bf16 v[100:103], v[136:139], v[232:235], v[100:103]
    v_mfma_f32_16x16x32_bf16 v[100:103], v[140:143], v[236:239], v[100:103]
    v_mfma_f32_16x16x32_bf16 v[108:111], v[148:151], v[236:239], v[108:111]
    v_mfma_f32_16x16x32_bf16 v[108:111], v[144:147], v[232:235], v[108:111]
    s_waitcnt lgkmcnt(6)
    v_mfma_f32_16x16x32_bf16 v[112:115], v[200:203], v[192:195], v[112:115]
    ds_read_b64_tr_b16 v[120:121], v6 offset:0
    ds_read_b64_tr_b16 v[122:123], v6 offset:512
    s_waitcnt lgkmcnt(6)
    v_mfma_f32_16x16x32_bf16 v[112:115], v[204:207], v[196:199], v[112:115]
    ds_read_b64_tr_b16 v[124:125], v6 offset:12288
    ds_read_b64_tr_b16 v[126:127], v6 offset:12800
    v_mfma_f32_16x16x32_bf16 v[72:75], v[204:207], v[188:191], v[72:75]
    ds_read_b64_tr_b16 v[128:129], v7 offset:0
    ds_read_b64_tr_b16 v[130:131], v7 offset:512
    v_mfma_f32_16x16x32_bf16 v[72:75], v[200:203], v[184:187], v[72:75]
    ds_read_b64_tr_b16 v[132:133], v7 offset:12288
    ds_read_b64_tr_b16 v[134:135], v7 offset:12800
    v_mfma_f32_16x16x32_bf16 v[64:67], v[200:203], v[176:179], v[64:67]
    ds_read_b64_tr_b16 v[136:137], v6 offset:2048
    ds_read_b64_tr_b16 v[138:139], v6 offset:2560
    v_mfma_f32_16x16x32_bf16 v[64:67], v[204:207], v[180:183], v[64:67]
    ds_read_b64_tr_b16 v[140:141], v6 offset:14336
    ds_read_b64_tr_b16 v[142:143], v6 offset:14848
    v_mfma_f32_16x16x32_bf16 v[56:59], v[204:207], v[172:175], v[56:59]
    ds_read_b64_tr_b16 v[144:145], v7 offset:2048
    ds_read_b64_tr_b16 v[146:147], v7 offset:2560
    v_mfma_f32_16x16x32_bf16 v[56:59], v[200:203], v[168:171], v[56:59]
    ds_read_b64_tr_b16 v[148:149], v7 offset:14336
    ds_read_b64_tr_b16 v[150:151], v7 offset:14848
    v_mfma_f32_16x16x32_bf16 v[48:51], v[200:203], v[160:163], v[48:51]
    v_cvt_pk_bf16_f32 v72, v72, v73
    v_cvt_pk_bf16_f32 v73, v74, v75
    v_mfma_f32_16x16x32_bf16 v[48:51], v[204:207], v[164:167], v[48:51]
    v_cvt_pk_bf16_f32 v64, v64, v65
    v_cvt_pk_bf16_f32 v65, v66, v67
    s_waitcnt lgkmcnt(14)
    v_mfma_f32_16x16x32_bf16 v[76:79], v[228:231], v[188:191], v[76:79]
    v_cvt_pk_bf16_f32 v56, v56, v57
    v_cvt_pk_bf16_f32 v57, v58, v59
    v_mfma_f32_16x16x32_bf16 v[76:79], v[224:227], v[184:187], v[76:79]
    v_cvt_pk_bf16_f32 v200, v112, v113
    v_cvt_pk_bf16_f32 v201, v114, v115
    v_mfma_f32_16x16x32_bf16 v[68:71], v[224:227], v[176:179], v[68:71]
    ds_write_b64 v216, v[200:201]
    ds_write_b64 v217, v[72:73]
    v_mfma_f32_16x16x32_bf16 v[68:71], v[228:231], v[180:183], v[68:71]
    v_cvt_pk_bf16_f32 v48, v48, v49
    v_cvt_pk_bf16_f32 v49, v50, v51
    v_mfma_f32_16x16x32_bf16 v[60:63], v[228:231], v[172:175], v[60:63]
    v_cvt_pk_bf16_f32 v74, v76, v77
    v_cvt_pk_bf16_f32 v75, v78, v79
    v_mfma_f32_16x16x32_bf16 v[60:63], v[224:227], v[168:171], v[60:63]
    ds_write_b64 v217, v[74:75] offset:512
    s_mov_b64 exec, 1
    ds_add_u32 v10, v11 offset:0
    s_mov_b64 exec, -1
    v_mfma_f32_16x16x32_bf16 v[52:55], v[224:227], v[160:163], v[52:55]
    v_cvt_pk_bf16_f32 v66, v68, v69
    v_cvt_pk_bf16_f32 v67, v70, v71
    v_mfma_f32_16x16x32_bf16 v[52:55], v[228:231], v[164:167], v[52:55]
    v_cvt_pk_bf16_f32 v58, v60, v61
    v_cvt_pk_bf16_f32 v59, v62, v63
    s_waitcnt lgkmcnt(14)
    v_mfma_f32_16x16x32_bf16 v[40:43], v[124:127], v[188:191], v[40:43]
    s_nop 1
    v_mfma_f32_16x16x32_bf16 v[40:43], v[120:123], v[184:187], v[40:43]
    s_nop 1
    v_mfma_f32_16x16x32_bf16 v[32:35], v[120:123], v[176:179], v[32:35]
    v_cvt_pk_bf16_f32 v50, v52, v53
    v_cvt_pk_bf16_f32 v51, v54, v55
    v_mfma_f32_16x16x32_bf16 v[32:35], v[124:127], v[180:183], v[32:35]
    s_nop 1
    v_mfma_f32_16x16x32_bf16 v[24:27], v[124:127], v[172:175], v[24:27]
    v_cvt_pk_bf16_f32 v40, v40, v41
    v_cvt_pk_bf16_f32 v41, v42, v43
    v_mfma_f32_16x16x32_bf16 v[24:27], v[120:123], v[168:171], v[24:27]
    s_nop 1
    v_mfma_f32_16x16x32_bf16 v[16:19], v[120:123], v[160:163], v[16:19]
    v_cvt_pk_bf16_f32 v32, v32, v33
    v_cvt_pk_bf16_f32 v33, v34, v35
    v_mfma_f32_16x16x32_bf16 v[16:19], v[124:127], v[164:167], v[16:19]
    s_nop 1
    s_waitcnt lgkmcnt(12)
    v_mfma_f32_16x16x32_bf16 v[44:47], v[132:135], v[188:191], v[44:47]
    v_cvt_pk_bf16_f32 v24, v24, v25
    v_cvt_pk_bf16_f32 v25, v26, v27
    v_mfma_f32_16x16x32_bf16 v[44:47], v[128:131], v[184:187], v[44:47]
    s_nop 1
    v_mfma_f32_16x16x32_bf16 v[36:39], v[128:131], v[176:179], v[36:39]
    v_cvt_pk_bf16_f32 v16, v16, v17
    v_cvt_pk_bf16_f32 v17, v18, v19
    v_mfma_f32_16x16x32_bf16 v[36:39], v[132:135], v[180:183], v[36:39]
    s_nop 1
    v_mfma_f32_16x16x32_bf16 v[28:31], v[132:135], v[172:175], v[28:31]
    v_cvt_pk_bf16_f32 v42, v44, v45
    v_cvt_pk_bf16_f32 v43, v46, v47
    v_mfma_f32_16x16x32_bf16 v[28:31], v[128:131], v[168:171], v[28:31]
    ds_read_b32 v223, v10 offset:0
    ds_read_b64 v[204:205], v218
    v_mfma_f32_16x16x32_bf16 v[20:23], v[128:131], v[160:163], v[20:23]
    ds_read_b64 v[206:207], v219
    v_cvt_pk_bf16_f32 v34, v36, v37
    v_mfma_f32_16x16x32_bf16 v[20:23], v[132:135], v[164:167], v[20:23]
    v_cvt_pk_bf16_f32 v35, v38, v39
    s_nop 0
    s_waitcnt lgkmcnt(11)
    v_mfma_f32_16x16x32_bf16 v[116:119], v[196:199], v[140:143], v[116:119]
    v_cvt_pk_bf16_f32 v26, v28, v29
    v_cvt_pk_bf16_f32 v27, v30, v31
    v_mfma_f32_16x16x32_bf16 v[116:119], v[192:195], v[136:139], v[116:119]
    s_nop 1
    v_mfma_f32_16x16x32_bf16 v[104:107], v[184:187], v[136:139], v[104:107]
    v_cvt_pk_bf16_f32 v18, v20, v21
    v_cvt_pk_bf16_f32 v19, v22, v23
    v_mfma_f32_16x16x32_bf16 v[104:107], v[188:191], v[140:143], v[104:107]
    s_nop 1
    v_mfma_f32_16x16x32_bf16 v[44:47], v[72:75], v[40:43], 0
    v_cvt_pk_bf16_f32 v202, v116, v117
    v_cvt_pk_bf16_f32 v203, v118, v119
    v_mfma_f32_16x16x32_bf16 v[76:79], v[64:67], v[40:43], 0
    s_nop 1
    v_mfma_f32_16x16x32_bf16 v[36:39], v[64:67], v[32:35], 0
    v_cvt_pk_bf16_f32 v232, v104, v105
    v_cvt_pk_bf16_f32 v233, v106, v107
    v_mfma_f32_16x16x32_bf16 v[68:71], v[56:59], v[32:35], 0
    ds_write_b64 v216, v[202:203] offset:1024
    ds_write_b64 v217, v[232:233] offset:1024
    v_mfma_f32_16x16x32_bf16 v[96:99], v[180:183], v[140:143], v[96:99]
    s_waitcnt lgkmcnt(4)
    v_cmp_gt_u32 vcc, 4, v223
    s_cbranch_vccnz LB_w1
LB_g1:
    v_mfma_f32_16x16x32_bf16 v[96:99], v[176:179], v[136:139], v[96:99]
    v_cndmask_b32 v124, v44, v45, s[88:89]
    v_cndmask_b32 v125, v76, v77, s[88:89]
    v_mfma_f32_16x16x32_bf16 v[28:31], v[56:59], v[24:27], 0
    v_cndmask_b32 v158, v125, v124, s[90:91]
    v_cndmask_b32 v126, v46, v47, s[88:89]
    v_mfma_f32_16x16x32_bf16 v[60:63], v[48:51], v[24:27], 0
    v_cndmask_b32 v127, v78, v79, s[88:89]
    v_cndmask_b32 v159, v127, v126, s[92:93]
    v_mfma_f32_16x16x32_bf16 v[20:23], v[48:51], v[16:19], 0
    v_max_f32 v123, v158, v159
    v_cndmask_b32 v124, v36, v37, s[88:89]
    v_mfma_f32_16x16x32_bf16 v[88:91], v[168:171], v[136:139], v[88:91]
    v_cndmask_b32 v125, v68, v69, s[88:89]
    v_cndmask_b32 v156, v125, v124, s[90:91]
    v_mfma_f32_16x16x32_bf16 v[88:91], v[172:175], v[140:143], v[88:91]
    v_cndmask_b32 v126, v38, v39, s[88:89]
    v_cndmask_b32 v127, v70, v71, s[88:89]
    s_waitcnt lgkmcnt(2)
    v_mfma_f32_16x16x32_bf16 v[52:55], v[204:207], v[16:19], v[212:215]
    v_cndmask_b32 v157, v127, v126, s[92:93]
    v_max_f32 v122, v156, v157
    v_mfma_f32_16x16x32_bf16 v[80:83], v[164:167], v[140:143], v[80:83]
    v_cndmask_b32 v124, v28, v29, s[88:89]
    v_cndmask_b32 v125, v60, v61, s[88:89]
    v_mfma_f32_16x16x32_bf16 v[80:83], v[160:163], v[136:139], v[80:83]
    v_cndmask_b32 v154, v125, v124, s[90:91]
    v_cndmask_b32 v126, v30, v31, s[88:89]
    v_mfma_f32_16x16x32_bf16 v[108:111], v[184:187], v[144:147], v[108:111]
    v_cndmask_b32 v127, v62, v63, s[88:89]
    v_cndmask_b32 v155, v127, v126, s[92:93]
    v_mfma_f32_16x16x32_bf16 v[108:111], v[188:191], v[148:151], v[108:111]
    v_max_f32 v121, v154, v155
    s_nop 0
    v_mfma_f32_16x16x32_bf16 v[100:103], v[180:183], v[148:151], v[100:103]
    s_nop 1
    v_mfma_f32_16x16x32_bf16 v[100:103], v[176:179], v[144:147], v[100:103]
    s_nop 1
    v_mfma_f32_16x16x32_bf16 v[92:95], v[168:171], v[144:147], v[92:95]
    v_cvt_pk_bf16_f32 v242, v108, v109
    v_cvt_pk_bf16_f32 v243, v110, v111
    v_mfma_f32_16x16x32_bf16 v[92:95], v[172:175], v[148:151], v[92:95]
    ds_write_b64 v217, v[242:243] offset:1536
    s_mov_b64 exec, 1
    ds_add_u32 v10, v11 offset:24
    s_mov_b64 exec, -1
    v_mfma_f32_16x16x32_bf16 v[84:87], v[164:167], v[148:151], v[84:87]
    v_cndmask_b32 v124, v20, v21, s[88:89]
    v_cndmask_b32 v125, v52, v53, s[88:89]
    v_mfma_f32_16x16x32_bf16 v[84:87], v[160:163], v[144:147], v[84:87]
    v_cndmask_b32 v152, v125, v124, s[90:91]
    v_cndmask_b32 v126, v22, v23, s[88:89]
    v_cndmask_b32 v127, v54, v55, s[88:89]
    v_cndmask_b32 v153, v127, v126, s[92:93]
    v_max_f32 v120, v152, v153
    s_mov_b32 s80, 0x3e8293ee
    s_add_u32 m0, s34, 36864
    s_add_u32 s35, s44, 0
    buffer_load_dwordx4 v245, s[64:67], s35 offen  lds
    v_cvt_pk_bf16_f32 v230, v96, v97
    v_permlane32_swap_b32 v122, v123
    v_permlane32_swap_b32 v120, v121
    v_max_f32 v122, v122, v123
    v_max_f32 v120, v120, v121
    v_cvt_pk_bf16_f32 v231, v98, v99
    v_cvt_pk_bf16_f32 v240, v100, v101
    v_permlane16_swap_b32 v120, v122
    v_max_f32 v120, v120, v122
    v_mul_f32 v120, s80, v120
    v_mov_b32 v122, v120
    v_cvt_pk_bf16_f32 v241, v102, v103
    v_cvt_pk_bf16_f32 v228, v88, v89
    v_permlane16_swap_b32 v120, v122
    v_mov_b32 v121, v120
    v_mov_b32 v123, v122
    s_add_u32 m0, s34, 40960
    s_add_u32 s35, s44, 65536
    buffer_load_dwordx4 v245, s[64:67], s35 offen  lds
    v_cvt_pk_bf16_f32 v229, v90, v91
    v_permlane32_swap_b32 v120, v121
    v_permlane32_swap_b32 v122, v123
    v_fma_f32 v152, v152, s80, -v120
    v_fma_f32 v153, v153, s80, -v120
    v_fma_f32 v154, v154, s80, -v121
    v_fma_f32 v155, v155, s80, -v121
    v_fma_f32 v156, v156, s80, -v122
    v_fma_f32 v157, v157, s80, -v122
    v_fma_f32 v158, v158, s80, -v123
    v_fma_f32 v159, v159, s80, -v123
    ds_read_b32 v223, v10 offset:24
    ds_read_b64 v[224:225], v218 offset:1024
    ds_read_b64 v[234:235], v219 offset:1024
    v_exp_f32 v152, v152
    v_exp_f32 v153, v153
    v_exp_f32 v154, v154
    s_add_u32 m0, s34, 45056
    s_add_u32 s35, s44, 131072
    buffer_load_dwordx4 v245, s[64:67], s35 offen  lds
    v_exp_f32 v155, v155
    v_exp_f32 v156, v156
    v_exp_f32 v157, v157
    v_exp_f32 v158, v158
    v_exp_f32 v159, v159
    v_add_f32 v120, v152, v153
    v_add_f32 v121, v154, v155
    v_add_f32 v122, v156, v157
    v_add_f32 v123, v158, v159
    v_cvt_pk_bf16_f32 v238, v92, v93
    s_nop 0
    v_permlane32_swap_b32 v122, v123
    v_permlane32_swap_b32 v120, v121
    v_add_f32 v122, v122, v123
    v_add_f32 v120, v120, v121
    v_cvt_pk_bf16_f32 v239, v94, v95
    v_cvt_pk_bf16_f32 v226, v80, v81
    s_add_u32 m0, s34, 49152
    s_add_u32 s35, s44, 196608
    buffer_load_dwordx4 v245, s[64:67], s35 offen  lds
    v_permlane16_swap_b32 v120, v122
    v_add_f32 v120, v120, v122
    v_rcp_f32 v120, v120
    s_nop 0
    v_mov_b32 v122, v120
    v_cvt_pk_bf16_f32 v227, v82, v83
    v_cvt_pk_bf16_f32 v236, v84, v85
    v_permlane16_swap_b32 v120, v122
    v_mov_b32 v121, v120
    v_mov_b32 v123, v122
    v_cvt_pk_bf16_f32 v237, v86, v87
    v_permlane32_swap_b32 v120, v121
    v_permlane32_swap_b32 v122, v123
    s_waitcnt lgkmcnt(2)
    v_cmp_gt_u32 vcc, 4, v223
    s_cbranch_vccnz LB_w6
LB_g6:
    v_mul_f32 v152, v152, v120
    v_mul_f32 v153, v153, v120
    v_cvt_pk_bf16_f32 v152, v152, v153
    v_perm_b32 v160, v152, v152, v208
    s_add_u32 m0, s34, 53248
    s_add_u32 s35, s45, 0
    buffer_load_dwordx4 v245, s[64:67], s35 offen  lds
    v_perm_b32 v161, v152, v152, v209
    v_perm_b32 v162, v152, v152, v210
    v_perm_b32 v163, v152, v152, v211
    v_mul_f32 v154, v154, v121
    v_mul_f32 v155, v155, v121
    v_cvt_pk_bf16_f32 v154, v154, v155
    v_perm_b32 v164, v154, v154, v208
    v_perm_b32 v165, v154, v154, v209
    v_perm_b32 v166, v154, v154, v210
    v_perm_b32 v167, v154, v154, v211
    s_waitcnt lgkmcnt(1)
    v_mfma_f32_16x16x32_bf16 v[16:19], v[224:227], v[160:163], 0
    s_waitcnt lgkmcnt(0)
    v_mfma_f32_16x16x32_bf16 v[20:23], v[234:237], v[160:163], 0
    v_mul_f32 v156, v156, v122
    v_mul_f32 v157, v157, v122
    v_cvt_pk_bf16_f32 v156, v156, v157
    v_perm_b32 v168, v156, v156, v208
    s_add_u32 m0, s34, 57344
    s_add_u32 s35, s45, 65536
    buffer_load_dwordx4 v245, s[64:67], s35 offen  lds
    v_perm_b32 v169, v156, v156, v209
    v_perm_b32 v170, v156, v156, v210
    v_perm_b32 v171, v156, v156, v211
    v_mfma_f32_16x16x32_bf16 v[24:27], v[226:229], v[164:167], 0
    v_mfma_f32_16x16x32_bf16 v[28:31], v[236:239], v[164:167], 0
    v_mul_f32 v158, v158, v123
    v_mul_f32 v159, v159, v123
    v_cvt_pk_bf16_f32 v158, v158, v159
    v_perm_b32 v172, v158, v158, v208
    v_perm_b32 v173, v158, v158, v209
    v_perm_b32 v174, v158, v158, v210
    v_perm_b32 v175, v158, v158, v211
    v_mfma_f32_16x16x32_bf16 v[32:35], v[228:231], v[168:171], 0
    v_mfma_f32_16x16x32_bf16 v[36:39], v[238:241], v[168:171], 0
    v_mfma_f32_16x16x32_bf16 v[40:43], v[230:233], v[172:175], 0
    v_mfma_f32_16x16x32_bf16 v[44:47], v[240:243], v[172:175], 0
    v_cvt_pk_bf16_f32 v80, v16, v17
    v_cvt_pk_bf16_f32 v81, v18, v19
    v_cvt_pk_bf16_f32 v82, v20, v21
    v_cvt_pk_bf16_f32 v83, v22, v23
    s_add_u32 s95, s94, 0
    buffer_store_dwordx4 v[80:83], v12, s[52:55], s95 offen sc1
    v_cvt_pk_bf16_f32 v84, v24, v25
    v_cvt_pk_bf16_f32 v85, v26, v27
    v_cvt_pk_bf16_f32 v86, v28, v29
    v_cvt_pk_bf16_f32 v87, v30, v31
    s_add_u32 s95, s94, 32768
    buffer_store_dwordx4 v[84:87], v12, s[52:55], s95 offen sc1
    v_cvt_pk_bf16_f32 v88, v32, v33
    v_cvt_pk_bf16_f32 v89, v34, v35
    v_cvt_pk_bf16_f32 v90, v36, v37
    v_cvt_pk_bf16_f32 v91, v38, v39
    s_add_u32 s95, s94, 65536
    buffer_store_dwordx4 v[88:91], v12, s[52:55], s95 offen sc1
    v_cvt_pk_bf16_f32 v92, v40, v41
    v_cvt_pk_bf16_f32 v93, v42, v43
    v_cvt_pk_bf16_f32 v94, v44, v45
    v_cvt_pk_bf16_f32 v95, v46, v47
    s_add_u32 s95, s94, 98304
    buffer_store_dwordx4 v[92:95], v12, s[52:55], s95 offen sc1
    s_add_u32 m0, s34, 61440
    s_add_u32 s35, s45, 131072
    buffer_load_dwordx4 v245, s[64:67], s35 offen  lds
    v_xor_b32 v2, 0, v244
    v_xor_b32 v3, 32, v244
    v_xor_b32 v4, 64, v244
    v_xor_b32 v5, 96, v244
    s_add_u32 m0, s34, 65536
    s_add_u32 s35, s45, 196608
    buffer_load_dwordx4 v245, s[64:67], s35 offen  lds
    v_xor_b32 v6, 2048, v244
    v_xor_b32 v7, 2080, v244
    v_xor_b32 v8, 2112, v244
    v_xor_b32 v9, 2144, v244
    s_waitcnt vmcnt(6)
    s_mov_b64 exec, 1
    ds_add_u32 v10, v11 offset:8
    s_mov_b64 exec, -1
    s_add_u32 m0, s34, 69632
    s_add_u32 s35, s46, 0
    buffer_load_dwordx4 v245, s[64:67], s35 offen  lds
    v_add_u32 v224, 65536, v2
    v_add_u32 v225, 65536, v3
    v_add_u32 v226, 65536, v4
    v_add_u32 v227, 65536, v5
    v_add_u32 v228, 65536, v6
    v_add_u32 v229, 65536, v7
    s_add_u32 m0, s34, 73728
    s_add_u32 s35, s46, 65536
    buffer_load_dwordx4 v245, s[64:67], s35 offen  lds
    v_add_u32 v230, 65536, v8
    v_add_u32 v231, 65536, v9
    v_add_u32 v15, 32768, v12
    v_add_u32 v232, 129024, v2
    v_add_u32 v233, 129024, v3
    v_add_u32 v234, 129024, v4
    s_add_u32 m0, s34, 77824
    s_add_u32 s35, s46, 131072
    buffer_load_dwordx4 v245, s[64:67], s35 offen  lds
    v_add_u32 v235, 129024, v5
    v_add_u32 v236, 129024, v6
    v_add_u32 v237, 129024, v7
    v_add_u32 v238, 129024, v8
    v_add_u32 v239, 129024, v9
    s_waitcnt vmcnt(5)
    s_mov_b64 exec, 1
    buffer_store_dword v11, v220, s[52:55], s97 offen sc1
    s_mov_b64 exec, -1
    s_branch LB_s2_in
LB_s2:
    s_sleep 1
LB_s2_in:
    ds_read_b32 v14, v10 offset:8
    s_waitcnt lgkmcnt(0)
    v_readfirstlane_b32 s78, v14
    s_nop 0
    s_cmp_ge_u32 s78, 8
    s_cbranch_scc0 LB_s2
    s_add_u32 m0, s34, 81920
    s_add_u32 s35, s46, 196608
    buffer_load_dwordx4 v245, s[64:67], s35 offen  lds
    ds_read_b64_tr_b16 v[48:49], v2 offset:36864
    ds_read_b64_tr_b16 v[50:51], v6 offset:36864
    s_add_u32 m0, s34, 86016
    s_add_u32 s35, s47, 0
    buffer_load_dwordx4 v245, s[64:67], s35 offen  lds
    ds_read_b64_tr_b16 v[52:53], v2 offset:40960
    s_add_u32 m0, s34, 0
    s_add_u32 s35, s47, 65536
    buffer_load_dwordx4 v245, s[64:67], s35 offen  lds
    ds_read_b64_tr_b16 v[54:55], v6 offset:40960
    s_add_u32 m0, s34, 4096
    s_add_u32 s35, s47, 131072
    buffer_load_dwordx4 v245, s[64:67], s35 offen  lds
    ds_read_b64_tr_b16 v[56:57], v2 offset:45056
    s_add_u32 m0, s34, 8192
    s_add_u32 s35, s47, 196608
    buffer_load_dwordx4 v245, s[64:67], s35 offen  lds
    ds_read_b64_tr_b16 v[58:59], v6 offset:45056
    s_add_u32 m0, s34, 12288
    s_add_u32 s35, s48, 0
    buffer_load_dwordx4 v245, s[64:67], s35 offen  lds
    ds_read_b64_tr_b16 v[60:61], v2 offset:49152
    s_add_u32 m0, s34, 16384
    s_add_u32 s35, s48, 65536
    buffer_load_dwordx4 v245, s[64:67], s35 offen  lds
    ds_read_b64_tr_b16 v[62:63], v6 offset:49152
    s_add_u32 m0, s34, 20480
    s_add_u32 s35, s48, 131072
    buffer_load_dwordx4 v245, s[64:67], s35 offen  lds
    ds_read_b64_tr_b16 v[64:65], v3 offset:36864
    s_add_u32 m0, s34, 110592
    s_add_u32 s35, s48, 196608
    buffer_load_dwordx4 v245, s[64:67], s35 offen  lds
    ds_read_b64_tr_b16 v[66:67], v7 offset:36864
    s_add_u32 m0, s34, 114688
    s_add_u32 s35, s49, 0
    buffer_load_dwordx4 v245, s[64:67], s35 offen  lds
    ds_read_b64_tr_b16 v[68:69], v3 offset:40960
    s_add_u32 m0, s34, 118784
    s_add_u32 s35, s49, 65536
    buffer_load_dwordx4 v245, s[64:67], s35 offen  lds
    ds_read_b64_tr_b16 v[70:71], v7 offset:40960
    s_add_u32 m0, s34, 122880
    s_add_u32 s35, s49, 131072
    buffer_load_dwordx4 v245, s[64:67], s35 offen  lds
    ds_read_b64_tr_b16 v[72:73], v3 offset:45056
    s_add_u32 m0, s34, 24576
    s_add_u32 s35, s49, 196608
    buffer_load_dwordx4 v245, s[64:67], s35 offen  lds
    ds_read_b64_tr_b16 v[74:75], v7 offset:45056
    s_add_u32 m0, s34, 28672
    s_add_u32 s35, s50, 0
    buffer_load_dwordx4 v245, s[64:67], s35 offen  lds
    ds_read_b64_tr_b16 v[76:77], v3 offset:49152
    s_add_u32 m0, s34, 32768
    s_add_u32 s35, s50, 65536
    buffer_load_dwordx4 v245, s[64:67], s35 offen  lds
    ds_read_b64_tr_b16 v[78:79], v7 offset:49152
    s_waitcnt vmcnt(0)
    s_mov_b64 exec, 1
    ds_add_u32 v10, v11 offset:16
    s_mov_b64 exec, -1
    s_mov_b64 exec, 0xffffffff
    s_mov_b32 s79, 0
LB_po:
    buffer_load_dword v14, v247, s[52:55], s30 offen sc1
    s_add_u32 s79, s79, 1
    s_cmp_gt_u32 s79, 200000
    s_cbranch_scc1 LB_po_x
    s_waitcnt vmcnt(0)
    v_cmp_ne_u32 vcc, 1, v14
    s_cbranch_vccz LB_po_x
    s_mov_b64 exec, vcc
    s_sleep 4
    s_branch LB_po
LB_po_x:
    s_waitcnt vmcnt(0)
    s_mov_b64 exec, -1
    ds_read_b32 v222, v10 offset:16
    buffer_load_dwordx4 v[96:99], v12, s[52:55], s36 offen offset:0 sc1
    buffer_load_dwordx4 v[100:103], v12, s[52:55], s36 offen offset:1024 sc1
    buffer_load_dwordx4 v[104:107], v12, s[52:55], s36 offen offset:2048 sc1
    buffer_load_dwordx4 v[108:111], v12, s[52:55], s36 offen offset:3072 sc1
    buffer_load_dwordx4 v[112:115], v15, s[52:55], s36 offen offset:0 sc1
    buffer_load_dwordx4 v[116:119], v15, s[52:55], s36 offen offset:1024 sc1
    buffer_load_dwordx4 v[120:123], v15, s[52:55], s36 offen offset:2048 sc1
    buffer_load_dwordx4 v[124:127], v15, s[52:55], s36 offen offset:3072 sc1
    buffer_load_dwordx4 v[128:131], v12, s[52:55], s37 offen offset:0 sc1
    buffer_load_dwordx4 v[132:135], v12, s[52:55], s37 offen offset:1024 sc1
    s_setprio 1
    s_waitcnt lgkmcnt(0)
    v_cmp_gt_u32 vcc, 4, v222
    s_cbranch_vccnz LB_w4
LB_g4:
    s_waitcnt vmcnt(9)
    v_mfma_f32_16x16x32_bf16 v[16:19], v[48:51], v[96:99], 0
    buffer_load_dwordx4 v[136:139], v12, s[52:55], s37 offen offset:2048 sc1
    buffer_load_dwordx4 v[140:143], v12, s[52:55], s37 offen offset:3072 sc1
    s_waitcnt vmcnt(10)
    v_mfma_f32_16x16x32_bf16 v[16:19], v[52:55], v[100:103], v[16:19]
    buffer_load_dwordx4 v[144:147], v15, s[52:55], s37 offen offset:0 sc1
    s_waitcnt vmcnt(10)
    v_mfma_f32_16x16x32_bf16 v[16:19], v[56:59], v[104:107], v[16:19]
    buffer_load_dwordx4 v[148:151], v15, s[52:55], s37 offen offset:1024 sc1
    ds_read_b64_tr_b16 v[80:81], v4 offset:36864
    s_waitcnt vmcnt(10)
    v_mfma_f32_16x16x32_bf16 v[16:19], v[60:63], v[108:111], v[16:19]
    ds_read_b64_tr_b16 v[82:83], v8 offset:36864
    s_waitcnt vmcnt(6)
    v_mfma_f32_16x16x32_bf16 v[32:35], v[60:63], v[124:127], 0
    ds_read_b64_tr_b16 v[84:85], v4 offset:40960
    ds_read_b64_tr_b16 v[86:87], v8 offset:40960
    v_mfma_f32_16x16x32_bf16 v[32:35], v[56:59], v[120:123], v[32:35]
    ds_read_b64_tr_b16 v[88:89], v4 offset:45056
    v_mfma_f32_16x16x32_bf16 v[32:35], v[52:55], v[116:119], v[32:35]
    ds_read_b64_tr_b16 v[90:91], v8 offset:45056
    ds_read_b64_tr_b16 v[92:93], v4 offset:49152
    v_mfma_f32_16x16x32_bf16 v[32:35], v[48:51], v[112:115], v[32:35]
    ds_read_b64_tr_b16 v[94:95], v8 offset:49152
    v_mfma_f32_16x16x32_bf16 v[36:39], v[64:67], v[112:115], 0
    buffer_load_dwordx4 v[152:155], v15, s[52:55], s37 offen offset:2048 sc1
    buffer_load_dwordx4 v[156:159], v15, s[52:55], s37 offen offset:3072 sc1
    v_mfma_f32_16x16x32_bf16 v[36:39], v[68:71], v[116:119], v[36:39]
    buffer_load_dwordx4 v[160:163], v12, s[52:55], s38 offen offset:0 sc1
    v_mfma_f32_16x16x32_bf16 v[36:39], v[72:75], v[120:123], v[36:39]
    buffer_load_dwordx4 v[164:167], v12, s[52:55], s38 offen offset:1024 sc1
    ds_read_b64_tr_b16 v[48:49], v5 offset:36864
    v_mfma_f32_16x16x32_bf16 v[36:39], v[76:79], v[124:127], v[36:39]
    ds_read_b64_tr_b16 v[50:51], v9 offset:36864
    v_mfma_f32_16x16x32_bf16 v[20:23], v[76:79], v[108:111], 0
    ds_read_b64_tr_b16 v[52:53], v5 offset:40960
    ds_read_b64_tr_b16 v[54:55], v9 offset:40960
    v_mfma_f32_16x16x32_bf16 v[20:23], v[72:75], v[104:107], v[20:23]
    ds_read_b64_tr_b16 v[56:57], v5 offset:45056
    v_mfma_f32_16x16x32_bf16 v[20:23], v[68:71], v[100:103], v[20:23]
    ds_read_b64_tr_b16 v[58:59], v9 offset:45056
    ds_read_b64_tr_b16 v[60:61], v5 offset:49152
    v_mfma_f32_16x16x32_bf16 v[20:23], v[64:67], v[96:99], v[20:23]
    ds_read_b64_tr_b16 v[62:63], v9 offset:49152
    s_waitcnt lgkmcnt(14)
    v_mfma_f32_16x16x32_bf16 v[24:27], v[80:83], v[96:99], 0
    buffer_load_dwordx4 v[168:171], v12, s[52:55], s38 offen offset:2048 sc1
    buffer_load_dwordx4 v[172:175], v12, s[52:55], s38 offen offset:3072 sc1
    s_waitcnt lgkmcnt(12)
    v_mfma_f32_16x16x32_bf16 v[24:27], v[84:87], v[100:103], v[24:27]
    buffer_load_dwordx4 v[176:179], v15, s[52:55], s38 offen offset:0 sc1
    s_waitcnt lgkmcnt(10)
    v_mfma_f32_16x16x32_bf16 v[24:27], v[88:91], v[104:107], v[24:27]
    buffer_load_dwordx4 v[180:183], v15, s[52:55], s38 offen offset:1024 sc1
    ds_read_b64_tr_b16 v[64:65], v2 offset:53248
    s_waitcnt lgkmcnt(9)
    v_mfma_f32_16x16x32_bf16 v[24:27], v[92:95], v[108:111], v[24:27]
    ds_read_b64_tr_b16 v[66:67], v6 offset:53248
    v_mfma_f32_16x16x32_bf16 v[40:43], v[92:95], v[124:127], 0
    ds_read_b64_tr_b16 v[68:69], v2 offset:57344
    ds_read_b64_tr_b16 v[70:71], v6 offset:57344
    v_mfma_f32_16x16x32_bf16 v[40:43], v[88:91], v[120:123], v[40:43]
    ds_read_b64_tr_b16 v[72:73], v2 offset:61440
    v_mfma_f32_16x16x32_bf16 v[40:43], v[84:87], v[116:119], v[40:43]
    ds_read_b64_tr_b16 v[74:75], v6 offset:61440
    ds_read_b64_tr_b16 v[76:77], v224 offset:0
    v_mfma_f32_16x16x32_bf16 v[40:43], v[80:83], v[112:115], v[40:43]
    ds_read_b64_tr_b16 v[78:79], v228 offset:0
    s_waitcnt lgkmcnt(14)
    v_mfma_f32_16x16x32_bf16 v[44:47], v[48:51], v[112:115], 0
    buffer_load_dwordx4 v[184:187], v15, s[52:55], s38 offen offset:2048 sc1
    buffer_load_dwordx4 v[188:191], v15, s[52:55], s38 offen offset:3072 sc1
    s_waitcnt lgkmcnt(12)
    v_mfma_f32_16x16x32_bf16 v[44:47], v[52:55], v[116:119], v[44:47]
    ds_read_b64_tr_b16 v[80:81], v3 offset:53248
    s_waitcnt lgkmcnt(11)
    v_mfma_f32_16x16x32_bf16 v[44:47], v[56:59], v[120:123], v[44:47]
    ds_read_b64_tr_b16 v[82:83], v7 offset:53248
    s_waitcnt lgkmcnt(10)
    v_mfma_f32_16x16x32_bf16 v[44:47], v[60:63], v[124:127], v[44:47]
    ds_read_b64_tr_b16 v[84:85], v3 offset:57344
    v_mfma_f32_16x16x32_bf16 v[28:31], v[60:63], v[108:111], 0
    ds_read_b64_tr_b16 v[86:87], v7 offset:57344
    ds_read_b64_tr_b16 v[88:89], v3 offset:61440
    v_mfma_f32_16x16x32_bf16 v[28:31], v[56:59], v[104:107], v[28:31]
    ds_read_b64_tr_b16 v[90:91], v7 offset:61440
    v_mfma_f32_16x16x32_bf16 v[28:31], v[52:55], v[100:103], v[28:31]
    ds_read_b64_tr_b16 v[92:93], v225 offset:0
    v_mfma_f32_16x16x32_bf16 v[28:31], v[48:51], v[96:99], v[28:31]
    ds_read_b64_tr_b16 v[94:95], v229 offset:0
    s_waitcnt vmcnt(8) lgkmcnt(8)
    v_mfma_f32_16x16x32_bf16 v[16:19], v[64:67], v[128:131], v[16:19]
    buffer_load_dwordx4 v[96:99], v12, s[52:55], s39 offen offset:0 sc1
    buffer_load_dwordx4 v[100:103], v12, s[52:55], s39 offen offset:1024 sc1
    v_mfma_f32_16x16x32_bf16 v[16:19], v[68:71], v[132:135], v[16:19]
    buffer_load_dwordx4 v[104:107], v12, s[52:55], s39 offen offset:2048 sc1
    v_mfma_f32_16x16x32_bf16 v[16:19], v[72:75], v[136:139], v[16:19]
    buffer_load_dwordx4 v[108:111], v12, s[52:55], s39 offen offset:3072 sc1
    ds_read_b64_tr_b16 v[48:49], v4 offset:53248
    v_mfma_f32_16x16x32_bf16 v[16:19], v[76:79], v[140:143], v[16:19]
    ds_read_b64_tr_b16 v[50:51], v8 offset:53248
    v_mfma_f32_16x16x32_bf16 v[32:35], v[76:79], v[156:159], v[32:35]
    ds_read_b64_tr_b16 v[52:53], v4 offset:57344
    ds_read_b64_tr_b16 v[54:55], v8 offset:57344
    v_mfma_f32_16x16x32_bf16 v[32:35], v[72:75], v[152:155], v[32:35]
    ds_read_b64_tr_b16 v[56:57], v4 offset:61440
    v_mfma_f32_16x16x32_bf16 v[32:35], v[68:71], v[148:151], v[32:35]
    ds_read_b64_tr_b16 v[58:59], v8 offset:61440
    ds_read_b64_tr_b16 v[60:61], v226 offset:0
    v_mfma_f32_16x16x32_bf16 v[32:35], v[64:67], v[144:147], v[32:35]
    ds_read_b64_tr_b16 v[62:63], v230 offset:0
    s_waitcnt lgkmcnt(8)
    v_mfma_f32_16x16x32_bf16 v[36:39], v[80:83], v[144:147], v[36:39]
    buffer_load_dwordx4 v[112:115], v15, s[52:55], s39 offen offset:0 sc1
    buffer_load_dwordx4 v[116:119], v15, s[52:55], s39 offen offset:1024 sc1
    v_mfma_f32_16x16x32_bf16 v[36:39], v[84:87], v[148:151], v[36:39]
    ds_read_b64_tr_b16 v[64:65], v5 offset:53248
    v_mfma_f32_16x16x32_bf16 v[36:39], v[88:91], v[152:155], v[36:39]
    ds_read_b64_tr_b16 v[66:67], v9 offset:53248
    v_mfma_f32_16x16x32_bf16 v[36:39], v[92:95], v[156:159], v[36:39]
    ds_read_b64_tr_b16 v[68:69], v5 offset:57344
    v_mfma_f32_16x16x32_bf16 v[20:23], v[92:95], v[140:143], v[20:23]
    ds_read_b64_tr_b16 v[70:71], v9 offset:57344
    ds_read_b64_tr_b16 v[72:73], v5 offset:61440
    v_mfma_f32_16x16x32_bf16 v[20:23], v[88:91], v[136:139], v[20:23]
    ds_read_b64_tr_b16 v[74:75], v9 offset:61440
    v_mfma_f32_16x16x32_bf16 v[20:23], v[84:87], v[132:135], v[20:23]
    ds_read_b64_tr_b16 v[76:77], v227 offset:0
    v_mfma_f32_16x16x32_bf16 v[20:23], v[80:83], v[128:131], v[20:23]
    ds_read_b64_tr_b16 v[78:79], v231 offset:0
    s_waitcnt lgkmcnt(8)
    v_mfma_f32_16x16x32_bf16 v[24:27], v[48:51], v[128:131], v[24:27]
    buffer_load_dwordx4 v[120:123], v15, s[52:55], s39 offen offset:2048 sc1
    buffer_load_dwordx4 v[124:127], v15, s[52:55], s39 offen offset:3072 sc1
    v_mfma_f32_16x16x32_bf16 v[24:27], v[52:55], v[132:135], v[24:27]
    ds_read_b64_tr_b16 v[80:81], v224 offset:4096
    v_mfma_f32_16x16x32_bf16 v[24:27], v[56:59], v[136:139], v[24:27]
    ds_read_b64_tr_b16 v[82:83], v228 offset:4096
    v_mfma_f32_16x16x32_bf16 v[24:27], v[60:63], v[140:143], v[24:27]
    ds_read_b64_tr_b16 v[84:85], v224 offset:8192
    v_mfma_f32_16x16x32_bf16 v[40:43], v[60:63], v[156:159], v[40:43]
    ds_read_b64_tr_b16 v[86:87], v228 offset:8192
    ds_read_b64_tr_b16 v[88:89], v224 offset:12288
    v_mfma_f32_16x16x32_bf16 v[40:43], v[56:59], v[152:155], v[40:43]
    ds_read_b64_tr_b16 v[90:91], v228 offset:12288
    v_mfma_f32_16x16x32_bf16 v[40:43], v[52:55], v[148:151], v[40:43]
    ds_read_b64_tr_b16 v[92:93], v224 offset:16384
    v_mfma_f32_16x16x32_bf16 v[40:43], v[48:51], v[144:147], v[40:43]
    ds_read_b64_tr_b16 v[94:95], v228 offset:16384
    s_waitcnt lgkmcnt(8)
    v_mfma_f32_16x16x32_bf16 v[44:47], v[64:67], v[144:147], v[44:47]
    ds_read_b64_tr_b16 v[48:49], v225 offset:4096
    v_mfma_f32_16x16x32_bf16 v[44:47], v[68:71], v[148:151], v[44:47]
    ds_read_b64_tr_b16 v[50:51], v229 offset:4096
    v_mfma_f32_16x16x32_bf16 v[44:47], v[72:75], v[152:155], v[44:47]
    ds_read_b64_tr_b16 v[52:53], v225 offset:8192
    v_mfma_f32_16x16x32_bf16 v[44:47], v[76:79], v[156:159], v[44:47]
    ds_read_b64_tr_b16 v[54:55], v229 offset:8192
    v_mfma_f32_16x16x32_bf16 v[28:31], v[76:79], v[140:143], v[28:31]
    ds_read_b64_tr_b16 v[56:57], v225 offset:12288
    v_mfma_f32_16x16x32_bf16 v[28:31], v[72:75], v[136:139], v[28:31]
    ds_read_b64_tr_b16 v[58:59], v229 offset:12288
    v_mfma_f32_16x16x32_bf16 v[28:31], v[68:71], v[132:135], v[28:31]
    ds_read_b64_tr_b16 v[60:61], v225 offset:16384
    v_mfma_f32_16x16x32_bf16 v[28:31], v[64:67], v[128:131], v[28:31]
    ds_read_b64_tr_b16 v[62:63], v229 offset:16384
    s_waitcnt vmcnt(8) lgkmcnt(8)
    v_mfma_f32_16x16x32_bf16 v[16:19], v[80:83], v[160:163], v[16:19]
    buffer_load_dwordx4 v[128:131], v12, s[52:55], s40 offen offset:0 sc1
    buffer_load_dwordx4 v[132:135], v12, s[52:55], s40 offen offset:1024 sc1
    v_mfma_f32_16x16x32_bf16 v[16:19], v[84:87], v[164:167], v[16:19]
    buffer_load_dwordx4 v[136:139], v12, s[52:55], s40 offen offset:2048 sc1
    v_mfma_f32_16x16x32_bf16 v[16:19], v[88:91], v[168:171], v[16:19]
    buffer_load_dwordx4 v[140:143], v12, s[52:55], s40 offen offset:3072 sc1
    ds_read_b64_tr_b16 v[64:65], v226 offset:4096
    v_mfma_f32_16x16x32_bf16 v[16:19], v[92:95], v[172:175], v[16:19]
    ds_read_b64_tr_b16 v[66:67], v230 offset:4096
    v_mfma_f32_16x16x32_bf16 v[32:35], v[92:95], v[188:191], v[32:35]
    ds_read_b64_tr_b16 v[68:69], v226 offset:8192
    ds_read_b64_tr_b16 v[70:71], v230 offset:8192
    v_mfma_f32_16x16x32_bf16 v[32:35], v[88:91], v[184:187], v[32:35]
    ds_read_b64_tr_b16 v[72:73], v226 offset:12288
    v_mfma_f32_16x16x32_bf16 v[32:35], v[84:87], v[180:183], v[32:35]
    ds_read_b64_tr_b16 v[74:75], v230 offset:12288
    ds_read_b64_tr_b16 v[76:77], v226 offset:16384
    v_mfma_f32_16x16x32_bf16 v[32:35], v[80:83], v[176:179], v[32:35]
    ds_read_b64_tr_b16 v[78:79], v230 offset:16384
    s_waitcnt lgkmcnt(8)
    v_mfma_f32_16x16x32_bf16 v[36:39], v[48:51], v[176:179], v[36:39]
    buffer_load_dwordx4 v[144:147], v15, s[52:55], s40 offen offset:0 sc1
    buffer_load_dwordx4 v[148:151], v15, s[52:55], s40 offen offset:1024 sc1
    v_mfma_f32_16x16x32_bf16 v[36:39], v[52:55], v[180:183], v[36:39]
    ds_read_b64_tr_b16 v[80:81], v227 offset:4096
    v_mfma_f32_16x16x32_bf16 v[36:39], v[56:59], v[184:187], v[36:39]
    ds_read_b64_tr_b16 v[82:83], v231 offset:4096
    v_mfma_f32_16x16x32_bf16 v[36:39], v[60:63], v[188:191], v[36:39]
    ds_read_b64_tr_b16 v[84:85], v227 offset:8192
    v_mfma_f32_16x16x32_bf16 v[20:23], v[60:63], v[172:175], v[20:23]
    ds_read_b64_tr_b16 v[86:87], v231 offset:8192
    ds_read_b64_tr_b16 v[88:89], v227 offset:12288
    v_mfma_f32_16x16x32_bf16 v[20:23], v[56:59], v[168:171], v[20:23]
    ds_read_b64_tr_b16 v[90:91], v231 offset:12288
    v_mfma_f32_16x16x32_bf16 v[20:23], v[52:55], v[164:167], v[20:23]
    ds_read_b64_tr_b16 v[92:93], v227 offset:16384
    v_mfma_f32_16x16x32_bf16 v[20:23], v[48:51], v[160:163], v[20:23]
    ds_read_b64_tr_b16 v[94:95], v231 offset:16384
    s_waitcnt lgkmcnt(8)
    v_mfma_f32_16x16x32_bf16 v[24:27], v[64:67], v[160:163], v[24:27]
    buffer_load_dwordx4 v[152:155], v15, s[52:55], s40 offen offset:2048 sc1
    buffer_load_dwordx4 v[156:159], v15, s[52:55], s40 offen offset:3072 sc1
    v_mfma_f32_16x16x32_bf16 v[24:27], v[68:71], v[164:167], v[24:27]
    ds_read_b64_tr_b16 v[48:49], v224 offset:20480
    v_mfma_f32_16x16x32_bf16 v[24:27], v[72:75], v[168:171], v[24:27]
    ds_read_b64_tr_b16 v[50:51], v228 offset:20480
    v_mfma_f32_16x16x32_bf16 v[24:27], v[76:79], v[172:175], v[24:27]
    ds_read_b64_tr_b16 v[52:53], v2 offset:0
    v_mfma_f32_16x16x32_bf16 v[40:43], v[76:79], v[188:191], v[40:43]
    ds_read_b64_tr_b16 v[54:55], v6 offset:0
    ds_read_b64_tr_b16 v[56:57], v2 offset:4096
    v_mfma_f32_16x16x32_bf16 v[40:43], v[72:75], v[184:187], v[40:43]
    ds_read_b64_tr_b16 v[58:59], v6 offset:4096
    v_mfma_f32_16x16x32_bf16 v[40:43], v[68:71], v[180:183], v[40:43]
    ds_read_b64_tr_b16 v[60:61], v2 offset:8192
    v_mfma_f32_16x16x32_bf16 v[40:43], v[64:67], v[176:179], v[40:43]
    ds_read_b64_tr_b16 v[62:63], v6 offset:8192
    s_waitcnt lgkmcnt(8)
    v_mfma_f32_16x16x32_bf16 v[44:47], v[80:83], v[176:179], v[44:47]
    ds_read_b64_tr_b16 v[64:65], v225 offset:20480
    v_mfma_f32_16x16x32_bf16 v[44:47], v[84:87], v[180:183], v[44:47]
    ds_read_b64_tr_b16 v[66:67], v229 offset:20480
    v_mfma_f32_16x16x32_bf16 v[44:47], v[88:91], v[184:187], v[44:47]
    ds_read_b64_tr_b16 v[68:69], v3 offset:0
    v_mfma_f32_16x16x32_bf16 v[44:47], v[92:95], v[188:191], v[44:47]
    ds_read_b64_tr_b16 v[70:71], v7 offset:0
    v_mfma_f32_16x16x32_bf16 v[28:31], v[92:95], v[172:175], v[28:31]
    ds_read_b64_tr_b16 v[72:73], v3 offset:4096
    v_mfma_f32_16x16x32_bf16 v[28:31], v[88:91], v[168:171], v[28:31]
    ds_read_b64_tr_b16 v[74:75], v7 offset:4096
    v_mfma_f32_16x16x32_bf16 v[28:31], v[84:87], v[164:167], v[28:31]
    ds_read_b64_tr_b16 v[76:77], v3 offset:8192
    v_mfma_f32_16x16x32_bf16 v[28:31], v[80:83], v[160:163], v[28:31]
    ds_read_b64_tr_b16 v[78:79], v7 offset:8192
    s_waitcnt vmcnt(8) lgkmcnt(8)
    v_mfma_f32_16x16x32_bf16 v[16:19], v[48:51], v[96:99], v[16:19]
    buffer_load_dwordx4 v[160:163], v12, s[52:55], s41 offen offset:0 sc1
    buffer_load_dwordx4 v[164:167], v12, s[52:55], s41 offen offset:1024 sc1
    v_mfma_f32_16x16x32_bf16 v[16:19], v[52:55], v[100:103], v[16:19]
    buffer_load_dwordx4 v[168:171], v12, s[52:55], s41 offen offset:2048 sc1
    v_mfma_f32_16x16x32_bf16 v[16:19], v[56:59], v[104:107], v[16:19]
    buffer_load_dwordx4 v[172:175], v12, s[52:55], s41 offen offset:3072 sc1
    ds_read_b64_tr_b16 v[80:81], v226 offset:20480
    v_mfma_f32_16x16x32_bf16 v[16:19], v[60:63], v[108:111], v[16:19]
    ds_read_b64_tr_b16 v[82:83], v230 offset:20480
    v_mfma_f32_16x16x32_bf16 v[32:35], v[60:63], v[124:127], v[32:35]
    ds_read_b64_tr_b16 v[84:85], v4 offset:0
    ds_read_b64_tr_b16 v[86:87], v8 offset:0
    v_mfma_f32_16x16x32_bf16 v[32:35], v[56:59], v[120:123], v[32:35]
    ds_read_b64_tr_b16 v[88:89], v4 offset:4096
    v_mfma_f32_16x16x32_bf16 v[32:35], v[52:55], v[116:119], v[32:35]
    ds_read_b64_tr_b16 v[90:91], v8 offset:4096
    ds_read_b64_tr_b16 v[92:93], v4 offset:8192
    v_mfma_f32_16x16x32_bf16 v[32:35], v[48:51], v[112:115], v[32:35]
    ds_read_b64_tr_b16 v[94:95], v8 offset:8192
    s_waitcnt lgkmcnt(8)
    v_mfma_f32_16x16x32_bf16 v[36:39], v[64:67], v[112:115], v[36:39]
    buffer_load_dwordx4 v[176:179], v15, s[52:55], s41 offen offset:0 sc1
    buffer_load_dwordx4 v[180:183], v15, s[52:55], s41 offen offset:1024 sc1
    v_mfma_f32_16x16x32_bf16 v[36:39], v[68:71], v[116:119], v[36:39]
    ds_read_b64_tr_b16 v[48:49], v227 offset:20480
    v_mfma_f32_16x16x32_bf16 v[36:39], v[72:75], v[120:123], v[36:39]
    ds_read_b64_tr_b16 v[50:51], v231 offset:20480
    v_mfma_f32_16x16x32_bf16 v[36:39], v[76:79], v[124:127], v[36:39]
    ds_read_b64_tr_b16 v[52:53], v5 offset:0
    v_mfma_f32_16x16x32_bf16 v[20:23], v[76:79], v[108:111], v[20:23]
    ds_read_b64_tr_b16 v[54:55], v9 offset:0
    ds_read_b64_tr_b16 v[56:57], v5 offset:4096
    v_mfma_f32_16x16x32_bf16 v[20:23], v[72:75], v[104:107], v[20:23]
    ds_read_b64_tr_b16 v[58:59], v9 offset:4096
    v_mfma_f32_16x16x32_bf16 v[20:23], v[68:71], v[100:103], v[20:23]
    ds_read_b64_tr_b16 v[60:61], v5 offset:8192
    v_mfma_f32_16x16x32_bf16 v[20:23], v[64:67], v[96:99], v[20:23]
    ds_read_b64_tr_b16 v[62:63], v9 offset:8192
    s_waitcnt lgkmcnt(8)
    v_mfma_f32_16x16x32_bf16 v[24:27], v[80:83], v[96:99], v[24:27]
    buffer_load_dwordx4 v[184:187], v15, s[52:55], s41 offen offset:2048 sc1
    buffer_load_dwordx4 v[188:191], v15, s[52:55], s41 offen offset:3072 sc1
    v_mfma_f32_16x16x32_bf16 v[24:27], v[84:87], v[100:103], v[24:27]
    ds_read_b64_tr_b16 v[64:65], v2 offset:12288
    v_mfma_f32_16x16x32_bf16 v[24:27], v[88:91], v[104:107], v[24:27]
    ds_read_b64_tr_b16 v[66:67], v6 offset:12288
    v_mfma_f32_16x16x32_bf16 v[24:27], v[92:95], v[108:111], v[24:27]
    ds_read_b64_tr_b16 v[68:69], v2 offset:16384
    v_mfma_f32_16x16x32_bf16 v[40:43], v[92:95], v[124:127], v[40:43]
    ds_read_b64_tr_b16 v[70:71], v6 offset:16384
    ds_read_b64_tr_b16 v[72:73], v2 offset:20480
    v_mfma_f32_16x16x32_bf16 v[40:43], v[88:91], v[120:123], v[40:43]
    ds_read_b64_tr_b16 v[74:75], v6 offset:20480
    v_mfma_f32_16x16x32_bf16 v[40:43], v[84:87], v[116:119], v[40:43]
    ds_read_b64_tr_b16 v[76:77], v224 offset:45056
    v_mfma_f32_16x16x32_bf16 v[40:43], v[80:83], v[112:115], v[40:43]
    ds_read_b64_tr_b16 v[78:79], v228 offset:45056
    s_mov_b64 exec, 1
    ds_add_u32 v10, v11 offset:28
    s_mov_b64 exec, -1
    s_waitcnt lgkmcnt(9)
    v_mfma_f32_16x16x32_bf16 v[44:47], v[48:51], v[112:115], v[44:47]
    ds_read_b64_tr_b16 v[80:81], v3 offset:12288
    v_mfma_f32_16x16x32_bf16 v[44:47], v[52:55], v[116:119], v[44:47]
    ds_read_b64_tr_b16 v[82:83], v7 offset:12288
    v_mfma_f32_16x16x32_bf16 v[44:47], v[56:59], v[120:123], v[44:47]
    ds_read_b64_tr_b16 v[84:85], v3 offset:16384
    v_mfma_f32_16x16x32_bf16 v[44:47], v[60:63], v[124:127], v[44:47]
    ds_read_b64_tr_b16 v[86:87], v7 offset:16384
    v_mfma_f32_16x16x32_bf16 v[28:31], v[60:63], v[108:111], v[28:31]
    ds_read_b64_tr_b16 v[88:89], v3 offset:20480
    v_mfma_f32_16x16x32_bf16 v[28:31], v[56:59], v[104:107], v[28:31]
    ds_read_b64_tr_b16 v[90:91], v7 offset:20480
    v_mfma_f32_16x16x32_bf16 v[28:31], v[52:55], v[100:103], v[28:31]
    ds_read_b64_tr_b16 v[92:93], v225 offset:45056
    v_mfma_f32_16x16x32_bf16 v[28:31], v[48:51], v[96:99], v[28:31]
    ds_read_b64_tr_b16 v[94:95], v229 offset:45056
    s_waitcnt vmcnt(8) lgkmcnt(9)
    v_mfma_f32_16x16x32_bf16 v[16:19], v[64:67], v[128:131], v[16:19]
    buffer_load_dwordx4 v[96:99], v12, s[52:55], s42 offen offset:0 sc1
    buffer_load_dwordx4 v[100:103], v12, s[52:55], s42 offen offset:1024 sc1
    v_mfma_f32_16x16x32_bf16 v[16:19], v[68:71], v[132:135], v[16:19]
    buffer_load_dwordx4 v[104:107], v12, s[52:55], s42 offen offset:2048 sc1
    v_mfma_f32_16x16x32_bf16 v[16:19], v[72:75], v[136:139], v[16:19]
    buffer_load_dwordx4 v[108:111], v12, s[52:55], s42 offen offset:3072 sc1
    ds_read_b64_tr_b16 v[48:49], v4 offset:12288
    v_mfma_f32_16x16x32_bf16 v[16:19], v[76:79], v[140:143], v[16:19]
    ds_read_b64_tr_b16 v[50:51], v8 offset:12288
    v_mfma_f32_16x16x32_bf16 v[32:35], v[76:79], v[156:159], v[32:35]
    ds_read_b64_tr_b16 v[52:53], v4 offset:16384
    ds_read_b64_tr_b16 v[54:55], v8 offset:16384
    v_mfma_f32_16x16x32_bf16 v[32:35], v[72:75], v[152:155], v[32:35]
    ds_read_b64_tr_b16 v[56:57], v4 offset:20480
    v_mfma_f32_16x16x32_bf16 v[32:35], v[68:71], v[148:151], v[32:35]
    ds_read_b64_tr_b16 v[58:59], v8 offset:20480
    ds_read_b64_tr_b16 v[60:61], v226 offset:45056
    v_mfma_f32_16x16x32_bf16 v[32:35], v[64:67], v[144:147], v[32:35]
    ds_read_b64_tr_b16 v[62:63], v230 offset:45056
    s_waitcnt lgkmcnt(8)
    v_mfma_f32_16x16x32_bf16 v[36:39], v[80:83], v[144:147], v[36:39]
    buffer_load_dwordx4 v[112:115], v15, s[52:55], s42 offen offset:0 sc1
    buffer_load_dwordx4 v[116:119], v15, s[52:55], s42 offen offset:1024 sc1
    v_mfma_f32_16x16x32_bf16 v[36:39], v[84:87], v[148:151], v[36:39]
    ds_read_b64_tr_b16 v[64:65], v5 offset:12288
    v_mfma_f32_16x16x32_bf16 v[36:39], v[88:91], v[152:155], v[36:39]
    ds_read_b64_tr_b16 v[66:67], v9 offset:12288
    v_mfma_f32_16x16x32_bf16 v[36:39], v[92:95], v[156:159], v[36:39]
    ds_read_b64_tr_b16 v[68:69], v5 offset:16384
    v_mfma_f32_16x16x32_bf16 v[20:23], v[92:95], v[140:143], v[20:23]
    ds_read_b64_tr_b16 v[70:71], v9 offset:16384
    ds_read_b64_tr_b16 v[72:73], v5 offset:20480
    v_mfma_f32_16x16x32_bf16 v[20:23], v[88:91], v[136:139], v[20:23]
    ds_read_b64_tr_b16 v[74:75], v9 offset:20480
    v_mfma_f32_16x16x32_bf16 v[20:23], v[84:87], v[132:135], v[20:23]
    ds_read_b64_tr_b16 v[76:77], v227 offset:45056
    v_mfma_f32_16x16x32_bf16 v[20:23], v[80:83], v[128:131], v[20:23]
    ds_read_b64_tr_b16 v[78:79], v231 offset:45056
    s_waitcnt lgkmcnt(8)
    v_mfma_f32_16x16x32_bf16 v[24:27], v[48:51], v[128:131], v[24:27]
    buffer_load_dwordx4 v[120:123], v15, s[52:55], s42 offen offset:2048 sc1
    buffer_load_dwordx4 v[124:127], v15, s[52:55], s42 offen offset:3072 sc1
    v_mfma_f32_16x16x32_bf16 v[24:27], v[52:55], v[132:135], v[24:27]
    ds_read_b64_tr_b16 v[80:81], v224 offset:49152
    v_mfma_f32_16x16x32_bf16 v[24:27], v[56:59], v[136:139], v[24:27]
    ds_read_b64_tr_b16 v[82:83], v228 offset:49152
    v_mfma_f32_16x16x32_bf16 v[24:27], v[60:63], v[140:143], v[24:27]
    ds_read_b64_tr_b16 v[84:85], v224 offset:53248
    v_mfma_f32_16x16x32_bf16 v[40:43], v[60:63], v[156:159], v[40:43]
    ds_read_b64_tr_b16 v[86:87], v228 offset:53248
    ds_read_b64_tr_b16 v[88:89], v224 offset:57344
    v_mfma_f32_16x16x32_bf16 v[40:43], v[56:59], v[152:155], v[40:43]
    ds_read_b64_tr_b16 v[90:91], v228 offset:57344
    v_mfma_f32_16x16x32_bf16 v[40:43], v[52:55], v[148:151], v[40:43]
    ds_read_b64_tr_b16 v[92:93], v2 offset:24576
    v_mfma_f32_16x16x32_bf16 v[40:43], v[48:51], v[144:147], v[40:43]
    ds_read_b64_tr_b16 v[94:95], v6 offset:24576
    s_waitcnt lgkmcnt(8)
    v_mfma_f32_16x16x32_bf16 v[44:47], v[64:67], v[144:147], v[44:47]
    ds_read_b64_tr_b16 v[48:49], v225 offset:49152
    v_mfma_f32_16x16x32_bf16 v[44:47], v[68:71], v[148:151], v[44:47]
    ds_read_b64_tr_b16 v[50:51], v229 offset:49152
    v_mfma_f32_16x16x32_bf16 v[44:47], v[72:75], v[152:155], v[44:47]
    ds_read_b64_tr_b16 v[52:53], v225 offset:53248
    v_mfma_f32_16x16x32_bf16 v[44:47], v[76:79], v[156:159], v[44:47]
    ds_read_b64_tr_b16 v[54:55], v229 offset:53248
    v_mfma_f32_16x16x32_bf16 v[28:31], v[76:79], v[140:143], v[28:31]
    ds_read_b64_tr_b16 v[56:57], v225 offset:57344
    v_mfma_f32_16x16x32_bf16 v[28:31], v[72:75], v[136:139], v[28:31]
    ds_read_b64_tr_b16 v[58:59], v229 offset:57344
    v_mfma_f32_16x16x32_bf16 v[28:31], v[68:71], v[132:135], v[28:31]
    ds_read_b64_tr_b16 v[60:61], v3 offset:24576
    v_mfma_f32_16x16x32_bf16 v[28:31], v[64:67], v[128:131], v[28:31]
    ds_read_b64_tr_b16 v[62:63], v7 offset:24576
    s_waitcnt vmcnt(8) lgkmcnt(8)
    v_mfma_f32_16x16x32_bf16 v[16:19], v[80:83], v[160:163], v[16:19]
    buffer_load_dwordx4 v[128:131], v12, s[52:55], s43 offen offset:0 sc1
    buffer_load_dwordx4 v[132:135], v12, s[52:55], s43 offen offset:1024 sc1
    v_mfma_f32_16x16x32_bf16 v[16:19], v[84:87], v[164:167], v[16:19]
    buffer_load_dwordx4 v[136:139], v12, s[52:55], s43 offen offset:2048 sc1
    v_mfma_f32_16x16x32_bf16 v[16:19], v[88:91], v[168:171], v[16:19]
    buffer_load_dwordx4 v[140:143], v12, s[52:55], s43 offen offset:3072 sc1
    ds_read_b64_tr_b16 v[64:65], v226 offset:49152
    v_mfma_f32_16x16x32_bf16 v[16:19], v[92:95], v[172:175], v[16:19]
    ds_read_b64_tr_b16 v[66:67], v230 offset:49152
    v_mfma_f32_16x16x32_bf16 v[32:35], v[92:95], v[188:191], v[32:35]
    ds_read_b64_tr_b16 v[68:69], v226 offset:53248
    ds_read_b64_tr_b16 v[70:71], v230 offset:53248
    v_mfma_f32_16x16x32_bf16 v[32:35], v[88:91], v[184:187], v[32:35]
    ds_read_b64_tr_b16 v[72:73], v226 offset:57344
    v_mfma_f32_16x16x32_bf16 v[32:35], v[84:87], v[180:183], v[32:35]
    ds_read_b64_tr_b16 v[74:75], v230 offset:57344
    ds_read_b64_tr_b16 v[76:77], v4 offset:24576
    v_mfma_f32_16x16x32_bf16 v[32:35], v[80:83], v[176:179], v[32:35]
    ds_read_b64_tr_b16 v[78:79], v8 offset:24576
    s_mov_b64 exec, 1
    ds_add_u32 v10, v11 offset:40
    s_mov_b64 exec, -1
    s_waitcnt lgkmcnt(9)
    v_mfma_f32_16x16x32_bf16 v[36:39], v[48:51], v[176:179], v[36:39]
    buffer_load_dwordx4 v[144:147], v15, s[52:55], s43 offen offset:0 sc1
    buffer_load_dwordx4 v[148:151], v15, s[52:55], s43 offen offset:1024 sc1
    v_mfma_f32_16x16x32_bf16 v[36:39], v[52:55], v[180:183], v[36:39]
    ds_read_b32 v223, v10 offset:32
    v_mfma_f32_16x16x32_bf16 v[36:39], v[56:59], v[184:187], v[36:39]
    ds_read_b64_tr_b16 v[80:81], v227 offset:49152
    ds_read_b64_tr_b16 v[82:83], v231 offset:49152
    v_mfma_f32_16x16x32_bf16 v[36:39], v[60:63], v[188:191], v[36:39]
    ds_read_b64_tr_b16 v[84:85], v227 offset:53248
    v_mfma_f32_16x16x32_bf16 v[20:23], v[60:63], v[172:175], v[20:23]
    ds_read_b64_tr_b16 v[86:87], v231 offset:53248
    v_mfma_f32_16x16x32_bf16 v[20:23], v[56:59], v[168:171], v[20:23]
    ds_read_b64_tr_b16 v[88:89], v227 offset:57344
    ds_read_b64_tr_b16 v[90:91], v231 offset:57344
    v_mfma_f32_16x16x32_bf16 v[20:23], v[52:55], v[164:167], v[20:23]
    ds_read_b64_tr_b16 v[92:93], v5 offset:24576
    v_mfma_f32_16x16x32_bf16 v[20:23], v[48:51], v[160:163], v[20:23]
    ds_read_b64_tr_b16 v[94:95], v9 offset:24576
    s_waitcnt lgkmcnt(8)
    v_cmp_gt_u32 vcc, 4, v223
    s_cbranch_vccnz LB_w8
LB_g8:
    v_mfma_f32_16x16x32_bf16 v[24:27], v[64:67], v[160:163], v[24:27]
    buffer_load_dwordx4 v[152:155], v15, s[52:55], s43 offen offset:2048 sc1
    buffer_load_dwordx4 v[156:159], v15, s[52:55], s43 offen offset:3072 sc1
    v_mfma_f32_16x16x32_bf16 v[24:27], v[68:71], v[164:167], v[24:27]
    ds_read_b64_tr_b16 v[48:49], v2 offset:28672
    v_mfma_f32_16x16x32_bf16 v[24:27], v[72:75], v[168:171], v[24:27]
    ds_read_b64_tr_b16 v[50:51], v6 offset:28672
    v_mfma_f32_16x16x32_bf16 v[24:27], v[76:79], v[172:175], v[24:27]
    ds_read_b64_tr_b16 v[52:53], v2 offset:32768
    v_mfma_f32_16x16x32_bf16 v[40:43], v[76:79], v[188:191], v[40:43]
    ds_read_b64_tr_b16 v[54:55], v6 offset:32768
    ds_read_b64_tr_b16 v[56:57], v232 offset:0
    v_mfma_f32_16x16x32_bf16 v[40:43], v[72:75], v[184:187], v[40:43]
    ds_read_b64_tr_b16 v[58:59], v236 offset:0
    v_mfma_f32_16x16x32_bf16 v[40:43], v[68:71], v[180:183], v[40:43]
    ds_read_b64_tr_b16 v[60:61], v232 offset:4096
    v_mfma_f32_16x16x32_bf16 v[40:43], v[64:67], v[176:179], v[40:43]
    ds_read_b64_tr_b16 v[62:63], v236 offset:4096
    s_waitcnt lgkmcnt(8)
    v_mfma_f32_16x16x32_bf16 v[44:47], v[80:83], v[176:179], v[44:47]
    ds_read_b64_tr_b16 v[64:65], v3 offset:28672
    v_mfma_f32_16x16x32_bf16 v[44:47], v[84:87], v[180:183], v[44:47]
    ds_read_b64_tr_b16 v[66:67], v7 offset:28672
    v_mfma_f32_16x16x32_bf16 v[44:47], v[88:91], v[184:187], v[44:47]
    ds_read_b64_tr_b16 v[68:69], v3 offset:32768
    v_mfma_f32_16x16x32_bf16 v[44:47], v[92:95], v[188:191], v[44:47]
    ds_read_b64_tr_b16 v[70:71], v7 offset:32768
    v_mfma_f32_16x16x32_bf16 v[28:31], v[92:95], v[172:175], v[28:31]
    ds_read_b64_tr_b16 v[72:73], v233 offset:0
    v_mfma_f32_16x16x32_bf16 v[28:31], v[88:91], v[168:171], v[28:31]
    ds_read_b64_tr_b16 v[74:75], v237 offset:0
    v_mfma_f32_16x16x32_bf16 v[28:31], v[84:87], v[164:167], v[28:31]
    ds_read_b64_tr_b16 v[76:77], v233 offset:4096
    v_mfma_f32_16x16x32_bf16 v[28:31], v[80:83], v[160:163], v[28:31]
    ds_read_b64_tr_b16 v[78:79], v237 offset:4096
    s_waitcnt vmcnt(8) lgkmcnt(8)
    v_mfma_f32_16x16x32_bf16 v[16:19], v[48:51], v[96:99], v[16:19]
    ds_read_b64_tr_b16 v[80:81], v4 offset:28672
    v_mfma_f32_16x16x32_bf16 v[16:19], v[52:55], v[100:103], v[16:19]
    ds_read_b64_tr_b16 v[82:83], v8 offset:28672
    v_mfma_f32_16x16x32_bf16 v[16:19], v[56:59], v[104:107], v[16:19]
    ds_read_b64_tr_b16 v[84:85], v4 offset:32768
    v_mfma_f32_16x16x32_bf16 v[16:19], v[60:63], v[108:111], v[16:19]
    ds_read_b64_tr_b16 v[86:87], v8 offset:32768
    v_mfma_f32_16x16x32_bf16 v[32:35], v[60:63], v[124:127], v[32:35]
    ds_read_b64_tr_b16 v[88:89], v234 offset:0
    v_mfma_f32_16x16x32_bf16 v[32:35], v[56:59], v[120:123], v[32:35]
    ds_read_b64_tr_b16 v[90:91], v238 offset:0
    v_mfma_f32_16x16x32_bf16 v[32:35], v[52:55], v[116:119], v[32:35]
    ds_read_b64_tr_b16 v[92:93], v234 offset:4096
    v_mfma_f32_16x16x32_bf16 v[32:35], v[48:51], v[112:115], v[32:35]
    ds_read_b64_tr_b16 v[94:95], v238 offset:4096
    s_waitcnt lgkmcnt(8)
    v_mfma_f32_16x16x32_bf16 v[36:39], v[64:67], v[112:115], v[36:39]
    ds_read_b64_tr_b16 v[48:49], v5 offset:28672
    v_mfma_f32_16x16x32_bf16 v[36:39], v[68:71], v[116:119], v[36:39]
    ds_read_b64_tr_b16 v[50:51], v9 offset:28672
    v_mfma_f32_16x16x32_bf16 v[36:39], v[72:75], v[120:123], v[36:39]
    ds_read_b64_tr_b16 v[52:53], v5 offset:32768
    v_mfma_f32_16x16x32_bf16 v[36:39], v[76:79], v[124:127], v[36:39]
    ds_read_b64_tr_b16 v[54:55], v9 offset:32768
    v_mfma_f32_16x16x32_bf16 v[20:23], v[76:79], v[108:111], v[20:23]
    ds_read_b64_tr_b16 v[56:57], v235 offset:0
    v_mfma_f32_16x16x32_bf16 v[20:23], v[72:75], v[104:107], v[20:23]
    ds_read_b64_tr_b16 v[58:59], v239 offset:0
    v_mfma_f32_16x16x32_bf16 v[20:23], v[68:71], v[100:103], v[20:23]
    ds_read_b64_tr_b16 v[60:61], v235 offset:4096
    v_mfma_f32_16x16x32_bf16 v[20:23], v[64:67], v[96:99], v[20:23]
    ds_read_b64_tr_b16 v[62:63], v239 offset:4096
    s_waitcnt lgkmcnt(8)
    v_mfma_f32_16x16x32_bf16 v[24:27], v[80:83], v[96:99], v[24:27]
    ds_read_b64_tr_b16 v[64:65], v232 offset:8192
    v_mfma_f32_16x16x32_bf16 v[24:27], v[84:87], v[100:103], v[24:27]
    ds_read_b64_tr_b16 v[66:67], v236 offset:8192
    v_mfma_f32_16x16x32_bf16 v[24:27], v[88:91], v[104:107], v[24:27]
    ds_read_b64_tr_b16 v[68:69], v232 offset:12288
    v_mfma_f32_16x16x32_bf16 v[24:27], v[92:95], v[108:111], v[24:27]
    ds_read_b64_tr_b16 v[70:71], v236 offset:12288
    v_mfma_f32_16x16x32_bf16 v[40:43], v[92:95], v[124:127], v[40:43]
    ds_read_b64_tr_b16 v[72:73], v232 offset:16384
    v_mfma_f32_16x16x32_bf16 v[40:43], v[88:91], v[120:123], v[40:43]
    ds_read_b64_tr_b16 v[74:75], v236 offset:16384
    v_mfma_f32_16x16x32_bf16 v[40:43], v[84:87], v[116:119], v[40:43]
    ds_read_b64_tr_b16 v[76:77], v232 offset:20480
    v_mfma_f32_16x16x32_bf16 v[40:43], v[80:83], v[112:115], v[40:43]
    ds_read_b64_tr_b16 v[78:79], v236 offset:20480
    s_waitcnt lgkmcnt(8)
    v_mfma_f32_16x16x32_bf16 v[44:47], v[48:51], v[112:115], v[44:47]
    ds_read_b64_tr_b16 v[80:81], v233 offset:8192
    v_mfma_f32_16x16x32_bf16 v[44:47], v[52:55], v[116:119], v[44:47]
    ds_read_b64_tr_b16 v[82:83], v237 offset:8192
    v_mfma_f32_16x16x32_bf16 v[44:47], v[56:59], v[120:123], v[44:47]
    ds_read_b64_tr_b16 v[84:85], v233 offset:12288
    v_mfma_f32_16x16x32_bf16 v[44:47], v[60:63], v[124:127], v[44:47]
    ds_read_b64_tr_b16 v[86:87], v237 offset:12288
    v_mfma_f32_16x16x32_bf16 v[28:31], v[60:63], v[108:111], v[28:31]
    ds_read_b64_tr_b16 v[88:89], v233 offset:16384
    v_mfma_f32_16x16x32_bf16 v[28:31], v[56:59], v[104:107], v[28:31]
    ds_read_b64_tr_b16 v[90:91], v237 offset:16384
    v_mfma_f32_16x16x32_bf16 v[28:31], v[52:55], v[100:103], v[28:31]
    ds_read_b64_tr_b16 v[92:93], v233 offset:20480
    v_mfma_f32_16x16x32_bf16 v[28:31], v[48:51], v[96:99], v[28:31]
    ds_read_b64_tr_b16 v[94:95], v237 offset:20480
    s_waitcnt vmcnt(0) lgkmcnt(8)
    v_mfma_f32_16x16x32_bf16 v[16:19], v[64:67], v[128:131], v[16:19]
    ds_read_b32 v223, v10 offset:40
    ds_read_b64_tr_b16 v[48:49], v234 offset:8192
    v_mfma_f32_16x16x32_bf16 v[16:19], v[68:71], v[132:135], v[16:19]
    ds_read_b64_tr_b16 v[50:51], v238 offset:8192
    v_mfma_f32_16x16x32_bf16 v[16:19], v[72:75], v[136:139], v[16:19]
    ds_read_b64_tr_b16 v[52:53], v234 offset:12288
    v_mfma_f32_16x16x32_bf16 v[16:19], v[76:79], v[140:143], v[16:19]
    ds_read_b64_tr_b16 v[54:55], v238 offset:12288
    v_mfma_f32_16x16x32_bf16 v[32:35], v[76:79], v[156:159], v[32:35]
    ds_read_b64_tr_b16 v[56:57], v234 offset:16384
    v_mfma_f32_16x16x32_bf16 v[32:35], v[72:75], v[152:155], v[32:35]
    ds_read_b64_tr_b16 v[58:59], v238 offset:16384
    v_mfma_f32_16x16x32_bf16 v[32:35], v[68:71], v[148:151], v[32:35]
    ds_read_b64_tr_b16 v[60:61], v234 offset:20480
    v_mfma_f32_16x16x32_bf16 v[32:35], v[64:67], v[144:147], v[32:35]
    ds_read_b64_tr_b16 v[62:63], v238 offset:20480
    s_waitcnt lgkmcnt(9)
    v_mfma_f32_16x16x32_bf16 v[36:39], v[80:83], v[144:147], v[36:39]
    ds_read_b64_tr_b16 v[64:65], v235 offset:8192
    v_mfma_f32_16x16x32_bf16 v[36:39], v[84:87], v[148:151], v[36:39]
    ds_read_b64_tr_b16 v[66:67], v239 offset:8192
    v_mfma_f32_16x16x32_bf16 v[36:39], v[88:91], v[152:155], v[36:39]
    ds_read_b64_tr_b16 v[68:69], v235 offset:12288
    v_mfma_f32_16x16x32_bf16 v[36:39], v[92:95], v[156:159], v[36:39]
    ds_read_b64_tr_b16 v[70:71], v239 offset:12288
    v_mfma_f32_16x16x32_bf16 v[20:23], v[92:95], v[140:143], v[20:23]
    ds_read_b64_tr_b16 v[72:73], v235 offset:16384
    v_mfma_f32_16x16x32_bf16 v[20:23], v[88:91], v[136:139], v[20:23]
    ds_read_b64_tr_b16 v[74:75], v239 offset:16384
    v_mfma_f32_16x16x32_bf16 v[20:23], v[84:87], v[132:135], v[20:23]
    ds_read_b64_tr_b16 v[76:77], v235 offset:20480
    v_mfma_f32_16x16x32_bf16 v[20:23], v[80:83], v[128:131], v[20:23]
    ds_read_b64_tr_b16 v[78:79], v239 offset:20480
    s_waitcnt lgkmcnt(14)
    v_cmp_gt_u32 vcc, 4, v223
    s_cbranch_vccnz LB_w7
LB_g7:
    v_mfma_f32_16x16x32_bf16 v[24:27], v[48:51], v[128:131], v[24:27]
    s_nop 1
    v_cvt_pk_bf16_f32 v200, v32, v33
    s_waitcnt lgkmcnt(12)
    v_mfma_f32_16x16x32_bf16 v[24:27], v[52:55], v[132:135], v[24:27]
    v_cvt_pk_bf16_f32 v201, v34, v35
    v_cvt_pk_bf16_f32 v202, v36, v37
    s_waitcnt lgkmcnt(10)
    v_mfma_f32_16x16x32_bf16 v[24:27], v[56:59], v[136:139], v[24:27]
    v_cvt_pk_bf16_f32 v203, v38, v39
    v_permlane16_swap_b32 v200, v202
    s_waitcnt lgkmcnt(8)
    v_mfma_f32_16x16x32_bf16 v[24:27], v[60:63], v[140:143], v[24:27]
    v_permlane16_swap_b32 v201, v203
    ds_write_b128 v248, v[200:203] offset:2048
    v_mfma_f32_16x16x32_bf16 v[40:43], v[60:63], v[156:159], v[40:43]
    v_cvt_pk_bf16_f32 v192, v16, v17
    v_cvt_pk_bf16_f32 v193, v18, v19
    v_mfma_f32_16x16x32_bf16 v[40:43], v[56:59], v[152:155], v[40:43]
    v_cvt_pk_bf16_f32 v194, v20, v21
    v_cvt_pk_bf16_f32 v195, v22, v23
    v_mfma_f32_16x16x32_bf16 v[40:43], v[52:55], v[148:151], v[40:43]
    v_permlane16_swap_b32 v192, v194
    v_permlane16_swap_b32 v193, v195
    v_mfma_f32_16x16x32_bf16 v[40:43], v[48:51], v[144:147], v[40:43]
    ds_write_b128 v248, v[192:195] offset:0
    v_cvt_pk_bf16_f32 v196, v24, v25
    s_waitcnt lgkmcnt(8)
    v_mfma_f32_16x16x32_bf16 v[44:47], v[64:67], v[144:147], v[44:47]
    v_cvt_pk_bf16_f32 v197, v26, v27
    s_nop 0
    s_waitcnt lgkmcnt(6)
    v_mfma_f32_16x16x32_bf16 v[44:47], v[68:71], v[148:151], v[44:47]
    s_nop 1
    s_waitcnt lgkmcnt(4)
    v_mfma_f32_16x16x32_bf16 v[44:47], v[72:75], v[152:155], v[44:47]
    v_cvt_pk_bf16_f32 v204, v40, v41
    v_cvt_pk_bf16_f32 v205, v42, v43
    s_waitcnt lgkmcnt(2)
    v_mfma_f32_16x16x32_bf16 v[44:47], v[76:79], v[156:159], v[44:47]
    s_nop 1
    v_mfma_f32_16x16x32_bf16 v[28:31], v[76:79], v[140:143], v[28:31]
    s_nop 1
    v_mfma_f32_16x16x32_bf16 v[28:31], v[72:75], v[136:139], v[28:31]
    s_nop 1
    v_mfma_f32_16x16x32_bf16 v[28:31], v[68:71], v[132:135], v[28:31]
    v_cvt_pk_bf16_f32 v206, v44, v45
    v_cvt_pk_bf16_f32 v207, v46, v47
    v_mfma_f32_16x16x32_bf16 v[28:31], v[64:67], v[128:131], v[28:31]
    v_permlane16_swap_b32 v204, v206
    v_permlane16_swap_b32 v205, v207
    ds_write_b128 v249, v[204:207] offset:2048
    ds_read_b128 v[184:187], v250 offset:2048
    ds_read_b128 v[188:191], v250 offset:3072
    s_nop 2
    v_cvt_pk_bf16_f32 v198, v28, v29
    v_cvt_pk_bf16_f32 v199, v30, v31
    s_nop 0
    v_permlane16_swap_b32 v196, v198
    v_permlane16_swap_b32 v197, v199
    ds_write_b128 v249, v[196:199] offset:0
    ds_read_b128 v[176:179], v250 offset:0
    ds_read_b128 v[180:183], v250 offset:1024
    s_mov_b32 s95, 65536
    s_waitcnt lgkmcnt(4)
    buffer_store_dwordx4 v[184:187], v246, s[60:63], s95 offen nt sc1
    s_mov_b32 s95, 98304
    s_waitcnt lgkmcnt(3)
    buffer_store_dwordx4 v[188:191], v246, s[60:63], s95 offen nt sc1
    s_mov_b32 s95, 0
    s_waitcnt lgkmcnt(1)
    buffer_store_dwordx4 v[176:179], v246, s[60:63], s95 offen nt sc1
    s_mov_b32 s95, 32768
    s_waitcnt lgkmcnt(0)
    buffer_store_dwordx4 v[180:183], v246, s[60:63], s95 offen nt sc1
    s_endpgm
LA_slow:
    s_mov_b32 s79, 0
LA_slow1:
    s_mov_b64 exec, vcc
    s_sleep 8
    buffer_load_dword v136, v33, s[68:71], 0 offen sc1
    buffer_load_dword v137, v34, s[52:55], 0 offen sc1
    s_add_u32 s79, s79, 1
    s_cmp_gt_u32 s79, 200000
    s_waitcnt vmcnt(0)
    s_cbranch_scc1 LA_back
    v_cmp_ne_u32 vcc, v136, v137
    v_cmp_gt_u32 s[80:81], s96, v136
    s_nop 0
    s_or_b64 vcc, vcc, s[80:81]
    s_cbranch_vccnz LA_slow1
    s_branch LA_back
LB_tag:
    s_mov_b64 exec, 0xffff
    s_waitcnt vmcnt(0)
    v_lshrrev_b32 v251, v0, v251
    v_and_b32 v251, 1, v251
    v_cmp_eq_u32 vcc, 0, v251
    s_nop 1
    s_or_b32 s83, vcc_lo, 0x10000
    s_mov_b64 exec, 1
    v_mov_b32 v251, s83
    buffer_store_dword v251, v220, s[68:71], s98 offen sc1
    s_mov_b64 exec, -1
    s_branch LB_tagb
LB_slow:
    s_mov_b32 s79, 0
LB_pt:
    buffer_load_dword v222, v220, s[68:71], s98 offen sc1
    s_add_u32 s79, s79, 1
    s_cmp_gt_u32 s79, 200000
    s_cbranch_scc1 LB_pt_x
    s_waitcnt vmcnt(0)
    v_cmp_gt_u32 vcc, 4096, v222
    s_cbranch_vccz LB_pt_x
    s_mov_b64 exec, vcc
    s_sleep 8
    s_branch LB_pt
LB_pt_x:
    s_waitcnt vmcnt(0)
    s_branch LB_back
LB_w1:
    s_branch LB_s1_in
LB_s1:
    s_sleep 1
LB_s1_in:
    ds_read_b32 v223, v10 offset:0
    ds_read_b64 v[204:205], v218
    ds_read_b64 v[206:207], v219
    s_waitcnt lgkmcnt(0)
    v_readfirstlane_b32 s78, v223
    s_nop 0
    s_cmp_ge_u32 s78, 4
    s_cbranch_scc0 LB_s1
    s_branch LB_g1
LB_w6:
    s_branch LB_s6_in
LB_s6:
    s_sleep 1
LB_s6_in:
    ds_read_b32 v223, v10 offset:24
    ds_read_b64 v[224:225], v218 offset:1024
    ds_read_b64 v[234:235], v219 offset:1024
    s_waitcnt lgkmcnt(0)
    v_readfirstlane_b32 s78, v223
    s_nop 0
    s_cmp_ge_u32 s78, 4
    s_cbranch_scc0 LB_s6
    s_branch LB_g6
LB_w4:
    s_branch LB_s4_in
LB_s4:
    s_sleep 1
LB_s4_in:
    ds_read_b32 v222, v10 offset:16
    s_waitcnt lgkmcnt(0)
    v_readfirstlane_b32 s78, v222
    s_nop 0
    s_cmp_ge_u32 s78, 4
    s_cbranch_scc0 LB_s4
    s_branch LB_g4
LB_w8:
    s_branch LB_s8_in
LB_s8:
    s_sleep 1
LB_s8_in:
    ds_read_b32 v223, v10 offset:32
    s_waitcnt lgkmcnt(0)
    v_readfirstlane_b32 s78, v223
    s_nop 0
    s_cmp_ge_u32 s78, 4
    s_cbranch_scc0 LB_s8
    s_branch LB_g8
LB_w7:
    s_branch LB_s7_in
LB_s7:
    s_sleep 1
LB_s7_in:
    ds_read_b32 v223, v10 offset:40
    s_waitcnt lgkmcnt(0)
    v_readfirstlane_b32 s78, v223
    s_nop 0
    s_cmp_ge_u32 s78, 4
    s_cbranch_scc0 LB_s7
    s_branch LB_g7
L_end:
    s_endpgm
.section .rodata,"a"
.p2align 6
.amdhsa_kernel concat_heads__ssm_conv_h3__sliding_local_dilated__prompt_kernel
  .amdhsa_next_free_vgpr 256
  .amdhsa_next_free_sgpr 102
  .amdhsa_accum_offset 256
  .amdhsa_group_segment_fixed_size 0
  .amdhsa_kernarg_size 96
  .amdhsa_user_sgpr_count 2
  .amdhsa_user_sgpr_kernarg_segment_ptr 1
  .amdhsa_system_sgpr_workgroup_id_x 1
.end_amdhsa_kernel
```

```asm
; @launch grid=(256,1,1) block=(512,1,1) lds=163840
.amdgcn_target "amdgcn-amd-amdhsa--gfx950"
.text
.globl concat_heads__ssm_conv_h3__sliding_local_dilated__prompt_kernel
.p2align 8
.type concat_heads__ssm_conv_h3__sliding_local_dilated__prompt_kernel,@function
concat_heads__ssm_conv_h3__sliding_local_dilated__prompt_kernel:
    s_cmp_ge_u32 s2, 256
    s_cbranch_scc1 L_end
    s_load_dwordx2 s[28:29], s[0:1], 48
    s_load_dwordx2 s[32:33], s[0:1], 56
    s_load_dwordx8 s[4:11], s[0:1], 0
    s_load_dwordx4 s[12:15], s[0:1], 32
    s_load_dwordx8 s[20:27], s[0:1], 64
    v_lshrrev_b32 v1, 6, v0
    v_and_b32 v0, 63, v0
    v_readfirstlane_b32 s3, v1
    s_nop 0
    s_cmp_lg_u32 s3, 4
    s_cbranch_scc1 L_nopf
    s_getpc_b64 s[80:81]
L_pc:
    s_bfe_u32 s78, s2, 0x40003
    v_lshl_add_u32 v1, v0, 4, s78
    v_lshlrev_b32 v1, 7, v1
    v_cmp_gt_u32 vcc, L_end-L_pc, v1
    s_nop 0
    s_and_saveexec_b64 s[82:83], vcc
    global_load_dword v222, v1, s[80:81]
    s_mov_b64 exec, -1
L_nopf:
    s_and_b32 s78, s2, 7
    s_lshr_b32 s79, s2, 3
    s_and_b32 s80, s78, 1
    s_lshl_b32 s80, s80, 3
    s_lshr_b32 s81, s78, 1
    s_lshl_b32 s81, s81, 2
    s_and_b32 s72, s79, 7
    s_add_u32 s72, s72, s80
    s_lshr_b32 s73, s79, 3
    s_xor_b32 s73, s73, 3
    s_add_u32 s73, s73, s81
    s_cmp_ge_u32 s3, 4
    s_cbranch_scc1 L_B
    v_lshrrev_b32 v5, 3, v0
    v_and_b32 v6, 7, v0
    v_lshrrev_b32 v7, 4, v0
    s_lshl_b32 s79, s72, 7
    s_lshl_b32 s80, s3, 5
    s_add_u32 s81, s79, s80
    v_xor_b32 v8, v7, v6
    v_lshlrev_b32 v8, 4, v8
    v_add_u32 v240, s81, v5
    v_lshl_add_u32 v240, v240, 11, v8
    v_xor_b32 v241, 64, v240
    v_add_u32 v241, 15360, v241
    v_add_u32 v242, 30720, v240
    v_add_u32 v243, 30720, v241
    s_lshl_b32 s87, s3, 12
    s_add_u32 s87, s87, 75776
    s_and_b32 s98, s73, 12
    s_and_b32 s78, s72, 8
    s_add_u32 s98, s98, s78
    s_add_u32 s101, s72, s73
    s_and_b32 s101, s101, 3
    s_lshl_b32 s78, s101, 2
    s_lshr_b32 s97, 0x101, s78
    s_add_u32 s97, s97, s98
    s_and_b32 s97, s97, 15
    s_mov_b32 m0, s87
    s_lshl_b32 s97, s97, 7
    s_mov_b32 s30, 0x400000
    s_mov_b32 s31, 0x20000
    s_waitcnt lgkmcnt(0)
    buffer_load_dwordx4 v240, s[28:31], s97 offen offset:0  lds
    s_and_b32 s78, s3, 1
    s_lshl_b32 s78, s78, 2
    s_lshl_b32 s80, s3, 3
    v_and_b32 v8, 1, v7
    v_lshl_or_b32 v8, v8, 1, s78
    v_xor_b32 v8, v8, v6
    buffer_load_dwordx4 v241, s[28:31], s97 offen offset:1024  lds
    v_lshlrev_b32 v8, 4, v8
    v_add_u32 v244, s80, v5
    v_mul_u32_u24 v244, 6144, v244
    s_lshl_b32 s82, s73, 7
    v_add3_u32 v244, v244, v8, s82
    buffer_load_dwordx4 v242, s[28:31], s97 offen offset:2048  lds
    v_add_u32 v245, 1024, v244
    v_add_u32 v246, 2048, v244
    s_bfe_u32 s62, s72, 0x10002
    s_mul_i32 s78, s62, 12288
    s_mul_i32 s80, s3, 3072
    s_add_u32 s60, s80, s78
    buffer_load_dwordx4 v243, s[28:31], s97 offen offset:3072  lds
    s_sub_u32 s61, s80, s78
    s_mul_i32 s62, s62, 196608
    s_sub_u32 s63, 196608, s62
    s_mov_b32 s34, 0x600000
    s_mov_b32 s35, 0x20000
    s_mul_i32 s16, s97, 3072
    s_add_u32 m0, s60, 0
    s_add_u32 s99, s16, s62
    buffer_load_dwordx4 v244, s[32:35], s99 offen offset:0  lds
    s_lshl_b32 s78, s3, 1
    s_lshl_b32 s80, s3, 2
    s_add_u32 s79, s79, s80
    s_sub_u32 s79, s79, 16
    v_add_u32 v8, s78, v7
    buffer_load_dwordx4 v245, s[32:35], s99 offen offset:1024  lds
    v_xor_b32 v8, v8, v6
    v_and_b32 v8, 7, v8
    v_lshlrev_b32 v8, 4, v8
    v_add_u32 v3, s79, v5
    buffer_load_dwordx4 v246, s[32:35], s99 offen offset:2048  lds
    v_lshl_add_u32 v3, v3, 11, v8
    s_lshl_b32 s86, s3, 10
    s_lshl_b32 s88, s3, 9
    s_add_u32 s88, s88, 73728
    s_add_u32 m0, s88, 0
    s_mov_b64 exec, 0xffffffff
    buffer_load_dwordx4 v3, s[28:31], s97 offen offset:0  lds
    s_mov_b64 exec, -1
    s_add_u32 m0, s61, 12288
    s_add_u32 s16, s16, s63
    buffer_load_dwordx4 v244, s[32:35], s16 offen offset:0  lds
    buffer_load_dwordx4 v245, s[32:35], s16 offen offset:1024  lds
    buffer_load_dwordx4 v246, s[32:35], s16 offen offset:2048  lds
    s_mov_b32 s0, 0x76583240
    s_mov_b32 s1, 0xfedba9c
    s_cmp_eq_u32 s101, 1
    s_cselect_b32 s0, 0x76943251, s0
    s_cselect_b32 s1, 0xfecbad8, s1
    s_cmp_eq_u32 s101, 2
    s_cselect_b32 s0, 0x7a543620, s0
    s_cselect_b32 s1, 0xfdcbe98, s1
    s_cmp_eq_u32 s101, 3
    s_cselect_b32 s0, 0xb6547231, s0
    s_cselect_b32 s1, 0xedcfa98, s1
    s_and_b32 s78, s73, 7
    s_cmp_lg_u32 s78, 3
    s_cbranch_scc1 LA_nb
    s_cmp_eq_u32 s101, 2
    s_cselect_b32 s0, 0x87654320, s0
    s_cselect_b32 s1, 0xfdcbea9, s1
    s_cmp_eq_u32 s101, 3
    s_cselect_b32 s0, 0x87654231, s0
    s_cselect_b32 s1, 0xedcfba9, s1
LA_nb:
    s_add_u32 s79, s72, s73
    s_add_u32 s78, s72, 5
    s_and_b32 s78, s78, 7
    s_lshl_b32 s78, s78, 1
    s_and_b32 s75, s79, 1
    s_add_u32 s78, s78, s75
    s_andn2_b32 s79, 2, s79
    s_lshl_b32 s79, s79, 3
    s_add_u32 s78, s78, s79
    s_and_b32 s76, s78, 3
    s_and_b32 s79, s73, 12
    s_add_u32 s76, s76, s79
    s_lshr_b32 s74, s78, 4
    s_add_u32 s74, s74, s79
    s_and_b32 s79, s72, 8
    s_lshr_b32 s77, s78, 2
    s_add_u32 s77, s77, s79
    s_lshr_b32 s79, s79, 2
    s_add_u32 s74, s74, s79
    s_xor_b32 s74, s74, 4
    s_and_b32 s75, s78, 15
    s_add_u32 s97, s98, s0
    s_lshr_b64 s[0:1], s[0:1], 4
    s_and_b32 s97, s97, 15
    s_add_u32 m0, s87, 18432
    s_lshl_b32 s97, s97, 7
    buffer_load_dwordx4 v240, s[28:31], s97 offen offset:0  lds
    s_mov_b32 s36, s6
    s_mov_b32 s37, s7
    s_mov_b32 s38, 0x400000
    s_mov_b32 s39, 0x20000
    s_mov_b32 s40, s8
    s_mov_b32 s41, s9
    s_mov_b32 s42, 0x400000
    s_mov_b32 s43, 0x20000
    s_mov_b32 s44, s10
    s_mov_b32 s45, s11
    s_mov_b32 s46, 0x2000
    s_mov_b32 s47, 0x20000
    v_lshlrev_b32 v15, 4, v0
    v_and_b32 v7, 7, v0
    s_lshl_b32 s79, s74, 7
    v_lshl_add_u32 v7, v7, 4, s79
    s_lshl_b32 s78, s75, 7
    s_lshl_b32 s80, s3, 3
    s_add_u32 s80, s80, s78
    v_lshrrev_b32 v5, 3, v0
    s_and_b32 s79, s3, 1
    v_xor_b32 v5, s79, v5
    v_add_u32 v5, s80, v5
    v_lshl_add_u32 v10, v5, 11, v7
    s_xor_b32 s80, s3, 1
    s_add_u32 s80, s78, s80
    s_sub_u32 s80, s80, 4
    s_lshl_b32 s80, s80, 11
    v_add_u32 v11, s80, v7
    s_mov_b32 s52, s26
    s_mov_b32 s53, s27
    s_mov_b32 s54, 0x1800000
    s_mov_b32 s55, 0x20000
    v_and_b32 v7, 7, v0
    s_lshl_b32 s79, s74, 7
    v_lshl_add_u32 v7, v7, 4, s79
    s_lshl_b32 s78, s75, 7
    v_bfe_u32 v5, v0, 3, 2
    v_lshrrev_b32 v6, 5, v0
    s_lshl_b32 s80, s3, 5
    v_lshlrev_b32 v8, 3, v5
    v_lshl_add_u32 v8, v6, 2, v8
    v_add_u32 v8, s80, v8
    v_and_b32 v35, 7, v0
    v_lshl_add_u32 v16, v35, 1, v6
    v_lshlrev_b32 v232, 5, v16
    v_lshlrev_b32 v16, 3, v16
    v_lshl_add_u32 v16, v5, 10, v16
    v_and_b32 v231, 1, v5
    v_lshl_add_u32 v16, v231, 7, v16
    s_lshl_b32 s79, s3, 12
    s_add_u32 s79, s79, 129024
    v_add_u32 v16, s79, v16
    v_xor_b32 v231, 128, v16
    v_lshrrev_b32 v35, 2, v35
    v_lshl_add_u32 v35, v35, 4, v232
    v_add_u32 v35, 162816, v35
    v_add_u32 v8, s78, v8
    v_lshl_add_u32 v9, v8, 11, v7
    v_lshl_add_u32 v13, v8, 12, v7
    v_bfe_u32 v8, v0, 2, 1
    v_lshlrev_b32 v8, 1, v8
    v_add_u32 v8, v8, v6
    v_lshlrev_b32 v8, 16, v8
    v_lshl_add_u32 v8, v5, 6, v8
    v_and_b32 v7, 3, v0
    v_lshl_add_u32 v8, v7, 4, v8
    s_add_u32 s78, s78, s80
    s_lshl_b32 s78, s78, 3
    s_lshl_b32 s79, s74, 18
    s_add_u32 s78, s78, s79
    v_add_u32 v12, s78, v8
    s_mov_b32 s48, s12
    s_mov_b32 s49, s13
    s_mov_b32 s50, 0x400000
    s_mov_b32 s51, 0x20000
    s_mov_b32 s56, s4
    s_mov_b32 s57, s5
    s_mov_b32 s58, 0x400000
    s_mov_b32 s59, 0x20000
    s_mov_b32 s64, s20
    s_mov_b32 s65, s21
    s_mov_b32 s66, 0x200000
    s_mov_b32 s67, 0x20000
    s_lshl_b32 s91, s74, 4
    s_add_u32 s91, s91, s75
    s_lshr_b32 s78, s91, 3
    s_lshl_b32 s78, s78, 5
    s_and_b32 s79, s91, 7
    s_add_u32 s78, s78, s79
    s_lshl_b32 s79, s3, 3
    s_add_u32 s90, s78, s79
    s_lshl_b32 s91, s91, 14
    s_mov_b32 s96, 4096
    s_mul_i32 s94, s3, 8320
    s_add_u32 s94, s94, 129024
    v_mov_b32 v229, 0
    s_mov_b64 s[4:5], s[64:65]
    s_mov_b32 s6, 0x0
    s_mov_b32 s7, 0x20000
    v_mov_b32 v228, 0x40000000
    s_bitcmp1_b32 s73, 2
    s_cbranch_scc1 LA_nh0
    s_mov_b64 s[4:5], s[28:29]
    s_mov_b32 s6, 0x400000
    v_mov_b32 v229, 0x40000000
    s_and_b32 s78, s73, 3
    s_cmp_eq_u32 s78, 3
    s_cbranch_scc1 LA_nh0
    s_and_b32 s79, s101, 2
    s_add_u32 s78, s72, 1
    s_add_u32 s78, s78, s79
    s_and_b32 s78, s78, 3
    s_bfe_u32 s80, s72, 0x10002
    s_and_b32 s81, s101, 1
    s_lshl_b32 s81, s81, 2
    s_add_u32 s81, s81, s79
    s_lshl_b32 s82, s78, 1
    s_cmp_lt_u32 s78, 2
    s_cselect_b32 s79, 12, 24
    s_cselect_b32 s82, s82, 0
    s_cselect_b32 s83, 6, 7
    s_add_u32 s81, s81, s83
    s_add_u32 s80, s80, s82
    s_lshl_b32 s80, s80, 2
    s_add_u32 s80, s80, s3
    s_mul_i32 s80, s80, s79
    s_add_u32 s82, s81, s78
    s_add_u32 s81, s81, s98
    s_and_b32 s81, s81, 15
    s_mul_i32 s81, s81, 192
    s_add_u32 s80, s80, s81
    s_or_b32 s81, s73, 3
    s_lshl_b32 s81, s81, 7
    v_add_u32 v5, s80, v0
    v_lshl_add_u32 v5, v5, 11, s81
    v_cmp_gt_u32 vcc, s79, v0
    s_nop 1
    v_cndmask_b32 v228, v228, v5, vcc
    s_cmp_ge_u32 s78, 2
    s_cbranch_scc1 LA_nh0
    s_add_u32 s82, s82, s98
    s_and_b32 s82, s82, 15
    s_lshl_b32 s78, s82, 7
    s_lshl_b32 s79, s72, 7
    s_mul_i32 s80, s3, 36
    s_add_u32 s79, s79, s80
    s_sub_u32 s79, s79, 16
    v_add_u32 v5, s79, v0
    v_lshl_add_u32 v5, v5, 11, s78
    v_cmp_gt_u32 vcc, 36, v0
    s_nop 1
    v_cndmask_b32 v229, v229, v5, vcc
LA_nh0:
    buffer_load_dwordx4 v241, s[28:31], s97 offen offset:1024  lds
    buffer_load_dwordx4 v242, s[28:31], s97 offen offset:2048  lds
    buffer_load_dwordx4 v243, s[28:31], s97 offen offset:3072  lds
    s_add_u32 m0, s88, 18432
    s_mov_b64 exec, 0xffffffff
    buffer_load_dwordx4 v3, s[28:31], s97 offen offset:0  lds
    s_mov_b64 exec, -1
    s_mul_i32 s16, s97, 3072
    s_add_u32 m0, s60, 24576
    s_add_u32 s99, s16, s62
    buffer_load_dwordx4 v244, s[32:35], s99 offen offset:0  lds
    buffer_load_dwordx4 v245, s[32:35], s99 offen offset:1024  lds
    buffer_load_dwordx4 v246, s[32:35], s99 offen offset:2048  lds
    s_add_u32 m0, s61, 36864
    s_add_u32 s16, s16, s63
    buffer_load_dwordx4 v244, s[32:35], s16 offen offset:0  lds
    buffer_load_dwordx4 v245, s[32:35], s16 offen offset:1024  lds
    buffer_load_dwordx4 v246, s[32:35], s16 offen offset:2048  lds
    s_waitcnt vmcnt(11)
    s_barrier
    s_add_u32 s97, s98, s0
    s_lshr_b64 s[0:1], s[0:1], 4
    s_and_b32 s97, s97, 15
    s_add_u32 m0, s87, 36864
    s_lshl_b32 s97, s97, 7
    buffer_load_dwordx4 v240, s[28:31], s97 offen offset:0  lds
    buffer_load_dwordx4 v241, s[28:31], s97 offen offset:1024  lds
    s_cmp_eq_u32 s101, 1
    s_cbranch_scc1 LA_c1
    s_cmp_eq_u32 s101, 2
    s_cbranch_scc1 LA_c2
    s_cmp_eq_u32 s101, 3
    s_cbranch_scc1 LA_c3
LA_c0:
    s_waitcnt vmcnt(8)
    s_barrier
    buffer_load_dwordx4 v242, s[28:31], s97 offen offset:2048  lds
    buffer_load_dwordx4 v243, s[28:31], s97 offen offset:3072  lds
    s_add_u32 m0, s88, 36864
    s_mov_b64 exec, 0xffffffff
    buffer_load_dwordx4 v3, s[28:31], s97 offen offset:0  lds
    s_mov_b64 exec, -1
    s_mul_i32 s16, s97, 3072
    s_add_u32 m0, s60, 49152
    s_add_u32 s99, s16, s62
    buffer_load_dwordx4 v244, s[32:35], s99 offen offset:0  lds
    buffer_load_dwordx4 v245, s[32:35], s99 offen offset:1024  lds
    buffer_load_dwordx4 v246, s[32:35], s99 offen offset:2048  lds
    s_add_u32 m0, s61, 61440
    s_add_u32 s16, s16, s63
    buffer_load_dwordx4 v244, s[32:35], s16 offen offset:0  lds
    buffer_load_dwordx4 v245, s[32:35], s16 offen offset:1024  lds
    buffer_load_dwordx4 v246, s[32:35], s16 offen offset:2048  lds
    s_add_u32 s97, s98, s0
    s_lshr_b64 s[0:1], s[0:1], 4
    s_and_b32 s97, s97, 15
    s_add_u32 m0, s87, 0
    s_lshl_b32 s97, s97, 7
    buffer_load_dwordx4 v240, s[28:31], s97 offen offset:0  lds
    buffer_load_dwordx4 v241, s[28:31], s97 offen offset:1024  lds
    buffer_load_dwordx4 v242, s[28:31], s97 offen offset:2048  lds
    buffer_load_dwordx4 v243, s[28:31], s97 offen offset:3072  lds
    s_add_u32 m0, s88, 0
    s_mov_b64 exec, 0xffffffff
    buffer_load_dwordx4 v3, s[28:31], s97 offen offset:0  lds
    s_mov_b64 exec, -1
    s_waitcnt vmcnt(11)
    s_barrier
    s_mul_i32 s16, s97, 3072
    s_add_u32 m0, s60, 0
    s_add_u32 s99, s16, s62
    buffer_load_dwordx4 v244, s[32:35], s99 offen offset:0  lds
    buffer_load_dwordx4 v245, s[32:35], s99 offen offset:1024  lds
    buffer_load_dwordx4 v246, s[32:35], s99 offen offset:2048  lds
    s_add_u32 m0, s61, 12288
    s_add_u32 s16, s16, s63
    buffer_load_dwordx4 v244, s[32:35], s16 offen offset:0  lds
    buffer_load_dwordx4 v245, s[32:35], s16 offen offset:1024  lds
    buffer_load_dwordx4 v246, s[32:35], s16 offen offset:2048  lds
    buffer_load_dword v230, v229, s[4:7], 0 offen
    buffer_load_dword v230, v228, s[32:35], 0 offen
    s_add_u32 m0, s86, 129536
    s_mov_b32 s89, 0
    buffer_load_dwordx4 v10, s[36:39], s89 offen nt lds
    s_add_u32 m0, s86, 145920
    s_mov_b32 s89, 0
    buffer_load_dwordx4 v10, s[40:43], s89 offen nt lds
    s_add_u32 m0, s86, 133632
    s_mov_b32 s89, 65536
    buffer_load_dwordx4 v10, s[36:39], s89 offen nt lds
    s_add_u32 m0, s86, 150016
    s_mov_b32 s89, 65536
    buffer_load_dwordx4 v10, s[40:43], s89 offen nt lds
    s_add_u32 m0, s86, 137728
    s_mov_b32 s89, 131072
    buffer_load_dwordx4 v10, s[36:39], s89 offen nt lds
    s_add_u32 m0, s86, 154112
    s_mov_b32 s89, 131072
    buffer_load_dwordx4 v10, s[40:43], s89 offen nt lds
    s_add_u32 m0, s86, 141824
    s_mov_b32 s89, 196608
    buffer_load_dwordx4 v10, s[36:39], s89 offen nt lds
    s_add_u32 m0, s86, 158208
    s_mov_b32 s89, 196608
    buffer_load_dwordx4 v10, s[40:43], s89 offen nt lds
    s_waitcnt vmcnt(16)
    s_barrier
    s_mov_b64 exec, 0xff
    s_lshl_b32 s82, s3, 7
    s_add_u32 m0, s82, 129024
    s_mov_b32 s89, 0
    buffer_load_dwordx4 v11, s[36:39], s89 offen nt lds
    s_lshl_b32 s83, s74, 9
    s_add_u32 s83, s83, s82
    s_and_b32 s89, s3, 2
    s_lshl_b32 s89, s89, 3
    s_add_u32 s82, s82, s89
    s_add_u32 m0, s82, 162816
    s_add_u32 s89, s83, 0
    buffer_load_dwordx4 v15, s[44:47], s89 offen  lds
    s_mov_b64 exec, -1
    s_add_u32 s97, s98, s0
    s_lshr_b64 s[0:1], s[0:1], 4
    s_and_b32 s97, s97, 15
    s_add_u32 m0, s87, 18432
    s_lshl_b32 s97, s97, 7
    buffer_load_dwordx4 v240, s[28:31], s97 offen offset:0  lds
    buffer_load_dwordx4 v241, s[28:31], s97 offen offset:1024  lds
    buffer_load_dwordx4 v242, s[28:31], s97 offen offset:2048  lds
    buffer_load_dwordx4 v243, s[28:31], s97 offen offset:3072  lds
    s_add_u32 m0, s88, 18432
    s_mov_b64 exec, 0xffffffff
    buffer_load_dwordx4 v3, s[28:31], s97 offen offset:0  lds
    s_mov_b64 exec, -1
    s_mul_i32 s16, s97, 3072
    s_add_u32 m0, s60, 24576
    s_add_u32 s99, s16, s62
    buffer_load_dwordx4 v244, s[32:35], s99 offen offset:0  lds
    buffer_load_dwordx4 v245, s[32:35], s99 offen offset:1024  lds
    buffer_load_dwordx4 v246, s[32:35], s99 offen offset:2048  lds
    s_add_u32 m0, s61, 36864
    s_add_u32 s16, s16, s63
    buffer_load_dwordx4 v244, s[32:35], s16 offen offset:0  lds
    buffer_load_dwordx4 v245, s[32:35], s16 offen offset:1024  lds
    buffer_load_dwordx4 v246, s[32:35], s16 offen offset:2048  lds
    s_add_u32 s97, s98, s0
    s_lshr_b64 s[0:1], s[0:1], 4
    s_and_b32 s97, s97, 15
    s_add_u32 m0, s87, 36864
    s_lshl_b32 s97, s97, 7
    buffer_load_dwordx4 v240, s[28:31], s97 offen offset:0  lds
    buffer_load_dwordx4 v241, s[28:31], s97 offen offset:1024  lds
    buffer_load_dwordx4 v242, s[28:31], s97 offen offset:2048  lds
    buffer_load_dwordx4 v243, s[28:31], s97 offen offset:3072  lds
    s_waitcnt vmcnt(10)
    s_barrier
    s_add_u32 m0, s88, 36864
    s_mov_b64 exec, 0xffffffff
    buffer_load_dwordx4 v3, s[28:31], s97 offen offset:0  lds
    s_mov_b64 exec, -1
    ds_read_b128 v[84:87], v35 offset:0
    ds_read_b128 v[88:91], v35 offset:16
    s_mul_i32 s16, s97, 3072
    s_add_u32 m0, s60, 49152
    s_add_u32 s99, s16, s62
    buffer_load_dwordx4 v244, s[32:35], s99 offen offset:0  lds
    ds_read_b64 v[40:41], v16 offset:0
    ds_read_b64 v[42:43], v231 offset:256
    buffer_load_dwordx4 v245, s[32:35], s99 offen offset:1024  lds
    ds_read_b64 v[44:45], v16 offset:256
    ds_read_b64 v[46:47], v16 offset:512
    buffer_load_dwordx4 v246, s[32:35], s99 offen offset:2048  lds
    ds_read_b64 v[48:49], v231 offset:512
    s_add_u32 m0, s61, 61440
    s_add_u32 s16, s16, s63
    buffer_load_dwordx4 v244, s[32:35], s16 offen offset:0  lds
    ds_read_b64 v[50:51], v16 offset:768
    ds_read_b64 v[52:53], v231 offset:768
    buffer_load_dwordx4 v245, s[32:35], s16 offen offset:1024  lds
    ds_read_b64 v[54:55], v16 offset:1024
    ds_read_b64 v[56:57], v231 offset:1024
    buffer_load_dwordx4 v246, s[32:35], s16 offen offset:2048  lds
    ds_read_b64 v[58:59], v16 offset:1280
    ds_read_b64 v[60:61], v231 offset:1280
    s_add_u32 s97, s98, s0
    s_lshr_b64 s[0:1], s[0:1], 4
    s_and_b32 s97, s97, 15
    s_add_u32 m0, s87, 0
    s_lshl_b32 s97, s97, 7
    buffer_load_dwordx4 v240, s[28:31], s97 offen offset:0  lds
    ds_read_b64 v[68:69], v16 offset:16896
    buffer_load_dwordx4 v241, s[28:31], s97 offen offset:1024  lds
    ds_read_b64 v[70:71], v231 offset:16896
    ds_read_b64 v[72:73], v16 offset:17152
    buffer_load_dwordx4 v242, s[28:31], s97 offen offset:2048  lds
    ds_read_b64 v[74:75], v231 offset:17152
    ds_read_b64 v[76:77], v16 offset:17408
    buffer_load_dwordx4 v243, s[28:31], s97 offen offset:3072  lds
    ds_read_b64 v[78:79], v231 offset:17408
    ds_read_b64 v[80:81], v16 offset:17664
    s_add_u32 m0, s88, 0
    s_mov_b64 exec, 0xffffffff
    buffer_load_dwordx4 v3, s[28:31], s97 offen offset:0  lds
    s_mov_b64 exec, -1
    ds_read_b64 v[82:83], v231 offset:17664
    s_waitcnt vmcnt(11)
    s_waitcnt lgkmcnt(0)
    s_barrier
    s_mul_i32 s16, s97, 3072
    s_add_u32 m0, s60, 0
    s_add_u32 s99, s16, s62
    buffer_load_dwordx4 v244, s[32:35], s99 offen offset:0  lds
    v_lshlrev_b32 v160, 16, v40
    v_lshlrev_b32 v161, 16, v42
    v_lshlrev_b32 v162, 16, v44
    v_lshlrev_b32 v163, 16, v46
    v_lshlrev_b32 v164, 16, v48
    buffer_load_dwordx4 v245, s[32:35], s99 offen offset:1024  lds
    v_lshlrev_b32 v165, 16, v50
    v_lshlrev_b32 v166, 16, v52
    v_lshlrev_b32 v167, 16, v54
    v_lshlrev_b32 v168, 16, v56
    v_lshlrev_b32 v169, 16, v58
    buffer_load_dwordx4 v246, s[32:35], s99 offen offset:2048  lds
    v_lshlrev_b32 v170, 16, v60
    v_lshlrev_b32 v172, 16, v84
    v_and_b32 v173, 0xffff0000, v84
    v_lshlrev_b32 v174, 16, v85
    v_and_b32 v175, 0xffff0000, v85
    s_add_u32 m0, s61, 12288
    s_add_u32 s16, s16, s63
    buffer_load_dwordx4 v244, s[32:35], s16 offen offset:0  lds
    v_lshlrev_b32 v176, 16, v68
    v_lshlrev_b32 v177, 16, v70
    v_lshlrev_b32 v178, 16, v72
    v_lshlrev_b32 v179, 16, v74
    v_lshlrev_b32 v180, 16, v76
    buffer_load_dwordx4 v245, s[32:35], s16 offen offset:1024  lds
    v_lshlrev_b32 v181, 16, v78
    v_lshlrev_b32 v182, 16, v80
    v_lshlrev_b32 v183, 16, v82
    v_mul_f32 v184, v160, v175
    v_mul_f32 v185, v161, v175
    buffer_load_dwordx4 v246, s[32:35], s16 offen offset:2048  lds
    v_mul_f32 v186, v162, v175
    v_mul_f32 v187, v163, v175
    v_mul_f32 v188, v164, v175
    v_mul_f32 v189, v165, v175
    v_mul_f32 v190, v166, v175
    s_add_u32 s97, s98, s0
    s_lshr_b64 s[0:1], s[0:1], 4
    s_and_b32 s97, s97, 15
    s_add_u32 m0, s87, 18432
    s_lshl_b32 s97, s97, 7
    buffer_load_dwordx4 v240, s[28:31], s97 offen offset:0  lds
    v_mul_f32 v191, v167, v175
    v_fmac_f32 v184, v161, v174
    v_fmac_f32 v185, v162, v174
    v_fmac_f32 v186, v163, v174
    v_fmac_f32 v187, v164, v174
    buffer_load_dwordx4 v241, s[28:31], s97 offen offset:1024  lds
    v_fmac_f32 v188, v165, v174
    v_fmac_f32 v189, v166, v174
    v_fmac_f32 v190, v167, v174
    v_fmac_f32 v191, v168, v174
    v_fmac_f32 v184, v162, v173
    buffer_load_dwordx4 v242, s[28:31], s97 offen offset:2048  lds
    v_fmac_f32 v185, v163, v173
    v_fmac_f32 v186, v164, v173
    v_fmac_f32 v187, v165, v173
    v_fmac_f32 v188, v166, v173
    v_fmac_f32 v189, v167, v173
    buffer_load_dwordx4 v243, s[28:31], s97 offen offset:3072  lds
    v_fmac_f32 v190, v168, v173
    v_fmac_f32 v191, v169, v173
    v_fmac_f32 v184, v163, v172
    v_fmac_f32 v185, v164, v172
    v_fmac_f32 v186, v165, v172
    s_add_u32 m0, s88, 18432
    s_mov_b64 exec, 0xffffffff
    buffer_load_dwordx4 v3, s[28:31], s97 offen offset:0  lds
    s_mov_b64 exec, -1
    v_fmac_f32 v187, v166, v172
    v_fmac_f32 v188, v167, v172
    v_fmac_f32 v189, v168, v172
    v_fmac_f32 v190, v169, v172
    v_fmac_f32 v191, v170, v172
    v_mul_f32 v184, v184, v176
    v_mul_f32 v185, v185, v177
    v_mul_f32 v186, v186, v178
    v_mul_f32 v187, v187, v179
    v_mul_f32 v188, v188, v180
    v_mul_f32 v189, v189, v181
    v_mul_f32 v190, v190, v182
    v_mul_f32 v191, v191, v183
    v_cvt_pk_bf16_f32 v100, v191, v190
    v_cvt_pk_bf16_f32 v101, v189, v188
    v_cvt_pk_bf16_f32 v102, v187, v186
    v_cvt_pk_bf16_f32 v103, v185, v184
    s_mov_b32 s89, 0
    buffer_store_dwordx4 v[100:103], v12, s[52:55], s89 offen sc1
    v_and_b32 v160, 0xffff0000, v40
    v_and_b32 v161, 0xffff0000, v42
    v_and_b32 v162, 0xffff0000, v44
    v_and_b32 v163, 0xffff0000, v46
    v_and_b32 v164, 0xffff0000, v48
    v_and_b32 v165, 0xffff0000, v50
    v_and_b32 v166, 0xffff0000, v52
    v_and_b32 v167, 0xffff0000, v54
    v_and_b32 v168, 0xffff0000, v56
    v_and_b32 v169, 0xffff0000, v58
    v_and_b32 v170, 0xffff0000, v60
    v_lshlrev_b32 v172, 16, v86
    v_and_b32 v173, 0xffff0000, v86
    v_lshlrev_b32 v174, 16, v87
    v_and_b32 v175, 0xffff0000, v87
    v_and_b32 v176, 0xffff0000, v68
    v_and_b32 v177, 0xffff0000, v70
    v_and_b32 v178, 0xffff0000, v72
    v_and_b32 v179, 0xffff0000, v74
    v_and_b32 v180, 0xffff0000, v76
    v_and_b32 v181, 0xffff0000, v78
    v_and_b32 v182, 0xffff0000, v80
    v_and_b32 v183, 0xffff0000, v82
    s_waitcnt vmcnt(12)
    s_barrier
    s_mul_i32 s16, s97, 3072
    s_add_u32 m0, s60, 24576
    s_add_u32 s99, s16, s62
    buffer_load_dwordx4 v244, s[32:35], s99 offen offset:0  lds
    v_mul_f32 v184, v160, v175
    v_mul_f32 v185, v161, v175
    v_mul_f32 v186, v162, v175
    v_mul_f32 v187, v163, v175
    v_mul_f32 v188, v164, v175
    buffer_load_dwordx4 v245, s[32:35], s99 offen offset:1024  lds
    v_mul_f32 v189, v165, v175
    v_mul_f32 v190, v166, v175
    v_mul_f32 v191, v167, v175
    v_fmac_f32 v184, v161, v174
    v_fmac_f32 v185, v162, v174
    buffer_load_dwordx4 v246, s[32:35], s99 offen offset:2048  lds
    v_fmac_f32 v186, v163, v174
    v_fmac_f32 v187, v164, v174
    v_fmac_f32 v188, v165, v174
    v_fmac_f32 v189, v166, v174
    v_fmac_f32 v190, v167, v174
    s_add_u32 m0, s61, 36864
    s_add_u32 s16, s16, s63
    buffer_load_dwordx4 v244, s[32:35], s16 offen offset:0  lds
    v_fmac_f32 v191, v168, v174
    v_fmac_f32 v184, v162, v173
    v_fmac_f32 v185, v163, v173
    v_fmac_f32 v186, v164, v173
    v_fmac_f32 v187, v165, v173
    buffer_load_dwordx4 v245, s[32:35], s16 offen offset:1024  lds
    v_fmac_f32 v188, v166, v173
    v_fmac_f32 v189, v167, v173
    v_fmac_f32 v190, v168, v173
    v_fmac_f32 v191, v169, v173
    v_fmac_f32 v184, v163, v172
    buffer_load_dwordx4 v246, s[32:35], s16 offen offset:2048  lds
    v_fmac_f32 v185, v164, v172
    v_fmac_f32 v186, v165, v172
    v_fmac_f32 v187, v166, v172
    v_fmac_f32 v188, v167, v172
    v_fmac_f32 v189, v168, v172
    s_add_u32 s97, s98, s0
    s_lshr_b64 s[0:1], s[0:1], 4
    s_and_b32 s97, s97, 15
    s_add_u32 m0, s87, 36864
    s_lshl_b32 s97, s97, 7
    buffer_load_dwordx4 v240, s[28:31], s97 offen offset:0  lds
    v_fmac_f32 v190, v169, v172
    v_fmac_f32 v191, v170, v172
    v_mul_f32 v184, v184, v176
    v_mul_f32 v185, v185, v177
    v_mul_f32 v186, v186, v178
    buffer_load_dwordx4 v241, s[28:31], s97 offen offset:1024  lds
    v_mul_f32 v187, v187, v179
    v_mul_f32 v188, v188, v180
    v_mul_f32 v189, v189, v181
    v_mul_f32 v190, v190, v182
    v_mul_f32 v191, v191, v183
    buffer_load_dwordx4 v242, s[28:31], s97 offen offset:2048  lds
    v_cvt_pk_bf16_f32 v104, v191, v190
    v_cvt_pk_bf16_f32 v105, v189, v188
    v_cvt_pk_bf16_f32 v106, v187, v186
    v_cvt_pk_bf16_f32 v107, v185, v184
    s_mov_b32 s89, 16384
    buffer_store_dwordx4 v[104:107], v12, s[52:55], s89 offen sc1
    buffer_load_dwordx4 v243, s[28:31], s97 offen offset:3072  lds
    v_lshlrev_b32 v160, 16, v41
    v_lshlrev_b32 v161, 16, v43
    v_lshlrev_b32 v162, 16, v45
    v_lshlrev_b32 v163, 16, v47
    v_lshlrev_b32 v164, 16, v49
    s_add_u32 m0, s88, 36864
    s_mov_b64 exec, 0xffffffff
    buffer_load_dwordx4 v3, s[28:31], s97 offen offset:0  lds
    s_mov_b64 exec, -1
    v_lshlrev_b32 v165, 16, v51
    v_lshlrev_b32 v166, 16, v53
    v_lshlrev_b32 v167, 16, v55
    v_lshlrev_b32 v168, 16, v57
    v_lshlrev_b32 v169, 16, v59
    v_lshlrev_b32 v170, 16, v61
    v_lshlrev_b32 v172, 16, v88
    v_and_b32 v173, 0xffff0000, v88
    v_lshlrev_b32 v174, 16, v89
    v_and_b32 v175, 0xffff0000, v89
    v_lshlrev_b32 v176, 16, v69
    v_lshlrev_b32 v177, 16, v71
    v_lshlrev_b32 v178, 16, v73
    v_lshlrev_b32 v179, 16, v75
    v_lshlrev_b32 v180, 16, v77
    v_lshlrev_b32 v181, 16, v79
    v_lshlrev_b32 v182, 16, v81
    v_lshlrev_b32 v183, 16, v83
    v_mul_f32 v184, v160, v175
    v_mul_f32 v185, v161, v175
    v_mul_f32 v186, v162, v175
    v_mul_f32 v187, v163, v175
    v_mul_f32 v188, v164, v175
    v_mul_f32 v189, v165, v175
    v_mul_f32 v190, v166, v175
    v_mul_f32 v191, v167, v175
    v_fmac_f32 v184, v161, v174
    v_fmac_f32 v185, v162, v174
    v_fmac_f32 v186, v163, v174
    v_fmac_f32 v187, v164, v174
    v_fmac_f32 v188, v165, v174
    v_fmac_f32 v189, v166, v174
    v_fmac_f32 v190, v167, v174
    v_fmac_f32 v191, v168, v174
    v_fmac_f32 v184, v162, v173
    v_fmac_f32 v185, v163, v173
    v_fmac_f32 v186, v164, v173
    v_fmac_f32 v187, v165, v173
    v_fmac_f32 v188, v166, v173
    v_fmac_f32 v189, v167, v173
    v_fmac_f32 v190, v168, v173
    s_waitcnt vmcnt(13)
    s_barrier
    s_mul_i32 s16, s97, 3072
    s_add_u32 m0, s60, 49152
    s_add_u32 s99, s16, s62
    buffer_load_dwordx4 v244, s[32:35], s99 offen offset:0  lds
    v_fmac_f32 v191, v169, v173
    v_fmac_f32 v184, v163, v172
    v_fmac_f32 v185, v164, v172
    v_fmac_f32 v186, v165, v172
    v_fmac_f32 v187, v166, v172
    buffer_load_dwordx4 v245, s[32:35], s99 offen offset:1024  lds
    v_fmac_f32 v188, v167, v172
    v_fmac_f32 v189, v168, v172
    v_fmac_f32 v190, v169, v172
    v_fmac_f32 v191, v170, v172
    v_mul_f32 v184, v184, v176
    buffer_load_dwordx4 v246, s[32:35], s99 offen offset:2048  lds
    v_mul_f32 v185, v185, v177
    v_mul_f32 v186, v186, v178
    v_mul_f32 v187, v187, v179
    v_mul_f32 v188, v188, v180
    v_mul_f32 v189, v189, v181
    s_add_u32 m0, s61, 61440
    s_add_u32 s16, s16, s63
    buffer_load_dwordx4 v244, s[32:35], s16 offen offset:0  lds
    v_mul_f32 v190, v190, v182
    v_mul_f32 v191, v191, v183
    v_cvt_pk_bf16_f32 v108, v191, v190
    v_cvt_pk_bf16_f32 v109, v189, v188
    v_cvt_pk_bf16_f32 v110, v187, v186
    buffer_load_dwordx4 v245, s[32:35], s16 offen offset:1024  lds
    v_cvt_pk_bf16_f32 v111, v185, v184
    s_mov_b32 s89, 32768
    buffer_store_dwordx4 v[108:111], v12, s[52:55], s89 offen sc1
    v_and_b32 v160, 0xffff0000, v41
    v_and_b32 v161, 0xffff0000, v43
    v_and_b32 v162, 0xffff0000, v45
    buffer_load_dwordx4 v246, s[32:35], s16 offen offset:2048  lds
    v_and_b32 v163, 0xffff0000, v47
    v_and_b32 v164, 0xffff0000, v49
    v_and_b32 v165, 0xffff0000, v51
    v_and_b32 v166, 0xffff0000, v53
    v_and_b32 v167, 0xffff0000, v55
    s_add_u32 s97, s98, s0
    s_lshr_b64 s[0:1], s[0:1], 4
    s_and_b32 s97, s97, 15
    s_add_u32 m0, s87, 0
    s_lshl_b32 s97, s97, 7
    buffer_load_dwordx4 v240, s[28:31], s97 offen offset:0  lds
    v_and_b32 v168, 0xffff0000, v57
    v_and_b32 v169, 0xffff0000, v59
    v_and_b32 v170, 0xffff0000, v61
    v_lshlrev_b32 v172, 16, v90
    v_and_b32 v173, 0xffff0000, v90
    buffer_load_dwordx4 v241, s[28:31], s97 offen offset:1024  lds
    v_lshlrev_b32 v174, 16, v91
    v_and_b32 v175, 0xffff0000, v91
    v_and_b32 v176, 0xffff0000, v69
    v_and_b32 v177, 0xffff0000, v71
    v_and_b32 v178, 0xffff0000, v73
    buffer_load_dwordx4 v242, s[28:31], s97 offen offset:2048  lds
    v_and_b32 v179, 0xffff0000, v75
    v_and_b32 v180, 0xffff0000, v77
    v_and_b32 v181, 0xffff0000, v79
    v_and_b32 v182, 0xffff0000, v81
    v_and_b32 v183, 0xffff0000, v83
    buffer_load_dwordx4 v243, s[28:31], s97 offen offset:3072  lds
    v_mul_f32 v184, v160, v175
    v_mul_f32 v185, v161, v175
    v_mul_f32 v186, v162, v175
    v_mul_f32 v187, v163, v175
    v_mul_f32 v188, v164, v175
    s_add_u32 m0, s88, 0
    s_mov_b64 exec, 0xffffffff
    buffer_load_dwordx4 v3, s[28:31], s97 offen offset:0  lds
    s_mov_b64 exec, -1
    v_mul_f32 v189, v165, v175
    v_mul_f32 v190, v166, v175
    v_mul_f32 v191, v167, v175
    v_fmac_f32 v184, v161, v174
    v_fmac_f32 v185, v162, v174
    v_fmac_f32 v186, v163, v174
    v_fmac_f32 v187, v164, v174
    v_fmac_f32 v188, v165, v174
    v_fmac_f32 v189, v166, v174
    v_fmac_f32 v190, v167, v174
    v_fmac_f32 v191, v168, v174
    v_fmac_f32 v184, v162, v173
    v_fmac_f32 v185, v163, v173
    v_fmac_f32 v186, v164, v173
    v_fmac_f32 v187, v165, v173
    v_fmac_f32 v188, v166, v173
    v_fmac_f32 v189, v167, v173
    v_fmac_f32 v190, v168, v173
    v_fmac_f32 v191, v169, v173
    v_fmac_f32 v184, v163, v172
    v_fmac_f32 v185, v164, v172
    v_fmac_f32 v186, v165, v172
    v_fmac_f32 v187, v166, v172
    v_fmac_f32 v188, v167, v172
    v_fmac_f32 v189, v168, v172
    v_fmac_f32 v190, v169, v172
    v_fmac_f32 v191, v170, v172
    v_mul_f32 v184, v184, v176
    v_mul_f32 v185, v185, v177
    v_mul_f32 v186, v186, v178
    v_mul_f32 v187, v187, v179
    v_mul_f32 v188, v188, v180
    v_mul_f32 v189, v189, v181
    v_mul_f32 v190, v190, v182
    v_mul_f32 v191, v191, v183
    v_cvt_pk_bf16_f32 v112, v191, v190
    v_cvt_pk_bf16_f32 v113, v189, v188
    v_cvt_pk_bf16_f32 v114, v187, v186
    v_cvt_pk_bf16_f32 v115, v185, v184
    s_mov_b32 s89, 49152
    buffer_store_dwordx4 v[112:115], v12, s[52:55], s89 offen sc1
    s_waitcnt vmcnt(13)
    s_barrier
    s_mul_i32 s16, s97, 3072
    s_add_u32 m0, s60, 0
    s_add_u32 s99, s16, s62
    buffer_load_dwordx4 v244, s[32:35], s99 offen offset:0  lds
    buffer_load_dwordx4 v245, s[32:35], s99 offen offset:1024  lds
    buffer_load_dwordx4 v246, s[32:35], s99 offen offset:2048  lds
    s_add_u32 m0, s61, 12288
    s_add_u32 s16, s16, s63
    buffer_load_dwordx4 v244, s[32:35], s16 offen offset:0  lds
    buffer_load_dwordx4 v245, s[32:35], s16 offen offset:1024  lds
    buffer_load_dwordx4 v246, s[32:35], s16 offen offset:2048  lds
    s_add_u32 m0, s94, 32
    s_lshl_b32 s89, s90, 12
    buffer_load_dwordx4 v15, s[48:51], s89 offen offset:0 nt lds
    s_add_u32 m0, s94, 32
    s_lshl_b32 s89, s90, 12
    buffer_load_dwordx4 v15, s[48:51], s89 offen offset:1024 nt lds
    s_add_u32 m0, s94, 32
    s_lshl_b32 s89, s90, 12
    buffer_load_dwordx4 v15, s[48:51], s89 offen offset:2048 nt lds
    s_add_u32 m0, s94, 32
    s_lshl_b32 s89, s90, 12
    buffer_load_dwordx4 v15, s[48:51], s89 offen offset:3072 nt lds
    s_add_u32 s97, s98, s0
    s_lshr_b64 s[0:1], s[0:1], 4
    s_and_b32 s97, s97, 15
    s_add_u32 m0, s87, 18432
    s_lshl_b32 s97, s97, 7
    buffer_load_dwordx4 v240, s[28:31], s97 offen offset:0  lds
    buffer_load_dwordx4 v241, s[28:31], s97 offen offset:1024  lds
    buffer_load_dwordx4 v242, s[28:31], s97 offen offset:2048  lds
    buffer_load_dwordx4 v243, s[28:31], s97 offen offset:3072  lds
    s_add_u32 m0, s88, 18432
    s_mov_b64 exec, 0xffffffff
    buffer_load_dwordx4 v3, s[28:31], s97 offen offset:0  lds
    s_mov_b64 exec, -1
    s_waitcnt vmcnt(16)
    s_barrier
    s_mul_i32 s16, s97, 3072
    s_add_u32 m0, s60, 24576
    s_add_u32 s99, s16, s62
    buffer_load_dwordx4 v244, s[32:35], s99 offen offset:0  lds
    s_mov_b32 s68, s24
    s_mov_b32 s69, s25
    s_mov_b32 s70, 0x100
    s_mov_b32 s71, 0x20000
    buffer_load_dwordx4 v245, s[32:35], s99 offen offset:1024  lds
    v_lshrrev_b32 v6, 5, v0
    v_and_b32 v7, 3, v0
    s_lshr_b32 s78, s90, 1
    s_lshl_b32 s78, s78, 2
    buffer_load_dwordx4 v246, s[32:35], s99 offen offset:2048  lds
    s_load_dword s92, s[14:15], s78
    v_bfe_u32 v5, v0, 2, 2
    v_lshlrev_b32 v5, 1, v5
    s_add_u32 m0, s61, 36864
    s_add_u32 s16, s16, s63
    buffer_load_dwordx4 v244, s[32:35], s16 offen offset:0  lds
    v_lshl_add_u32 v5, v6, 3, v5
    v_bfe_u32 v8, v0, 4, 1
    v_add_u32 v5, v5, v8
    s_and_b32 s78, s3, 1
    buffer_load_dwordx4 v245, s[32:35], s16 offen offset:1024  lds
    s_lshl_b32 s78, s78, 1
    v_add_u32 v8, s78, v6
    v_xor_b32 v8, v8, v7
    v_lshlrev_b32 v8, 4, v8
    buffer_load_dwordx4 v246, s[32:35], s16 offen offset:2048  lds
    v_lshl_add_u32 v5, v5, 6, v8
    v_add_u32 v14, s86, v5
    v_mov_b32 v18, 162304
    s_add_u32 s97, s98, s0
    s_lshr_b64 s[0:1], s[0:1], 4
    s_and_b32 s97, s97, 15
    s_add_u32 m0, s87, 36864
    s_lshl_b32 s97, s97, 7
    buffer_load_dwordx4 v240, s[28:31], s97 offen offset:0  lds
    v_mov_b32 v19, 1
    v_and_b32 v5, 3, v0
    s_lshl_b32 s78, s74, 4
    s_add_u32 s78, s78, s3
    buffer_load_dwordx4 v241, s[28:31], s97 offen offset:1024  lds
    v_lshl_add_u32 v6, v5, 2, s78
    s_lshr_b32 s78, s76, 3
    s_lshl_b32 s79, s3, 1
    s_add_u32 s78, s78, s79
    buffer_load_dwordx4 v242, s[28:31], s97 offen offset:2048  lds
    s_xor_b32 s78, s78, 2
    s_lshl_b32 s78, s78, 5
    s_add_u32 s79, s76, 5
    buffer_load_dwordx4 v243, s[28:31], s97 offen offset:3072  lds
    s_and_b32 s79, s79, 7
    s_lshl_b32 s79, s79, 1
    s_add_u32 s78, s78, s79
    v_mul_u32_u24 v7, 9, v5
    s_add_u32 m0, s88, 36864
    s_mov_b64 exec, 0xffffffff
    buffer_load_dwordx4 v3, s[28:31], s97 offen offset:0  lds
    s_mov_b64 exec, -1
    v_and_b32 v7, 17, v7
    v_add_u32 v7, s78, v7
    v_and_b32 v8, 4, v0
    s_waitcnt vmcnt(11)
    s_barrier
    s_mul_i32 s16, s97, 3072
    s_add_u32 m0, s60, 49152
    s_add_u32 s99, s16, s62
    buffer_load_dwordx4 v244, s[32:35], s99 offen offset:0  lds
    v_cmp_eq_u32 vcc, 0, v8
    s_nop 1
    v_cndmask_b32 v6, v7, v6, vcc
    v_and_b32 v33, 0xf0, v6
    v_lshlrev_b32 v34, 8, v6
    buffer_load_dwordx4 v245, s[32:35], s99 offen offset:1024  lds
    v_add_u32 v34, 12582912, v34
    v_and_b32 v5, 15, v0
    v_lshrrev_b32 v6, 4, v0
    v_add_u32 v7, 9, v5
    buffer_load_dwordx4 v246, s[32:35], s99 offen offset:2048  lds
    v_and_b32 v8, 1, v7
    v_mul_u32_u24 v8, 4160, v8
    v_lshrrev_b32 v7, 1, v7
    s_add_u32 m0, s61, 61440
    s_add_u32 s16, s16, s63
    buffer_load_dwordx4 v244, s[32:35], s16 offen offset:0  lds
    v_lshl_add_u32 v8, v7, 2, v8
    v_lshlrev_b32 v7, 4, v6
    v_sub_u32 v8, v8, v7
    s_add_u32 s78, s94, 32
    buffer_load_dwordx4 v245, s[32:35], s16 offen offset:1024  lds
    v_add_u32 v21, s78, v8
    v_add_u32 v22, 1024, v21
    v_add_u32 v23, 2048, v21
    v_add_u32 v24, 3072, v21
    buffer_load_dwordx4 v246, s[32:35], s16 offen offset:2048  lds
    v_lshl_add_u32 v7, v5, 1, v6
    v_add_u32 v7, 30, v7
    v_and_b32 v8, 1, v7
    s_add_u32 s97, s98, s0
    s_lshr_b64 s[0:1], s[0:1], 4
    s_and_b32 s97, s97, 15
    s_add_u32 m0, s87, 0
    s_lshl_b32 s97, s97, 7
    buffer_load_dwordx4 v240, s[28:31], s97 offen offset:0  lds
    v_bfe_u32 v136, v7, 1, 2
    v_lshl_add_u32 v136, v8, 2, v136
    v_lshlrev_b32 v136, 6, v136
    v_lshrrev_b32 v7, 3, v7
    buffer_load_dwordx4 v241, s[28:31], s97 offen offset:1024  lds
    v_lshl_add_u32 v136, v7, 9, v136
    v_bitop3_b32 v8, v7, 3, s3 bitop3:0x6a
    v_lshl_add_u32 v25, v8, 4, v136
    v_add_u32 v25, 92160, v25
    buffer_load_dwordx4 v242, s[28:31], s97 offen offset:2048  lds
    v_subrev_u32 v7, 1, v7
    v_bitop3_b32 v8, v7, 3, s3 bitop3:0x6a
    v_lshl_add_u32 v27, v8, 4, v136
    buffer_load_dwordx4 v243, s[28:31], s97 offen offset:3072  lds
    v_add_u32 v27, 91648, v27
    v_subrev_u32 v7, 1, v7
    v_bitop3_b32 v8, v7, 3, s3 bitop3:0x6a
    v_lshl_add_u32 v29, v8, 4, v136
    s_add_u32 m0, s88, 0
    s_mov_b64 exec, 0xffffffff
    buffer_load_dwordx4 v3, s[28:31], s97 offen offset:0  lds
    s_mov_b64 exec, -1
    v_add_u32 v29, 91136, v29
    v_subrev_u32 v7, 1, v7
    v_bitop3_b32 v8, v7, 3, s3 bitop3:0x6a
    s_waitcnt vmcnt(11)
    s_barrier
    s_mul_i32 s16, s97, 3072
    s_add_u32 m0, s60, 0
    s_add_u32 s99, s16, s62
    buffer_load_dwordx4 v244, s[32:35], s99 offen offset:0  lds
    v_lshl_add_u32 v31, v8, 4, v136
    v_add_u32 v31, 90624, v31
    v_lshl_add_u32 v7, v5, 1, v6
    v_add_u32 v7, 26, v7
    buffer_load_dwordx4 v245, s[32:35], s99 offen offset:1024  lds
    v_and_b32 v8, 1, v7
    v_bfe_u32 v136, v7, 1, 2
    v_lshl_add_u32 v136, v8, 2, v136
    v_lshlrev_b32 v136, 6, v136
    buffer_load_dwordx4 v246, s[32:35], s99 offen offset:2048  lds
    v_lshrrev_b32 v7, 3, v7
    v_lshl_add_u32 v136, v7, 9, v136
    v_bitop3_b32 v8, v7, 3, s3 bitop3:0x6a
    s_add_u32 m0, s61, 12288
    s_add_u32 s16, s16, s63
    buffer_load_dwordx4 v244, s[32:35], s16 offen offset:0  lds
    v_lshl_add_u32 v26, v8, 4, v136
    v_add_u32 v26, 92160, v26
    v_subrev_u32 v7, 1, v7
    v_bitop3_b32 v8, v7, 3, s3 bitop3:0x6a
    buffer_load_dwordx4 v245, s[32:35], s16 offen offset:1024  lds
    v_lshl_add_u32 v28, v8, 4, v136
    v_add_u32 v28, 91648, v28
    v_subrev_u32 v7, 1, v7
    v_bitop3_b32 v8, v7, 3, s3 bitop3:0x6a
    buffer_load_dwordx4 v246, s[32:35], s16 offen offset:2048  lds
    v_lshl_add_u32 v30, v8, 4, v136
    v_add_u32 v30, 91136, v30
    v_subrev_u32 v7, 1, v7
    s_add_u32 s97, s98, s0
    s_lshr_b64 s[0:1], s[0:1], 4
    s_and_b32 s97, s97, 15
    s_add_u32 m0, s87, 18432
    s_lshl_b32 s97, s97, 7
    buffer_load_dwordx4 v240, s[28:31], s97 offen offset:0  lds
    v_bitop3_b32 v8, v7, 3, s3 bitop3:0x6a
    v_lshl_add_u32 v32, v8, 4, v136
    v_add_u32 v32, 90624, v32
    v_lshrrev_b32 v7, 1, v6
    buffer_load_dwordx4 v241, s[28:31], s97 offen offset:1024  lds
    v_lshl_add_u32 v7, v5, 1, v7
    v_add_u32 v7, 32, v7
    v_and_b32 v8, 1, v7
    v_bfe_u32 v136, v7, 1, 2
    buffer_load_dwordx4 v242, s[28:31], s97 offen offset:2048  lds
    v_lshl_add_u32 v136, v8, 2, v136
    v_lshlrev_b32 v136, 6, v136
    v_lshrrev_b32 v7, 3, v7
    buffer_load_dwordx4 v243, s[28:31], s97 offen offset:3072  lds
    v_lshl_add_u32 v136, v7, 9, v136
    v_bitop3_b32 v8, v7, 3, s3 bitop3:0x6a
    v_lshl_add_u32 v20, v8, 4, v136
    v_add_u32 v20, 92160, v20
    s_add_u32 m0, s88, 18432
    s_mov_b64 exec, 0xffffffff
    buffer_load_dwordx4 v3, s[28:31], s97 offen offset:0  lds
    s_mov_b64 exec, -1
    v_and_b32 v8, 1, v6
    v_xor_b32 v8, 1, v8
    v_lshl_add_u32 v20, v8, 3, v20
    s_waitcnt vmcnt(11)
    s_barrier
    s_mul_i32 s16, s97, 3072
    s_add_u32 m0, s60, 24576
    s_add_u32 s99, s16, s62
    buffer_load_dwordx4 v244, s[32:35], s99 offen offset:0  lds
    s_waitcnt lgkmcnt(0)
    s_and_b32 s78, s92, 0xffff0000
    s_lshl_b32 s92, s92, 16
    buffer_load_dwordx4 v245, s[32:35], s99 offen offset:1024  lds
    s_bitcmp1_b32 s90, 0
    s_cselect_b32 s92, s78, s92
    v_lshlrev_b32 v7, 3, v6
    v_sub_u32 v7, v7, v5
    buffer_load_dwordx4 v246, s[32:35], s99 offen offset:2048  lds
    v_subrev_u32 v7, 9, v7
    v_and_b32 v8, 1, v7
    v_xor_b32 v8, 1, v8
    s_add_u32 m0, s61, 36864
    s_add_u32 s16, s16, s63
    buffer_load_dwordx4 v244, s[32:35], s16 offen offset:0  lds
    v_lshlrev_b32 v8, 4, v8
    v_lshrrev_b32 v8, v8, s92
    v_ashrrev_i32 v7, 1, v7
    buffer_load_dwordx4 v245, s[32:35], s16 offen offset:1024  lds
    v_cmp_eq_u32 vcc, 0, v7
    s_nop 1
    v_cndmask_b32 v236, 0, v8, vcc
    v_cmp_eq_u32 vcc, 1, v7
    buffer_load_dwordx4 v246, s[32:35], s16 offen offset:2048  lds
    s_nop 0
    v_cndmask_b32 v237, 0, v8, vcc
    v_cmp_eq_u32 vcc, 2, v7
    s_nop 1
    v_cndmask_b32 v238, 0, v8, vcc
    s_add_u32 s97, s98, s0
    s_lshr_b64 s[0:1], s[0:1], 4
    s_and_b32 s97, s97, 15
    s_add_u32 m0, s87, 36864
    s_lshl_b32 s97, s97, 7
    buffer_load_dwordx4 v240, s[28:31], s97 offen offset:0  lds
    v_cmp_eq_u32 vcc, 3, v7
    s_nop 1
    v_cndmask_b32 v239, 0, v8, vcc
    s_and_b32 s78, s77, 7
    s_mov_b32 s95, 0x76543210
    s_and_b32 s78, s76, 3
    s_mul_i32 s78, s78, 0x22222222
    s_add_u32 s95, s95, s78
    s_bfe_u32 s17, s95, 0x30000
    s_lshl_b32 s17, s17, 18
    s_bfe_u32 s18, s95, 0x30004
    s_lshl_b32 s18, s18, 18
    s_bfe_u32 s100, s95, 0x3001c
    s_lshl_b32 s100, s100, 18
    s_bfe_u32 s95, s95, 0x30018
    s_lshl_b32 s95, s95, 18
    buffer_load_dwordx4 v241, s[28:31], s97 offen offset:1024  lds
    v_lshrrev_b32 v136, 4, v0
    v_lshlrev_b32 v136, 1, v136
    v_and_b32 v137, 7, v0
    buffer_load_dwordx4 v242, s[28:31], s97 offen offset:2048  lds
    v_xor_b32 v136, v136, v137
    v_lshlrev_b32 v136, 4, v136
    v_lshrrev_b32 v137, 3, v0
    buffer_load_dwordx4 v243, s[28:31], s97 offen offset:3072  lds
    v_lshl_add_u32 v136, v137, 11, v136
    s_lshl_b32 s78, s77, 7
    s_lshl_b32 s79, s3, 14
    s_add_u32 m0, s88, 36864
    s_mov_b64 exec, 0xffffffff
    buffer_load_dwordx4 v3, s[28:31], s97 offen offset:0  lds
    s_mov_b64 exec, -1
    s_add_u32 s78, s78, s79
    v_add_u32 v17, s78, v136
    s_waitcnt vmcnt(11)
    s_barrier
    s_mul_i32 s16, s97, 3072
    s_add_u32 m0, s60, 49152
    s_add_u32 s99, s16, s62
    buffer_load_dwordx4 v244, s[32:35], s99 offen offset:0  lds
    v_add_u32 v5, s94, v15
    ds_read_b128 v[140:143], v5 offset:32
    ds_read_b32 v156, v5 offset:48
    ds_read_b128 v[144:147], v5 offset:1056
    buffer_load_dwordx4 v245, s[32:35], s99 offen offset:1024  lds
    ds_read_b32 v157, v5 offset:1072
    ds_read_b128 v[148:151], v5 offset:2080
    ds_read_b32 v158, v5 offset:2096
    ds_read_b128 v[152:155], v5 offset:3104
    buffer_load_dwordx4 v246, s[32:35], s99 offen offset:2048  lds
    ds_read_b32 v159, v5 offset:3120
    v_lshrrev_b32 v6, 3, v0
    v_mul_u32_u24 v6, 4160, v6
    s_add_u32 m0, s61, 61440
    s_add_u32 s16, s16, s63
    buffer_load_dwordx4 v244, s[32:35], s16 offen offset:0  lds
    v_and_b32 v7, 7, v0
    v_lshl_add_u32 v6, v7, 2, v6
    v_add_u32 v6, s94, v6
    v_mov_b32 v7, 0
    buffer_load_dwordx4 v245, s[32:35], s16 offen offset:1024  lds
    s_waitcnt lgkmcnt(0)
    v_readfirstlane_b32 s93, v140
    s_nop 0
    s_lshl_b32 s93, s93, 16
    s_nop 1
    v_writelane_b32 v7, s93, 15
    buffer_load_dwordx4 v246, s[32:35], s16 offen offset:2048  lds
    v_alignbit_b32 v140, v141, v140, 16
    v_alignbit_b32 v141, v142, v141, 16
    v_alignbit_b32 v142, v143, v142, 16
    s_add_u32 s97, s98, s0
    s_lshr_b64 s[0:1], s[0:1], 4
    s_and_b32 s97, s97, 15
    s_add_u32 m0, s87, 0
    s_lshl_b32 s97, s97, 7
    buffer_load_dwordx4 v240, s[28:31], s97 offen offset:0  lds
    v_alignbit_b32 v143, v156, v143, 16
    v_alignbit_b32 v144, v145, v144, 16
    v_alignbit_b32 v145, v146, v145, 16
    v_alignbit_b32 v146, v147, v146, 16
    buffer_load_dwordx4 v241, s[28:31], s97 offen offset:1024  lds
    v_alignbit_b32 v147, v157, v147, 16
    v_alignbit_b32 v148, v149, v148, 16
    v_alignbit_b32 v149, v150, v149, 16
    v_alignbit_b32 v150, v151, v150, 16
    buffer_load_dwordx4 v242, s[28:31], s97 offen offset:2048  lds
    v_alignbit_b32 v151, v158, v151, 16
    v_alignbit_b32 v152, v153, v152, 16
    v_alignbit_b32 v153, v154, v153, 16
    buffer_load_dwordx4 v243, s[28:31], s97 offen offset:3072  lds
    v_alignbit_b32 v154, v155, v154, 16
    v_alignbit_b32 v155, v159, v155, 16
    v_lshlrev_b32 v8, 3, v0
    s_add_u32 s78, s88, 18432
    s_add_u32 m0, s88, 0
    s_mov_b64 exec, 0xffffffff
    buffer_load_dwordx4 v3, s[28:31], s97 offen offset:0  lds
    s_mov_b64 exec, -1
    v_add_u32 v8, s78, v8
    v_mov_b32 v156, 0
    v_mov_b32 v157, 0
    s_waitcnt vmcnt(11)
    s_barrier
    s_mul_i32 s16, s97, 3072
    s_add_u32 m0, s60, 0
    s_add_u32 s99, s16, s62
    buffer_load_dwordx4 v244, s[32:35], s99 offen offset:0  lds
    buffer_load_dwordx4 v245, s[32:35], s99 offen offset:1024  lds
    buffer_load_dwordx4 v246, s[32:35], s99 offen offset:2048  lds
    s_add_u32 m0, s61, 12288
    s_add_u32 s16, s16, s63
    buffer_load_dwordx4 v244, s[32:35], s16 offen offset:0  lds
    buffer_load_dwordx4 v245, s[32:35], s16 offen offset:1024  lds
    buffer_load_dwordx4 v246, s[32:35], s16 offen offset:2048  lds
    s_mov_b64 exec, 0xff
    buffer_load_dword v136, v33, s[68:71], 0 offen sc1
    buffer_load_dword v137, v34, s[52:55], 0 offen sc1
    s_mov_b64 exec, -1
    buffer_load_dwordx4 v[212:215], v9, s[56:59], 0 offen offset:0 nt
    buffer_load_dwordx4 v[216:219], v9, s[56:59], 0 offen offset:2048 nt
    buffer_load_dwordx4 v[220:223], v9, s[56:59], s96 offen offset:0 nt
    buffer_load_dwordx4 v[224:227], v9, s[56:59], s96 offen offset:2048 nt
    s_waitcnt vmcnt(12)
    s_waitcnt vmcnt(6)
    s_barrier
    s_waitcnt vmcnt(4)
    s_branch LA_j
LA_c1:
    s_waitcnt vmcnt(8)
    s_barrier
    buffer_load_dwordx4 v242, s[28:31], s97 offen offset:2048  lds
    buffer_load_dwordx4 v243, s[28:31], s97 offen offset:3072  lds
    s_add_u32 m0, s88, 36864
    s_mov_b64 exec, 0xffffffff
    buffer_load_dwordx4 v3, s[28:31], s97 offen offset:0  lds
    s_mov_b64 exec, -1
    s_mul_i32 s16, s97, 3072
    s_add_u32 m0, s60, 49152
    s_add_u32 s99, s16, s62
    buffer_load_dwordx4 v244, s[32:35], s99 offen offset:0  lds
    buffer_load_dwordx4 v245, s[32:35], s99 offen offset:1024  lds
    buffer_load_dwordx4 v246, s[32:35], s99 offen offset:2048  lds
    s_add_u32 m0, s61, 61440
    s_add_u32 s16, s16, s63
    buffer_load_dwordx4 v244, s[32:35], s16 offen offset:0  lds
    buffer_load_dwordx4 v245, s[32:35], s16 offen offset:1024  lds
    buffer_load_dwordx4 v246, s[32:35], s16 offen offset:2048  lds
    s_add_u32 s97, s98, s0
    s_lshr_b64 s[0:1], s[0:1], 4
    s_and_b32 s97, s97, 15
    s_add_u32 m0, s87, 0
    s_lshl_b32 s97, s97, 7
    buffer_load_dwordx4 v240, s[28:31], s97 offen offset:0  lds
    buffer_load_dwordx4 v241, s[28:31], s97 offen offset:1024  lds
    buffer_load_dwordx4 v242, s[28:31], s97 offen offset:2048  lds
    buffer_load_dwordx4 v243, s[28:31], s97 offen offset:3072  lds
    s_add_u32 m0, s88, 0
    s_mov_b64 exec, 0xffffffff
    buffer_load_dwordx4 v3, s[28:31], s97 offen offset:0  lds
    s_mov_b64 exec, -1
    s_waitcnt vmcnt(11)
    s_barrier
    s_mul_i32 s16, s97, 3072
    s_add_u32 m0, s60, 0
    s_add_u32 s99, s16, s62
    buffer_load_dwordx4 v244, s[32:35], s99 offen offset:0  lds
    buffer_load_dwordx4 v245, s[32:35], s99 offen offset:1024  lds
    buffer_load_dwordx4 v246, s[32:35], s99 offen offset:2048  lds
    s_add_u32 m0, s61, 12288
    s_add_u32 s16, s16, s63
    buffer_load_dwordx4 v244, s[32:35], s16 offen offset:0  lds
    buffer_load_dwordx4 v245, s[32:35], s16 offen offset:1024  lds
    buffer_load_dwordx4 v246, s[32:35], s16 offen offset:2048  lds
    s_add_u32 m0, s86, 129536
    s_mov_b32 s89, 0
    buffer_load_dwordx4 v10, s[36:39], s89 offen nt lds
    s_add_u32 m0, s86, 145920
    s_mov_b32 s89, 0
    buffer_load_dwordx4 v10, s[40:43], s89 offen nt lds
    s_add_u32 m0, s86, 133632
    s_mov_b32 s89, 65536
    buffer_load_dwordx4 v10, s[36:39], s89 offen nt lds
    s_add_u32 m0, s86, 150016
    s_mov_b32 s89, 65536
    buffer_load_dwordx4 v10, s[40:43], s89 offen nt lds
    s_add_u32 m0, s86, 137728
    s_mov_b32 s89, 131072
    buffer_load_dwordx4 v10, s[36:39], s89 offen nt lds
    s_add_u32 m0, s86, 154112
    s_mov_b32 s89, 131072
    buffer_load_dwordx4 v10, s[40:43], s89 offen nt lds
    s_add_u32 m0, s86, 141824
    s_mov_b32 s89, 196608
    buffer_load_dwordx4 v10, s[36:39], s89 offen nt lds
    s_add_u32 m0, s86, 158208
    s_mov_b32 s89, 196608
    buffer_load_dwordx4 v10, s[40:43], s89 offen nt lds
    s_mov_b64 exec, 0xff
    s_lshl_b32 s82, s3, 7
    s_add_u32 m0, s82, 129024
    s_mov_b32 s89, 0
    buffer_load_dwordx4 v11, s[36:39], s89 offen nt lds
    s_lshl_b32 s83, s74, 9
    s_add_u32 s83, s83, s82
    s_and_b32 s89, s3, 2
    s_lshl_b32 s89, s89, 3
    s_add_u32 s82, s82, s89
    s_add_u32 m0, s82, 162816
    s_add_u32 s89, s83, 0
    buffer_load_dwordx4 v15, s[44:47], s89 offen  lds
    s_mov_b64 exec, -1
    s_add_u32 s97, s98, s0
    s_lshr_b64 s[0:1], s[0:1], 4
    s_and_b32 s97, s97, 15
    s_add_u32 m0, s87, 18432
    s_lshl_b32 s97, s97, 7
    buffer_load_dwordx4 v240, s[28:31], s97 offen offset:0  lds
    s_waitcnt vmcnt(17)
    s_barrier
    buffer_load_dwordx4 v241, s[28:31], s97 offen offset:1024  lds
    buffer_load_dwordx4 v242, s[28:31], s97 offen offset:2048  lds
    buffer_load_dwordx4 v243, s[28:31], s97 offen offset:3072  lds
    s_add_u32 m0, s88, 18432
    s_mov_b64 exec, 0xffffffff
    buffer_load_dwordx4 v3, s[28:31], s97 offen offset:0  lds
    s_mov_b64 exec, -1
    s_mul_i32 s16, s97, 3072
    s_add_u32 m0, s60, 24576
    s_add_u32 s99, s16, s62
    buffer_load_dwordx4 v244, s[32:35], s99 offen offset:0  lds
    buffer_load_dwordx4 v245, s[32:35], s99 offen offset:1024  lds
    buffer_load_dwordx4 v246, s[32:35], s99 offen offset:2048  lds
    s_add_u32 m0, s61, 36864
    s_add_u32 s16, s16, s63
    buffer_load_dwordx4 v244, s[32:35], s16 offen offset:0  lds
    buffer_load_dwordx4 v245, s[32:35], s16 offen offset:1024  lds
    buffer_load_dwordx4 v246, s[32:35], s16 offen offset:2048  lds
    s_add_u32 s97, s98, s0
    s_lshr_b64 s[0:1], s[0:1], 4
    s_and_b32 s97, s97, 15
    s_add_u32 m0, s87, 36864
    s_lshl_b32 s97, s97, 7
    buffer_load_dwordx4 v240, s[28:31], s97 offen offset:0  lds
    buffer_load_dwordx4 v241, s[28:31], s97 offen offset:1024  lds
    buffer_load_dwordx4 v242, s[28:31], s97 offen offset:2048  lds
    buffer_load_dwordx4 v243, s[28:31], s97 offen offset:3072  lds
    s_add_u32 m0, s88, 36864
    s_mov_b64 exec, 0xffffffff
    buffer_load_dwordx4 v3, s[28:31], s97 offen offset:0  lds
    s_mov_b64 exec, -1
    s_waitcnt vmcnt(11)
    s_barrier
    s_mul_i32 s16, s97, 3072
    s_add_u32 m0, s60, 49152
    s_add_u32 s99, s16, s62
    buffer_load_dwordx4 v244, s[32:35], s99 offen offset:0  lds
    ds_read_b128 v[84:87], v35 offset:0
    ds_read_b128 v[88:91], v35 offset:16
    buffer_load_dwordx4 v245, s[32:35], s99 offen offset:1024  lds
    ds_read_b64 v[40:41], v16 offset:0
    ds_read_b64 v[42:43], v231 offset:256
    buffer_load_dwordx4 v246, s[32:35], s99 offen offset:2048  lds
    ds_read_b64 v[44:45], v16 offset:256
    ds_read_b64 v[46:47], v16 offset:512
    s_add_u32 m0, s61, 61440
    s_add_u32 s16, s16, s63
    buffer_load_dwordx4 v244, s[32:35], s16 offen offset:0  lds
    ds_read_b64 v[48:49], v231 offset:512
    ds_read_b64 v[50:51], v16 offset:768
    buffer_load_dwordx4 v245, s[32:35], s16 offen offset:1024  lds
    ds_read_b64 v[52:53], v231 offset:768
    ds_read_b64 v[54:55], v16 offset:1024
    buffer_load_dwordx4 v246, s[32:35], s16 offen offset:2048  lds
    ds_read_b64 v[56:57], v231 offset:1024
    ds_read_b64 v[58:59], v16 offset:1280
    s_add_u32 s97, s98, s0
    s_lshr_b64 s[0:1], s[0:1], 4
    s_and_b32 s97, s97, 15
    s_add_u32 m0, s87, 0
    s_lshl_b32 s97, s97, 7
    buffer_load_dwordx4 v240, s[28:31], s97 offen offset:0  lds
    ds_read_b64 v[60:61], v231 offset:1280
    ds_read_b64 v[68:69], v16 offset:16896
    buffer_load_dwordx4 v241, s[28:31], s97 offen offset:1024  lds
    ds_read_b64 v[70:71], v231 offset:16896
    ds_read_b64 v[72:73], v16 offset:17152
    buffer_load_dwordx4 v242, s[28:31], s97 offen offset:2048  lds
    ds_read_b64 v[74:75], v231 offset:17152
    ds_read_b64 v[76:77], v16 offset:17408
    buffer_load_dwordx4 v243, s[28:31], s97 offen offset:3072  lds
    ds_read_b64 v[78:79], v231 offset:17408
    ds_read_b64 v[80:81], v16 offset:17664
    s_add_u32 m0, s88, 0
    s_mov_b64 exec, 0xffffffff
    buffer_load_dwordx4 v3, s[28:31], s97 offen offset:0  lds
    s_mov_b64 exec, -1
    ds_read_b64 v[82:83], v231 offset:17664
    s_waitcnt vmcnt(11)
    s_waitcnt lgkmcnt(0)
    s_barrier
    s_mul_i32 s16, s97, 3072
    s_add_u32 m0, s60, 0
    s_add_u32 s99, s16, s62
    buffer_load_dwordx4 v244, s[32:35], s99 offen offset:0  lds
    v_lshlrev_b32 v160, 16, v40
    v_lshlrev_b32 v161, 16, v42
    v_lshlrev_b32 v162, 16, v44
    v_lshlrev_b32 v163, 16, v46
    v_lshlrev_b32 v164, 16, v48
    buffer_load_dwordx4 v245, s[32:35], s99 offen offset:1024  lds
    v_lshlrev_b32 v165, 16, v50
    v_lshlrev_b32 v166, 16, v52
    v_lshlrev_b32 v167, 16, v54
    v_lshlrev_b32 v168, 16, v56
    v_lshlrev_b32 v169, 16, v58
    buffer_load_dwordx4 v246, s[32:35], s99 offen offset:2048  lds
    v_lshlrev_b32 v170, 16, v60
    v_lshlrev_b32 v172, 16, v84
    v_and_b32 v173, 0xffff0000, v84
    v_lshlrev_b32 v174, 16, v85
    v_and_b32 v175, 0xffff0000, v85
    s_add_u32 m0, s61, 12288
    s_add_u32 s16, s16, s63
    buffer_load_dwordx4 v244, s[32:35], s16 offen offset:0  lds
    v_lshlrev_b32 v176, 16, v68
    v_lshlrev_b32 v177, 16, v70
    v_lshlrev_b32 v178, 16, v72
    v_lshlrev_b32 v179, 16, v74
    v_lshlrev_b32 v180, 16, v76
    buffer_load_dwordx4 v245, s[32:35], s16 offen offset:1024  lds
    v_lshlrev_b32 v181, 16, v78
    v_lshlrev_b32 v182, 16, v80
    v_lshlrev_b32 v183, 16, v82
    v_mul_f32 v184, v160, v175
    v_mul_f32 v185, v161, v175
    buffer_load_dwordx4 v246, s[32:35], s16 offen offset:2048  lds
    v_mul_f32 v186, v162, v175
    v_mul_f32 v187, v163, v175
    v_mul_f32 v188, v164, v175
    v_mul_f32 v189, v165, v175
    v_mul_f32 v190, v166, v175
    buffer_load_dword v230, v229, s[4:7], 0 offen
    v_mul_f32 v191, v167, v175
    v_fmac_f32 v184, v161, v174
    v_fmac_f32 v185, v162, v174
    v_fmac_f32 v186, v163, v174
    v_fmac_f32 v187, v164, v174
    buffer_load_dword v230, v228, s[32:35], 0 offen
    v_fmac_f32 v188, v165, v174
    v_fmac_f32 v189, v166, v174
    v_fmac_f32 v190, v167, v174
    v_fmac_f32 v191, v168, v174
    v_fmac_f32 v184, v162, v173
    s_add_u32 s97, s98, s0
    s_lshr_b64 s[0:1], s[0:1], 4
    s_and_b32 s97, s97, 15
    s_add_u32 m0, s87, 18432
    s_lshl_b32 s97, s97, 7
    buffer_load_dwordx4 v240, s[28:31], s97 offen offset:0  lds
    v_fmac_f32 v185, v163, v173
    v_fmac_f32 v186, v164, v173
    v_fmac_f32 v187, v165, v173
    v_fmac_f32 v188, v166, v173
    v_fmac_f32 v189, v167, v173
    buffer_load_dwordx4 v241, s[28:31], s97 offen offset:1024  lds
    v_fmac_f32 v190, v168, v173
    v_fmac_f32 v191, v169, v173
    v_fmac_f32 v184, v163, v172
    v_fmac_f32 v185, v164, v172
    v_fmac_f32 v186, v165, v172
    buffer_load_dwordx4 v242, s[28:31], s97 offen offset:2048  lds
    v_fmac_f32 v187, v166, v172
    v_fmac_f32 v188, v167, v172
    v_fmac_f32 v189, v168, v172
    v_fmac_f32 v190, v169, v172
    v_fmac_f32 v191, v170, v172
    buffer_load_dwordx4 v243, s[28:31], s97 offen offset:3072  lds
    v_mul_f32 v184, v184, v176
    v_mul_f32 v185, v185, v177
    v_mul_f32 v186, v186, v178
    v_mul_f32 v187, v187, v179
    v_mul_f32 v188, v188, v180
    s_add_u32 m0, s88, 18432
    s_mov_b64 exec, 0xffffffff
    buffer_load_dwordx4 v3, s[28:31], s97 offen offset:0  lds
    s_mov_b64 exec, -1
    v_mul_f32 v189, v189, v181
    v_mul_f32 v190, v190, v182
    v_mul_f32 v191, v191, v183
    v_cvt_pk_bf16_f32 v100, v191, v190
    v_cvt_pk_bf16_f32 v101, v189, v188
    v_cvt_pk_bf16_f32 v102, v187, v186
    v_cvt_pk_bf16_f32 v103, v185, v184
    s_mov_b32 s89, 0
    buffer_store_dwordx4 v[100:103], v12, s[52:55], s89 offen sc1
    v_and_b32 v160, 0xffff0000, v40
    v_and_b32 v161, 0xffff0000, v42
    v_and_b32 v162, 0xffff0000, v44
    v_and_b32 v163, 0xffff0000, v46
    v_and_b32 v164, 0xffff0000, v48
    v_and_b32 v165, 0xffff0000, v50
    v_and_b32 v166, 0xffff0000, v52
    v_and_b32 v167, 0xffff0000, v54
    v_and_b32 v168, 0xffff0000, v56
    v_and_b32 v169, 0xffff0000, v58
    v_and_b32 v170, 0xffff0000, v60
    v_lshlrev_b32 v172, 16, v86
    v_and_b32 v173, 0xffff0000, v86
    v_lshlrev_b32 v174, 16, v87
    v_and_b32 v175, 0xffff0000, v87
    v_and_b32 v176, 0xffff0000, v68
    v_and_b32 v177, 0xffff0000, v70
    v_and_b32 v178, 0xffff0000, v72
    v_and_b32 v179, 0xffff0000, v74
    v_and_b32 v180, 0xffff0000, v76
    v_and_b32 v181, 0xffff0000, v78
    v_and_b32 v182, 0xffff0000, v80
    v_and_b32 v183, 0xffff0000, v82
    s_waitcnt vmcnt(14)
    s_barrier
    s_mul_i32 s16, s97, 3072
    s_add_u32 m0, s60, 24576
    s_add_u32 s99, s16, s62
    buffer_load_dwordx4 v244, s[32:35], s99 offen offset:0  lds
    v_mul_f32 v184, v160, v175
    v_mul_f32 v185, v161, v175
    v_mul_f32 v186, v162, v175
    v_mul_f32 v187, v163, v175
    v_mul_f32 v188, v164, v175
    buffer_load_dwordx4 v245, s[32:35], s99 offen offset:1024  lds
    v_mul_f32 v189, v165, v175
    v_mul_f32 v190, v166, v175
    v_mul_f32 v191, v167, v175
    v_fmac_f32 v184, v161, v174
    v_fmac_f32 v185, v162, v174
    buffer_load_dwordx4 v246, s[32:35], s99 offen offset:2048  lds
    v_fmac_f32 v186, v163, v174
    v_fmac_f32 v187, v164, v174
    v_fmac_f32 v188, v165, v174
    v_fmac_f32 v189, v166, v174
    v_fmac_f32 v190, v167, v174
    s_add_u32 m0, s61, 36864
    s_add_u32 s16, s16, s63
    buffer_load_dwordx4 v244, s[32:35], s16 offen offset:0  lds
    v_fmac_f32 v191, v168, v174
    v_fmac_f32 v184, v162, v173
    v_fmac_f32 v185, v163, v173
    v_fmac_f32 v186, v164, v173
    v_fmac_f32 v187, v165, v173
    buffer_load_dwordx4 v245, s[32:35], s16 offen offset:1024  lds
    v_fmac_f32 v188, v166, v173
    v_fmac_f32 v189, v167, v173
    v_fmac_f32 v190, v168, v173
    v_fmac_f32 v191, v169, v173
    v_fmac_f32 v184, v163, v172
    buffer_load_dwordx4 v246, s[32:35], s16 offen offset:2048  lds
    v_fmac_f32 v185, v164, v172
    v_fmac_f32 v186, v165, v172
    v_fmac_f32 v187, v166, v172
    v_fmac_f32 v188, v167, v172
    v_fmac_f32 v189, v168, v172
    s_add_u32 s97, s98, s0
    s_lshr_b64 s[0:1], s[0:1], 4
    s_and_b32 s97, s97, 15
    s_add_u32 m0, s87, 36864
    s_lshl_b32 s97, s97, 7
    buffer_load_dwordx4 v240, s[28:31], s97 offen offset:0  lds
    v_fmac_f32 v190, v169, v172
    v_fmac_f32 v191, v170, v172
    v_mul_f32 v184, v184, v176
    v_mul_f32 v185, v185, v177
    v_mul_f32 v186, v186, v178
    buffer_load_dwordx4 v241, s[28:31], s97 offen offset:1024  lds
    v_mul_f32 v187, v187, v179
    v_mul_f32 v188, v188, v180
    v_mul_f32 v189, v189, v181
    v_mul_f32 v190, v190, v182
    v_mul_f32 v191, v191, v183
    buffer_load_dwordx4 v242, s[28:31], s97 offen offset:2048  lds
    v_cvt_pk_bf16_f32 v104, v191, v190
    v_cvt_pk_bf16_f32 v105, v189, v188
    v_cvt_pk_bf16_f32 v106, v187, v186
    v_cvt_pk_bf16_f32 v107, v185, v184
    s_mov_b32 s89, 16384
    buffer_store_dwordx4 v[104:107], v12, s[52:55], s89 offen sc1
    buffer_load_dwordx4 v243, s[28:31], s97 offen offset:3072  lds
    v_lshlrev_b32 v160, 16, v41
    v_lshlrev_b32 v161, 16, v43
    v_lshlrev_b32 v162, 16, v45
    v_lshlrev_b32 v163, 16, v47
    v_lshlrev_b32 v164, 16, v49
    s_add_u32 m0, s88, 36864
    s_mov_b64 exec, 0xffffffff
    buffer_load_dwordx4 v3, s[28:31], s97 offen offset:0  lds
    s_mov_b64 exec, -1
    v_lshlrev_b32 v165, 16, v51
    v_lshlrev_b32 v166, 16, v53
    v_lshlrev_b32 v167, 16, v55
    v_lshlrev_b32 v168, 16, v57
    v_lshlrev_b32 v169, 16, v59
    v_lshlrev_b32 v170, 16, v61
    v_lshlrev_b32 v172, 16, v88
    v_and_b32 v173, 0xffff0000, v88
    v_lshlrev_b32 v174, 16, v89
    v_and_b32 v175, 0xffff0000, v89
    v_lshlrev_b32 v176, 16, v69
    v_lshlrev_b32 v177, 16, v71
    v_lshlrev_b32 v178, 16, v73
    v_lshlrev_b32 v179, 16, v75
    v_lshlrev_b32 v180, 16, v77
    v_lshlrev_b32 v181, 16, v79
    v_lshlrev_b32 v182, 16, v81
    v_lshlrev_b32 v183, 16, v83
    v_mul_f32 v184, v160, v175
    v_mul_f32 v185, v161, v175
    v_mul_f32 v186, v162, v175
    v_mul_f32 v187, v163, v175
    v_mul_f32 v188, v164, v175
    v_mul_f32 v189, v165, v175
    v_mul_f32 v190, v166, v175
    v_mul_f32 v191, v167, v175
    v_fmac_f32 v184, v161, v174
    v_fmac_f32 v185, v162, v174
    v_fmac_f32 v186, v163, v174
    v_fmac_f32 v187, v164, v174
    v_fmac_f32 v188, v165, v174
    v_fmac_f32 v189, v166, v174
    v_fmac_f32 v190, v167, v174
    v_fmac_f32 v191, v168, v174
    v_fmac_f32 v184, v162, v173
    v_fmac_f32 v185, v163, v173
    v_fmac_f32 v186, v164, v173
    v_fmac_f32 v187, v165, v173
    v_fmac_f32 v188, v166, v173
    v_fmac_f32 v189, v167, v173
    v_fmac_f32 v190, v168, v173
    s_waitcnt vmcnt(13)
    s_barrier
    s_mul_i32 s16, s97, 3072
    s_add_u32 m0, s60, 49152
    s_add_u32 s99, s16, s62
    buffer_load_dwordx4 v244, s[32:35], s99 offen offset:0  lds
    v_fmac_f32 v191, v169, v173
    v_fmac_f32 v184, v163, v172
    v_fmac_f32 v185, v164, v172
    v_fmac_f32 v186, v165, v172
    v_fmac_f32 v187, v166, v172
    buffer_load_dwordx4 v245, s[32:35], s99 offen offset:1024  lds
    v_fmac_f32 v188, v167, v172
    v_fmac_f32 v189, v168, v172
    v_fmac_f32 v190, v169, v172
    v_fmac_f32 v191, v170, v172
    v_mul_f32 v184, v184, v176
    buffer_load_dwordx4 v246, s[32:35], s99 offen offset:2048  lds
    v_mul_f32 v185, v185, v177
    v_mul_f32 v186, v186, v178
    v_mul_f32 v187, v187, v179
    v_mul_f32 v188, v188, v180
    v_mul_f32 v189, v189, v181
    s_add_u32 m0, s61, 61440
    s_add_u32 s16, s16, s63
    buffer_load_dwordx4 v244, s[32:35], s16 offen offset:0  lds
    v_mul_f32 v190, v190, v182
    v_mul_f32 v191, v191, v183
    v_cvt_pk_bf16_f32 v108, v191, v190
    v_cvt_pk_bf16_f32 v109, v189, v188
    v_cvt_pk_bf16_f32 v110, v187, v186
    buffer_load_dwordx4 v245, s[32:35], s16 offen offset:1024  lds
    v_cvt_pk_bf16_f32 v111, v185, v184
    s_mov_b32 s89, 32768
    buffer_store_dwordx4 v[108:111], v12, s[52:55], s89 offen sc1
    v_and_b32 v160, 0xffff0000, v41
    v_and_b32 v161, 0xffff0000, v43
    v_and_b32 v162, 0xffff0000, v45
    buffer_load_dwordx4 v246, s[32:35], s16 offen offset:2048  lds
    v_and_b32 v163, 0xffff0000, v47
    v_and_b32 v164, 0xffff0000, v49
    v_and_b32 v165, 0xffff0000, v51
    v_and_b32 v166, 0xffff0000, v53
    v_and_b32 v167, 0xffff0000, v55
    s_add_u32 s97, s98, s0
    s_lshr_b64 s[0:1], s[0:1], 4
    s_and_b32 s97, s97, 15
    s_add_u32 m0, s87, 0
    s_lshl_b32 s97, s97, 7
    buffer_load_dwordx4 v240, s[28:31], s97 offen offset:0  lds
    v_and_b32 v168, 0xffff0000, v57
    v_and_b32 v169, 0xffff0000, v59
    v_and_b32 v170, 0xffff0000, v61
    v_lshlrev_b32 v172, 16, v90
    v_and_b32 v173, 0xffff0000, v90
    buffer_load_dwordx4 v241, s[28:31], s97 offen offset:1024  lds
    v_lshlrev_b32 v174, 16, v91
    v_and_b32 v175, 0xffff0000, v91
    v_and_b32 v176, 0xffff0000, v69
    v_and_b32 v177, 0xffff0000, v71
    v_and_b32 v178, 0xffff0000, v73
    buffer_load_dwordx4 v242, s[28:31], s97 offen offset:2048  lds
    v_and_b32 v179, 0xffff0000, v75
    v_and_b32 v180, 0xffff0000, v77
    v_and_b32 v181, 0xffff0000, v79
    v_and_b32 v182, 0xffff0000, v81
    v_and_b32 v183, 0xffff0000, v83
    buffer_load_dwordx4 v243, s[28:31], s97 offen offset:3072  lds
    v_mul_f32 v184, v160, v175
    v_mul_f32 v185, v161, v175
    v_mul_f32 v186, v162, v175
    v_mul_f32 v187, v163, v175
    v_mul_f32 v188, v164, v175
    s_add_u32 m0, s88, 0
    s_mov_b64 exec, 0xffffffff
    buffer_load_dwordx4 v3, s[28:31], s97 offen offset:0  lds
    s_mov_b64 exec, -1
    v_mul_f32 v189, v165, v175
    v_mul_f32 v190, v166, v175
    v_mul_f32 v191, v167, v175
    v_fmac_f32 v184, v161, v174
    v_fmac_f32 v185, v162, v174
    v_fmac_f32 v186, v163, v174
    v_fmac_f32 v187, v164, v174
    v_fmac_f32 v188, v165, v174
    v_fmac_f32 v189, v166, v174
    v_fmac_f32 v190, v167, v174
    v_fmac_f32 v191, v168, v174
    v_fmac_f32 v184, v162, v173
    v_fmac_f32 v185, v163, v173
    v_fmac_f32 v186, v164, v173
    v_fmac_f32 v187, v165, v173
    v_fmac_f32 v188, v166, v173
    v_fmac_f32 v189, v167, v173
    v_fmac_f32 v190, v168, v173
    v_fmac_f32 v191, v169, v173
    v_fmac_f32 v184, v163, v172
    v_fmac_f32 v185, v164, v172
    v_fmac_f32 v186, v165, v172
    v_fmac_f32 v187, v166, v172
    v_fmac_f32 v188, v167, v172
    v_fmac_f32 v189, v168, v172
    v_fmac_f32 v190, v169, v172
    v_fmac_f32 v191, v170, v172
    v_mul_f32 v184, v184, v176
    v_mul_f32 v185, v185, v177
    v_mul_f32 v186, v186, v178
    v_mul_f32 v187, v187, v179
    v_mul_f32 v188, v188, v180
    v_mul_f32 v189, v189, v181
    v_mul_f32 v190, v190, v182
    v_mul_f32 v191, v191, v183
    v_cvt_pk_bf16_f32 v112, v191, v190
    v_cvt_pk_bf16_f32 v113, v189, v188
    v_cvt_pk_bf16_f32 v114, v187, v186
    v_cvt_pk_bf16_f32 v115, v185, v184
    s_mov_b32 s89, 49152
    buffer_store_dwordx4 v[112:115], v12, s[52:55], s89 offen sc1
    s_waitcnt vmcnt(13)
    s_barrier
    s_mul_i32 s16, s97, 3072
    s_add_u32 m0, s60, 0
    s_add_u32 s99, s16, s62
    buffer_load_dwordx4 v244, s[32:35], s99 offen offset:0  lds
    buffer_load_dwordx4 v245, s[32:35], s99 offen offset:1024  lds
    buffer_load_dwordx4 v246, s[32:35], s99 offen offset:2048  lds
    s_add_u32 m0, s61, 12288
    s_add_u32 s16, s16, s63
    buffer_load_dwordx4 v244, s[32:35], s16 offen offset:0  lds
    buffer_load_dwordx4 v245, s[32:35], s16 offen offset:1024  lds
    buffer_load_dwordx4 v246, s[32:35], s16 offen offset:2048  lds
    s_add_u32 s97, s98, s0
    s_lshr_b64 s[0:1], s[0:1], 4
    s_and_b32 s97, s97, 15
    s_add_u32 m0, s87, 18432
    s_lshl_b32 s97, s97, 7
    buffer_load_dwordx4 v240, s[28:31], s97 offen offset:0  lds
    buffer_load_dwordx4 v241, s[28:31], s97 offen offset:1024  lds
    buffer_load_dwordx4 v242, s[28:31], s97 offen offset:2048  lds
    buffer_load_dwordx4 v243, s[28:31], s97 offen offset:3072  lds
    s_add_u32 m0, s88, 18432
    s_mov_b64 exec, 0xffffffff
    buffer_load_dwordx4 v3, s[28:31], s97 offen offset:0  lds
    s_mov_b64 exec, -1
    s_waitcnt vmcnt(12)
    s_barrier
    s_mul_i32 s16, s97, 3072
    s_add_u32 m0, s60, 24576
    s_add_u32 s99, s16, s62
    buffer_load_dwordx4 v244, s[32:35], s99 offen offset:0  lds
    s_mov_b32 s68, s24
    s_mov_b32 s69, s25
    s_mov_b32 s70, 0x100
    buffer_load_dwordx4 v245, s[32:35], s99 offen offset:1024  lds
    s_mov_b32 s71, 0x20000
    v_lshrrev_b32 v6, 5, v0
    v_and_b32 v7, 3, v0
    buffer_load_dwordx4 v246, s[32:35], s99 offen offset:2048  lds
    s_lshr_b32 s78, s90, 1
    s_lshl_b32 s78, s78, 2
    s_add_u32 m0, s61, 36864
    s_add_u32 s16, s16, s63
    buffer_load_dwordx4 v244, s[32:35], s16 offen offset:0  lds
    s_load_dword s92, s[14:15], s78
    v_bfe_u32 v5, v0, 2, 2
    v_lshlrev_b32 v5, 1, v5
    buffer_load_dwordx4 v245, s[32:35], s16 offen offset:1024  lds
    v_lshl_add_u32 v5, v6, 3, v5
    v_bfe_u32 v8, v0, 4, 1
    v_add_u32 v5, v5, v8
    buffer_load_dwordx4 v246, s[32:35], s16 offen offset:2048  lds
    s_and_b32 s78, s3, 1
    s_lshl_b32 s78, s78, 1
    s_add_u32 m0, s94, 32
    s_lshl_b32 s89, s90, 12
    buffer_load_dwordx4 v15, s[48:51], s89 offen offset:0 nt lds
    v_add_u32 v8, s78, v6
    v_xor_b32 v8, v8, v7
    v_lshlrev_b32 v8, 4, v8
    s_add_u32 m0, s94, 32
    s_lshl_b32 s89, s90, 12
    buffer_load_dwordx4 v15, s[48:51], s89 offen offset:1024 nt lds
    v_lshl_add_u32 v5, v5, 6, v8
    v_add_u32 v14, s86, v5
    v_mov_b32 v18, 162304
    s_add_u32 m0, s94, 32
    s_lshl_b32 s89, s90, 12
    buffer_load_dwordx4 v15, s[48:51], s89 offen offset:2048 nt lds
    v_mov_b32 v19, 1
    v_and_b32 v5, 3, v0
    s_add_u32 m0, s94, 32
    s_lshl_b32 s89, s90, 12
    buffer_load_dwordx4 v15, s[48:51], s89 offen offset:3072 nt lds
    s_lshl_b32 s78, s74, 4
    s_add_u32 s78, s78, s3
    v_lshl_add_u32 v6, v5, 2, s78
    s_add_u32 s97, s98, s0
    s_lshr_b64 s[0:1], s[0:1], 4
    s_and_b32 s97, s97, 15
    s_add_u32 m0, s87, 36864
    s_lshl_b32 s97, s97, 7
    buffer_load_dwordx4 v240, s[28:31], s97 offen offset:0  lds
    s_lshr_b32 s78, s76, 3
    s_lshl_b32 s79, s3, 1
    s_add_u32 s78, s78, s79
    buffer_load_dwordx4 v241, s[28:31], s97 offen offset:1024  lds
    s_xor_b32 s78, s78, 2
    s_lshl_b32 s78, s78, 5
    buffer_load_dwordx4 v242, s[28:31], s97 offen offset:2048  lds
    s_add_u32 s79, s76, 5
    s_and_b32 s79, s79, 7
    s_lshl_b32 s79, s79, 1
    buffer_load_dwordx4 v243, s[28:31], s97 offen offset:3072  lds
    s_add_u32 s78, s78, s79
    v_mul_u32_u24 v7, 9, v5
    v_and_b32 v7, 17, v7
    s_add_u32 m0, s88, 36864
    s_mov_b64 exec, 0xffffffff
    buffer_load_dwordx4 v3, s[28:31], s97 offen offset:0  lds
    s_mov_b64 exec, -1
    v_add_u32 v7, s78, v7
    v_and_b32 v8, 4, v0
    s_waitcnt vmcnt(15)
    s_barrier
    s_mul_i32 s16, s97, 3072
    s_add_u32 m0, s60, 49152
    s_add_u32 s99, s16, s62
    buffer_load_dwordx4 v244, s[32:35], s99 offen offset:0  lds
    v_cmp_eq_u32 vcc, 0, v8
    s_nop 1
    v_cndmask_b32 v6, v7, v6, vcc
    v_and_b32 v33, 0xf0, v6
    v_lshlrev_b32 v34, 8, v6
    buffer_load_dwordx4 v245, s[32:35], s99 offen offset:1024  lds
    v_add_u32 v34, 12582912, v34
    v_and_b32 v5, 15, v0
    v_lshrrev_b32 v6, 4, v0
    v_add_u32 v7, 9, v5
    buffer_load_dwordx4 v246, s[32:35], s99 offen offset:2048  lds
    v_and_b32 v8, 1, v7
    v_mul_u32_u24 v8, 4160, v8
    v_lshrrev_b32 v7, 1, v7
    s_add_u32 m0, s61, 61440
    s_add_u32 s16, s16, s63
    buffer_load_dwordx4 v244, s[32:35], s16 offen offset:0  lds
    v_lshl_add_u32 v8, v7, 2, v8
    v_lshlrev_b32 v7, 4, v6
    v_sub_u32 v8, v8, v7
    s_add_u32 s78, s94, 32
    buffer_load_dwordx4 v245, s[32:35], s16 offen offset:1024  lds
    v_add_u32 v21, s78, v8
    v_add_u32 v22, 1024, v21
    v_add_u32 v23, 2048, v21
    v_add_u32 v24, 3072, v21
    buffer_load_dwordx4 v246, s[32:35], s16 offen offset:2048  lds
    v_lshl_add_u32 v7, v5, 1, v6
    v_add_u32 v7, 30, v7
    v_and_b32 v8, 1, v7
    s_add_u32 s97, s98, s0
    s_lshr_b64 s[0:1], s[0:1], 4
    s_and_b32 s97, s97, 15
    s_add_u32 m0, s87, 0
    s_lshl_b32 s97, s97, 7
    buffer_load_dwordx4 v240, s[28:31], s97 offen offset:0  lds
    v_bfe_u32 v136, v7, 1, 2
    v_lshl_add_u32 v136, v8, 2, v136
    v_lshlrev_b32 v136, 6, v136
    v_lshrrev_b32 v7, 3, v7
    buffer_load_dwordx4 v241, s[28:31], s97 offen offset:1024  lds
    v_lshl_add_u32 v136, v7, 9, v136
    v_bitop3_b32 v8, v7, 3, s3 bitop3:0x6a
    v_lshl_add_u32 v25, v8, 4, v136
    v_add_u32 v25, 92160, v25
    buffer_load_dwordx4 v242, s[28:31], s97 offen offset:2048  lds
    v_subrev_u32 v7, 1, v7
    v_bitop3_b32 v8, v7, 3, s3 bitop3:0x6a
    v_lshl_add_u32 v27, v8, 4, v136
    buffer_load_dwordx4 v243, s[28:31], s97 offen offset:3072  lds
    v_add_u32 v27, 91648, v27
    v_subrev_u32 v7, 1, v7
    v_bitop3_b32 v8, v7, 3, s3 bitop3:0x6a
    v_lshl_add_u32 v29, v8, 4, v136
    s_add_u32 m0, s88, 0
    s_mov_b64 exec, 0xffffffff
    buffer_load_dwordx4 v3, s[28:31], s97 offen offset:0  lds
    s_mov_b64 exec, -1
    v_add_u32 v29, 91136, v29
    v_subrev_u32 v7, 1, v7
    v_bitop3_b32 v8, v7, 3, s3 bitop3:0x6a
    s_waitcnt vmcnt(11)
    s_barrier
    s_mul_i32 s16, s97, 3072
    s_add_u32 m0, s60, 0
    s_add_u32 s99, s16, s62
    buffer_load_dwordx4 v244, s[32:35], s99 offen offset:0  lds
    v_lshl_add_u32 v31, v8, 4, v136
    v_add_u32 v31, 90624, v31
    v_lshl_add_u32 v7, v5, 1, v6
    v_add_u32 v7, 26, v7
    buffer_load_dwordx4 v245, s[32:35], s99 offen offset:1024  lds
    v_and_b32 v8, 1, v7
    v_bfe_u32 v136, v7, 1, 2
    v_lshl_add_u32 v136, v8, 2, v136
    v_lshlrev_b32 v136, 6, v136
    buffer_load_dwordx4 v246, s[32:35], s99 offen offset:2048  lds
    v_lshrrev_b32 v7, 3, v7
    v_lshl_add_u32 v136, v7, 9, v136
    v_bitop3_b32 v8, v7, 3, s3 bitop3:0x6a
    s_add_u32 m0, s61, 12288
    s_add_u32 s16, s16, s63
    buffer_load_dwordx4 v244, s[32:35], s16 offen offset:0  lds
    v_lshl_add_u32 v26, v8, 4, v136
    v_add_u32 v26, 92160, v26
    v_subrev_u32 v7, 1, v7
    v_bitop3_b32 v8, v7, 3, s3 bitop3:0x6a
    buffer_load_dwordx4 v245, s[32:35], s16 offen offset:1024  lds
    v_lshl_add_u32 v28, v8, 4, v136
    v_add_u32 v28, 91648, v28
    v_subrev_u32 v7, 1, v7
    v_bitop3_b32 v8, v7, 3, s3 bitop3:0x6a
    buffer_load_dwordx4 v246, s[32:35], s16 offen offset:2048  lds
    v_lshl_add_u32 v30, v8, 4, v136
    v_add_u32 v30, 91136, v30
    v_subrev_u32 v7, 1, v7
    s_add_u32 s97, s98, s0
    s_lshr_b64 s[0:1], s[0:1], 4
    s_and_b32 s97, s97, 15
    s_add_u32 m0, s87, 18432
    s_lshl_b32 s97, s97, 7
    buffer_load_dwordx4 v240, s[28:31], s97 offen offset:0  lds
    v_bitop3_b32 v8, v7, 3, s3 bitop3:0x6a
    v_lshl_add_u32 v32, v8, 4, v136
    v_add_u32 v32, 90624, v32
    v_lshrrev_b32 v7, 1, v6
    buffer_load_dwordx4 v241, s[28:31], s97 offen offset:1024  lds
    v_lshl_add_u32 v7, v5, 1, v7
    v_add_u32 v7, 32, v7
    v_and_b32 v8, 1, v7
    v_bfe_u32 v136, v7, 1, 2
    buffer_load_dwordx4 v242, s[28:31], s97 offen offset:2048  lds
    v_lshl_add_u32 v136, v8, 2, v136
    v_lshlrev_b32 v136, 6, v136
    v_lshrrev_b32 v7, 3, v7
    buffer_load_dwordx4 v243, s[28:31], s97 offen offset:3072  lds
    v_lshl_add_u32 v136, v7, 9, v136
    v_bitop3_b32 v8, v7, 3, s3 bitop3:0x6a
    v_lshl_add_u32 v20, v8, 4, v136
    v_add_u32 v20, 92160, v20
    s_add_u32 m0, s88, 18432
    s_mov_b64 exec, 0xffffffff
    buffer_load_dwordx4 v3, s[28:31], s97 offen offset:0  lds
    s_mov_b64 exec, -1
    v_and_b32 v8, 1, v6
    v_xor_b32 v8, 1, v8
    v_lshl_add_u32 v20, v8, 3, v20
    s_waitcnt vmcnt(11)
    s_barrier
    s_mul_i32 s16, s97, 3072
    s_add_u32 m0, s60, 24576
    s_add_u32 s99, s16, s62
    buffer_load_dwordx4 v244, s[32:35], s99 offen offset:0  lds
    s_waitcnt lgkmcnt(0)
    s_and_b32 s78, s92, 0xffff0000
    s_lshl_b32 s92, s92, 16
    buffer_load_dwordx4 v245, s[32:35], s99 offen offset:1024  lds
    s_bitcmp1_b32 s90, 0
    s_cselect_b32 s92, s78, s92
    v_lshlrev_b32 v7, 3, v6
    v_sub_u32 v7, v7, v5
    buffer_load_dwordx4 v246, s[32:35], s99 offen offset:2048  lds
    v_subrev_u32 v7, 9, v7
    v_and_b32 v8, 1, v7
    v_xor_b32 v8, 1, v8
    s_add_u32 m0, s61, 36864
    s_add_u32 s16, s16, s63
    buffer_load_dwordx4 v244, s[32:35], s16 offen offset:0  lds
    v_lshlrev_b32 v8, 4, v8
    v_lshrrev_b32 v8, v8, s92
    v_ashrrev_i32 v7, 1, v7
    buffer_load_dwordx4 v245, s[32:35], s16 offen offset:1024  lds
    v_cmp_eq_u32 vcc, 0, v7
    s_nop 1
    v_cndmask_b32 v236, 0, v8, vcc
    v_cmp_eq_u32 vcc, 1, v7
    buffer_load_dwordx4 v246, s[32:35], s16 offen offset:2048  lds
    s_nop 0
    v_cndmask_b32 v237, 0, v8, vcc
    v_cmp_eq_u32 vcc, 2, v7
    s_nop 1
    v_cndmask_b32 v238, 0, v8, vcc
    s_add_u32 s97, s98, s0
    s_lshr_b64 s[0:1], s[0:1], 4
    s_and_b32 s97, s97, 15
    s_add_u32 m0, s87, 36864
    s_lshl_b32 s97, s97, 7
    buffer_load_dwordx4 v240, s[28:31], s97 offen offset:0  lds
    v_cmp_eq_u32 vcc, 3, v7
    s_nop 1
    v_cndmask_b32 v239, 0, v8, vcc
    s_and_b32 s78, s77, 7
    s_mov_b32 s95, 0x76543210
    s_and_b32 s78, s76, 3
    s_mul_i32 s78, s78, 0x22222222
    s_add_u32 s95, s95, s78
    s_bfe_u32 s17, s95, 0x30000
    s_lshl_b32 s17, s17, 18
    s_bfe_u32 s18, s95, 0x30004
    s_lshl_b32 s18, s18, 18
    s_bfe_u32 s100, s95, 0x3001c
    s_lshl_b32 s100, s100, 18
    s_bfe_u32 s95, s95, 0x30018
    s_lshl_b32 s95, s95, 18
    buffer_load_dwordx4 v241, s[28:31], s97 offen offset:1024  lds
    v_lshrrev_b32 v136, 4, v0
    v_lshlrev_b32 v136, 1, v136
    v_and_b32 v137, 7, v0
    buffer_load_dwordx4 v242, s[28:31], s97 offen offset:2048  lds
    v_xor_b32 v136, v136, v137
    v_lshlrev_b32 v136, 4, v136
    v_lshrrev_b32 v137, 3, v0
    buffer_load_dwordx4 v243, s[28:31], s97 offen offset:3072  lds
    v_lshl_add_u32 v136, v137, 11, v136
    s_lshl_b32 s78, s77, 7
    s_lshl_b32 s79, s3, 14
    s_add_u32 m0, s88, 36864
    s_mov_b64 exec, 0xffffffff
    buffer_load_dwordx4 v3, s[28:31], s97 offen offset:0  lds
    s_mov_b64 exec, -1
    s_add_u32 s78, s78, s79
    v_add_u32 v17, s78, v136
    s_waitcnt vmcnt(11)
    s_barrier
    s_mul_i32 s16, s97, 3072
    s_add_u32 m0, s60, 49152
    s_add_u32 s99, s16, s62
    buffer_load_dwordx4 v244, s[32:35], s99 offen offset:0  lds
    v_add_u32 v5, s94, v15
    ds_read_b128 v[140:143], v5 offset:32
    ds_read_b32 v156, v5 offset:48
    ds_read_b128 v[144:147], v5 offset:1056
    buffer_load_dwordx4 v245, s[32:35], s99 offen offset:1024  lds
    ds_read_b32 v157, v5 offset:1072
    ds_read_b128 v[148:151], v5 offset:2080
    ds_read_b32 v158, v5 offset:2096
    ds_read_b128 v[152:155], v5 offset:3104
    buffer_load_dwordx4 v246, s[32:35], s99 offen offset:2048  lds
    ds_read_b32 v159, v5 offset:3120
    v_lshrrev_b32 v6, 3, v0
    v_mul_u32_u24 v6, 4160, v6
    s_add_u32 m0, s61, 61440
    s_add_u32 s16, s16, s63
    buffer_load_dwordx4 v244, s[32:35], s16 offen offset:0  lds
    v_and_b32 v7, 7, v0
    v_lshl_add_u32 v6, v7, 2, v6
    v_add_u32 v6, s94, v6
    v_mov_b32 v7, 0
    buffer_load_dwordx4 v245, s[32:35], s16 offen offset:1024  lds
    s_waitcnt lgkmcnt(0)
    v_readfirstlane_b32 s93, v140
    s_nop 0
    s_lshl_b32 s93, s93, 16
    s_nop 1
    v_writelane_b32 v7, s93, 15
    buffer_load_dwordx4 v246, s[32:35], s16 offen offset:2048  lds
    v_alignbit_b32 v140, v141, v140, 16
    v_alignbit_b32 v141, v142, v141, 16
    v_alignbit_b32 v142, v143, v142, 16
    s_add_u32 s97, s98, s0
    s_lshr_b64 s[0:1], s[0:1], 4
    s_and_b32 s97, s97, 15
    s_add_u32 m0, s87, 0
    s_lshl_b32 s97, s97, 7
    buffer_load_dwordx4 v240, s[28:31], s97 offen offset:0  lds
    v_alignbit_b32 v143, v156, v143, 16
    v_alignbit_b32 v144, v145, v144, 16
    v_alignbit_b32 v145, v146, v145, 16
    v_alignbit_b32 v146, v147, v146, 16
    buffer_load_dwordx4 v241, s[28:31], s97 offen offset:1024  lds
    v_alignbit_b32 v147, v157, v147, 16
    v_alignbit_b32 v148, v149, v148, 16
    v_alignbit_b32 v149, v150, v149, 16
    v_alignbit_b32 v150, v151, v150, 16
    buffer_load_dwordx4 v242, s[28:31], s97 offen offset:2048  lds
    v_alignbit_b32 v151, v158, v151, 16
    v_alignbit_b32 v152, v153, v152, 16
    v_alignbit_b32 v153, v154, v153, 16
    buffer_load_dwordx4 v243, s[28:31], s97 offen offset:3072  lds
    v_alignbit_b32 v154, v155, v154, 16
    v_alignbit_b32 v155, v159, v155, 16
    v_lshlrev_b32 v8, 3, v0
    s_add_u32 s78, s88, 18432
    s_add_u32 m0, s88, 0
    s_mov_b64 exec, 0xffffffff
    buffer_load_dwordx4 v3, s[28:31], s97 offen offset:0  lds
    s_mov_b64 exec, -1
    v_add_u32 v8, s78, v8
    v_mov_b32 v156, 0
    v_mov_b32 v157, 0
    s_waitcnt vmcnt(11)
    s_barrier
    s_mul_i32 s16, s97, 3072
    s_add_u32 m0, s60, 0
    s_add_u32 s99, s16, s62
    buffer_load_dwordx4 v244, s[32:35], s99 offen offset:0  lds
    buffer_load_dwordx4 v245, s[32:35], s99 offen offset:1024  lds
    buffer_load_dwordx4 v246, s[32:35], s99 offen offset:2048  lds
    s_add_u32 m0, s61, 12288
    s_add_u32 s16, s16, s63
    buffer_load_dwordx4 v244, s[32:35], s16 offen offset:0  lds
    buffer_load_dwordx4 v245, s[32:35], s16 offen offset:1024  lds
    buffer_load_dwordx4 v246, s[32:35], s16 offen offset:2048  lds
    s_mov_b64 exec, 0xff
    buffer_load_dword v136, v33, s[68:71], 0 offen sc1
    buffer_load_dword v137, v34, s[52:55], 0 offen sc1
    s_mov_b64 exec, -1
    buffer_load_dwordx4 v[212:215], v9, s[56:59], 0 offen offset:0 nt
    buffer_load_dwordx4 v[216:219], v9, s[56:59], 0 offen offset:2048 nt
    buffer_load_dwordx4 v[220:223], v9, s[56:59], s96 offen offset:0 nt
    buffer_load_dwordx4 v[224:227], v9, s[56:59], s96 offen offset:2048 nt
    s_waitcnt vmcnt(12)
    s_waitcnt vmcnt(6)
    s_barrier
    s_waitcnt vmcnt(4)
    s_branch LA_j
LA_c2:
    s_waitcnt vmcnt(8)
    s_barrier
    buffer_load_dwordx4 v242, s[28:31], s97 offen offset:2048  lds
    buffer_load_dwordx4 v243, s[28:31], s97 offen offset:3072  lds
    s_add_u32 m0, s88, 36864
    s_mov_b64 exec, 0xffffffff
    buffer_load_dwordx4 v3, s[28:31], s97 offen offset:0  lds
    s_mov_b64 exec, -1
    s_mul_i32 s16, s97, 3072
    s_add_u32 m0, s60, 49152
    s_add_u32 s99, s16, s62
    buffer_load_dwordx4 v244, s[32:35], s99 offen offset:0  lds
    buffer_load_dwordx4 v245, s[32:35], s99 offen offset:1024  lds
    buffer_load_dwordx4 v246, s[32:35], s99 offen offset:2048  lds
    s_add_u32 m0, s61, 61440
    s_add_u32 s16, s16, s63
    buffer_load_dwordx4 v244, s[32:35], s16 offen offset:0  lds
    buffer_load_dwordx4 v245, s[32:35], s16 offen offset:1024  lds
    buffer_load_dwordx4 v246, s[32:35], s16 offen offset:2048  lds
    s_add_u32 s97, s98, s0
    s_lshr_b64 s[0:1], s[0:1], 4
    s_and_b32 s97, s97, 15
    s_add_u32 m0, s87, 0
    s_lshl_b32 s97, s97, 7
    buffer_load_dwordx4 v240, s[28:31], s97 offen offset:0  lds
    buffer_load_dwordx4 v241, s[28:31], s97 offen offset:1024  lds
    buffer_load_dwordx4 v242, s[28:31], s97 offen offset:2048  lds
    buffer_load_dwordx4 v243, s[28:31], s97 offen offset:3072  lds
    s_add_u32 m0, s88, 0
    s_mov_b64 exec, 0xffffffff
    buffer_load_dwordx4 v3, s[28:31], s97 offen offset:0  lds
    s_mov_b64 exec, -1
    s_waitcnt vmcnt(11)
    s_barrier
    s_mul_i32 s16, s97, 3072
    s_add_u32 m0, s60, 0
    s_add_u32 s99, s16, s62
    buffer_load_dwordx4 v244, s[32:35], s99 offen offset:0  lds
    buffer_load_dwordx4 v245, s[32:35], s99 offen offset:1024  lds
    buffer_load_dwordx4 v246, s[32:35], s99 offen offset:2048  lds
    s_add_u32 m0, s61, 12288
    s_add_u32 s16, s16, s63
    buffer_load_dwordx4 v244, s[32:35], s16 offen offset:0  lds
    buffer_load_dwordx4 v245, s[32:35], s16 offen offset:1024  lds
    buffer_load_dwordx4 v246, s[32:35], s16 offen offset:2048  lds
    s_add_u32 s97, s98, s0
    s_lshr_b64 s[0:1], s[0:1], 4
    s_and_b32 s97, s97, 15
    s_add_u32 m0, s87, 18432
    s_lshl_b32 s97, s97, 7
    buffer_load_dwordx4 v240, s[28:31], s97 offen offset:0  lds
    buffer_load_dwordx4 v241, s[28:31], s97 offen offset:1024  lds
    buffer_load_dwordx4 v242, s[28:31], s97 offen offset:2048  lds
    buffer_load_dwordx4 v243, s[28:31], s97 offen offset:3072  lds
    s_add_u32 m0, s88, 18432
    s_mov_b64 exec, 0xffffffff
    buffer_load_dwordx4 v3, s[28:31], s97 offen offset:0  lds
    s_mov_b64 exec, -1
    s_waitcnt vmcnt(11)
    s_barrier
    s_mul_i32 s16, s97, 3072
    s_add_u32 m0, s60, 24576
    s_add_u32 s99, s16, s62
    buffer_load_dwordx4 v244, s[32:35], s99 offen offset:0  lds
    buffer_load_dwordx4 v245, s[32:35], s99 offen offset:1024  lds
    buffer_load_dwordx4 v246, s[32:35], s99 offen offset:2048  lds
    s_add_u32 m0, s61, 36864
    s_add_u32 s16, s16, s63
    buffer_load_dwordx4 v244, s[32:35], s16 offen offset:0  lds
    buffer_load_dwordx4 v245, s[32:35], s16 offen offset:1024  lds
    buffer_load_dwordx4 v246, s[32:35], s16 offen offset:2048  lds
    s_add_u32 m0, s86, 129536
    s_mov_b32 s89, 0
    buffer_load_dwordx4 v10, s[36:39], s89 offen nt lds
    s_add_u32 m0, s86, 145920
    s_mov_b32 s89, 0
    buffer_load_dwordx4 v10, s[40:43], s89 offen nt lds
    s_add_u32 m0, s86, 133632
    s_mov_b32 s89, 65536
    buffer_load_dwordx4 v10, s[36:39], s89 offen nt lds
    s_add_u32 m0, s86, 150016
    s_mov_b32 s89, 65536
    buffer_load_dwordx4 v10, s[40:43], s89 offen nt lds
    s_add_u32 m0, s86, 137728
    s_mov_b32 s89, 131072
    buffer_load_dwordx4 v10, s[36:39], s89 offen nt lds
    s_add_u32 m0, s86, 154112
    s_mov_b32 s89, 131072
    buffer_load_dwordx4 v10, s[40:43], s89 offen nt lds
    s_add_u32 m0, s86, 141824
    s_mov_b32 s89, 196608
    buffer_load_dwordx4 v10, s[36:39], s89 offen nt lds
    s_add_u32 m0, s86, 158208
    s_mov_b32 s89, 196608
    buffer_load_dwordx4 v10, s[40:43], s89 offen nt lds
    s_mov_b64 exec, 0xff
    s_lshl_b32 s82, s3, 7
    s_add_u32 m0, s82, 129024
    s_mov_b32 s89, 0
    buffer_load_dwordx4 v11, s[36:39], s89 offen nt lds
    s_lshl_b32 s83, s74, 9
    s_add_u32 s83, s83, s82
    s_and_b32 s89, s3, 2
    s_lshl_b32 s89, s89, 3
    s_add_u32 s82, s82, s89
    s_add_u32 m0, s82, 162816
    s_add_u32 s89, s83, 0
    buffer_load_dwordx4 v15, s[44:47], s89 offen  lds
    s_mov_b64 exec, -1
    s_add_u32 s97, s98, s0
    s_lshr_b64 s[0:1], s[0:1], 4
    s_and_b32 s97, s97, 15
    s_add_u32 m0, s87, 36864
    s_lshl_b32 s97, s97, 7
    buffer_load_dwordx4 v240, s[28:31], s97 offen offset:0  lds
    s_waitcnt vmcnt(17)
    s_barrier
    buffer_load_dwordx4 v241, s[28:31], s97 offen offset:1024  lds
    buffer_load_dwordx4 v242, s[28:31], s97 offen offset:2048  lds
    buffer_load_dwordx4 v243, s[28:31], s97 offen offset:3072  lds
    s_add_u32 m0, s88, 36864
    s_mov_b64 exec, 0xffffffff
    buffer_load_dwordx4 v3, s[28:31], s97 offen offset:0  lds
    s_mov_b64 exec, -1
    s_mul_i32 s16, s97, 3072
    s_add_u32 m0, s60, 49152
    s_add_u32 s99, s16, s62
    buffer_load_dwordx4 v244, s[32:35], s99 offen offset:0  lds
    buffer_load_dwordx4 v245, s[32:35], s99 offen offset:1024  lds
    buffer_load_dwordx4 v246, s[32:35], s99 offen offset:2048  lds
    s_add_u32 m0, s61, 61440
    s_add_u32 s16, s16, s63
    buffer_load_dwordx4 v244, s[32:35], s16 offen offset:0  lds
    buffer_load_dwordx4 v245, s[32:35], s16 offen offset:1024  lds
    buffer_load_dwordx4 v246, s[32:35], s16 offen offset:2048  lds
    s_add_u32 s97, s98, s0
    s_lshr_b64 s[0:1], s[0:1], 4
    s_and_b32 s97, s97, 15
    s_add_u32 m0, s87, 0
    s_lshl_b32 s97, s97, 7
    buffer_load_dwordx4 v240, s[28:31], s97 offen offset:0  lds
    buffer_load_dwordx4 v241, s[28:31], s97 offen offset:1024  lds
    buffer_load_dwordx4 v242, s[28:31], s97 offen offset:2048  lds
    buffer_load_dwordx4 v243, s[28:31], s97 offen offset:3072  lds
    s_add_u32 m0, s88, 0
    s_mov_b64 exec, 0xffffffff
    buffer_load_dwordx4 v3, s[28:31], s97 offen offset:0  lds
    s_mov_b64 exec, -1
    s_waitcnt vmcnt(11)
    s_barrier
    s_mul_i32 s16, s97, 3072
    s_add_u32 m0, s60, 0
    s_add_u32 s99, s16, s62
    buffer_load_dwordx4 v244, s[32:35], s99 offen offset:0  lds
    ds_read_b128 v[84:87], v35 offset:0
    ds_read_b128 v[88:91], v35 offset:16
    buffer_load_dwordx4 v245, s[32:35], s99 offen offset:1024  lds
    ds_read_b64 v[40:41], v16 offset:0
    ds_read_b64 v[42:43], v231 offset:256
    buffer_load_dwordx4 v246, s[32:35], s99 offen offset:2048  lds
    ds_read_b64 v[44:45], v16 offset:256
    ds_read_b64 v[46:47], v16 offset:512
    s_add_u32 m0, s61, 12288
    s_add_u32 s16, s16, s63
    buffer_load_dwordx4 v244, s[32:35], s16 offen offset:0  lds
    ds_read_b64 v[48:49], v231 offset:512
    ds_read_b64 v[50:51], v16 offset:768
    buffer_load_dwordx4 v245, s[32:35], s16 offen offset:1024  lds
    ds_read_b64 v[52:53], v231 offset:768
    ds_read_b64 v[54:55], v16 offset:1024
    buffer_load_dwordx4 v246, s[32:35], s16 offen offset:2048  lds
    ds_read_b64 v[56:57], v231 offset:1024
    ds_read_b64 v[58:59], v16 offset:1280
    s_add_u32 s97, s98, s0
    s_lshr_b64 s[0:1], s[0:1], 4
    s_and_b32 s97, s97, 15
    s_add_u32 m0, s87, 18432
    s_lshl_b32 s97, s97, 7
    buffer_load_dwordx4 v240, s[28:31], s97 offen offset:0  lds
    ds_read_b64 v[60:61], v231 offset:1280
    ds_read_b64 v[68:69], v16 offset:16896
    buffer_load_dwordx4 v241, s[28:31], s97 offen offset:1024  lds
    ds_read_b64 v[70:71], v231 offset:16896
    ds_read_b64 v[72:73], v16 offset:17152
    buffer_load_dwordx4 v242, s[28:31], s97 offen offset:2048  lds
    ds_read_b64 v[74:75], v231 offset:17152
    ds_read_b64 v[76:77], v16 offset:17408
    buffer_load_dwordx4 v243, s[28:31], s97 offen offset:3072  lds
    ds_read_b64 v[78:79], v231 offset:17408
    ds_read_b64 v[80:81], v16 offset:17664
    s_add_u32 m0, s88, 18432
    s_mov_b64 exec, 0xffffffff
    buffer_load_dwordx4 v3, s[28:31], s97 offen offset:0  lds
    s_mov_b64 exec, -1
    ds_read_b64 v[82:83], v231 offset:17664
    s_waitcnt vmcnt(11)
    s_waitcnt lgkmcnt(0)
    s_barrier
    s_mul_i32 s16, s97, 3072
    s_add_u32 m0, s60, 24576
    s_add_u32 s99, s16, s62
    buffer_load_dwordx4 v244, s[32:35], s99 offen offset:0  lds
    v_lshlrev_b32 v160, 16, v40
    v_lshlrev_b32 v161, 16, v42
    v_lshlrev_b32 v162, 16, v44
    v_lshlrev_b32 v163, 16, v46
    v_lshlrev_b32 v164, 16, v48
    buffer_load_dwordx4 v245, s[32:35], s99 offen offset:1024  lds
    v_lshlrev_b32 v165, 16, v50
    v_lshlrev_b32 v166, 16, v52
    v_lshlrev_b32 v167, 16, v54
    v_lshlrev_b32 v168, 16, v56
    v_lshlrev_b32 v169, 16, v58
    buffer_load_dwordx4 v246, s[32:35], s99 offen offset:2048  lds
    v_lshlrev_b32 v170, 16, v60
    v_lshlrev_b32 v172, 16, v84
    v_and_b32 v173, 0xffff0000, v84
    v_lshlrev_b32 v174, 16, v85
    v_and_b32 v175, 0xffff0000, v85
    s_add_u32 m0, s61, 36864
    s_add_u32 s16, s16, s63
    buffer_load_dwordx4 v244, s[32:35], s16 offen offset:0  lds
    v_lshlrev_b32 v176, 16, v68
    v_lshlrev_b32 v177, 16, v70
    v_lshlrev_b32 v178, 16, v72
    v_lshlrev_b32 v179, 16, v74
    v_lshlrev_b32 v180, 16, v76
    buffer_load_dwordx4 v245, s[32:35], s16 offen offset:1024  lds
    v_lshlrev_b32 v181, 16, v78
    v_lshlrev_b32 v182, 16, v80
    v_lshlrev_b32 v183, 16, v82
    v_mul_f32 v184, v160, v175
    v_mul_f32 v185, v161, v175
    buffer_load_dwordx4 v246, s[32:35], s16 offen offset:2048  lds
    v_mul_f32 v186, v162, v175
    v_mul_f32 v187, v163, v175
    v_mul_f32 v188, v164, v175
    v_mul_f32 v189, v165, v175
    v_mul_f32 v190, v166, v175
    s_add_u32 s97, s98, s0
    s_lshr_b64 s[0:1], s[0:1], 4
    s_and_b32 s97, s97, 15
    s_add_u32 m0, s87, 36864
    s_lshl_b32 s97, s97, 7
    buffer_load_dwordx4 v240, s[28:31], s97 offen offset:0  lds
    v_mul_f32 v191, v167, v175
    v_fmac_f32 v184, v161, v174
    v_fmac_f32 v185, v162, v174
    v_fmac_f32 v186, v163, v174
    v_fmac_f32 v187, v164, v174
    buffer_load_dwordx4 v241, s[28:31], s97 offen offset:1024  lds
    v_fmac_f32 v188, v165, v174
    v_fmac_f32 v189, v166, v174
    v_fmac_f32 v190, v167, v174
    v_fmac_f32 v191, v168, v174
    v_fmac_f32 v184, v162, v173
    buffer_load_dwordx4 v242, s[28:31], s97 offen offset:2048  lds
    v_fmac_f32 v185, v163, v173
    v_fmac_f32 v186, v164, v173
    v_fmac_f32 v187, v165, v173
    v_fmac_f32 v188, v166, v173
    v_fmac_f32 v189, v167, v173
    buffer_load_dwordx4 v243, s[28:31], s97 offen offset:3072  lds
    v_fmac_f32 v190, v168, v173
    v_fmac_f32 v191, v169, v173
    v_fmac_f32 v184, v163, v172
    v_fmac_f32 v185, v164, v172
    v_fmac_f32 v186, v165, v172
    s_add_u32 m0, s88, 36864
    s_mov_b64 exec, 0xffffffff
    buffer_load_dwordx4 v3, s[28:31], s97 offen offset:0  lds
    s_mov_b64 exec, -1
    v_fmac_f32 v187, v166, v172
    v_fmac_f32 v188, v167, v172
    v_fmac_f32 v189, v168, v172
    v_fmac_f32 v190, v169, v172
    v_fmac_f32 v191, v170, v172
    v_mul_f32 v184, v184, v176
    v_mul_f32 v185, v185, v177
    v_mul_f32 v186, v186, v178
    v_mul_f32 v187, v187, v179
    v_mul_f32 v188, v188, v180
    v_mul_f32 v189, v189, v181
    v_mul_f32 v190, v190, v182
    v_mul_f32 v191, v191, v183
    v_cvt_pk_bf16_f32 v100, v191, v190
    v_cvt_pk_bf16_f32 v101, v189, v188
    v_cvt_pk_bf16_f32 v102, v187, v186
    v_cvt_pk_bf16_f32 v103, v185, v184
    s_mov_b32 s89, 0
    buffer_store_dwordx4 v[100:103], v12, s[52:55], s89 offen sc1
    v_and_b32 v160, 0xffff0000, v40
    v_and_b32 v161, 0xffff0000, v42
    v_and_b32 v162, 0xffff0000, v44
    v_and_b32 v163, 0xffff0000, v46
    v_and_b32 v164, 0xffff0000, v48
    v_and_b32 v165, 0xffff0000, v50
    v_and_b32 v166, 0xffff0000, v52
    v_and_b32 v167, 0xffff0000, v54
    v_and_b32 v168, 0xffff0000, v56
    v_and_b32 v169, 0xffff0000, v58
    v_and_b32 v170, 0xffff0000, v60
    v_lshlrev_b32 v172, 16, v86
    v_and_b32 v173, 0xffff0000, v86
    v_lshlrev_b32 v174, 16, v87
    v_and_b32 v175, 0xffff0000, v87
    v_and_b32 v176, 0xffff0000, v68
    v_and_b32 v177, 0xffff0000, v70
    v_and_b32 v178, 0xffff0000, v72
    v_and_b32 v179, 0xffff0000, v74
    v_and_b32 v180, 0xffff0000, v76
    v_and_b32 v181, 0xffff0000, v78
    v_and_b32 v182, 0xffff0000, v80
    v_and_b32 v183, 0xffff0000, v82
    s_waitcnt vmcnt(12)
    s_barrier
    s_mul_i32 s16, s97, 3072
    s_add_u32 m0, s60, 49152
    s_add_u32 s99, s16, s62
    buffer_load_dwordx4 v244, s[32:35], s99 offen offset:0  lds
    v_mul_f32 v184, v160, v175
    v_mul_f32 v185, v161, v175
    v_mul_f32 v186, v162, v175
    v_mul_f32 v187, v163, v175
    v_mul_f32 v188, v164, v175
    buffer_load_dwordx4 v245, s[32:35], s99 offen offset:1024  lds
    v_mul_f32 v189, v165, v175
    v_mul_f32 v190, v166, v175
    v_mul_f32 v191, v167, v175
    v_fmac_f32 v184, v161, v174
    v_fmac_f32 v185, v162, v174
    buffer_load_dwordx4 v246, s[32:35], s99 offen offset:2048  lds
    v_fmac_f32 v186, v163, v174
    v_fmac_f32 v187, v164, v174
    v_fmac_f32 v188, v165, v174
    v_fmac_f32 v189, v166, v174
    v_fmac_f32 v190, v167, v174
    s_add_u32 m0, s61, 61440
    s_add_u32 s16, s16, s63
    buffer_load_dwordx4 v244, s[32:35], s16 offen offset:0  lds
    v_fmac_f32 v191, v168, v174
    v_fmac_f32 v184, v162, v173
    v_fmac_f32 v185, v163, v173
    v_fmac_f32 v186, v164, v173
    v_fmac_f32 v187, v165, v173
    buffer_load_dwordx4 v245, s[32:35], s16 offen offset:1024  lds
    v_fmac_f32 v188, v166, v173
    v_fmac_f32 v189, v167, v173
    v_fmac_f32 v190, v168, v173
    v_fmac_f32 v191, v169, v173
    v_fmac_f32 v184, v163, v172
    buffer_load_dwordx4 v246, s[32:35], s16 offen offset:2048  lds
    v_fmac_f32 v185, v164, v172
    v_fmac_f32 v186, v165, v172
    v_fmac_f32 v187, v166, v172
    v_fmac_f32 v188, v167, v172
    v_fmac_f32 v189, v168, v172
    s_add_u32 s97, s98, s0
    s_lshr_b64 s[0:1], s[0:1], 4
    s_and_b32 s97, s97, 15
    s_add_u32 m0, s87, 0
    s_lshl_b32 s97, s97, 7
    buffer_load_dwordx4 v240, s[28:31], s97 offen offset:0  lds
    v_fmac_f32 v190, v169, v172
    v_fmac_f32 v191, v170, v172
    v_mul_f32 v184, v184, v176
    v_mul_f32 v185, v185, v177
    v_mul_f32 v186, v186, v178
    buffer_load_dwordx4 v241, s[28:31], s97 offen offset:1024  lds
    v_mul_f32 v187, v187, v179
    v_mul_f32 v188, v188, v180
    v_mul_f32 v189, v189, v181
    v_mul_f32 v190, v190, v182
    v_mul_f32 v191, v191, v183
    buffer_load_dwordx4 v242, s[28:31], s97 offen offset:2048  lds
    v_cvt_pk_bf16_f32 v104, v191, v190
    v_cvt_pk_bf16_f32 v105, v189, v188
    v_cvt_pk_bf16_f32 v106, v187, v186
    v_cvt_pk_bf16_f32 v107, v185, v184
    s_mov_b32 s89, 16384
    buffer_store_dwordx4 v[104:107], v12, s[52:55], s89 offen sc1
    buffer_load_dwordx4 v243, s[28:31], s97 offen offset:3072  lds
    v_lshlrev_b32 v160, 16, v41
    v_lshlrev_b32 v161, 16, v43
    v_lshlrev_b32 v162, 16, v45
    v_lshlrev_b32 v163, 16, v47
    v_lshlrev_b32 v164, 16, v49
    s_add_u32 m0, s88, 0
    s_mov_b64 exec, 0xffffffff
    buffer_load_dwordx4 v3, s[28:31], s97 offen offset:0  lds
    s_mov_b64 exec, -1
    v_lshlrev_b32 v165, 16, v51
    v_lshlrev_b32 v166, 16, v53
    v_lshlrev_b32 v167, 16, v55
    v_lshlrev_b32 v168, 16, v57
    v_lshlrev_b32 v169, 16, v59
    v_lshlrev_b32 v170, 16, v61
    v_lshlrev_b32 v172, 16, v88
    v_and_b32 v173, 0xffff0000, v88
    v_lshlrev_b32 v174, 16, v89
    v_and_b32 v175, 0xffff0000, v89
    v_lshlrev_b32 v176, 16, v69
    v_lshlrev_b32 v177, 16, v71
    v_lshlrev_b32 v178, 16, v73
    v_lshlrev_b32 v179, 16, v75
    v_lshlrev_b32 v180, 16, v77
    v_lshlrev_b32 v181, 16, v79
    v_lshlrev_b32 v182, 16, v81
    v_lshlrev_b32 v183, 16, v83
    v_mul_f32 v184, v160, v175
    v_mul_f32 v185, v161, v175
    v_mul_f32 v186, v162, v175
    v_mul_f32 v187, v163, v175
    v_mul_f32 v188, v164, v175
    v_mul_f32 v189, v165, v175
    v_mul_f32 v190, v166, v175
    v_mul_f32 v191, v167, v175
    v_fmac_f32 v184, v161, v174
    v_fmac_f32 v185, v162, v174
    v_fmac_f32 v186, v163, v174
    v_fmac_f32 v187, v164, v174
    v_fmac_f32 v188, v165, v174
    v_fmac_f32 v189, v166, v174
    v_fmac_f32 v190, v167, v174
    v_fmac_f32 v191, v168, v174
    v_fmac_f32 v184, v162, v173
    v_fmac_f32 v185, v163, v173
    v_fmac_f32 v186, v164, v173
    v_fmac_f32 v187, v165, v173
    v_fmac_f32 v188, v166, v173
    v_fmac_f32 v189, v167, v173
    v_fmac_f32 v190, v168, v173
    s_waitcnt vmcnt(13)
    s_barrier
    s_mul_i32 s16, s97, 3072
    s_add_u32 m0, s60, 0
    s_add_u32 s99, s16, s62
    buffer_load_dwordx4 v244, s[32:35], s99 offen offset:0  lds
    v_fmac_f32 v191, v169, v173
    v_fmac_f32 v184, v163, v172
    v_fmac_f32 v185, v164, v172
    v_fmac_f32 v186, v165, v172
    v_fmac_f32 v187, v166, v172
    buffer_load_dwordx4 v245, s[32:35], s99 offen offset:1024  lds
    v_fmac_f32 v188, v167, v172
    v_fmac_f32 v189, v168, v172
    v_fmac_f32 v190, v169, v172
    v_fmac_f32 v191, v170, v172
    v_mul_f32 v184, v184, v176
    buffer_load_dwordx4 v246, s[32:35], s99 offen offset:2048  lds
    v_mul_f32 v185, v185, v177
    v_mul_f32 v186, v186, v178
    v_mul_f32 v187, v187, v179
    v_mul_f32 v188, v188, v180
    v_mul_f32 v189, v189, v181
    s_add_u32 m0, s61, 12288
    s_add_u32 s16, s16, s63
    buffer_load_dwordx4 v244, s[32:35], s16 offen offset:0  lds
    v_mul_f32 v190, v190, v182
    v_mul_f32 v191, v191, v183
    v_cvt_pk_bf16_f32 v108, v191, v190
    v_cvt_pk_bf16_f32 v109, v189, v188
    v_cvt_pk_bf16_f32 v110, v187, v186
    buffer_load_dwordx4 v245, s[32:35], s16 offen offset:1024  lds
    v_cvt_pk_bf16_f32 v111, v185, v184
    s_mov_b32 s89, 32768
    buffer_store_dwordx4 v[108:111], v12, s[52:55], s89 offen sc1
    v_and_b32 v160, 0xffff0000, v41
    v_and_b32 v161, 0xffff0000, v43
    v_and_b32 v162, 0xffff0000, v45
    buffer_load_dwordx4 v246, s[32:35], s16 offen offset:2048  lds
    v_and_b32 v163, 0xffff0000, v47
    v_and_b32 v164, 0xffff0000, v49
    v_and_b32 v165, 0xffff0000, v51
    v_and_b32 v166, 0xffff0000, v53
    v_and_b32 v167, 0xffff0000, v55
    s_add_u32 s97, s98, s0
    s_lshr_b64 s[0:1], s[0:1], 4
    s_and_b32 s97, s97, 15
    s_add_u32 m0, s87, 18432
    s_lshl_b32 s97, s97, 7
    buffer_load_dwordx4 v240, s[28:31], s97 offen offset:0  lds
    v_and_b32 v168, 0xffff0000, v57
    v_and_b32 v169, 0xffff0000, v59
    v_and_b32 v170, 0xffff0000, v61
    v_lshlrev_b32 v172, 16, v90
    v_and_b32 v173, 0xffff0000, v90
    buffer_load_dwordx4 v241, s[28:31], s97 offen offset:1024  lds
    v_lshlrev_b32 v174, 16, v91
    v_and_b32 v175, 0xffff0000, v91
    v_and_b32 v176, 0xffff0000, v69
    v_and_b32 v177, 0xffff0000, v71
    v_and_b32 v178, 0xffff0000, v73
    buffer_load_dwordx4 v242, s[28:31], s97 offen offset:2048  lds
    v_and_b32 v179, 0xffff0000, v75
    v_and_b32 v180, 0xffff0000, v77
    v_and_b32 v181, 0xffff0000, v79
    v_and_b32 v182, 0xffff0000, v81
    v_and_b32 v183, 0xffff0000, v83
    buffer_load_dwordx4 v243, s[28:31], s97 offen offset:3072  lds
    v_mul_f32 v184, v160, v175
    v_mul_f32 v185, v161, v175
    v_mul_f32 v186, v162, v175
    v_mul_f32 v187, v163, v175
    v_mul_f32 v188, v164, v175
    s_add_u32 m0, s88, 18432
    s_mov_b64 exec, 0xffffffff
    buffer_load_dwordx4 v3, s[28:31], s97 offen offset:0  lds
    s_mov_b64 exec, -1
    v_mul_f32 v189, v165, v175
    v_mul_f32 v190, v166, v175
    v_mul_f32 v191, v167, v175
    v_fmac_f32 v184, v161, v174
    v_fmac_f32 v185, v162, v174
    v_fmac_f32 v186, v163, v174
    v_fmac_f32 v187, v164, v174
    v_fmac_f32 v188, v165, v174
    v_fmac_f32 v189, v166, v174
    v_fmac_f32 v190, v167, v174
    v_fmac_f32 v191, v168, v174
    v_fmac_f32 v184, v162, v173
    v_fmac_f32 v185, v163, v173
    v_fmac_f32 v186, v164, v173
    v_fmac_f32 v187, v165, v173
    v_fmac_f32 v188, v166, v173
    v_fmac_f32 v189, v167, v173
    v_fmac_f32 v190, v168, v173
    v_fmac_f32 v191, v169, v173
    v_fmac_f32 v184, v163, v172
    v_fmac_f32 v185, v164, v172
    v_fmac_f32 v186, v165, v172
    v_fmac_f32 v187, v166, v172
    v_fmac_f32 v188, v167, v172
    v_fmac_f32 v189, v168, v172
    v_fmac_f32 v190, v169, v172
    v_fmac_f32 v191, v170, v172
    v_mul_f32 v184, v184, v176
    v_mul_f32 v185, v185, v177
    v_mul_f32 v186, v186, v178
    v_mul_f32 v187, v187, v179
    v_mul_f32 v188, v188, v180
    v_mul_f32 v189, v189, v181
    v_mul_f32 v190, v190, v182
    v_mul_f32 v191, v191, v183
    v_cvt_pk_bf16_f32 v112, v191, v190
    v_cvt_pk_bf16_f32 v113, v189, v188
    v_cvt_pk_bf16_f32 v114, v187, v186
    v_cvt_pk_bf16_f32 v115, v185, v184
    s_mov_b32 s89, 49152
    buffer_store_dwordx4 v[112:115], v12, s[52:55], s89 offen sc1
    s_waitcnt vmcnt(13)
    s_barrier
    s_mul_i32 s16, s97, 3072
    s_add_u32 m0, s60, 24576
    s_add_u32 s99, s16, s62
    buffer_load_dwordx4 v244, s[32:35], s99 offen offset:0  lds
    s_mov_b32 s68, s24
    s_mov_b32 s69, s25
    s_mov_b32 s70, 0x100
    s_mov_b32 s71, 0x20000
    buffer_load_dwordx4 v245, s[32:35], s99 offen offset:1024  lds
    v_lshrrev_b32 v6, 5, v0
    v_and_b32 v7, 3, v0
    s_lshr_b32 s78, s90, 1
    s_lshl_b32 s78, s78, 2
    buffer_load_dwordx4 v246, s[32:35], s99 offen offset:2048  lds
    s_load_dword s92, s[14:15], s78
    v_bfe_u32 v5, v0, 2, 2
    v_lshlrev_b32 v5, 1, v5
    s_add_u32 m0, s61, 36864
    s_add_u32 s16, s16, s63
    buffer_load_dwordx4 v244, s[32:35], s16 offen offset:0  lds
    v_lshl_add_u32 v5, v6, 3, v5
    v_bfe_u32 v8, v0, 4, 1
    v_add_u32 v5, v5, v8
    s_and_b32 s78, s3, 1
    buffer_load_dwordx4 v245, s[32:35], s16 offen offset:1024  lds
    s_lshl_b32 s78, s78, 1
    v_add_u32 v8, s78, v6
    v_xor_b32 v8, v8, v7
    v_lshlrev_b32 v8, 4, v8
    buffer_load_dwordx4 v246, s[32:35], s16 offen offset:2048  lds
    v_lshl_add_u32 v5, v5, 6, v8
    v_add_u32 v14, s86, v5
    v_mov_b32 v18, 162304
    s_add_u32 s97, s98, s0
    s_lshr_b64 s[0:1], s[0:1], 4
    s_and_b32 s97, s97, 15
    s_add_u32 m0, s87, 36864
    s_lshl_b32 s97, s97, 7
    buffer_load_dwordx4 v240, s[28:31], s97 offen offset:0  lds
    v_mov_b32 v19, 1
    v_and_b32 v5, 3, v0
    s_lshl_b32 s78, s74, 4
    s_add_u32 s78, s78, s3
    buffer_load_dwordx4 v241, s[28:31], s97 offen offset:1024  lds
    v_lshl_add_u32 v6, v5, 2, s78
    s_lshr_b32 s78, s76, 3
    s_lshl_b32 s79, s3, 1
    s_add_u32 s78, s78, s79
    buffer_load_dwordx4 v242, s[28:31], s97 offen offset:2048  lds
    s_xor_b32 s78, s78, 2
    s_lshl_b32 s78, s78, 5
    s_add_u32 s79, s76, 5
    buffer_load_dwordx4 v243, s[28:31], s97 offen offset:3072  lds
    s_and_b32 s79, s79, 7
    s_lshl_b32 s79, s79, 1
    s_add_u32 s78, s78, s79
    v_mul_u32_u24 v7, 9, v5
    s_add_u32 m0, s88, 36864
    s_mov_b64 exec, 0xffffffff
    buffer_load_dwordx4 v3, s[28:31], s97 offen offset:0  lds
    s_mov_b64 exec, -1
    v_and_b32 v7, 17, v7
    v_add_u32 v7, s78, v7
    v_and_b32 v8, 4, v0
    s_waitcnt vmcnt(12)
    s_waitcnt vmcnt(11)
    s_barrier
    s_mul_i32 s16, s97, 3072
    s_add_u32 m0, s60, 49152
    s_add_u32 s99, s16, s62
    buffer_load_dwordx4 v244, s[32:35], s99 offen offset:0  lds
    v_cmp_eq_u32 vcc, 0, v8
    s_nop 1
    v_cndmask_b32 v6, v7, v6, vcc
    v_and_b32 v33, 0xf0, v6
    buffer_load_dwordx4 v245, s[32:35], s99 offen offset:1024  lds
    v_lshlrev_b32 v34, 8, v6
    v_add_u32 v34, 12582912, v34
    v_and_b32 v5, 15, v0
    buffer_load_dwordx4 v246, s[32:35], s99 offen offset:2048  lds
    v_lshrrev_b32 v6, 4, v0
    v_add_u32 v7, 9, v5
    s_add_u32 m0, s61, 61440
    s_add_u32 s16, s16, s63
    buffer_load_dwordx4 v244, s[32:35], s16 offen offset:0  lds
    v_and_b32 v8, 1, v7
    v_mul_u32_u24 v8, 4160, v8
    v_lshrrev_b32 v7, 1, v7
    buffer_load_dwordx4 v245, s[32:35], s16 offen offset:1024  lds
    v_lshl_add_u32 v8, v7, 2, v8
    v_lshlrev_b32 v7, 4, v6
    v_sub_u32 v8, v8, v7
    buffer_load_dwordx4 v246, s[32:35], s16 offen offset:2048  lds
    s_add_u32 s78, s94, 32
    v_add_u32 v21, s78, v8
    s_add_u32 m0, s94, 32
    s_lshl_b32 s89, s90, 12
    buffer_load_dwordx4 v15, s[48:51], s89 offen offset:0 nt lds
    v_add_u32 v22, 1024, v21
    v_add_u32 v23, 2048, v21
    v_add_u32 v24, 3072, v21
    s_add_u32 m0, s94, 32
    s_lshl_b32 s89, s90, 12
    buffer_load_dwordx4 v15, s[48:51], s89 offen offset:1024 nt lds
    v_lshl_add_u32 v7, v5, 1, v6
    v_add_u32 v7, 30, v7
    v_and_b32 v8, 1, v7
    s_add_u32 m0, s94, 32
    s_lshl_b32 s89, s90, 12
    buffer_load_dwordx4 v15, s[48:51], s89 offen offset:2048 nt lds
    v_bfe_u32 v136, v7, 1, 2
    v_lshl_add_u32 v136, v8, 2, v136
    s_add_u32 m0, s94, 32
    s_lshl_b32 s89, s90, 12
    buffer_load_dwordx4 v15, s[48:51], s89 offen offset:3072 nt lds
    v_lshlrev_b32 v136, 6, v136
    v_lshrrev_b32 v7, 3, v7
    v_lshl_add_u32 v136, v7, 9, v136
    s_add_u32 s97, s98, s0
    s_lshr_b64 s[0:1], s[0:1], 4
    s_and_b32 s97, s97, 15
    s_add_u32 m0, s87, 0
    s_lshl_b32 s97, s97, 7
    buffer_load_dwordx4 v240, s[28:31], s97 offen offset:0  lds
    v_bitop3_b32 v8, v7, 3, s3 bitop3:0x6a
    v_lshl_add_u32 v25, v8, 4, v136
    v_add_u32 v25, 92160, v25
    buffer_load_dwordx4 v241, s[28:31], s97 offen offset:1024  lds
    v_subrev_u32 v7, 1, v7
    v_bitop3_b32 v8, v7, 3, s3 bitop3:0x6a
    buffer_load_dwordx4 v242, s[28:31], s97 offen offset:2048  lds
    v_lshl_add_u32 v27, v8, 4, v136
    v_add_u32 v27, 91648, v27
    v_subrev_u32 v7, 1, v7
    buffer_load_dwordx4 v243, s[28:31], s97 offen offset:3072  lds
    v_bitop3_b32 v8, v7, 3, s3 bitop3:0x6a
    v_lshl_add_u32 v29, v8, 4, v136
    v_add_u32 v29, 91136, v29
    s_add_u32 m0, s88, 0
    s_mov_b64 exec, 0xffffffff
    buffer_load_dwordx4 v3, s[28:31], s97 offen offset:0  lds
    s_mov_b64 exec, -1
    v_subrev_u32 v7, 1, v7
    v_bitop3_b32 v8, v7, 3, s3 bitop3:0x6a
    s_waitcnt vmcnt(15)
    s_barrier
    s_mul_i32 s16, s97, 3072
    s_add_u32 m0, s60, 0
    s_add_u32 s99, s16, s62
    buffer_load_dwordx4 v244, s[32:35], s99 offen offset:0  lds
    v_lshl_add_u32 v31, v8, 4, v136
    v_add_u32 v31, 90624, v31
    v_lshl_add_u32 v7, v5, 1, v6
    v_add_u32 v7, 26, v7
    buffer_load_dwordx4 v245, s[32:35], s99 offen offset:1024  lds
    v_and_b32 v8, 1, v7
    v_bfe_u32 v136, v7, 1, 2
    v_lshl_add_u32 v136, v8, 2, v136
    v_lshlrev_b32 v136, 6, v136
    buffer_load_dwordx4 v246, s[32:35], s99 offen offset:2048  lds
    v_lshrrev_b32 v7, 3, v7
    v_lshl_add_u32 v136, v7, 9, v136
    v_bitop3_b32 v8, v7, 3, s3 bitop3:0x6a
    s_add_u32 m0, s61, 12288
    s_add_u32 s16, s16, s63
    buffer_load_dwordx4 v244, s[32:35], s16 offen offset:0  lds
    v_lshl_add_u32 v26, v8, 4, v136
    v_add_u32 v26, 92160, v26
    v_subrev_u32 v7, 1, v7
    v_bitop3_b32 v8, v7, 3, s3 bitop3:0x6a
    buffer_load_dwordx4 v245, s[32:35], s16 offen offset:1024  lds
    v_lshl_add_u32 v28, v8, 4, v136
    v_add_u32 v28, 91648, v28
    v_subrev_u32 v7, 1, v7
    v_bitop3_b32 v8, v7, 3, s3 bitop3:0x6a
    buffer_load_dwordx4 v246, s[32:35], s16 offen offset:2048  lds
    v_lshl_add_u32 v30, v8, 4, v136
    v_add_u32 v30, 91136, v30
    v_subrev_u32 v7, 1, v7
    s_add_u32 s97, s98, s0
    s_lshr_b64 s[0:1], s[0:1], 4
    s_and_b32 s97, s97, 15
    s_add_u32 m0, s87, 18432
    s_lshl_b32 s97, s97, 7
    buffer_load_dwordx4 v240, s[28:31], s97 offen offset:0  lds
    v_bitop3_b32 v8, v7, 3, s3 bitop3:0x6a
    v_lshl_add_u32 v32, v8, 4, v136
    v_add_u32 v32, 90624, v32
    v_lshrrev_b32 v7, 1, v6
    buffer_load_dwordx4 v241, s[28:31], s97 offen offset:1024  lds
    v_lshl_add_u32 v7, v5, 1, v7
    v_add_u32 v7, 32, v7
    v_and_b32 v8, 1, v7
    v_bfe_u32 v136, v7, 1, 2
    buffer_load_dwordx4 v242, s[28:31], s97 offen offset:2048  lds
    v_lshl_add_u32 v136, v8, 2, v136
    v_lshlrev_b32 v136, 6, v136
    v_lshrrev_b32 v7, 3, v7
    buffer_load_dwordx4 v243, s[28:31], s97 offen offset:3072  lds
    v_lshl_add_u32 v136, v7, 9, v136
    v_bitop3_b32 v8, v7, 3, s3 bitop3:0x6a
    v_lshl_add_u32 v20, v8, 4, v136
    v_add_u32 v20, 92160, v20
    s_add_u32 m0, s88, 18432
    s_mov_b64 exec, 0xffffffff
    buffer_load_dwordx4 v3, s[28:31], s97 offen offset:0  lds
    s_mov_b64 exec, -1
    v_and_b32 v8, 1, v6
    v_xor_b32 v8, 1, v8
    v_lshl_add_u32 v20, v8, 3, v20
    s_waitcnt vmcnt(11)
    s_barrier
    s_mul_i32 s16, s97, 3072
    s_add_u32 m0, s60, 24576
    s_add_u32 s99, s16, s62
    buffer_load_dwordx4 v244, s[32:35], s99 offen offset:0  lds
    s_waitcnt lgkmcnt(0)
    s_and_b32 s78, s92, 0xffff0000
    s_lshl_b32 s92, s92, 16
    buffer_load_dwordx4 v245, s[32:35], s99 offen offset:1024  lds
    s_bitcmp1_b32 s90, 0
    s_cselect_b32 s92, s78, s92
    v_lshlrev_b32 v7, 3, v6
    v_sub_u32 v7, v7, v5
    buffer_load_dwordx4 v246, s[32:35], s99 offen offset:2048  lds
    v_subrev_u32 v7, 9, v7
    v_and_b32 v8, 1, v7
    v_xor_b32 v8, 1, v8
    s_add_u32 m0, s61, 36864
    s_add_u32 s16, s16, s63
    buffer_load_dwordx4 v244, s[32:35], s16 offen offset:0  lds
    v_lshlrev_b32 v8, 4, v8
    v_lshrrev_b32 v8, v8, s92
    v_ashrrev_i32 v7, 1, v7
    buffer_load_dwordx4 v245, s[32:35], s16 offen offset:1024  lds
    v_cmp_eq_u32 vcc, 0, v7
    s_nop 1
    v_cndmask_b32 v236, 0, v8, vcc
    v_cmp_eq_u32 vcc, 1, v7
    buffer_load_dwordx4 v246, s[32:35], s16 offen offset:2048  lds
    s_nop 0
    v_cndmask_b32 v237, 0, v8, vcc
    v_cmp_eq_u32 vcc, 2, v7
    s_nop 1
    v_cndmask_b32 v238, 0, v8, vcc
    s_add_u32 s97, s98, s0
    s_lshr_b64 s[0:1], s[0:1], 4
    s_and_b32 s97, s97, 15
    s_add_u32 m0, s87, 36864
    s_lshl_b32 s97, s97, 7
    buffer_load_dwordx4 v240, s[28:31], s97 offen offset:0  lds
    v_cmp_eq_u32 vcc, 3, v7
    s_nop 1
    v_cndmask_b32 v239, 0, v8, vcc
    s_and_b32 s78, s77, 7
    s_mov_b32 s95, 0x76543210
    s_and_b32 s78, s76, 3
    s_mul_i32 s78, s78, 0x22222222
    s_add_u32 s95, s95, s78
    s_bfe_u32 s17, s95, 0x30000
    s_lshl_b32 s17, s17, 18
    s_bfe_u32 s18, s95, 0x30004
    s_lshl_b32 s18, s18, 18
    s_bfe_u32 s100, s95, 0x3001c
    s_lshl_b32 s100, s100, 18
    s_bfe_u32 s95, s95, 0x30018
    s_lshl_b32 s95, s95, 18
    buffer_load_dwordx4 v241, s[28:31], s97 offen offset:1024  lds
    v_lshrrev_b32 v136, 4, v0
    v_lshlrev_b32 v136, 1, v136
    v_and_b32 v137, 7, v0
    buffer_load_dwordx4 v242, s[28:31], s97 offen offset:2048  lds
    v_xor_b32 v136, v136, v137
    v_lshlrev_b32 v136, 4, v136
    v_lshrrev_b32 v137, 3, v0
    buffer_load_dwordx4 v243, s[28:31], s97 offen offset:3072  lds
    v_lshl_add_u32 v136, v137, 11, v136
    s_lshl_b32 s78, s77, 7
    s_lshl_b32 s79, s3, 14
    s_add_u32 m0, s88, 36864
    s_mov_b64 exec, 0xffffffff
    buffer_load_dwordx4 v3, s[28:31], s97 offen offset:0  lds
    s_mov_b64 exec, -1
    s_add_u32 s78, s78, s79
    v_add_u32 v17, s78, v136
    s_waitcnt vmcnt(11)
    s_barrier
    s_mul_i32 s16, s97, 3072
    s_add_u32 m0, s60, 49152
    s_add_u32 s99, s16, s62
    buffer_load_dwordx4 v244, s[32:35], s99 offen offset:0  lds
    v_add_u32 v5, s94, v15
    ds_read_b128 v[140:143], v5 offset:32
    ds_read_b32 v156, v5 offset:48
    ds_read_b128 v[144:147], v5 offset:1056
    buffer_load_dwordx4 v245, s[32:35], s99 offen offset:1024  lds
    ds_read_b32 v157, v5 offset:1072
    ds_read_b128 v[148:151], v5 offset:2080
    ds_read_b32 v158, v5 offset:2096
    ds_read_b128 v[152:155], v5 offset:3104
    buffer_load_dwordx4 v246, s[32:35], s99 offen offset:2048  lds
    ds_read_b32 v159, v5 offset:3120
    v_lshrrev_b32 v6, 3, v0
    v_mul_u32_u24 v6, 4160, v6
    s_add_u32 m0, s61, 61440
    s_add_u32 s16, s16, s63
    buffer_load_dwordx4 v244, s[32:35], s16 offen offset:0  lds
    v_and_b32 v7, 7, v0
    v_lshl_add_u32 v6, v7, 2, v6
    v_add_u32 v6, s94, v6
    v_mov_b32 v7, 0
    buffer_load_dwordx4 v245, s[32:35], s16 offen offset:1024  lds
    s_waitcnt lgkmcnt(0)
    v_readfirstlane_b32 s93, v140
    s_nop 0
    s_lshl_b32 s93, s93, 16
    s_nop 1
    v_writelane_b32 v7, s93, 15
    buffer_load_dwordx4 v246, s[32:35], s16 offen offset:2048  lds
    v_alignbit_b32 v140, v141, v140, 16
    v_alignbit_b32 v141, v142, v141, 16
    v_alignbit_b32 v142, v143, v142, 16
    s_add_u32 s97, s98, s0
    s_lshr_b64 s[0:1], s[0:1], 4
    s_and_b32 s97, s97, 15
    s_add_u32 m0, s87, 0
    s_lshl_b32 s97, s97, 7
    buffer_load_dwordx4 v240, s[28:31], s97 offen offset:0  lds
    v_alignbit_b32 v143, v156, v143, 16
    v_alignbit_b32 v144, v145, v144, 16
    v_alignbit_b32 v145, v146, v145, 16
    v_alignbit_b32 v146, v147, v146, 16
    buffer_load_dwordx4 v241, s[28:31], s97 offen offset:1024  lds
    v_alignbit_b32 v147, v157, v147, 16
    v_alignbit_b32 v148, v149, v148, 16
    v_alignbit_b32 v149, v150, v149, 16
    v_alignbit_b32 v150, v151, v150, 16
    buffer_load_dwordx4 v242, s[28:31], s97 offen offset:2048  lds
    v_alignbit_b32 v151, v158, v151, 16
    v_alignbit_b32 v152, v153, v152, 16
    v_alignbit_b32 v153, v154, v153, 16
    buffer_load_dwordx4 v243, s[28:31], s97 offen offset:3072  lds
    v_alignbit_b32 v154, v155, v154, 16
    v_alignbit_b32 v155, v159, v155, 16
    v_lshlrev_b32 v8, 3, v0
    s_add_u32 s78, s88, 18432
    s_add_u32 m0, s88, 0
    s_mov_b64 exec, 0xffffffff
    buffer_load_dwordx4 v3, s[28:31], s97 offen offset:0  lds
    s_mov_b64 exec, -1
    v_add_u32 v8, s78, v8
    v_mov_b32 v156, 0
    v_mov_b32 v157, 0
    s_waitcnt vmcnt(11)
    s_barrier
    s_mul_i32 s16, s97, 3072
    s_add_u32 m0, s60, 0
    s_add_u32 s99, s16, s62
    buffer_load_dwordx4 v244, s[32:35], s99 offen offset:0  lds
    buffer_load_dwordx4 v245, s[32:35], s99 offen offset:1024  lds
    buffer_load_dwordx4 v246, s[32:35], s99 offen offset:2048  lds
    s_add_u32 m0, s61, 12288
    s_add_u32 s16, s16, s63
    buffer_load_dwordx4 v244, s[32:35], s16 offen offset:0  lds
    buffer_load_dwordx4 v245, s[32:35], s16 offen offset:1024  lds
    buffer_load_dwordx4 v246, s[32:35], s16 offen offset:2048  lds
    s_mov_b64 exec, 0xff
    buffer_load_dword v136, v33, s[68:71], 0 offen sc1
    buffer_load_dword v137, v34, s[52:55], 0 offen sc1
    s_mov_b64 exec, -1
    buffer_load_dwordx4 v[212:215], v9, s[56:59], 0 offen offset:0 nt
    buffer_load_dwordx4 v[216:219], v9, s[56:59], 0 offen offset:2048 nt
    buffer_load_dwordx4 v[220:223], v9, s[56:59], s96 offen offset:0 nt
    buffer_load_dwordx4 v[224:227], v9, s[56:59], s96 offen offset:2048 nt
    s_waitcnt vmcnt(12)
    s_waitcnt vmcnt(6)
    s_barrier
    s_waitcnt vmcnt(4)
    s_branch LA_j
LA_c3:
    s_waitcnt vmcnt(8)
    s_barrier
    buffer_load_dwordx4 v242, s[28:31], s97 offen offset:2048  lds
    buffer_load_dwordx4 v243, s[28:31], s97 offen offset:3072  lds
    s_add_u32 m0, s88, 36864
    s_mov_b64 exec, 0xffffffff
    buffer_load_dwordx4 v3, s[28:31], s97 offen offset:0  lds
    s_mov_b64 exec, -1
    s_mul_i32 s16, s97, 3072
    s_add_u32 m0, s60, 49152
    s_add_u32 s99, s16, s62
    buffer_load_dwordx4 v244, s[32:35], s99 offen offset:0  lds
    buffer_load_dwordx4 v245, s[32:35], s99 offen offset:1024  lds
    buffer_load_dwordx4 v246, s[32:35], s99 offen offset:2048  lds
    s_add_u32 m0, s61, 61440
    s_add_u32 s16, s16, s63
    buffer_load_dwordx4 v244, s[32:35], s16 offen offset:0  lds
    buffer_load_dwordx4 v245, s[32:35], s16 offen offset:1024  lds
    buffer_load_dwordx4 v246, s[32:35], s16 offen offset:2048  lds
    s_add_u32 s97, s98, s0
    s_lshr_b64 s[0:1], s[0:1], 4
    s_and_b32 s97, s97, 15
    s_add_u32 m0, s87, 0
    s_lshl_b32 s97, s97, 7
    buffer_load_dwordx4 v240, s[28:31], s97 offen offset:0  lds
    buffer_load_dwordx4 v241, s[28:31], s97 offen offset:1024  lds
    buffer_load_dwordx4 v242, s[28:31], s97 offen offset:2048  lds
    buffer_load_dwordx4 v243, s[28:31], s97 offen offset:3072  lds
    s_add_u32 m0, s88, 0
    s_mov_b64 exec, 0xffffffff
    buffer_load_dwordx4 v3, s[28:31], s97 offen offset:0  lds
    s_mov_b64 exec, -1
    s_waitcnt vmcnt(11)
    s_barrier
    s_mul_i32 s16, s97, 3072
    s_add_u32 m0, s60, 0
    s_add_u32 s99, s16, s62
    buffer_load_dwordx4 v244, s[32:35], s99 offen offset:0  lds
    buffer_load_dwordx4 v245, s[32:35], s99 offen offset:1024  lds
    buffer_load_dwordx4 v246, s[32:35], s99 offen offset:2048  lds
    s_add_u32 m0, s61, 12288
    s_add_u32 s16, s16, s63
    buffer_load_dwordx4 v244, s[32:35], s16 offen offset:0  lds
    buffer_load_dwordx4 v245, s[32:35], s16 offen offset:1024  lds
    buffer_load_dwordx4 v246, s[32:35], s16 offen offset:2048  lds
    s_add_u32 s97, s98, s0
    s_lshr_b64 s[0:1], s[0:1], 4
    s_and_b32 s97, s97, 15
    s_add_u32 m0, s87, 18432
    s_lshl_b32 s97, s97, 7
    buffer_load_dwordx4 v240, s[28:31], s97 offen offset:0  lds
    buffer_load_dwordx4 v241, s[28:31], s97 offen offset:1024  lds
    buffer_load_dwordx4 v242, s[28:31], s97 offen offset:2048  lds
    buffer_load_dwordx4 v243, s[28:31], s97 offen offset:3072  lds
    s_add_u32 m0, s88, 18432
    s_mov_b64 exec, 0xffffffff
    buffer_load_dwordx4 v3, s[28:31], s97 offen offset:0  lds
    s_mov_b64 exec, -1
    s_waitcnt vmcnt(11)
    s_barrier
    s_mul_i32 s16, s97, 3072
    s_add_u32 m0, s60, 24576
    s_add_u32 s99, s16, s62
    buffer_load_dwordx4 v244, s[32:35], s99 offen offset:0  lds
    buffer_load_dwordx4 v245, s[32:35], s99 offen offset:1024  lds
    buffer_load_dwordx4 v246, s[32:35], s99 offen offset:2048  lds
    s_add_u32 m0, s61, 36864
    s_add_u32 s16, s16, s63
    buffer_load_dwordx4 v244, s[32:35], s16 offen offset:0  lds
    buffer_load_dwordx4 v245, s[32:35], s16 offen offset:1024  lds
    buffer_load_dwordx4 v246, s[32:35], s16 offen offset:2048  lds
    s_add_u32 m0, s86, 129536
    s_mov_b32 s89, 0
    buffer_load_dwordx4 v10, s[36:39], s89 offen nt lds
    s_add_u32 m0, s86, 145920
    s_mov_b32 s89, 0
    buffer_load_dwordx4 v10, s[40:43], s89 offen nt lds
    s_add_u32 m0, s86, 133632
    s_mov_b32 s89, 65536
    buffer_load_dwordx4 v10, s[36:39], s89 offen nt lds
    s_add_u32 m0, s86, 150016
    s_mov_b32 s89, 65536
    buffer_load_dwordx4 v10, s[40:43], s89 offen nt lds
    s_add_u32 m0, s86, 137728
    s_mov_b32 s89, 131072
    buffer_load_dwordx4 v10, s[36:39], s89 offen nt lds
    s_add_u32 m0, s86, 154112
    s_mov_b32 s89, 131072
    buffer_load_dwordx4 v10, s[40:43], s89 offen nt lds
    s_add_u32 m0, s86, 141824
    s_mov_b32 s89, 196608
    buffer_load_dwordx4 v10, s[36:39], s89 offen nt lds
    s_add_u32 m0, s86, 158208
    s_mov_b32 s89, 196608
    buffer_load_dwordx4 v10, s[40:43], s89 offen nt lds
    s_mov_b64 exec, 0xff
    s_lshl_b32 s82, s3, 7
    s_add_u32 m0, s82, 129024
    s_mov_b32 s89, 0
    buffer_load_dwordx4 v11, s[36:39], s89 offen nt lds
    s_lshl_b32 s83, s74, 9
    s_add_u32 s83, s83, s82
    s_and_b32 s89, s3, 2
    s_lshl_b32 s89, s89, 3
    s_add_u32 s82, s82, s89
    s_add_u32 m0, s82, 162816
    s_add_u32 s89, s83, 0
    buffer_load_dwordx4 v15, s[44:47], s89 offen  lds
    s_mov_b64 exec, -1
    s_add_u32 s97, s98, s0
    s_lshr_b64 s[0:1], s[0:1], 4
    s_and_b32 s97, s97, 15
    s_add_u32 m0, s87, 36864
    s_lshl_b32 s97, s97, 7
    buffer_load_dwordx4 v240, s[28:31], s97 offen offset:0  lds
    s_waitcnt vmcnt(17)
    s_barrier
    buffer_load_dwordx4 v241, s[28:31], s97 offen offset:1024  lds
    buffer_load_dwordx4 v242, s[28:31], s97 offen offset:2048  lds
    buffer_load_dwordx4 v243, s[28:31], s97 offen offset:3072  lds
    s_add_u32 m0, s88, 36864
    s_mov_b64 exec, 0xffffffff
    buffer_load_dwordx4 v3, s[28:31], s97 offen offset:0  lds
    s_mov_b64 exec, -1
    s_mul_i32 s16, s97, 3072
    s_add_u32 m0, s60, 49152
    s_add_u32 s99, s16, s62
    buffer_load_dwordx4 v244, s[32:35], s99 offen offset:0  lds
    buffer_load_dwordx4 v245, s[32:35], s99 offen offset:1024  lds
    buffer_load_dwordx4 v246, s[32:35], s99 offen offset:2048  lds
    s_add_u32 m0, s61, 61440
    s_add_u32 s16, s16, s63
    buffer_load_dwordx4 v244, s[32:35], s16 offen offset:0  lds
    buffer_load_dwordx4 v245, s[32:35], s16 offen offset:1024  lds
    buffer_load_dwordx4 v246, s[32:35], s16 offen offset:2048  lds
    s_add_u32 s97, s98, s0
    s_lshr_b64 s[0:1], s[0:1], 4
    s_and_b32 s97, s97, 15
    s_add_u32 m0, s87, 0
    s_lshl_b32 s97, s97, 7
    buffer_load_dwordx4 v240, s[28:31], s97 offen offset:0  lds
    buffer_load_dwordx4 v241, s[28:31], s97 offen offset:1024  lds
    buffer_load_dwordx4 v242, s[28:31], s97 offen offset:2048  lds
    buffer_load_dwordx4 v243, s[28:31], s97 offen offset:3072  lds
    s_add_u32 m0, s88, 0
    s_mov_b64 exec, 0xffffffff
    buffer_load_dwordx4 v3, s[28:31], s97 offen offset:0  lds
    s_mov_b64 exec, -1
    s_waitcnt vmcnt(11)
    s_barrier
    s_mul_i32 s16, s97, 3072
    s_add_u32 m0, s60, 0
    s_add_u32 s99, s16, s62
    buffer_load_dwordx4 v244, s[32:35], s99 offen offset:0  lds
    ds_read_b128 v[84:87], v35 offset:0
    ds_read_b128 v[88:91], v35 offset:16
    buffer_load_dwordx4 v245, s[32:35], s99 offen offset:1024  lds
    ds_read_b64 v[40:41], v16 offset:0
    ds_read_b64 v[42:43], v231 offset:256
    buffer_load_dwordx4 v246, s[32:35], s99 offen offset:2048  lds
    ds_read_b64 v[44:45], v16 offset:256
    ds_read_b64 v[46:47], v16 offset:512
    s_add_u32 m0, s61, 12288
    s_add_u32 s16, s16, s63
    buffer_load_dwordx4 v244, s[32:35], s16 offen offset:0  lds
    ds_read_b64 v[48:49], v231 offset:512
    ds_read_b64 v[50:51], v16 offset:768
    buffer_load_dwordx4 v245, s[32:35], s16 offen offset:1024  lds
    ds_read_b64 v[52:53], v231 offset:768
    ds_read_b64 v[54:55], v16 offset:1024
    buffer_load_dwordx4 v246, s[32:35], s16 offen offset:2048  lds
    ds_read_b64 v[56:57], v231 offset:1024
    ds_read_b64 v[58:59], v16 offset:1280
    s_add_u32 s97, s98, s0
    s_lshr_b64 s[0:1], s[0:1], 4
    s_and_b32 s97, s97, 15
    s_add_u32 m0, s87, 18432
    s_lshl_b32 s97, s97, 7
    buffer_load_dwordx4 v240, s[28:31], s97 offen offset:0  lds
    ds_read_b64 v[60:61], v231 offset:1280
    ds_read_b64 v[68:69], v16 offset:16896
    buffer_load_dwordx4 v241, s[28:31], s97 offen offset:1024  lds
    ds_read_b64 v[70:71], v231 offset:16896
    ds_read_b64 v[72:73], v16 offset:17152
    buffer_load_dwordx4 v242, s[28:31], s97 offen offset:2048  lds
    ds_read_b64 v[74:75], v231 offset:17152
    ds_read_b64 v[76:77], v16 offset:17408
    buffer_load_dwordx4 v243, s[28:31], s97 offen offset:3072  lds
    ds_read_b64 v[78:79], v231 offset:17408
    ds_read_b64 v[80:81], v16 offset:17664
    s_add_u32 m0, s88, 18432
    s_mov_b64 exec, 0xffffffff
    buffer_load_dwordx4 v3, s[28:31], s97 offen offset:0  lds
    s_mov_b64 exec, -1
    ds_read_b64 v[82:83], v231 offset:17664
    s_waitcnt vmcnt(11)
    s_waitcnt lgkmcnt(0)
    s_barrier
    s_mul_i32 s16, s97, 3072
    s_add_u32 m0, s60, 24576
    s_add_u32 s99, s16, s62
    buffer_load_dwordx4 v244, s[32:35], s99 offen offset:0  lds
    v_lshlrev_b32 v160, 16, v40
    v_lshlrev_b32 v161, 16, v42
    v_lshlrev_b32 v162, 16, v44
    v_lshlrev_b32 v163, 16, v46
    v_lshlrev_b32 v164, 16, v48
    buffer_load_dwordx4 v245, s[32:35], s99 offen offset:1024  lds
    v_lshlrev_b32 v165, 16, v50
    v_lshlrev_b32 v166, 16, v52
    v_lshlrev_b32 v167, 16, v54
    v_lshlrev_b32 v168, 16, v56
    v_lshlrev_b32 v169, 16, v58
    buffer_load_dwordx4 v246, s[32:35], s99 offen offset:2048  lds
    v_lshlrev_b32 v170, 16, v60
    v_lshlrev_b32 v172, 16, v84
    v_and_b32 v173, 0xffff0000, v84
    v_lshlrev_b32 v174, 16, v85
    v_and_b32 v175, 0xffff0000, v85
    s_add_u32 m0, s61, 36864
    s_add_u32 s16, s16, s63
    buffer_load_dwordx4 v244, s[32:35], s16 offen offset:0  lds
    v_lshlrev_b32 v176, 16, v68
    v_lshlrev_b32 v177, 16, v70
    v_lshlrev_b32 v178, 16, v72
    v_lshlrev_b32 v179, 16, v74
    v_lshlrev_b32 v180, 16, v76
    buffer_load_dwordx4 v245, s[32:35], s16 offen offset:1024  lds
    v_lshlrev_b32 v181, 16, v78
    v_lshlrev_b32 v182, 16, v80
    v_lshlrev_b32 v183, 16, v82
    v_mul_f32 v184, v160, v175
    v_mul_f32 v185, v161, v175
    buffer_load_dwordx4 v246, s[32:35], s16 offen offset:2048  lds
    v_mul_f32 v186, v162, v175
    v_mul_f32 v187, v163, v175
    v_mul_f32 v188, v164, v175
    v_mul_f32 v189, v165, v175
    v_mul_f32 v190, v166, v175
    s_add_u32 s97, s98, s0
    s_lshr_b64 s[0:1], s[0:1], 4
    s_and_b32 s97, s97, 15
    s_add_u32 m0, s87, 36864
    s_lshl_b32 s97, s97, 7
    buffer_load_dwordx4 v240, s[28:31], s97 offen offset:0  lds
    v_mul_f32 v191, v167, v175
    v_fmac_f32 v184, v161, v174
    v_fmac_f32 v185, v162, v174
    v_fmac_f32 v186, v163, v174
    v_fmac_f32 v187, v164, v174
    buffer_load_dwordx4 v241, s[28:31], s97 offen offset:1024  lds
    v_fmac_f32 v188, v165, v174
    v_fmac_f32 v189, v166, v174
    v_fmac_f32 v190, v167, v174
    v_fmac_f32 v191, v168, v174
    v_fmac_f32 v184, v162, v173
    buffer_load_dwordx4 v242, s[28:31], s97 offen offset:2048  lds
    v_fmac_f32 v185, v163, v173
    v_fmac_f32 v186, v164, v173
    v_fmac_f32 v187, v165, v173
    v_fmac_f32 v188, v166, v173
    v_fmac_f32 v189, v167, v173
    buffer_load_dwordx4 v243, s[28:31], s97 offen offset:3072  lds
    v_fmac_f32 v190, v168, v173
    v_fmac_f32 v191, v169, v173
    v_fmac_f32 v184, v163, v172
    v_fmac_f32 v185, v164, v172
    v_fmac_f32 v186, v165, v172
    s_add_u32 m0, s88, 36864
    s_mov_b64 exec, 0xffffffff
    buffer_load_dwordx4 v3, s[28:31], s97 offen offset:0  lds
    s_mov_b64 exec, -1
    v_fmac_f32 v187, v166, v172
    v_fmac_f32 v188, v167, v172
    v_fmac_f32 v189, v168, v172
    v_fmac_f32 v190, v169, v172
    v_fmac_f32 v191, v170, v172
    v_mul_f32 v184, v184, v176
    v_mul_f32 v185, v185, v177
    v_mul_f32 v186, v186, v178
    v_mul_f32 v187, v187, v179
    v_mul_f32 v188, v188, v180
    v_mul_f32 v189, v189, v181
    v_mul_f32 v190, v190, v182
    v_mul_f32 v191, v191, v183
    v_cvt_pk_bf16_f32 v100, v191, v190
    v_cvt_pk_bf16_f32 v101, v189, v188
    v_cvt_pk_bf16_f32 v102, v187, v186
    v_cvt_pk_bf16_f32 v103, v185, v184
    s_mov_b32 s89, 0
    buffer_store_dwordx4 v[100:103], v12, s[52:55], s89 offen sc1
    v_and_b32 v160, 0xffff0000, v40
    v_and_b32 v161, 0xffff0000, v42
    v_and_b32 v162, 0xffff0000, v44
    v_and_b32 v163, 0xffff0000, v46
    v_and_b32 v164, 0xffff0000, v48
    v_and_b32 v165, 0xffff0000, v50
    v_and_b32 v166, 0xffff0000, v52
    v_and_b32 v167, 0xffff0000, v54
    v_and_b32 v168, 0xffff0000, v56
    v_and_b32 v169, 0xffff0000, v58
    v_and_b32 v170, 0xffff0000, v60
    v_lshlrev_b32 v172, 16, v86
    v_and_b32 v173, 0xffff0000, v86
    v_lshlrev_b32 v174, 16, v87
    v_and_b32 v175, 0xffff0000, v87
    v_and_b32 v176, 0xffff0000, v68
    v_and_b32 v177, 0xffff0000, v70
    v_and_b32 v178, 0xffff0000, v72
    v_and_b32 v179, 0xffff0000, v74
    v_and_b32 v180, 0xffff0000, v76
    v_and_b32 v181, 0xffff0000, v78
    v_and_b32 v182, 0xffff0000, v80
    v_and_b32 v183, 0xffff0000, v82
    s_waitcnt vmcnt(12)
    s_barrier
    s_mul_i32 s16, s97, 3072
    s_add_u32 m0, s60, 49152
    s_add_u32 s99, s16, s62
    buffer_load_dwordx4 v244, s[32:35], s99 offen offset:0  lds
    v_mul_f32 v184, v160, v175
    v_mul_f32 v185, v161, v175
    v_mul_f32 v186, v162, v175
    v_mul_f32 v187, v163, v175
    v_mul_f32 v188, v164, v175
    buffer_load_dwordx4 v245, s[32:35], s99 offen offset:1024  lds
    v_mul_f32 v189, v165, v175
    v_mul_f32 v190, v166, v175
    v_mul_f32 v191, v167, v175
    v_fmac_f32 v184, v161, v174
    v_fmac_f32 v185, v162, v174
    buffer_load_dwordx4 v246, s[32:35], s99 offen offset:2048  lds
    v_fmac_f32 v186, v163, v174
    v_fmac_f32 v187, v164, v174
    v_fmac_f32 v188, v165, v174
    v_fmac_f32 v189, v166, v174
    v_fmac_f32 v190, v167, v174
    s_add_u32 m0, s61, 61440
    s_add_u32 s16, s16, s63
    buffer_load_dwordx4 v244, s[32:35], s16 offen offset:0  lds
    v_fmac_f32 v191, v168, v174
    v_fmac_f32 v184, v162, v173
    v_fmac_f32 v185, v163, v173
    v_fmac_f32 v186, v164, v173
    v_fmac_f32 v187, v165, v173
    buffer_load_dwordx4 v245, s[32:35], s16 offen offset:1024  lds
    v_fmac_f32 v188, v166, v173
    v_fmac_f32 v189, v167, v173
    v_fmac_f32 v190, v168, v173
    v_fmac_f32 v191, v169, v173
    v_fmac_f32 v184, v163, v172
    buffer_load_dwordx4 v246, s[32:35], s16 offen offset:2048  lds
    v_fmac_f32 v185, v164, v172
    v_fmac_f32 v186, v165, v172
    v_fmac_f32 v187, v166, v172
    v_fmac_f32 v188, v167, v172
    v_fmac_f32 v189, v168, v172
    s_add_u32 s97, s98, s0
    s_lshr_b64 s[0:1], s[0:1], 4
    s_and_b32 s97, s97, 15
    s_add_u32 m0, s87, 0
    s_lshl_b32 s97, s97, 7
    buffer_load_dwordx4 v240, s[28:31], s97 offen offset:0  lds
    v_fmac_f32 v190, v169, v172
    v_fmac_f32 v191, v170, v172
    v_mul_f32 v184, v184, v176
    v_mul_f32 v185, v185, v177
    v_mul_f32 v186, v186, v178
    buffer_load_dwordx4 v241, s[28:31], s97 offen offset:1024  lds
    v_mul_f32 v187, v187, v179
    v_mul_f32 v188, v188, v180
    v_mul_f32 v189, v189, v181
    v_mul_f32 v190, v190, v182
    v_mul_f32 v191, v191, v183
    buffer_load_dwordx4 v242, s[28:31], s97 offen offset:2048  lds
    v_cvt_pk_bf16_f32 v104, v191, v190
    v_cvt_pk_bf16_f32 v105, v189, v188
    v_cvt_pk_bf16_f32 v106, v187, v186
    v_cvt_pk_bf16_f32 v107, v185, v184
    s_mov_b32 s89, 16384
    buffer_store_dwordx4 v[104:107], v12, s[52:55], s89 offen sc1
    buffer_load_dwordx4 v243, s[28:31], s97 offen offset:3072  lds
    v_lshlrev_b32 v160, 16, v41
    v_lshlrev_b32 v161, 16, v43
    v_lshlrev_b32 v162, 16, v45
    v_lshlrev_b32 v163, 16, v47
    v_lshlrev_b32 v164, 16, v49
    s_add_u32 m0, s88, 0
    s_mov_b64 exec, 0xffffffff
    buffer_load_dwordx4 v3, s[28:31], s97 offen offset:0  lds
    s_mov_b64 exec, -1
    v_lshlrev_b32 v165, 16, v51
    v_lshlrev_b32 v166, 16, v53
    v_lshlrev_b32 v167, 16, v55
    v_lshlrev_b32 v168, 16, v57
    v_lshlrev_b32 v169, 16, v59
    v_lshlrev_b32 v170, 16, v61
    v_lshlrev_b32 v172, 16, v88
    v_and_b32 v173, 0xffff0000, v88
    v_lshlrev_b32 v174, 16, v89
    v_and_b32 v175, 0xffff0000, v89
    v_lshlrev_b32 v176, 16, v69
    v_lshlrev_b32 v177, 16, v71
    v_lshlrev_b32 v178, 16, v73
    v_lshlrev_b32 v179, 16, v75
    v_lshlrev_b32 v180, 16, v77
    v_lshlrev_b32 v181, 16, v79
    v_lshlrev_b32 v182, 16, v81
    v_lshlrev_b32 v183, 16, v83
    v_mul_f32 v184, v160, v175
    v_mul_f32 v185, v161, v175
    v_mul_f32 v186, v162, v175
    v_mul_f32 v187, v163, v175
    v_mul_f32 v188, v164, v175
    v_mul_f32 v189, v165, v175
    v_mul_f32 v190, v166, v175
    v_mul_f32 v191, v167, v175
    v_fmac_f32 v184, v161, v174
    v_fmac_f32 v185, v162, v174
    v_fmac_f32 v186, v163, v174
    v_fmac_f32 v187, v164, v174
    v_fmac_f32 v188, v165, v174
    v_fmac_f32 v189, v166, v174
    v_fmac_f32 v190, v167, v174
    v_fmac_f32 v191, v168, v174
    v_fmac_f32 v184, v162, v173
    v_fmac_f32 v185, v163, v173
    v_fmac_f32 v186, v164, v173
    v_fmac_f32 v187, v165, v173
    v_fmac_f32 v188, v166, v173
    v_fmac_f32 v189, v167, v173
    v_fmac_f32 v190, v168, v173
    s_waitcnt vmcnt(13)
    s_barrier
    s_mul_i32 s16, s97, 3072
    s_add_u32 m0, s60, 0
    s_add_u32 s99, s16, s62
    buffer_load_dwordx4 v244, s[32:35], s99 offen offset:0  lds
    v_fmac_f32 v191, v169, v173
    v_fmac_f32 v184, v163, v172
    v_fmac_f32 v185, v164, v172
    v_fmac_f32 v186, v165, v172
    v_fmac_f32 v187, v166, v172
    buffer_load_dwordx4 v245, s[32:35], s99 offen offset:1024  lds
    v_fmac_f32 v188, v167, v172
    v_fmac_f32 v189, v168, v172
    v_fmac_f32 v190, v169, v172
    v_fmac_f32 v191, v170, v172
    v_mul_f32 v184, v184, v176
    buffer_load_dwordx4 v246, s[32:35], s99 offen offset:2048  lds
    v_mul_f32 v185, v185, v177
    v_mul_f32 v186, v186, v178
    v_mul_f32 v187, v187, v179
    v_mul_f32 v188, v188, v180
    v_mul_f32 v189, v189, v181
    s_add_u32 m0, s61, 12288
    s_add_u32 s16, s16, s63
    buffer_load_dwordx4 v244, s[32:35], s16 offen offset:0  lds
    v_mul_f32 v190, v190, v182
    v_mul_f32 v191, v191, v183
    v_cvt_pk_bf16_f32 v108, v191, v190
    v_cvt_pk_bf16_f32 v109, v189, v188
    v_cvt_pk_bf16_f32 v110, v187, v186
    buffer_load_dwordx4 v245, s[32:35], s16 offen offset:1024  lds
    v_cvt_pk_bf16_f32 v111, v185, v184
    s_mov_b32 s89, 32768
    buffer_store_dwordx4 v[108:111], v12, s[52:55], s89 offen sc1
    v_and_b32 v160, 0xffff0000, v41
    v_and_b32 v161, 0xffff0000, v43
    v_and_b32 v162, 0xffff0000, v45
    buffer_load_dwordx4 v246, s[32:35], s16 offen offset:2048  lds
    v_and_b32 v163, 0xffff0000, v47
    v_and_b32 v164, 0xffff0000, v49
    v_and_b32 v165, 0xffff0000, v51
    v_and_b32 v166, 0xffff0000, v53
    v_and_b32 v167, 0xffff0000, v55
    s_add_u32 s97, s98, s0
    s_lshr_b64 s[0:1], s[0:1], 4
    s_and_b32 s97, s97, 15
    s_add_u32 m0, s87, 18432
    s_lshl_b32 s97, s97, 7
    buffer_load_dwordx4 v240, s[28:31], s97 offen offset:0  lds
    v_and_b32 v168, 0xffff0000, v57
    v_and_b32 v169, 0xffff0000, v59
    v_and_b32 v170, 0xffff0000, v61
    v_lshlrev_b32 v172, 16, v90
    v_and_b32 v173, 0xffff0000, v90
    buffer_load_dwordx4 v241, s[28:31], s97 offen offset:1024  lds
    v_lshlrev_b32 v174, 16, v91
    v_and_b32 v175, 0xffff0000, v91
    v_and_b32 v176, 0xffff0000, v69
    v_and_b32 v177, 0xffff0000, v71
    v_and_b32 v178, 0xffff0000, v73
    buffer_load_dwordx4 v242, s[28:31], s97 offen offset:2048  lds
    v_and_b32 v179, 0xffff0000, v75
    v_and_b32 v180, 0xffff0000, v77
    v_and_b32 v181, 0xffff0000, v79
    v_and_b32 v182, 0xffff0000, v81
    v_and_b32 v183, 0xffff0000, v83
    buffer_load_dwordx4 v243, s[28:31], s97 offen offset:3072  lds
    v_mul_f32 v184, v160, v175
    v_mul_f32 v185, v161, v175
    v_mul_f32 v186, v162, v175
    v_mul_f32 v187, v163, v175
    v_mul_f32 v188, v164, v175
    s_add_u32 m0, s88, 18432
    s_mov_b64 exec, 0xffffffff
    buffer_load_dwordx4 v3, s[28:31], s97 offen offset:0  lds
    s_mov_b64 exec, -1
    v_mul_f32 v189, v165, v175
    v_mul_f32 v190, v166, v175
    v_mul_f32 v191, v167, v175
    v_fmac_f32 v184, v161, v174
    v_fmac_f32 v185, v162, v174
    v_fmac_f32 v186, v163, v174
    v_fmac_f32 v187, v164, v174
    v_fmac_f32 v188, v165, v174
    v_fmac_f32 v189, v166, v174
    v_fmac_f32 v190, v167, v174
    v_fmac_f32 v191, v168, v174
    v_fmac_f32 v184, v162, v173
    v_fmac_f32 v185, v163, v173
    v_fmac_f32 v186, v164, v173
    v_fmac_f32 v187, v165, v173
    v_fmac_f32 v188, v166, v173
    v_fmac_f32 v189, v167, v173
    v_fmac_f32 v190, v168, v173
    v_fmac_f32 v191, v169, v173
    v_fmac_f32 v184, v163, v172
    v_fmac_f32 v185, v164, v172
    v_fmac_f32 v186, v165, v172
    v_fmac_f32 v187, v166, v172
    v_fmac_f32 v188, v167, v172
    v_fmac_f32 v189, v168, v172
    v_fmac_f32 v190, v169, v172
    v_fmac_f32 v191, v170, v172
    v_mul_f32 v184, v184, v176
    v_mul_f32 v185, v185, v177
    v_mul_f32 v186, v186, v178
    v_mul_f32 v187, v187, v179
    v_mul_f32 v188, v188, v180
    v_mul_f32 v189, v189, v181
    v_mul_f32 v190, v190, v182
    v_mul_f32 v191, v191, v183
    v_cvt_pk_bf16_f32 v112, v191, v190
    v_cvt_pk_bf16_f32 v113, v189, v188
    v_cvt_pk_bf16_f32 v114, v187, v186
    v_cvt_pk_bf16_f32 v115, v185, v184
    s_mov_b32 s89, 49152
    buffer_store_dwordx4 v[112:115], v12, s[52:55], s89 offen sc1
    s_waitcnt vmcnt(13)
    s_barrier
    s_mul_i32 s16, s97, 3072
    s_add_u32 m0, s60, 24576
    s_add_u32 s99, s16, s62
    buffer_load_dwordx4 v244, s[32:35], s99 offen offset:0  lds
    s_mov_b32 s68, s24
    s_mov_b32 s69, s25
    s_mov_b32 s70, 0x100
    s_mov_b32 s71, 0x20000
    buffer_load_dwordx4 v245, s[32:35], s99 offen offset:1024  lds
    v_lshrrev_b32 v6, 5, v0
    v_and_b32 v7, 3, v0
    s_lshr_b32 s78, s90, 1
    s_lshl_b32 s78, s78, 2
    buffer_load_dwordx4 v246, s[32:35], s99 offen offset:2048  lds
    s_load_dword s92, s[14:15], s78
    v_bfe_u32 v5, v0, 2, 2
    v_lshlrev_b32 v5, 1, v5
    s_add_u32 m0, s61, 36864
    s_add_u32 s16, s16, s63
    buffer_load_dwordx4 v244, s[32:35], s16 offen offset:0  lds
    v_lshl_add_u32 v5, v6, 3, v5
    v_bfe_u32 v8, v0, 4, 1
    v_add_u32 v5, v5, v8
    s_and_b32 s78, s3, 1
    buffer_load_dwordx4 v245, s[32:35], s16 offen offset:1024  lds
    s_lshl_b32 s78, s78, 1
    v_add_u32 v8, s78, v6
    v_xor_b32 v8, v8, v7
    v_lshlrev_b32 v8, 4, v8
    buffer_load_dwordx4 v246, s[32:35], s16 offen offset:2048  lds
    v_lshl_add_u32 v5, v5, 6, v8
    v_add_u32 v14, s86, v5
    v_mov_b32 v18, 162304
    s_add_u32 s97, s98, s0
    s_lshr_b64 s[0:1], s[0:1], 4
    s_and_b32 s97, s97, 15
    s_add_u32 m0, s87, 36864
    s_lshl_b32 s97, s97, 7
    buffer_load_dwordx4 v240, s[28:31], s97 offen offset:0  lds
    v_mov_b32 v19, 1
    v_and_b32 v5, 3, v0
    s_lshl_b32 s78, s74, 4
    s_add_u32 s78, s78, s3
    buffer_load_dwordx4 v241, s[28:31], s97 offen offset:1024  lds
    v_lshl_add_u32 v6, v5, 2, s78
    s_lshr_b32 s78, s76, 3
    s_lshl_b32 s79, s3, 1
    s_add_u32 s78, s78, s79
    buffer_load_dwordx4 v242, s[28:31], s97 offen offset:2048  lds
    s_xor_b32 s78, s78, 2
    s_lshl_b32 s78, s78, 5
    s_add_u32 s79, s76, 5
    buffer_load_dwordx4 v243, s[28:31], s97 offen offset:3072  lds
    s_and_b32 s79, s79, 7
    s_lshl_b32 s79, s79, 1
    s_add_u32 s78, s78, s79
    v_mul_u32_u24 v7, 9, v5
    s_add_u32 m0, s88, 36864
    s_mov_b64 exec, 0xffffffff
    buffer_load_dwordx4 v3, s[28:31], s97 offen offset:0  lds
    s_mov_b64 exec, -1
    v_and_b32 v7, 17, v7
    v_add_u32 v7, s78, v7
    v_and_b32 v8, 4, v0
    s_waitcnt vmcnt(12)
    s_waitcnt vmcnt(11)
    s_barrier
    s_mul_i32 s16, s97, 3072
    s_add_u32 m0, s60, 49152
    s_add_u32 s99, s16, s62
    buffer_load_dwordx4 v244, s[32:35], s99 offen offset:0  lds
    v_cmp_eq_u32 vcc, 0, v8
    s_nop 1
    v_cndmask_b32 v6, v7, v6, vcc
    v_and_b32 v33, 0xf0, v6
    v_lshlrev_b32 v34, 8, v6
    buffer_load_dwordx4 v245, s[32:35], s99 offen offset:1024  lds
    v_add_u32 v34, 12582912, v34
    v_and_b32 v5, 15, v0
    v_lshrrev_b32 v6, 4, v0
    v_add_u32 v7, 9, v5
    buffer_load_dwordx4 v246, s[32:35], s99 offen offset:2048  lds
    v_and_b32 v8, 1, v7
    v_mul_u32_u24 v8, 4160, v8
    v_lshrrev_b32 v7, 1, v7
    s_add_u32 m0, s61, 61440
    s_add_u32 s16, s16, s63
    buffer_load_dwordx4 v244, s[32:35], s16 offen offset:0  lds
    v_lshl_add_u32 v8, v7, 2, v8
    v_lshlrev_b32 v7, 4, v6
    v_sub_u32 v8, v8, v7
    s_add_u32 s78, s94, 32
    buffer_load_dwordx4 v245, s[32:35], s16 offen offset:1024  lds
    v_add_u32 v21, s78, v8
    v_add_u32 v22, 1024, v21
    v_add_u32 v23, 2048, v21
    v_add_u32 v24, 3072, v21
    buffer_load_dwordx4 v246, s[32:35], s16 offen offset:2048  lds
    v_lshl_add_u32 v7, v5, 1, v6
    v_add_u32 v7, 30, v7
    v_and_b32 v8, 1, v7
    s_add_u32 s97, s98, s0
    s_lshr_b64 s[0:1], s[0:1], 4
    s_and_b32 s97, s97, 15
    s_add_u32 m0, s87, 0
    s_lshl_b32 s97, s97, 7
    buffer_load_dwordx4 v240, s[28:31], s97 offen offset:0  lds
    v_bfe_u32 v136, v7, 1, 2
    v_lshl_add_u32 v136, v8, 2, v136
    v_lshlrev_b32 v136, 6, v136
    v_lshrrev_b32 v7, 3, v7
    buffer_load_dwordx4 v241, s[28:31], s97 offen offset:1024  lds
    v_lshl_add_u32 v136, v7, 9, v136
    v_bitop3_b32 v8, v7, 3, s3 bitop3:0x6a
    v_lshl_add_u32 v25, v8, 4, v136
    v_add_u32 v25, 92160, v25
    buffer_load_dwordx4 v242, s[28:31], s97 offen offset:2048  lds
    v_subrev_u32 v7, 1, v7
    v_bitop3_b32 v8, v7, 3, s3 bitop3:0x6a
    v_lshl_add_u32 v27, v8, 4, v136
    buffer_load_dwordx4 v243, s[28:31], s97 offen offset:3072  lds
    v_add_u32 v27, 91648, v27
    v_subrev_u32 v7, 1, v7
    v_bitop3_b32 v8, v7, 3, s3 bitop3:0x6a
    v_lshl_add_u32 v29, v8, 4, v136
    s_add_u32 m0, s88, 0
    s_mov_b64 exec, 0xffffffff
    buffer_load_dwordx4 v3, s[28:31], s97 offen offset:0  lds
    s_mov_b64 exec, -1
    v_add_u32 v29, 91136, v29
    v_subrev_u32 v7, 1, v7
    v_bitop3_b32 v8, v7, 3, s3 bitop3:0x6a
    s_waitcnt vmcnt(11)
    s_barrier
    s_mul_i32 s16, s97, 3072
    s_add_u32 m0, s60, 0
    s_add_u32 s99, s16, s62
    buffer_load_dwordx4 v244, s[32:35], s99 offen offset:0  lds
    v_lshl_add_u32 v31, v8, 4, v136
    v_add_u32 v31, 90624, v31
    v_lshl_add_u32 v7, v5, 1, v6
    buffer_load_dwordx4 v245, s[32:35], s99 offen offset:1024  lds
    v_add_u32 v7, 26, v7
    v_and_b32 v8, 1, v7
    v_bfe_u32 v136, v7, 1, 2
    buffer_load_dwordx4 v246, s[32:35], s99 offen offset:2048  lds
    v_lshl_add_u32 v136, v8, 2, v136
    v_lshlrev_b32 v136, 6, v136
    s_add_u32 m0, s61, 12288
    s_add_u32 s16, s16, s63
    buffer_load_dwordx4 v244, s[32:35], s16 offen offset:0  lds
    v_lshrrev_b32 v7, 3, v7
    v_lshl_add_u32 v136, v7, 9, v136
    v_bitop3_b32 v8, v7, 3, s3 bitop3:0x6a
    buffer_load_dwordx4 v245, s[32:35], s16 offen offset:1024  lds
    v_lshl_add_u32 v26, v8, 4, v136
    v_add_u32 v26, 92160, v26
    v_subrev_u32 v7, 1, v7
    buffer_load_dwordx4 v246, s[32:35], s16 offen offset:2048  lds
    v_bitop3_b32 v8, v7, 3, s3 bitop3:0x6a
    v_lshl_add_u32 v28, v8, 4, v136
    s_add_u32 m0, s94, 32
    s_lshl_b32 s89, s90, 12
    buffer_load_dwordx4 v15, s[48:51], s89 offen offset:0 nt lds
    v_add_u32 v28, 91648, v28
    v_subrev_u32 v7, 1, v7
    v_bitop3_b32 v8, v7, 3, s3 bitop3:0x6a
    s_add_u32 m0, s94, 32
    s_lshl_b32 s89, s90, 12
    buffer_load_dwordx4 v15, s[48:51], s89 offen offset:1024 nt lds
    v_lshl_add_u32 v30, v8, 4, v136
    v_add_u32 v30, 91136, v30
    v_subrev_u32 v7, 1, v7
    s_add_u32 m0, s94, 32
    s_lshl_b32 s89, s90, 12
    buffer_load_dwordx4 v15, s[48:51], s89 offen offset:2048 nt lds
    v_bitop3_b32 v8, v7, 3, s3 bitop3:0x6a
    v_lshl_add_u32 v32, v8, 4, v136
    s_add_u32 m0, s94, 32
    s_lshl_b32 s89, s90, 12
    buffer_load_dwordx4 v15, s[48:51], s89 offen offset:3072 nt lds
    v_add_u32 v32, 90624, v32
    v_lshrrev_b32 v7, 1, v6
    v_lshl_add_u32 v7, v5, 1, v7
    s_add_u32 s97, s98, s0
    s_lshr_b64 s[0:1], s[0:1], 4
    s_and_b32 s97, s97, 15
    s_add_u32 m0, s87, 18432
    s_lshl_b32 s97, s97, 7
    buffer_load_dwordx4 v240, s[28:31], s97 offen offset:0  lds
    v_add_u32 v7, 32, v7
    v_and_b32 v8, 1, v7
    v_bfe_u32 v136, v7, 1, 2
    buffer_load_dwordx4 v241, s[28:31], s97 offen offset:1024  lds
    v_lshl_add_u32 v136, v8, 2, v136
    v_lshlrev_b32 v136, 6, v136
    buffer_load_dwordx4 v242, s[28:31], s97 offen offset:2048  lds
    v_lshrrev_b32 v7, 3, v7
    v_lshl_add_u32 v136, v7, 9, v136
    v_bitop3_b32 v8, v7, 3, s3 bitop3:0x6a
    buffer_load_dwordx4 v243, s[28:31], s97 offen offset:3072  lds
    v_lshl_add_u32 v20, v8, 4, v136
    v_add_u32 v20, 92160, v20
    v_and_b32 v8, 1, v6
    s_add_u32 m0, s88, 18432
    s_mov_b64 exec, 0xffffffff
    buffer_load_dwordx4 v3, s[28:31], s97 offen offset:0  lds
    s_mov_b64 exec, -1
    v_xor_b32 v8, 1, v8
    v_lshl_add_u32 v20, v8, 3, v20
    s_waitcnt vmcnt(15)
    s_barrier
    s_mul_i32 s16, s97, 3072
    s_add_u32 m0, s60, 24576
    s_add_u32 s99, s16, s62
    buffer_load_dwordx4 v244, s[32:35], s99 offen offset:0  lds
    s_waitcnt lgkmcnt(0)
    s_and_b32 s78, s92, 0xffff0000
    s_lshl_b32 s92, s92, 16
    buffer_load_dwordx4 v245, s[32:35], s99 offen offset:1024  lds
    s_bitcmp1_b32 s90, 0
    s_cselect_b32 s92, s78, s92
    v_lshlrev_b32 v7, 3, v6
    v_sub_u32 v7, v7, v5
    buffer_load_dwordx4 v246, s[32:35], s99 offen offset:2048  lds
    v_subrev_u32 v7, 9, v7
    v_and_b32 v8, 1, v7
    v_xor_b32 v8, 1, v8
    s_add_u32 m0, s61, 36864
    s_add_u32 s16, s16, s63
    buffer_load_dwordx4 v244, s[32:35], s16 offen offset:0  lds
    v_lshlrev_b32 v8, 4, v8
    v_lshrrev_b32 v8, v8, s92
    v_ashrrev_i32 v7, 1, v7
    buffer_load_dwordx4 v245, s[32:35], s16 offen offset:1024  lds
    v_cmp_eq_u32 vcc, 0, v7
    s_nop 1
    v_cndmask_b32 v236, 0, v8, vcc
    v_cmp_eq_u32 vcc, 1, v7
    buffer_load_dwordx4 v246, s[32:35], s16 offen offset:2048  lds
    s_nop 0
    v_cndmask_b32 v237, 0, v8, vcc
    v_cmp_eq_u32 vcc, 2, v7
    s_nop 1
    v_cndmask_b32 v238, 0, v8, vcc
    s_add_u32 s97, s98, s0
    s_lshr_b64 s[0:1], s[0:1], 4
    s_and_b32 s97, s97, 15
    s_add_u32 m0, s87, 36864
    s_lshl_b32 s97, s97, 7
    buffer_load_dwordx4 v240, s[28:31], s97 offen offset:0  lds
    v_cmp_eq_u32 vcc, 3, v7
    s_nop 1
    v_cndmask_b32 v239, 0, v8, vcc
    s_and_b32 s78, s77, 7
    s_mov_b32 s95, 0x76543210
    s_and_b32 s78, s76, 3
    s_mul_i32 s78, s78, 0x22222222
    s_add_u32 s95, s95, s78
    s_bfe_u32 s17, s95, 0x30000
    s_lshl_b32 s17, s17, 18
    s_bfe_u32 s18, s95, 0x30004
    s_lshl_b32 s18, s18, 18
    s_bfe_u32 s100, s95, 0x3001c
    s_lshl_b32 s100, s100, 18
    s_bfe_u32 s95, s95, 0x30018
    s_lshl_b32 s95, s95, 18
    buffer_load_dwordx4 v241, s[28:31], s97 offen offset:1024  lds
    v_lshrrev_b32 v136, 4, v0
    v_lshlrev_b32 v136, 1, v136
    v_and_b32 v137, 7, v0
    buffer_load_dwordx4 v242, s[28:31], s97 offen offset:2048  lds
    v_xor_b32 v136, v136, v137
    v_lshlrev_b32 v136, 4, v136
    v_lshrrev_b32 v137, 3, v0
    buffer_load_dwordx4 v243, s[28:31], s97 offen offset:3072  lds
    v_lshl_add_u32 v136, v137, 11, v136
    s_lshl_b32 s78, s77, 7
    s_lshl_b32 s79, s3, 14
    s_add_u32 m0, s88, 36864
    s_mov_b64 exec, 0xffffffff
    buffer_load_dwordx4 v3, s[28:31], s97 offen offset:0  lds
    s_mov_b64 exec, -1
    s_add_u32 s78, s78, s79
    v_add_u32 v17, s78, v136
    s_waitcnt vmcnt(11)
    s_barrier
    s_mul_i32 s16, s97, 3072
    s_add_u32 m0, s60, 49152
    s_add_u32 s99, s16, s62
    buffer_load_dwordx4 v244, s[32:35], s99 offen offset:0  lds
    v_add_u32 v5, s94, v15
    ds_read_b128 v[140:143], v5 offset:32
    ds_read_b32 v156, v5 offset:48
    ds_read_b128 v[144:147], v5 offset:1056
    buffer_load_dwordx4 v245, s[32:35], s99 offen offset:1024  lds
    ds_read_b32 v157, v5 offset:1072
    ds_read_b128 v[148:151], v5 offset:2080
    ds_read_b32 v158, v5 offset:2096
    ds_read_b128 v[152:155], v5 offset:3104
    buffer_load_dwordx4 v246, s[32:35], s99 offen offset:2048  lds
    ds_read_b32 v159, v5 offset:3120
    v_lshrrev_b32 v6, 3, v0
    v_mul_u32_u24 v6, 4160, v6
    s_add_u32 m0, s61, 61440
    s_add_u32 s16, s16, s63
    buffer_load_dwordx4 v244, s[32:35], s16 offen offset:0  lds
    v_and_b32 v7, 7, v0
    v_lshl_add_u32 v6, v7, 2, v6
    v_add_u32 v6, s94, v6
    v_mov_b32 v7, 0
    buffer_load_dwordx4 v245, s[32:35], s16 offen offset:1024  lds
    s_waitcnt lgkmcnt(0)
    v_readfirstlane_b32 s93, v140
    s_nop 0
    s_lshl_b32 s93, s93, 16
    s_nop 1
    v_writelane_b32 v7, s93, 15
    buffer_load_dwordx4 v246, s[32:35], s16 offen offset:2048  lds
    v_alignbit_b32 v140, v141, v140, 16
    v_alignbit_b32 v141, v142, v141, 16
    v_alignbit_b32 v142, v143, v142, 16
    s_add_u32 s97, s98, s0
    s_lshr_b64 s[0:1], s[0:1], 4
    s_and_b32 s97, s97, 15
    s_add_u32 m0, s87, 0
    s_lshl_b32 s97, s97, 7
    buffer_load_dwordx4 v240, s[28:31], s97 offen offset:0  lds
    v_alignbit_b32 v143, v156, v143, 16
    v_alignbit_b32 v144, v145, v144, 16
    v_alignbit_b32 v145, v146, v145, 16
    v_alignbit_b32 v146, v147, v146, 16
    buffer_load_dwordx4 v241, s[28:31], s97 offen offset:1024  lds
    v_alignbit_b32 v147, v157, v147, 16
    v_alignbit_b32 v148, v149, v148, 16
    v_alignbit_b32 v149, v150, v149, 16
    v_alignbit_b32 v150, v151, v150, 16
    buffer_load_dwordx4 v242, s[28:31], s97 offen offset:2048  lds
    v_alignbit_b32 v151, v158, v151, 16
    v_alignbit_b32 v152, v153, v152, 16
    v_alignbit_b32 v153, v154, v153, 16
    buffer_load_dwordx4 v243, s[28:31], s97 offen offset:3072  lds
    v_alignbit_b32 v154, v155, v154, 16
    v_alignbit_b32 v155, v159, v155, 16
    v_lshlrev_b32 v8, 3, v0
    s_add_u32 s78, s88, 18432
    s_add_u32 m0, s88, 0
    s_mov_b64 exec, 0xffffffff
    buffer_load_dwordx4 v3, s[28:31], s97 offen offset:0  lds
    s_mov_b64 exec, -1
    v_add_u32 v8, s78, v8
    v_mov_b32 v156, 0
    v_mov_b32 v157, 0
    s_waitcnt vmcnt(11)
    s_barrier
    s_mul_i32 s16, s97, 3072
    s_add_u32 m0, s60, 0
    s_add_u32 s99, s16, s62
    buffer_load_dwordx4 v244, s[32:35], s99 offen offset:0  lds
    buffer_load_dwordx4 v245, s[32:35], s99 offen offset:1024  lds
    buffer_load_dwordx4 v246, s[32:35], s99 offen offset:2048  lds
    s_add_u32 m0, s61, 12288
    s_add_u32 s16, s16, s63
    buffer_load_dwordx4 v244, s[32:35], s16 offen offset:0  lds
    buffer_load_dwordx4 v245, s[32:35], s16 offen offset:1024  lds
    buffer_load_dwordx4 v246, s[32:35], s16 offen offset:2048  lds
    s_mov_b64 exec, 0xff
    buffer_load_dword v136, v33, s[68:71], 0 offen sc1
    buffer_load_dword v137, v34, s[52:55], 0 offen sc1
    s_mov_b64 exec, -1
    buffer_load_dwordx4 v[212:215], v9, s[56:59], 0 offen offset:0 nt
    buffer_load_dwordx4 v[216:219], v9, s[56:59], 0 offen offset:2048 nt
    buffer_load_dwordx4 v[220:223], v9, s[56:59], s96 offen offset:0 nt
    buffer_load_dwordx4 v[224:227], v9, s[56:59], s96 offen offset:2048 nt
    s_waitcnt vmcnt(12)
    s_waitcnt vmcnt(6)
    s_barrier
    s_waitcnt vmcnt(4)
LA_j:
    s_mov_b64 exec, 0xff
    v_cmp_ne_u32 vcc, v136, v137
    v_cmp_gt_u32 s[80:81], s96, v136
    s_nop 0
    s_or_b64 vcc, vcc, s[80:81]
    s_cbranch_vccnz LA_slow
LA_back:
    s_mov_b64 exec, -1
    s_add_u32 m0, s86, 94208
    s_add_u32 s89, s91, 0
    buffer_load_dwordx4 v14, s[52:55], s89 offen sc1 lds
    s_add_u32 m0, s86, 98304
    s_add_u32 s89, s91, 4096
    buffer_load_dwordx4 v14, s[52:55], s89 offen sc1 lds
    s_add_u32 m0, s86, 102400
    s_add_u32 s89, s91, 8192
    buffer_load_dwordx4 v14, s[52:55], s89 offen sc1 lds
    s_add_u32 m0, s86, 106496
    s_add_u32 s89, s91, 12288
    buffer_load_dwordx4 v14, s[52:55], s89 offen sc1 lds
    s_mov_b64 exec, 0xffff
    ds_write_b32 v6, v7
    s_mov_b64 exec, -1
    ds_write_b128 v5, v[140:143] offset:4192
    ds_write_b128 v5, v[144:147] offset:5216
    ds_write_b128 v5, v[148:151] offset:6240
    ds_write_b128 v5, v[152:155] offset:7264
    ds_write_b64 v8, v[156:157]
    s_add_u32 s89, s95, 131072
    buffer_load_dwordx4 v[228:231], v17, s[64:67], s89 offen
    s_add_u32 s89, s95, 196608
    buffer_load_dwordx4 v[232:235], v17, s[64:67], s89 offen
    s_add_u32 s89, s100, 0
    buffer_load_dwordx4 v[240:243], v17, s[64:67], s89 offen
    s_add_u32 s89, s100, 65536
    buffer_load_dwordx4 v[244:247], v17, s[64:67], s89 offen
    s_add_u32 s89, s100, 131072
    buffer_load_dwordx4 v[248:251], v17, s[64:67], s89 offen
    s_add_u32 s89, s100, 196608
    buffer_load_dwordx4 v[196:199], v17, s[64:67], s89 offen
    ds_read2_b32 v[68:69], v21 offset0:0 offset1:1
    ds_read2_b32 v[70:71], v21 offset0:2 offset1:3
    ds_read2_b32 v[72:73], v21 offset0:128 offset1:129
    ds_read2_b32 v[74:75], v21 offset0:130 offset1:131
    ds_read2_b32 v[76:77], v22 offset0:0 offset1:1
    ds_read2_b32 v[78:79], v22 offset0:2 offset1:3
    ds_read2_b32 v[80:81], v22 offset0:128 offset1:129
    ds_read2_b32 v[82:83], v22 offset0:130 offset1:131
    ds_read2_b32 v[84:85], v23 offset0:0 offset1:1
    ds_read2_b32 v[86:87], v23 offset0:2 offset1:3
    ds_read2_b32 v[88:89], v23 offset0:128 offset1:129
    ds_read2_b32 v[90:91], v23 offset0:130 offset1:131
    ds_read2_b32 v[92:93], v24 offset0:0 offset1:1
    ds_read2_b32 v[94:95], v24 offset0:2 offset1:3
    ds_read2_b32 v[96:97], v24 offset0:128 offset1:129
    ds_read2_b32 v[98:99], v24 offset0:130 offset1:131
    s_waitcnt vmcnt(6)
    s_mov_b64 exec, 1
    ds_add_u32 v18, v19 offset:20
    s_mov_b64 exec, -1
    s_branch LA_s5_in
LA_s5:
    s_sleep 1
LA_s5_in:
    ds_read_b32 v6, v18 offset:20
    s_waitcnt lgkmcnt(0)
    v_readfirstlane_b32 s78, v6
    s_nop 0
    s_cmp_ge_u32 s78, 4
    s_cbranch_scc0 LA_s5
    s_mov_b64 exec, 1
    ds_add_u32 v18, v19 offset:8
    s_mov_b64 exec, -1
    ds_read_b128 v[100:103], v25 offset:0
    ds_read_b128 v[104:107], v25 offset:2048
    ds_read_b128 v[108:111], v25 offset:4096
    ds_read_b128 v[112:115], v25 offset:6144
    ds_read_b128 v[116:119], v25 offset:8192
    ds_read_b128 v[120:123], v25 offset:10240
    ds_read_b128 v[124:127], v25 offset:12288
    ds_read_b128 v[128:131], v25 offset:14336
    s_setprio 2
    s_waitcnt lgkmcnt(7)
    v_mfma_f32_16x16x32_bf16 v[36:39], v[236:239], v[100:103], 0
    ds_read2_b32 v[132:133], v21 offset0:16 offset1:17
    v_mfma_f32_16x16x32_bf16 v[36:39], v[68:71], v[100:103], v[36:39]
    ds_read2_b32 v[134:135], v21 offset0:18 offset1:19
    s_waitcnt lgkmcnt(8)
    v_mfma_f32_16x16x32_bf16 v[40:43], v[236:239], v[104:107], 0
    v_mfma_f32_16x16x32_bf16 v[40:43], v[68:71], v[104:107], v[40:43]
    ds_read_b128 v[164:167], v26 offset:0
    v_mfma_f32_16x16x32_bf16 v[40:43], v[72:75], v[100:103], v[40:43]
    s_waitcnt lgkmcnt(8)
    v_mfma_f32_16x16x32_bf16 v[44:47], v[236:239], v[108:111], 0
    ds_read2_b32 v[136:137], v21 offset0:144 offset1:145
    v_mfma_f32_16x16x32_bf16 v[44:47], v[68:71], v[108:111], v[44:47]
    ds_read2_b32 v[138:139], v21 offset0:146 offset1:147
    v_mfma_f32_16x16x32_bf16 v[44:47], v[72:75], v[104:107], v[44:47]
    v_mfma_f32_16x16x32_bf16 v[44:47], v[76:79], v[100:103], v[44:47]
    ds_read_b128 v[168:171], v26 offset:2048
    s_waitcnt lgkmcnt(10)
    v_mfma_f32_16x16x32_bf16 v[48:51], v[236:239], v[112:115], 0
    v_mfma_f32_16x16x32_bf16 v[48:51], v[68:71], v[112:115], v[48:51]
    ds_read2_b32 v[140:141], v22 offset0:16 offset1:17
    v_mfma_f32_16x16x32_bf16 v[48:51], v[72:75], v[108:111], v[48:51]
    ds_read2_b32 v[142:143], v22 offset0:18 offset1:19
    v_mfma_f32_16x16x32_bf16 v[48:51], v[76:79], v[104:107], v[48:51]
    v_mfma_f32_16x16x32_bf16 v[48:51], v[80:83], v[100:103], v[48:51]
    ds_read_b128 v[172:175], v26 offset:4096
    s_waitcnt lgkmcnt(12)
    v_mfma_f32_16x16x32_bf16 v[52:55], v[236:239], v[116:119], 0
    v_mfma_f32_16x16x32_bf16 v[52:55], v[68:71], v[116:119], v[52:55]
    ds_read2_b32 v[144:145], v22 offset0:144 offset1:145
    v_mfma_f32_16x16x32_bf16 v[52:55], v[72:75], v[112:115], v[52:55]
    ds_read2_b32 v[146:147], v22 offset0:146 offset1:147
    v_mfma_f32_16x16x32_bf16 v[52:55], v[76:79], v[108:111], v[52:55]
    v_mfma_f32_16x16x32_bf16 v[52:55], v[80:83], v[104:107], v[52:55]
    ds_read_b128 v[176:179], v26 offset:6144
    v_mfma_f32_16x16x32_bf16 v[52:55], v[84:87], v[100:103], v[52:55]
    s_waitcnt lgkmcnt(14)
    v_mfma_f32_16x16x32_bf16 v[56:59], v[236:239], v[120:123], 0
    ds_read2_b32 v[148:149], v23 offset0:16 offset1:17
    v_mfma_f32_16x16x32_bf16 v[56:59], v[68:71], v[120:123], v[56:59]
    ds_read2_b32 v[150:151], v23 offset0:18 offset1:19
    v_mfma_f32_16x16x32_bf16 v[56:59], v[72:75], v[116:119], v[56:59]
    v_mfma_f32_16x16x32_bf16 v[56:59], v[76:79], v[112:115], v[56:59]
    ds_read_b128 v[180:183], v26 offset:8192
    v_mfma_f32_16x16x32_bf16 v[56:59], v[80:83], v[108:111], v[56:59]
    v_mfma_f32_16x16x32_bf16 v[56:59], v[84:87], v[104:107], v[56:59]
    ds_read2_b32 v[152:153], v23 offset0:144 offset1:145
    v_mfma_f32_16x16x32_bf16 v[56:59], v[88:91], v[100:103], v[56:59]
    ds_read2_b32 v[154:155], v23 offset0:146 offset1:147
    s_waitcnt lgkmcnt(14)
    v_mfma_f32_16x16x32_bf16 v[60:63], v[236:239], v[124:127], 0
    v_mfma_f32_16x16x32_bf16 v[60:63], v[68:71], v[124:127], v[60:63]
    ds_read_b128 v[184:187], v26 offset:10240
    v_mfma_f32_16x16x32_bf16 v[60:63], v[72:75], v[120:123], v[60:63]
    v_mfma_f32_16x16x32_bf16 v[60:63], v[76:79], v[116:119], v[60:63]
    ds_read2_b32 v[156:157], v24 offset0:16 offset1:17
    v_mfma_f32_16x16x32_bf16 v[60:63], v[80:83], v[112:115], v[60:63]
    ds_read2_b32 v[158:159], v24 offset0:18 offset1:19
    v_mfma_f32_16x16x32_bf16 v[60:63], v[84:87], v[108:111], v[60:63]
    v_mfma_f32_16x16x32_bf16 v[60:63], v[88:91], v[104:107], v[60:63]
    ds_read_b128 v[188:191], v26 offset:12288
    v_mfma_f32_16x16x32_bf16 v[60:63], v[92:95], v[100:103], v[60:63]
    v_mfma_f32_16x16x32_bf16 v[64:67], v[236:239], v[128:131], 0
    ds_read2_b32 v[160:161], v24 offset0:144 offset1:145
    v_mfma_f32_16x16x32_bf16 v[64:67], v[68:71], v[128:131], v[64:67]
    ds_read2_b32 v[162:163], v24 offset0:146 offset1:147
    v_mfma_f32_16x16x32_bf16 v[64:67], v[72:75], v[124:127], v[64:67]
    v_mfma_f32_16x16x32_bf16 v[64:67], v[76:79], v[120:123], v[64:67]
    ds_read_b128 v[192:195], v26 offset:14336
    v_mfma_f32_16x16x32_bf16 v[64:67], v[80:83], v[116:119], v[64:67]
    v_mfma_f32_16x16x32_bf16 v[64:67], v[84:87], v[112:115], v[64:67]
    v_mfma_f32_16x16x32_bf16 v[64:67], v[88:91], v[108:111], v[64:67]
    v_mfma_f32_16x16x32_bf16 v[64:67], v[92:95], v[104:107], v[64:67]
    v_mfma_f32_16x16x32_bf16 v[64:67], v[96:99], v[100:103], v[64:67]
    v_mfma_f32_16x16x32_bf16 v[36:39], v[132:135], v[164:167], v[36:39]
    ds_read2_b32 v[68:69], v21 offset0:32 offset1:33
    s_waitcnt lgkmcnt(14)
    v_mfma_f32_16x16x32_bf16 v[40:43], v[136:139], v[164:167], v[40:43]
    ds_read2_b32 v[70:71], v21 offset0:34 offset1:35
    v_mfma_f32_16x16x32_bf16 v[40:43], v[132:135], v[168:171], v[40:43]
    ds_read_b128 v[100:103], v27 offset:0
    v_mfma_f32_16x16x32_bf16 v[44:47], v[132:135], v[172:175], v[44:47]
    v_mfma_f32_16x16x32_bf16 v[44:47], v[136:139], v[168:171], v[44:47]
    ds_read2_b32 v[72:73], v21 offset0:160 offset1:161
    v_mfma_f32_16x16x32_bf16 v[44:47], v[140:143], v[164:167], v[44:47]
    ds_read2_b32 v[74:75], v21 offset0:162 offset1:163
    v_mfma_f32_16x16x32_bf16 v[48:51], v[144:147], v[164:167], v[48:51]
    ds_read_b128 v[104:107], v27 offset:2048
    v_mfma_f32_16x16x32_bf16 v[48:51], v[140:143], v[168:171], v[48:51]
    v_mfma_f32_16x16x32_bf16 v[48:51], v[136:139], v[172:175], v[48:51]
    ds_read2_b32 v[76:77], v22 offset0:32 offset1:33
    s_waitcnt lgkmcnt(14)
    v_mfma_f32_16x16x32_bf16 v[48:51], v[132:135], v[176:179], v[48:51]
    ds_read2_b32 v[78:79], v22 offset0:34 offset1:35
    v_mfma_f32_16x16x32_bf16 v[52:55], v[132:135], v[180:183], v[52:55]
    ds_read_b128 v[108:111], v27 offset:4096
    v_mfma_f32_16x16x32_bf16 v[52:55], v[136:139], v[176:179], v[52:55]
    v_mfma_f32_16x16x32_bf16 v[52:55], v[140:143], v[172:175], v[52:55]
    ds_read2_b32 v[80:81], v22 offset0:160 offset1:161
    v_mfma_f32_16x16x32_bf16 v[52:55], v[144:147], v[168:171], v[52:55]
    ds_read2_b32 v[82:83], v22 offset0:162 offset1:163
    v_mfma_f32_16x16x32_bf16 v[52:55], v[148:151], v[164:167], v[52:55]
    ds_read_b128 v[112:115], v27 offset:6144
    v_mfma_f32_16x16x32_bf16 v[56:59], v[152:155], v[164:167], v[56:59]
    v_mfma_f32_16x16x32_bf16 v[56:59], v[148:151], v[168:171], v[56:59]
    ds_read2_b32 v[84:85], v23 offset0:32 offset1:33
    v_mfma_f32_16x16x32_bf16 v[56:59], v[144:147], v[172:175], v[56:59]
    ds_read2_b32 v[86:87], v23 offset0:34 offset1:35
    v_mfma_f32_16x16x32_bf16 v[56:59], v[140:143], v[176:179], v[56:59]
    ds_read_b128 v[116:119], v27 offset:8192
    v_mfma_f32_16x16x32_bf16 v[56:59], v[136:139], v[180:183], v[56:59]
    s_waitcnt lgkmcnt(14)
    v_mfma_f32_16x16x32_bf16 v[56:59], v[132:135], v[184:187], v[56:59]
    ds_read2_b32 v[88:89], v23 offset0:160 offset1:161
    v_mfma_f32_16x16x32_bf16 v[60:63], v[132:135], v[188:191], v[60:63]
    ds_read2_b32 v[90:91], v23 offset0:162 offset1:163
    v_mfma_f32_16x16x32_bf16 v[60:63], v[136:139], v[184:187], v[60:63]
    ds_read_b128 v[120:123], v27 offset:10240
    v_mfma_f32_16x16x32_bf16 v[60:63], v[140:143], v[180:183], v[60:63]
    v_mfma_f32_16x16x32_bf16 v[60:63], v[144:147], v[176:179], v[60:63]
    ds_read2_b32 v[92:93], v24 offset0:32 offset1:33
    v_mfma_f32_16x16x32_bf16 v[60:63], v[148:151], v[172:175], v[60:63]
    ds_read2_b32 v[94:95], v24 offset0:34 offset1:35
    v_mfma_f32_16x16x32_bf16 v[60:63], v[152:155], v[168:171], v[60:63]
    ds_read_b128 v[124:127], v27 offset:12288
    v_mfma_f32_16x16x32_bf16 v[60:63], v[156:159], v[164:167], v[60:63]
    v_mfma_f32_16x16x32_bf16 v[64:67], v[160:163], v[164:167], v[64:67]
    ds_read2_b32 v[96:97], v24 offset0:160 offset1:161
    v_mfma_f32_16x16x32_bf16 v[64:67], v[156:159], v[168:171], v[64:67]
    ds_read2_b32 v[98:99], v24 offset0:162 offset1:163
    v_mfma_f32_16x16x32_bf16 v[64:67], v[152:155], v[172:175], v[64:67]
    ds_read_b128 v[128:131], v27 offset:14336
    v_mfma_f32_16x16x32_bf16 v[64:67], v[148:151], v[176:179], v[64:67]
    v_mfma_f32_16x16x32_bf16 v[64:67], v[144:147], v[180:183], v[64:67]
    v_mfma_f32_16x16x32_bf16 v[64:67], v[140:143], v[184:187], v[64:67]
    v_mfma_f32_16x16x32_bf16 v[64:67], v[136:139], v[188:191], v[64:67]
    v_mfma_f32_16x16x32_bf16 v[64:67], v[132:135], v[192:195], v[64:67]
    s_waitcnt lgkmcnt(14)
    v_mfma_f32_16x16x32_bf16 v[36:39], v[68:71], v[100:103], v[36:39]
    ds_read2_b32 v[132:133], v21 offset0:48 offset1:49
    v_mfma_f32_16x16x32_bf16 v[40:43], v[72:75], v[100:103], v[40:43]
    ds_read2_b32 v[134:135], v21 offset0:50 offset1:51
    v_mfma_f32_16x16x32_bf16 v[40:43], v[68:71], v[104:107], v[40:43]
    ds_read_b128 v[164:167], v28 offset:0
    v_mfma_f32_16x16x32_bf16 v[44:47], v[68:71], v[108:111], v[44:47]
    v_mfma_f32_16x16x32_bf16 v[44:47], v[72:75], v[104:107], v[44:47]
    ds_read2_b32 v[136:137], v21 offset0:176 offset1:177
    v_mfma_f32_16x16x32_bf16 v[44:47], v[76:79], v[100:103], v[44:47]
    ds_read2_b32 v[138:139], v21 offset0:178 offset1:179
    s_waitcnt lgkmcnt(14)
    v_mfma_f32_16x16x32_bf16 v[48:51], v[80:83], v[100:103], v[48:51]
    ds_read_b128 v[168:171], v28 offset:2048
    v_mfma_f32_16x16x32_bf16 v[48:51], v[76:79], v[104:107], v[48:51]
    v_mfma_f32_16x16x32_bf16 v[48:51], v[72:75], v[108:111], v[48:51]
    ds_read2_b32 v[140:141], v22 offset0:48 offset1:49
    v_mfma_f32_16x16x32_bf16 v[48:51], v[68:71], v[112:115], v[48:51]
    ds_read2_b32 v[142:143], v22 offset0:50 offset1:51
    v_mfma_f32_16x16x32_bf16 v[52:55], v[68:71], v[116:119], v[52:55]
    ds_read_b128 v[172:175], v28 offset:4096
    v_mfma_f32_16x16x32_bf16 v[52:55], v[72:75], v[112:115], v[52:55]
    v_mfma_f32_16x16x32_bf16 v[52:55], v[76:79], v[108:111], v[52:55]
    ds_read2_b32 v[144:145], v22 offset0:176 offset1:177
    v_mfma_f32_16x16x32_bf16 v[52:55], v[80:83], v[104:107], v[52:55]
    ds_read2_b32 v[146:147], v22 offset0:178 offset1:179
    v_mfma_f32_16x16x32_bf16 v[52:55], v[84:87], v[100:103], v[52:55]
    ds_read_b128 v[176:179], v28 offset:6144
    s_waitcnt lgkmcnt(14)
    v_mfma_f32_16x16x32_bf16 v[56:59], v[88:91], v[100:103], v[56:59]
    v_mfma_f32_16x16x32_bf16 v[56:59], v[84:87], v[104:107], v[56:59]
    ds_read2_b32 v[148:149], v23 offset0:48 offset1:49
    v_mfma_f32_16x16x32_bf16 v[56:59], v[80:83], v[108:111], v[56:59]
    ds_read2_b32 v[150:151], v23 offset0:50 offset1:51
    v_mfma_f32_16x16x32_bf16 v[56:59], v[76:79], v[112:115], v[56:59]
    ds_read_b128 v[180:183], v28 offset:8192
    v_mfma_f32_16x16x32_bf16 v[56:59], v[72:75], v[116:119], v[56:59]
    v_mfma_f32_16x16x32_bf16 v[56:59], v[68:71], v[120:123], v[56:59]
    ds_read2_b32 v[152:153], v23 offset0:176 offset1:177
    v_mfma_f32_16x16x32_bf16 v[60:63], v[68:71], v[124:127], v[60:63]
    ds_read2_b32 v[154:155], v23 offset0:178 offset1:179
    v_mfma_f32_16x16x32_bf16 v[60:63], v[72:75], v[120:123], v[60:63]
    ds_read_b128 v[184:187], v28 offset:10240
    v_mfma_f32_16x16x32_bf16 v[60:63], v[76:79], v[116:119], v[60:63]
    v_mfma_f32_16x16x32_bf16 v[60:63], v[80:83], v[112:115], v[60:63]
    ds_read2_b32 v[156:157], v24 offset0:48 offset1:49
    v_mfma_f32_16x16x32_bf16 v[60:63], v[84:87], v[108:111], v[60:63]
    ds_read2_b32 v[158:159], v24 offset0:50 offset1:51
    v_mfma_f32_16x16x32_bf16 v[60:63], v[88:91], v[104:107], v[60:63]
    ds_read_b128 v[188:191], v28 offset:12288
    v_mfma_f32_16x16x32_bf16 v[60:63], v[92:95], v[100:103], v[60:63]
    s_waitcnt lgkmcnt(14)
    v_mfma_f32_16x16x32_bf16 v[64:67], v[96:99], v[100:103], v[64:67]
    ds_read2_b32 v[160:161], v24 offset0:176 offset1:177
    v_mfma_f32_16x16x32_bf16 v[64:67], v[92:95], v[104:107], v[64:67]
    ds_read2_b32 v[162:163], v24 offset0:178 offset1:179
    v_mfma_f32_16x16x32_bf16 v[64:67], v[88:91], v[108:111], v[64:67]
    ds_read_b128 v[192:195], v28 offset:14336
    v_mfma_f32_16x16x32_bf16 v[64:67], v[84:87], v[112:115], v[64:67]
    v_mfma_f32_16x16x32_bf16 v[64:67], v[80:83], v[116:119], v[64:67]
    v_mfma_f32_16x16x32_bf16 v[64:67], v[76:79], v[120:123], v[64:67]
    v_mfma_f32_16x16x32_bf16 v[64:67], v[72:75], v[124:127], v[64:67]
    v_mfma_f32_16x16x32_bf16 v[64:67], v[68:71], v[128:131], v[64:67]
    v_mfma_f32_16x16x32_bf16 v[36:39], v[132:135], v[164:167], v[36:39]
    ds_read2_b32 v[68:69], v21 offset0:64 offset1:65
    v_mfma_f32_16x16x32_bf16 v[40:43], v[136:139], v[164:167], v[40:43]
    ds_read2_b32 v[70:71], v21 offset0:66 offset1:67
    v_mfma_f32_16x16x32_bf16 v[40:43], v[132:135], v[168:171], v[40:43]
    ds_read_b128 v[100:103], v29 offset:0
    s_waitcnt lgkmcnt(14)
    v_mfma_f32_16x16x32_bf16 v[44:47], v[132:135], v[172:175], v[44:47]
    v_mfma_f32_16x16x32_bf16 v[44:47], v[136:139], v[168:171], v[44:47]
    ds_read2_b32 v[72:73], v21 offset0:192 offset1:193
    v_mfma_f32_16x16x32_bf16 v[44:47], v[140:143], v[164:167], v[44:47]
    ds_read2_b32 v[74:75], v21 offset0:194 offset1:195
    v_mfma_f32_16x16x32_bf16 v[48:51], v[144:147], v[164:167], v[48:51]
    ds_read_b128 v[104:107], v29 offset:2048
    v_mfma_f32_16x16x32_bf16 v[48:51], v[140:143], v[168:171], v[48:51]
    v_mfma_f32_16x16x32_bf16 v[48:51], v[136:139], v[172:175], v[48:51]
    ds_read2_b32 v[76:77], v22 offset0:64 offset1:65
    v_mfma_f32_16x16x32_bf16 v[48:51], v[132:135], v[176:179], v[48:51]
    ds_read2_b32 v[78:79], v22 offset0:66 offset1:67
    s_waitcnt lgkmcnt(14)
    v_mfma_f32_16x16x32_bf16 v[52:55], v[132:135], v[180:183], v[52:55]
    ds_read_b128 v[108:111], v29 offset:4096
    v_mfma_f32_16x16x32_bf16 v[52:55], v[136:139], v[176:179], v[52:55]
    v_mfma_f32_16x16x32_bf16 v[52:55], v[140:143], v[172:175], v[52:55]
    ds_read2_b32 v[80:81], v22 offset0:192 offset1:193
    v_mfma_f32_16x16x32_bf16 v[52:55], v[144:147], v[168:171], v[52:55]
    ds_read2_b32 v[82:83], v22 offset0:194 offset1:195
    v_mfma_f32_16x16x32_bf16 v[52:55], v[148:151], v[164:167], v[52:55]
    ds_read_b128 v[112:115], v29 offset:6144
    v_mfma_f32_16x16x32_bf16 v[56:59], v[152:155], v[164:167], v[56:59]
    v_mfma_f32_16x16x32_bf16 v[56:59], v[148:151], v[168:171], v[56:59]
    ds_read2_b32 v[84:85], v23 offset0:64 offset1:65
    v_mfma_f32_16x16x32_bf16 v[56:59], v[144:147], v[172:175], v[56:59]
    ds_read2_b32 v[86:87], v23 offset0:66 offset1:67
    v_mfma_f32_16x16x32_bf16 v[56:59], v[140:143], v[176:179], v[56:59]
    ds_read_b128 v[116:119], v29 offset:8192
    v_mfma_f32_16x16x32_bf16 v[56:59], v[136:139], v[180:183], v[56:59]
    v_mfma_f32_16x16x32_bf16 v[56:59], v[132:135], v[184:187], v[56:59]
    ds_read2_b32 v[88:89], v23 offset0:192 offset1:193
    s_waitcnt lgkmcnt(14)
    v_mfma_f32_16x16x32_bf16 v[60:63], v[132:135], v[188:191], v[60:63]
    ds_read2_b32 v[90:91], v23 offset0:194 offset1:195
    v_mfma_f32_16x16x32_bf16 v[60:63], v[136:139], v[184:187], v[60:63]
    ds_read_b128 v[120:123], v29 offset:10240
    v_mfma_f32_16x16x32_bf16 v[60:63], v[140:143], v[180:183], v[60:63]
    v_mfma_f32_16x16x32_bf16 v[60:63], v[144:147], v[176:179], v[60:63]
    ds_read2_b32 v[92:93], v24 offset0:64 offset1:65
    v_mfma_f32_16x16x32_bf16 v[60:63], v[148:151], v[172:175], v[60:63]
    ds_read2_b32 v[94:95], v24 offset0:66 offset1:67
    v_mfma_f32_16x16x32_bf16 v[60:63], v[152:155], v[168:171], v[60:63]
    ds_read_b128 v[124:127], v29 offset:12288
    v_mfma_f32_16x16x32_bf16 v[60:63], v[156:159], v[164:167], v[60:63]
    v_mfma_f32_16x16x32_bf16 v[64:67], v[160:163], v[164:167], v[64:67]
    ds_read2_b32 v[96:97], v24 offset0:192 offset1:193
    v_mfma_f32_16x16x32_bf16 v[64:67], v[156:159], v[168:171], v[64:67]
    ds_read2_b32 v[98:99], v24 offset0:194 offset1:195
    v_mfma_f32_16x16x32_bf16 v[64:67], v[152:155], v[172:175], v[64:67]
    ds_read_b128 v[128:131], v29 offset:14336
    v_mfma_f32_16x16x32_bf16 v[64:67], v[148:151], v[176:179], v[64:67]
    v_mfma_f32_16x16x32_bf16 v[64:67], v[144:147], v[180:183], v[64:67]
    v_mfma_f32_16x16x32_bf16 v[64:67], v[140:143], v[184:187], v[64:67]
    v_mfma_f32_16x16x32_bf16 v[64:67], v[136:139], v[188:191], v[64:67]
    v_mfma_f32_16x16x32_bf16 v[64:67], v[132:135], v[192:195], v[64:67]
    s_waitcnt lgkmcnt(14)
    v_mfma_f32_16x16x32_bf16 v[36:39], v[68:71], v[100:103], v[36:39]
    ds_read2_b32 v[132:133], v21 offset0:80 offset1:81
    v_mfma_f32_16x16x32_bf16 v[40:43], v[72:75], v[100:103], v[40:43]
    ds_read2_b32 v[134:135], v21 offset0:82 offset1:83
    v_mfma_f32_16x16x32_bf16 v[40:43], v[68:71], v[104:107], v[40:43]
    ds_read_b128 v[164:167], v30 offset:0
    v_mfma_f32_16x16x32_bf16 v[44:47], v[68:71], v[108:111], v[44:47]
    v_mfma_f32_16x16x32_bf16 v[44:47], v[72:75], v[104:107], v[44:47]
    ds_read2_b32 v[136:137], v21 offset0:208 offset1:209
    v_mfma_f32_16x16x32_bf16 v[44:47], v[76:79], v[100:103], v[44:47]
    ds_read2_b32 v[138:139], v21 offset0:210 offset1:211
    s_waitcnt lgkmcnt(14)
    v_mfma_f32_16x16x32_bf16 v[48:51], v[80:83], v[100:103], v[48:51]
    ds_read_b128 v[168:171], v30 offset:2048
    v_mfma_f32_16x16x32_bf16 v[48:51], v[76:79], v[104:107], v[48:51]
    v_mfma_f32_16x16x32_bf16 v[48:51], v[72:75], v[108:111], v[48:51]
    ds_read2_b32 v[140:141], v22 offset0:80 offset1:81
    v_mfma_f32_16x16x32_bf16 v[48:51], v[68:71], v[112:115], v[48:51]
    ds_read2_b32 v[142:143], v22 offset0:82 offset1:83
    v_mfma_f32_16x16x32_bf16 v[52:55], v[68:71], v[116:119], v[52:55]
    ds_read_b128 v[172:175], v30 offset:4096
    v_mfma_f32_16x16x32_bf16 v[52:55], v[72:75], v[112:115], v[52:55]
    v_mfma_f32_16x16x32_bf16 v[52:55], v[76:79], v[108:111], v[52:55]
    ds_read2_b32 v[144:145], v22 offset0:208 offset1:209
    v_mfma_f32_16x16x32_bf16 v[52:55], v[80:83], v[104:107], v[52:55]
    ds_read2_b32 v[146:147], v22 offset0:210 offset1:211
    v_mfma_f32_16x16x32_bf16 v[52:55], v[84:87], v[100:103], v[52:55]
    ds_read_b128 v[176:179], v30 offset:6144
    s_waitcnt lgkmcnt(14)
    v_mfma_f32_16x16x32_bf16 v[56:59], v[88:91], v[100:103], v[56:59]
    v_mfma_f32_16x16x32_bf16 v[56:59], v[84:87], v[104:107], v[56:59]
    ds_read2_b32 v[148:149], v23 offset0:80 offset1:81
    v_mfma_f32_16x16x32_bf16 v[56:59], v[80:83], v[108:111], v[56:59]
    ds_read2_b32 v[150:151], v23 offset0:82 offset1:83
    v_mfma_f32_16x16x32_bf16 v[56:59], v[76:79], v[112:115], v[56:59]
    ds_read_b128 v[180:183], v30 offset:8192
    v_mfma_f32_16x16x32_bf16 v[56:59], v[72:75], v[116:119], v[56:59]
    v_mfma_f32_16x16x32_bf16 v[56:59], v[68:71], v[120:123], v[56:59]
    ds_read2_b32 v[152:153], v23 offset0:208 offset1:209
    v_mfma_f32_16x16x32_bf16 v[60:63], v[68:71], v[124:127], v[60:63]
    ds_read2_b32 v[154:155], v23 offset0:210 offset1:211
    v_mfma_f32_16x16x32_bf16 v[60:63], v[72:75], v[120:123], v[60:63]
    ds_read_b128 v[184:187], v30 offset:10240
    v_mfma_f32_16x16x32_bf16 v[60:63], v[76:79], v[116:119], v[60:63]
    v_mfma_f32_16x16x32_bf16 v[60:63], v[80:83], v[112:115], v[60:63]
    ds_read2_b32 v[156:157], v24 offset0:80 offset1:81
    v_mfma_f32_16x16x32_bf16 v[60:63], v[84:87], v[108:111], v[60:63]
    ds_read2_b32 v[158:159], v24 offset0:82 offset1:83
    v_mfma_f32_16x16x32_bf16 v[60:63], v[88:91], v[104:107], v[60:63]
    ds_read_b128 v[188:191], v30 offset:12288
    v_mfma_f32_16x16x32_bf16 v[60:63], v[92:95], v[100:103], v[60:63]
    s_waitcnt lgkmcnt(14)
    v_mfma_f32_16x16x32_bf16 v[64:67], v[96:99], v[100:103], v[64:67]
    ds_read2_b32 v[160:161], v24 offset0:208 offset1:209
    v_mfma_f32_16x16x32_bf16 v[64:67], v[92:95], v[104:107], v[64:67]
    ds_read2_b32 v[162:163], v24 offset0:210 offset1:211
    v_mfma_f32_16x16x32_bf16 v[64:67], v[88:91], v[108:111], v[64:67]
    ds_read_b128 v[192:195], v30 offset:14336
    v_mfma_f32_16x16x32_bf16 v[64:67], v[84:87], v[112:115], v[64:67]
    v_mfma_f32_16x16x32_bf16 v[64:67], v[80:83], v[116:119], v[64:67]
    v_mfma_f32_16x16x32_bf16 v[64:67], v[76:79], v[120:123], v[64:67]
    v_mfma_f32_16x16x32_bf16 v[64:67], v[72:75], v[124:127], v[64:67]
    v_mfma_f32_16x16x32_bf16 v[64:67], v[68:71], v[128:131], v[64:67]
    v_mfma_f32_16x16x32_bf16 v[36:39], v[132:135], v[164:167], v[36:39]
    ds_read2_b32 v[68:69], v21 offset0:96 offset1:97
    v_mfma_f32_16x16x32_bf16 v[40:43], v[136:139], v[164:167], v[40:43]
    ds_read2_b32 v[70:71], v21 offset0:98 offset1:99
    v_mfma_f32_16x16x32_bf16 v[40:43], v[132:135], v[168:171], v[40:43]
    ds_read_b128 v[100:103], v31 offset:0
    s_waitcnt lgkmcnt(14)
    v_mfma_f32_16x16x32_bf16 v[44:47], v[132:135], v[172:175], v[44:47]
    v_mfma_f32_16x16x32_bf16 v[44:47], v[136:139], v[168:171], v[44:47]
    ds_read2_b32 v[72:73], v21 offset0:224 offset1:225
    v_mfma_f32_16x16x32_bf16 v[44:47], v[140:143], v[164:167], v[44:47]
    ds_read2_b32 v[74:75], v21 offset0:226 offset1:227
    v_mfma_f32_16x16x32_bf16 v[48:51], v[144:147], v[164:167], v[48:51]
    ds_read_b128 v[104:107], v31 offset:2048
    v_mfma_f32_16x16x32_bf16 v[48:51], v[140:143], v[168:171], v[48:51]
    v_mfma_f32_16x16x32_bf16 v[48:51], v[136:139], v[172:175], v[48:51]
    ds_read2_b32 v[76:77], v22 offset0:96 offset1:97
    v_mfma_f32_16x16x32_bf16 v[48:51], v[132:135], v[176:179], v[48:51]
    ds_read2_b32 v[78:79], v22 offset0:98 offset1:99
    s_waitcnt lgkmcnt(14)
    v_mfma_f32_16x16x32_bf16 v[52:55], v[132:135], v[180:183], v[52:55]
    ds_read_b128 v[108:111], v31 offset:4096
    v_mfma_f32_16x16x32_bf16 v[52:55], v[136:139], v[176:179], v[52:55]
    v_mfma_f32_16x16x32_bf16 v[52:55], v[140:143], v[172:175], v[52:55]
    ds_read2_b32 v[80:81], v22 offset0:224 offset1:225
    v_mfma_f32_16x16x32_bf16 v[52:55], v[144:147], v[168:171], v[52:55]
    ds_read2_b32 v[82:83], v22 offset0:226 offset1:227
    v_mfma_f32_16x16x32_bf16 v[52:55], v[148:151], v[164:167], v[52:55]
    ds_read_b128 v[112:115], v31 offset:6144
    v_mfma_f32_16x16x32_bf16 v[56:59], v[152:155], v[164:167], v[56:59]
    v_mfma_f32_16x16x32_bf16 v[56:59], v[148:151], v[168:171], v[56:59]
    ds_read2_b32 v[84:85], v23 offset0:96 offset1:97
    v_mfma_f32_16x16x32_bf16 v[56:59], v[144:147], v[172:175], v[56:59]
    ds_read2_b32 v[86:87], v23 offset0:98 offset1:99
    v_mfma_f32_16x16x32_bf16 v[56:59], v[140:143], v[176:179], v[56:59]
    ds_read_b128 v[116:119], v31 offset:8192
    v_mfma_f32_16x16x32_bf16 v[56:59], v[136:139], v[180:183], v[56:59]
    v_mfma_f32_16x16x32_bf16 v[56:59], v[132:135], v[184:187], v[56:59]
    ds_read2_b32 v[88:89], v23 offset0:224 offset1:225
    s_waitcnt lgkmcnt(14)
    v_mfma_f32_16x16x32_bf16 v[60:63], v[132:135], v[188:191], v[60:63]
    ds_read2_b32 v[90:91], v23 offset0:226 offset1:227
    v_mfma_f32_16x16x32_bf16 v[60:63], v[136:139], v[184:187], v[60:63]
    ds_read_b128 v[120:123], v31 offset:10240
    v_mfma_f32_16x16x32_bf16 v[60:63], v[140:143], v[180:183], v[60:63]
    v_mfma_f32_16x16x32_bf16 v[60:63], v[144:147], v[176:179], v[60:63]
    ds_read2_b32 v[92:93], v24 offset0:96 offset1:97
    v_mfma_f32_16x16x32_bf16 v[60:63], v[148:151], v[172:175], v[60:63]
    ds_read2_b32 v[94:95], v24 offset0:98 offset1:99
    v_mfma_f32_16x16x32_bf16 v[60:63], v[152:155], v[168:171], v[60:63]
    ds_read_b128 v[124:127], v31 offset:12288
    v_mfma_f32_16x16x32_bf16 v[60:63], v[156:159], v[164:167], v[60:63]
    v_mfma_f32_16x16x32_bf16 v[64:67], v[160:163], v[164:167], v[64:67]
    ds_read2_b32 v[96:97], v24 offset0:224 offset1:225
    v_mfma_f32_16x16x32_bf16 v[64:67], v[156:159], v[168:171], v[64:67]
    ds_read2_b32 v[98:99], v24 offset0:226 offset1:227
    v_mfma_f32_16x16x32_bf16 v[64:67], v[152:155], v[172:175], v[64:67]
    ds_read_b128 v[128:131], v31 offset:14336
    v_mfma_f32_16x16x32_bf16 v[64:67], v[148:151], v[176:179], v[64:67]
    v_mfma_f32_16x16x32_bf16 v[64:67], v[144:147], v[180:183], v[64:67]
    v_mfma_f32_16x16x32_bf16 v[64:67], v[140:143], v[184:187], v[64:67]
    v_mfma_f32_16x16x32_bf16 v[64:67], v[136:139], v[188:191], v[64:67]
    v_mfma_f32_16x16x32_bf16 v[64:67], v[132:135], v[192:195], v[64:67]
    s_waitcnt lgkmcnt(14)
    v_mfma_f32_16x16x32_bf16 v[36:39], v[68:71], v[100:103], v[36:39]
    ds_read2_b32 v[132:133], v21 offset0:112 offset1:113
    v_mfma_f32_16x16x32_bf16 v[40:43], v[72:75], v[100:103], v[40:43]
    ds_read2_b32 v[134:135], v21 offset0:114 offset1:115
    v_mfma_f32_16x16x32_bf16 v[40:43], v[68:71], v[104:107], v[40:43]
    ds_read_b128 v[164:167], v32 offset:0
    v_mfma_f32_16x16x32_bf16 v[44:47], v[68:71], v[108:111], v[44:47]
    v_mfma_f32_16x16x32_bf16 v[44:47], v[72:75], v[104:107], v[44:47]
    ds_read2_b32 v[136:137], v21 offset0:240 offset1:241
    v_mfma_f32_16x16x32_bf16 v[44:47], v[76:79], v[100:103], v[44:47]
    ds_read2_b32 v[138:139], v21 offset0:242 offset1:243
    s_waitcnt lgkmcnt(14)
    v_mfma_f32_16x16x32_bf16 v[48:51], v[80:83], v[100:103], v[48:51]
    ds_read_b128 v[168:171], v32 offset:2048
    v_mfma_f32_16x16x32_bf16 v[48:51], v[76:79], v[104:107], v[48:51]
    v_mfma_f32_16x16x32_bf16 v[48:51], v[72:75], v[108:111], v[48:51]
    ds_read2_b32 v[140:141], v22 offset0:112 offset1:113
    v_mfma_f32_16x16x32_bf16 v[48:51], v[68:71], v[112:115], v[48:51]
    ds_read2_b32 v[142:143], v22 offset0:114 offset1:115
    v_mfma_f32_16x16x32_bf16 v[52:55], v[68:71], v[116:119], v[52:55]
    ds_read_b128 v[172:175], v32 offset:4096
    v_mfma_f32_16x16x32_bf16 v[52:55], v[72:75], v[112:115], v[52:55]
    v_mfma_f32_16x16x32_bf16 v[52:55], v[76:79], v[108:111], v[52:55]
    ds_read2_b32 v[144:145], v22 offset0:240 offset1:241
    v_mfma_f32_16x16x32_bf16 v[52:55], v[80:83], v[104:107], v[52:55]
    ds_read2_b32 v[146:147], v22 offset0:242 offset1:243
    v_mfma_f32_16x16x32_bf16 v[52:55], v[84:87], v[100:103], v[52:55]
    ds_read_b128 v[176:179], v32 offset:6144
    s_waitcnt lgkmcnt(14)
    v_mfma_f32_16x16x32_bf16 v[56:59], v[88:91], v[100:103], v[56:59]
    v_mfma_f32_16x16x32_bf16 v[56:59], v[84:87], v[104:107], v[56:59]
    ds_read2_b32 v[148:149], v23 offset0:112 offset1:113
    v_mfma_f32_16x16x32_bf16 v[56:59], v[80:83], v[108:111], v[56:59]
    ds_read2_b32 v[150:151], v23 offset0:114 offset1:115
    v_mfma_f32_16x16x32_bf16 v[56:59], v[76:79], v[112:115], v[56:59]
    ds_read_b128 v[180:183], v32 offset:8192
    v_mfma_f32_16x16x32_bf16 v[56:59], v[72:75], v[116:119], v[56:59]
    v_mfma_f32_16x16x32_bf16 v[56:59], v[68:71], v[120:123], v[56:59]
    ds_read2_b32 v[152:153], v23 offset0:240 offset1:241
    v_mfma_f32_16x16x32_bf16 v[60:63], v[68:71], v[124:127], v[60:63]
    ds_read2_b32 v[154:155], v23 offset0:242 offset1:243
    v_mfma_f32_16x16x32_bf16 v[60:63], v[72:75], v[120:123], v[60:63]
    ds_read_b128 v[184:187], v32 offset:10240
    v_mfma_f32_16x16x32_bf16 v[60:63], v[76:79], v[116:119], v[60:63]
    v_mfma_f32_16x16x32_bf16 v[60:63], v[80:83], v[112:115], v[60:63]
    ds_read2_b32 v[156:157], v24 offset0:112 offset1:113
    v_mfma_f32_16x16x32_bf16 v[60:63], v[84:87], v[108:111], v[60:63]
    ds_read2_b32 v[158:159], v24 offset0:114 offset1:115
    v_mfma_f32_16x16x32_bf16 v[60:63], v[88:91], v[104:107], v[60:63]
    ds_read_b128 v[188:191], v32 offset:12288
    v_mfma_f32_16x16x32_bf16 v[60:63], v[92:95], v[100:103], v[60:63]
    s_waitcnt lgkmcnt(14)
    v_mfma_f32_16x16x32_bf16 v[64:67], v[96:99], v[100:103], v[64:67]
    ds_read2_b32 v[160:161], v24 offset0:240 offset1:241
    v_mfma_f32_16x16x32_bf16 v[64:67], v[92:95], v[104:107], v[64:67]
    ds_read2_b32 v[162:163], v24 offset0:242 offset1:243
    v_mfma_f32_16x16x32_bf16 v[64:67], v[88:91], v[108:111], v[64:67]
    ds_read_b128 v[192:195], v32 offset:14336
    v_mfma_f32_16x16x32_bf16 v[64:67], v[84:87], v[112:115], v[64:67]
    v_mfma_f32_16x16x32_bf16 v[64:67], v[80:83], v[116:119], v[64:67]
    v_mfma_f32_16x16x32_bf16 v[64:67], v[76:79], v[120:123], v[64:67]
    v_mfma_f32_16x16x32_bf16 v[64:67], v[72:75], v[124:127], v[64:67]
    v_mfma_f32_16x16x32_bf16 v[64:67], v[68:71], v[128:131], v[64:67]
    v_mfma_f32_16x16x32_bf16 v[36:39], v[132:135], v[164:167], v[36:39]
    v_mfma_f32_16x16x32_bf16 v[40:43], v[136:139], v[164:167], v[40:43]
    v_mfma_f32_16x16x32_bf16 v[40:43], v[132:135], v[168:171], v[40:43]
    s_waitcnt lgkmcnt(14)
    v_mfma_f32_16x16x32_bf16 v[44:47], v[132:135], v[172:175], v[44:47]
    v_mfma_f32_16x16x32_bf16 v[44:47], v[136:139], v[168:171], v[44:47]
    v_mfma_f32_16x16x32_bf16 v[44:47], v[140:143], v[164:167], v[44:47]
    s_waitcnt lgkmcnt(13)
    v_mfma_f32_16x16x32_bf16 v[48:51], v[144:147], v[164:167], v[48:51]
    v_mfma_f32_16x16x32_bf16 v[48:51], v[140:143], v[168:171], v[48:51]
    s_waitcnt lgkmcnt(0)
    v_cvt_pk_bf16_f32 v68, v39, v38
    v_cvt_pk_bf16_f32 v69, v37, v36
    v_mfma_f32_16x16x32_bf16 v[48:51], v[136:139], v[172:175], v[48:51]
    ds_write_b64 v20, v[68:69] offset:0
    v_cvt_pk_bf16_f32 v70, v43, v42
    v_mfma_f32_16x16x32_bf16 v[48:51], v[132:135], v[176:179], v[48:51]
    v_cvt_pk_bf16_f32 v71, v41, v40
    ds_write_b64 v20, v[70:71] offset:2048
    v_mfma_f32_16x16x32_bf16 v[52:55], v[132:135], v[180:183], v[52:55]
    v_mfma_f32_16x16x32_bf16 v[52:55], v[136:139], v[176:179], v[52:55]
    v_cvt_pk_bf16_f32 v72, v47, v46
    v_cvt_pk_bf16_f32 v73, v45, v44
    v_mfma_f32_16x16x32_bf16 v[52:55], v[140:143], v[172:175], v[52:55]
    ds_write_b64 v20, v[72:73] offset:4096
    v_mfma_f32_16x16x32_bf16 v[52:55], v[144:147], v[168:171], v[52:55]
    v_mfma_f32_16x16x32_bf16 v[52:55], v[148:151], v[164:167], v[52:55]
    v_mfma_f32_16x16x32_bf16 v[56:59], v[152:155], v[164:167], v[56:59]
    v_cvt_pk_bf16_f32 v74, v51, v50
    v_cvt_pk_bf16_f32 v75, v49, v48
    v_mfma_f32_16x16x32_bf16 v[56:59], v[148:151], v[168:171], v[56:59]
    ds_write_b64 v20, v[74:75] offset:6144
    v_mfma_f32_16x16x32_bf16 v[56:59], v[144:147], v[172:175], v[56:59]
    v_mfma_f32_16x16x32_bf16 v[56:59], v[140:143], v[176:179], v[56:59]
    v_mfma_f32_16x16x32_bf16 v[56:59], v[136:139], v[180:183], v[56:59]
    v_mfma_f32_16x16x32_bf16 v[56:59], v[132:135], v[184:187], v[56:59]
    v_cvt_pk_bf16_f32 v76, v55, v54
    v_cvt_pk_bf16_f32 v77, v53, v52
    v_mfma_f32_16x16x32_bf16 v[60:63], v[132:135], v[188:191], v[60:63]
    ds_write_b64 v20, v[76:77] offset:8192
    v_mfma_f32_16x16x32_bf16 v[60:63], v[136:139], v[184:187], v[60:63]
    v_mfma_f32_16x16x32_bf16 v[60:63], v[140:143], v[180:183], v[60:63]
    v_mfma_f32_16x16x32_bf16 v[60:63], v[144:147], v[176:179], v[60:63]
    v_mfma_f32_16x16x32_bf16 v[60:63], v[148:151], v[172:175], v[60:63]
    v_mfma_f32_16x16x32_bf16 v[60:63], v[152:155], v[168:171], v[60:63]
    v_cvt_pk_bf16_f32 v78, v59, v58
    v_cvt_pk_bf16_f32 v79, v57, v56
    v_mfma_f32_16x16x32_bf16 v[60:63], v[156:159], v[164:167], v[60:63]
    ds_write_b64 v20, v[78:79] offset:10240
    v_mfma_f32_16x16x32_bf16 v[64:67], v[160:163], v[164:167], v[64:67]
    v_mfma_f32_16x16x32_bf16 v[64:67], v[156:159], v[168:171], v[64:67]
    v_mfma_f32_16x16x32_bf16 v[64:67], v[152:155], v[172:175], v[64:67]
    v_mfma_f32_16x16x32_bf16 v[64:67], v[148:151], v[176:179], v[64:67]
    v_mfma_f32_16x16x32_bf16 v[64:67], v[144:147], v[180:183], v[64:67]
    v_mfma_f32_16x16x32_bf16 v[64:67], v[140:143], v[184:187], v[64:67]
    s_nop 0
    v_cvt_pk_bf16_f32 v80, v63, v62
    v_cvt_pk_bf16_f32 v81, v61, v60
    v_mfma_f32_16x16x32_bf16 v[64:67], v[136:139], v[188:191], v[64:67]
    ds_write_b64 v20, v[80:81] offset:12288
    v_mfma_f32_16x16x32_bf16 v[64:67], v[132:135], v[192:195], v[64:67]
    s_nop 7
    v_cvt_pk_bf16_f32 v82, v67, v66
    v_cvt_pk_bf16_f32 v83, v65, v64
    ds_write_b64 v20, v[82:83] offset:14336
    s_mov_b64 exec, 1
    ds_add_u32 v18, v19 offset:12
    s_mov_b64 exec, -1
    s_add_u32 s80, s86, 94208
    v_add_u32 v5, s80, v15
    s_branch LA_s3_in
LA_s3:
    s_sleep 1
LA_s3_in:
    ds_read_b32 v6, v18 offset:12
    ds_read_b128 v[84:87], v5 offset:0
    ds_read_b128 v[88:91], v5 offset:4096
    ds_read_b128 v[92:95], v5 offset:8192
    ds_read_b128 v[96:99], v5 offset:12288
    s_waitcnt lgkmcnt(0)
    v_readfirstlane_b32 s78, v6
    s_nop 0
    s_cmp_ge_u32 s78, 4
    s_cbranch_scc0 LA_s3
    s_add_u32 s89, s91, 4194304
    buffer_store_dwordx4 v[84:87], v14, s[52:55], s89 offen sc1
    s_add_u32 s89, s91, 4198400
    buffer_store_dwordx4 v[88:91], v14, s[52:55], s89 offen sc1
    s_add_u32 s89, s91, 4202496
    buffer_store_dwordx4 v[92:95], v14, s[52:55], s89 offen sc1
    s_add_u32 s89, s91, 4206592
    buffer_store_dwordx4 v[96:99], v14, s[52:55], s89 offen sc1
    s_add_u32 s80, s86, 129024
    v_add_u32 v5, s80, v15
    s_waitcnt vmcnt(9)
    ds_write_b128 v5, v[228:231] offset:0
    s_waitcnt vmcnt(8)
    ds_write_b128 v5, v[232:235] offset:4096
    s_waitcnt vmcnt(7)
    ds_write_b128 v5, v[240:243] offset:8192
    s_waitcnt vmcnt(6)
    ds_write_b128 v5, v[244:247] offset:12288
    s_waitcnt vmcnt(5)
    ds_write_b128 v5, v[248:251] offset:16384
    s_waitcnt vmcnt(4)
    ds_write_b128 v5, v[196:199] offset:20480
    s_mov_b64 exec, 1
    ds_add_u32 v18, v19 offset:32
    s_mov_b64 exec, -1
    s_setprio 0
    s_mov_b32 s60, s22
    s_mov_b32 s61, s23
    s_mov_b32 s62, 0x800000
    s_mov_b32 s63, 0x20000
    s_lshr_b32 s81, s91, 4
    s_lshl_b32 s82, s3, 8
    s_add_u32 s81, s81, s82
    s_add_u32 s81, s81, 12648448
    s_lshl_b32 s80, s74, 14
    s_and_b32 s82, s75, 3
    s_lshl_b32 s82, s82, 8
    s_add_u32 s80, s80, s82
    s_add_u32 s80, s80, 12648448
    v_mov_b32 v5, 0
    v_lshlrev_b32 v7, 10, v0
    v_lshlrev_b32 v132, 16, v212
    v_and_b32 v133, 0xffff0000, v212
    v_lshlrev_b32 v134, 16, v213
    v_and_b32 v135, 0xffff0000, v213
    v_lshlrev_b32 v136, 16, v214
    v_and_b32 v137, 0xffff0000, v214
    v_lshlrev_b32 v138, 16, v215
    v_and_b32 v139, 0xffff0000, v215
    v_lshlrev_b32 v140, 16, v216
    v_and_b32 v141, 0xffff0000, v216
    v_lshlrev_b32 v142, 16, v217
    v_and_b32 v143, 0xffff0000, v217
    v_lshlrev_b32 v144, 16, v218
    v_and_b32 v145, 0xffff0000, v218
    v_lshlrev_b32 v146, 16, v219
    v_and_b32 v147, 0xffff0000, v219
    v_lshlrev_b32 v148, 16, v220
    v_and_b32 v149, 0xffff0000, v220
    v_lshlrev_b32 v150, 16, v221
    v_and_b32 v151, 0xffff0000, v221
    v_lshlrev_b32 v152, 16, v222
    v_and_b32 v153, 0xffff0000, v222
    v_lshlrev_b32 v154, 16, v223
    v_and_b32 v155, 0xffff0000, v223
    v_lshlrev_b32 v156, 16, v224
    v_and_b32 v157, 0xffff0000, v224
    v_lshlrev_b32 v158, 16, v225
    v_and_b32 v159, 0xffff0000, v225
    v_lshlrev_b32 v160, 16, v226
    v_and_b32 v161, 0xffff0000, v226
    v_lshlrev_b32 v162, 16, v227
    v_and_b32 v163, 0xffff0000, v227
    s_waitcnt vmcnt(0)
    s_mov_b64 exec, 1
    buffer_store_dword v19, v5, s[52:55], s81 offen sc1
    s_mov_b64 exec, 0xffff
    s_waitcnt vmcnt(0)
    s_branch LA_s7a_in
LA_s7a:
    s_sleep 1
LA_s7a_in:
    ds_read_b32 v6, v18 offset:28
    s_waitcnt lgkmcnt(0)
    v_readfirstlane_b32 s78, v6
    s_nop 0
    s_cmp_ge_u32 s78, 4
    s_cbranch_scc0 LA_s7a
    s_setprio 2
    s_mov_b32 s79, 0
LA_py:
    buffer_load_dword v6, v7, s[52:55], s80 offen sc1
    s_add_u32 s79, s79, 1
    s_cmp_gt_u32 s79, 200000
    s_cbranch_scc1 LA_py_x
    s_waitcnt vmcnt(0)
    v_cmp_ne_u32 vcc, 1, v6
    s_cbranch_vccz LA_py_x
    s_mov_b64 exec, vcc
    s_sleep 8
    s_branch LA_py
LA_py_x:
    s_waitcnt vmcnt(0)
    s_mov_b64 exec, -1
    s_mov_b32 s89, 4194304
    buffer_load_dwordx4 v[100:103], v12, s[52:55], s89 offen sc1
    s_mov_b32 s89, 4210688
    buffer_load_dwordx4 v[104:107], v12, s[52:55], s89 offen sc1
    s_mov_b32 s89, 4227072
    buffer_load_dwordx4 v[108:111], v12, s[52:55], s89 offen sc1
    s_mov_b32 s89, 4243456
    buffer_load_dwordx4 v[112:115], v12, s[52:55], s89 offen sc1
    s_waitcnt vmcnt(3)
    v_permlane32_swap_b32 v102, v100
    v_permlane32_swap_b32 v103, v101
    s_waitcnt vmcnt(2)
    v_permlane32_swap_b32 v106, v104
    v_permlane32_swap_b32 v107, v105
    s_waitcnt vmcnt(1)
    v_permlane32_swap_b32 v110, v108
    v_permlane32_swap_b32 v111, v109
    s_waitcnt vmcnt(0)
    v_permlane32_swap_b32 v114, v112
    v_permlane32_swap_b32 v115, v113
    v_and_b32 v68, 0xffff0000, v103
    v_and_b32 v69, 0xffff0000, v107
    v_and_b32 v70, 0xffff0000, v111
    v_and_b32 v71, 0xffff0000, v115
    v_and_b32 v72, 0xffff0000, v101
    v_and_b32 v73, 0xffff0000, v105
    v_and_b32 v74, 0xffff0000, v109
    v_and_b32 v75, 0xffff0000, v113
    v_mul_f32 v68, v68, v132
    v_mul_f32 v69, v69, v133
    v_mul_f32 v70, v70, v134
    v_mul_f32 v71, v71, v135
    v_mul_f32 v72, v72, v136
    v_mul_f32 v73, v73, v137
    v_mul_f32 v74, v74, v138
    v_mul_f32 v75, v75, v139
    v_cvt_pk_bf16_f32 v36, v68, v69
    v_cvt_pk_bf16_f32 v37, v70, v71
    v_cvt_pk_bf16_f32 v38, v72, v73
    v_cvt_pk_bf16_f32 v39, v74, v75
    s_mov_b32 s89, 0
    buffer_store_dwordx4 v[36:39], v13, s[60:63], s89 offen nt sc1
    v_lshlrev_b32 v68, 16, v103
    v_lshlrev_b32 v69, 16, v107
    v_lshlrev_b32 v70, 16, v111
    v_lshlrev_b32 v71, 16, v115
    v_lshlrev_b32 v72, 16, v101
    v_lshlrev_b32 v73, 16, v105
    v_lshlrev_b32 v74, 16, v109
    v_lshlrev_b32 v75, 16, v113
    v_mul_f32 v68, v68, v140
    v_mul_f32 v69, v69, v141
    v_mul_f32 v70, v70, v142
    v_mul_f32 v71, v71, v143
    v_mul_f32 v72, v72, v144
    v_mul_f32 v73, v73, v145
    v_mul_f32 v74, v74, v146
    v_mul_f32 v75, v75, v147
    v_cvt_pk_bf16_f32 v40, v68, v69
    v_cvt_pk_bf16_f32 v41, v70, v71
    v_cvt_pk_bf16_f32 v42, v72, v73
    v_cvt_pk_bf16_f32 v43, v74, v75
    s_mov_b32 s89, 4096
    buffer_store_dwordx4 v[40:43], v13, s[60:63], s89 offen nt sc1
    v_and_b32 v68, 0xffff0000, v102
    v_and_b32 v69, 0xffff0000, v106
    v_and_b32 v70, 0xffff0000, v110
    v_and_b32 v71, 0xffff0000, v114
    v_and_b32 v72, 0xffff0000, v100
    v_and_b32 v73, 0xffff0000, v104
    v_and_b32 v74, 0xffff0000, v108
    v_and_b32 v75, 0xffff0000, v112
    v_mul_f32 v68, v68, v148
    v_mul_f32 v69, v69, v149
    v_mul_f32 v70, v70, v150
    v_mul_f32 v71, v71, v151
    v_mul_f32 v72, v72, v152
    v_mul_f32 v73, v73, v153
    v_mul_f32 v74, v74, v154
    v_mul_f32 v75, v75, v155
    v_cvt_pk_bf16_f32 v44, v68, v69
    v_cvt_pk_bf16_f32 v45, v70, v71
    v_cvt_pk_bf16_f32 v46, v72, v73
    v_cvt_pk_bf16_f32 v47, v74, v75
    s_mov_b32 s89, 8192
    buffer_store_dwordx4 v[44:47], v13, s[60:63], s89 offen nt sc1
    v_lshlrev_b32 v68, 16, v102
    v_lshlrev_b32 v69, 16, v106
    v_lshlrev_b32 v70, 16, v110
    v_lshlrev_b32 v71, 16, v114
    v_lshlrev_b32 v72, 16, v100
    v_lshlrev_b32 v73, 16, v104
    v_lshlrev_b32 v74, 16, v108
    v_lshlrev_b32 v75, 16, v112
    v_mul_f32 v68, v68, v156
    v_mul_f32 v69, v69, v157
    v_mul_f32 v70, v70, v158
    v_mul_f32 v71, v71, v159
    v_mul_f32 v72, v72, v160
    v_mul_f32 v73, v73, v161
    v_mul_f32 v74, v74, v162
    v_mul_f32 v75, v75, v163
    v_cvt_pk_bf16_f32 v48, v68, v69
    v_cvt_pk_bf16_f32 v49, v70, v71
    v_cvt_pk_bf16_f32 v50, v72, v73
    v_cvt_pk_bf16_f32 v51, v74, v75
    s_mov_b32 s89, 12288
    buffer_store_dwordx4 v[48:51], v13, s[60:63], s89 offen nt sc1
    s_endpgm
L_B:
    s_setprio 3
    s_and_b32 s3, s3, 3
    s_add_u32 s79, s72, s73
    s_add_u32 s78, s72, 5
    s_and_b32 s78, s78, 7
    s_lshl_b32 s78, s78, 1
    s_and_b32 s75, s79, 1
    s_add_u32 s78, s78, s75
    s_andn2_b32 s79, 2, s79
    s_lshl_b32 s79, s79, 3
    s_add_u32 s78, s78, s79
    s_and_b32 s76, s78, 3
    s_and_b32 s79, s73, 12
    s_add_u32 s76, s76, s79
    s_lshr_b32 s74, s78, 4
    s_add_u32 s74, s74, s79
    s_and_b32 s79, s72, 8
    s_lshr_b32 s77, s78, 2
    s_add_u32 s77, s77, s79
    s_lshr_b32 s79, s79, 2
    s_add_u32 s74, s74, s79
    s_xor_b32 s74, s74, 4
    s_and_b32 s75, s78, 15
    s_lshr_b32 s86, s3, 1
    s_and_b32 s87, s3, 1
    v_mov_b32 v10, 162304
    v_mov_b32 v11, 1
    v_lshlrev_b32 v12, 4, v0
    v_lshl_add_u32 v13, v0, 2, v10
    v_mov_b32 v14, 0
    ds_write_b32 v13, v14
    s_lshl_b32 s78, s74, 4
    s_add_u32 s78, s78, s75
    s_lshl_b32 s96, s78, 8
    s_add_u32 s96, s96, 12582912
    s_lshl_b32 s78, s78, 2
    s_add_u32 s78, s78, s3
    s_lshl_b32 s78, s78, 8
    s_add_u32 s80, s78, 12648448
    s_lshl_b32 s81, s72, 1
    s_add_u32 s81, s81, s86
    s_lshl_b32 s97, s81, 4
    s_add_u32 s97, s97, s73
    s_lshl_b32 s97, s97, 8
    s_add_u32 s97, s97, 12910464
    v_mov_b32 v15, s80
    v_mov_b32 v223, s97
    v_cmp_gt_u32 vcc, 8, v0
    s_nop 1
    v_cndmask_b32 v15, v223, v15, vcc
    v_add_u32 v221, v15, v12
    s_lshl_b32 s78, s87, 2
    s_add_u32 s78, s78, 128
    s_add_u32 s97, s97, s78
    s_lshl_b32 s82, s73, 1
    s_add_u32 s82, s82, s87
    s_lshl_b32 s78, s81, 7
    s_add_u32 s78, s78, s82
    s_lshl_b32 s94, s78, 10
    s_add_u32 s94, s94, 16777216
    v_mov_b32 v212, 0
    v_mov_b32 v213, 0
    v_mov_b32 v214, 0
    v_mov_b32 v215, 0
    v_mov_b32 v220, 0
    s_waitcnt lgkmcnt(0)
    s_mov_b32 s52, s26
    s_mov_b32 s53, s27
    s_mov_b32 s54, 0x1800000
    s_mov_b32 s55, 0x20000
    s_mov_b32 s68, s24
    s_mov_b32 s69, s25
    s_mov_b32 s70, 0x100
    s_mov_b32 s71, 0x20000
    s_lshl_b32 s98, s74, 4
    s_or_b32 s78, s75, s3
    s_cmp_lg_u32 s78, 0
    s_cbranch_scc1 LB_notag
    s_mov_b64 exec, 0xffff
    v_lshlrev_b32 v15, 8, v0
    buffer_load_dword v251, v15, s[52:55], s96 offen sc1
LB_notag:
    s_lshl_b32 s78, s87, 3
    s_lshr_b32 exec_lo, 0xffff, s78
    s_mov_b32 exec_hi, 0
    buffer_store_dwordx4 v[212:215], v221, s[52:55], 0 offen sc1
    s_mov_b64 exec, -1
    v_and_b32 v13, 15, v0
    v_lshrrev_b32 v14, 4, v0
    v_lshrrev_b32 v15, 1, v13
    v_xor_b32 v15, v15, v14
    v_lshlrev_b32 v15, 4, v15
    v_lshl_add_u32 v15, v13, 7, v15
    v_add_u32 v2, 73728, v15
    v_xor_b32 v3, 64, v2
    s_lshl_b32 s78, s86, 13
    s_add_u32 s78, s78, 2048
    v_add_u32 v4, s78, v2
    v_add_u32 v5, s78, v3
    v_bfe_u32 v15, v0, 3, 2
    s_lshl_b32 s78, s87, 1
    s_add_u32 s78, s78, s86
    v_xor_b32 v15, s78, v15
    v_lshlrev_b32 v15, 5, v15
    v_and_b32 v223, 3, v0
    v_lshl_add_u32 v15, v223, 3, v15
    v_bfe_u32 v223, v0, 2, 2
    v_lshl_add_u32 v15, v223, 7, v15
    v_mul_u32_u24 v223, 3072, v14
    v_add_u32 v6, v223, v15
    v_xor_b32 v7, 32, v6
    s_mov_b32 s60, s22
    s_mov_b32 s61, s23
    s_mov_b32 s62, 0x800000
    s_mov_b32 s63, 0x20000
    v_and_b32 v15, 1, v13
    v_cmp_eq_u32 s[88:89], 1, v15
    v_lshl_add_u32 v15, v14, 2, v15
    v_cmp_le_u32 s[90:91], v15, v13
    v_add_u32 v15, 2, v15
    v_cmp_le_u32 s[92:93], v15, v13
    v_mov_b32 v212, 0x0c0c0c0c
    v_mov_b32 v15, 0xc0c0100
    v_mov_b32 v223, 0x1000c0c
    v_cndmask_b32 v15, v15, v223, s[88:89]
    v_cndmask_b32 v208, v15, v212, s[90:91]
    v_cndmask_b32 v210, v212, v15, s[90:91]
    v_mov_b32 v15, 0xc0c0302
    v_mov_b32 v223, 0x3020c0c
    v_cndmask_b32 v15, v15, v223, s[88:89]
    v_cndmask_b32 v209, v15, v212, s[92:93]
    v_cndmask_b32 v211, v212, v15, s[92:93]
    s_or_b32 s78, s72, s86
    s_cmp_eq_u32 s78, 0
    s_cselect_b32 s78, 0xf149f2ca, 0
    v_mov_b32 v212, s78
    v_mov_b32 v213, s78
    v_mov_b32 v214, s78
    v_mov_b32 v215, s78
    s_lshl_b32 s78, s87, 12
    s_add_u32 s78, s78, 24576
    s_lshl_b32 s79, s86, 9
    s_add_u32 s79, s79, s78
    v_lshlrev_b32 v15, 3, v0
    v_add_u32 v216, s79, v15
    s_lshl_b32 s80, s86, 11
    v_add_u32 v218, s80, v216
    v_xor_b32 v219, 512, v218
    s_add_u32 s78, s78, 2048
    s_cmp_eq_u32 s86, 0
    s_cselect_b32 s78, s78, 32768
    v_add_u32 v217, s78, v15
    v_bfe_u32 v14, v0, 3, 2
    v_lshlrev_b32 v14, 5, v14
    v_and_b32 v15, 3, v0
    v_lshl_add_u32 v14, v15, 3, v14
    v_lshrrev_b32 v15, 2, v0
    v_lshl_add_u32 v14, v15, 7, v14
    s_lshl_b32 s78, s86, 11
    v_add_u32 v244, s78, v14
    s_mov_b32 s64, s20
    s_mov_b32 s65, s21
    s_mov_b32 s66, 0x200000
    s_mov_b32 s67, 0x20000
    v_lshrrev_b32 v14, 4, v0
    v_lshlrev_b32 v14, 1, v14
    v_and_b32 v15, 7, v0
    v_xor_b32 v14, v14, v15
    v_lshlrev_b32 v14, 4, v14
    v_lshrrev_b32 v15, 3, v0
    v_lshl_add_u32 v14, v15, 11, v14
    s_lshl_b32 s78, s77, 7
    s_lshl_b32 s79, s3, 14
    s_add_u32 s78, s78, s79
    v_add_u32 v245, s78, v14
    v_and_b32 v14, 15, v0
    s_lshl_b32 s78, s76, 2
    s_add_u32 s78, s78, s3
    s_lshl_b32 s79, s78, 5
    v_add_u32 v14, s79, v14
    v_lshlrev_b32 v14, 12, v14
    v_bfe_u32 v15, v0, 4, 1
    v_lshl_add_u32 v14, v15, 5, v14
    v_lshrrev_b32 v15, 5, v0
    v_lshl_add_u32 v14, v15, 4, v14
    s_lshl_b32 s79, s77, 7
    s_add_u32 s79, s79, 2048
    v_add_u32 v246, s79, v14
    s_lshl_b32 s28, s78, 16
    s_add_u32 s28, s28, 16777216
    s_lshl_b32 s30, s76, 1
    s_add_u32 s30, s30, s86
    s_lshl_b32 s30, s30, 12
    s_add_u32 s30, s30, 12910592
    v_lshrrev_b32 v15, 1, v0
    v_lshlrev_b32 v15, 8, v15
    v_and_b32 v14, 1, v0
    v_lshl_add_u32 v247, v14, 2, v15
    s_and_b32 s78, s77, 7
    s_mov_b32 s79, 0x76543210
    s_and_b32 s78, s76, 3
    s_mul_i32 s78, s78, 0x22222222
    s_add_u32 s79, s79, s78
    s_bfe_u32 s78, s79, 0x30000
    s_lshl_b32 s44, s78, 18
    s_lshl_b32 s78, s78, 12
    s_add_u32 s36, s78, s28
    s_bfe_u32 s78, s79, 0x30004
    s_lshl_b32 s45, s78, 18
    s_lshl_b32 s78, s78, 12
    s_add_u32 s37, s78, s28
    s_bfe_u32 s78, s79, 0x30008
    s_lshl_b32 s46, s78, 18
    s_lshl_b32 s78, s78, 12
    s_add_u32 s38, s78, s28
    s_bfe_u32 s78, s79, 0x3000c
    s_lshl_b32 s47, s78, 18
    s_lshl_b32 s78, s78, 12
    s_add_u32 s39, s78, s28
    s_bfe_u32 s78, s79, 0x30010
    s_lshl_b32 s48, s78, 18
    s_lshl_b32 s78, s78, 12
    s_add_u32 s40, s78, s28
    s_bfe_u32 s78, s79, 0x30014
    s_lshl_b32 s49, s78, 18
    s_lshl_b32 s78, s78, 12
    s_add_u32 s41, s78, s28
    s_bfe_u32 s78, s79, 0x30018
    s_lshl_b32 s50, s78, 18
    s_lshl_b32 s78, s78, 12
    s_add_u32 s42, s78, s28
    s_bfe_u32 s78, s79, 0x3001c
    s_lshl_b32 s51, s78, 18
    s_lshl_b32 s78, s78, 12
    s_add_u32 s43, s78, s28
    s_lshl_b32 s34, s3, 10
    v_mov_b32 v252, v12
    v_bfe_u32 v14, v0, 4, 1
    v_lshrrev_b32 v15, 5, v0
    v_lshl_add_u32 v14, v14, 1, v15
    v_and_b32 v15, 7, v0
    v_xor_b32 v14, v14, v15
    v_lshlrev_b32 v14, 4, v14
    v_and_b32 v223, 15, v0
    v_lshl_add_u32 v14, v223, 7, v14
    s_lshl_b32 s78, s3, 12
    v_add_u32 v248, s78, v14
    v_xor_b32 v249, 64, v248
    v_add_u32 v250, s78, v12
    v_lshrrev_b32 v14, 3, v0
    v_xor_b32 v15, v15, v14
    v_lshlrev_b32 v15, 4, v15
    v_lshl_add_u32 v14, v14, 12, v15
    s_lshl_b32 s78, s76, 2
    s_add_u32 s78, s78, s3
    s_lshl_b32 s78, s78, 17
    s_lshl_b32 s79, s77, 7
    s_add_u32 s78, s78, s79
    s_add_u32 s78, s78, 2048
    v_add_u32 v246, s78, v14
    s_waitcnt lgkmcnt(0)
    s_barrier
    ds_read_b64_tr_b16 v[200:201], v6 offset:1024
    ds_read_b64_tr_b16 v[202:203], v6 offset:1536
    ds_read_b64_tr_b16 v[204:205], v6 offset:13312
    ds_read_b64_tr_b16 v[206:207], v6 offset:13824
    ds_read_b128 v[152:155], v2 offset:0
    ds_read_b128 v[156:159], v3 offset:0
    ds_read_b128 v[144:147], v4 offset:6144
    ds_read_b128 v[148:151], v5 offset:6144
    ds_read_b128 v[136:139], v4 offset:4096
    ds_read_b128 v[140:143], v5 offset:4096
    ds_read_b128 v[128:131], v4 offset:2048
    ds_read_b128 v[132:135], v5 offset:2048
    ds_read_b128 v[120:123], v4 offset:0
    ds_read_b128 v[124:127], v5 offset:0
    ds_read_b64_tr_b16 v[224:225], v7 offset:1024
    ds_read_b64_tr_b16 v[226:227], v7 offset:1536
    ds_read_b64_tr_b16 v[228:229], v7 offset:13312
    ds_read_b64_tr_b16 v[230:231], v7 offset:13824
    s_waitcnt lgkmcnt(13)
    v_mfma_f32_16x16x32_bf16 v[112:115], v[200:203], v[152:155], 0
    ds_read_b64_tr_b16 v[232:233], v6 offset:0
    s_waitcnt lgkmcnt(13)
    v_mfma_f32_16x16x32_bf16 v[112:115], v[204:207], v[156:159], v[112:115]
    ds_read_b64_tr_b16 v[234:235], v6 offset:512
    s_waitcnt lgkmcnt(12)
    v_mfma_f32_16x16x32_bf16 v[72:75], v[204:207], v[148:151], 0
    ds_read_b64_tr_b16 v[236:237], v6 offset:12288
    v_mfma_f32_16x16x32_bf16 v[72:75], v[200:203], v[144:147], v[72:75]
    ds_read_b64_tr_b16 v[238:239], v6 offset:12800
    s_waitcnt lgkmcnt(13)
    v_mfma_f32_16x16x32_bf16 v[64:67], v[200:203], v[136:139], 0
    s_waitcnt lgkmcnt(12)
    v_mfma_f32_16x16x32_bf16 v[64:67], v[204:207], v[140:143], v[64:67]
    s_waitcnt lgkmcnt(10)
    v_mfma_f32_16x16x32_bf16 v[56:59], v[204:207], v[132:135], 0
    v_mfma_f32_16x16x32_bf16 v[56:59], v[200:203], v[128:131], v[56:59]
    s_waitcnt lgkmcnt(9)
    v_mfma_f32_16x16x32_bf16 v[48:51], v[200:203], v[120:123], 0
    s_waitcnt lgkmcnt(8)
    v_mfma_f32_16x16x32_bf16 v[48:51], v[204:207], v[124:127], v[48:51]
    s_waitcnt lgkmcnt(4)
    v_mfma_f32_16x16x32_bf16 v[52:55], v[228:231], v[124:127], 0
    ds_read_b64_tr_b16 v[200:201], v7 offset:0
    v_mfma_f32_16x16x32_bf16 v[52:55], v[224:227], v[120:123], v[52:55]
    ds_read_b64_tr_b16 v[202:203], v7 offset:512
    v_mfma_f32_16x16x32_bf16 v[60:63], v[224:227], v[128:131], 0
    ds_read_b64_tr_b16 v[204:205], v7 offset:12288
    v_mfma_f32_16x16x32_bf16 v[60:63], v[228:231], v[132:135], v[60:63]
    ds_read_b64_tr_b16 v[206:207], v7 offset:12800
    v_mfma_f32_16x16x32_bf16 v[68:71], v[228:231], v[140:143], 0
    v_mfma_f32_16x16x32_bf16 v[68:71], v[224:227], v[136:139], v[68:71]
    v_mfma_f32_16x16x32_bf16 v[76:79], v[224:227], v[144:147], 0
    v_mfma_f32_16x16x32_bf16 v[76:79], v[228:231], v[148:151], v[76:79]
    s_barrier
    s_waitcnt lgkmcnt(4)
    v_mfma_f32_16x16x32_bf16 v[40:43], v[236:239], v[148:151], 0
    ds_read_b64_tr_b16 v[224:225], v6 offset:2048
    ds_read_b64_tr_b16 v[226:227], v6 offset:2560
    v_mfma_f32_16x16x32_bf16 v[40:43], v[232:235], v[144:147], v[40:43]
    ds_read_b64_tr_b16 v[228:229], v6 offset:14336
    ds_read_b64_tr_b16 v[230:231], v6 offset:14848
    v_mfma_f32_16x16x32_bf16 v[32:35], v[232:235], v[136:139], 0
    ds_read_b128 v[192:195], v2 offset:18432
    ds_read_b128 v[196:199], v3 offset:18432
    v_mfma_f32_16x16x32_bf16 v[32:35], v[236:239], v[140:143], v[32:35]
    ds_read_b128 v[184:187], v4 offset:24576
    ds_read_b128 v[188:191], v5 offset:24576
    v_mfma_f32_16x16x32_bf16 v[24:27], v[236:239], v[132:135], 0
    ds_read_b128 v[176:179], v4 offset:22528
    v_mfma_f32_16x16x32_bf16 v[24:27], v[232:235], v[128:131], v[24:27]
    v_mfma_f32_16x16x32_bf16 v[16:19], v[232:235], v[120:123], 0
    v_mfma_f32_16x16x32_bf16 v[16:19], v[236:239], v[124:127], v[16:19]
    s_waitcnt lgkmcnt(9)
    v_mfma_f32_16x16x32_bf16 v[20:23], v[204:207], v[124:127], 0
    ds_read_b64_tr_b16 v[232:233], v7 offset:2048
    ds_read_b64_tr_b16 v[234:235], v7 offset:2560
    v_mfma_f32_16x16x32_bf16 v[20:23], v[200:203], v[120:123], v[20:23]
    ds_read_b64_tr_b16 v[236:237], v7 offset:14336
    ds_read_b64_tr_b16 v[238:239], v7 offset:14848
    v_mfma_f32_16x16x32_bf16 v[28:31], v[200:203], v[128:131], 0
    ds_read_b128 v[180:183], v5 offset:22528
    ds_read_b128 v[168:171], v4 offset:20480
    v_mfma_f32_16x16x32_bf16 v[28:31], v[204:207], v[132:135], v[28:31]
    ds_read_b128 v[172:175], v5 offset:20480
    ds_read_b128 v[160:163], v4 offset:18432
    v_mfma_f32_16x16x32_bf16 v[36:39], v[204:207], v[140:143], 0
    ds_read_b128 v[164:167], v5 offset:18432
    v_mfma_f32_16x16x32_bf16 v[36:39], v[200:203], v[136:139], v[36:39]
    v_mfma_f32_16x16x32_bf16 v[44:47], v[200:203], v[144:147], 0
    v_mfma_f32_16x16x32_bf16 v[44:47], v[204:207], v[148:151], v[44:47]
    s_waitcnt lgkmcnt(14)
    v_mfma_f32_16x16x32_bf16 v[116:119], v[156:159], v[228:231], 0
    v_mfma_f32_16x16x32_bf16 v[116:119], v[152:155], v[224:227], v[116:119]
    v_mfma_f32_16x16x32_bf16 v[104:107], v[144:147], v[224:227], 0
    v_mfma_f32_16x16x32_bf16 v[104:107], v[148:151], v[228:231], v[104:107]
    v_mfma_f32_16x16x32_bf16 v[96:99], v[140:143], v[228:231], 0
    s_waitcnt vmcnt(0) lgkmcnt(0)
    s_barrier
    s_or_b32 s78, s75, s3
    s_cbranch_scc0 LB_tag
LB_tagb:
    v_mfma_f32_16x16x32_bf16 v[96:99], v[136:139], v[224:227], v[96:99]
    ds_read_b64_tr_b16 v[200:201], v6 offset:25600
    v_mfma_f32_16x16x32_bf16 v[88:91], v[128:131], v[224:227], 0
    ds_read_b64_tr_b16 v[202:203], v6 offset:26112
    v_mfma_f32_16x16x32_bf16 v[88:91], v[132:135], v[228:231], v[88:91]
    ds_read_b64_tr_b16 v[204:205], v6 offset:37888
    v_mfma_f32_16x16x32_bf16 v[80:83], v[124:127], v[228:231], 0
    ds_read_b64_tr_b16 v[206:207], v6 offset:38400
    v_mfma_f32_16x16x32_bf16 v[80:83], v[120:123], v[224:227], v[80:83]
    v_mfma_f32_16x16x32_bf16 v[84:87], v[120:123], v[232:235], 0
    ds_read_b64_tr_b16 v[224:225], v7 offset:25600
    v_mfma_f32_16x16x32_bf16 v[84:87], v[124:127], v[236:239], v[84:87]
    ds_read_b64_tr_b16 v[226:227], v7 offset:26112
    v_mfma_f32_16x16x32_bf16 v[92:95], v[132:135], v[236:239], 0
    ds_read_b64_tr_b16 v[228:229], v7 offset:37888
    v_mfma_f32_16x16x32_bf16 v[92:95], v[128:131], v[232:235], v[92:95]
    ds_read_b64_tr_b16 v[230:231], v7 offset:38400
    v_mfma_f32_16x16x32_bf16 v[100:103], v[136:139], v[232:235], 0
    v_mfma_f32_16x16x32_bf16 v[100:103], v[140:143], v[236:239], v[100:103]
    v_mfma_f32_16x16x32_bf16 v[108:111], v[148:151], v[236:239], 0
    v_mfma_f32_16x16x32_bf16 v[108:111], v[144:147], v[232:235], v[108:111]
    s_waitcnt lgkmcnt(4)
    v_mfma_f32_16x16x32_bf16 v[112:115], v[200:203], v[192:195], v[112:115]
    ds_read_b64_tr_b16 v[232:233], v6 offset:24576
    v_mfma_f32_16x16x32_bf16 v[112:115], v[204:207], v[196:199], v[112:115]
    ds_read_b64_tr_b16 v[234:235], v6 offset:25088
    v_mfma_f32_16x16x32_bf16 v[72:75], v[204:207], v[188:191], v[72:75]
    ds_read_b64_tr_b16 v[236:237], v6 offset:36864
    v_mfma_f32_16x16x32_bf16 v[72:75], v[200:203], v[184:187], v[72:75]
    ds_read_b64_tr_b16 v[238:239], v6 offset:37376
    v_mfma_f32_16x16x32_bf16 v[64:67], v[200:203], v[176:179], v[64:67]
    ds_read_b128 v[152:155], v2 offset:36864
    v_mfma_f32_16x16x32_bf16 v[64:67], v[204:207], v[180:183], v[64:67]
    ds_read_b128 v[156:159], v3 offset:36864
    v_mfma_f32_16x16x32_bf16 v[56:59], v[204:207], v[172:175], v[56:59]
    ds_read_b128 v[144:147], v4 offset:43008
    v_mfma_f32_16x16x32_bf16 v[56:59], v[200:203], v[168:171], v[56:59]
    ds_read_b128 v[148:151], v5 offset:43008
    v_mfma_f32_16x16x32_bf16 v[48:51], v[200:203], v[160:163], v[48:51]
    v_mfma_f32_16x16x32_bf16 v[48:51], v[204:207], v[164:167], v[48:51]
    s_waitcnt lgkmcnt(8)
    v_mfma_f32_16x16x32_bf16 v[52:55], v[228:231], v[164:167], v[52:55]
    ds_read_b64_tr_b16 v[200:201], v7 offset:24576
    v_mfma_f32_16x16x32_bf16 v[52:55], v[224:227], v[160:163], v[52:55]
    ds_read_b64_tr_b16 v[202:203], v7 offset:25088
    v_mfma_f32_16x16x32_bf16 v[60:63], v[224:227], v[168:171], v[60:63]
    ds_read_b64_tr_b16 v[204:205], v7 offset:36864
    v_mfma_f32_16x16x32_bf16 v[60:63], v[228:231], v[172:175], v[60:63]
    ds_read_b64_tr_b16 v[206:207], v7 offset:37376
    v_mfma_f32_16x16x32_bf16 v[68:71], v[228:231], v[180:183], v[68:71]
    ds_read_b128 v[136:139], v4 offset:40960
    v_mfma_f32_16x16x32_bf16 v[68:71], v[224:227], v[176:179], v[68:71]
    ds_read_b128 v[140:143], v5 offset:40960
    v_mfma_f32_16x16x32_bf16 v[76:79], v[224:227], v[184:187], v[76:79]
    ds_read_b128 v[128:131], v4 offset:38912
    v_mfma_f32_16x16x32_bf16 v[76:79], v[228:231], v[188:191], v[76:79]
    s_waitcnt lgkmcnt(11)
    v_mfma_f32_16x16x32_bf16 v[40:43], v[236:239], v[188:191], v[40:43]
    ds_read_b64_tr_b16 v[224:225], v6 offset:26624
    v_mfma_f32_16x16x32_bf16 v[40:43], v[232:235], v[184:187], v[40:43]
    ds_read_b64_tr_b16 v[226:227], v6 offset:27136
    v_mfma_f32_16x16x32_bf16 v[32:35], v[232:235], v[176:179], v[32:35]
    ds_read_b64_tr_b16 v[228:229], v6 offset:38912
    v_mfma_f32_16x16x32_bf16 v[32:35], v[236:239], v[180:183], v[32:35]
    ds_read_b64_tr_b16 v[230:231], v6 offset:39424
    v_mfma_f32_16x16x32_bf16 v[24:27], v[236:239], v[172:175], v[24:27]
    ds_read_b128 v[132:135], v5 offset:38912
    v_mfma_f32_16x16x32_bf16 v[24:27], v[232:235], v[168:171], v[24:27]
    ds_read_b128 v[120:123], v4 offset:36864
    v_mfma_f32_16x16x32_bf16 v[16:19], v[232:235], v[160:163], v[16:19]
    ds_read_b128 v[124:127], v5 offset:36864
    v_mfma_f32_16x16x32_bf16 v[16:19], v[236:239], v[164:167], v[16:19]
    s_waitcnt lgkmcnt(10)
    v_mfma_f32_16x16x32_bf16 v[20:23], v[204:207], v[164:167], v[20:23]
    ds_read_b64_tr_b16 v[232:233], v7 offset:26624
    v_mfma_f32_16x16x32_bf16 v[20:23], v[200:203], v[160:163], v[20:23]
    ds_read_b64_tr_b16 v[234:235], v7 offset:27136
    v_mfma_f32_16x16x32_bf16 v[28:31], v[200:203], v[168:171], v[28:31]
    ds_read_b64_tr_b16 v[236:237], v7 offset:38912
    v_mfma_f32_16x16x32_bf16 v[28:31], v[204:207], v[172:175], v[28:31]
    ds_read_b64_tr_b16 v[238:239], v7 offset:39424
    v_mfma_f32_16x16x32_bf16 v[36:39], v[204:207], v[180:183], v[36:39]
    v_mfma_f32_16x16x32_bf16 v[36:39], v[200:203], v[176:179], v[36:39]
    v_mfma_f32_16x16x32_bf16 v[44:47], v[200:203], v[184:187], v[44:47]
    v_mfma_f32_16x16x32_bf16 v[44:47], v[204:207], v[188:191], v[44:47]
    s_waitcnt lgkmcnt(7)
    v_mfma_f32_16x16x32_bf16 v[116:119], v[196:199], v[228:231], v[116:119]
    v_mfma_f32_16x16x32_bf16 v[116:119], v[192:195], v[224:227], v[116:119]
    v_mfma_f32_16x16x32_bf16 v[104:107], v[184:187], v[224:227], v[104:107]
    v_mfma_f32_16x16x32_bf16 v[104:107], v[188:191], v[228:231], v[104:107]
    v_mfma_f32_16x16x32_bf16 v[96:99], v[180:183], v[228:231], v[96:99]
    s_waitcnt lgkmcnt(0)
    s_barrier
    v_mfma_f32_16x16x32_bf16 v[96:99], v[176:179], v[224:227], v[96:99]
    ds_read_b64_tr_b16 v[200:201], v6 offset:50176
    v_mfma_f32_16x16x32_bf16 v[88:91], v[168:171], v[224:227], v[88:91]
    ds_read_b64_tr_b16 v[202:203], v6 offset:50688
    v_mfma_f32_16x16x32_bf16 v[88:91], v[172:175], v[228:231], v[88:91]
    ds_read_b64_tr_b16 v[204:205], v6 offset:62464
    v_mfma_f32_16x16x32_bf16 v[80:83], v[164:167], v[228:231], v[80:83]
    ds_read_b64_tr_b16 v[206:207], v6 offset:62976
    v_mfma_f32_16x16x32_bf16 v[80:83], v[160:163], v[224:227], v[80:83]
    v_mfma_f32_16x16x32_bf16 v[84:87], v[160:163], v[232:235], v[84:87]
    ds_read_b64_tr_b16 v[224:225], v7 offset:50176
    v_mfma_f32_16x16x32_bf16 v[84:87], v[164:167], v[236:239], v[84:87]
    ds_read_b64_tr_b16 v[226:227], v7 offset:50688
    v_mfma_f32_16x16x32_bf16 v[92:95], v[172:175], v[236:239], v[92:95]
    ds_read_b64_tr_b16 v[228:229], v7 offset:62464
    v_mfma_f32_16x16x32_bf16 v[92:95], v[168:171], v[232:235], v[92:95]
    ds_read_b64_tr_b16 v[230:231], v7 offset:62976
    v_mfma_f32_16x16x32_bf16 v[100:103], v[176:179], v[232:235], v[100:103]
    v_mfma_f32_16x16x32_bf16 v[100:103], v[180:183], v[236:239], v[100:103]
    v_mfma_f32_16x16x32_bf16 v[108:111], v[188:191], v[236:239], v[108:111]
    v_mfma_f32_16x16x32_bf16 v[108:111], v[184:187], v[232:235], v[108:111]
    s_waitcnt lgkmcnt(4)
    v_mfma_f32_16x16x32_bf16 v[112:115], v[200:203], v[152:155], v[112:115]
    ds_read_b64_tr_b16 v[232:233], v6 offset:49152
    v_mfma_f32_16x16x32_bf16 v[112:115], v[204:207], v[156:159], v[112:115]
    ds_read_b64_tr_b16 v[234:235], v6 offset:49664
    v_mfma_f32_16x16x32_bf16 v[72:75], v[204:207], v[148:151], v[72:75]
    ds_read_b64_tr_b16 v[236:237], v6 offset:61440
    v_mfma_f32_16x16x32_bf16 v[72:75], v[200:203], v[144:147], v[72:75]
    ds_read_b64_tr_b16 v[238:239], v6 offset:61952
    v_mfma_f32_16x16x32_bf16 v[64:67], v[200:203], v[136:139], v[64:67]
    ds_read_b128 v[192:195], v2 offset:0
    v_mfma_f32_16x16x32_bf16 v[64:67], v[204:207], v[140:143], v[64:67]
    ds_read_b128 v[196:199], v3 offset:0
    v_mfma_f32_16x16x32_bf16 v[56:59], v[204:207], v[132:135], v[56:59]
    ds_read_b128 v[184:187], v4 offset:6144
    v_mfma_f32_16x16x32_bf16 v[56:59], v[200:203], v[128:131], v[56:59]
    ds_read_b128 v[188:191], v5 offset:6144
    v_mfma_f32_16x16x32_bf16 v[48:51], v[200:203], v[120:123], v[48:51]
    v_mfma_f32_16x16x32_bf16 v[48:51], v[204:207], v[124:127], v[48:51]
    s_waitcnt lgkmcnt(8)
    v_mfma_f32_16x16x32_bf16 v[52:55], v[228:231], v[124:127], v[52:55]
    ds_read_b64_tr_b16 v[200:201], v7 offset:49152
    v_mfma_f32_16x16x32_bf16 v[52:55], v[224:227], v[120:123], v[52:55]
    ds_read_b64_tr_b16 v[202:203], v7 offset:49664
    v_mfma_f32_16x16x32_bf16 v[60:63], v[224:227], v[128:131], v[60:63]
    ds_read_b64_tr_b16 v[204:205], v7 offset:61440
    v_mfma_f32_16x16x32_bf16 v[60:63], v[228:231], v[132:135], v[60:63]
    ds_read_b64_tr_b16 v[206:207], v7 offset:61952
    v_mfma_f32_16x16x32_bf16 v[68:71], v[228:231], v[140:143], v[68:71]
    ds_read_b128 v[176:179], v4 offset:4096
    v_mfma_f32_16x16x32_bf16 v[68:71], v[224:227], v[136:139], v[68:71]
    ds_read_b128 v[180:183], v5 offset:4096
    v_mfma_f32_16x16x32_bf16 v[76:79], v[224:227], v[144:147], v[76:79]
    ds_read_b128 v[168:171], v4 offset:2048
    v_mfma_f32_16x16x32_bf16 v[76:79], v[228:231], v[148:151], v[76:79]
    s_waitcnt lgkmcnt(11)
    v_mfma_f32_16x16x32_bf16 v[40:43], v[236:239], v[148:151], v[40:43]
    ds_read_b64_tr_b16 v[224:225], v6 offset:51200
    v_mfma_f32_16x16x32_bf16 v[40:43], v[232:235], v[144:147], v[40:43]
    ds_read_b64_tr_b16 v[226:227], v6 offset:51712
    v_mfma_f32_16x16x32_bf16 v[32:35], v[232:235], v[136:139], v[32:35]
    ds_read_b64_tr_b16 v[228:229], v6 offset:63488
    v_mfma_f32_16x16x32_bf16 v[32:35], v[236:239], v[140:143], v[32:35]
    ds_read_b64_tr_b16 v[230:231], v6 offset:64000
    v_mfma_f32_16x16x32_bf16 v[24:27], v[236:239], v[132:135], v[24:27]
    ds_read_b128 v[172:175], v5 offset:2048
    v_mfma_f32_16x16x32_bf16 v[24:27], v[232:235], v[128:131], v[24:27]
    ds_read_b128 v[160:163], v4 offset:0
    v_mfma_f32_16x16x32_bf16 v[16:19], v[232:235], v[120:123], v[16:19]
    ds_read_b128 v[164:167], v5 offset:0
    v_mfma_f32_16x16x32_bf16 v[16:19], v[236:239], v[124:127], v[16:19]
    s_waitcnt lgkmcnt(10)
    v_mfma_f32_16x16x32_bf16 v[20:23], v[204:207], v[124:127], v[20:23]
    ds_read_b64_tr_b16 v[232:233], v7 offset:51200
    v_mfma_f32_16x16x32_bf16 v[20:23], v[200:203], v[120:123], v[20:23]
    ds_read_b64_tr_b16 v[234:235], v7 offset:51712
    v_mfma_f32_16x16x32_bf16 v[28:31], v[200:203], v[128:131], v[28:31]
    ds_read_b64_tr_b16 v[236:237], v7 offset:63488
    v_mfma_f32_16x16x32_bf16 v[28:31], v[204:207], v[132:135], v[28:31]
    ds_read_b64_tr_b16 v[238:239], v7 offset:64000
    v_mfma_f32_16x16x32_bf16 v[36:39], v[204:207], v[140:143], v[36:39]
    v_mfma_f32_16x16x32_bf16 v[36:39], v[200:203], v[136:139], v[36:39]
    v_mfma_f32_16x16x32_bf16 v[44:47], v[200:203], v[144:147], v[44:47]
    v_mfma_f32_16x16x32_bf16 v[44:47], v[204:207], v[148:151], v[44:47]
    s_waitcnt lgkmcnt(7)
    v_mfma_f32_16x16x32_bf16 v[116:119], v[156:159], v[228:231], v[116:119]
    v_mfma_f32_16x16x32_bf16 v[116:119], v[152:155], v[224:227], v[116:119]
    v_mfma_f32_16x16x32_bf16 v[104:107], v[144:147], v[224:227], v[104:107]
    v_mfma_f32_16x16x32_bf16 v[104:107], v[148:151], v[228:231], v[104:107]
    v_mfma_f32_16x16x32_bf16 v[96:99], v[140:143], v[228:231], v[96:99]
    s_waitcnt lgkmcnt(0)
    s_barrier
    v_mfma_f32_16x16x32_bf16 v[96:99], v[136:139], v[224:227], v[96:99]
    ds_read_b64_tr_b16 v[200:201], v6 offset:1024
    v_mfma_f32_16x16x32_bf16 v[88:91], v[128:131], v[224:227], v[88:91]
    ds_read_b64_tr_b16 v[202:203], v6 offset:1536
    v_mfma_f32_16x16x32_bf16 v[88:91], v[132:135], v[228:231], v[88:91]
    ds_read_b64_tr_b16 v[204:205], v6 offset:13312
    v_mfma_f32_16x16x32_bf16 v[80:83], v[124:127], v[228:231], v[80:83]
    ds_read_b64_tr_b16 v[206:207], v6 offset:13824
    v_mfma_f32_16x16x32_bf16 v[80:83], v[120:123], v[224:227], v[80:83]
    v_mfma_f32_16x16x32_bf16 v[84:87], v[120:123], v[232:235], v[84:87]
    ds_read_b64_tr_b16 v[224:225], v7 offset:1024
    v_mfma_f32_16x16x32_bf16 v[84:87], v[124:127], v[236:239], v[84:87]
    ds_read_b64_tr_b16 v[226:227], v7 offset:1536
    v_mfma_f32_16x16x32_bf16 v[92:95], v[132:135], v[236:239], v[92:95]
    ds_read_b64_tr_b16 v[228:229], v7 offset:13312
    v_mfma_f32_16x16x32_bf16 v[92:95], v[128:131], v[232:235], v[92:95]
    ds_read_b64_tr_b16 v[230:231], v7 offset:13824
    v_mfma_f32_16x16x32_bf16 v[100:103], v[136:139], v[232:235], v[100:103]
    v_mfma_f32_16x16x32_bf16 v[100:103], v[140:143], v[236:239], v[100:103]
    v_mfma_f32_16x16x32_bf16 v[108:111], v[148:151], v[236:239], v[108:111]
    v_mfma_f32_16x16x32_bf16 v[108:111], v[144:147], v[232:235], v[108:111]
    s_waitcnt lgkmcnt(4)
    v_mfma_f32_16x16x32_bf16 v[112:115], v[200:203], v[192:195], v[112:115]
    ds_read_b64_tr_b16 v[232:233], v6 offset:0
    v_mfma_f32_16x16x32_bf16 v[112:115], v[204:207], v[196:199], v[112:115]
    ds_read_b64_tr_b16 v[234:235], v6 offset:512
    v_mfma_f32_16x16x32_bf16 v[72:75], v[204:207], v[188:191], v[72:75]
    ds_read_b64_tr_b16 v[236:237], v6 offset:12288
    v_mfma_f32_16x16x32_bf16 v[72:75], v[200:203], v[184:187], v[72:75]
    ds_read_b64_tr_b16 v[238:239], v6 offset:12800
    v_mfma_f32_16x16x32_bf16 v[64:67], v[200:203], v[176:179], v[64:67]
    ds_read_b128 v[152:155], v2 offset:18432
    v_mfma_f32_16x16x32_bf16 v[64:67], v[204:207], v[180:183], v[64:67]
    ds_read_b128 v[156:159], v3 offset:18432
    v_mfma_f32_16x16x32_bf16 v[56:59], v[204:207], v[172:175], v[56:59]
    ds_read_b128 v[144:147], v4 offset:24576
    v_mfma_f32_16x16x32_bf16 v[56:59], v[200:203], v[168:171], v[56:59]
    ds_read_b128 v[148:151], v5 offset:24576
    v_mfma_f32_16x16x32_bf16 v[48:51], v[200:203], v[160:163], v[48:51]
    v_mfma_f32_16x16x32_bf16 v[48:51], v[204:207], v[164:167], v[48:51]
    s_waitcnt lgkmcnt(8)
    v_mfma_f32_16x16x32_bf16 v[52:55], v[228:231], v[164:167], v[52:55]
    ds_read_b64_tr_b16 v[200:201], v7 offset:0
    v_mfma_f32_16x16x32_bf16 v[52:55], v[224:227], v[160:163], v[52:55]
    ds_read_b64_tr_b16 v[202:203], v7 offset:512
    v_mfma_f32_16x16x32_bf16 v[60:63], v[224:227], v[168:171], v[60:63]
    ds_read_b64_tr_b16 v[204:205], v7 offset:12288
    v_mfma_f32_16x16x32_bf16 v[60:63], v[228:231], v[172:175], v[60:63]
    ds_read_b64_tr_b16 v[206:207], v7 offset:12800
    v_mfma_f32_16x16x32_bf16 v[68:71], v[228:231], v[180:183], v[68:71]
    ds_read_b128 v[136:139], v4 offset:22528
    v_mfma_f32_16x16x32_bf16 v[68:71], v[224:227], v[176:179], v[68:71]
    ds_read_b128 v[140:143], v5 offset:22528
    v_mfma_f32_16x16x32_bf16 v[76:79], v[224:227], v[184:187], v[76:79]
    ds_read_b128 v[128:131], v4 offset:20480
    v_mfma_f32_16x16x32_bf16 v[76:79], v[228:231], v[188:191], v[76:79]
    s_waitcnt lgkmcnt(11)
    v_mfma_f32_16x16x32_bf16 v[40:43], v[236:239], v[188:191], v[40:43]
    ds_read_b64_tr_b16 v[224:225], v6 offset:2048
    v_mfma_f32_16x16x32_bf16 v[40:43], v[232:235], v[184:187], v[40:43]
    ds_read_b64_tr_b16 v[226:227], v6 offset:2560
    v_mfma_f32_16x16x32_bf16 v[32:35], v[232:235], v[176:179], v[32:35]
    ds_read_b64_tr_b16 v[228:229], v6 offset:14336
    v_mfma_f32_16x16x32_bf16 v[32:35], v[236:239], v[180:183], v[32:35]
    ds_read_b64_tr_b16 v[230:231], v6 offset:14848
    v_mfma_f32_16x16x32_bf16 v[24:27], v[236:239], v[172:175], v[24:27]
    ds_read_b128 v[132:135], v5 offset:20480
    v_mfma_f32_16x16x32_bf16 v[24:27], v[232:235], v[168:171], v[24:27]
    ds_read_b128 v[120:123], v4 offset:18432
    v_mfma_f32_16x16x32_bf16 v[16:19], v[232:235], v[160:163], v[16:19]
    ds_read_b128 v[124:127], v5 offset:18432
    v_mfma_f32_16x16x32_bf16 v[16:19], v[236:239], v[164:167], v[16:19]
    s_waitcnt lgkmcnt(10)
    v_mfma_f32_16x16x32_bf16 v[20:23], v[204:207], v[164:167], v[20:23]
    ds_read_b64_tr_b16 v[232:233], v7 offset:2048
    v_mfma_f32_16x16x32_bf16 v[20:23], v[200:203], v[160:163], v[20:23]
    ds_read_b64_tr_b16 v[234:235], v7 offset:2560
    v_mfma_f32_16x16x32_bf16 v[28:31], v[200:203], v[168:171], v[28:31]
    ds_read_b64_tr_b16 v[236:237], v7 offset:14336
    v_mfma_f32_16x16x32_bf16 v[28:31], v[204:207], v[172:175], v[28:31]
    ds_read_b64_tr_b16 v[238:239], v7 offset:14848
    v_mfma_f32_16x16x32_bf16 v[36:39], v[204:207], v[180:183], v[36:39]
    v_mfma_f32_16x16x32_bf16 v[36:39], v[200:203], v[176:179], v[36:39]
    v_mfma_f32_16x16x32_bf16 v[44:47], v[200:203], v[184:187], v[44:47]
    v_mfma_f32_16x16x32_bf16 v[44:47], v[204:207], v[188:191], v[44:47]
    s_waitcnt lgkmcnt(7)
    v_mfma_f32_16x16x32_bf16 v[116:119], v[196:199], v[228:231], v[116:119]
    v_mfma_f32_16x16x32_bf16 v[116:119], v[192:195], v[224:227], v[116:119]
    v_mfma_f32_16x16x32_bf16 v[104:107], v[184:187], v[224:227], v[104:107]
    v_mfma_f32_16x16x32_bf16 v[104:107], v[188:191], v[228:231], v[104:107]
    v_mfma_f32_16x16x32_bf16 v[96:99], v[180:183], v[228:231], v[96:99]
    s_waitcnt lgkmcnt(0)
    s_barrier
    v_mfma_f32_16x16x32_bf16 v[96:99], v[176:179], v[224:227], v[96:99]
    ds_read_b64_tr_b16 v[200:201], v6 offset:25600
    v_mfma_f32_16x16x32_bf16 v[88:91], v[168:171], v[224:227], v[88:91]
    ds_read_b64_tr_b16 v[202:203], v6 offset:26112
    v_mfma_f32_16x16x32_bf16 v[88:91], v[172:175], v[228:231], v[88:91]
    ds_read_b64_tr_b16 v[204:205], v6 offset:37888
    v_mfma_f32_16x16x32_bf16 v[80:83], v[164:167], v[228:231], v[80:83]
    ds_read_b64_tr_b16 v[206:207], v6 offset:38400
    v_mfma_f32_16x16x32_bf16 v[80:83], v[160:163], v[224:227], v[80:83]
    v_mfma_f32_16x16x32_bf16 v[84:87], v[160:163], v[232:235], v[84:87]
    ds_read_b64_tr_b16 v[224:225], v7 offset:25600
    v_mfma_f32_16x16x32_bf16 v[84:87], v[164:167], v[236:239], v[84:87]
    ds_read_b64_tr_b16 v[226:227], v7 offset:26112
    v_mfma_f32_16x16x32_bf16 v[92:95], v[172:175], v[236:239], v[92:95]
    ds_read_b64_tr_b16 v[228:229], v7 offset:37888
    v_mfma_f32_16x16x32_bf16 v[92:95], v[168:171], v[232:235], v[92:95]
    ds_read_b64_tr_b16 v[230:231], v7 offset:38400
    v_mfma_f32_16x16x32_bf16 v[100:103], v[176:179], v[232:235], v[100:103]
    v_mfma_f32_16x16x32_bf16 v[100:103], v[180:183], v[236:239], v[100:103]
    v_mfma_f32_16x16x32_bf16 v[108:111], v[188:191], v[236:239], v[108:111]
    v_mfma_f32_16x16x32_bf16 v[108:111], v[184:187], v[232:235], v[108:111]
    s_waitcnt lgkmcnt(4)
    v_mfma_f32_16x16x32_bf16 v[112:115], v[200:203], v[152:155], v[112:115]
    ds_read_b64_tr_b16 v[232:233], v6 offset:24576
    v_mfma_f32_16x16x32_bf16 v[112:115], v[204:207], v[156:159], v[112:115]
    ds_read_b64_tr_b16 v[234:235], v6 offset:25088
    v_mfma_f32_16x16x32_bf16 v[72:75], v[204:207], v[148:151], v[72:75]
    ds_read_b64_tr_b16 v[236:237], v6 offset:36864
    v_mfma_f32_16x16x32_bf16 v[72:75], v[200:203], v[144:147], v[72:75]
    ds_read_b64_tr_b16 v[238:239], v6 offset:37376
    v_mfma_f32_16x16x32_bf16 v[64:67], v[200:203], v[136:139], v[64:67]
    ds_read_b128 v[192:195], v2 offset:36864
    v_mfma_f32_16x16x32_bf16 v[64:67], v[204:207], v[140:143], v[64:67]
    ds_read_b128 v[196:199], v3 offset:36864
    v_mfma_f32_16x16x32_bf16 v[56:59], v[204:207], v[132:135], v[56:59]
    ds_read_b128 v[184:187], v4 offset:43008
    v_mfma_f32_16x16x32_bf16 v[56:59], v[200:203], v[128:131], v[56:59]
    ds_read_b128 v[188:191], v5 offset:43008
    v_mfma_f32_16x16x32_bf16 v[48:51], v[200:203], v[120:123], v[48:51]
    v_mfma_f32_16x16x32_bf16 v[48:51], v[204:207], v[124:127], v[48:51]
    s_waitcnt lgkmcnt(8)
    v_mfma_f32_16x16x32_bf16 v[52:55], v[228:231], v[124:127], v[52:55]
    ds_read_b64_tr_b16 v[200:201], v7 offset:24576
    v_mfma_f32_16x16x32_bf16 v[52:55], v[224:227], v[120:123], v[52:55]
    ds_read_b64_tr_b16 v[202:203], v7 offset:25088
    v_mfma_f32_16x16x32_bf16 v[60:63], v[224:227], v[128:131], v[60:63]
    ds_read_b64_tr_b16 v[204:205], v7 offset:36864
    v_mfma_f32_16x16x32_bf16 v[60:63], v[228:231], v[132:135], v[60:63]
    ds_read_b64_tr_b16 v[206:207], v7 offset:37376
    v_mfma_f32_16x16x32_bf16 v[68:71], v[228:231], v[140:143], v[68:71]
    ds_read_b128 v[176:179], v4 offset:40960
    v_mfma_f32_16x16x32_bf16 v[68:71], v[224:227], v[136:139], v[68:71]
    ds_read_b128 v[180:183], v5 offset:40960
    v_mfma_f32_16x16x32_bf16 v[76:79], v[224:227], v[144:147], v[76:79]
    ds_read_b128 v[168:171], v4 offset:38912
    v_mfma_f32_16x16x32_bf16 v[76:79], v[228:231], v[148:151], v[76:79]
    s_waitcnt lgkmcnt(11)
    v_mfma_f32_16x16x32_bf16 v[40:43], v[236:239], v[148:151], v[40:43]
    ds_read_b64_tr_b16 v[224:225], v6 offset:26624
    v_mfma_f32_16x16x32_bf16 v[40:43], v[232:235], v[144:147], v[40:43]
    ds_read_b64_tr_b16 v[226:227], v6 offset:27136
    v_mfma_f32_16x16x32_bf16 v[32:35], v[232:235], v[136:139], v[32:35]
    ds_read_b64_tr_b16 v[228:229], v6 offset:38912
    v_mfma_f32_16x16x32_bf16 v[32:35], v[236:239], v[140:143], v[32:35]
    ds_read_b64_tr_b16 v[230:231], v6 offset:39424
    v_mfma_f32_16x16x32_bf16 v[24:27], v[236:239], v[132:135], v[24:27]
    ds_read_b128 v[172:175], v5 offset:38912
    v_mfma_f32_16x16x32_bf16 v[24:27], v[232:235], v[128:131], v[24:27]
    ds_read_b128 v[160:163], v4 offset:36864
    v_mfma_f32_16x16x32_bf16 v[16:19], v[232:235], v[120:123], v[16:19]
    ds_read_b128 v[164:167], v5 offset:36864
    v_mfma_f32_16x16x32_bf16 v[16:19], v[236:239], v[124:127], v[16:19]
    s_waitcnt lgkmcnt(10)
    v_mfma_f32_16x16x32_bf16 v[20:23], v[204:207], v[124:127], v[20:23]
    ds_read_b64_tr_b16 v[232:233], v7 offset:26624
    v_mfma_f32_16x16x32_bf16 v[20:23], v[200:203], v[120:123], v[20:23]
    ds_read_b64_tr_b16 v[234:235], v7 offset:27136
    v_mfma_f32_16x16x32_bf16 v[28:31], v[200:203], v[128:131], v[28:31]
    ds_read_b64_tr_b16 v[236:237], v7 offset:38912
    v_mfma_f32_16x16x32_bf16 v[28:31], v[204:207], v[132:135], v[28:31]
    ds_read_b64_tr_b16 v[238:239], v7 offset:39424
    v_mfma_f32_16x16x32_bf16 v[36:39], v[204:207], v[140:143], v[36:39]
    v_mfma_f32_16x16x32_bf16 v[36:39], v[200:203], v[136:139], v[36:39]
    v_mfma_f32_16x16x32_bf16 v[44:47], v[200:203], v[144:147], v[44:47]
    v_mfma_f32_16x16x32_bf16 v[44:47], v[204:207], v[148:151], v[44:47]
    s_waitcnt lgkmcnt(7)
    v_mfma_f32_16x16x32_bf16 v[116:119], v[156:159], v[228:231], v[116:119]
    v_mfma_f32_16x16x32_bf16 v[116:119], v[152:155], v[224:227], v[116:119]
    v_mfma_f32_16x16x32_bf16 v[104:107], v[144:147], v[224:227], v[104:107]
    v_mfma_f32_16x16x32_bf16 v[104:107], v[148:151], v[228:231], v[104:107]
    v_mfma_f32_16x16x32_bf16 v[96:99], v[140:143], v[228:231], v[96:99]
    s_waitcnt lgkmcnt(0)
    s_barrier
    v_mfma_f32_16x16x32_bf16 v[96:99], v[136:139], v[224:227], v[96:99]
    ds_read_b64_tr_b16 v[200:201], v6 offset:50176
    v_mfma_f32_16x16x32_bf16 v[88:91], v[128:131], v[224:227], v[88:91]
    ds_read_b64_tr_b16 v[202:203], v6 offset:50688
    v_mfma_f32_16x16x32_bf16 v[88:91], v[132:135], v[228:231], v[88:91]
    ds_read_b64_tr_b16 v[204:205], v6 offset:62464
    v_mfma_f32_16x16x32_bf16 v[80:83], v[124:127], v[228:231], v[80:83]
    ds_read_b64_tr_b16 v[206:207], v6 offset:62976
    v_mfma_f32_16x16x32_bf16 v[80:83], v[120:123], v[224:227], v[80:83]
    v_mfma_f32_16x16x32_bf16 v[84:87], v[120:123], v[232:235], v[84:87]
    ds_read_b64_tr_b16 v[224:225], v7 offset:50176
    v_mfma_f32_16x16x32_bf16 v[84:87], v[124:127], v[236:239], v[84:87]
    ds_read_b64_tr_b16 v[226:227], v7 offset:50688
    v_mfma_f32_16x16x32_bf16 v[92:95], v[132:135], v[236:239], v[92:95]
    ds_read_b64_tr_b16 v[228:229], v7 offset:62464
    v_mfma_f32_16x16x32_bf16 v[92:95], v[128:131], v[232:235], v[92:95]
    ds_read_b64_tr_b16 v[230:231], v7 offset:62976
    v_mfma_f32_16x16x32_bf16 v[100:103], v[136:139], v[232:235], v[100:103]
    v_mfma_f32_16x16x32_bf16 v[100:103], v[140:143], v[236:239], v[100:103]
    v_mfma_f32_16x16x32_bf16 v[108:111], v[148:151], v[236:239], v[108:111]
    v_mfma_f32_16x16x32_bf16 v[108:111], v[144:147], v[232:235], v[108:111]
    s_waitcnt lgkmcnt(4)
    v_mfma_f32_16x16x32_bf16 v[112:115], v[200:203], v[192:195], v[112:115]
    ds_read_b64_tr_b16 v[232:233], v6 offset:49152
    v_mfma_f32_16x16x32_bf16 v[112:115], v[204:207], v[196:199], v[112:115]
    ds_read_b64_tr_b16 v[234:235], v6 offset:49664
    v_mfma_f32_16x16x32_bf16 v[72:75], v[204:207], v[188:191], v[72:75]
    ds_read_b64_tr_b16 v[236:237], v6 offset:61440
    v_mfma_f32_16x16x32_bf16 v[72:75], v[200:203], v[184:187], v[72:75]
    ds_read_b64_tr_b16 v[238:239], v6 offset:61952
    v_mfma_f32_16x16x32_bf16 v[64:67], v[200:203], v[176:179], v[64:67]
    ds_read_b128 v[152:155], v2 offset:0
    v_mfma_f32_16x16x32_bf16 v[64:67], v[204:207], v[180:183], v[64:67]
    ds_read_b128 v[156:159], v3 offset:0
    v_mfma_f32_16x16x32_bf16 v[56:59], v[204:207], v[172:175], v[56:59]
    ds_read_b128 v[144:147], v4 offset:6144
    v_mfma_f32_16x16x32_bf16 v[56:59], v[200:203], v[168:171], v[56:59]
    ds_read_b128 v[148:151], v5 offset:6144
    v_mfma_f32_16x16x32_bf16 v[48:51], v[200:203], v[160:163], v[48:51]
    v_mfma_f32_16x16x32_bf16 v[48:51], v[204:207], v[164:167], v[48:51]
    s_waitcnt lgkmcnt(8)
    v_mfma_f32_16x16x32_bf16 v[52:55], v[228:231], v[164:167], v[52:55]
    ds_read_b64_tr_b16 v[200:201], v7 offset:49152
    v_mfma_f32_16x16x32_bf16 v[52:55], v[224:227], v[160:163], v[52:55]
    ds_read_b64_tr_b16 v[202:203], v7 offset:49664
    v_mfma_f32_16x16x32_bf16 v[60:63], v[224:227], v[168:171], v[60:63]
    ds_read_b64_tr_b16 v[204:205], v7 offset:61440
    v_mfma_f32_16x16x32_bf16 v[60:63], v[228:231], v[172:175], v[60:63]
    ds_read_b64_tr_b16 v[206:207], v7 offset:61952
    v_mfma_f32_16x16x32_bf16 v[68:71], v[228:231], v[180:183], v[68:71]
    ds_read_b128 v[136:139], v4 offset:4096
    v_mfma_f32_16x16x32_bf16 v[68:71], v[224:227], v[176:179], v[68:71]
    ds_read_b128 v[140:143], v5 offset:4096
    v_mfma_f32_16x16x32_bf16 v[76:79], v[224:227], v[184:187], v[76:79]
    ds_read_b128 v[128:131], v4 offset:2048
    v_mfma_f32_16x16x32_bf16 v[76:79], v[228:231], v[188:191], v[76:79]
    s_waitcnt lgkmcnt(11)
    v_mfma_f32_16x16x32_bf16 v[40:43], v[236:239], v[188:191], v[40:43]
    ds_read_b64_tr_b16 v[224:225], v6 offset:51200
    v_mfma_f32_16x16x32_bf16 v[40:43], v[232:235], v[184:187], v[40:43]
    ds_read_b64_tr_b16 v[226:227], v6 offset:51712
    v_mfma_f32_16x16x32_bf16 v[32:35], v[232:235], v[176:179], v[32:35]
    ds_read_b64_tr_b16 v[228:229], v6 offset:63488
    v_mfma_f32_16x16x32_bf16 v[32:35], v[236:239], v[180:183], v[32:35]
    ds_read_b64_tr_b16 v[230:231], v6 offset:64000
    v_mfma_f32_16x16x32_bf16 v[24:27], v[236:239], v[172:175], v[24:27]
    ds_read_b128 v[132:135], v5 offset:2048
    v_mfma_f32_16x16x32_bf16 v[24:27], v[232:235], v[168:171], v[24:27]
    ds_read_b128 v[120:123], v4 offset:0
    v_mfma_f32_16x16x32_bf16 v[16:19], v[232:235], v[160:163], v[16:19]
    ds_read_b128 v[124:127], v5 offset:0
    v_mfma_f32_16x16x32_bf16 v[16:19], v[236:239], v[164:167], v[16:19]
    s_waitcnt lgkmcnt(10)
    v_mfma_f32_16x16x32_bf16 v[20:23], v[204:207], v[164:167], v[20:23]
    ds_read_b64_tr_b16 v[232:233], v7 offset:51200
    v_mfma_f32_16x16x32_bf16 v[20:23], v[200:203], v[160:163], v[20:23]
    ds_read_b64_tr_b16 v[234:235], v7 offset:51712
    v_mfma_f32_16x16x32_bf16 v[28:31], v[200:203], v[168:171], v[28:31]
    ds_read_b64_tr_b16 v[236:237], v7 offset:63488
    v_mfma_f32_16x16x32_bf16 v[28:31], v[204:207], v[172:175], v[28:31]
    ds_read_b64_tr_b16 v[238:239], v7 offset:64000
    v_mfma_f32_16x16x32_bf16 v[36:39], v[204:207], v[180:183], v[36:39]
    v_mfma_f32_16x16x32_bf16 v[36:39], v[200:203], v[176:179], v[36:39]
    v_mfma_f32_16x16x32_bf16 v[44:47], v[200:203], v[184:187], v[44:47]
    v_mfma_f32_16x16x32_bf16 v[44:47], v[204:207], v[188:191], v[44:47]
    s_waitcnt lgkmcnt(7)
    v_mfma_f32_16x16x32_bf16 v[116:119], v[196:199], v[228:231], v[116:119]
    v_mfma_f32_16x16x32_bf16 v[116:119], v[192:195], v[224:227], v[116:119]
    v_mfma_f32_16x16x32_bf16 v[104:107], v[184:187], v[224:227], v[104:107]
    v_mfma_f32_16x16x32_bf16 v[104:107], v[188:191], v[228:231], v[104:107]
    v_mfma_f32_16x16x32_bf16 v[96:99], v[180:183], v[228:231], v[96:99]
    s_waitcnt lgkmcnt(0)
    s_barrier
    v_mfma_f32_16x16x32_bf16 v[96:99], v[176:179], v[224:227], v[96:99]
    ds_read_b64_tr_b16 v[200:201], v6 offset:1024
    v_mfma_f32_16x16x32_bf16 v[88:91], v[168:171], v[224:227], v[88:91]
    ds_read_b64_tr_b16 v[202:203], v6 offset:1536
    v_mfma_f32_16x16x32_bf16 v[88:91], v[172:175], v[228:231], v[88:91]
    ds_read_b64_tr_b16 v[204:205], v6 offset:13312
    v_mfma_f32_16x16x32_bf16 v[80:83], v[164:167], v[228:231], v[80:83]
    ds_read_b64_tr_b16 v[206:207], v6 offset:13824
    v_mfma_f32_16x16x32_bf16 v[80:83], v[160:163], v[224:227], v[80:83]
    v_mfma_f32_16x16x32_bf16 v[84:87], v[160:163], v[232:235], v[84:87]
    ds_read_b64_tr_b16 v[224:225], v7 offset:1024
    v_mfma_f32_16x16x32_bf16 v[84:87], v[164:167], v[236:239], v[84:87]
    ds_read_b64_tr_b16 v[226:227], v7 offset:1536
    v_mfma_f32_16x16x32_bf16 v[92:95], v[172:175], v[236:239], v[92:95]
    ds_read_b64_tr_b16 v[228:229], v7 offset:13312
    v_mfma_f32_16x16x32_bf16 v[92:95], v[168:171], v[232:235], v[92:95]
    ds_read_b64_tr_b16 v[230:231], v7 offset:13824
    v_mfma_f32_16x16x32_bf16 v[100:103], v[176:179], v[232:235], v[100:103]
    v_mfma_f32_16x16x32_bf16 v[100:103], v[180:183], v[236:239], v[100:103]
    v_mfma_f32_16x16x32_bf16 v[108:111], v[188:191], v[236:239], v[108:111]
    v_mfma_f32_16x16x32_bf16 v[108:111], v[184:187], v[232:235], v[108:111]
    s_waitcnt lgkmcnt(4)
    v_mfma_f32_16x16x32_bf16 v[112:115], v[200:203], v[152:155], v[112:115]
    ds_read_b64_tr_b16 v[232:233], v6 offset:0
    v_mfma_f32_16x16x32_bf16 v[112:115], v[204:207], v[156:159], v[112:115]
    ds_read_b64_tr_b16 v[234:235], v6 offset:512
    v_mfma_f32_16x16x32_bf16 v[72:75], v[204:207], v[148:151], v[72:75]
    ds_read_b64_tr_b16 v[236:237], v6 offset:12288
    v_mfma_f32_16x16x32_bf16 v[72:75], v[200:203], v[144:147], v[72:75]
    ds_read_b64_tr_b16 v[238:239], v6 offset:12800
    v_mfma_f32_16x16x32_bf16 v[64:67], v[200:203], v[136:139], v[64:67]
    ds_read_b128 v[192:195], v2 offset:18432
    v_mfma_f32_16x16x32_bf16 v[64:67], v[204:207], v[140:143], v[64:67]
    ds_read_b128 v[196:199], v3 offset:18432
    v_mfma_f32_16x16x32_bf16 v[56:59], v[204:207], v[132:135], v[56:59]
    ds_read_b128 v[184:187], v4 offset:24576
    v_mfma_f32_16x16x32_bf16 v[56:59], v[200:203], v[128:131], v[56:59]
    ds_read_b128 v[188:191], v5 offset:24576
    v_mfma_f32_16x16x32_bf16 v[48:51], v[200:203], v[120:123], v[48:51]
    v_mfma_f32_16x16x32_bf16 v[48:51], v[204:207], v[124:127], v[48:51]
    s_waitcnt lgkmcnt(8)
    v_mfma_f32_16x16x32_bf16 v[52:55], v[228:231], v[124:127], v[52:55]
    ds_read_b64_tr_b16 v[200:201], v7 offset:0
    v_mfma_f32_16x16x32_bf16 v[52:55], v[224:227], v[120:123], v[52:55]
    ds_read_b64_tr_b16 v[202:203], v7 offset:512
    v_mfma_f32_16x16x32_bf16 v[60:63], v[224:227], v[128:131], v[60:63]
    ds_read_b64_tr_b16 v[204:205], v7 offset:12288
    v_mfma_f32_16x16x32_bf16 v[60:63], v[228:231], v[132:135], v[60:63]
    ds_read_b64_tr_b16 v[206:207], v7 offset:12800
    v_mfma_f32_16x16x32_bf16 v[68:71], v[228:231], v[140:143], v[68:71]
    ds_read_b128 v[176:179], v4 offset:22528
    v_mfma_f32_16x16x32_bf16 v[68:71], v[224:227], v[136:139], v[68:71]
    ds_read_b128 v[180:183], v5 offset:22528
    v_mfma_f32_16x16x32_bf16 v[76:79], v[224:227], v[144:147], v[76:79]
    ds_read_b128 v[168:171], v4 offset:20480
    v_mfma_f32_16x16x32_bf16 v[76:79], v[228:231], v[148:151], v[76:79]
    s_waitcnt lgkmcnt(11)
    v_mfma_f32_16x16x32_bf16 v[40:43], v[236:239], v[148:151], v[40:43]
    ds_read_b64_tr_b16 v[224:225], v6 offset:2048
    v_mfma_f32_16x16x32_bf16 v[40:43], v[232:235], v[144:147], v[40:43]
    ds_read_b64_tr_b16 v[226:227], v6 offset:2560
    v_mfma_f32_16x16x32_bf16 v[32:35], v[232:235], v[136:139], v[32:35]
    ds_read_b64_tr_b16 v[228:229], v6 offset:14336
    v_mfma_f32_16x16x32_bf16 v[32:35], v[236:239], v[140:143], v[32:35]
    ds_read_b64_tr_b16 v[230:231], v6 offset:14848
    v_mfma_f32_16x16x32_bf16 v[24:27], v[236:239], v[132:135], v[24:27]
    ds_read_b128 v[172:175], v5 offset:20480
    v_mfma_f32_16x16x32_bf16 v[24:27], v[232:235], v[128:131], v[24:27]
    ds_read_b128 v[160:163], v4 offset:18432
    v_mfma_f32_16x16x32_bf16 v[16:19], v[232:235], v[120:123], v[16:19]
    ds_read_b128 v[164:167], v5 offset:18432
    v_mfma_f32_16x16x32_bf16 v[16:19], v[236:239], v[124:127], v[16:19]
    s_waitcnt lgkmcnt(10)
    v_mfma_f32_16x16x32_bf16 v[20:23], v[204:207], v[124:127], v[20:23]
    ds_read_b64_tr_b16 v[232:233], v7 offset:2048
    v_mfma_f32_16x16x32_bf16 v[20:23], v[200:203], v[120:123], v[20:23]
    ds_read_b64_tr_b16 v[234:235], v7 offset:2560
    v_mfma_f32_16x16x32_bf16 v[28:31], v[200:203], v[128:131], v[28:31]
    ds_read_b64_tr_b16 v[236:237], v7 offset:14336
    v_mfma_f32_16x16x32_bf16 v[28:31], v[204:207], v[132:135], v[28:31]
    ds_read_b64_tr_b16 v[238:239], v7 offset:14848
    v_mfma_f32_16x16x32_bf16 v[36:39], v[204:207], v[140:143], v[36:39]
    buffer_load_dword v222, v220, s[68:71], s98 offen sc1
    v_mfma_f32_16x16x32_bf16 v[36:39], v[200:203], v[136:139], v[36:39]
    v_mfma_f32_16x16x32_bf16 v[44:47], v[200:203], v[144:147], v[44:47]
    v_mfma_f32_16x16x32_bf16 v[44:47], v[204:207], v[148:151], v[44:47]
    s_waitcnt lgkmcnt(7)
    v_mfma_f32_16x16x32_bf16 v[116:119], v[156:159], v[228:231], v[116:119]
    v_mfma_f32_16x16x32_bf16 v[116:119], v[152:155], v[224:227], v[116:119]
    v_mfma_f32_16x16x32_bf16 v[104:107], v[144:147], v[224:227], v[104:107]
    v_mfma_f32_16x16x32_bf16 v[104:107], v[148:151], v[228:231], v[104:107]
    v_mfma_f32_16x16x32_bf16 v[96:99], v[140:143], v[228:231], v[96:99]
    s_waitcnt lgkmcnt(0)
    s_barrier
    v_mfma_f32_16x16x32_bf16 v[96:99], v[136:139], v[224:227], v[96:99]
    ds_read_b64_tr_b16 v[200:201], v6 offset:25600
    v_mfma_f32_16x16x32_bf16 v[88:91], v[128:131], v[224:227], v[88:91]
    ds_read_b64_tr_b16 v[202:203], v6 offset:26112
    v_mfma_f32_16x16x32_bf16 v[88:91], v[132:135], v[228:231], v[88:91]
    ds_read_b64_tr_b16 v[204:205], v6 offset:37888
    v_mfma_f32_16x16x32_bf16 v[80:83], v[124:127], v[228:231], v[80:83]
    ds_read_b64_tr_b16 v[206:207], v6 offset:38400
    v_mfma_f32_16x16x32_bf16 v[80:83], v[120:123], v[224:227], v[80:83]
    v_mfma_f32_16x16x32_bf16 v[84:87], v[120:123], v[232:235], v[84:87]
    ds_read_b64_tr_b16 v[224:225], v7 offset:25600
    v_mfma_f32_16x16x32_bf16 v[84:87], v[124:127], v[236:239], v[84:87]
    ds_read_b64_tr_b16 v[226:227], v7 offset:26112
    v_mfma_f32_16x16x32_bf16 v[92:95], v[132:135], v[236:239], v[92:95]
    ds_read_b64_tr_b16 v[228:229], v7 offset:37888
    v_mfma_f32_16x16x32_bf16 v[92:95], v[128:131], v[232:235], v[92:95]
    ds_read_b64_tr_b16 v[230:231], v7 offset:38400
    v_mfma_f32_16x16x32_bf16 v[100:103], v[136:139], v[232:235], v[100:103]
    v_mfma_f32_16x16x32_bf16 v[100:103], v[140:143], v[236:239], v[100:103]
    v_mfma_f32_16x16x32_bf16 v[108:111], v[148:151], v[236:239], v[108:111]
    v_mfma_f32_16x16x32_bf16 v[108:111], v[144:147], v[232:235], v[108:111]
    s_waitcnt lgkmcnt(4)
    v_mfma_f32_16x16x32_bf16 v[112:115], v[200:203], v[192:195], v[112:115]
    ds_read_b64_tr_b16 v[232:233], v6 offset:24576
    v_mfma_f32_16x16x32_bf16 v[112:115], v[204:207], v[196:199], v[112:115]
    ds_read_b64_tr_b16 v[234:235], v6 offset:25088
    v_mfma_f32_16x16x32_bf16 v[72:75], v[204:207], v[188:191], v[72:75]
    ds_read_b64_tr_b16 v[236:237], v6 offset:36864
    v_mfma_f32_16x16x32_bf16 v[72:75], v[200:203], v[184:187], v[72:75]
    ds_read_b64_tr_b16 v[238:239], v6 offset:37376
    v_mfma_f32_16x16x32_bf16 v[64:67], v[200:203], v[176:179], v[64:67]
    ds_read_b128 v[152:155], v2 offset:36864
    v_mfma_f32_16x16x32_bf16 v[64:67], v[204:207], v[180:183], v[64:67]
    ds_read_b128 v[156:159], v3 offset:36864
    v_mfma_f32_16x16x32_bf16 v[56:59], v[204:207], v[172:175], v[56:59]
    ds_read_b128 v[144:147], v4 offset:43008
    v_mfma_f32_16x16x32_bf16 v[56:59], v[200:203], v[168:171], v[56:59]
    ds_read_b128 v[148:151], v5 offset:43008
    v_mfma_f32_16x16x32_bf16 v[48:51], v[200:203], v[160:163], v[48:51]
    v_mfma_f32_16x16x32_bf16 v[48:51], v[204:207], v[164:167], v[48:51]
    s_waitcnt lgkmcnt(8)
    v_mfma_f32_16x16x32_bf16 v[52:55], v[228:231], v[164:167], v[52:55]
    ds_read_b64_tr_b16 v[200:201], v7 offset:24576
    v_mfma_f32_16x16x32_bf16 v[52:55], v[224:227], v[160:163], v[52:55]
    ds_read_b64_tr_b16 v[202:203], v7 offset:25088
    v_mfma_f32_16x16x32_bf16 v[60:63], v[224:227], v[168:171], v[60:63]
    ds_read_b64_tr_b16 v[204:205], v7 offset:36864
    v_mfma_f32_16x16x32_bf16 v[60:63], v[228:231], v[172:175], v[60:63]
    ds_read_b64_tr_b16 v[206:207], v7 offset:37376
    v_mfma_f32_16x16x32_bf16 v[68:71], v[228:231], v[180:183], v[68:71]
    ds_read_b128 v[136:139], v4 offset:40960
    v_mfma_f32_16x16x32_bf16 v[68:71], v[224:227], v[176:179], v[68:71]
    ds_read_b128 v[140:143], v5 offset:40960
    v_mfma_f32_16x16x32_bf16 v[76:79], v[224:227], v[184:187], v[76:79]
    ds_read_b128 v[128:131], v4 offset:38912
    v_mfma_f32_16x16x32_bf16 v[76:79], v[228:231], v[188:191], v[76:79]
    s_waitcnt lgkmcnt(11)
    v_mfma_f32_16x16x32_bf16 v[40:43], v[236:239], v[188:191], v[40:43]
    ds_read_b64_tr_b16 v[224:225], v6 offset:26624
    v_mfma_f32_16x16x32_bf16 v[40:43], v[232:235], v[184:187], v[40:43]
    ds_read_b64_tr_b16 v[226:227], v6 offset:27136
    v_mfma_f32_16x16x32_bf16 v[32:35], v[232:235], v[176:179], v[32:35]
    ds_read_b64_tr_b16 v[228:229], v6 offset:38912
    v_mfma_f32_16x16x32_bf16 v[32:35], v[236:239], v[180:183], v[32:35]
    ds_read_b64_tr_b16 v[230:231], v6 offset:39424
    v_mfma_f32_16x16x32_bf16 v[24:27], v[236:239], v[172:175], v[24:27]
    ds_read_b128 v[132:135], v5 offset:38912
    v_mfma_f32_16x16x32_bf16 v[24:27], v[232:235], v[168:171], v[24:27]
    ds_read_b128 v[120:123], v4 offset:36864
    v_mfma_f32_16x16x32_bf16 v[16:19], v[232:235], v[160:163], v[16:19]
    ds_read_b128 v[124:127], v5 offset:36864
    v_mfma_f32_16x16x32_bf16 v[16:19], v[236:239], v[164:167], v[16:19]
    s_waitcnt lgkmcnt(10)
    v_mfma_f32_16x16x32_bf16 v[20:23], v[204:207], v[164:167], v[20:23]
    ds_read_b64_tr_b16 v[232:233], v7 offset:26624
    v_mfma_f32_16x16x32_bf16 v[20:23], v[200:203], v[160:163], v[20:23]
    ds_read_b64_tr_b16 v[234:235], v7 offset:27136
    v_mfma_f32_16x16x32_bf16 v[28:31], v[200:203], v[168:171], v[28:31]
    ds_read_b64_tr_b16 v[236:237], v7 offset:38912
    v_mfma_f32_16x16x32_bf16 v[28:31], v[204:207], v[172:175], v[28:31]
    ds_read_b64_tr_b16 v[238:239], v7 offset:39424
    v_mfma_f32_16x16x32_bf16 v[36:39], v[204:207], v[180:183], v[36:39]
    v_mfma_f32_16x16x32_bf16 v[36:39], v[200:203], v[176:179], v[36:39]
    v_mfma_f32_16x16x32_bf16 v[44:47], v[200:203], v[184:187], v[44:47]
    v_mfma_f32_16x16x32_bf16 v[44:47], v[204:207], v[188:191], v[44:47]
    s_waitcnt lgkmcnt(7)
    v_mfma_f32_16x16x32_bf16 v[116:119], v[196:199], v[228:231], v[116:119]
    v_mfma_f32_16x16x32_bf16 v[116:119], v[192:195], v[224:227], v[116:119]
    v_mfma_f32_16x16x32_bf16 v[104:107], v[184:187], v[224:227], v[104:107]
    v_mfma_f32_16x16x32_bf16 v[104:107], v[188:191], v[228:231], v[104:107]
    v_mfma_f32_16x16x32_bf16 v[96:99], v[180:183], v[228:231], v[96:99]
    s_waitcnt lgkmcnt(0)
    s_barrier
    v_mfma_f32_16x16x32_bf16 v[96:99], v[176:179], v[224:227], v[96:99]
    ds_read_b64_tr_b16 v[200:201], v6 offset:50176
    v_mfma_f32_16x16x32_bf16 v[88:91], v[168:171], v[224:227], v[88:91]
    ds_read_b64_tr_b16 v[202:203], v6 offset:50688
    v_mfma_f32_16x16x32_bf16 v[88:91], v[172:175], v[228:231], v[88:91]
    ds_read_b64_tr_b16 v[204:205], v6 offset:62464
    v_mfma_f32_16x16x32_bf16 v[80:83], v[164:167], v[228:231], v[80:83]
    ds_read_b64_tr_b16 v[206:207], v6 offset:62976
    v_mfma_f32_16x16x32_bf16 v[80:83], v[160:163], v[224:227], v[80:83]
    v_mfma_f32_16x16x32_bf16 v[84:87], v[160:163], v[232:235], v[84:87]
    ds_read_b64_tr_b16 v[224:225], v7 offset:50176
    v_mfma_f32_16x16x32_bf16 v[84:87], v[164:167], v[236:239], v[84:87]
    ds_read_b64_tr_b16 v[226:227], v7 offset:50688
    v_mfma_f32_16x16x32_bf16 v[92:95], v[172:175], v[236:239], v[92:95]
    ds_read_b64_tr_b16 v[228:229], v7 offset:62464
    v_mfma_f32_16x16x32_bf16 v[92:95], v[168:171], v[232:235], v[92:95]
    ds_read_b64_tr_b16 v[230:231], v7 offset:62976
    v_mfma_f32_16x16x32_bf16 v[100:103], v[176:179], v[232:235], v[100:103]
    v_mfma_f32_16x16x32_bf16 v[100:103], v[180:183], v[236:239], v[100:103]
    v_mfma_f32_16x16x32_bf16 v[108:111], v[188:191], v[236:239], v[108:111]
    v_mfma_f32_16x16x32_bf16 v[108:111], v[184:187], v[232:235], v[108:111]
    s_waitcnt lgkmcnt(4)
    v_mfma_f32_16x16x32_bf16 v[112:115], v[200:203], v[152:155], v[112:115]
    ds_read_b64_tr_b16 v[232:233], v6 offset:49152
    v_mfma_f32_16x16x32_bf16 v[112:115], v[204:207], v[156:159], v[112:115]
    ds_read_b64_tr_b16 v[234:235], v6 offset:49664
    v_mfma_f32_16x16x32_bf16 v[72:75], v[204:207], v[148:151], v[72:75]
    ds_read_b64_tr_b16 v[236:237], v6 offset:61440
    v_mfma_f32_16x16x32_bf16 v[72:75], v[200:203], v[144:147], v[72:75]
    ds_read_b64_tr_b16 v[238:239], v6 offset:61952
    v_mfma_f32_16x16x32_bf16 v[64:67], v[200:203], v[136:139], v[64:67]
    ds_read_b128 v[192:195], v2 offset:0
    v_mfma_f32_16x16x32_bf16 v[64:67], v[204:207], v[140:143], v[64:67]
    ds_read_b128 v[196:199], v3 offset:0
    v_mfma_f32_16x16x32_bf16 v[56:59], v[204:207], v[132:135], v[56:59]
    ds_read_b128 v[184:187], v4 offset:6144
    v_mfma_f32_16x16x32_bf16 v[56:59], v[200:203], v[128:131], v[56:59]
    ds_read_b128 v[188:191], v5 offset:6144
    v_mfma_f32_16x16x32_bf16 v[48:51], v[200:203], v[120:123], v[48:51]
    v_mfma_f32_16x16x32_bf16 v[48:51], v[204:207], v[124:127], v[48:51]
    s_waitcnt lgkmcnt(8)
    v_mfma_f32_16x16x32_bf16 v[52:55], v[228:231], v[124:127], v[52:55]
    ds_read_b64_tr_b16 v[200:201], v7 offset:49152
    v_mfma_f32_16x16x32_bf16 v[52:55], v[224:227], v[120:123], v[52:55]
    ds_read_b64_tr_b16 v[202:203], v7 offset:49664
    v_mfma_f32_16x16x32_bf16 v[60:63], v[224:227], v[128:131], v[60:63]
    ds_read_b64_tr_b16 v[204:205], v7 offset:61440
    v_mfma_f32_16x16x32_bf16 v[60:63], v[228:231], v[132:135], v[60:63]
    ds_read_b64_tr_b16 v[206:207], v7 offset:61952
    v_mfma_f32_16x16x32_bf16 v[68:71], v[228:231], v[140:143], v[68:71]
    ds_read_b128 v[176:179], v4 offset:4096
    v_mfma_f32_16x16x32_bf16 v[68:71], v[224:227], v[136:139], v[68:71]
    ds_read_b128 v[180:183], v5 offset:4096
    v_mfma_f32_16x16x32_bf16 v[76:79], v[224:227], v[144:147], v[76:79]
    ds_read_b128 v[168:171], v4 offset:2048
    v_mfma_f32_16x16x32_bf16 v[76:79], v[228:231], v[148:151], v[76:79]
    s_waitcnt lgkmcnt(11)
    v_mfma_f32_16x16x32_bf16 v[40:43], v[236:239], v[148:151], v[40:43]
    ds_read_b64_tr_b16 v[224:225], v6 offset:51200
    v_mfma_f32_16x16x32_bf16 v[40:43], v[232:235], v[144:147], v[40:43]
    ds_read_b64_tr_b16 v[226:227], v6 offset:51712
    v_mfma_f32_16x16x32_bf16 v[32:35], v[232:235], v[136:139], v[32:35]
    ds_read_b64_tr_b16 v[228:229], v6 offset:63488
    v_mfma_f32_16x16x32_bf16 v[32:35], v[236:239], v[140:143], v[32:35]
    ds_read_b64_tr_b16 v[230:231], v6 offset:64000
    v_mfma_f32_16x16x32_bf16 v[24:27], v[236:239], v[132:135], v[24:27]
    ds_read_b128 v[172:175], v5 offset:2048
    v_mfma_f32_16x16x32_bf16 v[24:27], v[232:235], v[128:131], v[24:27]
    ds_read_b128 v[160:163], v4 offset:0
    v_mfma_f32_16x16x32_bf16 v[16:19], v[232:235], v[120:123], v[16:19]
    ds_read_b128 v[164:167], v5 offset:0
    v_mfma_f32_16x16x32_bf16 v[16:19], v[236:239], v[124:127], v[16:19]
    s_waitcnt lgkmcnt(10)
    v_mfma_f32_16x16x32_bf16 v[20:23], v[204:207], v[124:127], v[20:23]
    ds_read_b64_tr_b16 v[232:233], v7 offset:51200
    v_mfma_f32_16x16x32_bf16 v[20:23], v[200:203], v[120:123], v[20:23]
    ds_read_b64_tr_b16 v[234:235], v7 offset:51712
    v_mfma_f32_16x16x32_bf16 v[28:31], v[200:203], v[128:131], v[28:31]
    ds_read_b64_tr_b16 v[236:237], v7 offset:63488
    v_mfma_f32_16x16x32_bf16 v[28:31], v[204:207], v[132:135], v[28:31]
    ds_read_b64_tr_b16 v[238:239], v7 offset:64000
    v_mfma_f32_16x16x32_bf16 v[36:39], v[204:207], v[140:143], v[36:39]
    v_mfma_f32_16x16x32_bf16 v[36:39], v[200:203], v[136:139], v[36:39]
    v_mfma_f32_16x16x32_bf16 v[44:47], v[200:203], v[144:147], v[44:47]
    v_mfma_f32_16x16x32_bf16 v[44:47], v[204:207], v[148:151], v[44:47]
    s_waitcnt lgkmcnt(7)
    v_mfma_f32_16x16x32_bf16 v[116:119], v[156:159], v[228:231], v[116:119]
    v_mfma_f32_16x16x32_bf16 v[116:119], v[152:155], v[224:227], v[116:119]
    v_mfma_f32_16x16x32_bf16 v[104:107], v[144:147], v[224:227], v[104:107]
    v_mfma_f32_16x16x32_bf16 v[104:107], v[148:151], v[228:231], v[104:107]
    v_mfma_f32_16x16x32_bf16 v[96:99], v[140:143], v[228:231], v[96:99]
    s_waitcnt lgkmcnt(0)
    s_barrier
    s_cmp_lg_u32 s3, 0
    s_cbranch_scc1 LB_sk
    s_waitcnt vmcnt(0)
    v_cmp_eq_u32 vcc, 0, v222
    s_cbranch_vccnz LB_slow
LB_back:
    s_mov_b64 exec, 1
    buffer_store_dword v222, v220, s[52:55], s96 offen sc1
    s_mov_b64 exec, -1
LB_sk:
    v_mfma_f32_16x16x32_bf16 v[96:99], v[136:139], v[224:227], v[96:99]
    ds_read_b64_tr_b16 v[200:201], v6 offset:1024
    v_mfma_f32_16x16x32_bf16 v[88:91], v[128:131], v[224:227], v[88:91]
    ds_read_b64_tr_b16 v[202:203], v6 offset:1536
    v_mfma_f32_16x16x32_bf16 v[88:91], v[132:135], v[228:231], v[88:91]
    ds_read_b64_tr_b16 v[204:205], v6 offset:13312
    v_mfma_f32_16x16x32_bf16 v[80:83], v[124:127], v[228:231], v[80:83]
    ds_read_b64_tr_b16 v[206:207], v6 offset:13824
    v_mfma_f32_16x16x32_bf16 v[80:83], v[120:123], v[224:227], v[80:83]
    v_mfma_f32_16x16x32_bf16 v[84:87], v[120:123], v[232:235], v[84:87]
    ds_read_b64_tr_b16 v[224:225], v7 offset:1024
    v_mfma_f32_16x16x32_bf16 v[84:87], v[124:127], v[236:239], v[84:87]
    ds_read_b64_tr_b16 v[226:227], v7 offset:1536
    v_mfma_f32_16x16x32_bf16 v[92:95], v[132:135], v[236:239], v[92:95]
    ds_read_b64_tr_b16 v[228:229], v7 offset:13312
    v_mfma_f32_16x16x32_bf16 v[92:95], v[128:131], v[232:235], v[92:95]
    ds_read_b64_tr_b16 v[230:231], v7 offset:13824
    v_mfma_f32_16x16x32_bf16 v[100:103], v[136:139], v[232:235], v[100:103]
    v_mfma_f32_16x16x32_bf16 v[100:103], v[140:143], v[236:239], v[100:103]
    v_mfma_f32_16x16x32_bf16 v[108:111], v[148:151], v[236:239], v[108:111]
    v_mfma_f32_16x16x32_bf16 v[108:111], v[144:147], v[232:235], v[108:111]
    s_waitcnt lgkmcnt(4)
    v_mfma_f32_16x16x32_bf16 v[112:115], v[200:203], v[192:195], v[112:115]
    ds_read_b64_tr_b16 v[232:233], v6 offset:0
    v_mfma_f32_16x16x32_bf16 v[112:115], v[204:207], v[196:199], v[112:115]
    ds_read_b64_tr_b16 v[234:235], v6 offset:512
    v_mfma_f32_16x16x32_bf16 v[72:75], v[204:207], v[188:191], v[72:75]
    ds_read_b64_tr_b16 v[236:237], v6 offset:12288
    v_mfma_f32_16x16x32_bf16 v[72:75], v[200:203], v[184:187], v[72:75]
    ds_read_b64_tr_b16 v[238:239], v6 offset:12800
    v_mfma_f32_16x16x32_bf16 v[64:67], v[200:203], v[176:179], v[64:67]
    ds_read_b128 v[152:155], v2 offset:18432
    v_mfma_f32_16x16x32_bf16 v[64:67], v[204:207], v[180:183], v[64:67]
    ds_read_b128 v[156:159], v3 offset:18432
    v_mfma_f32_16x16x32_bf16 v[56:59], v[204:207], v[172:175], v[56:59]
    ds_read_b128 v[144:147], v4 offset:24576
    v_mfma_f32_16x16x32_bf16 v[56:59], v[200:203], v[168:171], v[56:59]
    ds_read_b128 v[148:151], v5 offset:24576
    v_mfma_f32_16x16x32_bf16 v[48:51], v[200:203], v[160:163], v[48:51]
    v_mfma_f32_16x16x32_bf16 v[48:51], v[204:207], v[164:167], v[48:51]
    s_waitcnt lgkmcnt(8)
    v_mfma_f32_16x16x32_bf16 v[52:55], v[228:231], v[164:167], v[52:55]
    ds_read_b64_tr_b16 v[200:201], v7 offset:0
    v_mfma_f32_16x16x32_bf16 v[52:55], v[224:227], v[160:163], v[52:55]
    ds_read_b64_tr_b16 v[202:203], v7 offset:512
    v_mfma_f32_16x16x32_bf16 v[60:63], v[224:227], v[168:171], v[60:63]
    ds_read_b64_tr_b16 v[204:205], v7 offset:12288
    v_mfma_f32_16x16x32_bf16 v[60:63], v[228:231], v[172:175], v[60:63]
    ds_read_b64_tr_b16 v[206:207], v7 offset:12800
    v_mfma_f32_16x16x32_bf16 v[68:71], v[228:231], v[180:183], v[68:71]
    ds_read_b128 v[136:139], v4 offset:22528
    v_mfma_f32_16x16x32_bf16 v[68:71], v[224:227], v[176:179], v[68:71]
    ds_read_b128 v[140:143], v5 offset:22528
    v_mfma_f32_16x16x32_bf16 v[76:79], v[224:227], v[184:187], v[76:79]
    ds_read_b128 v[128:131], v4 offset:20480
    v_mfma_f32_16x16x32_bf16 v[76:79], v[228:231], v[188:191], v[76:79]
    s_waitcnt lgkmcnt(11)
    v_mfma_f32_16x16x32_bf16 v[40:43], v[236:239], v[188:191], v[40:43]
    ds_read_b64_tr_b16 v[224:225], v6 offset:2048
    v_mfma_f32_16x16x32_bf16 v[40:43], v[232:235], v[184:187], v[40:43]
    ds_read_b64_tr_b16 v[226:227], v6 offset:2560
    v_mfma_f32_16x16x32_bf16 v[32:35], v[232:235], v[176:179], v[32:35]
    ds_read_b64_tr_b16 v[228:229], v6 offset:14336
    v_mfma_f32_16x16x32_bf16 v[32:35], v[236:239], v[180:183], v[32:35]
    ds_read_b64_tr_b16 v[230:231], v6 offset:14848
    v_mfma_f32_16x16x32_bf16 v[24:27], v[236:239], v[172:175], v[24:27]
    ds_read_b128 v[132:135], v5 offset:20480
    v_mfma_f32_16x16x32_bf16 v[24:27], v[232:235], v[168:171], v[24:27]
    ds_read_b128 v[120:123], v4 offset:18432
    v_mfma_f32_16x16x32_bf16 v[16:19], v[232:235], v[160:163], v[16:19]
    ds_read_b128 v[124:127], v5 offset:18432
    v_mfma_f32_16x16x32_bf16 v[16:19], v[236:239], v[164:167], v[16:19]
    s_waitcnt lgkmcnt(10)
    v_mfma_f32_16x16x32_bf16 v[20:23], v[204:207], v[164:167], v[20:23]
    ds_read_b64_tr_b16 v[232:233], v7 offset:2048
    v_mfma_f32_16x16x32_bf16 v[20:23], v[200:203], v[160:163], v[20:23]
    ds_read_b64_tr_b16 v[234:235], v7 offset:2560
    v_mfma_f32_16x16x32_bf16 v[28:31], v[200:203], v[168:171], v[28:31]
    ds_read_b64_tr_b16 v[236:237], v7 offset:14336
    v_mfma_f32_16x16x32_bf16 v[28:31], v[204:207], v[172:175], v[28:31]
    ds_read_b64_tr_b16 v[238:239], v7 offset:14848
    v_mfma_f32_16x16x32_bf16 v[36:39], v[204:207], v[180:183], v[36:39]
    v_mfma_f32_16x16x32_bf16 v[36:39], v[200:203], v[176:179], v[36:39]
    v_mfma_f32_16x16x32_bf16 v[44:47], v[200:203], v[184:187], v[44:47]
    v_mfma_f32_16x16x32_bf16 v[44:47], v[204:207], v[188:191], v[44:47]
    s_waitcnt lgkmcnt(7)
    v_mfma_f32_16x16x32_bf16 v[116:119], v[196:199], v[228:231], v[116:119]
    v_mfma_f32_16x16x32_bf16 v[116:119], v[192:195], v[224:227], v[116:119]
    v_mfma_f32_16x16x32_bf16 v[104:107], v[184:187], v[224:227], v[104:107]
    v_mfma_f32_16x16x32_bf16 v[104:107], v[188:191], v[228:231], v[104:107]
    v_mfma_f32_16x16x32_bf16 v[96:99], v[180:183], v[228:231], v[96:99]
    s_waitcnt lgkmcnt(0)
    s_barrier
    v_mfma_f32_16x16x32_bf16 v[96:99], v[176:179], v[224:227], v[96:99]
    ds_read_b64_tr_b16 v[200:201], v6 offset:25600
    v_mfma_f32_16x16x32_bf16 v[88:91], v[168:171], v[224:227], v[88:91]
    ds_read_b64_tr_b16 v[202:203], v6 offset:26112
    v_mfma_f32_16x16x32_bf16 v[88:91], v[172:175], v[228:231], v[88:91]
    ds_read_b64_tr_b16 v[204:205], v6 offset:37888
    v_mfma_f32_16x16x32_bf16 v[80:83], v[164:167], v[228:231], v[80:83]
    ds_read_b64_tr_b16 v[206:207], v6 offset:38400
    v_mfma_f32_16x16x32_bf16 v[80:83], v[160:163], v[224:227], v[80:83]
    v_mfma_f32_16x16x32_bf16 v[84:87], v[160:163], v[232:235], v[84:87]
    ds_read_b64_tr_b16 v[224:225], v7 offset:25600
    v_mfma_f32_16x16x32_bf16 v[84:87], v[164:167], v[236:239], v[84:87]
    ds_read_b64_tr_b16 v[226:227], v7 offset:26112
    v_mfma_f32_16x16x32_bf16 v[92:95], v[172:175], v[236:239], v[92:95]
    ds_read_b64_tr_b16 v[228:229], v7 offset:37888
    v_mfma_f32_16x16x32_bf16 v[92:95], v[168:171], v[232:235], v[92:95]
    ds_read_b64_tr_b16 v[230:231], v7 offset:38400
    v_mfma_f32_16x16x32_bf16 v[100:103], v[176:179], v[232:235], v[100:103]
    v_mfma_f32_16x16x32_bf16 v[100:103], v[180:183], v[236:239], v[100:103]
    v_mfma_f32_16x16x32_bf16 v[108:111], v[188:191], v[236:239], v[108:111]
    v_mfma_f32_16x16x32_bf16 v[108:111], v[184:187], v[232:235], v[108:111]
    s_waitcnt lgkmcnt(4)
    v_mfma_f32_16x16x32_bf16 v[112:115], v[200:203], v[152:155], v[112:115]
    ds_read_b64_tr_b16 v[232:233], v6 offset:24576
    v_mfma_f32_16x16x32_bf16 v[112:115], v[204:207], v[156:159], v[112:115]
    ds_read_b64_tr_b16 v[234:235], v6 offset:25088
    v_mfma_f32_16x16x32_bf16 v[72:75], v[204:207], v[148:151], v[72:75]
    ds_read_b64_tr_b16 v[236:237], v6 offset:36864
    v_mfma_f32_16x16x32_bf16 v[72:75], v[200:203], v[144:147], v[72:75]
    ds_read_b64_tr_b16 v[238:239], v6 offset:37376
    v_mfma_f32_16x16x32_bf16 v[64:67], v[200:203], v[136:139], v[64:67]
    ds_read_b128 v[192:195], v2 offset:36864
    v_mfma_f32_16x16x32_bf16 v[64:67], v[204:207], v[140:143], v[64:67]
    ds_read_b128 v[196:199], v3 offset:36864
    v_mfma_f32_16x16x32_bf16 v[56:59], v[204:207], v[132:135], v[56:59]
    ds_read_b128 v[184:187], v4 offset:43008
    v_mfma_f32_16x16x32_bf16 v[56:59], v[200:203], v[128:131], v[56:59]
    ds_read_b128 v[188:191], v5 offset:43008
    v_mfma_f32_16x16x32_bf16 v[48:51], v[200:203], v[120:123], v[48:51]
    v_mfma_f32_16x16x32_bf16 v[48:51], v[204:207], v[124:127], v[48:51]
    s_waitcnt lgkmcnt(8)
    v_mfma_f32_16x16x32_bf16 v[52:55], v[228:231], v[124:127], v[52:55]
    ds_read_b64_tr_b16 v[200:201], v7 offset:24576
    v_mfma_f32_16x16x32_bf16 v[52:55], v[224:227], v[120:123], v[52:55]
    ds_read_b64_tr_b16 v[202:203], v7 offset:25088
    v_mfma_f32_16x16x32_bf16 v[60:63], v[224:227], v[128:131], v[60:63]
    ds_read_b64_tr_b16 v[204:205], v7 offset:36864
    v_mfma_f32_16x16x32_bf16 v[60:63], v[228:231], v[132:135], v[60:63]
    ds_read_b64_tr_b16 v[206:207], v7 offset:37376
    v_mfma_f32_16x16x32_bf16 v[68:71], v[228:231], v[140:143], v[68:71]
    ds_read_b128 v[176:179], v4 offset:40960
    v_mfma_f32_16x16x32_bf16 v[68:71], v[224:227], v[136:139], v[68:71]
    ds_read_b128 v[180:183], v5 offset:40960
    v_mfma_f32_16x16x32_bf16 v[76:79], v[224:227], v[144:147], v[76:79]
    ds_read_b128 v[168:171], v4 offset:38912
    v_mfma_f32_16x16x32_bf16 v[76:79], v[228:231], v[148:151], v[76:79]
    s_waitcnt lgkmcnt(11)
    v_mfma_f32_16x16x32_bf16 v[40:43], v[236:239], v[148:151], v[40:43]
    ds_read_b64_tr_b16 v[224:225], v6 offset:26624
    v_mfma_f32_16x16x32_bf16 v[40:43], v[232:235], v[144:147], v[40:43]
    ds_read_b64_tr_b16 v[226:227], v6 offset:27136
    v_mfma_f32_16x16x32_bf16 v[32:35], v[232:235], v[136:139], v[32:35]
    ds_read_b64_tr_b16 v[228:229], v6 offset:38912
    v_mfma_f32_16x16x32_bf16 v[32:35], v[236:239], v[140:143], v[32:35]
    ds_read_b64_tr_b16 v[230:231], v6 offset:39424
    v_mfma_f32_16x16x32_bf16 v[24:27], v[236:239], v[132:135], v[24:27]
    ds_read_b128 v[172:175], v5 offset:38912
    v_mfma_f32_16x16x32_bf16 v[24:27], v[232:235], v[128:131], v[24:27]
    ds_read_b128 v[160:163], v4 offset:36864
    v_mfma_f32_16x16x32_bf16 v[16:19], v[232:235], v[120:123], v[16:19]
    ds_read_b128 v[164:167], v5 offset:36864
    v_mfma_f32_16x16x32_bf16 v[16:19], v[236:239], v[124:127], v[16:19]
    s_waitcnt lgkmcnt(10)
    v_mfma_f32_16x16x32_bf16 v[20:23], v[204:207], v[124:127], v[20:23]
    ds_read_b64_tr_b16 v[232:233], v7 offset:26624
    v_mfma_f32_16x16x32_bf16 v[20:23], v[200:203], v[120:123], v[20:23]
    ds_read_b64_tr_b16 v[234:235], v7 offset:27136
    v_mfma_f32_16x16x32_bf16 v[28:31], v[200:203], v[128:131], v[28:31]
    ds_read_b64_tr_b16 v[236:237], v7 offset:38912
    v_mfma_f32_16x16x32_bf16 v[28:31], v[204:207], v[132:135], v[28:31]
    ds_read_b64_tr_b16 v[238:239], v7 offset:39424
    v_mfma_f32_16x16x32_bf16 v[36:39], v[204:207], v[140:143], v[36:39]
    v_mfma_f32_16x16x32_bf16 v[36:39], v[200:203], v[136:139], v[36:39]
    v_mfma_f32_16x16x32_bf16 v[44:47], v[200:203], v[144:147], v[44:47]
    v_mfma_f32_16x16x32_bf16 v[44:47], v[204:207], v[148:151], v[44:47]
    s_waitcnt lgkmcnt(7)
    v_mfma_f32_16x16x32_bf16 v[116:119], v[156:159], v[228:231], v[116:119]
    v_mfma_f32_16x16x32_bf16 v[116:119], v[152:155], v[224:227], v[116:119]
    v_mfma_f32_16x16x32_bf16 v[104:107], v[144:147], v[224:227], v[104:107]
    v_mfma_f32_16x16x32_bf16 v[104:107], v[148:151], v[228:231], v[104:107]
    v_mfma_f32_16x16x32_bf16 v[96:99], v[140:143], v[228:231], v[96:99]
    s_waitcnt lgkmcnt(0)
    s_barrier
    v_mfma_f32_16x16x32_bf16 v[96:99], v[136:139], v[224:227], v[96:99]
    ds_read_b64_tr_b16 v[200:201], v6 offset:50176
    v_mfma_f32_16x16x32_bf16 v[88:91], v[128:131], v[224:227], v[88:91]
    ds_read_b64_tr_b16 v[202:203], v6 offset:50688
    v_mfma_f32_16x16x32_bf16 v[88:91], v[132:135], v[228:231], v[88:91]
    ds_read_b64_tr_b16 v[204:205], v6 offset:62464
    v_mfma_f32_16x16x32_bf16 v[80:83], v[124:127], v[228:231], v[80:83]
    ds_read_b64_tr_b16 v[206:207], v6 offset:62976
    v_mfma_f32_16x16x32_bf16 v[80:83], v[120:123], v[224:227], v[80:83]
    v_mfma_f32_16x16x32_bf16 v[84:87], v[120:123], v[232:235], v[84:87]
    ds_read_b64_tr_b16 v[224:225], v7 offset:50176
    v_mfma_f32_16x16x32_bf16 v[84:87], v[124:127], v[236:239], v[84:87]
    ds_read_b64_tr_b16 v[226:227], v7 offset:50688
    v_mfma_f32_16x16x32_bf16 v[92:95], v[132:135], v[236:239], v[92:95]
    ds_read_b64_tr_b16 v[228:229], v7 offset:62464
    v_mfma_f32_16x16x32_bf16 v[92:95], v[128:131], v[232:235], v[92:95]
    ds_read_b64_tr_b16 v[230:231], v7 offset:62976
    v_mfma_f32_16x16x32_bf16 v[100:103], v[136:139], v[232:235], v[100:103]
    v_mfma_f32_16x16x32_bf16 v[100:103], v[140:143], v[236:239], v[100:103]
    v_mfma_f32_16x16x32_bf16 v[108:111], v[148:151], v[236:239], v[108:111]
    v_mfma_f32_16x16x32_bf16 v[108:111], v[144:147], v[232:235], v[108:111]
    s_waitcnt lgkmcnt(4)
    v_mfma_f32_16x16x32_bf16 v[112:115], v[200:203], v[192:195], v[112:115]
    ds_read_b64_tr_b16 v[232:233], v6 offset:49152
    v_mfma_f32_16x16x32_bf16 v[112:115], v[204:207], v[196:199], v[112:115]
    ds_read_b64_tr_b16 v[234:235], v6 offset:49664
    v_mfma_f32_16x16x32_bf16 v[72:75], v[204:207], v[188:191], v[72:75]
    ds_read_b64_tr_b16 v[236:237], v6 offset:61440
    v_mfma_f32_16x16x32_bf16 v[72:75], v[200:203], v[184:187], v[72:75]
    ds_read_b64_tr_b16 v[238:239], v6 offset:61952
    v_mfma_f32_16x16x32_bf16 v[64:67], v[200:203], v[176:179], v[64:67]
    ds_read_b128 v[152:155], v2 offset:0
    v_mfma_f32_16x16x32_bf16 v[64:67], v[204:207], v[180:183], v[64:67]
    ds_read_b128 v[156:159], v3 offset:0
    v_mfma_f32_16x16x32_bf16 v[56:59], v[204:207], v[172:175], v[56:59]
    ds_read_b128 v[144:147], v4 offset:6144
    v_mfma_f32_16x16x32_bf16 v[56:59], v[200:203], v[168:171], v[56:59]
    ds_read_b128 v[148:151], v5 offset:6144
    v_mfma_f32_16x16x32_bf16 v[48:51], v[200:203], v[160:163], v[48:51]
    v_mfma_f32_16x16x32_bf16 v[48:51], v[204:207], v[164:167], v[48:51]
    s_waitcnt lgkmcnt(8)
    v_mfma_f32_16x16x32_bf16 v[52:55], v[228:231], v[164:167], v[52:55]
    ds_read_b64_tr_b16 v[200:201], v7 offset:49152
    v_mfma_f32_16x16x32_bf16 v[52:55], v[224:227], v[160:163], v[52:55]
    ds_read_b64_tr_b16 v[202:203], v7 offset:49664
    v_mfma_f32_16x16x32_bf16 v[60:63], v[224:227], v[168:171], v[60:63]
    ds_read_b64_tr_b16 v[204:205], v7 offset:61440
    v_mfma_f32_16x16x32_bf16 v[60:63], v[228:231], v[172:175], v[60:63]
    ds_read_b64_tr_b16 v[206:207], v7 offset:61952
    v_mfma_f32_16x16x32_bf16 v[68:71], v[228:231], v[180:183], v[68:71]
    ds_read_b128 v[136:139], v4 offset:4096
    v_mfma_f32_16x16x32_bf16 v[68:71], v[224:227], v[176:179], v[68:71]
    ds_read_b128 v[140:143], v5 offset:4096
    v_mfma_f32_16x16x32_bf16 v[76:79], v[224:227], v[184:187], v[76:79]
    ds_read_b128 v[128:131], v4 offset:2048
    v_mfma_f32_16x16x32_bf16 v[76:79], v[228:231], v[188:191], v[76:79]
    s_waitcnt lgkmcnt(11)
    v_mfma_f32_16x16x32_bf16 v[40:43], v[236:239], v[188:191], v[40:43]
    ds_read_b64_tr_b16 v[224:225], v6 offset:51200
    v_mfma_f32_16x16x32_bf16 v[40:43], v[232:235], v[184:187], v[40:43]
    ds_read_b64_tr_b16 v[226:227], v6 offset:51712
    v_mfma_f32_16x16x32_bf16 v[32:35], v[232:235], v[176:179], v[32:35]
    ds_read_b64_tr_b16 v[228:229], v6 offset:63488
    v_mfma_f32_16x16x32_bf16 v[32:35], v[236:239], v[180:183], v[32:35]
    ds_read_b64_tr_b16 v[230:231], v6 offset:64000
    v_mfma_f32_16x16x32_bf16 v[24:27], v[236:239], v[172:175], v[24:27]
    ds_read_b128 v[132:135], v5 offset:2048
    v_mfma_f32_16x16x32_bf16 v[24:27], v[232:235], v[168:171], v[24:27]
    ds_read_b128 v[120:123], v4 offset:0
    v_mfma_f32_16x16x32_bf16 v[16:19], v[232:235], v[160:163], v[16:19]
    ds_read_b128 v[124:127], v5 offset:0
    v_mfma_f32_16x16x32_bf16 v[16:19], v[236:239], v[164:167], v[16:19]
    s_waitcnt lgkmcnt(10)
    v_mfma_f32_16x16x32_bf16 v[20:23], v[204:207], v[164:167], v[20:23]
    ds_read_b64_tr_b16 v[232:233], v7 offset:51200
    v_mfma_f32_16x16x32_bf16 v[20:23], v[200:203], v[160:163], v[20:23]
    ds_read_b64_tr_b16 v[234:235], v7 offset:51712
    v_mfma_f32_16x16x32_bf16 v[28:31], v[200:203], v[168:171], v[28:31]
    ds_read_b64_tr_b16 v[236:237], v7 offset:63488
    v_mfma_f32_16x16x32_bf16 v[28:31], v[204:207], v[172:175], v[28:31]
    ds_read_b64_tr_b16 v[238:239], v7 offset:64000
    v_mfma_f32_16x16x32_bf16 v[36:39], v[204:207], v[180:183], v[36:39]
    v_mfma_f32_16x16x32_bf16 v[36:39], v[200:203], v[176:179], v[36:39]
    v_mfma_f32_16x16x32_bf16 v[44:47], v[200:203], v[184:187], v[44:47]
    v_mfma_f32_16x16x32_bf16 v[44:47], v[204:207], v[188:191], v[44:47]
    s_waitcnt lgkmcnt(7)
    v_mfma_f32_16x16x32_bf16 v[116:119], v[196:199], v[228:231], v[116:119]
    v_mfma_f32_16x16x32_bf16 v[116:119], v[192:195], v[224:227], v[116:119]
    v_mfma_f32_16x16x32_bf16 v[104:107], v[184:187], v[224:227], v[104:107]
    v_mfma_f32_16x16x32_bf16 v[104:107], v[188:191], v[228:231], v[104:107]
    v_mfma_f32_16x16x32_bf16 v[96:99], v[180:183], v[228:231], v[96:99]
    s_waitcnt lgkmcnt(0)
    s_barrier
    v_mfma_f32_16x16x32_bf16 v[96:99], v[176:179], v[224:227], v[96:99]
    ds_read_b64_tr_b16 v[200:201], v6 offset:1024
    v_mfma_f32_16x16x32_bf16 v[88:91], v[168:171], v[224:227], v[88:91]
    ds_read_b64_tr_b16 v[202:203], v6 offset:1536
    v_mfma_f32_16x16x32_bf16 v[88:91], v[172:175], v[228:231], v[88:91]
    ds_read_b64_tr_b16 v[204:205], v6 offset:13312
    v_mfma_f32_16x16x32_bf16 v[80:83], v[164:167], v[228:231], v[80:83]
    ds_read_b64_tr_b16 v[206:207], v6 offset:13824
    v_mfma_f32_16x16x32_bf16 v[80:83], v[160:163], v[224:227], v[80:83]
    v_mfma_f32_16x16x32_bf16 v[84:87], v[160:163], v[232:235], v[84:87]
    ds_read_b64_tr_b16 v[224:225], v7 offset:1024
    v_mfma_f32_16x16x32_bf16 v[84:87], v[164:167], v[236:239], v[84:87]
    ds_read_b64_tr_b16 v[226:227], v7 offset:1536
    v_mfma_f32_16x16x32_bf16 v[92:95], v[172:175], v[236:239], v[92:95]
    ds_read_b64_tr_b16 v[228:229], v7 offset:13312
    v_mfma_f32_16x16x32_bf16 v[92:95], v[168:171], v[232:235], v[92:95]
    ds_read_b64_tr_b16 v[230:231], v7 offset:13824
    v_mfma_f32_16x16x32_bf16 v[100:103], v[176:179], v[232:235], v[100:103]
    v_mfma_f32_16x16x32_bf16 v[100:103], v[180:183], v[236:239], v[100:103]
    v_mfma_f32_16x16x32_bf16 v[108:111], v[188:191], v[236:239], v[108:111]
    v_mfma_f32_16x16x32_bf16 v[108:111], v[184:187], v[232:235], v[108:111]
    s_waitcnt lgkmcnt(4)
    v_mfma_f32_16x16x32_bf16 v[112:115], v[200:203], v[152:155], v[112:115]
    ds_read_b64_tr_b16 v[232:233], v6 offset:0
    v_mfma_f32_16x16x32_bf16 v[112:115], v[204:207], v[156:159], v[112:115]
    ds_read_b64_tr_b16 v[234:235], v6 offset:512
    v_mfma_f32_16x16x32_bf16 v[72:75], v[204:207], v[148:151], v[72:75]
    ds_read_b64_tr_b16 v[236:237], v6 offset:12288
    v_mfma_f32_16x16x32_bf16 v[72:75], v[200:203], v[144:147], v[72:75]
    ds_read_b64_tr_b16 v[238:239], v6 offset:12800
    v_mfma_f32_16x16x32_bf16 v[64:67], v[200:203], v[136:139], v[64:67]
    ds_read_b128 v[192:195], v2 offset:18432
    v_mfma_f32_16x16x32_bf16 v[64:67], v[204:207], v[140:143], v[64:67]
    ds_read_b128 v[196:199], v3 offset:18432
    v_mfma_f32_16x16x32_bf16 v[56:59], v[204:207], v[132:135], v[56:59]
    ds_read_b128 v[184:187], v4 offset:24576
    v_mfma_f32_16x16x32_bf16 v[56:59], v[200:203], v[128:131], v[56:59]
    ds_read_b128 v[188:191], v5 offset:24576
    v_mfma_f32_16x16x32_bf16 v[48:51], v[200:203], v[120:123], v[48:51]
    v_mfma_f32_16x16x32_bf16 v[48:51], v[204:207], v[124:127], v[48:51]
    s_waitcnt lgkmcnt(8)
    v_mfma_f32_16x16x32_bf16 v[52:55], v[228:231], v[124:127], v[52:55]
    ds_read_b64_tr_b16 v[200:201], v7 offset:0
    v_mfma_f32_16x16x32_bf16 v[52:55], v[224:227], v[120:123], v[52:55]
    ds_read_b64_tr_b16 v[202:203], v7 offset:512
    v_mfma_f32_16x16x32_bf16 v[60:63], v[224:227], v[128:131], v[60:63]
    ds_read_b64_tr_b16 v[204:205], v7 offset:12288
    v_mfma_f32_16x16x32_bf16 v[60:63], v[228:231], v[132:135], v[60:63]
    ds_read_b64_tr_b16 v[206:207], v7 offset:12800
    v_mfma_f32_16x16x32_bf16 v[68:71], v[228:231], v[140:143], v[68:71]
    ds_read_b128 v[176:179], v4 offset:22528
    v_mfma_f32_16x16x32_bf16 v[68:71], v[224:227], v[136:139], v[68:71]
    ds_read_b128 v[180:183], v5 offset:22528
    v_mfma_f32_16x16x32_bf16 v[76:79], v[224:227], v[144:147], v[76:79]
    ds_read_b128 v[168:171], v4 offset:20480
    v_mfma_f32_16x16x32_bf16 v[76:79], v[228:231], v[148:151], v[76:79]
    s_waitcnt lgkmcnt(11)
    v_mfma_f32_16x16x32_bf16 v[40:43], v[236:239], v[148:151], v[40:43]
    ds_read_b64_tr_b16 v[224:225], v6 offset:2048
    v_mfma_f32_16x16x32_bf16 v[40:43], v[232:235], v[144:147], v[40:43]
    ds_read_b64_tr_b16 v[226:227], v6 offset:2560
    v_mfma_f32_16x16x32_bf16 v[32:35], v[232:235], v[136:139], v[32:35]
    ds_read_b64_tr_b16 v[228:229], v6 offset:14336
    v_mfma_f32_16x16x32_bf16 v[32:35], v[236:239], v[140:143], v[32:35]
    ds_read_b64_tr_b16 v[230:231], v6 offset:14848
    v_mfma_f32_16x16x32_bf16 v[24:27], v[236:239], v[132:135], v[24:27]
    ds_read_b128 v[172:175], v5 offset:20480
    v_mfma_f32_16x16x32_bf16 v[24:27], v[232:235], v[128:131], v[24:27]
    ds_read_b128 v[160:163], v4 offset:18432
    v_mfma_f32_16x16x32_bf16 v[16:19], v[232:235], v[120:123], v[16:19]
    ds_read_b128 v[164:167], v5 offset:18432
    v_mfma_f32_16x16x32_bf16 v[16:19], v[236:239], v[124:127], v[16:19]
    s_waitcnt lgkmcnt(10)
    v_mfma_f32_16x16x32_bf16 v[20:23], v[204:207], v[124:127], v[20:23]
    ds_read_b64_tr_b16 v[232:233], v7 offset:2048
    v_mfma_f32_16x16x32_bf16 v[20:23], v[200:203], v[120:123], v[20:23]
    ds_read_b64_tr_b16 v[234:235], v7 offset:2560
    v_mfma_f32_16x16x32_bf16 v[28:31], v[200:203], v[128:131], v[28:31]
    ds_read_b64_tr_b16 v[236:237], v7 offset:14336
    v_mfma_f32_16x16x32_bf16 v[28:31], v[204:207], v[132:135], v[28:31]
    ds_read_b64_tr_b16 v[238:239], v7 offset:14848
    v_mfma_f32_16x16x32_bf16 v[36:39], v[204:207], v[140:143], v[36:39]
    v_mfma_f32_16x16x32_bf16 v[36:39], v[200:203], v[136:139], v[36:39]
    v_mfma_f32_16x16x32_bf16 v[44:47], v[200:203], v[144:147], v[44:47]
    v_mfma_f32_16x16x32_bf16 v[44:47], v[204:207], v[148:151], v[44:47]
    s_waitcnt lgkmcnt(7)
    v_mfma_f32_16x16x32_bf16 v[116:119], v[156:159], v[228:231], v[116:119]
    v_mfma_f32_16x16x32_bf16 v[116:119], v[152:155], v[224:227], v[116:119]
    v_mfma_f32_16x16x32_bf16 v[104:107], v[144:147], v[224:227], v[104:107]
    v_mfma_f32_16x16x32_bf16 v[104:107], v[148:151], v[228:231], v[104:107]
    v_mfma_f32_16x16x32_bf16 v[96:99], v[140:143], v[228:231], v[96:99]
    s_waitcnt lgkmcnt(0)
    s_barrier
    v_mfma_f32_16x16x32_bf16 v[96:99], v[136:139], v[224:227], v[96:99]
    ds_read_b64_tr_b16 v[200:201], v6 offset:25600
    v_mfma_f32_16x16x32_bf16 v[88:91], v[128:131], v[224:227], v[88:91]
    ds_read_b64_tr_b16 v[202:203], v6 offset:26112
    v_mfma_f32_16x16x32_bf16 v[88:91], v[132:135], v[228:231], v[88:91]
    ds_read_b64_tr_b16 v[204:205], v6 offset:37888
    v_mfma_f32_16x16x32_bf16 v[80:83], v[124:127], v[228:231], v[80:83]
    ds_read_b64_tr_b16 v[206:207], v6 offset:38400
    v_mfma_f32_16x16x32_bf16 v[80:83], v[120:123], v[224:227], v[80:83]
    v_mfma_f32_16x16x32_bf16 v[84:87], v[120:123], v[232:235], v[84:87]
    ds_read_b64_tr_b16 v[224:225], v7 offset:25600
    v_mfma_f32_16x16x32_bf16 v[84:87], v[124:127], v[236:239], v[84:87]
    ds_read_b64_tr_b16 v[226:227], v7 offset:26112
    v_mfma_f32_16x16x32_bf16 v[92:95], v[132:135], v[236:239], v[92:95]
    ds_read_b64_tr_b16 v[228:229], v7 offset:37888
    v_mfma_f32_16x16x32_bf16 v[92:95], v[128:131], v[232:235], v[92:95]
    ds_read_b64_tr_b16 v[230:231], v7 offset:38400
    v_mfma_f32_16x16x32_bf16 v[100:103], v[136:139], v[232:235], v[100:103]
    v_mfma_f32_16x16x32_bf16 v[100:103], v[140:143], v[236:239], v[100:103]
    v_mfma_f32_16x16x32_bf16 v[108:111], v[148:151], v[236:239], v[108:111]
    v_mfma_f32_16x16x32_bf16 v[108:111], v[144:147], v[232:235], v[108:111]
    s_waitcnt lgkmcnt(4)
    v_mfma_f32_16x16x32_bf16 v[112:115], v[200:203], v[192:195], v[112:115]
    ds_read_b64_tr_b16 v[232:233], v6 offset:24576
    v_mfma_f32_16x16x32_bf16 v[112:115], v[204:207], v[196:199], v[112:115]
    ds_read_b64_tr_b16 v[234:235], v6 offset:25088
    v_mfma_f32_16x16x32_bf16 v[72:75], v[204:207], v[188:191], v[72:75]
    ds_read_b64_tr_b16 v[236:237], v6 offset:36864
    v_mfma_f32_16x16x32_bf16 v[72:75], v[200:203], v[184:187], v[72:75]
    ds_read_b64_tr_b16 v[238:239], v6 offset:37376
    v_mfma_f32_16x16x32_bf16 v[64:67], v[200:203], v[176:179], v[64:67]
    ds_read_b128 v[152:155], v2 offset:36864
    v_mfma_f32_16x16x32_bf16 v[64:67], v[204:207], v[180:183], v[64:67]
    ds_read_b128 v[156:159], v3 offset:36864
    v_mfma_f32_16x16x32_bf16 v[56:59], v[204:207], v[172:175], v[56:59]
    ds_read_b128 v[144:147], v4 offset:43008
    v_mfma_f32_16x16x32_bf16 v[56:59], v[200:203], v[168:171], v[56:59]
    ds_read_b128 v[148:151], v5 offset:43008
    v_mfma_f32_16x16x32_bf16 v[48:51], v[200:203], v[160:163], v[48:51]
    v_mfma_f32_16x16x32_bf16 v[48:51], v[204:207], v[164:167], v[48:51]
    s_waitcnt lgkmcnt(8)
    v_mfma_f32_16x16x32_bf16 v[52:55], v[228:231], v[164:167], v[52:55]
    ds_read_b64_tr_b16 v[200:201], v7 offset:24576
    v_mfma_f32_16x16x32_bf16 v[52:55], v[224:227], v[160:163], v[52:55]
    ds_read_b64_tr_b16 v[202:203], v7 offset:25088
    v_mfma_f32_16x16x32_bf16 v[60:63], v[224:227], v[168:171], v[60:63]
    ds_read_b64_tr_b16 v[204:205], v7 offset:36864
    v_mfma_f32_16x16x32_bf16 v[60:63], v[228:231], v[172:175], v[60:63]
    ds_read_b64_tr_b16 v[206:207], v7 offset:37376
    v_mfma_f32_16x16x32_bf16 v[68:71], v[228:231], v[180:183], v[68:71]
    ds_read_b128 v[136:139], v4 offset:40960
    v_mfma_f32_16x16x32_bf16 v[68:71], v[224:227], v[176:179], v[68:71]
    ds_read_b128 v[140:143], v5 offset:40960
    v_mfma_f32_16x16x32_bf16 v[76:79], v[224:227], v[184:187], v[76:79]
    ds_read_b128 v[128:131], v4 offset:38912
    v_mfma_f32_16x16x32_bf16 v[76:79], v[228:231], v[188:191], v[76:79]
    s_waitcnt lgkmcnt(11)
    v_mfma_f32_16x16x32_bf16 v[40:43], v[236:239], v[188:191], v[40:43]
    ds_read_b64_tr_b16 v[224:225], v6 offset:26624
    v_mfma_f32_16x16x32_bf16 v[40:43], v[232:235], v[184:187], v[40:43]
    ds_read_b64_tr_b16 v[226:227], v6 offset:27136
    v_mfma_f32_16x16x32_bf16 v[32:35], v[232:235], v[176:179], v[32:35]
    ds_read_b64_tr_b16 v[228:229], v6 offset:38912
    v_mfma_f32_16x16x32_bf16 v[32:35], v[236:239], v[180:183], v[32:35]
    ds_read_b64_tr_b16 v[230:231], v6 offset:39424
    v_mfma_f32_16x16x32_bf16 v[24:27], v[236:239], v[172:175], v[24:27]
    ds_read_b128 v[132:135], v5 offset:38912
    v_mfma_f32_16x16x32_bf16 v[24:27], v[232:235], v[168:171], v[24:27]
    ds_read_b128 v[120:123], v4 offset:36864
    v_mfma_f32_16x16x32_bf16 v[16:19], v[232:235], v[160:163], v[16:19]
    ds_read_b128 v[124:127], v5 offset:36864
    v_mfma_f32_16x16x32_bf16 v[16:19], v[236:239], v[164:167], v[16:19]
    s_waitcnt lgkmcnt(10)
    v_mfma_f32_16x16x32_bf16 v[20:23], v[204:207], v[164:167], v[20:23]
    ds_read_b64_tr_b16 v[232:233], v7 offset:26624
    v_mfma_f32_16x16x32_bf16 v[20:23], v[200:203], v[160:163], v[20:23]
    ds_read_b64_tr_b16 v[234:235], v7 offset:27136
    v_mfma_f32_16x16x32_bf16 v[28:31], v[200:203], v[168:171], v[28:31]
    ds_read_b64_tr_b16 v[236:237], v7 offset:38912
    v_mfma_f32_16x16x32_bf16 v[28:31], v[204:207], v[172:175], v[28:31]
    ds_read_b64_tr_b16 v[238:239], v7 offset:39424
    v_mfma_f32_16x16x32_bf16 v[36:39], v[204:207], v[180:183], v[36:39]
    v_mfma_f32_16x16x32_bf16 v[36:39], v[200:203], v[176:179], v[36:39]
    v_mfma_f32_16x16x32_bf16 v[44:47], v[200:203], v[184:187], v[44:47]
    v_mfma_f32_16x16x32_bf16 v[44:47], v[204:207], v[188:191], v[44:47]
    s_waitcnt lgkmcnt(7)
    v_mfma_f32_16x16x32_bf16 v[116:119], v[196:199], v[228:231], v[116:119]
    v_mfma_f32_16x16x32_bf16 v[116:119], v[192:195], v[224:227], v[116:119]
    v_mfma_f32_16x16x32_bf16 v[104:107], v[184:187], v[224:227], v[104:107]
    v_mfma_f32_16x16x32_bf16 v[104:107], v[188:191], v[228:231], v[104:107]
    v_mfma_f32_16x16x32_bf16 v[96:99], v[180:183], v[228:231], v[96:99]
    s_waitcnt lgkmcnt(0)
    s_barrier
    v_mfma_f32_16x16x32_bf16 v[96:99], v[176:179], v[224:227], v[96:99]
    ds_read_b64_tr_b16 v[200:201], v6 offset:50176
    v_mfma_f32_16x16x32_bf16 v[88:91], v[168:171], v[224:227], v[88:91]
    ds_read_b64_tr_b16 v[202:203], v6 offset:50688
    v_mfma_f32_16x16x32_bf16 v[88:91], v[172:175], v[228:231], v[88:91]
    ds_read_b64_tr_b16 v[204:205], v6 offset:62464
    v_mfma_f32_16x16x32_bf16 v[80:83], v[164:167], v[228:231], v[80:83]
    ds_read_b64_tr_b16 v[206:207], v6 offset:62976
    v_mfma_f32_16x16x32_bf16 v[80:83], v[160:163], v[224:227], v[80:83]
    v_mfma_f32_16x16x32_bf16 v[84:87], v[160:163], v[232:235], v[84:87]
    ds_read_b64_tr_b16 v[224:225], v7 offset:50176
    v_mfma_f32_16x16x32_bf16 v[84:87], v[164:167], v[236:239], v[84:87]
    ds_read_b64_tr_b16 v[226:227], v7 offset:50688
    v_mfma_f32_16x16x32_bf16 v[92:95], v[172:175], v[236:239], v[92:95]
    ds_read_b64_tr_b16 v[228:229], v7 offset:62464
    v_mfma_f32_16x16x32_bf16 v[92:95], v[168:171], v[232:235], v[92:95]
    ds_read_b64_tr_b16 v[230:231], v7 offset:62976
    v_mfma_f32_16x16x32_bf16 v[100:103], v[176:179], v[232:235], v[100:103]
    v_mfma_f32_16x16x32_bf16 v[100:103], v[180:183], v[236:239], v[100:103]
    v_mfma_f32_16x16x32_bf16 v[108:111], v[188:191], v[236:239], v[108:111]
    v_mfma_f32_16x16x32_bf16 v[108:111], v[184:187], v[232:235], v[108:111]
    s_waitcnt lgkmcnt(4)
    v_mfma_f32_16x16x32_bf16 v[112:115], v[200:203], v[152:155], v[112:115]
    ds_read_b64_tr_b16 v[232:233], v6 offset:49152
    v_mfma_f32_16x16x32_bf16 v[112:115], v[204:207], v[156:159], v[112:115]
    ds_read_b64_tr_b16 v[234:235], v6 offset:49664
    v_mfma_f32_16x16x32_bf16 v[72:75], v[204:207], v[148:151], v[72:75]
    ds_read_b64_tr_b16 v[236:237], v6 offset:61440
    v_mfma_f32_16x16x32_bf16 v[72:75], v[200:203], v[144:147], v[72:75]
    ds_read_b64_tr_b16 v[238:239], v6 offset:61952
    v_mfma_f32_16x16x32_bf16 v[64:67], v[200:203], v[136:139], v[64:67]
    v_mfma_f32_16x16x32_bf16 v[64:67], v[204:207], v[140:143], v[64:67]
    v_mfma_f32_16x16x32_bf16 v[56:59], v[204:207], v[132:135], v[56:59]
    v_mfma_f32_16x16x32_bf16 v[56:59], v[200:203], v[128:131], v[56:59]
    v_mfma_f32_16x16x32_bf16 v[48:51], v[200:203], v[120:123], v[48:51]
    v_mfma_f32_16x16x32_bf16 v[48:51], v[204:207], v[124:127], v[48:51]
    s_waitcnt lgkmcnt(4)
    v_mfma_f32_16x16x32_bf16 v[52:55], v[228:231], v[124:127], v[52:55]
    ds_read_b64_tr_b16 v[200:201], v7 offset:49152
    v_mfma_f32_16x16x32_bf16 v[52:55], v[224:227], v[120:123], v[52:55]
    ds_read_b64_tr_b16 v[202:203], v7 offset:49664
    v_mfma_f32_16x16x32_bf16 v[60:63], v[224:227], v[128:131], v[60:63]
    ds_read_b64_tr_b16 v[204:205], v7 offset:61440
    v_mfma_f32_16x16x32_bf16 v[60:63], v[228:231], v[132:135], v[60:63]
    ds_read_b64_tr_b16 v[206:207], v7 offset:61952
    v_mfma_f32_16x16x32_bf16 v[68:71], v[228:231], v[140:143], v[68:71]
    v_mfma_f32_16x16x32_bf16 v[68:71], v[224:227], v[136:139], v[68:71]
    v_mfma_f32_16x16x32_bf16 v[76:79], v[224:227], v[144:147], v[76:79]
    v_mfma_f32_16x16x32_bf16 v[76:79], v[228:231], v[148:151], v[76:79]
    s_waitcnt lgkmcnt(4)
    v_mfma_f32_16x16x32_bf16 v[40:43], v[236:239], v[148:151], v[40:43]
    ds_read_b64_tr_b16 v[224:225], v6 offset:51200
    ds_read_b64_tr_b16 v[226:227], v6 offset:51712
    v_mfma_f32_16x16x32_bf16 v[40:43], v[232:235], v[144:147], v[40:43]
    ds_read_b64_tr_b16 v[228:229], v6 offset:63488
    ds_read_b64_tr_b16 v[230:231], v6 offset:64000
    v_mfma_f32_16x16x32_bf16 v[32:35], v[232:235], v[136:139], v[32:35]
    ds_read_b128 v[192:195], v2 offset:0
    ds_read_b128 v[196:199], v3 offset:0
    v_mfma_f32_16x16x32_bf16 v[32:35], v[236:239], v[140:143], v[32:35]
    ds_read_b128 v[184:187], v4 offset:6144
    ds_read_b128 v[188:191], v5 offset:6144
    v_mfma_f32_16x16x32_bf16 v[24:27], v[236:239], v[132:135], v[24:27]
    v_mfma_f32_16x16x32_bf16 v[24:27], v[232:235], v[128:131], v[24:27]
    v_mfma_f32_16x16x32_bf16 v[16:19], v[232:235], v[120:123], v[16:19]
    v_mfma_f32_16x16x32_bf16 v[16:19], v[236:239], v[124:127], v[16:19]
    s_waitcnt lgkmcnt(8)
    v_mfma_f32_16x16x32_bf16 v[20:23], v[204:207], v[124:127], v[20:23]
    ds_read_b64_tr_b16 v[232:233], v7 offset:51200
    v_mfma_f32_16x16x32_bf16 v[20:23], v[200:203], v[120:123], v[20:23]
    ds_read_b64_tr_b16 v[234:235], v7 offset:51712
    v_mfma_f32_16x16x32_bf16 v[28:31], v[200:203], v[128:131], v[28:31]
    ds_read_b64_tr_b16 v[236:237], v7 offset:63488
    v_mfma_f32_16x16x32_bf16 v[28:31], v[204:207], v[132:135], v[28:31]
    ds_read_b64_tr_b16 v[238:239], v7 offset:64000
    v_mfma_f32_16x16x32_bf16 v[36:39], v[204:207], v[140:143], v[36:39]
    ds_read_b128 v[176:179], v4 offset:4096
    v_mfma_f32_16x16x32_bf16 v[36:39], v[200:203], v[136:139], v[36:39]
    ds_read_b128 v[180:183], v5 offset:4096
    v_mfma_f32_16x16x32_bf16 v[44:47], v[200:203], v[144:147], v[44:47]
    ds_read_b128 v[168:171], v4 offset:2048
    v_mfma_f32_16x16x32_bf16 v[44:47], v[204:207], v[148:151], v[44:47]
    s_waitcnt lgkmcnt(11)
    v_mfma_f32_16x16x32_bf16 v[116:119], v[156:159], v[228:231], v[116:119]
    ds_read_b64_tr_b16 v[200:201], v6 offset:1024
    v_mfma_f32_16x16x32_bf16 v[116:119], v[152:155], v[224:227], v[116:119]
    ds_read_b64_tr_b16 v[202:203], v6 offset:1536
    v_mfma_f32_16x16x32_bf16 v[104:107], v[144:147], v[224:227], v[104:107]
    ds_read_b64_tr_b16 v[204:205], v6 offset:13312
    v_mfma_f32_16x16x32_bf16 v[104:107], v[148:151], v[228:231], v[104:107]
    ds_read_b64_tr_b16 v[206:207], v6 offset:13824
    v_mfma_f32_16x16x32_bf16 v[96:99], v[140:143], v[228:231], v[96:99]
    ds_read_b128 v[172:175], v5 offset:2048
    v_mfma_f32_16x16x32_bf16 v[96:99], v[136:139], v[224:227], v[96:99]
    ds_read_b128 v[160:163], v4 offset:0
    v_mfma_f32_16x16x32_bf16 v[88:91], v[128:131], v[224:227], v[88:91]
    ds_read_b128 v[164:167], v5 offset:0
    v_mfma_f32_16x16x32_bf16 v[88:91], v[132:135], v[228:231], v[88:91]
    v_mfma_f32_16x16x32_bf16 v[80:83], v[124:127], v[228:231], v[80:83]
    v_mfma_f32_16x16x32_bf16 v[80:83], v[120:123], v[224:227], v[80:83]
    s_waitcnt lgkmcnt(10)
    v_mfma_f32_16x16x32_bf16 v[84:87], v[120:123], v[232:235], v[84:87]
    ds_read_b64_tr_b16 v[224:225], v7 offset:1024
    v_mfma_f32_16x16x32_bf16 v[84:87], v[124:127], v[236:239], v[84:87]
    ds_read_b64_tr_b16 v[226:227], v7 offset:1536
    v_mfma_f32_16x16x32_bf16 v[92:95], v[132:135], v[236:239], v[92:95]
    ds_read_b64_tr_b16 v[228:229], v7 offset:13312
    v_mfma_f32_16x16x32_bf16 v[92:95], v[128:131], v[232:235], v[92:95]
    ds_read_b64_tr_b16 v[230:231], v7 offset:13824
    v_mfma_f32_16x16x32_bf16 v[100:103], v[136:139], v[232:235], v[100:103]
    v_mfma_f32_16x16x32_bf16 v[100:103], v[140:143], v[236:239], v[100:103]
    v_mfma_f32_16x16x32_bf16 v[108:111], v[148:151], v[236:239], v[108:111]
    v_mfma_f32_16x16x32_bf16 v[108:111], v[144:147], v[232:235], v[108:111]
    s_waitcnt lgkmcnt(9)
    v_mfma_f32_16x16x32_bf16 v[112:115], v[200:203], v[192:195], v[112:115]
    ds_read_b64_tr_b16 v[120:121], v6 offset:0
    ds_read_b64_tr_b16 v[122:123], v6 offset:512
    s_waitcnt lgkmcnt(9)
    v_mfma_f32_16x16x32_bf16 v[112:115], v[204:207], v[196:199], v[112:115]
    ds_read_b64_tr_b16 v[124:125], v6 offset:12288
    ds_read_b64_tr_b16 v[126:127], v6 offset:12800
    v_mfma_f32_16x16x32_bf16 v[72:75], v[204:207], v[188:191], v[72:75]
    ds_read_b64_tr_b16 v[128:129], v7 offset:0
    ds_read_b64_tr_b16 v[130:131], v7 offset:512
    v_mfma_f32_16x16x32_bf16 v[72:75], v[200:203], v[184:187], v[72:75]
    ds_read_b64_tr_b16 v[132:133], v7 offset:12288
    ds_read_b64_tr_b16 v[134:135], v7 offset:12800
    v_mfma_f32_16x16x32_bf16 v[64:67], v[200:203], v[176:179], v[64:67]
    ds_read_b64_tr_b16 v[136:137], v6 offset:2048
    ds_read_b64_tr_b16 v[138:139], v6 offset:2560
    v_mfma_f32_16x16x32_bf16 v[64:67], v[204:207], v[180:183], v[64:67]
    ds_read_b64_tr_b16 v[140:141], v6 offset:14336
    ds_read_b64_tr_b16 v[142:143], v6 offset:14848
    s_waitcnt lgkmcnt(14)
    v_mfma_f32_16x16x32_bf16 v[56:59], v[204:207], v[172:175], v[56:59]
    ds_read_b64_tr_b16 v[144:145], v7 offset:2048
    ds_read_b64_tr_b16 v[146:147], v7 offset:2560
    v_mfma_f32_16x16x32_bf16 v[56:59], v[200:203], v[168:171], v[56:59]
    ds_read_b64_tr_b16 v[148:149], v7 offset:14336
    ds_read_b64_tr_b16 v[150:151], v7 offset:14848
    v_mfma_f32_16x16x32_bf16 v[48:51], v[200:203], v[160:163], v[48:51]
    v_cvt_pk_bf16_f32 v72, v72, v73
    v_cvt_pk_bf16_f32 v73, v74, v75
    v_mfma_f32_16x16x32_bf16 v[48:51], v[204:207], v[164:167], v[48:51]
    v_cvt_pk_bf16_f32 v64, v64, v65
    v_cvt_pk_bf16_f32 v65, v66, v67
    s_waitcnt lgkmcnt(14)
    v_mfma_f32_16x16x32_bf16 v[76:79], v[228:231], v[188:191], v[76:79]
    v_cvt_pk_bf16_f32 v56, v56, v57
    v_cvt_pk_bf16_f32 v57, v58, v59
    v_mfma_f32_16x16x32_bf16 v[76:79], v[224:227], v[184:187], v[76:79]
    v_cvt_pk_bf16_f32 v200, v112, v113
    v_cvt_pk_bf16_f32 v201, v114, v115
    v_mfma_f32_16x16x32_bf16 v[68:71], v[224:227], v[176:179], v[68:71]
    ds_write_b64 v216, v[200:201]
    ds_write_b64 v217, v[72:73]
    v_mfma_f32_16x16x32_bf16 v[68:71], v[228:231], v[180:183], v[68:71]
    v_cvt_pk_bf16_f32 v48, v48, v49
    v_cvt_pk_bf16_f32 v49, v50, v51
    v_mfma_f32_16x16x32_bf16 v[60:63], v[228:231], v[172:175], v[60:63]
    v_cvt_pk_bf16_f32 v74, v76, v77
    v_cvt_pk_bf16_f32 v75, v78, v79
    v_mfma_f32_16x16x32_bf16 v[60:63], v[224:227], v[168:171], v[60:63]
    ds_write_b64 v217, v[74:75] offset:512
    s_mov_b64 exec, 1
    ds_add_u32 v10, v11 offset:0
    s_mov_b64 exec, -1
    v_mfma_f32_16x16x32_bf16 v[52:55], v[224:227], v[160:163], v[52:55]
    v_cvt_pk_bf16_f32 v66, v68, v69
    v_cvt_pk_bf16_f32 v67, v70, v71
    v_mfma_f32_16x16x32_bf16 v[52:55], v[228:231], v[164:167], v[52:55]
    v_cvt_pk_bf16_f32 v58, v60, v61
    v_cvt_pk_bf16_f32 v59, v62, v63
    s_waitcnt lgkmcnt(14)
    v_mfma_f32_16x16x32_bf16 v[40:43], v[124:127], v[188:191], v[40:43]
    s_nop 1
    v_mfma_f32_16x16x32_bf16 v[40:43], v[120:123], v[184:187], v[40:43]
    s_nop 1
    v_mfma_f32_16x16x32_bf16 v[32:35], v[120:123], v[176:179], v[32:35]
    v_cvt_pk_bf16_f32 v50, v52, v53
    v_cvt_pk_bf16_f32 v51, v54, v55
    v_mfma_f32_16x16x32_bf16 v[32:35], v[124:127], v[180:183], v[32:35]
    s_nop 1
    v_mfma_f32_16x16x32_bf16 v[24:27], v[124:127], v[172:175], v[24:27]
    v_cvt_pk_bf16_f32 v40, v40, v41
    v_cvt_pk_bf16_f32 v41, v42, v43
    v_mfma_f32_16x16x32_bf16 v[24:27], v[120:123], v[168:171], v[24:27]
    s_nop 1
    v_mfma_f32_16x16x32_bf16 v[16:19], v[120:123], v[160:163], v[16:19]
    v_cvt_pk_bf16_f32 v32, v32, v33
    v_cvt_pk_bf16_f32 v33, v34, v35
    v_mfma_f32_16x16x32_bf16 v[16:19], v[124:127], v[164:167], v[16:19]
    s_nop 1
    s_waitcnt lgkmcnt(12)
    v_mfma_f32_16x16x32_bf16 v[44:47], v[132:135], v[188:191], v[44:47]
    v_cvt_pk_bf16_f32 v24, v24, v25
    v_cvt_pk_bf16_f32 v25, v26, v27
    v_mfma_f32_16x16x32_bf16 v[44:47], v[128:131], v[184:187], v[44:47]
    s_nop 1
    v_mfma_f32_16x16x32_bf16 v[36:39], v[128:131], v[176:179], v[36:39]
    v_cvt_pk_bf16_f32 v16, v16, v17
    v_cvt_pk_bf16_f32 v17, v18, v19
    v_mfma_f32_16x16x32_bf16 v[36:39], v[132:135], v[180:183], v[36:39]
    s_nop 1
    v_mfma_f32_16x16x32_bf16 v[28:31], v[132:135], v[172:175], v[28:31]
    v_cvt_pk_bf16_f32 v42, v44, v45
    v_cvt_pk_bf16_f32 v43, v46, v47
    v_mfma_f32_16x16x32_bf16 v[28:31], v[128:131], v[168:171], v[28:31]
    ds_read_b32 v223, v10 offset:0
    ds_read_b64 v[204:205], v218
    v_mfma_f32_16x16x32_bf16 v[20:23], v[128:131], v[160:163], v[20:23]
    ds_read_b64 v[206:207], v219
    v_cvt_pk_bf16_f32 v34, v36, v37
    v_mfma_f32_16x16x32_bf16 v[20:23], v[132:135], v[164:167], v[20:23]
    v_cvt_pk_bf16_f32 v35, v38, v39
    s_nop 0
    s_waitcnt lgkmcnt(11)
    v_mfma_f32_16x16x32_bf16 v[116:119], v[196:199], v[140:143], v[116:119]
    v_cvt_pk_bf16_f32 v26, v28, v29
    v_cvt_pk_bf16_f32 v27, v30, v31
    v_mfma_f32_16x16x32_bf16 v[116:119], v[192:195], v[136:139], v[116:119]
    s_nop 1
    v_mfma_f32_16x16x32_bf16 v[104:107], v[184:187], v[136:139], v[104:107]
    v_cvt_pk_bf16_f32 v18, v20, v21
    v_cvt_pk_bf16_f32 v19, v22, v23
    v_mfma_f32_16x16x32_bf16 v[104:107], v[188:191], v[140:143], v[104:107]
    s_nop 1
    v_mfma_f32_16x16x32_bf16 v[44:47], v[72:75], v[40:43], 0
    v_cvt_pk_bf16_f32 v202, v116, v117
    v_cvt_pk_bf16_f32 v203, v118, v119
    v_mfma_f32_16x16x32_bf16 v[76:79], v[64:67], v[40:43], 0
    s_nop 1
    v_mfma_f32_16x16x32_bf16 v[36:39], v[64:67], v[32:35], 0
    v_cvt_pk_bf16_f32 v232, v104, v105
    v_cvt_pk_bf16_f32 v233, v106, v107
    v_mfma_f32_16x16x32_bf16 v[68:71], v[56:59], v[32:35], 0
    ds_write_b64 v216, v[202:203] offset:1024
    ds_write_b64 v217, v[232:233] offset:1024
    v_mfma_f32_16x16x32_bf16 v[96:99], v[180:183], v[140:143], v[96:99]
    s_waitcnt lgkmcnt(4)
    v_cmp_gt_u32 vcc, 4, v223
    s_cbranch_vccnz LB_w1
LB_g1:
    v_mfma_f32_16x16x32_bf16 v[96:99], v[176:179], v[136:139], v[96:99]
    v_cndmask_b32 v124, v44, v45, s[88:89]
    v_cndmask_b32 v125, v76, v77, s[88:89]
    v_mfma_f32_16x16x32_bf16 v[28:31], v[56:59], v[24:27], 0
    v_cndmask_b32 v158, v125, v124, s[90:91]
    v_cndmask_b32 v126, v46, v47, s[88:89]
    v_mfma_f32_16x16x32_bf16 v[60:63], v[48:51], v[24:27], 0
    v_cndmask_b32 v127, v78, v79, s[88:89]
    v_cndmask_b32 v159, v127, v126, s[92:93]
    v_mfma_f32_16x16x32_bf16 v[20:23], v[48:51], v[16:19], 0
    v_max_f32 v123, v158, v159
    v_cndmask_b32 v124, v36, v37, s[88:89]
    v_mfma_f32_16x16x32_bf16 v[88:91], v[168:171], v[136:139], v[88:91]
    v_cndmask_b32 v125, v68, v69, s[88:89]
    v_cndmask_b32 v156, v125, v124, s[90:91]
    v_mfma_f32_16x16x32_bf16 v[88:91], v[172:175], v[140:143], v[88:91]
    v_cndmask_b32 v126, v38, v39, s[88:89]
    v_cndmask_b32 v127, v70, v71, s[88:89]
    s_waitcnt lgkmcnt(2)
    v_mfma_f32_16x16x32_bf16 v[52:55], v[204:207], v[16:19], v[212:215]
    v_cndmask_b32 v157, v127, v126, s[92:93]
    v_max_f32 v122, v156, v157
    v_mfma_f32_16x16x32_bf16 v[80:83], v[164:167], v[140:143], v[80:83]
    v_cndmask_b32 v124, v28, v29, s[88:89]
    v_cndmask_b32 v125, v60, v61, s[88:89]
    v_mfma_f32_16x16x32_bf16 v[80:83], v[160:163], v[136:139], v[80:83]
    v_cndmask_b32 v154, v125, v124, s[90:91]
    v_cndmask_b32 v126, v30, v31, s[88:89]
    v_mfma_f32_16x16x32_bf16 v[108:111], v[184:187], v[144:147], v[108:111]
    v_cndmask_b32 v127, v62, v63, s[88:89]
    v_cndmask_b32 v155, v127, v126, s[92:93]
    v_mfma_f32_16x16x32_bf16 v[108:111], v[188:191], v[148:151], v[108:111]
    v_max_f32 v121, v154, v155
    s_nop 0
    v_mfma_f32_16x16x32_bf16 v[100:103], v[180:183], v[148:151], v[100:103]
    s_nop 1
    v_mfma_f32_16x16x32_bf16 v[100:103], v[176:179], v[144:147], v[100:103]
    s_nop 1
    v_mfma_f32_16x16x32_bf16 v[92:95], v[168:171], v[144:147], v[92:95]
    v_cvt_pk_bf16_f32 v242, v108, v109
    v_cvt_pk_bf16_f32 v243, v110, v111
    v_mfma_f32_16x16x32_bf16 v[92:95], v[172:175], v[148:151], v[92:95]
    ds_write_b64 v217, v[242:243] offset:1536
    s_mov_b64 exec, 1
    ds_add_u32 v10, v11 offset:24
    s_mov_b64 exec, -1
    v_mfma_f32_16x16x32_bf16 v[84:87], v[164:167], v[148:151], v[84:87]
    v_cndmask_b32 v124, v20, v21, s[88:89]
    v_cndmask_b32 v125, v52, v53, s[88:89]
    v_mfma_f32_16x16x32_bf16 v[84:87], v[160:163], v[144:147], v[84:87]
    v_cndmask_b32 v152, v125, v124, s[90:91]
    v_cndmask_b32 v126, v22, v23, s[88:89]
    v_cndmask_b32 v127, v54, v55, s[88:89]
    v_cndmask_b32 v153, v127, v126, s[92:93]
    v_max_f32 v120, v152, v153
    s_mov_b32 s80, 0x3e8293ee
    s_add_u32 m0, s34, 36864
    s_add_u32 s35, s44, 0
    buffer_load_dwordx4 v245, s[64:67], s35 offen  lds
    v_cvt_pk_bf16_f32 v230, v96, v97
    v_permlane32_swap_b32 v122, v123
    v_permlane32_swap_b32 v120, v121
    v_max_f32 v122, v122, v123
    v_max_f32 v120, v120, v121
    v_cvt_pk_bf16_f32 v231, v98, v99
    v_cvt_pk_bf16_f32 v240, v100, v101
    v_permlane16_swap_b32 v120, v122
    v_max_f32 v120, v120, v122
    v_mul_f32 v120, s80, v120
    v_mov_b32 v122, v120
    v_cvt_pk_bf16_f32 v241, v102, v103
    v_cvt_pk_bf16_f32 v228, v88, v89
    v_permlane16_swap_b32 v120, v122
    v_mov_b32 v121, v120
    v_mov_b32 v123, v122
    s_add_u32 m0, s34, 40960
    s_add_u32 s35, s44, 65536
    buffer_load_dwordx4 v245, s[64:67], s35 offen  lds
    v_cvt_pk_bf16_f32 v229, v90, v91
    v_permlane32_swap_b32 v120, v121
    v_permlane32_swap_b32 v122, v123
    v_fma_f32 v152, v152, s80, -v120
    v_fma_f32 v153, v153, s80, -v120
    v_fma_f32 v154, v154, s80, -v121
    v_fma_f32 v155, v155, s80, -v121
    v_fma_f32 v156, v156, s80, -v122
    v_fma_f32 v157, v157, s80, -v122
    v_fma_f32 v158, v158, s80, -v123
    v_fma_f32 v159, v159, s80, -v123
    ds_read_b32 v223, v10 offset:24
    ds_read_b64 v[224:225], v218 offset:1024
    ds_read_b64 v[234:235], v219 offset:1024
    v_exp_f32 v152, v152
    v_exp_f32 v153, v153
    v_exp_f32 v154, v154
    s_add_u32 m0, s34, 45056
    s_add_u32 s35, s44, 131072
    buffer_load_dwordx4 v245, s[64:67], s35 offen  lds
    v_exp_f32 v155, v155
    v_exp_f32 v156, v156
    v_exp_f32 v157, v157
    v_exp_f32 v158, v158
    v_exp_f32 v159, v159
    v_add_f32 v120, v152, v153
    v_add_f32 v121, v154, v155
    v_add_f32 v122, v156, v157
    v_add_f32 v123, v158, v159
    v_cvt_pk_bf16_f32 v238, v92, v93
    s_nop 0
    v_permlane32_swap_b32 v122, v123
    v_permlane32_swap_b32 v120, v121
    v_add_f32 v122, v122, v123
    v_add_f32 v120, v120, v121
    v_cvt_pk_bf16_f32 v239, v94, v95
    v_cvt_pk_bf16_f32 v226, v80, v81
    s_add_u32 m0, s34, 110592
    s_add_u32 s35, s44, 196608
    buffer_load_dwordx4 v245, s[64:67], s35 offen  lds
    v_permlane16_swap_b32 v120, v122
    v_add_f32 v120, v120, v122
    v_rcp_f32 v120, v120
    s_nop 0
    v_mov_b32 v122, v120
    v_cvt_pk_bf16_f32 v227, v82, v83
    v_cvt_pk_bf16_f32 v236, v84, v85
    v_permlane16_swap_b32 v120, v122
    v_mov_b32 v121, v120
    v_mov_b32 v123, v122
    v_cvt_pk_bf16_f32 v237, v86, v87
    v_permlane32_swap_b32 v120, v121
    v_permlane32_swap_b32 v122, v123
    s_waitcnt lgkmcnt(2)
    v_cmp_gt_u32 vcc, 4, v223
    s_cbranch_vccnz LB_w6
LB_g6:
    v_mul_f32 v152, v152, v120
    v_mul_f32 v153, v153, v120
    v_cvt_pk_bf16_f32 v152, v152, v153
    v_perm_b32 v160, v152, v152, v208
    s_add_u32 m0, s34, 114688
    s_add_u32 s35, s45, 0
    buffer_load_dwordx4 v245, s[64:67], s35 offen  lds
    v_perm_b32 v161, v152, v152, v209
    v_perm_b32 v162, v152, v152, v210
    v_perm_b32 v163, v152, v152, v211
    v_mul_f32 v154, v154, v121
    v_mul_f32 v155, v155, v121
    v_cvt_pk_bf16_f32 v154, v154, v155
    v_perm_b32 v164, v154, v154, v208
    v_perm_b32 v165, v154, v154, v209
    v_perm_b32 v166, v154, v154, v210
    v_perm_b32 v167, v154, v154, v211
    s_waitcnt lgkmcnt(1)
    v_mfma_f32_16x16x32_bf16 v[16:19], v[224:227], v[160:163], 0
    s_waitcnt lgkmcnt(0)
    v_mfma_f32_16x16x32_bf16 v[20:23], v[234:237], v[160:163], 0
    v_mul_f32 v156, v156, v122
    v_mul_f32 v157, v157, v122
    v_cvt_pk_bf16_f32 v156, v156, v157
    v_perm_b32 v168, v156, v156, v208
    s_add_u32 m0, s34, 118784
    s_add_u32 s35, s45, 65536
    buffer_load_dwordx4 v245, s[64:67], s35 offen  lds
    v_perm_b32 v169, v156, v156, v209
    v_perm_b32 v170, v156, v156, v210
    v_perm_b32 v171, v156, v156, v211
    v_mfma_f32_16x16x32_bf16 v[24:27], v[226:229], v[164:167], 0
    v_mfma_f32_16x16x32_bf16 v[28:31], v[236:239], v[164:167], 0
    v_mul_f32 v158, v158, v123
    v_mul_f32 v159, v159, v123
    v_cvt_pk_bf16_f32 v158, v158, v159
    v_perm_b32 v172, v158, v158, v208
    v_perm_b32 v173, v158, v158, v209
    v_perm_b32 v174, v158, v158, v210
    v_perm_b32 v175, v158, v158, v211
    v_mfma_f32_16x16x32_bf16 v[32:35], v[228:231], v[168:171], 0
    v_mfma_f32_16x16x32_bf16 v[36:39], v[238:241], v[168:171], 0
    v_mfma_f32_16x16x32_bf16 v[40:43], v[230:233], v[172:175], 0
    v_mfma_f32_16x16x32_bf16 v[44:47], v[240:243], v[172:175], 0
    v_cvt_pk_bf16_f32 v80, v16, v17
    v_cvt_pk_bf16_f32 v81, v18, v19
    v_cvt_pk_bf16_f32 v82, v20, v21
    v_cvt_pk_bf16_f32 v83, v22, v23
    s_add_u32 s95, s94, 0
    buffer_store_dwordx4 v[80:83], v252, s[52:55], s95 offen sc1
    v_cvt_pk_bf16_f32 v84, v24, v25
    v_cvt_pk_bf16_f32 v85, v26, v27
    v_cvt_pk_bf16_f32 v86, v28, v29
    v_cvt_pk_bf16_f32 v87, v30, v31
    s_add_u32 s95, s94, 32768
    buffer_store_dwordx4 v[84:87], v252, s[52:55], s95 offen sc1
    v_cvt_pk_bf16_f32 v88, v32, v33
    v_cvt_pk_bf16_f32 v89, v34, v35
    v_cvt_pk_bf16_f32 v90, v36, v37
    v_cvt_pk_bf16_f32 v91, v38, v39
    s_add_u32 s95, s94, 65536
    buffer_store_dwordx4 v[88:91], v252, s[52:55], s95 offen sc1
    v_cvt_pk_bf16_f32 v92, v40, v41
    v_cvt_pk_bf16_f32 v93, v42, v43
    v_cvt_pk_bf16_f32 v94, v44, v45
    v_cvt_pk_bf16_f32 v95, v46, v47
    s_add_u32 s95, s94, 98304
    buffer_store_dwordx4 v[92:95], v252, s[52:55], s95 offen sc1
    s_add_u32 m0, s34, 122880
    s_add_u32 s35, s45, 131072
    buffer_load_dwordx4 v245, s[64:67], s35 offen  lds
    v_xor_b32 v2, 0, v244
    v_xor_b32 v3, 32, v244
    v_xor_b32 v4, 64, v244
    v_xor_b32 v5, 96, v244
    s_add_u32 m0, s34, 49152
    s_add_u32 s35, s45, 196608
    buffer_load_dwordx4 v245, s[64:67], s35 offen  lds
    v_xor_b32 v6, 2048, v244
    v_xor_b32 v7, 2080, v244
    v_xor_b32 v8, 2112, v244
    v_xor_b32 v9, 2144, v244
    s_waitcnt vmcnt(6)
    s_mov_b64 exec, 1
    ds_add_u32 v10, v11 offset:8
    s_mov_b64 exec, -1
    s_add_u32 m0, s34, 53248
    s_add_u32 s35, s46, 0
    buffer_load_dwordx4 v245, s[64:67], s35 offen  lds
    v_add_u32 v224, 65536, v2
    v_add_u32 v225, 65536, v3
    v_add_u32 v226, 65536, v4
    v_add_u32 v227, 65536, v5
    v_add_u32 v228, 65536, v6
    v_add_u32 v229, 65536, v7
    s_add_u32 m0, s34, 57344
    s_add_u32 s35, s46, 65536
    buffer_load_dwordx4 v245, s[64:67], s35 offen  lds
    v_add_u32 v230, 65536, v8
    v_add_u32 v231, 65536, v9
    v_add_u32 v15, 32768, v252
    v_add_u32 v232, 129024, v2
    v_add_u32 v233, 129024, v3
    v_add_u32 v234, 129024, v4
    s_add_u32 m0, s34, 61440
    s_add_u32 s35, s46, 131072
    buffer_load_dwordx4 v245, s[64:67], s35 offen  lds
    v_add_u32 v235, 129024, v5
    v_add_u32 v236, 129024, v6
    v_add_u32 v237, 129024, v7
    v_add_u32 v238, 129024, v8
    v_add_u32 v239, 129024, v9
    s_waitcnt vmcnt(5)
    s_mov_b64 exec, 1
    buffer_store_dword v11, v220, s[52:55], s97 offen sc1
    s_mov_b64 exec, -1
    s_branch LB_s2_in
LB_s2:
    s_sleep 1
LB_s2_in:
    ds_read_b32 v14, v10 offset:8
    s_waitcnt lgkmcnt(0)
    v_readfirstlane_b32 s78, v14
    s_nop 0
    s_cmp_ge_u32 s78, 8
    s_cbranch_scc0 LB_s2
    s_add_u32 m0, s34, 65536
    s_add_u32 s35, s46, 196608
    buffer_load_dwordx4 v245, s[64:67], s35 offen  lds
    ds_read_b64_tr_b16 v[48:49], v2 offset:36864
    ds_read_b64_tr_b16 v[50:51], v6 offset:36864
    s_add_u32 m0, s34, 69632
    s_add_u32 s35, s47, 0
    buffer_load_dwordx4 v245, s[64:67], s35 offen  lds
    ds_read_b64_tr_b16 v[52:53], v2 offset:40960
    s_add_u32 m0, s34, 0
    s_add_u32 s35, s47, 65536
    buffer_load_dwordx4 v245, s[64:67], s35 offen  lds
    ds_read_b64_tr_b16 v[54:55], v6 offset:40960
    s_add_u32 m0, s34, 4096
    s_add_u32 s35, s47, 131072
    buffer_load_dwordx4 v245, s[64:67], s35 offen  lds
    ds_read_b64_tr_b16 v[56:57], v2 offset:45056
    s_add_u32 m0, s34, 8192
    s_add_u32 s35, s47, 196608
    buffer_load_dwordx4 v245, s[64:67], s35 offen  lds
    ds_read_b64_tr_b16 v[58:59], v6 offset:45056
    s_add_u32 m0, s34, 12288
    s_add_u32 s35, s48, 0
    buffer_load_dwordx4 v245, s[64:67], s35 offen  lds
    ds_read_b64_tr_b16 v[60:61], v224 offset:45056
    s_add_u32 m0, s34, 16384
    s_add_u32 s35, s48, 65536
    buffer_load_dwordx4 v245, s[64:67], s35 offen  lds
    ds_read_b64_tr_b16 v[62:63], v228 offset:45056
    s_add_u32 m0, s34, 20480
    s_add_u32 s35, s48, 131072
    buffer_load_dwordx4 v245, s[64:67], s35 offen  lds
    ds_read_b64_tr_b16 v[64:65], v3 offset:36864
    s_add_u32 m0, s34, 73728
    s_add_u32 s35, s48, 196608
    buffer_load_dwordx4 v245, s[64:67], s35 offen  lds
    ds_read_b64_tr_b16 v[66:67], v7 offset:36864
    s_add_u32 m0, s34, 77824
    s_add_u32 s35, s49, 0
    buffer_load_dwordx4 v245, s[64:67], s35 offen  lds
    ds_read_b64_tr_b16 v[68:69], v3 offset:40960
    s_add_u32 m0, s34, 81920
    s_add_u32 s35, s49, 65536
    buffer_load_dwordx4 v245, s[64:67], s35 offen  lds
    ds_read_b64_tr_b16 v[70:71], v7 offset:40960
    s_add_u32 m0, s34, 86016
    s_add_u32 s35, s49, 131072
    buffer_load_dwordx4 v245, s[64:67], s35 offen  lds
    ds_read_b64_tr_b16 v[72:73], v3 offset:45056
    s_add_u32 m0, s34, 24576
    s_add_u32 s35, s49, 196608
    buffer_load_dwordx4 v245, s[64:67], s35 offen  lds
    ds_read_b64_tr_b16 v[74:75], v7 offset:45056
    s_add_u32 m0, s34, 28672
    s_add_u32 s35, s50, 0
    buffer_load_dwordx4 v245, s[64:67], s35 offen  lds
    ds_read_b64_tr_b16 v[76:77], v225 offset:45056
    s_add_u32 m0, s34, 32768
    s_add_u32 s35, s50, 65536
    buffer_load_dwordx4 v245, s[64:67], s35 offen  lds
    ds_read_b64_tr_b16 v[78:79], v229 offset:45056
    s_waitcnt vmcnt(0)
    s_mov_b64 exec, 1
    ds_add_u32 v10, v11 offset:16
    s_mov_b64 exec, -1
    s_mov_b64 exec, 0xffffffff
    s_mov_b32 s79, 0
LB_po:
    buffer_load_dword v14, v247, s[52:55], s30 offen sc1
    s_add_u32 s79, s79, 1
    s_cmp_gt_u32 s79, 200000
    s_cbranch_scc1 LB_po_x
    s_waitcnt vmcnt(0)
    v_cmp_ne_u32 vcc, 1, v14
    s_cbranch_vccz LB_po_x
    s_mov_b64 exec, vcc
    s_sleep 4
    s_branch LB_po
LB_po_x:
    s_waitcnt vmcnt(0)
    s_mov_b64 exec, -1
    ds_read_b32 v222, v10 offset:16
    buffer_load_dwordx4 v[96:99], v252, s[52:55], s36 offen offset:0 sc1
    buffer_load_dwordx4 v[100:103], v252, s[52:55], s36 offen offset:1024 sc1
    buffer_load_dwordx4 v[104:107], v252, s[52:55], s36 offen offset:2048 sc1
    buffer_load_dwordx4 v[108:111], v252, s[52:55], s36 offen offset:3072 sc1
    buffer_load_dwordx4 v[112:115], v15, s[52:55], s36 offen offset:0 sc1
    buffer_load_dwordx4 v[116:119], v15, s[52:55], s36 offen offset:1024 sc1
    buffer_load_dwordx4 v[120:123], v15, s[52:55], s36 offen offset:2048 sc1
    buffer_load_dwordx4 v[124:127], v15, s[52:55], s36 offen offset:3072 sc1
    buffer_load_dwordx4 v[128:131], v252, s[52:55], s37 offen offset:0 sc1
    buffer_load_dwordx4 v[132:135], v252, s[52:55], s37 offen offset:1024 sc1
    s_setprio 1
    s_waitcnt lgkmcnt(0)
    v_cmp_gt_u32 vcc, 4, v222
    s_cbranch_vccnz LB_w4
LB_g4:
    s_waitcnt vmcnt(9)
    v_mfma_f32_16x16x32_bf16 v[16:19], v[48:51], v[96:99], 0
    buffer_load_dwordx4 v[136:139], v252, s[52:55], s37 offen offset:2048 sc1
    buffer_load_dwordx4 v[140:143], v252, s[52:55], s37 offen offset:3072 sc1
    s_waitcnt vmcnt(10)
    v_mfma_f32_16x16x32_bf16 v[16:19], v[52:55], v[100:103], v[16:19]
    buffer_load_dwordx4 v[144:147], v15, s[52:55], s37 offen offset:0 sc1
    s_waitcnt vmcnt(10)
    v_mfma_f32_16x16x32_bf16 v[16:19], v[56:59], v[104:107], v[16:19]
    buffer_load_dwordx4 v[148:151], v15, s[52:55], s37 offen offset:1024 sc1
    ds_read_b64_tr_b16 v[80:81], v4 offset:36864
    s_waitcnt vmcnt(10)
    v_mfma_f32_16x16x32_bf16 v[16:19], v[60:63], v[108:111], v[16:19]
    ds_read_b64_tr_b16 v[82:83], v8 offset:36864
    s_waitcnt vmcnt(6)
    v_mfma_f32_16x16x32_bf16 v[32:35], v[60:63], v[124:127], 0
    ds_read_b64_tr_b16 v[84:85], v4 offset:40960
    ds_read_b64_tr_b16 v[86:87], v8 offset:40960
    v_mfma_f32_16x16x32_bf16 v[32:35], v[56:59], v[120:123], v[32:35]
    ds_read_b64_tr_b16 v[88:89], v4 offset:45056
    v_mfma_f32_16x16x32_bf16 v[32:35], v[52:55], v[116:119], v[32:35]
    ds_read_b64_tr_b16 v[90:91], v8 offset:45056
    ds_read_b64_tr_b16 v[92:93], v226 offset:45056
    v_mfma_f32_16x16x32_bf16 v[32:35], v[48:51], v[112:115], v[32:35]
    ds_read_b64_tr_b16 v[94:95], v230 offset:45056
    v_mfma_f32_16x16x32_bf16 v[36:39], v[64:67], v[112:115], 0
    buffer_load_dwordx4 v[152:155], v15, s[52:55], s37 offen offset:2048 sc1
    buffer_load_dwordx4 v[156:159], v15, s[52:55], s37 offen offset:3072 sc1
    v_mfma_f32_16x16x32_bf16 v[36:39], v[68:71], v[116:119], v[36:39]
    buffer_load_dwordx4 v[160:163], v252, s[52:55], s38 offen offset:0 sc1
    v_mfma_f32_16x16x32_bf16 v[36:39], v[72:75], v[120:123], v[36:39]
    buffer_load_dwordx4 v[164:167], v252, s[52:55], s38 offen offset:1024 sc1
    ds_read_b64_tr_b16 v[48:49], v5 offset:36864
    v_mfma_f32_16x16x32_bf16 v[36:39], v[76:79], v[124:127], v[36:39]
    ds_read_b64_tr_b16 v[50:51], v9 offset:36864
    v_mfma_f32_16x16x32_bf16 v[20:23], v[76:79], v[108:111], 0
    ds_read_b64_tr_b16 v[52:53], v5 offset:40960
    ds_read_b64_tr_b16 v[54:55], v9 offset:40960
    v_mfma_f32_16x16x32_bf16 v[20:23], v[72:75], v[104:107], v[20:23]
    ds_read_b64_tr_b16 v[56:57], v5 offset:45056
    v_mfma_f32_16x16x32_bf16 v[20:23], v[68:71], v[100:103], v[20:23]
    ds_read_b64_tr_b16 v[58:59], v9 offset:45056
    ds_read_b64_tr_b16 v[60:61], v227 offset:45056
    v_mfma_f32_16x16x32_bf16 v[20:23], v[64:67], v[96:99], v[20:23]
    ds_read_b64_tr_b16 v[62:63], v231 offset:45056
    s_waitcnt lgkmcnt(14)
    v_mfma_f32_16x16x32_bf16 v[24:27], v[80:83], v[96:99], 0
    buffer_load_dwordx4 v[168:171], v252, s[52:55], s38 offen offset:2048 sc1
    buffer_load_dwordx4 v[172:175], v252, s[52:55], s38 offen offset:3072 sc1
    s_waitcnt lgkmcnt(12)
    v_mfma_f32_16x16x32_bf16 v[24:27], v[84:87], v[100:103], v[24:27]
    buffer_load_dwordx4 v[176:179], v15, s[52:55], s38 offen offset:0 sc1
    s_waitcnt lgkmcnt(10)
    v_mfma_f32_16x16x32_bf16 v[24:27], v[88:91], v[104:107], v[24:27]
    buffer_load_dwordx4 v[180:183], v15, s[52:55], s38 offen offset:1024 sc1
    ds_read_b64_tr_b16 v[64:65], v224 offset:49152
    s_waitcnt lgkmcnt(9)
    v_mfma_f32_16x16x32_bf16 v[24:27], v[92:95], v[108:111], v[24:27]
    ds_read_b64_tr_b16 v[66:67], v228 offset:49152
    v_mfma_f32_16x16x32_bf16 v[40:43], v[92:95], v[124:127], 0
    ds_read_b64_tr_b16 v[68:69], v224 offset:53248
    ds_read_b64_tr_b16 v[70:71], v228 offset:53248
    v_mfma_f32_16x16x32_bf16 v[40:43], v[88:91], v[120:123], v[40:43]
    ds_read_b64_tr_b16 v[72:73], v224 offset:57344
    v_mfma_f32_16x16x32_bf16 v[40:43], v[84:87], v[116:119], v[40:43]
    ds_read_b64_tr_b16 v[74:75], v228 offset:57344
    ds_read_b64_tr_b16 v[76:77], v2 offset:49152
    v_mfma_f32_16x16x32_bf16 v[40:43], v[80:83], v[112:115], v[40:43]
    ds_read_b64_tr_b16 v[78:79], v6 offset:49152
    s_waitcnt lgkmcnt(14)
    v_mfma_f32_16x16x32_bf16 v[44:47], v[48:51], v[112:115], 0
    buffer_load_dwordx4 v[184:187], v15, s[52:55], s38 offen offset:2048 sc1
    buffer_load_dwordx4 v[188:191], v15, s[52:55], s38 offen offset:3072 sc1
    s_waitcnt lgkmcnt(12)
    v_mfma_f32_16x16x32_bf16 v[44:47], v[52:55], v[116:119], v[44:47]
    ds_read_b64_tr_b16 v[80:81], v225 offset:49152
    s_waitcnt lgkmcnt(11)
    v_mfma_f32_16x16x32_bf16 v[44:47], v[56:59], v[120:123], v[44:47]
    ds_read_b64_tr_b16 v[82:83], v229 offset:49152
    s_waitcnt lgkmcnt(10)
    v_mfma_f32_16x16x32_bf16 v[44:47], v[60:63], v[124:127], v[44:47]
    ds_read_b64_tr_b16 v[84:85], v225 offset:53248
    v_mfma_f32_16x16x32_bf16 v[28:31], v[60:63], v[108:111], 0
    ds_read_b64_tr_b16 v[86:87], v229 offset:53248
    ds_read_b64_tr_b16 v[88:89], v225 offset:57344
    v_mfma_f32_16x16x32_bf16 v[28:31], v[56:59], v[104:107], v[28:31]
    ds_read_b64_tr_b16 v[90:91], v229 offset:57344
    v_mfma_f32_16x16x32_bf16 v[28:31], v[52:55], v[100:103], v[28:31]
    ds_read_b64_tr_b16 v[92:93], v3 offset:49152
    v_mfma_f32_16x16x32_bf16 v[28:31], v[48:51], v[96:99], v[28:31]
    ds_read_b64_tr_b16 v[94:95], v7 offset:49152
    s_waitcnt vmcnt(8) lgkmcnt(8)
    v_mfma_f32_16x16x32_bf16 v[16:19], v[64:67], v[128:131], v[16:19]
    buffer_load_dwordx4 v[96:99], v252, s[52:55], s39 offen offset:0 sc1
    buffer_load_dwordx4 v[100:103], v252, s[52:55], s39 offen offset:1024 sc1
    v_mfma_f32_16x16x32_bf16 v[16:19], v[68:71], v[132:135], v[16:19]
    buffer_load_dwordx4 v[104:107], v252, s[52:55], s39 offen offset:2048 sc1
    v_mfma_f32_16x16x32_bf16 v[16:19], v[72:75], v[136:139], v[16:19]
    buffer_load_dwordx4 v[108:111], v252, s[52:55], s39 offen offset:3072 sc1
    ds_read_b64_tr_b16 v[48:49], v226 offset:49152
    v_mfma_f32_16x16x32_bf16 v[16:19], v[76:79], v[140:143], v[16:19]
    ds_read_b64_tr_b16 v[50:51], v230 offset:49152
    v_mfma_f32_16x16x32_bf16 v[32:35], v[76:79], v[156:159], v[32:35]
    ds_read_b64_tr_b16 v[52:53], v226 offset:53248
    ds_read_b64_tr_b16 v[54:55], v230 offset:53248
    v_mfma_f32_16x16x32_bf16 v[32:35], v[72:75], v[152:155], v[32:35]
    ds_read_b64_tr_b16 v[56:57], v226 offset:57344
    v_mfma_f32_16x16x32_bf16 v[32:35], v[68:71], v[148:151], v[32:35]
    ds_read_b64_tr_b16 v[58:59], v230 offset:57344
    ds_read_b64_tr_b16 v[60:61], v4 offset:49152
    v_mfma_f32_16x16x32_bf16 v[32:35], v[64:67], v[144:147], v[32:35]
    ds_read_b64_tr_b16 v[62:63], v8 offset:49152
    s_waitcnt lgkmcnt(8)
    v_mfma_f32_16x16x32_bf16 v[36:39], v[80:83], v[144:147], v[36:39]
    buffer_load_dwordx4 v[112:115], v15, s[52:55], s39 offen offset:0 sc1
    buffer_load_dwordx4 v[116:119], v15, s[52:55], s39 offen offset:1024 sc1
    v_mfma_f32_16x16x32_bf16 v[36:39], v[84:87], v[148:151], v[36:39]
    ds_read_b64_tr_b16 v[64:65], v227 offset:49152
    v_mfma_f32_16x16x32_bf16 v[36:39], v[88:91], v[152:155], v[36:39]
    ds_read_b64_tr_b16 v[66:67], v231 offset:49152
    v_mfma_f32_16x16x32_bf16 v[36:39], v[92:95], v[156:159], v[36:39]
    ds_read_b64_tr_b16 v[68:69], v227 offset:53248
    v_mfma_f32_16x16x32_bf16 v[20:23], v[92:95], v[140:143], v[20:23]
    ds_read_b64_tr_b16 v[70:71], v231 offset:53248
    ds_read_b64_tr_b16 v[72:73], v227 offset:57344
    v_mfma_f32_16x16x32_bf16 v[20:23], v[88:91], v[136:139], v[20:23]
    ds_read_b64_tr_b16 v[74:75], v231 offset:57344
    v_mfma_f32_16x16x32_bf16 v[20:23], v[84:87], v[132:135], v[20:23]
    ds_read_b64_tr_b16 v[76:77], v5 offset:49152
    v_mfma_f32_16x16x32_bf16 v[20:23], v[80:83], v[128:131], v[20:23]
    ds_read_b64_tr_b16 v[78:79], v9 offset:49152
    s_waitcnt lgkmcnt(8)
    v_mfma_f32_16x16x32_bf16 v[24:27], v[48:51], v[128:131], v[24:27]
    buffer_load_dwordx4 v[120:123], v15, s[52:55], s39 offen offset:2048 sc1
    buffer_load_dwordx4 v[124:127], v15, s[52:55], s39 offen offset:3072 sc1
    v_mfma_f32_16x16x32_bf16 v[24:27], v[52:55], v[132:135], v[24:27]
    ds_read_b64_tr_b16 v[80:81], v2 offset:53248
    v_mfma_f32_16x16x32_bf16 v[24:27], v[56:59], v[136:139], v[24:27]
    ds_read_b64_tr_b16 v[82:83], v6 offset:53248
    v_mfma_f32_16x16x32_bf16 v[24:27], v[60:63], v[140:143], v[24:27]
    ds_read_b64_tr_b16 v[84:85], v2 offset:57344
    v_mfma_f32_16x16x32_bf16 v[40:43], v[60:63], v[156:159], v[40:43]
    ds_read_b64_tr_b16 v[86:87], v6 offset:57344
    ds_read_b64_tr_b16 v[88:89], v2 offset:61440
    v_mfma_f32_16x16x32_bf16 v[40:43], v[56:59], v[152:155], v[40:43]
    ds_read_b64_tr_b16 v[90:91], v6 offset:61440
    v_mfma_f32_16x16x32_bf16 v[40:43], v[52:55], v[148:151], v[40:43]
    ds_read_b64_tr_b16 v[92:93], v224 offset:0
    v_mfma_f32_16x16x32_bf16 v[40:43], v[48:51], v[144:147], v[40:43]
    ds_read_b64_tr_b16 v[94:95], v228 offset:0
    s_waitcnt lgkmcnt(8)
    v_mfma_f32_16x16x32_bf16 v[44:47], v[64:67], v[144:147], v[44:47]
    ds_read_b64_tr_b16 v[48:49], v3 offset:53248
    v_mfma_f32_16x16x32_bf16 v[44:47], v[68:71], v[148:151], v[44:47]
    ds_read_b64_tr_b16 v[50:51], v7 offset:53248
    v_mfma_f32_16x16x32_bf16 v[44:47], v[72:75], v[152:155], v[44:47]
    ds_read_b64_tr_b16 v[52:53], v3 offset:57344
    v_mfma_f32_16x16x32_bf16 v[44:47], v[76:79], v[156:159], v[44:47]
    ds_read_b64_tr_b16 v[54:55], v7 offset:57344
    v_mfma_f32_16x16x32_bf16 v[28:31], v[76:79], v[140:143], v[28:31]
    ds_read_b64_tr_b16 v[56:57], v3 offset:61440
    v_mfma_f32_16x16x32_bf16 v[28:31], v[72:75], v[136:139], v[28:31]
    ds_read_b64_tr_b16 v[58:59], v7 offset:61440
    v_mfma_f32_16x16x32_bf16 v[28:31], v[68:71], v[132:135], v[28:31]
    ds_read_b64_tr_b16 v[60:61], v225 offset:0
    v_mfma_f32_16x16x32_bf16 v[28:31], v[64:67], v[128:131], v[28:31]
    ds_read_b64_tr_b16 v[62:63], v229 offset:0
    s_waitcnt vmcnt(8) lgkmcnt(8)
    v_mfma_f32_16x16x32_bf16 v[16:19], v[80:83], v[160:163], v[16:19]
    buffer_load_dwordx4 v[128:131], v252, s[52:55], s40 offen offset:0 sc1
    buffer_load_dwordx4 v[132:135], v252, s[52:55], s40 offen offset:1024 sc1
    v_mfma_f32_16x16x32_bf16 v[16:19], v[84:87], v[164:167], v[16:19]
    buffer_load_dwordx4 v[136:139], v252, s[52:55], s40 offen offset:2048 sc1
    v_mfma_f32_16x16x32_bf16 v[16:19], v[88:91], v[168:171], v[16:19]
    buffer_load_dwordx4 v[140:143], v252, s[52:55], s40 offen offset:3072 sc1
    ds_read_b64_tr_b16 v[64:65], v4 offset:53248
    v_mfma_f32_16x16x32_bf16 v[16:19], v[92:95], v[172:175], v[16:19]
    ds_read_b64_tr_b16 v[66:67], v8 offset:53248
    v_mfma_f32_16x16x32_bf16 v[32:35], v[92:95], v[188:191], v[32:35]
    ds_read_b64_tr_b16 v[68:69], v4 offset:57344
    ds_read_b64_tr_b16 v[70:71], v8 offset:57344
    v_mfma_f32_16x16x32_bf16 v[32:35], v[88:91], v[184:187], v[32:35]
    ds_read_b64_tr_b16 v[72:73], v4 offset:61440
    v_mfma_f32_16x16x32_bf16 v[32:35], v[84:87], v[180:183], v[32:35]
    ds_read_b64_tr_b16 v[74:75], v8 offset:61440
    ds_read_b64_tr_b16 v[76:77], v226 offset:0
    v_mfma_f32_16x16x32_bf16 v[32:35], v[80:83], v[176:179], v[32:35]
    ds_read_b64_tr_b16 v[78:79], v230 offset:0
    s_waitcnt lgkmcnt(8)
    v_mfma_f32_16x16x32_bf16 v[36:39], v[48:51], v[176:179], v[36:39]
    buffer_load_dwordx4 v[144:147], v15, s[52:55], s40 offen offset:0 sc1
    buffer_load_dwordx4 v[148:151], v15, s[52:55], s40 offen offset:1024 sc1
    v_mfma_f32_16x16x32_bf16 v[36:39], v[52:55], v[180:183], v[36:39]
    ds_read_b64_tr_b16 v[80:81], v5 offset:53248
    v_mfma_f32_16x16x32_bf16 v[36:39], v[56:59], v[184:187], v[36:39]
    ds_read_b64_tr_b16 v[82:83], v9 offset:53248
    v_mfma_f32_16x16x32_bf16 v[36:39], v[60:63], v[188:191], v[36:39]
    ds_read_b64_tr_b16 v[84:85], v5 offset:57344
    v_mfma_f32_16x16x32_bf16 v[20:23], v[60:63], v[172:175], v[20:23]
    ds_read_b64_tr_b16 v[86:87], v9 offset:57344
    ds_read_b64_tr_b16 v[88:89], v5 offset:61440
    v_mfma_f32_16x16x32_bf16 v[20:23], v[56:59], v[168:171], v[20:23]
    ds_read_b64_tr_b16 v[90:91], v9 offset:61440
    v_mfma_f32_16x16x32_bf16 v[20:23], v[52:55], v[164:167], v[20:23]
    ds_read_b64_tr_b16 v[92:93], v227 offset:0
    v_mfma_f32_16x16x32_bf16 v[20:23], v[48:51], v[160:163], v[20:23]
    ds_read_b64_tr_b16 v[94:95], v231 offset:0
    s_waitcnt lgkmcnt(8)
    v_mfma_f32_16x16x32_bf16 v[24:27], v[64:67], v[160:163], v[24:27]
    buffer_load_dwordx4 v[152:155], v15, s[52:55], s40 offen offset:2048 sc1
    buffer_load_dwordx4 v[156:159], v15, s[52:55], s40 offen offset:3072 sc1
    v_mfma_f32_16x16x32_bf16 v[24:27], v[68:71], v[164:167], v[24:27]
    ds_read_b64_tr_b16 v[48:49], v224 offset:4096
    v_mfma_f32_16x16x32_bf16 v[24:27], v[72:75], v[168:171], v[24:27]
    ds_read_b64_tr_b16 v[50:51], v228 offset:4096
    v_mfma_f32_16x16x32_bf16 v[24:27], v[76:79], v[172:175], v[24:27]
    ds_read_b64_tr_b16 v[52:53], v2 offset:0
    v_mfma_f32_16x16x32_bf16 v[40:43], v[76:79], v[188:191], v[40:43]
    ds_read_b64_tr_b16 v[54:55], v6 offset:0
    ds_read_b64_tr_b16 v[56:57], v2 offset:4096
    v_mfma_f32_16x16x32_bf16 v[40:43], v[72:75], v[184:187], v[40:43]
    ds_read_b64_tr_b16 v[58:59], v6 offset:4096
    v_mfma_f32_16x16x32_bf16 v[40:43], v[68:71], v[180:183], v[40:43]
    ds_read_b64_tr_b16 v[60:61], v2 offset:8192
    v_mfma_f32_16x16x32_bf16 v[40:43], v[64:67], v[176:179], v[40:43]
    ds_read_b64_tr_b16 v[62:63], v6 offset:8192
    s_waitcnt lgkmcnt(8)
    v_mfma_f32_16x16x32_bf16 v[44:47], v[80:83], v[176:179], v[44:47]
    ds_read_b64_tr_b16 v[64:65], v225 offset:4096
    v_mfma_f32_16x16x32_bf16 v[44:47], v[84:87], v[180:183], v[44:47]
    ds_read_b64_tr_b16 v[66:67], v229 offset:4096
    v_mfma_f32_16x16x32_bf16 v[44:47], v[88:91], v[184:187], v[44:47]
    ds_read_b64_tr_b16 v[68:69], v3 offset:0
    v_mfma_f32_16x16x32_bf16 v[44:47], v[92:95], v[188:191], v[44:47]
    ds_read_b64_tr_b16 v[70:71], v7 offset:0
    v_mfma_f32_16x16x32_bf16 v[28:31], v[92:95], v[172:175], v[28:31]
    ds_read_b64_tr_b16 v[72:73], v3 offset:4096
    v_mfma_f32_16x16x32_bf16 v[28:31], v[88:91], v[168:171], v[28:31]
    ds_read_b64_tr_b16 v[74:75], v7 offset:4096
    v_mfma_f32_16x16x32_bf16 v[28:31], v[84:87], v[164:167], v[28:31]
    ds_read_b64_tr_b16 v[76:77], v3 offset:8192
    v_mfma_f32_16x16x32_bf16 v[28:31], v[80:83], v[160:163], v[28:31]
    ds_read_b64_tr_b16 v[78:79], v7 offset:8192
    s_waitcnt vmcnt(8) lgkmcnt(8)
    v_mfma_f32_16x16x32_bf16 v[16:19], v[48:51], v[96:99], v[16:19]
    buffer_load_dwordx4 v[160:163], v252, s[52:55], s41 offen offset:0 sc1
    buffer_load_dwordx4 v[164:167], v252, s[52:55], s41 offen offset:1024 sc1
    v_mfma_f32_16x16x32_bf16 v[16:19], v[52:55], v[100:103], v[16:19]
    buffer_load_dwordx4 v[168:171], v252, s[52:55], s41 offen offset:2048 sc1
    v_mfma_f32_16x16x32_bf16 v[16:19], v[56:59], v[104:107], v[16:19]
    buffer_load_dwordx4 v[172:175], v252, s[52:55], s41 offen offset:3072 sc1
    ds_read_b64_tr_b16 v[80:81], v226 offset:4096
    v_mfma_f32_16x16x32_bf16 v[16:19], v[60:63], v[108:111], v[16:19]
    ds_read_b64_tr_b16 v[82:83], v230 offset:4096
    v_mfma_f32_16x16x32_bf16 v[32:35], v[60:63], v[124:127], v[32:35]
    ds_read_b64_tr_b16 v[84:85], v4 offset:0
    ds_read_b64_tr_b16 v[86:87], v8 offset:0
    v_mfma_f32_16x16x32_bf16 v[32:35], v[56:59], v[120:123], v[32:35]
    ds_read_b64_tr_b16 v[88:89], v4 offset:4096
    v_mfma_f32_16x16x32_bf16 v[32:35], v[52:55], v[116:119], v[32:35]
    ds_read_b64_tr_b16 v[90:91], v8 offset:4096
    ds_read_b64_tr_b16 v[92:93], v4 offset:8192
    v_mfma_f32_16x16x32_bf16 v[32:35], v[48:51], v[112:115], v[32:35]
    ds_read_b64_tr_b16 v[94:95], v8 offset:8192
    s_waitcnt lgkmcnt(8)
    v_mfma_f32_16x16x32_bf16 v[36:39], v[64:67], v[112:115], v[36:39]
    buffer_load_dwordx4 v[176:179], v15, s[52:55], s41 offen offset:0 sc1
    buffer_load_dwordx4 v[180:183], v15, s[52:55], s41 offen offset:1024 sc1
    v_mfma_f32_16x16x32_bf16 v[36:39], v[68:71], v[116:119], v[36:39]
    ds_read_b64_tr_b16 v[48:49], v227 offset:4096
    v_mfma_f32_16x16x32_bf16 v[36:39], v[72:75], v[120:123], v[36:39]
    ds_read_b64_tr_b16 v[50:51], v231 offset:4096
    v_mfma_f32_16x16x32_bf16 v[36:39], v[76:79], v[124:127], v[36:39]
    ds_read_b64_tr_b16 v[52:53], v5 offset:0
    v_mfma_f32_16x16x32_bf16 v[20:23], v[76:79], v[108:111], v[20:23]
    ds_read_b64_tr_b16 v[54:55], v9 offset:0
    ds_read_b64_tr_b16 v[56:57], v5 offset:4096
    v_mfma_f32_16x16x32_bf16 v[20:23], v[72:75], v[104:107], v[20:23]
    ds_read_b64_tr_b16 v[58:59], v9 offset:4096
    v_mfma_f32_16x16x32_bf16 v[20:23], v[68:71], v[100:103], v[20:23]
    ds_read_b64_tr_b16 v[60:61], v5 offset:8192
    v_mfma_f32_16x16x32_bf16 v[20:23], v[64:67], v[96:99], v[20:23]
    ds_read_b64_tr_b16 v[62:63], v9 offset:8192
    s_mov_b64 exec, 1
    ds_add_u32 v10, v11 offset:28
    s_mov_b64 exec, -1
    s_waitcnt lgkmcnt(9)
    v_mfma_f32_16x16x32_bf16 v[24:27], v[80:83], v[96:99], v[24:27]
    buffer_load_dwordx4 v[184:187], v15, s[52:55], s41 offen offset:2048 sc1
    buffer_load_dwordx4 v[188:191], v15, s[52:55], s41 offen offset:3072 sc1
    v_mfma_f32_16x16x32_bf16 v[24:27], v[84:87], v[100:103], v[24:27]
    ds_read_b64_tr_b16 v[64:65], v2 offset:12288
    v_mfma_f32_16x16x32_bf16 v[24:27], v[88:91], v[104:107], v[24:27]
    ds_read_b64_tr_b16 v[66:67], v6 offset:12288
    v_mfma_f32_16x16x32_bf16 v[24:27], v[92:95], v[108:111], v[24:27]
    ds_read_b64_tr_b16 v[68:69], v2 offset:16384
    v_mfma_f32_16x16x32_bf16 v[40:43], v[92:95], v[124:127], v[40:43]
    ds_read_b64_tr_b16 v[70:71], v6 offset:16384
    ds_read_b64_tr_b16 v[72:73], v2 offset:20480
    v_mfma_f32_16x16x32_bf16 v[40:43], v[88:91], v[120:123], v[40:43]
    ds_read_b64_tr_b16 v[74:75], v6 offset:20480
    v_mfma_f32_16x16x32_bf16 v[40:43], v[84:87], v[116:119], v[40:43]
    ds_read_b64_tr_b16 v[76:77], v224 offset:8192
    v_mfma_f32_16x16x32_bf16 v[40:43], v[80:83], v[112:115], v[40:43]
    ds_read_b64_tr_b16 v[78:79], v228 offset:8192
    s_waitcnt lgkmcnt(9)
    v_mfma_f32_16x16x32_bf16 v[44:47], v[48:51], v[112:115], v[44:47]
    ds_read_b64_tr_b16 v[80:81], v3 offset:12288
    v_mfma_f32_16x16x32_bf16 v[44:47], v[52:55], v[116:119], v[44:47]
    ds_read_b64_tr_b16 v[82:83], v7 offset:12288
    v_mfma_f32_16x16x32_bf16 v[44:47], v[56:59], v[120:123], v[44:47]
    ds_read_b64_tr_b16 v[84:85], v3 offset:16384
    v_mfma_f32_16x16x32_bf16 v[44:47], v[60:63], v[124:127], v[44:47]
    ds_read_b64_tr_b16 v[86:87], v7 offset:16384
    v_mfma_f32_16x16x32_bf16 v[28:31], v[60:63], v[108:111], v[28:31]
    ds_read_b64_tr_b16 v[88:89], v3 offset:20480
    v_mfma_f32_16x16x32_bf16 v[28:31], v[56:59], v[104:107], v[28:31]
    ds_read_b64_tr_b16 v[90:91], v7 offset:20480
    v_mfma_f32_16x16x32_bf16 v[28:31], v[52:55], v[100:103], v[28:31]
    ds_read_b64_tr_b16 v[92:93], v225 offset:8192
    v_mfma_f32_16x16x32_bf16 v[28:31], v[48:51], v[96:99], v[28:31]
    ds_read_b64_tr_b16 v[94:95], v229 offset:8192
    s_waitcnt vmcnt(8) lgkmcnt(8)
    v_mfma_f32_16x16x32_bf16 v[16:19], v[64:67], v[128:131], v[16:19]
    buffer_load_dwordx4 v[96:99], v252, s[52:55], s42 offen offset:0 sc1
    buffer_load_dwordx4 v[100:103], v252, s[52:55], s42 offen offset:1024 sc1
    v_mfma_f32_16x16x32_bf16 v[16:19], v[68:71], v[132:135], v[16:19]
    buffer_load_dwordx4 v[104:107], v252, s[52:55], s42 offen offset:2048 sc1
    v_mfma_f32_16x16x32_bf16 v[16:19], v[72:75], v[136:139], v[16:19]
    buffer_load_dwordx4 v[108:111], v252, s[52:55], s42 offen offset:3072 sc1
    ds_read_b64_tr_b16 v[48:49], v4 offset:12288
    v_mfma_f32_16x16x32_bf16 v[16:19], v[76:79], v[140:143], v[16:19]
    ds_read_b64_tr_b16 v[50:51], v8 offset:12288
    v_mfma_f32_16x16x32_bf16 v[32:35], v[76:79], v[156:159], v[32:35]
    ds_read_b64_tr_b16 v[52:53], v4 offset:16384
    ds_read_b64_tr_b16 v[54:55], v8 offset:16384
    v_mfma_f32_16x16x32_bf16 v[32:35], v[72:75], v[152:155], v[32:35]
    ds_read_b64_tr_b16 v[56:57], v4 offset:20480
    v_mfma_f32_16x16x32_bf16 v[32:35], v[68:71], v[148:151], v[32:35]
    ds_read_b64_tr_b16 v[58:59], v8 offset:20480
    ds_read_b64_tr_b16 v[60:61], v226 offset:8192
    v_mfma_f32_16x16x32_bf16 v[32:35], v[64:67], v[144:147], v[32:35]
    ds_read_b64_tr_b16 v[62:63], v230 offset:8192
    s_waitcnt lgkmcnt(8)
    v_mfma_f32_16x16x32_bf16 v[36:39], v[80:83], v[144:147], v[36:39]
    buffer_load_dwordx4 v[112:115], v15, s[52:55], s42 offen offset:0 sc1
    buffer_load_dwordx4 v[116:119], v15, s[52:55], s42 offen offset:1024 sc1
    v_mfma_f32_16x16x32_bf16 v[36:39], v[84:87], v[148:151], v[36:39]
    ds_read_b64_tr_b16 v[64:65], v5 offset:12288
    v_mfma_f32_16x16x32_bf16 v[36:39], v[88:91], v[152:155], v[36:39]
    ds_read_b64_tr_b16 v[66:67], v9 offset:12288
    v_mfma_f32_16x16x32_bf16 v[36:39], v[92:95], v[156:159], v[36:39]
    ds_read_b64_tr_b16 v[68:69], v5 offset:16384
    v_mfma_f32_16x16x32_bf16 v[20:23], v[92:95], v[140:143], v[20:23]
    ds_read_b64_tr_b16 v[70:71], v9 offset:16384
    ds_read_b64_tr_b16 v[72:73], v5 offset:20480
    v_mfma_f32_16x16x32_bf16 v[20:23], v[88:91], v[136:139], v[20:23]
    ds_read_b64_tr_b16 v[74:75], v9 offset:20480
    v_mfma_f32_16x16x32_bf16 v[20:23], v[84:87], v[132:135], v[20:23]
    ds_read_b64_tr_b16 v[76:77], v227 offset:8192
    v_mfma_f32_16x16x32_bf16 v[20:23], v[80:83], v[128:131], v[20:23]
    ds_read_b64_tr_b16 v[78:79], v231 offset:8192
    s_waitcnt lgkmcnt(8)
    v_mfma_f32_16x16x32_bf16 v[24:27], v[48:51], v[128:131], v[24:27]
    buffer_load_dwordx4 v[120:123], v15, s[52:55], s42 offen offset:2048 sc1
    buffer_load_dwordx4 v[124:127], v15, s[52:55], s42 offen offset:3072 sc1
    v_mfma_f32_16x16x32_bf16 v[24:27], v[52:55], v[132:135], v[24:27]
    ds_read_b64_tr_b16 v[80:81], v224 offset:12288
    v_mfma_f32_16x16x32_bf16 v[24:27], v[56:59], v[136:139], v[24:27]
    ds_read_b64_tr_b16 v[82:83], v228 offset:12288
    v_mfma_f32_16x16x32_bf16 v[24:27], v[60:63], v[140:143], v[24:27]
    ds_read_b64_tr_b16 v[84:85], v224 offset:16384
    v_mfma_f32_16x16x32_bf16 v[40:43], v[60:63], v[156:159], v[40:43]
    ds_read_b64_tr_b16 v[86:87], v228 offset:16384
    ds_read_b64_tr_b16 v[88:89], v224 offset:20480
    v_mfma_f32_16x16x32_bf16 v[40:43], v[56:59], v[152:155], v[40:43]
    ds_read_b64_tr_b16 v[90:91], v228 offset:20480
    v_mfma_f32_16x16x32_bf16 v[40:43], v[52:55], v[148:151], v[40:43]
    ds_read_b64_tr_b16 v[92:93], v2 offset:24576
    v_mfma_f32_16x16x32_bf16 v[40:43], v[48:51], v[144:147], v[40:43]
    ds_read_b64_tr_b16 v[94:95], v6 offset:24576
    s_waitcnt lgkmcnt(8)
    v_mfma_f32_16x16x32_bf16 v[44:47], v[64:67], v[144:147], v[44:47]
    ds_read_b64_tr_b16 v[48:49], v225 offset:12288
    v_mfma_f32_16x16x32_bf16 v[44:47], v[68:71], v[148:151], v[44:47]
    ds_read_b64_tr_b16 v[50:51], v229 offset:12288
    v_mfma_f32_16x16x32_bf16 v[44:47], v[72:75], v[152:155], v[44:47]
    ds_read_b64_tr_b16 v[52:53], v225 offset:16384
    v_mfma_f32_16x16x32_bf16 v[44:47], v[76:79], v[156:159], v[44:47]
    ds_read_b64_tr_b16 v[54:55], v229 offset:16384
    v_mfma_f32_16x16x32_bf16 v[28:31], v[76:79], v[140:143], v[28:31]
    ds_read_b64_tr_b16 v[56:57], v225 offset:20480
    v_mfma_f32_16x16x32_bf16 v[28:31], v[72:75], v[136:139], v[28:31]
    ds_read_b64_tr_b16 v[58:59], v229 offset:20480
    v_mfma_f32_16x16x32_bf16 v[28:31], v[68:71], v[132:135], v[28:31]
    ds_read_b64_tr_b16 v[60:61], v3 offset:24576
    v_mfma_f32_16x16x32_bf16 v[28:31], v[64:67], v[128:131], v[28:31]
    ds_read_b64_tr_b16 v[62:63], v7 offset:24576
    s_waitcnt vmcnt(8) lgkmcnt(8)
    v_mfma_f32_16x16x32_bf16 v[16:19], v[80:83], v[160:163], v[16:19]
    buffer_load_dwordx4 v[128:131], v252, s[52:55], s43 offen offset:0 sc1
    buffer_load_dwordx4 v[132:135], v252, s[52:55], s43 offen offset:1024 sc1
    v_mfma_f32_16x16x32_bf16 v[16:19], v[84:87], v[164:167], v[16:19]
    buffer_load_dwordx4 v[136:139], v252, s[52:55], s43 offen offset:2048 sc1
    v_mfma_f32_16x16x32_bf16 v[16:19], v[88:91], v[168:171], v[16:19]
    buffer_load_dwordx4 v[140:143], v252, s[52:55], s43 offen offset:3072 sc1
    ds_read_b64_tr_b16 v[64:65], v226 offset:12288
    v_mfma_f32_16x16x32_bf16 v[16:19], v[92:95], v[172:175], v[16:19]
    ds_read_b64_tr_b16 v[66:67], v230 offset:12288
    v_mfma_f32_16x16x32_bf16 v[32:35], v[92:95], v[188:191], v[32:35]
    ds_read_b64_tr_b16 v[68:69], v226 offset:16384
    ds_read_b64_tr_b16 v[70:71], v230 offset:16384
    v_mfma_f32_16x16x32_bf16 v[32:35], v[88:91], v[184:187], v[32:35]
    ds_read_b64_tr_b16 v[72:73], v226 offset:20480
    v_mfma_f32_16x16x32_bf16 v[32:35], v[84:87], v[180:183], v[32:35]
    ds_read_b64_tr_b16 v[74:75], v230 offset:20480
    ds_read_b64_tr_b16 v[76:77], v4 offset:24576
    v_mfma_f32_16x16x32_bf16 v[32:35], v[80:83], v[176:179], v[32:35]
    ds_read_b64_tr_b16 v[78:79], v8 offset:24576
    s_mov_b64 exec, 1
    ds_add_u32 v10, v11 offset:40
    s_mov_b64 exec, -1
    s_waitcnt lgkmcnt(9)
    v_mfma_f32_16x16x32_bf16 v[36:39], v[48:51], v[176:179], v[36:39]
    buffer_load_dwordx4 v[144:147], v15, s[52:55], s43 offen offset:0 sc1
    buffer_load_dwordx4 v[148:151], v15, s[52:55], s43 offen offset:1024 sc1
    v_mfma_f32_16x16x32_bf16 v[36:39], v[52:55], v[180:183], v[36:39]
    ds_read_b32 v223, v10 offset:32
    v_mfma_f32_16x16x32_bf16 v[36:39], v[56:59], v[184:187], v[36:39]
    ds_read_b64_tr_b16 v[80:81], v227 offset:12288
    ds_read_b64_tr_b16 v[82:83], v231 offset:12288
    v_mfma_f32_16x16x32_bf16 v[36:39], v[60:63], v[188:191], v[36:39]
    ds_read_b64_tr_b16 v[84:85], v227 offset:16384
    v_mfma_f32_16x16x32_bf16 v[20:23], v[60:63], v[172:175], v[20:23]
    ds_read_b64_tr_b16 v[86:87], v231 offset:16384
    v_mfma_f32_16x16x32_bf16 v[20:23], v[56:59], v[168:171], v[20:23]
    ds_read_b64_tr_b16 v[88:89], v227 offset:20480
    ds_read_b64_tr_b16 v[90:91], v231 offset:20480
    v_mfma_f32_16x16x32_bf16 v[20:23], v[52:55], v[164:167], v[20:23]
    ds_read_b64_tr_b16 v[92:93], v5 offset:24576
    v_mfma_f32_16x16x32_bf16 v[20:23], v[48:51], v[160:163], v[20:23]
    ds_read_b64_tr_b16 v[94:95], v9 offset:24576
    s_waitcnt lgkmcnt(8)
    v_cmp_gt_u32 vcc, 4, v223
    s_cbranch_vccnz LB_w8
LB_g8:
    v_mfma_f32_16x16x32_bf16 v[24:27], v[64:67], v[160:163], v[24:27]
    buffer_load_dwordx4 v[152:155], v15, s[52:55], s43 offen offset:2048 sc1
    buffer_load_dwordx4 v[156:159], v15, s[52:55], s43 offen offset:3072 sc1
    v_mfma_f32_16x16x32_bf16 v[24:27], v[68:71], v[164:167], v[24:27]
    ds_read_b64_tr_b16 v[48:49], v2 offset:28672
    v_mfma_f32_16x16x32_bf16 v[24:27], v[72:75], v[168:171], v[24:27]
    ds_read_b64_tr_b16 v[50:51], v6 offset:28672
    v_mfma_f32_16x16x32_bf16 v[24:27], v[76:79], v[172:175], v[24:27]
    ds_read_b64_tr_b16 v[52:53], v2 offset:32768
    v_mfma_f32_16x16x32_bf16 v[40:43], v[76:79], v[188:191], v[40:43]
    ds_read_b64_tr_b16 v[54:55], v6 offset:32768
    ds_read_b64_tr_b16 v[56:57], v232 offset:0
    v_mfma_f32_16x16x32_bf16 v[40:43], v[72:75], v[184:187], v[40:43]
    ds_read_b64_tr_b16 v[58:59], v236 offset:0
    v_mfma_f32_16x16x32_bf16 v[40:43], v[68:71], v[180:183], v[40:43]
    ds_read_b64_tr_b16 v[60:61], v232 offset:4096
    v_mfma_f32_16x16x32_bf16 v[40:43], v[64:67], v[176:179], v[40:43]
    ds_read_b64_tr_b16 v[62:63], v236 offset:4096
    s_waitcnt lgkmcnt(8)
    v_mfma_f32_16x16x32_bf16 v[44:47], v[80:83], v[176:179], v[44:47]
    ds_read_b64_tr_b16 v[64:65], v3 offset:28672
    v_mfma_f32_16x16x32_bf16 v[44:47], v[84:87], v[180:183], v[44:47]
    ds_read_b64_tr_b16 v[66:67], v7 offset:28672
    v_mfma_f32_16x16x32_bf16 v[44:47], v[88:91], v[184:187], v[44:47]
    ds_read_b64_tr_b16 v[68:69], v3 offset:32768
    v_mfma_f32_16x16x32_bf16 v[44:47], v[92:95], v[188:191], v[44:47]
    ds_read_b64_tr_b16 v[70:71], v7 offset:32768
    v_mfma_f32_16x16x32_bf16 v[28:31], v[92:95], v[172:175], v[28:31]
    ds_read_b64_tr_b16 v[72:73], v233 offset:0
    v_mfma_f32_16x16x32_bf16 v[28:31], v[88:91], v[168:171], v[28:31]
    ds_read_b64_tr_b16 v[74:75], v237 offset:0
    v_mfma_f32_16x16x32_bf16 v[28:31], v[84:87], v[164:167], v[28:31]
    ds_read_b64_tr_b16 v[76:77], v233 offset:4096
    v_mfma_f32_16x16x32_bf16 v[28:31], v[80:83], v[160:163], v[28:31]
    ds_read_b64_tr_b16 v[78:79], v237 offset:4096
    s_waitcnt vmcnt(8) lgkmcnt(8)
    v_mfma_f32_16x16x32_bf16 v[16:19], v[48:51], v[96:99], v[16:19]
    ds_read_b64_tr_b16 v[80:81], v4 offset:28672
    v_mfma_f32_16x16x32_bf16 v[16:19], v[52:55], v[100:103], v[16:19]
    ds_read_b64_tr_b16 v[82:83], v8 offset:28672
    v_mfma_f32_16x16x32_bf16 v[16:19], v[56:59], v[104:107], v[16:19]
    ds_read_b64_tr_b16 v[84:85], v4 offset:32768
    v_mfma_f32_16x16x32_bf16 v[16:19], v[60:63], v[108:111], v[16:19]
    ds_read_b64_tr_b16 v[86:87], v8 offset:32768
    v_mfma_f32_16x16x32_bf16 v[32:35], v[60:63], v[124:127], v[32:35]
    ds_read_b64_tr_b16 v[88:89], v234 offset:0
    v_mfma_f32_16x16x32_bf16 v[32:35], v[56:59], v[120:123], v[32:35]
    ds_read_b64_tr_b16 v[90:91], v238 offset:0
    v_mfma_f32_16x16x32_bf16 v[32:35], v[52:55], v[116:119], v[32:35]
    ds_read_b64_tr_b16 v[92:93], v234 offset:4096
    v_mfma_f32_16x16x32_bf16 v[32:35], v[48:51], v[112:115], v[32:35]
    ds_read_b64_tr_b16 v[94:95], v238 offset:4096
    s_waitcnt lgkmcnt(8)
    v_mfma_f32_16x16x32_bf16 v[36:39], v[64:67], v[112:115], v[36:39]
    ds_read_b64_tr_b16 v[48:49], v5 offset:28672
    v_mfma_f32_16x16x32_bf16 v[36:39], v[68:71], v[116:119], v[36:39]
    ds_read_b64_tr_b16 v[50:51], v9 offset:28672
    v_mfma_f32_16x16x32_bf16 v[36:39], v[72:75], v[120:123], v[36:39]
    ds_read_b64_tr_b16 v[52:53], v5 offset:32768
    v_mfma_f32_16x16x32_bf16 v[36:39], v[76:79], v[124:127], v[36:39]
    ds_read_b64_tr_b16 v[54:55], v9 offset:32768
    v_mfma_f32_16x16x32_bf16 v[20:23], v[76:79], v[108:111], v[20:23]
    ds_read_b64_tr_b16 v[56:57], v235 offset:0
    v_mfma_f32_16x16x32_bf16 v[20:23], v[72:75], v[104:107], v[20:23]
    ds_read_b64_tr_b16 v[58:59], v239 offset:0
    v_mfma_f32_16x16x32_bf16 v[20:23], v[68:71], v[100:103], v[20:23]
    ds_read_b64_tr_b16 v[60:61], v235 offset:4096
    v_mfma_f32_16x16x32_bf16 v[20:23], v[64:67], v[96:99], v[20:23]
    ds_read_b64_tr_b16 v[62:63], v239 offset:4096
    s_waitcnt lgkmcnt(8)
    v_mfma_f32_16x16x32_bf16 v[24:27], v[80:83], v[96:99], v[24:27]
    ds_read_b64_tr_b16 v[64:65], v232 offset:8192
    v_mfma_f32_16x16x32_bf16 v[24:27], v[84:87], v[100:103], v[24:27]
    ds_read_b64_tr_b16 v[66:67], v236 offset:8192
    v_mfma_f32_16x16x32_bf16 v[24:27], v[88:91], v[104:107], v[24:27]
    ds_read_b64_tr_b16 v[68:69], v232 offset:12288
    v_mfma_f32_16x16x32_bf16 v[24:27], v[92:95], v[108:111], v[24:27]
    ds_read_b64_tr_b16 v[70:71], v236 offset:12288
    v_mfma_f32_16x16x32_bf16 v[40:43], v[92:95], v[124:127], v[40:43]
    ds_read_b64_tr_b16 v[72:73], v232 offset:16384
    v_mfma_f32_16x16x32_bf16 v[40:43], v[88:91], v[120:123], v[40:43]
    ds_read_b64_tr_b16 v[74:75], v236 offset:16384
    v_mfma_f32_16x16x32_bf16 v[40:43], v[84:87], v[116:119], v[40:43]
    ds_read_b64_tr_b16 v[76:77], v232 offset:20480
    v_mfma_f32_16x16x32_bf16 v[40:43], v[80:83], v[112:115], v[40:43]
    ds_read_b64_tr_b16 v[78:79], v236 offset:20480
    s_waitcnt lgkmcnt(8)
    v_mfma_f32_16x16x32_bf16 v[44:47], v[48:51], v[112:115], v[44:47]
    ds_read_b64_tr_b16 v[80:81], v233 offset:8192
    v_mfma_f32_16x16x32_bf16 v[44:47], v[52:55], v[116:119], v[44:47]
    ds_read_b64_tr_b16 v[82:83], v237 offset:8192
    v_mfma_f32_16x16x32_bf16 v[44:47], v[56:59], v[120:123], v[44:47]
    ds_read_b64_tr_b16 v[84:85], v233 offset:12288
    v_mfma_f32_16x16x32_bf16 v[44:47], v[60:63], v[124:127], v[44:47]
    ds_read_b64_tr_b16 v[86:87], v237 offset:12288
    v_mfma_f32_16x16x32_bf16 v[28:31], v[60:63], v[108:111], v[28:31]
    ds_read_b64_tr_b16 v[88:89], v233 offset:16384
    v_mfma_f32_16x16x32_bf16 v[28:31], v[56:59], v[104:107], v[28:31]
    ds_read_b64_tr_b16 v[90:91], v237 offset:16384
    v_mfma_f32_16x16x32_bf16 v[28:31], v[52:55], v[100:103], v[28:31]
    ds_read_b64_tr_b16 v[92:93], v233 offset:20480
    v_mfma_f32_16x16x32_bf16 v[28:31], v[48:51], v[96:99], v[28:31]
    ds_read_b64_tr_b16 v[94:95], v237 offset:20480
    s_waitcnt vmcnt(0) lgkmcnt(8)
    v_mfma_f32_16x16x32_bf16 v[16:19], v[64:67], v[128:131], v[16:19]
    ds_read_b32 v223, v10 offset:40
    ds_read_b64_tr_b16 v[48:49], v234 offset:8192
    v_mfma_f32_16x16x32_bf16 v[16:19], v[68:71], v[132:135], v[16:19]
    ds_read_b64_tr_b16 v[50:51], v238 offset:8192
    v_mfma_f32_16x16x32_bf16 v[16:19], v[72:75], v[136:139], v[16:19]
    ds_read_b64_tr_b16 v[52:53], v234 offset:12288
    v_mfma_f32_16x16x32_bf16 v[16:19], v[76:79], v[140:143], v[16:19]
    ds_read_b64_tr_b16 v[54:55], v238 offset:12288
    v_mfma_f32_16x16x32_bf16 v[32:35], v[76:79], v[156:159], v[32:35]
    ds_read_b64_tr_b16 v[56:57], v234 offset:16384
    v_mfma_f32_16x16x32_bf16 v[32:35], v[72:75], v[152:155], v[32:35]
    ds_read_b64_tr_b16 v[58:59], v238 offset:16384
    v_mfma_f32_16x16x32_bf16 v[32:35], v[68:71], v[148:151], v[32:35]
    ds_read_b64_tr_b16 v[60:61], v234 offset:20480
    v_mfma_f32_16x16x32_bf16 v[32:35], v[64:67], v[144:147], v[32:35]
    ds_read_b64_tr_b16 v[62:63], v238 offset:20480
    s_waitcnt lgkmcnt(9)
    v_mfma_f32_16x16x32_bf16 v[36:39], v[80:83], v[144:147], v[36:39]
    ds_read_b64_tr_b16 v[64:65], v235 offset:8192
    v_mfma_f32_16x16x32_bf16 v[36:39], v[84:87], v[148:151], v[36:39]
    ds_read_b64_tr_b16 v[66:67], v239 offset:8192
    v_mfma_f32_16x16x32_bf16 v[36:39], v[88:91], v[152:155], v[36:39]
    ds_read_b64_tr_b16 v[68:69], v235 offset:12288
    v_mfma_f32_16x16x32_bf16 v[36:39], v[92:95], v[156:159], v[36:39]
    ds_read_b64_tr_b16 v[70:71], v239 offset:12288
    v_mfma_f32_16x16x32_bf16 v[20:23], v[92:95], v[140:143], v[20:23]
    ds_read_b64_tr_b16 v[72:73], v235 offset:16384
    v_mfma_f32_16x16x32_bf16 v[20:23], v[88:91], v[136:139], v[20:23]
    ds_read_b64_tr_b16 v[74:75], v239 offset:16384
    v_mfma_f32_16x16x32_bf16 v[20:23], v[84:87], v[132:135], v[20:23]
    ds_read_b64_tr_b16 v[76:77], v235 offset:20480
    v_mfma_f32_16x16x32_bf16 v[20:23], v[80:83], v[128:131], v[20:23]
    ds_read_b64_tr_b16 v[78:79], v239 offset:20480
    s_waitcnt lgkmcnt(14)
    v_cmp_gt_u32 vcc, 4, v223
    s_cbranch_vccnz LB_w7
LB_g7:
    v_mfma_f32_16x16x32_bf16 v[24:27], v[48:51], v[128:131], v[24:27]
    s_nop 1
    v_cvt_pk_bf16_f32 v200, v32, v33
    s_waitcnt lgkmcnt(12)
    v_mfma_f32_16x16x32_bf16 v[24:27], v[52:55], v[132:135], v[24:27]
    v_cvt_pk_bf16_f32 v201, v34, v35
    v_cvt_pk_bf16_f32 v202, v36, v37
    s_waitcnt lgkmcnt(10)
    v_mfma_f32_16x16x32_bf16 v[24:27], v[56:59], v[136:139], v[24:27]
    v_cvt_pk_bf16_f32 v203, v38, v39
    v_permlane16_swap_b32 v200, v202
    s_waitcnt lgkmcnt(8)
    v_mfma_f32_16x16x32_bf16 v[24:27], v[60:63], v[140:143], v[24:27]
    v_permlane16_swap_b32 v201, v203
    ds_write_b128 v248, v[200:203] offset:2048
    v_mfma_f32_16x16x32_bf16 v[40:43], v[60:63], v[156:159], v[40:43]
    v_cvt_pk_bf16_f32 v192, v16, v17
    v_cvt_pk_bf16_f32 v193, v18, v19
    v_mfma_f32_16x16x32_bf16 v[40:43], v[56:59], v[152:155], v[40:43]
    v_cvt_pk_bf16_f32 v194, v20, v21
    v_cvt_pk_bf16_f32 v195, v22, v23
    v_mfma_f32_16x16x32_bf16 v[40:43], v[52:55], v[148:151], v[40:43]
    v_permlane16_swap_b32 v192, v194
    v_permlane16_swap_b32 v193, v195
    v_mfma_f32_16x16x32_bf16 v[40:43], v[48:51], v[144:147], v[40:43]
    ds_write_b128 v248, v[192:195] offset:0
    v_cvt_pk_bf16_f32 v196, v24, v25
    s_waitcnt lgkmcnt(8)
    v_mfma_f32_16x16x32_bf16 v[44:47], v[64:67], v[144:147], v[44:47]
    v_cvt_pk_bf16_f32 v197, v26, v27
    s_nop 0
    s_waitcnt lgkmcnt(6)
    v_mfma_f32_16x16x32_bf16 v[44:47], v[68:71], v[148:151], v[44:47]
    s_nop 1
    s_waitcnt lgkmcnt(4)
    v_mfma_f32_16x16x32_bf16 v[44:47], v[72:75], v[152:155], v[44:47]
    v_cvt_pk_bf16_f32 v204, v40, v41
    v_cvt_pk_bf16_f32 v205, v42, v43
    s_waitcnt lgkmcnt(2)
    v_mfma_f32_16x16x32_bf16 v[44:47], v[76:79], v[156:159], v[44:47]
    s_nop 1
    v_mfma_f32_16x16x32_bf16 v[28:31], v[76:79], v[140:143], v[28:31]
    s_nop 1
    v_mfma_f32_16x16x32_bf16 v[28:31], v[72:75], v[136:139], v[28:31]
    s_nop 1
    v_mfma_f32_16x16x32_bf16 v[28:31], v[68:71], v[132:135], v[28:31]
    v_cvt_pk_bf16_f32 v206, v44, v45
    v_cvt_pk_bf16_f32 v207, v46, v47
    v_mfma_f32_16x16x32_bf16 v[28:31], v[64:67], v[128:131], v[28:31]
    v_permlane16_swap_b32 v204, v206
    v_permlane16_swap_b32 v205, v207
    ds_write_b128 v249, v[204:207] offset:2048
    ds_read_b128 v[184:187], v250 offset:2048
    ds_read_b128 v[188:191], v250 offset:3072
    s_nop 2
    v_cvt_pk_bf16_f32 v198, v28, v29
    v_cvt_pk_bf16_f32 v199, v30, v31
    s_nop 0
    v_permlane16_swap_b32 v196, v198
    v_permlane16_swap_b32 v197, v199
    ds_write_b128 v249, v[196:199] offset:0
    ds_read_b128 v[176:179], v250 offset:0
    ds_read_b128 v[180:183], v250 offset:1024
    s_mov_b32 s95, 65536
    s_waitcnt lgkmcnt(4)
    buffer_store_dwordx4 v[184:187], v246, s[60:63], s95 offen nt sc1
    s_mov_b32 s95, 98304
    s_waitcnt lgkmcnt(3)
    buffer_store_dwordx4 v[188:191], v246, s[60:63], s95 offen nt sc1
    s_mov_b32 s95, 0
    s_waitcnt lgkmcnt(1)
    buffer_store_dwordx4 v[176:179], v246, s[60:63], s95 offen nt sc1
    s_mov_b32 s95, 32768
    s_waitcnt lgkmcnt(0)
    buffer_store_dwordx4 v[180:183], v246, s[60:63], s95 offen nt sc1
    s_endpgm
LA_slow:
    s_mov_b32 s79, 0
LA_slow1:
    s_mov_b64 exec, vcc
    s_sleep 8
    buffer_load_dword v136, v33, s[68:71], 0 offen sc1
    buffer_load_dword v137, v34, s[52:55], 0 offen sc1
    s_add_u32 s79, s79, 1
    s_cmp_gt_u32 s79, 200000
    s_waitcnt vmcnt(0)
    s_cbranch_scc1 LA_back
    v_cmp_ne_u32 vcc, v136, v137
    v_cmp_gt_u32 s[80:81], s96, v136
    s_nop 0
    s_or_b64 vcc, vcc, s[80:81]
    s_cbranch_vccnz LA_slow1
    s_branch LA_back
LB_tag:
    s_mov_b64 exec, 0xffff
    s_waitcnt vmcnt(0)
    v_lshrrev_b32 v251, v0, v251
    v_and_b32 v251, 1, v251
    v_cmp_eq_u32 vcc, 0, v251
    s_nop 1
    s_or_b32 s83, vcc_lo, 0x10000
    s_mov_b64 exec, 1
    v_mov_b32 v251, s83
    buffer_store_dword v251, v220, s[68:71], s98 offen sc1
    s_mov_b64 exec, -1
    s_branch LB_tagb
LB_slow:
    s_mov_b32 s79, 0
LB_pt:
    buffer_load_dword v222, v220, s[68:71], s98 offen sc1
    s_add_u32 s79, s79, 1
    s_cmp_gt_u32 s79, 200000
    s_cbranch_scc1 LB_pt_x
    s_waitcnt vmcnt(0)
    v_cmp_gt_u32 vcc, 4096, v222
    s_cbranch_vccz LB_pt_x
    s_mov_b64 exec, vcc
    s_sleep 8
    s_branch LB_pt
LB_pt_x:
    s_waitcnt vmcnt(0)
    s_branch LB_back
LB_w1:
    s_branch LB_s1_in
LB_s1:
    s_sleep 1
LB_s1_in:
    ds_read_b32 v223, v10 offset:0
    ds_read_b64 v[204:205], v218
    ds_read_b64 v[206:207], v219
    s_waitcnt lgkmcnt(0)
    v_readfirstlane_b32 s78, v223
    s_nop 0
    s_cmp_ge_u32 s78, 4
    s_cbranch_scc0 LB_s1
    s_branch LB_g1
LB_w6:
    s_branch LB_s6_in
LB_s6:
    s_sleep 1
LB_s6_in:
    ds_read_b32 v223, v10 offset:24
    ds_read_b64 v[224:225], v218 offset:1024
    ds_read_b64 v[234:235], v219 offset:1024
    s_waitcnt lgkmcnt(0)
    v_readfirstlane_b32 s78, v223
    s_nop 0
    s_cmp_ge_u32 s78, 4
    s_cbranch_scc0 LB_s6
    s_branch LB_g6
LB_w4:
    s_branch LB_s4_in
LB_s4:
    s_sleep 1
LB_s4_in:
    ds_read_b32 v222, v10 offset:16
    s_waitcnt lgkmcnt(0)
    v_readfirstlane_b32 s78, v222
    s_nop 0
    s_cmp_ge_u32 s78, 4
    s_cbranch_scc0 LB_s4
    s_branch LB_g4
LB_w8:
    s_branch LB_s8_in
LB_s8:
    s_sleep 1
LB_s8_in:
    ds_read_b32 v223, v10 offset:32
    s_waitcnt lgkmcnt(0)
    v_readfirstlane_b32 s78, v223
    s_nop 0
    s_cmp_ge_u32 s78, 4
    s_cbranch_scc0 LB_s8
    s_branch LB_g8
LB_w7:
    s_branch LB_s7_in
LB_s7:
    s_sleep 1
LB_s7_in:
    ds_read_b32 v223, v10 offset:40
    s_waitcnt lgkmcnt(0)
    v_readfirstlane_b32 s78, v223
    s_nop 0
    s_cmp_ge_u32 s78, 4
    s_cbranch_scc0 LB_s7
    s_branch LB_g7
L_end:
    s_endpgm
.section .rodata,"a"
.p2align 6
.amdhsa_kernel concat_heads__ssm_conv_h3__sliding_local_dilated__prompt_kernel
  .amdhsa_next_free_vgpr 256
  .amdhsa_next_free_sgpr 102
  .amdhsa_accum_offset 256
  .amdhsa_group_segment_fixed_size 0
  .amdhsa_kernarg_size 96
  .amdhsa_user_sgpr_count 2
  .amdhsa_user_sgpr_kernarg_segment_ptr 1
  .amdhsa_system_sgpr_workgroup_id_x 1
.end_amdhsa_kernel
```

```asm
; @launch grid=(256,1,1) block=(512,1,1) lds=163840
.amdgcn_target "amdgcn-amd-amdhsa--gfx950"
.text
.globl concat_heads__ssm_conv_h3__sliding_local_dilated__prompt_kernel
.p2align 8
.type concat_heads__ssm_conv_h3__sliding_local_dilated__prompt_kernel,@function
concat_heads__ssm_conv_h3__sliding_local_dilated__prompt_kernel:
    s_cmp_ge_u32 s2, 256
    s_cbranch_scc1 L_end
    s_load_dwordx2 s[28:29], s[0:1], 48
    s_load_dwordx2 s[32:33], s[0:1], 56
    s_load_dwordx8 s[4:11], s[0:1], 0
    s_load_dwordx4 s[12:15], s[0:1], 32
    s_load_dwordx8 s[20:27], s[0:1], 64
    v_lshrrev_b32 v1, 6, v0
    v_and_b32 v0, 63, v0
    v_readfirstlane_b32 s3, v1
    s_nop 0
    s_cmp_lg_u32 s3, 4
    s_cbranch_scc1 L_nopf
    s_getpc_b64 s[80:81]
L_pc:
    s_bfe_u32 s78, s2, 0x40003
    v_lshl_add_u32 v1, v0, 4, s78
    v_lshlrev_b32 v1, 7, v1
    v_cmp_gt_u32 vcc, L_end-L_pc, v1
    s_nop 0
    s_and_saveexec_b64 s[82:83], vcc
    global_load_dword v222, v1, s[80:81]
    s_mov_b64 exec, -1
L_nopf:
    s_and_b32 s78, s2, 7
    s_lshr_b32 s79, s2, 3
    s_and_b32 s80, s78, 1
    s_lshl_b32 s80, s80, 3
    s_lshr_b32 s81, s78, 1
    s_lshl_b32 s81, s81, 2
    s_and_b32 s72, s79, 7
    s_add_u32 s72, s72, s80
    s_lshr_b32 s73, s79, 3
    s_xor_b32 s73, s73, 3
    s_add_u32 s73, s73, s81
    s_cmp_ge_u32 s3, 4
    s_cbranch_scc1 L_B
    v_lshrrev_b32 v5, 3, v0
    v_and_b32 v6, 7, v0
    v_lshrrev_b32 v7, 4, v0
    s_lshl_b32 s79, s72, 7
    s_lshl_b32 s80, s3, 5
    s_add_u32 s81, s79, s80
    v_xor_b32 v8, v7, v6
    v_lshlrev_b32 v8, 4, v8
    v_add_u32 v240, s81, v5
    v_lshl_add_u32 v240, v240, 11, v8
    v_xor_b32 v241, 64, v240
    v_add_u32 v241, 15360, v241
    v_add_u32 v242, 30720, v240
    v_add_u32 v243, 30720, v241
    s_lshl_b32 s87, s3, 12
    s_add_u32 s87, s87, 75776
    s_and_b32 s98, s73, 12
    s_and_b32 s78, s72, 8
    s_add_u32 s98, s98, s78
    s_add_u32 s101, s72, s73
    s_and_b32 s101, s101, 3
    s_lshl_b32 s78, s101, 2
    s_lshr_b32 s97, 0x101, s78
    s_add_u32 s97, s97, s98
    s_and_b32 s97, s97, 15
    s_mov_b32 m0, s87
    s_lshl_b32 s97, s97, 7
    s_mov_b32 s30, 0x400000
    s_mov_b32 s31, 0x20000
    s_waitcnt lgkmcnt(0)
    buffer_load_dwordx4 v240, s[28:31], s97 offen offset:0  lds
    s_and_b32 s78, s3, 1
    s_lshl_b32 s78, s78, 2
    s_lshl_b32 s80, s3, 3
    v_and_b32 v8, 1, v7
    v_lshl_or_b32 v8, v8, 1, s78
    v_xor_b32 v8, v8, v6
    buffer_load_dwordx4 v241, s[28:31], s97 offen offset:1024  lds
    v_lshlrev_b32 v8, 4, v8
    v_add_u32 v244, s80, v5
    v_mul_u32_u24 v244, 6144, v244
    s_lshl_b32 s82, s73, 7
    v_add3_u32 v244, v244, v8, s82
    buffer_load_dwordx4 v242, s[28:31], s97 offen offset:2048  lds
    v_add_u32 v245, 1024, v244
    v_add_u32 v246, 2048, v244
    s_bfe_u32 s62, s72, 0x10002
    s_mul_i32 s78, s62, 12288
    s_mul_i32 s80, s3, 3072
    s_add_u32 s60, s80, s78
    buffer_load_dwordx4 v243, s[28:31], s97 offen offset:3072  lds
    s_sub_u32 s61, s80, s78
    s_mul_i32 s62, s62, 196608
    s_sub_u32 s63, 196608, s62
    s_mov_b32 s34, 0x600000
    s_mov_b32 s35, 0x20000
    s_mul_i32 s16, s97, 3072
    s_add_u32 m0, s60, 0
    s_add_u32 s99, s16, s62
    buffer_load_dwordx4 v244, s[32:35], s99 offen offset:0  lds
    s_lshl_b32 s78, s3, 1
    s_lshl_b32 s80, s3, 2
    s_add_u32 s79, s79, s80
    s_sub_u32 s79, s79, 16
    v_add_u32 v8, s78, v7
    buffer_load_dwordx4 v245, s[32:35], s99 offen offset:1024  lds
    v_xor_b32 v8, v8, v6
    v_and_b32 v8, 7, v8
    v_lshlrev_b32 v8, 4, v8
    v_add_u32 v3, s79, v5
    buffer_load_dwordx4 v246, s[32:35], s99 offen offset:2048  lds
    v_lshl_add_u32 v3, v3, 11, v8
    s_lshl_b32 s86, s3, 10
    s_lshl_b32 s88, s3, 9
    s_add_u32 s88, s88, 73728
    s_add_u32 m0, s88, 0
    s_mov_b64 exec, 0xffffffff
    buffer_load_dwordx4 v3, s[28:31], s97 offen offset:0  lds
    s_mov_b64 exec, -1
    s_add_u32 m0, s61, 12288
    s_add_u32 s16, s16, s63
    buffer_load_dwordx4 v244, s[32:35], s16 offen offset:0  lds
    buffer_load_dwordx4 v245, s[32:35], s16 offen offset:1024  lds
    buffer_load_dwordx4 v246, s[32:35], s16 offen offset:2048  lds
    s_mov_b32 s0, 0x76583240
    s_mov_b32 s1, 0xfedba9c
    s_cmp_eq_u32 s101, 1
    s_cselect_b32 s0, 0x76943251, s0
    s_cselect_b32 s1, 0xfecbda8, s1
    s_cmp_eq_u32 s101, 2
    s_cselect_b32 s0, 0x7a543602, s0
    s_cselect_b32 s1, 0xfdceb98, s1
    s_cmp_eq_u32 s101, 3
    s_cselect_b32 s0, 0xb6547213, s0
    s_cselect_b32 s1, 0xedfca98, s1
    s_and_b32 s78, s73, 7
    s_cmp_lg_u32 s78, 3
    s_cbranch_scc1 LA_nb
    s_cmp_eq_u32 s101, 2
    s_cselect_b32 s0, 0x87654302, s0
    s_cselect_b32 s1, 0xfdceba9, s1
    s_cmp_eq_u32 s101, 3
    s_cselect_b32 s0, 0x87654213, s0
    s_cselect_b32 s1, 0xedfcba9, s1
LA_nb:
    s_add_u32 s79, s72, s73
    s_add_u32 s78, s72, 5
    s_and_b32 s78, s78, 7
    s_lshl_b32 s78, s78, 1
    s_and_b32 s75, s79, 1
    s_add_u32 s78, s78, s75
    s_andn2_b32 s79, 2, s79
    s_lshl_b32 s79, s79, 3
    s_add_u32 s78, s78, s79
    s_and_b32 s76, s78, 3
    s_and_b32 s79, s73, 12
    s_add_u32 s76, s76, s79
    s_lshr_b32 s74, s78, 4
    s_add_u32 s74, s74, s79
    s_and_b32 s79, s72, 8
    s_lshr_b32 s77, s78, 2
    s_add_u32 s77, s77, s79
    s_lshr_b32 s79, s79, 2
    s_add_u32 s74, s74, s79
    s_xor_b32 s74, s74, 4
    s_and_b32 s75, s78, 15
    s_add_u32 s97, s98, s0
    s_lshr_b64 s[0:1], s[0:1], 4
    s_and_b32 s97, s97, 15
    s_add_u32 m0, s87, 18432
    s_lshl_b32 s97, s97, 7
    buffer_load_dwordx4 v240, s[28:31], s97 offen offset:0  lds
    s_mov_b32 s36, s6
    s_mov_b32 s37, s7
    s_mov_b32 s38, 0x400000
    s_mov_b32 s39, 0x20000
    s_mov_b32 s40, s8
    s_mov_b32 s41, s9
    s_mov_b32 s42, 0x400000
    s_mov_b32 s43, 0x20000
    s_mov_b32 s44, s10
    s_mov_b32 s45, s11
    s_mov_b32 s46, 0x2000
    s_mov_b32 s47, 0x20000
    v_lshlrev_b32 v15, 4, v0
    v_and_b32 v7, 7, v0
    s_lshl_b32 s79, s74, 7
    v_lshl_add_u32 v7, v7, 4, s79
    s_lshl_b32 s78, s75, 7
    s_lshl_b32 s80, s3, 3
    s_add_u32 s80, s80, s78
    v_lshrrev_b32 v5, 3, v0
    s_and_b32 s79, s3, 1
    v_xor_b32 v5, s79, v5
    v_add_u32 v5, s80, v5
    v_lshl_add_u32 v10, v5, 11, v7
    s_xor_b32 s80, s3, 1
    s_add_u32 s80, s78, s80
    s_sub_u32 s80, s80, 4
    s_lshl_b32 s80, s80, 11
    v_add_u32 v11, s80, v7
    s_mov_b32 s52, s26
    s_mov_b32 s53, s27
    s_mov_b32 s54, 0x1800000
    s_mov_b32 s55, 0x20000
    v_and_b32 v7, 7, v0
    s_lshl_b32 s79, s74, 7
    v_lshl_add_u32 v7, v7, 4, s79
    s_lshl_b32 s78, s75, 7
    v_bfe_u32 v5, v0, 3, 2
    v_lshrrev_b32 v6, 5, v0
    s_lshl_b32 s80, s3, 5
    v_lshlrev_b32 v8, 3, v5
    v_lshl_add_u32 v8, v6, 2, v8
    v_add_u32 v8, s80, v8
    v_and_b32 v35, 7, v0
    v_lshl_add_u32 v16, v35, 1, v6
    v_lshlrev_b32 v232, 5, v16
    v_lshlrev_b32 v16, 3, v16
    v_lshl_add_u32 v16, v5, 10, v16
    v_and_b32 v231, 1, v5
    v_lshl_add_u32 v16, v231, 7, v16
    s_lshl_b32 s79, s3, 12
    s_add_u32 s79, s79, 129024
    v_add_u32 v16, s79, v16
    v_xor_b32 v231, 128, v16
    v_lshrrev_b32 v35, 2, v35
    v_lshl_add_u32 v35, v35, 4, v232
    v_add_u32 v35, 162816, v35
    v_add_u32 v8, s78, v8
    v_lshl_add_u32 v9, v8, 11, v7
    v_lshl_add_u32 v13, v8, 12, v7
    v_bfe_u32 v8, v0, 2, 1
    v_lshlrev_b32 v8, 1, v8
    v_add_u32 v8, v8, v6
    v_lshlrev_b32 v8, 16, v8
    v_lshl_add_u32 v8, v5, 6, v8
    v_and_b32 v7, 3, v0
    v_lshl_add_u32 v8, v7, 4, v8
    s_add_u32 s78, s78, s80
    s_lshl_b32 s78, s78, 3
    s_lshl_b32 s79, s74, 18
    s_add_u32 s78, s78, s79
    v_add_u32 v12, s78, v8
    s_mov_b32 s48, s12
    s_mov_b32 s49, s13
    s_mov_b32 s50, 0x400000
    s_mov_b32 s51, 0x20000
    s_mov_b32 s56, s4
    s_mov_b32 s57, s5
    s_mov_b32 s58, 0x400000
    s_mov_b32 s59, 0x20000
    s_mov_b32 s64, s20
    s_mov_b32 s65, s21
    s_mov_b32 s66, 0x200000
    s_mov_b32 s67, 0x20000
    s_lshl_b32 s91, s74, 4
    s_add_u32 s91, s91, s75
    s_lshr_b32 s78, s91, 3
    s_lshl_b32 s78, s78, 5
    s_and_b32 s79, s91, 7
    s_add_u32 s78, s78, s79
    s_lshl_b32 s79, s3, 3
    s_add_u32 s90, s78, s79
    s_lshl_b32 s91, s91, 14
    s_mov_b32 s96, 4096
    s_mul_i32 s94, s3, 8320
    s_add_u32 s94, s94, 129024
    v_mov_b32 v229, 0
    s_mov_b64 s[4:5], s[64:65]
    s_mov_b32 s6, 0x0
    s_mov_b32 s7, 0x20000
    v_mov_b32 v228, 0x40000000
    s_bitcmp1_b32 s73, 2
    s_cbranch_scc1 LA_nh0
    s_mov_b64 s[4:5], s[28:29]
    s_mov_b32 s6, 0x400000
    v_mov_b32 v229, 0x40000000
    s_and_b32 s78, s73, 3
    s_cmp_eq_u32 s78, 3
    s_cbranch_scc1 LA_nh0
    s_and_b32 s79, s101, 2
    s_add_u32 s78, s72, 1
    s_add_u32 s78, s78, s79
    s_and_b32 s78, s78, 3
    s_bfe_u32 s80, s72, 0x10002
    s_and_b32 s81, s101, 1
    s_lshl_b32 s81, s81, 2
    s_add_u32 s81, s81, s79
    s_lshl_b32 s82, s78, 1
    s_cmp_lt_u32 s78, 2
    s_cselect_b32 s79, 12, 24
    s_cselect_b32 s82, s82, 0
    s_cselect_b32 s83, 6, 7
    s_add_u32 s81, s81, s83
    s_add_u32 s80, s80, s82
    s_lshl_b32 s80, s80, 2
    s_add_u32 s80, s80, s3
    s_mul_i32 s80, s80, s79
    s_add_u32 s82, s81, s78
    s_add_u32 s81, s81, s98
    s_and_b32 s81, s81, 15
    s_mul_i32 s81, s81, 192
    s_add_u32 s80, s80, s81
    s_or_b32 s81, s73, 3
    s_lshl_b32 s81, s81, 7
    v_add_u32 v5, s80, v0
    v_lshl_add_u32 v5, v5, 11, s81
    v_cmp_gt_u32 vcc, s79, v0
    s_nop 1
    v_cndmask_b32 v228, v228, v5, vcc
    s_cmp_ge_u32 s78, 2
    s_cbranch_scc1 LA_nh0
    s_add_u32 s82, s82, s98
    s_and_b32 s82, s82, 15
    s_lshl_b32 s78, s82, 7
    s_lshl_b32 s79, s72, 7
    s_mul_i32 s80, s3, 36
    s_add_u32 s79, s79, s80
    s_sub_u32 s79, s79, 16
    v_add_u32 v5, s79, v0
    v_lshl_add_u32 v5, v5, 11, s78
    v_cmp_gt_u32 vcc, 36, v0
    s_nop 1
    v_cndmask_b32 v229, v229, v5, vcc
LA_nh0:
    buffer_load_dwordx4 v241, s[28:31], s97 offen offset:1024  lds
    buffer_load_dwordx4 v242, s[28:31], s97 offen offset:2048  lds
    buffer_load_dwordx4 v243, s[28:31], s97 offen offset:3072  lds
    s_add_u32 m0, s88, 18432
    s_mov_b64 exec, 0xffffffff
    buffer_load_dwordx4 v3, s[28:31], s97 offen offset:0  lds
    s_mov_b64 exec, -1
    s_mul_i32 s16, s97, 3072
    s_add_u32 m0, s60, 24576
    s_add_u32 s99, s16, s62
    buffer_load_dwordx4 v244, s[32:35], s99 offen offset:0  lds
    buffer_load_dwordx4 v245, s[32:35], s99 offen offset:1024  lds
    buffer_load_dwordx4 v246, s[32:35], s99 offen offset:2048  lds
    s_add_u32 m0, s61, 36864
    s_add_u32 s16, s16, s63
    buffer_load_dwordx4 v244, s[32:35], s16 offen offset:0  lds
    buffer_load_dwordx4 v245, s[32:35], s16 offen offset:1024  lds
    buffer_load_dwordx4 v246, s[32:35], s16 offen offset:2048  lds
    s_waitcnt vmcnt(11)
    s_barrier
    s_add_u32 s97, s98, s0
    s_lshr_b64 s[0:1], s[0:1], 4
    s_and_b32 s97, s97, 15
    s_add_u32 m0, s87, 36864
    s_lshl_b32 s97, s97, 7
    buffer_load_dwordx4 v240, s[28:31], s97 offen offset:0  lds
    buffer_load_dwordx4 v241, s[28:31], s97 offen offset:1024  lds
    s_cmp_eq_u32 s101, 1
    s_cbranch_scc1 LA_c1
    s_cmp_eq_u32 s101, 2
    s_cbranch_scc1 LA_c2
    s_cmp_eq_u32 s101, 3
    s_cbranch_scc1 LA_c3
LA_c0:
    s_waitcnt vmcnt(8)
    s_barrier
    buffer_load_dwordx4 v242, s[28:31], s97 offen offset:2048  lds
    buffer_load_dwordx4 v243, s[28:31], s97 offen offset:3072  lds
    s_add_u32 m0, s88, 36864
    s_mov_b64 exec, 0xffffffff
    buffer_load_dwordx4 v3, s[28:31], s97 offen offset:0  lds
    s_mov_b64 exec, -1
    s_mul_i32 s16, s97, 3072
    s_add_u32 m0, s60, 49152
    s_add_u32 s99, s16, s62
    buffer_load_dwordx4 v244, s[32:35], s99 offen offset:0  lds
    buffer_load_dwordx4 v245, s[32:35], s99 offen offset:1024  lds
    buffer_load_dwordx4 v246, s[32:35], s99 offen offset:2048  lds
    s_add_u32 m0, s61, 61440
    s_add_u32 s16, s16, s63
    buffer_load_dwordx4 v244, s[32:35], s16 offen offset:0  lds
    buffer_load_dwordx4 v245, s[32:35], s16 offen offset:1024  lds
    buffer_load_dwordx4 v246, s[32:35], s16 offen offset:2048  lds
    s_add_u32 s97, s98, s0
    s_lshr_b64 s[0:1], s[0:1], 4
    s_and_b32 s97, s97, 15
    s_add_u32 m0, s87, 0
    s_lshl_b32 s97, s97, 7
    buffer_load_dwordx4 v240, s[28:31], s97 offen offset:0  lds
    buffer_load_dwordx4 v241, s[28:31], s97 offen offset:1024  lds
    buffer_load_dwordx4 v242, s[28:31], s97 offen offset:2048  lds
    buffer_load_dwordx4 v243, s[28:31], s97 offen offset:3072  lds
    s_add_u32 m0, s88, 0
    s_mov_b64 exec, 0xffffffff
    buffer_load_dwordx4 v3, s[28:31], s97 offen offset:0  lds
    s_mov_b64 exec, -1
    s_waitcnt vmcnt(11)
    s_barrier
    s_mul_i32 s16, s97, 3072
    s_add_u32 m0, s60, 0
    s_add_u32 s99, s16, s62
    buffer_load_dwordx4 v244, s[32:35], s99 offen offset:0  lds
    buffer_load_dwordx4 v245, s[32:35], s99 offen offset:1024  lds
    buffer_load_dwordx4 v246, s[32:35], s99 offen offset:2048  lds
    s_add_u32 m0, s61, 12288
    s_add_u32 s16, s16, s63
    buffer_load_dwordx4 v244, s[32:35], s16 offen offset:0  lds
    buffer_load_dwordx4 v245, s[32:35], s16 offen offset:1024  lds
    buffer_load_dwordx4 v246, s[32:35], s16 offen offset:2048  lds
    s_add_u32 m0, s86, 129536
    s_mov_b32 s89, 0
    buffer_load_dwordx4 v10, s[36:39], s89 offen nt lds
    s_add_u32 m0, s86, 145920
    s_mov_b32 s89, 0
    buffer_load_dwordx4 v10, s[40:43], s89 offen nt lds
    s_add_u32 m0, s86, 133632
    s_mov_b32 s89, 65536
    buffer_load_dwordx4 v10, s[36:39], s89 offen nt lds
    s_add_u32 m0, s86, 150016
    s_mov_b32 s89, 65536
    buffer_load_dwordx4 v10, s[40:43], s89 offen nt lds
    s_add_u32 m0, s86, 137728
    s_mov_b32 s89, 131072
    buffer_load_dwordx4 v10, s[36:39], s89 offen nt lds
    s_add_u32 m0, s86, 154112
    s_mov_b32 s89, 131072
    buffer_load_dwordx4 v10, s[40:43], s89 offen nt lds
    s_add_u32 m0, s86, 141824
    s_mov_b32 s89, 196608
    buffer_load_dwordx4 v10, s[36:39], s89 offen nt lds
    s_add_u32 m0, s86, 158208
    s_mov_b32 s89, 196608
    buffer_load_dwordx4 v10, s[40:43], s89 offen nt lds
    s_mov_b64 exec, 0xff
    s_lshl_b32 s82, s3, 7
    s_add_u32 m0, s82, 129024
    s_mov_b32 s89, 0
    buffer_load_dwordx4 v11, s[36:39], s89 offen nt lds
    s_lshl_b32 s83, s74, 9
    s_add_u32 s83, s83, s82
    s_and_b32 s89, s3, 2
    s_lshl_b32 s89, s89, 3
    s_add_u32 s82, s82, s89
    s_add_u32 m0, s82, 162816
    s_add_u32 s89, s83, 0
    buffer_load_dwordx4 v15, s[44:47], s89 offen  lds
    s_mov_b64 exec, -1
    s_add_u32 s97, s98, s0
    s_lshr_b64 s[0:1], s[0:1], 4
    s_and_b32 s97, s97, 15
    s_add_u32 m0, s87, 18432
    s_lshl_b32 s97, s97, 7
    buffer_load_dwordx4 v240, s[28:31], s97 offen offset:0  lds
    s_waitcnt vmcnt(17)
    s_barrier
    buffer_load_dwordx4 v241, s[28:31], s97 offen offset:1024  lds
    buffer_load_dwordx4 v242, s[28:31], s97 offen offset:2048  lds
    buffer_load_dwordx4 v243, s[28:31], s97 offen offset:3072  lds
    s_add_u32 m0, s88, 18432
    s_mov_b64 exec, 0xffffffff
    buffer_load_dwordx4 v3, s[28:31], s97 offen offset:0  lds
    s_mov_b64 exec, -1
    s_mul_i32 s16, s97, 3072
    s_add_u32 m0, s60, 24576
    s_add_u32 s99, s16, s62
    buffer_load_dwordx4 v244, s[32:35], s99 offen offset:0  lds
    buffer_load_dwordx4 v245, s[32:35], s99 offen offset:1024  lds
    buffer_load_dwordx4 v246, s[32:35], s99 offen offset:2048  lds
    s_add_u32 m0, s61, 36864
    s_add_u32 s16, s16, s63
    buffer_load_dwordx4 v244, s[32:35], s16 offen offset:0  lds
    buffer_load_dwordx4 v245, s[32:35], s16 offen offset:1024  lds
    buffer_load_dwordx4 v246, s[32:35], s16 offen offset:2048  lds
    buffer_load_dword v230, v229, s[4:7], 0 offen
    buffer_load_dword v230, v228, s[32:35], 0 offen
    s_add_u32 s97, s98, s0
    s_lshr_b64 s[0:1], s[0:1], 4
    s_and_b32 s97, s97, 15
    s_add_u32 m0, s87, 36864
    s_lshl_b32 s97, s97, 7
    buffer_load_dwordx4 v240, s[28:31], s97 offen offset:0  lds
    buffer_load_dwordx4 v241, s[28:31], s97 offen offset:1024  lds
    buffer_load_dwordx4 v242, s[28:31], s97 offen offset:2048  lds
    buffer_load_dwordx4 v243, s[28:31], s97 offen offset:3072  lds
    s_waitcnt vmcnt(12)
    s_barrier
    s_add_u32 m0, s88, 36864
    s_mov_b64 exec, 0xffffffff
    buffer_load_dwordx4 v3, s[28:31], s97 offen offset:0  lds
    s_mov_b64 exec, -1
    ds_read_b128 v[84:87], v35 offset:0
    ds_read_b128 v[88:91], v35 offset:16
    s_mul_i32 s16, s97, 3072
    s_add_u32 m0, s60, 49152
    s_add_u32 s99, s16, s62
    buffer_load_dwordx4 v244, s[32:35], s99 offen offset:0  lds
    ds_read_b64 v[40:41], v16 offset:0
    ds_read_b64 v[42:43], v231 offset:256
    buffer_load_dwordx4 v245, s[32:35], s99 offen offset:1024  lds
    ds_read_b64 v[44:45], v16 offset:256
    ds_read_b64 v[46:47], v16 offset:512
    buffer_load_dwordx4 v246, s[32:35], s99 offen offset:2048  lds
    ds_read_b64 v[48:49], v231 offset:512
    s_add_u32 m0, s61, 61440
    s_add_u32 s16, s16, s63
    buffer_load_dwordx4 v244, s[32:35], s16 offen offset:0  lds
    ds_read_b64 v[50:51], v16 offset:768
    ds_read_b64 v[52:53], v231 offset:768
    buffer_load_dwordx4 v245, s[32:35], s16 offen offset:1024  lds
    ds_read_b64 v[54:55], v16 offset:1024
    ds_read_b64 v[56:57], v231 offset:1024
    buffer_load_dwordx4 v246, s[32:35], s16 offen offset:2048  lds
    ds_read_b64 v[58:59], v16 offset:1280
    ds_read_b64 v[60:61], v231 offset:1280
    s_add_u32 s97, s98, s0
    s_lshr_b64 s[0:1], s[0:1], 4
    s_and_b32 s97, s97, 15
    s_add_u32 m0, s87, 0
    s_lshl_b32 s97, s97, 7
    buffer_load_dwordx4 v240, s[28:31], s97 offen offset:0  lds
    ds_read_b64 v[68:69], v16 offset:16896
    buffer_load_dwordx4 v241, s[28:31], s97 offen offset:1024  lds
    ds_read_b64 v[70:71], v231 offset:16896
    ds_read_b64 v[72:73], v16 offset:17152
    buffer_load_dwordx4 v242, s[28:31], s97 offen offset:2048  lds
    ds_read_b64 v[74:75], v231 offset:17152
    ds_read_b64 v[76:77], v16 offset:17408
    buffer_load_dwordx4 v243, s[28:31], s97 offen offset:3072  lds
    ds_read_b64 v[78:79], v231 offset:17408
    ds_read_b64 v[80:81], v16 offset:17664
    s_add_u32 m0, s88, 0
    s_mov_b64 exec, 0xffffffff
    buffer_load_dwordx4 v3, s[28:31], s97 offen offset:0  lds
    s_mov_b64 exec, -1
    ds_read_b64 v[82:83], v231 offset:17664
    s_waitcnt vmcnt(11)
    s_waitcnt lgkmcnt(0)
    s_barrier
    s_mul_i32 s16, s97, 3072
    s_add_u32 m0, s60, 0
    s_add_u32 s99, s16, s62
    buffer_load_dwordx4 v244, s[32:35], s99 offen offset:0  lds
    v_lshlrev_b32 v160, 16, v40
    v_lshlrev_b32 v161, 16, v42
    v_lshlrev_b32 v162, 16, v44
    v_lshlrev_b32 v163, 16, v46
    v_lshlrev_b32 v164, 16, v48
    buffer_load_dwordx4 v245, s[32:35], s99 offen offset:1024  lds
    v_lshlrev_b32 v165, 16, v50
    v_lshlrev_b32 v166, 16, v52
    v_lshlrev_b32 v167, 16, v54
    v_lshlrev_b32 v168, 16, v56
    v_lshlrev_b32 v169, 16, v58
    buffer_load_dwordx4 v246, s[32:35], s99 offen offset:2048  lds
    v_lshlrev_b32 v170, 16, v60
    v_lshlrev_b32 v172, 16, v84
    v_and_b32 v173, 0xffff0000, v84
    v_lshlrev_b32 v174, 16, v85
    v_and_b32 v175, 0xffff0000, v85
    s_add_u32 m0, s61, 12288
    s_add_u32 s16, s16, s63
    buffer_load_dwordx4 v244, s[32:35], s16 offen offset:0  lds
    v_lshlrev_b32 v176, 16, v68
    v_lshlrev_b32 v177, 16, v70
    v_lshlrev_b32 v178, 16, v72
    v_lshlrev_b32 v179, 16, v74
    v_lshlrev_b32 v180, 16, v76
    buffer_load_dwordx4 v245, s[32:35], s16 offen offset:1024  lds
    v_lshlrev_b32 v181, 16, v78
    v_lshlrev_b32 v182, 16, v80
    v_lshlrev_b32 v183, 16, v82
    v_mul_f32 v184, v160, v175
    v_mul_f32 v185, v161, v175
    buffer_load_dwordx4 v246, s[32:35], s16 offen offset:2048  lds
    v_mul_f32 v186, v162, v175
    v_mul_f32 v187, v163, v175
    v_mul_f32 v188, v164, v175
    v_mul_f32 v189, v165, v175
    v_mul_f32 v190, v166, v175
    s_add_u32 s97, s98, s0
    s_lshr_b64 s[0:1], s[0:1], 4
    s_and_b32 s97, s97, 15
    s_add_u32 m0, s87, 18432
    s_lshl_b32 s97, s97, 7
    buffer_load_dwordx4 v240, s[28:31], s97 offen offset:0  lds
    v_mul_f32 v191, v167, v175
    v_fmac_f32 v184, v161, v174
    v_fmac_f32 v185, v162, v174
    v_fmac_f32 v186, v163, v174
    v_fmac_f32 v187, v164, v174
    buffer_load_dwordx4 v241, s[28:31], s97 offen offset:1024  lds
    v_fmac_f32 v188, v165, v174
    v_fmac_f32 v189, v166, v174
    v_fmac_f32 v190, v167, v174
    v_fmac_f32 v191, v168, v174
    v_fmac_f32 v184, v162, v173
    buffer_load_dwordx4 v242, s[28:31], s97 offen offset:2048  lds
    v_fmac_f32 v185, v163, v173
    v_fmac_f32 v186, v164, v173
    v_fmac_f32 v187, v165, v173
    v_fmac_f32 v188, v166, v173
    v_fmac_f32 v189, v167, v173
    buffer_load_dwordx4 v243, s[28:31], s97 offen offset:3072  lds
    v_fmac_f32 v190, v168, v173
    v_fmac_f32 v191, v169, v173
    v_fmac_f32 v184, v163, v172
    v_fmac_f32 v185, v164, v172
    v_fmac_f32 v186, v165, v172
    s_add_u32 m0, s88, 18432
    s_mov_b64 exec, 0xffffffff
    buffer_load_dwordx4 v3, s[28:31], s97 offen offset:0  lds
    s_mov_b64 exec, -1
    v_fmac_f32 v187, v166, v172
    v_fmac_f32 v188, v167, v172
    v_fmac_f32 v189, v168, v172
    v_fmac_f32 v190, v169, v172
    v_fmac_f32 v191, v170, v172
    v_mul_f32 v184, v184, v176
    v_mul_f32 v185, v185, v177
    v_mul_f32 v186, v186, v178
    v_mul_f32 v187, v187, v179
    v_mul_f32 v188, v188, v180
    v_mul_f32 v189, v189, v181
    v_mul_f32 v190, v190, v182
    v_mul_f32 v191, v191, v183
    v_cvt_pk_bf16_f32 v100, v191, v190
    v_cvt_pk_bf16_f32 v101, v189, v188
    v_cvt_pk_bf16_f32 v102, v187, v186
    v_cvt_pk_bf16_f32 v103, v185, v184
    s_mov_b32 s89, 0
    buffer_store_dwordx4 v[100:103], v12, s[52:55], s89 offen sc1
    v_and_b32 v160, 0xffff0000, v40
    v_and_b32 v161, 0xffff0000, v42
    v_and_b32 v162, 0xffff0000, v44
    v_and_b32 v163, 0xffff0000, v46
    v_and_b32 v164, 0xffff0000, v48
    v_and_b32 v165, 0xffff0000, v50
    v_and_b32 v166, 0xffff0000, v52
    v_and_b32 v167, 0xffff0000, v54
    v_and_b32 v168, 0xffff0000, v56
    v_and_b32 v169, 0xffff0000, v58
    v_and_b32 v170, 0xffff0000, v60
    v_lshlrev_b32 v172, 16, v86
    v_and_b32 v173, 0xffff0000, v86
    v_lshlrev_b32 v174, 16, v87
    v_and_b32 v175, 0xffff0000, v87
    v_and_b32 v176, 0xffff0000, v68
    v_and_b32 v177, 0xffff0000, v70
    v_and_b32 v178, 0xffff0000, v72
    v_and_b32 v179, 0xffff0000, v74
    v_and_b32 v180, 0xffff0000, v76
    v_and_b32 v181, 0xffff0000, v78
    v_and_b32 v182, 0xffff0000, v80
    v_and_b32 v183, 0xffff0000, v82
    s_waitcnt vmcnt(12)
    s_barrier
    s_mul_i32 s16, s97, 3072
    s_add_u32 m0, s60, 24576
    s_add_u32 s99, s16, s62
    buffer_load_dwordx4 v244, s[32:35], s99 offen offset:0  lds
    v_mul_f32 v184, v160, v175
    v_mul_f32 v185, v161, v175
    v_mul_f32 v186, v162, v175
    v_mul_f32 v187, v163, v175
    v_mul_f32 v188, v164, v175
    buffer_load_dwordx4 v245, s[32:35], s99 offen offset:1024  lds
    v_mul_f32 v189, v165, v175
    v_mul_f32 v190, v166, v175
    v_mul_f32 v191, v167, v175
    v_fmac_f32 v184, v161, v174
    v_fmac_f32 v185, v162, v174
    buffer_load_dwordx4 v246, s[32:35], s99 offen offset:2048  lds
    v_fmac_f32 v186, v163, v174
    v_fmac_f32 v187, v164, v174
    v_fmac_f32 v188, v165, v174
    v_fmac_f32 v189, v166, v174
    v_fmac_f32 v190, v167, v174
    s_add_u32 m0, s61, 36864
    s_add_u32 s16, s16, s63
    buffer_load_dwordx4 v244, s[32:35], s16 offen offset:0  lds
    v_fmac_f32 v191, v168, v174
    v_fmac_f32 v184, v162, v173
    v_fmac_f32 v185, v163, v173
    v_fmac_f32 v186, v164, v173
    v_fmac_f32 v187, v165, v173
    buffer_load_dwordx4 v245, s[32:35], s16 offen offset:1024  lds
    v_fmac_f32 v188, v166, v173
    v_fmac_f32 v189, v167, v173
    v_fmac_f32 v190, v168, v173
    v_fmac_f32 v191, v169, v173
    v_fmac_f32 v184, v163, v172
    buffer_load_dwordx4 v246, s[32:35], s16 offen offset:2048  lds
    v_fmac_f32 v185, v164, v172
    v_fmac_f32 v186, v165, v172
    v_fmac_f32 v187, v166, v172
    v_fmac_f32 v188, v167, v172
    v_fmac_f32 v189, v168, v172
    s_add_u32 s97, s98, s0
    s_lshr_b64 s[0:1], s[0:1], 4
    s_and_b32 s97, s97, 15
    s_add_u32 m0, s87, 36864
    s_lshl_b32 s97, s97, 7
    buffer_load_dwordx4 v240, s[28:31], s97 offen offset:0  lds
    v_fmac_f32 v190, v169, v172
    v_fmac_f32 v191, v170, v172
    v_mul_f32 v184, v184, v176
    v_mul_f32 v185, v185, v177
    v_mul_f32 v186, v186, v178
    buffer_load_dwordx4 v241, s[28:31], s97 offen offset:1024  lds
    v_mul_f32 v187, v187, v179
    v_mul_f32 v188, v188, v180
    v_mul_f32 v189, v189, v181
    v_mul_f32 v190, v190, v182
    v_mul_f32 v191, v191, v183
    buffer_load_dwordx4 v242, s[28:31], s97 offen offset:2048  lds
    v_cvt_pk_bf16_f32 v104, v191, v190
    v_cvt_pk_bf16_f32 v105, v189, v188
    v_cvt_pk_bf16_f32 v106, v187, v186
    v_cvt_pk_bf16_f32 v107, v185, v184
    s_mov_b32 s89, 16384
    buffer_store_dwordx4 v[104:107], v12, s[52:55], s89 offen sc1
    buffer_load_dwordx4 v243, s[28:31], s97 offen offset:3072  lds
    v_lshlrev_b32 v160, 16, v41
    v_lshlrev_b32 v161, 16, v43
    v_lshlrev_b32 v162, 16, v45
    v_lshlrev_b32 v163, 16, v47
    v_lshlrev_b32 v164, 16, v49
    s_add_u32 m0, s88, 36864
    s_mov_b64 exec, 0xffffffff
    buffer_load_dwordx4 v3, s[28:31], s97 offen offset:0  lds
    s_mov_b64 exec, -1
    v_lshlrev_b32 v165, 16, v51
    v_lshlrev_b32 v166, 16, v53
    v_lshlrev_b32 v167, 16, v55
    v_lshlrev_b32 v168, 16, v57
    v_lshlrev_b32 v169, 16, v59
    v_lshlrev_b32 v170, 16, v61
    v_lshlrev_b32 v172, 16, v88
    v_and_b32 v173, 0xffff0000, v88
    v_lshlrev_b32 v174, 16, v89
    v_and_b32 v175, 0xffff0000, v89
    v_lshlrev_b32 v176, 16, v69
    v_lshlrev_b32 v177, 16, v71
    v_lshlrev_b32 v178, 16, v73
    v_lshlrev_b32 v179, 16, v75
    v_lshlrev_b32 v180, 16, v77
    v_lshlrev_b32 v181, 16, v79
    v_lshlrev_b32 v182, 16, v81
    v_lshlrev_b32 v183, 16, v83
    v_mul_f32 v184, v160, v175
    v_mul_f32 v185, v161, v175
    v_mul_f32 v186, v162, v175
    v_mul_f32 v187, v163, v175
    v_mul_f32 v188, v164, v175
    v_mul_f32 v189, v165, v175
    v_mul_f32 v190, v166, v175
    v_mul_f32 v191, v167, v175
    v_fmac_f32 v184, v161, v174
    v_fmac_f32 v185, v162, v174
    v_fmac_f32 v186, v163, v174
    v_fmac_f32 v187, v164, v174
    v_fmac_f32 v188, v165, v174
    v_fmac_f32 v189, v166, v174
    v_fmac_f32 v190, v167, v174
    v_fmac_f32 v191, v168, v174
    v_fmac_f32 v184, v162, v173
    v_fmac_f32 v185, v163, v173
    v_fmac_f32 v186, v164, v173
    v_fmac_f32 v187, v165, v173
    v_fmac_f32 v188, v166, v173
    v_fmac_f32 v189, v167, v173
    v_fmac_f32 v190, v168, v173
    s_waitcnt vmcnt(13)
    s_barrier
    s_mul_i32 s16, s97, 3072
    s_add_u32 m0, s60, 49152
    s_add_u32 s99, s16, s62
    buffer_load_dwordx4 v244, s[32:35], s99 offen offset:0  lds
    v_fmac_f32 v191, v169, v173
    v_fmac_f32 v184, v163, v172
    v_fmac_f32 v185, v164, v172
    v_fmac_f32 v186, v165, v172
    v_fmac_f32 v187, v166, v172
    buffer_load_dwordx4 v245, s[32:35], s99 offen offset:1024  lds
    v_fmac_f32 v188, v167, v172
    v_fmac_f32 v189, v168, v172
    v_fmac_f32 v190, v169, v172
    v_fmac_f32 v191, v170, v172
    v_mul_f32 v184, v184, v176
    buffer_load_dwordx4 v246, s[32:35], s99 offen offset:2048  lds
    v_mul_f32 v185, v185, v177
    v_mul_f32 v186, v186, v178
    v_mul_f32 v187, v187, v179
    v_mul_f32 v188, v188, v180
    v_mul_f32 v189, v189, v181
    s_add_u32 m0, s61, 61440
    s_add_u32 s16, s16, s63
    buffer_load_dwordx4 v244, s[32:35], s16 offen offset:0  lds
    v_mul_f32 v190, v190, v182
    v_mul_f32 v191, v191, v183
    v_cvt_pk_bf16_f32 v108, v191, v190
    v_cvt_pk_bf16_f32 v109, v189, v188
    v_cvt_pk_bf16_f32 v110, v187, v186
    buffer_load_dwordx4 v245, s[32:35], s16 offen offset:1024  lds
    v_cvt_pk_bf16_f32 v111, v185, v184
    s_mov_b32 s89, 32768
    buffer_store_dwordx4 v[108:111], v12, s[52:55], s89 offen sc1
    v_and_b32 v160, 0xffff0000, v41
    v_and_b32 v161, 0xffff0000, v43
    v_and_b32 v162, 0xffff0000, v45
    buffer_load_dwordx4 v246, s[32:35], s16 offen offset:2048  lds
    v_and_b32 v163, 0xffff0000, v47
    v_and_b32 v164, 0xffff0000, v49
    v_and_b32 v165, 0xffff0000, v51
    v_and_b32 v166, 0xffff0000, v53
    v_and_b32 v167, 0xffff0000, v55
    s_add_u32 s97, s98, s0
    s_lshr_b64 s[0:1], s[0:1], 4
    s_and_b32 s97, s97, 15
    s_add_u32 m0, s87, 0
    s_lshl_b32 s97, s97, 7
    buffer_load_dwordx4 v240, s[28:31], s97 offen offset:0  lds
    v_and_b32 v168, 0xffff0000, v57
    v_and_b32 v169, 0xffff0000, v59
    v_and_b32 v170, 0xffff0000, v61
    v_lshlrev_b32 v172, 16, v90
    v_and_b32 v173, 0xffff0000, v90
    buffer_load_dwordx4 v241, s[28:31], s97 offen offset:1024  lds
    v_lshlrev_b32 v174, 16, v91
    v_and_b32 v175, 0xffff0000, v91
    v_and_b32 v176, 0xffff0000, v69
    v_and_b32 v177, 0xffff0000, v71
    v_and_b32 v178, 0xffff0000, v73
    buffer_load_dwordx4 v242, s[28:31], s97 offen offset:2048  lds
    v_and_b32 v179, 0xffff0000, v75
    v_and_b32 v180, 0xffff0000, v77
    v_and_b32 v181, 0xffff0000, v79
    v_and_b32 v182, 0xffff0000, v81
    v_and_b32 v183, 0xffff0000, v83
    buffer_load_dwordx4 v243, s[28:31], s97 offen offset:3072  lds
    v_mul_f32 v184, v160, v175
    v_mul_f32 v185, v161, v175
    v_mul_f32 v186, v162, v175
    v_mul_f32 v187, v163, v175
    v_mul_f32 v188, v164, v175
    s_add_u32 m0, s88, 0
    s_mov_b64 exec, 0xffffffff
    buffer_load_dwordx4 v3, s[28:31], s97 offen offset:0  lds
    s_mov_b64 exec, -1
    v_mul_f32 v189, v165, v175
    v_mul_f32 v190, v166, v175
    v_mul_f32 v191, v167, v175
    v_fmac_f32 v184, v161, v174
    v_fmac_f32 v185, v162, v174
    v_fmac_f32 v186, v163, v174
    v_fmac_f32 v187, v164, v174
    v_fmac_f32 v188, v165, v174
    v_fmac_f32 v189, v166, v174
    v_fmac_f32 v190, v167, v174
    v_fmac_f32 v191, v168, v174
    v_fmac_f32 v184, v162, v173
    v_fmac_f32 v185, v163, v173
    v_fmac_f32 v186, v164, v173
    v_fmac_f32 v187, v165, v173
    v_fmac_f32 v188, v166, v173
    v_fmac_f32 v189, v167, v173
    v_fmac_f32 v190, v168, v173
    v_fmac_f32 v191, v169, v173
    v_fmac_f32 v184, v163, v172
    v_fmac_f32 v185, v164, v172
    v_fmac_f32 v186, v165, v172
    v_fmac_f32 v187, v166, v172
    v_fmac_f32 v188, v167, v172
    v_fmac_f32 v189, v168, v172
    v_fmac_f32 v190, v169, v172
    v_fmac_f32 v191, v170, v172
    v_mul_f32 v184, v184, v176
    v_mul_f32 v185, v185, v177
    v_mul_f32 v186, v186, v178
    v_mul_f32 v187, v187, v179
    v_mul_f32 v188, v188, v180
    v_mul_f32 v189, v189, v181
    v_mul_f32 v190, v190, v182
    v_mul_f32 v191, v191, v183
    v_cvt_pk_bf16_f32 v112, v191, v190
    v_cvt_pk_bf16_f32 v113, v189, v188
    v_cvt_pk_bf16_f32 v114, v187, v186
    v_cvt_pk_bf16_f32 v115, v185, v184
    s_mov_b32 s89, 49152
    buffer_store_dwordx4 v[112:115], v12, s[52:55], s89 offen sc1
    s_waitcnt vmcnt(13)
    s_barrier
    s_mul_i32 s16, s97, 3072
    s_add_u32 m0, s60, 0
    s_add_u32 s99, s16, s62
    buffer_load_dwordx4 v244, s[32:35], s99 offen offset:0  lds
    buffer_load_dwordx4 v245, s[32:35], s99 offen offset:1024  lds
    buffer_load_dwordx4 v246, s[32:35], s99 offen offset:2048  lds
    s_add_u32 m0, s61, 12288
    s_add_u32 s16, s16, s63
    buffer_load_dwordx4 v244, s[32:35], s16 offen offset:0  lds
    buffer_load_dwordx4 v245, s[32:35], s16 offen offset:1024  lds
    buffer_load_dwordx4 v246, s[32:35], s16 offen offset:2048  lds
    s_add_u32 m0, s94, 32
    s_lshl_b32 s89, s90, 12
    buffer_load_dwordx4 v15, s[48:51], s89 offen offset:0 nt lds
    s_add_u32 m0, s94, 32
    s_lshl_b32 s89, s90, 12
    buffer_load_dwordx4 v15, s[48:51], s89 offen offset:1024 nt lds
    s_add_u32 m0, s94, 32
    s_lshl_b32 s89, s90, 12
    buffer_load_dwordx4 v15, s[48:51], s89 offen offset:2048 nt lds
    s_add_u32 m0, s94, 32
    s_lshl_b32 s89, s90, 12
    buffer_load_dwordx4 v15, s[48:51], s89 offen offset:3072 nt lds
    s_add_u32 s97, s98, s0
    s_lshr_b64 s[0:1], s[0:1], 4
    s_and_b32 s97, s97, 15
    s_add_u32 m0, s87, 18432
    s_lshl_b32 s97, s97, 7
    buffer_load_dwordx4 v240, s[28:31], s97 offen offset:0  lds
    buffer_load_dwordx4 v241, s[28:31], s97 offen offset:1024  lds
    buffer_load_dwordx4 v242, s[28:31], s97 offen offset:2048  lds
    buffer_load_dwordx4 v243, s[28:31], s97 offen offset:3072  lds
    s_add_u32 m0, s88, 18432
    s_mov_b64 exec, 0xffffffff
    buffer_load_dwordx4 v3, s[28:31], s97 offen offset:0  lds
    s_mov_b64 exec, -1
    s_waitcnt vmcnt(16)
    s_barrier
    s_mul_i32 s16, s97, 3072
    s_add_u32 m0, s60, 24576
    s_add_u32 s99, s16, s62
    buffer_load_dwordx4 v244, s[32:35], s99 offen offset:0  lds
    s_mov_b32 s68, s24
    s_mov_b32 s69, s25
    s_mov_b32 s70, 0x100
    s_mov_b32 s71, 0x20000
    buffer_load_dwordx4 v245, s[32:35], s99 offen offset:1024  lds
    v_lshrrev_b32 v6, 5, v0
    v_and_b32 v7, 3, v0
    s_lshr_b32 s78, s90, 1
    s_lshl_b32 s78, s78, 2
    buffer_load_dwordx4 v246, s[32:35], s99 offen offset:2048  lds
    s_load_dword s92, s[14:15], s78
    v_bfe_u32 v5, v0, 2, 2
    v_lshlrev_b32 v5, 1, v5
    s_add_u32 m0, s61, 36864
    s_add_u32 s16, s16, s63
    buffer_load_dwordx4 v244, s[32:35], s16 offen offset:0  lds
    v_lshl_add_u32 v5, v6, 3, v5
    v_bfe_u32 v8, v0, 4, 1
    v_add_u32 v5, v5, v8
    s_and_b32 s78, s3, 1
    buffer_load_dwordx4 v245, s[32:35], s16 offen offset:1024  lds
    s_lshl_b32 s78, s78, 1
    v_add_u32 v8, s78, v6
    v_xor_b32 v8, v8, v7
    v_lshlrev_b32 v8, 4, v8
    buffer_load_dwordx4 v246, s[32:35], s16 offen offset:2048  lds
    v_lshl_add_u32 v5, v5, 6, v8
    v_add_u32 v14, s86, v5
    v_mov_b32 v18, 162304
    s_add_u32 s97, s98, s0
    s_lshr_b64 s[0:1], s[0:1], 4
    s_and_b32 s97, s97, 15
    s_add_u32 m0, s87, 36864
    s_lshl_b32 s97, s97, 7
    buffer_load_dwordx4 v240, s[28:31], s97 offen offset:0  lds
    v_mov_b32 v19, 1
    v_and_b32 v5, 3, v0
    s_lshl_b32 s78, s74, 4
    s_add_u32 s78, s78, s3
    buffer_load_dwordx4 v241, s[28:31], s97 offen offset:1024  lds
    v_lshl_add_u32 v6, v5, 2, s78
    s_lshr_b32 s78, s76, 3
    s_lshl_b32 s79, s3, 1
    s_add_u32 s78, s78, s79
    buffer_load_dwordx4 v242, s[28:31], s97 offen offset:2048  lds
    s_xor_b32 s78, s78, 2
    s_lshl_b32 s78, s78, 5
    s_add_u32 s79, s76, 5
    buffer_load_dwordx4 v243, s[28:31], s97 offen offset:3072  lds
    s_and_b32 s79, s79, 7
    s_lshl_b32 s79, s79, 1
    s_add_u32 s78, s78, s79
    v_mul_u32_u24 v7, 9, v5
    s_add_u32 m0, s88, 36864
    s_mov_b64 exec, 0xffffffff
    buffer_load_dwordx4 v3, s[28:31], s97 offen offset:0  lds
    s_mov_b64 exec, -1
    v_and_b32 v7, 17, v7
    v_add_u32 v7, s78, v7
    v_and_b32 v8, 4, v0
    s_waitcnt vmcnt(11)
    s_barrier
    s_mul_i32 s16, s97, 3072
    s_add_u32 m0, s60, 49152
    s_add_u32 s99, s16, s62
    buffer_load_dwordx4 v244, s[32:35], s99 offen offset:0  lds
    v_cmp_eq_u32 vcc, 0, v8
    s_nop 1
    v_cndmask_b32 v6, v7, v6, vcc
    v_and_b32 v33, 0xf0, v6
    v_lshlrev_b32 v34, 8, v6
    buffer_load_dwordx4 v245, s[32:35], s99 offen offset:1024  lds
    v_add_u32 v34, 12582912, v34
    v_and_b32 v5, 15, v0
    v_lshrrev_b32 v6, 4, v0
    v_add_u32 v7, 9, v5
    buffer_load_dwordx4 v246, s[32:35], s99 offen offset:2048  lds
    v_and_b32 v8, 1, v7
    v_mul_u32_u24 v8, 4160, v8
    v_lshrrev_b32 v7, 1, v7
    s_add_u32 m0, s61, 61440
    s_add_u32 s16, s16, s63
    buffer_load_dwordx4 v244, s[32:35], s16 offen offset:0  lds
    v_lshl_add_u32 v8, v7, 2, v8
    v_lshlrev_b32 v7, 4, v6
    v_sub_u32 v8, v8, v7
    s_add_u32 s78, s94, 32
    buffer_load_dwordx4 v245, s[32:35], s16 offen offset:1024  lds
    v_add_u32 v21, s78, v8
    v_add_u32 v22, 1024, v21
    v_add_u32 v23, 2048, v21
    v_add_u32 v24, 3072, v21
    buffer_load_dwordx4 v246, s[32:35], s16 offen offset:2048  lds
    v_lshl_add_u32 v7, v5, 1, v6
    v_add_u32 v7, 30, v7
    v_and_b32 v8, 1, v7
    s_add_u32 s97, s98, s0
    s_lshr_b64 s[0:1], s[0:1], 4
    s_and_b32 s97, s97, 15
    s_add_u32 m0, s87, 0
    s_lshl_b32 s97, s97, 7
    buffer_load_dwordx4 v240, s[28:31], s97 offen offset:0  lds
    v_bfe_u32 v136, v7, 1, 2
    v_lshl_add_u32 v136, v8, 2, v136
    v_lshlrev_b32 v136, 6, v136
    v_lshrrev_b32 v7, 3, v7
    buffer_load_dwordx4 v241, s[28:31], s97 offen offset:1024  lds
    v_lshl_add_u32 v136, v7, 9, v136
    v_bitop3_b32 v8, v7, 3, s3 bitop3:0x6a
    v_lshl_add_u32 v25, v8, 4, v136
    v_add_u32 v25, 92160, v25
    buffer_load_dwordx4 v242, s[28:31], s97 offen offset:2048  lds
    v_subrev_u32 v7, 1, v7
    v_bitop3_b32 v8, v7, 3, s3 bitop3:0x6a
    v_lshl_add_u32 v27, v8, 4, v136
    buffer_load_dwordx4 v243, s[28:31], s97 offen offset:3072  lds
    v_add_u32 v27, 91648, v27
    v_subrev_u32 v7, 1, v7
    v_bitop3_b32 v8, v7, 3, s3 bitop3:0x6a
    v_lshl_add_u32 v29, v8, 4, v136
    s_add_u32 m0, s88, 0
    s_mov_b64 exec, 0xffffffff
    buffer_load_dwordx4 v3, s[28:31], s97 offen offset:0  lds
    s_mov_b64 exec, -1
    v_add_u32 v29, 91136, v29
    v_subrev_u32 v7, 1, v7
    v_bitop3_b32 v8, v7, 3, s3 bitop3:0x6a
    s_waitcnt vmcnt(11)
    s_barrier
    s_mul_i32 s16, s97, 3072
    s_add_u32 m0, s60, 0
    s_add_u32 s99, s16, s62
    buffer_load_dwordx4 v244, s[32:35], s99 offen offset:0  lds
    v_lshl_add_u32 v31, v8, 4, v136
    v_add_u32 v31, 90624, v31
    v_lshl_add_u32 v7, v5, 1, v6
    v_add_u32 v7, 26, v7
    buffer_load_dwordx4 v245, s[32:35], s99 offen offset:1024  lds
    v_and_b32 v8, 1, v7
    v_bfe_u32 v136, v7, 1, 2
    v_lshl_add_u32 v136, v8, 2, v136
    v_lshlrev_b32 v136, 6, v136
    buffer_load_dwordx4 v246, s[32:35], s99 offen offset:2048  lds
    v_lshrrev_b32 v7, 3, v7
    v_lshl_add_u32 v136, v7, 9, v136
    v_bitop3_b32 v8, v7, 3, s3 bitop3:0x6a
    s_add_u32 m0, s61, 12288
    s_add_u32 s16, s16, s63
    buffer_load_dwordx4 v244, s[32:35], s16 offen offset:0  lds
    v_lshl_add_u32 v26, v8, 4, v136
    v_add_u32 v26, 92160, v26
    v_subrev_u32 v7, 1, v7
    v_bitop3_b32 v8, v7, 3, s3 bitop3:0x6a
    buffer_load_dwordx4 v245, s[32:35], s16 offen offset:1024  lds
    v_lshl_add_u32 v28, v8, 4, v136
    v_add_u32 v28, 91648, v28
    v_subrev_u32 v7, 1, v7
    v_bitop3_b32 v8, v7, 3, s3 bitop3:0x6a
    buffer_load_dwordx4 v246, s[32:35], s16 offen offset:2048  lds
    v_lshl_add_u32 v30, v8, 4, v136
    v_add_u32 v30, 91136, v30
    v_subrev_u32 v7, 1, v7
    s_add_u32 s97, s98, s0
    s_lshr_b64 s[0:1], s[0:1], 4
    s_and_b32 s97, s97, 15
    s_add_u32 m0, s87, 18432
    s_lshl_b32 s97, s97, 7
    buffer_load_dwordx4 v240, s[28:31], s97 offen offset:0  lds
    v_bitop3_b32 v8, v7, 3, s3 bitop3:0x6a
    v_lshl_add_u32 v32, v8, 4, v136
    v_add_u32 v32, 90624, v32
    v_lshrrev_b32 v7, 1, v6
    buffer_load_dwordx4 v241, s[28:31], s97 offen offset:1024  lds
    v_lshl_add_u32 v7, v5, 1, v7
    v_add_u32 v7, 32, v7
    v_and_b32 v8, 1, v7
    v_bfe_u32 v136, v7, 1, 2
    buffer_load_dwordx4 v242, s[28:31], s97 offen offset:2048  lds
    v_lshl_add_u32 v136, v8, 2, v136
    v_lshlrev_b32 v136, 6, v136
    v_lshrrev_b32 v7, 3, v7
    buffer_load_dwordx4 v243, s[28:31], s97 offen offset:3072  lds
    v_lshl_add_u32 v136, v7, 9, v136
    v_bitop3_b32 v8, v7, 3, s3 bitop3:0x6a
    v_lshl_add_u32 v20, v8, 4, v136
    v_add_u32 v20, 92160, v20
    s_add_u32 m0, s88, 18432
    s_mov_b64 exec, 0xffffffff
    buffer_load_dwordx4 v3, s[28:31], s97 offen offset:0  lds
    s_mov_b64 exec, -1
    v_and_b32 v8, 1, v6
    v_xor_b32 v8, 1, v8
    v_lshl_add_u32 v20, v8, 3, v20
    s_waitcnt vmcnt(11)
    s_barrier
    s_mul_i32 s16, s97, 3072
    s_add_u32 m0, s60, 24576
    s_add_u32 s99, s16, s62
    buffer_load_dwordx4 v244, s[32:35], s99 offen offset:0  lds
    s_waitcnt lgkmcnt(0)
    s_and_b32 s78, s92, 0xffff0000
    s_lshl_b32 s92, s92, 16
    buffer_load_dwordx4 v245, s[32:35], s99 offen offset:1024  lds
    s_bitcmp1_b32 s90, 0
    s_cselect_b32 s92, s78, s92
    v_lshlrev_b32 v7, 3, v6
    v_sub_u32 v7, v7, v5
    buffer_load_dwordx4 v246, s[32:35], s99 offen offset:2048  lds
    v_subrev_u32 v7, 9, v7
    v_and_b32 v8, 1, v7
    v_xor_b32 v8, 1, v8
    s_add_u32 m0, s61, 36864
    s_add_u32 s16, s16, s63
    buffer_load_dwordx4 v244, s[32:35], s16 offen offset:0  lds
    v_lshlrev_b32 v8, 4, v8
    v_lshrrev_b32 v8, v8, s92
    v_ashrrev_i32 v7, 1, v7
    buffer_load_dwordx4 v245, s[32:35], s16 offen offset:1024  lds
    v_cmp_eq_u32 vcc, 0, v7
    s_nop 1
    v_cndmask_b32 v236, 0, v8, vcc
    v_cmp_eq_u32 vcc, 1, v7
    buffer_load_dwordx4 v246, s[32:35], s16 offen offset:2048  lds
    s_nop 0
    v_cndmask_b32 v237, 0, v8, vcc
    v_cmp_eq_u32 vcc, 2, v7
    s_nop 1
    v_cndmask_b32 v238, 0, v8, vcc
    s_add_u32 s97, s98, s0
    s_lshr_b64 s[0:1], s[0:1], 4
    s_and_b32 s97, s97, 15
    s_add_u32 m0, s87, 36864
    s_lshl_b32 s97, s97, 7
    buffer_load_dwordx4 v240, s[28:31], s97 offen offset:0  lds
    v_cmp_eq_u32 vcc, 3, v7
    s_nop 1
    v_cndmask_b32 v239, 0, v8, vcc
    s_and_b32 s78, s77, 7
    s_mov_b32 s95, 0x76543210
    s_and_b32 s78, s76, 3
    s_mul_i32 s78, s78, 0x22222222
    s_add_u32 s95, s95, s78
    s_bfe_u32 s17, s95, 0x30000
    s_lshl_b32 s17, s17, 18
    s_bfe_u32 s18, s95, 0x30004
    s_lshl_b32 s18, s18, 18
    s_bfe_u32 s100, s95, 0x3001c
    s_lshl_b32 s100, s100, 18
    s_bfe_u32 s95, s95, 0x30018
    s_lshl_b32 s95, s95, 18
    buffer_load_dwordx4 v241, s[28:31], s97 offen offset:1024  lds
    v_lshrrev_b32 v136, 4, v0
    v_lshlrev_b32 v136, 1, v136
    v_and_b32 v137, 7, v0
    buffer_load_dwordx4 v242, s[28:31], s97 offen offset:2048  lds
    v_xor_b32 v136, v136, v137
    v_lshlrev_b32 v136, 4, v136
    v_lshrrev_b32 v137, 3, v0
    buffer_load_dwordx4 v243, s[28:31], s97 offen offset:3072  lds
    v_lshl_add_u32 v136, v137, 11, v136
    s_lshl_b32 s78, s77, 7
    s_lshl_b32 s79, s3, 14
    s_add_u32 m0, s88, 36864
    s_mov_b64 exec, 0xffffffff
    buffer_load_dwordx4 v3, s[28:31], s97 offen offset:0  lds
    s_mov_b64 exec, -1
    s_add_u32 s78, s78, s79
    v_add_u32 v17, s78, v136
    s_waitcnt vmcnt(11)
    s_barrier
    s_mul_i32 s16, s97, 3072
    s_add_u32 m0, s60, 49152
    s_add_u32 s99, s16, s62
    buffer_load_dwordx4 v244, s[32:35], s99 offen offset:0  lds
    v_add_u32 v5, s94, v15
    ds_read_b128 v[140:143], v5 offset:32
    ds_read_b32 v156, v5 offset:48
    ds_read_b128 v[144:147], v5 offset:1056
    buffer_load_dwordx4 v245, s[32:35], s99 offen offset:1024  lds
    ds_read_b32 v157, v5 offset:1072
    ds_read_b128 v[148:151], v5 offset:2080
    ds_read_b32 v158, v5 offset:2096
    ds_read_b128 v[152:155], v5 offset:3104
    buffer_load_dwordx4 v246, s[32:35], s99 offen offset:2048  lds
    ds_read_b32 v159, v5 offset:3120
    v_lshrrev_b32 v6, 3, v0
    v_mul_u32_u24 v6, 4160, v6
    s_add_u32 m0, s61, 61440
    s_add_u32 s16, s16, s63
    buffer_load_dwordx4 v244, s[32:35], s16 offen offset:0  lds
    v_and_b32 v7, 7, v0
    v_lshl_add_u32 v6, v7, 2, v6
    v_add_u32 v6, s94, v6
    v_mov_b32 v7, 0
    buffer_load_dwordx4 v245, s[32:35], s16 offen offset:1024  lds
    s_waitcnt lgkmcnt(0)
    v_readfirstlane_b32 s93, v140
    s_nop 0
    s_lshl_b32 s93, s93, 16
    s_nop 1
    v_writelane_b32 v7, s93, 15
    buffer_load_dwordx4 v246, s[32:35], s16 offen offset:2048  lds
    v_alignbit_b32 v140, v141, v140, 16
    v_alignbit_b32 v141, v142, v141, 16
    v_alignbit_b32 v142, v143, v142, 16
    s_add_u32 s97, s98, s0
    s_lshr_b64 s[0:1], s[0:1], 4
    s_and_b32 s97, s97, 15
    s_add_u32 m0, s87, 0
    s_lshl_b32 s97, s97, 7
    buffer_load_dwordx4 v240, s[28:31], s97 offen offset:0  lds
    v_alignbit_b32 v143, v156, v143, 16
    v_alignbit_b32 v144, v145, v144, 16
    v_alignbit_b32 v145, v146, v145, 16
    v_alignbit_b32 v146, v147, v146, 16
    buffer_load_dwordx4 v241, s[28:31], s97 offen offset:1024  lds
    v_alignbit_b32 v147, v157, v147, 16
    v_alignbit_b32 v148, v149, v148, 16
    v_alignbit_b32 v149, v150, v149, 16
    v_alignbit_b32 v150, v151, v150, 16
    buffer_load_dwordx4 v242, s[28:31], s97 offen offset:2048  lds
    v_alignbit_b32 v151, v158, v151, 16
    v_alignbit_b32 v152, v153, v152, 16
    v_alignbit_b32 v153, v154, v153, 16
    buffer_load_dwordx4 v243, s[28:31], s97 offen offset:3072  lds
    v_alignbit_b32 v154, v155, v154, 16
    v_alignbit_b32 v155, v159, v155, 16
    v_lshlrev_b32 v8, 3, v0
    s_add_u32 s78, s88, 18432
    s_add_u32 m0, s88, 0
    s_mov_b64 exec, 0xffffffff
    buffer_load_dwordx4 v3, s[28:31], s97 offen offset:0  lds
    s_mov_b64 exec, -1
    v_add_u32 v8, s78, v8
    v_mov_b32 v156, 0
    v_mov_b32 v157, 0
    s_waitcnt vmcnt(11)
    s_barrier
    s_mul_i32 s16, s97, 3072
    s_add_u32 m0, s60, 0
    s_add_u32 s99, s16, s62
    buffer_load_dwordx4 v244, s[32:35], s99 offen offset:0  lds
    buffer_load_dwordx4 v245, s[32:35], s99 offen offset:1024  lds
    buffer_load_dwordx4 v246, s[32:35], s99 offen offset:2048  lds
    s_add_u32 m0, s61, 12288
    s_add_u32 s16, s16, s63
    buffer_load_dwordx4 v244, s[32:35], s16 offen offset:0  lds
    buffer_load_dwordx4 v245, s[32:35], s16 offen offset:1024  lds
    buffer_load_dwordx4 v246, s[32:35], s16 offen offset:2048  lds
    s_mov_b64 exec, 0xff
    buffer_load_dword v136, v33, s[68:71], 0 offen sc1
    buffer_load_dword v137, v34, s[52:55], 0 offen sc1
    s_mov_b64 exec, -1
    buffer_load_dwordx4 v[212:215], v9, s[56:59], 0 offen offset:0 nt
    buffer_load_dwordx4 v[216:219], v9, s[56:59], 0 offen offset:2048 nt
    buffer_load_dwordx4 v[220:223], v9, s[56:59], s96 offen offset:0 nt
    buffer_load_dwordx4 v[224:227], v9, s[56:59], s96 offen offset:2048 nt
    s_waitcnt vmcnt(12)
    s_waitcnt vmcnt(6)
    s_barrier
    s_waitcnt vmcnt(4)
    s_branch LA_j
LA_c1:
    s_waitcnt vmcnt(8)
    s_barrier
    buffer_load_dwordx4 v242, s[28:31], s97 offen offset:2048  lds
    buffer_load_dwordx4 v243, s[28:31], s97 offen offset:3072  lds
    s_add_u32 m0, s88, 36864
    s_mov_b64 exec, 0xffffffff
    buffer_load_dwordx4 v3, s[28:31], s97 offen offset:0  lds
    s_mov_b64 exec, -1
    s_mul_i32 s16, s97, 3072
    s_add_u32 m0, s60, 49152
    s_add_u32 s99, s16, s62
    buffer_load_dwordx4 v244, s[32:35], s99 offen offset:0  lds
    buffer_load_dwordx4 v245, s[32:35], s99 offen offset:1024  lds
    buffer_load_dwordx4 v246, s[32:35], s99 offen offset:2048  lds
    s_add_u32 m0, s61, 61440
    s_add_u32 s16, s16, s63
    buffer_load_dwordx4 v244, s[32:35], s16 offen offset:0  lds
    buffer_load_dwordx4 v245, s[32:35], s16 offen offset:1024  lds
    buffer_load_dwordx4 v246, s[32:35], s16 offen offset:2048  lds
    s_add_u32 s97, s98, s0
    s_lshr_b64 s[0:1], s[0:1], 4
    s_and_b32 s97, s97, 15
    s_add_u32 m0, s87, 0
    s_lshl_b32 s97, s97, 7
    buffer_load_dwordx4 v240, s[28:31], s97 offen offset:0  lds
    buffer_load_dwordx4 v241, s[28:31], s97 offen offset:1024  lds
    buffer_load_dwordx4 v242, s[28:31], s97 offen offset:2048  lds
    buffer_load_dwordx4 v243, s[28:31], s97 offen offset:3072  lds
    s_add_u32 m0, s88, 0
    s_mov_b64 exec, 0xffffffff
    buffer_load_dwordx4 v3, s[28:31], s97 offen offset:0  lds
    s_mov_b64 exec, -1
    s_waitcnt vmcnt(11)
    s_barrier
    s_mul_i32 s16, s97, 3072
    s_add_u32 m0, s60, 0
    s_add_u32 s99, s16, s62
    buffer_load_dwordx4 v244, s[32:35], s99 offen offset:0  lds
    buffer_load_dwordx4 v245, s[32:35], s99 offen offset:1024  lds
    buffer_load_dwordx4 v246, s[32:35], s99 offen offset:2048  lds
    s_add_u32 m0, s61, 12288
    s_add_u32 s16, s16, s63
    buffer_load_dwordx4 v244, s[32:35], s16 offen offset:0  lds
    buffer_load_dwordx4 v245, s[32:35], s16 offen offset:1024  lds
    buffer_load_dwordx4 v246, s[32:35], s16 offen offset:2048  lds
    s_add_u32 m0, s86, 129536
    s_mov_b32 s89, 0
    buffer_load_dwordx4 v10, s[36:39], s89 offen nt lds
    s_add_u32 m0, s86, 145920
    s_mov_b32 s89, 0
    buffer_load_dwordx4 v10, s[40:43], s89 offen nt lds
    s_add_u32 m0, s86, 133632
    s_mov_b32 s89, 65536
    buffer_load_dwordx4 v10, s[36:39], s89 offen nt lds
    s_add_u32 m0, s86, 150016
    s_mov_b32 s89, 65536
    buffer_load_dwordx4 v10, s[40:43], s89 offen nt lds
    s_add_u32 m0, s86, 137728
    s_mov_b32 s89, 131072
    buffer_load_dwordx4 v10, s[36:39], s89 offen nt lds
    s_add_u32 m0, s86, 154112
    s_mov_b32 s89, 131072
    buffer_load_dwordx4 v10, s[40:43], s89 offen nt lds
    s_add_u32 m0, s86, 141824
    s_mov_b32 s89, 196608
    buffer_load_dwordx4 v10, s[36:39], s89 offen nt lds
    s_add_u32 m0, s86, 158208
    s_mov_b32 s89, 196608
    buffer_load_dwordx4 v10, s[40:43], s89 offen nt lds
    s_mov_b64 exec, 0xff
    s_lshl_b32 s82, s3, 7
    s_add_u32 m0, s82, 129024
    s_mov_b32 s89, 0
    buffer_load_dwordx4 v11, s[36:39], s89 offen nt lds
    s_lshl_b32 s83, s74, 9
    s_add_u32 s83, s83, s82
    s_and_b32 s89, s3, 2
    s_lshl_b32 s89, s89, 3
    s_add_u32 s82, s82, s89
    s_add_u32 m0, s82, 162816
    s_add_u32 s89, s83, 0
    buffer_load_dwordx4 v15, s[44:47], s89 offen  lds
    s_mov_b64 exec, -1
    s_add_u32 s97, s98, s0
    s_lshr_b64 s[0:1], s[0:1], 4
    s_and_b32 s97, s97, 15
    s_add_u32 m0, s87, 18432
    s_lshl_b32 s97, s97, 7
    buffer_load_dwordx4 v240, s[28:31], s97 offen offset:0  lds
    s_waitcnt vmcnt(17)
    s_barrier
    buffer_load_dwordx4 v241, s[28:31], s97 offen offset:1024  lds
    buffer_load_dwordx4 v242, s[28:31], s97 offen offset:2048  lds
    buffer_load_dwordx4 v243, s[28:31], s97 offen offset:3072  lds
    s_add_u32 m0, s88, 18432
    s_mov_b64 exec, 0xffffffff
    buffer_load_dwordx4 v3, s[28:31], s97 offen offset:0  lds
    s_mov_b64 exec, -1
    s_mul_i32 s16, s97, 3072
    s_add_u32 m0, s60, 24576
    s_add_u32 s99, s16, s62
    buffer_load_dwordx4 v244, s[32:35], s99 offen offset:0  lds
    buffer_load_dwordx4 v245, s[32:35], s99 offen offset:1024  lds
    buffer_load_dwordx4 v246, s[32:35], s99 offen offset:2048  lds
    s_add_u32 m0, s61, 36864
    s_add_u32 s16, s16, s63
    buffer_load_dwordx4 v244, s[32:35], s16 offen offset:0  lds
    buffer_load_dwordx4 v245, s[32:35], s16 offen offset:1024  lds
    buffer_load_dwordx4 v246, s[32:35], s16 offen offset:2048  lds
    s_add_u32 s97, s98, s0
    s_lshr_b64 s[0:1], s[0:1], 4
    s_and_b32 s97, s97, 15
    s_add_u32 m0, s87, 36864
    s_lshl_b32 s97, s97, 7
    buffer_load_dwordx4 v240, s[28:31], s97 offen offset:0  lds
    buffer_load_dwordx4 v241, s[28:31], s97 offen offset:1024  lds
    buffer_load_dwordx4 v242, s[28:31], s97 offen offset:2048  lds
    buffer_load_dwordx4 v243, s[28:31], s97 offen offset:3072  lds
    s_add_u32 m0, s88, 36864
    s_mov_b64 exec, 0xffffffff
    buffer_load_dwordx4 v3, s[28:31], s97 offen offset:0  lds
    s_mov_b64 exec, -1
    s_waitcnt vmcnt(11)
    s_barrier
    s_mul_i32 s16, s97, 3072
    s_add_u32 m0, s60, 49152
    s_add_u32 s99, s16, s62
    buffer_load_dwordx4 v244, s[32:35], s99 offen offset:0  lds
    ds_read_b128 v[84:87], v35 offset:0
    ds_read_b128 v[88:91], v35 offset:16
    buffer_load_dwordx4 v245, s[32:35], s99 offen offset:1024  lds
    ds_read_b64 v[40:41], v16 offset:0
    ds_read_b64 v[42:43], v231 offset:256
    buffer_load_dwordx4 v246, s[32:35], s99 offen offset:2048  lds
    ds_read_b64 v[44:45], v16 offset:256
    s_add_u32 m0, s61, 61440
    s_add_u32 s16, s16, s63
    buffer_load_dwordx4 v244, s[32:35], s16 offen offset:0  lds
    ds_read_b64 v[46:47], v16 offset:512
    ds_read_b64 v[48:49], v231 offset:512
    buffer_load_dwordx4 v245, s[32:35], s16 offen offset:1024  lds
    ds_read_b64 v[50:51], v16 offset:768
    ds_read_b64 v[52:53], v231 offset:768
    buffer_load_dwordx4 v246, s[32:35], s16 offen offset:2048  lds
    ds_read_b64 v[54:55], v16 offset:1024
    buffer_load_dword v230, v229, s[4:7], 0 offen
    ds_read_b64 v[56:57], v231 offset:1024
    ds_read_b64 v[58:59], v16 offset:1280
    buffer_load_dword v230, v228, s[32:35], 0 offen
    ds_read_b64 v[60:61], v231 offset:1280
    s_add_u32 s97, s98, s0
    s_lshr_b64 s[0:1], s[0:1], 4
    s_and_b32 s97, s97, 15
    s_add_u32 m0, s87, 0
    s_lshl_b32 s97, s97, 7
    buffer_load_dwordx4 v240, s[28:31], s97 offen offset:0  lds
    ds_read_b64 v[68:69], v16 offset:16896
    ds_read_b64 v[70:71], v231 offset:16896
    buffer_load_dwordx4 v241, s[28:31], s97 offen offset:1024  lds
    ds_read_b64 v[72:73], v16 offset:17152
    ds_read_b64 v[74:75], v231 offset:17152
    buffer_load_dwordx4 v242, s[28:31], s97 offen offset:2048  lds
    ds_read_b64 v[76:77], v16 offset:17408
    buffer_load_dwordx4 v243, s[28:31], s97 offen offset:3072  lds
    ds_read_b64 v[78:79], v231 offset:17408
    ds_read_b64 v[80:81], v16 offset:17664
    s_add_u32 m0, s88, 0
    s_mov_b64 exec, 0xffffffff
    buffer_load_dwordx4 v3, s[28:31], s97 offen offset:0  lds
    s_mov_b64 exec, -1
    ds_read_b64 v[82:83], v231 offset:17664
    s_waitcnt vmcnt(13)
    s_waitcnt lgkmcnt(0)
    s_barrier
    s_mul_i32 s16, s97, 3072
    s_add_u32 m0, s60, 0
    s_add_u32 s99, s16, s62
    buffer_load_dwordx4 v244, s[32:35], s99 offen offset:0  lds
    v_lshlrev_b32 v160, 16, v40
    v_lshlrev_b32 v161, 16, v42
    v_lshlrev_b32 v162, 16, v44
    v_lshlrev_b32 v163, 16, v46
    v_lshlrev_b32 v164, 16, v48
    buffer_load_dwordx4 v245, s[32:35], s99 offen offset:1024  lds
    v_lshlrev_b32 v165, 16, v50
    v_lshlrev_b32 v166, 16, v52
    v_lshlrev_b32 v167, 16, v54
    v_lshlrev_b32 v168, 16, v56
    v_lshlrev_b32 v169, 16, v58
    buffer_load_dwordx4 v246, s[32:35], s99 offen offset:2048  lds
    v_lshlrev_b32 v170, 16, v60
    v_lshlrev_b32 v172, 16, v84
    v_and_b32 v173, 0xffff0000, v84
    v_lshlrev_b32 v174, 16, v85
    v_and_b32 v175, 0xffff0000, v85
    s_add_u32 m0, s61, 12288
    s_add_u32 s16, s16, s63
    buffer_load_dwordx4 v244, s[32:35], s16 offen offset:0  lds
    v_lshlrev_b32 v176, 16, v68
    v_lshlrev_b32 v177, 16, v70
    v_lshlrev_b32 v178, 16, v72
    v_lshlrev_b32 v179, 16, v74
    v_lshlrev_b32 v180, 16, v76
    buffer_load_dwordx4 v245, s[32:35], s16 offen offset:1024  lds
    v_lshlrev_b32 v181, 16, v78
    v_lshlrev_b32 v182, 16, v80
    v_lshlrev_b32 v183, 16, v82
    v_mul_f32 v184, v160, v175
    v_mul_f32 v185, v161, v175
    buffer_load_dwordx4 v246, s[32:35], s16 offen offset:2048  lds
    v_mul_f32 v186, v162, v175
    v_mul_f32 v187, v163, v175
    v_mul_f32 v188, v164, v175
    v_mul_f32 v189, v165, v175
    v_mul_f32 v190, v166, v175
    s_add_u32 s97, s98, s0
    s_lshr_b64 s[0:1], s[0:1], 4
    s_and_b32 s97, s97, 15
    s_add_u32 m0, s87, 18432
    s_lshl_b32 s97, s97, 7
    buffer_load_dwordx4 v240, s[28:31], s97 offen offset:0  lds
    v_mul_f32 v191, v167, v175
    v_fmac_f32 v184, v161, v174
    v_fmac_f32 v185, v162, v174
    v_fmac_f32 v186, v163, v174
    v_fmac_f32 v187, v164, v174
    buffer_load_dwordx4 v241, s[28:31], s97 offen offset:1024  lds
    v_fmac_f32 v188, v165, v174
    v_fmac_f32 v189, v166, v174
    v_fmac_f32 v190, v167, v174
    v_fmac_f32 v191, v168, v174
    v_fmac_f32 v184, v162, v173
    buffer_load_dwordx4 v242, s[28:31], s97 offen offset:2048  lds
    v_fmac_f32 v185, v163, v173
    v_fmac_f32 v186, v164, v173
    v_fmac_f32 v187, v165, v173
    v_fmac_f32 v188, v166, v173
    v_fmac_f32 v189, v167, v173
    buffer_load_dwordx4 v243, s[28:31], s97 offen offset:3072  lds
    v_fmac_f32 v190, v168, v173
    v_fmac_f32 v191, v169, v173
    v_fmac_f32 v184, v163, v172
    v_fmac_f32 v185, v164, v172
    v_fmac_f32 v186, v165, v172
    s_add_u32 m0, s88, 18432
    s_mov_b64 exec, 0xffffffff
    buffer_load_dwordx4 v3, s[28:31], s97 offen offset:0  lds
    s_mov_b64 exec, -1
    v_fmac_f32 v187, v166, v172
    v_fmac_f32 v188, v167, v172
    v_fmac_f32 v189, v168, v172
    v_fmac_f32 v190, v169, v172
    v_fmac_f32 v191, v170, v172
    v_mul_f32 v184, v184, v176
    v_mul_f32 v185, v185, v177
    v_mul_f32 v186, v186, v178
    v_mul_f32 v187, v187, v179
    v_mul_f32 v188, v188, v180
    v_mul_f32 v189, v189, v181
    v_mul_f32 v190, v190, v182
    v_mul_f32 v191, v191, v183
    v_cvt_pk_bf16_f32 v100, v191, v190
    v_cvt_pk_bf16_f32 v101, v189, v188
    v_cvt_pk_bf16_f32 v102, v187, v186
    v_cvt_pk_bf16_f32 v103, v185, v184
    s_mov_b32 s89, 0
    buffer_store_dwordx4 v[100:103], v12, s[52:55], s89 offen sc1
    v_and_b32 v160, 0xffff0000, v40
    v_and_b32 v161, 0xffff0000, v42
    v_and_b32 v162, 0xffff0000, v44
    v_and_b32 v163, 0xffff0000, v46
    v_and_b32 v164, 0xffff0000, v48
    v_and_b32 v165, 0xffff0000, v50
    v_and_b32 v166, 0xffff0000, v52
    v_and_b32 v167, 0xffff0000, v54
    v_and_b32 v168, 0xffff0000, v56
    v_and_b32 v169, 0xffff0000, v58
    v_and_b32 v170, 0xffff0000, v60
    v_lshlrev_b32 v172, 16, v86
    v_and_b32 v173, 0xffff0000, v86
    v_lshlrev_b32 v174, 16, v87
    v_and_b32 v175, 0xffff0000, v87
    v_and_b32 v176, 0xffff0000, v68
    v_and_b32 v177, 0xffff0000, v70
    v_and_b32 v178, 0xffff0000, v72
    v_and_b32 v179, 0xffff0000, v74
    v_and_b32 v180, 0xffff0000, v76
    v_and_b32 v181, 0xffff0000, v78
    v_and_b32 v182, 0xffff0000, v80
    v_and_b32 v183, 0xffff0000, v82
    s_waitcnt vmcnt(12)
    s_barrier
    s_mul_i32 s16, s97, 3072
    s_add_u32 m0, s60, 24576
    s_add_u32 s99, s16, s62
    buffer_load_dwordx4 v244, s[32:35], s99 offen offset:0  lds
    v_mul_f32 v184, v160, v175
    v_mul_f32 v185, v161, v175
    v_mul_f32 v186, v162, v175
    v_mul_f32 v187, v163, v175
    v_mul_f32 v188, v164, v175
    buffer_load_dwordx4 v245, s[32:35], s99 offen offset:1024  lds
    v_mul_f32 v189, v165, v175
    v_mul_f32 v190, v166, v175
    v_mul_f32 v191, v167, v175
    v_fmac_f32 v184, v161, v174
    v_fmac_f32 v185, v162, v174
    buffer_load_dwordx4 v246, s[32:35], s99 offen offset:2048  lds
    v_fmac_f32 v186, v163, v174
    v_fmac_f32 v187, v164, v174
    v_fmac_f32 v188, v165, v174
    v_fmac_f32 v189, v166, v174
    v_fmac_f32 v190, v167, v174
    s_add_u32 m0, s61, 36864
    s_add_u32 s16, s16, s63
    buffer_load_dwordx4 v244, s[32:35], s16 offen offset:0  lds
    v_fmac_f32 v191, v168, v174
    v_fmac_f32 v184, v162, v173
    v_fmac_f32 v185, v163, v173
    v_fmac_f32 v186, v164, v173
    v_fmac_f32 v187, v165, v173
    buffer_load_dwordx4 v245, s[32:35], s16 offen offset:1024  lds
    v_fmac_f32 v188, v166, v173
    v_fmac_f32 v189, v167, v173
    v_fmac_f32 v190, v168, v173
    v_fmac_f32 v191, v169, v173
    v_fmac_f32 v184, v163, v172
    buffer_load_dwordx4 v246, s[32:35], s16 offen offset:2048  lds
    v_fmac_f32 v185, v164, v172
    v_fmac_f32 v186, v165, v172
    v_fmac_f32 v187, v166, v172
    v_fmac_f32 v188, v167, v172
    v_fmac_f32 v189, v168, v172
    s_add_u32 s97, s98, s0
    s_lshr_b64 s[0:1], s[0:1], 4
    s_and_b32 s97, s97, 15
    s_add_u32 m0, s87, 36864
    s_lshl_b32 s97, s97, 7
    buffer_load_dwordx4 v240, s[28:31], s97 offen offset:0  lds
    v_fmac_f32 v190, v169, v172
    v_fmac_f32 v191, v170, v172
    v_mul_f32 v184, v184, v176
    v_mul_f32 v185, v185, v177
    v_mul_f32 v186, v186, v178
    buffer_load_dwordx4 v241, s[28:31], s97 offen offset:1024  lds
    v_mul_f32 v187, v187, v179
    v_mul_f32 v188, v188, v180
    v_mul_f32 v189, v189, v181
    v_mul_f32 v190, v190, v182
    v_mul_f32 v191, v191, v183
    buffer_load_dwordx4 v242, s[28:31], s97 offen offset:2048  lds
    v_cvt_pk_bf16_f32 v104, v191, v190
    v_cvt_pk_bf16_f32 v105, v189, v188
    v_cvt_pk_bf16_f32 v106, v187, v186
    v_cvt_pk_bf16_f32 v107, v185, v184
    s_mov_b32 s89, 16384
    buffer_store_dwordx4 v[104:107], v12, s[52:55], s89 offen sc1
    buffer_load_dwordx4 v243, s[28:31], s97 offen offset:3072  lds
    v_lshlrev_b32 v160, 16, v41
    v_lshlrev_b32 v161, 16, v43
    v_lshlrev_b32 v162, 16, v45
    v_lshlrev_b32 v163, 16, v47
    v_lshlrev_b32 v164, 16, v49
    s_add_u32 m0, s88, 36864
    s_mov_b64 exec, 0xffffffff
    buffer_load_dwordx4 v3, s[28:31], s97 offen offset:0  lds
    s_mov_b64 exec, -1
    v_lshlrev_b32 v165, 16, v51
    v_lshlrev_b32 v166, 16, v53
    v_lshlrev_b32 v167, 16, v55
    v_lshlrev_b32 v168, 16, v57
    v_lshlrev_b32 v169, 16, v59
    v_lshlrev_b32 v170, 16, v61
    v_lshlrev_b32 v172, 16, v88
    v_and_b32 v173, 0xffff0000, v88
    v_lshlrev_b32 v174, 16, v89
    v_and_b32 v175, 0xffff0000, v89
    v_lshlrev_b32 v176, 16, v69
    v_lshlrev_b32 v177, 16, v71
    v_lshlrev_b32 v178, 16, v73
    v_lshlrev_b32 v179, 16, v75
    v_lshlrev_b32 v180, 16, v77
    v_lshlrev_b32 v181, 16, v79
    v_lshlrev_b32 v182, 16, v81
    v_lshlrev_b32 v183, 16, v83
    v_mul_f32 v184, v160, v175
    v_mul_f32 v185, v161, v175
    v_mul_f32 v186, v162, v175
    v_mul_f32 v187, v163, v175
    v_mul_f32 v188, v164, v175
    v_mul_f32 v189, v165, v175
    v_mul_f32 v190, v166, v175
    v_mul_f32 v191, v167, v175
    v_fmac_f32 v184, v161, v174
    v_fmac_f32 v185, v162, v174
    v_fmac_f32 v186, v163, v174
    v_fmac_f32 v187, v164, v174
    v_fmac_f32 v188, v165, v174
    v_fmac_f32 v189, v166, v174
    v_fmac_f32 v190, v167, v174
    v_fmac_f32 v191, v168, v174
    v_fmac_f32 v184, v162, v173
    v_fmac_f32 v185, v163, v173
    v_fmac_f32 v186, v164, v173
    v_fmac_f32 v187, v165, v173
    v_fmac_f32 v188, v166, v173
    v_fmac_f32 v189, v167, v173
    v_fmac_f32 v190, v168, v173
    s_waitcnt vmcnt(13)
    s_barrier
    s_mul_i32 s16, s97, 3072
    s_add_u32 m0, s60, 49152
    s_add_u32 s99, s16, s62
    buffer_load_dwordx4 v244, s[32:35], s99 offen offset:0  lds
    v_fmac_f32 v191, v169, v173
    v_fmac_f32 v184, v163, v172
    v_fmac_f32 v185, v164, v172
    v_fmac_f32 v186, v165, v172
    v_fmac_f32 v187, v166, v172
    buffer_load_dwordx4 v245, s[32:35], s99 offen offset:1024  lds
    v_fmac_f32 v188, v167, v172
    v_fmac_f32 v189, v168, v172
    v_fmac_f32 v190, v169, v172
    v_fmac_f32 v191, v170, v172
    v_mul_f32 v184, v184, v176
    buffer_load_dwordx4 v246, s[32:35], s99 offen offset:2048  lds
    v_mul_f32 v185, v185, v177
    v_mul_f32 v186, v186, v178
    v_mul_f32 v187, v187, v179
    v_mul_f32 v188, v188, v180
    v_mul_f32 v189, v189, v181
    s_add_u32 m0, s61, 61440
    s_add_u32 s16, s16, s63
    buffer_load_dwordx4 v244, s[32:35], s16 offen offset:0  lds
    v_mul_f32 v190, v190, v182
    v_mul_f32 v191, v191, v183
    v_cvt_pk_bf16_f32 v108, v191, v190
    v_cvt_pk_bf16_f32 v109, v189, v188
    v_cvt_pk_bf16_f32 v110, v187, v186
    buffer_load_dwordx4 v245, s[32:35], s16 offen offset:1024  lds
    v_cvt_pk_bf16_f32 v111, v185, v184
    s_mov_b32 s89, 32768
    buffer_store_dwordx4 v[108:111], v12, s[52:55], s89 offen sc1
    v_and_b32 v160, 0xffff0000, v41
    v_and_b32 v161, 0xffff0000, v43
    v_and_b32 v162, 0xffff0000, v45
    buffer_load_dwordx4 v246, s[32:35], s16 offen offset:2048  lds
    v_and_b32 v163, 0xffff0000, v47
    v_and_b32 v164, 0xffff0000, v49
    v_and_b32 v165, 0xffff0000, v51
    v_and_b32 v166, 0xffff0000, v53
    v_and_b32 v167, 0xffff0000, v55
    s_add_u32 s97, s98, s0
    s_lshr_b64 s[0:1], s[0:1], 4
    s_and_b32 s97, s97, 15
    s_add_u32 m0, s87, 0
    s_lshl_b32 s97, s97, 7
    buffer_load_dwordx4 v240, s[28:31], s97 offen offset:0  lds
    v_and_b32 v168, 0xffff0000, v57
    v_and_b32 v169, 0xffff0000, v59
    v_and_b32 v170, 0xffff0000, v61
    v_lshlrev_b32 v172, 16, v90
    v_and_b32 v173, 0xffff0000, v90
    buffer_load_dwordx4 v241, s[28:31], s97 offen offset:1024  lds
    v_lshlrev_b32 v174, 16, v91
    v_and_b32 v175, 0xffff0000, v91
    v_and_b32 v176, 0xffff0000, v69
    v_and_b32 v177, 0xffff0000, v71
    v_and_b32 v178, 0xffff0000, v73
    buffer_load_dwordx4 v242, s[28:31], s97 offen offset:2048  lds
    v_and_b32 v179, 0xffff0000, v75
    v_and_b32 v180, 0xffff0000, v77
    v_and_b32 v181, 0xffff0000, v79
    v_and_b32 v182, 0xffff0000, v81
    v_and_b32 v183, 0xffff0000, v83
    buffer_load_dwordx4 v243, s[28:31], s97 offen offset:3072  lds
    v_mul_f32 v184, v160, v175
    v_mul_f32 v185, v161, v175
    v_mul_f32 v186, v162, v175
    v_mul_f32 v187, v163, v175
    v_mul_f32 v188, v164, v175
    s_add_u32 m0, s88, 0
    s_mov_b64 exec, 0xffffffff
    buffer_load_dwordx4 v3, s[28:31], s97 offen offset:0  lds
    s_mov_b64 exec, -1
    v_mul_f32 v189, v165, v175
    v_mul_f32 v190, v166, v175
    v_mul_f32 v191, v167, v175
    v_fmac_f32 v184, v161, v174
    v_fmac_f32 v185, v162, v174
    v_fmac_f32 v186, v163, v174
    v_fmac_f32 v187, v164, v174
    v_fmac_f32 v188, v165, v174
    v_fmac_f32 v189, v166, v174
    v_fmac_f32 v190, v167, v174
    v_fmac_f32 v191, v168, v174
    v_fmac_f32 v184, v162, v173
    v_fmac_f32 v185, v163, v173
    v_fmac_f32 v186, v164, v173
    v_fmac_f32 v187, v165, v173
    v_fmac_f32 v188, v166, v173
    v_fmac_f32 v189, v167, v173
    v_fmac_f32 v190, v168, v173
    v_fmac_f32 v191, v169, v173
    v_fmac_f32 v184, v163, v172
    v_fmac_f32 v185, v164, v172
    v_fmac_f32 v186, v165, v172
    v_fmac_f32 v187, v166, v172
    v_fmac_f32 v188, v167, v172
    v_fmac_f32 v189, v168, v172
    v_fmac_f32 v190, v169, v172
    v_fmac_f32 v191, v170, v172
    v_mul_f32 v184, v184, v176
    v_mul_f32 v185, v185, v177
    v_mul_f32 v186, v186, v178
    v_mul_f32 v187, v187, v179
    v_mul_f32 v188, v188, v180
    v_mul_f32 v189, v189, v181
    v_mul_f32 v190, v190, v182
    v_mul_f32 v191, v191, v183
    v_cvt_pk_bf16_f32 v112, v191, v190
    v_cvt_pk_bf16_f32 v113, v189, v188
    v_cvt_pk_bf16_f32 v114, v187, v186
    v_cvt_pk_bf16_f32 v115, v185, v184
    s_mov_b32 s89, 49152
    buffer_store_dwordx4 v[112:115], v12, s[52:55], s89 offen sc1
    s_waitcnt vmcnt(13)
    s_barrier
    s_mul_i32 s16, s97, 3072
    s_add_u32 m0, s60, 0
    s_add_u32 s99, s16, s62
    buffer_load_dwordx4 v244, s[32:35], s99 offen offset:0  lds
    buffer_load_dwordx4 v245, s[32:35], s99 offen offset:1024  lds
    buffer_load_dwordx4 v246, s[32:35], s99 offen offset:2048  lds
    s_add_u32 m0, s61, 12288
    s_add_u32 s16, s16, s63
    buffer_load_dwordx4 v244, s[32:35], s16 offen offset:0  lds
    buffer_load_dwordx4 v245, s[32:35], s16 offen offset:1024  lds
    buffer_load_dwordx4 v246, s[32:35], s16 offen offset:2048  lds
    s_add_u32 s97, s98, s0
    s_lshr_b64 s[0:1], s[0:1], 4
    s_and_b32 s97, s97, 15
    s_add_u32 m0, s87, 18432
    s_lshl_b32 s97, s97, 7
    buffer_load_dwordx4 v240, s[28:31], s97 offen offset:0  lds
    buffer_load_dwordx4 v241, s[28:31], s97 offen offset:1024  lds
    buffer_load_dwordx4 v242, s[28:31], s97 offen offset:2048  lds
    buffer_load_dwordx4 v243, s[28:31], s97 offen offset:3072  lds
    s_add_u32 m0, s88, 18432
    s_mov_b64 exec, 0xffffffff
    buffer_load_dwordx4 v3, s[28:31], s97 offen offset:0  lds
    s_mov_b64 exec, -1
    s_waitcnt vmcnt(12)
    s_barrier
    s_mul_i32 s16, s97, 3072
    s_add_u32 m0, s60, 24576
    s_add_u32 s99, s16, s62
    buffer_load_dwordx4 v244, s[32:35], s99 offen offset:0  lds
    s_mov_b32 s68, s24
    s_mov_b32 s69, s25
    s_mov_b32 s70, 0x100
    buffer_load_dwordx4 v245, s[32:35], s99 offen offset:1024  lds
    s_mov_b32 s71, 0x20000
    v_lshrrev_b32 v6, 5, v0
    v_and_b32 v7, 3, v0
    buffer_load_dwordx4 v246, s[32:35], s99 offen offset:2048  lds
    s_lshr_b32 s78, s90, 1
    s_lshl_b32 s78, s78, 2
    s_add_u32 m0, s61, 36864
    s_add_u32 s16, s16, s63
    buffer_load_dwordx4 v244, s[32:35], s16 offen offset:0  lds
    s_load_dword s92, s[14:15], s78
    v_bfe_u32 v5, v0, 2, 2
    v_lshlrev_b32 v5, 1, v5
    buffer_load_dwordx4 v245, s[32:35], s16 offen offset:1024  lds
    v_lshl_add_u32 v5, v6, 3, v5
    v_bfe_u32 v8, v0, 4, 1
    v_add_u32 v5, v5, v8
    buffer_load_dwordx4 v246, s[32:35], s16 offen offset:2048  lds
    s_and_b32 s78, s3, 1
    s_lshl_b32 s78, s78, 1
    s_add_u32 m0, s94, 32
    s_lshl_b32 s89, s90, 12
    buffer_load_dwordx4 v15, s[48:51], s89 offen offset:0 nt lds
    v_add_u32 v8, s78, v6
    v_xor_b32 v8, v8, v7
    v_lshlrev_b32 v8, 4, v8
    s_add_u32 m0, s94, 32
    s_lshl_b32 s89, s90, 12
    buffer_load_dwordx4 v15, s[48:51], s89 offen offset:1024 nt lds
    v_lshl_add_u32 v5, v5, 6, v8
    v_add_u32 v14, s86, v5
    v_mov_b32 v18, 162304
    s_add_u32 m0, s94, 32
    s_lshl_b32 s89, s90, 12
    buffer_load_dwordx4 v15, s[48:51], s89 offen offset:2048 nt lds
    v_mov_b32 v19, 1
    v_and_b32 v5, 3, v0
    s_add_u32 m0, s94, 32
    s_lshl_b32 s89, s90, 12
    buffer_load_dwordx4 v15, s[48:51], s89 offen offset:3072 nt lds
    s_lshl_b32 s78, s74, 4
    s_add_u32 s78, s78, s3
    v_lshl_add_u32 v6, v5, 2, s78
    s_add_u32 s97, s98, s0
    s_lshr_b64 s[0:1], s[0:1], 4
    s_and_b32 s97, s97, 15
    s_add_u32 m0, s87, 36864
    s_lshl_b32 s97, s97, 7
    buffer_load_dwordx4 v240, s[28:31], s97 offen offset:0  lds
    s_lshr_b32 s78, s76, 3
    s_lshl_b32 s79, s3, 1
    s_add_u32 s78, s78, s79
    buffer_load_dwordx4 v241, s[28:31], s97 offen offset:1024  lds
    s_xor_b32 s78, s78, 2
    s_lshl_b32 s78, s78, 5
    buffer_load_dwordx4 v242, s[28:31], s97 offen offset:2048  lds
    s_add_u32 s79, s76, 5
    s_and_b32 s79, s79, 7
    s_lshl_b32 s79, s79, 1
    buffer_load_dwordx4 v243, s[28:31], s97 offen offset:3072  lds
    s_add_u32 s78, s78, s79
    v_mul_u32_u24 v7, 9, v5
    v_and_b32 v7, 17, v7
    s_add_u32 m0, s88, 36864
    s_mov_b64 exec, 0xffffffff
    buffer_load_dwordx4 v3, s[28:31], s97 offen offset:0  lds
    s_mov_b64 exec, -1
    v_add_u32 v7, s78, v7
    v_and_b32 v8, 4, v0
    s_waitcnt vmcnt(15)
    s_barrier
    s_mul_i32 s16, s97, 3072
    s_add_u32 m0, s60, 49152
    s_add_u32 s99, s16, s62
    buffer_load_dwordx4 v244, s[32:35], s99 offen offset:0  lds
    v_cmp_eq_u32 vcc, 0, v8
    s_nop 1
    v_cndmask_b32 v6, v7, v6, vcc
    v_and_b32 v33, 0xf0, v6
    v_lshlrev_b32 v34, 8, v6
    buffer_load_dwordx4 v245, s[32:35], s99 offen offset:1024  lds
    v_add_u32 v34, 12582912, v34
    v_and_b32 v5, 15, v0
    v_lshrrev_b32 v6, 4, v0
    v_add_u32 v7, 9, v5
    buffer_load_dwordx4 v246, s[32:35], s99 offen offset:2048  lds
    v_and_b32 v8, 1, v7
    v_mul_u32_u24 v8, 4160, v8
    v_lshrrev_b32 v7, 1, v7
    s_add_u32 m0, s61, 61440
    s_add_u32 s16, s16, s63
    buffer_load_dwordx4 v244, s[32:35], s16 offen offset:0  lds
    v_lshl_add_u32 v8, v7, 2, v8
    v_lshlrev_b32 v7, 4, v6
    v_sub_u32 v8, v8, v7
    s_add_u32 s78, s94, 32
    buffer_load_dwordx4 v245, s[32:35], s16 offen offset:1024  lds
    v_add_u32 v21, s78, v8
    v_add_u32 v22, 1024, v21
    v_add_u32 v23, 2048, v21
    v_add_u32 v24, 3072, v21
    buffer_load_dwordx4 v246, s[32:35], s16 offen offset:2048  lds
    v_lshl_add_u32 v7, v5, 1, v6
    v_add_u32 v7, 30, v7
    v_and_b32 v8, 1, v7
    s_add_u32 s97, s98, s0
    s_lshr_b64 s[0:1], s[0:1], 4
    s_and_b32 s97, s97, 15
    s_add_u32 m0, s87, 0
    s_lshl_b32 s97, s97, 7
    buffer_load_dwordx4 v240, s[28:31], s97 offen offset:0  lds
    v_bfe_u32 v136, v7, 1, 2
    v_lshl_add_u32 v136, v8, 2, v136
    v_lshlrev_b32 v136, 6, v136
    v_lshrrev_b32 v7, 3, v7
    buffer_load_dwordx4 v241, s[28:31], s97 offen offset:1024  lds
    v_lshl_add_u32 v136, v7, 9, v136
    v_bitop3_b32 v8, v7, 3, s3 bitop3:0x6a
    v_lshl_add_u32 v25, v8, 4, v136
    v_add_u32 v25, 92160, v25
    buffer_load_dwordx4 v242, s[28:31], s97 offen offset:2048  lds
    v_subrev_u32 v7, 1, v7
    v_bitop3_b32 v8, v7, 3, s3 bitop3:0x6a
    v_lshl_add_u32 v27, v8, 4, v136
    buffer_load_dwordx4 v243, s[28:31], s97 offen offset:3072  lds
    v_add_u32 v27, 91648, v27
    v_subrev_u32 v7, 1, v7
    v_bitop3_b32 v8, v7, 3, s3 bitop3:0x6a
    v_lshl_add_u32 v29, v8, 4, v136
    s_add_u32 m0, s88, 0
    s_mov_b64 exec, 0xffffffff
    buffer_load_dwordx4 v3, s[28:31], s97 offen offset:0  lds
    s_mov_b64 exec, -1
    v_add_u32 v29, 91136, v29
    v_subrev_u32 v7, 1, v7
    v_bitop3_b32 v8, v7, 3, s3 bitop3:0x6a
    s_waitcnt vmcnt(11)
    s_barrier
    s_mul_i32 s16, s97, 3072
    s_add_u32 m0, s60, 0
    s_add_u32 s99, s16, s62
    buffer_load_dwordx4 v244, s[32:35], s99 offen offset:0  lds
    v_lshl_add_u32 v31, v8, 4, v136
    v_add_u32 v31, 90624, v31
    v_lshl_add_u32 v7, v5, 1, v6
    v_add_u32 v7, 26, v7
    buffer_load_dwordx4 v245, s[32:35], s99 offen offset:1024  lds
    v_and_b32 v8, 1, v7
    v_bfe_u32 v136, v7, 1, 2
    v_lshl_add_u32 v136, v8, 2, v136
    v_lshlrev_b32 v136, 6, v136
    buffer_load_dwordx4 v246, s[32:35], s99 offen offset:2048  lds
    v_lshrrev_b32 v7, 3, v7
    v_lshl_add_u32 v136, v7, 9, v136
    v_bitop3_b32 v8, v7, 3, s3 bitop3:0x6a
    s_add_u32 m0, s61, 12288
    s_add_u32 s16, s16, s63
    buffer_load_dwordx4 v244, s[32:35], s16 offen offset:0  lds
    v_lshl_add_u32 v26, v8, 4, v136
    v_add_u32 v26, 92160, v26
    v_subrev_u32 v7, 1, v7
    v_bitop3_b32 v8, v7, 3, s3 bitop3:0x6a
    buffer_load_dwordx4 v245, s[32:35], s16 offen offset:1024  lds
    v_lshl_add_u32 v28, v8, 4, v136
    v_add_u32 v28, 91648, v28
    v_subrev_u32 v7, 1, v7
    v_bitop3_b32 v8, v7, 3, s3 bitop3:0x6a
    buffer_load_dwordx4 v246, s[32:35], s16 offen offset:2048  lds
    v_lshl_add_u32 v30, v8, 4, v136
    v_add_u32 v30, 91136, v30
    v_subrev_u32 v7, 1, v7
    s_add_u32 s97, s98, s0
    s_lshr_b64 s[0:1], s[0:1], 4
    s_and_b32 s97, s97, 15
    s_add_u32 m0, s87, 18432
    s_lshl_b32 s97, s97, 7
    buffer_load_dwordx4 v240, s[28:31], s97 offen offset:0  lds
    v_bitop3_b32 v8, v7, 3, s3 bitop3:0x6a
    v_lshl_add_u32 v32, v8, 4, v136
    v_add_u32 v32, 90624, v32
    v_lshrrev_b32 v7, 1, v6
    buffer_load_dwordx4 v241, s[28:31], s97 offen offset:1024  lds
    v_lshl_add_u32 v7, v5, 1, v7
    v_add_u32 v7, 32, v7
    v_and_b32 v8, 1, v7
    v_bfe_u32 v136, v7, 1, 2
    buffer_load_dwordx4 v242, s[28:31], s97 offen offset:2048  lds
    v_lshl_add_u32 v136, v8, 2, v136
    v_lshlrev_b32 v136, 6, v136
    v_lshrrev_b32 v7, 3, v7
    buffer_load_dwordx4 v243, s[28:31], s97 offen offset:3072  lds
    v_lshl_add_u32 v136, v7, 9, v136
    v_bitop3_b32 v8, v7, 3, s3 bitop3:0x6a
    v_lshl_add_u32 v20, v8, 4, v136
    v_add_u32 v20, 92160, v20
    s_add_u32 m0, s88, 18432
    s_mov_b64 exec, 0xffffffff
    buffer_load_dwordx4 v3, s[28:31], s97 offen offset:0  lds
    s_mov_b64 exec, -1
    v_and_b32 v8, 1, v6
    v_xor_b32 v8, 1, v8
    v_lshl_add_u32 v20, v8, 3, v20
    s_waitcnt vmcnt(11)
    s_barrier
    s_mul_i32 s16, s97, 3072
    s_add_u32 m0, s60, 24576
    s_add_u32 s99, s16, s62
    buffer_load_dwordx4 v244, s[32:35], s99 offen offset:0  lds
    s_waitcnt lgkmcnt(0)
    s_and_b32 s78, s92, 0xffff0000
    s_lshl_b32 s92, s92, 16
    buffer_load_dwordx4 v245, s[32:35], s99 offen offset:1024  lds
    s_bitcmp1_b32 s90, 0
    s_cselect_b32 s92, s78, s92
    v_lshlrev_b32 v7, 3, v6
    v_sub_u32 v7, v7, v5
    buffer_load_dwordx4 v246, s[32:35], s99 offen offset:2048  lds
    v_subrev_u32 v7, 9, v7
    v_and_b32 v8, 1, v7
    v_xor_b32 v8, 1, v8
    s_add_u32 m0, s61, 36864
    s_add_u32 s16, s16, s63
    buffer_load_dwordx4 v244, s[32:35], s16 offen offset:0  lds
    v_lshlrev_b32 v8, 4, v8
    v_lshrrev_b32 v8, v8, s92
    v_ashrrev_i32 v7, 1, v7
    buffer_load_dwordx4 v245, s[32:35], s16 offen offset:1024  lds
    v_cmp_eq_u32 vcc, 0, v7
    s_nop 1
    v_cndmask_b32 v236, 0, v8, vcc
    v_cmp_eq_u32 vcc, 1, v7
    buffer_load_dwordx4 v246, s[32:35], s16 offen offset:2048  lds
    s_nop 0
    v_cndmask_b32 v237, 0, v8, vcc
    v_cmp_eq_u32 vcc, 2, v7
    s_nop 1
    v_cndmask_b32 v238, 0, v8, vcc
    s_add_u32 s97, s98, s0
    s_lshr_b64 s[0:1], s[0:1], 4
    s_and_b32 s97, s97, 15
    s_add_u32 m0, s87, 36864
    s_lshl_b32 s97, s97, 7
    buffer_load_dwordx4 v240, s[28:31], s97 offen offset:0  lds
    v_cmp_eq_u32 vcc, 3, v7
    s_nop 1
    v_cndmask_b32 v239, 0, v8, vcc
    s_and_b32 s78, s77, 7
    s_mov_b32 s95, 0x76543210
    s_and_b32 s78, s76, 3
    s_mul_i32 s78, s78, 0x22222222
    s_add_u32 s95, s95, s78
    s_bfe_u32 s17, s95, 0x30000
    s_lshl_b32 s17, s17, 18
    s_bfe_u32 s18, s95, 0x30004
    s_lshl_b32 s18, s18, 18
    s_bfe_u32 s100, s95, 0x3001c
    s_lshl_b32 s100, s100, 18
    s_bfe_u32 s95, s95, 0x30018
    s_lshl_b32 s95, s95, 18
    buffer_load_dwordx4 v241, s[28:31], s97 offen offset:1024  lds
    v_lshrrev_b32 v136, 4, v0
    v_lshlrev_b32 v136, 1, v136
    v_and_b32 v137, 7, v0
    buffer_load_dwordx4 v242, s[28:31], s97 offen offset:2048  lds
    v_xor_b32 v136, v136, v137
    v_lshlrev_b32 v136, 4, v136
    v_lshrrev_b32 v137, 3, v0
    buffer_load_dwordx4 v243, s[28:31], s97 offen offset:3072  lds
    v_lshl_add_u32 v136, v137, 11, v136
    s_lshl_b32 s78, s77, 7
    s_lshl_b32 s79, s3, 14
    s_add_u32 m0, s88, 36864
    s_mov_b64 exec, 0xffffffff
    buffer_load_dwordx4 v3, s[28:31], s97 offen offset:0  lds
    s_mov_b64 exec, -1
    s_add_u32 s78, s78, s79
    v_add_u32 v17, s78, v136
    s_waitcnt vmcnt(11)
    s_barrier
    s_mul_i32 s16, s97, 3072
    s_add_u32 m0, s60, 49152
    s_add_u32 s99, s16, s62
    buffer_load_dwordx4 v244, s[32:35], s99 offen offset:0  lds
    v_add_u32 v5, s94, v15
    ds_read_b128 v[140:143], v5 offset:32
    ds_read_b32 v156, v5 offset:48
    ds_read_b128 v[144:147], v5 offset:1056
    buffer_load_dwordx4 v245, s[32:35], s99 offen offset:1024  lds
    ds_read_b32 v157, v5 offset:1072
    ds_read_b128 v[148:151], v5 offset:2080
    ds_read_b32 v158, v5 offset:2096
    ds_read_b128 v[152:155], v5 offset:3104
    buffer_load_dwordx4 v246, s[32:35], s99 offen offset:2048  lds
    ds_read_b32 v159, v5 offset:3120
    v_lshrrev_b32 v6, 3, v0
    v_mul_u32_u24 v6, 4160, v6
    s_add_u32 m0, s61, 61440
    s_add_u32 s16, s16, s63
    buffer_load_dwordx4 v244, s[32:35], s16 offen offset:0  lds
    v_and_b32 v7, 7, v0
    v_lshl_add_u32 v6, v7, 2, v6
    v_add_u32 v6, s94, v6
    v_mov_b32 v7, 0
    buffer_load_dwordx4 v245, s[32:35], s16 offen offset:1024  lds
    s_waitcnt lgkmcnt(0)
    v_readfirstlane_b32 s93, v140
    s_nop 0
    s_lshl_b32 s93, s93, 16
    s_nop 1
    v_writelane_b32 v7, s93, 15
    buffer_load_dwordx4 v246, s[32:35], s16 offen offset:2048  lds
    v_alignbit_b32 v140, v141, v140, 16
    v_alignbit_b32 v141, v142, v141, 16
    v_alignbit_b32 v142, v143, v142, 16
    s_add_u32 s97, s98, s0
    s_lshr_b64 s[0:1], s[0:1], 4
    s_and_b32 s97, s97, 15
    s_add_u32 m0, s87, 0
    s_lshl_b32 s97, s97, 7
    buffer_load_dwordx4 v240, s[28:31], s97 offen offset:0  lds
    v_alignbit_b32 v143, v156, v143, 16
    v_alignbit_b32 v144, v145, v144, 16
    v_alignbit_b32 v145, v146, v145, 16
    v_alignbit_b32 v146, v147, v146, 16
    buffer_load_dwordx4 v241, s[28:31], s97 offen offset:1024  lds
    v_alignbit_b32 v147, v157, v147, 16
    v_alignbit_b32 v148, v149, v148, 16
    v_alignbit_b32 v149, v150, v149, 16
    v_alignbit_b32 v150, v151, v150, 16
    buffer_load_dwordx4 v242, s[28:31], s97 offen offset:2048  lds
    v_alignbit_b32 v151, v158, v151, 16
    v_alignbit_b32 v152, v153, v152, 16
    v_alignbit_b32 v153, v154, v153, 16
    buffer_load_dwordx4 v243, s[28:31], s97 offen offset:3072  lds
    v_alignbit_b32 v154, v155, v154, 16
    v_alignbit_b32 v155, v159, v155, 16
    v_lshlrev_b32 v8, 3, v0
    s_add_u32 s78, s88, 18432
    s_add_u32 m0, s88, 0
    s_mov_b64 exec, 0xffffffff
    buffer_load_dwordx4 v3, s[28:31], s97 offen offset:0  lds
    s_mov_b64 exec, -1
    v_add_u32 v8, s78, v8
    v_mov_b32 v156, 0
    v_mov_b32 v157, 0
    s_waitcnt vmcnt(11)
    s_barrier
    s_mul_i32 s16, s97, 3072
    s_add_u32 m0, s60, 0
    s_add_u32 s99, s16, s62
    buffer_load_dwordx4 v244, s[32:35], s99 offen offset:0  lds
    buffer_load_dwordx4 v245, s[32:35], s99 offen offset:1024  lds
    buffer_load_dwordx4 v246, s[32:35], s99 offen offset:2048  lds
    s_add_u32 m0, s61, 12288
    s_add_u32 s16, s16, s63
    buffer_load_dwordx4 v244, s[32:35], s16 offen offset:0  lds
    buffer_load_dwordx4 v245, s[32:35], s16 offen offset:1024  lds
    buffer_load_dwordx4 v246, s[32:35], s16 offen offset:2048  lds
    s_mov_b64 exec, 0xff
    buffer_load_dword v136, v33, s[68:71], 0 offen sc1
    buffer_load_dword v137, v34, s[52:55], 0 offen sc1
    s_mov_b64 exec, -1
    buffer_load_dwordx4 v[212:215], v9, s[56:59], 0 offen offset:0 nt
    buffer_load_dwordx4 v[216:219], v9, s[56:59], 0 offen offset:2048 nt
    buffer_load_dwordx4 v[220:223], v9, s[56:59], s96 offen offset:0 nt
    buffer_load_dwordx4 v[224:227], v9, s[56:59], s96 offen offset:2048 nt
    s_waitcnt vmcnt(12)
    s_waitcnt vmcnt(6)
    s_barrier
    s_waitcnt vmcnt(4)
    s_branch LA_j
LA_c2:
    s_waitcnt vmcnt(8)
    s_barrier
    buffer_load_dwordx4 v242, s[28:31], s97 offen offset:2048  lds
    buffer_load_dwordx4 v243, s[28:31], s97 offen offset:3072  lds
    s_add_u32 m0, s88, 36864
    s_mov_b64 exec, 0xffffffff
    buffer_load_dwordx4 v3, s[28:31], s97 offen offset:0  lds
    s_mov_b64 exec, -1
    s_mul_i32 s16, s97, 3072
    s_add_u32 m0, s60, 49152
    s_add_u32 s99, s16, s62
    buffer_load_dwordx4 v244, s[32:35], s99 offen offset:0  lds
    buffer_load_dwordx4 v245, s[32:35], s99 offen offset:1024  lds
    buffer_load_dwordx4 v246, s[32:35], s99 offen offset:2048  lds
    s_add_u32 m0, s61, 61440
    s_add_u32 s16, s16, s63
    buffer_load_dwordx4 v244, s[32:35], s16 offen offset:0  lds
    buffer_load_dwordx4 v245, s[32:35], s16 offen offset:1024  lds
    buffer_load_dwordx4 v246, s[32:35], s16 offen offset:2048  lds
    s_add_u32 s97, s98, s0
    s_lshr_b64 s[0:1], s[0:1], 4
    s_and_b32 s97, s97, 15
    s_add_u32 m0, s87, 0
    s_lshl_b32 s97, s97, 7
    buffer_load_dwordx4 v240, s[28:31], s97 offen offset:0  lds
    buffer_load_dwordx4 v241, s[28:31], s97 offen offset:1024  lds
    buffer_load_dwordx4 v242, s[28:31], s97 offen offset:2048  lds
    buffer_load_dwordx4 v243, s[28:31], s97 offen offset:3072  lds
    s_add_u32 m0, s88, 0
    s_mov_b64 exec, 0xffffffff
    buffer_load_dwordx4 v3, s[28:31], s97 offen offset:0  lds
    s_mov_b64 exec, -1
    s_waitcnt vmcnt(11)
    s_barrier
    s_mul_i32 s16, s97, 3072
    s_add_u32 m0, s60, 0
    s_add_u32 s99, s16, s62
    buffer_load_dwordx4 v244, s[32:35], s99 offen offset:0  lds
    buffer_load_dwordx4 v245, s[32:35], s99 offen offset:1024  lds
    buffer_load_dwordx4 v246, s[32:35], s99 offen offset:2048  lds
    s_add_u32 m0, s61, 12288
    s_add_u32 s16, s16, s63
    buffer_load_dwordx4 v244, s[32:35], s16 offen offset:0  lds
    buffer_load_dwordx4 v245, s[32:35], s16 offen offset:1024  lds
    buffer_load_dwordx4 v246, s[32:35], s16 offen offset:2048  lds
    s_add_u32 s97, s98, s0
    s_lshr_b64 s[0:1], s[0:1], 4
    s_and_b32 s97, s97, 15
    s_add_u32 m0, s87, 18432
    s_lshl_b32 s97, s97, 7
    buffer_load_dwordx4 v240, s[28:31], s97 offen offset:0  lds
    buffer_load_dwordx4 v241, s[28:31], s97 offen offset:1024  lds
    buffer_load_dwordx4 v242, s[28:31], s97 offen offset:2048  lds
    buffer_load_dwordx4 v243, s[28:31], s97 offen offset:3072  lds
    s_add_u32 m0, s88, 18432
    s_mov_b64 exec, 0xffffffff
    buffer_load_dwordx4 v3, s[28:31], s97 offen offset:0  lds
    s_mov_b64 exec, -1
    s_waitcnt vmcnt(11)
    s_barrier
    s_mul_i32 s16, s97, 3072
    s_add_u32 m0, s60, 24576
    s_add_u32 s99, s16, s62
    buffer_load_dwordx4 v244, s[32:35], s99 offen offset:0  lds
    buffer_load_dwordx4 v245, s[32:35], s99 offen offset:1024  lds
    buffer_load_dwordx4 v246, s[32:35], s99 offen offset:2048  lds
    s_add_u32 m0, s61, 36864
    s_add_u32 s16, s16, s63
    buffer_load_dwordx4 v244, s[32:35], s16 offen offset:0  lds
    buffer_load_dwordx4 v245, s[32:35], s16 offen offset:1024  lds
    buffer_load_dwordx4 v246, s[32:35], s16 offen offset:2048  lds
    s_add_u32 m0, s86, 129536
    s_mov_b32 s89, 0
    buffer_load_dwordx4 v10, s[36:39], s89 offen nt lds
    s_add_u32 m0, s86, 145920
    s_mov_b32 s89, 0
    buffer_load_dwordx4 v10, s[40:43], s89 offen nt lds
    s_add_u32 m0, s86, 133632
    s_mov_b32 s89, 65536
    buffer_load_dwordx4 v10, s[36:39], s89 offen nt lds
    s_add_u32 m0, s86, 150016
    s_mov_b32 s89, 65536
    buffer_load_dwordx4 v10, s[40:43], s89 offen nt lds
    s_add_u32 m0, s86, 137728
    s_mov_b32 s89, 131072
    buffer_load_dwordx4 v10, s[36:39], s89 offen nt lds
    s_add_u32 m0, s86, 154112
    s_mov_b32 s89, 131072
    buffer_load_dwordx4 v10, s[40:43], s89 offen nt lds
    s_add_u32 m0, s86, 141824
    s_mov_b32 s89, 196608
    buffer_load_dwordx4 v10, s[36:39], s89 offen nt lds
    s_add_u32 m0, s86, 158208
    s_mov_b32 s89, 196608
    buffer_load_dwordx4 v10, s[40:43], s89 offen nt lds
    s_mov_b64 exec, 0xff
    s_lshl_b32 s82, s3, 7
    s_add_u32 m0, s82, 129024
    s_mov_b32 s89, 0
    buffer_load_dwordx4 v11, s[36:39], s89 offen nt lds
    s_lshl_b32 s83, s74, 9
    s_add_u32 s83, s83, s82
    s_and_b32 s89, s3, 2
    s_lshl_b32 s89, s89, 3
    s_add_u32 s82, s82, s89
    s_add_u32 m0, s82, 162816
    s_add_u32 s89, s83, 0
    buffer_load_dwordx4 v15, s[44:47], s89 offen  lds
    s_mov_b64 exec, -1
    s_add_u32 s97, s98, s0
    s_lshr_b64 s[0:1], s[0:1], 4
    s_and_b32 s97, s97, 15
    s_add_u32 m0, s87, 36864
    s_lshl_b32 s97, s97, 7
    buffer_load_dwordx4 v240, s[28:31], s97 offen offset:0  lds
    s_waitcnt vmcnt(17)
    s_barrier
    buffer_load_dwordx4 v241, s[28:31], s97 offen offset:1024  lds
    buffer_load_dwordx4 v242, s[28:31], s97 offen offset:2048  lds
    buffer_load_dwordx4 v243, s[28:31], s97 offen offset:3072  lds
    s_add_u32 m0, s88, 36864
    s_mov_b64 exec, 0xffffffff
    buffer_load_dwordx4 v3, s[28:31], s97 offen offset:0  lds
    s_mov_b64 exec, -1
    s_mul_i32 s16, s97, 3072
    s_add_u32 m0, s60, 49152
    s_add_u32 s99, s16, s62
    buffer_load_dwordx4 v244, s[32:35], s99 offen offset:0  lds
    buffer_load_dwordx4 v245, s[32:35], s99 offen offset:1024  lds
    buffer_load_dwordx4 v246, s[32:35], s99 offen offset:2048  lds
    s_add_u32 m0, s61, 61440
    s_add_u32 s16, s16, s63
    buffer_load_dwordx4 v244, s[32:35], s16 offen offset:0  lds
    buffer_load_dwordx4 v245, s[32:35], s16 offen offset:1024  lds
    buffer_load_dwordx4 v246, s[32:35], s16 offen offset:2048  lds
    s_add_u32 s97, s98, s0
    s_lshr_b64 s[0:1], s[0:1], 4
    s_and_b32 s97, s97, 15
    s_add_u32 m0, s87, 0
    s_lshl_b32 s97, s97, 7
    buffer_load_dwordx4 v240, s[28:31], s97 offen offset:0  lds
    buffer_load_dwordx4 v241, s[28:31], s97 offen offset:1024  lds
    buffer_load_dwordx4 v242, s[28:31], s97 offen offset:2048  lds
    buffer_load_dwordx4 v243, s[28:31], s97 offen offset:3072  lds
    s_add_u32 m0, s88, 0
    s_mov_b64 exec, 0xffffffff
    buffer_load_dwordx4 v3, s[28:31], s97 offen offset:0  lds
    s_mov_b64 exec, -1
    s_waitcnt vmcnt(11)
    s_barrier
    s_mul_i32 s16, s97, 3072
    s_add_u32 m0, s60, 0
    s_add_u32 s99, s16, s62
    buffer_load_dwordx4 v244, s[32:35], s99 offen offset:0  lds
    ds_read_b128 v[84:87], v35 offset:0
    ds_read_b128 v[88:91], v35 offset:16
    buffer_load_dwordx4 v245, s[32:35], s99 offen offset:1024  lds
    ds_read_b64 v[40:41], v16 offset:0
    ds_read_b64 v[42:43], v231 offset:256
    buffer_load_dwordx4 v246, s[32:35], s99 offen offset:2048  lds
    ds_read_b64 v[44:45], v16 offset:256
    ds_read_b64 v[46:47], v16 offset:512
    s_add_u32 m0, s61, 12288
    s_add_u32 s16, s16, s63
    buffer_load_dwordx4 v244, s[32:35], s16 offen offset:0  lds
    ds_read_b64 v[48:49], v231 offset:512
    ds_read_b64 v[50:51], v16 offset:768
    buffer_load_dwordx4 v245, s[32:35], s16 offen offset:1024  lds
    ds_read_b64 v[52:53], v231 offset:768
    ds_read_b64 v[54:55], v16 offset:1024
    buffer_load_dwordx4 v246, s[32:35], s16 offen offset:2048  lds
    ds_read_b64 v[56:57], v231 offset:1024
    ds_read_b64 v[58:59], v16 offset:1280
    s_add_u32 s97, s98, s0
    s_lshr_b64 s[0:1], s[0:1], 4
    s_and_b32 s97, s97, 15
    s_add_u32 m0, s87, 18432
    s_lshl_b32 s97, s97, 7
    buffer_load_dwordx4 v240, s[28:31], s97 offen offset:0  lds
    ds_read_b64 v[60:61], v231 offset:1280
    ds_read_b64 v[68:69], v16 offset:16896
    buffer_load_dwordx4 v241, s[28:31], s97 offen offset:1024  lds
    ds_read_b64 v[70:71], v231 offset:16896
    ds_read_b64 v[72:73], v16 offset:17152
    buffer_load_dwordx4 v242, s[28:31], s97 offen offset:2048  lds
    ds_read_b64 v[74:75], v231 offset:17152
    ds_read_b64 v[76:77], v16 offset:17408
    buffer_load_dwordx4 v243, s[28:31], s97 offen offset:3072  lds
    ds_read_b64 v[78:79], v231 offset:17408
    ds_read_b64 v[80:81], v16 offset:17664
    s_add_u32 m0, s88, 18432
    s_mov_b64 exec, 0xffffffff
    buffer_load_dwordx4 v3, s[28:31], s97 offen offset:0  lds
    s_mov_b64 exec, -1
    ds_read_b64 v[82:83], v231 offset:17664
    s_waitcnt vmcnt(11)
    s_waitcnt lgkmcnt(0)
    s_barrier
    s_mul_i32 s16, s97, 3072
    s_add_u32 m0, s60, 24576
    s_add_u32 s99, s16, s62
    buffer_load_dwordx4 v244, s[32:35], s99 offen offset:0  lds
    v_lshlrev_b32 v160, 16, v40
    v_lshlrev_b32 v161, 16, v42
    v_lshlrev_b32 v162, 16, v44
    v_lshlrev_b32 v163, 16, v46
    v_lshlrev_b32 v164, 16, v48
    buffer_load_dwordx4 v245, s[32:35], s99 offen offset:1024  lds
    v_lshlrev_b32 v165, 16, v50
    v_lshlrev_b32 v166, 16, v52
    v_lshlrev_b32 v167, 16, v54
    v_lshlrev_b32 v168, 16, v56
    v_lshlrev_b32 v169, 16, v58
    buffer_load_dwordx4 v246, s[32:35], s99 offen offset:2048  lds
    v_lshlrev_b32 v170, 16, v60
    v_lshlrev_b32 v172, 16, v84
    v_and_b32 v173, 0xffff0000, v84
    v_lshlrev_b32 v174, 16, v85
    v_and_b32 v175, 0xffff0000, v85
    s_add_u32 m0, s61, 36864
    s_add_u32 s16, s16, s63
    buffer_load_dwordx4 v244, s[32:35], s16 offen offset:0  lds
    v_lshlrev_b32 v176, 16, v68
    v_lshlrev_b32 v177, 16, v70
    v_lshlrev_b32 v178, 16, v72
    v_lshlrev_b32 v179, 16, v74
    v_lshlrev_b32 v180, 16, v76
    buffer_load_dwordx4 v245, s[32:35], s16 offen offset:1024  lds
    v_lshlrev_b32 v181, 16, v78
    v_lshlrev_b32 v182, 16, v80
    v_lshlrev_b32 v183, 16, v82
    v_mul_f32 v184, v160, v175
    v_mul_f32 v185, v161, v175
    buffer_load_dwordx4 v246, s[32:35], s16 offen offset:2048  lds
    v_mul_f32 v186, v162, v175
    v_mul_f32 v187, v163, v175
    v_mul_f32 v188, v164, v175
    v_mul_f32 v189, v165, v175
    v_mul_f32 v190, v166, v175
    s_add_u32 s97, s98, s0
    s_lshr_b64 s[0:1], s[0:1], 4
    s_and_b32 s97, s97, 15
    s_add_u32 m0, s87, 36864
    s_lshl_b32 s97, s97, 7
    buffer_load_dwordx4 v240, s[28:31], s97 offen offset:0  lds
    v_mul_f32 v191, v167, v175
    v_fmac_f32 v184, v161, v174
    v_fmac_f32 v185, v162, v174
    v_fmac_f32 v186, v163, v174
    v_fmac_f32 v187, v164, v174
    buffer_load_dwordx4 v241, s[28:31], s97 offen offset:1024  lds
    v_fmac_f32 v188, v165, v174
    v_fmac_f32 v189, v166, v174
    v_fmac_f32 v190, v167, v174
    v_fmac_f32 v191, v168, v174
    v_fmac_f32 v184, v162, v173
    buffer_load_dwordx4 v242, s[28:31], s97 offen offset:2048  lds
    v_fmac_f32 v185, v163, v173
    v_fmac_f32 v186, v164, v173
    v_fmac_f32 v187, v165, v173
    v_fmac_f32 v188, v166, v173
    v_fmac_f32 v189, v167, v173
    buffer_load_dwordx4 v243, s[28:31], s97 offen offset:3072  lds
    v_fmac_f32 v190, v168, v173
    v_fmac_f32 v191, v169, v173
    v_fmac_f32 v184, v163, v172
    v_fmac_f32 v185, v164, v172
    v_fmac_f32 v186, v165, v172
    s_add_u32 m0, s88, 36864
    s_mov_b64 exec, 0xffffffff
    buffer_load_dwordx4 v3, s[28:31], s97 offen offset:0  lds
    s_mov_b64 exec, -1
    v_fmac_f32 v187, v166, v172
    v_fmac_f32 v188, v167, v172
    v_fmac_f32 v189, v168, v172
    v_fmac_f32 v190, v169, v172
    v_fmac_f32 v191, v170, v172
    v_mul_f32 v184, v184, v176
    v_mul_f32 v185, v185, v177
    v_mul_f32 v186, v186, v178
    v_mul_f32 v187, v187, v179
    v_mul_f32 v188, v188, v180
    v_mul_f32 v189, v189, v181
    v_mul_f32 v190, v190, v182
    v_mul_f32 v191, v191, v183
    v_cvt_pk_bf16_f32 v100, v191, v190
    v_cvt_pk_bf16_f32 v101, v189, v188
    v_cvt_pk_bf16_f32 v102, v187, v186
    v_cvt_pk_bf16_f32 v103, v185, v184
    s_mov_b32 s89, 0
    buffer_store_dwordx4 v[100:103], v12, s[52:55], s89 offen sc1
    v_and_b32 v160, 0xffff0000, v40
    v_and_b32 v161, 0xffff0000, v42
    v_and_b32 v162, 0xffff0000, v44
    v_and_b32 v163, 0xffff0000, v46
    v_and_b32 v164, 0xffff0000, v48
    v_and_b32 v165, 0xffff0000, v50
    v_and_b32 v166, 0xffff0000, v52
    v_and_b32 v167, 0xffff0000, v54
    v_and_b32 v168, 0xffff0000, v56
    v_and_b32 v169, 0xffff0000, v58
    v_and_b32 v170, 0xffff0000, v60
    v_lshlrev_b32 v172, 16, v86
    v_and_b32 v173, 0xffff0000, v86
    v_lshlrev_b32 v174, 16, v87
    v_and_b32 v175, 0xffff0000, v87
    v_and_b32 v176, 0xffff0000, v68
    v_and_b32 v177, 0xffff0000, v70
    v_and_b32 v178, 0xffff0000, v72
    v_and_b32 v179, 0xffff0000, v74
    v_and_b32 v180, 0xffff0000, v76
    v_and_b32 v181, 0xffff0000, v78
    v_and_b32 v182, 0xffff0000, v80
    v_and_b32 v183, 0xffff0000, v82
    s_waitcnt vmcnt(12)
    s_barrier
    s_mul_i32 s16, s97, 3072
    s_add_u32 m0, s60, 49152
    s_add_u32 s99, s16, s62
    buffer_load_dwordx4 v244, s[32:35], s99 offen offset:0  lds
    v_mul_f32 v184, v160, v175
    v_mul_f32 v185, v161, v175
    v_mul_f32 v186, v162, v175
    v_mul_f32 v187, v163, v175
    v_mul_f32 v188, v164, v175
    buffer_load_dwordx4 v245, s[32:35], s99 offen offset:1024  lds
    v_mul_f32 v189, v165, v175
    v_mul_f32 v190, v166, v175
    v_mul_f32 v191, v167, v175
    v_fmac_f32 v184, v161, v174
    v_fmac_f32 v185, v162, v174
    buffer_load_dwordx4 v246, s[32:35], s99 offen offset:2048  lds
    v_fmac_f32 v186, v163, v174
    v_fmac_f32 v187, v164, v174
    v_fmac_f32 v188, v165, v174
    v_fmac_f32 v189, v166, v174
    v_fmac_f32 v190, v167, v174
    s_add_u32 m0, s61, 61440
    s_add_u32 s16, s16, s63
    buffer_load_dwordx4 v244, s[32:35], s16 offen offset:0  lds
    v_fmac_f32 v191, v168, v174
    v_fmac_f32 v184, v162, v173
    v_fmac_f32 v185, v163, v173
    v_fmac_f32 v186, v164, v173
    v_fmac_f32 v187, v165, v173
    buffer_load_dwordx4 v245, s[32:35], s16 offen offset:1024  lds
    v_fmac_f32 v188, v166, v173
    v_fmac_f32 v189, v167, v173
    v_fmac_f32 v190, v168, v173
    v_fmac_f32 v191, v169, v173
    v_fmac_f32 v184, v163, v172
    buffer_load_dwordx4 v246, s[32:35], s16 offen offset:2048  lds
    v_fmac_f32 v185, v164, v172
    v_fmac_f32 v186, v165, v172
    v_fmac_f32 v187, v166, v172
    v_fmac_f32 v188, v167, v172
    v_fmac_f32 v189, v168, v172
    s_add_u32 s97, s98, s0
    s_lshr_b64 s[0:1], s[0:1], 4
    s_and_b32 s97, s97, 15
    s_add_u32 m0, s87, 0
    s_lshl_b32 s97, s97, 7
    buffer_load_dwordx4 v240, s[28:31], s97 offen offset:0  lds
    v_fmac_f32 v190, v169, v172
    v_fmac_f32 v191, v170, v172
    v_mul_f32 v184, v184, v176
    v_mul_f32 v185, v185, v177
    v_mul_f32 v186, v186, v178
    buffer_load_dwordx4 v241, s[28:31], s97 offen offset:1024  lds
    v_mul_f32 v187, v187, v179
    v_mul_f32 v188, v188, v180
    v_mul_f32 v189, v189, v181
    v_mul_f32 v190, v190, v182
    v_mul_f32 v191, v191, v183
    buffer_load_dwordx4 v242, s[28:31], s97 offen offset:2048  lds
    v_cvt_pk_bf16_f32 v104, v191, v190
    v_cvt_pk_bf16_f32 v105, v189, v188
    v_cvt_pk_bf16_f32 v106, v187, v186
    v_cvt_pk_bf16_f32 v107, v185, v184
    s_mov_b32 s89, 16384
    buffer_store_dwordx4 v[104:107], v12, s[52:55], s89 offen sc1
    buffer_load_dwordx4 v243, s[28:31], s97 offen offset:3072  lds
    v_lshlrev_b32 v160, 16, v41
    v_lshlrev_b32 v161, 16, v43
    v_lshlrev_b32 v162, 16, v45
    v_lshlrev_b32 v163, 16, v47
    v_lshlrev_b32 v164, 16, v49
    s_add_u32 m0, s88, 0
    s_mov_b64 exec, 0xffffffff
    buffer_load_dwordx4 v3, s[28:31], s97 offen offset:0  lds
    s_mov_b64 exec, -1
    v_lshlrev_b32 v165, 16, v51
    v_lshlrev_b32 v166, 16, v53
    v_lshlrev_b32 v167, 16, v55
    v_lshlrev_b32 v168, 16, v57
    v_lshlrev_b32 v169, 16, v59
    v_lshlrev_b32 v170, 16, v61
    v_lshlrev_b32 v172, 16, v88
    v_and_b32 v173, 0xffff0000, v88
    v_lshlrev_b32 v174, 16, v89
    v_and_b32 v175, 0xffff0000, v89
    v_lshlrev_b32 v176, 16, v69
    v_lshlrev_b32 v177, 16, v71
    v_lshlrev_b32 v178, 16, v73
    v_lshlrev_b32 v179, 16, v75
    v_lshlrev_b32 v180, 16, v77
    v_lshlrev_b32 v181, 16, v79
    v_lshlrev_b32 v182, 16, v81
    v_lshlrev_b32 v183, 16, v83
    v_mul_f32 v184, v160, v175
    v_mul_f32 v185, v161, v175
    v_mul_f32 v186, v162, v175
    v_mul_f32 v187, v163, v175
    v_mul_f32 v188, v164, v175
    v_mul_f32 v189, v165, v175
    v_mul_f32 v190, v166, v175
    v_mul_f32 v191, v167, v175
    v_fmac_f32 v184, v161, v174
    v_fmac_f32 v185, v162, v174
    v_fmac_f32 v186, v163, v174
    v_fmac_f32 v187, v164, v174
    v_fmac_f32 v188, v165, v174
    v_fmac_f32 v189, v166, v174
    v_fmac_f32 v190, v167, v174
    v_fmac_f32 v191, v168, v174
    v_fmac_f32 v184, v162, v173
    v_fmac_f32 v185, v163, v173
    v_fmac_f32 v186, v164, v173
    v_fmac_f32 v187, v165, v173
    v_fmac_f32 v188, v166, v173
    v_fmac_f32 v189, v167, v173
    v_fmac_f32 v190, v168, v173
    s_waitcnt vmcnt(13)
    s_barrier
    s_mul_i32 s16, s97, 3072
    s_add_u32 m0, s60, 0
    s_add_u32 s99, s16, s62
    buffer_load_dwordx4 v244, s[32:35], s99 offen offset:0  lds
    v_fmac_f32 v191, v169, v173
    v_fmac_f32 v184, v163, v172
    v_fmac_f32 v185, v164, v172
    v_fmac_f32 v186, v165, v172
    v_fmac_f32 v187, v166, v172
    buffer_load_dwordx4 v245, s[32:35], s99 offen offset:1024  lds
    v_fmac_f32 v188, v167, v172
    v_fmac_f32 v189, v168, v172
    v_fmac_f32 v190, v169, v172
    v_fmac_f32 v191, v170, v172
    v_mul_f32 v184, v184, v176
    buffer_load_dwordx4 v246, s[32:35], s99 offen offset:2048  lds
    v_mul_f32 v185, v185, v177
    v_mul_f32 v186, v186, v178
    v_mul_f32 v187, v187, v179
    v_mul_f32 v188, v188, v180
    v_mul_f32 v189, v189, v181
    s_add_u32 m0, s61, 12288
    s_add_u32 s16, s16, s63
    buffer_load_dwordx4 v244, s[32:35], s16 offen offset:0  lds
    v_mul_f32 v190, v190, v182
    v_mul_f32 v191, v191, v183
    v_cvt_pk_bf16_f32 v108, v191, v190
    v_cvt_pk_bf16_f32 v109, v189, v188
    v_cvt_pk_bf16_f32 v110, v187, v186
    buffer_load_dwordx4 v245, s[32:35], s16 offen offset:1024  lds
    v_cvt_pk_bf16_f32 v111, v185, v184
    s_mov_b32 s89, 32768
    buffer_store_dwordx4 v[108:111], v12, s[52:55], s89 offen sc1
    v_and_b32 v160, 0xffff0000, v41
    v_and_b32 v161, 0xffff0000, v43
    v_and_b32 v162, 0xffff0000, v45
    buffer_load_dwordx4 v246, s[32:35], s16 offen offset:2048  lds
    v_and_b32 v163, 0xffff0000, v47
    v_and_b32 v164, 0xffff0000, v49
    v_and_b32 v165, 0xffff0000, v51
    v_and_b32 v166, 0xffff0000, v53
    v_and_b32 v167, 0xffff0000, v55
    s_add_u32 s97, s98, s0
    s_lshr_b64 s[0:1], s[0:1], 4
    s_and_b32 s97, s97, 15
    s_add_u32 m0, s87, 18432
    s_lshl_b32 s97, s97, 7
    buffer_load_dwordx4 v240, s[28:31], s97 offen offset:0  lds
    v_and_b32 v168, 0xffff0000, v57
    v_and_b32 v169, 0xffff0000, v59
    v_and_b32 v170, 0xffff0000, v61
    v_lshlrev_b32 v172, 16, v90
    v_and_b32 v173, 0xffff0000, v90
    buffer_load_dwordx4 v241, s[28:31], s97 offen offset:1024  lds
    v_lshlrev_b32 v174, 16, v91
    v_and_b32 v175, 0xffff0000, v91
    v_and_b32 v176, 0xffff0000, v69
    v_and_b32 v177, 0xffff0000, v71
    v_and_b32 v178, 0xffff0000, v73
    buffer_load_dwordx4 v242, s[28:31], s97 offen offset:2048  lds
    v_and_b32 v179, 0xffff0000, v75
    v_and_b32 v180, 0xffff0000, v77
    v_and_b32 v181, 0xffff0000, v79
    v_and_b32 v182, 0xffff0000, v81
    v_and_b32 v183, 0xffff0000, v83
    buffer_load_dwordx4 v243, s[28:31], s97 offen offset:3072  lds
    v_mul_f32 v184, v160, v175
    v_mul_f32 v185, v161, v175
    v_mul_f32 v186, v162, v175
    v_mul_f32 v187, v163, v175
    v_mul_f32 v188, v164, v175
    s_add_u32 m0, s88, 18432
    s_mov_b64 exec, 0xffffffff
    buffer_load_dwordx4 v3, s[28:31], s97 offen offset:0  lds
    s_mov_b64 exec, -1
    v_mul_f32 v189, v165, v175
    v_mul_f32 v190, v166, v175
    v_mul_f32 v191, v167, v175
    v_fmac_f32 v184, v161, v174
    v_fmac_f32 v185, v162, v174
    v_fmac_f32 v186, v163, v174
    v_fmac_f32 v187, v164, v174
    v_fmac_f32 v188, v165, v174
    v_fmac_f32 v189, v166, v174
    v_fmac_f32 v190, v167, v174
    v_fmac_f32 v191, v168, v174
    v_fmac_f32 v184, v162, v173
    v_fmac_f32 v185, v163, v173
    v_fmac_f32 v186, v164, v173
    v_fmac_f32 v187, v165, v173
    v_fmac_f32 v188, v166, v173
    v_fmac_f32 v189, v167, v173
    v_fmac_f32 v190, v168, v173
    v_fmac_f32 v191, v169, v173
    v_fmac_f32 v184, v163, v172
    v_fmac_f32 v185, v164, v172
    v_fmac_f32 v186, v165, v172
    v_fmac_f32 v187, v166, v172
    v_fmac_f32 v188, v167, v172
    v_fmac_f32 v189, v168, v172
    v_fmac_f32 v190, v169, v172
    v_fmac_f32 v191, v170, v172
    v_mul_f32 v184, v184, v176
    v_mul_f32 v185, v185, v177
    v_mul_f32 v186, v186, v178
    v_mul_f32 v187, v187, v179
    v_mul_f32 v188, v188, v180
    v_mul_f32 v189, v189, v181
    v_mul_f32 v190, v190, v182
    v_mul_f32 v191, v191, v183
    v_cvt_pk_bf16_f32 v112, v191, v190
    v_cvt_pk_bf16_f32 v113, v189, v188
    v_cvt_pk_bf16_f32 v114, v187, v186
    v_cvt_pk_bf16_f32 v115, v185, v184
    s_mov_b32 s89, 49152
    buffer_store_dwordx4 v[112:115], v12, s[52:55], s89 offen sc1
    s_waitcnt vmcnt(13)
    s_barrier
    s_mul_i32 s16, s97, 3072
    s_add_u32 m0, s60, 24576
    s_add_u32 s99, s16, s62
    buffer_load_dwordx4 v244, s[32:35], s99 offen offset:0  lds
    s_mov_b32 s68, s24
    s_mov_b32 s69, s25
    s_mov_b32 s70, 0x100
    s_mov_b32 s71, 0x20000
    buffer_load_dwordx4 v245, s[32:35], s99 offen offset:1024  lds
    v_lshrrev_b32 v6, 5, v0
    v_and_b32 v7, 3, v0
    s_lshr_b32 s78, s90, 1
    s_lshl_b32 s78, s78, 2
    buffer_load_dwordx4 v246, s[32:35], s99 offen offset:2048  lds
    s_load_dword s92, s[14:15], s78
    v_bfe_u32 v5, v0, 2, 2
    v_lshlrev_b32 v5, 1, v5
    s_add_u32 m0, s61, 36864
    s_add_u32 s16, s16, s63
    buffer_load_dwordx4 v244, s[32:35], s16 offen offset:0  lds
    v_lshl_add_u32 v5, v6, 3, v5
    v_bfe_u32 v8, v0, 4, 1
    v_add_u32 v5, v5, v8
    s_and_b32 s78, s3, 1
    buffer_load_dwordx4 v245, s[32:35], s16 offen offset:1024  lds
    s_lshl_b32 s78, s78, 1
    v_add_u32 v8, s78, v6
    v_xor_b32 v8, v8, v7
    v_lshlrev_b32 v8, 4, v8
    buffer_load_dwordx4 v246, s[32:35], s16 offen offset:2048  lds
    v_lshl_add_u32 v5, v5, 6, v8
    v_add_u32 v14, s86, v5
    v_mov_b32 v18, 162304
    s_add_u32 s97, s98, s0
    s_lshr_b64 s[0:1], s[0:1], 4
    s_and_b32 s97, s97, 15
    s_add_u32 m0, s87, 36864
    s_lshl_b32 s97, s97, 7
    buffer_load_dwordx4 v240, s[28:31], s97 offen offset:0  lds
    v_mov_b32 v19, 1
    v_and_b32 v5, 3, v0
    s_lshl_b32 s78, s74, 4
    s_add_u32 s78, s78, s3
    buffer_load_dwordx4 v241, s[28:31], s97 offen offset:1024  lds
    v_lshl_add_u32 v6, v5, 2, s78
    s_lshr_b32 s78, s76, 3
    s_lshl_b32 s79, s3, 1
    s_add_u32 s78, s78, s79
    buffer_load_dwordx4 v242, s[28:31], s97 offen offset:2048  lds
    s_xor_b32 s78, s78, 2
    s_lshl_b32 s78, s78, 5
    s_add_u32 s79, s76, 5
    buffer_load_dwordx4 v243, s[28:31], s97 offen offset:3072  lds
    s_and_b32 s79, s79, 7
    s_lshl_b32 s79, s79, 1
    s_add_u32 s78, s78, s79
    v_mul_u32_u24 v7, 9, v5
    s_add_u32 m0, s88, 36864
    s_mov_b64 exec, 0xffffffff
    buffer_load_dwordx4 v3, s[28:31], s97 offen offset:0  lds
    s_mov_b64 exec, -1
    v_and_b32 v7, 17, v7
    v_add_u32 v7, s78, v7
    v_and_b32 v8, 4, v0
    s_waitcnt vmcnt(12)
    s_waitcnt vmcnt(11)
    s_barrier
    s_mul_i32 s16, s97, 3072
    s_add_u32 m0, s60, 49152
    s_add_u32 s99, s16, s62
    buffer_load_dwordx4 v244, s[32:35], s99 offen offset:0  lds
    v_cmp_eq_u32 vcc, 0, v8
    s_nop 1
    v_cndmask_b32 v6, v7, v6, vcc
    v_and_b32 v33, 0xf0, v6
    buffer_load_dwordx4 v245, s[32:35], s99 offen offset:1024  lds
    v_lshlrev_b32 v34, 8, v6
    v_add_u32 v34, 12582912, v34
    v_and_b32 v5, 15, v0
    buffer_load_dwordx4 v246, s[32:35], s99 offen offset:2048  lds
    v_lshrrev_b32 v6, 4, v0
    v_add_u32 v7, 9, v5
    s_add_u32 m0, s61, 61440
    s_add_u32 s16, s16, s63
    buffer_load_dwordx4 v244, s[32:35], s16 offen offset:0  lds
    v_and_b32 v8, 1, v7
    v_mul_u32_u24 v8, 4160, v8
    v_lshrrev_b32 v7, 1, v7
    buffer_load_dwordx4 v245, s[32:35], s16 offen offset:1024  lds
    v_lshl_add_u32 v8, v7, 2, v8
    v_lshlrev_b32 v7, 4, v6
    v_sub_u32 v8, v8, v7
    buffer_load_dwordx4 v246, s[32:35], s16 offen offset:2048  lds
    s_add_u32 s78, s94, 32
    v_add_u32 v21, s78, v8
    s_add_u32 m0, s94, 32
    s_lshl_b32 s89, s90, 12
    buffer_load_dwordx4 v15, s[48:51], s89 offen offset:0 nt lds
    v_add_u32 v22, 1024, v21
    v_add_u32 v23, 2048, v21
    v_add_u32 v24, 3072, v21
    s_add_u32 m0, s94, 32
    s_lshl_b32 s89, s90, 12
    buffer_load_dwordx4 v15, s[48:51], s89 offen offset:1024 nt lds
    v_lshl_add_u32 v7, v5, 1, v6
    v_add_u32 v7, 30, v7
    v_and_b32 v8, 1, v7
    s_add_u32 m0, s94, 32
    s_lshl_b32 s89, s90, 12
    buffer_load_dwordx4 v15, s[48:51], s89 offen offset:2048 nt lds
    v_bfe_u32 v136, v7, 1, 2
    v_lshl_add_u32 v136, v8, 2, v136
    s_add_u32 m0, s94, 32
    s_lshl_b32 s89, s90, 12
    buffer_load_dwordx4 v15, s[48:51], s89 offen offset:3072 nt lds
    v_lshlrev_b32 v136, 6, v136
    v_lshrrev_b32 v7, 3, v7
    v_lshl_add_u32 v136, v7, 9, v136
    s_add_u32 s97, s98, s0
    s_lshr_b64 s[0:1], s[0:1], 4
    s_and_b32 s97, s97, 15
    s_add_u32 m0, s87, 0
    s_lshl_b32 s97, s97, 7
    buffer_load_dwordx4 v240, s[28:31], s97 offen offset:0  lds
    v_bitop3_b32 v8, v7, 3, s3 bitop3:0x6a
    v_lshl_add_u32 v25, v8, 4, v136
    v_add_u32 v25, 92160, v25
    buffer_load_dwordx4 v241, s[28:31], s97 offen offset:1024  lds
    v_subrev_u32 v7, 1, v7
    v_bitop3_b32 v8, v7, 3, s3 bitop3:0x6a
    buffer_load_dwordx4 v242, s[28:31], s97 offen offset:2048  lds
    v_lshl_add_u32 v27, v8, 4, v136
    v_add_u32 v27, 91648, v27
    v_subrev_u32 v7, 1, v7
    buffer_load_dwordx4 v243, s[28:31], s97 offen offset:3072  lds
    v_bitop3_b32 v8, v7, 3, s3 bitop3:0x6a
    v_lshl_add_u32 v29, v8, 4, v136
    v_add_u32 v29, 91136, v29
    s_add_u32 m0, s88, 0
    s_mov_b64 exec, 0xffffffff
    buffer_load_dwordx4 v3, s[28:31], s97 offen offset:0  lds
    s_mov_b64 exec, -1
    v_subrev_u32 v7, 1, v7
    v_bitop3_b32 v8, v7, 3, s3 bitop3:0x6a
    s_waitcnt vmcnt(15)
    s_barrier
    s_mul_i32 s16, s97, 3072
    s_add_u32 m0, s60, 0
    s_add_u32 s99, s16, s62
    buffer_load_dwordx4 v244, s[32:35], s99 offen offset:0  lds
    v_lshl_add_u32 v31, v8, 4, v136
    v_add_u32 v31, 90624, v31
    v_lshl_add_u32 v7, v5, 1, v6
    v_add_u32 v7, 26, v7
    buffer_load_dwordx4 v245, s[32:35], s99 offen offset:1024  lds
    v_and_b32 v8, 1, v7
    v_bfe_u32 v136, v7, 1, 2
    v_lshl_add_u32 v136, v8, 2, v136
    v_lshlrev_b32 v136, 6, v136
    buffer_load_dwordx4 v246, s[32:35], s99 offen offset:2048  lds
    v_lshrrev_b32 v7, 3, v7
    v_lshl_add_u32 v136, v7, 9, v136
    v_bitop3_b32 v8, v7, 3, s3 bitop3:0x6a
    s_add_u32 m0, s61, 12288
    s_add_u32 s16, s16, s63
    buffer_load_dwordx4 v244, s[32:35], s16 offen offset:0  lds
    v_lshl_add_u32 v26, v8, 4, v136
    v_add_u32 v26, 92160, v26
    v_subrev_u32 v7, 1, v7
    v_bitop3_b32 v8, v7, 3, s3 bitop3:0x6a
    buffer_load_dwordx4 v245, s[32:35], s16 offen offset:1024  lds
    v_lshl_add_u32 v28, v8, 4, v136
    v_add_u32 v28, 91648, v28
    v_subrev_u32 v7, 1, v7
    v_bitop3_b32 v8, v7, 3, s3 bitop3:0x6a
    buffer_load_dwordx4 v246, s[32:35], s16 offen offset:2048  lds
    v_lshl_add_u32 v30, v8, 4, v136
    v_add_u32 v30, 91136, v30
    v_subrev_u32 v7, 1, v7
    s_add_u32 s97, s98, s0
    s_lshr_b64 s[0:1], s[0:1], 4
    s_and_b32 s97, s97, 15
    s_add_u32 m0, s87, 18432
    s_lshl_b32 s97, s97, 7
    buffer_load_dwordx4 v240, s[28:31], s97 offen offset:0  lds
    v_bitop3_b32 v8, v7, 3, s3 bitop3:0x6a
    v_lshl_add_u32 v32, v8, 4, v136
    v_add_u32 v32, 90624, v32
    v_lshrrev_b32 v7, 1, v6
    buffer_load_dwordx4 v241, s[28:31], s97 offen offset:1024  lds
    v_lshl_add_u32 v7, v5, 1, v7
    v_add_u32 v7, 32, v7
    v_and_b32 v8, 1, v7
    v_bfe_u32 v136, v7, 1, 2
    buffer_load_dwordx4 v242, s[28:31], s97 offen offset:2048  lds
    v_lshl_add_u32 v136, v8, 2, v136
    v_lshlrev_b32 v136, 6, v136
    v_lshrrev_b32 v7, 3, v7
    buffer_load_dwordx4 v243, s[28:31], s97 offen offset:3072  lds
    v_lshl_add_u32 v136, v7, 9, v136
    v_bitop3_b32 v8, v7, 3, s3 bitop3:0x6a
    v_lshl_add_u32 v20, v8, 4, v136
    v_add_u32 v20, 92160, v20
    s_add_u32 m0, s88, 18432
    s_mov_b64 exec, 0xffffffff
    buffer_load_dwordx4 v3, s[28:31], s97 offen offset:0  lds
    s_mov_b64 exec, -1
    v_and_b32 v8, 1, v6
    v_xor_b32 v8, 1, v8
    v_lshl_add_u32 v20, v8, 3, v20
    s_waitcnt vmcnt(11)
    s_barrier
    s_mul_i32 s16, s97, 3072
    s_add_u32 m0, s60, 24576
    s_add_u32 s99, s16, s62
    buffer_load_dwordx4 v244, s[32:35], s99 offen offset:0  lds
    s_waitcnt lgkmcnt(0)
    s_and_b32 s78, s92, 0xffff0000
    s_lshl_b32 s92, s92, 16
    buffer_load_dwordx4 v245, s[32:35], s99 offen offset:1024  lds
    s_bitcmp1_b32 s90, 0
    s_cselect_b32 s92, s78, s92
    v_lshlrev_b32 v7, 3, v6
    v_sub_u32 v7, v7, v5
    buffer_load_dwordx4 v246, s[32:35], s99 offen offset:2048  lds
    v_subrev_u32 v7, 9, v7
    v_and_b32 v8, 1, v7
    v_xor_b32 v8, 1, v8
    s_add_u32 m0, s61, 36864
    s_add_u32 s16, s16, s63
    buffer_load_dwordx4 v244, s[32:35], s16 offen offset:0  lds
    v_lshlrev_b32 v8, 4, v8
    v_lshrrev_b32 v8, v8, s92
    v_ashrrev_i32 v7, 1, v7
    buffer_load_dwordx4 v245, s[32:35], s16 offen offset:1024  lds
    v_cmp_eq_u32 vcc, 0, v7
    s_nop 1
    v_cndmask_b32 v236, 0, v8, vcc
    v_cmp_eq_u32 vcc, 1, v7
    buffer_load_dwordx4 v246, s[32:35], s16 offen offset:2048  lds
    s_nop 0
    v_cndmask_b32 v237, 0, v8, vcc
    v_cmp_eq_u32 vcc, 2, v7
    s_nop 1
    v_cndmask_b32 v238, 0, v8, vcc
    s_add_u32 s97, s98, s0
    s_lshr_b64 s[0:1], s[0:1], 4
    s_and_b32 s97, s97, 15
    s_add_u32 m0, s87, 36864
    s_lshl_b32 s97, s97, 7
    buffer_load_dwordx4 v240, s[28:31], s97 offen offset:0  lds
    v_cmp_eq_u32 vcc, 3, v7
    s_nop 1
    v_cndmask_b32 v239, 0, v8, vcc
    s_and_b32 s78, s77, 7
    s_mov_b32 s95, 0x76543210
    s_and_b32 s78, s76, 3
    s_mul_i32 s78, s78, 0x22222222
    s_add_u32 s95, s95, s78
    s_bfe_u32 s17, s95, 0x30000
    s_lshl_b32 s17, s17, 18
    s_bfe_u32 s18, s95, 0x30004
    s_lshl_b32 s18, s18, 18
    s_bfe_u32 s100, s95, 0x3001c
    s_lshl_b32 s100, s100, 18
    s_bfe_u32 s95, s95, 0x30018
    s_lshl_b32 s95, s95, 18
    buffer_load_dwordx4 v241, s[28:31], s97 offen offset:1024  lds
    v_lshrrev_b32 v136, 4, v0
    v_lshlrev_b32 v136, 1, v136
    v_and_b32 v137, 7, v0
    buffer_load_dwordx4 v242, s[28:31], s97 offen offset:2048  lds
    v_xor_b32 v136, v136, v137
    v_lshlrev_b32 v136, 4, v136
    v_lshrrev_b32 v137, 3, v0
    buffer_load_dwordx4 v243, s[28:31], s97 offen offset:3072  lds
    v_lshl_add_u32 v136, v137, 11, v136
    s_lshl_b32 s78, s77, 7
    s_lshl_b32 s79, s3, 14
    s_add_u32 m0, s88, 36864
    s_mov_b64 exec, 0xffffffff
    buffer_load_dwordx4 v3, s[28:31], s97 offen offset:0  lds
    s_mov_b64 exec, -1
    s_add_u32 s78, s78, s79
    v_add_u32 v17, s78, v136
    s_waitcnt vmcnt(11)
    s_barrier
    s_mul_i32 s16, s97, 3072
    s_add_u32 m0, s60, 49152
    s_add_u32 s99, s16, s62
    buffer_load_dwordx4 v244, s[32:35], s99 offen offset:0  lds
    v_add_u32 v5, s94, v15
    ds_read_b128 v[140:143], v5 offset:32
    ds_read_b32 v156, v5 offset:48
    ds_read_b128 v[144:147], v5 offset:1056
    buffer_load_dwordx4 v245, s[32:35], s99 offen offset:1024  lds
    ds_read_b32 v157, v5 offset:1072
    ds_read_b128 v[148:151], v5 offset:2080
    ds_read_b32 v158, v5 offset:2096
    ds_read_b128 v[152:155], v5 offset:3104
    buffer_load_dwordx4 v246, s[32:35], s99 offen offset:2048  lds
    ds_read_b32 v159, v5 offset:3120
    v_lshrrev_b32 v6, 3, v0
    v_mul_u32_u24 v6, 4160, v6
    s_add_u32 m0, s61, 61440
    s_add_u32 s16, s16, s63
    buffer_load_dwordx4 v244, s[32:35], s16 offen offset:0  lds
    v_and_b32 v7, 7, v0
    v_lshl_add_u32 v6, v7, 2, v6
    v_add_u32 v6, s94, v6
    v_mov_b32 v7, 0
    buffer_load_dwordx4 v245, s[32:35], s16 offen offset:1024  lds
    s_waitcnt lgkmcnt(0)
    v_readfirstlane_b32 s93, v140
    s_nop 0
    s_lshl_b32 s93, s93, 16
    s_nop 1
    v_writelane_b32 v7, s93, 15
    buffer_load_dwordx4 v246, s[32:35], s16 offen offset:2048  lds
    v_alignbit_b32 v140, v141, v140, 16
    v_alignbit_b32 v141, v142, v141, 16
    v_alignbit_b32 v142, v143, v142, 16
    s_add_u32 s97, s98, s0
    s_lshr_b64 s[0:1], s[0:1], 4
    s_and_b32 s97, s97, 15
    s_add_u32 m0, s87, 0
    s_lshl_b32 s97, s97, 7
    buffer_load_dwordx4 v240, s[28:31], s97 offen offset:0  lds
    v_alignbit_b32 v143, v156, v143, 16
    v_alignbit_b32 v144, v145, v144, 16
    v_alignbit_b32 v145, v146, v145, 16
    v_alignbit_b32 v146, v147, v146, 16
    buffer_load_dwordx4 v241, s[28:31], s97 offen offset:1024  lds
    v_alignbit_b32 v147, v157, v147, 16
    v_alignbit_b32 v148, v149, v148, 16
    v_alignbit_b32 v149, v150, v149, 16
    v_alignbit_b32 v150, v151, v150, 16
    buffer_load_dwordx4 v242, s[28:31], s97 offen offset:2048  lds
    v_alignbit_b32 v151, v158, v151, 16
    v_alignbit_b32 v152, v153, v152, 16
    v_alignbit_b32 v153, v154, v153, 16
    buffer_load_dwordx4 v243, s[28:31], s97 offen offset:3072  lds
    v_alignbit_b32 v154, v155, v154, 16
    v_alignbit_b32 v155, v159, v155, 16
    v_lshlrev_b32 v8, 3, v0
    s_add_u32 s78, s88, 18432
    s_add_u32 m0, s88, 0
    s_mov_b64 exec, 0xffffffff
    buffer_load_dwordx4 v3, s[28:31], s97 offen offset:0  lds
    s_mov_b64 exec, -1
    v_add_u32 v8, s78, v8
    v_mov_b32 v156, 0
    v_mov_b32 v157, 0
    s_waitcnt vmcnt(11)
    s_barrier
    s_mul_i32 s16, s97, 3072
    s_add_u32 m0, s60, 0
    s_add_u32 s99, s16, s62
    buffer_load_dwordx4 v244, s[32:35], s99 offen offset:0  lds
    buffer_load_dwordx4 v245, s[32:35], s99 offen offset:1024  lds
    buffer_load_dwordx4 v246, s[32:35], s99 offen offset:2048  lds
    s_add_u32 m0, s61, 12288
    s_add_u32 s16, s16, s63
    buffer_load_dwordx4 v244, s[32:35], s16 offen offset:0  lds
    buffer_load_dwordx4 v245, s[32:35], s16 offen offset:1024  lds
    buffer_load_dwordx4 v246, s[32:35], s16 offen offset:2048  lds
    s_mov_b64 exec, 0xff
    buffer_load_dword v136, v33, s[68:71], 0 offen sc1
    buffer_load_dword v137, v34, s[52:55], 0 offen sc1
    s_mov_b64 exec, -1
    buffer_load_dwordx4 v[212:215], v9, s[56:59], 0 offen offset:0 nt
    buffer_load_dwordx4 v[216:219], v9, s[56:59], 0 offen offset:2048 nt
    buffer_load_dwordx4 v[220:223], v9, s[56:59], s96 offen offset:0 nt
    buffer_load_dwordx4 v[224:227], v9, s[56:59], s96 offen offset:2048 nt
    s_waitcnt vmcnt(12)
    s_waitcnt vmcnt(6)
    s_barrier
    s_waitcnt vmcnt(4)
    s_branch LA_j
LA_c3:
    s_waitcnt vmcnt(8)
    s_barrier
    buffer_load_dwordx4 v242, s[28:31], s97 offen offset:2048  lds
    buffer_load_dwordx4 v243, s[28:31], s97 offen offset:3072  lds
    s_add_u32 m0, s88, 36864
    s_mov_b64 exec, 0xffffffff
    buffer_load_dwordx4 v3, s[28:31], s97 offen offset:0  lds
    s_mov_b64 exec, -1
    s_mul_i32 s16, s97, 3072
    s_add_u32 m0, s60, 49152
    s_add_u32 s99, s16, s62
    buffer_load_dwordx4 v244, s[32:35], s99 offen offset:0  lds
    buffer_load_dwordx4 v245, s[32:35], s99 offen offset:1024  lds
    buffer_load_dwordx4 v246, s[32:35], s99 offen offset:2048  lds
    s_add_u32 m0, s61, 61440
    s_add_u32 s16, s16, s63
    buffer_load_dwordx4 v244, s[32:35], s16 offen offset:0  lds
    buffer_load_dwordx4 v245, s[32:35], s16 offen offset:1024  lds
    buffer_load_dwordx4 v246, s[32:35], s16 offen offset:2048  lds
    s_add_u32 s97, s98, s0
    s_lshr_b64 s[0:1], s[0:1], 4
    s_and_b32 s97, s97, 15
    s_add_u32 m0, s87, 0
    s_lshl_b32 s97, s97, 7
    buffer_load_dwordx4 v240, s[28:31], s97 offen offset:0  lds
    buffer_load_dwordx4 v241, s[28:31], s97 offen offset:1024  lds
    buffer_load_dwordx4 v242, s[28:31], s97 offen offset:2048  lds
    buffer_load_dwordx4 v243, s[28:31], s97 offen offset:3072  lds
    s_add_u32 m0, s88, 0
    s_mov_b64 exec, 0xffffffff
    buffer_load_dwordx4 v3, s[28:31], s97 offen offset:0  lds
    s_mov_b64 exec, -1
    s_waitcnt vmcnt(11)
    s_barrier
    s_mul_i32 s16, s97, 3072
    s_add_u32 m0, s60, 0
    s_add_u32 s99, s16, s62
    buffer_load_dwordx4 v244, s[32:35], s99 offen offset:0  lds
    buffer_load_dwordx4 v245, s[32:35], s99 offen offset:1024  lds
    buffer_load_dwordx4 v246, s[32:35], s99 offen offset:2048  lds
    s_add_u32 m0, s61, 12288
    s_add_u32 s16, s16, s63
    buffer_load_dwordx4 v244, s[32:35], s16 offen offset:0  lds
    buffer_load_dwordx4 v245, s[32:35], s16 offen offset:1024  lds
    buffer_load_dwordx4 v246, s[32:35], s16 offen offset:2048  lds
    s_add_u32 s97, s98, s0
    s_lshr_b64 s[0:1], s[0:1], 4
    s_and_b32 s97, s97, 15
    s_add_u32 m0, s87, 18432
    s_lshl_b32 s97, s97, 7
    buffer_load_dwordx4 v240, s[28:31], s97 offen offset:0  lds
    buffer_load_dwordx4 v241, s[28:31], s97 offen offset:1024  lds
    buffer_load_dwordx4 v242, s[28:31], s97 offen offset:2048  lds
    buffer_load_dwordx4 v243, s[28:31], s97 offen offset:3072  lds
    s_add_u32 m0, s88, 18432
    s_mov_b64 exec, 0xffffffff
    buffer_load_dwordx4 v3, s[28:31], s97 offen offset:0  lds
    s_mov_b64 exec, -1
    s_waitcnt vmcnt(11)
    s_barrier
    s_mul_i32 s16, s97, 3072
    s_add_u32 m0, s60, 24576
    s_add_u32 s99, s16, s62
    buffer_load_dwordx4 v244, s[32:35], s99 offen offset:0  lds
    buffer_load_dwordx4 v245, s[32:35], s99 offen offset:1024  lds
    buffer_load_dwordx4 v246, s[32:35], s99 offen offset:2048  lds
    s_add_u32 m0, s61, 36864
    s_add_u32 s16, s16, s63
    buffer_load_dwordx4 v244, s[32:35], s16 offen offset:0  lds
    buffer_load_dwordx4 v245, s[32:35], s16 offen offset:1024  lds
    buffer_load_dwordx4 v246, s[32:35], s16 offen offset:2048  lds
    s_add_u32 m0, s86, 129536
    s_mov_b32 s89, 0
    buffer_load_dwordx4 v10, s[36:39], s89 offen nt lds
    s_add_u32 m0, s86, 145920
    s_mov_b32 s89, 0
    buffer_load_dwordx4 v10, s[40:43], s89 offen nt lds
    s_add_u32 m0, s86, 133632
    s_mov_b32 s89, 65536
    buffer_load_dwordx4 v10, s[36:39], s89 offen nt lds
    s_add_u32 m0, s86, 150016
    s_mov_b32 s89, 65536
    buffer_load_dwordx4 v10, s[40:43], s89 offen nt lds
    s_add_u32 m0, s86, 137728
    s_mov_b32 s89, 131072
    buffer_load_dwordx4 v10, s[36:39], s89 offen nt lds
    s_add_u32 m0, s86, 154112
    s_mov_b32 s89, 131072
    buffer_load_dwordx4 v10, s[40:43], s89 offen nt lds
    s_add_u32 m0, s86, 141824
    s_mov_b32 s89, 196608
    buffer_load_dwordx4 v10, s[36:39], s89 offen nt lds
    s_add_u32 m0, s86, 158208
    s_mov_b32 s89, 196608
    buffer_load_dwordx4 v10, s[40:43], s89 offen nt lds
    s_mov_b64 exec, 0xff
    s_lshl_b32 s82, s3, 7
    s_add_u32 m0, s82, 129024
    s_mov_b32 s89, 0
    buffer_load_dwordx4 v11, s[36:39], s89 offen nt lds
    s_lshl_b32 s83, s74, 9
    s_add_u32 s83, s83, s82
    s_and_b32 s89, s3, 2
    s_lshl_b32 s89, s89, 3
    s_add_u32 s82, s82, s89
    s_add_u32 m0, s82, 162816
    s_add_u32 s89, s83, 0
    buffer_load_dwordx4 v15, s[44:47], s89 offen  lds
    s_mov_b64 exec, -1
    s_add_u32 s97, s98, s0
    s_lshr_b64 s[0:1], s[0:1], 4
    s_and_b32 s97, s97, 15
    s_add_u32 m0, s87, 36864
    s_lshl_b32 s97, s97, 7
    buffer_load_dwordx4 v240, s[28:31], s97 offen offset:0  lds
    s_waitcnt vmcnt(17)
    s_barrier
    buffer_load_dwordx4 v241, s[28:31], s97 offen offset:1024  lds
    buffer_load_dwordx4 v242, s[28:31], s97 offen offset:2048  lds
    buffer_load_dwordx4 v243, s[28:31], s97 offen offset:3072  lds
    s_add_u32 m0, s88, 36864
    s_mov_b64 exec, 0xffffffff
    buffer_load_dwordx4 v3, s[28:31], s97 offen offset:0  lds
    s_mov_b64 exec, -1
    s_mul_i32 s16, s97, 3072
    s_add_u32 m0, s60, 49152
    s_add_u32 s99, s16, s62
    buffer_load_dwordx4 v244, s[32:35], s99 offen offset:0  lds
    buffer_load_dwordx4 v245, s[32:35], s99 offen offset:1024  lds
    buffer_load_dwordx4 v246, s[32:35], s99 offen offset:2048  lds
    s_add_u32 m0, s61, 61440
    s_add_u32 s16, s16, s63
    buffer_load_dwordx4 v244, s[32:35], s16 offen offset:0  lds
    buffer_load_dwordx4 v245, s[32:35], s16 offen offset:1024  lds
    buffer_load_dwordx4 v246, s[32:35], s16 offen offset:2048  lds
    s_add_u32 s97, s98, s0
    s_lshr_b64 s[0:1], s[0:1], 4
    s_and_b32 s97, s97, 15
    s_add_u32 m0, s87, 0
    s_lshl_b32 s97, s97, 7
    buffer_load_dwordx4 v240, s[28:31], s97 offen offset:0  lds
    buffer_load_dwordx4 v241, s[28:31], s97 offen offset:1024  lds
    buffer_load_dwordx4 v242, s[28:31], s97 offen offset:2048  lds
    buffer_load_dwordx4 v243, s[28:31], s97 offen offset:3072  lds
    s_add_u32 m0, s88, 0
    s_mov_b64 exec, 0xffffffff
    buffer_load_dwordx4 v3, s[28:31], s97 offen offset:0  lds
    s_mov_b64 exec, -1
    s_waitcnt vmcnt(11)
    s_barrier
    s_mul_i32 s16, s97, 3072
    s_add_u32 m0, s60, 0
    s_add_u32 s99, s16, s62
    buffer_load_dwordx4 v244, s[32:35], s99 offen offset:0  lds
    ds_read_b128 v[84:87], v35 offset:0
    ds_read_b128 v[88:91], v35 offset:16
    buffer_load_dwordx4 v245, s[32:35], s99 offen offset:1024  lds
    ds_read_b64 v[40:41], v16 offset:0
    ds_read_b64 v[42:43], v231 offset:256
    buffer_load_dwordx4 v246, s[32:35], s99 offen offset:2048  lds
    ds_read_b64 v[44:45], v16 offset:256
    ds_read_b64 v[46:47], v16 offset:512
    s_add_u32 m0, s61, 12288
    s_add_u32 s16, s16, s63
    buffer_load_dwordx4 v244, s[32:35], s16 offen offset:0  lds
    ds_read_b64 v[48:49], v231 offset:512
    ds_read_b64 v[50:51], v16 offset:768
    buffer_load_dwordx4 v245, s[32:35], s16 offen offset:1024  lds
    ds_read_b64 v[52:53], v231 offset:768
    ds_read_b64 v[54:55], v16 offset:1024
    buffer_load_dwordx4 v246, s[32:35], s16 offen offset:2048  lds
    ds_read_b64 v[56:57], v231 offset:1024
    ds_read_b64 v[58:59], v16 offset:1280
    s_add_u32 s97, s98, s0
    s_lshr_b64 s[0:1], s[0:1], 4
    s_and_b32 s97, s97, 15
    s_add_u32 m0, s87, 18432
    s_lshl_b32 s97, s97, 7
    buffer_load_dwordx4 v240, s[28:31], s97 offen offset:0  lds
    ds_read_b64 v[60:61], v231 offset:1280
    ds_read_b64 v[68:69], v16 offset:16896
    buffer_load_dwordx4 v241, s[28:31], s97 offen offset:1024  lds
    ds_read_b64 v[70:71], v231 offset:16896
    ds_read_b64 v[72:73], v16 offset:17152
    buffer_load_dwordx4 v242, s[28:31], s97 offen offset:2048  lds
    ds_read_b64 v[74:75], v231 offset:17152
    ds_read_b64 v[76:77], v16 offset:17408
    buffer_load_dwordx4 v243, s[28:31], s97 offen offset:3072  lds
    ds_read_b64 v[78:79], v231 offset:17408
    ds_read_b64 v[80:81], v16 offset:17664
    s_add_u32 m0, s88, 18432
    s_mov_b64 exec, 0xffffffff
    buffer_load_dwordx4 v3, s[28:31], s97 offen offset:0  lds
    s_mov_b64 exec, -1
    ds_read_b64 v[82:83], v231 offset:17664
    s_waitcnt vmcnt(11)
    s_waitcnt lgkmcnt(0)
    s_barrier
    s_mul_i32 s16, s97, 3072
    s_add_u32 m0, s60, 24576
    s_add_u32 s99, s16, s62
    buffer_load_dwordx4 v244, s[32:35], s99 offen offset:0  lds
    v_lshlrev_b32 v160, 16, v40
    v_lshlrev_b32 v161, 16, v42
    v_lshlrev_b32 v162, 16, v44
    v_lshlrev_b32 v163, 16, v46
    v_lshlrev_b32 v164, 16, v48
    buffer_load_dwordx4 v245, s[32:35], s99 offen offset:1024  lds
    v_lshlrev_b32 v165, 16, v50
    v_lshlrev_b32 v166, 16, v52
    v_lshlrev_b32 v167, 16, v54
    v_lshlrev_b32 v168, 16, v56
    v_lshlrev_b32 v169, 16, v58
    buffer_load_dwordx4 v246, s[32:35], s99 offen offset:2048  lds
    v_lshlrev_b32 v170, 16, v60
    v_lshlrev_b32 v172, 16, v84
    v_and_b32 v173, 0xffff0000, v84
    v_lshlrev_b32 v174, 16, v85
    v_and_b32 v175, 0xffff0000, v85
    s_add_u32 m0, s61, 36864
    s_add_u32 s16, s16, s63
    buffer_load_dwordx4 v244, s[32:35], s16 offen offset:0  lds
    v_lshlrev_b32 v176, 16, v68
    v_lshlrev_b32 v177, 16, v70
    v_lshlrev_b32 v178, 16, v72
    v_lshlrev_b32 v179, 16, v74
    v_lshlrev_b32 v180, 16, v76
    buffer_load_dwordx4 v245, s[32:35], s16 offen offset:1024  lds
    v_lshlrev_b32 v181, 16, v78
    v_lshlrev_b32 v182, 16, v80
    v_lshlrev_b32 v183, 16, v82
    v_mul_f32 v184, v160, v175
    v_mul_f32 v185, v161, v175
    buffer_load_dwordx4 v246, s[32:35], s16 offen offset:2048  lds
    v_mul_f32 v186, v162, v175
    v_mul_f32 v187, v163, v175
    v_mul_f32 v188, v164, v175
    v_mul_f32 v189, v165, v175
    v_mul_f32 v190, v166, v175
    s_add_u32 s97, s98, s0
    s_lshr_b64 s[0:1], s[0:1], 4
    s_and_b32 s97, s97, 15
    s_add_u32 m0, s87, 36864
    s_lshl_b32 s97, s97, 7
    buffer_load_dwordx4 v240, s[28:31], s97 offen offset:0  lds
    v_mul_f32 v191, v167, v175
    v_fmac_f32 v184, v161, v174
    v_fmac_f32 v185, v162, v174
    v_fmac_f32 v186, v163, v174
    v_fmac_f32 v187, v164, v174
    buffer_load_dwordx4 v241, s[28:31], s97 offen offset:1024  lds
    v_fmac_f32 v188, v165, v174
    v_fmac_f32 v189, v166, v174
    v_fmac_f32 v190, v167, v174
    v_fmac_f32 v191, v168, v174
    v_fmac_f32 v184, v162, v173
    buffer_load_dwordx4 v242, s[28:31], s97 offen offset:2048  lds
    v_fmac_f32 v185, v163, v173
    v_fmac_f32 v186, v164, v173
    v_fmac_f32 v187, v165, v173
    v_fmac_f32 v188, v166, v173
    v_fmac_f32 v189, v167, v173
    buffer_load_dwordx4 v243, s[28:31], s97 offen offset:3072  lds
    v_fmac_f32 v190, v168, v173
    v_fmac_f32 v191, v169, v173
    v_fmac_f32 v184, v163, v172
    v_fmac_f32 v185, v164, v172
    v_fmac_f32 v186, v165, v172
    s_add_u32 m0, s88, 36864
    s_mov_b64 exec, 0xffffffff
    buffer_load_dwordx4 v3, s[28:31], s97 offen offset:0  lds
    s_mov_b64 exec, -1
    v_fmac_f32 v187, v166, v172
    v_fmac_f32 v188, v167, v172
    v_fmac_f32 v189, v168, v172
    v_fmac_f32 v190, v169, v172
    v_fmac_f32 v191, v170, v172
    v_mul_f32 v184, v184, v176
    v_mul_f32 v185, v185, v177
    v_mul_f32 v186, v186, v178
    v_mul_f32 v187, v187, v179
    v_mul_f32 v188, v188, v180
    v_mul_f32 v189, v189, v181
    v_mul_f32 v190, v190, v182
    v_mul_f32 v191, v191, v183
    v_cvt_pk_bf16_f32 v100, v191, v190
    v_cvt_pk_bf16_f32 v101, v189, v188
    v_cvt_pk_bf16_f32 v102, v187, v186
    v_cvt_pk_bf16_f32 v103, v185, v184
    s_mov_b32 s89, 0
    buffer_store_dwordx4 v[100:103], v12, s[52:55], s89 offen sc1
    v_and_b32 v160, 0xffff0000, v40
    v_and_b32 v161, 0xffff0000, v42
    v_and_b32 v162, 0xffff0000, v44
    v_and_b32 v163, 0xffff0000, v46
    v_and_b32 v164, 0xffff0000, v48
    v_and_b32 v165, 0xffff0000, v50
    v_and_b32 v166, 0xffff0000, v52
    v_and_b32 v167, 0xffff0000, v54
    v_and_b32 v168, 0xffff0000, v56
    v_and_b32 v169, 0xffff0000, v58
    v_and_b32 v170, 0xffff0000, v60
    v_lshlrev_b32 v172, 16, v86
    v_and_b32 v173, 0xffff0000, v86
    v_lshlrev_b32 v174, 16, v87
    v_and_b32 v175, 0xffff0000, v87
    v_and_b32 v176, 0xffff0000, v68
    v_and_b32 v177, 0xffff0000, v70
    v_and_b32 v178, 0xffff0000, v72
    v_and_b32 v179, 0xffff0000, v74
    v_and_b32 v180, 0xffff0000, v76
    v_and_b32 v181, 0xffff0000, v78
    v_and_b32 v182, 0xffff0000, v80
    v_and_b32 v183, 0xffff0000, v82
    s_waitcnt vmcnt(12)
    s_barrier
    s_mul_i32 s16, s97, 3072
    s_add_u32 m0, s60, 49152
    s_add_u32 s99, s16, s62
    buffer_load_dwordx4 v244, s[32:35], s99 offen offset:0  lds
    v_mul_f32 v184, v160, v175
    v_mul_f32 v185, v161, v175
    v_mul_f32 v186, v162, v175
    v_mul_f32 v187, v163, v175
    v_mul_f32 v188, v164, v175
    buffer_load_dwordx4 v245, s[32:35], s99 offen offset:1024  lds
    v_mul_f32 v189, v165, v175
    v_mul_f32 v190, v166, v175
    v_mul_f32 v191, v167, v175
    v_fmac_f32 v184, v161, v174
    v_fmac_f32 v185, v162, v174
    buffer_load_dwordx4 v246, s[32:35], s99 offen offset:2048  lds
    v_fmac_f32 v186, v163, v174
    v_fmac_f32 v187, v164, v174
    v_fmac_f32 v188, v165, v174
    v_fmac_f32 v189, v166, v174
    v_fmac_f32 v190, v167, v174
    s_add_u32 m0, s61, 61440
    s_add_u32 s16, s16, s63
    buffer_load_dwordx4 v244, s[32:35], s16 offen offset:0  lds
    v_fmac_f32 v191, v168, v174
    v_fmac_f32 v184, v162, v173
    v_fmac_f32 v185, v163, v173
    v_fmac_f32 v186, v164, v173
    v_fmac_f32 v187, v165, v173
    buffer_load_dwordx4 v245, s[32:35], s16 offen offset:1024  lds
    v_fmac_f32 v188, v166, v173
    v_fmac_f32 v189, v167, v173
    v_fmac_f32 v190, v168, v173
    v_fmac_f32 v191, v169, v173
    v_fmac_f32 v184, v163, v172
    buffer_load_dwordx4 v246, s[32:35], s16 offen offset:2048  lds
    v_fmac_f32 v185, v164, v172
    v_fmac_f32 v186, v165, v172
    v_fmac_f32 v187, v166, v172
    v_fmac_f32 v188, v167, v172
    v_fmac_f32 v189, v168, v172
    s_add_u32 s97, s98, s0
    s_lshr_b64 s[0:1], s[0:1], 4
    s_and_b32 s97, s97, 15
    s_add_u32 m0, s87, 0
    s_lshl_b32 s97, s97, 7
    buffer_load_dwordx4 v240, s[28:31], s97 offen offset:0  lds
    v_fmac_f32 v190, v169, v172
    v_fmac_f32 v191, v170, v172
    v_mul_f32 v184, v184, v176
    v_mul_f32 v185, v185, v177
    v_mul_f32 v186, v186, v178
    buffer_load_dwordx4 v241, s[28:31], s97 offen offset:1024  lds
    v_mul_f32 v187, v187, v179
    v_mul_f32 v188, v188, v180
    v_mul_f32 v189, v189, v181
    v_mul_f32 v190, v190, v182
    v_mul_f32 v191, v191, v183
    buffer_load_dwordx4 v242, s[28:31], s97 offen offset:2048  lds
    v_cvt_pk_bf16_f32 v104, v191, v190
    v_cvt_pk_bf16_f32 v105, v189, v188
    v_cvt_pk_bf16_f32 v106, v187, v186
    v_cvt_pk_bf16_f32 v107, v185, v184
    s_mov_b32 s89, 16384
    buffer_store_dwordx4 v[104:107], v12, s[52:55], s89 offen sc1
    buffer_load_dwordx4 v243, s[28:31], s97 offen offset:3072  lds
    v_lshlrev_b32 v160, 16, v41
    v_lshlrev_b32 v161, 16, v43
    v_lshlrev_b32 v162, 16, v45
    v_lshlrev_b32 v163, 16, v47
    v_lshlrev_b32 v164, 16, v49
    s_add_u32 m0, s88, 0
    s_mov_b64 exec, 0xffffffff
    buffer_load_dwordx4 v3, s[28:31], s97 offen offset:0  lds
    s_mov_b64 exec, -1
    v_lshlrev_b32 v165, 16, v51
    v_lshlrev_b32 v166, 16, v53
    v_lshlrev_b32 v167, 16, v55
    v_lshlrev_b32 v168, 16, v57
    v_lshlrev_b32 v169, 16, v59
    v_lshlrev_b32 v170, 16, v61
    v_lshlrev_b32 v172, 16, v88
    v_and_b32 v173, 0xffff0000, v88
    v_lshlrev_b32 v174, 16, v89
    v_and_b32 v175, 0xffff0000, v89
    v_lshlrev_b32 v176, 16, v69
    v_lshlrev_b32 v177, 16, v71
    v_lshlrev_b32 v178, 16, v73
    v_lshlrev_b32 v179, 16, v75
    v_lshlrev_b32 v180, 16, v77
    v_lshlrev_b32 v181, 16, v79
    v_lshlrev_b32 v182, 16, v81
    v_lshlrev_b32 v183, 16, v83
    v_mul_f32 v184, v160, v175
    v_mul_f32 v185, v161, v175
    v_mul_f32 v186, v162, v175
    v_mul_f32 v187, v163, v175
    v_mul_f32 v188, v164, v175
    v_mul_f32 v189, v165, v175
    v_mul_f32 v190, v166, v175
    v_mul_f32 v191, v167, v175
    v_fmac_f32 v184, v161, v174
    v_fmac_f32 v185, v162, v174
    v_fmac_f32 v186, v163, v174
    v_fmac_f32 v187, v164, v174
    v_fmac_f32 v188, v165, v174
    v_fmac_f32 v189, v166, v174
    v_fmac_f32 v190, v167, v174
    v_fmac_f32 v191, v168, v174
    v_fmac_f32 v184, v162, v173
    v_fmac_f32 v185, v163, v173
    v_fmac_f32 v186, v164, v173
    v_fmac_f32 v187, v165, v173
    v_fmac_f32 v188, v166, v173
    v_fmac_f32 v189, v167, v173
    v_fmac_f32 v190, v168, v173
    s_waitcnt vmcnt(13)
    s_barrier
    s_mul_i32 s16, s97, 3072
    s_add_u32 m0, s60, 0
    s_add_u32 s99, s16, s62
    buffer_load_dwordx4 v244, s[32:35], s99 offen offset:0  lds
    v_fmac_f32 v191, v169, v173
    v_fmac_f32 v184, v163, v172
    v_fmac_f32 v185, v164, v172
    v_fmac_f32 v186, v165, v172
    v_fmac_f32 v187, v166, v172
    buffer_load_dwordx4 v245, s[32:35], s99 offen offset:1024  lds
    v_fmac_f32 v188, v167, v172
    v_fmac_f32 v189, v168, v172
    v_fmac_f32 v190, v169, v172
    v_fmac_f32 v191, v170, v172
    v_mul_f32 v184, v184, v176
    buffer_load_dwordx4 v246, s[32:35], s99 offen offset:2048  lds
    v_mul_f32 v185, v185, v177
    v_mul_f32 v186, v186, v178
    v_mul_f32 v187, v187, v179
    v_mul_f32 v188, v188, v180
    v_mul_f32 v189, v189, v181
    s_add_u32 m0, s61, 12288
    s_add_u32 s16, s16, s63
    buffer_load_dwordx4 v244, s[32:35], s16 offen offset:0  lds
    v_mul_f32 v190, v190, v182
    v_mul_f32 v191, v191, v183
    v_cvt_pk_bf16_f32 v108, v191, v190
    v_cvt_pk_bf16_f32 v109, v189, v188
    v_cvt_pk_bf16_f32 v110, v187, v186
    buffer_load_dwordx4 v245, s[32:35], s16 offen offset:1024  lds
    v_cvt_pk_bf16_f32 v111, v185, v184
    s_mov_b32 s89, 32768
    buffer_store_dwordx4 v[108:111], v12, s[52:55], s89 offen sc1
    v_and_b32 v160, 0xffff0000, v41
    v_and_b32 v161, 0xffff0000, v43
    v_and_b32 v162, 0xffff0000, v45
    buffer_load_dwordx4 v246, s[32:35], s16 offen offset:2048  lds
    v_and_b32 v163, 0xffff0000, v47
    v_and_b32 v164, 0xffff0000, v49
    v_and_b32 v165, 0xffff0000, v51
    v_and_b32 v166, 0xffff0000, v53
    v_and_b32 v167, 0xffff0000, v55
    s_add_u32 s97, s98, s0
    s_lshr_b64 s[0:1], s[0:1], 4
    s_and_b32 s97, s97, 15
    s_add_u32 m0, s87, 18432
    s_lshl_b32 s97, s97, 7
    buffer_load_dwordx4 v240, s[28:31], s97 offen offset:0  lds
    v_and_b32 v168, 0xffff0000, v57
    v_and_b32 v169, 0xffff0000, v59
    v_and_b32 v170, 0xffff0000, v61
    v_lshlrev_b32 v172, 16, v90
    v_and_b32 v173, 0xffff0000, v90
    buffer_load_dwordx4 v241, s[28:31], s97 offen offset:1024  lds
    v_lshlrev_b32 v174, 16, v91
    v_and_b32 v175, 0xffff0000, v91
    v_and_b32 v176, 0xffff0000, v69
    v_and_b32 v177, 0xffff0000, v71
    v_and_b32 v178, 0xffff0000, v73
    buffer_load_dwordx4 v242, s[28:31], s97 offen offset:2048  lds
    v_and_b32 v179, 0xffff0000, v75
    v_and_b32 v180, 0xffff0000, v77
    v_and_b32 v181, 0xffff0000, v79
    v_and_b32 v182, 0xffff0000, v81
    v_and_b32 v183, 0xffff0000, v83
    buffer_load_dwordx4 v243, s[28:31], s97 offen offset:3072  lds
    v_mul_f32 v184, v160, v175
    v_mul_f32 v185, v161, v175
    v_mul_f32 v186, v162, v175
    v_mul_f32 v187, v163, v175
    v_mul_f32 v188, v164, v175
    s_add_u32 m0, s88, 18432
    s_mov_b64 exec, 0xffffffff
    buffer_load_dwordx4 v3, s[28:31], s97 offen offset:0  lds
    s_mov_b64 exec, -1
    v_mul_f32 v189, v165, v175
    v_mul_f32 v190, v166, v175
    v_mul_f32 v191, v167, v175
    v_fmac_f32 v184, v161, v174
    v_fmac_f32 v185, v162, v174
    v_fmac_f32 v186, v163, v174
    v_fmac_f32 v187, v164, v174
    v_fmac_f32 v188, v165, v174
    v_fmac_f32 v189, v166, v174
    v_fmac_f32 v190, v167, v174
    v_fmac_f32 v191, v168, v174
    v_fmac_f32 v184, v162, v173
    v_fmac_f32 v185, v163, v173
    v_fmac_f32 v186, v164, v173
    v_fmac_f32 v187, v165, v173
    v_fmac_f32 v188, v166, v173
    v_fmac_f32 v189, v167, v173
    v_fmac_f32 v190, v168, v173
    v_fmac_f32 v191, v169, v173
    v_fmac_f32 v184, v163, v172
    v_fmac_f32 v185, v164, v172
    v_fmac_f32 v186, v165, v172
    v_fmac_f32 v187, v166, v172
    v_fmac_f32 v188, v167, v172
    v_fmac_f32 v189, v168, v172
    v_fmac_f32 v190, v169, v172
    v_fmac_f32 v191, v170, v172
    v_mul_f32 v184, v184, v176
    v_mul_f32 v185, v185, v177
    v_mul_f32 v186, v186, v178
    v_mul_f32 v187, v187, v179
    v_mul_f32 v188, v188, v180
    v_mul_f32 v189, v189, v181
    v_mul_f32 v190, v190, v182
    v_mul_f32 v191, v191, v183
    v_cvt_pk_bf16_f32 v112, v191, v190
    v_cvt_pk_bf16_f32 v113, v189, v188
    v_cvt_pk_bf16_f32 v114, v187, v186
    v_cvt_pk_bf16_f32 v115, v185, v184
    s_mov_b32 s89, 49152
    buffer_store_dwordx4 v[112:115], v12, s[52:55], s89 offen sc1
    s_waitcnt vmcnt(13)
    s_barrier
    s_mul_i32 s16, s97, 3072
    s_add_u32 m0, s60, 24576
    s_add_u32 s99, s16, s62
    buffer_load_dwordx4 v244, s[32:35], s99 offen offset:0  lds
    s_mov_b32 s68, s24
    s_mov_b32 s69, s25
    s_mov_b32 s70, 0x100
    s_mov_b32 s71, 0x20000
    buffer_load_dwordx4 v245, s[32:35], s99 offen offset:1024  lds
    v_lshrrev_b32 v6, 5, v0
    v_and_b32 v7, 3, v0
    s_lshr_b32 s78, s90, 1
    s_lshl_b32 s78, s78, 2
    buffer_load_dwordx4 v246, s[32:35], s99 offen offset:2048  lds
    s_load_dword s92, s[14:15], s78
    v_bfe_u32 v5, v0, 2, 2
    v_lshlrev_b32 v5, 1, v5
    s_add_u32 m0, s61, 36864
    s_add_u32 s16, s16, s63
    buffer_load_dwordx4 v244, s[32:35], s16 offen offset:0  lds
    v_lshl_add_u32 v5, v6, 3, v5
    v_bfe_u32 v8, v0, 4, 1
    v_add_u32 v5, v5, v8
    s_and_b32 s78, s3, 1
    buffer_load_dwordx4 v245, s[32:35], s16 offen offset:1024  lds
    s_lshl_b32 s78, s78, 1
    v_add_u32 v8, s78, v6
    v_xor_b32 v8, v8, v7
    v_lshlrev_b32 v8, 4, v8
    buffer_load_dwordx4 v246, s[32:35], s16 offen offset:2048  lds
    v_lshl_add_u32 v5, v5, 6, v8
    v_add_u32 v14, s86, v5
    v_mov_b32 v18, 162304
    s_add_u32 s97, s98, s0
    s_lshr_b64 s[0:1], s[0:1], 4
    s_and_b32 s97, s97, 15
    s_add_u32 m0, s87, 36864
    s_lshl_b32 s97, s97, 7
    buffer_load_dwordx4 v240, s[28:31], s97 offen offset:0  lds
    v_mov_b32 v19, 1
    v_and_b32 v5, 3, v0
    s_lshl_b32 s78, s74, 4
    s_add_u32 s78, s78, s3
    buffer_load_dwordx4 v241, s[28:31], s97 offen offset:1024  lds
    v_lshl_add_u32 v6, v5, 2, s78
    s_lshr_b32 s78, s76, 3
    s_lshl_b32 s79, s3, 1
    s_add_u32 s78, s78, s79
    buffer_load_dwordx4 v242, s[28:31], s97 offen offset:2048  lds
    s_xor_b32 s78, s78, 2
    s_lshl_b32 s78, s78, 5
    s_add_u32 s79, s76, 5
    buffer_load_dwordx4 v243, s[28:31], s97 offen offset:3072  lds
    s_and_b32 s79, s79, 7
    s_lshl_b32 s79, s79, 1
    s_add_u32 s78, s78, s79
    v_mul_u32_u24 v7, 9, v5
    s_add_u32 m0, s88, 36864
    s_mov_b64 exec, 0xffffffff
    buffer_load_dwordx4 v3, s[28:31], s97 offen offset:0  lds
    s_mov_b64 exec, -1
    v_and_b32 v7, 17, v7
    v_add_u32 v7, s78, v7
    v_and_b32 v8, 4, v0
    s_waitcnt vmcnt(12)
    s_waitcnt vmcnt(11)
    s_barrier
    s_mul_i32 s16, s97, 3072
    s_add_u32 m0, s60, 49152
    s_add_u32 s99, s16, s62
    buffer_load_dwordx4 v244, s[32:35], s99 offen offset:0  lds
    v_cmp_eq_u32 vcc, 0, v8
    s_nop 1
    v_cndmask_b32 v6, v7, v6, vcc
    v_and_b32 v33, 0xf0, v6
    v_lshlrev_b32 v34, 8, v6
    buffer_load_dwordx4 v245, s[32:35], s99 offen offset:1024  lds
    v_add_u32 v34, 12582912, v34
    v_and_b32 v5, 15, v0
    v_lshrrev_b32 v6, 4, v0
    v_add_u32 v7, 9, v5
    buffer_load_dwordx4 v246, s[32:35], s99 offen offset:2048  lds
    v_and_b32 v8, 1, v7
    v_mul_u32_u24 v8, 4160, v8
    v_lshrrev_b32 v7, 1, v7
    s_add_u32 m0, s61, 61440
    s_add_u32 s16, s16, s63
    buffer_load_dwordx4 v244, s[32:35], s16 offen offset:0  lds
    v_lshl_add_u32 v8, v7, 2, v8
    v_lshlrev_b32 v7, 4, v6
    v_sub_u32 v8, v8, v7
    s_add_u32 s78, s94, 32
    buffer_load_dwordx4 v245, s[32:35], s16 offen offset:1024  lds
    v_add_u32 v21, s78, v8
    v_add_u32 v22, 1024, v21
    v_add_u32 v23, 2048, v21
    v_add_u32 v24, 3072, v21
    buffer_load_dwordx4 v246, s[32:35], s16 offen offset:2048  lds
    v_lshl_add_u32 v7, v5, 1, v6
    v_add_u32 v7, 30, v7
    v_and_b32 v8, 1, v7
    s_add_u32 s97, s98, s0
    s_lshr_b64 s[0:1], s[0:1], 4
    s_and_b32 s97, s97, 15
    s_add_u32 m0, s87, 0
    s_lshl_b32 s97, s97, 7
    buffer_load_dwordx4 v240, s[28:31], s97 offen offset:0  lds
    v_bfe_u32 v136, v7, 1, 2
    v_lshl_add_u32 v136, v8, 2, v136
    v_lshlrev_b32 v136, 6, v136
    v_lshrrev_b32 v7, 3, v7
    buffer_load_dwordx4 v241, s[28:31], s97 offen offset:1024  lds
    v_lshl_add_u32 v136, v7, 9, v136
    v_bitop3_b32 v8, v7, 3, s3 bitop3:0x6a
    v_lshl_add_u32 v25, v8, 4, v136
    v_add_u32 v25, 92160, v25
    buffer_load_dwordx4 v242, s[28:31], s97 offen offset:2048  lds
    v_subrev_u32 v7, 1, v7
    v_bitop3_b32 v8, v7, 3, s3 bitop3:0x6a
    v_lshl_add_u32 v27, v8, 4, v136
    buffer_load_dwordx4 v243, s[28:31], s97 offen offset:3072  lds
    v_add_u32 v27, 91648, v27
    v_subrev_u32 v7, 1, v7
    v_bitop3_b32 v8, v7, 3, s3 bitop3:0x6a
    v_lshl_add_u32 v29, v8, 4, v136
    s_add_u32 m0, s88, 0
    s_mov_b64 exec, 0xffffffff
    buffer_load_dwordx4 v3, s[28:31], s97 offen offset:0  lds
    s_mov_b64 exec, -1
    v_add_u32 v29, 91136, v29
    v_subrev_u32 v7, 1, v7
    v_bitop3_b32 v8, v7, 3, s3 bitop3:0x6a
    s_waitcnt vmcnt(11)
    s_barrier
    s_mul_i32 s16, s97, 3072
    s_add_u32 m0, s60, 0
    s_add_u32 s99, s16, s62
    buffer_load_dwordx4 v244, s[32:35], s99 offen offset:0  lds
    v_lshl_add_u32 v31, v8, 4, v136
    v_add_u32 v31, 90624, v31
    v_lshl_add_u32 v7, v5, 1, v6
    buffer_load_dwordx4 v245, s[32:35], s99 offen offset:1024  lds
    v_add_u32 v7, 26, v7
    v_and_b32 v8, 1, v7
    v_bfe_u32 v136, v7, 1, 2
    buffer_load_dwordx4 v246, s[32:35], s99 offen offset:2048  lds
    v_lshl_add_u32 v136, v8, 2, v136
    v_lshlrev_b32 v136, 6, v136
    s_add_u32 m0, s61, 12288
    s_add_u32 s16, s16, s63
    buffer_load_dwordx4 v244, s[32:35], s16 offen offset:0  lds
    v_lshrrev_b32 v7, 3, v7
    v_lshl_add_u32 v136, v7, 9, v136
    v_bitop3_b32 v8, v7, 3, s3 bitop3:0x6a
    buffer_load_dwordx4 v245, s[32:35], s16 offen offset:1024  lds
    v_lshl_add_u32 v26, v8, 4, v136
    v_add_u32 v26, 92160, v26
    v_subrev_u32 v7, 1, v7
    buffer_load_dwordx4 v246, s[32:35], s16 offen offset:2048  lds
    v_bitop3_b32 v8, v7, 3, s3 bitop3:0x6a
    v_lshl_add_u32 v28, v8, 4, v136
    s_add_u32 m0, s94, 32
    s_lshl_b32 s89, s90, 12
    buffer_load_dwordx4 v15, s[48:51], s89 offen offset:0 nt lds
    v_add_u32 v28, 91648, v28
    v_subrev_u32 v7, 1, v7
    v_bitop3_b32 v8, v7, 3, s3 bitop3:0x6a
    s_add_u32 m0, s94, 32
    s_lshl_b32 s89, s90, 12
    buffer_load_dwordx4 v15, s[48:51], s89 offen offset:1024 nt lds
    v_lshl_add_u32 v30, v8, 4, v136
    v_add_u32 v30, 91136, v30
    v_subrev_u32 v7, 1, v7
    s_add_u32 m0, s94, 32
    s_lshl_b32 s89, s90, 12
    buffer_load_dwordx4 v15, s[48:51], s89 offen offset:2048 nt lds
    v_bitop3_b32 v8, v7, 3, s3 bitop3:0x6a
    v_lshl_add_u32 v32, v8, 4, v136
    s_add_u32 m0, s94, 32
    s_lshl_b32 s89, s90, 12
    buffer_load_dwordx4 v15, s[48:51], s89 offen offset:3072 nt lds
    v_add_u32 v32, 90624, v32
    v_lshrrev_b32 v7, 1, v6
    v_lshl_add_u32 v7, v5, 1, v7
    s_add_u32 s97, s98, s0
    s_lshr_b64 s[0:1], s[0:1], 4
    s_and_b32 s97, s97, 15
    s_add_u32 m0, s87, 18432
    s_lshl_b32 s97, s97, 7
    buffer_load_dwordx4 v240, s[28:31], s97 offen offset:0  lds
    v_add_u32 v7, 32, v7
    v_and_b32 v8, 1, v7
    v_bfe_u32 v136, v7, 1, 2
    buffer_load_dwordx4 v241, s[28:31], s97 offen offset:1024  lds
    v_lshl_add_u32 v136, v8, 2, v136
    v_lshlrev_b32 v136, 6, v136
    buffer_load_dwordx4 v242, s[28:31], s97 offen offset:2048  lds
    v_lshrrev_b32 v7, 3, v7
    v_lshl_add_u32 v136, v7, 9, v136
    v_bitop3_b32 v8, v7, 3, s3 bitop3:0x6a
    buffer_load_dwordx4 v243, s[28:31], s97 offen offset:3072  lds
    v_lshl_add_u32 v20, v8, 4, v136
    v_add_u32 v20, 92160, v20
    v_and_b32 v8, 1, v6
    s_add_u32 m0, s88, 18432
    s_mov_b64 exec, 0xffffffff
    buffer_load_dwordx4 v3, s[28:31], s97 offen offset:0  lds
    s_mov_b64 exec, -1
    v_xor_b32 v8, 1, v8
    v_lshl_add_u32 v20, v8, 3, v20
    s_waitcnt vmcnt(15)
    s_barrier
    s_mul_i32 s16, s97, 3072
    s_add_u32 m0, s60, 24576
    s_add_u32 s99, s16, s62
    buffer_load_dwordx4 v244, s[32:35], s99 offen offset:0  lds
    s_waitcnt lgkmcnt(0)
    s_and_b32 s78, s92, 0xffff0000
    s_lshl_b32 s92, s92, 16
    buffer_load_dwordx4 v245, s[32:35], s99 offen offset:1024  lds
    s_bitcmp1_b32 s90, 0
    s_cselect_b32 s92, s78, s92
    v_lshlrev_b32 v7, 3, v6
    v_sub_u32 v7, v7, v5
    buffer_load_dwordx4 v246, s[32:35], s99 offen offset:2048  lds
    v_subrev_u32 v7, 9, v7
    v_and_b32 v8, 1, v7
    v_xor_b32 v8, 1, v8
    s_add_u32 m0, s61, 36864
    s_add_u32 s16, s16, s63
    buffer_load_dwordx4 v244, s[32:35], s16 offen offset:0  lds
    v_lshlrev_b32 v8, 4, v8
    v_lshrrev_b32 v8, v8, s92
    v_ashrrev_i32 v7, 1, v7
    buffer_load_dwordx4 v245, s[32:35], s16 offen offset:1024  lds
    v_cmp_eq_u32 vcc, 0, v7
    s_nop 1
    v_cndmask_b32 v236, 0, v8, vcc
    v_cmp_eq_u32 vcc, 1, v7
    buffer_load_dwordx4 v246, s[32:35], s16 offen offset:2048  lds
    s_nop 0
    v_cndmask_b32 v237, 0, v8, vcc
    v_cmp_eq_u32 vcc, 2, v7
    s_nop 1
    v_cndmask_b32 v238, 0, v8, vcc
    s_add_u32 s97, s98, s0
    s_lshr_b64 s[0:1], s[0:1], 4
    s_and_b32 s97, s97, 15
    s_add_u32 m0, s87, 36864
    s_lshl_b32 s97, s97, 7
    buffer_load_dwordx4 v240, s[28:31], s97 offen offset:0  lds
    v_cmp_eq_u32 vcc, 3, v7
    s_nop 1
    v_cndmask_b32 v239, 0, v8, vcc
    s_and_b32 s78, s77, 7
    s_mov_b32 s95, 0x76543210
    s_and_b32 s78, s76, 3
    s_mul_i32 s78, s78, 0x22222222
    s_add_u32 s95, s95, s78
    s_bfe_u32 s17, s95, 0x30000
    s_lshl_b32 s17, s17, 18
    s_bfe_u32 s18, s95, 0x30004
    s_lshl_b32 s18, s18, 18
    s_bfe_u32 s100, s95, 0x3001c
    s_lshl_b32 s100, s100, 18
    s_bfe_u32 s95, s95, 0x30018
    s_lshl_b32 s95, s95, 18
    buffer_load_dwordx4 v241, s[28:31], s97 offen offset:1024  lds
    v_lshrrev_b32 v136, 4, v0
    v_lshlrev_b32 v136, 1, v136
    v_and_b32 v137, 7, v0
    buffer_load_dwordx4 v242, s[28:31], s97 offen offset:2048  lds
    v_xor_b32 v136, v136, v137
    v_lshlrev_b32 v136, 4, v136
    v_lshrrev_b32 v137, 3, v0
    buffer_load_dwordx4 v243, s[28:31], s97 offen offset:3072  lds
    v_lshl_add_u32 v136, v137, 11, v136
    s_lshl_b32 s78, s77, 7
    s_lshl_b32 s79, s3, 14
    s_add_u32 m0, s88, 36864
    s_mov_b64 exec, 0xffffffff
    buffer_load_dwordx4 v3, s[28:31], s97 offen offset:0  lds
    s_mov_b64 exec, -1
    s_add_u32 s78, s78, s79
    v_add_u32 v17, s78, v136
    s_waitcnt vmcnt(11)
    s_barrier
    s_mul_i32 s16, s97, 3072
    s_add_u32 m0, s60, 49152
    s_add_u32 s99, s16, s62
    buffer_load_dwordx4 v244, s[32:35], s99 offen offset:0  lds
    v_add_u32 v5, s94, v15
    ds_read_b128 v[140:143], v5 offset:32
    ds_read_b32 v156, v5 offset:48
    ds_read_b128 v[144:147], v5 offset:1056
    buffer_load_dwordx4 v245, s[32:35], s99 offen offset:1024  lds
    ds_read_b32 v157, v5 offset:1072
    ds_read_b128 v[148:151], v5 offset:2080
    ds_read_b32 v158, v5 offset:2096
    ds_read_b128 v[152:155], v5 offset:3104
    buffer_load_dwordx4 v246, s[32:35], s99 offen offset:2048  lds
    ds_read_b32 v159, v5 offset:3120
    v_lshrrev_b32 v6, 3, v0
    v_mul_u32_u24 v6, 4160, v6
    s_add_u32 m0, s61, 61440
    s_add_u32 s16, s16, s63
    buffer_load_dwordx4 v244, s[32:35], s16 offen offset:0  lds
    v_and_b32 v7, 7, v0
    v_lshl_add_u32 v6, v7, 2, v6
    v_add_u32 v6, s94, v6
    v_mov_b32 v7, 0
    buffer_load_dwordx4 v245, s[32:35], s16 offen offset:1024  lds
    s_waitcnt lgkmcnt(0)
    v_readfirstlane_b32 s93, v140
    s_nop 0
    s_lshl_b32 s93, s93, 16
    s_nop 1
    v_writelane_b32 v7, s93, 15
    buffer_load_dwordx4 v246, s[32:35], s16 offen offset:2048  lds
    v_alignbit_b32 v140, v141, v140, 16
    v_alignbit_b32 v141, v142, v141, 16
    v_alignbit_b32 v142, v143, v142, 16
    s_add_u32 s97, s98, s0
    s_lshr_b64 s[0:1], s[0:1], 4
    s_and_b32 s97, s97, 15
    s_add_u32 m0, s87, 0
    s_lshl_b32 s97, s97, 7
    buffer_load_dwordx4 v240, s[28:31], s97 offen offset:0  lds
    v_alignbit_b32 v143, v156, v143, 16
    v_alignbit_b32 v144, v145, v144, 16
    v_alignbit_b32 v145, v146, v145, 16
    v_alignbit_b32 v146, v147, v146, 16
    buffer_load_dwordx4 v241, s[28:31], s97 offen offset:1024  lds
    v_alignbit_b32 v147, v157, v147, 16
    v_alignbit_b32 v148, v149, v148, 16
    v_alignbit_b32 v149, v150, v149, 16
    v_alignbit_b32 v150, v151, v150, 16
    buffer_load_dwordx4 v242, s[28:31], s97 offen offset:2048  lds
    v_alignbit_b32 v151, v158, v151, 16
    v_alignbit_b32 v152, v153, v152, 16
    v_alignbit_b32 v153, v154, v153, 16
    buffer_load_dwordx4 v243, s[28:31], s97 offen offset:3072  lds
    v_alignbit_b32 v154, v155, v154, 16
    v_alignbit_b32 v155, v159, v155, 16
    v_lshlrev_b32 v8, 3, v0
    s_add_u32 s78, s88, 18432
    s_add_u32 m0, s88, 0
    s_mov_b64 exec, 0xffffffff
    buffer_load_dwordx4 v3, s[28:31], s97 offen offset:0  lds
    s_mov_b64 exec, -1
    v_add_u32 v8, s78, v8
    v_mov_b32 v156, 0
    v_mov_b32 v157, 0
    s_waitcnt vmcnt(11)
    s_barrier
    s_mul_i32 s16, s97, 3072
    s_add_u32 m0, s60, 0
    s_add_u32 s99, s16, s62
    buffer_load_dwordx4 v244, s[32:35], s99 offen offset:0  lds
    buffer_load_dwordx4 v245, s[32:35], s99 offen offset:1024  lds
    buffer_load_dwordx4 v246, s[32:35], s99 offen offset:2048  lds
    s_add_u32 m0, s61, 12288
    s_add_u32 s16, s16, s63
    buffer_load_dwordx4 v244, s[32:35], s16 offen offset:0  lds
    buffer_load_dwordx4 v245, s[32:35], s16 offen offset:1024  lds
    buffer_load_dwordx4 v246, s[32:35], s16 offen offset:2048  lds
    s_mov_b64 exec, 0xff
    buffer_load_dword v136, v33, s[68:71], 0 offen sc1
    buffer_load_dword v137, v34, s[52:55], 0 offen sc1
    s_mov_b64 exec, -1
    buffer_load_dwordx4 v[212:215], v9, s[56:59], 0 offen offset:0 nt
    buffer_load_dwordx4 v[216:219], v9, s[56:59], 0 offen offset:2048 nt
    buffer_load_dwordx4 v[220:223], v9, s[56:59], s96 offen offset:0 nt
    buffer_load_dwordx4 v[224:227], v9, s[56:59], s96 offen offset:2048 nt
    s_waitcnt vmcnt(12)
    s_waitcnt vmcnt(6)
    s_barrier
    s_waitcnt vmcnt(4)
LA_j:
    s_mov_b64 exec, 0xff
    v_cmp_ne_u32 vcc, v136, v137
    v_cmp_gt_u32 s[80:81], s96, v136
    s_nop 0
    s_or_b64 vcc, vcc, s[80:81]
    s_cbranch_vccnz LA_slow
LA_back:
    s_mov_b64 exec, -1
    s_add_u32 m0, s86, 94208
    s_add_u32 s89, s91, 0
    buffer_load_dwordx4 v14, s[52:55], s89 offen sc1 lds
    s_add_u32 m0, s86, 98304
    s_add_u32 s89, s91, 4096
    buffer_load_dwordx4 v14, s[52:55], s89 offen sc1 lds
    s_add_u32 m0, s86, 102400
    s_add_u32 s89, s91, 8192
    buffer_load_dwordx4 v14, s[52:55], s89 offen sc1 lds
    s_add_u32 m0, s86, 106496
    s_add_u32 s89, s91, 12288
    buffer_load_dwordx4 v14, s[52:55], s89 offen sc1 lds
    s_mov_b64 exec, 0xffff
    ds_write_b32 v6, v7
    s_mov_b64 exec, -1
    ds_write_b128 v5, v[140:143] offset:4192
    ds_write_b128 v5, v[144:147] offset:5216
    ds_write_b128 v5, v[148:151] offset:6240
    ds_write_b128 v5, v[152:155] offset:7264
    ds_write_b64 v8, v[156:157]
    s_add_u32 s89, s95, 131072
    buffer_load_dwordx4 v[228:231], v17, s[64:67], s89 offen
    s_add_u32 s89, s95, 196608
    buffer_load_dwordx4 v[232:235], v17, s[64:67], s89 offen
    s_add_u32 s89, s100, 0
    buffer_load_dwordx4 v[240:243], v17, s[64:67], s89 offen
    s_add_u32 s89, s100, 65536
    buffer_load_dwordx4 v[244:247], v17, s[64:67], s89 offen
    s_add_u32 s89, s100, 131072
    buffer_load_dwordx4 v[248:251], v17, s[64:67], s89 offen
    s_add_u32 s89, s100, 196608
    buffer_load_dwordx4 v[196:199], v17, s[64:67], s89 offen
    ds_read2_b32 v[68:69], v21 offset0:0 offset1:1
    ds_read2_b32 v[70:71], v21 offset0:2 offset1:3
    ds_read2_b32 v[72:73], v21 offset0:128 offset1:129
    ds_read2_b32 v[74:75], v21 offset0:130 offset1:131
    ds_read2_b32 v[76:77], v22 offset0:0 offset1:1
    ds_read2_b32 v[78:79], v22 offset0:2 offset1:3
    ds_read2_b32 v[80:81], v22 offset0:128 offset1:129
    ds_read2_b32 v[82:83], v22 offset0:130 offset1:131
    ds_read2_b32 v[84:85], v23 offset0:0 offset1:1
    ds_read2_b32 v[86:87], v23 offset0:2 offset1:3
    ds_read2_b32 v[88:89], v23 offset0:128 offset1:129
    ds_read2_b32 v[90:91], v23 offset0:130 offset1:131
    ds_read2_b32 v[92:93], v24 offset0:0 offset1:1
    ds_read2_b32 v[94:95], v24 offset0:2 offset1:3
    ds_read2_b32 v[96:97], v24 offset0:128 offset1:129
    ds_read2_b32 v[98:99], v24 offset0:130 offset1:131
    s_waitcnt vmcnt(6)
    s_mov_b64 exec, 1
    ds_add_u32 v18, v19 offset:20
    s_mov_b64 exec, -1
    s_branch LA_s5_in
LA_s5:
    s_sleep 1
LA_s5_in:
    ds_read_b32 v6, v18 offset:20
    s_waitcnt lgkmcnt(0)
    v_readfirstlane_b32 s78, v6
    s_nop 0
    s_cmp_ge_u32 s78, 4
    s_cbranch_scc0 LA_s5
    s_mov_b64 exec, 1
    ds_add_u32 v18, v19 offset:8
    s_mov_b64 exec, -1
    ds_read_b128 v[100:103], v25 offset:0
    ds_read_b128 v[104:107], v25 offset:2048
    ds_read_b128 v[108:111], v25 offset:4096
    ds_read_b128 v[112:115], v25 offset:6144
    ds_read_b128 v[116:119], v25 offset:8192
    ds_read_b128 v[120:123], v25 offset:10240
    ds_read_b128 v[124:127], v25 offset:12288
    ds_read_b128 v[128:131], v25 offset:14336
    s_setprio 2
    s_waitcnt lgkmcnt(7)
    v_mfma_f32_16x16x32_bf16 v[36:39], v[236:239], v[100:103], 0
    ds_read2_b32 v[132:133], v21 offset0:16 offset1:17
    v_mfma_f32_16x16x32_bf16 v[36:39], v[68:71], v[100:103], v[36:39]
    ds_read2_b32 v[134:135], v21 offset0:18 offset1:19
    s_waitcnt lgkmcnt(8)
    v_mfma_f32_16x16x32_bf16 v[40:43], v[236:239], v[104:107], 0
    v_mfma_f32_16x16x32_bf16 v[40:43], v[68:71], v[104:107], v[40:43]
    ds_read_b128 v[164:167], v26 offset:0
    v_mfma_f32_16x16x32_bf16 v[40:43], v[72:75], v[100:103], v[40:43]
    s_waitcnt lgkmcnt(8)
    v_mfma_f32_16x16x32_bf16 v[44:47], v[236:239], v[108:111], 0
    ds_read2_b32 v[136:137], v21 offset0:144 offset1:145
    v_mfma_f32_16x16x32_bf16 v[44:47], v[68:71], v[108:111], v[44:47]
    ds_read2_b32 v[138:139], v21 offset0:146 offset1:147
    v_mfma_f32_16x16x32_bf16 v[44:47], v[72:75], v[104:107], v[44:47]
    v_mfma_f32_16x16x32_bf16 v[44:47], v[76:79], v[100:103], v[44:47]
    ds_read_b128 v[168:171], v26 offset:2048
    s_waitcnt lgkmcnt(10)
    v_mfma_f32_16x16x32_bf16 v[48:51], v[236:239], v[112:115], 0
    v_mfma_f32_16x16x32_bf16 v[48:51], v[68:71], v[112:115], v[48:51]
    ds_read2_b32 v[140:141], v22 offset0:16 offset1:17
    v_mfma_f32_16x16x32_bf16 v[48:51], v[72:75], v[108:111], v[48:51]
    ds_read2_b32 v[142:143], v22 offset0:18 offset1:19
    v_mfma_f32_16x16x32_bf16 v[48:51], v[76:79], v[104:107], v[48:51]
    v_mfma_f32_16x16x32_bf16 v[48:51], v[80:83], v[100:103], v[48:51]
    ds_read_b128 v[172:175], v26 offset:4096
    s_waitcnt lgkmcnt(12)
    v_mfma_f32_16x16x32_bf16 v[52:55], v[236:239], v[116:119], 0
    v_mfma_f32_16x16x32_bf16 v[52:55], v[68:71], v[116:119], v[52:55]
    ds_read2_b32 v[144:145], v22 offset0:144 offset1:145
    v_mfma_f32_16x16x32_bf16 v[52:55], v[72:75], v[112:115], v[52:55]
    ds_read2_b32 v[146:147], v22 offset0:146 offset1:147
    v_mfma_f32_16x16x32_bf16 v[52:55], v[76:79], v[108:111], v[52:55]
    v_mfma_f32_16x16x32_bf16 v[52:55], v[80:83], v[104:107], v[52:55]
    ds_read_b128 v[176:179], v26 offset:6144
    v_mfma_f32_16x16x32_bf16 v[52:55], v[84:87], v[100:103], v[52:55]
    s_waitcnt lgkmcnt(14)
    v_mfma_f32_16x16x32_bf16 v[56:59], v[236:239], v[120:123], 0
    ds_read2_b32 v[148:149], v23 offset0:16 offset1:17
    v_mfma_f32_16x16x32_bf16 v[56:59], v[68:71], v[120:123], v[56:59]
    ds_read2_b32 v[150:151], v23 offset0:18 offset1:19
    v_mfma_f32_16x16x32_bf16 v[56:59], v[72:75], v[116:119], v[56:59]
    v_mfma_f32_16x16x32_bf16 v[56:59], v[76:79], v[112:115], v[56:59]
    ds_read_b128 v[180:183], v26 offset:8192
    v_mfma_f32_16x16x32_bf16 v[56:59], v[80:83], v[108:111], v[56:59]
    v_mfma_f32_16x16x32_bf16 v[56:59], v[84:87], v[104:107], v[56:59]
    ds_read2_b32 v[152:153], v23 offset0:144 offset1:145
    v_mfma_f32_16x16x32_bf16 v[56:59], v[88:91], v[100:103], v[56:59]
    ds_read2_b32 v[154:155], v23 offset0:146 offset1:147
    s_waitcnt lgkmcnt(14)
    v_mfma_f32_16x16x32_bf16 v[60:63], v[236:239], v[124:127], 0
    v_mfma_f32_16x16x32_bf16 v[60:63], v[68:71], v[124:127], v[60:63]
    ds_read_b128 v[184:187], v26 offset:10240
    v_mfma_f32_16x16x32_bf16 v[60:63], v[72:75], v[120:123], v[60:63]
    v_mfma_f32_16x16x32_bf16 v[60:63], v[76:79], v[116:119], v[60:63]
    ds_read2_b32 v[156:157], v24 offset0:16 offset1:17
    v_mfma_f32_16x16x32_bf16 v[60:63], v[80:83], v[112:115], v[60:63]
    ds_read2_b32 v[158:159], v24 offset0:18 offset1:19
    v_mfma_f32_16x16x32_bf16 v[60:63], v[84:87], v[108:111], v[60:63]
    v_mfma_f32_16x16x32_bf16 v[60:63], v[88:91], v[104:107], v[60:63]
    ds_read_b128 v[188:191], v26 offset:12288
    v_mfma_f32_16x16x32_bf16 v[60:63], v[92:95], v[100:103], v[60:63]
    v_mfma_f32_16x16x32_bf16 v[64:67], v[236:239], v[128:131], 0
    ds_read2_b32 v[160:161], v24 offset0:144 offset1:145
    v_mfma_f32_16x16x32_bf16 v[64:67], v[68:71], v[128:131], v[64:67]
    ds_read2_b32 v[162:163], v24 offset0:146 offset1:147
    v_mfma_f32_16x16x32_bf16 v[64:67], v[72:75], v[124:127], v[64:67]
    v_mfma_f32_16x16x32_bf16 v[64:67], v[76:79], v[120:123], v[64:67]
    ds_read_b128 v[192:195], v26 offset:14336
    v_mfma_f32_16x16x32_bf16 v[64:67], v[80:83], v[116:119], v[64:67]
    v_mfma_f32_16x16x32_bf16 v[64:67], v[84:87], v[112:115], v[64:67]
    v_mfma_f32_16x16x32_bf16 v[64:67], v[88:91], v[108:111], v[64:67]
    v_mfma_f32_16x16x32_bf16 v[64:67], v[92:95], v[104:107], v[64:67]
    v_mfma_f32_16x16x32_bf16 v[64:67], v[96:99], v[100:103], v[64:67]
    v_mfma_f32_16x16x32_bf16 v[36:39], v[132:135], v[164:167], v[36:39]
    ds_read2_b32 v[68:69], v21 offset0:32 offset1:33
    s_waitcnt lgkmcnt(14)
    v_mfma_f32_16x16x32_bf16 v[40:43], v[136:139], v[164:167], v[40:43]
    ds_read2_b32 v[70:71], v21 offset0:34 offset1:35
    v_mfma_f32_16x16x32_bf16 v[40:43], v[132:135], v[168:171], v[40:43]
    ds_read_b128 v[100:103], v27 offset:0
    v_mfma_f32_16x16x32_bf16 v[44:47], v[132:135], v[172:175], v[44:47]
    v_mfma_f32_16x16x32_bf16 v[44:47], v[136:139], v[168:171], v[44:47]
    ds_read2_b32 v[72:73], v21 offset0:160 offset1:161
    v_mfma_f32_16x16x32_bf16 v[44:47], v[140:143], v[164:167], v[44:47]
    ds_read2_b32 v[74:75], v21 offset0:162 offset1:163
    v_mfma_f32_16x16x32_bf16 v[48:51], v[144:147], v[164:167], v[48:51]
    ds_read_b128 v[104:107], v27 offset:2048
    v_mfma_f32_16x16x32_bf16 v[48:51], v[140:143], v[168:171], v[48:51]
    v_mfma_f32_16x16x32_bf16 v[48:51], v[136:139], v[172:175], v[48:51]
    ds_read2_b32 v[76:77], v22 offset0:32 offset1:33
    s_waitcnt lgkmcnt(14)
    v_mfma_f32_16x16x32_bf16 v[48:51], v[132:135], v[176:179], v[48:51]
    ds_read2_b32 v[78:79], v22 offset0:34 offset1:35
    v_mfma_f32_16x16x32_bf16 v[52:55], v[132:135], v[180:183], v[52:55]
    ds_read_b128 v[108:111], v27 offset:4096
    v_mfma_f32_16x16x32_bf16 v[52:55], v[136:139], v[176:179], v[52:55]
    v_mfma_f32_16x16x32_bf16 v[52:55], v[140:143], v[172:175], v[52:55]
    ds_read2_b32 v[80:81], v22 offset0:160 offset1:161
    v_mfma_f32_16x16x32_bf16 v[52:55], v[144:147], v[168:171], v[52:55]
    ds_read2_b32 v[82:83], v22 offset0:162 offset1:163
    v_mfma_f32_16x16x32_bf16 v[52:55], v[148:151], v[164:167], v[52:55]
    ds_read_b128 v[112:115], v27 offset:6144
    v_mfma_f32_16x16x32_bf16 v[56:59], v[152:155], v[164:167], v[56:59]
    v_mfma_f32_16x16x32_bf16 v[56:59], v[148:151], v[168:171], v[56:59]
    ds_read2_b32 v[84:85], v23 offset0:32 offset1:33
    v_mfma_f32_16x16x32_bf16 v[56:59], v[144:147], v[172:175], v[56:59]
    ds_read2_b32 v[86:87], v23 offset0:34 offset1:35
    v_mfma_f32_16x16x32_bf16 v[56:59], v[140:143], v[176:179], v[56:59]
    ds_read_b128 v[116:119], v27 offset:8192
    v_mfma_f32_16x16x32_bf16 v[56:59], v[136:139], v[180:183], v[56:59]
    s_waitcnt lgkmcnt(14)
    v_mfma_f32_16x16x32_bf16 v[56:59], v[132:135], v[184:187], v[56:59]
    ds_read2_b32 v[88:89], v23 offset0:160 offset1:161
    v_mfma_f32_16x16x32_bf16 v[60:63], v[132:135], v[188:191], v[60:63]
    ds_read2_b32 v[90:91], v23 offset0:162 offset1:163
    v_mfma_f32_16x16x32_bf16 v[60:63], v[136:139], v[184:187], v[60:63]
    ds_read_b128 v[120:123], v27 offset:10240
    v_mfma_f32_16x16x32_bf16 v[60:63], v[140:143], v[180:183], v[60:63]
    v_mfma_f32_16x16x32_bf16 v[60:63], v[144:147], v[176:179], v[60:63]
    ds_read2_b32 v[92:93], v24 offset0:32 offset1:33
    v_mfma_f32_16x16x32_bf16 v[60:63], v[148:151], v[172:175], v[60:63]
    ds_read2_b32 v[94:95], v24 offset0:34 offset1:35
    v_mfma_f32_16x16x32_bf16 v[60:63], v[152:155], v[168:171], v[60:63]
    ds_read_b128 v[124:127], v27 offset:12288
    v_mfma_f32_16x16x32_bf16 v[60:63], v[156:159], v[164:167], v[60:63]
    v_mfma_f32_16x16x32_bf16 v[64:67], v[160:163], v[164:167], v[64:67]
    ds_read2_b32 v[96:97], v24 offset0:160 offset1:161
    v_mfma_f32_16x16x32_bf16 v[64:67], v[156:159], v[168:171], v[64:67]
    ds_read2_b32 v[98:99], v24 offset0:162 offset1:163
    v_mfma_f32_16x16x32_bf16 v[64:67], v[152:155], v[172:175], v[64:67]
    ds_read_b128 v[128:131], v27 offset:14336
    v_mfma_f32_16x16x32_bf16 v[64:67], v[148:151], v[176:179], v[64:67]
    v_mfma_f32_16x16x32_bf16 v[64:67], v[144:147], v[180:183], v[64:67]
    v_mfma_f32_16x16x32_bf16 v[64:67], v[140:143], v[184:187], v[64:67]
    v_mfma_f32_16x16x32_bf16 v[64:67], v[136:139], v[188:191], v[64:67]
    v_mfma_f32_16x16x32_bf16 v[64:67], v[132:135], v[192:195], v[64:67]
    s_waitcnt lgkmcnt(14)
    v_mfma_f32_16x16x32_bf16 v[36:39], v[68:71], v[100:103], v[36:39]
    ds_read2_b32 v[132:133], v21 offset0:48 offset1:49
    v_mfma_f32_16x16x32_bf16 v[40:43], v[72:75], v[100:103], v[40:43]
    ds_read2_b32 v[134:135], v21 offset0:50 offset1:51
    v_mfma_f32_16x16x32_bf16 v[40:43], v[68:71], v[104:107], v[40:43]
    ds_read_b128 v[164:167], v28 offset:0
    v_mfma_f32_16x16x32_bf16 v[44:47], v[68:71], v[108:111], v[44:47]
    v_mfma_f32_16x16x32_bf16 v[44:47], v[72:75], v[104:107], v[44:47]
    ds_read2_b32 v[136:137], v21 offset0:176 offset1:177
    v_mfma_f32_16x16x32_bf16 v[44:47], v[76:79], v[100:103], v[44:47]
    ds_read2_b32 v[138:139], v21 offset0:178 offset1:179
    s_waitcnt lgkmcnt(14)
    v_mfma_f32_16x16x32_bf16 v[48:51], v[80:83], v[100:103], v[48:51]
    ds_read_b128 v[168:171], v28 offset:2048
    v_mfma_f32_16x16x32_bf16 v[48:51], v[76:79], v[104:107], v[48:51]
    v_mfma_f32_16x16x32_bf16 v[48:51], v[72:75], v[108:111], v[48:51]
    ds_read2_b32 v[140:141], v22 offset0:48 offset1:49
    v_mfma_f32_16x16x32_bf16 v[48:51], v[68:71], v[112:115], v[48:51]
    ds_read2_b32 v[142:143], v22 offset0:50 offset1:51
    v_mfma_f32_16x16x32_bf16 v[52:55], v[68:71], v[116:119], v[52:55]
    ds_read_b128 v[172:175], v28 offset:4096
    v_mfma_f32_16x16x32_bf16 v[52:55], v[72:75], v[112:115], v[52:55]
    v_mfma_f32_16x16x32_bf16 v[52:55], v[76:79], v[108:111], v[52:55]
    ds_read2_b32 v[144:145], v22 offset0:176 offset1:177
    v_mfma_f32_16x16x32_bf16 v[52:55], v[80:83], v[104:107], v[52:55]
    ds_read2_b32 v[146:147], v22 offset0:178 offset1:179
    v_mfma_f32_16x16x32_bf16 v[52:55], v[84:87], v[100:103], v[52:55]
    ds_read_b128 v[176:179], v28 offset:6144
    s_waitcnt lgkmcnt(14)
    v_mfma_f32_16x16x32_bf16 v[56:59], v[88:91], v[100:103], v[56:59]
    v_mfma_f32_16x16x32_bf16 v[56:59], v[84:87], v[104:107], v[56:59]
    ds_read2_b32 v[148:149], v23 offset0:48 offset1:49
    v_mfma_f32_16x16x32_bf16 v[56:59], v[80:83], v[108:111], v[56:59]
    ds_read2_b32 v[150:151], v23 offset0:50 offset1:51
    v_mfma_f32_16x16x32_bf16 v[56:59], v[76:79], v[112:115], v[56:59]
    ds_read_b128 v[180:183], v28 offset:8192
    v_mfma_f32_16x16x32_bf16 v[56:59], v[72:75], v[116:119], v[56:59]
    v_mfma_f32_16x16x32_bf16 v[56:59], v[68:71], v[120:123], v[56:59]
    ds_read2_b32 v[152:153], v23 offset0:176 offset1:177
    v_mfma_f32_16x16x32_bf16 v[60:63], v[68:71], v[124:127], v[60:63]
    ds_read2_b32 v[154:155], v23 offset0:178 offset1:179
    v_mfma_f32_16x16x32_bf16 v[60:63], v[72:75], v[120:123], v[60:63]
    ds_read_b128 v[184:187], v28 offset:10240
    v_mfma_f32_16x16x32_bf16 v[60:63], v[76:79], v[116:119], v[60:63]
    v_mfma_f32_16x16x32_bf16 v[60:63], v[80:83], v[112:115], v[60:63]
    ds_read2_b32 v[156:157], v24 offset0:48 offset1:49
    v_mfma_f32_16x16x32_bf16 v[60:63], v[84:87], v[108:111], v[60:63]
    ds_read2_b32 v[158:159], v24 offset0:50 offset1:51
    v_mfma_f32_16x16x32_bf16 v[60:63], v[88:91], v[104:107], v[60:63]
    ds_read_b128 v[188:191], v28 offset:12288
    v_mfma_f32_16x16x32_bf16 v[60:63], v[92:95], v[100:103], v[60:63]
    s_waitcnt lgkmcnt(14)
    v_mfma_f32_16x16x32_bf16 v[64:67], v[96:99], v[100:103], v[64:67]
    ds_read2_b32 v[160:161], v24 offset0:176 offset1:177
    v_mfma_f32_16x16x32_bf16 v[64:67], v[92:95], v[104:107], v[64:67]
    ds_read2_b32 v[162:163], v24 offset0:178 offset1:179
    v_mfma_f32_16x16x32_bf16 v[64:67], v[88:91], v[108:111], v[64:67]
    ds_read_b128 v[192:195], v28 offset:14336
    v_mfma_f32_16x16x32_bf16 v[64:67], v[84:87], v[112:115], v[64:67]
    v_mfma_f32_16x16x32_bf16 v[64:67], v[80:83], v[116:119], v[64:67]
    v_mfma_f32_16x16x32_bf16 v[64:67], v[76:79], v[120:123], v[64:67]
    v_mfma_f32_16x16x32_bf16 v[64:67], v[72:75], v[124:127], v[64:67]
    v_mfma_f32_16x16x32_bf16 v[64:67], v[68:71], v[128:131], v[64:67]
    v_mfma_f32_16x16x32_bf16 v[36:39], v[132:135], v[164:167], v[36:39]
    ds_read2_b32 v[68:69], v21 offset0:64 offset1:65
    v_mfma_f32_16x16x32_bf16 v[40:43], v[136:139], v[164:167], v[40:43]
    ds_read2_b32 v[70:71], v21 offset0:66 offset1:67
    v_mfma_f32_16x16x32_bf16 v[40:43], v[132:135], v[168:171], v[40:43]
    ds_read_b128 v[100:103], v29 offset:0
    s_waitcnt lgkmcnt(14)
    v_mfma_f32_16x16x32_bf16 v[44:47], v[132:135], v[172:175], v[44:47]
    v_mfma_f32_16x16x32_bf16 v[44:47], v[136:139], v[168:171], v[44:47]
    ds_read2_b32 v[72:73], v21 offset0:192 offset1:193
    v_mfma_f32_16x16x32_bf16 v[44:47], v[140:143], v[164:167], v[44:47]
    ds_read2_b32 v[74:75], v21 offset0:194 offset1:195
    v_mfma_f32_16x16x32_bf16 v[48:51], v[144:147], v[164:167], v[48:51]
    ds_read_b128 v[104:107], v29 offset:2048
    v_mfma_f32_16x16x32_bf16 v[48:51], v[140:143], v[168:171], v[48:51]
    v_mfma_f32_16x16x32_bf16 v[48:51], v[136:139], v[172:175], v[48:51]
    ds_read2_b32 v[76:77], v22 offset0:64 offset1:65
    v_mfma_f32_16x16x32_bf16 v[48:51], v[132:135], v[176:179], v[48:51]
    ds_read2_b32 v[78:79], v22 offset0:66 offset1:67
    s_waitcnt lgkmcnt(14)
    v_mfma_f32_16x16x32_bf16 v[52:55], v[132:135], v[180:183], v[52:55]
    ds_read_b128 v[108:111], v29 offset:4096
    v_mfma_f32_16x16x32_bf16 v[52:55], v[136:139], v[176:179], v[52:55]
    v_mfma_f32_16x16x32_bf16 v[52:55], v[140:143], v[172:175], v[52:55]
    ds_read2_b32 v[80:81], v22 offset0:192 offset1:193
    v_mfma_f32_16x16x32_bf16 v[52:55], v[144:147], v[168:171], v[52:55]
    ds_read2_b32 v[82:83], v22 offset0:194 offset1:195
    v_mfma_f32_16x16x32_bf16 v[52:55], v[148:151], v[164:167], v[52:55]
    ds_read_b128 v[112:115], v29 offset:6144
    v_mfma_f32_16x16x32_bf16 v[56:59], v[152:155], v[164:167], v[56:59]
    v_mfma_f32_16x16x32_bf16 v[56:59], v[148:151], v[168:171], v[56:59]
    ds_read2_b32 v[84:85], v23 offset0:64 offset1:65
    v_mfma_f32_16x16x32_bf16 v[56:59], v[144:147], v[172:175], v[56:59]
    ds_read2_b32 v[86:87], v23 offset0:66 offset1:67
    v_mfma_f32_16x16x32_bf16 v[56:59], v[140:143], v[176:179], v[56:59]
    ds_read_b128 v[116:119], v29 offset:8192
    v_mfma_f32_16x16x32_bf16 v[56:59], v[136:139], v[180:183], v[56:59]
    v_mfma_f32_16x16x32_bf16 v[56:59], v[132:135], v[184:187], v[56:59]
    ds_read2_b32 v[88:89], v23 offset0:192 offset1:193
    s_waitcnt lgkmcnt(14)
    v_mfma_f32_16x16x32_bf16 v[60:63], v[132:135], v[188:191], v[60:63]
    ds_read2_b32 v[90:91], v23 offset0:194 offset1:195
    v_mfma_f32_16x16x32_bf16 v[60:63], v[136:139], v[184:187], v[60:63]
    ds_read_b128 v[120:123], v29 offset:10240
    v_mfma_f32_16x16x32_bf16 v[60:63], v[140:143], v[180:183], v[60:63]
    v_mfma_f32_16x16x32_bf16 v[60:63], v[144:147], v[176:179], v[60:63]
    ds_read2_b32 v[92:93], v24 offset0:64 offset1:65
    v_mfma_f32_16x16x32_bf16 v[60:63], v[148:151], v[172:175], v[60:63]
    ds_read2_b32 v[94:95], v24 offset0:66 offset1:67
    v_mfma_f32_16x16x32_bf16 v[60:63], v[152:155], v[168:171], v[60:63]
    ds_read_b128 v[124:127], v29 offset:12288
    v_mfma_f32_16x16x32_bf16 v[60:63], v[156:159], v[164:167], v[60:63]
    v_mfma_f32_16x16x32_bf16 v[64:67], v[160:163], v[164:167], v[64:67]
    ds_read2_b32 v[96:97], v24 offset0:192 offset1:193
    v_mfma_f32_16x16x32_bf16 v[64:67], v[156:159], v[168:171], v[64:67]
    ds_read2_b32 v[98:99], v24 offset0:194 offset1:195
    v_mfma_f32_16x16x32_bf16 v[64:67], v[152:155], v[172:175], v[64:67]
    ds_read_b128 v[128:131], v29 offset:14336
    v_mfma_f32_16x16x32_bf16 v[64:67], v[148:151], v[176:179], v[64:67]
    v_mfma_f32_16x16x32_bf16 v[64:67], v[144:147], v[180:183], v[64:67]
    v_mfma_f32_16x16x32_bf16 v[64:67], v[140:143], v[184:187], v[64:67]
    v_mfma_f32_16x16x32_bf16 v[64:67], v[136:139], v[188:191], v[64:67]
    v_mfma_f32_16x16x32_bf16 v[64:67], v[132:135], v[192:195], v[64:67]
    s_waitcnt lgkmcnt(14)
    v_mfma_f32_16x16x32_bf16 v[36:39], v[68:71], v[100:103], v[36:39]
    ds_read2_b32 v[132:133], v21 offset0:80 offset1:81
    v_mfma_f32_16x16x32_bf16 v[40:43], v[72:75], v[100:103], v[40:43]
    ds_read2_b32 v[134:135], v21 offset0:82 offset1:83
    v_mfma_f32_16x16x32_bf16 v[40:43], v[68:71], v[104:107], v[40:43]
    ds_read_b128 v[164:167], v30 offset:0
    v_mfma_f32_16x16x32_bf16 v[44:47], v[68:71], v[108:111], v[44:47]
    v_mfma_f32_16x16x32_bf16 v[44:47], v[72:75], v[104:107], v[44:47]
    ds_read2_b32 v[136:137], v21 offset0:208 offset1:209
    v_mfma_f32_16x16x32_bf16 v[44:47], v[76:79], v[100:103], v[44:47]
    ds_read2_b32 v[138:139], v21 offset0:210 offset1:211
    s_waitcnt lgkmcnt(14)
    v_mfma_f32_16x16x32_bf16 v[48:51], v[80:83], v[100:103], v[48:51]
    ds_read_b128 v[168:171], v30 offset:2048
    v_mfma_f32_16x16x32_bf16 v[48:51], v[76:79], v[104:107], v[48:51]
    v_mfma_f32_16x16x32_bf16 v[48:51], v[72:75], v[108:111], v[48:51]
    ds_read2_b32 v[140:141], v22 offset0:80 offset1:81
    v_mfma_f32_16x16x32_bf16 v[48:51], v[68:71], v[112:115], v[48:51]
    ds_read2_b32 v[142:143], v22 offset0:82 offset1:83
    v_mfma_f32_16x16x32_bf16 v[52:55], v[68:71], v[116:119], v[52:55]
    ds_read_b128 v[172:175], v30 offset:4096
    v_mfma_f32_16x16x32_bf16 v[52:55], v[72:75], v[112:115], v[52:55]
    v_mfma_f32_16x16x32_bf16 v[52:55], v[76:79], v[108:111], v[52:55]
    ds_read2_b32 v[144:145], v22 offset0:208 offset1:209
    v_mfma_f32_16x16x32_bf16 v[52:55], v[80:83], v[104:107], v[52:55]
    ds_read2_b32 v[146:147], v22 offset0:210 offset1:211
    v_mfma_f32_16x16x32_bf16 v[52:55], v[84:87], v[100:103], v[52:55]
    ds_read_b128 v[176:179], v30 offset:6144
    s_waitcnt lgkmcnt(14)
    v_mfma_f32_16x16x32_bf16 v[56:59], v[88:91], v[100:103], v[56:59]
    v_mfma_f32_16x16x32_bf16 v[56:59], v[84:87], v[104:107], v[56:59]
    ds_read2_b32 v[148:149], v23 offset0:80 offset1:81
    v_mfma_f32_16x16x32_bf16 v[56:59], v[80:83], v[108:111], v[56:59]
    ds_read2_b32 v[150:151], v23 offset0:82 offset1:83
    v_mfma_f32_16x16x32_bf16 v[56:59], v[76:79], v[112:115], v[56:59]
    ds_read_b128 v[180:183], v30 offset:8192
    v_mfma_f32_16x16x32_bf16 v[56:59], v[72:75], v[116:119], v[56:59]
    v_mfma_f32_16x16x32_bf16 v[56:59], v[68:71], v[120:123], v[56:59]
    ds_read2_b32 v[152:153], v23 offset0:208 offset1:209
    v_mfma_f32_16x16x32_bf16 v[60:63], v[68:71], v[124:127], v[60:63]
    ds_read2_b32 v[154:155], v23 offset0:210 offset1:211
    v_mfma_f32_16x16x32_bf16 v[60:63], v[72:75], v[120:123], v[60:63]
    ds_read_b128 v[184:187], v30 offset:10240
    v_mfma_f32_16x16x32_bf16 v[60:63], v[76:79], v[116:119], v[60:63]
    v_mfma_f32_16x16x32_bf16 v[60:63], v[80:83], v[112:115], v[60:63]
    ds_read2_b32 v[156:157], v24 offset0:80 offset1:81
    v_mfma_f32_16x16x32_bf16 v[60:63], v[84:87], v[108:111], v[60:63]
    ds_read2_b32 v[158:159], v24 offset0:82 offset1:83
    v_mfma_f32_16x16x32_bf16 v[60:63], v[88:91], v[104:107], v[60:63]
    ds_read_b128 v[188:191], v30 offset:12288
    v_mfma_f32_16x16x32_bf16 v[60:63], v[92:95], v[100:103], v[60:63]
    s_waitcnt lgkmcnt(14)
    v_mfma_f32_16x16x32_bf16 v[64:67], v[96:99], v[100:103], v[64:67]
    ds_read2_b32 v[160:161], v24 offset0:208 offset1:209
    v_mfma_f32_16x16x32_bf16 v[64:67], v[92:95], v[104:107], v[64:67]
    ds_read2_b32 v[162:163], v24 offset0:210 offset1:211
    v_mfma_f32_16x16x32_bf16 v[64:67], v[88:91], v[108:111], v[64:67]
    ds_read_b128 v[192:195], v30 offset:14336
    v_mfma_f32_16x16x32_bf16 v[64:67], v[84:87], v[112:115], v[64:67]
    v_mfma_f32_16x16x32_bf16 v[64:67], v[80:83], v[116:119], v[64:67]
    v_mfma_f32_16x16x32_bf16 v[64:67], v[76:79], v[120:123], v[64:67]
    v_mfma_f32_16x16x32_bf16 v[64:67], v[72:75], v[124:127], v[64:67]
    v_mfma_f32_16x16x32_bf16 v[64:67], v[68:71], v[128:131], v[64:67]
    v_mfma_f32_16x16x32_bf16 v[36:39], v[132:135], v[164:167], v[36:39]
    ds_read2_b32 v[68:69], v21 offset0:96 offset1:97
    v_mfma_f32_16x16x32_bf16 v[40:43], v[136:139], v[164:167], v[40:43]
    ds_read2_b32 v[70:71], v21 offset0:98 offset1:99
    v_mfma_f32_16x16x32_bf16 v[40:43], v[132:135], v[168:171], v[40:43]
    ds_read_b128 v[100:103], v31 offset:0
    s_waitcnt lgkmcnt(14)
    v_mfma_f32_16x16x32_bf16 v[44:47], v[132:135], v[172:175], v[44:47]
    v_mfma_f32_16x16x32_bf16 v[44:47], v[136:139], v[168:171], v[44:47]
    ds_read2_b32 v[72:73], v21 offset0:224 offset1:225
    v_mfma_f32_16x16x32_bf16 v[44:47], v[140:143], v[164:167], v[44:47]
    ds_read2_b32 v[74:75], v21 offset0:226 offset1:227
    v_mfma_f32_16x16x32_bf16 v[48:51], v[144:147], v[164:167], v[48:51]
    ds_read_b128 v[104:107], v31 offset:2048
    v_mfma_f32_16x16x32_bf16 v[48:51], v[140:143], v[168:171], v[48:51]
    v_mfma_f32_16x16x32_bf16 v[48:51], v[136:139], v[172:175], v[48:51]
    ds_read2_b32 v[76:77], v22 offset0:96 offset1:97
    v_mfma_f32_16x16x32_bf16 v[48:51], v[132:135], v[176:179], v[48:51]
    ds_read2_b32 v[78:79], v22 offset0:98 offset1:99
    s_waitcnt lgkmcnt(14)
    v_mfma_f32_16x16x32_bf16 v[52:55], v[132:135], v[180:183], v[52:55]
    ds_read_b128 v[108:111], v31 offset:4096
    v_mfma_f32_16x16x32_bf16 v[52:55], v[136:139], v[176:179], v[52:55]
    v_mfma_f32_16x16x32_bf16 v[52:55], v[140:143], v[172:175], v[52:55]
    ds_read2_b32 v[80:81], v22 offset0:224 offset1:225
    v_mfma_f32_16x16x32_bf16 v[52:55], v[144:147], v[168:171], v[52:55]
    ds_read2_b32 v[82:83], v22 offset0:226 offset1:227
    v_mfma_f32_16x16x32_bf16 v[52:55], v[148:151], v[164:167], v[52:55]
    ds_read_b128 v[112:115], v31 offset:6144
    v_mfma_f32_16x16x32_bf16 v[56:59], v[152:155], v[164:167], v[56:59]
    v_mfma_f32_16x16x32_bf16 v[56:59], v[148:151], v[168:171], v[56:59]
    ds_read2_b32 v[84:85], v23 offset0:96 offset1:97
    v_mfma_f32_16x16x32_bf16 v[56:59], v[144:147], v[172:175], v[56:59]
    ds_read2_b32 v[86:87], v23 offset0:98 offset1:99
    v_mfma_f32_16x16x32_bf16 v[56:59], v[140:143], v[176:179], v[56:59]
    ds_read_b128 v[116:119], v31 offset:8192
    v_mfma_f32_16x16x32_bf16 v[56:59], v[136:139], v[180:183], v[56:59]
    v_mfma_f32_16x16x32_bf16 v[56:59], v[132:135], v[184:187], v[56:59]
    ds_read2_b32 v[88:89], v23 offset0:224 offset1:225
    s_waitcnt lgkmcnt(14)
    v_mfma_f32_16x16x32_bf16 v[60:63], v[132:135], v[188:191], v[60:63]
    ds_read2_b32 v[90:91], v23 offset0:226 offset1:227
    v_mfma_f32_16x16x32_bf16 v[60:63], v[136:139], v[184:187], v[60:63]
    ds_read_b128 v[120:123], v31 offset:10240
    v_mfma_f32_16x16x32_bf16 v[60:63], v[140:143], v[180:183], v[60:63]
    v_mfma_f32_16x16x32_bf16 v[60:63], v[144:147], v[176:179], v[60:63]
    ds_read2_b32 v[92:93], v24 offset0:96 offset1:97
    v_mfma_f32_16x16x32_bf16 v[60:63], v[148:151], v[172:175], v[60:63]
    ds_read2_b32 v[94:95], v24 offset0:98 offset1:99
    v_mfma_f32_16x16x32_bf16 v[60:63], v[152:155], v[168:171], v[60:63]
    ds_read_b128 v[124:127], v31 offset:12288
    v_mfma_f32_16x16x32_bf16 v[60:63], v[156:159], v[164:167], v[60:63]
    v_mfma_f32_16x16x32_bf16 v[64:67], v[160:163], v[164:167], v[64:67]
    ds_read2_b32 v[96:97], v24 offset0:224 offset1:225
    v_mfma_f32_16x16x32_bf16 v[64:67], v[156:159], v[168:171], v[64:67]
    ds_read2_b32 v[98:99], v24 offset0:226 offset1:227
    v_mfma_f32_16x16x32_bf16 v[64:67], v[152:155], v[172:175], v[64:67]
    ds_read_b128 v[128:131], v31 offset:14336
    v_mfma_f32_16x16x32_bf16 v[64:67], v[148:151], v[176:179], v[64:67]
    v_mfma_f32_16x16x32_bf16 v[64:67], v[144:147], v[180:183], v[64:67]
    v_mfma_f32_16x16x32_bf16 v[64:67], v[140:143], v[184:187], v[64:67]
    v_mfma_f32_16x16x32_bf16 v[64:67], v[136:139], v[188:191], v[64:67]
    v_mfma_f32_16x16x32_bf16 v[64:67], v[132:135], v[192:195], v[64:67]
    s_waitcnt lgkmcnt(14)
    v_mfma_f32_16x16x32_bf16 v[36:39], v[68:71], v[100:103], v[36:39]
    ds_read2_b32 v[132:133], v21 offset0:112 offset1:113
    v_mfma_f32_16x16x32_bf16 v[40:43], v[72:75], v[100:103], v[40:43]
    ds_read2_b32 v[134:135], v21 offset0:114 offset1:115
    v_mfma_f32_16x16x32_bf16 v[40:43], v[68:71], v[104:107], v[40:43]
    ds_read_b128 v[164:167], v32 offset:0
    v_mfma_f32_16x16x32_bf16 v[44:47], v[68:71], v[108:111], v[44:47]
    v_mfma_f32_16x16x32_bf16 v[44:47], v[72:75], v[104:107], v[44:47]
    ds_read2_b32 v[136:137], v21 offset0:240 offset1:241
    v_mfma_f32_16x16x32_bf16 v[44:47], v[76:79], v[100:103], v[44:47]
    ds_read2_b32 v[138:139], v21 offset0:242 offset1:243
    s_waitcnt lgkmcnt(14)
    v_mfma_f32_16x16x32_bf16 v[48:51], v[80:83], v[100:103], v[48:51]
    ds_read_b128 v[168:171], v32 offset:2048
    v_mfma_f32_16x16x32_bf16 v[48:51], v[76:79], v[104:107], v[48:51]
    v_mfma_f32_16x16x32_bf16 v[48:51], v[72:75], v[108:111], v[48:51]
    ds_read2_b32 v[140:141], v22 offset0:112 offset1:113
    v_mfma_f32_16x16x32_bf16 v[48:51], v[68:71], v[112:115], v[48:51]
    ds_read2_b32 v[142:143], v22 offset0:114 offset1:115
    v_mfma_f32_16x16x32_bf16 v[52:55], v[68:71], v[116:119], v[52:55]
    ds_read_b128 v[172:175], v32 offset:4096
    v_mfma_f32_16x16x32_bf16 v[52:55], v[72:75], v[112:115], v[52:55]
    v_mfma_f32_16x16x32_bf16 v[52:55], v[76:79], v[108:111], v[52:55]
    ds_read2_b32 v[144:145], v22 offset0:240 offset1:241
    v_mfma_f32_16x16x32_bf16 v[52:55], v[80:83], v[104:107], v[52:55]
    ds_read2_b32 v[146:147], v22 offset0:242 offset1:243
    v_mfma_f32_16x16x32_bf16 v[52:55], v[84:87], v[100:103], v[52:55]
    ds_read_b128 v[176:179], v32 offset:6144
    s_waitcnt lgkmcnt(14)
    v_mfma_f32_16x16x32_bf16 v[56:59], v[88:91], v[100:103], v[56:59]
    v_mfma_f32_16x16x32_bf16 v[56:59], v[84:87], v[104:107], v[56:59]
    ds_read2_b32 v[148:149], v23 offset0:112 offset1:113
    v_mfma_f32_16x16x32_bf16 v[56:59], v[80:83], v[108:111], v[56:59]
    ds_read2_b32 v[150:151], v23 offset0:114 offset1:115
    v_mfma_f32_16x16x32_bf16 v[56:59], v[76:79], v[112:115], v[56:59]
    ds_read_b128 v[180:183], v32 offset:8192
    v_mfma_f32_16x16x32_bf16 v[56:59], v[72:75], v[116:119], v[56:59]
    v_mfma_f32_16x16x32_bf16 v[56:59], v[68:71], v[120:123], v[56:59]
    ds_read2_b32 v[152:153], v23 offset0:240 offset1:241
    v_mfma_f32_16x16x32_bf16 v[60:63], v[68:71], v[124:127], v[60:63]
    ds_read2_b32 v[154:155], v23 offset0:242 offset1:243
    v_mfma_f32_16x16x32_bf16 v[60:63], v[72:75], v[120:123], v[60:63]
    ds_read_b128 v[184:187], v32 offset:10240
    v_mfma_f32_16x16x32_bf16 v[60:63], v[76:79], v[116:119], v[60:63]
    v_mfma_f32_16x16x32_bf16 v[60:63], v[80:83], v[112:115], v[60:63]
    ds_read2_b32 v[156:157], v24 offset0:112 offset1:113
    v_mfma_f32_16x16x32_bf16 v[60:63], v[84:87], v[108:111], v[60:63]
    ds_read2_b32 v[158:159], v24 offset0:114 offset1:115
    v_mfma_f32_16x16x32_bf16 v[60:63], v[88:91], v[104:107], v[60:63]
    ds_read_b128 v[188:191], v32 offset:12288
    v_mfma_f32_16x16x32_bf16 v[60:63], v[92:95], v[100:103], v[60:63]
    s_waitcnt lgkmcnt(14)
    v_mfma_f32_16x16x32_bf16 v[64:67], v[96:99], v[100:103], v[64:67]
    ds_read2_b32 v[160:161], v24 offset0:240 offset1:241
    v_mfma_f32_16x16x32_bf16 v[64:67], v[92:95], v[104:107], v[64:67]
    ds_read2_b32 v[162:163], v24 offset0:242 offset1:243
    v_mfma_f32_16x16x32_bf16 v[64:67], v[88:91], v[108:111], v[64:67]
    ds_read_b128 v[192:195], v32 offset:14336
    v_mfma_f32_16x16x32_bf16 v[64:67], v[84:87], v[112:115], v[64:67]
    v_mfma_f32_16x16x32_bf16 v[64:67], v[80:83], v[116:119], v[64:67]
    v_mfma_f32_16x16x32_bf16 v[64:67], v[76:79], v[120:123], v[64:67]
    v_mfma_f32_16x16x32_bf16 v[64:67], v[72:75], v[124:127], v[64:67]
    v_mfma_f32_16x16x32_bf16 v[64:67], v[68:71], v[128:131], v[64:67]
    v_mfma_f32_16x16x32_bf16 v[36:39], v[132:135], v[164:167], v[36:39]
    v_mfma_f32_16x16x32_bf16 v[40:43], v[136:139], v[164:167], v[40:43]
    v_mfma_f32_16x16x32_bf16 v[40:43], v[132:135], v[168:171], v[40:43]
    s_waitcnt lgkmcnt(14)
    v_mfma_f32_16x16x32_bf16 v[44:47], v[132:135], v[172:175], v[44:47]
    v_mfma_f32_16x16x32_bf16 v[44:47], v[136:139], v[168:171], v[44:47]
    v_mfma_f32_16x16x32_bf16 v[44:47], v[140:143], v[164:167], v[44:47]
    s_waitcnt lgkmcnt(13)
    v_mfma_f32_16x16x32_bf16 v[48:51], v[144:147], v[164:167], v[48:51]
    v_mfma_f32_16x16x32_bf16 v[48:51], v[140:143], v[168:171], v[48:51]
    s_waitcnt lgkmcnt(0)
    v_cvt_pk_bf16_f32 v68, v39, v38
    v_cvt_pk_bf16_f32 v69, v37, v36
    v_mfma_f32_16x16x32_bf16 v[48:51], v[136:139], v[172:175], v[48:51]
    ds_write_b64 v20, v[68:69] offset:0
    v_cvt_pk_bf16_f32 v70, v43, v42
    v_mfma_f32_16x16x32_bf16 v[48:51], v[132:135], v[176:179], v[48:51]
    v_cvt_pk_bf16_f32 v71, v41, v40
    ds_write_b64 v20, v[70:71] offset:2048
    v_mfma_f32_16x16x32_bf16 v[52:55], v[132:135], v[180:183], v[52:55]
    v_mfma_f32_16x16x32_bf16 v[52:55], v[136:139], v[176:179], v[52:55]
    v_cvt_pk_bf16_f32 v72, v47, v46
    v_cvt_pk_bf16_f32 v73, v45, v44
    v_mfma_f32_16x16x32_bf16 v[52:55], v[140:143], v[172:175], v[52:55]
    ds_write_b64 v20, v[72:73] offset:4096
    v_mfma_f32_16x16x32_bf16 v[52:55], v[144:147], v[168:171], v[52:55]
    v_mfma_f32_16x16x32_bf16 v[52:55], v[148:151], v[164:167], v[52:55]
    v_mfma_f32_16x16x32_bf16 v[56:59], v[152:155], v[164:167], v[56:59]
    v_cvt_pk_bf16_f32 v74, v51, v50
    v_cvt_pk_bf16_f32 v75, v49, v48
    v_mfma_f32_16x16x32_bf16 v[56:59], v[148:151], v[168:171], v[56:59]
    ds_write_b64 v20, v[74:75] offset:6144
    v_mfma_f32_16x16x32_bf16 v[56:59], v[144:147], v[172:175], v[56:59]
    v_mfma_f32_16x16x32_bf16 v[56:59], v[140:143], v[176:179], v[56:59]
    v_mfma_f32_16x16x32_bf16 v[56:59], v[136:139], v[180:183], v[56:59]
    v_mfma_f32_16x16x32_bf16 v[56:59], v[132:135], v[184:187], v[56:59]
    v_cvt_pk_bf16_f32 v76, v55, v54
    v_cvt_pk_bf16_f32 v77, v53, v52
    v_mfma_f32_16x16x32_bf16 v[60:63], v[132:135], v[188:191], v[60:63]
    ds_write_b64 v20, v[76:77] offset:8192
    v_mfma_f32_16x16x32_bf16 v[60:63], v[136:139], v[184:187], v[60:63]
    v_mfma_f32_16x16x32_bf16 v[60:63], v[140:143], v[180:183], v[60:63]
    v_mfma_f32_16x16x32_bf16 v[60:63], v[144:147], v[176:179], v[60:63]
    v_mfma_f32_16x16x32_bf16 v[60:63], v[148:151], v[172:175], v[60:63]
    v_mfma_f32_16x16x32_bf16 v[60:63], v[152:155], v[168:171], v[60:63]
    v_cvt_pk_bf16_f32 v78, v59, v58
    v_cvt_pk_bf16_f32 v79, v57, v56
    v_mfma_f32_16x16x32_bf16 v[60:63], v[156:159], v[164:167], v[60:63]
    ds_write_b64 v20, v[78:79] offset:10240
    v_mfma_f32_16x16x32_bf16 v[64:67], v[160:163], v[164:167], v[64:67]
    v_mfma_f32_16x16x32_bf16 v[64:67], v[156:159], v[168:171], v[64:67]
    v_mfma_f32_16x16x32_bf16 v[64:67], v[152:155], v[172:175], v[64:67]
    v_mfma_f32_16x16x32_bf16 v[64:67], v[148:151], v[176:179], v[64:67]
    v_mfma_f32_16x16x32_bf16 v[64:67], v[144:147], v[180:183], v[64:67]
    v_mfma_f32_16x16x32_bf16 v[64:67], v[140:143], v[184:187], v[64:67]
    s_nop 0
    v_cvt_pk_bf16_f32 v80, v63, v62
    v_cvt_pk_bf16_f32 v81, v61, v60
    v_mfma_f32_16x16x32_bf16 v[64:67], v[136:139], v[188:191], v[64:67]
    ds_write_b64 v20, v[80:81] offset:12288
    v_mfma_f32_16x16x32_bf16 v[64:67], v[132:135], v[192:195], v[64:67]
    s_nop 7
    v_cvt_pk_bf16_f32 v82, v67, v66
    v_cvt_pk_bf16_f32 v83, v65, v64
    ds_write_b64 v20, v[82:83] offset:14336
    s_mov_b64 exec, 1
    ds_add_u32 v18, v19 offset:12
    s_mov_b64 exec, -1
    s_add_u32 s80, s86, 94208
    v_add_u32 v5, s80, v15
    s_branch LA_s3_in
LA_s3:
    s_sleep 1
LA_s3_in:
    ds_read_b32 v6, v18 offset:12
    ds_read_b128 v[84:87], v5 offset:0
    ds_read_b128 v[88:91], v5 offset:4096
    ds_read_b128 v[92:95], v5 offset:8192
    ds_read_b128 v[96:99], v5 offset:12288
    s_waitcnt lgkmcnt(0)
    v_readfirstlane_b32 s78, v6
    s_nop 0
    s_cmp_ge_u32 s78, 4
    s_cbranch_scc0 LA_s3
    s_add_u32 s89, s91, 4194304
    buffer_store_dwordx4 v[84:87], v14, s[52:55], s89 offen sc1
    s_add_u32 s89, s91, 4198400
    buffer_store_dwordx4 v[88:91], v14, s[52:55], s89 offen sc1
    s_add_u32 s89, s91, 4202496
    buffer_store_dwordx4 v[92:95], v14, s[52:55], s89 offen sc1
    s_add_u32 s89, s91, 4206592
    buffer_store_dwordx4 v[96:99], v14, s[52:55], s89 offen sc1
    s_add_u32 s80, s86, 129024
    v_add_u32 v5, s80, v15
    s_waitcnt vmcnt(9)
    ds_write_b128 v5, v[228:231] offset:0
    s_waitcnt vmcnt(8)
    ds_write_b128 v5, v[232:235] offset:4096
    s_waitcnt vmcnt(7)
    ds_write_b128 v5, v[240:243] offset:8192
    s_waitcnt vmcnt(6)
    ds_write_b128 v5, v[244:247] offset:12288
    s_waitcnt vmcnt(5)
    ds_write_b128 v5, v[248:251] offset:16384
    s_waitcnt vmcnt(4)
    ds_write_b128 v5, v[196:199] offset:20480
    s_mov_b64 exec, 1
    ds_add_u32 v18, v19 offset:32
    s_mov_b64 exec, -1
    s_setprio 0
    s_mov_b32 s60, s22
    s_mov_b32 s61, s23
    s_mov_b32 s62, 0x800000
    s_mov_b32 s63, 0x20000
    s_lshr_b32 s81, s91, 4
    s_lshl_b32 s82, s3, 8
    s_add_u32 s81, s81, s82
    s_add_u32 s81, s81, 12648448
    s_lshl_b32 s80, s74, 14
    s_and_b32 s82, s75, 3
    s_lshl_b32 s82, s82, 8
    s_add_u32 s80, s80, s82
    s_add_u32 s80, s80, 12648448
    v_mov_b32 v5, 0
    v_lshlrev_b32 v7, 10, v0
    v_lshlrev_b32 v132, 16, v212
    v_and_b32 v133, 0xffff0000, v212
    v_lshlrev_b32 v134, 16, v213
    v_and_b32 v135, 0xffff0000, v213
    v_lshlrev_b32 v136, 16, v214
    v_and_b32 v137, 0xffff0000, v214
    v_lshlrev_b32 v138, 16, v215
    v_and_b32 v139, 0xffff0000, v215
    v_lshlrev_b32 v140, 16, v216
    v_and_b32 v141, 0xffff0000, v216
    v_lshlrev_b32 v142, 16, v217
    v_and_b32 v143, 0xffff0000, v217
    v_lshlrev_b32 v144, 16, v218
    v_and_b32 v145, 0xffff0000, v218
    v_lshlrev_b32 v146, 16, v219
    v_and_b32 v147, 0xffff0000, v219
    v_lshlrev_b32 v148, 16, v220
    v_and_b32 v149, 0xffff0000, v220
    v_lshlrev_b32 v150, 16, v221
    v_and_b32 v151, 0xffff0000, v221
    v_lshlrev_b32 v152, 16, v222
    v_and_b32 v153, 0xffff0000, v222
    v_lshlrev_b32 v154, 16, v223
    v_and_b32 v155, 0xffff0000, v223
    v_lshlrev_b32 v156, 16, v224
    v_and_b32 v157, 0xffff0000, v224
    v_lshlrev_b32 v158, 16, v225
    v_and_b32 v159, 0xffff0000, v225
    v_lshlrev_b32 v160, 16, v226
    v_and_b32 v161, 0xffff0000, v226
    v_lshlrev_b32 v162, 16, v227
    v_and_b32 v163, 0xffff0000, v227
    s_waitcnt vmcnt(0)
    s_mov_b64 exec, 1
    buffer_store_dword v19, v5, s[52:55], s81 offen sc1
    s_mov_b64 exec, 0xffff
    s_waitcnt vmcnt(0)
    s_branch LA_s7a_in
LA_s7a:
    s_sleep 1
LA_s7a_in:
    ds_read_b32 v6, v18 offset:28
    s_waitcnt lgkmcnt(0)
    v_readfirstlane_b32 s78, v6
    s_nop 0
    s_cmp_ge_u32 s78, 4
    s_cbranch_scc0 LA_s7a
    s_setprio 2
    s_mov_b32 s79, 0
LA_py:
    buffer_load_dword v6, v7, s[52:55], s80 offen sc1
    s_add_u32 s79, s79, 1
    s_cmp_gt_u32 s79, 200000
    s_cbranch_scc1 LA_py_x
    s_waitcnt vmcnt(0)
    v_cmp_ne_u32 vcc, 1, v6
    s_cbranch_vccz LA_py_x
    s_mov_b64 exec, vcc
    s_sleep 8
    s_branch LA_py
LA_py_x:
    s_waitcnt vmcnt(0)
    s_mov_b64 exec, -1
    s_mov_b32 s89, 4194304
    buffer_load_dwordx4 v[100:103], v12, s[52:55], s89 offen sc1
    s_mov_b32 s89, 4210688
    buffer_load_dwordx4 v[104:107], v12, s[52:55], s89 offen sc1
    s_mov_b32 s89, 4227072
    buffer_load_dwordx4 v[108:111], v12, s[52:55], s89 offen sc1
    s_mov_b32 s89, 4243456
    buffer_load_dwordx4 v[112:115], v12, s[52:55], s89 offen sc1
    s_waitcnt vmcnt(3)
    v_permlane32_swap_b32 v102, v100
    v_permlane32_swap_b32 v103, v101
    s_waitcnt vmcnt(2)
    v_permlane32_swap_b32 v106, v104
    v_permlane32_swap_b32 v107, v105
    s_waitcnt vmcnt(1)
    v_permlane32_swap_b32 v110, v108
    v_permlane32_swap_b32 v111, v109
    s_waitcnt vmcnt(0)
    v_permlane32_swap_b32 v114, v112
    v_permlane32_swap_b32 v115, v113
    v_and_b32 v68, 0xffff0000, v103
    v_and_b32 v69, 0xffff0000, v107
    v_and_b32 v70, 0xffff0000, v111
    v_and_b32 v71, 0xffff0000, v115
    v_and_b32 v72, 0xffff0000, v101
    v_and_b32 v73, 0xffff0000, v105
    v_and_b32 v74, 0xffff0000, v109
    v_and_b32 v75, 0xffff0000, v113
    v_mul_f32 v68, v68, v132
    v_mul_f32 v69, v69, v133
    v_mul_f32 v70, v70, v134
    v_mul_f32 v71, v71, v135
    v_mul_f32 v72, v72, v136
    v_mul_f32 v73, v73, v137
    v_mul_f32 v74, v74, v138
    v_mul_f32 v75, v75, v139
    v_cvt_pk_bf16_f32 v36, v68, v69
    v_cvt_pk_bf16_f32 v37, v70, v71
    v_cvt_pk_bf16_f32 v38, v72, v73
    v_cvt_pk_bf16_f32 v39, v74, v75
    s_mov_b32 s89, 0
    buffer_store_dwordx4 v[36:39], v13, s[60:63], s89 offen nt sc1
    v_lshlrev_b32 v68, 16, v103
    v_lshlrev_b32 v69, 16, v107
    v_lshlrev_b32 v70, 16, v111
    v_lshlrev_b32 v71, 16, v115
    v_lshlrev_b32 v72, 16, v101
    v_lshlrev_b32 v73, 16, v105
    v_lshlrev_b32 v74, 16, v109
    v_lshlrev_b32 v75, 16, v113
    v_mul_f32 v68, v68, v140
    v_mul_f32 v69, v69, v141
    v_mul_f32 v70, v70, v142
    v_mul_f32 v71, v71, v143
    v_mul_f32 v72, v72, v144
    v_mul_f32 v73, v73, v145
    v_mul_f32 v74, v74, v146
    v_mul_f32 v75, v75, v147
    v_cvt_pk_bf16_f32 v40, v68, v69
    v_cvt_pk_bf16_f32 v41, v70, v71
    v_cvt_pk_bf16_f32 v42, v72, v73
    v_cvt_pk_bf16_f32 v43, v74, v75
    s_mov_b32 s89, 4096
    buffer_store_dwordx4 v[40:43], v13, s[60:63], s89 offen nt sc1
    v_and_b32 v68, 0xffff0000, v102
    v_and_b32 v69, 0xffff0000, v106
    v_and_b32 v70, 0xffff0000, v110
    v_and_b32 v71, 0xffff0000, v114
    v_and_b32 v72, 0xffff0000, v100
    v_and_b32 v73, 0xffff0000, v104
    v_and_b32 v74, 0xffff0000, v108
    v_and_b32 v75, 0xffff0000, v112
    v_mul_f32 v68, v68, v148
    v_mul_f32 v69, v69, v149
    v_mul_f32 v70, v70, v150
    v_mul_f32 v71, v71, v151
    v_mul_f32 v72, v72, v152
    v_mul_f32 v73, v73, v153
    v_mul_f32 v74, v74, v154
    v_mul_f32 v75, v75, v155
    v_cvt_pk_bf16_f32 v44, v68, v69
    v_cvt_pk_bf16_f32 v45, v70, v71
    v_cvt_pk_bf16_f32 v46, v72, v73
    v_cvt_pk_bf16_f32 v47, v74, v75
    s_mov_b32 s89, 8192
    buffer_store_dwordx4 v[44:47], v13, s[60:63], s89 offen nt sc1
    v_lshlrev_b32 v68, 16, v102
    v_lshlrev_b32 v69, 16, v106
    v_lshlrev_b32 v70, 16, v110
    v_lshlrev_b32 v71, 16, v114
    v_lshlrev_b32 v72, 16, v100
    v_lshlrev_b32 v73, 16, v104
    v_lshlrev_b32 v74, 16, v108
    v_lshlrev_b32 v75, 16, v112
    v_mul_f32 v68, v68, v156
    v_mul_f32 v69, v69, v157
    v_mul_f32 v70, v70, v158
    v_mul_f32 v71, v71, v159
    v_mul_f32 v72, v72, v160
    v_mul_f32 v73, v73, v161
    v_mul_f32 v74, v74, v162
    v_mul_f32 v75, v75, v163
    v_cvt_pk_bf16_f32 v48, v68, v69
    v_cvt_pk_bf16_f32 v49, v70, v71
    v_cvt_pk_bf16_f32 v50, v72, v73
    v_cvt_pk_bf16_f32 v51, v74, v75
    s_mov_b32 s89, 12288
    buffer_store_dwordx4 v[48:51], v13, s[60:63], s89 offen nt sc1
    s_endpgm
L_B:
    s_setprio 3
    s_and_b32 s3, s3, 3
    s_add_u32 s79, s72, s73
    s_add_u32 s78, s72, 5
    s_and_b32 s78, s78, 7
    s_lshl_b32 s78, s78, 1
    s_and_b32 s75, s79, 1
    s_add_u32 s78, s78, s75
    s_andn2_b32 s79, 2, s79
    s_lshl_b32 s79, s79, 3
    s_add_u32 s78, s78, s79
    s_and_b32 s76, s78, 3
    s_and_b32 s79, s73, 12
    s_add_u32 s76, s76, s79
    s_lshr_b32 s74, s78, 4
    s_add_u32 s74, s74, s79
    s_and_b32 s79, s72, 8
    s_lshr_b32 s77, s78, 2
    s_add_u32 s77, s77, s79
    s_lshr_b32 s79, s79, 2
    s_add_u32 s74, s74, s79
    s_xor_b32 s74, s74, 4
    s_and_b32 s75, s78, 15
    s_lshr_b32 s86, s3, 1
    s_and_b32 s87, s3, 1
    v_mov_b32 v10, 162304
    v_mov_b32 v11, 1
    v_lshlrev_b32 v12, 4, v0
    v_lshl_add_u32 v13, v0, 2, v10
    v_mov_b32 v14, 0
    ds_write_b32 v13, v14
    s_lshl_b32 s78, s74, 4
    s_add_u32 s78, s78, s75
    s_lshl_b32 s96, s78, 8
    s_add_u32 s96, s96, 12582912
    s_lshl_b32 s78, s78, 2
    s_add_u32 s78, s78, s3
    s_lshl_b32 s78, s78, 8
    s_add_u32 s80, s78, 12648448
    s_lshl_b32 s81, s72, 1
    s_add_u32 s81, s81, s86
    s_lshl_b32 s97, s81, 4
    s_add_u32 s97, s97, s73
    s_lshl_b32 s97, s97, 8
    s_add_u32 s97, s97, 12910464
    v_mov_b32 v15, s80
    v_mov_b32 v223, s97
    v_cmp_gt_u32 vcc, 8, v0
    s_nop 1
    v_cndmask_b32 v15, v223, v15, vcc
    v_add_u32 v221, v15, v12
    s_lshl_b32 s78, s87, 2
    s_add_u32 s78, s78, 128
    s_add_u32 s97, s97, s78
    s_lshl_b32 s82, s73, 1
    s_add_u32 s82, s82, s87
    s_lshl_b32 s78, s81, 7
    s_add_u32 s78, s78, s82
    s_lshl_b32 s94, s78, 10
    s_add_u32 s94, s94, 16777216
    v_mov_b32 v212, 0
    v_mov_b32 v213, 0
    v_mov_b32 v214, 0
    v_mov_b32 v215, 0
    v_mov_b32 v220, 0
    s_waitcnt lgkmcnt(0)
    s_mov_b32 s52, s26
    s_mov_b32 s53, s27
    s_mov_b32 s54, 0x1800000
    s_mov_b32 s55, 0x20000
    s_mov_b32 s68, s24
    s_mov_b32 s69, s25
    s_mov_b32 s70, 0x100
    s_mov_b32 s71, 0x20000
    s_lshl_b32 s98, s74, 4
    s_or_b32 s78, s75, s3
    s_cmp_lg_u32 s78, 0
    s_cbranch_scc1 LB_notag
    s_mov_b64 exec, 0xffff
    v_lshlrev_b32 v15, 8, v0
    buffer_load_dword v251, v15, s[52:55], s96 offen sc1
LB_notag:
    s_lshl_b32 s78, s87, 3
    s_lshr_b32 exec_lo, 0xffff, s78
    s_mov_b32 exec_hi, 0
    buffer_store_dwordx4 v[212:215], v221, s[52:55], 0 offen sc1
    s_mov_b64 exec, -1
    v_and_b32 v13, 15, v0
    v_lshrrev_b32 v14, 4, v0
    v_lshrrev_b32 v15, 1, v13
    v_xor_b32 v15, v15, v14
    v_lshlrev_b32 v15, 4, v15
    v_lshl_add_u32 v15, v13, 7, v15
    v_add_u32 v2, 73728, v15
    v_xor_b32 v3, 64, v2
    s_lshl_b32 s78, s86, 13
    s_add_u32 s78, s78, 2048
    v_add_u32 v4, s78, v2
    v_add_u32 v5, s78, v3
    v_bfe_u32 v15, v0, 3, 2
    s_lshl_b32 s78, s87, 1
    s_add_u32 s78, s78, s86
    v_xor_b32 v15, s78, v15
    v_lshlrev_b32 v15, 5, v15
    v_and_b32 v223, 3, v0
    v_lshl_add_u32 v15, v223, 3, v15
    v_bfe_u32 v223, v0, 2, 2
    v_lshl_add_u32 v15, v223, 7, v15
    v_mul_u32_u24 v223, 3072, v14
    v_add_u32 v6, v223, v15
    v_xor_b32 v7, 32, v6
    s_mov_b32 s60, s22
    s_mov_b32 s61, s23
    s_mov_b32 s62, 0x800000
    s_mov_b32 s63, 0x20000
    v_and_b32 v15, 1, v13
    v_cmp_eq_u32 s[88:89], 1, v15
    v_lshl_add_u32 v15, v14, 2, v15
    v_cmp_le_u32 s[90:91], v15, v13
    v_add_u32 v15, 2, v15
    v_cmp_le_u32 s[92:93], v15, v13
    v_mov_b32 v212, 0x0c0c0c0c
    v_mov_b32 v15, 0xc0c0100
    v_mov_b32 v223, 0x1000c0c
    v_cndmask_b32 v15, v15, v223, s[88:89]
    v_cndmask_b32 v208, v15, v212, s[90:91]
    v_cndmask_b32 v210, v212, v15, s[90:91]
    v_mov_b32 v15, 0xc0c0302
    v_mov_b32 v223, 0x3020c0c
    v_cndmask_b32 v15, v15, v223, s[88:89]
    v_cndmask_b32 v209, v15, v212, s[92:93]
    v_cndmask_b32 v211, v212, v15, s[92:93]
    s_or_b32 s78, s72, s86
    s_cmp_eq_u32 s78, 0
    s_cselect_b32 s78, 0xf149f2ca, 0
    v_mov_b32 v212, s78
    v_mov_b32 v213, s78
    v_mov_b32 v214, s78
    v_mov_b32 v215, s78
    s_lshl_b32 s78, s87, 12
    s_add_u32 s78, s78, 24576
    s_lshl_b32 s79, s86, 9
    s_add_u32 s79, s79, s78
    v_lshlrev_b32 v15, 3, v0
    v_add_u32 v216, s79, v15
    s_lshl_b32 s80, s86, 11
    v_add_u32 v218, s80, v216
    v_xor_b32 v219, 512, v218
    s_add_u32 s78, s78, 2048
    s_cmp_eq_u32 s86, 0
    s_cselect_b32 s78, s78, 32768
    v_add_u32 v217, s78, v15
    v_bfe_u32 v14, v0, 3, 2
    v_lshlrev_b32 v14, 5, v14
    v_and_b32 v15, 3, v0
    v_lshl_add_u32 v14, v15, 3, v14
    v_lshrrev_b32 v15, 2, v0
    v_lshl_add_u32 v14, v15, 7, v14
    s_lshl_b32 s78, s86, 11
    v_add_u32 v244, s78, v14
    s_mov_b32 s64, s20
    s_mov_b32 s65, s21
    s_mov_b32 s66, 0x200000
    s_mov_b32 s67, 0x20000
    v_lshrrev_b32 v14, 4, v0
    v_lshlrev_b32 v14, 1, v14
    v_and_b32 v15, 7, v0
    v_xor_b32 v14, v14, v15
    v_lshlrev_b32 v14, 4, v14
    v_lshrrev_b32 v15, 3, v0
    v_lshl_add_u32 v14, v15, 11, v14
    s_lshl_b32 s78, s77, 7
    s_lshl_b32 s79, s3, 14
    s_add_u32 s78, s78, s79
    v_add_u32 v245, s78, v14
    v_and_b32 v14, 15, v0
    s_lshl_b32 s78, s76, 2
    s_add_u32 s78, s78, s3
    s_lshl_b32 s79, s78, 5
    v_add_u32 v14, s79, v14
    v_lshlrev_b32 v14, 12, v14
    v_bfe_u32 v15, v0, 4, 1
    v_lshl_add_u32 v14, v15, 5, v14
    v_lshrrev_b32 v15, 5, v0
    v_lshl_add_u32 v14, v15, 4, v14
    s_lshl_b32 s79, s77, 7
    s_add_u32 s79, s79, 2048
    v_add_u32 v246, s79, v14
    s_lshl_b32 s28, s78, 16
    s_add_u32 s28, s28, 16777216
    s_lshl_b32 s30, s76, 1
    s_add_u32 s30, s30, s86
    s_lshl_b32 s30, s30, 12
    s_add_u32 s30, s30, 12910592
    v_lshrrev_b32 v15, 1, v0
    v_lshlrev_b32 v15, 8, v15
    v_and_b32 v14, 1, v0
    v_lshl_add_u32 v247, v14, 2, v15
    s_and_b32 s78, s77, 7
    s_mov_b32 s79, 0x76543210
    s_and_b32 s78, s76, 3
    s_mul_i32 s78, s78, 0x22222222
    s_add_u32 s79, s79, s78
    s_bfe_u32 s78, s79, 0x30000
    s_lshl_b32 s44, s78, 18
    s_lshl_b32 s78, s78, 12
    s_add_u32 s36, s78, s28
    s_bfe_u32 s78, s79, 0x30004
    s_lshl_b32 s45, s78, 18
    s_lshl_b32 s78, s78, 12
    s_add_u32 s37, s78, s28
    s_bfe_u32 s78, s79, 0x30008
    s_lshl_b32 s46, s78, 18
    s_lshl_b32 s78, s78, 12
    s_add_u32 s38, s78, s28
    s_bfe_u32 s78, s79, 0x3000c
    s_lshl_b32 s47, s78, 18
    s_lshl_b32 s78, s78, 12
    s_add_u32 s39, s78, s28
    s_bfe_u32 s78, s79, 0x30010
    s_lshl_b32 s48, s78, 18
    s_lshl_b32 s78, s78, 12
    s_add_u32 s40, s78, s28
    s_bfe_u32 s78, s79, 0x30014
    s_lshl_b32 s49, s78, 18
    s_lshl_b32 s78, s78, 12
    s_add_u32 s41, s78, s28
    s_bfe_u32 s78, s79, 0x30018
    s_lshl_b32 s50, s78, 18
    s_lshl_b32 s78, s78, 12
    s_add_u32 s42, s78, s28
    s_bfe_u32 s78, s79, 0x3001c
    s_lshl_b32 s51, s78, 18
    s_lshl_b32 s78, s78, 12
    s_add_u32 s43, s78, s28
    s_lshl_b32 s34, s3, 10
    v_mov_b32 v252, v12
    v_bfe_u32 v14, v0, 4, 1
    v_lshrrev_b32 v15, 5, v0
    v_lshl_add_u32 v14, v14, 1, v15
    v_and_b32 v15, 7, v0
    v_xor_b32 v14, v14, v15
    v_lshlrev_b32 v14, 4, v14
    v_and_b32 v223, 15, v0
    v_lshl_add_u32 v14, v223, 7, v14
    s_lshl_b32 s78, s3, 12
    v_add_u32 v248, s78, v14
    v_xor_b32 v249, 64, v248
    v_add_u32 v250, s78, v12
    v_lshrrev_b32 v14, 3, v0
    v_xor_b32 v15, v15, v14
    v_lshlrev_b32 v15, 4, v15
    v_lshl_add_u32 v14, v14, 12, v15
    s_lshl_b32 s78, s76, 2
    s_add_u32 s78, s78, s3
    s_lshl_b32 s78, s78, 17
    s_lshl_b32 s79, s77, 7
    s_add_u32 s78, s78, s79
    s_add_u32 s78, s78, 2048
    v_add_u32 v246, s78, v14
    s_waitcnt lgkmcnt(0)
    s_barrier
    ds_read_b64_tr_b16 v[200:201], v6 offset:1024
    ds_read_b64_tr_b16 v[202:203], v6 offset:1536
    ds_read_b64_tr_b16 v[204:205], v6 offset:13312
    ds_read_b64_tr_b16 v[206:207], v6 offset:13824
    ds_read_b128 v[152:155], v2 offset:0
    ds_read_b128 v[156:159], v3 offset:0
    ds_read_b128 v[144:147], v4 offset:6144
    ds_read_b128 v[148:151], v5 offset:6144
    ds_read_b128 v[136:139], v4 offset:4096
    ds_read_b128 v[140:143], v5 offset:4096
    ds_read_b128 v[128:131], v4 offset:2048
    ds_read_b128 v[132:135], v5 offset:2048
    ds_read_b128 v[120:123], v4 offset:0
    ds_read_b128 v[124:127], v5 offset:0
    ds_read_b64_tr_b16 v[224:225], v7 offset:1024
    ds_read_b64_tr_b16 v[226:227], v7 offset:1536
    ds_read_b64_tr_b16 v[228:229], v7 offset:13312
    ds_read_b64_tr_b16 v[230:231], v7 offset:13824
    s_waitcnt lgkmcnt(13)
    v_mfma_f32_16x16x32_bf16 v[112:115], v[200:203], v[152:155], 0
    ds_read_b64_tr_b16 v[232:233], v6 offset:0
    s_waitcnt lgkmcnt(13)
    v_mfma_f32_16x16x32_bf16 v[112:115], v[204:207], v[156:159], v[112:115]
    ds_read_b64_tr_b16 v[234:235], v6 offset:512
    s_waitcnt lgkmcnt(12)
    v_mfma_f32_16x16x32_bf16 v[72:75], v[204:207], v[148:151], 0
    ds_read_b64_tr_b16 v[236:237], v6 offset:12288
    v_mfma_f32_16x16x32_bf16 v[72:75], v[200:203], v[144:147], v[72:75]
    ds_read_b64_tr_b16 v[238:239], v6 offset:12800
    s_waitcnt lgkmcnt(13)
    v_mfma_f32_16x16x32_bf16 v[64:67], v[200:203], v[136:139], 0
    s_waitcnt lgkmcnt(12)
    v_mfma_f32_16x16x32_bf16 v[64:67], v[204:207], v[140:143], v[64:67]
    s_waitcnt lgkmcnt(10)
    v_mfma_f32_16x16x32_bf16 v[56:59], v[204:207], v[132:135], 0
    v_mfma_f32_16x16x32_bf16 v[56:59], v[200:203], v[128:131], v[56:59]
    s_waitcnt lgkmcnt(9)
    v_mfma_f32_16x16x32_bf16 v[48:51], v[200:203], v[120:123], 0
    s_waitcnt lgkmcnt(8)
    v_mfma_f32_16x16x32_bf16 v[48:51], v[204:207], v[124:127], v[48:51]
    s_waitcnt lgkmcnt(4)
    v_mfma_f32_16x16x32_bf16 v[52:55], v[228:231], v[124:127], 0
    ds_read_b64_tr_b16 v[200:201], v7 offset:0
    v_mfma_f32_16x16x32_bf16 v[52:55], v[224:227], v[120:123], v[52:55]
    ds_read_b64_tr_b16 v[202:203], v7 offset:512
    v_mfma_f32_16x16x32_bf16 v[60:63], v[224:227], v[128:131], 0
    ds_read_b64_tr_b16 v[204:205], v7 offset:12288
    v_mfma_f32_16x16x32_bf16 v[60:63], v[228:231], v[132:135], v[60:63]
    ds_read_b64_tr_b16 v[206:207], v7 offset:12800
    v_mfma_f32_16x16x32_bf16 v[68:71], v[228:231], v[140:143], 0
    v_mfma_f32_16x16x32_bf16 v[68:71], v[224:227], v[136:139], v[68:71]
    v_mfma_f32_16x16x32_bf16 v[76:79], v[224:227], v[144:147], 0
    v_mfma_f32_16x16x32_bf16 v[76:79], v[228:231], v[148:151], v[76:79]
    s_barrier
    s_waitcnt lgkmcnt(4)
    v_mfma_f32_16x16x32_bf16 v[40:43], v[236:239], v[148:151], 0
    ds_read_b64_tr_b16 v[224:225], v6 offset:2048
    ds_read_b64_tr_b16 v[226:227], v6 offset:2560
    v_mfma_f32_16x16x32_bf16 v[40:43], v[232:235], v[144:147], v[40:43]
    ds_read_b64_tr_b16 v[228:229], v6 offset:14336
    ds_read_b64_tr_b16 v[230:231], v6 offset:14848
    v_mfma_f32_16x16x32_bf16 v[32:35], v[232:235], v[136:139], 0
    ds_read_b128 v[192:195], v2 offset:18432
    ds_read_b128 v[196:199], v3 offset:18432
    v_mfma_f32_16x16x32_bf16 v[32:35], v[236:239], v[140:143], v[32:35]
    ds_read_b128 v[184:187], v4 offset:24576
    ds_read_b128 v[188:191], v5 offset:24576
    v_mfma_f32_16x16x32_bf16 v[24:27], v[236:239], v[132:135], 0
    ds_read_b128 v[176:179], v4 offset:22528
    v_mfma_f32_16x16x32_bf16 v[24:27], v[232:235], v[128:131], v[24:27]
    v_mfma_f32_16x16x32_bf16 v[16:19], v[232:235], v[120:123], 0
    v_mfma_f32_16x16x32_bf16 v[16:19], v[236:239], v[124:127], v[16:19]
    s_waitcnt lgkmcnt(9)
    v_mfma_f32_16x16x32_bf16 v[20:23], v[204:207], v[124:127], 0
    ds_read_b64_tr_b16 v[232:233], v7 offset:2048
    ds_read_b64_tr_b16 v[234:235], v7 offset:2560
    v_mfma_f32_16x16x32_bf16 v[20:23], v[200:203], v[120:123], v[20:23]
    ds_read_b64_tr_b16 v[236:237], v7 offset:14336
    ds_read_b64_tr_b16 v[238:239], v7 offset:14848
    v_mfma_f32_16x16x32_bf16 v[28:31], v[200:203], v[128:131], 0
    ds_read_b128 v[180:183], v5 offset:22528
    ds_read_b128 v[168:171], v4 offset:20480
    v_mfma_f32_16x16x32_bf16 v[28:31], v[204:207], v[132:135], v[28:31]
    ds_read_b128 v[172:175], v5 offset:20480
    ds_read_b128 v[160:163], v4 offset:18432
    v_mfma_f32_16x16x32_bf16 v[36:39], v[204:207], v[140:143], 0
    ds_read_b128 v[164:167], v5 offset:18432
    v_mfma_f32_16x16x32_bf16 v[36:39], v[200:203], v[136:139], v[36:39]
    v_mfma_f32_16x16x32_bf16 v[44:47], v[200:203], v[144:147], 0
    v_mfma_f32_16x16x32_bf16 v[44:47], v[204:207], v[148:151], v[44:47]
    s_waitcnt lgkmcnt(14)
    v_mfma_f32_16x16x32_bf16 v[116:119], v[156:159], v[228:231], 0
    v_mfma_f32_16x16x32_bf16 v[116:119], v[152:155], v[224:227], v[116:119]
    v_mfma_f32_16x16x32_bf16 v[104:107], v[144:147], v[224:227], 0
    v_mfma_f32_16x16x32_bf16 v[104:107], v[148:151], v[228:231], v[104:107]
    v_mfma_f32_16x16x32_bf16 v[96:99], v[140:143], v[228:231], 0
    s_waitcnt vmcnt(0) lgkmcnt(0)
    s_barrier
    s_or_b32 s78, s75, s3
    s_cbranch_scc0 LB_tag
LB_tagb:
    v_mfma_f32_16x16x32_bf16 v[96:99], v[136:139], v[224:227], v[96:99]
    ds_read_b64_tr_b16 v[200:201], v6 offset:25600
    v_mfma_f32_16x16x32_bf16 v[88:91], v[128:131], v[224:227], 0
    ds_read_b64_tr_b16 v[202:203], v6 offset:26112
    v_mfma_f32_16x16x32_bf16 v[88:91], v[132:135], v[228:231], v[88:91]
    ds_read_b64_tr_b16 v[204:205], v6 offset:37888
    v_mfma_f32_16x16x32_bf16 v[80:83], v[124:127], v[228:231], 0
    ds_read_b64_tr_b16 v[206:207], v6 offset:38400
    v_mfma_f32_16x16x32_bf16 v[80:83], v[120:123], v[224:227], v[80:83]
    v_mfma_f32_16x16x32_bf16 v[84:87], v[120:123], v[232:235], 0
    ds_read_b64_tr_b16 v[224:225], v7 offset:25600
    v_mfma_f32_16x16x32_bf16 v[84:87], v[124:127], v[236:239], v[84:87]
    ds_read_b64_tr_b16 v[226:227], v7 offset:26112
    v_mfma_f32_16x16x32_bf16 v[92:95], v[132:135], v[236:239], 0
    ds_read_b64_tr_b16 v[228:229], v7 offset:37888
    v_mfma_f32_16x16x32_bf16 v[92:95], v[128:131], v[232:235], v[92:95]
    ds_read_b64_tr_b16 v[230:231], v7 offset:38400
    v_mfma_f32_16x16x32_bf16 v[100:103], v[136:139], v[232:235], 0
    v_mfma_f32_16x16x32_bf16 v[100:103], v[140:143], v[236:239], v[100:103]
    v_mfma_f32_16x16x32_bf16 v[108:111], v[148:151], v[236:239], 0
    v_mfma_f32_16x16x32_bf16 v[108:111], v[144:147], v[232:235], v[108:111]
    s_waitcnt lgkmcnt(4)
    v_mfma_f32_16x16x32_bf16 v[112:115], v[200:203], v[192:195], v[112:115]
    ds_read_b64_tr_b16 v[232:233], v6 offset:24576
    v_mfma_f32_16x16x32_bf16 v[112:115], v[204:207], v[196:199], v[112:115]
    ds_read_b64_tr_b16 v[234:235], v6 offset:25088
    v_mfma_f32_16x16x32_bf16 v[72:75], v[204:207], v[188:191], v[72:75]
    ds_read_b64_tr_b16 v[236:237], v6 offset:36864
    v_mfma_f32_16x16x32_bf16 v[72:75], v[200:203], v[184:187], v[72:75]
    ds_read_b64_tr_b16 v[238:239], v6 offset:37376
    v_mfma_f32_16x16x32_bf16 v[64:67], v[200:203], v[176:179], v[64:67]
    ds_read_b128 v[152:155], v2 offset:36864
    v_mfma_f32_16x16x32_bf16 v[64:67], v[204:207], v[180:183], v[64:67]
    ds_read_b128 v[156:159], v3 offset:36864
    v_mfma_f32_16x16x32_bf16 v[56:59], v[204:207], v[172:175], v[56:59]
    ds_read_b128 v[144:147], v4 offset:43008
    v_mfma_f32_16x16x32_bf16 v[56:59], v[200:203], v[168:171], v[56:59]
    ds_read_b128 v[148:151], v5 offset:43008
    v_mfma_f32_16x16x32_bf16 v[48:51], v[200:203], v[160:163], v[48:51]
    v_mfma_f32_16x16x32_bf16 v[48:51], v[204:207], v[164:167], v[48:51]
    s_waitcnt lgkmcnt(8)
    v_mfma_f32_16x16x32_bf16 v[52:55], v[228:231], v[164:167], v[52:55]
    ds_read_b64_tr_b16 v[200:201], v7 offset:24576
    v_mfma_f32_16x16x32_bf16 v[52:55], v[224:227], v[160:163], v[52:55]
    ds_read_b64_tr_b16 v[202:203], v7 offset:25088
    v_mfma_f32_16x16x32_bf16 v[60:63], v[224:227], v[168:171], v[60:63]
    ds_read_b64_tr_b16 v[204:205], v7 offset:36864
    v_mfma_f32_16x16x32_bf16 v[60:63], v[228:231], v[172:175], v[60:63]
    ds_read_b64_tr_b16 v[206:207], v7 offset:37376
    v_mfma_f32_16x16x32_bf16 v[68:71], v[228:231], v[180:183], v[68:71]
    ds_read_b128 v[136:139], v4 offset:40960
    v_mfma_f32_16x16x32_bf16 v[68:71], v[224:227], v[176:179], v[68:71]
    ds_read_b128 v[140:143], v5 offset:40960
    v_mfma_f32_16x16x32_bf16 v[76:79], v[224:227], v[184:187], v[76:79]
    ds_read_b128 v[128:131], v4 offset:38912
    v_mfma_f32_16x16x32_bf16 v[76:79], v[228:231], v[188:191], v[76:79]
    s_waitcnt lgkmcnt(11)
    v_mfma_f32_16x16x32_bf16 v[40:43], v[236:239], v[188:191], v[40:43]
    ds_read_b64_tr_b16 v[224:225], v6 offset:26624
    v_mfma_f32_16x16x32_bf16 v[40:43], v[232:235], v[184:187], v[40:43]
    ds_read_b64_tr_b16 v[226:227], v6 offset:27136
    v_mfma_f32_16x16x32_bf16 v[32:35], v[232:235], v[176:179], v[32:35]
    ds_read_b64_tr_b16 v[228:229], v6 offset:38912
    v_mfma_f32_16x16x32_bf16 v[32:35], v[236:239], v[180:183], v[32:35]
    ds_read_b64_tr_b16 v[230:231], v6 offset:39424
    v_mfma_f32_16x16x32_bf16 v[24:27], v[236:239], v[172:175], v[24:27]
    ds_read_b128 v[132:135], v5 offset:38912
    v_mfma_f32_16x16x32_bf16 v[24:27], v[232:235], v[168:171], v[24:27]
    ds_read_b128 v[120:123], v4 offset:36864
    v_mfma_f32_16x16x32_bf16 v[16:19], v[232:235], v[160:163], v[16:19]
    ds_read_b128 v[124:127], v5 offset:36864
    v_mfma_f32_16x16x32_bf16 v[16:19], v[236:239], v[164:167], v[16:19]
    s_waitcnt lgkmcnt(10)
    v_mfma_f32_16x16x32_bf16 v[20:23], v[204:207], v[164:167], v[20:23]
    ds_read_b64_tr_b16 v[232:233], v7 offset:26624
    v_mfma_f32_16x16x32_bf16 v[20:23], v[200:203], v[160:163], v[20:23]
    ds_read_b64_tr_b16 v[234:235], v7 offset:27136
    v_mfma_f32_16x16x32_bf16 v[28:31], v[200:203], v[168:171], v[28:31]
    ds_read_b64_tr_b16 v[236:237], v7 offset:38912
    v_mfma_f32_16x16x32_bf16 v[28:31], v[204:207], v[172:175], v[28:31]
    ds_read_b64_tr_b16 v[238:239], v7 offset:39424
    v_mfma_f32_16x16x32_bf16 v[36:39], v[204:207], v[180:183], v[36:39]
    v_mfma_f32_16x16x32_bf16 v[36:39], v[200:203], v[176:179], v[36:39]
    v_mfma_f32_16x16x32_bf16 v[44:47], v[200:203], v[184:187], v[44:47]
    v_mfma_f32_16x16x32_bf16 v[44:47], v[204:207], v[188:191], v[44:47]
    s_waitcnt lgkmcnt(7)
    v_mfma_f32_16x16x32_bf16 v[116:119], v[196:199], v[228:231], v[116:119]
    v_mfma_f32_16x16x32_bf16 v[116:119], v[192:195], v[224:227], v[116:119]
    v_mfma_f32_16x16x32_bf16 v[104:107], v[184:187], v[224:227], v[104:107]
    v_mfma_f32_16x16x32_bf16 v[104:107], v[188:191], v[228:231], v[104:107]
    v_mfma_f32_16x16x32_bf16 v[96:99], v[180:183], v[228:231], v[96:99]
    s_waitcnt lgkmcnt(0)
    s_barrier
    v_mfma_f32_16x16x32_bf16 v[96:99], v[176:179], v[224:227], v[96:99]
    ds_read_b64_tr_b16 v[200:201], v6 offset:50176
    v_mfma_f32_16x16x32_bf16 v[88:91], v[168:171], v[224:227], v[88:91]
    ds_read_b64_tr_b16 v[202:203], v6 offset:50688
    v_mfma_f32_16x16x32_bf16 v[88:91], v[172:175], v[228:231], v[88:91]
    ds_read_b64_tr_b16 v[204:205], v6 offset:62464
    v_mfma_f32_16x16x32_bf16 v[80:83], v[164:167], v[228:231], v[80:83]
    ds_read_b64_tr_b16 v[206:207], v6 offset:62976
    v_mfma_f32_16x16x32_bf16 v[80:83], v[160:163], v[224:227], v[80:83]
    v_mfma_f32_16x16x32_bf16 v[84:87], v[160:163], v[232:235], v[84:87]
    ds_read_b64_tr_b16 v[224:225], v7 offset:50176
    v_mfma_f32_16x16x32_bf16 v[84:87], v[164:167], v[236:239], v[84:87]
    ds_read_b64_tr_b16 v[226:227], v7 offset:50688
    v_mfma_f32_16x16x32_bf16 v[92:95], v[172:175], v[236:239], v[92:95]
    ds_read_b64_tr_b16 v[228:229], v7 offset:62464
    v_mfma_f32_16x16x32_bf16 v[92:95], v[168:171], v[232:235], v[92:95]
    ds_read_b64_tr_b16 v[230:231], v7 offset:62976
    v_mfma_f32_16x16x32_bf16 v[100:103], v[176:179], v[232:235], v[100:103]
    v_mfma_f32_16x16x32_bf16 v[100:103], v[180:183], v[236:239], v[100:103]
    v_mfma_f32_16x16x32_bf16 v[108:111], v[188:191], v[236:239], v[108:111]
    v_mfma_f32_16x16x32_bf16 v[108:111], v[184:187], v[232:235], v[108:111]
    s_waitcnt lgkmcnt(4)
    v_mfma_f32_16x16x32_bf16 v[112:115], v[200:203], v[152:155], v[112:115]
    ds_read_b64_tr_b16 v[232:233], v6 offset:49152
    v_mfma_f32_16x16x32_bf16 v[112:115], v[204:207], v[156:159], v[112:115]
    ds_read_b64_tr_b16 v[234:235], v6 offset:49664
    v_mfma_f32_16x16x32_bf16 v[72:75], v[204:207], v[148:151], v[72:75]
    ds_read_b64_tr_b16 v[236:237], v6 offset:61440
    v_mfma_f32_16x16x32_bf16 v[72:75], v[200:203], v[144:147], v[72:75]
    ds_read_b64_tr_b16 v[238:239], v6 offset:61952
    v_mfma_f32_16x16x32_bf16 v[64:67], v[200:203], v[136:139], v[64:67]
    ds_read_b128 v[192:195], v2 offset:0
    v_mfma_f32_16x16x32_bf16 v[64:67], v[204:207], v[140:143], v[64:67]
    ds_read_b128 v[196:199], v3 offset:0
    v_mfma_f32_16x16x32_bf16 v[56:59], v[204:207], v[132:135], v[56:59]
    ds_read_b128 v[184:187], v4 offset:6144
    v_mfma_f32_16x16x32_bf16 v[56:59], v[200:203], v[128:131], v[56:59]
    ds_read_b128 v[188:191], v5 offset:6144
    v_mfma_f32_16x16x32_bf16 v[48:51], v[200:203], v[120:123], v[48:51]
    v_mfma_f32_16x16x32_bf16 v[48:51], v[204:207], v[124:127], v[48:51]
    s_waitcnt lgkmcnt(8)
    v_mfma_f32_16x16x32_bf16 v[52:55], v[228:231], v[124:127], v[52:55]
    ds_read_b64_tr_b16 v[200:201], v7 offset:49152
    v_mfma_f32_16x16x32_bf16 v[52:55], v[224:227], v[120:123], v[52:55]
    ds_read_b64_tr_b16 v[202:203], v7 offset:49664
    v_mfma_f32_16x16x32_bf16 v[60:63], v[224:227], v[128:131], v[60:63]
    ds_read_b64_tr_b16 v[204:205], v7 offset:61440
    v_mfma_f32_16x16x32_bf16 v[60:63], v[228:231], v[132:135], v[60:63]
    ds_read_b64_tr_b16 v[206:207], v7 offset:61952
    v_mfma_f32_16x16x32_bf16 v[68:71], v[228:231], v[140:143], v[68:71]
    ds_read_b128 v[176:179], v4 offset:4096
    v_mfma_f32_16x16x32_bf16 v[68:71], v[224:227], v[136:139], v[68:71]
    ds_read_b128 v[180:183], v5 offset:4096
    v_mfma_f32_16x16x32_bf16 v[76:79], v[224:227], v[144:147], v[76:79]
    ds_read_b128 v[168:171], v4 offset:2048
    v_mfma_f32_16x16x32_bf16 v[76:79], v[228:231], v[148:151], v[76:79]
    s_waitcnt lgkmcnt(11)
    v_mfma_f32_16x16x32_bf16 v[40:43], v[236:239], v[148:151], v[40:43]
    ds_read_b64_tr_b16 v[224:225], v6 offset:51200
    v_mfma_f32_16x16x32_bf16 v[40:43], v[232:235], v[144:147], v[40:43]
    ds_read_b64_tr_b16 v[226:227], v6 offset:51712
    v_mfma_f32_16x16x32_bf16 v[32:35], v[232:235], v[136:139], v[32:35]
    ds_read_b64_tr_b16 v[228:229], v6 offset:63488
    v_mfma_f32_16x16x32_bf16 v[32:35], v[236:239], v[140:143], v[32:35]
    ds_read_b64_tr_b16 v[230:231], v6 offset:64000
    v_mfma_f32_16x16x32_bf16 v[24:27], v[236:239], v[132:135], v[24:27]
    ds_read_b128 v[172:175], v5 offset:2048
    v_mfma_f32_16x16x32_bf16 v[24:27], v[232:235], v[128:131], v[24:27]
    ds_read_b128 v[160:163], v4 offset:0
    v_mfma_f32_16x16x32_bf16 v[16:19], v[232:235], v[120:123], v[16:19]
    ds_read_b128 v[164:167], v5 offset:0
    v_mfma_f32_16x16x32_bf16 v[16:19], v[236:239], v[124:127], v[16:19]
    s_waitcnt lgkmcnt(10)
    v_mfma_f32_16x16x32_bf16 v[20:23], v[204:207], v[124:127], v[20:23]
    ds_read_b64_tr_b16 v[232:233], v7 offset:51200
    v_mfma_f32_16x16x32_bf16 v[20:23], v[200:203], v[120:123], v[20:23]
    ds_read_b64_tr_b16 v[234:235], v7 offset:51712
    v_mfma_f32_16x16x32_bf16 v[28:31], v[200:203], v[128:131], v[28:31]
    ds_read_b64_tr_b16 v[236:237], v7 offset:63488
    v_mfma_f32_16x16x32_bf16 v[28:31], v[204:207], v[132:135], v[28:31]
    ds_read_b64_tr_b16 v[238:239], v7 offset:64000
    v_mfma_f32_16x16x32_bf16 v[36:39], v[204:207], v[140:143], v[36:39]
    v_mfma_f32_16x16x32_bf16 v[36:39], v[200:203], v[136:139], v[36:39]
    v_mfma_f32_16x16x32_bf16 v[44:47], v[200:203], v[144:147], v[44:47]
    v_mfma_f32_16x16x32_bf16 v[44:47], v[204:207], v[148:151], v[44:47]
    s_waitcnt lgkmcnt(7)
    v_mfma_f32_16x16x32_bf16 v[116:119], v[156:159], v[228:231], v[116:119]
    v_mfma_f32_16x16x32_bf16 v[116:119], v[152:155], v[224:227], v[116:119]
    v_mfma_f32_16x16x32_bf16 v[104:107], v[144:147], v[224:227], v[104:107]
    v_mfma_f32_16x16x32_bf16 v[104:107], v[148:151], v[228:231], v[104:107]
    v_mfma_f32_16x16x32_bf16 v[96:99], v[140:143], v[228:231], v[96:99]
    s_waitcnt lgkmcnt(0)
    s_barrier
    v_mfma_f32_16x16x32_bf16 v[96:99], v[136:139], v[224:227], v[96:99]
    ds_read_b64_tr_b16 v[200:201], v6 offset:1024
    v_mfma_f32_16x16x32_bf16 v[88:91], v[128:131], v[224:227], v[88:91]
    ds_read_b64_tr_b16 v[202:203], v6 offset:1536
    v_mfma_f32_16x16x32_bf16 v[88:91], v[132:135], v[228:231], v[88:91]
    ds_read_b64_tr_b16 v[204:205], v6 offset:13312
    v_mfma_f32_16x16x32_bf16 v[80:83], v[124:127], v[228:231], v[80:83]
    ds_read_b64_tr_b16 v[206:207], v6 offset:13824
    v_mfma_f32_16x16x32_bf16 v[80:83], v[120:123], v[224:227], v[80:83]
    v_mfma_f32_16x16x32_bf16 v[84:87], v[120:123], v[232:235], v[84:87]
    ds_read_b64_tr_b16 v[224:225], v7 offset:1024
    v_mfma_f32_16x16x32_bf16 v[84:87], v[124:127], v[236:239], v[84:87]
    ds_read_b64_tr_b16 v[226:227], v7 offset:1536
    v_mfma_f32_16x16x32_bf16 v[92:95], v[132:135], v[236:239], v[92:95]
    ds_read_b64_tr_b16 v[228:229], v7 offset:13312
    v_mfma_f32_16x16x32_bf16 v[92:95], v[128:131], v[232:235], v[92:95]
    ds_read_b64_tr_b16 v[230:231], v7 offset:13824
    v_mfma_f32_16x16x32_bf16 v[100:103], v[136:139], v[232:235], v[100:103]
    v_mfma_f32_16x16x32_bf16 v[100:103], v[140:143], v[236:239], v[100:103]
    v_mfma_f32_16x16x32_bf16 v[108:111], v[148:151], v[236:239], v[108:111]
    v_mfma_f32_16x16x32_bf16 v[108:111], v[144:147], v[232:235], v[108:111]
    s_waitcnt lgkmcnt(4)
    v_mfma_f32_16x16x32_bf16 v[112:115], v[200:203], v[192:195], v[112:115]
    ds_read_b64_tr_b16 v[232:233], v6 offset:0
    v_mfma_f32_16x16x32_bf16 v[112:115], v[204:207], v[196:199], v[112:115]
    ds_read_b64_tr_b16 v[234:235], v6 offset:512
    v_mfma_f32_16x16x32_bf16 v[72:75], v[204:207], v[188:191], v[72:75]
    ds_read_b64_tr_b16 v[236:237], v6 offset:12288
    v_mfma_f32_16x16x32_bf16 v[72:75], v[200:203], v[184:187], v[72:75]
    ds_read_b64_tr_b16 v[238:239], v6 offset:12800
    v_mfma_f32_16x16x32_bf16 v[64:67], v[200:203], v[176:179], v[64:67]
    ds_read_b128 v[152:155], v2 offset:18432
    v_mfma_f32_16x16x32_bf16 v[64:67], v[204:207], v[180:183], v[64:67]
    ds_read_b128 v[156:159], v3 offset:18432
    v_mfma_f32_16x16x32_bf16 v[56:59], v[204:207], v[172:175], v[56:59]
    ds_read_b128 v[144:147], v4 offset:24576
    v_mfma_f32_16x16x32_bf16 v[56:59], v[200:203], v[168:171], v[56:59]
    ds_read_b128 v[148:151], v5 offset:24576
    v_mfma_f32_16x16x32_bf16 v[48:51], v[200:203], v[160:163], v[48:51]
    v_mfma_f32_16x16x32_bf16 v[48:51], v[204:207], v[164:167], v[48:51]
    s_waitcnt lgkmcnt(8)
    v_mfma_f32_16x16x32_bf16 v[52:55], v[228:231], v[164:167], v[52:55]
    ds_read_b64_tr_b16 v[200:201], v7 offset:0
    v_mfma_f32_16x16x32_bf16 v[52:55], v[224:227], v[160:163], v[52:55]
    ds_read_b64_tr_b16 v[202:203], v7 offset:512
    v_mfma_f32_16x16x32_bf16 v[60:63], v[224:227], v[168:171], v[60:63]
    ds_read_b64_tr_b16 v[204:205], v7 offset:12288
    v_mfma_f32_16x16x32_bf16 v[60:63], v[228:231], v[172:175], v[60:63]
    ds_read_b64_tr_b16 v[206:207], v7 offset:12800
    v_mfma_f32_16x16x32_bf16 v[68:71], v[228:231], v[180:183], v[68:71]
    ds_read_b128 v[136:139], v4 offset:22528
    v_mfma_f32_16x16x32_bf16 v[68:71], v[224:227], v[176:179], v[68:71]
    ds_read_b128 v[140:143], v5 offset:22528
    v_mfma_f32_16x16x32_bf16 v[76:79], v[224:227], v[184:187], v[76:79]
    ds_read_b128 v[128:131], v4 offset:20480
    v_mfma_f32_16x16x32_bf16 v[76:79], v[228:231], v[188:191], v[76:79]
    s_waitcnt lgkmcnt(11)
    v_mfma_f32_16x16x32_bf16 v[40:43], v[236:239], v[188:191], v[40:43]
    ds_read_b64_tr_b16 v[224:225], v6 offset:2048
    v_mfma_f32_16x16x32_bf16 v[40:43], v[232:235], v[184:187], v[40:43]
    ds_read_b64_tr_b16 v[226:227], v6 offset:2560
    v_mfma_f32_16x16x32_bf16 v[32:35], v[232:235], v[176:179], v[32:35]
    ds_read_b64_tr_b16 v[228:229], v6 offset:14336
    v_mfma_f32_16x16x32_bf16 v[32:35], v[236:239], v[180:183], v[32:35]
    ds_read_b64_tr_b16 v[230:231], v6 offset:14848
    v_mfma_f32_16x16x32_bf16 v[24:27], v[236:239], v[172:175], v[24:27]
    ds_read_b128 v[132:135], v5 offset:20480
    v_mfma_f32_16x16x32_bf16 v[24:27], v[232:235], v[168:171], v[24:27]
    ds_read_b128 v[120:123], v4 offset:18432
    v_mfma_f32_16x16x32_bf16 v[16:19], v[232:235], v[160:163], v[16:19]
    ds_read_b128 v[124:127], v5 offset:18432
    v_mfma_f32_16x16x32_bf16 v[16:19], v[236:239], v[164:167], v[16:19]
    s_waitcnt lgkmcnt(10)
    v_mfma_f32_16x16x32_bf16 v[20:23], v[204:207], v[164:167], v[20:23]
    ds_read_b64_tr_b16 v[232:233], v7 offset:2048
    v_mfma_f32_16x16x32_bf16 v[20:23], v[200:203], v[160:163], v[20:23]
    ds_read_b64_tr_b16 v[234:235], v7 offset:2560
    v_mfma_f32_16x16x32_bf16 v[28:31], v[200:203], v[168:171], v[28:31]
    ds_read_b64_tr_b16 v[236:237], v7 offset:14336
    v_mfma_f32_16x16x32_bf16 v[28:31], v[204:207], v[172:175], v[28:31]
    ds_read_b64_tr_b16 v[238:239], v7 offset:14848
    v_mfma_f32_16x16x32_bf16 v[36:39], v[204:207], v[180:183], v[36:39]
    v_mfma_f32_16x16x32_bf16 v[36:39], v[200:203], v[176:179], v[36:39]
    v_mfma_f32_16x16x32_bf16 v[44:47], v[200:203], v[184:187], v[44:47]
    v_mfma_f32_16x16x32_bf16 v[44:47], v[204:207], v[188:191], v[44:47]
    s_waitcnt lgkmcnt(7)
    v_mfma_f32_16x16x32_bf16 v[116:119], v[196:199], v[228:231], v[116:119]
    v_mfma_f32_16x16x32_bf16 v[116:119], v[192:195], v[224:227], v[116:119]
    v_mfma_f32_16x16x32_bf16 v[104:107], v[184:187], v[224:227], v[104:107]
    v_mfma_f32_16x16x32_bf16 v[104:107], v[188:191], v[228:231], v[104:107]
    v_mfma_f32_16x16x32_bf16 v[96:99], v[180:183], v[228:231], v[96:99]
    s_waitcnt lgkmcnt(0)
    s_barrier
    v_mfma_f32_16x16x32_bf16 v[96:99], v[176:179], v[224:227], v[96:99]
    ds_read_b64_tr_b16 v[200:201], v6 offset:25600
    v_mfma_f32_16x16x32_bf16 v[88:91], v[168:171], v[224:227], v[88:91]
    ds_read_b64_tr_b16 v[202:203], v6 offset:26112
    v_mfma_f32_16x16x32_bf16 v[88:91], v[172:175], v[228:231], v[88:91]
    ds_read_b64_tr_b16 v[204:205], v6 offset:37888
    v_mfma_f32_16x16x32_bf16 v[80:83], v[164:167], v[228:231], v[80:83]
    ds_read_b64_tr_b16 v[206:207], v6 offset:38400
    v_mfma_f32_16x16x32_bf16 v[80:83], v[160:163], v[224:227], v[80:83]
    v_mfma_f32_16x16x32_bf16 v[84:87], v[160:163], v[232:235], v[84:87]
    ds_read_b64_tr_b16 v[224:225], v7 offset:25600
    v_mfma_f32_16x16x32_bf16 v[84:87], v[164:167], v[236:239], v[84:87]
    ds_read_b64_tr_b16 v[226:227], v7 offset:26112
    v_mfma_f32_16x16x32_bf16 v[92:95], v[172:175], v[236:239], v[92:95]
    ds_read_b64_tr_b16 v[228:229], v7 offset:37888
    v_mfma_f32_16x16x32_bf16 v[92:95], v[168:171], v[232:235], v[92:95]
    ds_read_b64_tr_b16 v[230:231], v7 offset:38400
    v_mfma_f32_16x16x32_bf16 v[100:103], v[176:179], v[232:235], v[100:103]
    v_mfma_f32_16x16x32_bf16 v[100:103], v[180:183], v[236:239], v[100:103]
    v_mfma_f32_16x16x32_bf16 v[108:111], v[188:191], v[236:239], v[108:111]
    v_mfma_f32_16x16x32_bf16 v[108:111], v[184:187], v[232:235], v[108:111]
    s_waitcnt lgkmcnt(4)
    v_mfma_f32_16x16x32_bf16 v[112:115], v[200:203], v[152:155], v[112:115]
    ds_read_b64_tr_b16 v[232:233], v6 offset:24576
    v_mfma_f32_16x16x32_bf16 v[112:115], v[204:207], v[156:159], v[112:115]
    ds_read_b64_tr_b16 v[234:235], v6 offset:25088
    v_mfma_f32_16x16x32_bf16 v[72:75], v[204:207], v[148:151], v[72:75]
    ds_read_b64_tr_b16 v[236:237], v6 offset:36864
    v_mfma_f32_16x16x32_bf16 v[72:75], v[200:203], v[144:147], v[72:75]
    ds_read_b64_tr_b16 v[238:239], v6 offset:37376
    v_mfma_f32_16x16x32_bf16 v[64:67], v[200:203], v[136:139], v[64:67]
    ds_read_b128 v[192:195], v2 offset:36864
    v_mfma_f32_16x16x32_bf16 v[64:67], v[204:207], v[140:143], v[64:67]
    ds_read_b128 v[196:199], v3 offset:36864
    v_mfma_f32_16x16x32_bf16 v[56:59], v[204:207], v[132:135], v[56:59]
    ds_read_b128 v[184:187], v4 offset:43008
    v_mfma_f32_16x16x32_bf16 v[56:59], v[200:203], v[128:131], v[56:59]
    ds_read_b128 v[188:191], v5 offset:43008
    v_mfma_f32_16x16x32_bf16 v[48:51], v[200:203], v[120:123], v[48:51]
    v_mfma_f32_16x16x32_bf16 v[48:51], v[204:207], v[124:127], v[48:51]
    s_waitcnt lgkmcnt(8)
    v_mfma_f32_16x16x32_bf16 v[52:55], v[228:231], v[124:127], v[52:55]
    ds_read_b64_tr_b16 v[200:201], v7 offset:24576
    v_mfma_f32_16x16x32_bf16 v[52:55], v[224:227], v[120:123], v[52:55]
    ds_read_b64_tr_b16 v[202:203], v7 offset:25088
    v_mfma_f32_16x16x32_bf16 v[60:63], v[224:227], v[128:131], v[60:63]
    ds_read_b64_tr_b16 v[204:205], v7 offset:36864
    v_mfma_f32_16x16x32_bf16 v[60:63], v[228:231], v[132:135], v[60:63]
    ds_read_b64_tr_b16 v[206:207], v7 offset:37376
    v_mfma_f32_16x16x32_bf16 v[68:71], v[228:231], v[140:143], v[68:71]
    ds_read_b128 v[176:179], v4 offset:40960
    v_mfma_f32_16x16x32_bf16 v[68:71], v[224:227], v[136:139], v[68:71]
    ds_read_b128 v[180:183], v5 offset:40960
    v_mfma_f32_16x16x32_bf16 v[76:79], v[224:227], v[144:147], v[76:79]
    ds_read_b128 v[168:171], v4 offset:38912
    v_mfma_f32_16x16x32_bf16 v[76:79], v[228:231], v[148:151], v[76:79]
    s_waitcnt lgkmcnt(11)
    v_mfma_f32_16x16x32_bf16 v[40:43], v[236:239], v[148:151], v[40:43]
    ds_read_b64_tr_b16 v[224:225], v6 offset:26624
    v_mfma_f32_16x16x32_bf16 v[40:43], v[232:235], v[144:147], v[40:43]
    ds_read_b64_tr_b16 v[226:227], v6 offset:27136
    v_mfma_f32_16x16x32_bf16 v[32:35], v[232:235], v[136:139], v[32:35]
    ds_read_b64_tr_b16 v[228:229], v6 offset:38912
    v_mfma_f32_16x16x32_bf16 v[32:35], v[236:239], v[140:143], v[32:35]
    ds_read_b64_tr_b16 v[230:231], v6 offset:39424
    v_mfma_f32_16x16x32_bf16 v[24:27], v[236:239], v[132:135], v[24:27]
    ds_read_b128 v[172:175], v5 offset:38912
    v_mfma_f32_16x16x32_bf16 v[24:27], v[232:235], v[128:131], v[24:27]
    ds_read_b128 v[160:163], v4 offset:36864
    v_mfma_f32_16x16x32_bf16 v[16:19], v[232:235], v[120:123], v[16:19]
    ds_read_b128 v[164:167], v5 offset:36864
    v_mfma_f32_16x16x32_bf16 v[16:19], v[236:239], v[124:127], v[16:19]
    s_waitcnt lgkmcnt(10)
    v_mfma_f32_16x16x32_bf16 v[20:23], v[204:207], v[124:127], v[20:23]
    ds_read_b64_tr_b16 v[232:233], v7 offset:26624
    v_mfma_f32_16x16x32_bf16 v[20:23], v[200:203], v[120:123], v[20:23]
    ds_read_b64_tr_b16 v[234:235], v7 offset:27136
    v_mfma_f32_16x16x32_bf16 v[28:31], v[200:203], v[128:131], v[28:31]
    ds_read_b64_tr_b16 v[236:237], v7 offset:38912
    v_mfma_f32_16x16x32_bf16 v[28:31], v[204:207], v[132:135], v[28:31]
    ds_read_b64_tr_b16 v[238:239], v7 offset:39424
    v_mfma_f32_16x16x32_bf16 v[36:39], v[204:207], v[140:143], v[36:39]
    v_mfma_f32_16x16x32_bf16 v[36:39], v[200:203], v[136:139], v[36:39]
    v_mfma_f32_16x16x32_bf16 v[44:47], v[200:203], v[144:147], v[44:47]
    v_mfma_f32_16x16x32_bf16 v[44:47], v[204:207], v[148:151], v[44:47]
    s_waitcnt lgkmcnt(7)
    v_mfma_f32_16x16x32_bf16 v[116:119], v[156:159], v[228:231], v[116:119]
    v_mfma_f32_16x16x32_bf16 v[116:119], v[152:155], v[224:227], v[116:119]
    v_mfma_f32_16x16x32_bf16 v[104:107], v[144:147], v[224:227], v[104:107]
    v_mfma_f32_16x16x32_bf16 v[104:107], v[148:151], v[228:231], v[104:107]
    v_mfma_f32_16x16x32_bf16 v[96:99], v[140:143], v[228:231], v[96:99]
    s_waitcnt lgkmcnt(0)
    s_barrier
    v_mfma_f32_16x16x32_bf16 v[96:99], v[136:139], v[224:227], v[96:99]
    ds_read_b64_tr_b16 v[200:201], v6 offset:50176
    v_mfma_f32_16x16x32_bf16 v[88:91], v[128:131], v[224:227], v[88:91]
    ds_read_b64_tr_b16 v[202:203], v6 offset:50688
    v_mfma_f32_16x16x32_bf16 v[88:91], v[132:135], v[228:231], v[88:91]
    ds_read_b64_tr_b16 v[204:205], v6 offset:62464
    v_mfma_f32_16x16x32_bf16 v[80:83], v[124:127], v[228:231], v[80:83]
    ds_read_b64_tr_b16 v[206:207], v6 offset:62976
    v_mfma_f32_16x16x32_bf16 v[80:83], v[120:123], v[224:227], v[80:83]
    v_mfma_f32_16x16x32_bf16 v[84:87], v[120:123], v[232:235], v[84:87]
    ds_read_b64_tr_b16 v[224:225], v7 offset:50176
    v_mfma_f32_16x16x32_bf16 v[84:87], v[124:127], v[236:239], v[84:87]
    ds_read_b64_tr_b16 v[226:227], v7 offset:50688
    v_mfma_f32_16x16x32_bf16 v[92:95], v[132:135], v[236:239], v[92:95]
    ds_read_b64_tr_b16 v[228:229], v7 offset:62464
    v_mfma_f32_16x16x32_bf16 v[92:95], v[128:131], v[232:235], v[92:95]
    ds_read_b64_tr_b16 v[230:231], v7 offset:62976
    v_mfma_f32_16x16x32_bf16 v[100:103], v[136:139], v[232:235], v[100:103]
    v_mfma_f32_16x16x32_bf16 v[100:103], v[140:143], v[236:239], v[100:103]
    v_mfma_f32_16x16x32_bf16 v[108:111], v[148:151], v[236:239], v[108:111]
    v_mfma_f32_16x16x32_bf16 v[108:111], v[144:147], v[232:235], v[108:111]
    s_waitcnt lgkmcnt(4)
    v_mfma_f32_16x16x32_bf16 v[112:115], v[200:203], v[192:195], v[112:115]
    ds_read_b64_tr_b16 v[232:233], v6 offset:49152
    v_mfma_f32_16x16x32_bf16 v[112:115], v[204:207], v[196:199], v[112:115]
    ds_read_b64_tr_b16 v[234:235], v6 offset:49664
    v_mfma_f32_16x16x32_bf16 v[72:75], v[204:207], v[188:191], v[72:75]
    ds_read_b64_tr_b16 v[236:237], v6 offset:61440
    v_mfma_f32_16x16x32_bf16 v[72:75], v[200:203], v[184:187], v[72:75]
    ds_read_b64_tr_b16 v[238:239], v6 offset:61952
    v_mfma_f32_16x16x32_bf16 v[64:67], v[200:203], v[176:179], v[64:67]
    ds_read_b128 v[152:155], v2 offset:0
    v_mfma_f32_16x16x32_bf16 v[64:67], v[204:207], v[180:183], v[64:67]
    ds_read_b128 v[156:159], v3 offset:0
    v_mfma_f32_16x16x32_bf16 v[56:59], v[204:207], v[172:175], v[56:59]
    ds_read_b128 v[144:147], v4 offset:6144
    v_mfma_f32_16x16x32_bf16 v[56:59], v[200:203], v[168:171], v[56:59]
    ds_read_b128 v[148:151], v5 offset:6144
    v_mfma_f32_16x16x32_bf16 v[48:51], v[200:203], v[160:163], v[48:51]
    v_mfma_f32_16x16x32_bf16 v[48:51], v[204:207], v[164:167], v[48:51]
    s_waitcnt lgkmcnt(8)
    v_mfma_f32_16x16x32_bf16 v[52:55], v[228:231], v[164:167], v[52:55]
    ds_read_b64_tr_b16 v[200:201], v7 offset:49152
    v_mfma_f32_16x16x32_bf16 v[52:55], v[224:227], v[160:163], v[52:55]
    ds_read_b64_tr_b16 v[202:203], v7 offset:49664
    v_mfma_f32_16x16x32_bf16 v[60:63], v[224:227], v[168:171], v[60:63]
    ds_read_b64_tr_b16 v[204:205], v7 offset:61440
    v_mfma_f32_16x16x32_bf16 v[60:63], v[228:231], v[172:175], v[60:63]
    ds_read_b64_tr_b16 v[206:207], v7 offset:61952
    v_mfma_f32_16x16x32_bf16 v[68:71], v[228:231], v[180:183], v[68:71]
    ds_read_b128 v[136:139], v4 offset:4096
    v_mfma_f32_16x16x32_bf16 v[68:71], v[224:227], v[176:179], v[68:71]
    ds_read_b128 v[140:143], v5 offset:4096
    v_mfma_f32_16x16x32_bf16 v[76:79], v[224:227], v[184:187], v[76:79]
    ds_read_b128 v[128:131], v4 offset:2048
    v_mfma_f32_16x16x32_bf16 v[76:79], v[228:231], v[188:191], v[76:79]
    s_waitcnt lgkmcnt(11)
    v_mfma_f32_16x16x32_bf16 v[40:43], v[236:239], v[188:191], v[40:43]
    ds_read_b64_tr_b16 v[224:225], v6 offset:51200
    v_mfma_f32_16x16x32_bf16 v[40:43], v[232:235], v[184:187], v[40:43]
    ds_read_b64_tr_b16 v[226:227], v6 offset:51712
    v_mfma_f32_16x16x32_bf16 v[32:35], v[232:235], v[176:179], v[32:35]
    ds_read_b64_tr_b16 v[228:229], v6 offset:63488
    v_mfma_f32_16x16x32_bf16 v[32:35], v[236:239], v[180:183], v[32:35]
    ds_read_b64_tr_b16 v[230:231], v6 offset:64000
    v_mfma_f32_16x16x32_bf16 v[24:27], v[236:239], v[172:175], v[24:27]
    ds_read_b128 v[132:135], v5 offset:2048
    v_mfma_f32_16x16x32_bf16 v[24:27], v[232:235], v[168:171], v[24:27]
    ds_read_b128 v[120:123], v4 offset:0
    v_mfma_f32_16x16x32_bf16 v[16:19], v[232:235], v[160:163], v[16:19]
    ds_read_b128 v[124:127], v5 offset:0
    v_mfma_f32_16x16x32_bf16 v[16:19], v[236:239], v[164:167], v[16:19]
    s_waitcnt lgkmcnt(10)
    v_mfma_f32_16x16x32_bf16 v[20:23], v[204:207], v[164:167], v[20:23]
    ds_read_b64_tr_b16 v[232:233], v7 offset:51200
    v_mfma_f32_16x16x32_bf16 v[20:23], v[200:203], v[160:163], v[20:23]
    ds_read_b64_tr_b16 v[234:235], v7 offset:51712
    v_mfma_f32_16x16x32_bf16 v[28:31], v[200:203], v[168:171], v[28:31]
    ds_read_b64_tr_b16 v[236:237], v7 offset:63488
    v_mfma_f32_16x16x32_bf16 v[28:31], v[204:207], v[172:175], v[28:31]
    ds_read_b64_tr_b16 v[238:239], v7 offset:64000
    v_mfma_f32_16x16x32_bf16 v[36:39], v[204:207], v[180:183], v[36:39]
    v_mfma_f32_16x16x32_bf16 v[36:39], v[200:203], v[176:179], v[36:39]
    v_mfma_f32_16x16x32_bf16 v[44:47], v[200:203], v[184:187], v[44:47]
    v_mfma_f32_16x16x32_bf16 v[44:47], v[204:207], v[188:191], v[44:47]
    s_waitcnt lgkmcnt(7)
    v_mfma_f32_16x16x32_bf16 v[116:119], v[196:199], v[228:231], v[116:119]
    v_mfma_f32_16x16x32_bf16 v[116:119], v[192:195], v[224:227], v[116:119]
    v_mfma_f32_16x16x32_bf16 v[104:107], v[184:187], v[224:227], v[104:107]
    v_mfma_f32_16x16x32_bf16 v[104:107], v[188:191], v[228:231], v[104:107]
    v_mfma_f32_16x16x32_bf16 v[96:99], v[180:183], v[228:231], v[96:99]
    s_waitcnt lgkmcnt(0)
    s_barrier
    v_mfma_f32_16x16x32_bf16 v[96:99], v[176:179], v[224:227], v[96:99]
    ds_read_b64_tr_b16 v[200:201], v6 offset:1024
    v_mfma_f32_16x16x32_bf16 v[88:91], v[168:171], v[224:227], v[88:91]
    ds_read_b64_tr_b16 v[202:203], v6 offset:1536
    v_mfma_f32_16x16x32_bf16 v[88:91], v[172:175], v[228:231], v[88:91]
    ds_read_b64_tr_b16 v[204:205], v6 offset:13312
    v_mfma_f32_16x16x32_bf16 v[80:83], v[164:167], v[228:231], v[80:83]
    ds_read_b64_tr_b16 v[206:207], v6 offset:13824
    v_mfma_f32_16x16x32_bf16 v[80:83], v[160:163], v[224:227], v[80:83]
    v_mfma_f32_16x16x32_bf16 v[84:87], v[160:163], v[232:235], v[84:87]
    ds_read_b64_tr_b16 v[224:225], v7 offset:1024
    v_mfma_f32_16x16x32_bf16 v[84:87], v[164:167], v[236:239], v[84:87]
    ds_read_b64_tr_b16 v[226:227], v7 offset:1536
    v_mfma_f32_16x16x32_bf16 v[92:95], v[172:175], v[236:239], v[92:95]
    ds_read_b64_tr_b16 v[228:229], v7 offset:13312
    v_mfma_f32_16x16x32_bf16 v[92:95], v[168:171], v[232:235], v[92:95]
    ds_read_b64_tr_b16 v[230:231], v7 offset:13824
    v_mfma_f32_16x16x32_bf16 v[100:103], v[176:179], v[232:235], v[100:103]
    v_mfma_f32_16x16x32_bf16 v[100:103], v[180:183], v[236:239], v[100:103]
    v_mfma_f32_16x16x32_bf16 v[108:111], v[188:191], v[236:239], v[108:111]
    v_mfma_f32_16x16x32_bf16 v[108:111], v[184:187], v[232:235], v[108:111]
    s_waitcnt lgkmcnt(4)
    v_mfma_f32_16x16x32_bf16 v[112:115], v[200:203], v[152:155], v[112:115]
    ds_read_b64_tr_b16 v[232:233], v6 offset:0
    v_mfma_f32_16x16x32_bf16 v[112:115], v[204:207], v[156:159], v[112:115]
    ds_read_b64_tr_b16 v[234:235], v6 offset:512
    v_mfma_f32_16x16x32_bf16 v[72:75], v[204:207], v[148:151], v[72:75]
    ds_read_b64_tr_b16 v[236:237], v6 offset:12288
    v_mfma_f32_16x16x32_bf16 v[72:75], v[200:203], v[144:147], v[72:75]
    ds_read_b64_tr_b16 v[238:239], v6 offset:12800
    v_mfma_f32_16x16x32_bf16 v[64:67], v[200:203], v[136:139], v[64:67]
    ds_read_b128 v[192:195], v2 offset:18432
    v_mfma_f32_16x16x32_bf16 v[64:67], v[204:207], v[140:143], v[64:67]
    ds_read_b128 v[196:199], v3 offset:18432
    v_mfma_f32_16x16x32_bf16 v[56:59], v[204:207], v[132:135], v[56:59]
    ds_read_b128 v[184:187], v4 offset:24576
    v_mfma_f32_16x16x32_bf16 v[56:59], v[200:203], v[128:131], v[56:59]
    ds_read_b128 v[188:191], v5 offset:24576
    v_mfma_f32_16x16x32_bf16 v[48:51], v[200:203], v[120:123], v[48:51]
    v_mfma_f32_16x16x32_bf16 v[48:51], v[204:207], v[124:127], v[48:51]
    s_waitcnt lgkmcnt(8)
    v_mfma_f32_16x16x32_bf16 v[52:55], v[228:231], v[124:127], v[52:55]
    ds_read_b64_tr_b16 v[200:201], v7 offset:0
    v_mfma_f32_16x16x32_bf16 v[52:55], v[224:227], v[120:123], v[52:55]
    ds_read_b64_tr_b16 v[202:203], v7 offset:512
    v_mfma_f32_16x16x32_bf16 v[60:63], v[224:227], v[128:131], v[60:63]
    ds_read_b64_tr_b16 v[204:205], v7 offset:12288
    v_mfma_f32_16x16x32_bf16 v[60:63], v[228:231], v[132:135], v[60:63]
    ds_read_b64_tr_b16 v[206:207], v7 offset:12800
    v_mfma_f32_16x16x32_bf16 v[68:71], v[228:231], v[140:143], v[68:71]
    ds_read_b128 v[176:179], v4 offset:22528
    v_mfma_f32_16x16x32_bf16 v[68:71], v[224:227], v[136:139], v[68:71]
    ds_read_b128 v[180:183], v5 offset:22528
    v_mfma_f32_16x16x32_bf16 v[76:79], v[224:227], v[144:147], v[76:79]
    ds_read_b128 v[168:171], v4 offset:20480
    v_mfma_f32_16x16x32_bf16 v[76:79], v[228:231], v[148:151], v[76:79]
    s_waitcnt lgkmcnt(11)
    v_mfma_f32_16x16x32_bf16 v[40:43], v[236:239], v[148:151], v[40:43]
    ds_read_b64_tr_b16 v[224:225], v6 offset:2048
    v_mfma_f32_16x16x32_bf16 v[40:43], v[232:235], v[144:147], v[40:43]
    ds_read_b64_tr_b16 v[226:227], v6 offset:2560
    v_mfma_f32_16x16x32_bf16 v[32:35], v[232:235], v[136:139], v[32:35]
    ds_read_b64_tr_b16 v[228:229], v6 offset:14336
    v_mfma_f32_16x16x32_bf16 v[32:35], v[236:239], v[140:143], v[32:35]
    ds_read_b64_tr_b16 v[230:231], v6 offset:14848
    v_mfma_f32_16x16x32_bf16 v[24:27], v[236:239], v[132:135], v[24:27]
    ds_read_b128 v[172:175], v5 offset:20480
    v_mfma_f32_16x16x32_bf16 v[24:27], v[232:235], v[128:131], v[24:27]
    ds_read_b128 v[160:163], v4 offset:18432
    v_mfma_f32_16x16x32_bf16 v[16:19], v[232:235], v[120:123], v[16:19]
    ds_read_b128 v[164:167], v5 offset:18432
    v_mfma_f32_16x16x32_bf16 v[16:19], v[236:239], v[124:127], v[16:19]
    s_waitcnt lgkmcnt(10)
    v_mfma_f32_16x16x32_bf16 v[20:23], v[204:207], v[124:127], v[20:23]
    ds_read_b64_tr_b16 v[232:233], v7 offset:2048
    v_mfma_f32_16x16x32_bf16 v[20:23], v[200:203], v[120:123], v[20:23]
    ds_read_b64_tr_b16 v[234:235], v7 offset:2560
    v_mfma_f32_16x16x32_bf16 v[28:31], v[200:203], v[128:131], v[28:31]
    ds_read_b64_tr_b16 v[236:237], v7 offset:14336
    v_mfma_f32_16x16x32_bf16 v[28:31], v[204:207], v[132:135], v[28:31]
    ds_read_b64_tr_b16 v[238:239], v7 offset:14848
    v_mfma_f32_16x16x32_bf16 v[36:39], v[204:207], v[140:143], v[36:39]
    buffer_load_dword v222, v220, s[68:71], s98 offen sc1
    v_mfma_f32_16x16x32_bf16 v[36:39], v[200:203], v[136:139], v[36:39]
    v_mfma_f32_16x16x32_bf16 v[44:47], v[200:203], v[144:147], v[44:47]
    v_mfma_f32_16x16x32_bf16 v[44:47], v[204:207], v[148:151], v[44:47]
    s_waitcnt lgkmcnt(7)
    v_mfma_f32_16x16x32_bf16 v[116:119], v[156:159], v[228:231], v[116:119]
    v_mfma_f32_16x16x32_bf16 v[116:119], v[152:155], v[224:227], v[116:119]
    v_mfma_f32_16x16x32_bf16 v[104:107], v[144:147], v[224:227], v[104:107]
    v_mfma_f32_16x16x32_bf16 v[104:107], v[148:151], v[228:231], v[104:107]
    v_mfma_f32_16x16x32_bf16 v[96:99], v[140:143], v[228:231], v[96:99]
    s_waitcnt lgkmcnt(0)
    s_barrier
    v_mfma_f32_16x16x32_bf16 v[96:99], v[136:139], v[224:227], v[96:99]
    ds_read_b64_tr_b16 v[200:201], v6 offset:25600
    v_mfma_f32_16x16x32_bf16 v[88:91], v[128:131], v[224:227], v[88:91]
    ds_read_b64_tr_b16 v[202:203], v6 offset:26112
    v_mfma_f32_16x16x32_bf16 v[88:91], v[132:135], v[228:231], v[88:91]
    ds_read_b64_tr_b16 v[204:205], v6 offset:37888
    v_mfma_f32_16x16x32_bf16 v[80:83], v[124:127], v[228:231], v[80:83]
    ds_read_b64_tr_b16 v[206:207], v6 offset:38400
    v_mfma_f32_16x16x32_bf16 v[80:83], v[120:123], v[224:227], v[80:83]
    v_mfma_f32_16x16x32_bf16 v[84:87], v[120:123], v[232:235], v[84:87]
    ds_read_b64_tr_b16 v[224:225], v7 offset:25600
    v_mfma_f32_16x16x32_bf16 v[84:87], v[124:127], v[236:239], v[84:87]
    ds_read_b64_tr_b16 v[226:227], v7 offset:26112
    v_mfma_f32_16x16x32_bf16 v[92:95], v[132:135], v[236:239], v[92:95]
    ds_read_b64_tr_b16 v[228:229], v7 offset:37888
    v_mfma_f32_16x16x32_bf16 v[92:95], v[128:131], v[232:235], v[92:95]
    ds_read_b64_tr_b16 v[230:231], v7 offset:38400
    v_mfma_f32_16x16x32_bf16 v[100:103], v[136:139], v[232:235], v[100:103]
    v_mfma_f32_16x16x32_bf16 v[100:103], v[140:143], v[236:239], v[100:103]
    v_mfma_f32_16x16x32_bf16 v[108:111], v[148:151], v[236:239], v[108:111]
    v_mfma_f32_16x16x32_bf16 v[108:111], v[144:147], v[232:235], v[108:111]
    s_waitcnt lgkmcnt(4)
    v_mfma_f32_16x16x32_bf16 v[112:115], v[200:203], v[192:195], v[112:115]
    ds_read_b64_tr_b16 v[232:233], v6 offset:24576
    v_mfma_f32_16x16x32_bf16 v[112:115], v[204:207], v[196:199], v[112:115]
    ds_read_b64_tr_b16 v[234:235], v6 offset:25088
    v_mfma_f32_16x16x32_bf16 v[72:75], v[204:207], v[188:191], v[72:75]
    ds_read_b64_tr_b16 v[236:237], v6 offset:36864
    v_mfma_f32_16x16x32_bf16 v[72:75], v[200:203], v[184:187], v[72:75]
    ds_read_b64_tr_b16 v[238:239], v6 offset:37376
    v_mfma_f32_16x16x32_bf16 v[64:67], v[200:203], v[176:179], v[64:67]
    ds_read_b128 v[152:155], v2 offset:36864
    v_mfma_f32_16x16x32_bf16 v[64:67], v[204:207], v[180:183], v[64:67]
    ds_read_b128 v[156:159], v3 offset:36864
    v_mfma_f32_16x16x32_bf16 v[56:59], v[204:207], v[172:175], v[56:59]
    ds_read_b128 v[144:147], v4 offset:43008
    v_mfma_f32_16x16x32_bf16 v[56:59], v[200:203], v[168:171], v[56:59]
    ds_read_b128 v[148:151], v5 offset:43008
    v_mfma_f32_16x16x32_bf16 v[48:51], v[200:203], v[160:163], v[48:51]
    v_mfma_f32_16x16x32_bf16 v[48:51], v[204:207], v[164:167], v[48:51]
    s_waitcnt lgkmcnt(8)
    v_mfma_f32_16x16x32_bf16 v[52:55], v[228:231], v[164:167], v[52:55]
    ds_read_b64_tr_b16 v[200:201], v7 offset:24576
    v_mfma_f32_16x16x32_bf16 v[52:55], v[224:227], v[160:163], v[52:55]
    ds_read_b64_tr_b16 v[202:203], v7 offset:25088
    v_mfma_f32_16x16x32_bf16 v[60:63], v[224:227], v[168:171], v[60:63]
    ds_read_b64_tr_b16 v[204:205], v7 offset:36864
    v_mfma_f32_16x16x32_bf16 v[60:63], v[228:231], v[172:175], v[60:63]
    ds_read_b64_tr_b16 v[206:207], v7 offset:37376
    v_mfma_f32_16x16x32_bf16 v[68:71], v[228:231], v[180:183], v[68:71]
    ds_read_b128 v[136:139], v4 offset:40960
    v_mfma_f32_16x16x32_bf16 v[68:71], v[224:227], v[176:179], v[68:71]
    ds_read_b128 v[140:143], v5 offset:40960
    v_mfma_f32_16x16x32_bf16 v[76:79], v[224:227], v[184:187], v[76:79]
    ds_read_b128 v[128:131], v4 offset:38912
    v_mfma_f32_16x16x32_bf16 v[76:79], v[228:231], v[188:191], v[76:79]
    s_waitcnt lgkmcnt(11)
    v_mfma_f32_16x16x32_bf16 v[40:43], v[236:239], v[188:191], v[40:43]
    ds_read_b64_tr_b16 v[224:225], v6 offset:26624
    v_mfma_f32_16x16x32_bf16 v[40:43], v[232:235], v[184:187], v[40:43]
    ds_read_b64_tr_b16 v[226:227], v6 offset:27136
    v_mfma_f32_16x16x32_bf16 v[32:35], v[232:235], v[176:179], v[32:35]
    ds_read_b64_tr_b16 v[228:229], v6 offset:38912
    v_mfma_f32_16x16x32_bf16 v[32:35], v[236:239], v[180:183], v[32:35]
    ds_read_b64_tr_b16 v[230:231], v6 offset:39424
    v_mfma_f32_16x16x32_bf16 v[24:27], v[236:239], v[172:175], v[24:27]
    ds_read_b128 v[132:135], v5 offset:38912
    v_mfma_f32_16x16x32_bf16 v[24:27], v[232:235], v[168:171], v[24:27]
    ds_read_b128 v[120:123], v4 offset:36864
    v_mfma_f32_16x16x32_bf16 v[16:19], v[232:235], v[160:163], v[16:19]
    ds_read_b128 v[124:127], v5 offset:36864
    v_mfma_f32_16x16x32_bf16 v[16:19], v[236:239], v[164:167], v[16:19]
    s_waitcnt lgkmcnt(10)
    v_mfma_f32_16x16x32_bf16 v[20:23], v[204:207], v[164:167], v[20:23]
    ds_read_b64_tr_b16 v[232:233], v7 offset:26624
    v_mfma_f32_16x16x32_bf16 v[20:23], v[200:203], v[160:163], v[20:23]
    ds_read_b64_tr_b16 v[234:235], v7 offset:27136
    v_mfma_f32_16x16x32_bf16 v[28:31], v[200:203], v[168:171], v[28:31]
    ds_read_b64_tr_b16 v[236:237], v7 offset:38912
    v_mfma_f32_16x16x32_bf16 v[28:31], v[204:207], v[172:175], v[28:31]
    ds_read_b64_tr_b16 v[238:239], v7 offset:39424
    v_mfma_f32_16x16x32_bf16 v[36:39], v[204:207], v[180:183], v[36:39]
    v_mfma_f32_16x16x32_bf16 v[36:39], v[200:203], v[176:179], v[36:39]
    v_mfma_f32_16x16x32_bf16 v[44:47], v[200:203], v[184:187], v[44:47]
    v_mfma_f32_16x16x32_bf16 v[44:47], v[204:207], v[188:191], v[44:47]
    s_waitcnt lgkmcnt(7)
    v_mfma_f32_16x16x32_bf16 v[116:119], v[196:199], v[228:231], v[116:119]
    v_mfma_f32_16x16x32_bf16 v[116:119], v[192:195], v[224:227], v[116:119]
    v_mfma_f32_16x16x32_bf16 v[104:107], v[184:187], v[224:227], v[104:107]
    v_mfma_f32_16x16x32_bf16 v[104:107], v[188:191], v[228:231], v[104:107]
    v_mfma_f32_16x16x32_bf16 v[96:99], v[180:183], v[228:231], v[96:99]
    s_waitcnt lgkmcnt(0)
    s_barrier
    v_mfma_f32_16x16x32_bf16 v[96:99], v[176:179], v[224:227], v[96:99]
    ds_read_b64_tr_b16 v[200:201], v6 offset:50176
    v_mfma_f32_16x16x32_bf16 v[88:91], v[168:171], v[224:227], v[88:91]
    ds_read_b64_tr_b16 v[202:203], v6 offset:50688
    v_mfma_f32_16x16x32_bf16 v[88:91], v[172:175], v[228:231], v[88:91]
    ds_read_b64_tr_b16 v[204:205], v6 offset:62464
    v_mfma_f32_16x16x32_bf16 v[80:83], v[164:167], v[228:231], v[80:83]
    ds_read_b64_tr_b16 v[206:207], v6 offset:62976
    v_mfma_f32_16x16x32_bf16 v[80:83], v[160:163], v[224:227], v[80:83]
    v_mfma_f32_16x16x32_bf16 v[84:87], v[160:163], v[232:235], v[84:87]
    ds_read_b64_tr_b16 v[224:225], v7 offset:50176
    v_mfma_f32_16x16x32_bf16 v[84:87], v[164:167], v[236:239], v[84:87]
    ds_read_b64_tr_b16 v[226:227], v7 offset:50688
    v_mfma_f32_16x16x32_bf16 v[92:95], v[172:175], v[236:239], v[92:95]
    ds_read_b64_tr_b16 v[228:229], v7 offset:62464
    v_mfma_f32_16x16x32_bf16 v[92:95], v[168:171], v[232:235], v[92:95]
    ds_read_b64_tr_b16 v[230:231], v7 offset:62976
    v_mfma_f32_16x16x32_bf16 v[100:103], v[176:179], v[232:235], v[100:103]
    v_mfma_f32_16x16x32_bf16 v[100:103], v[180:183], v[236:239], v[100:103]
    v_mfma_f32_16x16x32_bf16 v[108:111], v[188:191], v[236:239], v[108:111]
    v_mfma_f32_16x16x32_bf16 v[108:111], v[184:187], v[232:235], v[108:111]
    s_waitcnt lgkmcnt(4)
    v_mfma_f32_16x16x32_bf16 v[112:115], v[200:203], v[152:155], v[112:115]
    ds_read_b64_tr_b16 v[232:233], v6 offset:49152
    v_mfma_f32_16x16x32_bf16 v[112:115], v[204:207], v[156:159], v[112:115]
    ds_read_b64_tr_b16 v[234:235], v6 offset:49664
    v_mfma_f32_16x16x32_bf16 v[72:75], v[204:207], v[148:151], v[72:75]
    ds_read_b64_tr_b16 v[236:237], v6 offset:61440
    v_mfma_f32_16x16x32_bf16 v[72:75], v[200:203], v[144:147], v[72:75]
    ds_read_b64_tr_b16 v[238:239], v6 offset:61952
    v_mfma_f32_16x16x32_bf16 v[64:67], v[200:203], v[136:139], v[64:67]
    ds_read_b128 v[192:195], v2 offset:0
    v_mfma_f32_16x16x32_bf16 v[64:67], v[204:207], v[140:143], v[64:67]
    ds_read_b128 v[196:199], v3 offset:0
    v_mfma_f32_16x16x32_bf16 v[56:59], v[204:207], v[132:135], v[56:59]
    ds_read_b128 v[184:187], v4 offset:6144
    v_mfma_f32_16x16x32_bf16 v[56:59], v[200:203], v[128:131], v[56:59]
    ds_read_b128 v[188:191], v5 offset:6144
    v_mfma_f32_16x16x32_bf16 v[48:51], v[200:203], v[120:123], v[48:51]
    v_mfma_f32_16x16x32_bf16 v[48:51], v[204:207], v[124:127], v[48:51]
    s_waitcnt lgkmcnt(8)
    v_mfma_f32_16x16x32_bf16 v[52:55], v[228:231], v[124:127], v[52:55]
    ds_read_b64_tr_b16 v[200:201], v7 offset:49152
    v_mfma_f32_16x16x32_bf16 v[52:55], v[224:227], v[120:123], v[52:55]
    ds_read_b64_tr_b16 v[202:203], v7 offset:49664
    v_mfma_f32_16x16x32_bf16 v[60:63], v[224:227], v[128:131], v[60:63]
    ds_read_b64_tr_b16 v[204:205], v7 offset:61440
    v_mfma_f32_16x16x32_bf16 v[60:63], v[228:231], v[132:135], v[60:63]
    ds_read_b64_tr_b16 v[206:207], v7 offset:61952
    v_mfma_f32_16x16x32_bf16 v[68:71], v[228:231], v[140:143], v[68:71]
    ds_read_b128 v[176:179], v4 offset:4096
    v_mfma_f32_16x16x32_bf16 v[68:71], v[224:227], v[136:139], v[68:71]
    ds_read_b128 v[180:183], v5 offset:4096
    v_mfma_f32_16x16x32_bf16 v[76:79], v[224:227], v[144:147], v[76:79]
    ds_read_b128 v[168:171], v4 offset:2048
    v_mfma_f32_16x16x32_bf16 v[76:79], v[228:231], v[148:151], v[76:79]
    s_waitcnt lgkmcnt(11)
    v_mfma_f32_16x16x32_bf16 v[40:43], v[236:239], v[148:151], v[40:43]
    ds_read_b64_tr_b16 v[224:225], v6 offset:51200
    v_mfma_f32_16x16x32_bf16 v[40:43], v[232:235], v[144:147], v[40:43]
    ds_read_b64_tr_b16 v[226:227], v6 offset:51712
    v_mfma_f32_16x16x32_bf16 v[32:35], v[232:235], v[136:139], v[32:35]
    ds_read_b64_tr_b16 v[228:229], v6 offset:63488
    v_mfma_f32_16x16x32_bf16 v[32:35], v[236:239], v[140:143], v[32:35]
    ds_read_b64_tr_b16 v[230:231], v6 offset:64000
    v_mfma_f32_16x16x32_bf16 v[24:27], v[236:239], v[132:135], v[24:27]
    ds_read_b128 v[172:175], v5 offset:2048
    v_mfma_f32_16x16x32_bf16 v[24:27], v[232:235], v[128:131], v[24:27]
    ds_read_b128 v[160:163], v4 offset:0
    v_mfma_f32_16x16x32_bf16 v[16:19], v[232:235], v[120:123], v[16:19]
    ds_read_b128 v[164:167], v5 offset:0
    v_mfma_f32_16x16x32_bf16 v[16:19], v[236:239], v[124:127], v[16:19]
    s_waitcnt lgkmcnt(10)
    v_mfma_f32_16x16x32_bf16 v[20:23], v[204:207], v[124:127], v[20:23]
    ds_read_b64_tr_b16 v[232:233], v7 offset:51200
    v_mfma_f32_16x16x32_bf16 v[20:23], v[200:203], v[120:123], v[20:23]
    ds_read_b64_tr_b16 v[234:235], v7 offset:51712
    v_mfma_f32_16x16x32_bf16 v[28:31], v[200:203], v[128:131], v[28:31]
    ds_read_b64_tr_b16 v[236:237], v7 offset:63488
    v_mfma_f32_16x16x32_bf16 v[28:31], v[204:207], v[132:135], v[28:31]
    ds_read_b64_tr_b16 v[238:239], v7 offset:64000
    v_mfma_f32_16x16x32_bf16 v[36:39], v[204:207], v[140:143], v[36:39]
    v_mfma_f32_16x16x32_bf16 v[36:39], v[200:203], v[136:139], v[36:39]
    v_mfma_f32_16x16x32_bf16 v[44:47], v[200:203], v[144:147], v[44:47]
    v_mfma_f32_16x16x32_bf16 v[44:47], v[204:207], v[148:151], v[44:47]
    s_waitcnt lgkmcnt(7)
    v_mfma_f32_16x16x32_bf16 v[116:119], v[156:159], v[228:231], v[116:119]
    v_mfma_f32_16x16x32_bf16 v[116:119], v[152:155], v[224:227], v[116:119]
    v_mfma_f32_16x16x32_bf16 v[104:107], v[144:147], v[224:227], v[104:107]
    v_mfma_f32_16x16x32_bf16 v[104:107], v[148:151], v[228:231], v[104:107]
    v_mfma_f32_16x16x32_bf16 v[96:99], v[140:143], v[228:231], v[96:99]
    s_waitcnt lgkmcnt(0)
    s_barrier
    s_cmp_lg_u32 s3, 0
    s_cbranch_scc1 LB_sk
    s_waitcnt vmcnt(0)
    v_cmp_eq_u32 vcc, 0, v222
    s_cbranch_vccnz LB_slow
LB_back:
    s_mov_b64 exec, 1
    buffer_store_dword v222, v220, s[52:55], s96 offen sc1
    s_mov_b64 exec, -1
LB_sk:
    v_mfma_f32_16x16x32_bf16 v[96:99], v[136:139], v[224:227], v[96:99]
    ds_read_b64_tr_b16 v[200:201], v6 offset:1024
    v_mfma_f32_16x16x32_bf16 v[88:91], v[128:131], v[224:227], v[88:91]
    ds_read_b64_tr_b16 v[202:203], v6 offset:1536
    v_mfma_f32_16x16x32_bf16 v[88:91], v[132:135], v[228:231], v[88:91]
    ds_read_b64_tr_b16 v[204:205], v6 offset:13312
    v_mfma_f32_16x16x32_bf16 v[80:83], v[124:127], v[228:231], v[80:83]
    ds_read_b64_tr_b16 v[206:207], v6 offset:13824
    v_mfma_f32_16x16x32_bf16 v[80:83], v[120:123], v[224:227], v[80:83]
    v_mfma_f32_16x16x32_bf16 v[84:87], v[120:123], v[232:235], v[84:87]
    ds_read_b64_tr_b16 v[224:225], v7 offset:1024
    v_mfma_f32_16x16x32_bf16 v[84:87], v[124:127], v[236:239], v[84:87]
    ds_read_b64_tr_b16 v[226:227], v7 offset:1536
    v_mfma_f32_16x16x32_bf16 v[92:95], v[132:135], v[236:239], v[92:95]
    ds_read_b64_tr_b16 v[228:229], v7 offset:13312
    v_mfma_f32_16x16x32_bf16 v[92:95], v[128:131], v[232:235], v[92:95]
    ds_read_b64_tr_b16 v[230:231], v7 offset:13824
    v_mfma_f32_16x16x32_bf16 v[100:103], v[136:139], v[232:235], v[100:103]
    v_mfma_f32_16x16x32_bf16 v[100:103], v[140:143], v[236:239], v[100:103]
    v_mfma_f32_16x16x32_bf16 v[108:111], v[148:151], v[236:239], v[108:111]
    v_mfma_f32_16x16x32_bf16 v[108:111], v[144:147], v[232:235], v[108:111]
    s_waitcnt lgkmcnt(4)
    v_mfma_f32_16x16x32_bf16 v[112:115], v[200:203], v[192:195], v[112:115]
    ds_read_b64_tr_b16 v[232:233], v6 offset:0
    v_mfma_f32_16x16x32_bf16 v[112:115], v[204:207], v[196:199], v[112:115]
    ds_read_b64_tr_b16 v[234:235], v6 offset:512
    v_mfma_f32_16x16x32_bf16 v[72:75], v[204:207], v[188:191], v[72:75]
    ds_read_b64_tr_b16 v[236:237], v6 offset:12288
    v_mfma_f32_16x16x32_bf16 v[72:75], v[200:203], v[184:187], v[72:75]
    ds_read_b64_tr_b16 v[238:239], v6 offset:12800
    v_mfma_f32_16x16x32_bf16 v[64:67], v[200:203], v[176:179], v[64:67]
    ds_read_b128 v[152:155], v2 offset:18432
    v_mfma_f32_16x16x32_bf16 v[64:67], v[204:207], v[180:183], v[64:67]
    ds_read_b128 v[156:159], v3 offset:18432
    v_mfma_f32_16x16x32_bf16 v[56:59], v[204:207], v[172:175], v[56:59]
    ds_read_b128 v[144:147], v4 offset:24576
    v_mfma_f32_16x16x32_bf16 v[56:59], v[200:203], v[168:171], v[56:59]
    ds_read_b128 v[148:151], v5 offset:24576
    v_mfma_f32_16x16x32_bf16 v[48:51], v[200:203], v[160:163], v[48:51]
    v_mfma_f32_16x16x32_bf16 v[48:51], v[204:207], v[164:167], v[48:51]
    s_waitcnt lgkmcnt(8)
    v_mfma_f32_16x16x32_bf16 v[52:55], v[228:231], v[164:167], v[52:55]
    ds_read_b64_tr_b16 v[200:201], v7 offset:0
    v_mfma_f32_16x16x32_bf16 v[52:55], v[224:227], v[160:163], v[52:55]
    ds_read_b64_tr_b16 v[202:203], v7 offset:512
    v_mfma_f32_16x16x32_bf16 v[60:63], v[224:227], v[168:171], v[60:63]
    ds_read_b64_tr_b16 v[204:205], v7 offset:12288
    v_mfma_f32_16x16x32_bf16 v[60:63], v[228:231], v[172:175], v[60:63]
    ds_read_b64_tr_b16 v[206:207], v7 offset:12800
    v_mfma_f32_16x16x32_bf16 v[68:71], v[228:231], v[180:183], v[68:71]
    ds_read_b128 v[136:139], v4 offset:22528
    v_mfma_f32_16x16x32_bf16 v[68:71], v[224:227], v[176:179], v[68:71]
    ds_read_b128 v[140:143], v5 offset:22528
    v_mfma_f32_16x16x32_bf16 v[76:79], v[224:227], v[184:187], v[76:79]
    ds_read_b128 v[128:131], v4 offset:20480
    v_mfma_f32_16x16x32_bf16 v[76:79], v[228:231], v[188:191], v[76:79]
    s_waitcnt lgkmcnt(11)
    v_mfma_f32_16x16x32_bf16 v[40:43], v[236:239], v[188:191], v[40:43]
    ds_read_b64_tr_b16 v[224:225], v6 offset:2048
    v_mfma_f32_16x16x32_bf16 v[40:43], v[232:235], v[184:187], v[40:43]
    ds_read_b64_tr_b16 v[226:227], v6 offset:2560
    v_mfma_f32_16x16x32_bf16 v[32:35], v[232:235], v[176:179], v[32:35]
    ds_read_b64_tr_b16 v[228:229], v6 offset:14336
    v_mfma_f32_16x16x32_bf16 v[32:35], v[236:239], v[180:183], v[32:35]
    ds_read_b64_tr_b16 v[230:231], v6 offset:14848
    v_mfma_f32_16x16x32_bf16 v[24:27], v[236:239], v[172:175], v[24:27]
    ds_read_b128 v[132:135], v5 offset:20480
    v_mfma_f32_16x16x32_bf16 v[24:27], v[232:235], v[168:171], v[24:27]
    ds_read_b128 v[120:123], v4 offset:18432
    v_mfma_f32_16x16x32_bf16 v[16:19], v[232:235], v[160:163], v[16:19]
    ds_read_b128 v[124:127], v5 offset:18432
    v_mfma_f32_16x16x32_bf16 v[16:19], v[236:239], v[164:167], v[16:19]
    s_waitcnt lgkmcnt(10)
    v_mfma_f32_16x16x32_bf16 v[20:23], v[204:207], v[164:167], v[20:23]
    ds_read_b64_tr_b16 v[232:233], v7 offset:2048
    v_mfma_f32_16x16x32_bf16 v[20:23], v[200:203], v[160:163], v[20:23]
    ds_read_b64_tr_b16 v[234:235], v7 offset:2560
    v_mfma_f32_16x16x32_bf16 v[28:31], v[200:203], v[168:171], v[28:31]
    ds_read_b64_tr_b16 v[236:237], v7 offset:14336
    v_mfma_f32_16x16x32_bf16 v[28:31], v[204:207], v[172:175], v[28:31]
    ds_read_b64_tr_b16 v[238:239], v7 offset:14848
    v_mfma_f32_16x16x32_bf16 v[36:39], v[204:207], v[180:183], v[36:39]
    v_mfma_f32_16x16x32_bf16 v[36:39], v[200:203], v[176:179], v[36:39]
    v_mfma_f32_16x16x32_bf16 v[44:47], v[200:203], v[184:187], v[44:47]
    v_mfma_f32_16x16x32_bf16 v[44:47], v[204:207], v[188:191], v[44:47]
    s_waitcnt lgkmcnt(7)
    v_mfma_f32_16x16x32_bf16 v[116:119], v[196:199], v[228:231], v[116:119]
    v_mfma_f32_16x16x32_bf16 v[116:119], v[192:195], v[224:227], v[116:119]
    v_mfma_f32_16x16x32_bf16 v[104:107], v[184:187], v[224:227], v[104:107]
    v_mfma_f32_16x16x32_bf16 v[104:107], v[188:191], v[228:231], v[104:107]
    v_mfma_f32_16x16x32_bf16 v[96:99], v[180:183], v[228:231], v[96:99]
    s_waitcnt lgkmcnt(0)
    s_barrier
    v_mfma_f32_16x16x32_bf16 v[96:99], v[176:179], v[224:227], v[96:99]
    ds_read_b64_tr_b16 v[200:201], v6 offset:25600
    v_mfma_f32_16x16x32_bf16 v[88:91], v[168:171], v[224:227], v[88:91]
    ds_read_b64_tr_b16 v[202:203], v6 offset:26112
    v_mfma_f32_16x16x32_bf16 v[88:91], v[172:175], v[228:231], v[88:91]
    ds_read_b64_tr_b16 v[204:205], v6 offset:37888
    v_mfma_f32_16x16x32_bf16 v[80:83], v[164:167], v[228:231], v[80:83]
    ds_read_b64_tr_b16 v[206:207], v6 offset:38400
    v_mfma_f32_16x16x32_bf16 v[80:83], v[160:163], v[224:227], v[80:83]
    v_mfma_f32_16x16x32_bf16 v[84:87], v[160:163], v[232:235], v[84:87]
    ds_read_b64_tr_b16 v[224:225], v7 offset:25600
    v_mfma_f32_16x16x32_bf16 v[84:87], v[164:167], v[236:239], v[84:87]
    ds_read_b64_tr_b16 v[226:227], v7 offset:26112
    v_mfma_f32_16x16x32_bf16 v[92:95], v[172:175], v[236:239], v[92:95]
    ds_read_b64_tr_b16 v[228:229], v7 offset:37888
    v_mfma_f32_16x16x32_bf16 v[92:95], v[168:171], v[232:235], v[92:95]
    ds_read_b64_tr_b16 v[230:231], v7 offset:38400
    v_mfma_f32_16x16x32_bf16 v[100:103], v[176:179], v[232:235], v[100:103]
    v_mfma_f32_16x16x32_bf16 v[100:103], v[180:183], v[236:239], v[100:103]
    v_mfma_f32_16x16x32_bf16 v[108:111], v[188:191], v[236:239], v[108:111]
    v_mfma_f32_16x16x32_bf16 v[108:111], v[184:187], v[232:235], v[108:111]
    s_waitcnt lgkmcnt(4)
    v_mfma_f32_16x16x32_bf16 v[112:115], v[200:203], v[152:155], v[112:115]
    ds_read_b64_tr_b16 v[232:233], v6 offset:24576
    v_mfma_f32_16x16x32_bf16 v[112:115], v[204:207], v[156:159], v[112:115]
    ds_read_b64_tr_b16 v[234:235], v6 offset:25088
    v_mfma_f32_16x16x32_bf16 v[72:75], v[204:207], v[148:151], v[72:75]
    ds_read_b64_tr_b16 v[236:237], v6 offset:36864
    v_mfma_f32_16x16x32_bf16 v[72:75], v[200:203], v[144:147], v[72:75]
    ds_read_b64_tr_b16 v[238:239], v6 offset:37376
    v_mfma_f32_16x16x32_bf16 v[64:67], v[200:203], v[136:139], v[64:67]
    ds_read_b128 v[192:195], v2 offset:36864
    v_mfma_f32_16x16x32_bf16 v[64:67], v[204:207], v[140:143], v[64:67]
    ds_read_b128 v[196:199], v3 offset:36864
    v_mfma_f32_16x16x32_bf16 v[56:59], v[204:207], v[132:135], v[56:59]
    ds_read_b128 v[184:187], v4 offset:43008
    v_mfma_f32_16x16x32_bf16 v[56:59], v[200:203], v[128:131], v[56:59]
    ds_read_b128 v[188:191], v5 offset:43008
    v_mfma_f32_16x16x32_bf16 v[48:51], v[200:203], v[120:123], v[48:51]
    v_mfma_f32_16x16x32_bf16 v[48:51], v[204:207], v[124:127], v[48:51]
    s_waitcnt lgkmcnt(8)
    v_mfma_f32_16x16x32_bf16 v[52:55], v[228:231], v[124:127], v[52:55]
    ds_read_b64_tr_b16 v[200:201], v7 offset:24576
    v_mfma_f32_16x16x32_bf16 v[52:55], v[224:227], v[120:123], v[52:55]
    ds_read_b64_tr_b16 v[202:203], v7 offset:25088
    v_mfma_f32_16x16x32_bf16 v[60:63], v[224:227], v[128:131], v[60:63]
    ds_read_b64_tr_b16 v[204:205], v7 offset:36864
    v_mfma_f32_16x16x32_bf16 v[60:63], v[228:231], v[132:135], v[60:63]
    ds_read_b64_tr_b16 v[206:207], v7 offset:37376
    v_mfma_f32_16x16x32_bf16 v[68:71], v[228:231], v[140:143], v[68:71]
    ds_read_b128 v[176:179], v4 offset:40960
    v_mfma_f32_16x16x32_bf16 v[68:71], v[224:227], v[136:139], v[68:71]
    ds_read_b128 v[180:183], v5 offset:40960
    v_mfma_f32_16x16x32_bf16 v[76:79], v[224:227], v[144:147], v[76:79]
    ds_read_b128 v[168:171], v4 offset:38912
    v_mfma_f32_16x16x32_bf16 v[76:79], v[228:231], v[148:151], v[76:79]
    s_waitcnt lgkmcnt(11)
    v_mfma_f32_16x16x32_bf16 v[40:43], v[236:239], v[148:151], v[40:43]
    ds_read_b64_tr_b16 v[224:225], v6 offset:26624
    v_mfma_f32_16x16x32_bf16 v[40:43], v[232:235], v[144:147], v[40:43]
    ds_read_b64_tr_b16 v[226:227], v6 offset:27136
    v_mfma_f32_16x16x32_bf16 v[32:35], v[232:235], v[136:139], v[32:35]
    ds_read_b64_tr_b16 v[228:229], v6 offset:38912
    v_mfma_f32_16x16x32_bf16 v[32:35], v[236:239], v[140:143], v[32:35]
    ds_read_b64_tr_b16 v[230:231], v6 offset:39424
    v_mfma_f32_16x16x32_bf16 v[24:27], v[236:239], v[132:135], v[24:27]
    ds_read_b128 v[172:175], v5 offset:38912
    v_mfma_f32_16x16x32_bf16 v[24:27], v[232:235], v[128:131], v[24:27]
    ds_read_b128 v[160:163], v4 offset:36864
    v_mfma_f32_16x16x32_bf16 v[16:19], v[232:235], v[120:123], v[16:19]
    ds_read_b128 v[164:167], v5 offset:36864
    v_mfma_f32_16x16x32_bf16 v[16:19], v[236:239], v[124:127], v[16:19]
    s_waitcnt lgkmcnt(10)
    v_mfma_f32_16x16x32_bf16 v[20:23], v[204:207], v[124:127], v[20:23]
    ds_read_b64_tr_b16 v[232:233], v7 offset:26624
    v_mfma_f32_16x16x32_bf16 v[20:23], v[200:203], v[120:123], v[20:23]
    ds_read_b64_tr_b16 v[234:235], v7 offset:27136
    v_mfma_f32_16x16x32_bf16 v[28:31], v[200:203], v[128:131], v[28:31]
    ds_read_b64_tr_b16 v[236:237], v7 offset:38912
    v_mfma_f32_16x16x32_bf16 v[28:31], v[204:207], v[132:135], v[28:31]
    ds_read_b64_tr_b16 v[238:239], v7 offset:39424
    v_mfma_f32_16x16x32_bf16 v[36:39], v[204:207], v[140:143], v[36:39]
    v_mfma_f32_16x16x32_bf16 v[36:39], v[200:203], v[136:139], v[36:39]
    v_mfma_f32_16x16x32_bf16 v[44:47], v[200:203], v[144:147], v[44:47]
    v_mfma_f32_16x16x32_bf16 v[44:47], v[204:207], v[148:151], v[44:47]
    s_waitcnt lgkmcnt(7)
    v_mfma_f32_16x16x32_bf16 v[116:119], v[156:159], v[228:231], v[116:119]
    v_mfma_f32_16x16x32_bf16 v[116:119], v[152:155], v[224:227], v[116:119]
    v_mfma_f32_16x16x32_bf16 v[104:107], v[144:147], v[224:227], v[104:107]
    v_mfma_f32_16x16x32_bf16 v[104:107], v[148:151], v[228:231], v[104:107]
    v_mfma_f32_16x16x32_bf16 v[96:99], v[140:143], v[228:231], v[96:99]
    s_waitcnt lgkmcnt(0)
    s_barrier
    v_mfma_f32_16x16x32_bf16 v[96:99], v[136:139], v[224:227], v[96:99]
    ds_read_b64_tr_b16 v[200:201], v6 offset:50176
    v_mfma_f32_16x16x32_bf16 v[88:91], v[128:131], v[224:227], v[88:91]
    ds_read_b64_tr_b16 v[202:203], v6 offset:50688
    v_mfma_f32_16x16x32_bf16 v[88:91], v[132:135], v[228:231], v[88:91]
    ds_read_b64_tr_b16 v[204:205], v6 offset:62464
    v_mfma_f32_16x16x32_bf16 v[80:83], v[124:127], v[228:231], v[80:83]
    ds_read_b64_tr_b16 v[206:207], v6 offset:62976
    v_mfma_f32_16x16x32_bf16 v[80:83], v[120:123], v[224:227], v[80:83]
    v_mfma_f32_16x16x32_bf16 v[84:87], v[120:123], v[232:235], v[84:87]
    ds_read_b64_tr_b16 v[224:225], v7 offset:50176
    v_mfma_f32_16x16x32_bf16 v[84:87], v[124:127], v[236:239], v[84:87]
    ds_read_b64_tr_b16 v[226:227], v7 offset:50688
    v_mfma_f32_16x16x32_bf16 v[92:95], v[132:135], v[236:239], v[92:95]
    ds_read_b64_tr_b16 v[228:229], v7 offset:62464
    v_mfma_f32_16x16x32_bf16 v[92:95], v[128:131], v[232:235], v[92:95]
    ds_read_b64_tr_b16 v[230:231], v7 offset:62976
    v_mfma_f32_16x16x32_bf16 v[100:103], v[136:139], v[232:235], v[100:103]
    v_mfma_f32_16x16x32_bf16 v[100:103], v[140:143], v[236:239], v[100:103]
    v_mfma_f32_16x16x32_bf16 v[108:111], v[148:151], v[236:239], v[108:111]
    v_mfma_f32_16x16x32_bf16 v[108:111], v[144:147], v[232:235], v[108:111]
    s_waitcnt lgkmcnt(4)
    v_mfma_f32_16x16x32_bf16 v[112:115], v[200:203], v[192:195], v[112:115]
    ds_read_b64_tr_b16 v[232:233], v6 offset:49152
    v_mfma_f32_16x16x32_bf16 v[112:115], v[204:207], v[196:199], v[112:115]
    ds_read_b64_tr_b16 v[234:235], v6 offset:49664
    v_mfma_f32_16x16x32_bf16 v[72:75], v[204:207], v[188:191], v[72:75]
    ds_read_b64_tr_b16 v[236:237], v6 offset:61440
    v_mfma_f32_16x16x32_bf16 v[72:75], v[200:203], v[184:187], v[72:75]
    ds_read_b64_tr_b16 v[238:239], v6 offset:61952
    v_mfma_f32_16x16x32_bf16 v[64:67], v[200:203], v[176:179], v[64:67]
    ds_read_b128 v[152:155], v2 offset:0
    v_mfma_f32_16x16x32_bf16 v[64:67], v[204:207], v[180:183], v[64:67]
    ds_read_b128 v[156:159], v3 offset:0
    v_mfma_f32_16x16x32_bf16 v[56:59], v[204:207], v[172:175], v[56:59]
    ds_read_b128 v[144:147], v4 offset:6144
    v_mfma_f32_16x16x32_bf16 v[56:59], v[200:203], v[168:171], v[56:59]
    ds_read_b128 v[148:151], v5 offset:6144
    v_mfma_f32_16x16x32_bf16 v[48:51], v[200:203], v[160:163], v[48:51]
    v_mfma_f32_16x16x32_bf16 v[48:51], v[204:207], v[164:167], v[48:51]
    s_waitcnt lgkmcnt(8)
    v_mfma_f32_16x16x32_bf16 v[52:55], v[228:231], v[164:167], v[52:55]
    ds_read_b64_tr_b16 v[200:201], v7 offset:49152
    v_mfma_f32_16x16x32_bf16 v[52:55], v[224:227], v[160:163], v[52:55]
    ds_read_b64_tr_b16 v[202:203], v7 offset:49664
    v_mfma_f32_16x16x32_bf16 v[60:63], v[224:227], v[168:171], v[60:63]
    ds_read_b64_tr_b16 v[204:205], v7 offset:61440
    v_mfma_f32_16x16x32_bf16 v[60:63], v[228:231], v[172:175], v[60:63]
    ds_read_b64_tr_b16 v[206:207], v7 offset:61952
    v_mfma_f32_16x16x32_bf16 v[68:71], v[228:231], v[180:183], v[68:71]
    ds_read_b128 v[136:139], v4 offset:4096
    v_mfma_f32_16x16x32_bf16 v[68:71], v[224:227], v[176:179], v[68:71]
    ds_read_b128 v[140:143], v5 offset:4096
    v_mfma_f32_16x16x32_bf16 v[76:79], v[224:227], v[184:187], v[76:79]
    ds_read_b128 v[128:131], v4 offset:2048
    v_mfma_f32_16x16x32_bf16 v[76:79], v[228:231], v[188:191], v[76:79]
    s_waitcnt lgkmcnt(11)
    v_mfma_f32_16x16x32_bf16 v[40:43], v[236:239], v[188:191], v[40:43]
    ds_read_b64_tr_b16 v[224:225], v6 offset:51200
    v_mfma_f32_16x16x32_bf16 v[40:43], v[232:235], v[184:187], v[40:43]
    ds_read_b64_tr_b16 v[226:227], v6 offset:51712
    v_mfma_f32_16x16x32_bf16 v[32:35], v[232:235], v[176:179], v[32:35]
    ds_read_b64_tr_b16 v[228:229], v6 offset:63488
    v_mfma_f32_16x16x32_bf16 v[32:35], v[236:239], v[180:183], v[32:35]
    ds_read_b64_tr_b16 v[230:231], v6 offset:64000
    v_mfma_f32_16x16x32_bf16 v[24:27], v[236:239], v[172:175], v[24:27]
    ds_read_b128 v[132:135], v5 offset:2048
    v_mfma_f32_16x16x32_bf16 v[24:27], v[232:235], v[168:171], v[24:27]
    ds_read_b128 v[120:123], v4 offset:0
    v_mfma_f32_16x16x32_bf16 v[16:19], v[232:235], v[160:163], v[16:19]
    ds_read_b128 v[124:127], v5 offset:0
    v_mfma_f32_16x16x32_bf16 v[16:19], v[236:239], v[164:167], v[16:19]
    s_waitcnt lgkmcnt(10)
    v_mfma_f32_16x16x32_bf16 v[20:23], v[204:207], v[164:167], v[20:23]
    ds_read_b64_tr_b16 v[232:233], v7 offset:51200
    v_mfma_f32_16x16x32_bf16 v[20:23], v[200:203], v[160:163], v[20:23]
    ds_read_b64_tr_b16 v[234:235], v7 offset:51712
    v_mfma_f32_16x16x32_bf16 v[28:31], v[200:203], v[168:171], v[28:31]
    ds_read_b64_tr_b16 v[236:237], v7 offset:63488
    v_mfma_f32_16x16x32_bf16 v[28:31], v[204:207], v[172:175], v[28:31]
    ds_read_b64_tr_b16 v[238:239], v7 offset:64000
    v_mfma_f32_16x16x32_bf16 v[36:39], v[204:207], v[180:183], v[36:39]
    v_mfma_f32_16x16x32_bf16 v[36:39], v[200:203], v[176:179], v[36:39]
    v_mfma_f32_16x16x32_bf16 v[44:47], v[200:203], v[184:187], v[44:47]
    v_mfma_f32_16x16x32_bf16 v[44:47], v[204:207], v[188:191], v[44:47]
    s_waitcnt lgkmcnt(7)
    v_mfma_f32_16x16x32_bf16 v[116:119], v[196:199], v[228:231], v[116:119]
    v_mfma_f32_16x16x32_bf16 v[116:119], v[192:195], v[224:227], v[116:119]
    v_mfma_f32_16x16x32_bf16 v[104:107], v[184:187], v[224:227], v[104:107]
    v_mfma_f32_16x16x32_bf16 v[104:107], v[188:191], v[228:231], v[104:107]
    v_mfma_f32_16x16x32_bf16 v[96:99], v[180:183], v[228:231], v[96:99]
    s_waitcnt lgkmcnt(0)
    s_barrier
    v_mfma_f32_16x16x32_bf16 v[96:99], v[176:179], v[224:227], v[96:99]
    ds_read_b64_tr_b16 v[200:201], v6 offset:1024
    v_mfma_f32_16x16x32_bf16 v[88:91], v[168:171], v[224:227], v[88:91]
    ds_read_b64_tr_b16 v[202:203], v6 offset:1536
    v_mfma_f32_16x16x32_bf16 v[88:91], v[172:175], v[228:231], v[88:91]
    ds_read_b64_tr_b16 v[204:205], v6 offset:13312
    v_mfma_f32_16x16x32_bf16 v[80:83], v[164:167], v[228:231], v[80:83]
    ds_read_b64_tr_b16 v[206:207], v6 offset:13824
    v_mfma_f32_16x16x32_bf16 v[80:83], v[160:163], v[224:227], v[80:83]
    v_mfma_f32_16x16x32_bf16 v[84:87], v[160:163], v[232:235], v[84:87]
    ds_read_b64_tr_b16 v[224:225], v7 offset:1024
    v_mfma_f32_16x16x32_bf16 v[84:87], v[164:167], v[236:239], v[84:87]
    ds_read_b64_tr_b16 v[226:227], v7 offset:1536
    v_mfma_f32_16x16x32_bf16 v[92:95], v[172:175], v[236:239], v[92:95]
    ds_read_b64_tr_b16 v[228:229], v7 offset:13312
    v_mfma_f32_16x16x32_bf16 v[92:95], v[168:171], v[232:235], v[92:95]
    ds_read_b64_tr_b16 v[230:231], v7 offset:13824
    v_mfma_f32_16x16x32_bf16 v[100:103], v[176:179], v[232:235], v[100:103]
    v_mfma_f32_16x16x32_bf16 v[100:103], v[180:183], v[236:239], v[100:103]
    v_mfma_f32_16x16x32_bf16 v[108:111], v[188:191], v[236:239], v[108:111]
    v_mfma_f32_16x16x32_bf16 v[108:111], v[184:187], v[232:235], v[108:111]
    s_waitcnt lgkmcnt(4)
    v_mfma_f32_16x16x32_bf16 v[112:115], v[200:203], v[152:155], v[112:115]
    ds_read_b64_tr_b16 v[232:233], v6 offset:0
    v_mfma_f32_16x16x32_bf16 v[112:115], v[204:207], v[156:159], v[112:115]
    ds_read_b64_tr_b16 v[234:235], v6 offset:512
    v_mfma_f32_16x16x32_bf16 v[72:75], v[204:207], v[148:151], v[72:75]
    ds_read_b64_tr_b16 v[236:237], v6 offset:12288
    v_mfma_f32_16x16x32_bf16 v[72:75], v[200:203], v[144:147], v[72:75]
    ds_read_b64_tr_b16 v[238:239], v6 offset:12800
    v_mfma_f32_16x16x32_bf16 v[64:67], v[200:203], v[136:139], v[64:67]
    ds_read_b128 v[192:195], v2 offset:18432
    v_mfma_f32_16x16x32_bf16 v[64:67], v[204:207], v[140:143], v[64:67]
    ds_read_b128 v[196:199], v3 offset:18432
    v_mfma_f32_16x16x32_bf16 v[56:59], v[204:207], v[132:135], v[56:59]
    ds_read_b128 v[184:187], v4 offset:24576
    v_mfma_f32_16x16x32_bf16 v[56:59], v[200:203], v[128:131], v[56:59]
    ds_read_b128 v[188:191], v5 offset:24576
    v_mfma_f32_16x16x32_bf16 v[48:51], v[200:203], v[120:123], v[48:51]
    v_mfma_f32_16x16x32_bf16 v[48:51], v[204:207], v[124:127], v[48:51]
    s_waitcnt lgkmcnt(8)
    v_mfma_f32_16x16x32_bf16 v[52:55], v[228:231], v[124:127], v[52:55]
    ds_read_b64_tr_b16 v[200:201], v7 offset:0
    v_mfma_f32_16x16x32_bf16 v[52:55], v[224:227], v[120:123], v[52:55]
    ds_read_b64_tr_b16 v[202:203], v7 offset:512
    v_mfma_f32_16x16x32_bf16 v[60:63], v[224:227], v[128:131], v[60:63]
    ds_read_b64_tr_b16 v[204:205], v7 offset:12288
    v_mfma_f32_16x16x32_bf16 v[60:63], v[228:231], v[132:135], v[60:63]
    ds_read_b64_tr_b16 v[206:207], v7 offset:12800
    v_mfma_f32_16x16x32_bf16 v[68:71], v[228:231], v[140:143], v[68:71]
    ds_read_b128 v[176:179], v4 offset:22528
    v_mfma_f32_16x16x32_bf16 v[68:71], v[224:227], v[136:139], v[68:71]
    ds_read_b128 v[180:183], v5 offset:22528
    v_mfma_f32_16x16x32_bf16 v[76:79], v[224:227], v[144:147], v[76:79]
    ds_read_b128 v[168:171], v4 offset:20480
    v_mfma_f32_16x16x32_bf16 v[76:79], v[228:231], v[148:151], v[76:79]
    s_waitcnt lgkmcnt(11)
    v_mfma_f32_16x16x32_bf16 v[40:43], v[236:239], v[148:151], v[40:43]
    ds_read_b64_tr_b16 v[224:225], v6 offset:2048
    v_mfma_f32_16x16x32_bf16 v[40:43], v[232:235], v[144:147], v[40:43]
    ds_read_b64_tr_b16 v[226:227], v6 offset:2560
    v_mfma_f32_16x16x32_bf16 v[32:35], v[232:235], v[136:139], v[32:35]
    ds_read_b64_tr_b16 v[228:229], v6 offset:14336
    v_mfma_f32_16x16x32_bf16 v[32:35], v[236:239], v[140:143], v[32:35]
    ds_read_b64_tr_b16 v[230:231], v6 offset:14848
    v_mfma_f32_16x16x32_bf16 v[24:27], v[236:239], v[132:135], v[24:27]
    ds_read_b128 v[172:175], v5 offset:20480
    v_mfma_f32_16x16x32_bf16 v[24:27], v[232:235], v[128:131], v[24:27]
    ds_read_b128 v[160:163], v4 offset:18432
    v_mfma_f32_16x16x32_bf16 v[16:19], v[232:235], v[120:123], v[16:19]
    ds_read_b128 v[164:167], v5 offset:18432
    v_mfma_f32_16x16x32_bf16 v[16:19], v[236:239], v[124:127], v[16:19]
    s_waitcnt lgkmcnt(10)
    v_mfma_f32_16x16x32_bf16 v[20:23], v[204:207], v[124:127], v[20:23]
    ds_read_b64_tr_b16 v[232:233], v7 offset:2048
    v_mfma_f32_16x16x32_bf16 v[20:23], v[200:203], v[120:123], v[20:23]
    ds_read_b64_tr_b16 v[234:235], v7 offset:2560
    v_mfma_f32_16x16x32_bf16 v[28:31], v[200:203], v[128:131], v[28:31]
    ds_read_b64_tr_b16 v[236:237], v7 offset:14336
    v_mfma_f32_16x16x32_bf16 v[28:31], v[204:207], v[132:135], v[28:31]
    ds_read_b64_tr_b16 v[238:239], v7 offset:14848
    v_mfma_f32_16x16x32_bf16 v[36:39], v[204:207], v[140:143], v[36:39]
    v_mfma_f32_16x16x32_bf16 v[36:39], v[200:203], v[136:139], v[36:39]
    v_mfma_f32_16x16x32_bf16 v[44:47], v[200:203], v[144:147], v[44:47]
    v_mfma_f32_16x16x32_bf16 v[44:47], v[204:207], v[148:151], v[44:47]
    s_waitcnt lgkmcnt(7)
    v_mfma_f32_16x16x32_bf16 v[116:119], v[156:159], v[228:231], v[116:119]
    v_mfma_f32_16x16x32_bf16 v[116:119], v[152:155], v[224:227], v[116:119]
    v_mfma_f32_16x16x32_bf16 v[104:107], v[144:147], v[224:227], v[104:107]
    v_mfma_f32_16x16x32_bf16 v[104:107], v[148:151], v[228:231], v[104:107]
    v_mfma_f32_16x16x32_bf16 v[96:99], v[140:143], v[228:231], v[96:99]
    s_waitcnt lgkmcnt(0)
    s_barrier
    v_mfma_f32_16x16x32_bf16 v[96:99], v[136:139], v[224:227], v[96:99]
    ds_read_b64_tr_b16 v[200:201], v6 offset:25600
    v_mfma_f32_16x16x32_bf16 v[88:91], v[128:131], v[224:227], v[88:91]
    ds_read_b64_tr_b16 v[202:203], v6 offset:26112
    v_mfma_f32_16x16x32_bf16 v[88:91], v[132:135], v[228:231], v[88:91]
    ds_read_b64_tr_b16 v[204:205], v6 offset:37888
    v_mfma_f32_16x16x32_bf16 v[80:83], v[124:127], v[228:231], v[80:83]
    ds_read_b64_tr_b16 v[206:207], v6 offset:38400
    v_mfma_f32_16x16x32_bf16 v[80:83], v[120:123], v[224:227], v[80:83]
    v_mfma_f32_16x16x32_bf16 v[84:87], v[120:123], v[232:235], v[84:87]
    ds_read_b64_tr_b16 v[224:225], v7 offset:25600
    v_mfma_f32_16x16x32_bf16 v[84:87], v[124:127], v[236:239], v[84:87]
    ds_read_b64_tr_b16 v[226:227], v7 offset:26112
    v_mfma_f32_16x16x32_bf16 v[92:95], v[132:135], v[236:239], v[92:95]
    ds_read_b64_tr_b16 v[228:229], v7 offset:37888
    v_mfma_f32_16x16x32_bf16 v[92:95], v[128:131], v[232:235], v[92:95]
    ds_read_b64_tr_b16 v[230:231], v7 offset:38400
    v_mfma_f32_16x16x32_bf16 v[100:103], v[136:139], v[232:235], v[100:103]
    v_mfma_f32_16x16x32_bf16 v[100:103], v[140:143], v[236:239], v[100:103]
    v_mfma_f32_16x16x32_bf16 v[108:111], v[148:151], v[236:239], v[108:111]
    v_mfma_f32_16x16x32_bf16 v[108:111], v[144:147], v[232:235], v[108:111]
    s_waitcnt lgkmcnt(4)
    v_mfma_f32_16x16x32_bf16 v[112:115], v[200:203], v[192:195], v[112:115]
    ds_read_b64_tr_b16 v[232:233], v6 offset:24576
    v_mfma_f32_16x16x32_bf16 v[112:115], v[204:207], v[196:199], v[112:115]
    ds_read_b64_tr_b16 v[234:235], v6 offset:25088
    v_mfma_f32_16x16x32_bf16 v[72:75], v[204:207], v[188:191], v[72:75]
    ds_read_b64_tr_b16 v[236:237], v6 offset:36864
    v_mfma_f32_16x16x32_bf16 v[72:75], v[200:203], v[184:187], v[72:75]
    ds_read_b64_tr_b16 v[238:239], v6 offset:37376
    v_mfma_f32_16x16x32_bf16 v[64:67], v[200:203], v[176:179], v[64:67]
    ds_read_b128 v[152:155], v2 offset:36864
    v_mfma_f32_16x16x32_bf16 v[64:67], v[204:207], v[180:183], v[64:67]
    ds_read_b128 v[156:159], v3 offset:36864
    v_mfma_f32_16x16x32_bf16 v[56:59], v[204:207], v[172:175], v[56:59]
    ds_read_b128 v[144:147], v4 offset:43008
    v_mfma_f32_16x16x32_bf16 v[56:59], v[200:203], v[168:171], v[56:59]
    ds_read_b128 v[148:151], v5 offset:43008
    v_mfma_f32_16x16x32_bf16 v[48:51], v[200:203], v[160:163], v[48:51]
    v_mfma_f32_16x16x32_bf16 v[48:51], v[204:207], v[164:167], v[48:51]
    s_waitcnt lgkmcnt(8)
    v_mfma_f32_16x16x32_bf16 v[52:55], v[228:231], v[164:167], v[52:55]
    ds_read_b64_tr_b16 v[200:201], v7 offset:24576
    v_mfma_f32_16x16x32_bf16 v[52:55], v[224:227], v[160:163], v[52:55]
    ds_read_b64_tr_b16 v[202:203], v7 offset:25088
    v_mfma_f32_16x16x32_bf16 v[60:63], v[224:227], v[168:171], v[60:63]
    ds_read_b64_tr_b16 v[204:205], v7 offset:36864
    v_mfma_f32_16x16x32_bf16 v[60:63], v[228:231], v[172:175], v[60:63]
    ds_read_b64_tr_b16 v[206:207], v7 offset:37376
    v_mfma_f32_16x16x32_bf16 v[68:71], v[228:231], v[180:183], v[68:71]
    ds_read_b128 v[136:139], v4 offset:40960
    v_mfma_f32_16x16x32_bf16 v[68:71], v[224:227], v[176:179], v[68:71]
    ds_read_b128 v[140:143], v5 offset:40960
    v_mfma_f32_16x16x32_bf16 v[76:79], v[224:227], v[184:187], v[76:79]
    ds_read_b128 v[128:131], v4 offset:38912
    v_mfma_f32_16x16x32_bf16 v[76:79], v[228:231], v[188:191], v[76:79]
    s_waitcnt lgkmcnt(11)
    v_mfma_f32_16x16x32_bf16 v[40:43], v[236:239], v[188:191], v[40:43]
    ds_read_b64_tr_b16 v[224:225], v6 offset:26624
    v_mfma_f32_16x16x32_bf16 v[40:43], v[232:235], v[184:187], v[40:43]
    ds_read_b64_tr_b16 v[226:227], v6 offset:27136
    v_mfma_f32_16x16x32_bf16 v[32:35], v[232:235], v[176:179], v[32:35]
    ds_read_b64_tr_b16 v[228:229], v6 offset:38912
    v_mfma_f32_16x16x32_bf16 v[32:35], v[236:239], v[180:183], v[32:35]
    ds_read_b64_tr_b16 v[230:231], v6 offset:39424
    v_mfma_f32_16x16x32_bf16 v[24:27], v[236:239], v[172:175], v[24:27]
    ds_read_b128 v[132:135], v5 offset:38912
    v_mfma_f32_16x16x32_bf16 v[24:27], v[232:235], v[168:171], v[24:27]
    ds_read_b128 v[120:123], v4 offset:36864
    v_mfma_f32_16x16x32_bf16 v[16:19], v[232:235], v[160:163], v[16:19]
    ds_read_b128 v[124:127], v5 offset:36864
    v_mfma_f32_16x16x32_bf16 v[16:19], v[236:239], v[164:167], v[16:19]
    s_waitcnt lgkmcnt(10)
    v_mfma_f32_16x16x32_bf16 v[20:23], v[204:207], v[164:167], v[20:23]
    ds_read_b64_tr_b16 v[232:233], v7 offset:26624
    v_mfma_f32_16x16x32_bf16 v[20:23], v[200:203], v[160:163], v[20:23]
    ds_read_b64_tr_b16 v[234:235], v7 offset:27136
    v_mfma_f32_16x16x32_bf16 v[28:31], v[200:203], v[168:171], v[28:31]
    ds_read_b64_tr_b16 v[236:237], v7 offset:38912
    v_mfma_f32_16x16x32_bf16 v[28:31], v[204:207], v[172:175], v[28:31]
    ds_read_b64_tr_b16 v[238:239], v7 offset:39424
    v_mfma_f32_16x16x32_bf16 v[36:39], v[204:207], v[180:183], v[36:39]
    v_mfma_f32_16x16x32_bf16 v[36:39], v[200:203], v[176:179], v[36:39]
    v_mfma_f32_16x16x32_bf16 v[44:47], v[200:203], v[184:187], v[44:47]
    v_mfma_f32_16x16x32_bf16 v[44:47], v[204:207], v[188:191], v[44:47]
    s_waitcnt lgkmcnt(7)
    v_mfma_f32_16x16x32_bf16 v[116:119], v[196:199], v[228:231], v[116:119]
    v_mfma_f32_16x16x32_bf16 v[116:119], v[192:195], v[224:227], v[116:119]
    v_mfma_f32_16x16x32_bf16 v[104:107], v[184:187], v[224:227], v[104:107]
    v_mfma_f32_16x16x32_bf16 v[104:107], v[188:191], v[228:231], v[104:107]
    v_mfma_f32_16x16x32_bf16 v[96:99], v[180:183], v[228:231], v[96:99]
    s_waitcnt lgkmcnt(0)
    s_barrier
    v_mfma_f32_16x16x32_bf16 v[96:99], v[176:179], v[224:227], v[96:99]
    ds_read_b64_tr_b16 v[200:201], v6 offset:50176
    v_mfma_f32_16x16x32_bf16 v[88:91], v[168:171], v[224:227], v[88:91]
    ds_read_b64_tr_b16 v[202:203], v6 offset:50688
    v_mfma_f32_16x16x32_bf16 v[88:91], v[172:175], v[228:231], v[88:91]
    ds_read_b64_tr_b16 v[204:205], v6 offset:62464
    v_mfma_f32_16x16x32_bf16 v[80:83], v[164:167], v[228:231], v[80:83]
    ds_read_b64_tr_b16 v[206:207], v6 offset:62976
    v_mfma_f32_16x16x32_bf16 v[80:83], v[160:163], v[224:227], v[80:83]
    v_mfma_f32_16x16x32_bf16 v[84:87], v[160:163], v[232:235], v[84:87]
    ds_read_b64_tr_b16 v[224:225], v7 offset:50176
    v_mfma_f32_16x16x32_bf16 v[84:87], v[164:167], v[236:239], v[84:87]
    ds_read_b64_tr_b16 v[226:227], v7 offset:50688
    v_mfma_f32_16x16x32_bf16 v[92:95], v[172:175], v[236:239], v[92:95]
    ds_read_b64_tr_b16 v[228:229], v7 offset:62464
    v_mfma_f32_16x16x32_bf16 v[92:95], v[168:171], v[232:235], v[92:95]
    ds_read_b64_tr_b16 v[230:231], v7 offset:62976
    v_mfma_f32_16x16x32_bf16 v[100:103], v[176:179], v[232:235], v[100:103]
    v_mfma_f32_16x16x32_bf16 v[100:103], v[180:183], v[236:239], v[100:103]
    v_mfma_f32_16x16x32_bf16 v[108:111], v[188:191], v[236:239], v[108:111]
    v_mfma_f32_16x16x32_bf16 v[108:111], v[184:187], v[232:235], v[108:111]
    s_waitcnt lgkmcnt(4)
    v_mfma_f32_16x16x32_bf16 v[112:115], v[200:203], v[152:155], v[112:115]
    ds_read_b64_tr_b16 v[232:233], v6 offset:49152
    v_mfma_f32_16x16x32_bf16 v[112:115], v[204:207], v[156:159], v[112:115]
    ds_read_b64_tr_b16 v[234:235], v6 offset:49664
    v_mfma_f32_16x16x32_bf16 v[72:75], v[204:207], v[148:151], v[72:75]
    ds_read_b64_tr_b16 v[236:237], v6 offset:61440
    v_mfma_f32_16x16x32_bf16 v[72:75], v[200:203], v[144:147], v[72:75]
    ds_read_b64_tr_b16 v[238:239], v6 offset:61952
    v_mfma_f32_16x16x32_bf16 v[64:67], v[200:203], v[136:139], v[64:67]
    v_mfma_f32_16x16x32_bf16 v[64:67], v[204:207], v[140:143], v[64:67]
    v_mfma_f32_16x16x32_bf16 v[56:59], v[204:207], v[132:135], v[56:59]
    v_mfma_f32_16x16x32_bf16 v[56:59], v[200:203], v[128:131], v[56:59]
    v_mfma_f32_16x16x32_bf16 v[48:51], v[200:203], v[120:123], v[48:51]
    v_mfma_f32_16x16x32_bf16 v[48:51], v[204:207], v[124:127], v[48:51]
    s_waitcnt lgkmcnt(4)
    v_mfma_f32_16x16x32_bf16 v[52:55], v[228:231], v[124:127], v[52:55]
    ds_read_b64_tr_b16 v[200:201], v7 offset:49152
    v_mfma_f32_16x16x32_bf16 v[52:55], v[224:227], v[120:123], v[52:55]
    ds_read_b64_tr_b16 v[202:203], v7 offset:49664
    v_mfma_f32_16x16x32_bf16 v[60:63], v[224:227], v[128:131], v[60:63]
    ds_read_b64_tr_b16 v[204:205], v7 offset:61440
    v_mfma_f32_16x16x32_bf16 v[60:63], v[228:231], v[132:135], v[60:63]
    ds_read_b64_tr_b16 v[206:207], v7 offset:61952
    v_mfma_f32_16x16x32_bf16 v[68:71], v[228:231], v[140:143], v[68:71]
    v_mfma_f32_16x16x32_bf16 v[68:71], v[224:227], v[136:139], v[68:71]
    v_mfma_f32_16x16x32_bf16 v[76:79], v[224:227], v[144:147], v[76:79]
    v_mfma_f32_16x16x32_bf16 v[76:79], v[228:231], v[148:151], v[76:79]
    s_waitcnt lgkmcnt(4)
    v_mfma_f32_16x16x32_bf16 v[40:43], v[236:239], v[148:151], v[40:43]
    ds_read_b64_tr_b16 v[224:225], v6 offset:51200
    ds_read_b64_tr_b16 v[226:227], v6 offset:51712
    v_mfma_f32_16x16x32_bf16 v[40:43], v[232:235], v[144:147], v[40:43]
    ds_read_b64_tr_b16 v[228:229], v6 offset:63488
    ds_read_b64_tr_b16 v[230:231], v6 offset:64000
    v_mfma_f32_16x16x32_bf16 v[32:35], v[232:235], v[136:139], v[32:35]
    ds_read_b128 v[192:195], v2 offset:0
    ds_read_b128 v[196:199], v3 offset:0
    v_mfma_f32_16x16x32_bf16 v[32:35], v[236:239], v[140:143], v[32:35]
    ds_read_b128 v[184:187], v4 offset:6144
    ds_read_b128 v[188:191], v5 offset:6144
    v_mfma_f32_16x16x32_bf16 v[24:27], v[236:239], v[132:135], v[24:27]
    v_mfma_f32_16x16x32_bf16 v[24:27], v[232:235], v[128:131], v[24:27]
    v_mfma_f32_16x16x32_bf16 v[16:19], v[232:235], v[120:123], v[16:19]
    v_mfma_f32_16x16x32_bf16 v[16:19], v[236:239], v[124:127], v[16:19]
    s_waitcnt lgkmcnt(8)
    v_mfma_f32_16x16x32_bf16 v[20:23], v[204:207], v[124:127], v[20:23]
    ds_read_b64_tr_b16 v[232:233], v7 offset:51200
    v_mfma_f32_16x16x32_bf16 v[20:23], v[200:203], v[120:123], v[20:23]
    ds_read_b64_tr_b16 v[234:235], v7 offset:51712
    v_mfma_f32_16x16x32_bf16 v[28:31], v[200:203], v[128:131], v[28:31]
    ds_read_b64_tr_b16 v[236:237], v7 offset:63488
    v_mfma_f32_16x16x32_bf16 v[28:31], v[204:207], v[132:135], v[28:31]
    ds_read_b64_tr_b16 v[238:239], v7 offset:64000
    v_mfma_f32_16x16x32_bf16 v[36:39], v[204:207], v[140:143], v[36:39]
    ds_read_b128 v[176:179], v4 offset:4096
    v_mfma_f32_16x16x32_bf16 v[36:39], v[200:203], v[136:139], v[36:39]
    ds_read_b128 v[180:183], v5 offset:4096
    v_mfma_f32_16x16x32_bf16 v[44:47], v[200:203], v[144:147], v[44:47]
    ds_read_b128 v[168:171], v4 offset:2048
    v_mfma_f32_16x16x32_bf16 v[44:47], v[204:207], v[148:151], v[44:47]
    s_waitcnt lgkmcnt(11)
    v_mfma_f32_16x16x32_bf16 v[116:119], v[156:159], v[228:231], v[116:119]
    ds_read_b64_tr_b16 v[200:201], v6 offset:1024
    v_mfma_f32_16x16x32_bf16 v[116:119], v[152:155], v[224:227], v[116:119]
    ds_read_b64_tr_b16 v[202:203], v6 offset:1536
    v_mfma_f32_16x16x32_bf16 v[104:107], v[144:147], v[224:227], v[104:107]
    ds_read_b64_tr_b16 v[204:205], v6 offset:13312
    v_mfma_f32_16x16x32_bf16 v[104:107], v[148:151], v[228:231], v[104:107]
    ds_read_b64_tr_b16 v[206:207], v6 offset:13824
    v_mfma_f32_16x16x32_bf16 v[96:99], v[140:143], v[228:231], v[96:99]
    ds_read_b128 v[172:175], v5 offset:2048
    v_mfma_f32_16x16x32_bf16 v[96:99], v[136:139], v[224:227], v[96:99]
    ds_read_b128 v[160:163], v4 offset:0
    v_mfma_f32_16x16x32_bf16 v[88:91], v[128:131], v[224:227], v[88:91]
    ds_read_b128 v[164:167], v5 offset:0
    v_mfma_f32_16x16x32_bf16 v[88:91], v[132:135], v[228:231], v[88:91]
    v_mfma_f32_16x16x32_bf16 v[80:83], v[124:127], v[228:231], v[80:83]
    v_mfma_f32_16x16x32_bf16 v[80:83], v[120:123], v[224:227], v[80:83]
    s_waitcnt lgkmcnt(10)
    v_mfma_f32_16x16x32_bf16 v[84:87], v[120:123], v[232:235], v[84:87]
    ds_read_b64_tr_b16 v[224:225], v7 offset:1024
    v_mfma_f32_16x16x32_bf16 v[84:87], v[124:127], v[236:239], v[84:87]
    ds_read_b64_tr_b16 v[226:227], v7 offset:1536
    v_mfma_f32_16x16x32_bf16 v[92:95], v[132:135], v[236:239], v[92:95]
    ds_read_b64_tr_b16 v[228:229], v7 offset:13312
    v_mfma_f32_16x16x32_bf16 v[92:95], v[128:131], v[232:235], v[92:95]
    ds_read_b64_tr_b16 v[230:231], v7 offset:13824
    v_mfma_f32_16x16x32_bf16 v[100:103], v[136:139], v[232:235], v[100:103]
    v_mfma_f32_16x16x32_bf16 v[100:103], v[140:143], v[236:239], v[100:103]
    v_mfma_f32_16x16x32_bf16 v[108:111], v[148:151], v[236:239], v[108:111]
    v_mfma_f32_16x16x32_bf16 v[108:111], v[144:147], v[232:235], v[108:111]
    s_waitcnt lgkmcnt(9)
    v_mfma_f32_16x16x32_bf16 v[112:115], v[200:203], v[192:195], v[112:115]
    ds_read_b64_tr_b16 v[120:121], v6 offset:0
    ds_read_b64_tr_b16 v[122:123], v6 offset:512
    s_waitcnt lgkmcnt(9)
    v_mfma_f32_16x16x32_bf16 v[112:115], v[204:207], v[196:199], v[112:115]
    ds_read_b64_tr_b16 v[124:125], v6 offset:12288
    ds_read_b64_tr_b16 v[126:127], v6 offset:12800
    v_mfma_f32_16x16x32_bf16 v[72:75], v[204:207], v[188:191], v[72:75]
    ds_read_b64_tr_b16 v[128:129], v7 offset:0
    ds_read_b64_tr_b16 v[130:131], v7 offset:512
    v_mfma_f32_16x16x32_bf16 v[72:75], v[200:203], v[184:187], v[72:75]
    ds_read_b64_tr_b16 v[132:133], v7 offset:12288
    ds_read_b64_tr_b16 v[134:135], v7 offset:12800
    v_mfma_f32_16x16x32_bf16 v[64:67], v[200:203], v[176:179], v[64:67]
    ds_read_b64_tr_b16 v[136:137], v6 offset:2048
    ds_read_b64_tr_b16 v[138:139], v6 offset:2560
    v_mfma_f32_16x16x32_bf16 v[64:67], v[204:207], v[180:183], v[64:67]
    ds_read_b64_tr_b16 v[140:141], v6 offset:14336
    ds_read_b64_tr_b16 v[142:143], v6 offset:14848
    s_waitcnt lgkmcnt(14)
    v_mfma_f32_16x16x32_bf16 v[56:59], v[204:207], v[172:175], v[56:59]
    ds_read_b64_tr_b16 v[144:145], v7 offset:2048
    ds_read_b64_tr_b16 v[146:147], v7 offset:2560
    v_mfma_f32_16x16x32_bf16 v[56:59], v[200:203], v[168:171], v[56:59]
    ds_read_b64_tr_b16 v[148:149], v7 offset:14336
    ds_read_b64_tr_b16 v[150:151], v7 offset:14848
    v_mfma_f32_16x16x32_bf16 v[48:51], v[200:203], v[160:163], v[48:51]
    v_cvt_pk_bf16_f32 v72, v72, v73
    v_cvt_pk_bf16_f32 v73, v74, v75
    v_mfma_f32_16x16x32_bf16 v[48:51], v[204:207], v[164:167], v[48:51]
    v_cvt_pk_bf16_f32 v64, v64, v65
    v_cvt_pk_bf16_f32 v65, v66, v67
    s_waitcnt lgkmcnt(14)
    v_mfma_f32_16x16x32_bf16 v[76:79], v[228:231], v[188:191], v[76:79]
    v_cvt_pk_bf16_f32 v56, v56, v57
    v_cvt_pk_bf16_f32 v57, v58, v59
    v_mfma_f32_16x16x32_bf16 v[76:79], v[224:227], v[184:187], v[76:79]
    v_cvt_pk_bf16_f32 v200, v112, v113
    v_cvt_pk_bf16_f32 v201, v114, v115
    v_mfma_f32_16x16x32_bf16 v[68:71], v[224:227], v[176:179], v[68:71]
    ds_write_b64 v216, v[200:201]
    ds_write_b64 v217, v[72:73]
    v_mfma_f32_16x16x32_bf16 v[68:71], v[228:231], v[180:183], v[68:71]
    v_cvt_pk_bf16_f32 v48, v48, v49
    v_cvt_pk_bf16_f32 v49, v50, v51
    v_mfma_f32_16x16x32_bf16 v[60:63], v[228:231], v[172:175], v[60:63]
    v_cvt_pk_bf16_f32 v74, v76, v77
    v_cvt_pk_bf16_f32 v75, v78, v79
    v_mfma_f32_16x16x32_bf16 v[60:63], v[224:227], v[168:171], v[60:63]
    ds_write_b64 v217, v[74:75] offset:512
    s_mov_b64 exec, 1
    ds_add_u32 v10, v11 offset:0
    s_mov_b64 exec, -1
    v_mfma_f32_16x16x32_bf16 v[52:55], v[224:227], v[160:163], v[52:55]
    v_cvt_pk_bf16_f32 v66, v68, v69
    v_cvt_pk_bf16_f32 v67, v70, v71
    v_mfma_f32_16x16x32_bf16 v[52:55], v[228:231], v[164:167], v[52:55]
    v_cvt_pk_bf16_f32 v58, v60, v61
    v_cvt_pk_bf16_f32 v59, v62, v63
    s_waitcnt lgkmcnt(14)
    v_mfma_f32_16x16x32_bf16 v[40:43], v[124:127], v[188:191], v[40:43]
    s_nop 1
    v_mfma_f32_16x16x32_bf16 v[40:43], v[120:123], v[184:187], v[40:43]
    s_nop 1
    v_mfma_f32_16x16x32_bf16 v[32:35], v[120:123], v[176:179], v[32:35]
    v_cvt_pk_bf16_f32 v50, v52, v53
    v_cvt_pk_bf16_f32 v51, v54, v55
    v_mfma_f32_16x16x32_bf16 v[32:35], v[124:127], v[180:183], v[32:35]
    s_nop 1
    v_mfma_f32_16x16x32_bf16 v[24:27], v[124:127], v[172:175], v[24:27]
    v_cvt_pk_bf16_f32 v40, v40, v41
    v_cvt_pk_bf16_f32 v41, v42, v43
    v_mfma_f32_16x16x32_bf16 v[24:27], v[120:123], v[168:171], v[24:27]
    s_nop 1
    v_mfma_f32_16x16x32_bf16 v[16:19], v[120:123], v[160:163], v[16:19]
    v_cvt_pk_bf16_f32 v32, v32, v33
    v_cvt_pk_bf16_f32 v33, v34, v35
    v_mfma_f32_16x16x32_bf16 v[16:19], v[124:127], v[164:167], v[16:19]
    s_nop 1
    s_waitcnt lgkmcnt(12)
    v_mfma_f32_16x16x32_bf16 v[44:47], v[132:135], v[188:191], v[44:47]
    v_cvt_pk_bf16_f32 v24, v24, v25
    v_cvt_pk_bf16_f32 v25, v26, v27
    v_mfma_f32_16x16x32_bf16 v[44:47], v[128:131], v[184:187], v[44:47]
    s_nop 1
    v_mfma_f32_16x16x32_bf16 v[36:39], v[128:131], v[176:179], v[36:39]
    v_cvt_pk_bf16_f32 v16, v16, v17
    v_cvt_pk_bf16_f32 v17, v18, v19
    v_mfma_f32_16x16x32_bf16 v[36:39], v[132:135], v[180:183], v[36:39]
    s_nop 1
    v_mfma_f32_16x16x32_bf16 v[28:31], v[132:135], v[172:175], v[28:31]
    v_cvt_pk_bf16_f32 v42, v44, v45
    v_cvt_pk_bf16_f32 v43, v46, v47
    v_mfma_f32_16x16x32_bf16 v[28:31], v[128:131], v[168:171], v[28:31]
    ds_read_b32 v223, v10 offset:0
    ds_read_b64 v[204:205], v218
    v_mfma_f32_16x16x32_bf16 v[20:23], v[128:131], v[160:163], v[20:23]
    ds_read_b64 v[206:207], v219
    v_cvt_pk_bf16_f32 v34, v36, v37
    v_mfma_f32_16x16x32_bf16 v[20:23], v[132:135], v[164:167], v[20:23]
    v_cvt_pk_bf16_f32 v35, v38, v39
    s_nop 0
    s_waitcnt lgkmcnt(11)
    v_mfma_f32_16x16x32_bf16 v[116:119], v[196:199], v[140:143], v[116:119]
    v_cvt_pk_bf16_f32 v26, v28, v29
    v_cvt_pk_bf16_f32 v27, v30, v31
    v_mfma_f32_16x16x32_bf16 v[116:119], v[192:195], v[136:139], v[116:119]
    s_nop 1
    v_mfma_f32_16x16x32_bf16 v[104:107], v[184:187], v[136:139], v[104:107]
    v_cvt_pk_bf16_f32 v18, v20, v21
    v_cvt_pk_bf16_f32 v19, v22, v23
    v_mfma_f32_16x16x32_bf16 v[104:107], v[188:191], v[140:143], v[104:107]
    s_nop 1
    v_mfma_f32_16x16x32_bf16 v[44:47], v[72:75], v[40:43], 0
    v_cvt_pk_bf16_f32 v202, v116, v117
    v_cvt_pk_bf16_f32 v203, v118, v119
    v_mfma_f32_16x16x32_bf16 v[76:79], v[64:67], v[40:43], 0
    s_nop 1
    v_mfma_f32_16x16x32_bf16 v[36:39], v[64:67], v[32:35], 0
    v_cvt_pk_bf16_f32 v232, v104, v105
    v_cvt_pk_bf16_f32 v233, v106, v107
    v_mfma_f32_16x16x32_bf16 v[68:71], v[56:59], v[32:35], 0
    ds_write_b64 v216, v[202:203] offset:1024
    ds_write_b64 v217, v[232:233] offset:1024
    v_mfma_f32_16x16x32_bf16 v[96:99], v[180:183], v[140:143], v[96:99]
    s_waitcnt lgkmcnt(4)
    v_cmp_gt_u32 vcc, 4, v223
    s_cbranch_vccnz LB_w1
LB_g1:
    v_mfma_f32_16x16x32_bf16 v[96:99], v[176:179], v[136:139], v[96:99]
    v_cndmask_b32 v124, v44, v45, s[88:89]
    v_cndmask_b32 v125, v76, v77, s[88:89]
    v_mfma_f32_16x16x32_bf16 v[28:31], v[56:59], v[24:27], 0
    v_cndmask_b32 v158, v125, v124, s[90:91]
    v_cndmask_b32 v126, v46, v47, s[88:89]
    v_mfma_f32_16x16x32_bf16 v[60:63], v[48:51], v[24:27], 0
    v_cndmask_b32 v127, v78, v79, s[88:89]
    v_cndmask_b32 v159, v127, v126, s[92:93]
    v_mfma_f32_16x16x32_bf16 v[20:23], v[48:51], v[16:19], 0
    v_max_f32 v123, v158, v159
    v_cndmask_b32 v124, v36, v37, s[88:89]
    v_mfma_f32_16x16x32_bf16 v[88:91], v[168:171], v[136:139], v[88:91]
    v_cndmask_b32 v125, v68, v69, s[88:89]
    v_cndmask_b32 v156, v125, v124, s[90:91]
    v_mfma_f32_16x16x32_bf16 v[88:91], v[172:175], v[140:143], v[88:91]
    v_cndmask_b32 v126, v38, v39, s[88:89]
    v_cndmask_b32 v127, v70, v71, s[88:89]
    s_waitcnt lgkmcnt(2)
    v_mfma_f32_16x16x32_bf16 v[52:55], v[204:207], v[16:19], v[212:215]
    v_cndmask_b32 v157, v127, v126, s[92:93]
    v_max_f32 v122, v156, v157
    v_mfma_f32_16x16x32_bf16 v[80:83], v[164:167], v[140:143], v[80:83]
    v_cndmask_b32 v124, v28, v29, s[88:89]
    v_cndmask_b32 v125, v60, v61, s[88:89]
    v_mfma_f32_16x16x32_bf16 v[80:83], v[160:163], v[136:139], v[80:83]
    v_cndmask_b32 v154, v125, v124, s[90:91]
    v_cndmask_b32 v126, v30, v31, s[88:89]
    v_mfma_f32_16x16x32_bf16 v[108:111], v[184:187], v[144:147], v[108:111]
    v_cndmask_b32 v127, v62, v63, s[88:89]
    v_cndmask_b32 v155, v127, v126, s[92:93]
    v_mfma_f32_16x16x32_bf16 v[108:111], v[188:191], v[148:151], v[108:111]
    v_max_f32 v121, v154, v155
    s_nop 0
    v_mfma_f32_16x16x32_bf16 v[100:103], v[180:183], v[148:151], v[100:103]
    s_nop 1
    v_mfma_f32_16x16x32_bf16 v[100:103], v[176:179], v[144:147], v[100:103]
    s_nop 1
    v_mfma_f32_16x16x32_bf16 v[92:95], v[168:171], v[144:147], v[92:95]
    v_cvt_pk_bf16_f32 v242, v108, v109
    v_cvt_pk_bf16_f32 v243, v110, v111
    v_mfma_f32_16x16x32_bf16 v[92:95], v[172:175], v[148:151], v[92:95]
    ds_write_b64 v217, v[242:243] offset:1536
    s_mov_b64 exec, 1
    ds_add_u32 v10, v11 offset:24
    s_mov_b64 exec, -1
    v_mfma_f32_16x16x32_bf16 v[84:87], v[164:167], v[148:151], v[84:87]
    v_cndmask_b32 v124, v20, v21, s[88:89]
    v_cndmask_b32 v125, v52, v53, s[88:89]
    v_mfma_f32_16x16x32_bf16 v[84:87], v[160:163], v[144:147], v[84:87]
    v_cndmask_b32 v152, v125, v124, s[90:91]
    v_cndmask_b32 v126, v22, v23, s[88:89]
    v_cndmask_b32 v127, v54, v55, s[88:89]
    v_cndmask_b32 v153, v127, v126, s[92:93]
    v_max_f32 v120, v152, v153
    s_mov_b32 s80, 0x3e8293ee
    s_add_u32 m0, s34, 36864
    s_add_u32 s35, s44, 0
    buffer_load_dwordx4 v245, s[64:67], s35 offen  lds
    v_cvt_pk_bf16_f32 v230, v96, v97
    v_permlane32_swap_b32 v122, v123
    v_permlane32_swap_b32 v120, v121
    v_max_f32 v122, v122, v123
    v_max_f32 v120, v120, v121
    v_cvt_pk_bf16_f32 v231, v98, v99
    v_cvt_pk_bf16_f32 v240, v100, v101
    v_permlane16_swap_b32 v120, v122
    v_max_f32 v120, v120, v122
    v_mul_f32 v120, s80, v120
    v_mov_b32 v122, v120
    v_cvt_pk_bf16_f32 v241, v102, v103
    v_cvt_pk_bf16_f32 v228, v88, v89
    v_permlane16_swap_b32 v120, v122
    v_mov_b32 v121, v120
    v_mov_b32 v123, v122
    s_add_u32 m0, s34, 40960
    s_add_u32 s35, s44, 65536
    buffer_load_dwordx4 v245, s[64:67], s35 offen  lds
    v_cvt_pk_bf16_f32 v229, v90, v91
    v_permlane32_swap_b32 v120, v121
    v_permlane32_swap_b32 v122, v123
    v_fma_f32 v152, v152, s80, -v120
    v_fma_f32 v153, v153, s80, -v120
    v_fma_f32 v154, v154, s80, -v121
    v_fma_f32 v155, v155, s80, -v121
    v_fma_f32 v156, v156, s80, -v122
    v_fma_f32 v157, v157, s80, -v122
    v_fma_f32 v158, v158, s80, -v123
    v_fma_f32 v159, v159, s80, -v123
    ds_read_b32 v223, v10 offset:24
    ds_read_b64 v[224:225], v218 offset:1024
    ds_read_b64 v[234:235], v219 offset:1024
    v_exp_f32 v152, v152
    v_exp_f32 v153, v153
    v_exp_f32 v154, v154
    s_add_u32 m0, s34, 45056
    s_add_u32 s35, s44, 131072
    buffer_load_dwordx4 v245, s[64:67], s35 offen  lds
    v_exp_f32 v155, v155
    v_exp_f32 v156, v156
    v_exp_f32 v157, v157
    v_exp_f32 v158, v158
    v_exp_f32 v159, v159
    v_add_f32 v120, v152, v153
    v_add_f32 v121, v154, v155
    v_add_f32 v122, v156, v157
    v_add_f32 v123, v158, v159
    v_cvt_pk_bf16_f32 v238, v92, v93
    s_nop 0
    v_permlane32_swap_b32 v122, v123
    v_permlane32_swap_b32 v120, v121
    v_add_f32 v122, v122, v123
    v_add_f32 v120, v120, v121
    v_cvt_pk_bf16_f32 v239, v94, v95
    v_cvt_pk_bf16_f32 v226, v80, v81
    s_add_u32 m0, s34, 110592
    s_add_u32 s35, s44, 196608
    buffer_load_dwordx4 v245, s[64:67], s35 offen  lds
    v_permlane16_swap_b32 v120, v122
    v_add_f32 v120, v120, v122
    v_rcp_f32 v120, v120
    s_nop 0
    v_mov_b32 v122, v120
    v_cvt_pk_bf16_f32 v227, v82, v83
    v_cvt_pk_bf16_f32 v236, v84, v85
    v_permlane16_swap_b32 v120, v122
    v_mov_b32 v121, v120
    v_mov_b32 v123, v122
    v_cvt_pk_bf16_f32 v237, v86, v87
    v_permlane32_swap_b32 v120, v121
    v_permlane32_swap_b32 v122, v123
    s_waitcnt lgkmcnt(2)
    v_cmp_gt_u32 vcc, 4, v223
    s_cbranch_vccnz LB_w6
LB_g6:
    v_mul_f32 v152, v152, v120
    v_mul_f32 v153, v153, v120
    v_cvt_pk_bf16_f32 v152, v152, v153
    v_perm_b32 v160, v152, v152, v208
    s_add_u32 m0, s34, 114688
    s_add_u32 s35, s45, 0
    buffer_load_dwordx4 v245, s[64:67], s35 offen  lds
    v_perm_b32 v161, v152, v152, v209
    v_perm_b32 v162, v152, v152, v210
    v_perm_b32 v163, v152, v152, v211
    v_mul_f32 v154, v154, v121
    v_mul_f32 v155, v155, v121
    v_cvt_pk_bf16_f32 v154, v154, v155
    v_perm_b32 v164, v154, v154, v208
    v_perm_b32 v165, v154, v154, v209
    v_perm_b32 v166, v154, v154, v210
    v_perm_b32 v167, v154, v154, v211
    s_waitcnt lgkmcnt(1)
    v_mfma_f32_16x16x32_bf16 v[16:19], v[224:227], v[160:163], 0
    s_waitcnt lgkmcnt(0)
    v_mfma_f32_16x16x32_bf16 v[20:23], v[234:237], v[160:163], 0
    v_mul_f32 v156, v156, v122
    v_mul_f32 v157, v157, v122
    v_cvt_pk_bf16_f32 v156, v156, v157
    v_perm_b32 v168, v156, v156, v208
    s_add_u32 m0, s34, 118784
    s_add_u32 s35, s45, 65536
    buffer_load_dwordx4 v245, s[64:67], s35 offen  lds
    v_perm_b32 v169, v156, v156, v209
    v_perm_b32 v170, v156, v156, v210
    v_perm_b32 v171, v156, v156, v211
    v_mfma_f32_16x16x32_bf16 v[24:27], v[226:229], v[164:167], 0
    v_mfma_f32_16x16x32_bf16 v[28:31], v[236:239], v[164:167], 0
    v_mul_f32 v158, v158, v123
    v_mul_f32 v159, v159, v123
    v_cvt_pk_bf16_f32 v158, v158, v159
    v_perm_b32 v172, v158, v158, v208
    v_perm_b32 v173, v158, v158, v209
    v_perm_b32 v174, v158, v158, v210
    v_perm_b32 v175, v158, v158, v211
    v_mfma_f32_16x16x32_bf16 v[32:35], v[228:231], v[168:171], 0
    v_mfma_f32_16x16x32_bf16 v[36:39], v[238:241], v[168:171], 0
    v_mfma_f32_16x16x32_bf16 v[40:43], v[230:233], v[172:175], 0
    v_mfma_f32_16x16x32_bf16 v[44:47], v[240:243], v[172:175], 0
    v_cvt_pk_bf16_f32 v80, v16, v17
    v_cvt_pk_bf16_f32 v81, v18, v19
    v_cvt_pk_bf16_f32 v82, v20, v21
    v_cvt_pk_bf16_f32 v83, v22, v23
    s_add_u32 s95, s94, 0
    buffer_store_dwordx4 v[80:83], v252, s[52:55], s95 offen sc1
    v_cvt_pk_bf16_f32 v84, v24, v25
    v_cvt_pk_bf16_f32 v85, v26, v27
    v_cvt_pk_bf16_f32 v86, v28, v29
    v_cvt_pk_bf16_f32 v87, v30, v31
    s_add_u32 s95, s94, 32768
    buffer_store_dwordx4 v[84:87], v252, s[52:55], s95 offen sc1
    v_cvt_pk_bf16_f32 v88, v32, v33
    v_cvt_pk_bf16_f32 v89, v34, v35
    v_cvt_pk_bf16_f32 v90, v36, v37
    v_cvt_pk_bf16_f32 v91, v38, v39
    s_add_u32 s95, s94, 65536
    buffer_store_dwordx4 v[88:91], v252, s[52:55], s95 offen sc1
    v_cvt_pk_bf16_f32 v92, v40, v41
    v_cvt_pk_bf16_f32 v93, v42, v43
    v_cvt_pk_bf16_f32 v94, v44, v45
    v_cvt_pk_bf16_f32 v95, v46, v47
    s_add_u32 s95, s94, 98304
    buffer_store_dwordx4 v[92:95], v252, s[52:55], s95 offen sc1
    s_add_u32 m0, s34, 122880
    s_add_u32 s35, s45, 131072
    buffer_load_dwordx4 v245, s[64:67], s35 offen  lds
    v_xor_b32 v2, 0, v244
    v_xor_b32 v3, 32, v244
    v_xor_b32 v4, 64, v244
    v_xor_b32 v5, 96, v244
    s_add_u32 m0, s34, 49152
    s_add_u32 s35, s45, 196608
    buffer_load_dwordx4 v245, s[64:67], s35 offen  lds
    v_xor_b32 v6, 2048, v244
    v_xor_b32 v7, 2080, v244
    v_xor_b32 v8, 2112, v244
    v_xor_b32 v9, 2144, v244
    s_waitcnt vmcnt(6)
    s_mov_b64 exec, 1
    ds_add_u32 v10, v11 offset:8
    s_mov_b64 exec, -1
    s_add_u32 m0, s34, 53248
    s_add_u32 s35, s46, 0
    buffer_load_dwordx4 v245, s[64:67], s35 offen  lds
    v_add_u32 v224, 65536, v2
    v_add_u32 v225, 65536, v3
    v_add_u32 v226, 65536, v4
    v_add_u32 v227, 65536, v5
    v_add_u32 v228, 65536, v6
    v_add_u32 v229, 65536, v7
    s_add_u32 m0, s34, 57344
    s_add_u32 s35, s46, 65536
    buffer_load_dwordx4 v245, s[64:67], s35 offen  lds
    v_add_u32 v230, 65536, v8
    v_add_u32 v231, 65536, v9
    v_add_u32 v15, 32768, v252
    v_add_u32 v232, 129024, v2
    v_add_u32 v233, 129024, v3
    v_add_u32 v234, 129024, v4
    s_add_u32 m0, s34, 61440
    s_add_u32 s35, s46, 131072
    buffer_load_dwordx4 v245, s[64:67], s35 offen  lds
    v_add_u32 v235, 129024, v5
    v_add_u32 v236, 129024, v6
    v_add_u32 v237, 129024, v7
    v_add_u32 v238, 129024, v8
    v_add_u32 v239, 129024, v9
    s_waitcnt vmcnt(5)
    s_mov_b64 exec, 1
    buffer_store_dword v11, v220, s[52:55], s97 offen sc1
    s_mov_b64 exec, -1
    s_branch LB_s2_in
LB_s2:
    s_sleep 1
LB_s2_in:
    ds_read_b32 v14, v10 offset:8
    s_waitcnt lgkmcnt(0)
    v_readfirstlane_b32 s78, v14
    s_nop 0
    s_cmp_ge_u32 s78, 8
    s_cbranch_scc0 LB_s2
    s_add_u32 m0, s34, 65536
    s_add_u32 s35, s46, 196608
    buffer_load_dwordx4 v245, s[64:67], s35 offen  lds
    ds_read_b64_tr_b16 v[48:49], v2 offset:36864
    ds_read_b64_tr_b16 v[50:51], v6 offset:36864
    s_add_u32 m0, s34, 69632
    s_add_u32 s35, s47, 0
    buffer_load_dwordx4 v245, s[64:67], s35 offen  lds
    ds_read_b64_tr_b16 v[52:53], v2 offset:40960
    s_add_u32 m0, s34, 0
    s_add_u32 s35, s47, 65536
    buffer_load_dwordx4 v245, s[64:67], s35 offen  lds
    ds_read_b64_tr_b16 v[54:55], v6 offset:40960
    s_add_u32 m0, s34, 4096
    s_add_u32 s35, s47, 131072
    buffer_load_dwordx4 v245, s[64:67], s35 offen  lds
    ds_read_b64_tr_b16 v[56:57], v2 offset:45056
    s_add_u32 m0, s34, 8192
    s_add_u32 s35, s47, 196608
    buffer_load_dwordx4 v245, s[64:67], s35 offen  lds
    ds_read_b64_tr_b16 v[58:59], v6 offset:45056
    s_add_u32 m0, s34, 12288
    s_add_u32 s35, s48, 0
    buffer_load_dwordx4 v245, s[64:67], s35 offen  lds
    ds_read_b64_tr_b16 v[60:61], v224 offset:45056
    s_add_u32 m0, s34, 16384
    s_add_u32 s35, s48, 65536
    buffer_load_dwordx4 v245, s[64:67], s35 offen  lds
    ds_read_b64_tr_b16 v[62:63], v228 offset:45056
    s_add_u32 m0, s34, 20480
    s_add_u32 s35, s48, 131072
    buffer_load_dwordx4 v245, s[64:67], s35 offen  lds
    ds_read_b64_tr_b16 v[64:65], v3 offset:36864
    s_add_u32 m0, s34, 73728
    s_add_u32 s35, s48, 196608
    buffer_load_dwordx4 v245, s[64:67], s35 offen  lds
    ds_read_b64_tr_b16 v[66:67], v7 offset:36864
    s_add_u32 m0, s34, 77824
    s_add_u32 s35, s49, 0
    buffer_load_dwordx4 v245, s[64:67], s35 offen  lds
    ds_read_b64_tr_b16 v[68:69], v3 offset:40960
    s_add_u32 m0, s34, 81920
    s_add_u32 s35, s49, 65536
    buffer_load_dwordx4 v245, s[64:67], s35 offen  lds
    ds_read_b64_tr_b16 v[70:71], v7 offset:40960
    s_add_u32 m0, s34, 86016
    s_add_u32 s35, s49, 131072
    buffer_load_dwordx4 v245, s[64:67], s35 offen  lds
    ds_read_b64_tr_b16 v[72:73], v3 offset:45056
    s_add_u32 m0, s34, 24576
    s_add_u32 s35, s49, 196608
    buffer_load_dwordx4 v245, s[64:67], s35 offen  lds
    ds_read_b64_tr_b16 v[74:75], v7 offset:45056
    s_add_u32 m0, s34, 28672
    s_add_u32 s35, s50, 0
    buffer_load_dwordx4 v245, s[64:67], s35 offen  lds
    ds_read_b64_tr_b16 v[76:77], v225 offset:45056
    s_add_u32 m0, s34, 32768
    s_add_u32 s35, s50, 65536
    buffer_load_dwordx4 v245, s[64:67], s35 offen  lds
    ds_read_b64_tr_b16 v[78:79], v229 offset:45056
    s_waitcnt vmcnt(0)
    s_mov_b64 exec, 1
    ds_add_u32 v10, v11 offset:16
    s_mov_b64 exec, -1
    s_mov_b64 exec, 0xffffffff
    s_mov_b32 s79, 0
LB_po:
    buffer_load_dword v14, v247, s[52:55], s30 offen sc1
    s_add_u32 s79, s79, 1
    s_cmp_gt_u32 s79, 200000
    s_cbranch_scc1 LB_po_x
    s_waitcnt vmcnt(0)
    v_cmp_ne_u32 vcc, 1, v14
    s_cbranch_vccz LB_po_x
    s_mov_b64 exec, vcc
    s_sleep 4
    s_branch LB_po
LB_po_x:
    s_waitcnt vmcnt(0)
    s_mov_b64 exec, -1
    ds_read_b32 v222, v10 offset:16
    buffer_load_dwordx4 v[96:99], v252, s[52:55], s36 offen offset:0 sc1
    buffer_load_dwordx4 v[100:103], v252, s[52:55], s36 offen offset:1024 sc1
    buffer_load_dwordx4 v[104:107], v252, s[52:55], s36 offen offset:2048 sc1
    buffer_load_dwordx4 v[108:111], v252, s[52:55], s36 offen offset:3072 sc1
    buffer_load_dwordx4 v[112:115], v15, s[52:55], s36 offen offset:0 sc1
    buffer_load_dwordx4 v[116:119], v15, s[52:55], s36 offen offset:1024 sc1
    buffer_load_dwordx4 v[120:123], v15, s[52:55], s36 offen offset:2048 sc1
    buffer_load_dwordx4 v[124:127], v15, s[52:55], s36 offen offset:3072 sc1
    buffer_load_dwordx4 v[128:131], v252, s[52:55], s37 offen offset:0 sc1
    buffer_load_dwordx4 v[132:135], v252, s[52:55], s37 offen offset:1024 sc1
    s_setprio 1
    s_waitcnt lgkmcnt(0)
    v_cmp_gt_u32 vcc, 4, v222
    s_cbranch_vccnz LB_w4
LB_g4:
    s_waitcnt vmcnt(9)
    v_mfma_f32_16x16x32_bf16 v[16:19], v[48:51], v[96:99], 0
    buffer_load_dwordx4 v[136:139], v252, s[52:55], s37 offen offset:2048 sc1
    buffer_load_dwordx4 v[140:143], v252, s[52:55], s37 offen offset:3072 sc1
    s_waitcnt vmcnt(10)
    v_mfma_f32_16x16x32_bf16 v[16:19], v[52:55], v[100:103], v[16:19]
    buffer_load_dwordx4 v[144:147], v15, s[52:55], s37 offen offset:0 sc1
    s_waitcnt vmcnt(10)
    v_mfma_f32_16x16x32_bf16 v[16:19], v[56:59], v[104:107], v[16:19]
    buffer_load_dwordx4 v[148:151], v15, s[52:55], s37 offen offset:1024 sc1
    ds_read_b64_tr_b16 v[80:81], v4 offset:36864
    s_waitcnt vmcnt(10)
    v_mfma_f32_16x16x32_bf16 v[16:19], v[60:63], v[108:111], v[16:19]
    ds_read_b64_tr_b16 v[82:83], v8 offset:36864
    s_waitcnt vmcnt(6)
    v_mfma_f32_16x16x32_bf16 v[32:35], v[60:63], v[124:127], 0
    ds_read_b64_tr_b16 v[84:85], v4 offset:40960
    ds_read_b64_tr_b16 v[86:87], v8 offset:40960
    v_mfma_f32_16x16x32_bf16 v[32:35], v[56:59], v[120:123], v[32:35]
    ds_read_b64_tr_b16 v[88:89], v4 offset:45056
    v_mfma_f32_16x16x32_bf16 v[32:35], v[52:55], v[116:119], v[32:35]
    ds_read_b64_tr_b16 v[90:91], v8 offset:45056
    ds_read_b64_tr_b16 v[92:93], v226 offset:45056
    v_mfma_f32_16x16x32_bf16 v[32:35], v[48:51], v[112:115], v[32:35]
    ds_read_b64_tr_b16 v[94:95], v230 offset:45056
    v_mfma_f32_16x16x32_bf16 v[36:39], v[64:67], v[112:115], 0
    buffer_load_dwordx4 v[152:155], v15, s[52:55], s37 offen offset:2048 sc1
    buffer_load_dwordx4 v[156:159], v15, s[52:55], s37 offen offset:3072 sc1
    v_mfma_f32_16x16x32_bf16 v[36:39], v[68:71], v[116:119], v[36:39]
    buffer_load_dwordx4 v[160:163], v252, s[52:55], s38 offen offset:0 sc1
    v_mfma_f32_16x16x32_bf16 v[36:39], v[72:75], v[120:123], v[36:39]
    buffer_load_dwordx4 v[164:167], v252, s[52:55], s38 offen offset:1024 sc1
    ds_read_b64_tr_b16 v[48:49], v5 offset:36864
    v_mfma_f32_16x16x32_bf16 v[36:39], v[76:79], v[124:127], v[36:39]
    ds_read_b64_tr_b16 v[50:51], v9 offset:36864
    v_mfma_f32_16x16x32_bf16 v[20:23], v[76:79], v[108:111], 0
    ds_read_b64_tr_b16 v[52:53], v5 offset:40960
    ds_read_b64_tr_b16 v[54:55], v9 offset:40960
    v_mfma_f32_16x16x32_bf16 v[20:23], v[72:75], v[104:107], v[20:23]
    ds_read_b64_tr_b16 v[56:57], v5 offset:45056
    v_mfma_f32_16x16x32_bf16 v[20:23], v[68:71], v[100:103], v[20:23]
    ds_read_b64_tr_b16 v[58:59], v9 offset:45056
    ds_read_b64_tr_b16 v[60:61], v227 offset:45056
    v_mfma_f32_16x16x32_bf16 v[20:23], v[64:67], v[96:99], v[20:23]
    ds_read_b64_tr_b16 v[62:63], v231 offset:45056
    s_waitcnt lgkmcnt(14)
    v_mfma_f32_16x16x32_bf16 v[24:27], v[80:83], v[96:99], 0
    buffer_load_dwordx4 v[168:171], v252, s[52:55], s38 offen offset:2048 sc1
    buffer_load_dwordx4 v[172:175], v252, s[52:55], s38 offen offset:3072 sc1
    s_waitcnt lgkmcnt(12)
    v_mfma_f32_16x16x32_bf16 v[24:27], v[84:87], v[100:103], v[24:27]
    buffer_load_dwordx4 v[176:179], v15, s[52:55], s38 offen offset:0 sc1
    s_waitcnt lgkmcnt(10)
    v_mfma_f32_16x16x32_bf16 v[24:27], v[88:91], v[104:107], v[24:27]
    buffer_load_dwordx4 v[180:183], v15, s[52:55], s38 offen offset:1024 sc1
    ds_read_b64_tr_b16 v[64:65], v224 offset:49152
    s_waitcnt lgkmcnt(9)
    v_mfma_f32_16x16x32_bf16 v[24:27], v[92:95], v[108:111], v[24:27]
    ds_read_b64_tr_b16 v[66:67], v228 offset:49152
    v_mfma_f32_16x16x32_bf16 v[40:43], v[92:95], v[124:127], 0
    ds_read_b64_tr_b16 v[68:69], v224 offset:53248
    ds_read_b64_tr_b16 v[70:71], v228 offset:53248
    v_mfma_f32_16x16x32_bf16 v[40:43], v[88:91], v[120:123], v[40:43]
    ds_read_b64_tr_b16 v[72:73], v224 offset:57344
    v_mfma_f32_16x16x32_bf16 v[40:43], v[84:87], v[116:119], v[40:43]
    ds_read_b64_tr_b16 v[74:75], v228 offset:57344
    ds_read_b64_tr_b16 v[76:77], v2 offset:49152
    v_mfma_f32_16x16x32_bf16 v[40:43], v[80:83], v[112:115], v[40:43]
    ds_read_b64_tr_b16 v[78:79], v6 offset:49152
    s_waitcnt lgkmcnt(14)
    v_mfma_f32_16x16x32_bf16 v[44:47], v[48:51], v[112:115], 0
    buffer_load_dwordx4 v[184:187], v15, s[52:55], s38 offen offset:2048 sc1
    buffer_load_dwordx4 v[188:191], v15, s[52:55], s38 offen offset:3072 sc1
    s_waitcnt lgkmcnt(12)
    v_mfma_f32_16x16x32_bf16 v[44:47], v[52:55], v[116:119], v[44:47]
    ds_read_b64_tr_b16 v[80:81], v225 offset:49152
    s_waitcnt lgkmcnt(11)
    v_mfma_f32_16x16x32_bf16 v[44:47], v[56:59], v[120:123], v[44:47]
    ds_read_b64_tr_b16 v[82:83], v229 offset:49152
    s_waitcnt lgkmcnt(10)
    v_mfma_f32_16x16x32_bf16 v[44:47], v[60:63], v[124:127], v[44:47]
    ds_read_b64_tr_b16 v[84:85], v225 offset:53248
    v_mfma_f32_16x16x32_bf16 v[28:31], v[60:63], v[108:111], 0
    ds_read_b64_tr_b16 v[86:87], v229 offset:53248
    ds_read_b64_tr_b16 v[88:89], v225 offset:57344
    v_mfma_f32_16x16x32_bf16 v[28:31], v[56:59], v[104:107], v[28:31]
    ds_read_b64_tr_b16 v[90:91], v229 offset:57344
    v_mfma_f32_16x16x32_bf16 v[28:31], v[52:55], v[100:103], v[28:31]
    ds_read_b64_tr_b16 v[92:93], v3 offset:49152
    v_mfma_f32_16x16x32_bf16 v[28:31], v[48:51], v[96:99], v[28:31]
    ds_read_b64_tr_b16 v[94:95], v7 offset:49152
    s_waitcnt vmcnt(8) lgkmcnt(8)
    v_mfma_f32_16x16x32_bf16 v[16:19], v[64:67], v[128:131], v[16:19]
    buffer_load_dwordx4 v[96:99], v252, s[52:55], s39 offen offset:0 sc1
    buffer_load_dwordx4 v[100:103], v252, s[52:55], s39 offen offset:1024 sc1
    v_mfma_f32_16x16x32_bf16 v[16:19], v[68:71], v[132:135], v[16:19]
    buffer_load_dwordx4 v[104:107], v252, s[52:55], s39 offen offset:2048 sc1
    v_mfma_f32_16x16x32_bf16 v[16:19], v[72:75], v[136:139], v[16:19]
    buffer_load_dwordx4 v[108:111], v252, s[52:55], s39 offen offset:3072 sc1
    ds_read_b64_tr_b16 v[48:49], v226 offset:49152
    v_mfma_f32_16x16x32_bf16 v[16:19], v[76:79], v[140:143], v[16:19]
    ds_read_b64_tr_b16 v[50:51], v230 offset:49152
    v_mfma_f32_16x16x32_bf16 v[32:35], v[76:79], v[156:159], v[32:35]
    ds_read_b64_tr_b16 v[52:53], v226 offset:53248
    ds_read_b64_tr_b16 v[54:55], v230 offset:53248
    v_mfma_f32_16x16x32_bf16 v[32:35], v[72:75], v[152:155], v[32:35]
    ds_read_b64_tr_b16 v[56:57], v226 offset:57344
    v_mfma_f32_16x16x32_bf16 v[32:35], v[68:71], v[148:151], v[32:35]
    ds_read_b64_tr_b16 v[58:59], v230 offset:57344
    ds_read_b64_tr_b16 v[60:61], v4 offset:49152
    v_mfma_f32_16x16x32_bf16 v[32:35], v[64:67], v[144:147], v[32:35]
    ds_read_b64_tr_b16 v[62:63], v8 offset:49152
    s_waitcnt lgkmcnt(8)
    v_mfma_f32_16x16x32_bf16 v[36:39], v[80:83], v[144:147], v[36:39]
    buffer_load_dwordx4 v[112:115], v15, s[52:55], s39 offen offset:0 sc1
    buffer_load_dwordx4 v[116:119], v15, s[52:55], s39 offen offset:1024 sc1
    v_mfma_f32_16x16x32_bf16 v[36:39], v[84:87], v[148:151], v[36:39]
    ds_read_b64_tr_b16 v[64:65], v227 offset:49152
    v_mfma_f32_16x16x32_bf16 v[36:39], v[88:91], v[152:155], v[36:39]
    ds_read_b64_tr_b16 v[66:67], v231 offset:49152
    v_mfma_f32_16x16x32_bf16 v[36:39], v[92:95], v[156:159], v[36:39]
    ds_read_b64_tr_b16 v[68:69], v227 offset:53248
    v_mfma_f32_16x16x32_bf16 v[20:23], v[92:95], v[140:143], v[20:23]
    ds_read_b64_tr_b16 v[70:71], v231 offset:53248
    ds_read_b64_tr_b16 v[72:73], v227 offset:57344
    v_mfma_f32_16x16x32_bf16 v[20:23], v[88:91], v[136:139], v[20:23]
    ds_read_b64_tr_b16 v[74:75], v231 offset:57344
    v_mfma_f32_16x16x32_bf16 v[20:23], v[84:87], v[132:135], v[20:23]
    ds_read_b64_tr_b16 v[76:77], v5 offset:49152
    v_mfma_f32_16x16x32_bf16 v[20:23], v[80:83], v[128:131], v[20:23]
    ds_read_b64_tr_b16 v[78:79], v9 offset:49152
    s_waitcnt lgkmcnt(8)
    v_mfma_f32_16x16x32_bf16 v[24:27], v[48:51], v[128:131], v[24:27]
    buffer_load_dwordx4 v[120:123], v15, s[52:55], s39 offen offset:2048 sc1
    buffer_load_dwordx4 v[124:127], v15, s[52:55], s39 offen offset:3072 sc1
    v_mfma_f32_16x16x32_bf16 v[24:27], v[52:55], v[132:135], v[24:27]
    ds_read_b64_tr_b16 v[80:81], v2 offset:53248
    v_mfma_f32_16x16x32_bf16 v[24:27], v[56:59], v[136:139], v[24:27]
    ds_read_b64_tr_b16 v[82:83], v6 offset:53248
    v_mfma_f32_16x16x32_bf16 v[24:27], v[60:63], v[140:143], v[24:27]
    ds_read_b64_tr_b16 v[84:85], v2 offset:57344
    v_mfma_f32_16x16x32_bf16 v[40:43], v[60:63], v[156:159], v[40:43]
    ds_read_b64_tr_b16 v[86:87], v6 offset:57344
    ds_read_b64_tr_b16 v[88:89], v2 offset:61440
    v_mfma_f32_16x16x32_bf16 v[40:43], v[56:59], v[152:155], v[40:43]
    ds_read_b64_tr_b16 v[90:91], v6 offset:61440
    v_mfma_f32_16x16x32_bf16 v[40:43], v[52:55], v[148:151], v[40:43]
    ds_read_b64_tr_b16 v[92:93], v224 offset:0
    v_mfma_f32_16x16x32_bf16 v[40:43], v[48:51], v[144:147], v[40:43]
    ds_read_b64_tr_b16 v[94:95], v228 offset:0
    s_waitcnt lgkmcnt(8)
    v_mfma_f32_16x16x32_bf16 v[44:47], v[64:67], v[144:147], v[44:47]
    ds_read_b64_tr_b16 v[48:49], v3 offset:53248
    v_mfma_f32_16x16x32_bf16 v[44:47], v[68:71], v[148:151], v[44:47]
    ds_read_b64_tr_b16 v[50:51], v7 offset:53248
    v_mfma_f32_16x16x32_bf16 v[44:47], v[72:75], v[152:155], v[44:47]
    ds_read_b64_tr_b16 v[52:53], v3 offset:57344
    v_mfma_f32_16x16x32_bf16 v[44:47], v[76:79], v[156:159], v[44:47]
    ds_read_b64_tr_b16 v[54:55], v7 offset:57344
    v_mfma_f32_16x16x32_bf16 v[28:31], v[76:79], v[140:143], v[28:31]
    ds_read_b64_tr_b16 v[56:57], v3 offset:61440
    v_mfma_f32_16x16x32_bf16 v[28:31], v[72:75], v[136:139], v[28:31]
    ds_read_b64_tr_b16 v[58:59], v7 offset:61440
    v_mfma_f32_16x16x32_bf16 v[28:31], v[68:71], v[132:135], v[28:31]
    ds_read_b64_tr_b16 v[60:61], v225 offset:0
    v_mfma_f32_16x16x32_bf16 v[28:31], v[64:67], v[128:131], v[28:31]
    ds_read_b64_tr_b16 v[62:63], v229 offset:0
    s_waitcnt vmcnt(8) lgkmcnt(8)
    v_mfma_f32_16x16x32_bf16 v[16:19], v[80:83], v[160:163], v[16:19]
    buffer_load_dwordx4 v[128:131], v252, s[52:55], s40 offen offset:0 sc1
    buffer_load_dwordx4 v[132:135], v252, s[52:55], s40 offen offset:1024 sc1
    v_mfma_f32_16x16x32_bf16 v[16:19], v[84:87], v[164:167], v[16:19]
    buffer_load_dwordx4 v[136:139], v252, s[52:55], s40 offen offset:2048 sc1
    v_mfma_f32_16x16x32_bf16 v[16:19], v[88:91], v[168:171], v[16:19]
    buffer_load_dwordx4 v[140:143], v252, s[52:55], s40 offen offset:3072 sc1
    ds_read_b64_tr_b16 v[64:65], v4 offset:53248
    v_mfma_f32_16x16x32_bf16 v[16:19], v[92:95], v[172:175], v[16:19]
    ds_read_b64_tr_b16 v[66:67], v8 offset:53248
    v_mfma_f32_16x16x32_bf16 v[32:35], v[92:95], v[188:191], v[32:35]
    ds_read_b64_tr_b16 v[68:69], v4 offset:57344
    ds_read_b64_tr_b16 v[70:71], v8 offset:57344
    v_mfma_f32_16x16x32_bf16 v[32:35], v[88:91], v[184:187], v[32:35]
    ds_read_b64_tr_b16 v[72:73], v4 offset:61440
    v_mfma_f32_16x16x32_bf16 v[32:35], v[84:87], v[180:183], v[32:35]
    ds_read_b64_tr_b16 v[74:75], v8 offset:61440
    ds_read_b64_tr_b16 v[76:77], v226 offset:0
    v_mfma_f32_16x16x32_bf16 v[32:35], v[80:83], v[176:179], v[32:35]
    ds_read_b64_tr_b16 v[78:79], v230 offset:0
    s_waitcnt lgkmcnt(8)
    v_mfma_f32_16x16x32_bf16 v[36:39], v[48:51], v[176:179], v[36:39]
    buffer_load_dwordx4 v[144:147], v15, s[52:55], s40 offen offset:0 sc1
    buffer_load_dwordx4 v[148:151], v15, s[52:55], s40 offen offset:1024 sc1
    v_mfma_f32_16x16x32_bf16 v[36:39], v[52:55], v[180:183], v[36:39]
    ds_read_b64_tr_b16 v[80:81], v5 offset:53248
    v_mfma_f32_16x16x32_bf16 v[36:39], v[56:59], v[184:187], v[36:39]
    ds_read_b64_tr_b16 v[82:83], v9 offset:53248
    v_mfma_f32_16x16x32_bf16 v[36:39], v[60:63], v[188:191], v[36:39]
    ds_read_b64_tr_b16 v[84:85], v5 offset:57344
    v_mfma_f32_16x16x32_bf16 v[20:23], v[60:63], v[172:175], v[20:23]
    ds_read_b64_tr_b16 v[86:87], v9 offset:57344
    ds_read_b64_tr_b16 v[88:89], v5 offset:61440
    v_mfma_f32_16x16x32_bf16 v[20:23], v[56:59], v[168:171], v[20:23]
    ds_read_b64_tr_b16 v[90:91], v9 offset:61440
    v_mfma_f32_16x16x32_bf16 v[20:23], v[52:55], v[164:167], v[20:23]
    ds_read_b64_tr_b16 v[92:93], v227 offset:0
    v_mfma_f32_16x16x32_bf16 v[20:23], v[48:51], v[160:163], v[20:23]
    ds_read_b64_tr_b16 v[94:95], v231 offset:0
    s_waitcnt lgkmcnt(8)
    v_mfma_f32_16x16x32_bf16 v[24:27], v[64:67], v[160:163], v[24:27]
    buffer_load_dwordx4 v[152:155], v15, s[52:55], s40 offen offset:2048 sc1
    buffer_load_dwordx4 v[156:159], v15, s[52:55], s40 offen offset:3072 sc1
    v_mfma_f32_16x16x32_bf16 v[24:27], v[68:71], v[164:167], v[24:27]
    ds_read_b64_tr_b16 v[48:49], v224 offset:4096
    v_mfma_f32_16x16x32_bf16 v[24:27], v[72:75], v[168:171], v[24:27]
    ds_read_b64_tr_b16 v[50:51], v228 offset:4096
    v_mfma_f32_16x16x32_bf16 v[24:27], v[76:79], v[172:175], v[24:27]
    ds_read_b64_tr_b16 v[52:53], v2 offset:0
    v_mfma_f32_16x16x32_bf16 v[40:43], v[76:79], v[188:191], v[40:43]
    ds_read_b64_tr_b16 v[54:55], v6 offset:0
    ds_read_b64_tr_b16 v[56:57], v2 offset:4096
    v_mfma_f32_16x16x32_bf16 v[40:43], v[72:75], v[184:187], v[40:43]
    ds_read_b64_tr_b16 v[58:59], v6 offset:4096
    v_mfma_f32_16x16x32_bf16 v[40:43], v[68:71], v[180:183], v[40:43]
    ds_read_b64_tr_b16 v[60:61], v2 offset:8192
    v_mfma_f32_16x16x32_bf16 v[40:43], v[64:67], v[176:179], v[40:43]
    ds_read_b64_tr_b16 v[62:63], v6 offset:8192
    s_waitcnt lgkmcnt(8)
    v_mfma_f32_16x16x32_bf16 v[44:47], v[80:83], v[176:179], v[44:47]
    ds_read_b64_tr_b16 v[64:65], v225 offset:4096
    v_mfma_f32_16x16x32_bf16 v[44:47], v[84:87], v[180:183], v[44:47]
    ds_read_b64_tr_b16 v[66:67], v229 offset:4096
    v_mfma_f32_16x16x32_bf16 v[44:47], v[88:91], v[184:187], v[44:47]
    ds_read_b64_tr_b16 v[68:69], v3 offset:0
    v_mfma_f32_16x16x32_bf16 v[44:47], v[92:95], v[188:191], v[44:47]
    ds_read_b64_tr_b16 v[70:71], v7 offset:0
    v_mfma_f32_16x16x32_bf16 v[28:31], v[92:95], v[172:175], v[28:31]
    ds_read_b64_tr_b16 v[72:73], v3 offset:4096
    v_mfma_f32_16x16x32_bf16 v[28:31], v[88:91], v[168:171], v[28:31]
    ds_read_b64_tr_b16 v[74:75], v7 offset:4096
    v_mfma_f32_16x16x32_bf16 v[28:31], v[84:87], v[164:167], v[28:31]
    ds_read_b64_tr_b16 v[76:77], v3 offset:8192
    v_mfma_f32_16x16x32_bf16 v[28:31], v[80:83], v[160:163], v[28:31]
    ds_read_b64_tr_b16 v[78:79], v7 offset:8192
    s_waitcnt vmcnt(8) lgkmcnt(8)
    v_mfma_f32_16x16x32_bf16 v[16:19], v[48:51], v[96:99], v[16:19]
    buffer_load_dwordx4 v[160:163], v252, s[52:55], s41 offen offset:0 sc1
    buffer_load_dwordx4 v[164:167], v252, s[52:55], s41 offen offset:1024 sc1
    v_mfma_f32_16x16x32_bf16 v[16:19], v[52:55], v[100:103], v[16:19]
    buffer_load_dwordx4 v[168:171], v252, s[52:55], s41 offen offset:2048 sc1
    v_mfma_f32_16x16x32_bf16 v[16:19], v[56:59], v[104:107], v[16:19]
    buffer_load_dwordx4 v[172:175], v252, s[52:55], s41 offen offset:3072 sc1
    ds_read_b64_tr_b16 v[80:81], v226 offset:4096
    v_mfma_f32_16x16x32_bf16 v[16:19], v[60:63], v[108:111], v[16:19]
    ds_read_b64_tr_b16 v[82:83], v230 offset:4096
    v_mfma_f32_16x16x32_bf16 v[32:35], v[60:63], v[124:127], v[32:35]
    ds_read_b64_tr_b16 v[84:85], v4 offset:0
    ds_read_b64_tr_b16 v[86:87], v8 offset:0
    v_mfma_f32_16x16x32_bf16 v[32:35], v[56:59], v[120:123], v[32:35]
    ds_read_b64_tr_b16 v[88:89], v4 offset:4096
    v_mfma_f32_16x16x32_bf16 v[32:35], v[52:55], v[116:119], v[32:35]
    ds_read_b64_tr_b16 v[90:91], v8 offset:4096
    ds_read_b64_tr_b16 v[92:93], v4 offset:8192
    v_mfma_f32_16x16x32_bf16 v[32:35], v[48:51], v[112:115], v[32:35]
    ds_read_b64_tr_b16 v[94:95], v8 offset:8192
    s_waitcnt lgkmcnt(8)
    v_mfma_f32_16x16x32_bf16 v[36:39], v[64:67], v[112:115], v[36:39]
    buffer_load_dwordx4 v[176:179], v15, s[52:55], s41 offen offset:0 sc1
    buffer_load_dwordx4 v[180:183], v15, s[52:55], s41 offen offset:1024 sc1
    v_mfma_f32_16x16x32_bf16 v[36:39], v[68:71], v[116:119], v[36:39]
    ds_read_b64_tr_b16 v[48:49], v227 offset:4096
    v_mfma_f32_16x16x32_bf16 v[36:39], v[72:75], v[120:123], v[36:39]
    ds_read_b64_tr_b16 v[50:51], v231 offset:4096
    v_mfma_f32_16x16x32_bf16 v[36:39], v[76:79], v[124:127], v[36:39]
    ds_read_b64_tr_b16 v[52:53], v5 offset:0
    v_mfma_f32_16x16x32_bf16 v[20:23], v[76:79], v[108:111], v[20:23]
    ds_read_b64_tr_b16 v[54:55], v9 offset:0
    ds_read_b64_tr_b16 v[56:57], v5 offset:4096
    v_mfma_f32_16x16x32_bf16 v[20:23], v[72:75], v[104:107], v[20:23]
    ds_read_b64_tr_b16 v[58:59], v9 offset:4096
    v_mfma_f32_16x16x32_bf16 v[20:23], v[68:71], v[100:103], v[20:23]
    ds_read_b64_tr_b16 v[60:61], v5 offset:8192
    v_mfma_f32_16x16x32_bf16 v[20:23], v[64:67], v[96:99], v[20:23]
    ds_read_b64_tr_b16 v[62:63], v9 offset:8192
    s_mov_b64 exec, 1
    ds_add_u32 v10, v11 offset:28
    s_mov_b64 exec, -1
    s_waitcnt lgkmcnt(9)
    v_mfma_f32_16x16x32_bf16 v[24:27], v[80:83], v[96:99], v[24:27]
    buffer_load_dwordx4 v[184:187], v15, s[52:55], s41 offen offset:2048 sc1
    buffer_load_dwordx4 v[188:191], v15, s[52:55], s41 offen offset:3072 sc1
    v_mfma_f32_16x16x32_bf16 v[24:27], v[84:87], v[100:103], v[24:27]
    ds_read_b64_tr_b16 v[64:65], v2 offset:12288
    v_mfma_f32_16x16x32_bf16 v[24:27], v[88:91], v[104:107], v[24:27]
    ds_read_b64_tr_b16 v[66:67], v6 offset:12288
    v_mfma_f32_16x16x32_bf16 v[24:27], v[92:95], v[108:111], v[24:27]
    ds_read_b64_tr_b16 v[68:69], v2 offset:16384
    v_mfma_f32_16x16x32_bf16 v[40:43], v[92:95], v[124:127], v[40:43]
    ds_read_b64_tr_b16 v[70:71], v6 offset:16384
    ds_read_b64_tr_b16 v[72:73], v2 offset:20480
    v_mfma_f32_16x16x32_bf16 v[40:43], v[88:91], v[120:123], v[40:43]
    ds_read_b64_tr_b16 v[74:75], v6 offset:20480
    v_mfma_f32_16x16x32_bf16 v[40:43], v[84:87], v[116:119], v[40:43]
    ds_read_b64_tr_b16 v[76:77], v224 offset:8192
    v_mfma_f32_16x16x32_bf16 v[40:43], v[80:83], v[112:115], v[40:43]
    ds_read_b64_tr_b16 v[78:79], v228 offset:8192
    s_waitcnt lgkmcnt(9)
    v_mfma_f32_16x16x32_bf16 v[44:47], v[48:51], v[112:115], v[44:47]
    ds_read_b64_tr_b16 v[80:81], v3 offset:12288
    v_mfma_f32_16x16x32_bf16 v[44:47], v[52:55], v[116:119], v[44:47]
    ds_read_b64_tr_b16 v[82:83], v7 offset:12288
    v_mfma_f32_16x16x32_bf16 v[44:47], v[56:59], v[120:123], v[44:47]
    ds_read_b64_tr_b16 v[84:85], v3 offset:16384
    v_mfma_f32_16x16x32_bf16 v[44:47], v[60:63], v[124:127], v[44:47]
    ds_read_b64_tr_b16 v[86:87], v7 offset:16384
    v_mfma_f32_16x16x32_bf16 v[28:31], v[60:63], v[108:111], v[28:31]
    ds_read_b64_tr_b16 v[88:89], v3 offset:20480
    v_mfma_f32_16x16x32_bf16 v[28:31], v[56:59], v[104:107], v[28:31]
    ds_read_b64_tr_b16 v[90:91], v7 offset:20480
    v_mfma_f32_16x16x32_bf16 v[28:31], v[52:55], v[100:103], v[28:31]
    ds_read_b64_tr_b16 v[92:93], v225 offset:8192
    v_mfma_f32_16x16x32_bf16 v[28:31], v[48:51], v[96:99], v[28:31]
    ds_read_b64_tr_b16 v[94:95], v229 offset:8192
    s_waitcnt vmcnt(8) lgkmcnt(8)
    v_mfma_f32_16x16x32_bf16 v[16:19], v[64:67], v[128:131], v[16:19]
    buffer_load_dwordx4 v[96:99], v252, s[52:55], s42 offen offset:0 sc1
    buffer_load_dwordx4 v[100:103], v252, s[52:55], s42 offen offset:1024 sc1
    v_mfma_f32_16x16x32_bf16 v[16:19], v[68:71], v[132:135], v[16:19]
    buffer_load_dwordx4 v[104:107], v252, s[52:55], s42 offen offset:2048 sc1
    v_mfma_f32_16x16x32_bf16 v[16:19], v[72:75], v[136:139], v[16:19]
    buffer_load_dwordx4 v[108:111], v252, s[52:55], s42 offen offset:3072 sc1
    ds_read_b64_tr_b16 v[48:49], v4 offset:12288
    v_mfma_f32_16x16x32_bf16 v[16:19], v[76:79], v[140:143], v[16:19]
    ds_read_b64_tr_b16 v[50:51], v8 offset:12288
    v_mfma_f32_16x16x32_bf16 v[32:35], v[76:79], v[156:159], v[32:35]
    ds_read_b64_tr_b16 v[52:53], v4 offset:16384
    ds_read_b64_tr_b16 v[54:55], v8 offset:16384
    v_mfma_f32_16x16x32_bf16 v[32:35], v[72:75], v[152:155], v[32:35]
    ds_read_b64_tr_b16 v[56:57], v4 offset:20480
    v_mfma_f32_16x16x32_bf16 v[32:35], v[68:71], v[148:151], v[32:35]
    ds_read_b64_tr_b16 v[58:59], v8 offset:20480
    ds_read_b64_tr_b16 v[60:61], v226 offset:8192
    v_mfma_f32_16x16x32_bf16 v[32:35], v[64:67], v[144:147], v[32:35]
    ds_read_b64_tr_b16 v[62:63], v230 offset:8192
    s_waitcnt lgkmcnt(8)
    v_mfma_f32_16x16x32_bf16 v[36:39], v[80:83], v[144:147], v[36:39]
    buffer_load_dwordx4 v[112:115], v15, s[52:55], s42 offen offset:0 sc1
    buffer_load_dwordx4 v[116:119], v15, s[52:55], s42 offen offset:1024 sc1
    v_mfma_f32_16x16x32_bf16 v[36:39], v[84:87], v[148:151], v[36:39]
    ds_read_b64_tr_b16 v[64:65], v5 offset:12288
    v_mfma_f32_16x16x32_bf16 v[36:39], v[88:91], v[152:155], v[36:39]
    ds_read_b64_tr_b16 v[66:67], v9 offset:12288
    v_mfma_f32_16x16x32_bf16 v[36:39], v[92:95], v[156:159], v[36:39]
    ds_read_b64_tr_b16 v[68:69], v5 offset:16384
    v_mfma_f32_16x16x32_bf16 v[20:23], v[92:95], v[140:143], v[20:23]
    ds_read_b64_tr_b16 v[70:71], v9 offset:16384
    ds_read_b64_tr_b16 v[72:73], v5 offset:20480
    v_mfma_f32_16x16x32_bf16 v[20:23], v[88:91], v[136:139], v[20:23]
    ds_read_b64_tr_b16 v[74:75], v9 offset:20480
    v_mfma_f32_16x16x32_bf16 v[20:23], v[84:87], v[132:135], v[20:23]
    ds_read_b64_tr_b16 v[76:77], v227 offset:8192
    v_mfma_f32_16x16x32_bf16 v[20:23], v[80:83], v[128:131], v[20:23]
    ds_read_b64_tr_b16 v[78:79], v231 offset:8192
    s_waitcnt lgkmcnt(8)
    v_mfma_f32_16x16x32_bf16 v[24:27], v[48:51], v[128:131], v[24:27]
    buffer_load_dwordx4 v[120:123], v15, s[52:55], s42 offen offset:2048 sc1
    buffer_load_dwordx4 v[124:127], v15, s[52:55], s42 offen offset:3072 sc1
    v_mfma_f32_16x16x32_bf16 v[24:27], v[52:55], v[132:135], v[24:27]
    ds_read_b64_tr_b16 v[80:81], v224 offset:12288
    v_mfma_f32_16x16x32_bf16 v[24:27], v[56:59], v[136:139], v[24:27]
    ds_read_b64_tr_b16 v[82:83], v228 offset:12288
    v_mfma_f32_16x16x32_bf16 v[24:27], v[60:63], v[140:143], v[24:27]
    ds_read_b64_tr_b16 v[84:85], v224 offset:16384
    v_mfma_f32_16x16x32_bf16 v[40:43], v[60:63], v[156:159], v[40:43]
    ds_read_b64_tr_b16 v[86:87], v228 offset:16384
    ds_read_b64_tr_b16 v[88:89], v224 offset:20480
    v_mfma_f32_16x16x32_bf16 v[40:43], v[56:59], v[152:155], v[40:43]
    ds_read_b64_tr_b16 v[90:91], v228 offset:20480
    v_mfma_f32_16x16x32_bf16 v[40:43], v[52:55], v[148:151], v[40:43]
    ds_read_b64_tr_b16 v[92:93], v2 offset:24576
    v_mfma_f32_16x16x32_bf16 v[40:43], v[48:51], v[144:147], v[40:43]
    ds_read_b64_tr_b16 v[94:95], v6 offset:24576
    s_waitcnt lgkmcnt(8)
    v_mfma_f32_16x16x32_bf16 v[44:47], v[64:67], v[144:147], v[44:47]
    ds_read_b64_tr_b16 v[48:49], v225 offset:12288
    v_mfma_f32_16x16x32_bf16 v[44:47], v[68:71], v[148:151], v[44:47]
    ds_read_b64_tr_b16 v[50:51], v229 offset:12288
    v_mfma_f32_16x16x32_bf16 v[44:47], v[72:75], v[152:155], v[44:47]
    ds_read_b64_tr_b16 v[52:53], v225 offset:16384
    v_mfma_f32_16x16x32_bf16 v[44:47], v[76:79], v[156:159], v[44:47]
    ds_read_b64_tr_b16 v[54:55], v229 offset:16384
    v_mfma_f32_16x16x32_bf16 v[28:31], v[76:79], v[140:143], v[28:31]
    ds_read_b64_tr_b16 v[56:57], v225 offset:20480
    v_mfma_f32_16x16x32_bf16 v[28:31], v[72:75], v[136:139], v[28:31]
    ds_read_b64_tr_b16 v[58:59], v229 offset:20480
    v_mfma_f32_16x16x32_bf16 v[28:31], v[68:71], v[132:135], v[28:31]
    ds_read_b64_tr_b16 v[60:61], v3 offset:24576
    v_mfma_f32_16x16x32_bf16 v[28:31], v[64:67], v[128:131], v[28:31]
    ds_read_b64_tr_b16 v[62:63], v7 offset:24576
    s_waitcnt vmcnt(8) lgkmcnt(8)
    v_mfma_f32_16x16x32_bf16 v[16:19], v[80:83], v[160:163], v[16:19]
    buffer_load_dwordx4 v[128:131], v252, s[52:55], s43 offen offset:0 sc1
    buffer_load_dwordx4 v[132:135], v252, s[52:55], s43 offen offset:1024 sc1
    v_mfma_f32_16x16x32_bf16 v[16:19], v[84:87], v[164:167], v[16:19]
    buffer_load_dwordx4 v[136:139], v252, s[52:55], s43 offen offset:2048 sc1
    v_mfma_f32_16x16x32_bf16 v[16:19], v[88:91], v[168:171], v[16:19]
    buffer_load_dwordx4 v[140:143], v252, s[52:55], s43 offen offset:3072 sc1
    ds_read_b64_tr_b16 v[64:65], v226 offset:12288
    v_mfma_f32_16x16x32_bf16 v[16:19], v[92:95], v[172:175], v[16:19]
    ds_read_b64_tr_b16 v[66:67], v230 offset:12288
    v_mfma_f32_16x16x32_bf16 v[32:35], v[92:95], v[188:191], v[32:35]
    ds_read_b64_tr_b16 v[68:69], v226 offset:16384
    ds_read_b64_tr_b16 v[70:71], v230 offset:16384
    v_mfma_f32_16x16x32_bf16 v[32:35], v[88:91], v[184:187], v[32:35]
    ds_read_b64_tr_b16 v[72:73], v226 offset:20480
    v_mfma_f32_16x16x32_bf16 v[32:35], v[84:87], v[180:183], v[32:35]
    ds_read_b64_tr_b16 v[74:75], v230 offset:20480
    ds_read_b64_tr_b16 v[76:77], v4 offset:24576
    v_mfma_f32_16x16x32_bf16 v[32:35], v[80:83], v[176:179], v[32:35]
    ds_read_b64_tr_b16 v[78:79], v8 offset:24576
    s_mov_b64 exec, 1
    ds_add_u32 v10, v11 offset:40
    s_mov_b64 exec, -1
    s_waitcnt lgkmcnt(9)
    v_mfma_f32_16x16x32_bf16 v[36:39], v[48:51], v[176:179], v[36:39]
    buffer_load_dwordx4 v[144:147], v15, s[52:55], s43 offen offset:0 sc1
    buffer_load_dwordx4 v[148:151], v15, s[52:55], s43 offen offset:1024 sc1
    v_mfma_f32_16x16x32_bf16 v[36:39], v[52:55], v[180:183], v[36:39]
    ds_read_b32 v223, v10 offset:32
    v_mfma_f32_16x16x32_bf16 v[36:39], v[56:59], v[184:187], v[36:39]
    ds_read_b64_tr_b16 v[80:81], v227 offset:12288
    ds_read_b64_tr_b16 v[82:83], v231 offset:12288
    v_mfma_f32_16x16x32_bf16 v[36:39], v[60:63], v[188:191], v[36:39]
    ds_read_b64_tr_b16 v[84:85], v227 offset:16384
    v_mfma_f32_16x16x32_bf16 v[20:23], v[60:63], v[172:175], v[20:23]
    ds_read_b64_tr_b16 v[86:87], v231 offset:16384
    v_mfma_f32_16x16x32_bf16 v[20:23], v[56:59], v[168:171], v[20:23]
    ds_read_b64_tr_b16 v[88:89], v227 offset:20480
    ds_read_b64_tr_b16 v[90:91], v231 offset:20480
    v_mfma_f32_16x16x32_bf16 v[20:23], v[52:55], v[164:167], v[20:23]
    ds_read_b64_tr_b16 v[92:93], v5 offset:24576
    v_mfma_f32_16x16x32_bf16 v[20:23], v[48:51], v[160:163], v[20:23]
    ds_read_b64_tr_b16 v[94:95], v9 offset:24576
    s_waitcnt lgkmcnt(8)
    v_cmp_gt_u32 vcc, 4, v223
    s_cbranch_vccnz LB_w8
LB_g8:
    v_mfma_f32_16x16x32_bf16 v[24:27], v[64:67], v[160:163], v[24:27]
    buffer_load_dwordx4 v[152:155], v15, s[52:55], s43 offen offset:2048 sc1
    buffer_load_dwordx4 v[156:159], v15, s[52:55], s43 offen offset:3072 sc1
    v_mfma_f32_16x16x32_bf16 v[24:27], v[68:71], v[164:167], v[24:27]
    ds_read_b64_tr_b16 v[48:49], v2 offset:28672
    v_mfma_f32_16x16x32_bf16 v[24:27], v[72:75], v[168:171], v[24:27]
    ds_read_b64_tr_b16 v[50:51], v6 offset:28672
    v_mfma_f32_16x16x32_bf16 v[24:27], v[76:79], v[172:175], v[24:27]
    ds_read_b64_tr_b16 v[52:53], v2 offset:32768
    v_mfma_f32_16x16x32_bf16 v[40:43], v[76:79], v[188:191], v[40:43]
    ds_read_b64_tr_b16 v[54:55], v6 offset:32768
    ds_read_b64_tr_b16 v[56:57], v232 offset:0
    v_mfma_f32_16x16x32_bf16 v[40:43], v[72:75], v[184:187], v[40:43]
    ds_read_b64_tr_b16 v[58:59], v236 offset:0
    v_mfma_f32_16x16x32_bf16 v[40:43], v[68:71], v[180:183], v[40:43]
    ds_read_b64_tr_b16 v[60:61], v232 offset:4096
    v_mfma_f32_16x16x32_bf16 v[40:43], v[64:67], v[176:179], v[40:43]
    ds_read_b64_tr_b16 v[62:63], v236 offset:4096
    s_waitcnt lgkmcnt(8)
    v_mfma_f32_16x16x32_bf16 v[44:47], v[80:83], v[176:179], v[44:47]
    ds_read_b64_tr_b16 v[64:65], v3 offset:28672
    v_mfma_f32_16x16x32_bf16 v[44:47], v[84:87], v[180:183], v[44:47]
    ds_read_b64_tr_b16 v[66:67], v7 offset:28672
    v_mfma_f32_16x16x32_bf16 v[44:47], v[88:91], v[184:187], v[44:47]
    ds_read_b64_tr_b16 v[68:69], v3 offset:32768
    v_mfma_f32_16x16x32_bf16 v[44:47], v[92:95], v[188:191], v[44:47]
    ds_read_b64_tr_b16 v[70:71], v7 offset:32768
    v_mfma_f32_16x16x32_bf16 v[28:31], v[92:95], v[172:175], v[28:31]
    ds_read_b64_tr_b16 v[72:73], v233 offset:0
    v_mfma_f32_16x16x32_bf16 v[28:31], v[88:91], v[168:171], v[28:31]
    ds_read_b64_tr_b16 v[74:75], v237 offset:0
    v_mfma_f32_16x16x32_bf16 v[28:31], v[84:87], v[164:167], v[28:31]
    ds_read_b64_tr_b16 v[76:77], v233 offset:4096
    v_mfma_f32_16x16x32_bf16 v[28:31], v[80:83], v[160:163], v[28:31]
    ds_read_b64_tr_b16 v[78:79], v237 offset:4096
    s_waitcnt vmcnt(8) lgkmcnt(8)
    v_mfma_f32_16x16x32_bf16 v[16:19], v[48:51], v[96:99], v[16:19]
    ds_read_b64_tr_b16 v[80:81], v4 offset:28672
    v_mfma_f32_16x16x32_bf16 v[16:19], v[52:55], v[100:103], v[16:19]
    ds_read_b64_tr_b16 v[82:83], v8 offset:28672
    v_mfma_f32_16x16x32_bf16 v[16:19], v[56:59], v[104:107], v[16:19]
    ds_read_b64_tr_b16 v[84:85], v4 offset:32768
    v_mfma_f32_16x16x32_bf16 v[16:19], v[60:63], v[108:111], v[16:19]
    ds_read_b64_tr_b16 v[86:87], v8 offset:32768
    v_mfma_f32_16x16x32_bf16 v[32:35], v[60:63], v[124:127], v[32:35]
    ds_read_b64_tr_b16 v[88:89], v234 offset:0
    v_mfma_f32_16x16x32_bf16 v[32:35], v[56:59], v[120:123], v[32:35]
    ds_read_b64_tr_b16 v[90:91], v238 offset:0
    v_mfma_f32_16x16x32_bf16 v[32:35], v[52:55], v[116:119], v[32:35]
    ds_read_b64_tr_b16 v[92:93], v234 offset:4096
    v_mfma_f32_16x16x32_bf16 v[32:35], v[48:51], v[112:115], v[32:35]
    ds_read_b64_tr_b16 v[94:95], v238 offset:4096
    s_waitcnt lgkmcnt(8)
    v_mfma_f32_16x16x32_bf16 v[36:39], v[64:67], v[112:115], v[36:39]
    ds_read_b64_tr_b16 v[48:49], v5 offset:28672
    v_mfma_f32_16x16x32_bf16 v[36:39], v[68:71], v[116:119], v[36:39]
    ds_read_b64_tr_b16 v[50:51], v9 offset:28672
    v_mfma_f32_16x16x32_bf16 v[36:39], v[72:75], v[120:123], v[36:39]
    ds_read_b64_tr_b16 v[52:53], v5 offset:32768
    v_mfma_f32_16x16x32_bf16 v[36:39], v[76:79], v[124:127], v[36:39]
    ds_read_b64_tr_b16 v[54:55], v9 offset:32768
    v_mfma_f32_16x16x32_bf16 v[20:23], v[76:79], v[108:111], v[20:23]
    ds_read_b64_tr_b16 v[56:57], v235 offset:0
    v_mfma_f32_16x16x32_bf16 v[20:23], v[72:75], v[104:107], v[20:23]
    ds_read_b64_tr_b16 v[58:59], v239 offset:0
    v_mfma_f32_16x16x32_bf16 v[20:23], v[68:71], v[100:103], v[20:23]
    ds_read_b64_tr_b16 v[60:61], v235 offset:4096
    v_mfma_f32_16x16x32_bf16 v[20:23], v[64:67], v[96:99], v[20:23]
    ds_read_b64_tr_b16 v[62:63], v239 offset:4096
    s_waitcnt lgkmcnt(8)
    v_mfma_f32_16x16x32_bf16 v[24:27], v[80:83], v[96:99], v[24:27]
    ds_read_b64_tr_b16 v[64:65], v232 offset:8192
    v_mfma_f32_16x16x32_bf16 v[24:27], v[84:87], v[100:103], v[24:27]
    ds_read_b64_tr_b16 v[66:67], v236 offset:8192
    v_mfma_f32_16x16x32_bf16 v[24:27], v[88:91], v[104:107], v[24:27]
    ds_read_b64_tr_b16 v[68:69], v232 offset:12288
    v_mfma_f32_16x16x32_bf16 v[24:27], v[92:95], v[108:111], v[24:27]
    ds_read_b64_tr_b16 v[70:71], v236 offset:12288
    v_mfma_f32_16x16x32_bf16 v[40:43], v[92:95], v[124:127], v[40:43]
    ds_read_b64_tr_b16 v[72:73], v232 offset:16384
    v_mfma_f32_16x16x32_bf16 v[40:43], v[88:91], v[120:123], v[40:43]
    ds_read_b64_tr_b16 v[74:75], v236 offset:16384
    v_mfma_f32_16x16x32_bf16 v[40:43], v[84:87], v[116:119], v[40:43]
    ds_read_b64_tr_b16 v[76:77], v232 offset:20480
    v_mfma_f32_16x16x32_bf16 v[40:43], v[80:83], v[112:115], v[40:43]
    ds_read_b64_tr_b16 v[78:79], v236 offset:20480
    s_waitcnt lgkmcnt(8)
    v_mfma_f32_16x16x32_bf16 v[44:47], v[48:51], v[112:115], v[44:47]
    ds_read_b64_tr_b16 v[80:81], v233 offset:8192
    v_mfma_f32_16x16x32_bf16 v[44:47], v[52:55], v[116:119], v[44:47]
    ds_read_b64_tr_b16 v[82:83], v237 offset:8192
    v_mfma_f32_16x16x32_bf16 v[44:47], v[56:59], v[120:123], v[44:47]
    ds_read_b64_tr_b16 v[84:85], v233 offset:12288
    v_mfma_f32_16x16x32_bf16 v[44:47], v[60:63], v[124:127], v[44:47]
    ds_read_b64_tr_b16 v[86:87], v237 offset:12288
    v_mfma_f32_16x16x32_bf16 v[28:31], v[60:63], v[108:111], v[28:31]
    ds_read_b64_tr_b16 v[88:89], v233 offset:16384
    v_mfma_f32_16x16x32_bf16 v[28:31], v[56:59], v[104:107], v[28:31]
    ds_read_b64_tr_b16 v[90:91], v237 offset:16384
    v_mfma_f32_16x16x32_bf16 v[28:31], v[52:55], v[100:103], v[28:31]
    ds_read_b64_tr_b16 v[92:93], v233 offset:20480
    v_mfma_f32_16x16x32_bf16 v[28:31], v[48:51], v[96:99], v[28:31]
    ds_read_b64_tr_b16 v[94:95], v237 offset:20480
    s_waitcnt vmcnt(0) lgkmcnt(8)
    v_mfma_f32_16x16x32_bf16 v[16:19], v[64:67], v[128:131], v[16:19]
    ds_read_b32 v223, v10 offset:40
    ds_read_b64_tr_b16 v[48:49], v234 offset:8192
    v_mfma_f32_16x16x32_bf16 v[16:19], v[68:71], v[132:135], v[16:19]
    ds_read_b64_tr_b16 v[50:51], v238 offset:8192
    v_mfma_f32_16x16x32_bf16 v[16:19], v[72:75], v[136:139], v[16:19]
    ds_read_b64_tr_b16 v[52:53], v234 offset:12288
    v_mfma_f32_16x16x32_bf16 v[16:19], v[76:79], v[140:143], v[16:19]
    ds_read_b64_tr_b16 v[54:55], v238 offset:12288
    v_mfma_f32_16x16x32_bf16 v[32:35], v[76:79], v[156:159], v[32:35]
    ds_read_b64_tr_b16 v[56:57], v234 offset:16384
    v_mfma_f32_16x16x32_bf16 v[32:35], v[72:75], v[152:155], v[32:35]
    ds_read_b64_tr_b16 v[58:59], v238 offset:16384
    v_mfma_f32_16x16x32_bf16 v[32:35], v[68:71], v[148:151], v[32:35]
    ds_read_b64_tr_b16 v[60:61], v234 offset:20480
    v_mfma_f32_16x16x32_bf16 v[32:35], v[64:67], v[144:147], v[32:35]
    ds_read_b64_tr_b16 v[62:63], v238 offset:20480
    s_waitcnt lgkmcnt(9)
    v_mfma_f32_16x16x32_bf16 v[36:39], v[80:83], v[144:147], v[36:39]
    ds_read_b64_tr_b16 v[64:65], v235 offset:8192
    v_mfma_f32_16x16x32_bf16 v[36:39], v[84:87], v[148:151], v[36:39]
    ds_read_b64_tr_b16 v[66:67], v239 offset:8192
    v_mfma_f32_16x16x32_bf16 v[36:39], v[88:91], v[152:155], v[36:39]
    ds_read_b64_tr_b16 v[68:69], v235 offset:12288
    v_mfma_f32_16x16x32_bf16 v[36:39], v[92:95], v[156:159], v[36:39]
    ds_read_b64_tr_b16 v[70:71], v239 offset:12288
    v_mfma_f32_16x16x32_bf16 v[20:23], v[92:95], v[140:143], v[20:23]
    ds_read_b64_tr_b16 v[72:73], v235 offset:16384
    v_mfma_f32_16x16x32_bf16 v[20:23], v[88:91], v[136:139], v[20:23]
    ds_read_b64_tr_b16 v[74:75], v239 offset:16384
    v_mfma_f32_16x16x32_bf16 v[20:23], v[84:87], v[132:135], v[20:23]
    ds_read_b64_tr_b16 v[76:77], v235 offset:20480
    v_mfma_f32_16x16x32_bf16 v[20:23], v[80:83], v[128:131], v[20:23]
    ds_read_b64_tr_b16 v[78:79], v239 offset:20480
    s_waitcnt lgkmcnt(14)
    v_cmp_gt_u32 vcc, 4, v223
    s_cbranch_vccnz LB_w7
LB_g7:
    v_mfma_f32_16x16x32_bf16 v[24:27], v[48:51], v[128:131], v[24:27]
    s_nop 1
    v_cvt_pk_bf16_f32 v200, v32, v33
    s_waitcnt lgkmcnt(12)
    v_mfma_f32_16x16x32_bf16 v[24:27], v[52:55], v[132:135], v[24:27]
    v_cvt_pk_bf16_f32 v201, v34, v35
    v_cvt_pk_bf16_f32 v202, v36, v37
    s_waitcnt lgkmcnt(10)
    v_mfma_f32_16x16x32_bf16 v[24:27], v[56:59], v[136:139], v[24:27]
    v_cvt_pk_bf16_f32 v203, v38, v39
    v_permlane16_swap_b32 v200, v202
    s_waitcnt lgkmcnt(8)
    v_mfma_f32_16x16x32_bf16 v[24:27], v[60:63], v[140:143], v[24:27]
    v_permlane16_swap_b32 v201, v203
    ds_write_b128 v248, v[200:203] offset:2048
    v_mfma_f32_16x16x32_bf16 v[40:43], v[60:63], v[156:159], v[40:43]
    v_cvt_pk_bf16_f32 v192, v16, v17
    v_cvt_pk_bf16_f32 v193, v18, v19
    v_mfma_f32_16x16x32_bf16 v[40:43], v[56:59], v[152:155], v[40:43]
    v_cvt_pk_bf16_f32 v194, v20, v21
    v_cvt_pk_bf16_f32 v195, v22, v23
    v_mfma_f32_16x16x32_bf16 v[40:43], v[52:55], v[148:151], v[40:43]
    v_permlane16_swap_b32 v192, v194
    v_permlane16_swap_b32 v193, v195
    v_mfma_f32_16x16x32_bf16 v[40:43], v[48:51], v[144:147], v[40:43]
    ds_write_b128 v248, v[192:195] offset:0
    v_cvt_pk_bf16_f32 v196, v24, v25
    s_waitcnt lgkmcnt(8)
    v_mfma_f32_16x16x32_bf16 v[44:47], v[64:67], v[144:147], v[44:47]
    v_cvt_pk_bf16_f32 v197, v26, v27
    s_nop 0
    s_waitcnt lgkmcnt(6)
    v_mfma_f32_16x16x32_bf16 v[44:47], v[68:71], v[148:151], v[44:47]
    s_nop 1
    s_waitcnt lgkmcnt(4)
    v_mfma_f32_16x16x32_bf16 v[44:47], v[72:75], v[152:155], v[44:47]
    v_cvt_pk_bf16_f32 v204, v40, v41
    v_cvt_pk_bf16_f32 v205, v42, v43
    s_waitcnt lgkmcnt(2)
    v_mfma_f32_16x16x32_bf16 v[44:47], v[76:79], v[156:159], v[44:47]
    s_nop 1
    v_mfma_f32_16x16x32_bf16 v[28:31], v[76:79], v[140:143], v[28:31]
    s_nop 1
    v_mfma_f32_16x16x32_bf16 v[28:31], v[72:75], v[136:139], v[28:31]
    s_nop 1
    v_mfma_f32_16x16x32_bf16 v[28:31], v[68:71], v[132:135], v[28:31]
    v_cvt_pk_bf16_f32 v206, v44, v45
    v_cvt_pk_bf16_f32 v207, v46, v47
    v_mfma_f32_16x16x32_bf16 v[28:31], v[64:67], v[128:131], v[28:31]
    v_permlane16_swap_b32 v204, v206
    v_permlane16_swap_b32 v205, v207
    ds_write_b128 v249, v[204:207] offset:2048
    ds_read_b128 v[184:187], v250 offset:2048
    ds_read_b128 v[188:191], v250 offset:3072
    s_nop 2
    v_cvt_pk_bf16_f32 v198, v28, v29
    v_cvt_pk_bf16_f32 v199, v30, v31
    s_nop 0
    v_permlane16_swap_b32 v196, v198
    v_permlane16_swap_b32 v197, v199
    ds_write_b128 v249, v[196:199] offset:0
    ds_read_b128 v[176:179], v250 offset:0
    ds_read_b128 v[180:183], v250 offset:1024
    s_mov_b32 s95, 65536
    s_waitcnt lgkmcnt(4)
    buffer_store_dwordx4 v[184:187], v246, s[60:63], s95 offen nt sc1
    s_mov_b32 s95, 98304
    s_waitcnt lgkmcnt(3)
    buffer_store_dwordx4 v[188:191], v246, s[60:63], s95 offen nt sc1
    s_mov_b32 s95, 0
    s_waitcnt lgkmcnt(1)
    buffer_store_dwordx4 v[176:179], v246, s[60:63], s95 offen nt sc1
    s_mov_b32 s95, 32768
    s_waitcnt lgkmcnt(0)
    buffer_store_dwordx4 v[180:183], v246, s[60:63], s95 offen nt sc1
    s_endpgm
LA_slow:
    s_mov_b32 s79, 0
LA_slow1:
    s_mov_b64 exec, vcc
    s_sleep 8
    buffer_load_dword v136, v33, s[68:71], 0 offen sc1
    buffer_load_dword v137, v34, s[52:55], 0 offen sc1
    s_add_u32 s79, s79, 1
    s_cmp_gt_u32 s79, 200000
    s_waitcnt vmcnt(0)
    s_cbranch_scc1 LA_back
    v_cmp_ne_u32 vcc, v136, v137
    v_cmp_gt_u32 s[80:81], s96, v136
    s_nop 0
    s_or_b64 vcc, vcc, s[80:81]
    s_cbranch_vccnz LA_slow1
    s_branch LA_back
LB_tag:
    s_mov_b64 exec, 0xffff
    s_waitcnt vmcnt(0)
    v_lshrrev_b32 v251, v0, v251
    v_and_b32 v251, 1, v251
    v_cmp_eq_u32 vcc, 0, v251
    s_nop 1
    s_or_b32 s83, vcc_lo, 0x10000
    s_mov_b64 exec, 1
    v_mov_b32 v251, s83
    buffer_store_dword v251, v220, s[68:71], s98 offen sc1
    s_mov_b64 exec, -1
    s_branch LB_tagb
LB_slow:
    s_mov_b32 s79, 0
LB_pt:
    buffer_load_dword v222, v220, s[68:71], s98 offen sc1
    s_add_u32 s79, s79, 1
    s_cmp_gt_u32 s79, 200000
    s_cbranch_scc1 LB_pt_x
    s_waitcnt vmcnt(0)
    v_cmp_gt_u32 vcc, 4096, v222
    s_cbranch_vccz LB_pt_x
    s_mov_b64 exec, vcc
    s_sleep 8
    s_branch LB_pt
LB_pt_x:
    s_waitcnt vmcnt(0)
    s_branch LB_back
LB_w1:
    s_branch LB_s1_in
LB_s1:
    s_sleep 1
LB_s1_in:
    ds_read_b32 v223, v10 offset:0
    ds_read_b64 v[204:205], v218
    ds_read_b64 v[206:207], v219
    s_waitcnt lgkmcnt(0)
    v_readfirstlane_b32 s78, v223
    s_nop 0
    s_cmp_ge_u32 s78, 4
    s_cbranch_scc0 LB_s1
    s_branch LB_g1
LB_w6:
    s_branch LB_s6_in
LB_s6:
    s_sleep 1
LB_s6_in:
    ds_read_b32 v223, v10 offset:24
    ds_read_b64 v[224:225], v218 offset:1024
    ds_read_b64 v[234:235], v219 offset:1024
    s_waitcnt lgkmcnt(0)
    v_readfirstlane_b32 s78, v223
    s_nop 0
    s_cmp_ge_u32 s78, 4
    s_cbranch_scc0 LB_s6
    s_branch LB_g6
LB_w4:
    s_branch LB_s4_in
LB_s4:
    s_sleep 1
LB_s4_in:
    ds_read_b32 v222, v10 offset:16
    s_waitcnt lgkmcnt(0)
    v_readfirstlane_b32 s78, v222
    s_nop 0
    s_cmp_ge_u32 s78, 4
    s_cbranch_scc0 LB_s4
    s_branch LB_g4
LB_w8:
    s_branch LB_s8_in
LB_s8:
    s_sleep 1
LB_s8_in:
    ds_read_b32 v223, v10 offset:32
    s_waitcnt lgkmcnt(0)
    v_readfirstlane_b32 s78, v223
    s_nop 0
    s_cmp_ge_u32 s78, 4
    s_cbranch_scc0 LB_s8
    s_branch LB_g8
LB_w7:
    s_branch LB_s7_in
LB_s7:
    s_sleep 1
LB_s7_in:
    ds_read_b32 v223, v10 offset:40
    s_waitcnt lgkmcnt(0)
    v_readfirstlane_b32 s78, v223
    s_nop 0
    s_cmp_ge_u32 s78, 4
    s_cbranch_scc0 LB_s7
    s_branch LB_g7
L_end:
    s_endpgm
.section .rodata,"a"
.p2align 6
.amdhsa_kernel concat_heads__ssm_conv_h3__sliding_local_dilated__prompt_kernel
  .amdhsa_next_free_vgpr 256
  .amdhsa_next_free_sgpr 102
  .amdhsa_accum_offset 256
  .amdhsa_group_segment_fixed_size 0
  .amdhsa_kernarg_size 96
  .amdhsa_user_sgpr_count 2
  .amdhsa_user_sgpr_kernarg_segment_ptr 1
  .amdhsa_system_sgpr_workgroup_id_x 1
.end_amdhsa_kernel
```

```asm
; @launch grid=(256,1,1) block=(512,1,1) lds=163840
.amdgcn_target "amdgcn-amd-amdhsa--gfx950"
.text
.globl concat_heads__ssm_conv_h3__sliding_local_dilated__prompt_kernel
.p2align 8
.type concat_heads__ssm_conv_h3__sliding_local_dilated__prompt_kernel,@function
concat_heads__ssm_conv_h3__sliding_local_dilated__prompt_kernel:
    s_cmp_ge_u32 s2, 256
    s_cbranch_scc1 L_end
    s_load_dwordx2 s[28:29], s[0:1], 48
    s_load_dwordx2 s[32:33], s[0:1], 56
    s_load_dwordx8 s[4:11], s[0:1], 0
    s_load_dwordx4 s[12:15], s[0:1], 32
    s_load_dwordx8 s[20:27], s[0:1], 64
    v_lshrrev_b32 v1, 6, v0
    v_and_b32 v0, 63, v0
    v_readfirstlane_b32 s3, v1
    s_nop 0
    s_cmp_lg_u32 s3, 4
    s_cbranch_scc1 L_nopf
    s_getpc_b64 s[80:81]
L_pc:
    s_bfe_u32 s78, s2, 0x40003
    v_lshl_add_u32 v1, v0, 4, s78
    v_lshlrev_b32 v1, 7, v1
    v_cmp_gt_u32 vcc, L_end-L_pc, v1
    s_nop 0
    s_and_saveexec_b64 s[82:83], vcc
    global_load_dword v222, v1, s[80:81]
    s_mov_b64 exec, -1
L_nopf:
    s_and_b32 s78, s2, 7
    s_lshr_b32 s79, s2, 3
    s_and_b32 s80, s78, 1
    s_lshl_b32 s80, s80, 3
    s_lshr_b32 s81, s78, 1
    s_lshl_b32 s81, s81, 2
    s_and_b32 s72, s79, 7
    s_add_u32 s72, s72, s80
    s_lshr_b32 s73, s79, 3
    s_xor_b32 s73, s73, 3
    s_add_u32 s73, s73, s81
    s_cmp_ge_u32 s3, 4
    s_cbranch_scc1 L_B
    v_lshrrev_b32 v5, 3, v0
    v_and_b32 v6, 7, v0
    v_lshrrev_b32 v7, 4, v0
    s_lshl_b32 s79, s72, 7
    s_lshl_b32 s80, s3, 5
    s_add_u32 s81, s79, s80
    v_xor_b32 v8, v7, v6
    v_lshlrev_b32 v8, 4, v8
    v_add_u32 v240, s81, v5
    v_lshl_add_u32 v240, v240, 11, v8
    v_xor_b32 v241, 64, v240
    v_add_u32 v241, 15360, v241
    v_add_u32 v242, 30720, v240
    v_add_u32 v243, 30720, v241
    s_lshl_b32 s87, s3, 12
    s_add_u32 s87, s87, 75776
    s_and_b32 s98, s73, 12
    s_and_b32 s78, s72, 8
    s_add_u32 s98, s98, s78
    s_add_u32 s101, s72, s73
    s_and_b32 s101, s101, 3
    s_lshl_b32 s78, s101, 2
    s_lshr_b32 s97, 0x101, s78
    s_add_u32 s97, s97, s98
    s_and_b32 s97, s97, 15
    s_mov_b32 m0, s87
    s_lshl_b32 s97, s97, 7
    s_mov_b32 s30, 0x400000
    s_mov_b32 s31, 0x20000
    s_waitcnt lgkmcnt(0)
    buffer_load_dwordx4 v240, s[28:31], s97 offen offset:0  lds
    s_and_b32 s78, s3, 1
    s_lshl_b32 s78, s78, 2
    s_lshl_b32 s80, s3, 3
    v_and_b32 v8, 1, v7
    v_lshl_or_b32 v8, v8, 1, s78
    v_xor_b32 v8, v8, v6
    buffer_load_dwordx4 v241, s[28:31], s97 offen offset:1024  lds
    v_lshlrev_b32 v8, 4, v8
    v_add_u32 v244, s80, v5
    v_mul_u32_u24 v244, 6144, v244
    s_lshl_b32 s82, s73, 7
    v_add3_u32 v244, v244, v8, s82
    buffer_load_dwordx4 v242, s[28:31], s97 offen offset:2048  lds
    v_add_u32 v245, 1024, v244
    v_add_u32 v246, 2048, v244
    s_bfe_u32 s62, s72, 0x10002
    s_mul_i32 s78, s62, 12288
    s_mul_i32 s80, s3, 3072
    s_add_u32 s60, s80, s78
    buffer_load_dwordx4 v243, s[28:31], s97 offen offset:3072  lds
    s_sub_u32 s61, s80, s78
    s_mul_i32 s62, s62, 196608
    s_sub_u32 s63, 196608, s62
    s_mov_b32 s34, 0x600000
    s_mov_b32 s35, 0x20000
    s_mul_i32 s16, s97, 3072
    s_add_u32 m0, s60, 0
    s_add_u32 s99, s16, s62
    buffer_load_dwordx4 v244, s[32:35], s99 offen offset:0  lds
    s_lshl_b32 s78, s3, 1
    s_lshl_b32 s80, s3, 2
    s_add_u32 s79, s79, s80
    s_sub_u32 s79, s79, 16
    v_add_u32 v8, s78, v7
    buffer_load_dwordx4 v245, s[32:35], s99 offen offset:1024  lds
    v_xor_b32 v8, v8, v6
    v_and_b32 v8, 7, v8
    v_lshlrev_b32 v8, 4, v8
    v_add_u32 v3, s79, v5
    buffer_load_dwordx4 v246, s[32:35], s99 offen offset:2048  lds
    v_lshl_add_u32 v3, v3, 11, v8
    s_lshl_b32 s86, s3, 10
    s_lshl_b32 s88, s3, 9
    s_add_u32 s88, s88, 73728
    s_add_u32 m0, s88, 0
    s_mov_b64 exec, 0xffffffff
    buffer_load_dwordx4 v3, s[28:31], s97 offen offset:0  lds
    s_mov_b64 exec, -1
    s_add_u32 m0, s61, 12288
    s_add_u32 s16, s16, s63
    buffer_load_dwordx4 v244, s[32:35], s16 offen offset:0  lds
    buffer_load_dwordx4 v245, s[32:35], s16 offen offset:1024  lds
    buffer_load_dwordx4 v246, s[32:35], s16 offen offset:2048  lds
    s_mov_b32 s0, 0x76583240
    s_mov_b32 s1, 0xfedba9c
    s_cmp_eq_u32 s101, 1
    s_cselect_b32 s0, 0x76943251, s0
    s_cselect_b32 s1, 0xfecbda8, s1
    s_cmp_eq_u32 s101, 2
    s_cselect_b32 s0, 0x7a543602, s0
    s_cselect_b32 s1, 0xfdceb98, s1
    s_cmp_eq_u32 s101, 3
    s_cselect_b32 s0, 0xb6547213, s0
    s_cselect_b32 s1, 0xedfca98, s1
    s_and_b32 s78, s73, 7
    s_cmp_lg_u32 s78, 3
    s_cbranch_scc1 LA_nb
    s_cmp_eq_u32 s101, 2
    s_cselect_b32 s0, 0x87654302, s0
    s_cselect_b32 s1, 0xfdceba9, s1
    s_cmp_eq_u32 s101, 3
    s_cselect_b32 s0, 0x87654213, s0
    s_cselect_b32 s1, 0xedfcba9, s1
LA_nb:
    s_add_u32 s79, s72, s73
    s_add_u32 s78, s72, 5
    s_and_b32 s78, s78, 7
    s_lshl_b32 s78, s78, 1
    s_and_b32 s75, s79, 1
    s_add_u32 s78, s78, s75
    s_andn2_b32 s79, 2, s79
    s_lshl_b32 s79, s79, 3
    s_add_u32 s78, s78, s79
    s_and_b32 s76, s78, 3
    s_and_b32 s79, s73, 12
    s_add_u32 s76, s76, s79
    s_lshr_b32 s74, s78, 4
    s_add_u32 s74, s74, s79
    s_and_b32 s79, s72, 8
    s_lshr_b32 s77, s78, 2
    s_add_u32 s77, s77, s79
    s_lshr_b32 s79, s79, 2
    s_add_u32 s74, s74, s79
    s_xor_b32 s74, s74, 4
    s_and_b32 s75, s78, 15
    s_add_u32 s97, s98, s0
    s_lshr_b64 s[0:1], s[0:1], 4
    s_and_b32 s97, s97, 15
    s_add_u32 m0, s87, 18432
    s_lshl_b32 s97, s97, 7
    buffer_load_dwordx4 v240, s[28:31], s97 offen offset:0  lds
    s_mov_b32 s36, s6
    s_mov_b32 s37, s7
    s_mov_b32 s38, 0x400000
    s_mov_b32 s39, 0x20000
    s_mov_b32 s40, s8
    s_mov_b32 s41, s9
    s_mov_b32 s42, 0x400000
    s_mov_b32 s43, 0x20000
    s_mov_b32 s44, s10
    s_mov_b32 s45, s11
    s_mov_b32 s46, 0x2000
    s_mov_b32 s47, 0x20000
    v_lshlrev_b32 v15, 4, v0
    v_and_b32 v7, 7, v0
    s_lshl_b32 s79, s74, 7
    v_lshl_add_u32 v7, v7, 4, s79
    s_lshl_b32 s78, s75, 7
    s_lshl_b32 s80, s3, 3
    s_add_u32 s80, s80, s78
    v_lshrrev_b32 v5, 3, v0
    s_and_b32 s79, s3, 1
    v_xor_b32 v5, s79, v5
    v_add_u32 v5, s80, v5
    v_lshl_add_u32 v10, v5, 11, v7
    s_xor_b32 s80, s3, 1
    s_add_u32 s80, s78, s80
    s_sub_u32 s80, s80, 4
    s_lshl_b32 s80, s80, 11
    v_add_u32 v11, s80, v7
    s_mov_b32 s52, s26
    s_mov_b32 s53, s27
    s_mov_b32 s54, 0x1800000
    s_mov_b32 s55, 0x20000
    v_and_b32 v7, 7, v0
    s_lshl_b32 s79, s74, 7
    v_lshl_add_u32 v7, v7, 4, s79
    s_lshl_b32 s78, s75, 7
    v_bfe_u32 v5, v0, 3, 2
    v_lshrrev_b32 v6, 5, v0
    s_lshl_b32 s80, s3, 5
    v_lshlrev_b32 v8, 3, v5
    v_lshl_add_u32 v8, v6, 2, v8
    v_add_u32 v8, s80, v8
    v_and_b32 v35, 7, v0
    v_lshl_add_u32 v16, v35, 1, v6
    v_lshlrev_b32 v232, 5, v16
    v_lshlrev_b32 v16, 3, v16
    v_lshl_add_u32 v16, v5, 10, v16
    v_and_b32 v231, 1, v5
    v_lshl_add_u32 v16, v231, 7, v16
    s_lshl_b32 s79, s3, 12
    s_add_u32 s79, s79, 129024
    v_add_u32 v16, s79, v16
    v_xor_b32 v231, 128, v16
    v_lshrrev_b32 v35, 2, v35
    v_lshl_add_u32 v35, v35, 4, v232
    v_add_u32 v35, 162816, v35
    v_add_u32 v8, s78, v8
    v_lshl_add_u32 v9, v8, 11, v7
    v_lshl_add_u32 v13, v8, 12, v7
    v_bfe_u32 v8, v0, 2, 1
    v_lshlrev_b32 v8, 1, v8
    v_add_u32 v8, v8, v6
    v_lshlrev_b32 v8, 16, v8
    v_lshl_add_u32 v8, v5, 6, v8
    v_and_b32 v7, 3, v0
    v_lshl_add_u32 v8, v7, 4, v8
    s_add_u32 s78, s78, s80
    s_lshl_b32 s78, s78, 3
    s_lshl_b32 s79, s74, 18
    s_add_u32 s78, s78, s79
    v_add_u32 v12, s78, v8
    s_mov_b32 s48, s12
    s_mov_b32 s49, s13
    s_mov_b32 s50, 0x400000
    s_mov_b32 s51, 0x20000
    s_mov_b32 s56, s4
    s_mov_b32 s57, s5
    s_mov_b32 s58, 0x400000
    s_mov_b32 s59, 0x20000
    s_mov_b32 s64, s20
    s_mov_b32 s65, s21
    s_mov_b32 s66, 0x200000
    s_mov_b32 s67, 0x20000
    s_lshl_b32 s91, s74, 4
    s_add_u32 s91, s91, s75
    s_lshr_b32 s78, s91, 3
    s_lshl_b32 s78, s78, 5
    s_and_b32 s79, s91, 7
    s_add_u32 s78, s78, s79
    s_lshl_b32 s79, s3, 3
    s_add_u32 s90, s78, s79
    s_lshl_b32 s91, s91, 14
    s_mov_b32 s96, 4096
    s_mul_i32 s94, s3, 8320
    s_add_u32 s94, s94, 129024
    v_mov_b32 v229, 0
    s_mov_b64 s[4:5], s[64:65]
    s_mov_b32 s6, 0x0
    s_mov_b32 s7, 0x20000
    v_mov_b32 v228, 0x40000000
    s_bitcmp1_b32 s73, 2
    s_cbranch_scc1 LA_nh0
    s_mov_b64 s[4:5], s[28:29]
    s_mov_b32 s6, 0x400000
    v_mov_b32 v229, 0x40000000
    s_and_b32 s78, s73, 3
    s_cmp_eq_u32 s78, 3
    s_cbranch_scc1 LA_nh0
    s_and_b32 s79, s101, 2
    s_add_u32 s78, s72, 1
    s_add_u32 s78, s78, s79
    s_and_b32 s78, s78, 3
    s_bfe_u32 s80, s72, 0x10002
    s_and_b32 s81, s101, 1
    s_lshl_b32 s81, s81, 2
    s_add_u32 s81, s81, s79
    s_lshl_b32 s82, s78, 1
    s_cmp_lt_u32 s78, 2
    s_cselect_b32 s79, 12, 24
    s_cselect_b32 s82, s82, 0
    s_cselect_b32 s83, 6, 7
    s_add_u32 s81, s81, s83
    s_add_u32 s80, s80, s82
    s_lshl_b32 s80, s80, 2
    s_add_u32 s80, s80, s3
    s_mul_i32 s80, s80, s79
    s_add_u32 s82, s81, s78
    s_add_u32 s81, s81, s98
    s_and_b32 s81, s81, 15
    s_mul_i32 s81, s81, 192
    s_add_u32 s80, s80, s81
    s_or_b32 s81, s73, 3
    s_lshl_b32 s81, s81, 7
    v_add_u32 v5, s80, v0
    v_lshl_add_u32 v5, v5, 11, s81
    v_cmp_gt_u32 vcc, s79, v0
    s_nop 1
    v_cndmask_b32 v228, v228, v5, vcc
    s_cmp_ge_u32 s78, 2
    s_cbranch_scc1 LA_nh0
    s_add_u32 s82, s82, s98
    s_and_b32 s82, s82, 15
    s_lshl_b32 s78, s82, 7
    s_lshl_b32 s79, s72, 7
    s_mul_i32 s80, s3, 36
    s_add_u32 s79, s79, s80
    s_sub_u32 s79, s79, 16
    v_add_u32 v5, s79, v0
    v_lshl_add_u32 v5, v5, 11, s78
    v_cmp_gt_u32 vcc, 36, v0
    s_nop 1
    v_cndmask_b32 v229, v229, v5, vcc
LA_nh0:
    buffer_load_dwordx4 v241, s[28:31], s97 offen offset:1024  lds
    buffer_load_dwordx4 v242, s[28:31], s97 offen offset:2048  lds
    buffer_load_dwordx4 v243, s[28:31], s97 offen offset:3072  lds
    s_add_u32 m0, s88, 18432
    s_mov_b64 exec, 0xffffffff
    buffer_load_dwordx4 v3, s[28:31], s97 offen offset:0  lds
    s_mov_b64 exec, -1
    s_mul_i32 s16, s97, 3072
    s_add_u32 m0, s60, 24576
    s_add_u32 s99, s16, s62
    buffer_load_dwordx4 v244, s[32:35], s99 offen offset:0  lds
    buffer_load_dwordx4 v245, s[32:35], s99 offen offset:1024  lds
    buffer_load_dwordx4 v246, s[32:35], s99 offen offset:2048  lds
    s_add_u32 m0, s61, 36864
    s_add_u32 s16, s16, s63
    buffer_load_dwordx4 v244, s[32:35], s16 offen offset:0  lds
    buffer_load_dwordx4 v245, s[32:35], s16 offen offset:1024  lds
    buffer_load_dwordx4 v246, s[32:35], s16 offen offset:2048  lds
    s_waitcnt vmcnt(11)
    s_barrier
    s_add_u32 s97, s98, s0
    s_lshr_b64 s[0:1], s[0:1], 4
    s_and_b32 s97, s97, 15
    s_add_u32 m0, s87, 36864
    s_lshl_b32 s97, s97, 7
    buffer_load_dwordx4 v240, s[28:31], s97 offen offset:0  lds
    buffer_load_dwordx4 v241, s[28:31], s97 offen offset:1024  lds
    s_cmp_eq_u32 s101, 1
    s_cbranch_scc1 LA_c1
    s_cmp_eq_u32 s101, 2
    s_cbranch_scc1 LA_c2
    s_cmp_eq_u32 s101, 3
    s_cbranch_scc1 LA_c3
LA_c0:
    s_waitcnt vmcnt(8)
    s_barrier
    buffer_load_dwordx4 v242, s[28:31], s97 offen offset:2048  lds
    buffer_load_dwordx4 v243, s[28:31], s97 offen offset:3072  lds
    s_add_u32 m0, s88, 36864
    s_mov_b64 exec, 0xffffffff
    buffer_load_dwordx4 v3, s[28:31], s97 offen offset:0  lds
    s_mov_b64 exec, -1
    s_mul_i32 s16, s97, 3072
    s_add_u32 m0, s60, 49152
    s_add_u32 s99, s16, s62
    buffer_load_dwordx4 v244, s[32:35], s99 offen offset:0  lds
    buffer_load_dwordx4 v245, s[32:35], s99 offen offset:1024  lds
    buffer_load_dwordx4 v246, s[32:35], s99 offen offset:2048  lds
    s_add_u32 m0, s61, 61440
    s_add_u32 s16, s16, s63
    buffer_load_dwordx4 v244, s[32:35], s16 offen offset:0  lds
    buffer_load_dwordx4 v245, s[32:35], s16 offen offset:1024  lds
    buffer_load_dwordx4 v246, s[32:35], s16 offen offset:2048  lds
    s_add_u32 s97, s98, s0
    s_lshr_b64 s[0:1], s[0:1], 4
    s_and_b32 s97, s97, 15
    s_add_u32 m0, s87, 0
    s_lshl_b32 s97, s97, 7
    buffer_load_dwordx4 v240, s[28:31], s97 offen offset:0  lds
    buffer_load_dwordx4 v241, s[28:31], s97 offen offset:1024  lds
    buffer_load_dwordx4 v242, s[28:31], s97 offen offset:2048  lds
    buffer_load_dwordx4 v243, s[28:31], s97 offen offset:3072  lds
    s_add_u32 m0, s88, 0
    s_mov_b64 exec, 0xffffffff
    buffer_load_dwordx4 v3, s[28:31], s97 offen offset:0  lds
    s_mov_b64 exec, -1
    s_waitcnt vmcnt(11)
    s_barrier
    s_mul_i32 s16, s97, 3072
    s_add_u32 m0, s60, 0
    s_add_u32 s99, s16, s62
    buffer_load_dwordx4 v244, s[32:35], s99 offen offset:0  lds
    buffer_load_dwordx4 v245, s[32:35], s99 offen offset:1024  lds
    buffer_load_dwordx4 v246, s[32:35], s99 offen offset:2048  lds
    s_add_u32 m0, s61, 12288
    s_add_u32 s16, s16, s63
    buffer_load_dwordx4 v244, s[32:35], s16 offen offset:0  lds
    buffer_load_dwordx4 v245, s[32:35], s16 offen offset:1024  lds
    buffer_load_dwordx4 v246, s[32:35], s16 offen offset:2048  lds
    s_add_u32 m0, s86, 129536
    s_mov_b32 s89, 0
    buffer_load_dwordx4 v10, s[36:39], s89 offen nt lds
    s_add_u32 m0, s86, 145920
    s_mov_b32 s89, 0
    buffer_load_dwordx4 v10, s[40:43], s89 offen nt lds
    s_add_u32 m0, s86, 133632
    s_mov_b32 s89, 65536
    buffer_load_dwordx4 v10, s[36:39], s89 offen nt lds
    s_add_u32 m0, s86, 150016
    s_mov_b32 s89, 65536
    buffer_load_dwordx4 v10, s[40:43], s89 offen nt lds
    s_add_u32 m0, s86, 137728
    s_mov_b32 s89, 131072
    buffer_load_dwordx4 v10, s[36:39], s89 offen nt lds
    s_add_u32 m0, s86, 154112
    s_mov_b32 s89, 131072
    buffer_load_dwordx4 v10, s[40:43], s89 offen nt lds
    s_add_u32 m0, s86, 141824
    s_mov_b32 s89, 196608
    buffer_load_dwordx4 v10, s[36:39], s89 offen nt lds
    s_add_u32 m0, s86, 158208
    s_mov_b32 s89, 196608
    buffer_load_dwordx4 v10, s[40:43], s89 offen nt lds
    s_mov_b64 exec, 0xff
    s_lshl_b32 s82, s3, 7
    s_add_u32 m0, s82, 129024
    s_mov_b32 s89, 0
    buffer_load_dwordx4 v11, s[36:39], s89 offen nt lds
    s_lshl_b32 s83, s74, 9
    s_add_u32 s83, s83, s82
    s_and_b32 s89, s3, 2
    s_lshl_b32 s89, s89, 3
    s_add_u32 s82, s82, s89
    s_add_u32 m0, s82, 162816
    s_add_u32 s89, s83, 0
    buffer_load_dwordx4 v15, s[44:47], s89 offen  lds
    s_mov_b64 exec, -1
    s_add_u32 s97, s98, s0
    s_lshr_b64 s[0:1], s[0:1], 4
    s_and_b32 s97, s97, 15
    s_add_u32 m0, s87, 18432
    s_lshl_b32 s97, s97, 7
    buffer_load_dwordx4 v240, s[28:31], s97 offen offset:0  lds
    buffer_load_dwordx4 v241, s[28:31], s97 offen offset:1024  lds
    buffer_load_dwordx4 v242, s[28:31], s97 offen offset:2048  lds
    buffer_load_dwordx4 v243, s[28:31], s97 offen offset:3072  lds
    s_add_u32 m0, s88, 18432
    s_mov_b64 exec, 0xffffffff
    buffer_load_dwordx4 v3, s[28:31], s97 offen offset:0  lds
    s_mov_b64 exec, -1
    s_waitcnt vmcnt(21)
    s_barrier
    s_mul_i32 s16, s97, 3072
    s_add_u32 m0, s60, 24576
    s_add_u32 s99, s16, s62
    buffer_load_dwordx4 v244, s[32:35], s99 offen offset:0  lds
    buffer_load_dwordx4 v245, s[32:35], s99 offen offset:1024  lds
    buffer_load_dwordx4 v246, s[32:35], s99 offen offset:2048  lds
    s_add_u32 m0, s61, 36864
    s_add_u32 s16, s16, s63
    buffer_load_dwordx4 v244, s[32:35], s16 offen offset:0  lds
    buffer_load_dwordx4 v245, s[32:35], s16 offen offset:1024  lds
    buffer_load_dwordx4 v246, s[32:35], s16 offen offset:2048  lds
    buffer_load_dword v230, v229, s[4:7], 0 offen
    buffer_load_dword v230, v228, s[32:35], 0 offen
    s_add_u32 s97, s98, s0
    s_lshr_b64 s[0:1], s[0:1], 4
    s_and_b32 s97, s97, 15
    s_add_u32 m0, s87, 36864
    s_lshl_b32 s97, s97, 7
    buffer_load_dwordx4 v240, s[28:31], s97 offen offset:0  lds
    buffer_load_dwordx4 v241, s[28:31], s97 offen offset:1024  lds
    buffer_load_dwordx4 v242, s[28:31], s97 offen offset:2048  lds
    buffer_load_dwordx4 v243, s[28:31], s97 offen offset:3072  lds
    s_add_u32 m0, s88, 36864
    s_mov_b64 exec, 0xffffffff
    buffer_load_dwordx4 v3, s[28:31], s97 offen offset:0  lds
    s_mov_b64 exec, -1
    s_waitcnt vmcnt(13)
    s_barrier
    s_mul_i32 s16, s97, 3072
    s_add_u32 m0, s60, 49152
    s_add_u32 s99, s16, s62
    buffer_load_dwordx4 v244, s[32:35], s99 offen offset:0  lds
    ds_read_b128 v[84:87], v35 offset:0
    ds_read_b128 v[88:91], v35 offset:16
    buffer_load_dwordx4 v245, s[32:35], s99 offen offset:1024  lds
    ds_read_b64 v[40:41], v16 offset:0
    ds_read_b64 v[42:43], v231 offset:256
    buffer_load_dwordx4 v246, s[32:35], s99 offen offset:2048  lds
    ds_read_b64 v[44:45], v16 offset:256
    ds_read_b64 v[46:47], v16 offset:512
    s_add_u32 m0, s61, 61440
    s_add_u32 s16, s16, s63
    buffer_load_dwordx4 v244, s[32:35], s16 offen offset:0  lds
    ds_read_b64 v[48:49], v231 offset:512
    ds_read_b64 v[50:51], v16 offset:768
    buffer_load_dwordx4 v245, s[32:35], s16 offen offset:1024  lds
    ds_read_b64 v[52:53], v231 offset:768
    ds_read_b64 v[54:55], v16 offset:1024
    buffer_load_dwordx4 v246, s[32:35], s16 offen offset:2048  lds
    ds_read_b64 v[56:57], v231 offset:1024
    ds_read_b64 v[58:59], v16 offset:1280
    s_add_u32 s97, s98, s0
    s_lshr_b64 s[0:1], s[0:1], 4
    s_and_b32 s97, s97, 15
    s_add_u32 m0, s87, 0
    s_lshl_b32 s97, s97, 7
    buffer_load_dwordx4 v240, s[28:31], s97 offen offset:0  lds
    ds_read_b64 v[60:61], v231 offset:1280
    ds_read_b64 v[68:69], v16 offset:16896
    buffer_load_dwordx4 v241, s[28:31], s97 offen offset:1024  lds
    ds_read_b64 v[70:71], v231 offset:16896
    ds_read_b64 v[72:73], v16 offset:17152
    buffer_load_dwordx4 v242, s[28:31], s97 offen offset:2048  lds
    ds_read_b64 v[74:75], v231 offset:17152
    ds_read_b64 v[76:77], v16 offset:17408
    buffer_load_dwordx4 v243, s[28:31], s97 offen offset:3072  lds
    ds_read_b64 v[78:79], v231 offset:17408
    ds_read_b64 v[80:81], v16 offset:17664
    s_add_u32 m0, s88, 0
    s_mov_b64 exec, 0xffffffff
    buffer_load_dwordx4 v3, s[28:31], s97 offen offset:0  lds
    s_mov_b64 exec, -1
    ds_read_b64 v[82:83], v231 offset:17664
    s_waitcnt vmcnt(11)
    s_waitcnt lgkmcnt(0)
    s_barrier
    s_mul_i32 s16, s97, 3072
    s_add_u32 m0, s60, 0
    s_add_u32 s99, s16, s62
    buffer_load_dwordx4 v244, s[32:35], s99 offen offset:0  lds
    v_lshlrev_b32 v160, 16, v40
    v_lshlrev_b32 v161, 16, v42
    v_lshlrev_b32 v162, 16, v44
    v_lshlrev_b32 v163, 16, v46
    v_lshlrev_b32 v164, 16, v48
    buffer_load_dwordx4 v245, s[32:35], s99 offen offset:1024  lds
    v_lshlrev_b32 v165, 16, v50
    v_lshlrev_b32 v166, 16, v52
    v_lshlrev_b32 v167, 16, v54
    v_lshlrev_b32 v168, 16, v56
    v_lshlrev_b32 v169, 16, v58
    buffer_load_dwordx4 v246, s[32:35], s99 offen offset:2048  lds
    v_lshlrev_b32 v170, 16, v60
    v_lshlrev_b32 v172, 16, v84
    v_and_b32 v173, 0xffff0000, v84
    v_lshlrev_b32 v174, 16, v85
    v_and_b32 v175, 0xffff0000, v85
    s_add_u32 m0, s61, 12288
    s_add_u32 s16, s16, s63
    buffer_load_dwordx4 v244, s[32:35], s16 offen offset:0  lds
    v_lshlrev_b32 v176, 16, v68
    v_lshlrev_b32 v177, 16, v70
    v_lshlrev_b32 v178, 16, v72
    v_lshlrev_b32 v179, 16, v74
    v_lshlrev_b32 v180, 16, v76
    buffer_load_dwordx4 v245, s[32:35], s16 offen offset:1024  lds
    v_lshlrev_b32 v181, 16, v78
    v_lshlrev_b32 v182, 16, v80
    v_lshlrev_b32 v183, 16, v82
    v_mul_f32 v184, v160, v175
    v_mul_f32 v185, v161, v175
    buffer_load_dwordx4 v246, s[32:35], s16 offen offset:2048  lds
    v_mul_f32 v186, v162, v175
    v_mul_f32 v187, v163, v175
    v_mul_f32 v188, v164, v175
    v_mul_f32 v189, v165, v175
    v_mul_f32 v190, v166, v175
    s_add_u32 s97, s98, s0
    s_lshr_b64 s[0:1], s[0:1], 4
    s_and_b32 s97, s97, 15
    s_add_u32 m0, s87, 18432
    s_lshl_b32 s97, s97, 7
    buffer_load_dwordx4 v240, s[28:31], s97 offen offset:0  lds
    v_mul_f32 v191, v167, v175
    v_fmac_f32 v184, v161, v174
    v_fmac_f32 v185, v162, v174
    v_fmac_f32 v186, v163, v174
    v_fmac_f32 v187, v164, v174
    buffer_load_dwordx4 v241, s[28:31], s97 offen offset:1024  lds
    v_fmac_f32 v188, v165, v174
    v_fmac_f32 v189, v166, v174
    v_fmac_f32 v190, v167, v174
    v_fmac_f32 v191, v168, v174
    v_fmac_f32 v184, v162, v173
    buffer_load_dwordx4 v242, s[28:31], s97 offen offset:2048  lds
    v_fmac_f32 v185, v163, v173
    v_fmac_f32 v186, v164, v173
    v_fmac_f32 v187, v165, v173
    v_fmac_f32 v188, v166, v173
    v_fmac_f32 v189, v167, v173
    buffer_load_dwordx4 v243, s[28:31], s97 offen offset:3072  lds
    v_fmac_f32 v190, v168, v173
    v_fmac_f32 v191, v169, v173
    v_fmac_f32 v184, v163, v172
    v_fmac_f32 v185, v164, v172
    v_fmac_f32 v186, v165, v172
    s_add_u32 m0, s88, 18432
    s_mov_b64 exec, 0xffffffff
    buffer_load_dwordx4 v3, s[28:31], s97 offen offset:0  lds
    s_mov_b64 exec, -1
    v_fmac_f32 v187, v166, v172
    v_fmac_f32 v188, v167, v172
    v_fmac_f32 v189, v168, v172
    v_fmac_f32 v190, v169, v172
    v_fmac_f32 v191, v170, v172
    v_mul_f32 v184, v184, v176
    v_mul_f32 v185, v185, v177
    v_mul_f32 v186, v186, v178
    v_mul_f32 v187, v187, v179
    v_mul_f32 v188, v188, v180
    v_mul_f32 v189, v189, v181
    v_mul_f32 v190, v190, v182
    v_mul_f32 v191, v191, v183
    v_cvt_pk_bf16_f32 v100, v191, v190
    v_cvt_pk_bf16_f32 v101, v189, v188
    v_cvt_pk_bf16_f32 v102, v187, v186
    v_cvt_pk_bf16_f32 v103, v185, v184
    s_mov_b32 s89, 0
    buffer_store_dwordx4 v[100:103], v12, s[52:55], s89 offen sc1
    v_and_b32 v160, 0xffff0000, v40
    v_and_b32 v161, 0xffff0000, v42
    v_and_b32 v162, 0xffff0000, v44
    v_and_b32 v163, 0xffff0000, v46
    v_and_b32 v164, 0xffff0000, v48
    v_and_b32 v165, 0xffff0000, v50
    v_and_b32 v166, 0xffff0000, v52
    v_and_b32 v167, 0xffff0000, v54
    v_and_b32 v168, 0xffff0000, v56
    v_and_b32 v169, 0xffff0000, v58
    v_and_b32 v170, 0xffff0000, v60
    v_lshlrev_b32 v172, 16, v86
    v_and_b32 v173, 0xffff0000, v86
    v_lshlrev_b32 v174, 16, v87
    v_and_b32 v175, 0xffff0000, v87
    v_and_b32 v176, 0xffff0000, v68
    v_and_b32 v177, 0xffff0000, v70
    v_and_b32 v178, 0xffff0000, v72
    v_and_b32 v179, 0xffff0000, v74
    v_and_b32 v180, 0xffff0000, v76
    v_and_b32 v181, 0xffff0000, v78
    v_and_b32 v182, 0xffff0000, v80
    v_and_b32 v183, 0xffff0000, v82
    s_waitcnt vmcnt(12)
    s_barrier
    s_mul_i32 s16, s97, 3072
    s_add_u32 m0, s60, 24576
    s_add_u32 s99, s16, s62
    buffer_load_dwordx4 v244, s[32:35], s99 offen offset:0  lds
    v_mul_f32 v184, v160, v175
    v_mul_f32 v185, v161, v175
    v_mul_f32 v186, v162, v175
    v_mul_f32 v187, v163, v175
    v_mul_f32 v188, v164, v175
    buffer_load_dwordx4 v245, s[32:35], s99 offen offset:1024  lds
    v_mul_f32 v189, v165, v175
    v_mul_f32 v190, v166, v175
    v_mul_f32 v191, v167, v175
    v_fmac_f32 v184, v161, v174
    v_fmac_f32 v185, v162, v174
    buffer_load_dwordx4 v246, s[32:35], s99 offen offset:2048  lds
    v_fmac_f32 v186, v163, v174
    v_fmac_f32 v187, v164, v174
    v_fmac_f32 v188, v165, v174
    v_fmac_f32 v189, v166, v174
    v_fmac_f32 v190, v167, v174
    s_add_u32 m0, s61, 36864
    s_add_u32 s16, s16, s63
    buffer_load_dwordx4 v244, s[32:35], s16 offen offset:0  lds
    v_fmac_f32 v191, v168, v174
    v_fmac_f32 v184, v162, v173
    v_fmac_f32 v185, v163, v173
    v_fmac_f32 v186, v164, v173
    v_fmac_f32 v187, v165, v173
    buffer_load_dwordx4 v245, s[32:35], s16 offen offset:1024  lds
    v_fmac_f32 v188, v166, v173
    v_fmac_f32 v189, v167, v173
    v_fmac_f32 v190, v168, v173
    v_fmac_f32 v191, v169, v173
    v_fmac_f32 v184, v163, v172
    buffer_load_dwordx4 v246, s[32:35], s16 offen offset:2048  lds
    v_fmac_f32 v185, v164, v172
    v_fmac_f32 v186, v165, v172
    v_fmac_f32 v187, v166, v172
    v_fmac_f32 v188, v167, v172
    v_fmac_f32 v189, v168, v172
    s_add_u32 s97, s98, s0
    s_lshr_b64 s[0:1], s[0:1], 4
    s_and_b32 s97, s97, 15
    s_add_u32 m0, s87, 36864
    s_lshl_b32 s97, s97, 7
    buffer_load_dwordx4 v240, s[28:31], s97 offen offset:0  lds
    v_fmac_f32 v190, v169, v172
    v_fmac_f32 v191, v170, v172
    v_mul_f32 v184, v184, v176
    v_mul_f32 v185, v185, v177
    v_mul_f32 v186, v186, v178
    buffer_load_dwordx4 v241, s[28:31], s97 offen offset:1024  lds
    v_mul_f32 v187, v187, v179
    v_mul_f32 v188, v188, v180
    v_mul_f32 v189, v189, v181
    v_mul_f32 v190, v190, v182
    v_mul_f32 v191, v191, v183
    buffer_load_dwordx4 v242, s[28:31], s97 offen offset:2048  lds
    v_cvt_pk_bf16_f32 v104, v191, v190
    v_cvt_pk_bf16_f32 v105, v189, v188
    v_cvt_pk_bf16_f32 v106, v187, v186
    v_cvt_pk_bf16_f32 v107, v185, v184
    s_mov_b32 s89, 16384
    buffer_store_dwordx4 v[104:107], v12, s[52:55], s89 offen sc1
    buffer_load_dwordx4 v243, s[28:31], s97 offen offset:3072  lds
    v_lshlrev_b32 v160, 16, v41
    v_lshlrev_b32 v161, 16, v43
    v_lshlrev_b32 v162, 16, v45
    v_lshlrev_b32 v163, 16, v47
    v_lshlrev_b32 v164, 16, v49
    s_add_u32 m0, s88, 36864
    s_mov_b64 exec, 0xffffffff
    buffer_load_dwordx4 v3, s[28:31], s97 offen offset:0  lds
    s_mov_b64 exec, -1
    v_lshlrev_b32 v165, 16, v51
    v_lshlrev_b32 v166, 16, v53
    v_lshlrev_b32 v167, 16, v55
    v_lshlrev_b32 v168, 16, v57
    v_lshlrev_b32 v169, 16, v59
    v_lshlrev_b32 v170, 16, v61
    v_lshlrev_b32 v172, 16, v88
    v_and_b32 v173, 0xffff0000, v88
    v_lshlrev_b32 v174, 16, v89
    v_and_b32 v175, 0xffff0000, v89
    v_lshlrev_b32 v176, 16, v69
    v_lshlrev_b32 v177, 16, v71
    v_lshlrev_b32 v178, 16, v73
    v_lshlrev_b32 v179, 16, v75
    v_lshlrev_b32 v180, 16, v77
    v_lshlrev_b32 v181, 16, v79
    v_lshlrev_b32 v182, 16, v81
    v_lshlrev_b32 v183, 16, v83
    v_mul_f32 v184, v160, v175
    v_mul_f32 v185, v161, v175
    v_mul_f32 v186, v162, v175
    v_mul_f32 v187, v163, v175
    v_mul_f32 v188, v164, v175
    v_mul_f32 v189, v165, v175
    v_mul_f32 v190, v166, v175
    v_mul_f32 v191, v167, v175
    v_fmac_f32 v184, v161, v174
    v_fmac_f32 v185, v162, v174
    v_fmac_f32 v186, v163, v174
    v_fmac_f32 v187, v164, v174
    v_fmac_f32 v188, v165, v174
    v_fmac_f32 v189, v166, v174
    v_fmac_f32 v190, v167, v174
    v_fmac_f32 v191, v168, v174
    v_fmac_f32 v184, v162, v173
    v_fmac_f32 v185, v163, v173
    v_fmac_f32 v186, v164, v173
    v_fmac_f32 v187, v165, v173
    v_fmac_f32 v188, v166, v173
    v_fmac_f32 v189, v167, v173
    v_fmac_f32 v190, v168, v173
    s_waitcnt vmcnt(13)
    s_barrier
    s_mul_i32 s16, s97, 3072
    s_add_u32 m0, s60, 49152
    s_add_u32 s99, s16, s62
    buffer_load_dwordx4 v244, s[32:35], s99 offen offset:0  lds
    v_fmac_f32 v191, v169, v173
    v_fmac_f32 v184, v163, v172
    v_fmac_f32 v185, v164, v172
    v_fmac_f32 v186, v165, v172
    v_fmac_f32 v187, v166, v172
    buffer_load_dwordx4 v245, s[32:35], s99 offen offset:1024  lds
    v_fmac_f32 v188, v167, v172
    v_fmac_f32 v189, v168, v172
    v_fmac_f32 v190, v169, v172
    v_fmac_f32 v191, v170, v172
    v_mul_f32 v184, v184, v176
    buffer_load_dwordx4 v246, s[32:35], s99 offen offset:2048  lds
    v_mul_f32 v185, v185, v177
    v_mul_f32 v186, v186, v178
    v_mul_f32 v187, v187, v179
    v_mul_f32 v188, v188, v180
    v_mul_f32 v189, v189, v181
    s_add_u32 m0, s61, 61440
    s_add_u32 s16, s16, s63
    buffer_load_dwordx4 v244, s[32:35], s16 offen offset:0  lds
    v_mul_f32 v190, v190, v182
    v_mul_f32 v191, v191, v183
    v_cvt_pk_bf16_f32 v108, v191, v190
    v_cvt_pk_bf16_f32 v109, v189, v188
    v_cvt_pk_bf16_f32 v110, v187, v186
    buffer_load_dwordx4 v245, s[32:35], s16 offen offset:1024  lds
    v_cvt_pk_bf16_f32 v111, v185, v184
    s_mov_b32 s89, 32768
    buffer_store_dwordx4 v[108:111], v12, s[52:55], s89 offen sc1
    v_and_b32 v160, 0xffff0000, v41
    v_and_b32 v161, 0xffff0000, v43
    v_and_b32 v162, 0xffff0000, v45
    buffer_load_dwordx4 v246, s[32:35], s16 offen offset:2048  lds
    v_and_b32 v163, 0xffff0000, v47
    v_and_b32 v164, 0xffff0000, v49
    v_and_b32 v165, 0xffff0000, v51
    v_and_b32 v166, 0xffff0000, v53
    v_and_b32 v167, 0xffff0000, v55
    s_add_u32 s97, s98, s0
    s_lshr_b64 s[0:1], s[0:1], 4
    s_and_b32 s97, s97, 15
    s_add_u32 m0, s87, 0
    s_lshl_b32 s97, s97, 7
    buffer_load_dwordx4 v240, s[28:31], s97 offen offset:0  lds
    v_and_b32 v168, 0xffff0000, v57
    v_and_b32 v169, 0xffff0000, v59
    v_and_b32 v170, 0xffff0000, v61
    v_lshlrev_b32 v172, 16, v90
    v_and_b32 v173, 0xffff0000, v90
    buffer_load_dwordx4 v241, s[28:31], s97 offen offset:1024  lds
    v_lshlrev_b32 v174, 16, v91
    v_and_b32 v175, 0xffff0000, v91
    v_and_b32 v176, 0xffff0000, v69
    v_and_b32 v177, 0xffff0000, v71
    v_and_b32 v178, 0xffff0000, v73
    buffer_load_dwordx4 v242, s[28:31], s97 offen offset:2048  lds
    v_and_b32 v179, 0xffff0000, v75
    v_and_b32 v180, 0xffff0000, v77
    v_and_b32 v181, 0xffff0000, v79
    v_and_b32 v182, 0xffff0000, v81
    v_and_b32 v183, 0xffff0000, v83
    buffer_load_dwordx4 v243, s[28:31], s97 offen offset:3072  lds
    v_mul_f32 v184, v160, v175
    v_mul_f32 v185, v161, v175
    v_mul_f32 v186, v162, v175
    v_mul_f32 v187, v163, v175
    v_mul_f32 v188, v164, v175
    s_add_u32 m0, s88, 0
    s_mov_b64 exec, 0xffffffff
    buffer_load_dwordx4 v3, s[28:31], s97 offen offset:0  lds
    s_mov_b64 exec, -1
    v_mul_f32 v189, v165, v175
    v_mul_f32 v190, v166, v175
    v_mul_f32 v191, v167, v175
    v_fmac_f32 v184, v161, v174
    v_fmac_f32 v185, v162, v174
    v_fmac_f32 v186, v163, v174
    v_fmac_f32 v187, v164, v174
    v_fmac_f32 v188, v165, v174
    v_fmac_f32 v189, v166, v174
    v_fmac_f32 v190, v167, v174
    v_fmac_f32 v191, v168, v174
    v_fmac_f32 v184, v162, v173
    v_fmac_f32 v185, v163, v173
    v_fmac_f32 v186, v164, v173
    v_fmac_f32 v187, v165, v173
    v_fmac_f32 v188, v166, v173
    v_fmac_f32 v189, v167, v173
    v_fmac_f32 v190, v168, v173
    v_fmac_f32 v191, v169, v173
    v_fmac_f32 v184, v163, v172
    v_fmac_f32 v185, v164, v172
    v_fmac_f32 v186, v165, v172
    v_fmac_f32 v187, v166, v172
    v_fmac_f32 v188, v167, v172
    v_fmac_f32 v189, v168, v172
    v_fmac_f32 v190, v169, v172
    v_fmac_f32 v191, v170, v172
    v_mul_f32 v184, v184, v176
    v_mul_f32 v185, v185, v177
    v_mul_f32 v186, v186, v178
    v_mul_f32 v187, v187, v179
    v_mul_f32 v188, v188, v180
    v_mul_f32 v189, v189, v181
    v_mul_f32 v190, v190, v182
    v_mul_f32 v191, v191, v183
    v_cvt_pk_bf16_f32 v112, v191, v190
    v_cvt_pk_bf16_f32 v113, v189, v188
    v_cvt_pk_bf16_f32 v114, v187, v186
    v_cvt_pk_bf16_f32 v115, v185, v184
    s_mov_b32 s89, 49152
    buffer_store_dwordx4 v[112:115], v12, s[52:55], s89 offen sc1
    s_waitcnt vmcnt(13)
    s_barrier
    s_mul_i32 s16, s97, 3072
    s_add_u32 m0, s60, 0
    s_add_u32 s99, s16, s62
    buffer_load_dwordx4 v244, s[32:35], s99 offen offset:0  lds
    buffer_load_dwordx4 v245, s[32:35], s99 offen offset:1024  lds
    buffer_load_dwordx4 v246, s[32:35], s99 offen offset:2048  lds
    s_add_u32 m0, s61, 12288
    s_add_u32 s16, s16, s63
    buffer_load_dwordx4 v244, s[32:35], s16 offen offset:0  lds
    buffer_load_dwordx4 v245, s[32:35], s16 offen offset:1024  lds
    buffer_load_dwordx4 v246, s[32:35], s16 offen offset:2048  lds
    s_add_u32 s97, s98, s0
    s_lshr_b64 s[0:1], s[0:1], 4
    s_and_b32 s97, s97, 15
    s_add_u32 m0, s87, 18432
    s_lshl_b32 s97, s97, 7
    buffer_load_dwordx4 v240, s[28:31], s97 offen offset:0  lds
    buffer_load_dwordx4 v241, s[28:31], s97 offen offset:1024  lds
    buffer_load_dwordx4 v242, s[28:31], s97 offen offset:2048  lds
    buffer_load_dwordx4 v243, s[28:31], s97 offen offset:3072  lds
    s_add_u32 m0, s88, 18432
    s_mov_b64 exec, 0xffffffff
    buffer_load_dwordx4 v3, s[28:31], s97 offen offset:0  lds
    s_mov_b64 exec, -1
    s_waitcnt vmcnt(12)
    s_barrier
    s_mul_i32 s16, s97, 3072
    s_add_u32 m0, s60, 24576
    s_add_u32 s99, s16, s62
    buffer_load_dwordx4 v244, s[32:35], s99 offen offset:0  lds
    s_mov_b32 s68, s24
    s_mov_b32 s69, s25
    s_mov_b32 s70, 0x100
    s_mov_b32 s71, 0x20000
    buffer_load_dwordx4 v245, s[32:35], s99 offen offset:1024  lds
    v_lshrrev_b32 v6, 5, v0
    v_and_b32 v7, 3, v0
    s_lshr_b32 s78, s90, 1
    s_lshl_b32 s78, s78, 2
    buffer_load_dwordx4 v246, s[32:35], s99 offen offset:2048  lds
    s_load_dword s92, s[14:15], s78
    v_bfe_u32 v5, v0, 2, 2
    v_lshlrev_b32 v5, 1, v5
    s_add_u32 m0, s61, 36864
    s_add_u32 s16, s16, s63
    buffer_load_dwordx4 v244, s[32:35], s16 offen offset:0  lds
    v_lshl_add_u32 v5, v6, 3, v5
    v_bfe_u32 v8, v0, 4, 1
    v_add_u32 v5, v5, v8
    s_and_b32 s78, s3, 1
    buffer_load_dwordx4 v245, s[32:35], s16 offen offset:1024  lds
    s_lshl_b32 s78, s78, 1
    v_add_u32 v8, s78, v6
    v_xor_b32 v8, v8, v7
    v_lshlrev_b32 v8, 4, v8
    buffer_load_dwordx4 v246, s[32:35], s16 offen offset:2048  lds
    v_lshl_add_u32 v5, v5, 6, v8
    v_add_u32 v14, s86, v5
    v_mov_b32 v18, 162304
    s_add_u32 s97, s98, s0
    s_lshr_b64 s[0:1], s[0:1], 4
    s_and_b32 s97, s97, 15
    s_add_u32 m0, s87, 36864
    s_lshl_b32 s97, s97, 7
    buffer_load_dwordx4 v240, s[28:31], s97 offen offset:0  lds
    v_mov_b32 v19, 1
    v_and_b32 v5, 3, v0
    s_lshl_b32 s78, s74, 4
    s_add_u32 s78, s78, s3
    buffer_load_dwordx4 v241, s[28:31], s97 offen offset:1024  lds
    v_lshl_add_u32 v6, v5, 2, s78
    s_lshr_b32 s78, s76, 3
    s_lshl_b32 s79, s3, 1
    s_add_u32 s78, s78, s79
    buffer_load_dwordx4 v242, s[28:31], s97 offen offset:2048  lds
    s_xor_b32 s78, s78, 2
    s_lshl_b32 s78, s78, 5
    s_add_u32 s79, s76, 5
    buffer_load_dwordx4 v243, s[28:31], s97 offen offset:3072  lds
    s_and_b32 s79, s79, 7
    s_lshl_b32 s79, s79, 1
    s_add_u32 s78, s78, s79
    v_mul_u32_u24 v7, 9, v5
    s_add_u32 m0, s88, 36864
    s_mov_b64 exec, 0xffffffff
    buffer_load_dwordx4 v3, s[28:31], s97 offen offset:0  lds
    s_mov_b64 exec, -1
    v_and_b32 v7, 17, v7
    v_add_u32 v7, s78, v7
    v_and_b32 v8, 4, v0
    s_waitcnt vmcnt(11)
    s_barrier
    s_mul_i32 s16, s97, 3072
    s_add_u32 m0, s60, 49152
    s_add_u32 s99, s16, s62
    buffer_load_dwordx4 v244, s[32:35], s99 offen offset:0  lds
    v_cmp_eq_u32 vcc, 0, v8
    s_nop 1
    v_cndmask_b32 v6, v7, v6, vcc
    v_and_b32 v33, 0xf0, v6
    buffer_load_dwordx4 v245, s[32:35], s99 offen offset:1024  lds
    v_lshlrev_b32 v34, 8, v6
    v_add_u32 v34, 12582912, v34
    v_and_b32 v5, 15, v0
    buffer_load_dwordx4 v246, s[32:35], s99 offen offset:2048  lds
    v_lshrrev_b32 v6, 4, v0
    v_add_u32 v7, 9, v5
    s_add_u32 m0, s61, 61440
    s_add_u32 s16, s16, s63
    buffer_load_dwordx4 v244, s[32:35], s16 offen offset:0  lds
    v_and_b32 v8, 1, v7
    v_mul_u32_u24 v8, 4160, v8
    v_lshrrev_b32 v7, 1, v7
    buffer_load_dwordx4 v245, s[32:35], s16 offen offset:1024  lds
    v_lshl_add_u32 v8, v7, 2, v8
    v_lshlrev_b32 v7, 4, v6
    v_sub_u32 v8, v8, v7
    buffer_load_dwordx4 v246, s[32:35], s16 offen offset:2048  lds
    s_add_u32 s78, s94, 32
    v_add_u32 v21, s78, v8
    s_add_u32 m0, s94, 32
    s_lshl_b32 s89, s90, 12
    buffer_load_dwordx4 v15, s[48:51], s89 offen offset:0 nt lds
    v_add_u32 v22, 1024, v21
    v_add_u32 v23, 2048, v21
    v_add_u32 v24, 3072, v21
    s_add_u32 m0, s94, 32
    s_lshl_b32 s89, s90, 12
    buffer_load_dwordx4 v15, s[48:51], s89 offen offset:1024 nt lds
    v_lshl_add_u32 v7, v5, 1, v6
    v_add_u32 v7, 30, v7
    v_and_b32 v8, 1, v7
    s_add_u32 m0, s94, 32
    s_lshl_b32 s89, s90, 12
    buffer_load_dwordx4 v15, s[48:51], s89 offen offset:2048 nt lds
    v_bfe_u32 v136, v7, 1, 2
    v_lshl_add_u32 v136, v8, 2, v136
    s_add_u32 m0, s94, 32
    s_lshl_b32 s89, s90, 12
    buffer_load_dwordx4 v15, s[48:51], s89 offen offset:3072 nt lds
    v_lshlrev_b32 v136, 6, v136
    v_lshrrev_b32 v7, 3, v7
    v_lshl_add_u32 v136, v7, 9, v136
    s_add_u32 s97, s98, s0
    s_lshr_b64 s[0:1], s[0:1], 4
    s_and_b32 s97, s97, 15
    s_add_u32 m0, s87, 0
    s_lshl_b32 s97, s97, 7
    buffer_load_dwordx4 v240, s[28:31], s97 offen offset:0  lds
    v_bitop3_b32 v8, v7, 3, s3 bitop3:0x6a
    v_lshl_add_u32 v25, v8, 4, v136
    v_add_u32 v25, 92160, v25
    buffer_load_dwordx4 v241, s[28:31], s97 offen offset:1024  lds
    v_subrev_u32 v7, 1, v7
    v_bitop3_b32 v8, v7, 3, s3 bitop3:0x6a
    buffer_load_dwordx4 v242, s[28:31], s97 offen offset:2048  lds
    v_lshl_add_u32 v27, v8, 4, v136
    v_add_u32 v27, 91648, v27
    v_subrev_u32 v7, 1, v7
    buffer_load_dwordx4 v243, s[28:31], s97 offen offset:3072  lds
    v_bitop3_b32 v8, v7, 3, s3 bitop3:0x6a
    v_lshl_add_u32 v29, v8, 4, v136
    v_add_u32 v29, 91136, v29
    s_add_u32 m0, s88, 0
    s_mov_b64 exec, 0xffffffff
    buffer_load_dwordx4 v3, s[28:31], s97 offen offset:0  lds
    s_mov_b64 exec, -1
    v_subrev_u32 v7, 1, v7
    v_bitop3_b32 v8, v7, 3, s3 bitop3:0x6a
    s_waitcnt vmcnt(15)
    s_barrier
    s_mul_i32 s16, s97, 3072
    s_add_u32 m0, s60, 0
    s_add_u32 s99, s16, s62
    buffer_load_dwordx4 v244, s[32:35], s99 offen offset:0  lds
    v_lshl_add_u32 v31, v8, 4, v136
    v_add_u32 v31, 90624, v31
    v_lshl_add_u32 v7, v5, 1, v6
    v_add_u32 v7, 26, v7
    buffer_load_dwordx4 v245, s[32:35], s99 offen offset:1024  lds
    v_and_b32 v8, 1, v7
    v_bfe_u32 v136, v7, 1, 2
    v_lshl_add_u32 v136, v8, 2, v136
    v_lshlrev_b32 v136, 6, v136
    buffer_load_dwordx4 v246, s[32:35], s99 offen offset:2048  lds
    v_lshrrev_b32 v7, 3, v7
    v_lshl_add_u32 v136, v7, 9, v136
    v_bitop3_b32 v8, v7, 3, s3 bitop3:0x6a
    s_add_u32 m0, s61, 12288
    s_add_u32 s16, s16, s63
    buffer_load_dwordx4 v244, s[32:35], s16 offen offset:0  lds
    v_lshl_add_u32 v26, v8, 4, v136
    v_add_u32 v26, 92160, v26
    v_subrev_u32 v7, 1, v7
    v_bitop3_b32 v8, v7, 3, s3 bitop3:0x6a
    buffer_load_dwordx4 v245, s[32:35], s16 offen offset:1024  lds
    v_lshl_add_u32 v28, v8, 4, v136
    v_add_u32 v28, 91648, v28
    v_subrev_u32 v7, 1, v7
    v_bitop3_b32 v8, v7, 3, s3 bitop3:0x6a
    buffer_load_dwordx4 v246, s[32:35], s16 offen offset:2048  lds
    v_lshl_add_u32 v30, v8, 4, v136
    v_add_u32 v30, 91136, v30
    v_subrev_u32 v7, 1, v7
    s_add_u32 s97, s98, s0
    s_lshr_b64 s[0:1], s[0:1], 4
    s_and_b32 s97, s97, 15
    s_add_u32 m0, s87, 18432
    s_lshl_b32 s97, s97, 7
    buffer_load_dwordx4 v240, s[28:31], s97 offen offset:0  lds
    v_bitop3_b32 v8, v7, 3, s3 bitop3:0x6a
    v_lshl_add_u32 v32, v8, 4, v136
    v_add_u32 v32, 90624, v32
    v_lshrrev_b32 v7, 1, v6
    buffer_load_dwordx4 v241, s[28:31], s97 offen offset:1024  lds
    v_lshl_add_u32 v7, v5, 1, v7
    v_add_u32 v7, 32, v7
    v_and_b32 v8, 1, v7
    v_bfe_u32 v136, v7, 1, 2
    buffer_load_dwordx4 v242, s[28:31], s97 offen offset:2048  lds
    v_lshl_add_u32 v136, v8, 2, v136
    v_lshlrev_b32 v136, 6, v136
    v_lshrrev_b32 v7, 3, v7
    buffer_load_dwordx4 v243, s[28:31], s97 offen offset:3072  lds
    v_lshl_add_u32 v136, v7, 9, v136
    v_bitop3_b32 v8, v7, 3, s3 bitop3:0x6a
    v_lshl_add_u32 v20, v8, 4, v136
    v_add_u32 v20, 92160, v20
    s_add_u32 m0, s88, 18432
    s_mov_b64 exec, 0xffffffff
    buffer_load_dwordx4 v3, s[28:31], s97 offen offset:0  lds
    s_mov_b64 exec, -1
    v_and_b32 v8, 1, v6
    v_xor_b32 v8, 1, v8
    v_lshl_add_u32 v20, v8, 3, v20
    s_waitcnt vmcnt(11)
    s_barrier
    s_mul_i32 s16, s97, 3072
    s_add_u32 m0, s60, 24576
    s_add_u32 s99, s16, s62
    buffer_load_dwordx4 v244, s[32:35], s99 offen offset:0  lds
    s_waitcnt lgkmcnt(0)
    s_and_b32 s78, s92, 0xffff0000
    s_lshl_b32 s92, s92, 16
    buffer_load_dwordx4 v245, s[32:35], s99 offen offset:1024  lds
    s_bitcmp1_b32 s90, 0
    s_cselect_b32 s92, s78, s92
    v_lshlrev_b32 v7, 3, v6
    v_sub_u32 v7, v7, v5
    buffer_load_dwordx4 v246, s[32:35], s99 offen offset:2048  lds
    v_subrev_u32 v7, 9, v7
    v_and_b32 v8, 1, v7
    v_xor_b32 v8, 1, v8
    s_add_u32 m0, s61, 36864
    s_add_u32 s16, s16, s63
    buffer_load_dwordx4 v244, s[32:35], s16 offen offset:0  lds
    v_lshlrev_b32 v8, 4, v8
    v_lshrrev_b32 v8, v8, s92
    v_ashrrev_i32 v7, 1, v7
    buffer_load_dwordx4 v245, s[32:35], s16 offen offset:1024  lds
    v_cmp_eq_u32 vcc, 0, v7
    s_nop 1
    v_cndmask_b32 v236, 0, v8, vcc
    v_cmp_eq_u32 vcc, 1, v7
    buffer_load_dwordx4 v246, s[32:35], s16 offen offset:2048  lds
    s_nop 0
    v_cndmask_b32 v237, 0, v8, vcc
    v_cmp_eq_u32 vcc, 2, v7
    s_nop 1
    v_cndmask_b32 v238, 0, v8, vcc
    s_add_u32 s97, s98, s0
    s_lshr_b64 s[0:1], s[0:1], 4
    s_and_b32 s97, s97, 15
    s_add_u32 m0, s87, 36864
    s_lshl_b32 s97, s97, 7
    buffer_load_dwordx4 v240, s[28:31], s97 offen offset:0  lds
    v_cmp_eq_u32 vcc, 3, v7
    s_nop 1
    v_cndmask_b32 v239, 0, v8, vcc
    s_and_b32 s78, s77, 7
    s_mov_b32 s95, 0x76543210
    s_and_b32 s78, s76, 3
    s_mul_i32 s78, s78, 0x22222222
    s_add_u32 s95, s95, s78
    s_bfe_u32 s17, s95, 0x30000
    s_lshl_b32 s17, s17, 18
    s_bfe_u32 s18, s95, 0x30004
    s_lshl_b32 s18, s18, 18
    s_bfe_u32 s100, s95, 0x3001c
    s_lshl_b32 s100, s100, 18
    s_bfe_u32 s95, s95, 0x30018
    s_lshl_b32 s95, s95, 18
    buffer_load_dwordx4 v241, s[28:31], s97 offen offset:1024  lds
    v_lshrrev_b32 v136, 4, v0
    v_lshlrev_b32 v136, 1, v136
    v_and_b32 v137, 7, v0
    buffer_load_dwordx4 v242, s[28:31], s97 offen offset:2048  lds
    v_xor_b32 v136, v136, v137
    v_lshlrev_b32 v136, 4, v136
    v_lshrrev_b32 v137, 3, v0
    buffer_load_dwordx4 v243, s[28:31], s97 offen offset:3072  lds
    v_lshl_add_u32 v136, v137, 11, v136
    s_lshl_b32 s78, s77, 7
    s_lshl_b32 s79, s3, 14
    s_add_u32 m0, s88, 36864
    s_mov_b64 exec, 0xffffffff
    buffer_load_dwordx4 v3, s[28:31], s97 offen offset:0  lds
    s_mov_b64 exec, -1
    s_add_u32 s78, s78, s79
    v_add_u32 v17, s78, v136
    s_waitcnt vmcnt(11)
    s_barrier
    s_mul_i32 s16, s97, 3072
    s_add_u32 m0, s60, 49152
    s_add_u32 s99, s16, s62
    buffer_load_dwordx4 v244, s[32:35], s99 offen offset:0  lds
    v_add_u32 v5, s94, v15
    ds_read_b128 v[140:143], v5 offset:32
    ds_read_b32 v156, v5 offset:48
    ds_read_b128 v[144:147], v5 offset:1056
    buffer_load_dwordx4 v245, s[32:35], s99 offen offset:1024  lds
    ds_read_b32 v157, v5 offset:1072
    ds_read_b128 v[148:151], v5 offset:2080
    ds_read_b32 v158, v5 offset:2096
    ds_read_b128 v[152:155], v5 offset:3104
    buffer_load_dwordx4 v246, s[32:35], s99 offen offset:2048  lds
    ds_read_b32 v159, v5 offset:3120
    v_lshrrev_b32 v6, 3, v0
    v_mul_u32_u24 v6, 4160, v6
    s_add_u32 m0, s61, 61440
    s_add_u32 s16, s16, s63
    buffer_load_dwordx4 v244, s[32:35], s16 offen offset:0  lds
    v_and_b32 v7, 7, v0
    v_lshl_add_u32 v6, v7, 2, v6
    v_add_u32 v6, s94, v6
    v_mov_b32 v7, 0
    buffer_load_dwordx4 v245, s[32:35], s16 offen offset:1024  lds
    s_waitcnt lgkmcnt(0)
    v_readfirstlane_b32 s93, v140
    s_nop 0
    s_lshl_b32 s93, s93, 16
    s_nop 1
    v_writelane_b32 v7, s93, 15
    buffer_load_dwordx4 v246, s[32:35], s16 offen offset:2048  lds
    v_alignbit_b32 v140, v141, v140, 16
    v_alignbit_b32 v141, v142, v141, 16
    v_alignbit_b32 v142, v143, v142, 16
    s_add_u32 s97, s98, s0
    s_lshr_b64 s[0:1], s[0:1], 4
    s_and_b32 s97, s97, 15
    s_add_u32 m0, s87, 0
    s_lshl_b32 s97, s97, 7
    buffer_load_dwordx4 v240, s[28:31], s97 offen offset:0  lds
    v_alignbit_b32 v143, v156, v143, 16
    v_alignbit_b32 v144, v145, v144, 16
    v_alignbit_b32 v145, v146, v145, 16
    v_alignbit_b32 v146, v147, v146, 16
    buffer_load_dwordx4 v241, s[28:31], s97 offen offset:1024  lds
    v_alignbit_b32 v147, v157, v147, 16
    v_alignbit_b32 v148, v149, v148, 16
    v_alignbit_b32 v149, v150, v149, 16
    v_alignbit_b32 v150, v151, v150, 16
    buffer_load_dwordx4 v242, s[28:31], s97 offen offset:2048  lds
    v_alignbit_b32 v151, v158, v151, 16
    v_alignbit_b32 v152, v153, v152, 16
    v_alignbit_b32 v153, v154, v153, 16
    buffer_load_dwordx4 v243, s[28:31], s97 offen offset:3072  lds
    v_alignbit_b32 v154, v155, v154, 16
    v_alignbit_b32 v155, v159, v155, 16
    v_lshlrev_b32 v8, 3, v0
    s_add_u32 s78, s88, 18432
    s_add_u32 m0, s88, 0
    s_mov_b64 exec, 0xffffffff
    buffer_load_dwordx4 v3, s[28:31], s97 offen offset:0  lds
    s_mov_b64 exec, -1
    v_add_u32 v8, s78, v8
    v_mov_b32 v156, 0
    v_mov_b32 v157, 0
    s_waitcnt vmcnt(11)
    s_barrier
    s_mul_i32 s16, s97, 3072
    s_add_u32 m0, s60, 0
    s_add_u32 s99, s16, s62
    buffer_load_dwordx4 v244, s[32:35], s99 offen offset:0  lds
    buffer_load_dwordx4 v245, s[32:35], s99 offen offset:1024  lds
    buffer_load_dwordx4 v246, s[32:35], s99 offen offset:2048  lds
    s_add_u32 m0, s61, 12288
    s_add_u32 s16, s16, s63
    buffer_load_dwordx4 v244, s[32:35], s16 offen offset:0  lds
    buffer_load_dwordx4 v245, s[32:35], s16 offen offset:1024  lds
    buffer_load_dwordx4 v246, s[32:35], s16 offen offset:2048  lds
    s_mov_b64 exec, 0xff
    buffer_load_dword v136, v33, s[68:71], 0 offen sc1
    buffer_load_dword v137, v34, s[52:55], 0 offen sc1
    s_mov_b64 exec, -1
    buffer_load_dwordx4 v[212:215], v9, s[56:59], 0 offen offset:0 nt
    buffer_load_dwordx4 v[216:219], v9, s[56:59], 0 offen offset:2048 nt
    buffer_load_dwordx4 v[220:223], v9, s[56:59], s96 offen offset:0 nt
    buffer_load_dwordx4 v[224:227], v9, s[56:59], s96 offen offset:2048 nt
    s_waitcnt vmcnt(12)
    s_waitcnt vmcnt(6)
    s_barrier
    s_waitcnt vmcnt(4)
    s_branch LA_j
LA_c1:
    s_waitcnt vmcnt(8)
    s_barrier
    buffer_load_dwordx4 v242, s[28:31], s97 offen offset:2048  lds
    buffer_load_dwordx4 v243, s[28:31], s97 offen offset:3072  lds
    s_add_u32 m0, s88, 36864
    s_mov_b64 exec, 0xffffffff
    buffer_load_dwordx4 v3, s[28:31], s97 offen offset:0  lds
    s_mov_b64 exec, -1
    s_mul_i32 s16, s97, 3072
    s_add_u32 m0, s60, 49152
    s_add_u32 s99, s16, s62
    buffer_load_dwordx4 v244, s[32:35], s99 offen offset:0  lds
    buffer_load_dwordx4 v245, s[32:35], s99 offen offset:1024  lds
    buffer_load_dwordx4 v246, s[32:35], s99 offen offset:2048  lds
    s_add_u32 m0, s61, 61440
    s_add_u32 s16, s16, s63
    buffer_load_dwordx4 v244, s[32:35], s16 offen offset:0  lds
    buffer_load_dwordx4 v245, s[32:35], s16 offen offset:1024  lds
    buffer_load_dwordx4 v246, s[32:35], s16 offen offset:2048  lds
    s_add_u32 s97, s98, s0
    s_lshr_b64 s[0:1], s[0:1], 4
    s_and_b32 s97, s97, 15
    s_add_u32 m0, s87, 0
    s_lshl_b32 s97, s97, 7
    buffer_load_dwordx4 v240, s[28:31], s97 offen offset:0  lds
    buffer_load_dwordx4 v241, s[28:31], s97 offen offset:1024  lds
    buffer_load_dwordx4 v242, s[28:31], s97 offen offset:2048  lds
    buffer_load_dwordx4 v243, s[28:31], s97 offen offset:3072  lds
    s_add_u32 m0, s88, 0
    s_mov_b64 exec, 0xffffffff
    buffer_load_dwordx4 v3, s[28:31], s97 offen offset:0  lds
    s_mov_b64 exec, -1
    s_waitcnt vmcnt(11)
    s_barrier
    s_mul_i32 s16, s97, 3072
    s_add_u32 m0, s60, 0
    s_add_u32 s99, s16, s62
    buffer_load_dwordx4 v244, s[32:35], s99 offen offset:0  lds
    buffer_load_dwordx4 v245, s[32:35], s99 offen offset:1024  lds
    buffer_load_dwordx4 v246, s[32:35], s99 offen offset:2048  lds
    s_add_u32 m0, s61, 12288
    s_add_u32 s16, s16, s63
    buffer_load_dwordx4 v244, s[32:35], s16 offen offset:0  lds
    buffer_load_dwordx4 v245, s[32:35], s16 offen offset:1024  lds
    buffer_load_dwordx4 v246, s[32:35], s16 offen offset:2048  lds
    s_add_u32 m0, s86, 129536
    s_mov_b32 s89, 0
    buffer_load_dwordx4 v10, s[36:39], s89 offen nt lds
    s_add_u32 m0, s86, 145920
    s_mov_b32 s89, 0
    buffer_load_dwordx4 v10, s[40:43], s89 offen nt lds
    s_add_u32 m0, s86, 133632
    s_mov_b32 s89, 65536
    buffer_load_dwordx4 v10, s[36:39], s89 offen nt lds
    s_add_u32 m0, s86, 150016
    s_mov_b32 s89, 65536
    buffer_load_dwordx4 v10, s[40:43], s89 offen nt lds
    s_add_u32 m0, s86, 137728
    s_mov_b32 s89, 131072
    buffer_load_dwordx4 v10, s[36:39], s89 offen nt lds
    s_add_u32 m0, s86, 154112
    s_mov_b32 s89, 131072
    buffer_load_dwordx4 v10, s[40:43], s89 offen nt lds
    s_add_u32 m0, s86, 141824
    s_mov_b32 s89, 196608
    buffer_load_dwordx4 v10, s[36:39], s89 offen nt lds
    s_add_u32 m0, s86, 158208
    s_mov_b32 s89, 196608
    buffer_load_dwordx4 v10, s[40:43], s89 offen nt lds
    s_mov_b64 exec, 0xff
    s_lshl_b32 s82, s3, 7
    s_add_u32 m0, s82, 129024
    s_mov_b32 s89, 0
    buffer_load_dwordx4 v11, s[36:39], s89 offen nt lds
    s_lshl_b32 s83, s74, 9
    s_add_u32 s83, s83, s82
    s_and_b32 s89, s3, 2
    s_lshl_b32 s89, s89, 3
    s_add_u32 s82, s82, s89
    s_add_u32 m0, s82, 162816
    s_add_u32 s89, s83, 0
    buffer_load_dwordx4 v15, s[44:47], s89 offen  lds
    s_mov_b64 exec, -1
    s_add_u32 s97, s98, s0
    s_lshr_b64 s[0:1], s[0:1], 4
    s_and_b32 s97, s97, 15
    s_add_u32 m0, s87, 18432
    s_lshl_b32 s97, s97, 7
    buffer_load_dwordx4 v240, s[28:31], s97 offen offset:0  lds
    buffer_load_dwordx4 v241, s[28:31], s97 offen offset:1024  lds
    buffer_load_dwordx4 v242, s[28:31], s97 offen offset:2048  lds
    buffer_load_dwordx4 v243, s[28:31], s97 offen offset:3072  lds
    s_add_u32 m0, s88, 18432
    s_mov_b64 exec, 0xffffffff
    buffer_load_dwordx4 v3, s[28:31], s97 offen offset:0  lds
    s_mov_b64 exec, -1
    s_waitcnt vmcnt(21)
    s_barrier
    s_mul_i32 s16, s97, 3072
    s_add_u32 m0, s60, 24576
    s_add_u32 s99, s16, s62
    buffer_load_dwordx4 v244, s[32:35], s99 offen offset:0  lds
    buffer_load_dwordx4 v245, s[32:35], s99 offen offset:1024  lds
    buffer_load_dwordx4 v246, s[32:35], s99 offen offset:2048  lds
    s_add_u32 m0, s61, 36864
    s_add_u32 s16, s16, s63
    buffer_load_dwordx4 v244, s[32:35], s16 offen offset:0  lds
    buffer_load_dwordx4 v245, s[32:35], s16 offen offset:1024  lds
    buffer_load_dwordx4 v246, s[32:35], s16 offen offset:2048  lds
    s_add_u32 s97, s98, s0
    s_lshr_b64 s[0:1], s[0:1], 4
    s_and_b32 s97, s97, 15
    s_add_u32 m0, s87, 36864
    s_lshl_b32 s97, s97, 7
    buffer_load_dwordx4 v240, s[28:31], s97 offen offset:0  lds
    buffer_load_dwordx4 v241, s[28:31], s97 offen offset:1024  lds
    buffer_load_dwordx4 v242, s[28:31], s97 offen offset:2048  lds
    buffer_load_dwordx4 v243, s[28:31], s97 offen offset:3072  lds
    s_add_u32 m0, s88, 36864
    s_mov_b64 exec, 0xffffffff
    buffer_load_dwordx4 v3, s[28:31], s97 offen offset:0  lds
    s_mov_b64 exec, -1
    s_waitcnt vmcnt(11)
    s_barrier
    s_mul_i32 s16, s97, 3072
    s_add_u32 m0, s60, 49152
    s_add_u32 s99, s16, s62
    buffer_load_dwordx4 v244, s[32:35], s99 offen offset:0  lds
    ds_read_b128 v[84:87], v35 offset:0
    ds_read_b128 v[88:91], v35 offset:16
    buffer_load_dwordx4 v245, s[32:35], s99 offen offset:1024  lds
    ds_read_b64 v[40:41], v16 offset:0
    ds_read_b64 v[42:43], v231 offset:256
    buffer_load_dwordx4 v246, s[32:35], s99 offen offset:2048  lds
    ds_read_b64 v[44:45], v16 offset:256
    s_add_u32 m0, s61, 61440
    s_add_u32 s16, s16, s63
    buffer_load_dwordx4 v244, s[32:35], s16 offen offset:0  lds
    ds_read_b64 v[46:47], v16 offset:512
    ds_read_b64 v[48:49], v231 offset:512
    buffer_load_dwordx4 v245, s[32:35], s16 offen offset:1024  lds
    ds_read_b64 v[50:51], v16 offset:768
    ds_read_b64 v[52:53], v231 offset:768
    buffer_load_dwordx4 v246, s[32:35], s16 offen offset:2048  lds
    ds_read_b64 v[54:55], v16 offset:1024
    buffer_load_dword v230, v229, s[4:7], 0 offen
    ds_read_b64 v[56:57], v231 offset:1024
    ds_read_b64 v[58:59], v16 offset:1280
    buffer_load_dword v230, v228, s[32:35], 0 offen
    ds_read_b64 v[60:61], v231 offset:1280
    s_add_u32 s97, s98, s0
    s_lshr_b64 s[0:1], s[0:1], 4
    s_and_b32 s97, s97, 15
    s_add_u32 m0, s87, 0
    s_lshl_b32 s97, s97, 7
    buffer_load_dwordx4 v240, s[28:31], s97 offen offset:0  lds
    ds_read_b64 v[68:69], v16 offset:16896
    ds_read_b64 v[70:71], v231 offset:16896
    buffer_load_dwordx4 v241, s[28:31], s97 offen offset:1024  lds
    ds_read_b64 v[72:73], v16 offset:17152
    ds_read_b64 v[74:75], v231 offset:17152
    buffer_load_dwordx4 v242, s[28:31], s97 offen offset:2048  lds
    ds_read_b64 v[76:77], v16 offset:17408
    buffer_load_dwordx4 v243, s[28:31], s97 offen offset:3072  lds
    ds_read_b64 v[78:79], v231 offset:17408
    ds_read_b64 v[80:81], v16 offset:17664
    s_add_u32 m0, s88, 0
    s_mov_b64 exec, 0xffffffff
    buffer_load_dwordx4 v3, s[28:31], s97 offen offset:0  lds
    s_mov_b64 exec, -1
    ds_read_b64 v[82:83], v231 offset:17664
    s_waitcnt vmcnt(13)
    s_waitcnt lgkmcnt(0)
    s_barrier
    s_mul_i32 s16, s97, 3072
    s_add_u32 m0, s60, 0
    s_add_u32 s99, s16, s62
    buffer_load_dwordx4 v244, s[32:35], s99 offen offset:0  lds
    v_lshlrev_b32 v160, 16, v40
    v_lshlrev_b32 v161, 16, v42
    v_lshlrev_b32 v162, 16, v44
    v_lshlrev_b32 v163, 16, v46
    v_lshlrev_b32 v164, 16, v48
    buffer_load_dwordx4 v245, s[32:35], s99 offen offset:1024  lds
    v_lshlrev_b32 v165, 16, v50
    v_lshlrev_b32 v166, 16, v52
    v_lshlrev_b32 v167, 16, v54
    v_lshlrev_b32 v168, 16, v56
    v_lshlrev_b32 v169, 16, v58
    buffer_load_dwordx4 v246, s[32:35], s99 offen offset:2048  lds
    v_lshlrev_b32 v170, 16, v60
    v_lshlrev_b32 v172, 16, v84
    v_and_b32 v173, 0xffff0000, v84
    v_lshlrev_b32 v174, 16, v85
    v_and_b32 v175, 0xffff0000, v85
    s_add_u32 m0, s61, 12288
    s_add_u32 s16, s16, s63
    buffer_load_dwordx4 v244, s[32:35], s16 offen offset:0  lds
    v_lshlrev_b32 v176, 16, v68
    v_lshlrev_b32 v177, 16, v70
    v_lshlrev_b32 v178, 16, v72
    v_lshlrev_b32 v179, 16, v74
    v_lshlrev_b32 v180, 16, v76
    buffer_load_dwordx4 v245, s[32:35], s16 offen offset:1024  lds
    v_lshlrev_b32 v181, 16, v78
    v_lshlrev_b32 v182, 16, v80
    v_lshlrev_b32 v183, 16, v82
    v_mul_f32 v184, v160, v175
    v_mul_f32 v185, v161, v175
    buffer_load_dwordx4 v246, s[32:35], s16 offen offset:2048  lds
    v_mul_f32 v186, v162, v175
    v_mul_f32 v187, v163, v175
    v_mul_f32 v188, v164, v175
    v_mul_f32 v189, v165, v175
    v_mul_f32 v190, v166, v175
    s_add_u32 s97, s98, s0
    s_lshr_b64 s[0:1], s[0:1], 4
    s_and_b32 s97, s97, 15
    s_add_u32 m0, s87, 18432
    s_lshl_b32 s97, s97, 7
    buffer_load_dwordx4 v240, s[28:31], s97 offen offset:0  lds
    v_mul_f32 v191, v167, v175
    v_fmac_f32 v184, v161, v174
    v_fmac_f32 v185, v162, v174
    v_fmac_f32 v186, v163, v174
    v_fmac_f32 v187, v164, v174
    buffer_load_dwordx4 v241, s[28:31], s97 offen offset:1024  lds
    v_fmac_f32 v188, v165, v174
    v_fmac_f32 v189, v166, v174
    v_fmac_f32 v190, v167, v174
    v_fmac_f32 v191, v168, v174
    v_fmac_f32 v184, v162, v173
    buffer_load_dwordx4 v242, s[28:31], s97 offen offset:2048  lds
    v_fmac_f32 v185, v163, v173
    v_fmac_f32 v186, v164, v173
    v_fmac_f32 v187, v165, v173
    v_fmac_f32 v188, v166, v173
    v_fmac_f32 v189, v167, v173
    buffer_load_dwordx4 v243, s[28:31], s97 offen offset:3072  lds
    v_fmac_f32 v190, v168, v173
    v_fmac_f32 v191, v169, v173
    v_fmac_f32 v184, v163, v172
    v_fmac_f32 v185, v164, v172
    v_fmac_f32 v186, v165, v172
    s_add_u32 m0, s88, 18432
    s_mov_b64 exec, 0xffffffff
    buffer_load_dwordx4 v3, s[28:31], s97 offen offset:0  lds
    s_mov_b64 exec, -1
    v_fmac_f32 v187, v166, v172
    v_fmac_f32 v188, v167, v172
    v_fmac_f32 v189, v168, v172
    v_fmac_f32 v190, v169, v172
    v_fmac_f32 v191, v170, v172
    v_mul_f32 v184, v184, v176
    v_mul_f32 v185, v185, v177
    v_mul_f32 v186, v186, v178
    v_mul_f32 v187, v187, v179
    v_mul_f32 v188, v188, v180
    v_mul_f32 v189, v189, v181
    v_mul_f32 v190, v190, v182
    v_mul_f32 v191, v191, v183
    v_cvt_pk_bf16_f32 v100, v191, v190
    v_cvt_pk_bf16_f32 v101, v189, v188
    v_cvt_pk_bf16_f32 v102, v187, v186
    v_cvt_pk_bf16_f32 v103, v185, v184
    s_mov_b32 s89, 0
    buffer_store_dwordx4 v[100:103], v12, s[52:55], s89 offen sc1
    v_and_b32 v160, 0xffff0000, v40
    v_and_b32 v161, 0xffff0000, v42
    v_and_b32 v162, 0xffff0000, v44
    v_and_b32 v163, 0xffff0000, v46
    v_and_b32 v164, 0xffff0000, v48
    v_and_b32 v165, 0xffff0000, v50
    v_and_b32 v166, 0xffff0000, v52
    v_and_b32 v167, 0xffff0000, v54
    v_and_b32 v168, 0xffff0000, v56
    v_and_b32 v169, 0xffff0000, v58
    v_and_b32 v170, 0xffff0000, v60
    v_lshlrev_b32 v172, 16, v86
    v_and_b32 v173, 0xffff0000, v86
    v_lshlrev_b32 v174, 16, v87
    v_and_b32 v175, 0xffff0000, v87
    v_and_b32 v176, 0xffff0000, v68
    v_and_b32 v177, 0xffff0000, v70
    v_and_b32 v178, 0xffff0000, v72
    v_and_b32 v179, 0xffff0000, v74
    v_and_b32 v180, 0xffff0000, v76
    v_and_b32 v181, 0xffff0000, v78
    v_and_b32 v182, 0xffff0000, v80
    v_and_b32 v183, 0xffff0000, v82
    s_waitcnt vmcnt(12)
    s_barrier
    s_mul_i32 s16, s97, 3072
    s_add_u32 m0, s60, 24576
    s_add_u32 s99, s16, s62
    buffer_load_dwordx4 v244, s[32:35], s99 offen offset:0  lds
    v_mul_f32 v184, v160, v175
    v_mul_f32 v185, v161, v175
    v_mul_f32 v186, v162, v175
    v_mul_f32 v187, v163, v175
    v_mul_f32 v188, v164, v175
    buffer_load_dwordx4 v245, s[32:35], s99 offen offset:1024  lds
    v_mul_f32 v189, v165, v175
    v_mul_f32 v190, v166, v175
    v_mul_f32 v191, v167, v175
    v_fmac_f32 v184, v161, v174
    v_fmac_f32 v185, v162, v174
    buffer_load_dwordx4 v246, s[32:35], s99 offen offset:2048  lds
    v_fmac_f32 v186, v163, v174
    v_fmac_f32 v187, v164, v174
    v_fmac_f32 v188, v165, v174
    v_fmac_f32 v189, v166, v174
    v_fmac_f32 v190, v167, v174
    s_add_u32 m0, s61, 36864
    s_add_u32 s16, s16, s63
    buffer_load_dwordx4 v244, s[32:35], s16 offen offset:0  lds
    v_fmac_f32 v191, v168, v174
    v_fmac_f32 v184, v162, v173
    v_fmac_f32 v185, v163, v173
    v_fmac_f32 v186, v164, v173
    v_fmac_f32 v187, v165, v173
    buffer_load_dwordx4 v245, s[32:35], s16 offen offset:1024  lds
    v_fmac_f32 v188, v166, v173
    v_fmac_f32 v189, v167, v173
    v_fmac_f32 v190, v168, v173
    v_fmac_f32 v191, v169, v173
    v_fmac_f32 v184, v163, v172
    buffer_load_dwordx4 v246, s[32:35], s16 offen offset:2048  lds
    v_fmac_f32 v185, v164, v172
    v_fmac_f32 v186, v165, v172
    v_fmac_f32 v187, v166, v172
    v_fmac_f32 v188, v167, v172
    v_fmac_f32 v189, v168, v172
    s_add_u32 s97, s98, s0
    s_lshr_b64 s[0:1], s[0:1], 4
    s_and_b32 s97, s97, 15
    s_add_u32 m0, s87, 36864
    s_lshl_b32 s97, s97, 7
    buffer_load_dwordx4 v240, s[28:31], s97 offen offset:0  lds
    v_fmac_f32 v190, v169, v172
    v_fmac_f32 v191, v170, v172
    v_mul_f32 v184, v184, v176
    v_mul_f32 v185, v185, v177
    v_mul_f32 v186, v186, v178
    buffer_load_dwordx4 v241, s[28:31], s97 offen offset:1024  lds
    v_mul_f32 v187, v187, v179
    v_mul_f32 v188, v188, v180
    v_mul_f32 v189, v189, v181
    v_mul_f32 v190, v190, v182
    v_mul_f32 v191, v191, v183
    buffer_load_dwordx4 v242, s[28:31], s97 offen offset:2048  lds
    v_cvt_pk_bf16_f32 v104, v191, v190
    v_cvt_pk_bf16_f32 v105, v189, v188
    v_cvt_pk_bf16_f32 v106, v187, v186
    v_cvt_pk_bf16_f32 v107, v185, v184
    s_mov_b32 s89, 16384
    buffer_store_dwordx4 v[104:107], v12, s[52:55], s89 offen sc1
    buffer_load_dwordx4 v243, s[28:31], s97 offen offset:3072  lds
    v_lshlrev_b32 v160, 16, v41
    v_lshlrev_b32 v161, 16, v43
    v_lshlrev_b32 v162, 16, v45
    v_lshlrev_b32 v163, 16, v47
    v_lshlrev_b32 v164, 16, v49
    s_add_u32 m0, s88, 36864
    s_mov_b64 exec, 0xffffffff
    buffer_load_dwordx4 v3, s[28:31], s97 offen offset:0  lds
    s_mov_b64 exec, -1
    v_lshlrev_b32 v165, 16, v51
    v_lshlrev_b32 v166, 16, v53
    v_lshlrev_b32 v167, 16, v55
    v_lshlrev_b32 v168, 16, v57
    v_lshlrev_b32 v169, 16, v59
    v_lshlrev_b32 v170, 16, v61
    v_lshlrev_b32 v172, 16, v88
    v_and_b32 v173, 0xffff0000, v88
    v_lshlrev_b32 v174, 16, v89
    v_and_b32 v175, 0xffff0000, v89
    v_lshlrev_b32 v176, 16, v69
    v_lshlrev_b32 v177, 16, v71
    v_lshlrev_b32 v178, 16, v73
    v_lshlrev_b32 v179, 16, v75
    v_lshlrev_b32 v180, 16, v77
    v_lshlrev_b32 v181, 16, v79
    v_lshlrev_b32 v182, 16, v81
    v_lshlrev_b32 v183, 16, v83
    v_mul_f32 v184, v160, v175
    v_mul_f32 v185, v161, v175
    v_mul_f32 v186, v162, v175
    v_mul_f32 v187, v163, v175
    v_mul_f32 v188, v164, v175
    v_mul_f32 v189, v165, v175
    v_mul_f32 v190, v166, v175
    v_mul_f32 v191, v167, v175
    v_fmac_f32 v184, v161, v174
    v_fmac_f32 v185, v162, v174
    v_fmac_f32 v186, v163, v174
    v_fmac_f32 v187, v164, v174
    v_fmac_f32 v188, v165, v174
    v_fmac_f32 v189, v166, v174
    v_fmac_f32 v190, v167, v174
    v_fmac_f32 v191, v168, v174
    v_fmac_f32 v184, v162, v173
    v_fmac_f32 v185, v163, v173
    v_fmac_f32 v186, v164, v173
    v_fmac_f32 v187, v165, v173
    v_fmac_f32 v188, v166, v173
    v_fmac_f32 v189, v167, v173
    v_fmac_f32 v190, v168, v173
    s_waitcnt vmcnt(13)
    s_barrier
    s_mul_i32 s16, s97, 3072
    s_add_u32 m0, s60, 49152
    s_add_u32 s99, s16, s62
    buffer_load_dwordx4 v244, s[32:35], s99 offen offset:0  lds
    v_fmac_f32 v191, v169, v173
    v_fmac_f32 v184, v163, v172
    v_fmac_f32 v185, v164, v172
    v_fmac_f32 v186, v165, v172
    v_fmac_f32 v187, v166, v172
    buffer_load_dwordx4 v245, s[32:35], s99 offen offset:1024  lds
    v_fmac_f32 v188, v167, v172
    v_fmac_f32 v189, v168, v172
    v_fmac_f32 v190, v169, v172
    v_fmac_f32 v191, v170, v172
    v_mul_f32 v184, v184, v176
    buffer_load_dwordx4 v246, s[32:35], s99 offen offset:2048  lds
    v_mul_f32 v185, v185, v177
    v_mul_f32 v186, v186, v178
    v_mul_f32 v187, v187, v179
    v_mul_f32 v188, v188, v180
    v_mul_f32 v189, v189, v181
    s_add_u32 m0, s61, 61440
    s_add_u32 s16, s16, s63
    buffer_load_dwordx4 v244, s[32:35], s16 offen offset:0  lds
    v_mul_f32 v190, v190, v182
    v_mul_f32 v191, v191, v183
    v_cvt_pk_bf16_f32 v108, v191, v190
    v_cvt_pk_bf16_f32 v109, v189, v188
    v_cvt_pk_bf16_f32 v110, v187, v186
    buffer_load_dwordx4 v245, s[32:35], s16 offen offset:1024  lds
    v_cvt_pk_bf16_f32 v111, v185, v184
    s_mov_b32 s89, 32768
    buffer_store_dwordx4 v[108:111], v12, s[52:55], s89 offen sc1
    v_and_b32 v160, 0xffff0000, v41
    v_and_b32 v161, 0xffff0000, v43
    v_and_b32 v162, 0xffff0000, v45
    buffer_load_dwordx4 v246, s[32:35], s16 offen offset:2048  lds
    v_and_b32 v163, 0xffff0000, v47
    v_and_b32 v164, 0xffff0000, v49
    v_and_b32 v165, 0xffff0000, v51
    v_and_b32 v166, 0xffff0000, v53
    v_and_b32 v167, 0xffff0000, v55
    s_add_u32 s97, s98, s0
    s_lshr_b64 s[0:1], s[0:1], 4
    s_and_b32 s97, s97, 15
    s_add_u32 m0, s87, 0
    s_lshl_b32 s97, s97, 7
    buffer_load_dwordx4 v240, s[28:31], s97 offen offset:0  lds
    v_and_b32 v168, 0xffff0000, v57
    v_and_b32 v169, 0xffff0000, v59
    v_and_b32 v170, 0xffff0000, v61
    v_lshlrev_b32 v172, 16, v90
    v_and_b32 v173, 0xffff0000, v90
    buffer_load_dwordx4 v241, s[28:31], s97 offen offset:1024  lds
    v_lshlrev_b32 v174, 16, v91
    v_and_b32 v175, 0xffff0000, v91
    v_and_b32 v176, 0xffff0000, v69
    v_and_b32 v177, 0xffff0000, v71
    v_and_b32 v178, 0xffff0000, v73
    buffer_load_dwordx4 v242, s[28:31], s97 offen offset:2048  lds
    v_and_b32 v179, 0xffff0000, v75
    v_and_b32 v180, 0xffff0000, v77
    v_and_b32 v181, 0xffff0000, v79
    v_and_b32 v182, 0xffff0000, v81
    v_and_b32 v183, 0xffff0000, v83
    buffer_load_dwordx4 v243, s[28:31], s97 offen offset:3072  lds
    v_mul_f32 v184, v160, v175
    v_mul_f32 v185, v161, v175
    v_mul_f32 v186, v162, v175
    v_mul_f32 v187, v163, v175
    v_mul_f32 v188, v164, v175
    s_add_u32 m0, s88, 0
    s_mov_b64 exec, 0xffffffff
    buffer_load_dwordx4 v3, s[28:31], s97 offen offset:0  lds
    s_mov_b64 exec, -1
    v_mul_f32 v189, v165, v175
    v_mul_f32 v190, v166, v175
    v_mul_f32 v191, v167, v175
    v_fmac_f32 v184, v161, v174
    v_fmac_f32 v185, v162, v174
    v_fmac_f32 v186, v163, v174
    v_fmac_f32 v187, v164, v174
    v_fmac_f32 v188, v165, v174
    v_fmac_f32 v189, v166, v174
    v_fmac_f32 v190, v167, v174
    v_fmac_f32 v191, v168, v174
    v_fmac_f32 v184, v162, v173
    v_fmac_f32 v185, v163, v173
    v_fmac_f32 v186, v164, v173
    v_fmac_f32 v187, v165, v173
    v_fmac_f32 v188, v166, v173
    v_fmac_f32 v189, v167, v173
    v_fmac_f32 v190, v168, v173
    v_fmac_f32 v191, v169, v173
    v_fmac_f32 v184, v163, v172
    v_fmac_f32 v185, v164, v172
    v_fmac_f32 v186, v165, v172
    v_fmac_f32 v187, v166, v172
    v_fmac_f32 v188, v167, v172
    v_fmac_f32 v189, v168, v172
    v_fmac_f32 v190, v169, v172
    v_fmac_f32 v191, v170, v172
    v_mul_f32 v184, v184, v176
    v_mul_f32 v185, v185, v177
    v_mul_f32 v186, v186, v178
    v_mul_f32 v187, v187, v179
    v_mul_f32 v188, v188, v180
    v_mul_f32 v189, v189, v181
    v_mul_f32 v190, v190, v182
    v_mul_f32 v191, v191, v183
    v_cvt_pk_bf16_f32 v112, v191, v190
    v_cvt_pk_bf16_f32 v113, v189, v188
    v_cvt_pk_bf16_f32 v114, v187, v186
    v_cvt_pk_bf16_f32 v115, v185, v184
    s_mov_b32 s89, 49152
    buffer_store_dwordx4 v[112:115], v12, s[52:55], s89 offen sc1
    s_waitcnt vmcnt(13)
    s_barrier
    s_mul_i32 s16, s97, 3072
    s_add_u32 m0, s60, 0
    s_add_u32 s99, s16, s62
    buffer_load_dwordx4 v244, s[32:35], s99 offen offset:0  lds
    buffer_load_dwordx4 v245, s[32:35], s99 offen offset:1024  lds
    buffer_load_dwordx4 v246, s[32:35], s99 offen offset:2048  lds
    s_add_u32 m0, s61, 12288
    s_add_u32 s16, s16, s63
    buffer_load_dwordx4 v244, s[32:35], s16 offen offset:0  lds
    buffer_load_dwordx4 v245, s[32:35], s16 offen offset:1024  lds
    buffer_load_dwordx4 v246, s[32:35], s16 offen offset:2048  lds
    s_add_u32 s97, s98, s0
    s_lshr_b64 s[0:1], s[0:1], 4
    s_and_b32 s97, s97, 15
    s_add_u32 m0, s87, 18432
    s_lshl_b32 s97, s97, 7
    buffer_load_dwordx4 v240, s[28:31], s97 offen offset:0  lds
    buffer_load_dwordx4 v241, s[28:31], s97 offen offset:1024  lds
    buffer_load_dwordx4 v242, s[28:31], s97 offen offset:2048  lds
    buffer_load_dwordx4 v243, s[28:31], s97 offen offset:3072  lds
    s_add_u32 m0, s88, 18432
    s_mov_b64 exec, 0xffffffff
    buffer_load_dwordx4 v3, s[28:31], s97 offen offset:0  lds
    s_mov_b64 exec, -1
    s_waitcnt vmcnt(12)
    s_barrier
    s_mul_i32 s16, s97, 3072
    s_add_u32 m0, s60, 24576
    s_add_u32 s99, s16, s62
    buffer_load_dwordx4 v244, s[32:35], s99 offen offset:0  lds
    s_mov_b32 s68, s24
    s_mov_b32 s69, s25
    s_mov_b32 s70, 0x100
    s_mov_b32 s71, 0x20000
    buffer_load_dwordx4 v245, s[32:35], s99 offen offset:1024  lds
    v_lshrrev_b32 v6, 5, v0
    v_and_b32 v7, 3, v0
    s_lshr_b32 s78, s90, 1
    s_lshl_b32 s78, s78, 2
    buffer_load_dwordx4 v246, s[32:35], s99 offen offset:2048  lds
    s_load_dword s92, s[14:15], s78
    v_bfe_u32 v5, v0, 2, 2
    v_lshlrev_b32 v5, 1, v5
    s_add_u32 m0, s61, 36864
    s_add_u32 s16, s16, s63
    buffer_load_dwordx4 v244, s[32:35], s16 offen offset:0  lds
    v_lshl_add_u32 v5, v6, 3, v5
    v_bfe_u32 v8, v0, 4, 1
    v_add_u32 v5, v5, v8
    s_and_b32 s78, s3, 1
    buffer_load_dwordx4 v245, s[32:35], s16 offen offset:1024  lds
    s_lshl_b32 s78, s78, 1
    v_add_u32 v8, s78, v6
    v_xor_b32 v8, v8, v7
    v_lshlrev_b32 v8, 4, v8
    buffer_load_dwordx4 v246, s[32:35], s16 offen offset:2048  lds
    v_lshl_add_u32 v5, v5, 6, v8
    v_add_u32 v14, s86, v5
    v_mov_b32 v18, 162304
    s_add_u32 s97, s98, s0
    s_lshr_b64 s[0:1], s[0:1], 4
    s_and_b32 s97, s97, 15
    s_add_u32 m0, s87, 36864
    s_lshl_b32 s97, s97, 7
    buffer_load_dwordx4 v240, s[28:31], s97 offen offset:0  lds
    v_mov_b32 v19, 1
    v_and_b32 v5, 3, v0
    s_lshl_b32 s78, s74, 4
    s_add_u32 s78, s78, s3
    buffer_load_dwordx4 v241, s[28:31], s97 offen offset:1024  lds
    v_lshl_add_u32 v6, v5, 2, s78
    s_lshr_b32 s78, s76, 3
    s_lshl_b32 s79, s3, 1
    s_add_u32 s78, s78, s79
    buffer_load_dwordx4 v242, s[28:31], s97 offen offset:2048  lds
    s_xor_b32 s78, s78, 2
    s_lshl_b32 s78, s78, 5
    s_add_u32 s79, s76, 5
    buffer_load_dwordx4 v243, s[28:31], s97 offen offset:3072  lds
    s_and_b32 s79, s79, 7
    s_lshl_b32 s79, s79, 1
    s_add_u32 s78, s78, s79
    v_mul_u32_u24 v7, 9, v5
    s_add_u32 m0, s88, 36864
    s_mov_b64 exec, 0xffffffff
    buffer_load_dwordx4 v3, s[28:31], s97 offen offset:0  lds
    s_mov_b64 exec, -1
    v_and_b32 v7, 17, v7
    v_add_u32 v7, s78, v7
    v_and_b32 v8, 4, v0
    s_waitcnt vmcnt(11)
    s_barrier
    s_mul_i32 s16, s97, 3072
    s_add_u32 m0, s60, 49152
    s_add_u32 s99, s16, s62
    buffer_load_dwordx4 v244, s[32:35], s99 offen offset:0  lds
    v_cmp_eq_u32 vcc, 0, v8
    s_nop 1
    v_cndmask_b32 v6, v7, v6, vcc
    v_and_b32 v33, 0xf0, v6
    buffer_load_dwordx4 v245, s[32:35], s99 offen offset:1024  lds
    v_lshlrev_b32 v34, 8, v6
    v_add_u32 v34, 12582912, v34
    v_and_b32 v5, 15, v0
    buffer_load_dwordx4 v246, s[32:35], s99 offen offset:2048  lds
    v_lshrrev_b32 v6, 4, v0
    v_add_u32 v7, 9, v5
    s_add_u32 m0, s61, 61440
    s_add_u32 s16, s16, s63
    buffer_load_dwordx4 v244, s[32:35], s16 offen offset:0  lds
    v_and_b32 v8, 1, v7
    v_mul_u32_u24 v8, 4160, v8
    v_lshrrev_b32 v7, 1, v7
    buffer_load_dwordx4 v245, s[32:35], s16 offen offset:1024  lds
    v_lshl_add_u32 v8, v7, 2, v8
    v_lshlrev_b32 v7, 4, v6
    v_sub_u32 v8, v8, v7
    buffer_load_dwordx4 v246, s[32:35], s16 offen offset:2048  lds
    s_add_u32 s78, s94, 32
    v_add_u32 v21, s78, v8
    s_add_u32 m0, s94, 32
    s_lshl_b32 s89, s90, 12
    buffer_load_dwordx4 v15, s[48:51], s89 offen offset:0 nt lds
    v_add_u32 v22, 1024, v21
    v_add_u32 v23, 2048, v21
    v_add_u32 v24, 3072, v21
    s_add_u32 m0, s94, 32
    s_lshl_b32 s89, s90, 12
    buffer_load_dwordx4 v15, s[48:51], s89 offen offset:1024 nt lds
    v_lshl_add_u32 v7, v5, 1, v6
    v_add_u32 v7, 30, v7
    v_and_b32 v8, 1, v7
    s_add_u32 m0, s94, 32
    s_lshl_b32 s89, s90, 12
    buffer_load_dwordx4 v15, s[48:51], s89 offen offset:2048 nt lds
    v_bfe_u32 v136, v7, 1, 2
    v_lshl_add_u32 v136, v8, 2, v136
    s_add_u32 m0, s94, 32
    s_lshl_b32 s89, s90, 12
    buffer_load_dwordx4 v15, s[48:51], s89 offen offset:3072 nt lds
    v_lshlrev_b32 v136, 6, v136
    v_lshrrev_b32 v7, 3, v7
    v_lshl_add_u32 v136, v7, 9, v136
    s_add_u32 s97, s98, s0
    s_lshr_b64 s[0:1], s[0:1], 4
    s_and_b32 s97, s97, 15
    s_add_u32 m0, s87, 0
    s_lshl_b32 s97, s97, 7
    buffer_load_dwordx4 v240, s[28:31], s97 offen offset:0  lds
    v_bitop3_b32 v8, v7, 3, s3 bitop3:0x6a
    v_lshl_add_u32 v25, v8, 4, v136
    v_add_u32 v25, 92160, v25
    buffer_load_dwordx4 v241, s[28:31], s97 offen offset:1024  lds
    v_subrev_u32 v7, 1, v7
    v_bitop3_b32 v8, v7, 3, s3 bitop3:0x6a
    buffer_load_dwordx4 v242, s[28:31], s97 offen offset:2048  lds
    v_lshl_add_u32 v27, v8, 4, v136
    v_add_u32 v27, 91648, v27
    v_subrev_u32 v7, 1, v7
    buffer_load_dwordx4 v243, s[28:31], s97 offen offset:3072  lds
    v_bitop3_b32 v8, v7, 3, s3 bitop3:0x6a
    v_lshl_add_u32 v29, v8, 4, v136
    v_add_u32 v29, 91136, v29
    s_add_u32 m0, s88, 0
    s_mov_b64 exec, 0xffffffff
    buffer_load_dwordx4 v3, s[28:31], s97 offen offset:0  lds
    s_mov_b64 exec, -1
    v_subrev_u32 v7, 1, v7
    v_bitop3_b32 v8, v7, 3, s3 bitop3:0x6a
    s_waitcnt vmcnt(15)
    s_barrier
    s_mul_i32 s16, s97, 3072
    s_add_u32 m0, s60, 0
    s_add_u32 s99, s16, s62
    buffer_load_dwordx4 v244, s[32:35], s99 offen offset:0  lds
    v_lshl_add_u32 v31, v8, 4, v136
    v_add_u32 v31, 90624, v31
    v_lshl_add_u32 v7, v5, 1, v6
    v_add_u32 v7, 26, v7
    buffer_load_dwordx4 v245, s[32:35], s99 offen offset:1024  lds
    v_and_b32 v8, 1, v7
    v_bfe_u32 v136, v7, 1, 2
    v_lshl_add_u32 v136, v8, 2, v136
    v_lshlrev_b32 v136, 6, v136
    buffer_load_dwordx4 v246, s[32:35], s99 offen offset:2048  lds
    v_lshrrev_b32 v7, 3, v7
    v_lshl_add_u32 v136, v7, 9, v136
    v_bitop3_b32 v8, v7, 3, s3 bitop3:0x6a
    s_add_u32 m0, s61, 12288
    s_add_u32 s16, s16, s63
    buffer_load_dwordx4 v244, s[32:35], s16 offen offset:0  lds
    v_lshl_add_u32 v26, v8, 4, v136
    v_add_u32 v26, 92160, v26
    v_subrev_u32 v7, 1, v7
    v_bitop3_b32 v8, v7, 3, s3 bitop3:0x6a
    buffer_load_dwordx4 v245, s[32:35], s16 offen offset:1024  lds
    v_lshl_add_u32 v28, v8, 4, v136
    v_add_u32 v28, 91648, v28
    v_subrev_u32 v7, 1, v7
    v_bitop3_b32 v8, v7, 3, s3 bitop3:0x6a
    buffer_load_dwordx4 v246, s[32:35], s16 offen offset:2048  lds
    v_lshl_add_u32 v30, v8, 4, v136
    v_add_u32 v30, 91136, v30
    v_subrev_u32 v7, 1, v7
    s_add_u32 s97, s98, s0
    s_lshr_b64 s[0:1], s[0:1], 4
    s_and_b32 s97, s97, 15
    s_add_u32 m0, s87, 18432
    s_lshl_b32 s97, s97, 7
    buffer_load_dwordx4 v240, s[28:31], s97 offen offset:0  lds
    v_bitop3_b32 v8, v7, 3, s3 bitop3:0x6a
    v_lshl_add_u32 v32, v8, 4, v136
    v_add_u32 v32, 90624, v32
    v_lshrrev_b32 v7, 1, v6
    buffer_load_dwordx4 v241, s[28:31], s97 offen offset:1024  lds
    v_lshl_add_u32 v7, v5, 1, v7
    v_add_u32 v7, 32, v7
    v_and_b32 v8, 1, v7
    v_bfe_u32 v136, v7, 1, 2
    buffer_load_dwordx4 v242, s[28:31], s97 offen offset:2048  lds
    v_lshl_add_u32 v136, v8, 2, v136
    v_lshlrev_b32 v136, 6, v136
    v_lshrrev_b32 v7, 3, v7
    buffer_load_dwordx4 v243, s[28:31], s97 offen offset:3072  lds
    v_lshl_add_u32 v136, v7, 9, v136
    v_bitop3_b32 v8, v7, 3, s3 bitop3:0x6a
    v_lshl_add_u32 v20, v8, 4, v136
    v_add_u32 v20, 92160, v20
    s_add_u32 m0, s88, 18432
    s_mov_b64 exec, 0xffffffff
    buffer_load_dwordx4 v3, s[28:31], s97 offen offset:0  lds
    s_mov_b64 exec, -1
    v_and_b32 v8, 1, v6
    v_xor_b32 v8, 1, v8
    v_lshl_add_u32 v20, v8, 3, v20
    s_waitcnt vmcnt(11)
    s_barrier
    s_mul_i32 s16, s97, 3072
    s_add_u32 m0, s60, 24576
    s_add_u32 s99, s16, s62
    buffer_load_dwordx4 v244, s[32:35], s99 offen offset:0  lds
    s_waitcnt lgkmcnt(0)
    s_and_b32 s78, s92, 0xffff0000
    s_lshl_b32 s92, s92, 16
    buffer_load_dwordx4 v245, s[32:35], s99 offen offset:1024  lds
    s_bitcmp1_b32 s90, 0
    s_cselect_b32 s92, s78, s92
    v_lshlrev_b32 v7, 3, v6
    v_sub_u32 v7, v7, v5
    buffer_load_dwordx4 v246, s[32:35], s99 offen offset:2048  lds
    v_subrev_u32 v7, 9, v7
    v_and_b32 v8, 1, v7
    v_xor_b32 v8, 1, v8
    s_add_u32 m0, s61, 36864
    s_add_u32 s16, s16, s63
    buffer_load_dwordx4 v244, s[32:35], s16 offen offset:0  lds
    v_lshlrev_b32 v8, 4, v8
    v_lshrrev_b32 v8, v8, s92
    v_ashrrev_i32 v7, 1, v7
    buffer_load_dwordx4 v245, s[32:35], s16 offen offset:1024  lds
    v_cmp_eq_u32 vcc, 0, v7
    s_nop 1
    v_cndmask_b32 v236, 0, v8, vcc
    v_cmp_eq_u32 vcc, 1, v7
    buffer_load_dwordx4 v246, s[32:35], s16 offen offset:2048  lds
    s_nop 0
    v_cndmask_b32 v237, 0, v8, vcc
    v_cmp_eq_u32 vcc, 2, v7
    s_nop 1
    v_cndmask_b32 v238, 0, v8, vcc
    s_add_u32 s97, s98, s0
    s_lshr_b64 s[0:1], s[0:1], 4
    s_and_b32 s97, s97, 15
    s_add_u32 m0, s87, 36864
    s_lshl_b32 s97, s97, 7
    buffer_load_dwordx4 v240, s[28:31], s97 offen offset:0  lds
    v_cmp_eq_u32 vcc, 3, v7
    s_nop 1
    v_cndmask_b32 v239, 0, v8, vcc
    s_and_b32 s78, s77, 7
    s_mov_b32 s95, 0x76543210
    s_and_b32 s78, s76, 3
    s_mul_i32 s78, s78, 0x22222222
    s_add_u32 s95, s95, s78
    s_bfe_u32 s17, s95, 0x30000
    s_lshl_b32 s17, s17, 18
    s_bfe_u32 s18, s95, 0x30004
    s_lshl_b32 s18, s18, 18
    s_bfe_u32 s100, s95, 0x3001c
    s_lshl_b32 s100, s100, 18
    s_bfe_u32 s95, s95, 0x30018
    s_lshl_b32 s95, s95, 18
    buffer_load_dwordx4 v241, s[28:31], s97 offen offset:1024  lds
    v_lshrrev_b32 v136, 4, v0
    v_lshlrev_b32 v136, 1, v136
    v_and_b32 v137, 7, v0
    buffer_load_dwordx4 v242, s[28:31], s97 offen offset:2048  lds
    v_xor_b32 v136, v136, v137
    v_lshlrev_b32 v136, 4, v136
    v_lshrrev_b32 v137, 3, v0
    buffer_load_dwordx4 v243, s[28:31], s97 offen offset:3072  lds
    v_lshl_add_u32 v136, v137, 11, v136
    s_lshl_b32 s78, s77, 7
    s_lshl_b32 s79, s3, 14
    s_add_u32 m0, s88, 36864
    s_mov_b64 exec, 0xffffffff
    buffer_load_dwordx4 v3, s[28:31], s97 offen offset:0  lds
    s_mov_b64 exec, -1
    s_add_u32 s78, s78, s79
    v_add_u32 v17, s78, v136
    s_waitcnt vmcnt(11)
    s_barrier
    s_mul_i32 s16, s97, 3072
    s_add_u32 m0, s60, 49152
    s_add_u32 s99, s16, s62
    buffer_load_dwordx4 v244, s[32:35], s99 offen offset:0  lds
    v_add_u32 v5, s94, v15
    ds_read_b128 v[140:143], v5 offset:32
    ds_read_b32 v156, v5 offset:48
    ds_read_b128 v[144:147], v5 offset:1056
    buffer_load_dwordx4 v245, s[32:35], s99 offen offset:1024  lds
    ds_read_b32 v157, v5 offset:1072
    ds_read_b128 v[148:151], v5 offset:2080
    ds_read_b32 v158, v5 offset:2096
    ds_read_b128 v[152:155], v5 offset:3104
    buffer_load_dwordx4 v246, s[32:35], s99 offen offset:2048  lds
    ds_read_b32 v159, v5 offset:3120
    v_lshrrev_b32 v6, 3, v0
    v_mul_u32_u24 v6, 4160, v6
    s_add_u32 m0, s61, 61440
    s_add_u32 s16, s16, s63
    buffer_load_dwordx4 v244, s[32:35], s16 offen offset:0  lds
    v_and_b32 v7, 7, v0
    v_lshl_add_u32 v6, v7, 2, v6
    v_add_u32 v6, s94, v6
    v_mov_b32 v7, 0
    buffer_load_dwordx4 v245, s[32:35], s16 offen offset:1024  lds
    s_waitcnt lgkmcnt(0)
    v_readfirstlane_b32 s93, v140
    s_nop 0
    s_lshl_b32 s93, s93, 16
    s_nop 1
    v_writelane_b32 v7, s93, 15
    buffer_load_dwordx4 v246, s[32:35], s16 offen offset:2048  lds
    v_alignbit_b32 v140, v141, v140, 16
    v_alignbit_b32 v141, v142, v141, 16
    v_alignbit_b32 v142, v143, v142, 16
    s_add_u32 s97, s98, s0
    s_lshr_b64 s[0:1], s[0:1], 4
    s_and_b32 s97, s97, 15
    s_add_u32 m0, s87, 0
    s_lshl_b32 s97, s97, 7
    buffer_load_dwordx4 v240, s[28:31], s97 offen offset:0  lds
    v_alignbit_b32 v143, v156, v143, 16
    v_alignbit_b32 v144, v145, v144, 16
    v_alignbit_b32 v145, v146, v145, 16
    v_alignbit_b32 v146, v147, v146, 16
    buffer_load_dwordx4 v241, s[28:31], s97 offen offset:1024  lds
    v_alignbit_b32 v147, v157, v147, 16
    v_alignbit_b32 v148, v149, v148, 16
    v_alignbit_b32 v149, v150, v149, 16
    v_alignbit_b32 v150, v151, v150, 16
    buffer_load_dwordx4 v242, s[28:31], s97 offen offset:2048  lds
    v_alignbit_b32 v151, v158, v151, 16
    v_alignbit_b32 v152, v153, v152, 16
    v_alignbit_b32 v153, v154, v153, 16
    buffer_load_dwordx4 v243, s[28:31], s97 offen offset:3072  lds
    v_alignbit_b32 v154, v155, v154, 16
    v_alignbit_b32 v155, v159, v155, 16
    v_lshlrev_b32 v8, 3, v0
    s_add_u32 s78, s88, 18432
    s_add_u32 m0, s88, 0
    s_mov_b64 exec, 0xffffffff
    buffer_load_dwordx4 v3, s[28:31], s97 offen offset:0  lds
    s_mov_b64 exec, -1
    v_add_u32 v8, s78, v8
    v_mov_b32 v156, 0
    v_mov_b32 v157, 0
    s_waitcnt vmcnt(11)
    s_barrier
    s_mul_i32 s16, s97, 3072
    s_add_u32 m0, s60, 0
    s_add_u32 s99, s16, s62
    buffer_load_dwordx4 v244, s[32:35], s99 offen offset:0  lds
    buffer_load_dwordx4 v245, s[32:35], s99 offen offset:1024  lds
    buffer_load_dwordx4 v246, s[32:35], s99 offen offset:2048  lds
    s_add_u32 m0, s61, 12288
    s_add_u32 s16, s16, s63
    buffer_load_dwordx4 v244, s[32:35], s16 offen offset:0  lds
    buffer_load_dwordx4 v245, s[32:35], s16 offen offset:1024  lds
    buffer_load_dwordx4 v246, s[32:35], s16 offen offset:2048  lds
    s_mov_b64 exec, 0xff
    buffer_load_dword v136, v33, s[68:71], 0 offen sc1
    buffer_load_dword v137, v34, s[52:55], 0 offen sc1
    s_mov_b64 exec, -1
    buffer_load_dwordx4 v[212:215], v9, s[56:59], 0 offen offset:0 nt
    buffer_load_dwordx4 v[216:219], v9, s[56:59], 0 offen offset:2048 nt
    buffer_load_dwordx4 v[220:223], v9, s[56:59], s96 offen offset:0 nt
    buffer_load_dwordx4 v[224:227], v9, s[56:59], s96 offen offset:2048 nt
    s_waitcnt vmcnt(12)
    s_waitcnt vmcnt(6)
    s_barrier
    s_waitcnt vmcnt(4)
    s_branch LA_j
LA_c2:
    s_waitcnt vmcnt(8)
    s_barrier
    buffer_load_dwordx4 v242, s[28:31], s97 offen offset:2048  lds
    buffer_load_dwordx4 v243, s[28:31], s97 offen offset:3072  lds
    s_add_u32 m0, s88, 36864
    s_mov_b64 exec, 0xffffffff
    buffer_load_dwordx4 v3, s[28:31], s97 offen offset:0  lds
    s_mov_b64 exec, -1
    s_mul_i32 s16, s97, 3072
    s_add_u32 m0, s60, 49152
    s_add_u32 s99, s16, s62
    buffer_load_dwordx4 v244, s[32:35], s99 offen offset:0  lds
    buffer_load_dwordx4 v245, s[32:35], s99 offen offset:1024  lds
    buffer_load_dwordx4 v246, s[32:35], s99 offen offset:2048  lds
    s_add_u32 m0, s61, 61440
    s_add_u32 s16, s16, s63
    buffer_load_dwordx4 v244, s[32:35], s16 offen offset:0  lds
    buffer_load_dwordx4 v245, s[32:35], s16 offen offset:1024  lds
    buffer_load_dwordx4 v246, s[32:35], s16 offen offset:2048  lds
    s_add_u32 s97, s98, s0
    s_lshr_b64 s[0:1], s[0:1], 4
    s_and_b32 s97, s97, 15
    s_add_u32 m0, s87, 0
    s_lshl_b32 s97, s97, 7
    buffer_load_dwordx4 v240, s[28:31], s97 offen offset:0  lds
    buffer_load_dwordx4 v241, s[28:31], s97 offen offset:1024  lds
    buffer_load_dwordx4 v242, s[28:31], s97 offen offset:2048  lds
    buffer_load_dwordx4 v243, s[28:31], s97 offen offset:3072  lds
    s_add_u32 m0, s88, 0
    s_mov_b64 exec, 0xffffffff
    buffer_load_dwordx4 v3, s[28:31], s97 offen offset:0  lds
    s_mov_b64 exec, -1
    s_waitcnt vmcnt(11)
    s_barrier
    s_mul_i32 s16, s97, 3072
    s_add_u32 m0, s60, 0
    s_add_u32 s99, s16, s62
    buffer_load_dwordx4 v244, s[32:35], s99 offen offset:0  lds
    buffer_load_dwordx4 v245, s[32:35], s99 offen offset:1024  lds
    buffer_load_dwordx4 v246, s[32:35], s99 offen offset:2048  lds
    s_add_u32 m0, s61, 12288
    s_add_u32 s16, s16, s63
    buffer_load_dwordx4 v244, s[32:35], s16 offen offset:0  lds
    buffer_load_dwordx4 v245, s[32:35], s16 offen offset:1024  lds
    buffer_load_dwordx4 v246, s[32:35], s16 offen offset:2048  lds
    s_add_u32 s97, s98, s0
    s_lshr_b64 s[0:1], s[0:1], 4
    s_and_b32 s97, s97, 15
    s_add_u32 m0, s87, 18432
    s_lshl_b32 s97, s97, 7
    buffer_load_dwordx4 v240, s[28:31], s97 offen offset:0  lds
    buffer_load_dwordx4 v241, s[28:31], s97 offen offset:1024  lds
    buffer_load_dwordx4 v242, s[28:31], s97 offen offset:2048  lds
    buffer_load_dwordx4 v243, s[28:31], s97 offen offset:3072  lds
    s_add_u32 m0, s88, 18432
    s_mov_b64 exec, 0xffffffff
    buffer_load_dwordx4 v3, s[28:31], s97 offen offset:0  lds
    s_mov_b64 exec, -1
    s_waitcnt vmcnt(11)
    s_barrier
    s_mul_i32 s16, s97, 3072
    s_add_u32 m0, s60, 24576
    s_add_u32 s99, s16, s62
    buffer_load_dwordx4 v244, s[32:35], s99 offen offset:0  lds
    buffer_load_dwordx4 v245, s[32:35], s99 offen offset:1024  lds
    buffer_load_dwordx4 v246, s[32:35], s99 offen offset:2048  lds
    s_add_u32 m0, s61, 36864
    s_add_u32 s16, s16, s63
    buffer_load_dwordx4 v244, s[32:35], s16 offen offset:0  lds
    buffer_load_dwordx4 v245, s[32:35], s16 offen offset:1024  lds
    buffer_load_dwordx4 v246, s[32:35], s16 offen offset:2048  lds
    s_add_u32 m0, s86, 129536
    s_mov_b32 s89, 0
    buffer_load_dwordx4 v10, s[36:39], s89 offen nt lds
    s_add_u32 m0, s86, 145920
    s_mov_b32 s89, 0
    buffer_load_dwordx4 v10, s[40:43], s89 offen nt lds
    s_add_u32 m0, s86, 133632
    s_mov_b32 s89, 65536
    buffer_load_dwordx4 v10, s[36:39], s89 offen nt lds
    s_add_u32 m0, s86, 150016
    s_mov_b32 s89, 65536
    buffer_load_dwordx4 v10, s[40:43], s89 offen nt lds
    s_add_u32 m0, s86, 137728
    s_mov_b32 s89, 131072
    buffer_load_dwordx4 v10, s[36:39], s89 offen nt lds
    s_add_u32 m0, s86, 154112
    s_mov_b32 s89, 131072
    buffer_load_dwordx4 v10, s[40:43], s89 offen nt lds
    s_add_u32 m0, s86, 141824
    s_mov_b32 s89, 196608
    buffer_load_dwordx4 v10, s[36:39], s89 offen nt lds
    s_add_u32 m0, s86, 158208
    s_mov_b32 s89, 196608
    buffer_load_dwordx4 v10, s[40:43], s89 offen nt lds
    s_mov_b64 exec, 0xff
    s_lshl_b32 s82, s3, 7
    s_add_u32 m0, s82, 129024
    s_mov_b32 s89, 0
    buffer_load_dwordx4 v11, s[36:39], s89 offen nt lds
    s_lshl_b32 s83, s74, 9
    s_add_u32 s83, s83, s82
    s_and_b32 s89, s3, 2
    s_lshl_b32 s89, s89, 3
    s_add_u32 s82, s82, s89
    s_add_u32 m0, s82, 162816
    s_add_u32 s89, s83, 0
    buffer_load_dwordx4 v15, s[44:47], s89 offen  lds
    s_mov_b64 exec, -1
    s_add_u32 s97, s98, s0
    s_lshr_b64 s[0:1], s[0:1], 4
    s_and_b32 s97, s97, 15
    s_add_u32 m0, s87, 36864
    s_lshl_b32 s97, s97, 7
    buffer_load_dwordx4 v240, s[28:31], s97 offen offset:0  lds
    buffer_load_dwordx4 v241, s[28:31], s97 offen offset:1024  lds
    buffer_load_dwordx4 v242, s[28:31], s97 offen offset:2048  lds
    buffer_load_dwordx4 v243, s[28:31], s97 offen offset:3072  lds
    s_add_u32 m0, s88, 36864
    s_mov_b64 exec, 0xffffffff
    buffer_load_dwordx4 v3, s[28:31], s97 offen offset:0  lds
    s_mov_b64 exec, -1
    s_waitcnt vmcnt(21)
    s_barrier
    s_mul_i32 s16, s97, 3072
    s_add_u32 m0, s60, 49152
    s_add_u32 s99, s16, s62
    buffer_load_dwordx4 v244, s[32:35], s99 offen offset:0  lds
    buffer_load_dwordx4 v245, s[32:35], s99 offen offset:1024  lds
    buffer_load_dwordx4 v246, s[32:35], s99 offen offset:2048  lds
    s_add_u32 m0, s61, 61440
    s_add_u32 s16, s16, s63
    buffer_load_dwordx4 v244, s[32:35], s16 offen offset:0  lds
    buffer_load_dwordx4 v245, s[32:35], s16 offen offset:1024  lds
    buffer_load_dwordx4 v246, s[32:35], s16 offen offset:2048  lds
    s_add_u32 s97, s98, s0
    s_lshr_b64 s[0:1], s[0:1], 4
    s_and_b32 s97, s97, 15
    s_add_u32 m0, s87, 0
    s_lshl_b32 s97, s97, 7
    buffer_load_dwordx4 v240, s[28:31], s97 offen offset:0  lds
    buffer_load_dwordx4 v241, s[28:31], s97 offen offset:1024  lds
    buffer_load_dwordx4 v242, s[28:31], s97 offen offset:2048  lds
    buffer_load_dwordx4 v243, s[28:31], s97 offen offset:3072  lds
    s_add_u32 m0, s88, 0
    s_mov_b64 exec, 0xffffffff
    buffer_load_dwordx4 v3, s[28:31], s97 offen offset:0  lds
    s_mov_b64 exec, -1
    s_waitcnt vmcnt(11)
    s_barrier
    s_mul_i32 s16, s97, 3072
    s_add_u32 m0, s60, 0
    s_add_u32 s99, s16, s62
    buffer_load_dwordx4 v244, s[32:35], s99 offen offset:0  lds
    ds_read_b128 v[84:87], v35 offset:0
    ds_read_b128 v[88:91], v35 offset:16
    buffer_load_dwordx4 v245, s[32:35], s99 offen offset:1024  lds
    ds_read_b64 v[40:41], v16 offset:0
    ds_read_b64 v[42:43], v231 offset:256
    buffer_load_dwordx4 v246, s[32:35], s99 offen offset:2048  lds
    ds_read_b64 v[44:45], v16 offset:256
    ds_read_b64 v[46:47], v16 offset:512
    s_add_u32 m0, s61, 12288
    s_add_u32 s16, s16, s63
    buffer_load_dwordx4 v244, s[32:35], s16 offen offset:0  lds
    ds_read_b64 v[48:49], v231 offset:512
    ds_read_b64 v[50:51], v16 offset:768
    buffer_load_dwordx4 v245, s[32:35], s16 offen offset:1024  lds
    ds_read_b64 v[52:53], v231 offset:768
    ds_read_b64 v[54:55], v16 offset:1024
    buffer_load_dwordx4 v246, s[32:35], s16 offen offset:2048  lds
    ds_read_b64 v[56:57], v231 offset:1024
    ds_read_b64 v[58:59], v16 offset:1280
    s_add_u32 s97, s98, s0
    s_lshr_b64 s[0:1], s[0:1], 4
    s_and_b32 s97, s97, 15
    s_add_u32 m0, s87, 18432
    s_lshl_b32 s97, s97, 7
    buffer_load_dwordx4 v240, s[28:31], s97 offen offset:0  lds
    ds_read_b64 v[60:61], v231 offset:1280
    ds_read_b64 v[68:69], v16 offset:16896
    buffer_load_dwordx4 v241, s[28:31], s97 offen offset:1024  lds
    ds_read_b64 v[70:71], v231 offset:16896
    ds_read_b64 v[72:73], v16 offset:17152
    buffer_load_dwordx4 v242, s[28:31], s97 offen offset:2048  lds
    ds_read_b64 v[74:75], v231 offset:17152
    ds_read_b64 v[76:77], v16 offset:17408
    buffer_load_dwordx4 v243, s[28:31], s97 offen offset:3072  lds
    ds_read_b64 v[78:79], v231 offset:17408
    ds_read_b64 v[80:81], v16 offset:17664
    s_add_u32 m0, s88, 18432
    s_mov_b64 exec, 0xffffffff
    buffer_load_dwordx4 v3, s[28:31], s97 offen offset:0  lds
    s_mov_b64 exec, -1
    ds_read_b64 v[82:83], v231 offset:17664
    s_waitcnt vmcnt(11)
    s_waitcnt lgkmcnt(0)
    s_barrier
    s_mul_i32 s16, s97, 3072
    s_add_u32 m0, s60, 24576
    s_add_u32 s99, s16, s62
    buffer_load_dwordx4 v244, s[32:35], s99 offen offset:0  lds
    v_lshlrev_b32 v160, 16, v40
    v_lshlrev_b32 v161, 16, v42
    v_lshlrev_b32 v162, 16, v44
    v_lshlrev_b32 v163, 16, v46
    v_lshlrev_b32 v164, 16, v48
    buffer_load_dwordx4 v245, s[32:35], s99 offen offset:1024  lds
    v_lshlrev_b32 v165, 16, v50
    v_lshlrev_b32 v166, 16, v52
    v_lshlrev_b32 v167, 16, v54
    v_lshlrev_b32 v168, 16, v56
    v_lshlrev_b32 v169, 16, v58
    buffer_load_dwordx4 v246, s[32:35], s99 offen offset:2048  lds
    v_lshlrev_b32 v170, 16, v60
    v_lshlrev_b32 v172, 16, v84
    v_and_b32 v173, 0xffff0000, v84
    v_lshlrev_b32 v174, 16, v85
    v_and_b32 v175, 0xffff0000, v85
    s_add_u32 m0, s61, 36864
    s_add_u32 s16, s16, s63
    buffer_load_dwordx4 v244, s[32:35], s16 offen offset:0  lds
    v_lshlrev_b32 v176, 16, v68
    v_lshlrev_b32 v177, 16, v70
    v_lshlrev_b32 v178, 16, v72
    v_lshlrev_b32 v179, 16, v74
    v_lshlrev_b32 v180, 16, v76
    buffer_load_dwordx4 v245, s[32:35], s16 offen offset:1024  lds
    v_lshlrev_b32 v181, 16, v78
    v_lshlrev_b32 v182, 16, v80
    v_lshlrev_b32 v183, 16, v82
    v_mul_f32 v184, v160, v175
    v_mul_f32 v185, v161, v175
    buffer_load_dwordx4 v246, s[32:35], s16 offen offset:2048  lds
    v_mul_f32 v186, v162, v175
    v_mul_f32 v187, v163, v175
    v_mul_f32 v188, v164, v175
    v_mul_f32 v189, v165, v175
    v_mul_f32 v190, v166, v175
    s_add_u32 s97, s98, s0
    s_lshr_b64 s[0:1], s[0:1], 4
    s_and_b32 s97, s97, 15
    s_add_u32 m0, s87, 36864
    s_lshl_b32 s97, s97, 7
    buffer_load_dwordx4 v240, s[28:31], s97 offen offset:0  lds
    v_mul_f32 v191, v167, v175
    v_fmac_f32 v184, v161, v174
    v_fmac_f32 v185, v162, v174
    v_fmac_f32 v186, v163, v174
    v_fmac_f32 v187, v164, v174
    buffer_load_dwordx4 v241, s[28:31], s97 offen offset:1024  lds
    v_fmac_f32 v188, v165, v174
    v_fmac_f32 v189, v166, v174
    v_fmac_f32 v190, v167, v174
    v_fmac_f32 v191, v168, v174
    v_fmac_f32 v184, v162, v173
    buffer_load_dwordx4 v242, s[28:31], s97 offen offset:2048  lds
    v_fmac_f32 v185, v163, v173
    v_fmac_f32 v186, v164, v173
    v_fmac_f32 v187, v165, v173
    v_fmac_f32 v188, v166, v173
    v_fmac_f32 v189, v167, v173
    buffer_load_dwordx4 v243, s[28:31], s97 offen offset:3072  lds
    v_fmac_f32 v190, v168, v173
    v_fmac_f32 v191, v169, v173
    v_fmac_f32 v184, v163, v172
    v_fmac_f32 v185, v164, v172
    v_fmac_f32 v186, v165, v172
    s_add_u32 m0, s88, 36864
    s_mov_b64 exec, 0xffffffff
    buffer_load_dwordx4 v3, s[28:31], s97 offen offset:0  lds
    s_mov_b64 exec, -1
    v_fmac_f32 v187, v166, v172
    v_fmac_f32 v188, v167, v172
    v_fmac_f32 v189, v168, v172
    v_fmac_f32 v190, v169, v172
    v_fmac_f32 v191, v170, v172
    v_mul_f32 v184, v184, v176
    v_mul_f32 v185, v185, v177
    v_mul_f32 v186, v186, v178
    v_mul_f32 v187, v187, v179
    v_mul_f32 v188, v188, v180
    v_mul_f32 v189, v189, v181
    v_mul_f32 v190, v190, v182
    v_mul_f32 v191, v191, v183
    v_cvt_pk_bf16_f32 v100, v191, v190
    v_cvt_pk_bf16_f32 v101, v189, v188
    v_cvt_pk_bf16_f32 v102, v187, v186
    v_cvt_pk_bf16_f32 v103, v185, v184
    s_mov_b32 s89, 0
    buffer_store_dwordx4 v[100:103], v12, s[52:55], s89 offen sc1
    v_and_b32 v160, 0xffff0000, v40
    v_and_b32 v161, 0xffff0000, v42
    v_and_b32 v162, 0xffff0000, v44
    v_and_b32 v163, 0xffff0000, v46
    v_and_b32 v164, 0xffff0000, v48
    v_and_b32 v165, 0xffff0000, v50
    v_and_b32 v166, 0xffff0000, v52
    v_and_b32 v167, 0xffff0000, v54
    v_and_b32 v168, 0xffff0000, v56
    v_and_b32 v169, 0xffff0000, v58
    v_and_b32 v170, 0xffff0000, v60
    v_lshlrev_b32 v172, 16, v86
    v_and_b32 v173, 0xffff0000, v86
    v_lshlrev_b32 v174, 16, v87
    v_and_b32 v175, 0xffff0000, v87
    v_and_b32 v176, 0xffff0000, v68
    v_and_b32 v177, 0xffff0000, v70
    v_and_b32 v178, 0xffff0000, v72
    v_and_b32 v179, 0xffff0000, v74
    v_and_b32 v180, 0xffff0000, v76
    v_and_b32 v181, 0xffff0000, v78
    v_and_b32 v182, 0xffff0000, v80
    v_and_b32 v183, 0xffff0000, v82
    s_waitcnt vmcnt(12)
    s_barrier
    s_mul_i32 s16, s97, 3072
    s_add_u32 m0, s60, 49152
    s_add_u32 s99, s16, s62
    buffer_load_dwordx4 v244, s[32:35], s99 offen offset:0  lds
    v_mul_f32 v184, v160, v175
    v_mul_f32 v185, v161, v175
    v_mul_f32 v186, v162, v175
    v_mul_f32 v187, v163, v175
    v_mul_f32 v188, v164, v175
    buffer_load_dwordx4 v245, s[32:35], s99 offen offset:1024  lds
    v_mul_f32 v189, v165, v175
    v_mul_f32 v190, v166, v175
    v_mul_f32 v191, v167, v175
    v_fmac_f32 v184, v161, v174
    v_fmac_f32 v185, v162, v174
    buffer_load_dwordx4 v246, s[32:35], s99 offen offset:2048  lds
    v_fmac_f32 v186, v163, v174
    v_fmac_f32 v187, v164, v174
    v_fmac_f32 v188, v165, v174
    v_fmac_f32 v189, v166, v174
    v_fmac_f32 v190, v167, v174
    s_add_u32 m0, s61, 61440
    s_add_u32 s16, s16, s63
    buffer_load_dwordx4 v244, s[32:35], s16 offen offset:0  lds
    v_fmac_f32 v191, v168, v174
    v_fmac_f32 v184, v162, v173
    v_fmac_f32 v185, v163, v173
    v_fmac_f32 v186, v164, v173
    v_fmac_f32 v187, v165, v173
    buffer_load_dwordx4 v245, s[32:35], s16 offen offset:1024  lds
    v_fmac_f32 v188, v166, v173
    v_fmac_f32 v189, v167, v173
    v_fmac_f32 v190, v168, v173
    v_fmac_f32 v191, v169, v173
    v_fmac_f32 v184, v163, v172
    buffer_load_dwordx4 v246, s[32:35], s16 offen offset:2048  lds
    v_fmac_f32 v185, v164, v172
    v_fmac_f32 v186, v165, v172
    v_fmac_f32 v187, v166, v172
    v_fmac_f32 v188, v167, v172
    v_fmac_f32 v189, v168, v172
    s_add_u32 s97, s98, s0
    s_lshr_b64 s[0:1], s[0:1], 4
    s_and_b32 s97, s97, 15
    s_add_u32 m0, s87, 0
    s_lshl_b32 s97, s97, 7
    buffer_load_dwordx4 v240, s[28:31], s97 offen offset:0  lds
    v_fmac_f32 v190, v169, v172
    v_fmac_f32 v191, v170, v172
    v_mul_f32 v184, v184, v176
    v_mul_f32 v185, v185, v177
    v_mul_f32 v186, v186, v178
    buffer_load_dwordx4 v241, s[28:31], s97 offen offset:1024  lds
    v_mul_f32 v187, v187, v179
    v_mul_f32 v188, v188, v180
    v_mul_f32 v189, v189, v181
    v_mul_f32 v190, v190, v182
    v_mul_f32 v191, v191, v183
    buffer_load_dwordx4 v242, s[28:31], s97 offen offset:2048  lds
    v_cvt_pk_bf16_f32 v104, v191, v190
    v_cvt_pk_bf16_f32 v105, v189, v188
    v_cvt_pk_bf16_f32 v106, v187, v186
    v_cvt_pk_bf16_f32 v107, v185, v184
    s_mov_b32 s89, 16384
    buffer_store_dwordx4 v[104:107], v12, s[52:55], s89 offen sc1
    buffer_load_dwordx4 v243, s[28:31], s97 offen offset:3072  lds
    v_lshlrev_b32 v160, 16, v41
    v_lshlrev_b32 v161, 16, v43
    v_lshlrev_b32 v162, 16, v45
    v_lshlrev_b32 v163, 16, v47
    v_lshlrev_b32 v164, 16, v49
    s_add_u32 m0, s88, 0
    s_mov_b64 exec, 0xffffffff
    buffer_load_dwordx4 v3, s[28:31], s97 offen offset:0  lds
    s_mov_b64 exec, -1
    v_lshlrev_b32 v165, 16, v51
    v_lshlrev_b32 v166, 16, v53
    v_lshlrev_b32 v167, 16, v55
    v_lshlrev_b32 v168, 16, v57
    v_lshlrev_b32 v169, 16, v59
    v_lshlrev_b32 v170, 16, v61
    v_lshlrev_b32 v172, 16, v88
    v_and_b32 v173, 0xffff0000, v88
    v_lshlrev_b32 v174, 16, v89
    v_and_b32 v175, 0xffff0000, v89
    v_lshlrev_b32 v176, 16, v69
    v_lshlrev_b32 v177, 16, v71
    v_lshlrev_b32 v178, 16, v73
    v_lshlrev_b32 v179, 16, v75
    v_lshlrev_b32 v180, 16, v77
    v_lshlrev_b32 v181, 16, v79
    v_lshlrev_b32 v182, 16, v81
    v_lshlrev_b32 v183, 16, v83
    v_mul_f32 v184, v160, v175
    v_mul_f32 v185, v161, v175
    v_mul_f32 v186, v162, v175
    v_mul_f32 v187, v163, v175
    v_mul_f32 v188, v164, v175
    v_mul_f32 v189, v165, v175
    v_mul_f32 v190, v166, v175
    v_mul_f32 v191, v167, v175
    v_fmac_f32 v184, v161, v174
    v_fmac_f32 v185, v162, v174
    v_fmac_f32 v186, v163, v174
    v_fmac_f32 v187, v164, v174
    v_fmac_f32 v188, v165, v174
    v_fmac_f32 v189, v166, v174
    v_fmac_f32 v190, v167, v174
    v_fmac_f32 v191, v168, v174
    v_fmac_f32 v184, v162, v173
    v_fmac_f32 v185, v163, v173
    v_fmac_f32 v186, v164, v173
    v_fmac_f32 v187, v165, v173
    v_fmac_f32 v188, v166, v173
    v_fmac_f32 v189, v167, v173
    v_fmac_f32 v190, v168, v173
    s_waitcnt vmcnt(13)
    s_barrier
    s_mul_i32 s16, s97, 3072
    s_add_u32 m0, s60, 0
    s_add_u32 s99, s16, s62
    buffer_load_dwordx4 v244, s[32:35], s99 offen offset:0  lds
    v_fmac_f32 v191, v169, v173
    v_fmac_f32 v184, v163, v172
    v_fmac_f32 v185, v164, v172
    v_fmac_f32 v186, v165, v172
    v_fmac_f32 v187, v166, v172
    buffer_load_dwordx4 v245, s[32:35], s99 offen offset:1024  lds
    v_fmac_f32 v188, v167, v172
    v_fmac_f32 v189, v168, v172
    v_fmac_f32 v190, v169, v172
    v_fmac_f32 v191, v170, v172
    v_mul_f32 v184, v184, v176
    buffer_load_dwordx4 v246, s[32:35], s99 offen offset:2048  lds
    v_mul_f32 v185, v185, v177
    v_mul_f32 v186, v186, v178
    v_mul_f32 v187, v187, v179
    v_mul_f32 v188, v188, v180
    v_mul_f32 v189, v189, v181
    s_add_u32 m0, s61, 12288
    s_add_u32 s16, s16, s63
    buffer_load_dwordx4 v244, s[32:35], s16 offen offset:0  lds
    v_mul_f32 v190, v190, v182
    v_mul_f32 v191, v191, v183
    v_cvt_pk_bf16_f32 v108, v191, v190
    v_cvt_pk_bf16_f32 v109, v189, v188
    v_cvt_pk_bf16_f32 v110, v187, v186
    buffer_load_dwordx4 v245, s[32:35], s16 offen offset:1024  lds
    v_cvt_pk_bf16_f32 v111, v185, v184
    s_mov_b32 s89, 32768
    buffer_store_dwordx4 v[108:111], v12, s[52:55], s89 offen sc1
    v_and_b32 v160, 0xffff0000, v41
    v_and_b32 v161, 0xffff0000, v43
    v_and_b32 v162, 0xffff0000, v45
    buffer_load_dwordx4 v246, s[32:35], s16 offen offset:2048  lds
    v_and_b32 v163, 0xffff0000, v47
    v_and_b32 v164, 0xffff0000, v49
    v_and_b32 v165, 0xffff0000, v51
    v_and_b32 v166, 0xffff0000, v53
    v_and_b32 v167, 0xffff0000, v55
    s_add_u32 s97, s98, s0
    s_lshr_b64 s[0:1], s[0:1], 4
    s_and_b32 s97, s97, 15
    s_add_u32 m0, s87, 18432
    s_lshl_b32 s97, s97, 7
    buffer_load_dwordx4 v240, s[28:31], s97 offen offset:0  lds
    v_and_b32 v168, 0xffff0000, v57
    v_and_b32 v169, 0xffff0000, v59
    v_and_b32 v170, 0xffff0000, v61
    v_lshlrev_b32 v172, 16, v90
    v_and_b32 v173, 0xffff0000, v90
    buffer_load_dwordx4 v241, s[28:31], s97 offen offset:1024  lds
    v_lshlrev_b32 v174, 16, v91
    v_and_b32 v175, 0xffff0000, v91
    v_and_b32 v176, 0xffff0000, v69
    v_and_b32 v177, 0xffff0000, v71
    v_and_b32 v178, 0xffff0000, v73
    buffer_load_dwordx4 v242, s[28:31], s97 offen offset:2048  lds
    v_and_b32 v179, 0xffff0000, v75
    v_and_b32 v180, 0xffff0000, v77
    v_and_b32 v181, 0xffff0000, v79
    v_and_b32 v182, 0xffff0000, v81
    v_and_b32 v183, 0xffff0000, v83
    buffer_load_dwordx4 v243, s[28:31], s97 offen offset:3072  lds
    v_mul_f32 v184, v160, v175
    v_mul_f32 v185, v161, v175
    v_mul_f32 v186, v162, v175
    v_mul_f32 v187, v163, v175
    v_mul_f32 v188, v164, v175
    s_add_u32 m0, s88, 18432
    s_mov_b64 exec, 0xffffffff
    buffer_load_dwordx4 v3, s[28:31], s97 offen offset:0  lds
    s_mov_b64 exec, -1
    v_mul_f32 v189, v165, v175
    v_mul_f32 v190, v166, v175
    v_mul_f32 v191, v167, v175
    v_fmac_f32 v184, v161, v174
    v_fmac_f32 v185, v162, v174
    v_fmac_f32 v186, v163, v174
    v_fmac_f32 v187, v164, v174
    v_fmac_f32 v188, v165, v174
    v_fmac_f32 v189, v166, v174
    v_fmac_f32 v190, v167, v174
    v_fmac_f32 v191, v168, v174
    v_fmac_f32 v184, v162, v173
    v_fmac_f32 v185, v163, v173
    v_fmac_f32 v186, v164, v173
    v_fmac_f32 v187, v165, v173
    v_fmac_f32 v188, v166, v173
    v_fmac_f32 v189, v167, v173
    v_fmac_f32 v190, v168, v173
    v_fmac_f32 v191, v169, v173
    v_fmac_f32 v184, v163, v172
    v_fmac_f32 v185, v164, v172
    v_fmac_f32 v186, v165, v172
    v_fmac_f32 v187, v166, v172
    v_fmac_f32 v188, v167, v172
    v_fmac_f32 v189, v168, v172
    v_fmac_f32 v190, v169, v172
    v_fmac_f32 v191, v170, v172
    v_mul_f32 v184, v184, v176
    v_mul_f32 v185, v185, v177
    v_mul_f32 v186, v186, v178
    v_mul_f32 v187, v187, v179
    v_mul_f32 v188, v188, v180
    v_mul_f32 v189, v189, v181
    v_mul_f32 v190, v190, v182
    v_mul_f32 v191, v191, v183
    v_cvt_pk_bf16_f32 v112, v191, v190
    v_cvt_pk_bf16_f32 v113, v189, v188
    v_cvt_pk_bf16_f32 v114, v187, v186
    v_cvt_pk_bf16_f32 v115, v185, v184
    s_mov_b32 s89, 49152
    buffer_store_dwordx4 v[112:115], v12, s[52:55], s89 offen sc1
    s_waitcnt vmcnt(13)
    s_barrier
    s_mul_i32 s16, s97, 3072
    s_add_u32 m0, s60, 24576
    s_add_u32 s99, s16, s62
    buffer_load_dwordx4 v244, s[32:35], s99 offen offset:0  lds
    s_mov_b32 s68, s24
    s_mov_b32 s69, s25
    s_mov_b32 s70, 0x100
    s_mov_b32 s71, 0x20000
    buffer_load_dwordx4 v245, s[32:35], s99 offen offset:1024  lds
    v_lshrrev_b32 v6, 5, v0
    v_and_b32 v7, 3, v0
    s_lshr_b32 s78, s90, 1
    s_lshl_b32 s78, s78, 2
    buffer_load_dwordx4 v246, s[32:35], s99 offen offset:2048  lds
    s_load_dword s92, s[14:15], s78
    v_bfe_u32 v5, v0, 2, 2
    v_lshlrev_b32 v5, 1, v5
    s_add_u32 m0, s61, 36864
    s_add_u32 s16, s16, s63
    buffer_load_dwordx4 v244, s[32:35], s16 offen offset:0  lds
    v_lshl_add_u32 v5, v6, 3, v5
    v_bfe_u32 v8, v0, 4, 1
    v_add_u32 v5, v5, v8
    s_and_b32 s78, s3, 1
    buffer_load_dwordx4 v245, s[32:35], s16 offen offset:1024  lds
    s_lshl_b32 s78, s78, 1
    v_add_u32 v8, s78, v6
    v_xor_b32 v8, v8, v7
    v_lshlrev_b32 v8, 4, v8
    buffer_load_dwordx4 v246, s[32:35], s16 offen offset:2048  lds
    v_lshl_add_u32 v5, v5, 6, v8
    v_add_u32 v14, s86, v5
    v_mov_b32 v18, 162304
    s_add_u32 s97, s98, s0
    s_lshr_b64 s[0:1], s[0:1], 4
    s_and_b32 s97, s97, 15
    s_add_u32 m0, s87, 36864
    s_lshl_b32 s97, s97, 7
    buffer_load_dwordx4 v240, s[28:31], s97 offen offset:0  lds
    v_mov_b32 v19, 1
    v_and_b32 v5, 3, v0
    s_lshl_b32 s78, s74, 4
    s_add_u32 s78, s78, s3
    buffer_load_dwordx4 v241, s[28:31], s97 offen offset:1024  lds
    v_lshl_add_u32 v6, v5, 2, s78
    s_lshr_b32 s78, s76, 3
    s_lshl_b32 s79, s3, 1
    s_add_u32 s78, s78, s79
    buffer_load_dwordx4 v242, s[28:31], s97 offen offset:2048  lds
    s_xor_b32 s78, s78, 2
    s_lshl_b32 s78, s78, 5
    s_add_u32 s79, s76, 5
    buffer_load_dwordx4 v243, s[28:31], s97 offen offset:3072  lds
    s_and_b32 s79, s79, 7
    s_lshl_b32 s79, s79, 1
    s_add_u32 s78, s78, s79
    v_mul_u32_u24 v7, 9, v5
    s_add_u32 m0, s88, 36864
    s_mov_b64 exec, 0xffffffff
    buffer_load_dwordx4 v3, s[28:31], s97 offen offset:0  lds
    s_mov_b64 exec, -1
    v_and_b32 v7, 17, v7
    v_add_u32 v7, s78, v7
    v_and_b32 v8, 4, v0
    s_waitcnt vmcnt(12)
    s_waitcnt vmcnt(11)
    s_barrier
    s_mul_i32 s16, s97, 3072
    s_add_u32 m0, s60, 49152
    s_add_u32 s99, s16, s62
    buffer_load_dwordx4 v244, s[32:35], s99 offen offset:0  lds
    v_cmp_eq_u32 vcc, 0, v8
    s_nop 1
    v_cndmask_b32 v6, v7, v6, vcc
    v_and_b32 v33, 0xf0, v6
    v_lshlrev_b32 v34, 8, v6
    buffer_load_dwordx4 v245, s[32:35], s99 offen offset:1024  lds
    v_add_u32 v34, 12582912, v34
    v_and_b32 v5, 15, v0
    v_lshrrev_b32 v6, 4, v0
    v_add_u32 v7, 9, v5
    buffer_load_dwordx4 v246, s[32:35], s99 offen offset:2048  lds
    v_and_b32 v8, 1, v7
    v_mul_u32_u24 v8, 4160, v8
    v_lshrrev_b32 v7, 1, v7
    s_add_u32 m0, s61, 61440
    s_add_u32 s16, s16, s63
    buffer_load_dwordx4 v244, s[32:35], s16 offen offset:0  lds
    v_lshl_add_u32 v8, v7, 2, v8
    v_lshlrev_b32 v7, 4, v6
    v_sub_u32 v8, v8, v7
    s_add_u32 s78, s94, 32
    buffer_load_dwordx4 v245, s[32:35], s16 offen offset:1024  lds
    v_add_u32 v21, s78, v8
    v_add_u32 v22, 1024, v21
    v_add_u32 v23, 2048, v21
    v_add_u32 v24, 3072, v21
    buffer_load_dwordx4 v246, s[32:35], s16 offen offset:2048  lds
    v_lshl_add_u32 v7, v5, 1, v6
    v_add_u32 v7, 30, v7
    v_and_b32 v8, 1, v7
    s_add_u32 s97, s98, s0
    s_lshr_b64 s[0:1], s[0:1], 4
    s_and_b32 s97, s97, 15
    s_add_u32 m0, s87, 0
    s_lshl_b32 s97, s97, 7
    buffer_load_dwordx4 v240, s[28:31], s97 offen offset:0  lds
    v_bfe_u32 v136, v7, 1, 2
    v_lshl_add_u32 v136, v8, 2, v136
    v_lshlrev_b32 v136, 6, v136
    v_lshrrev_b32 v7, 3, v7
    buffer_load_dwordx4 v241, s[28:31], s97 offen offset:1024  lds
    v_lshl_add_u32 v136, v7, 9, v136
    v_bitop3_b32 v8, v7, 3, s3 bitop3:0x6a
    v_lshl_add_u32 v25, v8, 4, v136
    v_add_u32 v25, 92160, v25
    buffer_load_dwordx4 v242, s[28:31], s97 offen offset:2048  lds
    v_subrev_u32 v7, 1, v7
    v_bitop3_b32 v8, v7, 3, s3 bitop3:0x6a
    v_lshl_add_u32 v27, v8, 4, v136
    buffer_load_dwordx4 v243, s[28:31], s97 offen offset:3072  lds
    v_add_u32 v27, 91648, v27
    v_subrev_u32 v7, 1, v7
    v_bitop3_b32 v8, v7, 3, s3 bitop3:0x6a
    v_lshl_add_u32 v29, v8, 4, v136
    s_add_u32 m0, s88, 0
    s_mov_b64 exec, 0xffffffff
    buffer_load_dwordx4 v3, s[28:31], s97 offen offset:0  lds
    s_mov_b64 exec, -1
    v_add_u32 v29, 91136, v29
    v_subrev_u32 v7, 1, v7
    v_bitop3_b32 v8, v7, 3, s3 bitop3:0x6a
    s_waitcnt vmcnt(11)
    s_barrier
    s_mul_i32 s16, s97, 3072
    s_add_u32 m0, s60, 0
    s_add_u32 s99, s16, s62
    buffer_load_dwordx4 v244, s[32:35], s99 offen offset:0  lds
    v_lshl_add_u32 v31, v8, 4, v136
    v_add_u32 v31, 90624, v31
    v_lshl_add_u32 v7, v5, 1, v6
    buffer_load_dwordx4 v245, s[32:35], s99 offen offset:1024  lds
    v_add_u32 v7, 26, v7
    v_and_b32 v8, 1, v7
    v_bfe_u32 v136, v7, 1, 2
    buffer_load_dwordx4 v246, s[32:35], s99 offen offset:2048  lds
    v_lshl_add_u32 v136, v8, 2, v136
    v_lshlrev_b32 v136, 6, v136
    s_add_u32 m0, s61, 12288
    s_add_u32 s16, s16, s63
    buffer_load_dwordx4 v244, s[32:35], s16 offen offset:0  lds
    v_lshrrev_b32 v7, 3, v7
    v_lshl_add_u32 v136, v7, 9, v136
    v_bitop3_b32 v8, v7, 3, s3 bitop3:0x6a
    buffer_load_dwordx4 v245, s[32:35], s16 offen offset:1024  lds
    v_lshl_add_u32 v26, v8, 4, v136
    v_add_u32 v26, 92160, v26
    v_subrev_u32 v7, 1, v7
    buffer_load_dwordx4 v246, s[32:35], s16 offen offset:2048  lds
    v_bitop3_b32 v8, v7, 3, s3 bitop3:0x6a
    v_lshl_add_u32 v28, v8, 4, v136
    s_add_u32 m0, s94, 32
    s_lshl_b32 s89, s90, 12
    buffer_load_dwordx4 v15, s[48:51], s89 offen offset:0 nt lds
    v_add_u32 v28, 91648, v28
    v_subrev_u32 v7, 1, v7
    v_bitop3_b32 v8, v7, 3, s3 bitop3:0x6a
    s_add_u32 m0, s94, 32
    s_lshl_b32 s89, s90, 12
    buffer_load_dwordx4 v15, s[48:51], s89 offen offset:1024 nt lds
    v_lshl_add_u32 v30, v8, 4, v136
    v_add_u32 v30, 91136, v30
    v_subrev_u32 v7, 1, v7
    s_add_u32 m0, s94, 32
    s_lshl_b32 s89, s90, 12
    buffer_load_dwordx4 v15, s[48:51], s89 offen offset:2048 nt lds
    v_bitop3_b32 v8, v7, 3, s3 bitop3:0x6a
    v_lshl_add_u32 v32, v8, 4, v136
    s_add_u32 m0, s94, 32
    s_lshl_b32 s89, s90, 12
    buffer_load_dwordx4 v15, s[48:51], s89 offen offset:3072 nt lds
    v_add_u32 v32, 90624, v32
    v_lshrrev_b32 v7, 1, v6
    v_lshl_add_u32 v7, v5, 1, v7
    s_add_u32 s97, s98, s0
    s_lshr_b64 s[0:1], s[0:1], 4
    s_and_b32 s97, s97, 15
    s_add_u32 m0, s87, 18432
    s_lshl_b32 s97, s97, 7
    buffer_load_dwordx4 v240, s[28:31], s97 offen offset:0  lds
    v_add_u32 v7, 32, v7
    v_and_b32 v8, 1, v7
    v_bfe_u32 v136, v7, 1, 2
    buffer_load_dwordx4 v241, s[28:31], s97 offen offset:1024  lds
    v_lshl_add_u32 v136, v8, 2, v136
    v_lshlrev_b32 v136, 6, v136
    buffer_load_dwordx4 v242, s[28:31], s97 offen offset:2048  lds
    v_lshrrev_b32 v7, 3, v7
    v_lshl_add_u32 v136, v7, 9, v136
    v_bitop3_b32 v8, v7, 3, s3 bitop3:0x6a
    buffer_load_dwordx4 v243, s[28:31], s97 offen offset:3072  lds
    v_lshl_add_u32 v20, v8, 4, v136
    v_add_u32 v20, 92160, v20
    v_and_b32 v8, 1, v6
    s_add_u32 m0, s88, 18432
    s_mov_b64 exec, 0xffffffff
    buffer_load_dwordx4 v3, s[28:31], s97 offen offset:0  lds
    s_mov_b64 exec, -1
    v_xor_b32 v8, 1, v8
    v_lshl_add_u32 v20, v8, 3, v20
    s_waitcnt vmcnt(15)
    s_barrier
    s_mul_i32 s16, s97, 3072
    s_add_u32 m0, s60, 24576
    s_add_u32 s99, s16, s62
    buffer_load_dwordx4 v244, s[32:35], s99 offen offset:0  lds
    s_waitcnt lgkmcnt(0)
    s_and_b32 s78, s92, 0xffff0000
    s_lshl_b32 s92, s92, 16
    buffer_load_dwordx4 v245, s[32:35], s99 offen offset:1024  lds
    s_bitcmp1_b32 s90, 0
    s_cselect_b32 s92, s78, s92
    v_lshlrev_b32 v7, 3, v6
    v_sub_u32 v7, v7, v5
    buffer_load_dwordx4 v246, s[32:35], s99 offen offset:2048  lds
    v_subrev_u32 v7, 9, v7
    v_and_b32 v8, 1, v7
    v_xor_b32 v8, 1, v8
    s_add_u32 m0, s61, 36864
    s_add_u32 s16, s16, s63
    buffer_load_dwordx4 v244, s[32:35], s16 offen offset:0  lds
    v_lshlrev_b32 v8, 4, v8
    v_lshrrev_b32 v8, v8, s92
    v_ashrrev_i32 v7, 1, v7
    buffer_load_dwordx4 v245, s[32:35], s16 offen offset:1024  lds
    v_cmp_eq_u32 vcc, 0, v7
    s_nop 1
    v_cndmask_b32 v236, 0, v8, vcc
    v_cmp_eq_u32 vcc, 1, v7
    buffer_load_dwordx4 v246, s[32:35], s16 offen offset:2048  lds
    s_nop 0
    v_cndmask_b32 v237, 0, v8, vcc
    v_cmp_eq_u32 vcc, 2, v7
    s_nop 1
    v_cndmask_b32 v238, 0, v8, vcc
    s_add_u32 s97, s98, s0
    s_lshr_b64 s[0:1], s[0:1], 4
    s_and_b32 s97, s97, 15
    s_add_u32 m0, s87, 36864
    s_lshl_b32 s97, s97, 7
    buffer_load_dwordx4 v240, s[28:31], s97 offen offset:0  lds
    v_cmp_eq_u32 vcc, 3, v7
    s_nop 1
    v_cndmask_b32 v239, 0, v8, vcc
    s_and_b32 s78, s77, 7
    s_mov_b32 s95, 0x76543210
    s_and_b32 s78, s76, 3
    s_mul_i32 s78, s78, 0x22222222
    s_add_u32 s95, s95, s78
    s_bfe_u32 s17, s95, 0x30000
    s_lshl_b32 s17, s17, 18
    s_bfe_u32 s18, s95, 0x30004
    s_lshl_b32 s18, s18, 18
    s_bfe_u32 s100, s95, 0x3001c
    s_lshl_b32 s100, s100, 18
    s_bfe_u32 s95, s95, 0x30018
    s_lshl_b32 s95, s95, 18
    buffer_load_dwordx4 v241, s[28:31], s97 offen offset:1024  lds
    v_lshrrev_b32 v136, 4, v0
    v_lshlrev_b32 v136, 1, v136
    v_and_b32 v137, 7, v0
    buffer_load_dwordx4 v242, s[28:31], s97 offen offset:2048  lds
    v_xor_b32 v136, v136, v137
    v_lshlrev_b32 v136, 4, v136
    v_lshrrev_b32 v137, 3, v0
    buffer_load_dwordx4 v243, s[28:31], s97 offen offset:3072  lds
    v_lshl_add_u32 v136, v137, 11, v136
    s_lshl_b32 s78, s77, 7
    s_lshl_b32 s79, s3, 14
    s_add_u32 m0, s88, 36864
    s_mov_b64 exec, 0xffffffff
    buffer_load_dwordx4 v3, s[28:31], s97 offen offset:0  lds
    s_mov_b64 exec, -1
    s_add_u32 s78, s78, s79
    v_add_u32 v17, s78, v136
    s_waitcnt vmcnt(11)
    s_barrier
    s_mul_i32 s16, s97, 3072
    s_add_u32 m0, s60, 49152
    s_add_u32 s99, s16, s62
    buffer_load_dwordx4 v244, s[32:35], s99 offen offset:0  lds
    v_add_u32 v5, s94, v15
    ds_read_b128 v[140:143], v5 offset:32
    ds_read_b32 v156, v5 offset:48
    ds_read_b128 v[144:147], v5 offset:1056
    buffer_load_dwordx4 v245, s[32:35], s99 offen offset:1024  lds
    ds_read_b32 v157, v5 offset:1072
    ds_read_b128 v[148:151], v5 offset:2080
    ds_read_b32 v158, v5 offset:2096
    ds_read_b128 v[152:155], v5 offset:3104
    buffer_load_dwordx4 v246, s[32:35], s99 offen offset:2048  lds
    ds_read_b32 v159, v5 offset:3120
    v_lshrrev_b32 v6, 3, v0
    v_mul_u32_u24 v6, 4160, v6
    s_add_u32 m0, s61, 61440
    s_add_u32 s16, s16, s63
    buffer_load_dwordx4 v244, s[32:35], s16 offen offset:0  lds
    v_and_b32 v7, 7, v0
    v_lshl_add_u32 v6, v7, 2, v6
    v_add_u32 v6, s94, v6
    v_mov_b32 v7, 0
    buffer_load_dwordx4 v245, s[32:35], s16 offen offset:1024  lds
    s_waitcnt lgkmcnt(0)
    v_readfirstlane_b32 s93, v140
    s_nop 0
    s_lshl_b32 s93, s93, 16
    s_nop 1
    v_writelane_b32 v7, s93, 15
    buffer_load_dwordx4 v246, s[32:35], s16 offen offset:2048  lds
    v_alignbit_b32 v140, v141, v140, 16
    v_alignbit_b32 v141, v142, v141, 16
    v_alignbit_b32 v142, v143, v142, 16
    s_add_u32 s97, s98, s0
    s_lshr_b64 s[0:1], s[0:1], 4
    s_and_b32 s97, s97, 15
    s_add_u32 m0, s87, 0
    s_lshl_b32 s97, s97, 7
    buffer_load_dwordx4 v240, s[28:31], s97 offen offset:0  lds
    v_alignbit_b32 v143, v156, v143, 16
    v_alignbit_b32 v144, v145, v144, 16
    v_alignbit_b32 v145, v146, v145, 16
    v_alignbit_b32 v146, v147, v146, 16
    buffer_load_dwordx4 v241, s[28:31], s97 offen offset:1024  lds
    v_alignbit_b32 v147, v157, v147, 16
    v_alignbit_b32 v148, v149, v148, 16
    v_alignbit_b32 v149, v150, v149, 16
    v_alignbit_b32 v150, v151, v150, 16
    buffer_load_dwordx4 v242, s[28:31], s97 offen offset:2048  lds
    v_alignbit_b32 v151, v158, v151, 16
    v_alignbit_b32 v152, v153, v152, 16
    v_alignbit_b32 v153, v154, v153, 16
    buffer_load_dwordx4 v243, s[28:31], s97 offen offset:3072  lds
    v_alignbit_b32 v154, v155, v154, 16
    v_alignbit_b32 v155, v159, v155, 16
    v_lshlrev_b32 v8, 3, v0
    s_add_u32 s78, s88, 18432
    s_add_u32 m0, s88, 0
    s_mov_b64 exec, 0xffffffff
    buffer_load_dwordx4 v3, s[28:31], s97 offen offset:0  lds
    s_mov_b64 exec, -1
    v_add_u32 v8, s78, v8
    v_mov_b32 v156, 0
    v_mov_b32 v157, 0
    s_waitcnt vmcnt(11)
    s_barrier
    s_mul_i32 s16, s97, 3072
    s_add_u32 m0, s60, 0
    s_add_u32 s99, s16, s62
    buffer_load_dwordx4 v244, s[32:35], s99 offen offset:0  lds
    buffer_load_dwordx4 v245, s[32:35], s99 offen offset:1024  lds
    buffer_load_dwordx4 v246, s[32:35], s99 offen offset:2048  lds
    s_add_u32 m0, s61, 12288
    s_add_u32 s16, s16, s63
    buffer_load_dwordx4 v244, s[32:35], s16 offen offset:0  lds
    buffer_load_dwordx4 v245, s[32:35], s16 offen offset:1024  lds
    buffer_load_dwordx4 v246, s[32:35], s16 offen offset:2048  lds
    s_mov_b64 exec, 0xff
    buffer_load_dword v136, v33, s[68:71], 0 offen sc1
    buffer_load_dword v137, v34, s[52:55], 0 offen sc1
    s_mov_b64 exec, -1
    buffer_load_dwordx4 v[212:215], v9, s[56:59], 0 offen offset:0 nt
    buffer_load_dwordx4 v[216:219], v9, s[56:59], 0 offen offset:2048 nt
    buffer_load_dwordx4 v[220:223], v9, s[56:59], s96 offen offset:0 nt
    buffer_load_dwordx4 v[224:227], v9, s[56:59], s96 offen offset:2048 nt
    s_waitcnt vmcnt(12)
    s_waitcnt vmcnt(6)
    s_barrier
    s_waitcnt vmcnt(4)
    s_branch LA_j
LA_c3:
    s_waitcnt vmcnt(8)
    s_barrier
    buffer_load_dwordx4 v242, s[28:31], s97 offen offset:2048  lds
    buffer_load_dwordx4 v243, s[28:31], s97 offen offset:3072  lds
    s_add_u32 m0, s88, 36864
    s_mov_b64 exec, 0xffffffff
    buffer_load_dwordx4 v3, s[28:31], s97 offen offset:0  lds
    s_mov_b64 exec, -1
    s_mul_i32 s16, s97, 3072
    s_add_u32 m0, s60, 49152
    s_add_u32 s99, s16, s62
    buffer_load_dwordx4 v244, s[32:35], s99 offen offset:0  lds
    buffer_load_dwordx4 v245, s[32:35], s99 offen offset:1024  lds
    buffer_load_dwordx4 v246, s[32:35], s99 offen offset:2048  lds
    s_add_u32 m0, s61, 61440
    s_add_u32 s16, s16, s63
    buffer_load_dwordx4 v244, s[32:35], s16 offen offset:0  lds
    buffer_load_dwordx4 v245, s[32:35], s16 offen offset:1024  lds
    buffer_load_dwordx4 v246, s[32:35], s16 offen offset:2048  lds
    s_add_u32 s97, s98, s0
    s_lshr_b64 s[0:1], s[0:1], 4
    s_and_b32 s97, s97, 15
    s_add_u32 m0, s87, 0
    s_lshl_b32 s97, s97, 7
    buffer_load_dwordx4 v240, s[28:31], s97 offen offset:0  lds
    buffer_load_dwordx4 v241, s[28:31], s97 offen offset:1024  lds
    buffer_load_dwordx4 v242, s[28:31], s97 offen offset:2048  lds
    buffer_load_dwordx4 v243, s[28:31], s97 offen offset:3072  lds
    s_add_u32 m0, s88, 0
    s_mov_b64 exec, 0xffffffff
    buffer_load_dwordx4 v3, s[28:31], s97 offen offset:0  lds
    s_mov_b64 exec, -1
    s_waitcnt vmcnt(11)
    s_barrier
    s_mul_i32 s16, s97, 3072
    s_add_u32 m0, s60, 0
    s_add_u32 s99, s16, s62
    buffer_load_dwordx4 v244, s[32:35], s99 offen offset:0  lds
    buffer_load_dwordx4 v245, s[32:35], s99 offen offset:1024  lds
    buffer_load_dwordx4 v246, s[32:35], s99 offen offset:2048  lds
    s_add_u32 m0, s61, 12288
    s_add_u32 s16, s16, s63
    buffer_load_dwordx4 v244, s[32:35], s16 offen offset:0  lds
    buffer_load_dwordx4 v245, s[32:35], s16 offen offset:1024  lds
    buffer_load_dwordx4 v246, s[32:35], s16 offen offset:2048  lds
    s_add_u32 s97, s98, s0
    s_lshr_b64 s[0:1], s[0:1], 4
    s_and_b32 s97, s97, 15
    s_add_u32 m0, s87, 18432
    s_lshl_b32 s97, s97, 7
    buffer_load_dwordx4 v240, s[28:31], s97 offen offset:0  lds
    buffer_load_dwordx4 v241, s[28:31], s97 offen offset:1024  lds
    buffer_load_dwordx4 v242, s[28:31], s97 offen offset:2048  lds
    buffer_load_dwordx4 v243, s[28:31], s97 offen offset:3072  lds
    s_add_u32 m0, s88, 18432
    s_mov_b64 exec, 0xffffffff
    buffer_load_dwordx4 v3, s[28:31], s97 offen offset:0  lds
    s_mov_b64 exec, -1
    s_waitcnt vmcnt(11)
    s_barrier
    s_mul_i32 s16, s97, 3072
    s_add_u32 m0, s60, 24576
    s_add_u32 s99, s16, s62
    buffer_load_dwordx4 v244, s[32:35], s99 offen offset:0  lds
    buffer_load_dwordx4 v245, s[32:35], s99 offen offset:1024  lds
    buffer_load_dwordx4 v246, s[32:35], s99 offen offset:2048  lds
    s_add_u32 m0, s61, 36864
    s_add_u32 s16, s16, s63
    buffer_load_dwordx4 v244, s[32:35], s16 offen offset:0  lds
    buffer_load_dwordx4 v245, s[32:35], s16 offen offset:1024  lds
    buffer_load_dwordx4 v246, s[32:35], s16 offen offset:2048  lds
    s_add_u32 m0, s86, 129536
    s_mov_b32 s89, 0
    buffer_load_dwordx4 v10, s[36:39], s89 offen nt lds
    s_add_u32 m0, s86, 145920
    s_mov_b32 s89, 0
    buffer_load_dwordx4 v10, s[40:43], s89 offen nt lds
    s_add_u32 m0, s86, 133632
    s_mov_b32 s89, 65536
    buffer_load_dwordx4 v10, s[36:39], s89 offen nt lds
    s_add_u32 m0, s86, 150016
    s_mov_b32 s89, 65536
    buffer_load_dwordx4 v10, s[40:43], s89 offen nt lds
    s_add_u32 m0, s86, 137728
    s_mov_b32 s89, 131072
    buffer_load_dwordx4 v10, s[36:39], s89 offen nt lds
    s_add_u32 m0, s86, 154112
    s_mov_b32 s89, 131072
    buffer_load_dwordx4 v10, s[40:43], s89 offen nt lds
    s_add_u32 m0, s86, 141824
    s_mov_b32 s89, 196608
    buffer_load_dwordx4 v10, s[36:39], s89 offen nt lds
    s_add_u32 m0, s86, 158208
    s_mov_b32 s89, 196608
    buffer_load_dwordx4 v10, s[40:43], s89 offen nt lds
    s_mov_b64 exec, 0xff
    s_lshl_b32 s82, s3, 7
    s_add_u32 m0, s82, 129024
    s_mov_b32 s89, 0
    buffer_load_dwordx4 v11, s[36:39], s89 offen nt lds
    s_lshl_b32 s83, s74, 9
    s_add_u32 s83, s83, s82
    s_and_b32 s89, s3, 2
    s_lshl_b32 s89, s89, 3
    s_add_u32 s82, s82, s89
    s_add_u32 m0, s82, 162816
    s_add_u32 s89, s83, 0
    buffer_load_dwordx4 v15, s[44:47], s89 offen  lds
    s_mov_b64 exec, -1
    s_add_u32 s97, s98, s0
    s_lshr_b64 s[0:1], s[0:1], 4
    s_and_b32 s97, s97, 15
    s_add_u32 m0, s87, 36864
    s_lshl_b32 s97, s97, 7
    buffer_load_dwordx4 v240, s[28:31], s97 offen offset:0  lds
    buffer_load_dwordx4 v241, s[28:31], s97 offen offset:1024  lds
    buffer_load_dwordx4 v242, s[28:31], s97 offen offset:2048  lds
    buffer_load_dwordx4 v243, s[28:31], s97 offen offset:3072  lds
    s_add_u32 m0, s88, 36864
    s_mov_b64 exec, 0xffffffff
    buffer_load_dwordx4 v3, s[28:31], s97 offen offset:0  lds
    s_mov_b64 exec, -1
    s_waitcnt vmcnt(21)
    s_barrier
    s_mul_i32 s16, s97, 3072
    s_add_u32 m0, s60, 49152
    s_add_u32 s99, s16, s62
    buffer_load_dwordx4 v244, s[32:35], s99 offen offset:0  lds
    buffer_load_dwordx4 v245, s[32:35], s99 offen offset:1024  lds
    buffer_load_dwordx4 v246, s[32:35], s99 offen offset:2048  lds
    s_add_u32 m0, s61, 61440
    s_add_u32 s16, s16, s63
    buffer_load_dwordx4 v244, s[32:35], s16 offen offset:0  lds
    buffer_load_dwordx4 v245, s[32:35], s16 offen offset:1024  lds
    buffer_load_dwordx4 v246, s[32:35], s16 offen offset:2048  lds
    s_add_u32 s97, s98, s0
    s_lshr_b64 s[0:1], s[0:1], 4
    s_and_b32 s97, s97, 15
    s_add_u32 m0, s87, 0
    s_lshl_b32 s97, s97, 7
    buffer_load_dwordx4 v240, s[28:31], s97 offen offset:0  lds
    buffer_load_dwordx4 v241, s[28:31], s97 offen offset:1024  lds
    buffer_load_dwordx4 v242, s[28:31], s97 offen offset:2048  lds
    buffer_load_dwordx4 v243, s[28:31], s97 offen offset:3072  lds
    s_add_u32 m0, s88, 0
    s_mov_b64 exec, 0xffffffff
    buffer_load_dwordx4 v3, s[28:31], s97 offen offset:0  lds
    s_mov_b64 exec, -1
    s_waitcnt vmcnt(11)
    s_barrier
    s_mul_i32 s16, s97, 3072
    s_add_u32 m0, s60, 0
    s_add_u32 s99, s16, s62
    buffer_load_dwordx4 v244, s[32:35], s99 offen offset:0  lds
    ds_read_b128 v[84:87], v35 offset:0
    ds_read_b128 v[88:91], v35 offset:16
    buffer_load_dwordx4 v245, s[32:35], s99 offen offset:1024  lds
    ds_read_b64 v[40:41], v16 offset:0
    ds_read_b64 v[42:43], v231 offset:256
    buffer_load_dwordx4 v246, s[32:35], s99 offen offset:2048  lds
    ds_read_b64 v[44:45], v16 offset:256
    ds_read_b64 v[46:47], v16 offset:512
    s_add_u32 m0, s61, 12288
    s_add_u32 s16, s16, s63
    buffer_load_dwordx4 v244, s[32:35], s16 offen offset:0  lds
    ds_read_b64 v[48:49], v231 offset:512
    ds_read_b64 v[50:51], v16 offset:768
    buffer_load_dwordx4 v245, s[32:35], s16 offen offset:1024  lds
    ds_read_b64 v[52:53], v231 offset:768
    ds_read_b64 v[54:55], v16 offset:1024
    buffer_load_dwordx4 v246, s[32:35], s16 offen offset:2048  lds
    ds_read_b64 v[56:57], v231 offset:1024
    ds_read_b64 v[58:59], v16 offset:1280
    s_add_u32 s97, s98, s0
    s_lshr_b64 s[0:1], s[0:1], 4
    s_and_b32 s97, s97, 15
    s_add_u32 m0, s87, 18432
    s_lshl_b32 s97, s97, 7
    buffer_load_dwordx4 v240, s[28:31], s97 offen offset:0  lds
    ds_read_b64 v[60:61], v231 offset:1280
    ds_read_b64 v[68:69], v16 offset:16896
    buffer_load_dwordx4 v241, s[28:31], s97 offen offset:1024  lds
    ds_read_b64 v[70:71], v231 offset:16896
    ds_read_b64 v[72:73], v16 offset:17152
    buffer_load_dwordx4 v242, s[28:31], s97 offen offset:2048  lds
    ds_read_b64 v[74:75], v231 offset:17152
    ds_read_b64 v[76:77], v16 offset:17408
    buffer_load_dwordx4 v243, s[28:31], s97 offen offset:3072  lds
    ds_read_b64 v[78:79], v231 offset:17408
    ds_read_b64 v[80:81], v16 offset:17664
    s_add_u32 m0, s88, 18432
    s_mov_b64 exec, 0xffffffff
    buffer_load_dwordx4 v3, s[28:31], s97 offen offset:0  lds
    s_mov_b64 exec, -1
    ds_read_b64 v[82:83], v231 offset:17664
    s_waitcnt vmcnt(11)
    s_waitcnt lgkmcnt(0)
    s_barrier
    s_mul_i32 s16, s97, 3072
    s_add_u32 m0, s60, 24576
    s_add_u32 s99, s16, s62
    buffer_load_dwordx4 v244, s[32:35], s99 offen offset:0  lds
    v_lshlrev_b32 v160, 16, v40
    v_lshlrev_b32 v161, 16, v42
    v_lshlrev_b32 v162, 16, v44
    v_lshlrev_b32 v163, 16, v46
    v_lshlrev_b32 v164, 16, v48
    buffer_load_dwordx4 v245, s[32:35], s99 offen offset:1024  lds
    v_lshlrev_b32 v165, 16, v50
    v_lshlrev_b32 v166, 16, v52
    v_lshlrev_b32 v167, 16, v54
    v_lshlrev_b32 v168, 16, v56
    v_lshlrev_b32 v169, 16, v58
    buffer_load_dwordx4 v246, s[32:35], s99 offen offset:2048  lds
    v_lshlrev_b32 v170, 16, v60
    v_lshlrev_b32 v172, 16, v84
    v_and_b32 v173, 0xffff0000, v84
    v_lshlrev_b32 v174, 16, v85
    v_and_b32 v175, 0xffff0000, v85
    s_add_u32 m0, s61, 36864
    s_add_u32 s16, s16, s63
    buffer_load_dwordx4 v244, s[32:35], s16 offen offset:0  lds
    v_lshlrev_b32 v176, 16, v68
    v_lshlrev_b32 v177, 16, v70
    v_lshlrev_b32 v178, 16, v72
    v_lshlrev_b32 v179, 16, v74
    v_lshlrev_b32 v180, 16, v76
    buffer_load_dwordx4 v245, s[32:35], s16 offen offset:1024  lds
    v_lshlrev_b32 v181, 16, v78
    v_lshlrev_b32 v182, 16, v80
    v_lshlrev_b32 v183, 16, v82
    v_mul_f32 v184, v160, v175
    v_mul_f32 v185, v161, v175
    buffer_load_dwordx4 v246, s[32:35], s16 offen offset:2048  lds
    v_mul_f32 v186, v162, v175
    v_mul_f32 v187, v163, v175
    v_mul_f32 v188, v164, v175
    v_mul_f32 v189, v165, v175
    v_mul_f32 v190, v166, v175
    s_add_u32 s97, s98, s0
    s_lshr_b64 s[0:1], s[0:1], 4
    s_and_b32 s97, s97, 15
    s_add_u32 m0, s87, 36864
    s_lshl_b32 s97, s97, 7
    buffer_load_dwordx4 v240, s[28:31], s97 offen offset:0  lds
    v_mul_f32 v191, v167, v175
    v_fmac_f32 v184, v161, v174
    v_fmac_f32 v185, v162, v174
    v_fmac_f32 v186, v163, v174
    v_fmac_f32 v187, v164, v174
    buffer_load_dwordx4 v241, s[28:31], s97 offen offset:1024  lds
    v_fmac_f32 v188, v165, v174
    v_fmac_f32 v189, v166, v174
    v_fmac_f32 v190, v167, v174
    v_fmac_f32 v191, v168, v174
    v_fmac_f32 v184, v162, v173
    buffer_load_dwordx4 v242, s[28:31], s97 offen offset:2048  lds
    v_fmac_f32 v185, v163, v173
    v_fmac_f32 v186, v164, v173
    v_fmac_f32 v187, v165, v173
    v_fmac_f32 v188, v166, v173
    v_fmac_f32 v189, v167, v173
    buffer_load_dwordx4 v243, s[28:31], s97 offen offset:3072  lds
    v_fmac_f32 v190, v168, v173
    v_fmac_f32 v191, v169, v173
    v_fmac_f32 v184, v163, v172
    v_fmac_f32 v185, v164, v172
    v_fmac_f32 v186, v165, v172
    s_add_u32 m0, s88, 36864
    s_mov_b64 exec, 0xffffffff
    buffer_load_dwordx4 v3, s[28:31], s97 offen offset:0  lds
    s_mov_b64 exec, -1
    v_fmac_f32 v187, v166, v172
    v_fmac_f32 v188, v167, v172
    v_fmac_f32 v189, v168, v172
    v_fmac_f32 v190, v169, v172
    v_fmac_f32 v191, v170, v172
    v_mul_f32 v184, v184, v176
    v_mul_f32 v185, v185, v177
    v_mul_f32 v186, v186, v178
    v_mul_f32 v187, v187, v179
    v_mul_f32 v188, v188, v180
    v_mul_f32 v189, v189, v181
    v_mul_f32 v190, v190, v182
    v_mul_f32 v191, v191, v183
    v_cvt_pk_bf16_f32 v100, v191, v190
    v_cvt_pk_bf16_f32 v101, v189, v188
    v_cvt_pk_bf16_f32 v102, v187, v186
    v_cvt_pk_bf16_f32 v103, v185, v184
    s_mov_b32 s89, 0
    buffer_store_dwordx4 v[100:103], v12, s[52:55], s89 offen sc1
    v_and_b32 v160, 0xffff0000, v40
    v_and_b32 v161, 0xffff0000, v42
    v_and_b32 v162, 0xffff0000, v44
    v_and_b32 v163, 0xffff0000, v46
    v_and_b32 v164, 0xffff0000, v48
    v_and_b32 v165, 0xffff0000, v50
    v_and_b32 v166, 0xffff0000, v52
    v_and_b32 v167, 0xffff0000, v54
    v_and_b32 v168, 0xffff0000, v56
    v_and_b32 v169, 0xffff0000, v58
    v_and_b32 v170, 0xffff0000, v60
    v_lshlrev_b32 v172, 16, v86
    v_and_b32 v173, 0xffff0000, v86
    v_lshlrev_b32 v174, 16, v87
    v_and_b32 v175, 0xffff0000, v87
    v_and_b32 v176, 0xffff0000, v68
    v_and_b32 v177, 0xffff0000, v70
    v_and_b32 v178, 0xffff0000, v72
    v_and_b32 v179, 0xffff0000, v74
    v_and_b32 v180, 0xffff0000, v76
    v_and_b32 v181, 0xffff0000, v78
    v_and_b32 v182, 0xffff0000, v80
    v_and_b32 v183, 0xffff0000, v82
    s_waitcnt vmcnt(12)
    s_barrier
    s_mul_i32 s16, s97, 3072
    s_add_u32 m0, s60, 49152
    s_add_u32 s99, s16, s62
    buffer_load_dwordx4 v244, s[32:35], s99 offen offset:0  lds
    v_mul_f32 v184, v160, v175
    v_mul_f32 v185, v161, v175
    v_mul_f32 v186, v162, v175
    v_mul_f32 v187, v163, v175
    v_mul_f32 v188, v164, v175
    buffer_load_dwordx4 v245, s[32:35], s99 offen offset:1024  lds
    v_mul_f32 v189, v165, v175
    v_mul_f32 v190, v166, v175
    v_mul_f32 v191, v167, v175
    v_fmac_f32 v184, v161, v174
    v_fmac_f32 v185, v162, v174
    buffer_load_dwordx4 v246, s[32:35], s99 offen offset:2048  lds
    v_fmac_f32 v186, v163, v174
    v_fmac_f32 v187, v164, v174
    v_fmac_f32 v188, v165, v174
    v_fmac_f32 v189, v166, v174
    v_fmac_f32 v190, v167, v174
    s_add_u32 m0, s61, 61440
    s_add_u32 s16, s16, s63
    buffer_load_dwordx4 v244, s[32:35], s16 offen offset:0  lds
    v_fmac_f32 v191, v168, v174
    v_fmac_f32 v184, v162, v173
    v_fmac_f32 v185, v163, v173
    v_fmac_f32 v186, v164, v173
    v_fmac_f32 v187, v165, v173
    buffer_load_dwordx4 v245, s[32:35], s16 offen offset:1024  lds
    v_fmac_f32 v188, v166, v173
    v_fmac_f32 v189, v167, v173
    v_fmac_f32 v190, v168, v173
    v_fmac_f32 v191, v169, v173
    v_fmac_f32 v184, v163, v172
    buffer_load_dwordx4 v246, s[32:35], s16 offen offset:2048  lds
    v_fmac_f32 v185, v164, v172
    v_fmac_f32 v186, v165, v172
    v_fmac_f32 v187, v166, v172
    v_fmac_f32 v188, v167, v172
    v_fmac_f32 v189, v168, v172
    s_add_u32 s97, s98, s0
    s_lshr_b64 s[0:1], s[0:1], 4
    s_and_b32 s97, s97, 15
    s_add_u32 m0, s87, 0
    s_lshl_b32 s97, s97, 7
    buffer_load_dwordx4 v240, s[28:31], s97 offen offset:0  lds
    v_fmac_f32 v190, v169, v172
    v_fmac_f32 v191, v170, v172
    v_mul_f32 v184, v184, v176
    v_mul_f32 v185, v185, v177
    v_mul_f32 v186, v186, v178
    buffer_load_dwordx4 v241, s[28:31], s97 offen offset:1024  lds
    v_mul_f32 v187, v187, v179
    v_mul_f32 v188, v188, v180
    v_mul_f32 v189, v189, v181
    v_mul_f32 v190, v190, v182
    v_mul_f32 v191, v191, v183
    buffer_load_dwordx4 v242, s[28:31], s97 offen offset:2048  lds
    v_cvt_pk_bf16_f32 v104, v191, v190
    v_cvt_pk_bf16_f32 v105, v189, v188
    v_cvt_pk_bf16_f32 v106, v187, v186
    v_cvt_pk_bf16_f32 v107, v185, v184
    s_mov_b32 s89, 16384
    buffer_store_dwordx4 v[104:107], v12, s[52:55], s89 offen sc1
    buffer_load_dwordx4 v243, s[28:31], s97 offen offset:3072  lds
    v_lshlrev_b32 v160, 16, v41
    v_lshlrev_b32 v161, 16, v43
    v_lshlrev_b32 v162, 16, v45
    v_lshlrev_b32 v163, 16, v47
    v_lshlrev_b32 v164, 16, v49
    s_add_u32 m0, s88, 0
    s_mov_b64 exec, 0xffffffff
    buffer_load_dwordx4 v3, s[28:31], s97 offen offset:0  lds
    s_mov_b64 exec, -1
    v_lshlrev_b32 v165, 16, v51
    v_lshlrev_b32 v166, 16, v53
    v_lshlrev_b32 v167, 16, v55
    v_lshlrev_b32 v168, 16, v57
    v_lshlrev_b32 v169, 16, v59
    v_lshlrev_b32 v170, 16, v61
    v_lshlrev_b32 v172, 16, v88
    v_and_b32 v173, 0xffff0000, v88
    v_lshlrev_b32 v174, 16, v89
    v_and_b32 v175, 0xffff0000, v89
    v_lshlrev_b32 v176, 16, v69
    v_lshlrev_b32 v177, 16, v71
    v_lshlrev_b32 v178, 16, v73
    v_lshlrev_b32 v179, 16, v75
    v_lshlrev_b32 v180, 16, v77
    v_lshlrev_b32 v181, 16, v79
    v_lshlrev_b32 v182, 16, v81
    v_lshlrev_b32 v183, 16, v83
    v_mul_f32 v184, v160, v175
    v_mul_f32 v185, v161, v175
    v_mul_f32 v186, v162, v175
    v_mul_f32 v187, v163, v175
    v_mul_f32 v188, v164, v175
    v_mul_f32 v189, v165, v175
    v_mul_f32 v190, v166, v175
    v_mul_f32 v191, v167, v175
    v_fmac_f32 v184, v161, v174
    v_fmac_f32 v185, v162, v174
    v_fmac_f32 v186, v163, v174
    v_fmac_f32 v187, v164, v174
    v_fmac_f32 v188, v165, v174
    v_fmac_f32 v189, v166, v174
    v_fmac_f32 v190, v167, v174
    v_fmac_f32 v191, v168, v174
    v_fmac_f32 v184, v162, v173
    v_fmac_f32 v185, v163, v173
    v_fmac_f32 v186, v164, v173
    v_fmac_f32 v187, v165, v173
    v_fmac_f32 v188, v166, v173
    v_fmac_f32 v189, v167, v173
    v_fmac_f32 v190, v168, v173
    s_waitcnt vmcnt(13)
    s_barrier
    s_mul_i32 s16, s97, 3072
    s_add_u32 m0, s60, 0
    s_add_u32 s99, s16, s62
    buffer_load_dwordx4 v244, s[32:35], s99 offen offset:0  lds
    v_fmac_f32 v191, v169, v173
    v_fmac_f32 v184, v163, v172
    v_fmac_f32 v185, v164, v172
    v_fmac_f32 v186, v165, v172
    v_fmac_f32 v187, v166, v172
    buffer_load_dwordx4 v245, s[32:35], s99 offen offset:1024  lds
    v_fmac_f32 v188, v167, v172
    v_fmac_f32 v189, v168, v172
    v_fmac_f32 v190, v169, v172
    v_fmac_f32 v191, v170, v172
    v_mul_f32 v184, v184, v176
    buffer_load_dwordx4 v246, s[32:35], s99 offen offset:2048  lds
    v_mul_f32 v185, v185, v177
    v_mul_f32 v186, v186, v178
    v_mul_f32 v187, v187, v179
    v_mul_f32 v188, v188, v180
    v_mul_f32 v189, v189, v181
    s_add_u32 m0, s61, 12288
    s_add_u32 s16, s16, s63
    buffer_load_dwordx4 v244, s[32:35], s16 offen offset:0  lds
    v_mul_f32 v190, v190, v182
    v_mul_f32 v191, v191, v183
    v_cvt_pk_bf16_f32 v108, v191, v190
    v_cvt_pk_bf16_f32 v109, v189, v188
    v_cvt_pk_bf16_f32 v110, v187, v186
    buffer_load_dwordx4 v245, s[32:35], s16 offen offset:1024  lds
    v_cvt_pk_bf16_f32 v111, v185, v184
    s_mov_b32 s89, 32768
    buffer_store_dwordx4 v[108:111], v12, s[52:55], s89 offen sc1
    v_and_b32 v160, 0xffff0000, v41
    v_and_b32 v161, 0xffff0000, v43
    v_and_b32 v162, 0xffff0000, v45
    buffer_load_dwordx4 v246, s[32:35], s16 offen offset:2048  lds
    v_and_b32 v163, 0xffff0000, v47
    v_and_b32 v164, 0xffff0000, v49
    v_and_b32 v165, 0xffff0000, v51
    v_and_b32 v166, 0xffff0000, v53
    v_and_b32 v167, 0xffff0000, v55
    s_add_u32 s97, s98, s0
    s_lshr_b64 s[0:1], s[0:1], 4
    s_and_b32 s97, s97, 15
    s_add_u32 m0, s87, 18432
    s_lshl_b32 s97, s97, 7
    buffer_load_dwordx4 v240, s[28:31], s97 offen offset:0  lds
    v_and_b32 v168, 0xffff0000, v57
    v_and_b32 v169, 0xffff0000, v59
    v_and_b32 v170, 0xffff0000, v61
    v_lshlrev_b32 v172, 16, v90
    v_and_b32 v173, 0xffff0000, v90
    buffer_load_dwordx4 v241, s[28:31], s97 offen offset:1024  lds
    v_lshlrev_b32 v174, 16, v91
    v_and_b32 v175, 0xffff0000, v91
    v_and_b32 v176, 0xffff0000, v69
    v_and_b32 v177, 0xffff0000, v71
    v_and_b32 v178, 0xffff0000, v73
    buffer_load_dwordx4 v242, s[28:31], s97 offen offset:2048  lds
    v_and_b32 v179, 0xffff0000, v75
    v_and_b32 v180, 0xffff0000, v77
    v_and_b32 v181, 0xffff0000, v79
    v_and_b32 v182, 0xffff0000, v81
    v_and_b32 v183, 0xffff0000, v83
    buffer_load_dwordx4 v243, s[28:31], s97 offen offset:3072  lds
    v_mul_f32 v184, v160, v175
    v_mul_f32 v185, v161, v175
    v_mul_f32 v186, v162, v175
    v_mul_f32 v187, v163, v175
    v_mul_f32 v188, v164, v175
    s_add_u32 m0, s88, 18432
    s_mov_b64 exec, 0xffffffff
    buffer_load_dwordx4 v3, s[28:31], s97 offen offset:0  lds
    s_mov_b64 exec, -1
    v_mul_f32 v189, v165, v175
    v_mul_f32 v190, v166, v175
    v_mul_f32 v191, v167, v175
    v_fmac_f32 v184, v161, v174
    v_fmac_f32 v185, v162, v174
    v_fmac_f32 v186, v163, v174
    v_fmac_f32 v187, v164, v174
    v_fmac_f32 v188, v165, v174
    v_fmac_f32 v189, v166, v174
    v_fmac_f32 v190, v167, v174
    v_fmac_f32 v191, v168, v174
    v_fmac_f32 v184, v162, v173
    v_fmac_f32 v185, v163, v173
    v_fmac_f32 v186, v164, v173
    v_fmac_f32 v187, v165, v173
    v_fmac_f32 v188, v166, v173
    v_fmac_f32 v189, v167, v173
    v_fmac_f32 v190, v168, v173
    v_fmac_f32 v191, v169, v173
    v_fmac_f32 v184, v163, v172
    v_fmac_f32 v185, v164, v172
    v_fmac_f32 v186, v165, v172
    v_fmac_f32 v187, v166, v172
    v_fmac_f32 v188, v167, v172
    v_fmac_f32 v189, v168, v172
    v_fmac_f32 v190, v169, v172
    v_fmac_f32 v191, v170, v172
    v_mul_f32 v184, v184, v176
    v_mul_f32 v185, v185, v177
    v_mul_f32 v186, v186, v178
    v_mul_f32 v187, v187, v179
    v_mul_f32 v188, v188, v180
    v_mul_f32 v189, v189, v181
    v_mul_f32 v190, v190, v182
    v_mul_f32 v191, v191, v183
    v_cvt_pk_bf16_f32 v112, v191, v190
    v_cvt_pk_bf16_f32 v113, v189, v188
    v_cvt_pk_bf16_f32 v114, v187, v186
    v_cvt_pk_bf16_f32 v115, v185, v184
    s_mov_b32 s89, 49152
    buffer_store_dwordx4 v[112:115], v12, s[52:55], s89 offen sc1
    s_waitcnt vmcnt(13)
    s_barrier
    s_mul_i32 s16, s97, 3072
    s_add_u32 m0, s60, 24576
    s_add_u32 s99, s16, s62
    buffer_load_dwordx4 v244, s[32:35], s99 offen offset:0  lds
    s_mov_b32 s68, s24
    s_mov_b32 s69, s25
    s_mov_b32 s70, 0x100
    s_mov_b32 s71, 0x20000
    buffer_load_dwordx4 v245, s[32:35], s99 offen offset:1024  lds
    v_lshrrev_b32 v6, 5, v0
    v_and_b32 v7, 3, v0
    s_lshr_b32 s78, s90, 1
    s_lshl_b32 s78, s78, 2
    buffer_load_dwordx4 v246, s[32:35], s99 offen offset:2048  lds
    s_load_dword s92, s[14:15], s78
    v_bfe_u32 v5, v0, 2, 2
    v_lshlrev_b32 v5, 1, v5
    s_add_u32 m0, s61, 36864
    s_add_u32 s16, s16, s63
    buffer_load_dwordx4 v244, s[32:35], s16 offen offset:0  lds
    v_lshl_add_u32 v5, v6, 3, v5
    v_bfe_u32 v8, v0, 4, 1
    v_add_u32 v5, v5, v8
    s_and_b32 s78, s3, 1
    buffer_load_dwordx4 v245, s[32:35], s16 offen offset:1024  lds
    s_lshl_b32 s78, s78, 1
    v_add_u32 v8, s78, v6
    v_xor_b32 v8, v8, v7
    v_lshlrev_b32 v8, 4, v8
    buffer_load_dwordx4 v246, s[32:35], s16 offen offset:2048  lds
    v_lshl_add_u32 v5, v5, 6, v8
    v_add_u32 v14, s86, v5
    v_mov_b32 v18, 162304
    s_add_u32 s97, s98, s0
    s_lshr_b64 s[0:1], s[0:1], 4
    s_and_b32 s97, s97, 15
    s_add_u32 m0, s87, 36864
    s_lshl_b32 s97, s97, 7
    buffer_load_dwordx4 v240, s[28:31], s97 offen offset:0  lds
    v_mov_b32 v19, 1
    v_and_b32 v5, 3, v0
    s_lshl_b32 s78, s74, 4
    s_add_u32 s78, s78, s3
    buffer_load_dwordx4 v241, s[28:31], s97 offen offset:1024  lds
    v_lshl_add_u32 v6, v5, 2, s78
    s_lshr_b32 s78, s76, 3
    s_lshl_b32 s79, s3, 1
    s_add_u32 s78, s78, s79
    buffer_load_dwordx4 v242, s[28:31], s97 offen offset:2048  lds
    s_xor_b32 s78, s78, 2
    s_lshl_b32 s78, s78, 5
    s_add_u32 s79, s76, 5
    buffer_load_dwordx4 v243, s[28:31], s97 offen offset:3072  lds
    s_and_b32 s79, s79, 7
    s_lshl_b32 s79, s79, 1
    s_add_u32 s78, s78, s79
    v_mul_u32_u24 v7, 9, v5
    s_add_u32 m0, s88, 36864
    s_mov_b64 exec, 0xffffffff
    buffer_load_dwordx4 v3, s[28:31], s97 offen offset:0  lds
    s_mov_b64 exec, -1
    v_and_b32 v7, 17, v7
    v_add_u32 v7, s78, v7
    v_and_b32 v8, 4, v0
    s_waitcnt vmcnt(12)
    s_waitcnt vmcnt(11)
    s_barrier
    s_mul_i32 s16, s97, 3072
    s_add_u32 m0, s60, 49152
    s_add_u32 s99, s16, s62
    buffer_load_dwordx4 v244, s[32:35], s99 offen offset:0  lds
    v_cmp_eq_u32 vcc, 0, v8
    s_nop 1
    v_cndmask_b32 v6, v7, v6, vcc
    v_and_b32 v33, 0xf0, v6
    v_lshlrev_b32 v34, 8, v6
    buffer_load_dwordx4 v245, s[32:35], s99 offen offset:1024  lds
    v_add_u32 v34, 12582912, v34
    v_and_b32 v5, 15, v0
    v_lshrrev_b32 v6, 4, v0
    v_add_u32 v7, 9, v5
    buffer_load_dwordx4 v246, s[32:35], s99 offen offset:2048  lds
    v_and_b32 v8, 1, v7
    v_mul_u32_u24 v8, 4160, v8
    v_lshrrev_b32 v7, 1, v7
    s_add_u32 m0, s61, 61440
    s_add_u32 s16, s16, s63
    buffer_load_dwordx4 v244, s[32:35], s16 offen offset:0  lds
    v_lshl_add_u32 v8, v7, 2, v8
    v_lshlrev_b32 v7, 4, v6
    v_sub_u32 v8, v8, v7
    s_add_u32 s78, s94, 32
    buffer_load_dwordx4 v245, s[32:35], s16 offen offset:1024  lds
    v_add_u32 v21, s78, v8
    v_add_u32 v22, 1024, v21
    v_add_u32 v23, 2048, v21
    v_add_u32 v24, 3072, v21
    buffer_load_dwordx4 v246, s[32:35], s16 offen offset:2048  lds
    v_lshl_add_u32 v7, v5, 1, v6
    v_add_u32 v7, 30, v7
    v_and_b32 v8, 1, v7
    s_add_u32 s97, s98, s0
    s_lshr_b64 s[0:1], s[0:1], 4
    s_and_b32 s97, s97, 15
    s_add_u32 m0, s87, 0
    s_lshl_b32 s97, s97, 7
    buffer_load_dwordx4 v240, s[28:31], s97 offen offset:0  lds
    v_bfe_u32 v136, v7, 1, 2
    v_lshl_add_u32 v136, v8, 2, v136
    v_lshlrev_b32 v136, 6, v136
    v_lshrrev_b32 v7, 3, v7
    buffer_load_dwordx4 v241, s[28:31], s97 offen offset:1024  lds
    v_lshl_add_u32 v136, v7, 9, v136
    v_bitop3_b32 v8, v7, 3, s3 bitop3:0x6a
    v_lshl_add_u32 v25, v8, 4, v136
    v_add_u32 v25, 92160, v25
    buffer_load_dwordx4 v242, s[28:31], s97 offen offset:2048  lds
    v_subrev_u32 v7, 1, v7
    v_bitop3_b32 v8, v7, 3, s3 bitop3:0x6a
    v_lshl_add_u32 v27, v8, 4, v136
    buffer_load_dwordx4 v243, s[28:31], s97 offen offset:3072  lds
    v_add_u32 v27, 91648, v27
    v_subrev_u32 v7, 1, v7
    v_bitop3_b32 v8, v7, 3, s3 bitop3:0x6a
    v_lshl_add_u32 v29, v8, 4, v136
    s_add_u32 m0, s88, 0
    s_mov_b64 exec, 0xffffffff
    buffer_load_dwordx4 v3, s[28:31], s97 offen offset:0  lds
    s_mov_b64 exec, -1
    v_add_u32 v29, 91136, v29
    v_subrev_u32 v7, 1, v7
    v_bitop3_b32 v8, v7, 3, s3 bitop3:0x6a
    s_waitcnt vmcnt(11)
    s_barrier
    s_mul_i32 s16, s97, 3072
    s_add_u32 m0, s60, 0
    s_add_u32 s99, s16, s62
    buffer_load_dwordx4 v244, s[32:35], s99 offen offset:0  lds
    v_lshl_add_u32 v31, v8, 4, v136
    v_add_u32 v31, 90624, v31
    v_lshl_add_u32 v7, v5, 1, v6
    buffer_load_dwordx4 v245, s[32:35], s99 offen offset:1024  lds
    v_add_u32 v7, 26, v7
    v_and_b32 v8, 1, v7
    v_bfe_u32 v136, v7, 1, 2
    buffer_load_dwordx4 v246, s[32:35], s99 offen offset:2048  lds
    v_lshl_add_u32 v136, v8, 2, v136
    v_lshlrev_b32 v136, 6, v136
    s_add_u32 m0, s61, 12288
    s_add_u32 s16, s16, s63
    buffer_load_dwordx4 v244, s[32:35], s16 offen offset:0  lds
    v_lshrrev_b32 v7, 3, v7
    v_lshl_add_u32 v136, v7, 9, v136
    v_bitop3_b32 v8, v7, 3, s3 bitop3:0x6a
    buffer_load_dwordx4 v245, s[32:35], s16 offen offset:1024  lds
    v_lshl_add_u32 v26, v8, 4, v136
    v_add_u32 v26, 92160, v26
    v_subrev_u32 v7, 1, v7
    buffer_load_dwordx4 v246, s[32:35], s16 offen offset:2048  lds
    v_bitop3_b32 v8, v7, 3, s3 bitop3:0x6a
    v_lshl_add_u32 v28, v8, 4, v136
    s_add_u32 m0, s94, 32
    s_lshl_b32 s89, s90, 12
    buffer_load_dwordx4 v15, s[48:51], s89 offen offset:0 nt lds
    v_add_u32 v28, 91648, v28
    v_subrev_u32 v7, 1, v7
    v_bitop3_b32 v8, v7, 3, s3 bitop3:0x6a
    s_add_u32 m0, s94, 32
    s_lshl_b32 s89, s90, 12
    buffer_load_dwordx4 v15, s[48:51], s89 offen offset:1024 nt lds
    v_lshl_add_u32 v30, v8, 4, v136
    v_add_u32 v30, 91136, v30
    v_subrev_u32 v7, 1, v7
    s_add_u32 m0, s94, 32
    s_lshl_b32 s89, s90, 12
    buffer_load_dwordx4 v15, s[48:51], s89 offen offset:2048 nt lds
    v_bitop3_b32 v8, v7, 3, s3 bitop3:0x6a
    v_lshl_add_u32 v32, v8, 4, v136
    s_add_u32 m0, s94, 32
    s_lshl_b32 s89, s90, 12
    buffer_load_dwordx4 v15, s[48:51], s89 offen offset:3072 nt lds
    v_add_u32 v32, 90624, v32
    v_lshrrev_b32 v7, 1, v6
    v_lshl_add_u32 v7, v5, 1, v7
    s_add_u32 s97, s98, s0
    s_lshr_b64 s[0:1], s[0:1], 4
    s_and_b32 s97, s97, 15
    s_add_u32 m0, s87, 18432
    s_lshl_b32 s97, s97, 7
    buffer_load_dwordx4 v240, s[28:31], s97 offen offset:0  lds
    v_add_u32 v7, 32, v7
    v_and_b32 v8, 1, v7
    v_bfe_u32 v136, v7, 1, 2
    buffer_load_dwordx4 v241, s[28:31], s97 offen offset:1024  lds
    v_lshl_add_u32 v136, v8, 2, v136
    v_lshlrev_b32 v136, 6, v136
    buffer_load_dwordx4 v242, s[28:31], s97 offen offset:2048  lds
    v_lshrrev_b32 v7, 3, v7
    v_lshl_add_u32 v136, v7, 9, v136
    v_bitop3_b32 v8, v7, 3, s3 bitop3:0x6a
    buffer_load_dwordx4 v243, s[28:31], s97 offen offset:3072  lds
    v_lshl_add_u32 v20, v8, 4, v136
    v_add_u32 v20, 92160, v20
    v_and_b32 v8, 1, v6
    s_add_u32 m0, s88, 18432
    s_mov_b64 exec, 0xffffffff
    buffer_load_dwordx4 v3, s[28:31], s97 offen offset:0  lds
    s_mov_b64 exec, -1
    v_xor_b32 v8, 1, v8
    v_lshl_add_u32 v20, v8, 3, v20
    s_waitcnt vmcnt(15)
    s_barrier
    s_mul_i32 s16, s97, 3072
    s_add_u32 m0, s60, 24576
    s_add_u32 s99, s16, s62
    buffer_load_dwordx4 v244, s[32:35], s99 offen offset:0  lds
    s_waitcnt lgkmcnt(0)
    s_and_b32 s78, s92, 0xffff0000
    s_lshl_b32 s92, s92, 16
    buffer_load_dwordx4 v245, s[32:35], s99 offen offset:1024  lds
    s_bitcmp1_b32 s90, 0
    s_cselect_b32 s92, s78, s92
    v_lshlrev_b32 v7, 3, v6
    v_sub_u32 v7, v7, v5
    buffer_load_dwordx4 v246, s[32:35], s99 offen offset:2048  lds
    v_subrev_u32 v7, 9, v7
    v_and_b32 v8, 1, v7
    v_xor_b32 v8, 1, v8
    s_add_u32 m0, s61, 36864
    s_add_u32 s16, s16, s63
    buffer_load_dwordx4 v244, s[32:35], s16 offen offset:0  lds
    v_lshlrev_b32 v8, 4, v8
    v_lshrrev_b32 v8, v8, s92
    v_ashrrev_i32 v7, 1, v7
    buffer_load_dwordx4 v245, s[32:35], s16 offen offset:1024  lds
    v_cmp_eq_u32 vcc, 0, v7
    s_nop 1
    v_cndmask_b32 v236, 0, v8, vcc
    v_cmp_eq_u32 vcc, 1, v7
    buffer_load_dwordx4 v246, s[32:35], s16 offen offset:2048  lds
    s_nop 0
    v_cndmask_b32 v237, 0, v8, vcc
    v_cmp_eq_u32 vcc, 2, v7
    s_nop 1
    v_cndmask_b32 v238, 0, v8, vcc
    s_add_u32 s97, s98, s0
    s_lshr_b64 s[0:1], s[0:1], 4
    s_and_b32 s97, s97, 15
    s_add_u32 m0, s87, 36864
    s_lshl_b32 s97, s97, 7
    buffer_load_dwordx4 v240, s[28:31], s97 offen offset:0  lds
    v_cmp_eq_u32 vcc, 3, v7
    s_nop 1
    v_cndmask_b32 v239, 0, v8, vcc
    s_and_b32 s78, s77, 7
    s_mov_b32 s95, 0x76543210
    s_and_b32 s78, s76, 3
    s_mul_i32 s78, s78, 0x22222222
    s_add_u32 s95, s95, s78
    s_bfe_u32 s17, s95, 0x30000
    s_lshl_b32 s17, s17, 18
    s_bfe_u32 s18, s95, 0x30004
    s_lshl_b32 s18, s18, 18
    s_bfe_u32 s100, s95, 0x3001c
    s_lshl_b32 s100, s100, 18
    s_bfe_u32 s95, s95, 0x30018
    s_lshl_b32 s95, s95, 18
    buffer_load_dwordx4 v241, s[28:31], s97 offen offset:1024  lds
    v_lshrrev_b32 v136, 4, v0
    v_lshlrev_b32 v136, 1, v136
    v_and_b32 v137, 7, v0
    buffer_load_dwordx4 v242, s[28:31], s97 offen offset:2048  lds
    v_xor_b32 v136, v136, v137
    v_lshlrev_b32 v136, 4, v136
    v_lshrrev_b32 v137, 3, v0
    buffer_load_dwordx4 v243, s[28:31], s97 offen offset:3072  lds
    v_lshl_add_u32 v136, v137, 11, v136
    s_lshl_b32 s78, s77, 7
    s_lshl_b32 s79, s3, 14
    s_add_u32 m0, s88, 36864
    s_mov_b64 exec, 0xffffffff
    buffer_load_dwordx4 v3, s[28:31], s97 offen offset:0  lds
    s_mov_b64 exec, -1
    s_add_u32 s78, s78, s79
    v_add_u32 v17, s78, v136
    s_waitcnt vmcnt(11)
    s_barrier
    s_mul_i32 s16, s97, 3072
    s_add_u32 m0, s60, 49152
    s_add_u32 s99, s16, s62
    buffer_load_dwordx4 v244, s[32:35], s99 offen offset:0  lds
    v_add_u32 v5, s94, v15
    ds_read_b128 v[140:143], v5 offset:32
    ds_read_b32 v156, v5 offset:48
    ds_read_b128 v[144:147], v5 offset:1056
    buffer_load_dwordx4 v245, s[32:35], s99 offen offset:1024  lds
    ds_read_b32 v157, v5 offset:1072
    ds_read_b128 v[148:151], v5 offset:2080
    ds_read_b32 v158, v5 offset:2096
    ds_read_b128 v[152:155], v5 offset:3104
    buffer_load_dwordx4 v246, s[32:35], s99 offen offset:2048  lds
    ds_read_b32 v159, v5 offset:3120
    v_lshrrev_b32 v6, 3, v0
    v_mul_u32_u24 v6, 4160, v6
    s_add_u32 m0, s61, 61440
    s_add_u32 s16, s16, s63
    buffer_load_dwordx4 v244, s[32:35], s16 offen offset:0  lds
    v_and_b32 v7, 7, v0
    v_lshl_add_u32 v6, v7, 2, v6
    v_add_u32 v6, s94, v6
    v_mov_b32 v7, 0
    buffer_load_dwordx4 v245, s[32:35], s16 offen offset:1024  lds
    s_waitcnt lgkmcnt(0)
    v_readfirstlane_b32 s93, v140
    s_nop 0
    s_lshl_b32 s93, s93, 16
    s_nop 1
    v_writelane_b32 v7, s93, 15
    buffer_load_dwordx4 v246, s[32:35], s16 offen offset:2048  lds
    v_alignbit_b32 v140, v141, v140, 16
    v_alignbit_b32 v141, v142, v141, 16
    v_alignbit_b32 v142, v143, v142, 16
    s_add_u32 s97, s98, s0
    s_lshr_b64 s[0:1], s[0:1], 4
    s_and_b32 s97, s97, 15
    s_add_u32 m0, s87, 0
    s_lshl_b32 s97, s97, 7
    buffer_load_dwordx4 v240, s[28:31], s97 offen offset:0  lds
    v_alignbit_b32 v143, v156, v143, 16
    v_alignbit_b32 v144, v145, v144, 16
    v_alignbit_b32 v145, v146, v145, 16
    v_alignbit_b32 v146, v147, v146, 16
    buffer_load_dwordx4 v241, s[28:31], s97 offen offset:1024  lds
    v_alignbit_b32 v147, v157, v147, 16
    v_alignbit_b32 v148, v149, v148, 16
    v_alignbit_b32 v149, v150, v149, 16
    v_alignbit_b32 v150, v151, v150, 16
    buffer_load_dwordx4 v242, s[28:31], s97 offen offset:2048  lds
    v_alignbit_b32 v151, v158, v151, 16
    v_alignbit_b32 v152, v153, v152, 16
    v_alignbit_b32 v153, v154, v153, 16
    buffer_load_dwordx4 v243, s[28:31], s97 offen offset:3072  lds
    v_alignbit_b32 v154, v155, v154, 16
    v_alignbit_b32 v155, v159, v155, 16
    v_lshlrev_b32 v8, 3, v0
    s_add_u32 s78, s88, 18432
    s_add_u32 m0, s88, 0
    s_mov_b64 exec, 0xffffffff
    buffer_load_dwordx4 v3, s[28:31], s97 offen offset:0  lds
    s_mov_b64 exec, -1
    v_add_u32 v8, s78, v8
    v_mov_b32 v156, 0
    v_mov_b32 v157, 0
    s_waitcnt vmcnt(11)
    s_barrier
    s_mul_i32 s16, s97, 3072
    s_add_u32 m0, s60, 0
    s_add_u32 s99, s16, s62
    buffer_load_dwordx4 v244, s[32:35], s99 offen offset:0  lds
    buffer_load_dwordx4 v245, s[32:35], s99 offen offset:1024  lds
    buffer_load_dwordx4 v246, s[32:35], s99 offen offset:2048  lds
    s_add_u32 m0, s61, 12288
    s_add_u32 s16, s16, s63
    buffer_load_dwordx4 v244, s[32:35], s16 offen offset:0  lds
    buffer_load_dwordx4 v245, s[32:35], s16 offen offset:1024  lds
    buffer_load_dwordx4 v246, s[32:35], s16 offen offset:2048  lds
    s_mov_b64 exec, 0xff
    buffer_load_dword v136, v33, s[68:71], 0 offen sc1
    buffer_load_dword v137, v34, s[52:55], 0 offen sc1
    s_mov_b64 exec, -1
    buffer_load_dwordx4 v[212:215], v9, s[56:59], 0 offen offset:0 nt
    buffer_load_dwordx4 v[216:219], v9, s[56:59], 0 offen offset:2048 nt
    buffer_load_dwordx4 v[220:223], v9, s[56:59], s96 offen offset:0 nt
    buffer_load_dwordx4 v[224:227], v9, s[56:59], s96 offen offset:2048 nt
    s_waitcnt vmcnt(12)
    s_waitcnt vmcnt(6)
    s_barrier
    s_waitcnt vmcnt(4)
LA_j:
    s_mov_b64 exec, 0xff
    v_cmp_ne_u32 vcc, v136, v137
    v_cmp_gt_u32 s[80:81], s96, v136
    s_nop 0
    s_or_b64 vcc, vcc, s[80:81]
    s_cbranch_vccnz LA_slow
LA_back:
    s_mov_b64 exec, -1
    s_add_u32 m0, s86, 94208
    s_add_u32 s89, s91, 0
    buffer_load_dwordx4 v14, s[52:55], s89 offen sc1 lds
    s_add_u32 m0, s86, 98304
    s_add_u32 s89, s91, 4096
    buffer_load_dwordx4 v14, s[52:55], s89 offen sc1 lds
    s_add_u32 m0, s86, 102400
    s_add_u32 s89, s91, 8192
    buffer_load_dwordx4 v14, s[52:55], s89 offen sc1 lds
    s_add_u32 m0, s86, 106496
    s_add_u32 s89, s91, 12288
    buffer_load_dwordx4 v14, s[52:55], s89 offen sc1 lds
    s_mov_b64 exec, 0xffff
    ds_write_b32 v6, v7
    s_mov_b64 exec, -1
    ds_write_b128 v5, v[140:143] offset:4192
    ds_write_b128 v5, v[144:147] offset:5216
    ds_write_b128 v5, v[148:151] offset:6240
    ds_write_b128 v5, v[152:155] offset:7264
    ds_write_b64 v8, v[156:157]
    s_add_u32 s89, s95, 131072
    buffer_load_dwordx4 v[228:231], v17, s[64:67], s89 offen
    s_add_u32 s89, s95, 196608
    buffer_load_dwordx4 v[232:235], v17, s[64:67], s89 offen
    s_add_u32 s89, s100, 0
    buffer_load_dwordx4 v[240:243], v17, s[64:67], s89 offen
    s_add_u32 s89, s100, 65536
    buffer_load_dwordx4 v[244:247], v17, s[64:67], s89 offen
    s_add_u32 s89, s100, 131072
    buffer_load_dwordx4 v[248:251], v17, s[64:67], s89 offen
    s_add_u32 s89, s100, 196608
    buffer_load_dwordx4 v[196:199], v17, s[64:67], s89 offen
    ds_read2_b32 v[68:69], v21 offset0:0 offset1:1
    ds_read2_b32 v[70:71], v21 offset0:2 offset1:3
    ds_read2_b32 v[72:73], v21 offset0:128 offset1:129
    ds_read2_b32 v[74:75], v21 offset0:130 offset1:131
    ds_read2_b32 v[76:77], v22 offset0:0 offset1:1
    ds_read2_b32 v[78:79], v22 offset0:2 offset1:3
    ds_read2_b32 v[80:81], v22 offset0:128 offset1:129
    ds_read2_b32 v[82:83], v22 offset0:130 offset1:131
    ds_read2_b32 v[84:85], v23 offset0:0 offset1:1
    ds_read2_b32 v[86:87], v23 offset0:2 offset1:3
    ds_read2_b32 v[88:89], v23 offset0:128 offset1:129
    ds_read2_b32 v[90:91], v23 offset0:130 offset1:131
    ds_read2_b32 v[92:93], v24 offset0:0 offset1:1
    ds_read2_b32 v[94:95], v24 offset0:2 offset1:3
    ds_read2_b32 v[96:97], v24 offset0:128 offset1:129
    ds_read2_b32 v[98:99], v24 offset0:130 offset1:131
    s_waitcnt vmcnt(6)
    s_mov_b64 exec, 1
    ds_add_u32 v18, v19 offset:20
    s_mov_b64 exec, -1
    s_branch LA_s5_in
LA_s5:
    s_sleep 1
LA_s5_in:
    ds_read_b32 v6, v18 offset:20
    s_waitcnt lgkmcnt(0)
    v_readfirstlane_b32 s78, v6
    s_nop 0
    s_cmp_ge_u32 s78, 4
    s_cbranch_scc0 LA_s5
    s_mov_b64 exec, 1
    ds_add_u32 v18, v19 offset:8
    s_mov_b64 exec, -1
    ds_read_b128 v[100:103], v25 offset:0
    ds_read_b128 v[104:107], v25 offset:2048
    ds_read_b128 v[108:111], v25 offset:4096
    ds_read_b128 v[112:115], v25 offset:6144
    ds_read_b128 v[116:119], v25 offset:8192
    ds_read_b128 v[120:123], v25 offset:10240
    ds_read_b128 v[124:127], v25 offset:12288
    ds_read_b128 v[128:131], v25 offset:14336
    s_setprio 2
    s_waitcnt lgkmcnt(7)
    v_mfma_f32_16x16x32_bf16 v[36:39], v[236:239], v[100:103], 0
    ds_read2_b32 v[132:133], v21 offset0:16 offset1:17
    v_mfma_f32_16x16x32_bf16 v[36:39], v[68:71], v[100:103], v[36:39]
    ds_read2_b32 v[134:135], v21 offset0:18 offset1:19
    s_waitcnt lgkmcnt(8)
    v_mfma_f32_16x16x32_bf16 v[40:43], v[236:239], v[104:107], 0
    v_mfma_f32_16x16x32_bf16 v[40:43], v[68:71], v[104:107], v[40:43]
    ds_read_b128 v[164:167], v26 offset:0
    v_mfma_f32_16x16x32_bf16 v[40:43], v[72:75], v[100:103], v[40:43]
    s_waitcnt lgkmcnt(8)
    v_mfma_f32_16x16x32_bf16 v[44:47], v[236:239], v[108:111], 0
    ds_read2_b32 v[136:137], v21 offset0:144 offset1:145
    v_mfma_f32_16x16x32_bf16 v[44:47], v[68:71], v[108:111], v[44:47]
    ds_read2_b32 v[138:139], v21 offset0:146 offset1:147
    v_mfma_f32_16x16x32_bf16 v[44:47], v[72:75], v[104:107], v[44:47]
    v_mfma_f32_16x16x32_bf16 v[44:47], v[76:79], v[100:103], v[44:47]
    ds_read_b128 v[168:171], v26 offset:2048
    s_waitcnt lgkmcnt(10)
    v_mfma_f32_16x16x32_bf16 v[48:51], v[236:239], v[112:115], 0
    v_mfma_f32_16x16x32_bf16 v[48:51], v[68:71], v[112:115], v[48:51]
    ds_read2_b32 v[140:141], v22 offset0:16 offset1:17
    v_mfma_f32_16x16x32_bf16 v[48:51], v[72:75], v[108:111], v[48:51]
    ds_read2_b32 v[142:143], v22 offset0:18 offset1:19
    v_mfma_f32_16x16x32_bf16 v[48:51], v[76:79], v[104:107], v[48:51]
    v_mfma_f32_16x16x32_bf16 v[48:51], v[80:83], v[100:103], v[48:51]
    ds_read_b128 v[172:175], v26 offset:4096
    s_waitcnt lgkmcnt(12)
    v_mfma_f32_16x16x32_bf16 v[52:55], v[236:239], v[116:119], 0
    v_mfma_f32_16x16x32_bf16 v[52:55], v[68:71], v[116:119], v[52:55]
    ds_read2_b32 v[144:145], v22 offset0:144 offset1:145
    v_mfma_f32_16x16x32_bf16 v[52:55], v[72:75], v[112:115], v[52:55]
    ds_read2_b32 v[146:147], v22 offset0:146 offset1:147
    v_mfma_f32_16x16x32_bf16 v[52:55], v[76:79], v[108:111], v[52:55]
    v_mfma_f32_16x16x32_bf16 v[52:55], v[80:83], v[104:107], v[52:55]
    ds_read_b128 v[176:179], v26 offset:6144
    v_mfma_f32_16x16x32_bf16 v[52:55], v[84:87], v[100:103], v[52:55]
    s_waitcnt lgkmcnt(14)
    v_mfma_f32_16x16x32_bf16 v[56:59], v[236:239], v[120:123], 0
    ds_read2_b32 v[148:149], v23 offset0:16 offset1:17
    v_mfma_f32_16x16x32_bf16 v[56:59], v[68:71], v[120:123], v[56:59]
    ds_read2_b32 v[150:151], v23 offset0:18 offset1:19
    v_mfma_f32_16x16x32_bf16 v[56:59], v[72:75], v[116:119], v[56:59]
    v_mfma_f32_16x16x32_bf16 v[56:59], v[76:79], v[112:115], v[56:59]
    ds_read_b128 v[180:183], v26 offset:8192
    v_mfma_f32_16x16x32_bf16 v[56:59], v[80:83], v[108:111], v[56:59]
    v_mfma_f32_16x16x32_bf16 v[56:59], v[84:87], v[104:107], v[56:59]
    ds_read2_b32 v[152:153], v23 offset0:144 offset1:145
    v_mfma_f32_16x16x32_bf16 v[56:59], v[88:91], v[100:103], v[56:59]
    ds_read2_b32 v[154:155], v23 offset0:146 offset1:147
    s_waitcnt lgkmcnt(14)
    v_mfma_f32_16x16x32_bf16 v[60:63], v[236:239], v[124:127], 0
    v_mfma_f32_16x16x32_bf16 v[60:63], v[68:71], v[124:127], v[60:63]
    ds_read_b128 v[184:187], v26 offset:10240
    v_mfma_f32_16x16x32_bf16 v[60:63], v[72:75], v[120:123], v[60:63]
    v_mfma_f32_16x16x32_bf16 v[60:63], v[76:79], v[116:119], v[60:63]
    ds_read2_b32 v[156:157], v24 offset0:16 offset1:17
    v_mfma_f32_16x16x32_bf16 v[60:63], v[80:83], v[112:115], v[60:63]
    ds_read2_b32 v[158:159], v24 offset0:18 offset1:19
    v_mfma_f32_16x16x32_bf16 v[60:63], v[84:87], v[108:111], v[60:63]
    v_mfma_f32_16x16x32_bf16 v[60:63], v[88:91], v[104:107], v[60:63]
    ds_read_b128 v[188:191], v26 offset:12288
    v_mfma_f32_16x16x32_bf16 v[60:63], v[92:95], v[100:103], v[60:63]
    v_mfma_f32_16x16x32_bf16 v[64:67], v[236:239], v[128:131], 0
    ds_read2_b32 v[160:161], v24 offset0:144 offset1:145
    v_mfma_f32_16x16x32_bf16 v[64:67], v[68:71], v[128:131], v[64:67]
    ds_read2_b32 v[162:163], v24 offset0:146 offset1:147
    v_mfma_f32_16x16x32_bf16 v[64:67], v[72:75], v[124:127], v[64:67]
    v_mfma_f32_16x16x32_bf16 v[64:67], v[76:79], v[120:123], v[64:67]
    ds_read_b128 v[192:195], v26 offset:14336
    v_mfma_f32_16x16x32_bf16 v[64:67], v[80:83], v[116:119], v[64:67]
    v_mfma_f32_16x16x32_bf16 v[64:67], v[84:87], v[112:115], v[64:67]
    v_mfma_f32_16x16x32_bf16 v[64:67], v[88:91], v[108:111], v[64:67]
    v_mfma_f32_16x16x32_bf16 v[64:67], v[92:95], v[104:107], v[64:67]
    v_mfma_f32_16x16x32_bf16 v[64:67], v[96:99], v[100:103], v[64:67]
    v_mfma_f32_16x16x32_bf16 v[36:39], v[132:135], v[164:167], v[36:39]
    ds_read2_b32 v[68:69], v21 offset0:32 offset1:33
    s_waitcnt lgkmcnt(14)
    v_mfma_f32_16x16x32_bf16 v[40:43], v[136:139], v[164:167], v[40:43]
    ds_read2_b32 v[70:71], v21 offset0:34 offset1:35
    v_mfma_f32_16x16x32_bf16 v[40:43], v[132:135], v[168:171], v[40:43]
    ds_read_b128 v[100:103], v27 offset:0
    v_mfma_f32_16x16x32_bf16 v[44:47], v[132:135], v[172:175], v[44:47]
    v_mfma_f32_16x16x32_bf16 v[44:47], v[136:139], v[168:171], v[44:47]
    ds_read2_b32 v[72:73], v21 offset0:160 offset1:161
    v_mfma_f32_16x16x32_bf16 v[44:47], v[140:143], v[164:167], v[44:47]
    ds_read2_b32 v[74:75], v21 offset0:162 offset1:163
    v_mfma_f32_16x16x32_bf16 v[48:51], v[144:147], v[164:167], v[48:51]
    ds_read_b128 v[104:107], v27 offset:2048
    v_mfma_f32_16x16x32_bf16 v[48:51], v[140:143], v[168:171], v[48:51]
    v_mfma_f32_16x16x32_bf16 v[48:51], v[136:139], v[172:175], v[48:51]
    ds_read2_b32 v[76:77], v22 offset0:32 offset1:33
    s_waitcnt lgkmcnt(14)
    v_mfma_f32_16x16x32_bf16 v[48:51], v[132:135], v[176:179], v[48:51]
    ds_read2_b32 v[78:79], v22 offset0:34 offset1:35
    v_mfma_f32_16x16x32_bf16 v[52:55], v[132:135], v[180:183], v[52:55]
    ds_read_b128 v[108:111], v27 offset:4096
    v_mfma_f32_16x16x32_bf16 v[52:55], v[136:139], v[176:179], v[52:55]
    v_mfma_f32_16x16x32_bf16 v[52:55], v[140:143], v[172:175], v[52:55]
    ds_read2_b32 v[80:81], v22 offset0:160 offset1:161
    v_mfma_f32_16x16x32_bf16 v[52:55], v[144:147], v[168:171], v[52:55]
    ds_read2_b32 v[82:83], v22 offset0:162 offset1:163
    v_mfma_f32_16x16x32_bf16 v[52:55], v[148:151], v[164:167], v[52:55]
    ds_read_b128 v[112:115], v27 offset:6144
    v_mfma_f32_16x16x32_bf16 v[56:59], v[152:155], v[164:167], v[56:59]
    v_mfma_f32_16x16x32_bf16 v[56:59], v[148:151], v[168:171], v[56:59]
    ds_read2_b32 v[84:85], v23 offset0:32 offset1:33
    v_mfma_f32_16x16x32_bf16 v[56:59], v[144:147], v[172:175], v[56:59]
    ds_read2_b32 v[86:87], v23 offset0:34 offset1:35
    v_mfma_f32_16x16x32_bf16 v[56:59], v[140:143], v[176:179], v[56:59]
    ds_read_b128 v[116:119], v27 offset:8192
    v_mfma_f32_16x16x32_bf16 v[56:59], v[136:139], v[180:183], v[56:59]
    s_waitcnt lgkmcnt(14)
    v_mfma_f32_16x16x32_bf16 v[56:59], v[132:135], v[184:187], v[56:59]
    ds_read2_b32 v[88:89], v23 offset0:160 offset1:161
    v_mfma_f32_16x16x32_bf16 v[60:63], v[132:135], v[188:191], v[60:63]
    ds_read2_b32 v[90:91], v23 offset0:162 offset1:163
    v_mfma_f32_16x16x32_bf16 v[60:63], v[136:139], v[184:187], v[60:63]
    ds_read_b128 v[120:123], v27 offset:10240
    v_mfma_f32_16x16x32_bf16 v[60:63], v[140:143], v[180:183], v[60:63]
    v_mfma_f32_16x16x32_bf16 v[60:63], v[144:147], v[176:179], v[60:63]
    ds_read2_b32 v[92:93], v24 offset0:32 offset1:33
    v_mfma_f32_16x16x32_bf16 v[60:63], v[148:151], v[172:175], v[60:63]
    ds_read2_b32 v[94:95], v24 offset0:34 offset1:35
    v_mfma_f32_16x16x32_bf16 v[60:63], v[152:155], v[168:171], v[60:63]
    ds_read_b128 v[124:127], v27 offset:12288
    v_mfma_f32_16x16x32_bf16 v[60:63], v[156:159], v[164:167], v[60:63]
    v_mfma_f32_16x16x32_bf16 v[64:67], v[160:163], v[164:167], v[64:67]
    ds_read2_b32 v[96:97], v24 offset0:160 offset1:161
    v_mfma_f32_16x16x32_bf16 v[64:67], v[156:159], v[168:171], v[64:67]
    ds_read2_b32 v[98:99], v24 offset0:162 offset1:163
    v_mfma_f32_16x16x32_bf16 v[64:67], v[152:155], v[172:175], v[64:67]
    ds_read_b128 v[128:131], v27 offset:14336
    v_mfma_f32_16x16x32_bf16 v[64:67], v[148:151], v[176:179], v[64:67]
    v_mfma_f32_16x16x32_bf16 v[64:67], v[144:147], v[180:183], v[64:67]
    v_mfma_f32_16x16x32_bf16 v[64:67], v[140:143], v[184:187], v[64:67]
    v_mfma_f32_16x16x32_bf16 v[64:67], v[136:139], v[188:191], v[64:67]
    v_mfma_f32_16x16x32_bf16 v[64:67], v[132:135], v[192:195], v[64:67]
    s_waitcnt lgkmcnt(14)
    v_mfma_f32_16x16x32_bf16 v[36:39], v[68:71], v[100:103], v[36:39]
    ds_read2_b32 v[132:133], v21 offset0:48 offset1:49
    v_mfma_f32_16x16x32_bf16 v[40:43], v[72:75], v[100:103], v[40:43]
    ds_read2_b32 v[134:135], v21 offset0:50 offset1:51
    v_mfma_f32_16x16x32_bf16 v[40:43], v[68:71], v[104:107], v[40:43]
    ds_read_b128 v[164:167], v28 offset:0
    v_mfma_f32_16x16x32_bf16 v[44:47], v[68:71], v[108:111], v[44:47]
    v_mfma_f32_16x16x32_bf16 v[44:47], v[72:75], v[104:107], v[44:47]
    ds_read2_b32 v[136:137], v21 offset0:176 offset1:177
    v_mfma_f32_16x16x32_bf16 v[44:47], v[76:79], v[100:103], v[44:47]
    ds_read2_b32 v[138:139], v21 offset0:178 offset1:179
    s_waitcnt lgkmcnt(14)
    v_mfma_f32_16x16x32_bf16 v[48:51], v[80:83], v[100:103], v[48:51]
    ds_read_b128 v[168:171], v28 offset:2048
    v_mfma_f32_16x16x32_bf16 v[48:51], v[76:79], v[104:107], v[48:51]
    v_mfma_f32_16x16x32_bf16 v[48:51], v[72:75], v[108:111], v[48:51]
    ds_read2_b32 v[140:141], v22 offset0:48 offset1:49
    v_mfma_f32_16x16x32_bf16 v[48:51], v[68:71], v[112:115], v[48:51]
    ds_read2_b32 v[142:143], v22 offset0:50 offset1:51
    v_mfma_f32_16x16x32_bf16 v[52:55], v[68:71], v[116:119], v[52:55]
    ds_read_b128 v[172:175], v28 offset:4096
    v_mfma_f32_16x16x32_bf16 v[52:55], v[72:75], v[112:115], v[52:55]
    v_mfma_f32_16x16x32_bf16 v[52:55], v[76:79], v[108:111], v[52:55]
    ds_read2_b32 v[144:145], v22 offset0:176 offset1:177
    v_mfma_f32_16x16x32_bf16 v[52:55], v[80:83], v[104:107], v[52:55]
    ds_read2_b32 v[146:147], v22 offset0:178 offset1:179
    v_mfma_f32_16x16x32_bf16 v[52:55], v[84:87], v[100:103], v[52:55]
    ds_read_b128 v[176:179], v28 offset:6144
    s_waitcnt lgkmcnt(14)
    v_mfma_f32_16x16x32_bf16 v[56:59], v[88:91], v[100:103], v[56:59]
    v_mfma_f32_16x16x32_bf16 v[56:59], v[84:87], v[104:107], v[56:59]
    ds_read2_b32 v[148:149], v23 offset0:48 offset1:49
    v_mfma_f32_16x16x32_bf16 v[56:59], v[80:83], v[108:111], v[56:59]
    ds_read2_b32 v[150:151], v23 offset0:50 offset1:51
    v_mfma_f32_16x16x32_bf16 v[56:59], v[76:79], v[112:115], v[56:59]
    ds_read_b128 v[180:183], v28 offset:8192
    v_mfma_f32_16x16x32_bf16 v[56:59], v[72:75], v[116:119], v[56:59]
    v_mfma_f32_16x16x32_bf16 v[56:59], v[68:71], v[120:123], v[56:59]
    ds_read2_b32 v[152:153], v23 offset0:176 offset1:177
    v_mfma_f32_16x16x32_bf16 v[60:63], v[68:71], v[124:127], v[60:63]
    ds_read2_b32 v[154:155], v23 offset0:178 offset1:179
    v_mfma_f32_16x16x32_bf16 v[60:63], v[72:75], v[120:123], v[60:63]
    ds_read_b128 v[184:187], v28 offset:10240
    v_mfma_f32_16x16x32_bf16 v[60:63], v[76:79], v[116:119], v[60:63]
    v_mfma_f32_16x16x32_bf16 v[60:63], v[80:83], v[112:115], v[60:63]
    ds_read2_b32 v[156:157], v24 offset0:48 offset1:49
    v_mfma_f32_16x16x32_bf16 v[60:63], v[84:87], v[108:111], v[60:63]
    ds_read2_b32 v[158:159], v24 offset0:50 offset1:51
    v_mfma_f32_16x16x32_bf16 v[60:63], v[88:91], v[104:107], v[60:63]
    ds_read_b128 v[188:191], v28 offset:12288
    v_mfma_f32_16x16x32_bf16 v[60:63], v[92:95], v[100:103], v[60:63]
    s_waitcnt lgkmcnt(14)
    v_mfma_f32_16x16x32_bf16 v[64:67], v[96:99], v[100:103], v[64:67]
    ds_read2_b32 v[160:161], v24 offset0:176 offset1:177
    v_mfma_f32_16x16x32_bf16 v[64:67], v[92:95], v[104:107], v[64:67]
    ds_read2_b32 v[162:163], v24 offset0:178 offset1:179
    v_mfma_f32_16x16x32_bf16 v[64:67], v[88:91], v[108:111], v[64:67]
    ds_read_b128 v[192:195], v28 offset:14336
    v_mfma_f32_16x16x32_bf16 v[64:67], v[84:87], v[112:115], v[64:67]
    v_mfma_f32_16x16x32_bf16 v[64:67], v[80:83], v[116:119], v[64:67]
    v_mfma_f32_16x16x32_bf16 v[64:67], v[76:79], v[120:123], v[64:67]
    v_mfma_f32_16x16x32_bf16 v[64:67], v[72:75], v[124:127], v[64:67]
    v_mfma_f32_16x16x32_bf16 v[64:67], v[68:71], v[128:131], v[64:67]
    v_mfma_f32_16x16x32_bf16 v[36:39], v[132:135], v[164:167], v[36:39]
    ds_read2_b32 v[68:69], v21 offset0:64 offset1:65
    v_mfma_f32_16x16x32_bf16 v[40:43], v[136:139], v[164:167], v[40:43]
    ds_read2_b32 v[70:71], v21 offset0:66 offset1:67
    v_mfma_f32_16x16x32_bf16 v[40:43], v[132:135], v[168:171], v[40:43]
    ds_read_b128 v[100:103], v29 offset:0
    s_waitcnt lgkmcnt(14)
    v_mfma_f32_16x16x32_bf16 v[44:47], v[132:135], v[172:175], v[44:47]
    v_mfma_f32_16x16x32_bf16 v[44:47], v[136:139], v[168:171], v[44:47]
    ds_read2_b32 v[72:73], v21 offset0:192 offset1:193
    v_mfma_f32_16x16x32_bf16 v[44:47], v[140:143], v[164:167], v[44:47]
    ds_read2_b32 v[74:75], v21 offset0:194 offset1:195
    v_mfma_f32_16x16x32_bf16 v[48:51], v[144:147], v[164:167], v[48:51]
    ds_read_b128 v[104:107], v29 offset:2048
    v_mfma_f32_16x16x32_bf16 v[48:51], v[140:143], v[168:171], v[48:51]
    v_mfma_f32_16x16x32_bf16 v[48:51], v[136:139], v[172:175], v[48:51]
    ds_read2_b32 v[76:77], v22 offset0:64 offset1:65
    v_mfma_f32_16x16x32_bf16 v[48:51], v[132:135], v[176:179], v[48:51]
    ds_read2_b32 v[78:79], v22 offset0:66 offset1:67
    s_waitcnt lgkmcnt(14)
    v_mfma_f32_16x16x32_bf16 v[52:55], v[132:135], v[180:183], v[52:55]
    ds_read_b128 v[108:111], v29 offset:4096
    v_mfma_f32_16x16x32_bf16 v[52:55], v[136:139], v[176:179], v[52:55]
    v_mfma_f32_16x16x32_bf16 v[52:55], v[140:143], v[172:175], v[52:55]
    ds_read2_b32 v[80:81], v22 offset0:192 offset1:193
    v_mfma_f32_16x16x32_bf16 v[52:55], v[144:147], v[168:171], v[52:55]
    ds_read2_b32 v[82:83], v22 offset0:194 offset1:195
    v_mfma_f32_16x16x32_bf16 v[52:55], v[148:151], v[164:167], v[52:55]
    ds_read_b128 v[112:115], v29 offset:6144
    v_mfma_f32_16x16x32_bf16 v[56:59], v[152:155], v[164:167], v[56:59]
    v_mfma_f32_16x16x32_bf16 v[56:59], v[148:151], v[168:171], v[56:59]
    ds_read2_b32 v[84:85], v23 offset0:64 offset1:65
    v_mfma_f32_16x16x32_bf16 v[56:59], v[144:147], v[172:175], v[56:59]
    ds_read2_b32 v[86:87], v23 offset0:66 offset1:67
    v_mfma_f32_16x16x32_bf16 v[56:59], v[140:143], v[176:179], v[56:59]
    ds_read_b128 v[116:119], v29 offset:8192
    v_mfma_f32_16x16x32_bf16 v[56:59], v[136:139], v[180:183], v[56:59]
    v_mfma_f32_16x16x32_bf16 v[56:59], v[132:135], v[184:187], v[56:59]
    ds_read2_b32 v[88:89], v23 offset0:192 offset1:193
    s_waitcnt lgkmcnt(14)
    v_mfma_f32_16x16x32_bf16 v[60:63], v[132:135], v[188:191], v[60:63]
    ds_read2_b32 v[90:91], v23 offset0:194 offset1:195
    v_mfma_f32_16x16x32_bf16 v[60:63], v[136:139], v[184:187], v[60:63]
    ds_read_b128 v[120:123], v29 offset:10240
    v_mfma_f32_16x16x32_bf16 v[60:63], v[140:143], v[180:183], v[60:63]
    v_mfma_f32_16x16x32_bf16 v[60:63], v[144:147], v[176:179], v[60:63]
    ds_read2_b32 v[92:93], v24 offset0:64 offset1:65
    v_mfma_f32_16x16x32_bf16 v[60:63], v[148:151], v[172:175], v[60:63]
    ds_read2_b32 v[94:95], v24 offset0:66 offset1:67
    v_mfma_f32_16x16x32_bf16 v[60:63], v[152:155], v[168:171], v[60:63]
    ds_read_b128 v[124:127], v29 offset:12288
    v_mfma_f32_16x16x32_bf16 v[60:63], v[156:159], v[164:167], v[60:63]
    v_mfma_f32_16x16x32_bf16 v[64:67], v[160:163], v[164:167], v[64:67]
    ds_read2_b32 v[96:97], v24 offset0:192 offset1:193
    v_mfma_f32_16x16x32_bf16 v[64:67], v[156:159], v[168:171], v[64:67]
    ds_read2_b32 v[98:99], v24 offset0:194 offset1:195
    v_mfma_f32_16x16x32_bf16 v[64:67], v[152:155], v[172:175], v[64:67]
    ds_read_b128 v[128:131], v29 offset:14336
    v_mfma_f32_16x16x32_bf16 v[64:67], v[148:151], v[176:179], v[64:67]
    v_mfma_f32_16x16x32_bf16 v[64:67], v[144:147], v[180:183], v[64:67]
    v_mfma_f32_16x16x32_bf16 v[64:67], v[140:143], v[184:187], v[64:67]
    v_mfma_f32_16x16x32_bf16 v[64:67], v[136:139], v[188:191], v[64:67]
    v_mfma_f32_16x16x32_bf16 v[64:67], v[132:135], v[192:195], v[64:67]
    s_waitcnt lgkmcnt(14)
    v_mfma_f32_16x16x32_bf16 v[36:39], v[68:71], v[100:103], v[36:39]
    ds_read2_b32 v[132:133], v21 offset0:80 offset1:81
    v_mfma_f32_16x16x32_bf16 v[40:43], v[72:75], v[100:103], v[40:43]
    ds_read2_b32 v[134:135], v21 offset0:82 offset1:83
    v_mfma_f32_16x16x32_bf16 v[40:43], v[68:71], v[104:107], v[40:43]
    ds_read_b128 v[164:167], v30 offset:0
    v_mfma_f32_16x16x32_bf16 v[44:47], v[68:71], v[108:111], v[44:47]
    v_mfma_f32_16x16x32_bf16 v[44:47], v[72:75], v[104:107], v[44:47]
    ds_read2_b32 v[136:137], v21 offset0:208 offset1:209
    v_mfma_f32_16x16x32_bf16 v[44:47], v[76:79], v[100:103], v[44:47]
    ds_read2_b32 v[138:139], v21 offset0:210 offset1:211
    s_waitcnt lgkmcnt(14)
    v_mfma_f32_16x16x32_bf16 v[48:51], v[80:83], v[100:103], v[48:51]
    ds_read_b128 v[168:171], v30 offset:2048
    v_mfma_f32_16x16x32_bf16 v[48:51], v[76:79], v[104:107], v[48:51]
    v_mfma_f32_16x16x32_bf16 v[48:51], v[72:75], v[108:111], v[48:51]
    ds_read2_b32 v[140:141], v22 offset0:80 offset1:81
    v_mfma_f32_16x16x32_bf16 v[48:51], v[68:71], v[112:115], v[48:51]
    ds_read2_b32 v[142:143], v22 offset0:82 offset1:83
    v_mfma_f32_16x16x32_bf16 v[52:55], v[68:71], v[116:119], v[52:55]
    ds_read_b128 v[172:175], v30 offset:4096
    v_mfma_f32_16x16x32_bf16 v[52:55], v[72:75], v[112:115], v[52:55]
    v_mfma_f32_16x16x32_bf16 v[52:55], v[76:79], v[108:111], v[52:55]
    ds_read2_b32 v[144:145], v22 offset0:208 offset1:209
    v_mfma_f32_16x16x32_bf16 v[52:55], v[80:83], v[104:107], v[52:55]
    ds_read2_b32 v[146:147], v22 offset0:210 offset1:211
    v_mfma_f32_16x16x32_bf16 v[52:55], v[84:87], v[100:103], v[52:55]
    ds_read_b128 v[176:179], v30 offset:6144
    s_waitcnt lgkmcnt(14)
    v_mfma_f32_16x16x32_bf16 v[56:59], v[88:91], v[100:103], v[56:59]
    v_mfma_f32_16x16x32_bf16 v[56:59], v[84:87], v[104:107], v[56:59]
    ds_read2_b32 v[148:149], v23 offset0:80 offset1:81
    v_mfma_f32_16x16x32_bf16 v[56:59], v[80:83], v[108:111], v[56:59]
    ds_read2_b32 v[150:151], v23 offset0:82 offset1:83
    v_mfma_f32_16x16x32_bf16 v[56:59], v[76:79], v[112:115], v[56:59]
    ds_read_b128 v[180:183], v30 offset:8192
    v_mfma_f32_16x16x32_bf16 v[56:59], v[72:75], v[116:119], v[56:59]
    v_mfma_f32_16x16x32_bf16 v[56:59], v[68:71], v[120:123], v[56:59]
    ds_read2_b32 v[152:153], v23 offset0:208 offset1:209
    v_mfma_f32_16x16x32_bf16 v[60:63], v[68:71], v[124:127], v[60:63]
    ds_read2_b32 v[154:155], v23 offset0:210 offset1:211
    v_mfma_f32_16x16x32_bf16 v[60:63], v[72:75], v[120:123], v[60:63]
    ds_read_b128 v[184:187], v30 offset:10240
    v_mfma_f32_16x16x32_bf16 v[60:63], v[76:79], v[116:119], v[60:63]
    v_mfma_f32_16x16x32_bf16 v[60:63], v[80:83], v[112:115], v[60:63]
    ds_read2_b32 v[156:157], v24 offset0:80 offset1:81
    v_mfma_f32_16x16x32_bf16 v[60:63], v[84:87], v[108:111], v[60:63]
    ds_read2_b32 v[158:159], v24 offset0:82 offset1:83
    v_mfma_f32_16x16x32_bf16 v[60:63], v[88:91], v[104:107], v[60:63]
    ds_read_b128 v[188:191], v30 offset:12288
    v_mfma_f32_16x16x32_bf16 v[60:63], v[92:95], v[100:103], v[60:63]
    s_waitcnt lgkmcnt(14)
    v_mfma_f32_16x16x32_bf16 v[64:67], v[96:99], v[100:103], v[64:67]
    ds_read2_b32 v[160:161], v24 offset0:208 offset1:209
    v_mfma_f32_16x16x32_bf16 v[64:67], v[92:95], v[104:107], v[64:67]
    ds_read2_b32 v[162:163], v24 offset0:210 offset1:211
    v_mfma_f32_16x16x32_bf16 v[64:67], v[88:91], v[108:111], v[64:67]
    ds_read_b128 v[192:195], v30 offset:14336
    v_mfma_f32_16x16x32_bf16 v[64:67], v[84:87], v[112:115], v[64:67]
    v_mfma_f32_16x16x32_bf16 v[64:67], v[80:83], v[116:119], v[64:67]
    v_mfma_f32_16x16x32_bf16 v[64:67], v[76:79], v[120:123], v[64:67]
    v_mfma_f32_16x16x32_bf16 v[64:67], v[72:75], v[124:127], v[64:67]
    v_mfma_f32_16x16x32_bf16 v[64:67], v[68:71], v[128:131], v[64:67]
    v_mfma_f32_16x16x32_bf16 v[36:39], v[132:135], v[164:167], v[36:39]
    ds_read2_b32 v[68:69], v21 offset0:96 offset1:97
    v_mfma_f32_16x16x32_bf16 v[40:43], v[136:139], v[164:167], v[40:43]
    ds_read2_b32 v[70:71], v21 offset0:98 offset1:99
    v_mfma_f32_16x16x32_bf16 v[40:43], v[132:135], v[168:171], v[40:43]
    ds_read_b128 v[100:103], v31 offset:0
    s_waitcnt lgkmcnt(14)
    v_mfma_f32_16x16x32_bf16 v[44:47], v[132:135], v[172:175], v[44:47]
    v_mfma_f32_16x16x32_bf16 v[44:47], v[136:139], v[168:171], v[44:47]
    ds_read2_b32 v[72:73], v21 offset0:224 offset1:225
    v_mfma_f32_16x16x32_bf16 v[44:47], v[140:143], v[164:167], v[44:47]
    ds_read2_b32 v[74:75], v21 offset0:226 offset1:227
    v_mfma_f32_16x16x32_bf16 v[48:51], v[144:147], v[164:167], v[48:51]
    ds_read_b128 v[104:107], v31 offset:2048
    v_mfma_f32_16x16x32_bf16 v[48:51], v[140:143], v[168:171], v[48:51]
    v_mfma_f32_16x16x32_bf16 v[48:51], v[136:139], v[172:175], v[48:51]
    ds_read2_b32 v[76:77], v22 offset0:96 offset1:97
    v_mfma_f32_16x16x32_bf16 v[48:51], v[132:135], v[176:179], v[48:51]
    ds_read2_b32 v[78:79], v22 offset0:98 offset1:99
    s_waitcnt lgkmcnt(14)
    v_mfma_f32_16x16x32_bf16 v[52:55], v[132:135], v[180:183], v[52:55]
    ds_read_b128 v[108:111], v31 offset:4096
    v_mfma_f32_16x16x32_bf16 v[52:55], v[136:139], v[176:179], v[52:55]
    v_mfma_f32_16x16x32_bf16 v[52:55], v[140:143], v[172:175], v[52:55]
    ds_read2_b32 v[80:81], v22 offset0:224 offset1:225
    v_mfma_f32_16x16x32_bf16 v[52:55], v[144:147], v[168:171], v[52:55]
    ds_read2_b32 v[82:83], v22 offset0:226 offset1:227
    v_mfma_f32_16x16x32_bf16 v[52:55], v[148:151], v[164:167], v[52:55]
    ds_read_b128 v[112:115], v31 offset:6144
    v_mfma_f32_16x16x32_bf16 v[56:59], v[152:155], v[164:167], v[56:59]
    v_mfma_f32_16x16x32_bf16 v[56:59], v[148:151], v[168:171], v[56:59]
    ds_read2_b32 v[84:85], v23 offset0:96 offset1:97
    v_mfma_f32_16x16x32_bf16 v[56:59], v[144:147], v[172:175], v[56:59]
    ds_read2_b32 v[86:87], v23 offset0:98 offset1:99
    v_mfma_f32_16x16x32_bf16 v[56:59], v[140:143], v[176:179], v[56:59]
    ds_read_b128 v[116:119], v31 offset:8192
    v_mfma_f32_16x16x32_bf16 v[56:59], v[136:139], v[180:183], v[56:59]
    v_mfma_f32_16x16x32_bf16 v[56:59], v[132:135], v[184:187], v[56:59]
    ds_read2_b32 v[88:89], v23 offset0:224 offset1:225
    s_waitcnt lgkmcnt(14)
    v_mfma_f32_16x16x32_bf16 v[60:63], v[132:135], v[188:191], v[60:63]
    ds_read2_b32 v[90:91], v23 offset0:226 offset1:227
    v_mfma_f32_16x16x32_bf16 v[60:63], v[136:139], v[184:187], v[60:63]
    ds_read_b128 v[120:123], v31 offset:10240
    v_mfma_f32_16x16x32_bf16 v[60:63], v[140:143], v[180:183], v[60:63]
    v_mfma_f32_16x16x32_bf16 v[60:63], v[144:147], v[176:179], v[60:63]
    ds_read2_b32 v[92:93], v24 offset0:96 offset1:97
    v_mfma_f32_16x16x32_bf16 v[60:63], v[148:151], v[172:175], v[60:63]
    ds_read2_b32 v[94:95], v24 offset0:98 offset1:99
    v_mfma_f32_16x16x32_bf16 v[60:63], v[152:155], v[168:171], v[60:63]
    ds_read_b128 v[124:127], v31 offset:12288
    v_mfma_f32_16x16x32_bf16 v[60:63], v[156:159], v[164:167], v[60:63]
    v_mfma_f32_16x16x32_bf16 v[64:67], v[160:163], v[164:167], v[64:67]
    ds_read2_b32 v[96:97], v24 offset0:224 offset1:225
    v_mfma_f32_16x16x32_bf16 v[64:67], v[156:159], v[168:171], v[64:67]
    ds_read2_b32 v[98:99], v24 offset0:226 offset1:227
    v_mfma_f32_16x16x32_bf16 v[64:67], v[152:155], v[172:175], v[64:67]
    ds_read_b128 v[128:131], v31 offset:14336
    v_mfma_f32_16x16x32_bf16 v[64:67], v[148:151], v[176:179], v[64:67]
    v_mfma_f32_16x16x32_bf16 v[64:67], v[144:147], v[180:183], v[64:67]
    v_mfma_f32_16x16x32_bf16 v[64:67], v[140:143], v[184:187], v[64:67]
    v_mfma_f32_16x16x32_bf16 v[64:67], v[136:139], v[188:191], v[64:67]
    v_mfma_f32_16x16x32_bf16 v[64:67], v[132:135], v[192:195], v[64:67]
    s_waitcnt lgkmcnt(14)
    v_mfma_f32_16x16x32_bf16 v[36:39], v[68:71], v[100:103], v[36:39]
    ds_read2_b32 v[132:133], v21 offset0:112 offset1:113
    v_mfma_f32_16x16x32_bf16 v[40:43], v[72:75], v[100:103], v[40:43]
    ds_read2_b32 v[134:135], v21 offset0:114 offset1:115
    v_mfma_f32_16x16x32_bf16 v[40:43], v[68:71], v[104:107], v[40:43]
    ds_read_b128 v[164:167], v32 offset:0
    v_mfma_f32_16x16x32_bf16 v[44:47], v[68:71], v[108:111], v[44:47]
    v_mfma_f32_16x16x32_bf16 v[44:47], v[72:75], v[104:107], v[44:47]
    ds_read2_b32 v[136:137], v21 offset0:240 offset1:241
    v_mfma_f32_16x16x32_bf16 v[44:47], v[76:79], v[100:103], v[44:47]
    ds_read2_b32 v[138:139], v21 offset0:242 offset1:243
    s_waitcnt lgkmcnt(14)
    v_mfma_f32_16x16x32_bf16 v[48:51], v[80:83], v[100:103], v[48:51]
    ds_read_b128 v[168:171], v32 offset:2048
    v_mfma_f32_16x16x32_bf16 v[48:51], v[76:79], v[104:107], v[48:51]
    v_mfma_f32_16x16x32_bf16 v[48:51], v[72:75], v[108:111], v[48:51]
    ds_read2_b32 v[140:141], v22 offset0:112 offset1:113
    v_mfma_f32_16x16x32_bf16 v[48:51], v[68:71], v[112:115], v[48:51]
    ds_read2_b32 v[142:143], v22 offset0:114 offset1:115
    v_mfma_f32_16x16x32_bf16 v[52:55], v[68:71], v[116:119], v[52:55]
    ds_read_b128 v[172:175], v32 offset:4096
    v_mfma_f32_16x16x32_bf16 v[52:55], v[72:75], v[112:115], v[52:55]
    v_mfma_f32_16x16x32_bf16 v[52:55], v[76:79], v[108:111], v[52:55]
    ds_read2_b32 v[144:145], v22 offset0:240 offset1:241
    v_mfma_f32_16x16x32_bf16 v[52:55], v[80:83], v[104:107], v[52:55]
    ds_read2_b32 v[146:147], v22 offset0:242 offset1:243
    v_mfma_f32_16x16x32_bf16 v[52:55], v[84:87], v[100:103], v[52:55]
    ds_read_b128 v[176:179], v32 offset:6144
    s_waitcnt lgkmcnt(14)
    v_mfma_f32_16x16x32_bf16 v[56:59], v[88:91], v[100:103], v[56:59]
    v_mfma_f32_16x16x32_bf16 v[56:59], v[84:87], v[104:107], v[56:59]
    ds_read2_b32 v[148:149], v23 offset0:112 offset1:113
    v_mfma_f32_16x16x32_bf16 v[56:59], v[80:83], v[108:111], v[56:59]
    ds_read2_b32 v[150:151], v23 offset0:114 offset1:115
    v_mfma_f32_16x16x32_bf16 v[56:59], v[76:79], v[112:115], v[56:59]
    ds_read_b128 v[180:183], v32 offset:8192
    v_mfma_f32_16x16x32_bf16 v[56:59], v[72:75], v[116:119], v[56:59]
    v_mfma_f32_16x16x32_bf16 v[56:59], v[68:71], v[120:123], v[56:59]
    ds_read2_b32 v[152:153], v23 offset0:240 offset1:241
    v_mfma_f32_16x16x32_bf16 v[60:63], v[68:71], v[124:127], v[60:63]
    ds_read2_b32 v[154:155], v23 offset0:242 offset1:243
    v_mfma_f32_16x16x32_bf16 v[60:63], v[72:75], v[120:123], v[60:63]
    ds_read_b128 v[184:187], v32 offset:10240
    v_mfma_f32_16x16x32_bf16 v[60:63], v[76:79], v[116:119], v[60:63]
    v_mfma_f32_16x16x32_bf16 v[60:63], v[80:83], v[112:115], v[60:63]
    ds_read2_b32 v[156:157], v24 offset0:112 offset1:113
    v_mfma_f32_16x16x32_bf16 v[60:63], v[84:87], v[108:111], v[60:63]
    ds_read2_b32 v[158:159], v24 offset0:114 offset1:115
    v_mfma_f32_16x16x32_bf16 v[60:63], v[88:91], v[104:107], v[60:63]
    ds_read_b128 v[188:191], v32 offset:12288
    v_mfma_f32_16x16x32_bf16 v[60:63], v[92:95], v[100:103], v[60:63]
    s_waitcnt lgkmcnt(14)
    v_mfma_f32_16x16x32_bf16 v[64:67], v[96:99], v[100:103], v[64:67]
    ds_read2_b32 v[160:161], v24 offset0:240 offset1:241
    v_mfma_f32_16x16x32_bf16 v[64:67], v[92:95], v[104:107], v[64:67]
    ds_read2_b32 v[162:163], v24 offset0:242 offset1:243
    v_mfma_f32_16x16x32_bf16 v[64:67], v[88:91], v[108:111], v[64:67]
    ds_read_b128 v[192:195], v32 offset:14336
    v_mfma_f32_16x16x32_bf16 v[64:67], v[84:87], v[112:115], v[64:67]
    v_mfma_f32_16x16x32_bf16 v[64:67], v[80:83], v[116:119], v[64:67]
    v_mfma_f32_16x16x32_bf16 v[64:67], v[76:79], v[120:123], v[64:67]
    v_mfma_f32_16x16x32_bf16 v[64:67], v[72:75], v[124:127], v[64:67]
    v_mfma_f32_16x16x32_bf16 v[64:67], v[68:71], v[128:131], v[64:67]
    v_mfma_f32_16x16x32_bf16 v[36:39], v[132:135], v[164:167], v[36:39]
    v_mfma_f32_16x16x32_bf16 v[40:43], v[136:139], v[164:167], v[40:43]
    v_mfma_f32_16x16x32_bf16 v[40:43], v[132:135], v[168:171], v[40:43]
    s_waitcnt lgkmcnt(14)
    v_mfma_f32_16x16x32_bf16 v[44:47], v[132:135], v[172:175], v[44:47]
    v_mfma_f32_16x16x32_bf16 v[44:47], v[136:139], v[168:171], v[44:47]
    v_mfma_f32_16x16x32_bf16 v[44:47], v[140:143], v[164:167], v[44:47]
    s_waitcnt lgkmcnt(13)
    v_mfma_f32_16x16x32_bf16 v[48:51], v[144:147], v[164:167], v[48:51]
    v_mfma_f32_16x16x32_bf16 v[48:51], v[140:143], v[168:171], v[48:51]
    s_waitcnt lgkmcnt(0)
    v_cvt_pk_bf16_f32 v68, v39, v38
    v_cvt_pk_bf16_f32 v69, v37, v36
    v_mfma_f32_16x16x32_bf16 v[48:51], v[136:139], v[172:175], v[48:51]
    ds_write_b64 v20, v[68:69] offset:0
    v_cvt_pk_bf16_f32 v70, v43, v42
    v_mfma_f32_16x16x32_bf16 v[48:51], v[132:135], v[176:179], v[48:51]
    v_cvt_pk_bf16_f32 v71, v41, v40
    ds_write_b64 v20, v[70:71] offset:2048
    v_mfma_f32_16x16x32_bf16 v[52:55], v[132:135], v[180:183], v[52:55]
    v_mfma_f32_16x16x32_bf16 v[52:55], v[136:139], v[176:179], v[52:55]
    v_cvt_pk_bf16_f32 v72, v47, v46
    v_cvt_pk_bf16_f32 v73, v45, v44
    v_mfma_f32_16x16x32_bf16 v[52:55], v[140:143], v[172:175], v[52:55]
    ds_write_b64 v20, v[72:73] offset:4096
    v_mfma_f32_16x16x32_bf16 v[52:55], v[144:147], v[168:171], v[52:55]
    v_mfma_f32_16x16x32_bf16 v[52:55], v[148:151], v[164:167], v[52:55]
    v_mfma_f32_16x16x32_bf16 v[56:59], v[152:155], v[164:167], v[56:59]
    v_cvt_pk_bf16_f32 v74, v51, v50
    v_cvt_pk_bf16_f32 v75, v49, v48
    v_mfma_f32_16x16x32_bf16 v[56:59], v[148:151], v[168:171], v[56:59]
    ds_write_b64 v20, v[74:75] offset:6144
    v_mfma_f32_16x16x32_bf16 v[56:59], v[144:147], v[172:175], v[56:59]
    v_mfma_f32_16x16x32_bf16 v[56:59], v[140:143], v[176:179], v[56:59]
    v_mfma_f32_16x16x32_bf16 v[56:59], v[136:139], v[180:183], v[56:59]
    v_mfma_f32_16x16x32_bf16 v[56:59], v[132:135], v[184:187], v[56:59]
    v_cvt_pk_bf16_f32 v76, v55, v54
    v_cvt_pk_bf16_f32 v77, v53, v52
    v_mfma_f32_16x16x32_bf16 v[60:63], v[132:135], v[188:191], v[60:63]
    ds_write_b64 v20, v[76:77] offset:8192
    v_mfma_f32_16x16x32_bf16 v[60:63], v[136:139], v[184:187], v[60:63]
    v_mfma_f32_16x16x32_bf16 v[60:63], v[140:143], v[180:183], v[60:63]
    v_mfma_f32_16x16x32_bf16 v[60:63], v[144:147], v[176:179], v[60:63]
    v_mfma_f32_16x16x32_bf16 v[60:63], v[148:151], v[172:175], v[60:63]
    v_mfma_f32_16x16x32_bf16 v[60:63], v[152:155], v[168:171], v[60:63]
    v_cvt_pk_bf16_f32 v78, v59, v58
    v_cvt_pk_bf16_f32 v79, v57, v56
    v_mfma_f32_16x16x32_bf16 v[60:63], v[156:159], v[164:167], v[60:63]
    ds_write_b64 v20, v[78:79] offset:10240
    v_mfma_f32_16x16x32_bf16 v[64:67], v[160:163], v[164:167], v[64:67]
    v_mfma_f32_16x16x32_bf16 v[64:67], v[156:159], v[168:171], v[64:67]
    v_mfma_f32_16x16x32_bf16 v[64:67], v[152:155], v[172:175], v[64:67]
    v_mfma_f32_16x16x32_bf16 v[64:67], v[148:151], v[176:179], v[64:67]
    v_mfma_f32_16x16x32_bf16 v[64:67], v[144:147], v[180:183], v[64:67]
    v_mfma_f32_16x16x32_bf16 v[64:67], v[140:143], v[184:187], v[64:67]
    s_nop 0
    v_cvt_pk_bf16_f32 v80, v63, v62
    v_cvt_pk_bf16_f32 v81, v61, v60
    v_mfma_f32_16x16x32_bf16 v[64:67], v[136:139], v[188:191], v[64:67]
    ds_write_b64 v20, v[80:81] offset:12288
    v_mfma_f32_16x16x32_bf16 v[64:67], v[132:135], v[192:195], v[64:67]
    s_nop 7
    v_cvt_pk_bf16_f32 v82, v67, v66
    v_cvt_pk_bf16_f32 v83, v65, v64
    ds_write_b64 v20, v[82:83] offset:14336
    s_mov_b64 exec, 1
    ds_add_u32 v18, v19 offset:12
    s_mov_b64 exec, -1
    s_add_u32 s80, s86, 94208
    v_add_u32 v5, s80, v15
    s_branch LA_s3_in
LA_s3:
    s_sleep 1
LA_s3_in:
    ds_read_b32 v6, v18 offset:12
    ds_read_b128 v[84:87], v5 offset:0
    ds_read_b128 v[88:91], v5 offset:4096
    ds_read_b128 v[92:95], v5 offset:8192
    ds_read_b128 v[96:99], v5 offset:12288
    s_waitcnt lgkmcnt(0)
    v_readfirstlane_b32 s78, v6
    s_nop 0
    s_cmp_ge_u32 s78, 4
    s_cbranch_scc0 LA_s3
    s_add_u32 s89, s91, 4194304
    buffer_store_dwordx4 v[84:87], v14, s[52:55], s89 offen sc1
    s_add_u32 s89, s91, 4198400
    buffer_store_dwordx4 v[88:91], v14, s[52:55], s89 offen sc1
    s_add_u32 s89, s91, 4202496
    buffer_store_dwordx4 v[92:95], v14, s[52:55], s89 offen sc1
    s_add_u32 s89, s91, 4206592
    buffer_store_dwordx4 v[96:99], v14, s[52:55], s89 offen sc1
    s_add_u32 s80, s86, 129024
    v_add_u32 v5, s80, v15
    s_waitcnt vmcnt(9)
    ds_write_b128 v5, v[228:231] offset:0
    s_waitcnt vmcnt(8)
    ds_write_b128 v5, v[232:235] offset:4096
    s_waitcnt vmcnt(7)
    ds_write_b128 v5, v[240:243] offset:8192
    s_waitcnt vmcnt(6)
    ds_write_b128 v5, v[244:247] offset:12288
    s_waitcnt vmcnt(5)
    ds_write_b128 v5, v[248:251] offset:16384
    s_waitcnt vmcnt(4)
    ds_write_b128 v5, v[196:199] offset:20480
    s_mov_b64 exec, 1
    ds_add_u32 v18, v19 offset:32
    s_mov_b64 exec, -1
    s_setprio 0
    s_mov_b32 s60, s22
    s_mov_b32 s61, s23
    s_mov_b32 s62, 0x800000
    s_mov_b32 s63, 0x20000
    s_lshr_b32 s81, s91, 4
    s_lshl_b32 s82, s3, 8
    s_add_u32 s81, s81, s82
    s_add_u32 s81, s81, 12648448
    s_lshl_b32 s80, s74, 14
    s_and_b32 s82, s75, 3
    s_lshl_b32 s82, s82, 8
    s_add_u32 s80, s80, s82
    s_add_u32 s80, s80, 12648448
    v_mov_b32 v5, 0
    v_lshlrev_b32 v7, 10, v0
    v_lshlrev_b32 v132, 16, v212
    v_and_b32 v133, 0xffff0000, v212
    v_lshlrev_b32 v134, 16, v213
    v_and_b32 v135, 0xffff0000, v213
    v_lshlrev_b32 v136, 16, v214
    v_and_b32 v137, 0xffff0000, v214
    v_lshlrev_b32 v138, 16, v215
    v_and_b32 v139, 0xffff0000, v215
    v_lshlrev_b32 v140, 16, v216
    v_and_b32 v141, 0xffff0000, v216
    v_lshlrev_b32 v142, 16, v217
    v_and_b32 v143, 0xffff0000, v217
    v_lshlrev_b32 v144, 16, v218
    v_and_b32 v145, 0xffff0000, v218
    v_lshlrev_b32 v146, 16, v219
    v_and_b32 v147, 0xffff0000, v219
    v_lshlrev_b32 v148, 16, v220
    v_and_b32 v149, 0xffff0000, v220
    v_lshlrev_b32 v150, 16, v221
    v_and_b32 v151, 0xffff0000, v221
    v_lshlrev_b32 v152, 16, v222
    v_and_b32 v153, 0xffff0000, v222
    v_lshlrev_b32 v154, 16, v223
    v_and_b32 v155, 0xffff0000, v223
    v_lshlrev_b32 v156, 16, v224
    v_and_b32 v157, 0xffff0000, v224
    v_lshlrev_b32 v158, 16, v225
    v_and_b32 v159, 0xffff0000, v225
    v_lshlrev_b32 v160, 16, v226
    v_and_b32 v161, 0xffff0000, v226
    v_lshlrev_b32 v162, 16, v227
    v_and_b32 v163, 0xffff0000, v227
    s_waitcnt vmcnt(0)
    s_mov_b64 exec, 1
    buffer_store_dword v19, v5, s[52:55], s81 offen sc1
    s_mov_b64 exec, 0xffff
    s_waitcnt vmcnt(0)
    s_branch LA_s7a_in
LA_s7a:
    s_sleep 1
LA_s7a_in:
    ds_read_b32 v6, v18 offset:28
    s_waitcnt lgkmcnt(0)
    v_readfirstlane_b32 s78, v6
    s_nop 0
    s_cmp_ge_u32 s78, 4
    s_cbranch_scc0 LA_s7a
    s_setprio 2
    s_mov_b32 s79, 0
LA_py:
    buffer_load_dword v6, v7, s[52:55], s80 offen sc1
    s_add_u32 s79, s79, 1
    s_cmp_gt_u32 s79, 200000
    s_cbranch_scc1 LA_py_x
    s_waitcnt vmcnt(0)
    v_cmp_ne_u32 vcc, 1, v6
    s_cbranch_vccz LA_py_x
    s_mov_b64 exec, vcc
    s_sleep 8
    s_branch LA_py
LA_py_x:
    s_waitcnt vmcnt(0)
    s_mov_b64 exec, -1
    s_mov_b32 s89, 4194304
    buffer_load_dwordx4 v[100:103], v12, s[52:55], s89 offen sc1
    s_mov_b32 s89, 4210688
    buffer_load_dwordx4 v[104:107], v12, s[52:55], s89 offen sc1
    s_mov_b32 s89, 4227072
    buffer_load_dwordx4 v[108:111], v12, s[52:55], s89 offen sc1
    s_mov_b32 s89, 4243456
    buffer_load_dwordx4 v[112:115], v12, s[52:55], s89 offen sc1
    s_waitcnt vmcnt(3)
    v_permlane32_swap_b32 v102, v100
    v_permlane32_swap_b32 v103, v101
    s_waitcnt vmcnt(2)
    v_permlane32_swap_b32 v106, v104
    v_permlane32_swap_b32 v107, v105
    s_waitcnt vmcnt(1)
    v_permlane32_swap_b32 v110, v108
    v_permlane32_swap_b32 v111, v109
    s_waitcnt vmcnt(0)
    v_permlane32_swap_b32 v114, v112
    v_permlane32_swap_b32 v115, v113
    v_and_b32 v68, 0xffff0000, v103
    v_and_b32 v69, 0xffff0000, v107
    v_and_b32 v70, 0xffff0000, v111
    v_and_b32 v71, 0xffff0000, v115
    v_and_b32 v72, 0xffff0000, v101
    v_and_b32 v73, 0xffff0000, v105
    v_and_b32 v74, 0xffff0000, v109
    v_and_b32 v75, 0xffff0000, v113
    v_mul_f32 v68, v68, v132
    v_mul_f32 v69, v69, v133
    v_mul_f32 v70, v70, v134
    v_mul_f32 v71, v71, v135
    v_mul_f32 v72, v72, v136
    v_mul_f32 v73, v73, v137
    v_mul_f32 v74, v74, v138
    v_mul_f32 v75, v75, v139
    v_cvt_pk_bf16_f32 v36, v68, v69
    v_cvt_pk_bf16_f32 v37, v70, v71
    v_cvt_pk_bf16_f32 v38, v72, v73
    v_cvt_pk_bf16_f32 v39, v74, v75
    s_mov_b32 s89, 0
    buffer_store_dwordx4 v[36:39], v13, s[60:63], s89 offen nt sc1
    v_lshlrev_b32 v68, 16, v103
    v_lshlrev_b32 v69, 16, v107
    v_lshlrev_b32 v70, 16, v111
    v_lshlrev_b32 v71, 16, v115
    v_lshlrev_b32 v72, 16, v101
    v_lshlrev_b32 v73, 16, v105
    v_lshlrev_b32 v74, 16, v109
    v_lshlrev_b32 v75, 16, v113
    v_mul_f32 v68, v68, v140
    v_mul_f32 v69, v69, v141
    v_mul_f32 v70, v70, v142
    v_mul_f32 v71, v71, v143
    v_mul_f32 v72, v72, v144
    v_mul_f32 v73, v73, v145
    v_mul_f32 v74, v74, v146
    v_mul_f32 v75, v75, v147
    v_cvt_pk_bf16_f32 v40, v68, v69
    v_cvt_pk_bf16_f32 v41, v70, v71
    v_cvt_pk_bf16_f32 v42, v72, v73
    v_cvt_pk_bf16_f32 v43, v74, v75
    s_mov_b32 s89, 4096
    buffer_store_dwordx4 v[40:43], v13, s[60:63], s89 offen nt sc1
    v_and_b32 v68, 0xffff0000, v102
    v_and_b32 v69, 0xffff0000, v106
    v_and_b32 v70, 0xffff0000, v110
    v_and_b32 v71, 0xffff0000, v114
    v_and_b32 v72, 0xffff0000, v100
    v_and_b32 v73, 0xffff0000, v104
    v_and_b32 v74, 0xffff0000, v108
    v_and_b32 v75, 0xffff0000, v112
    v_mul_f32 v68, v68, v148
    v_mul_f32 v69, v69, v149
    v_mul_f32 v70, v70, v150
    v_mul_f32 v71, v71, v151
    v_mul_f32 v72, v72, v152
    v_mul_f32 v73, v73, v153
    v_mul_f32 v74, v74, v154
    v_mul_f32 v75, v75, v155
    v_cvt_pk_bf16_f32 v44, v68, v69
    v_cvt_pk_bf16_f32 v45, v70, v71
    v_cvt_pk_bf16_f32 v46, v72, v73
    v_cvt_pk_bf16_f32 v47, v74, v75
    s_mov_b32 s89, 8192
    buffer_store_dwordx4 v[44:47], v13, s[60:63], s89 offen nt sc1
    v_lshlrev_b32 v68, 16, v102
    v_lshlrev_b32 v69, 16, v106
    v_lshlrev_b32 v70, 16, v110
    v_lshlrev_b32 v71, 16, v114
    v_lshlrev_b32 v72, 16, v100
    v_lshlrev_b32 v73, 16, v104
    v_lshlrev_b32 v74, 16, v108
    v_lshlrev_b32 v75, 16, v112
    v_mul_f32 v68, v68, v156
    v_mul_f32 v69, v69, v157
    v_mul_f32 v70, v70, v158
    v_mul_f32 v71, v71, v159
    v_mul_f32 v72, v72, v160
    v_mul_f32 v73, v73, v161
    v_mul_f32 v74, v74, v162
    v_mul_f32 v75, v75, v163
    v_cvt_pk_bf16_f32 v48, v68, v69
    v_cvt_pk_bf16_f32 v49, v70, v71
    v_cvt_pk_bf16_f32 v50, v72, v73
    v_cvt_pk_bf16_f32 v51, v74, v75
    s_mov_b32 s89, 12288
    buffer_store_dwordx4 v[48:51], v13, s[60:63], s89 offen nt sc1
    s_endpgm
L_B:
    s_setprio 3
    s_and_b32 s3, s3, 3
    s_add_u32 s79, s72, s73
    s_add_u32 s78, s72, 5
    s_and_b32 s78, s78, 7
    s_lshl_b32 s78, s78, 1
    s_and_b32 s75, s79, 1
    s_add_u32 s78, s78, s75
    s_andn2_b32 s79, 2, s79
    s_lshl_b32 s79, s79, 3
    s_add_u32 s78, s78, s79
    s_and_b32 s76, s78, 3
    s_and_b32 s79, s73, 12
    s_add_u32 s76, s76, s79
    s_lshr_b32 s74, s78, 4
    s_add_u32 s74, s74, s79
    s_and_b32 s79, s72, 8
    s_lshr_b32 s77, s78, 2
    s_add_u32 s77, s77, s79
    s_lshr_b32 s79, s79, 2
    s_add_u32 s74, s74, s79
    s_xor_b32 s74, s74, 4
    s_and_b32 s75, s78, 15
    s_lshr_b32 s86, s3, 1
    s_and_b32 s87, s3, 1
    v_mov_b32 v10, 162304
    v_mov_b32 v11, 1
    v_lshlrev_b32 v12, 4, v0
    v_lshl_add_u32 v13, v0, 2, v10
    v_mov_b32 v14, 0
    ds_write_b32 v13, v14
    s_lshl_b32 s78, s74, 4
    s_add_u32 s78, s78, s75
    s_lshl_b32 s96, s78, 8
    s_add_u32 s96, s96, 12582912
    s_lshl_b32 s78, s78, 2
    s_add_u32 s78, s78, s3
    s_lshl_b32 s78, s78, 8
    s_add_u32 s80, s78, 12648448
    s_lshl_b32 s81, s72, 1
    s_add_u32 s81, s81, s86
    s_lshl_b32 s97, s81, 4
    s_add_u32 s97, s97, s73
    s_lshl_b32 s97, s97, 8
    s_add_u32 s97, s97, 12910464
    v_mov_b32 v15, s80
    v_mov_b32 v223, s97
    v_cmp_gt_u32 vcc, 8, v0
    s_nop 1
    v_cndmask_b32 v15, v223, v15, vcc
    v_add_u32 v221, v15, v12
    s_lshl_b32 s78, s87, 2
    s_add_u32 s78, s78, 128
    s_add_u32 s97, s97, s78
    s_lshl_b32 s82, s73, 1
    s_add_u32 s82, s82, s87
    s_lshl_b32 s78, s81, 7
    s_add_u32 s78, s78, s82
    s_lshl_b32 s94, s78, 10
    s_add_u32 s94, s94, 16777216
    v_mov_b32 v212, 0
    v_mov_b32 v213, 0
    v_mov_b32 v214, 0
    v_mov_b32 v215, 0
    v_mov_b32 v220, 0
    s_waitcnt lgkmcnt(0)
    s_mov_b32 s52, s26
    s_mov_b32 s53, s27
    s_mov_b32 s54, 0x1800000
    s_mov_b32 s55, 0x20000
    s_mov_b32 s68, s24
    s_mov_b32 s69, s25
    s_mov_b32 s70, 0x100
    s_mov_b32 s71, 0x20000
    s_lshl_b32 s98, s74, 4
    s_or_b32 s78, s75, s3
    s_cmp_lg_u32 s78, 0
    s_cbranch_scc1 LB_notag
    s_mov_b64 exec, 0xffff
    v_lshlrev_b32 v15, 8, v0
    buffer_load_dword v251, v15, s[52:55], s96 offen sc1
LB_notag:
    s_lshl_b32 s78, s87, 3
    s_lshr_b32 exec_lo, 0xffff, s78
    s_mov_b32 exec_hi, 0
    buffer_store_dwordx4 v[212:215], v221, s[52:55], 0 offen sc1
    s_mov_b64 exec, -1
    v_and_b32 v13, 15, v0
    v_lshrrev_b32 v14, 4, v0
    v_lshrrev_b32 v15, 1, v13
    v_xor_b32 v15, v15, v14
    v_lshlrev_b32 v15, 4, v15
    v_lshl_add_u32 v15, v13, 7, v15
    v_add_u32 v2, 73728, v15
    v_xor_b32 v3, 64, v2
    s_lshl_b32 s78, s86, 13
    s_add_u32 s78, s78, 2048
    v_add_u32 v4, s78, v2
    v_add_u32 v5, s78, v3
    v_bfe_u32 v15, v0, 3, 2
    s_lshl_b32 s78, s87, 1
    s_add_u32 s78, s78, s86
    v_xor_b32 v15, s78, v15
    v_lshlrev_b32 v15, 5, v15
    v_and_b32 v223, 3, v0
    v_lshl_add_u32 v15, v223, 3, v15
    v_bfe_u32 v223, v0, 2, 2
    v_lshl_add_u32 v15, v223, 7, v15
    v_mul_u32_u24 v223, 3072, v14
    v_add_u32 v6, v223, v15
    v_xor_b32 v7, 32, v6
    s_mov_b32 s60, s22
    s_mov_b32 s61, s23
    s_mov_b32 s62, 0x800000
    s_mov_b32 s63, 0x20000
    v_and_b32 v15, 1, v13
    v_cmp_eq_u32 s[88:89], 1, v15
    v_lshl_add_u32 v15, v14, 2, v15
    v_cmp_le_u32 s[90:91], v15, v13
    v_add_u32 v15, 2, v15
    v_cmp_le_u32 s[92:93], v15, v13
    v_mov_b32 v212, 0x0c0c0c0c
    v_mov_b32 v15, 0xc0c0100
    v_mov_b32 v223, 0x1000c0c
    v_cndmask_b32 v15, v15, v223, s[88:89]
    v_cndmask_b32 v208, v15, v212, s[90:91]
    v_cndmask_b32 v210, v212, v15, s[90:91]
    v_mov_b32 v15, 0xc0c0302
    v_mov_b32 v223, 0x3020c0c
    v_cndmask_b32 v15, v15, v223, s[88:89]
    v_cndmask_b32 v209, v15, v212, s[92:93]
    v_cndmask_b32 v211, v212, v15, s[92:93]
    s_or_b32 s78, s72, s86
    s_cmp_eq_u32 s78, 0
    s_cselect_b32 s78, 0xf149f2ca, 0
    v_mov_b32 v212, s78
    v_mov_b32 v213, s78
    v_mov_b32 v214, s78
    v_mov_b32 v215, s78
    s_lshl_b32 s78, s87, 12
    s_add_u32 s78, s78, 24576
    s_lshl_b32 s79, s86, 9
    s_add_u32 s79, s79, s78
    v_lshlrev_b32 v15, 3, v0
    v_add_u32 v216, s79, v15
    s_lshl_b32 s80, s86, 11
    v_add_u32 v218, s80, v216
    v_xor_b32 v219, 512, v218
    s_add_u32 s78, s78, 2048
    s_cmp_eq_u32 s86, 0
    s_cselect_b32 s78, s78, 32768
    v_add_u32 v217, s78, v15
    v_bfe_u32 v14, v0, 3, 2
    v_lshlrev_b32 v14, 5, v14
    v_and_b32 v15, 3, v0
    v_lshl_add_u32 v14, v15, 3, v14
    v_lshrrev_b32 v15, 2, v0
    v_lshl_add_u32 v14, v15, 7, v14
    s_lshl_b32 s78, s86, 11
    v_add_u32 v244, s78, v14
    s_mov_b32 s64, s20
    s_mov_b32 s65, s21
    s_mov_b32 s66, 0x200000
    s_mov_b32 s67, 0x20000
    v_lshrrev_b32 v14, 4, v0
    v_lshlrev_b32 v14, 1, v14
    v_and_b32 v15, 7, v0
    v_xor_b32 v14, v14, v15
    v_lshlrev_b32 v14, 4, v14
    v_lshrrev_b32 v15, 3, v0
    v_lshl_add_u32 v14, v15, 11, v14
    s_lshl_b32 s78, s77, 7
    s_lshl_b32 s79, s3, 14
    s_add_u32 s78, s78, s79
    v_add_u32 v245, s78, v14
    v_and_b32 v14, 15, v0
    s_lshl_b32 s78, s76, 2
    s_add_u32 s78, s78, s3
    s_lshl_b32 s79, s78, 5
    v_add_u32 v14, s79, v14
    v_lshlrev_b32 v14, 12, v14
    v_bfe_u32 v15, v0, 4, 1
    v_lshl_add_u32 v14, v15, 5, v14
    v_lshrrev_b32 v15, 5, v0
    v_lshl_add_u32 v14, v15, 4, v14
    s_lshl_b32 s79, s77, 7
    s_add_u32 s79, s79, 2048
    v_add_u32 v246, s79, v14
    s_lshl_b32 s28, s78, 16
    s_add_u32 s28, s28, 16777216
    s_lshl_b32 s30, s76, 1
    s_add_u32 s30, s30, s86
    s_lshl_b32 s30, s30, 12
    s_add_u32 s30, s30, 12910592
    v_lshrrev_b32 v15, 1, v0
    v_lshlrev_b32 v15, 8, v15
    v_and_b32 v14, 1, v0
    v_lshl_add_u32 v247, v14, 2, v15
    s_and_b32 s78, s77, 7
    s_mov_b32 s79, 0x76543210
    s_and_b32 s78, s76, 3
    s_mul_i32 s78, s78, 0x22222222
    s_add_u32 s79, s79, s78
    s_bfe_u32 s78, s79, 0x30000
    s_lshl_b32 s44, s78, 18
    s_lshl_b32 s78, s78, 12
    s_add_u32 s36, s78, s28
    s_bfe_u32 s78, s79, 0x30004
    s_lshl_b32 s45, s78, 18
    s_lshl_b32 s78, s78, 12
    s_add_u32 s37, s78, s28
    s_bfe_u32 s78, s79, 0x30008
    s_lshl_b32 s46, s78, 18
    s_lshl_b32 s78, s78, 12
    s_add_u32 s38, s78, s28
    s_bfe_u32 s78, s79, 0x3000c
    s_lshl_b32 s47, s78, 18
    s_lshl_b32 s78, s78, 12
    s_add_u32 s39, s78, s28
    s_bfe_u32 s78, s79, 0x30010
    s_lshl_b32 s48, s78, 18
    s_lshl_b32 s78, s78, 12
    s_add_u32 s40, s78, s28
    s_bfe_u32 s78, s79, 0x30014
    s_lshl_b32 s49, s78, 18
    s_lshl_b32 s78, s78, 12
    s_add_u32 s41, s78, s28
    s_bfe_u32 s78, s79, 0x30018
    s_lshl_b32 s50, s78, 18
    s_lshl_b32 s78, s78, 12
    s_add_u32 s42, s78, s28
    s_bfe_u32 s78, s79, 0x3001c
    s_lshl_b32 s51, s78, 18
    s_lshl_b32 s78, s78, 12
    s_add_u32 s43, s78, s28
    s_lshl_b32 s34, s3, 10
    v_mov_b32 v252, v12
    v_bfe_u32 v14, v0, 4, 1
    v_lshrrev_b32 v15, 5, v0
    v_lshl_add_u32 v14, v14, 1, v15
    v_and_b32 v15, 7, v0
    v_xor_b32 v14, v14, v15
    v_lshlrev_b32 v14, 4, v14
    v_and_b32 v223, 15, v0
    v_lshl_add_u32 v14, v223, 7, v14
    s_lshl_b32 s78, s3, 12
    v_add_u32 v248, s78, v14
    v_xor_b32 v249, 64, v248
    v_add_u32 v250, s78, v12
    v_lshrrev_b32 v14, 3, v0
    v_xor_b32 v15, v15, v14
    v_lshlrev_b32 v15, 4, v15
    v_lshl_add_u32 v14, v14, 12, v15
    s_lshl_b32 s78, s76, 2
    s_add_u32 s78, s78, s3
    s_lshl_b32 s78, s78, 17
    s_lshl_b32 s79, s77, 7
    s_add_u32 s78, s78, s79
    s_add_u32 s78, s78, 2048
    v_add_u32 v246, s78, v14
    s_waitcnt lgkmcnt(0)
    s_barrier
    ds_read_b64_tr_b16 v[200:201], v6 offset:1024
    ds_read_b64_tr_b16 v[202:203], v6 offset:1536
    ds_read_b64_tr_b16 v[204:205], v6 offset:13312
    ds_read_b64_tr_b16 v[206:207], v6 offset:13824
    ds_read_b128 v[152:155], v2 offset:0
    ds_read_b128 v[156:159], v3 offset:0
    ds_read_b128 v[144:147], v4 offset:6144
    ds_read_b128 v[148:151], v5 offset:6144
    ds_read_b128 v[136:139], v4 offset:4096
    ds_read_b128 v[140:143], v5 offset:4096
    ds_read_b128 v[128:131], v4 offset:2048
    ds_read_b128 v[132:135], v5 offset:2048
    ds_read_b128 v[120:123], v4 offset:0
    ds_read_b128 v[124:127], v5 offset:0
    ds_read_b64_tr_b16 v[224:225], v7 offset:1024
    ds_read_b64_tr_b16 v[226:227], v7 offset:1536
    ds_read_b64_tr_b16 v[228:229], v7 offset:13312
    ds_read_b64_tr_b16 v[230:231], v7 offset:13824
    s_waitcnt lgkmcnt(13)
    v_mfma_f32_16x16x32_bf16 v[112:115], v[200:203], v[152:155], 0
    ds_read_b64_tr_b16 v[232:233], v6 offset:0
    s_waitcnt lgkmcnt(13)
    v_mfma_f32_16x16x32_bf16 v[112:115], v[204:207], v[156:159], v[112:115]
    ds_read_b64_tr_b16 v[234:235], v6 offset:512
    s_waitcnt lgkmcnt(12)
    v_mfma_f32_16x16x32_bf16 v[72:75], v[204:207], v[148:151], 0
    ds_read_b64_tr_b16 v[236:237], v6 offset:12288
    v_mfma_f32_16x16x32_bf16 v[72:75], v[200:203], v[144:147], v[72:75]
    ds_read_b64_tr_b16 v[238:239], v6 offset:12800
    s_waitcnt lgkmcnt(13)
    v_mfma_f32_16x16x32_bf16 v[64:67], v[200:203], v[136:139], 0
    s_waitcnt lgkmcnt(12)
    v_mfma_f32_16x16x32_bf16 v[64:67], v[204:207], v[140:143], v[64:67]
    s_waitcnt lgkmcnt(10)
    v_mfma_f32_16x16x32_bf16 v[56:59], v[204:207], v[132:135], 0
    v_mfma_f32_16x16x32_bf16 v[56:59], v[200:203], v[128:131], v[56:59]
    s_waitcnt lgkmcnt(9)
    v_mfma_f32_16x16x32_bf16 v[48:51], v[200:203], v[120:123], 0
    s_waitcnt lgkmcnt(8)
    v_mfma_f32_16x16x32_bf16 v[48:51], v[204:207], v[124:127], v[48:51]
    s_waitcnt lgkmcnt(4)
    v_mfma_f32_16x16x32_bf16 v[52:55], v[228:231], v[124:127], 0
    ds_read_b64_tr_b16 v[200:201], v7 offset:0
    v_mfma_f32_16x16x32_bf16 v[52:55], v[224:227], v[120:123], v[52:55]
    ds_read_b64_tr_b16 v[202:203], v7 offset:512
    v_mfma_f32_16x16x32_bf16 v[60:63], v[224:227], v[128:131], 0
    ds_read_b64_tr_b16 v[204:205], v7 offset:12288
    v_mfma_f32_16x16x32_bf16 v[60:63], v[228:231], v[132:135], v[60:63]
    ds_read_b64_tr_b16 v[206:207], v7 offset:12800
    v_mfma_f32_16x16x32_bf16 v[68:71], v[228:231], v[140:143], 0
    v_mfma_f32_16x16x32_bf16 v[68:71], v[224:227], v[136:139], v[68:71]
    v_mfma_f32_16x16x32_bf16 v[76:79], v[224:227], v[144:147], 0
    v_mfma_f32_16x16x32_bf16 v[76:79], v[228:231], v[148:151], v[76:79]
    s_barrier
    s_waitcnt lgkmcnt(4)
    v_mfma_f32_16x16x32_bf16 v[40:43], v[236:239], v[148:151], 0
    ds_read_b64_tr_b16 v[224:225], v6 offset:2048
    ds_read_b64_tr_b16 v[226:227], v6 offset:2560
    v_mfma_f32_16x16x32_bf16 v[40:43], v[232:235], v[144:147], v[40:43]
    ds_read_b64_tr_b16 v[228:229], v6 offset:14336
    ds_read_b64_tr_b16 v[230:231], v6 offset:14848
    v_mfma_f32_16x16x32_bf16 v[32:35], v[232:235], v[136:139], 0
    ds_read_b128 v[192:195], v2 offset:18432
    ds_read_b128 v[196:199], v3 offset:18432
    v_mfma_f32_16x16x32_bf16 v[32:35], v[236:239], v[140:143], v[32:35]
    ds_read_b128 v[184:187], v4 offset:24576
    ds_read_b128 v[188:191], v5 offset:24576
    v_mfma_f32_16x16x32_bf16 v[24:27], v[236:239], v[132:135], 0
    ds_read_b128 v[176:179], v4 offset:22528
    v_mfma_f32_16x16x32_bf16 v[24:27], v[232:235], v[128:131], v[24:27]
    v_mfma_f32_16x16x32_bf16 v[16:19], v[232:235], v[120:123], 0
    v_mfma_f32_16x16x32_bf16 v[16:19], v[236:239], v[124:127], v[16:19]
    s_waitcnt lgkmcnt(9)
    v_mfma_f32_16x16x32_bf16 v[20:23], v[204:207], v[124:127], 0
    ds_read_b64_tr_b16 v[232:233], v7 offset:2048
    ds_read_b64_tr_b16 v[234:235], v7 offset:2560
    v_mfma_f32_16x16x32_bf16 v[20:23], v[200:203], v[120:123], v[20:23]
    ds_read_b64_tr_b16 v[236:237], v7 offset:14336
    ds_read_b64_tr_b16 v[238:239], v7 offset:14848
    v_mfma_f32_16x16x32_bf16 v[28:31], v[200:203], v[128:131], 0
    ds_read_b128 v[180:183], v5 offset:22528
    ds_read_b128 v[168:171], v4 offset:20480
    v_mfma_f32_16x16x32_bf16 v[28:31], v[204:207], v[132:135], v[28:31]
    ds_read_b128 v[172:175], v5 offset:20480
    ds_read_b128 v[160:163], v4 offset:18432
    v_mfma_f32_16x16x32_bf16 v[36:39], v[204:207], v[140:143], 0
    ds_read_b128 v[164:167], v5 offset:18432
    v_mfma_f32_16x16x32_bf16 v[36:39], v[200:203], v[136:139], v[36:39]
    v_mfma_f32_16x16x32_bf16 v[44:47], v[200:203], v[144:147], 0
    v_mfma_f32_16x16x32_bf16 v[44:47], v[204:207], v[148:151], v[44:47]
    s_waitcnt lgkmcnt(14)
    v_mfma_f32_16x16x32_bf16 v[116:119], v[156:159], v[228:231], 0
    v_mfma_f32_16x16x32_bf16 v[116:119], v[152:155], v[224:227], v[116:119]
    v_mfma_f32_16x16x32_bf16 v[104:107], v[144:147], v[224:227], 0
    v_mfma_f32_16x16x32_bf16 v[104:107], v[148:151], v[228:231], v[104:107]
    v_mfma_f32_16x16x32_bf16 v[96:99], v[140:143], v[228:231], 0
    s_waitcnt vmcnt(0) lgkmcnt(0)
    s_barrier
    s_or_b32 s78, s75, s3
    s_cbranch_scc0 LB_tag
LB_tagb:
    v_mfma_f32_16x16x32_bf16 v[96:99], v[136:139], v[224:227], v[96:99]
    ds_read_b64_tr_b16 v[200:201], v6 offset:25600
    v_mfma_f32_16x16x32_bf16 v[88:91], v[128:131], v[224:227], 0
    ds_read_b64_tr_b16 v[202:203], v6 offset:26112
    v_mfma_f32_16x16x32_bf16 v[88:91], v[132:135], v[228:231], v[88:91]
    ds_read_b64_tr_b16 v[204:205], v6 offset:37888
    v_mfma_f32_16x16x32_bf16 v[80:83], v[124:127], v[228:231], 0
    ds_read_b64_tr_b16 v[206:207], v6 offset:38400
    v_mfma_f32_16x16x32_bf16 v[80:83], v[120:123], v[224:227], v[80:83]
    v_mfma_f32_16x16x32_bf16 v[84:87], v[120:123], v[232:235], 0
    ds_read_b64_tr_b16 v[224:225], v7 offset:25600
    v_mfma_f32_16x16x32_bf16 v[84:87], v[124:127], v[236:239], v[84:87]
    ds_read_b64_tr_b16 v[226:227], v7 offset:26112
    v_mfma_f32_16x16x32_bf16 v[92:95], v[132:135], v[236:239], 0
    ds_read_b64_tr_b16 v[228:229], v7 offset:37888
    v_mfma_f32_16x16x32_bf16 v[92:95], v[128:131], v[232:235], v[92:95]
    ds_read_b64_tr_b16 v[230:231], v7 offset:38400
    v_mfma_f32_16x16x32_bf16 v[100:103], v[136:139], v[232:235], 0
    v_mfma_f32_16x16x32_bf16 v[100:103], v[140:143], v[236:239], v[100:103]
    v_mfma_f32_16x16x32_bf16 v[108:111], v[148:151], v[236:239], 0
    v_mfma_f32_16x16x32_bf16 v[108:111], v[144:147], v[232:235], v[108:111]
    s_waitcnt lgkmcnt(4)
    v_mfma_f32_16x16x32_bf16 v[112:115], v[200:203], v[192:195], v[112:115]
    ds_read_b64_tr_b16 v[232:233], v6 offset:24576
    v_mfma_f32_16x16x32_bf16 v[112:115], v[204:207], v[196:199], v[112:115]
    ds_read_b64_tr_b16 v[234:235], v6 offset:25088
    v_mfma_f32_16x16x32_bf16 v[72:75], v[204:207], v[188:191], v[72:75]
    ds_read_b64_tr_b16 v[236:237], v6 offset:36864
    v_mfma_f32_16x16x32_bf16 v[72:75], v[200:203], v[184:187], v[72:75]
    ds_read_b64_tr_b16 v[238:239], v6 offset:37376
    v_mfma_f32_16x16x32_bf16 v[64:67], v[200:203], v[176:179], v[64:67]
    ds_read_b128 v[152:155], v2 offset:36864
    v_mfma_f32_16x16x32_bf16 v[64:67], v[204:207], v[180:183], v[64:67]
    ds_read_b128 v[156:159], v3 offset:36864
    v_mfma_f32_16x16x32_bf16 v[56:59], v[204:207], v[172:175], v[56:59]
    ds_read_b128 v[144:147], v4 offset:43008
    v_mfma_f32_16x16x32_bf16 v[56:59], v[200:203], v[168:171], v[56:59]
    ds_read_b128 v[148:151], v5 offset:43008
    v_mfma_f32_16x16x32_bf16 v[48:51], v[200:203], v[160:163], v[48:51]
    v_mfma_f32_16x16x32_bf16 v[48:51], v[204:207], v[164:167], v[48:51]
    s_waitcnt lgkmcnt(8)
    v_mfma_f32_16x16x32_bf16 v[52:55], v[228:231], v[164:167], v[52:55]
    ds_read_b64_tr_b16 v[200:201], v7 offset:24576
    v_mfma_f32_16x16x32_bf16 v[52:55], v[224:227], v[160:163], v[52:55]
    ds_read_b64_tr_b16 v[202:203], v7 offset:25088
    v_mfma_f32_16x16x32_bf16 v[60:63], v[224:227], v[168:171], v[60:63]
    ds_read_b64_tr_b16 v[204:205], v7 offset:36864
    v_mfma_f32_16x16x32_bf16 v[60:63], v[228:231], v[172:175], v[60:63]
    ds_read_b64_tr_b16 v[206:207], v7 offset:37376
    v_mfma_f32_16x16x32_bf16 v[68:71], v[228:231], v[180:183], v[68:71]
    ds_read_b128 v[136:139], v4 offset:40960
    v_mfma_f32_16x16x32_bf16 v[68:71], v[224:227], v[176:179], v[68:71]
    ds_read_b128 v[140:143], v5 offset:40960
    v_mfma_f32_16x16x32_bf16 v[76:79], v[224:227], v[184:187], v[76:79]
    ds_read_b128 v[128:131], v4 offset:38912
    v_mfma_f32_16x16x32_bf16 v[76:79], v[228:231], v[188:191], v[76:79]
    s_waitcnt lgkmcnt(11)
    v_mfma_f32_16x16x32_bf16 v[40:43], v[236:239], v[188:191], v[40:43]
    ds_read_b64_tr_b16 v[224:225], v6 offset:26624
    v_mfma_f32_16x16x32_bf16 v[40:43], v[232:235], v[184:187], v[40:43]
    ds_read_b64_tr_b16 v[226:227], v6 offset:27136
    v_mfma_f32_16x16x32_bf16 v[32:35], v[232:235], v[176:179], v[32:35]
    ds_read_b64_tr_b16 v[228:229], v6 offset:38912
    v_mfma_f32_16x16x32_bf16 v[32:35], v[236:239], v[180:183], v[32:35]
    ds_read_b64_tr_b16 v[230:231], v6 offset:39424
    v_mfma_f32_16x16x32_bf16 v[24:27], v[236:239], v[172:175], v[24:27]
    ds_read_b128 v[132:135], v5 offset:38912
    v_mfma_f32_16x16x32_bf16 v[24:27], v[232:235], v[168:171], v[24:27]
    ds_read_b128 v[120:123], v4 offset:36864
    v_mfma_f32_16x16x32_bf16 v[16:19], v[232:235], v[160:163], v[16:19]
    ds_read_b128 v[124:127], v5 offset:36864
    v_mfma_f32_16x16x32_bf16 v[16:19], v[236:239], v[164:167], v[16:19]
    s_waitcnt lgkmcnt(10)
    v_mfma_f32_16x16x32_bf16 v[20:23], v[204:207], v[164:167], v[20:23]
    ds_read_b64_tr_b16 v[232:233], v7 offset:26624
    v_mfma_f32_16x16x32_bf16 v[20:23], v[200:203], v[160:163], v[20:23]
    ds_read_b64_tr_b16 v[234:235], v7 offset:27136
    v_mfma_f32_16x16x32_bf16 v[28:31], v[200:203], v[168:171], v[28:31]
    ds_read_b64_tr_b16 v[236:237], v7 offset:38912
    v_mfma_f32_16x16x32_bf16 v[28:31], v[204:207], v[172:175], v[28:31]
    ds_read_b64_tr_b16 v[238:239], v7 offset:39424
    v_mfma_f32_16x16x32_bf16 v[36:39], v[204:207], v[180:183], v[36:39]
    v_mfma_f32_16x16x32_bf16 v[36:39], v[200:203], v[176:179], v[36:39]
    v_mfma_f32_16x16x32_bf16 v[44:47], v[200:203], v[184:187], v[44:47]
    v_mfma_f32_16x16x32_bf16 v[44:47], v[204:207], v[188:191], v[44:47]
    s_waitcnt lgkmcnt(7)
    v_mfma_f32_16x16x32_bf16 v[116:119], v[196:199], v[228:231], v[116:119]
    v_mfma_f32_16x16x32_bf16 v[116:119], v[192:195], v[224:227], v[116:119]
    v_mfma_f32_16x16x32_bf16 v[104:107], v[184:187], v[224:227], v[104:107]
    v_mfma_f32_16x16x32_bf16 v[104:107], v[188:191], v[228:231], v[104:107]
    v_mfma_f32_16x16x32_bf16 v[96:99], v[180:183], v[228:231], v[96:99]
    s_waitcnt lgkmcnt(0)
    s_barrier
    v_mfma_f32_16x16x32_bf16 v[96:99], v[176:179], v[224:227], v[96:99]
    ds_read_b64_tr_b16 v[200:201], v6 offset:50176
    v_mfma_f32_16x16x32_bf16 v[88:91], v[168:171], v[224:227], v[88:91]
    ds_read_b64_tr_b16 v[202:203], v6 offset:50688
    v_mfma_f32_16x16x32_bf16 v[88:91], v[172:175], v[228:231], v[88:91]
    ds_read_b64_tr_b16 v[204:205], v6 offset:62464
    v_mfma_f32_16x16x32_bf16 v[80:83], v[164:167], v[228:231], v[80:83]
    ds_read_b64_tr_b16 v[206:207], v6 offset:62976
    v_mfma_f32_16x16x32_bf16 v[80:83], v[160:163], v[224:227], v[80:83]
    v_mfma_f32_16x16x32_bf16 v[84:87], v[160:163], v[232:235], v[84:87]
    ds_read_b64_tr_b16 v[224:225], v7 offset:50176
    v_mfma_f32_16x16x32_bf16 v[84:87], v[164:167], v[236:239], v[84:87]
    ds_read_b64_tr_b16 v[226:227], v7 offset:50688
    v_mfma_f32_16x16x32_bf16 v[92:95], v[172:175], v[236:239], v[92:95]
    ds_read_b64_tr_b16 v[228:229], v7 offset:62464
    v_mfma_f32_16x16x32_bf16 v[92:95], v[168:171], v[232:235], v[92:95]
    ds_read_b64_tr_b16 v[230:231], v7 offset:62976
    v_mfma_f32_16x16x32_bf16 v[100:103], v[176:179], v[232:235], v[100:103]
    v_mfma_f32_16x16x32_bf16 v[100:103], v[180:183], v[236:239], v[100:103]
    v_mfma_f32_16x16x32_bf16 v[108:111], v[188:191], v[236:239], v[108:111]
    v_mfma_f32_16x16x32_bf16 v[108:111], v[184:187], v[232:235], v[108:111]
    s_waitcnt lgkmcnt(4)
    v_mfma_f32_16x16x32_bf16 v[112:115], v[200:203], v[152:155], v[112:115]
    ds_read_b64_tr_b16 v[232:233], v6 offset:49152
    v_mfma_f32_16x16x32_bf16 v[112:115], v[204:207], v[156:159], v[112:115]
    ds_read_b64_tr_b16 v[234:235], v6 offset:49664
    v_mfma_f32_16x16x32_bf16 v[72:75], v[204:207], v[148:151], v[72:75]
    ds_read_b64_tr_b16 v[236:237], v6 offset:61440
    v_mfma_f32_16x16x32_bf16 v[72:75], v[200:203], v[144:147], v[72:75]
    ds_read_b64_tr_b16 v[238:239], v6 offset:61952
    v_mfma_f32_16x16x32_bf16 v[64:67], v[200:203], v[136:139], v[64:67]
    ds_read_b128 v[192:195], v2 offset:0
    v_mfma_f32_16x16x32_bf16 v[64:67], v[204:207], v[140:143], v[64:67]
    ds_read_b128 v[196:199], v3 offset:0
    v_mfma_f32_16x16x32_bf16 v[56:59], v[204:207], v[132:135], v[56:59]
    ds_read_b128 v[184:187], v4 offset:6144
    v_mfma_f32_16x16x32_bf16 v[56:59], v[200:203], v[128:131], v[56:59]
    ds_read_b128 v[188:191], v5 offset:6144
    v_mfma_f32_16x16x32_bf16 v[48:51], v[200:203], v[120:123], v[48:51]
    v_mfma_f32_16x16x32_bf16 v[48:51], v[204:207], v[124:127], v[48:51]
    s_waitcnt lgkmcnt(8)
    v_mfma_f32_16x16x32_bf16 v[52:55], v[228:231], v[124:127], v[52:55]
    ds_read_b64_tr_b16 v[200:201], v7 offset:49152
    v_mfma_f32_16x16x32_bf16 v[52:55], v[224:227], v[120:123], v[52:55]
    ds_read_b64_tr_b16 v[202:203], v7 offset:49664
    v_mfma_f32_16x16x32_bf16 v[60:63], v[224:227], v[128:131], v[60:63]
    ds_read_b64_tr_b16 v[204:205], v7 offset:61440
    v_mfma_f32_16x16x32_bf16 v[60:63], v[228:231], v[132:135], v[60:63]
    ds_read_b64_tr_b16 v[206:207], v7 offset:61952
    v_mfma_f32_16x16x32_bf16 v[68:71], v[228:231], v[140:143], v[68:71]
    ds_read_b128 v[176:179], v4 offset:4096
    v_mfma_f32_16x16x32_bf16 v[68:71], v[224:227], v[136:139], v[68:71]
    ds_read_b128 v[180:183], v5 offset:4096
    v_mfma_f32_16x16x32_bf16 v[76:79], v[224:227], v[144:147], v[76:79]
    ds_read_b128 v[168:171], v4 offset:2048
    v_mfma_f32_16x16x32_bf16 v[76:79], v[228:231], v[148:151], v[76:79]
    s_waitcnt lgkmcnt(11)
    v_mfma_f32_16x16x32_bf16 v[40:43], v[236:239], v[148:151], v[40:43]
    ds_read_b64_tr_b16 v[224:225], v6 offset:51200
    v_mfma_f32_16x16x32_bf16 v[40:43], v[232:235], v[144:147], v[40:43]
    ds_read_b64_tr_b16 v[226:227], v6 offset:51712
    v_mfma_f32_16x16x32_bf16 v[32:35], v[232:235], v[136:139], v[32:35]
    ds_read_b64_tr_b16 v[228:229], v6 offset:63488
    v_mfma_f32_16x16x32_bf16 v[32:35], v[236:239], v[140:143], v[32:35]
    ds_read_b64_tr_b16 v[230:231], v6 offset:64000
    v_mfma_f32_16x16x32_bf16 v[24:27], v[236:239], v[132:135], v[24:27]
    ds_read_b128 v[172:175], v5 offset:2048
    v_mfma_f32_16x16x32_bf16 v[24:27], v[232:235], v[128:131], v[24:27]
    ds_read_b128 v[160:163], v4 offset:0
    v_mfma_f32_16x16x32_bf16 v[16:19], v[232:235], v[120:123], v[16:19]
    ds_read_b128 v[164:167], v5 offset:0
    v_mfma_f32_16x16x32_bf16 v[16:19], v[236:239], v[124:127], v[16:19]
    s_waitcnt lgkmcnt(10)
    v_mfma_f32_16x16x32_bf16 v[20:23], v[204:207], v[124:127], v[20:23]
    ds_read_b64_tr_b16 v[232:233], v7 offset:51200
    v_mfma_f32_16x16x32_bf16 v[20:23], v[200:203], v[120:123], v[20:23]
    ds_read_b64_tr_b16 v[234:235], v7 offset:51712
    v_mfma_f32_16x16x32_bf16 v[28:31], v[200:203], v[128:131], v[28:31]
    ds_read_b64_tr_b16 v[236:237], v7 offset:63488
    v_mfma_f32_16x16x32_bf16 v[28:31], v[204:207], v[132:135], v[28:31]
    ds_read_b64_tr_b16 v[238:239], v7 offset:64000
    v_mfma_f32_16x16x32_bf16 v[36:39], v[204:207], v[140:143], v[36:39]
    v_mfma_f32_16x16x32_bf16 v[36:39], v[200:203], v[136:139], v[36:39]
    v_mfma_f32_16x16x32_bf16 v[44:47], v[200:203], v[144:147], v[44:47]
    v_mfma_f32_16x16x32_bf16 v[44:47], v[204:207], v[148:151], v[44:47]
    s_waitcnt lgkmcnt(7)
    v_mfma_f32_16x16x32_bf16 v[116:119], v[156:159], v[228:231], v[116:119]
    v_mfma_f32_16x16x32_bf16 v[116:119], v[152:155], v[224:227], v[116:119]
    v_mfma_f32_16x16x32_bf16 v[104:107], v[144:147], v[224:227], v[104:107]
    v_mfma_f32_16x16x32_bf16 v[104:107], v[148:151], v[228:231], v[104:107]
    v_mfma_f32_16x16x32_bf16 v[96:99], v[140:143], v[228:231], v[96:99]
    s_waitcnt lgkmcnt(0)
    s_barrier
    v_mfma_f32_16x16x32_bf16 v[96:99], v[136:139], v[224:227], v[96:99]
    ds_read_b64_tr_b16 v[200:201], v6 offset:1024
    v_mfma_f32_16x16x32_bf16 v[88:91], v[128:131], v[224:227], v[88:91]
    ds_read_b64_tr_b16 v[202:203], v6 offset:1536
    v_mfma_f32_16x16x32_bf16 v[88:91], v[132:135], v[228:231], v[88:91]
    ds_read_b64_tr_b16 v[204:205], v6 offset:13312
    v_mfma_f32_16x16x32_bf16 v[80:83], v[124:127], v[228:231], v[80:83]
    ds_read_b64_tr_b16 v[206:207], v6 offset:13824
    v_mfma_f32_16x16x32_bf16 v[80:83], v[120:123], v[224:227], v[80:83]
    v_mfma_f32_16x16x32_bf16 v[84:87], v[120:123], v[232:235], v[84:87]
    ds_read_b64_tr_b16 v[224:225], v7 offset:1024
    v_mfma_f32_16x16x32_bf16 v[84:87], v[124:127], v[236:239], v[84:87]
    ds_read_b64_tr_b16 v[226:227], v7 offset:1536
    v_mfma_f32_16x16x32_bf16 v[92:95], v[132:135], v[236:239], v[92:95]
    ds_read_b64_tr_b16 v[228:229], v7 offset:13312
    v_mfma_f32_16x16x32_bf16 v[92:95], v[128:131], v[232:235], v[92:95]
    ds_read_b64_tr_b16 v[230:231], v7 offset:13824
    v_mfma_f32_16x16x32_bf16 v[100:103], v[136:139], v[232:235], v[100:103]
    v_mfma_f32_16x16x32_bf16 v[100:103], v[140:143], v[236:239], v[100:103]
    v_mfma_f32_16x16x32_bf16 v[108:111], v[148:151], v[236:239], v[108:111]
    v_mfma_f32_16x16x32_bf16 v[108:111], v[144:147], v[232:235], v[108:111]
    s_waitcnt lgkmcnt(4)
    v_mfma_f32_16x16x32_bf16 v[112:115], v[200:203], v[192:195], v[112:115]
    ds_read_b64_tr_b16 v[232:233], v6 offset:0
    v_mfma_f32_16x16x32_bf16 v[112:115], v[204:207], v[196:199], v[112:115]
    ds_read_b64_tr_b16 v[234:235], v6 offset:512
    v_mfma_f32_16x16x32_bf16 v[72:75], v[204:207], v[188:191], v[72:75]
    ds_read_b64_tr_b16 v[236:237], v6 offset:12288
    v_mfma_f32_16x16x32_bf16 v[72:75], v[200:203], v[184:187], v[72:75]
    ds_read_b64_tr_b16 v[238:239], v6 offset:12800
    v_mfma_f32_16x16x32_bf16 v[64:67], v[200:203], v[176:179], v[64:67]
    ds_read_b128 v[152:155], v2 offset:18432
    v_mfma_f32_16x16x32_bf16 v[64:67], v[204:207], v[180:183], v[64:67]
    ds_read_b128 v[156:159], v3 offset:18432
    v_mfma_f32_16x16x32_bf16 v[56:59], v[204:207], v[172:175], v[56:59]
    ds_read_b128 v[144:147], v4 offset:24576
    v_mfma_f32_16x16x32_bf16 v[56:59], v[200:203], v[168:171], v[56:59]
    ds_read_b128 v[148:151], v5 offset:24576
    v_mfma_f32_16x16x32_bf16 v[48:51], v[200:203], v[160:163], v[48:51]
    v_mfma_f32_16x16x32_bf16 v[48:51], v[204:207], v[164:167], v[48:51]
    s_waitcnt lgkmcnt(8)
    v_mfma_f32_16x16x32_bf16 v[52:55], v[228:231], v[164:167], v[52:55]
    ds_read_b64_tr_b16 v[200:201], v7 offset:0
    v_mfma_f32_16x16x32_bf16 v[52:55], v[224:227], v[160:163], v[52:55]
    ds_read_b64_tr_b16 v[202:203], v7 offset:512
    v_mfma_f32_16x16x32_bf16 v[60:63], v[224:227], v[168:171], v[60:63]
    ds_read_b64_tr_b16 v[204:205], v7 offset:12288
    v_mfma_f32_16x16x32_bf16 v[60:63], v[228:231], v[172:175], v[60:63]
    ds_read_b64_tr_b16 v[206:207], v7 offset:12800
    v_mfma_f32_16x16x32_bf16 v[68:71], v[228:231], v[180:183], v[68:71]
    ds_read_b128 v[136:139], v4 offset:22528
    v_mfma_f32_16x16x32_bf16 v[68:71], v[224:227], v[176:179], v[68:71]
    ds_read_b128 v[140:143], v5 offset:22528
    v_mfma_f32_16x16x32_bf16 v[76:79], v[224:227], v[184:187], v[76:79]
    ds_read_b128 v[128:131], v4 offset:20480
    v_mfma_f32_16x16x32_bf16 v[76:79], v[228:231], v[188:191], v[76:79]
    s_waitcnt lgkmcnt(11)
    v_mfma_f32_16x16x32_bf16 v[40:43], v[236:239], v[188:191], v[40:43]
    ds_read_b64_tr_b16 v[224:225], v6 offset:2048
    v_mfma_f32_16x16x32_bf16 v[40:43], v[232:235], v[184:187], v[40:43]
    ds_read_b64_tr_b16 v[226:227], v6 offset:2560
    v_mfma_f32_16x16x32_bf16 v[32:35], v[232:235], v[176:179], v[32:35]
    ds_read_b64_tr_b16 v[228:229], v6 offset:14336
    v_mfma_f32_16x16x32_bf16 v[32:35], v[236:239], v[180:183], v[32:35]
    ds_read_b64_tr_b16 v[230:231], v6 offset:14848
    v_mfma_f32_16x16x32_bf16 v[24:27], v[236:239], v[172:175], v[24:27]
    ds_read_b128 v[132:135], v5 offset:20480
    v_mfma_f32_16x16x32_bf16 v[24:27], v[232:235], v[168:171], v[24:27]
    ds_read_b128 v[120:123], v4 offset:18432
    v_mfma_f32_16x16x32_bf16 v[16:19], v[232:235], v[160:163], v[16:19]
    ds_read_b128 v[124:127], v5 offset:18432
    v_mfma_f32_16x16x32_bf16 v[16:19], v[236:239], v[164:167], v[16:19]
    s_waitcnt lgkmcnt(10)
    v_mfma_f32_16x16x32_bf16 v[20:23], v[204:207], v[164:167], v[20:23]
    ds_read_b64_tr_b16 v[232:233], v7 offset:2048
    v_mfma_f32_16x16x32_bf16 v[20:23], v[200:203], v[160:163], v[20:23]
    ds_read_b64_tr_b16 v[234:235], v7 offset:2560
    v_mfma_f32_16x16x32_bf16 v[28:31], v[200:203], v[168:171], v[28:31]
    ds_read_b64_tr_b16 v[236:237], v7 offset:14336
    v_mfma_f32_16x16x32_bf16 v[28:31], v[204:207], v[172:175], v[28:31]
    ds_read_b64_tr_b16 v[238:239], v7 offset:14848
    v_mfma_f32_16x16x32_bf16 v[36:39], v[204:207], v[180:183], v[36:39]
    v_mfma_f32_16x16x32_bf16 v[36:39], v[200:203], v[176:179], v[36:39]
    v_mfma_f32_16x16x32_bf16 v[44:47], v[200:203], v[184:187], v[44:47]
    v_mfma_f32_16x16x32_bf16 v[44:47], v[204:207], v[188:191], v[44:47]
    s_waitcnt lgkmcnt(7)
    v_mfma_f32_16x16x32_bf16 v[116:119], v[196:199], v[228:231], v[116:119]
    v_mfma_f32_16x16x32_bf16 v[116:119], v[192:195], v[224:227], v[116:119]
    v_mfma_f32_16x16x32_bf16 v[104:107], v[184:187], v[224:227], v[104:107]
    v_mfma_f32_16x16x32_bf16 v[104:107], v[188:191], v[228:231], v[104:107]
    v_mfma_f32_16x16x32_bf16 v[96:99], v[180:183], v[228:231], v[96:99]
    s_waitcnt lgkmcnt(0)
    s_barrier
    v_mfma_f32_16x16x32_bf16 v[96:99], v[176:179], v[224:227], v[96:99]
    ds_read_b64_tr_b16 v[200:201], v6 offset:25600
    v_mfma_f32_16x16x32_bf16 v[88:91], v[168:171], v[224:227], v[88:91]
    ds_read_b64_tr_b16 v[202:203], v6 offset:26112
    v_mfma_f32_16x16x32_bf16 v[88:91], v[172:175], v[228:231], v[88:91]
    ds_read_b64_tr_b16 v[204:205], v6 offset:37888
    v_mfma_f32_16x16x32_bf16 v[80:83], v[164:167], v[228:231], v[80:83]
    ds_read_b64_tr_b16 v[206:207], v6 offset:38400
    v_mfma_f32_16x16x32_bf16 v[80:83], v[160:163], v[224:227], v[80:83]
    v_mfma_f32_16x16x32_bf16 v[84:87], v[160:163], v[232:235], v[84:87]
    ds_read_b64_tr_b16 v[224:225], v7 offset:25600
    v_mfma_f32_16x16x32_bf16 v[84:87], v[164:167], v[236:239], v[84:87]
    ds_read_b64_tr_b16 v[226:227], v7 offset:26112
    v_mfma_f32_16x16x32_bf16 v[92:95], v[172:175], v[236:239], v[92:95]
    ds_read_b64_tr_b16 v[228:229], v7 offset:37888
    v_mfma_f32_16x16x32_bf16 v[92:95], v[168:171], v[232:235], v[92:95]
    ds_read_b64_tr_b16 v[230:231], v7 offset:38400
    v_mfma_f32_16x16x32_bf16 v[100:103], v[176:179], v[232:235], v[100:103]
    v_mfma_f32_16x16x32_bf16 v[100:103], v[180:183], v[236:239], v[100:103]
    v_mfma_f32_16x16x32_bf16 v[108:111], v[188:191], v[236:239], v[108:111]
    v_mfma_f32_16x16x32_bf16 v[108:111], v[184:187], v[232:235], v[108:111]
    s_waitcnt lgkmcnt(4)
    v_mfma_f32_16x16x32_bf16 v[112:115], v[200:203], v[152:155], v[112:115]
    ds_read_b64_tr_b16 v[232:233], v6 offset:24576
    v_mfma_f32_16x16x32_bf16 v[112:115], v[204:207], v[156:159], v[112:115]
    ds_read_b64_tr_b16 v[234:235], v6 offset:25088
    v_mfma_f32_16x16x32_bf16 v[72:75], v[204:207], v[148:151], v[72:75]
    ds_read_b64_tr_b16 v[236:237], v6 offset:36864
    v_mfma_f32_16x16x32_bf16 v[72:75], v[200:203], v[144:147], v[72:75]
    ds_read_b64_tr_b16 v[238:239], v6 offset:37376
    v_mfma_f32_16x16x32_bf16 v[64:67], v[200:203], v[136:139], v[64:67]
    ds_read_b128 v[192:195], v2 offset:36864
    v_mfma_f32_16x16x32_bf16 v[64:67], v[204:207], v[140:143], v[64:67]
    ds_read_b128 v[196:199], v3 offset:36864
    v_mfma_f32_16x16x32_bf16 v[56:59], v[204:207], v[132:135], v[56:59]
    ds_read_b128 v[184:187], v4 offset:43008
    v_mfma_f32_16x16x32_bf16 v[56:59], v[200:203], v[128:131], v[56:59]
    ds_read_b128 v[188:191], v5 offset:43008
    v_mfma_f32_16x16x32_bf16 v[48:51], v[200:203], v[120:123], v[48:51]
    v_mfma_f32_16x16x32_bf16 v[48:51], v[204:207], v[124:127], v[48:51]
    s_waitcnt lgkmcnt(8)
    v_mfma_f32_16x16x32_bf16 v[52:55], v[228:231], v[124:127], v[52:55]
    ds_read_b64_tr_b16 v[200:201], v7 offset:24576
    v_mfma_f32_16x16x32_bf16 v[52:55], v[224:227], v[120:123], v[52:55]
    ds_read_b64_tr_b16 v[202:203], v7 offset:25088
    v_mfma_f32_16x16x32_bf16 v[60:63], v[224:227], v[128:131], v[60:63]
    ds_read_b64_tr_b16 v[204:205], v7 offset:36864
    v_mfma_f32_16x16x32_bf16 v[60:63], v[228:231], v[132:135], v[60:63]
    ds_read_b64_tr_b16 v[206:207], v7 offset:37376
    v_mfma_f32_16x16x32_bf16 v[68:71], v[228:231], v[140:143], v[68:71]
    ds_read_b128 v[176:179], v4 offset:40960
    v_mfma_f32_16x16x32_bf16 v[68:71], v[224:227], v[136:139], v[68:71]
    ds_read_b128 v[180:183], v5 offset:40960
    v_mfma_f32_16x16x32_bf16 v[76:79], v[224:227], v[144:147], v[76:79]
    ds_read_b128 v[168:171], v4 offset:38912
    v_mfma_f32_16x16x32_bf16 v[76:79], v[228:231], v[148:151], v[76:79]
    s_waitcnt lgkmcnt(11)
    v_mfma_f32_16x16x32_bf16 v[40:43], v[236:239], v[148:151], v[40:43]
    ds_read_b64_tr_b16 v[224:225], v6 offset:26624
    v_mfma_f32_16x16x32_bf16 v[40:43], v[232:235], v[144:147], v[40:43]
    ds_read_b64_tr_b16 v[226:227], v6 offset:27136
    v_mfma_f32_16x16x32_bf16 v[32:35], v[232:235], v[136:139], v[32:35]
    ds_read_b64_tr_b16 v[228:229], v6 offset:38912
    v_mfma_f32_16x16x32_bf16 v[32:35], v[236:239], v[140:143], v[32:35]
    ds_read_b64_tr_b16 v[230:231], v6 offset:39424
    v_mfma_f32_16x16x32_bf16 v[24:27], v[236:239], v[132:135], v[24:27]
    ds_read_b128 v[172:175], v5 offset:38912
    v_mfma_f32_16x16x32_bf16 v[24:27], v[232:235], v[128:131], v[24:27]
    ds_read_b128 v[160:163], v4 offset:36864
    v_mfma_f32_16x16x32_bf16 v[16:19], v[232:235], v[120:123], v[16:19]
    ds_read_b128 v[164:167], v5 offset:36864
    v_mfma_f32_16x16x32_bf16 v[16:19], v[236:239], v[124:127], v[16:19]
    s_waitcnt lgkmcnt(10)
    v_mfma_f32_16x16x32_bf16 v[20:23], v[204:207], v[124:127], v[20:23]
    ds_read_b64_tr_b16 v[232:233], v7 offset:26624
    v_mfma_f32_16x16x32_bf16 v[20:23], v[200:203], v[120:123], v[20:23]
    ds_read_b64_tr_b16 v[234:235], v7 offset:27136
    v_mfma_f32_16x16x32_bf16 v[28:31], v[200:203], v[128:131], v[28:31]
    ds_read_b64_tr_b16 v[236:237], v7 offset:38912
    v_mfma_f32_16x16x32_bf16 v[28:31], v[204:207], v[132:135], v[28:31]
    ds_read_b64_tr_b16 v[238:239], v7 offset:39424
    v_mfma_f32_16x16x32_bf16 v[36:39], v[204:207], v[140:143], v[36:39]
    v_mfma_f32_16x16x32_bf16 v[36:39], v[200:203], v[136:139], v[36:39]
    v_mfma_f32_16x16x32_bf16 v[44:47], v[200:203], v[144:147], v[44:47]
    v_mfma_f32_16x16x32_bf16 v[44:47], v[204:207], v[148:151], v[44:47]
    s_waitcnt lgkmcnt(7)
    v_mfma_f32_16x16x32_bf16 v[116:119], v[156:159], v[228:231], v[116:119]
    v_mfma_f32_16x16x32_bf16 v[116:119], v[152:155], v[224:227], v[116:119]
    v_mfma_f32_16x16x32_bf16 v[104:107], v[144:147], v[224:227], v[104:107]
    v_mfma_f32_16x16x32_bf16 v[104:107], v[148:151], v[228:231], v[104:107]
    v_mfma_f32_16x16x32_bf16 v[96:99], v[140:143], v[228:231], v[96:99]
    s_waitcnt lgkmcnt(0)
    s_barrier
    v_mfma_f32_16x16x32_bf16 v[96:99], v[136:139], v[224:227], v[96:99]
    ds_read_b64_tr_b16 v[200:201], v6 offset:50176
    v_mfma_f32_16x16x32_bf16 v[88:91], v[128:131], v[224:227], v[88:91]
    ds_read_b64_tr_b16 v[202:203], v6 offset:50688
    v_mfma_f32_16x16x32_bf16 v[88:91], v[132:135], v[228:231], v[88:91]
    ds_read_b64_tr_b16 v[204:205], v6 offset:62464
    v_mfma_f32_16x16x32_bf16 v[80:83], v[124:127], v[228:231], v[80:83]
    ds_read_b64_tr_b16 v[206:207], v6 offset:62976
    v_mfma_f32_16x16x32_bf16 v[80:83], v[120:123], v[224:227], v[80:83]
    v_mfma_f32_16x16x32_bf16 v[84:87], v[120:123], v[232:235], v[84:87]
    ds_read_b64_tr_b16 v[224:225], v7 offset:50176
    v_mfma_f32_16x16x32_bf16 v[84:87], v[124:127], v[236:239], v[84:87]
    ds_read_b64_tr_b16 v[226:227], v7 offset:50688
    v_mfma_f32_16x16x32_bf16 v[92:95], v[132:135], v[236:239], v[92:95]
    ds_read_b64_tr_b16 v[228:229], v7 offset:62464
    v_mfma_f32_16x16x32_bf16 v[92:95], v[128:131], v[232:235], v[92:95]
    ds_read_b64_tr_b16 v[230:231], v7 offset:62976
    v_mfma_f32_16x16x32_bf16 v[100:103], v[136:139], v[232:235], v[100:103]
    v_mfma_f32_16x16x32_bf16 v[100:103], v[140:143], v[236:239], v[100:103]
    v_mfma_f32_16x16x32_bf16 v[108:111], v[148:151], v[236:239], v[108:111]
    v_mfma_f32_16x16x32_bf16 v[108:111], v[144:147], v[232:235], v[108:111]
    s_waitcnt lgkmcnt(4)
    v_mfma_f32_16x16x32_bf16 v[112:115], v[200:203], v[192:195], v[112:115]
    ds_read_b64_tr_b16 v[232:233], v6 offset:49152
    v_mfma_f32_16x16x32_bf16 v[112:115], v[204:207], v[196:199], v[112:115]
    ds_read_b64_tr_b16 v[234:235], v6 offset:49664
    v_mfma_f32_16x16x32_bf16 v[72:75], v[204:207], v[188:191], v[72:75]
    ds_read_b64_tr_b16 v[236:237], v6 offset:61440
    v_mfma_f32_16x16x32_bf16 v[72:75], v[200:203], v[184:187], v[72:75]
    ds_read_b64_tr_b16 v[238:239], v6 offset:61952
    v_mfma_f32_16x16x32_bf16 v[64:67], v[200:203], v[176:179], v[64:67]
    ds_read_b128 v[152:155], v2 offset:0
    v_mfma_f32_16x16x32_bf16 v[64:67], v[204:207], v[180:183], v[64:67]
    ds_read_b128 v[156:159], v3 offset:0
    v_mfma_f32_16x16x32_bf16 v[56:59], v[204:207], v[172:175], v[56:59]
    ds_read_b128 v[144:147], v4 offset:6144
    v_mfma_f32_16x16x32_bf16 v[56:59], v[200:203], v[168:171], v[56:59]
    ds_read_b128 v[148:151], v5 offset:6144
    v_mfma_f32_16x16x32_bf16 v[48:51], v[200:203], v[160:163], v[48:51]
    v_mfma_f32_16x16x32_bf16 v[48:51], v[204:207], v[164:167], v[48:51]
    s_waitcnt lgkmcnt(8)
    v_mfma_f32_16x16x32_bf16 v[52:55], v[228:231], v[164:167], v[52:55]
    ds_read_b64_tr_b16 v[200:201], v7 offset:49152
    v_mfma_f32_16x16x32_bf16 v[52:55], v[224:227], v[160:163], v[52:55]
    ds_read_b64_tr_b16 v[202:203], v7 offset:49664
    v_mfma_f32_16x16x32_bf16 v[60:63], v[224:227], v[168:171], v[60:63]
    ds_read_b64_tr_b16 v[204:205], v7 offset:61440
    v_mfma_f32_16x16x32_bf16 v[60:63], v[228:231], v[172:175], v[60:63]
    ds_read_b64_tr_b16 v[206:207], v7 offset:61952
    v_mfma_f32_16x16x32_bf16 v[68:71], v[228:231], v[180:183], v[68:71]
    ds_read_b128 v[136:139], v4 offset:4096
    v_mfma_f32_16x16x32_bf16 v[68:71], v[224:227], v[176:179], v[68:71]
    ds_read_b128 v[140:143], v5 offset:4096
    v_mfma_f32_16x16x32_bf16 v[76:79], v[224:227], v[184:187], v[76:79]
    ds_read_b128 v[128:131], v4 offset:2048
    v_mfma_f32_16x16x32_bf16 v[76:79], v[228:231], v[188:191], v[76:79]
    s_waitcnt lgkmcnt(11)
    v_mfma_f32_16x16x32_bf16 v[40:43], v[236:239], v[188:191], v[40:43]
    ds_read_b64_tr_b16 v[224:225], v6 offset:51200
    v_mfma_f32_16x16x32_bf16 v[40:43], v[232:235], v[184:187], v[40:43]
    ds_read_b64_tr_b16 v[226:227], v6 offset:51712
    v_mfma_f32_16x16x32_bf16 v[32:35], v[232:235], v[176:179], v[32:35]
    ds_read_b64_tr_b16 v[228:229], v6 offset:63488
    v_mfma_f32_16x16x32_bf16 v[32:35], v[236:239], v[180:183], v[32:35]
    ds_read_b64_tr_b16 v[230:231], v6 offset:64000
    v_mfma_f32_16x16x32_bf16 v[24:27], v[236:239], v[172:175], v[24:27]
    ds_read_b128 v[132:135], v5 offset:2048
    v_mfma_f32_16x16x32_bf16 v[24:27], v[232:235], v[168:171], v[24:27]
    ds_read_b128 v[120:123], v4 offset:0
    v_mfma_f32_16x16x32_bf16 v[16:19], v[232:235], v[160:163], v[16:19]
    ds_read_b128 v[124:127], v5 offset:0
    v_mfma_f32_16x16x32_bf16 v[16:19], v[236:239], v[164:167], v[16:19]
    s_waitcnt lgkmcnt(10)
    v_mfma_f32_16x16x32_bf16 v[20:23], v[204:207], v[164:167], v[20:23]
    ds_read_b64_tr_b16 v[232:233], v7 offset:51200
    v_mfma_f32_16x16x32_bf16 v[20:23], v[200:203], v[160:163], v[20:23]
    ds_read_b64_tr_b16 v[234:235], v7 offset:51712
    v_mfma_f32_16x16x32_bf16 v[28:31], v[200:203], v[168:171], v[28:31]
    ds_read_b64_tr_b16 v[236:237], v7 offset:63488
    v_mfma_f32_16x16x32_bf16 v[28:31], v[204:207], v[172:175], v[28:31]
    ds_read_b64_tr_b16 v[238:239], v7 offset:64000
    v_mfma_f32_16x16x32_bf16 v[36:39], v[204:207], v[180:183], v[36:39]
    v_mfma_f32_16x16x32_bf16 v[36:39], v[200:203], v[176:179], v[36:39]
    v_mfma_f32_16x16x32_bf16 v[44:47], v[200:203], v[184:187], v[44:47]
    v_mfma_f32_16x16x32_bf16 v[44:47], v[204:207], v[188:191], v[44:47]
    s_waitcnt lgkmcnt(7)
    v_mfma_f32_16x16x32_bf16 v[116:119], v[196:199], v[228:231], v[116:119]
    v_mfma_f32_16x16x32_bf16 v[116:119], v[192:195], v[224:227], v[116:119]
    v_mfma_f32_16x16x32_bf16 v[104:107], v[184:187], v[224:227], v[104:107]
    v_mfma_f32_16x16x32_bf16 v[104:107], v[188:191], v[228:231], v[104:107]
    v_mfma_f32_16x16x32_bf16 v[96:99], v[180:183], v[228:231], v[96:99]
    s_waitcnt lgkmcnt(0)
    s_barrier
    v_mfma_f32_16x16x32_bf16 v[96:99], v[176:179], v[224:227], v[96:99]
    ds_read_b64_tr_b16 v[200:201], v6 offset:1024
    v_mfma_f32_16x16x32_bf16 v[88:91], v[168:171], v[224:227], v[88:91]
    ds_read_b64_tr_b16 v[202:203], v6 offset:1536
    v_mfma_f32_16x16x32_bf16 v[88:91], v[172:175], v[228:231], v[88:91]
    ds_read_b64_tr_b16 v[204:205], v6 offset:13312
    v_mfma_f32_16x16x32_bf16 v[80:83], v[164:167], v[228:231], v[80:83]
    ds_read_b64_tr_b16 v[206:207], v6 offset:13824
    v_mfma_f32_16x16x32_bf16 v[80:83], v[160:163], v[224:227], v[80:83]
    v_mfma_f32_16x16x32_bf16 v[84:87], v[160:163], v[232:235], v[84:87]
    ds_read_b64_tr_b16 v[224:225], v7 offset:1024
    v_mfma_f32_16x16x32_bf16 v[84:87], v[164:167], v[236:239], v[84:87]
    ds_read_b64_tr_b16 v[226:227], v7 offset:1536
    v_mfma_f32_16x16x32_bf16 v[92:95], v[172:175], v[236:239], v[92:95]
    ds_read_b64_tr_b16 v[228:229], v7 offset:13312
    v_mfma_f32_16x16x32_bf16 v[92:95], v[168:171], v[232:235], v[92:95]
    ds_read_b64_tr_b16 v[230:231], v7 offset:13824
    v_mfma_f32_16x16x32_bf16 v[100:103], v[176:179], v[232:235], v[100:103]
    v_mfma_f32_16x16x32_bf16 v[100:103], v[180:183], v[236:239], v[100:103]
    v_mfma_f32_16x16x32_bf16 v[108:111], v[188:191], v[236:239], v[108:111]
    v_mfma_f32_16x16x32_bf16 v[108:111], v[184:187], v[232:235], v[108:111]
    s_waitcnt lgkmcnt(4)
    v_mfma_f32_16x16x32_bf16 v[112:115], v[200:203], v[152:155], v[112:115]
    ds_read_b64_tr_b16 v[232:233], v6 offset:0
    v_mfma_f32_16x16x32_bf16 v[112:115], v[204:207], v[156:159], v[112:115]
    ds_read_b64_tr_b16 v[234:235], v6 offset:512
    v_mfma_f32_16x16x32_bf16 v[72:75], v[204:207], v[148:151], v[72:75]
    ds_read_b64_tr_b16 v[236:237], v6 offset:12288
    v_mfma_f32_16x16x32_bf16 v[72:75], v[200:203], v[144:147], v[72:75]
    ds_read_b64_tr_b16 v[238:239], v6 offset:12800
    v_mfma_f32_16x16x32_bf16 v[64:67], v[200:203], v[136:139], v[64:67]
    ds_read_b128 v[192:195], v2 offset:18432
    v_mfma_f32_16x16x32_bf16 v[64:67], v[204:207], v[140:143], v[64:67]
    ds_read_b128 v[196:199], v3 offset:18432
    v_mfma_f32_16x16x32_bf16 v[56:59], v[204:207], v[132:135], v[56:59]
    ds_read_b128 v[184:187], v4 offset:24576
    v_mfma_f32_16x16x32_bf16 v[56:59], v[200:203], v[128:131], v[56:59]
    ds_read_b128 v[188:191], v5 offset:24576
    v_mfma_f32_16x16x32_bf16 v[48:51], v[200:203], v[120:123], v[48:51]
    v_mfma_f32_16x16x32_bf16 v[48:51], v[204:207], v[124:127], v[48:51]
    s_waitcnt lgkmcnt(8)
    v_mfma_f32_16x16x32_bf16 v[52:55], v[228:231], v[124:127], v[52:55]
    ds_read_b64_tr_b16 v[200:201], v7 offset:0
    v_mfma_f32_16x16x32_bf16 v[52:55], v[224:227], v[120:123], v[52:55]
    ds_read_b64_tr_b16 v[202:203], v7 offset:512
    v_mfma_f32_16x16x32_bf16 v[60:63], v[224:227], v[128:131], v[60:63]
    ds_read_b64_tr_b16 v[204:205], v7 offset:12288
    v_mfma_f32_16x16x32_bf16 v[60:63], v[228:231], v[132:135], v[60:63]
    ds_read_b64_tr_b16 v[206:207], v7 offset:12800
    v_mfma_f32_16x16x32_bf16 v[68:71], v[228:231], v[140:143], v[68:71]
    ds_read_b128 v[176:179], v4 offset:22528
    v_mfma_f32_16x16x32_bf16 v[68:71], v[224:227], v[136:139], v[68:71]
    ds_read_b128 v[180:183], v5 offset:22528
    v_mfma_f32_16x16x32_bf16 v[76:79], v[224:227], v[144:147], v[76:79]
    ds_read_b128 v[168:171], v4 offset:20480
    v_mfma_f32_16x16x32_bf16 v[76:79], v[228:231], v[148:151], v[76:79]
    s_waitcnt lgkmcnt(11)
    v_mfma_f32_16x16x32_bf16 v[40:43], v[236:239], v[148:151], v[40:43]
    ds_read_b64_tr_b16 v[224:225], v6 offset:2048
    v_mfma_f32_16x16x32_bf16 v[40:43], v[232:235], v[144:147], v[40:43]
    ds_read_b64_tr_b16 v[226:227], v6 offset:2560
    v_mfma_f32_16x16x32_bf16 v[32:35], v[232:235], v[136:139], v[32:35]
    ds_read_b64_tr_b16 v[228:229], v6 offset:14336
    v_mfma_f32_16x16x32_bf16 v[32:35], v[236:239], v[140:143], v[32:35]
    ds_read_b64_tr_b16 v[230:231], v6 offset:14848
    v_mfma_f32_16x16x32_bf16 v[24:27], v[236:239], v[132:135], v[24:27]
    ds_read_b128 v[172:175], v5 offset:20480
    v_mfma_f32_16x16x32_bf16 v[24:27], v[232:235], v[128:131], v[24:27]
    ds_read_b128 v[160:163], v4 offset:18432
    v_mfma_f32_16x16x32_bf16 v[16:19], v[232:235], v[120:123], v[16:19]
    ds_read_b128 v[164:167], v5 offset:18432
    v_mfma_f32_16x16x32_bf16 v[16:19], v[236:239], v[124:127], v[16:19]
    s_waitcnt lgkmcnt(10)
    v_mfma_f32_16x16x32_bf16 v[20:23], v[204:207], v[124:127], v[20:23]
    ds_read_b64_tr_b16 v[232:233], v7 offset:2048
    v_mfma_f32_16x16x32_bf16 v[20:23], v[200:203], v[120:123], v[20:23]
    ds_read_b64_tr_b16 v[234:235], v7 offset:2560
    v_mfma_f32_16x16x32_bf16 v[28:31], v[200:203], v[128:131], v[28:31]
    ds_read_b64_tr_b16 v[236:237], v7 offset:14336
    v_mfma_f32_16x16x32_bf16 v[28:31], v[204:207], v[132:135], v[28:31]
    ds_read_b64_tr_b16 v[238:239], v7 offset:14848
    v_mfma_f32_16x16x32_bf16 v[36:39], v[204:207], v[140:143], v[36:39]
    buffer_load_dword v222, v220, s[68:71], s98 offen sc1
    v_mfma_f32_16x16x32_bf16 v[36:39], v[200:203], v[136:139], v[36:39]
    v_mfma_f32_16x16x32_bf16 v[44:47], v[200:203], v[144:147], v[44:47]
    v_mfma_f32_16x16x32_bf16 v[44:47], v[204:207], v[148:151], v[44:47]
    s_waitcnt lgkmcnt(7)
    v_mfma_f32_16x16x32_bf16 v[116:119], v[156:159], v[228:231], v[116:119]
    v_mfma_f32_16x16x32_bf16 v[116:119], v[152:155], v[224:227], v[116:119]
    v_mfma_f32_16x16x32_bf16 v[104:107], v[144:147], v[224:227], v[104:107]
    v_mfma_f32_16x16x32_bf16 v[104:107], v[148:151], v[228:231], v[104:107]
    v_mfma_f32_16x16x32_bf16 v[96:99], v[140:143], v[228:231], v[96:99]
    s_waitcnt lgkmcnt(0)
    s_barrier
    v_mfma_f32_16x16x32_bf16 v[96:99], v[136:139], v[224:227], v[96:99]
    ds_read_b64_tr_b16 v[200:201], v6 offset:25600
    v_mfma_f32_16x16x32_bf16 v[88:91], v[128:131], v[224:227], v[88:91]
    ds_read_b64_tr_b16 v[202:203], v6 offset:26112
    v_mfma_f32_16x16x32_bf16 v[88:91], v[132:135], v[228:231], v[88:91]
    ds_read_b64_tr_b16 v[204:205], v6 offset:37888
    v_mfma_f32_16x16x32_bf16 v[80:83], v[124:127], v[228:231], v[80:83]
    ds_read_b64_tr_b16 v[206:207], v6 offset:38400
    v_mfma_f32_16x16x32_bf16 v[80:83], v[120:123], v[224:227], v[80:83]
    v_mfma_f32_16x16x32_bf16 v[84:87], v[120:123], v[232:235], v[84:87]
    ds_read_b64_tr_b16 v[224:225], v7 offset:25600
    v_mfma_f32_16x16x32_bf16 v[84:87], v[124:127], v[236:239], v[84:87]
    ds_read_b64_tr_b16 v[226:227], v7 offset:26112
    v_mfma_f32_16x16x32_bf16 v[92:95], v[132:135], v[236:239], v[92:95]
    ds_read_b64_tr_b16 v[228:229], v7 offset:37888
    v_mfma_f32_16x16x32_bf16 v[92:95], v[128:131], v[232:235], v[92:95]
    ds_read_b64_tr_b16 v[230:231], v7 offset:38400
    v_mfma_f32_16x16x32_bf16 v[100:103], v[136:139], v[232:235], v[100:103]
    v_mfma_f32_16x16x32_bf16 v[100:103], v[140:143], v[236:239], v[100:103]
    v_mfma_f32_16x16x32_bf16 v[108:111], v[148:151], v[236:239], v[108:111]
    v_mfma_f32_16x16x32_bf16 v[108:111], v[144:147], v[232:235], v[108:111]
    s_waitcnt lgkmcnt(4)
    v_mfma_f32_16x16x32_bf16 v[112:115], v[200:203], v[192:195], v[112:115]
    ds_read_b64_tr_b16 v[232:233], v6 offset:24576
    v_mfma_f32_16x16x32_bf16 v[112:115], v[204:207], v[196:199], v[112:115]
    ds_read_b64_tr_b16 v[234:235], v6 offset:25088
    v_mfma_f32_16x16x32_bf16 v[72:75], v[204:207], v[188:191], v[72:75]
    ds_read_b64_tr_b16 v[236:237], v6 offset:36864
    v_mfma_f32_16x16x32_bf16 v[72:75], v[200:203], v[184:187], v[72:75]
    ds_read_b64_tr_b16 v[238:239], v6 offset:37376
    v_mfma_f32_16x16x32_bf16 v[64:67], v[200:203], v[176:179], v[64:67]
    ds_read_b128 v[152:155], v2 offset:36864
    v_mfma_f32_16x16x32_bf16 v[64:67], v[204:207], v[180:183], v[64:67]
    ds_read_b128 v[156:159], v3 offset:36864
    v_mfma_f32_16x16x32_bf16 v[56:59], v[204:207], v[172:175], v[56:59]
    ds_read_b128 v[144:147], v4 offset:43008
    v_mfma_f32_16x16x32_bf16 v[56:59], v[200:203], v[168:171], v[56:59]
    ds_read_b128 v[148:151], v5 offset:43008
    v_mfma_f32_16x16x32_bf16 v[48:51], v[200:203], v[160:163], v[48:51]
    v_mfma_f32_16x16x32_bf16 v[48:51], v[204:207], v[164:167], v[48:51]
    s_waitcnt lgkmcnt(8)
    v_mfma_f32_16x16x32_bf16 v[52:55], v[228:231], v[164:167], v[52:55]
    ds_read_b64_tr_b16 v[200:201], v7 offset:24576
    v_mfma_f32_16x16x32_bf16 v[52:55], v[224:227], v[160:163], v[52:55]
    ds_read_b64_tr_b16 v[202:203], v7 offset:25088
    v_mfma_f32_16x16x32_bf16 v[60:63], v[224:227], v[168:171], v[60:63]
    ds_read_b64_tr_b16 v[204:205], v7 offset:36864
    v_mfma_f32_16x16x32_bf16 v[60:63], v[228:231], v[172:175], v[60:63]
    ds_read_b64_tr_b16 v[206:207], v7 offset:37376
    v_mfma_f32_16x16x32_bf16 v[68:71], v[228:231], v[180:183], v[68:71]
    ds_read_b128 v[136:139], v4 offset:40960
    v_mfma_f32_16x16x32_bf16 v[68:71], v[224:227], v[176:179], v[68:71]
    ds_read_b128 v[140:143], v5 offset:40960
    v_mfma_f32_16x16x32_bf16 v[76:79], v[224:227], v[184:187], v[76:79]
    ds_read_b128 v[128:131], v4 offset:38912
    v_mfma_f32_16x16x32_bf16 v[76:79], v[228:231], v[188:191], v[76:79]
    s_waitcnt lgkmcnt(11)
    v_mfma_f32_16x16x32_bf16 v[40:43], v[236:239], v[188:191], v[40:43]
    ds_read_b64_tr_b16 v[224:225], v6 offset:26624
    v_mfma_f32_16x16x32_bf16 v[40:43], v[232:235], v[184:187], v[40:43]
    ds_read_b64_tr_b16 v[226:227], v6 offset:27136
    v_mfma_f32_16x16x32_bf16 v[32:35], v[232:235], v[176:179], v[32:35]
    ds_read_b64_tr_b16 v[228:229], v6 offset:38912
    v_mfma_f32_16x16x32_bf16 v[32:35], v[236:239], v[180:183], v[32:35]
    ds_read_b64_tr_b16 v[230:231], v6 offset:39424
    v_mfma_f32_16x16x32_bf16 v[24:27], v[236:239], v[172:175], v[24:27]
    ds_read_b128 v[132:135], v5 offset:38912
    v_mfma_f32_16x16x32_bf16 v[24:27], v[232:235], v[168:171], v[24:27]
    ds_read_b128 v[120:123], v4 offset:36864
    v_mfma_f32_16x16x32_bf16 v[16:19], v[232:235], v[160:163], v[16:19]
    ds_read_b128 v[124:127], v5 offset:36864
    v_mfma_f32_16x16x32_bf16 v[16:19], v[236:239], v[164:167], v[16:19]
    s_waitcnt lgkmcnt(10)
    v_mfma_f32_16x16x32_bf16 v[20:23], v[204:207], v[164:167], v[20:23]
    ds_read_b64_tr_b16 v[232:233], v7 offset:26624
    v_mfma_f32_16x16x32_bf16 v[20:23], v[200:203], v[160:163], v[20:23]
    ds_read_b64_tr_b16 v[234:235], v7 offset:27136
    v_mfma_f32_16x16x32_bf16 v[28:31], v[200:203], v[168:171], v[28:31]
    ds_read_b64_tr_b16 v[236:237], v7 offset:38912
    v_mfma_f32_16x16x32_bf16 v[28:31], v[204:207], v[172:175], v[28:31]
    ds_read_b64_tr_b16 v[238:239], v7 offset:39424
    v_mfma_f32_16x16x32_bf16 v[36:39], v[204:207], v[180:183], v[36:39]
    v_mfma_f32_16x16x32_bf16 v[36:39], v[200:203], v[176:179], v[36:39]
    v_mfma_f32_16x16x32_bf16 v[44:47], v[200:203], v[184:187], v[44:47]
    v_mfma_f32_16x16x32_bf16 v[44:47], v[204:207], v[188:191], v[44:47]
    s_waitcnt lgkmcnt(7)
    v_mfma_f32_16x16x32_bf16 v[116:119], v[196:199], v[228:231], v[116:119]
    v_mfma_f32_16x16x32_bf16 v[116:119], v[192:195], v[224:227], v[116:119]
    v_mfma_f32_16x16x32_bf16 v[104:107], v[184:187], v[224:227], v[104:107]
    v_mfma_f32_16x16x32_bf16 v[104:107], v[188:191], v[228:231], v[104:107]
    v_mfma_f32_16x16x32_bf16 v[96:99], v[180:183], v[228:231], v[96:99]
    s_waitcnt lgkmcnt(0)
    s_barrier
    v_mfma_f32_16x16x32_bf16 v[96:99], v[176:179], v[224:227], v[96:99]
    ds_read_b64_tr_b16 v[200:201], v6 offset:50176
    v_mfma_f32_16x16x32_bf16 v[88:91], v[168:171], v[224:227], v[88:91]
    ds_read_b64_tr_b16 v[202:203], v6 offset:50688
    v_mfma_f32_16x16x32_bf16 v[88:91], v[172:175], v[228:231], v[88:91]
    ds_read_b64_tr_b16 v[204:205], v6 offset:62464
    v_mfma_f32_16x16x32_bf16 v[80:83], v[164:167], v[228:231], v[80:83]
    ds_read_b64_tr_b16 v[206:207], v6 offset:62976
    v_mfma_f32_16x16x32_bf16 v[80:83], v[160:163], v[224:227], v[80:83]
    v_mfma_f32_16x16x32_bf16 v[84:87], v[160:163], v[232:235], v[84:87]
    ds_read_b64_tr_b16 v[224:225], v7 offset:50176
    v_mfma_f32_16x16x32_bf16 v[84:87], v[164:167], v[236:239], v[84:87]
    ds_read_b64_tr_b16 v[226:227], v7 offset:50688
    v_mfma_f32_16x16x32_bf16 v[92:95], v[172:175], v[236:239], v[92:95]
    ds_read_b64_tr_b16 v[228:229], v7 offset:62464
    v_mfma_f32_16x16x32_bf16 v[92:95], v[168:171], v[232:235], v[92:95]
    ds_read_b64_tr_b16 v[230:231], v7 offset:62976
    v_mfma_f32_16x16x32_bf16 v[100:103], v[176:179], v[232:235], v[100:103]
    v_mfma_f32_16x16x32_bf16 v[100:103], v[180:183], v[236:239], v[100:103]
    v_mfma_f32_16x16x32_bf16 v[108:111], v[188:191], v[236:239], v[108:111]
    v_mfma_f32_16x16x32_bf16 v[108:111], v[184:187], v[232:235], v[108:111]
    s_waitcnt lgkmcnt(4)
    v_mfma_f32_16x16x32_bf16 v[112:115], v[200:203], v[152:155], v[112:115]
    ds_read_b64_tr_b16 v[232:233], v6 offset:49152
    v_mfma_f32_16x16x32_bf16 v[112:115], v[204:207], v[156:159], v[112:115]
    ds_read_b64_tr_b16 v[234:235], v6 offset:49664
    v_mfma_f32_16x16x32_bf16 v[72:75], v[204:207], v[148:151], v[72:75]
    ds_read_b64_tr_b16 v[236:237], v6 offset:61440
    v_mfma_f32_16x16x32_bf16 v[72:75], v[200:203], v[144:147], v[72:75]
    ds_read_b64_tr_b16 v[238:239], v6 offset:61952
    v_mfma_f32_16x16x32_bf16 v[64:67], v[200:203], v[136:139], v[64:67]
    ds_read_b128 v[192:195], v2 offset:0
    v_mfma_f32_16x16x32_bf16 v[64:67], v[204:207], v[140:143], v[64:67]
    ds_read_b128 v[196:199], v3 offset:0
    v_mfma_f32_16x16x32_bf16 v[56:59], v[204:207], v[132:135], v[56:59]
    ds_read_b128 v[184:187], v4 offset:6144
    v_mfma_f32_16x16x32_bf16 v[56:59], v[200:203], v[128:131], v[56:59]
    ds_read_b128 v[188:191], v5 offset:6144
    v_mfma_f32_16x16x32_bf16 v[48:51], v[200:203], v[120:123], v[48:51]
    v_mfma_f32_16x16x32_bf16 v[48:51], v[204:207], v[124:127], v[48:51]
    s_waitcnt lgkmcnt(8)
    v_mfma_f32_16x16x32_bf16 v[52:55], v[228:231], v[124:127], v[52:55]
    ds_read_b64_tr_b16 v[200:201], v7 offset:49152
    v_mfma_f32_16x16x32_bf16 v[52:55], v[224:227], v[120:123], v[52:55]
    ds_read_b64_tr_b16 v[202:203], v7 offset:49664
    v_mfma_f32_16x16x32_bf16 v[60:63], v[224:227], v[128:131], v[60:63]
    ds_read_b64_tr_b16 v[204:205], v7 offset:61440
    v_mfma_f32_16x16x32_bf16 v[60:63], v[228:231], v[132:135], v[60:63]
    ds_read_b64_tr_b16 v[206:207], v7 offset:61952
    v_mfma_f32_16x16x32_bf16 v[68:71], v[228:231], v[140:143], v[68:71]
    ds_read_b128 v[176:179], v4 offset:4096
    v_mfma_f32_16x16x32_bf16 v[68:71], v[224:227], v[136:139], v[68:71]
    ds_read_b128 v[180:183], v5 offset:4096
    v_mfma_f32_16x16x32_bf16 v[76:79], v[224:227], v[144:147], v[76:79]
    ds_read_b128 v[168:171], v4 offset:2048
    v_mfma_f32_16x16x32_bf16 v[76:79], v[228:231], v[148:151], v[76:79]
    s_waitcnt lgkmcnt(11)
    v_mfma_f32_16x16x32_bf16 v[40:43], v[236:239], v[148:151], v[40:43]
    ds_read_b64_tr_b16 v[224:225], v6 offset:51200
    v_mfma_f32_16x16x32_bf16 v[40:43], v[232:235], v[144:147], v[40:43]
    ds_read_b64_tr_b16 v[226:227], v6 offset:51712
    v_mfma_f32_16x16x32_bf16 v[32:35], v[232:235], v[136:139], v[32:35]
    ds_read_b64_tr_b16 v[228:229], v6 offset:63488
    v_mfma_f32_16x16x32_bf16 v[32:35], v[236:239], v[140:143], v[32:35]
    ds_read_b64_tr_b16 v[230:231], v6 offset:64000
    v_mfma_f32_16x16x32_bf16 v[24:27], v[236:239], v[132:135], v[24:27]
    ds_read_b128 v[172:175], v5 offset:2048
    v_mfma_f32_16x16x32_bf16 v[24:27], v[232:235], v[128:131], v[24:27]
    ds_read_b128 v[160:163], v4 offset:0
    v_mfma_f32_16x16x32_bf16 v[16:19], v[232:235], v[120:123], v[16:19]
    ds_read_b128 v[164:167], v5 offset:0
    v_mfma_f32_16x16x32_bf16 v[16:19], v[236:239], v[124:127], v[16:19]
    s_waitcnt lgkmcnt(10)
    v_mfma_f32_16x16x32_bf16 v[20:23], v[204:207], v[124:127], v[20:23]
    ds_read_b64_tr_b16 v[232:233], v7 offset:51200
    v_mfma_f32_16x16x32_bf16 v[20:23], v[200:203], v[120:123], v[20:23]
    ds_read_b64_tr_b16 v[234:235], v7 offset:51712
    v_mfma_f32_16x16x32_bf16 v[28:31], v[200:203], v[128:131], v[28:31]
    ds_read_b64_tr_b16 v[236:237], v7 offset:63488
    v_mfma_f32_16x16x32_bf16 v[28:31], v[204:207], v[132:135], v[28:31]
    ds_read_b64_tr_b16 v[238:239], v7 offset:64000
    v_mfma_f32_16x16x32_bf16 v[36:39], v[204:207], v[140:143], v[36:39]
    v_mfma_f32_16x16x32_bf16 v[36:39], v[200:203], v[136:139], v[36:39]
    v_mfma_f32_16x16x32_bf16 v[44:47], v[200:203], v[144:147], v[44:47]
    v_mfma_f32_16x16x32_bf16 v[44:47], v[204:207], v[148:151], v[44:47]
    s_waitcnt lgkmcnt(7)
    v_mfma_f32_16x16x32_bf16 v[116:119], v[156:159], v[228:231], v[116:119]
    v_mfma_f32_16x16x32_bf16 v[116:119], v[152:155], v[224:227], v[116:119]
    v_mfma_f32_16x16x32_bf16 v[104:107], v[144:147], v[224:227], v[104:107]
    v_mfma_f32_16x16x32_bf16 v[104:107], v[148:151], v[228:231], v[104:107]
    v_mfma_f32_16x16x32_bf16 v[96:99], v[140:143], v[228:231], v[96:99]
    s_waitcnt lgkmcnt(0)
    s_barrier
    s_cmp_lg_u32 s3, 0
    s_cbranch_scc1 LB_sk
    s_waitcnt vmcnt(0)
    v_cmp_eq_u32 vcc, 0, v222
    s_cbranch_vccnz LB_slow
LB_back:
    s_mov_b64 exec, 1
    buffer_store_dword v222, v220, s[52:55], s96 offen sc1
    s_mov_b64 exec, -1
LB_sk:
    v_mfma_f32_16x16x32_bf16 v[96:99], v[136:139], v[224:227], v[96:99]
    ds_read_b64_tr_b16 v[200:201], v6 offset:1024
    v_mfma_f32_16x16x32_bf16 v[88:91], v[128:131], v[224:227], v[88:91]
    ds_read_b64_tr_b16 v[202:203], v6 offset:1536
    v_mfma_f32_16x16x32_bf16 v[88:91], v[132:135], v[228:231], v[88:91]
    ds_read_b64_tr_b16 v[204:205], v6 offset:13312
    v_mfma_f32_16x16x32_bf16 v[80:83], v[124:127], v[228:231], v[80:83]
    ds_read_b64_tr_b16 v[206:207], v6 offset:13824
    v_mfma_f32_16x16x32_bf16 v[80:83], v[120:123], v[224:227], v[80:83]
    v_mfma_f32_16x16x32_bf16 v[84:87], v[120:123], v[232:235], v[84:87]
    ds_read_b64_tr_b16 v[224:225], v7 offset:1024
    v_mfma_f32_16x16x32_bf16 v[84:87], v[124:127], v[236:239], v[84:87]
    ds_read_b64_tr_b16 v[226:227], v7 offset:1536
    v_mfma_f32_16x16x32_bf16 v[92:95], v[132:135], v[236:239], v[92:95]
    ds_read_b64_tr_b16 v[228:229], v7 offset:13312
    v_mfma_f32_16x16x32_bf16 v[92:95], v[128:131], v[232:235], v[92:95]
    ds_read_b64_tr_b16 v[230:231], v7 offset:13824
    v_mfma_f32_16x16x32_bf16 v[100:103], v[136:139], v[232:235], v[100:103]
    v_mfma_f32_16x16x32_bf16 v[100:103], v[140:143], v[236:239], v[100:103]
    v_mfma_f32_16x16x32_bf16 v[108:111], v[148:151], v[236:239], v[108:111]
    v_mfma_f32_16x16x32_bf16 v[108:111], v[144:147], v[232:235], v[108:111]
    s_waitcnt lgkmcnt(4)
    v_mfma_f32_16x16x32_bf16 v[112:115], v[200:203], v[192:195], v[112:115]
    ds_read_b64_tr_b16 v[232:233], v6 offset:0
    v_mfma_f32_16x16x32_bf16 v[112:115], v[204:207], v[196:199], v[112:115]
    ds_read_b64_tr_b16 v[234:235], v6 offset:512
    v_mfma_f32_16x16x32_bf16 v[72:75], v[204:207], v[188:191], v[72:75]
    ds_read_b64_tr_b16 v[236:237], v6 offset:12288
    v_mfma_f32_16x16x32_bf16 v[72:75], v[200:203], v[184:187], v[72:75]
    ds_read_b64_tr_b16 v[238:239], v6 offset:12800
    v_mfma_f32_16x16x32_bf16 v[64:67], v[200:203], v[176:179], v[64:67]
    ds_read_b128 v[152:155], v2 offset:18432
    v_mfma_f32_16x16x32_bf16 v[64:67], v[204:207], v[180:183], v[64:67]
    ds_read_b128 v[156:159], v3 offset:18432
    v_mfma_f32_16x16x32_bf16 v[56:59], v[204:207], v[172:175], v[56:59]
    ds_read_b128 v[144:147], v4 offset:24576
    v_mfma_f32_16x16x32_bf16 v[56:59], v[200:203], v[168:171], v[56:59]
    ds_read_b128 v[148:151], v5 offset:24576
    v_mfma_f32_16x16x32_bf16 v[48:51], v[200:203], v[160:163], v[48:51]
    v_mfma_f32_16x16x32_bf16 v[48:51], v[204:207], v[164:167], v[48:51]
    s_waitcnt lgkmcnt(8)
    v_mfma_f32_16x16x32_bf16 v[52:55], v[228:231], v[164:167], v[52:55]
    ds_read_b64_tr_b16 v[200:201], v7 offset:0
    v_mfma_f32_16x16x32_bf16 v[52:55], v[224:227], v[160:163], v[52:55]
    ds_read_b64_tr_b16 v[202:203], v7 offset:512
    v_mfma_f32_16x16x32_bf16 v[60:63], v[224:227], v[168:171], v[60:63]
    ds_read_b64_tr_b16 v[204:205], v7 offset:12288
    v_mfma_f32_16x16x32_bf16 v[60:63], v[228:231], v[172:175], v[60:63]
    ds_read_b64_tr_b16 v[206:207], v7 offset:12800
    v_mfma_f32_16x16x32_bf16 v[68:71], v[228:231], v[180:183], v[68:71]
    ds_read_b128 v[136:139], v4 offset:22528
    v_mfma_f32_16x16x32_bf16 v[68:71], v[224:227], v[176:179], v[68:71]
    ds_read_b128 v[140:143], v5 offset:22528
    v_mfma_f32_16x16x32_bf16 v[76:79], v[224:227], v[184:187], v[76:79]
    ds_read_b128 v[128:131], v4 offset:20480
    v_mfma_f32_16x16x32_bf16 v[76:79], v[228:231], v[188:191], v[76:79]
    s_waitcnt lgkmcnt(11)
    v_mfma_f32_16x16x32_bf16 v[40:43], v[236:239], v[188:191], v[40:43]
    ds_read_b64_tr_b16 v[224:225], v6 offset:2048
    v_mfma_f32_16x16x32_bf16 v[40:43], v[232:235], v[184:187], v[40:43]
    ds_read_b64_tr_b16 v[226:227], v6 offset:2560
    v_mfma_f32_16x16x32_bf16 v[32:35], v[232:235], v[176:179], v[32:35]
    ds_read_b64_tr_b16 v[228:229], v6 offset:14336
    v_mfma_f32_16x16x32_bf16 v[32:35], v[236:239], v[180:183], v[32:35]
    ds_read_b64_tr_b16 v[230:231], v6 offset:14848
    v_mfma_f32_16x16x32_bf16 v[24:27], v[236:239], v[172:175], v[24:27]
    ds_read_b128 v[132:135], v5 offset:20480
    v_mfma_f32_16x16x32_bf16 v[24:27], v[232:235], v[168:171], v[24:27]
    ds_read_b128 v[120:123], v4 offset:18432
    v_mfma_f32_16x16x32_bf16 v[16:19], v[232:235], v[160:163], v[16:19]
    ds_read_b128 v[124:127], v5 offset:18432
    v_mfma_f32_16x16x32_bf16 v[16:19], v[236:239], v[164:167], v[16:19]
    s_waitcnt lgkmcnt(10)
    v_mfma_f32_16x16x32_bf16 v[20:23], v[204:207], v[164:167], v[20:23]
    ds_read_b64_tr_b16 v[232:233], v7 offset:2048
    v_mfma_f32_16x16x32_bf16 v[20:23], v[200:203], v[160:163], v[20:23]
    ds_read_b64_tr_b16 v[234:235], v7 offset:2560
    v_mfma_f32_16x16x32_bf16 v[28:31], v[200:203], v[168:171], v[28:31]
    ds_read_b64_tr_b16 v[236:237], v7 offset:14336
    v_mfma_f32_16x16x32_bf16 v[28:31], v[204:207], v[172:175], v[28:31]
    ds_read_b64_tr_b16 v[238:239], v7 offset:14848
    v_mfma_f32_16x16x32_bf16 v[36:39], v[204:207], v[180:183], v[36:39]
    v_mfma_f32_16x16x32_bf16 v[36:39], v[200:203], v[176:179], v[36:39]
    v_mfma_f32_16x16x32_bf16 v[44:47], v[200:203], v[184:187], v[44:47]
    v_mfma_f32_16x16x32_bf16 v[44:47], v[204:207], v[188:191], v[44:47]
    s_waitcnt lgkmcnt(7)
    v_mfma_f32_16x16x32_bf16 v[116:119], v[196:199], v[228:231], v[116:119]
    v_mfma_f32_16x16x32_bf16 v[116:119], v[192:195], v[224:227], v[116:119]
    v_mfma_f32_16x16x32_bf16 v[104:107], v[184:187], v[224:227], v[104:107]
    v_mfma_f32_16x16x32_bf16 v[104:107], v[188:191], v[228:231], v[104:107]
    v_mfma_f32_16x16x32_bf16 v[96:99], v[180:183], v[228:231], v[96:99]
    s_waitcnt lgkmcnt(0)
    s_barrier
    v_mfma_f32_16x16x32_bf16 v[96:99], v[176:179], v[224:227], v[96:99]
    ds_read_b64_tr_b16 v[200:201], v6 offset:25600
    v_mfma_f32_16x16x32_bf16 v[88:91], v[168:171], v[224:227], v[88:91]
    ds_read_b64_tr_b16 v[202:203], v6 offset:26112
    v_mfma_f32_16x16x32_bf16 v[88:91], v[172:175], v[228:231], v[88:91]
    ds_read_b64_tr_b16 v[204:205], v6 offset:37888
    v_mfma_f32_16x16x32_bf16 v[80:83], v[164:167], v[228:231], v[80:83]
    ds_read_b64_tr_b16 v[206:207], v6 offset:38400
    v_mfma_f32_16x16x32_bf16 v[80:83], v[160:163], v[224:227], v[80:83]
    v_mfma_f32_16x16x32_bf16 v[84:87], v[160:163], v[232:235], v[84:87]
    ds_read_b64_tr_b16 v[224:225], v7 offset:25600
    v_mfma_f32_16x16x32_bf16 v[84:87], v[164:167], v[236:239], v[84:87]
    ds_read_b64_tr_b16 v[226:227], v7 offset:26112
    v_mfma_f32_16x16x32_bf16 v[92:95], v[172:175], v[236:239], v[92:95]
    ds_read_b64_tr_b16 v[228:229], v7 offset:37888
    v_mfma_f32_16x16x32_bf16 v[92:95], v[168:171], v[232:235], v[92:95]
    ds_read_b64_tr_b16 v[230:231], v7 offset:38400
    v_mfma_f32_16x16x32_bf16 v[100:103], v[176:179], v[232:235], v[100:103]
    v_mfma_f32_16x16x32_bf16 v[100:103], v[180:183], v[236:239], v[100:103]
    v_mfma_f32_16x16x32_bf16 v[108:111], v[188:191], v[236:239], v[108:111]
    v_mfma_f32_16x16x32_bf16 v[108:111], v[184:187], v[232:235], v[108:111]
    s_waitcnt lgkmcnt(4)
    v_mfma_f32_16x16x32_bf16 v[112:115], v[200:203], v[152:155], v[112:115]
    ds_read_b64_tr_b16 v[232:233], v6 offset:24576
    v_mfma_f32_16x16x32_bf16 v[112:115], v[204:207], v[156:159], v[112:115]
    ds_read_b64_tr_b16 v[234:235], v6 offset:25088
    v_mfma_f32_16x16x32_bf16 v[72:75], v[204:207], v[148:151], v[72:75]
    ds_read_b64_tr_b16 v[236:237], v6 offset:36864
    v_mfma_f32_16x16x32_bf16 v[72:75], v[200:203], v[144:147], v[72:75]
    ds_read_b64_tr_b16 v[238:239], v6 offset:37376
    v_mfma_f32_16x16x32_bf16 v[64:67], v[200:203], v[136:139], v[64:67]
    ds_read_b128 v[192:195], v2 offset:36864
    v_mfma_f32_16x16x32_bf16 v[64:67], v[204:207], v[140:143], v[64:67]
    ds_read_b128 v[196:199], v3 offset:36864
    v_mfma_f32_16x16x32_bf16 v[56:59], v[204:207], v[132:135], v[56:59]
    ds_read_b128 v[184:187], v4 offset:43008
    v_mfma_f32_16x16x32_bf16 v[56:59], v[200:203], v[128:131], v[56:59]
    ds_read_b128 v[188:191], v5 offset:43008
    v_mfma_f32_16x16x32_bf16 v[48:51], v[200:203], v[120:123], v[48:51]
    v_mfma_f32_16x16x32_bf16 v[48:51], v[204:207], v[124:127], v[48:51]
    s_waitcnt lgkmcnt(8)
    v_mfma_f32_16x16x32_bf16 v[52:55], v[228:231], v[124:127], v[52:55]
    ds_read_b64_tr_b16 v[200:201], v7 offset:24576
    v_mfma_f32_16x16x32_bf16 v[52:55], v[224:227], v[120:123], v[52:55]
    ds_read_b64_tr_b16 v[202:203], v7 offset:25088
    v_mfma_f32_16x16x32_bf16 v[60:63], v[224:227], v[128:131], v[60:63]
    ds_read_b64_tr_b16 v[204:205], v7 offset:36864
    v_mfma_f32_16x16x32_bf16 v[60:63], v[228:231], v[132:135], v[60:63]
    ds_read_b64_tr_b16 v[206:207], v7 offset:37376
    v_mfma_f32_16x16x32_bf16 v[68:71], v[228:231], v[140:143], v[68:71]
    ds_read_b128 v[176:179], v4 offset:40960
    v_mfma_f32_16x16x32_bf16 v[68:71], v[224:227], v[136:139], v[68:71]
    ds_read_b128 v[180:183], v5 offset:40960
    v_mfma_f32_16x16x32_bf16 v[76:79], v[224:227], v[144:147], v[76:79]
    ds_read_b128 v[168:171], v4 offset:38912
    v_mfma_f32_16x16x32_bf16 v[76:79], v[228:231], v[148:151], v[76:79]
    s_waitcnt lgkmcnt(11)
    v_mfma_f32_16x16x32_bf16 v[40:43], v[236:239], v[148:151], v[40:43]
    ds_read_b64_tr_b16 v[224:225], v6 offset:26624
    v_mfma_f32_16x16x32_bf16 v[40:43], v[232:235], v[144:147], v[40:43]
    ds_read_b64_tr_b16 v[226:227], v6 offset:27136
    v_mfma_f32_16x16x32_bf16 v[32:35], v[232:235], v[136:139], v[32:35]
    ds_read_b64_tr_b16 v[228:229], v6 offset:38912
    v_mfma_f32_16x16x32_bf16 v[32:35], v[236:239], v[140:143], v[32:35]
    ds_read_b64_tr_b16 v[230:231], v6 offset:39424
    v_mfma_f32_16x16x32_bf16 v[24:27], v[236:239], v[132:135], v[24:27]
    ds_read_b128 v[172:175], v5 offset:38912
    v_mfma_f32_16x16x32_bf16 v[24:27], v[232:235], v[128:131], v[24:27]
    ds_read_b128 v[160:163], v4 offset:36864
    v_mfma_f32_16x16x32_bf16 v[16:19], v[232:235], v[120:123], v[16:19]
    ds_read_b128 v[164:167], v5 offset:36864
    v_mfma_f32_16x16x32_bf16 v[16:19], v[236:239], v[124:127], v[16:19]
    s_waitcnt lgkmcnt(10)
    v_mfma_f32_16x16x32_bf16 v[20:23], v[204:207], v[124:127], v[20:23]
    ds_read_b64_tr_b16 v[232:233], v7 offset:26624
    v_mfma_f32_16x16x32_bf16 v[20:23], v[200:203], v[120:123], v[20:23]
    ds_read_b64_tr_b16 v[234:235], v7 offset:27136
    v_mfma_f32_16x16x32_bf16 v[28:31], v[200:203], v[128:131], v[28:31]
    ds_read_b64_tr_b16 v[236:237], v7 offset:38912
    v_mfma_f32_16x16x32_bf16 v[28:31], v[204:207], v[132:135], v[28:31]
    ds_read_b64_tr_b16 v[238:239], v7 offset:39424
    v_mfma_f32_16x16x32_bf16 v[36:39], v[204:207], v[140:143], v[36:39]
    v_mfma_f32_16x16x32_bf16 v[36:39], v[200:203], v[136:139], v[36:39]
    v_mfma_f32_16x16x32_bf16 v[44:47], v[200:203], v[144:147], v[44:47]
    v_mfma_f32_16x16x32_bf16 v[44:47], v[204:207], v[148:151], v[44:47]
    s_waitcnt lgkmcnt(7)
    v_mfma_f32_16x16x32_bf16 v[116:119], v[156:159], v[228:231], v[116:119]
    v_mfma_f32_16x16x32_bf16 v[116:119], v[152:155], v[224:227], v[116:119]
    v_mfma_f32_16x16x32_bf16 v[104:107], v[144:147], v[224:227], v[104:107]
    v_mfma_f32_16x16x32_bf16 v[104:107], v[148:151], v[228:231], v[104:107]
    v_mfma_f32_16x16x32_bf16 v[96:99], v[140:143], v[228:231], v[96:99]
    s_waitcnt lgkmcnt(0)
    s_barrier
    v_mfma_f32_16x16x32_bf16 v[96:99], v[136:139], v[224:227], v[96:99]
    ds_read_b64_tr_b16 v[200:201], v6 offset:50176
    v_mfma_f32_16x16x32_bf16 v[88:91], v[128:131], v[224:227], v[88:91]
    ds_read_b64_tr_b16 v[202:203], v6 offset:50688
    v_mfma_f32_16x16x32_bf16 v[88:91], v[132:135], v[228:231], v[88:91]
    ds_read_b64_tr_b16 v[204:205], v6 offset:62464
    v_mfma_f32_16x16x32_bf16 v[80:83], v[124:127], v[228:231], v[80:83]
    ds_read_b64_tr_b16 v[206:207], v6 offset:62976
    v_mfma_f32_16x16x32_bf16 v[80:83], v[120:123], v[224:227], v[80:83]
    v_mfma_f32_16x16x32_bf16 v[84:87], v[120:123], v[232:235], v[84:87]
    ds_read_b64_tr_b16 v[224:225], v7 offset:50176
    v_mfma_f32_16x16x32_bf16 v[84:87], v[124:127], v[236:239], v[84:87]
    ds_read_b64_tr_b16 v[226:227], v7 offset:50688
    v_mfma_f32_16x16x32_bf16 v[92:95], v[132:135], v[236:239], v[92:95]
    ds_read_b64_tr_b16 v[228:229], v7 offset:62464
    v_mfma_f32_16x16x32_bf16 v[92:95], v[128:131], v[232:235], v[92:95]
    ds_read_b64_tr_b16 v[230:231], v7 offset:62976
    v_mfma_f32_16x16x32_bf16 v[100:103], v[136:139], v[232:235], v[100:103]
    v_mfma_f32_16x16x32_bf16 v[100:103], v[140:143], v[236:239], v[100:103]
    v_mfma_f32_16x16x32_bf16 v[108:111], v[148:151], v[236:239], v[108:111]
    v_mfma_f32_16x16x32_bf16 v[108:111], v[144:147], v[232:235], v[108:111]
    s_waitcnt lgkmcnt(4)
    v_mfma_f32_16x16x32_bf16 v[112:115], v[200:203], v[192:195], v[112:115]
    ds_read_b64_tr_b16 v[232:233], v6 offset:49152
    v_mfma_f32_16x16x32_bf16 v[112:115], v[204:207], v[196:199], v[112:115]
    ds_read_b64_tr_b16 v[234:235], v6 offset:49664
    v_mfma_f32_16x16x32_bf16 v[72:75], v[204:207], v[188:191], v[72:75]
    ds_read_b64_tr_b16 v[236:237], v6 offset:61440
    v_mfma_f32_16x16x32_bf16 v[72:75], v[200:203], v[184:187], v[72:75]
    ds_read_b64_tr_b16 v[238:239], v6 offset:61952
    v_mfma_f32_16x16x32_bf16 v[64:67], v[200:203], v[176:179], v[64:67]
    ds_read_b128 v[152:155], v2 offset:0
    v_mfma_f32_16x16x32_bf16 v[64:67], v[204:207], v[180:183], v[64:67]
    ds_read_b128 v[156:159], v3 offset:0
    v_mfma_f32_16x16x32_bf16 v[56:59], v[204:207], v[172:175], v[56:59]
    ds_read_b128 v[144:147], v4 offset:6144
    v_mfma_f32_16x16x32_bf16 v[56:59], v[200:203], v[168:171], v[56:59]
    ds_read_b128 v[148:151], v5 offset:6144
    v_mfma_f32_16x16x32_bf16 v[48:51], v[200:203], v[160:163], v[48:51]
    v_mfma_f32_16x16x32_bf16 v[48:51], v[204:207], v[164:167], v[48:51]
    s_waitcnt lgkmcnt(8)
    v_mfma_f32_16x16x32_bf16 v[52:55], v[228:231], v[164:167], v[52:55]
    ds_read_b64_tr_b16 v[200:201], v7 offset:49152
    v_mfma_f32_16x16x32_bf16 v[52:55], v[224:227], v[160:163], v[52:55]
    ds_read_b64_tr_b16 v[202:203], v7 offset:49664
    v_mfma_f32_16x16x32_bf16 v[60:63], v[224:227], v[168:171], v[60:63]
    ds_read_b64_tr_b16 v[204:205], v7 offset:61440
    v_mfma_f32_16x16x32_bf16 v[60:63], v[228:231], v[172:175], v[60:63]
    ds_read_b64_tr_b16 v[206:207], v7 offset:61952
    v_mfma_f32_16x16x32_bf16 v[68:71], v[228:231], v[180:183], v[68:71]
    ds_read_b128 v[136:139], v4 offset:4096
    v_mfma_f32_16x16x32_bf16 v[68:71], v[224:227], v[176:179], v[68:71]
    ds_read_b128 v[140:143], v5 offset:4096
    v_mfma_f32_16x16x32_bf16 v[76:79], v[224:227], v[184:187], v[76:79]
    ds_read_b128 v[128:131], v4 offset:2048
    v_mfma_f32_16x16x32_bf16 v[76:79], v[228:231], v[188:191], v[76:79]
    s_waitcnt lgkmcnt(11)
    v_mfma_f32_16x16x32_bf16 v[40:43], v[236:239], v[188:191], v[40:43]
    ds_read_b64_tr_b16 v[224:225], v6 offset:51200
    v_mfma_f32_16x16x32_bf16 v[40:43], v[232:235], v[184:187], v[40:43]
    ds_read_b64_tr_b16 v[226:227], v6 offset:51712
    v_mfma_f32_16x16x32_bf16 v[32:35], v[232:235], v[176:179], v[32:35]
    ds_read_b64_tr_b16 v[228:229], v6 offset:63488
    v_mfma_f32_16x16x32_bf16 v[32:35], v[236:239], v[180:183], v[32:35]
    ds_read_b64_tr_b16 v[230:231], v6 offset:64000
    v_mfma_f32_16x16x32_bf16 v[24:27], v[236:239], v[172:175], v[24:27]
    ds_read_b128 v[132:135], v5 offset:2048
    v_mfma_f32_16x16x32_bf16 v[24:27], v[232:235], v[168:171], v[24:27]
    ds_read_b128 v[120:123], v4 offset:0
    v_mfma_f32_16x16x32_bf16 v[16:19], v[232:235], v[160:163], v[16:19]
    ds_read_b128 v[124:127], v5 offset:0
    v_mfma_f32_16x16x32_bf16 v[16:19], v[236:239], v[164:167], v[16:19]
    s_waitcnt lgkmcnt(10)
    v_mfma_f32_16x16x32_bf16 v[20:23], v[204:207], v[164:167], v[20:23]
    ds_read_b64_tr_b16 v[232:233], v7 offset:51200
    v_mfma_f32_16x16x32_bf16 v[20:23], v[200:203], v[160:163], v[20:23]
    ds_read_b64_tr_b16 v[234:235], v7 offset:51712
    v_mfma_f32_16x16x32_bf16 v[28:31], v[200:203], v[168:171], v[28:31]
    ds_read_b64_tr_b16 v[236:237], v7 offset:63488
    v_mfma_f32_16x16x32_bf16 v[28:31], v[204:207], v[172:175], v[28:31]
    ds_read_b64_tr_b16 v[238:239], v7 offset:64000
    v_mfma_f32_16x16x32_bf16 v[36:39], v[204:207], v[180:183], v[36:39]
    v_mfma_f32_16x16x32_bf16 v[36:39], v[200:203], v[176:179], v[36:39]
    v_mfma_f32_16x16x32_bf16 v[44:47], v[200:203], v[184:187], v[44:47]
    v_mfma_f32_16x16x32_bf16 v[44:47], v[204:207], v[188:191], v[44:47]
    s_waitcnt lgkmcnt(7)
    v_mfma_f32_16x16x32_bf16 v[116:119], v[196:199], v[228:231], v[116:119]
    v_mfma_f32_16x16x32_bf16 v[116:119], v[192:195], v[224:227], v[116:119]
    v_mfma_f32_16x16x32_bf16 v[104:107], v[184:187], v[224:227], v[104:107]
    v_mfma_f32_16x16x32_bf16 v[104:107], v[188:191], v[228:231], v[104:107]
    v_mfma_f32_16x16x32_bf16 v[96:99], v[180:183], v[228:231], v[96:99]
    s_waitcnt lgkmcnt(0)
    s_barrier
    v_mfma_f32_16x16x32_bf16 v[96:99], v[176:179], v[224:227], v[96:99]
    ds_read_b64_tr_b16 v[200:201], v6 offset:1024
    v_mfma_f32_16x16x32_bf16 v[88:91], v[168:171], v[224:227], v[88:91]
    ds_read_b64_tr_b16 v[202:203], v6 offset:1536
    v_mfma_f32_16x16x32_bf16 v[88:91], v[172:175], v[228:231], v[88:91]
    ds_read_b64_tr_b16 v[204:205], v6 offset:13312
    v_mfma_f32_16x16x32_bf16 v[80:83], v[164:167], v[228:231], v[80:83]
    ds_read_b64_tr_b16 v[206:207], v6 offset:13824
    v_mfma_f32_16x16x32_bf16 v[80:83], v[160:163], v[224:227], v[80:83]
    v_mfma_f32_16x16x32_bf16 v[84:87], v[160:163], v[232:235], v[84:87]
    ds_read_b64_tr_b16 v[224:225], v7 offset:1024
    v_mfma_f32_16x16x32_bf16 v[84:87], v[164:167], v[236:239], v[84:87]
    ds_read_b64_tr_b16 v[226:227], v7 offset:1536
    v_mfma_f32_16x16x32_bf16 v[92:95], v[172:175], v[236:239], v[92:95]
    ds_read_b64_tr_b16 v[228:229], v7 offset:13312
    v_mfma_f32_16x16x32_bf16 v[92:95], v[168:171], v[232:235], v[92:95]
    ds_read_b64_tr_b16 v[230:231], v7 offset:13824
    v_mfma_f32_16x16x32_bf16 v[100:103], v[176:179], v[232:235], v[100:103]
    v_mfma_f32_16x16x32_bf16 v[100:103], v[180:183], v[236:239], v[100:103]
    v_mfma_f32_16x16x32_bf16 v[108:111], v[188:191], v[236:239], v[108:111]
    v_mfma_f32_16x16x32_bf16 v[108:111], v[184:187], v[232:235], v[108:111]
    s_waitcnt lgkmcnt(4)
    v_mfma_f32_16x16x32_bf16 v[112:115], v[200:203], v[152:155], v[112:115]
    ds_read_b64_tr_b16 v[232:233], v6 offset:0
    v_mfma_f32_16x16x32_bf16 v[112:115], v[204:207], v[156:159], v[112:115]
    ds_read_b64_tr_b16 v[234:235], v6 offset:512
    v_mfma_f32_16x16x32_bf16 v[72:75], v[204:207], v[148:151], v[72:75]
    ds_read_b64_tr_b16 v[236:237], v6 offset:12288
    v_mfma_f32_16x16x32_bf16 v[72:75], v[200:203], v[144:147], v[72:75]
    ds_read_b64_tr_b16 v[238:239], v6 offset:12800
    v_mfma_f32_16x16x32_bf16 v[64:67], v[200:203], v[136:139], v[64:67]
    ds_read_b128 v[192:195], v2 offset:18432
    v_mfma_f32_16x16x32_bf16 v[64:67], v[204:207], v[140:143], v[64:67]
    ds_read_b128 v[196:199], v3 offset:18432
    v_mfma_f32_16x16x32_bf16 v[56:59], v[204:207], v[132:135], v[56:59]
    ds_read_b128 v[184:187], v4 offset:24576
    v_mfma_f32_16x16x32_bf16 v[56:59], v[200:203], v[128:131], v[56:59]
    ds_read_b128 v[188:191], v5 offset:24576
    v_mfma_f32_16x16x32_bf16 v[48:51], v[200:203], v[120:123], v[48:51]
    v_mfma_f32_16x16x32_bf16 v[48:51], v[204:207], v[124:127], v[48:51]
    s_waitcnt lgkmcnt(8)
    v_mfma_f32_16x16x32_bf16 v[52:55], v[228:231], v[124:127], v[52:55]
    ds_read_b64_tr_b16 v[200:201], v7 offset:0
    v_mfma_f32_16x16x32_bf16 v[52:55], v[224:227], v[120:123], v[52:55]
    ds_read_b64_tr_b16 v[202:203], v7 offset:512
    v_mfma_f32_16x16x32_bf16 v[60:63], v[224:227], v[128:131], v[60:63]
    ds_read_b64_tr_b16 v[204:205], v7 offset:12288
    v_mfma_f32_16x16x32_bf16 v[60:63], v[228:231], v[132:135], v[60:63]
    ds_read_b64_tr_b16 v[206:207], v7 offset:12800
    v_mfma_f32_16x16x32_bf16 v[68:71], v[228:231], v[140:143], v[68:71]
    ds_read_b128 v[176:179], v4 offset:22528
    v_mfma_f32_16x16x32_bf16 v[68:71], v[224:227], v[136:139], v[68:71]
    ds_read_b128 v[180:183], v5 offset:22528
    v_mfma_f32_16x16x32_bf16 v[76:79], v[224:227], v[144:147], v[76:79]
    ds_read_b128 v[168:171], v4 offset:20480
    v_mfma_f32_16x16x32_bf16 v[76:79], v[228:231], v[148:151], v[76:79]
    s_waitcnt lgkmcnt(11)
    v_mfma_f32_16x16x32_bf16 v[40:43], v[236:239], v[148:151], v[40:43]
    ds_read_b64_tr_b16 v[224:225], v6 offset:2048
    v_mfma_f32_16x16x32_bf16 v[40:43], v[232:235], v[144:147], v[40:43]
    ds_read_b64_tr_b16 v[226:227], v6 offset:2560
    v_mfma_f32_16x16x32_bf16 v[32:35], v[232:235], v[136:139], v[32:35]
    ds_read_b64_tr_b16 v[228:229], v6 offset:14336
    v_mfma_f32_16x16x32_bf16 v[32:35], v[236:239], v[140:143], v[32:35]
    ds_read_b64_tr_b16 v[230:231], v6 offset:14848
    v_mfma_f32_16x16x32_bf16 v[24:27], v[236:239], v[132:135], v[24:27]
    ds_read_b128 v[172:175], v5 offset:20480
    v_mfma_f32_16x16x32_bf16 v[24:27], v[232:235], v[128:131], v[24:27]
    ds_read_b128 v[160:163], v4 offset:18432
    v_mfma_f32_16x16x32_bf16 v[16:19], v[232:235], v[120:123], v[16:19]
    ds_read_b128 v[164:167], v5 offset:18432
    v_mfma_f32_16x16x32_bf16 v[16:19], v[236:239], v[124:127], v[16:19]
    s_waitcnt lgkmcnt(10)
    v_mfma_f32_16x16x32_bf16 v[20:23], v[204:207], v[124:127], v[20:23]
    ds_read_b64_tr_b16 v[232:233], v7 offset:2048
    v_mfma_f32_16x16x32_bf16 v[20:23], v[200:203], v[120:123], v[20:23]
    ds_read_b64_tr_b16 v[234:235], v7 offset:2560
    v_mfma_f32_16x16x32_bf16 v[28:31], v[200:203], v[128:131], v[28:31]
    ds_read_b64_tr_b16 v[236:237], v7 offset:14336
    v_mfma_f32_16x16x32_bf16 v[28:31], v[204:207], v[132:135], v[28:31]
    ds_read_b64_tr_b16 v[238:239], v7 offset:14848
    v_mfma_f32_16x16x32_bf16 v[36:39], v[204:207], v[140:143], v[36:39]
    v_mfma_f32_16x16x32_bf16 v[36:39], v[200:203], v[136:139], v[36:39]
    v_mfma_f32_16x16x32_bf16 v[44:47], v[200:203], v[144:147], v[44:47]
    v_mfma_f32_16x16x32_bf16 v[44:47], v[204:207], v[148:151], v[44:47]
    s_waitcnt lgkmcnt(7)
    v_mfma_f32_16x16x32_bf16 v[116:119], v[156:159], v[228:231], v[116:119]
    v_mfma_f32_16x16x32_bf16 v[116:119], v[152:155], v[224:227], v[116:119]
    v_mfma_f32_16x16x32_bf16 v[104:107], v[144:147], v[224:227], v[104:107]
    v_mfma_f32_16x16x32_bf16 v[104:107], v[148:151], v[228:231], v[104:107]
    v_mfma_f32_16x16x32_bf16 v[96:99], v[140:143], v[228:231], v[96:99]
    s_waitcnt lgkmcnt(0)
    s_barrier
    v_mfma_f32_16x16x32_bf16 v[96:99], v[136:139], v[224:227], v[96:99]
    ds_read_b64_tr_b16 v[200:201], v6 offset:25600
    v_mfma_f32_16x16x32_bf16 v[88:91], v[128:131], v[224:227], v[88:91]
    ds_read_b64_tr_b16 v[202:203], v6 offset:26112
    v_mfma_f32_16x16x32_bf16 v[88:91], v[132:135], v[228:231], v[88:91]
    ds_read_b64_tr_b16 v[204:205], v6 offset:37888
    v_mfma_f32_16x16x32_bf16 v[80:83], v[124:127], v[228:231], v[80:83]
    ds_read_b64_tr_b16 v[206:207], v6 offset:38400
    v_mfma_f32_16x16x32_bf16 v[80:83], v[120:123], v[224:227], v[80:83]
    v_mfma_f32_16x16x32_bf16 v[84:87], v[120:123], v[232:235], v[84:87]
    ds_read_b64_tr_b16 v[224:225], v7 offset:25600
    v_mfma_f32_16x16x32_bf16 v[84:87], v[124:127], v[236:239], v[84:87]
    ds_read_b64_tr_b16 v[226:227], v7 offset:26112
    v_mfma_f32_16x16x32_bf16 v[92:95], v[132:135], v[236:239], v[92:95]
    ds_read_b64_tr_b16 v[228:229], v7 offset:37888
    v_mfma_f32_16x16x32_bf16 v[92:95], v[128:131], v[232:235], v[92:95]
    ds_read_b64_tr_b16 v[230:231], v7 offset:38400
    v_mfma_f32_16x16x32_bf16 v[100:103], v[136:139], v[232:235], v[100:103]
    v_mfma_f32_16x16x32_bf16 v[100:103], v[140:143], v[236:239], v[100:103]
    v_mfma_f32_16x16x32_bf16 v[108:111], v[148:151], v[236:239], v[108:111]
    v_mfma_f32_16x16x32_bf16 v[108:111], v[144:147], v[232:235], v[108:111]
    s_waitcnt lgkmcnt(4)
    v_mfma_f32_16x16x32_bf16 v[112:115], v[200:203], v[192:195], v[112:115]
    ds_read_b64_tr_b16 v[232:233], v6 offset:24576
    v_mfma_f32_16x16x32_bf16 v[112:115], v[204:207], v[196:199], v[112:115]
    ds_read_b64_tr_b16 v[234:235], v6 offset:25088
    v_mfma_f32_16x16x32_bf16 v[72:75], v[204:207], v[188:191], v[72:75]
    ds_read_b64_tr_b16 v[236:237], v6 offset:36864
    v_mfma_f32_16x16x32_bf16 v[72:75], v[200:203], v[184:187], v[72:75]
    ds_read_b64_tr_b16 v[238:239], v6 offset:37376
    v_mfma_f32_16x16x32_bf16 v[64:67], v[200:203], v[176:179], v[64:67]
    ds_read_b128 v[152:155], v2 offset:36864
    v_mfma_f32_16x16x32_bf16 v[64:67], v[204:207], v[180:183], v[64:67]
    ds_read_b128 v[156:159], v3 offset:36864
    v_mfma_f32_16x16x32_bf16 v[56:59], v[204:207], v[172:175], v[56:59]
    ds_read_b128 v[144:147], v4 offset:43008
    v_mfma_f32_16x16x32_bf16 v[56:59], v[200:203], v[168:171], v[56:59]
    ds_read_b128 v[148:151], v5 offset:43008
    v_mfma_f32_16x16x32_bf16 v[48:51], v[200:203], v[160:163], v[48:51]
    v_mfma_f32_16x16x32_bf16 v[48:51], v[204:207], v[164:167], v[48:51]
    s_waitcnt lgkmcnt(8)
    v_mfma_f32_16x16x32_bf16 v[52:55], v[228:231], v[164:167], v[52:55]
    ds_read_b64_tr_b16 v[200:201], v7 offset:24576
    v_mfma_f32_16x16x32_bf16 v[52:55], v[224:227], v[160:163], v[52:55]
    ds_read_b64_tr_b16 v[202:203], v7 offset:25088
    v_mfma_f32_16x16x32_bf16 v[60:63], v[224:227], v[168:171], v[60:63]
    ds_read_b64_tr_b16 v[204:205], v7 offset:36864
    v_mfma_f32_16x16x32_bf16 v[60:63], v[228:231], v[172:175], v[60:63]
    ds_read_b64_tr_b16 v[206:207], v7 offset:37376
    v_mfma_f32_16x16x32_bf16 v[68:71], v[228:231], v[180:183], v[68:71]
    ds_read_b128 v[136:139], v4 offset:40960
    v_mfma_f32_16x16x32_bf16 v[68:71], v[224:227], v[176:179], v[68:71]
    ds_read_b128 v[140:143], v5 offset:40960
    v_mfma_f32_16x16x32_bf16 v[76:79], v[224:227], v[184:187], v[76:79]
    ds_read_b128 v[128:131], v4 offset:38912
    v_mfma_f32_16x16x32_bf16 v[76:79], v[228:231], v[188:191], v[76:79]
    s_waitcnt lgkmcnt(11)
    v_mfma_f32_16x16x32_bf16 v[40:43], v[236:239], v[188:191], v[40:43]
    ds_read_b64_tr_b16 v[224:225], v6 offset:26624
    v_mfma_f32_16x16x32_bf16 v[40:43], v[232:235], v[184:187], v[40:43]
    ds_read_b64_tr_b16 v[226:227], v6 offset:27136
    v_mfma_f32_16x16x32_bf16 v[32:35], v[232:235], v[176:179], v[32:35]
    ds_read_b64_tr_b16 v[228:229], v6 offset:38912
    v_mfma_f32_16x16x32_bf16 v[32:35], v[236:239], v[180:183], v[32:35]
    ds_read_b64_tr_b16 v[230:231], v6 offset:39424
    v_mfma_f32_16x16x32_bf16 v[24:27], v[236:239], v[172:175], v[24:27]
    ds_read_b128 v[132:135], v5 offset:38912
    v_mfma_f32_16x16x32_bf16 v[24:27], v[232:235], v[168:171], v[24:27]
    ds_read_b128 v[120:123], v4 offset:36864
    v_mfma_f32_16x16x32_bf16 v[16:19], v[232:235], v[160:163], v[16:19]
    ds_read_b128 v[124:127], v5 offset:36864
    v_mfma_f32_16x16x32_bf16 v[16:19], v[236:239], v[164:167], v[16:19]
    s_waitcnt lgkmcnt(10)
    v_mfma_f32_16x16x32_bf16 v[20:23], v[204:207], v[164:167], v[20:23]
    ds_read_b64_tr_b16 v[232:233], v7 offset:26624
    v_mfma_f32_16x16x32_bf16 v[20:23], v[200:203], v[160:163], v[20:23]
    ds_read_b64_tr_b16 v[234:235], v7 offset:27136
    v_mfma_f32_16x16x32_bf16 v[28:31], v[200:203], v[168:171], v[28:31]
    ds_read_b64_tr_b16 v[236:237], v7 offset:38912
    v_mfma_f32_16x16x32_bf16 v[28:31], v[204:207], v[172:175], v[28:31]
    ds_read_b64_tr_b16 v[238:239], v7 offset:39424
    v_mfma_f32_16x16x32_bf16 v[36:39], v[204:207], v[180:183], v[36:39]
    v_mfma_f32_16x16x32_bf16 v[36:39], v[200:203], v[176:179], v[36:39]
    v_mfma_f32_16x16x32_bf16 v[44:47], v[200:203], v[184:187], v[44:47]
    v_mfma_f32_16x16x32_bf16 v[44:47], v[204:207], v[188:191], v[44:47]
    s_waitcnt lgkmcnt(7)
    v_mfma_f32_16x16x32_bf16 v[116:119], v[196:199], v[228:231], v[116:119]
    v_mfma_f32_16x16x32_bf16 v[116:119], v[192:195], v[224:227], v[116:119]
    v_mfma_f32_16x16x32_bf16 v[104:107], v[184:187], v[224:227], v[104:107]
    v_mfma_f32_16x16x32_bf16 v[104:107], v[188:191], v[228:231], v[104:107]
    v_mfma_f32_16x16x32_bf16 v[96:99], v[180:183], v[228:231], v[96:99]
    s_waitcnt lgkmcnt(0)
    s_barrier
    v_mfma_f32_16x16x32_bf16 v[96:99], v[176:179], v[224:227], v[96:99]
    ds_read_b64_tr_b16 v[200:201], v6 offset:50176
    v_mfma_f32_16x16x32_bf16 v[88:91], v[168:171], v[224:227], v[88:91]
    ds_read_b64_tr_b16 v[202:203], v6 offset:50688
    v_mfma_f32_16x16x32_bf16 v[88:91], v[172:175], v[228:231], v[88:91]
    ds_read_b64_tr_b16 v[204:205], v6 offset:62464
    v_mfma_f32_16x16x32_bf16 v[80:83], v[164:167], v[228:231], v[80:83]
    ds_read_b64_tr_b16 v[206:207], v6 offset:62976
    v_mfma_f32_16x16x32_bf16 v[80:83], v[160:163], v[224:227], v[80:83]
    v_mfma_f32_16x16x32_bf16 v[84:87], v[160:163], v[232:235], v[84:87]
    ds_read_b64_tr_b16 v[224:225], v7 offset:50176
    v_mfma_f32_16x16x32_bf16 v[84:87], v[164:167], v[236:239], v[84:87]
    ds_read_b64_tr_b16 v[226:227], v7 offset:50688
    v_mfma_f32_16x16x32_bf16 v[92:95], v[172:175], v[236:239], v[92:95]
    ds_read_b64_tr_b16 v[228:229], v7 offset:62464
    v_mfma_f32_16x16x32_bf16 v[92:95], v[168:171], v[232:235], v[92:95]
    ds_read_b64_tr_b16 v[230:231], v7 offset:62976
    v_mfma_f32_16x16x32_bf16 v[100:103], v[176:179], v[232:235], v[100:103]
    v_mfma_f32_16x16x32_bf16 v[100:103], v[180:183], v[236:239], v[100:103]
    v_mfma_f32_16x16x32_bf16 v[108:111], v[188:191], v[236:239], v[108:111]
    v_mfma_f32_16x16x32_bf16 v[108:111], v[184:187], v[232:235], v[108:111]
    s_waitcnt lgkmcnt(4)
    v_mfma_f32_16x16x32_bf16 v[112:115], v[200:203], v[152:155], v[112:115]
    ds_read_b64_tr_b16 v[232:233], v6 offset:49152
    v_mfma_f32_16x16x32_bf16 v[112:115], v[204:207], v[156:159], v[112:115]
    ds_read_b64_tr_b16 v[234:235], v6 offset:49664
    v_mfma_f32_16x16x32_bf16 v[72:75], v[204:207], v[148:151], v[72:75]
    ds_read_b64_tr_b16 v[236:237], v6 offset:61440
    v_mfma_f32_16x16x32_bf16 v[72:75], v[200:203], v[144:147], v[72:75]
    ds_read_b64_tr_b16 v[238:239], v6 offset:61952
    v_mfma_f32_16x16x32_bf16 v[64:67], v[200:203], v[136:139], v[64:67]
    v_mfma_f32_16x16x32_bf16 v[64:67], v[204:207], v[140:143], v[64:67]
    v_mfma_f32_16x16x32_bf16 v[56:59], v[204:207], v[132:135], v[56:59]
    v_mfma_f32_16x16x32_bf16 v[56:59], v[200:203], v[128:131], v[56:59]
    v_mfma_f32_16x16x32_bf16 v[48:51], v[200:203], v[120:123], v[48:51]
    v_mfma_f32_16x16x32_bf16 v[48:51], v[204:207], v[124:127], v[48:51]
    s_waitcnt lgkmcnt(4)
    v_mfma_f32_16x16x32_bf16 v[52:55], v[228:231], v[124:127], v[52:55]
    ds_read_b64_tr_b16 v[200:201], v7 offset:49152
    v_mfma_f32_16x16x32_bf16 v[52:55], v[224:227], v[120:123], v[52:55]
    ds_read_b64_tr_b16 v[202:203], v7 offset:49664
    v_mfma_f32_16x16x32_bf16 v[60:63], v[224:227], v[128:131], v[60:63]
    ds_read_b64_tr_b16 v[204:205], v7 offset:61440
    v_mfma_f32_16x16x32_bf16 v[60:63], v[228:231], v[132:135], v[60:63]
    ds_read_b64_tr_b16 v[206:207], v7 offset:61952
    v_mfma_f32_16x16x32_bf16 v[68:71], v[228:231], v[140:143], v[68:71]
    v_mfma_f32_16x16x32_bf16 v[68:71], v[224:227], v[136:139], v[68:71]
    v_mfma_f32_16x16x32_bf16 v[76:79], v[224:227], v[144:147], v[76:79]
    v_mfma_f32_16x16x32_bf16 v[76:79], v[228:231], v[148:151], v[76:79]
    s_waitcnt lgkmcnt(4)
    v_mfma_f32_16x16x32_bf16 v[40:43], v[236:239], v[148:151], v[40:43]
    ds_read_b64_tr_b16 v[224:225], v6 offset:51200
    ds_read_b64_tr_b16 v[226:227], v6 offset:51712
    v_mfma_f32_16x16x32_bf16 v[40:43], v[232:235], v[144:147], v[40:43]
    ds_read_b64_tr_b16 v[228:229], v6 offset:63488
    ds_read_b64_tr_b16 v[230:231], v6 offset:64000
    v_mfma_f32_16x16x32_bf16 v[32:35], v[232:235], v[136:139], v[32:35]
    ds_read_b128 v[192:195], v2 offset:0
    ds_read_b128 v[196:199], v3 offset:0
    v_mfma_f32_16x16x32_bf16 v[32:35], v[236:239], v[140:143], v[32:35]
    ds_read_b128 v[184:187], v4 offset:6144
    ds_read_b128 v[188:191], v5 offset:6144
    v_mfma_f32_16x16x32_bf16 v[24:27], v[236:239], v[132:135], v[24:27]
    v_mfma_f32_16x16x32_bf16 v[24:27], v[232:235], v[128:131], v[24:27]
    v_mfma_f32_16x16x32_bf16 v[16:19], v[232:235], v[120:123], v[16:19]
    v_mfma_f32_16x16x32_bf16 v[16:19], v[236:239], v[124:127], v[16:19]
    s_waitcnt lgkmcnt(8)
    v_mfma_f32_16x16x32_bf16 v[20:23], v[204:207], v[124:127], v[20:23]
    ds_read_b64_tr_b16 v[232:233], v7 offset:51200
    v_mfma_f32_16x16x32_bf16 v[20:23], v[200:203], v[120:123], v[20:23]
    ds_read_b64_tr_b16 v[234:235], v7 offset:51712
    v_mfma_f32_16x16x32_bf16 v[28:31], v[200:203], v[128:131], v[28:31]
    ds_read_b64_tr_b16 v[236:237], v7 offset:63488
    v_mfma_f32_16x16x32_bf16 v[28:31], v[204:207], v[132:135], v[28:31]
    ds_read_b64_tr_b16 v[238:239], v7 offset:64000
    v_mfma_f32_16x16x32_bf16 v[36:39], v[204:207], v[140:143], v[36:39]
    ds_read_b128 v[176:179], v4 offset:4096
    v_mfma_f32_16x16x32_bf16 v[36:39], v[200:203], v[136:139], v[36:39]
    ds_read_b128 v[180:183], v5 offset:4096
    v_mfma_f32_16x16x32_bf16 v[44:47], v[200:203], v[144:147], v[44:47]
    ds_read_b128 v[168:171], v4 offset:2048
    v_mfma_f32_16x16x32_bf16 v[44:47], v[204:207], v[148:151], v[44:47]
    s_waitcnt lgkmcnt(11)
    v_mfma_f32_16x16x32_bf16 v[116:119], v[156:159], v[228:231], v[116:119]
    ds_read_b64_tr_b16 v[200:201], v6 offset:1024
    v_mfma_f32_16x16x32_bf16 v[116:119], v[152:155], v[224:227], v[116:119]
    ds_read_b64_tr_b16 v[202:203], v6 offset:1536
    v_mfma_f32_16x16x32_bf16 v[104:107], v[144:147], v[224:227], v[104:107]
    ds_read_b64_tr_b16 v[204:205], v6 offset:13312
    v_mfma_f32_16x16x32_bf16 v[104:107], v[148:151], v[228:231], v[104:107]
    ds_read_b64_tr_b16 v[206:207], v6 offset:13824
    v_mfma_f32_16x16x32_bf16 v[96:99], v[140:143], v[228:231], v[96:99]
    ds_read_b128 v[172:175], v5 offset:2048
    v_mfma_f32_16x16x32_bf16 v[96:99], v[136:139], v[224:227], v[96:99]
    ds_read_b128 v[160:163], v4 offset:0
    v_mfma_f32_16x16x32_bf16 v[88:91], v[128:131], v[224:227], v[88:91]
    ds_read_b128 v[164:167], v5 offset:0
    v_mfma_f32_16x16x32_bf16 v[88:91], v[132:135], v[228:231], v[88:91]
    v_mfma_f32_16x16x32_bf16 v[80:83], v[124:127], v[228:231], v[80:83]
    v_mfma_f32_16x16x32_bf16 v[80:83], v[120:123], v[224:227], v[80:83]
    s_waitcnt lgkmcnt(10)
    v_mfma_f32_16x16x32_bf16 v[84:87], v[120:123], v[232:235], v[84:87]
    ds_read_b64_tr_b16 v[224:225], v7 offset:1024
    v_mfma_f32_16x16x32_bf16 v[84:87], v[124:127], v[236:239], v[84:87]
    ds_read_b64_tr_b16 v[226:227], v7 offset:1536
    v_mfma_f32_16x16x32_bf16 v[92:95], v[132:135], v[236:239], v[92:95]
    ds_read_b64_tr_b16 v[228:229], v7 offset:13312
    v_mfma_f32_16x16x32_bf16 v[92:95], v[128:131], v[232:235], v[92:95]
    ds_read_b64_tr_b16 v[230:231], v7 offset:13824
    v_mfma_f32_16x16x32_bf16 v[100:103], v[136:139], v[232:235], v[100:103]
    v_mfma_f32_16x16x32_bf16 v[100:103], v[140:143], v[236:239], v[100:103]
    v_mfma_f32_16x16x32_bf16 v[108:111], v[148:151], v[236:239], v[108:111]
    v_mfma_f32_16x16x32_bf16 v[108:111], v[144:147], v[232:235], v[108:111]
    s_waitcnt lgkmcnt(9)
    v_mfma_f32_16x16x32_bf16 v[112:115], v[200:203], v[192:195], v[112:115]
    ds_read_b64_tr_b16 v[120:121], v6 offset:0
    ds_read_b64_tr_b16 v[122:123], v6 offset:512
    s_waitcnt lgkmcnt(9)
    v_mfma_f32_16x16x32_bf16 v[112:115], v[204:207], v[196:199], v[112:115]
    ds_read_b64_tr_b16 v[124:125], v6 offset:12288
    ds_read_b64_tr_b16 v[126:127], v6 offset:12800
    v_mfma_f32_16x16x32_bf16 v[72:75], v[204:207], v[188:191], v[72:75]
    ds_read_b64_tr_b16 v[128:129], v7 offset:0
    ds_read_b64_tr_b16 v[130:131], v7 offset:512
    v_mfma_f32_16x16x32_bf16 v[72:75], v[200:203], v[184:187], v[72:75]
    ds_read_b64_tr_b16 v[132:133], v7 offset:12288
    ds_read_b64_tr_b16 v[134:135], v7 offset:12800
    v_mfma_f32_16x16x32_bf16 v[64:67], v[200:203], v[176:179], v[64:67]
    ds_read_b64_tr_b16 v[136:137], v6 offset:2048
    ds_read_b64_tr_b16 v[138:139], v6 offset:2560
    v_mfma_f32_16x16x32_bf16 v[64:67], v[204:207], v[180:183], v[64:67]
    ds_read_b64_tr_b16 v[140:141], v6 offset:14336
    ds_read_b64_tr_b16 v[142:143], v6 offset:14848
    s_waitcnt lgkmcnt(14)
    v_mfma_f32_16x16x32_bf16 v[56:59], v[204:207], v[172:175], v[56:59]
    ds_read_b64_tr_b16 v[144:145], v7 offset:2048
    ds_read_b64_tr_b16 v[146:147], v7 offset:2560
    v_mfma_f32_16x16x32_bf16 v[56:59], v[200:203], v[168:171], v[56:59]
    ds_read_b64_tr_b16 v[148:149], v7 offset:14336
    ds_read_b64_tr_b16 v[150:151], v7 offset:14848
    v_mfma_f32_16x16x32_bf16 v[48:51], v[200:203], v[160:163], v[48:51]
    v_cvt_pk_bf16_f32 v72, v72, v73
    v_cvt_pk_bf16_f32 v73, v74, v75
    v_mfma_f32_16x16x32_bf16 v[48:51], v[204:207], v[164:167], v[48:51]
    v_cvt_pk_bf16_f32 v64, v64, v65
    v_cvt_pk_bf16_f32 v65, v66, v67
    s_waitcnt lgkmcnt(14)
    v_mfma_f32_16x16x32_bf16 v[76:79], v[228:231], v[188:191], v[76:79]
    v_cvt_pk_bf16_f32 v56, v56, v57
    v_cvt_pk_bf16_f32 v57, v58, v59
    v_mfma_f32_16x16x32_bf16 v[76:79], v[224:227], v[184:187], v[76:79]
    v_cvt_pk_bf16_f32 v200, v112, v113
    v_cvt_pk_bf16_f32 v201, v114, v115
    v_mfma_f32_16x16x32_bf16 v[68:71], v[224:227], v[176:179], v[68:71]
    ds_write_b64 v216, v[200:201]
    ds_write_b64 v217, v[72:73]
    v_mfma_f32_16x16x32_bf16 v[68:71], v[228:231], v[180:183], v[68:71]
    v_cvt_pk_bf16_f32 v48, v48, v49
    v_cvt_pk_bf16_f32 v49, v50, v51
    v_mfma_f32_16x16x32_bf16 v[60:63], v[228:231], v[172:175], v[60:63]
    v_cvt_pk_bf16_f32 v74, v76, v77
    v_cvt_pk_bf16_f32 v75, v78, v79
    v_mfma_f32_16x16x32_bf16 v[60:63], v[224:227], v[168:171], v[60:63]
    ds_write_b64 v217, v[74:75] offset:512
    s_mov_b64 exec, 1
    ds_add_u32 v10, v11 offset:0
    s_mov_b64 exec, -1
    v_mfma_f32_16x16x32_bf16 v[52:55], v[224:227], v[160:163], v[52:55]
    v_cvt_pk_bf16_f32 v66, v68, v69
    v_cvt_pk_bf16_f32 v67, v70, v71
    v_mfma_f32_16x16x32_bf16 v[52:55], v[228:231], v[164:167], v[52:55]
    v_cvt_pk_bf16_f32 v58, v60, v61
    v_cvt_pk_bf16_f32 v59, v62, v63
    s_waitcnt lgkmcnt(14)
    v_mfma_f32_16x16x32_bf16 v[40:43], v[124:127], v[188:191], v[40:43]
    s_nop 1
    v_mfma_f32_16x16x32_bf16 v[40:43], v[120:123], v[184:187], v[40:43]
    s_nop 1
    v_mfma_f32_16x16x32_bf16 v[32:35], v[120:123], v[176:179], v[32:35]
    v_cvt_pk_bf16_f32 v50, v52, v53
    v_cvt_pk_bf16_f32 v51, v54, v55
    v_mfma_f32_16x16x32_bf16 v[32:35], v[124:127], v[180:183], v[32:35]
    s_nop 1
    v_mfma_f32_16x16x32_bf16 v[24:27], v[124:127], v[172:175], v[24:27]
    v_cvt_pk_bf16_f32 v40, v40, v41
    v_cvt_pk_bf16_f32 v41, v42, v43
    v_mfma_f32_16x16x32_bf16 v[24:27], v[120:123], v[168:171], v[24:27]
    s_nop 1
    v_mfma_f32_16x16x32_bf16 v[16:19], v[120:123], v[160:163], v[16:19]
    v_cvt_pk_bf16_f32 v32, v32, v33
    v_cvt_pk_bf16_f32 v33, v34, v35
    v_mfma_f32_16x16x32_bf16 v[16:19], v[124:127], v[164:167], v[16:19]
    s_nop 1
    s_waitcnt lgkmcnt(12)
    v_mfma_f32_16x16x32_bf16 v[44:47], v[132:135], v[188:191], v[44:47]
    v_cvt_pk_bf16_f32 v24, v24, v25
    v_cvt_pk_bf16_f32 v25, v26, v27
    v_mfma_f32_16x16x32_bf16 v[44:47], v[128:131], v[184:187], v[44:47]
    s_nop 1
    v_mfma_f32_16x16x32_bf16 v[36:39], v[128:131], v[176:179], v[36:39]
    v_cvt_pk_bf16_f32 v16, v16, v17
    v_cvt_pk_bf16_f32 v17, v18, v19
    v_mfma_f32_16x16x32_bf16 v[36:39], v[132:135], v[180:183], v[36:39]
    ds_read_b32 v223, v10 offset:0
    ds_read_b64 v[204:205], v218
    v_mfma_f32_16x16x32_bf16 v[28:31], v[132:135], v[172:175], v[28:31]
    ds_read_b64 v[206:207], v219
    v_cvt_pk_bf16_f32 v42, v44, v45
    v_mfma_f32_16x16x32_bf16 v[28:31], v[128:131], v[168:171], v[28:31]
    v_cvt_pk_bf16_f32 v43, v46, v47
    s_nop 0
    v_mfma_f32_16x16x32_bf16 v[20:23], v[128:131], v[160:163], v[20:23]
    v_cvt_pk_bf16_f32 v34, v36, v37
    v_cvt_pk_bf16_f32 v35, v38, v39
    v_mfma_f32_16x16x32_bf16 v[20:23], v[132:135], v[164:167], v[20:23]
    s_nop 1
    s_waitcnt lgkmcnt(11)
    v_mfma_f32_16x16x32_bf16 v[116:119], v[196:199], v[140:143], v[116:119]
    v_cvt_pk_bf16_f32 v26, v28, v29
    v_cvt_pk_bf16_f32 v27, v30, v31
    v_mfma_f32_16x16x32_bf16 v[116:119], v[192:195], v[136:139], v[116:119]
    s_nop 1
    v_mfma_f32_16x16x32_bf16 v[104:107], v[184:187], v[136:139], v[104:107]
    v_cvt_pk_bf16_f32 v18, v20, v21
    v_cvt_pk_bf16_f32 v19, v22, v23
    v_mfma_f32_16x16x32_bf16 v[104:107], v[188:191], v[140:143], v[104:107]
    s_nop 1
    v_mfma_f32_16x16x32_bf16 v[44:47], v[72:75], v[40:43], 0
    v_cvt_pk_bf16_f32 v202, v116, v117
    v_cvt_pk_bf16_f32 v203, v118, v119
    v_mfma_f32_16x16x32_bf16 v[76:79], v[64:67], v[40:43], 0
    s_nop 1
    v_mfma_f32_16x16x32_bf16 v[36:39], v[64:67], v[32:35], 0
    v_cvt_pk_bf16_f32 v232, v104, v105
    v_cvt_pk_bf16_f32 v233, v106, v107
    v_mfma_f32_16x16x32_bf16 v[68:71], v[56:59], v[32:35], 0
    ds_write_b64 v216, v[202:203] offset:1024
    ds_write_b64 v217, v[232:233] offset:1024
    v_mfma_f32_16x16x32_bf16 v[96:99], v[180:183], v[140:143], v[96:99]
    s_waitcnt lgkmcnt(4)
    v_cmp_gt_u32 vcc, 4, v223
    s_cbranch_vccnz LB_w1
LB_g1:
    v_mfma_f32_16x16x32_bf16 v[96:99], v[176:179], v[136:139], v[96:99]
    v_cndmask_b32 v124, v44, v45, s[88:89]
    v_cndmask_b32 v125, v76, v77, s[88:89]
    v_mfma_f32_16x16x32_bf16 v[28:31], v[56:59], v[24:27], 0
    v_cndmask_b32 v158, v125, v124, s[90:91]
    v_cndmask_b32 v126, v46, v47, s[88:89]
    v_mfma_f32_16x16x32_bf16 v[60:63], v[48:51], v[24:27], 0
    v_cndmask_b32 v127, v78, v79, s[88:89]
    v_cndmask_b32 v159, v127, v126, s[92:93]
    v_mfma_f32_16x16x32_bf16 v[20:23], v[48:51], v[16:19], 0
    v_max_f32 v123, v158, v159
    v_cndmask_b32 v124, v36, v37, s[88:89]
    v_mfma_f32_16x16x32_bf16 v[88:91], v[168:171], v[136:139], v[88:91]
    v_cndmask_b32 v125, v68, v69, s[88:89]
    v_cndmask_b32 v156, v125, v124, s[90:91]
    v_mfma_f32_16x16x32_bf16 v[88:91], v[172:175], v[140:143], v[88:91]
    v_cndmask_b32 v126, v38, v39, s[88:89]
    v_cndmask_b32 v127, v70, v71, s[88:89]
    s_waitcnt lgkmcnt(2)
    v_mfma_f32_16x16x32_bf16 v[52:55], v[204:207], v[16:19], v[212:215]
    v_cndmask_b32 v157, v127, v126, s[92:93]
    v_max_f32 v122, v156, v157
    v_mfma_f32_16x16x32_bf16 v[80:83], v[164:167], v[140:143], v[80:83]
    v_cndmask_b32 v124, v28, v29, s[88:89]
    v_cndmask_b32 v125, v60, v61, s[88:89]
    v_mfma_f32_16x16x32_bf16 v[80:83], v[160:163], v[136:139], v[80:83]
    v_cndmask_b32 v154, v125, v124, s[90:91]
    v_cndmask_b32 v126, v30, v31, s[88:89]
    v_mfma_f32_16x16x32_bf16 v[108:111], v[184:187], v[144:147], v[108:111]
    v_cndmask_b32 v127, v62, v63, s[88:89]
    v_cndmask_b32 v155, v127, v126, s[92:93]
    v_mfma_f32_16x16x32_bf16 v[108:111], v[188:191], v[148:151], v[108:111]
    v_max_f32 v121, v154, v155
    s_nop 0
    v_mfma_f32_16x16x32_bf16 v[100:103], v[180:183], v[148:151], v[100:103]
    s_nop 1
    v_mfma_f32_16x16x32_bf16 v[100:103], v[176:179], v[144:147], v[100:103]
    s_nop 1
    v_mfma_f32_16x16x32_bf16 v[92:95], v[168:171], v[144:147], v[92:95]
    v_cvt_pk_bf16_f32 v242, v108, v109
    v_cvt_pk_bf16_f32 v243, v110, v111
    v_mfma_f32_16x16x32_bf16 v[92:95], v[172:175], v[148:151], v[92:95]
    ds_write_b64 v217, v[242:243] offset:1536
    s_mov_b64 exec, 1
    ds_add_u32 v10, v11 offset:24
    s_mov_b64 exec, -1
    v_mfma_f32_16x16x32_bf16 v[84:87], v[164:167], v[148:151], v[84:87]
    v_cndmask_b32 v124, v20, v21, s[88:89]
    v_cndmask_b32 v125, v52, v53, s[88:89]
    v_mfma_f32_16x16x32_bf16 v[84:87], v[160:163], v[144:147], v[84:87]
    v_cndmask_b32 v152, v125, v124, s[90:91]
    v_cndmask_b32 v126, v22, v23, s[88:89]
    v_cndmask_b32 v127, v54, v55, s[88:89]
    v_cndmask_b32 v153, v127, v126, s[92:93]
    v_max_f32 v120, v152, v153
    s_mov_b32 s80, 0x3e8293ee
    s_add_u32 m0, s34, 36864
    s_add_u32 s35, s44, 0
    buffer_load_dwordx4 v245, s[64:67], s35 offen  lds
    v_cvt_pk_bf16_f32 v230, v96, v97
    v_permlane32_swap_b32 v122, v123
    v_permlane32_swap_b32 v120, v121
    v_max_f32 v122, v122, v123
    v_max_f32 v120, v120, v121
    v_cvt_pk_bf16_f32 v231, v98, v99
    v_cvt_pk_bf16_f32 v240, v100, v101
    v_permlane16_swap_b32 v120, v122
    v_max_f32 v120, v120, v122
    v_mul_f32 v120, s80, v120
    v_mov_b32 v122, v120
    v_cvt_pk_bf16_f32 v241, v102, v103
    v_cvt_pk_bf16_f32 v228, v88, v89
    v_permlane16_swap_b32 v120, v122
    s_add_u32 m0, s34, 40960
    s_add_u32 s35, s44, 65536
    buffer_load_dwordx4 v245, s[64:67], s35 offen  lds
    v_mov_b32 v121, v120
    v_mov_b32 v123, v122
    v_cvt_pk_bf16_f32 v229, v90, v91
    v_permlane32_swap_b32 v120, v121
    v_permlane32_swap_b32 v122, v123
    v_fma_f32 v152, v152, s80, -v120
    v_fma_f32 v153, v153, s80, -v120
    v_fma_f32 v154, v154, s80, -v121
    v_fma_f32 v155, v155, s80, -v121
    v_fma_f32 v156, v156, s80, -v122
    v_fma_f32 v157, v157, s80, -v122
    v_fma_f32 v158, v158, s80, -v123
    v_fma_f32 v159, v159, s80, -v123
    ds_read_b32 v223, v10 offset:24
    s_add_u32 m0, s34, 45056
    s_add_u32 s35, s44, 131072
    buffer_load_dwordx4 v245, s[64:67], s35 offen  lds
    ds_read_b64 v[224:225], v218 offset:1024
    ds_read_b64 v[234:235], v219 offset:1024
    v_exp_f32 v152, v152
    v_exp_f32 v153, v153
    v_exp_f32 v154, v154
    v_exp_f32 v155, v155
    v_exp_f32 v156, v156
    v_exp_f32 v157, v157
    v_exp_f32 v158, v158
    v_exp_f32 v159, v159
    v_add_f32 v120, v152, v153
    v_add_f32 v121, v154, v155
    v_add_f32 v122, v156, v157
    v_add_f32 v123, v158, v159
    s_add_u32 m0, s34, 110592
    s_add_u32 s35, s44, 196608
    buffer_load_dwordx4 v245, s[64:67], s35 offen  lds
    v_cvt_pk_bf16_f32 v238, v92, v93
    v_permlane32_swap_b32 v122, v123
    v_permlane32_swap_b32 v120, v121
    v_add_f32 v122, v122, v123
    v_add_f32 v120, v120, v121
    v_cvt_pk_bf16_f32 v239, v94, v95
    v_cvt_pk_bf16_f32 v226, v80, v81
    v_permlane16_swap_b32 v120, v122
    v_add_f32 v120, v120, v122
    v_rcp_f32 v120, v120
    s_nop 0
    v_mov_b32 v122, v120
    v_cvt_pk_bf16_f32 v227, v82, v83
    v_cvt_pk_bf16_f32 v236, v84, v85
    v_permlane16_swap_b32 v120, v122
    s_add_u32 m0, s34, 114688
    s_add_u32 s35, s45, 0
    buffer_load_dwordx4 v245, s[64:67], s35 offen  lds
    v_mov_b32 v121, v120
    v_mov_b32 v123, v122
    v_cvt_pk_bf16_f32 v237, v86, v87
    v_permlane32_swap_b32 v120, v121
    v_permlane32_swap_b32 v122, v123
    s_waitcnt lgkmcnt(2)
    v_cmp_gt_u32 vcc, 4, v223
    s_cbranch_vccnz LB_w6
LB_g6:
    v_mul_f32 v152, v152, v120
    v_mul_f32 v153, v153, v120
    v_cvt_pk_bf16_f32 v152, v152, v153
    v_perm_b32 v160, v152, v152, v208
    v_perm_b32 v161, v152, v152, v209
    v_perm_b32 v162, v152, v152, v210
    v_perm_b32 v163, v152, v152, v211
    v_mul_f32 v154, v154, v121
    s_add_u32 m0, s34, 118784
    s_add_u32 s35, s45, 65536
    buffer_load_dwordx4 v245, s[64:67], s35 offen  lds
    v_mul_f32 v155, v155, v121
    v_cvt_pk_bf16_f32 v154, v154, v155
    v_perm_b32 v164, v154, v154, v208
    v_perm_b32 v165, v154, v154, v209
    v_perm_b32 v166, v154, v154, v210
    v_perm_b32 v167, v154, v154, v211
    s_waitcnt lgkmcnt(1)
    v_mfma_f32_16x16x32_bf16 v[16:19], v[224:227], v[160:163], 0
    s_waitcnt lgkmcnt(0)
    v_mfma_f32_16x16x32_bf16 v[20:23], v[234:237], v[160:163], 0
    v_mul_f32 v156, v156, v122
    v_mul_f32 v157, v157, v122
    v_cvt_pk_bf16_f32 v156, v156, v157
    v_perm_b32 v168, v156, v156, v208
    v_perm_b32 v169, v156, v156, v209
    v_perm_b32 v170, v156, v156, v210
    s_add_u32 m0, s34, 122880
    s_add_u32 s35, s45, 131072
    buffer_load_dwordx4 v245, s[64:67], s35 offen  lds
    v_perm_b32 v171, v156, v156, v211
    v_mfma_f32_16x16x32_bf16 v[24:27], v[226:229], v[164:167], 0
    v_mfma_f32_16x16x32_bf16 v[28:31], v[236:239], v[164:167], 0
    v_mul_f32 v158, v158, v123
    v_mul_f32 v159, v159, v123
    v_cvt_pk_bf16_f32 v158, v158, v159
    v_perm_b32 v172, v158, v158, v208
    v_perm_b32 v173, v158, v158, v209
    v_perm_b32 v174, v158, v158, v210
    v_perm_b32 v175, v158, v158, v211
    v_mfma_f32_16x16x32_bf16 v[32:35], v[228:231], v[168:171], 0
    v_mfma_f32_16x16x32_bf16 v[36:39], v[238:241], v[168:171], 0
    v_mfma_f32_16x16x32_bf16 v[40:43], v[230:233], v[172:175], 0
    v_mfma_f32_16x16x32_bf16 v[44:47], v[240:243], v[172:175], 0
    v_cvt_pk_bf16_f32 v80, v16, v17
    v_cvt_pk_bf16_f32 v81, v18, v19
    v_cvt_pk_bf16_f32 v82, v20, v21
    v_cvt_pk_bf16_f32 v83, v22, v23
    s_add_u32 s95, s94, 0
    buffer_store_dwordx4 v[80:83], v252, s[52:55], s95 offen sc1
    v_cvt_pk_bf16_f32 v84, v24, v25
    v_cvt_pk_bf16_f32 v85, v26, v27
    v_cvt_pk_bf16_f32 v86, v28, v29
    v_cvt_pk_bf16_f32 v87, v30, v31
    s_add_u32 s95, s94, 32768
    buffer_store_dwordx4 v[84:87], v252, s[52:55], s95 offen sc1
    v_cvt_pk_bf16_f32 v88, v32, v33
    v_cvt_pk_bf16_f32 v89, v34, v35
    v_cvt_pk_bf16_f32 v90, v36, v37
    v_cvt_pk_bf16_f32 v91, v38, v39
    s_add_u32 s95, s94, 65536
    buffer_store_dwordx4 v[88:91], v252, s[52:55], s95 offen sc1
    v_cvt_pk_bf16_f32 v92, v40, v41
    v_cvt_pk_bf16_f32 v93, v42, v43
    v_cvt_pk_bf16_f32 v94, v44, v45
    v_cvt_pk_bf16_f32 v95, v46, v47
    s_add_u32 s95, s94, 98304
    buffer_store_dwordx4 v[92:95], v252, s[52:55], s95 offen sc1
    s_add_u32 m0, s34, 49152
    s_add_u32 s35, s45, 196608
    buffer_load_dwordx4 v245, s[64:67], s35 offen  lds
    v_xor_b32 v2, 0, v244
    v_xor_b32 v3, 32, v244
    v_xor_b32 v4, 64, v244
    v_xor_b32 v5, 96, v244
    s_add_u32 m0, s34, 53248
    s_add_u32 s35, s46, 0
    buffer_load_dwordx4 v245, s[64:67], s35 offen  lds
    v_xor_b32 v6, 2048, v244
    v_xor_b32 v7, 2080, v244
    v_xor_b32 v8, 2112, v244
    v_xor_b32 v9, 2144, v244
    s_waitcnt vmcnt(7)
    s_mov_b64 exec, 1
    ds_add_u32 v10, v11 offset:8
    s_mov_b64 exec, -1
    s_add_u32 m0, s34, 57344
    s_add_u32 s35, s46, 65536
    buffer_load_dwordx4 v245, s[64:67], s35 offen  lds
    v_add_u32 v224, 65536, v2
    v_add_u32 v225, 65536, v3
    v_add_u32 v226, 65536, v4
    v_add_u32 v227, 65536, v5
    v_add_u32 v228, 65536, v6
    v_add_u32 v229, 65536, v7
    s_add_u32 m0, s34, 61440
    s_add_u32 s35, s46, 131072
    buffer_load_dwordx4 v245, s[64:67], s35 offen  lds
    v_add_u32 v230, 65536, v8
    v_add_u32 v231, 65536, v9
    v_add_u32 v15, 32768, v252
    v_add_u32 v232, 129024, v2
    v_add_u32 v233, 129024, v3
    v_add_u32 v234, 129024, v4
    s_add_u32 m0, s34, 65536
    s_add_u32 s35, s46, 196608
    buffer_load_dwordx4 v245, s[64:67], s35 offen  lds
    v_add_u32 v235, 129024, v5
    v_add_u32 v236, 129024, v6
    v_add_u32 v237, 129024, v7
    v_add_u32 v238, 129024, v8
    v_add_u32 v239, 129024, v9
    s_waitcnt vmcnt(5)
    s_mov_b64 exec, 1
    buffer_store_dword v11, v220, s[52:55], s97 offen sc1
    s_mov_b64 exec, -1
    s_branch LB_s2_in
LB_s2:
    s_sleep 1
LB_s2_in:
    ds_read_b32 v14, v10 offset:8
    s_waitcnt lgkmcnt(0)
    v_readfirstlane_b32 s78, v14
    s_nop 0
    s_cmp_ge_u32 s78, 8
    s_cbranch_scc0 LB_s2
    s_add_u32 m0, s34, 69632
    s_add_u32 s35, s47, 0
    buffer_load_dwordx4 v245, s[64:67], s35 offen  lds
    ds_read_b64_tr_b16 v[48:49], v2 offset:36864
    ds_read_b64_tr_b16 v[50:51], v6 offset:36864
    s_add_u32 m0, s34, 0
    s_add_u32 s35, s47, 65536
    buffer_load_dwordx4 v245, s[64:67], s35 offen  lds
    ds_read_b64_tr_b16 v[52:53], v2 offset:40960
    s_add_u32 m0, s34, 4096
    s_add_u32 s35, s47, 131072
    buffer_load_dwordx4 v245, s[64:67], s35 offen  lds
    ds_read_b64_tr_b16 v[54:55], v6 offset:40960
    s_add_u32 m0, s34, 8192
    s_add_u32 s35, s47, 196608
    buffer_load_dwordx4 v245, s[64:67], s35 offen  lds
    ds_read_b64_tr_b16 v[56:57], v2 offset:45056
    s_add_u32 m0, s34, 12288
    s_add_u32 s35, s48, 0
    buffer_load_dwordx4 v245, s[64:67], s35 offen  lds
    ds_read_b64_tr_b16 v[58:59], v6 offset:45056
    s_add_u32 m0, s34, 16384
    s_add_u32 s35, s48, 65536
    buffer_load_dwordx4 v245, s[64:67], s35 offen  lds
    ds_read_b64_tr_b16 v[60:61], v224 offset:45056
    s_add_u32 m0, s34, 20480
    s_add_u32 s35, s48, 131072
    buffer_load_dwordx4 v245, s[64:67], s35 offen  lds
    ds_read_b64_tr_b16 v[62:63], v228 offset:45056
    s_add_u32 m0, s34, 73728
    s_add_u32 s35, s48, 196608
    buffer_load_dwordx4 v245, s[64:67], s35 offen  lds
    ds_read_b64_tr_b16 v[64:65], v3 offset:36864
    ds_read_b64_tr_b16 v[66:67], v7 offset:36864
    s_add_u32 m0, s34, 77824
    s_add_u32 s35, s49, 0
    buffer_load_dwordx4 v245, s[64:67], s35 offen  lds
    ds_read_b64_tr_b16 v[68:69], v3 offset:40960
    s_add_u32 m0, s34, 81920
    s_add_u32 s35, s49, 65536
    buffer_load_dwordx4 v245, s[64:67], s35 offen  lds
    ds_read_b64_tr_b16 v[70:71], v7 offset:40960
    s_add_u32 m0, s34, 86016
    s_add_u32 s35, s49, 131072
    buffer_load_dwordx4 v245, s[64:67], s35 offen  lds
    ds_read_b64_tr_b16 v[72:73], v3 offset:45056
    s_add_u32 m0, s34, 24576
    s_add_u32 s35, s49, 196608
    buffer_load_dwordx4 v245, s[64:67], s35 offen  lds
    ds_read_b64_tr_b16 v[74:75], v7 offset:45056
    s_add_u32 m0, s34, 28672
    s_add_u32 s35, s50, 0
    buffer_load_dwordx4 v245, s[64:67], s35 offen  lds
    ds_read_b64_tr_b16 v[76:77], v225 offset:45056
    s_add_u32 m0, s34, 32768
    s_add_u32 s35, s50, 65536
    buffer_load_dwordx4 v245, s[64:67], s35 offen  lds
    ds_read_b64_tr_b16 v[78:79], v229 offset:45056
    s_waitcnt vmcnt(0)
    s_mov_b64 exec, 1
    ds_add_u32 v10, v11 offset:16
    s_mov_b64 exec, -1
    s_mov_b64 exec, 0xffffffff
    s_mov_b32 s79, 0
LB_po:
    buffer_load_dword v14, v247, s[52:55], s30 offen sc1
    s_add_u32 s79, s79, 1
    s_cmp_gt_u32 s79, 200000
    s_cbranch_scc1 LB_po_x
    s_waitcnt vmcnt(0)
    v_cmp_ne_u32 vcc, 1, v14
    s_cbranch_vccz LB_po_x
    s_mov_b64 exec, vcc
    s_sleep 4
    s_branch LB_po
LB_po_x:
    s_waitcnt vmcnt(0)
    s_mov_b64 exec, -1
    ds_read_b32 v222, v10 offset:16
    buffer_load_dwordx4 v[96:99], v252, s[52:55], s36 offen offset:0 sc1
    buffer_load_dwordx4 v[100:103], v252, s[52:55], s36 offen offset:1024 sc1
    buffer_load_dwordx4 v[104:107], v252, s[52:55], s36 offen offset:2048 sc1
    buffer_load_dwordx4 v[108:111], v252, s[52:55], s36 offen offset:3072 sc1
    buffer_load_dwordx4 v[112:115], v15, s[52:55], s36 offen offset:0 sc1
    buffer_load_dwordx4 v[116:119], v15, s[52:55], s36 offen offset:1024 sc1
    buffer_load_dwordx4 v[120:123], v15, s[52:55], s36 offen offset:2048 sc1
    buffer_load_dwordx4 v[124:127], v15, s[52:55], s36 offen offset:3072 sc1
    buffer_load_dwordx4 v[128:131], v252, s[52:55], s37 offen offset:0 sc1
    buffer_load_dwordx4 v[132:135], v252, s[52:55], s37 offen offset:1024 sc1
    s_setprio 1
    s_waitcnt lgkmcnt(0)
    v_cmp_gt_u32 vcc, 4, v222
    s_cbranch_vccnz LB_w4
LB_g4:
    s_waitcnt vmcnt(9)
    v_mfma_f32_16x16x32_bf16 v[16:19], v[48:51], v[96:99], 0
    buffer_load_dwordx4 v[136:139], v252, s[52:55], s37 offen offset:2048 sc1
    buffer_load_dwordx4 v[140:143], v252, s[52:55], s37 offen offset:3072 sc1
    s_waitcnt vmcnt(10)
    v_mfma_f32_16x16x32_bf16 v[16:19], v[52:55], v[100:103], v[16:19]
    buffer_load_dwordx4 v[144:147], v15, s[52:55], s37 offen offset:0 sc1
    s_waitcnt vmcnt(10)
    v_mfma_f32_16x16x32_bf16 v[16:19], v[56:59], v[104:107], v[16:19]
    buffer_load_dwordx4 v[148:151], v15, s[52:55], s37 offen offset:1024 sc1
    ds_read_b64_tr_b16 v[80:81], v4 offset:36864
    s_waitcnt vmcnt(10)
    v_mfma_f32_16x16x32_bf16 v[16:19], v[60:63], v[108:111], v[16:19]
    ds_read_b64_tr_b16 v[82:83], v8 offset:36864
    s_waitcnt vmcnt(6)
    v_mfma_f32_16x16x32_bf16 v[32:35], v[60:63], v[124:127], 0
    ds_read_b64_tr_b16 v[84:85], v4 offset:40960
    ds_read_b64_tr_b16 v[86:87], v8 offset:40960
    v_mfma_f32_16x16x32_bf16 v[32:35], v[56:59], v[120:123], v[32:35]
    ds_read_b64_tr_b16 v[88:89], v4 offset:45056
    v_mfma_f32_16x16x32_bf16 v[32:35], v[52:55], v[116:119], v[32:35]
    ds_read_b64_tr_b16 v[90:91], v8 offset:45056
    ds_read_b64_tr_b16 v[92:93], v226 offset:45056
    v_mfma_f32_16x16x32_bf16 v[32:35], v[48:51], v[112:115], v[32:35]
    ds_read_b64_tr_b16 v[94:95], v230 offset:45056
    v_mfma_f32_16x16x32_bf16 v[36:39], v[64:67], v[112:115], 0
    buffer_load_dwordx4 v[152:155], v15, s[52:55], s37 offen offset:2048 sc1
    buffer_load_dwordx4 v[156:159], v15, s[52:55], s37 offen offset:3072 sc1
    v_mfma_f32_16x16x32_bf16 v[36:39], v[68:71], v[116:119], v[36:39]
    buffer_load_dwordx4 v[160:163], v252, s[52:55], s38 offen offset:0 sc1
    v_mfma_f32_16x16x32_bf16 v[36:39], v[72:75], v[120:123], v[36:39]
    buffer_load_dwordx4 v[164:167], v252, s[52:55], s38 offen offset:1024 sc1
    ds_read_b64_tr_b16 v[48:49], v5 offset:36864
    v_mfma_f32_16x16x32_bf16 v[36:39], v[76:79], v[124:127], v[36:39]
    ds_read_b64_tr_b16 v[50:51], v9 offset:36864
    v_mfma_f32_16x16x32_bf16 v[20:23], v[76:79], v[108:111], 0
    ds_read_b64_tr_b16 v[52:53], v5 offset:40960
    ds_read_b64_tr_b16 v[54:55], v9 offset:40960
    v_mfma_f32_16x16x32_bf16 v[20:23], v[72:75], v[104:107], v[20:23]
    ds_read_b64_tr_b16 v[56:57], v5 offset:45056
    v_mfma_f32_16x16x32_bf16 v[20:23], v[68:71], v[100:103], v[20:23]
    ds_read_b64_tr_b16 v[58:59], v9 offset:45056
    ds_read_b64_tr_b16 v[60:61], v227 offset:45056
    v_mfma_f32_16x16x32_bf16 v[20:23], v[64:67], v[96:99], v[20:23]
    ds_read_b64_tr_b16 v[62:63], v231 offset:45056
    s_waitcnt lgkmcnt(14)
    v_mfma_f32_16x16x32_bf16 v[24:27], v[80:83], v[96:99], 0
    buffer_load_dwordx4 v[168:171], v252, s[52:55], s38 offen offset:2048 sc1
    buffer_load_dwordx4 v[172:175], v252, s[52:55], s38 offen offset:3072 sc1
    s_waitcnt lgkmcnt(12)
    v_mfma_f32_16x16x32_bf16 v[24:27], v[84:87], v[100:103], v[24:27]
    buffer_load_dwordx4 v[176:179], v15, s[52:55], s38 offen offset:0 sc1
    s_waitcnt lgkmcnt(10)
    v_mfma_f32_16x16x32_bf16 v[24:27], v[88:91], v[104:107], v[24:27]
    buffer_load_dwordx4 v[180:183], v15, s[52:55], s38 offen offset:1024 sc1
    ds_read_b64_tr_b16 v[64:65], v224 offset:49152
    s_waitcnt lgkmcnt(9)
    v_mfma_f32_16x16x32_bf16 v[24:27], v[92:95], v[108:111], v[24:27]
    ds_read_b64_tr_b16 v[66:67], v228 offset:49152
    v_mfma_f32_16x16x32_bf16 v[40:43], v[92:95], v[124:127], 0
    ds_read_b64_tr_b16 v[68:69], v224 offset:53248
    ds_read_b64_tr_b16 v[70:71], v228 offset:53248
    v_mfma_f32_16x16x32_bf16 v[40:43], v[88:91], v[120:123], v[40:43]
    ds_read_b64_tr_b16 v[72:73], v224 offset:57344
    v_mfma_f32_16x16x32_bf16 v[40:43], v[84:87], v[116:119], v[40:43]
    ds_read_b64_tr_b16 v[74:75], v228 offset:57344
    ds_read_b64_tr_b16 v[76:77], v2 offset:49152
    v_mfma_f32_16x16x32_bf16 v[40:43], v[80:83], v[112:115], v[40:43]
    ds_read_b64_tr_b16 v[78:79], v6 offset:49152
    s_waitcnt lgkmcnt(14)
    v_mfma_f32_16x16x32_bf16 v[44:47], v[48:51], v[112:115], 0
    buffer_load_dwordx4 v[184:187], v15, s[52:55], s38 offen offset:2048 sc1
    buffer_load_dwordx4 v[188:191], v15, s[52:55], s38 offen offset:3072 sc1
    s_waitcnt lgkmcnt(12)
    v_mfma_f32_16x16x32_bf16 v[44:47], v[52:55], v[116:119], v[44:47]
    ds_read_b64_tr_b16 v[80:81], v225 offset:49152
    s_waitcnt lgkmcnt(11)
    v_mfma_f32_16x16x32_bf16 v[44:47], v[56:59], v[120:123], v[44:47]
    ds_read_b64_tr_b16 v[82:83], v229 offset:49152
    s_waitcnt lgkmcnt(10)
    v_mfma_f32_16x16x32_bf16 v[44:47], v[60:63], v[124:127], v[44:47]
    ds_read_b64_tr_b16 v[84:85], v225 offset:53248
    v_mfma_f32_16x16x32_bf16 v[28:31], v[60:63], v[108:111], 0
    ds_read_b64_tr_b16 v[86:87], v229 offset:53248
    ds_read_b64_tr_b16 v[88:89], v225 offset:57344
    v_mfma_f32_16x16x32_bf16 v[28:31], v[56:59], v[104:107], v[28:31]
    ds_read_b64_tr_b16 v[90:91], v229 offset:57344
    v_mfma_f32_16x16x32_bf16 v[28:31], v[52:55], v[100:103], v[28:31]
    ds_read_b64_tr_b16 v[92:93], v3 offset:49152
    v_mfma_f32_16x16x32_bf16 v[28:31], v[48:51], v[96:99], v[28:31]
    ds_read_b64_tr_b16 v[94:95], v7 offset:49152
    s_waitcnt vmcnt(8) lgkmcnt(8)
    v_mfma_f32_16x16x32_bf16 v[16:19], v[64:67], v[128:131], v[16:19]
    buffer_load_dwordx4 v[96:99], v252, s[52:55], s39 offen offset:0 sc1
    buffer_load_dwordx4 v[100:103], v252, s[52:55], s39 offen offset:1024 sc1
    v_mfma_f32_16x16x32_bf16 v[16:19], v[68:71], v[132:135], v[16:19]
    buffer_load_dwordx4 v[104:107], v252, s[52:55], s39 offen offset:2048 sc1
    v_mfma_f32_16x16x32_bf16 v[16:19], v[72:75], v[136:139], v[16:19]
    buffer_load_dwordx4 v[108:111], v252, s[52:55], s39 offen offset:3072 sc1
    ds_read_b64_tr_b16 v[48:49], v226 offset:49152
    v_mfma_f32_16x16x32_bf16 v[16:19], v[76:79], v[140:143], v[16:19]
    ds_read_b64_tr_b16 v[50:51], v230 offset:49152
    v_mfma_f32_16x16x32_bf16 v[32:35], v[76:79], v[156:159], v[32:35]
    ds_read_b64_tr_b16 v[52:53], v226 offset:53248
    ds_read_b64_tr_b16 v[54:55], v230 offset:53248
    v_mfma_f32_16x16x32_bf16 v[32:35], v[72:75], v[152:155], v[32:35]
    ds_read_b64_tr_b16 v[56:57], v226 offset:57344
    v_mfma_f32_16x16x32_bf16 v[32:35], v[68:71], v[148:151], v[32:35]
    ds_read_b64_tr_b16 v[58:59], v230 offset:57344
    ds_read_b64_tr_b16 v[60:61], v4 offset:49152
    v_mfma_f32_16x16x32_bf16 v[32:35], v[64:67], v[144:147], v[32:35]
    ds_read_b64_tr_b16 v[62:63], v8 offset:49152
    s_waitcnt lgkmcnt(8)
    v_mfma_f32_16x16x32_bf16 v[36:39], v[80:83], v[144:147], v[36:39]
    buffer_load_dwordx4 v[112:115], v15, s[52:55], s39 offen offset:0 sc1
    buffer_load_dwordx4 v[116:119], v15, s[52:55], s39 offen offset:1024 sc1
    v_mfma_f32_16x16x32_bf16 v[36:39], v[84:87], v[148:151], v[36:39]
    ds_read_b64_tr_b16 v[64:65], v227 offset:49152
    v_mfma_f32_16x16x32_bf16 v[36:39], v[88:91], v[152:155], v[36:39]
    ds_read_b64_tr_b16 v[66:67], v231 offset:49152
    v_mfma_f32_16x16x32_bf16 v[36:39], v[92:95], v[156:159], v[36:39]
    ds_read_b64_tr_b16 v[68:69], v227 offset:53248
    v_mfma_f32_16x16x32_bf16 v[20:23], v[92:95], v[140:143], v[20:23]
    ds_read_b64_tr_b16 v[70:71], v231 offset:53248
    ds_read_b64_tr_b16 v[72:73], v227 offset:57344
    v_mfma_f32_16x16x32_bf16 v[20:23], v[88:91], v[136:139], v[20:23]
    ds_read_b64_tr_b16 v[74:75], v231 offset:57344
    v_mfma_f32_16x16x32_bf16 v[20:23], v[84:87], v[132:135], v[20:23]
    ds_read_b64_tr_b16 v[76:77], v5 offset:49152
    v_mfma_f32_16x16x32_bf16 v[20:23], v[80:83], v[128:131], v[20:23]
    ds_read_b64_tr_b16 v[78:79], v9 offset:49152
    s_waitcnt lgkmcnt(8)
    v_mfma_f32_16x16x32_bf16 v[24:27], v[48:51], v[128:131], v[24:27]
    buffer_load_dwordx4 v[120:123], v15, s[52:55], s39 offen offset:2048 sc1
    buffer_load_dwordx4 v[124:127], v15, s[52:55], s39 offen offset:3072 sc1
    v_mfma_f32_16x16x32_bf16 v[24:27], v[52:55], v[132:135], v[24:27]
    ds_read_b64_tr_b16 v[80:81], v2 offset:53248
    v_mfma_f32_16x16x32_bf16 v[24:27], v[56:59], v[136:139], v[24:27]
    ds_read_b64_tr_b16 v[82:83], v6 offset:53248
    v_mfma_f32_16x16x32_bf16 v[24:27], v[60:63], v[140:143], v[24:27]
    ds_read_b64_tr_b16 v[84:85], v2 offset:57344
    v_mfma_f32_16x16x32_bf16 v[40:43], v[60:63], v[156:159], v[40:43]
    ds_read_b64_tr_b16 v[86:87], v6 offset:57344
    ds_read_b64_tr_b16 v[88:89], v2 offset:61440
    v_mfma_f32_16x16x32_bf16 v[40:43], v[56:59], v[152:155], v[40:43]
    ds_read_b64_tr_b16 v[90:91], v6 offset:61440
    v_mfma_f32_16x16x32_bf16 v[40:43], v[52:55], v[148:151], v[40:43]
    ds_read_b64_tr_b16 v[92:93], v224 offset:0
    v_mfma_f32_16x16x32_bf16 v[40:43], v[48:51], v[144:147], v[40:43]
    ds_read_b64_tr_b16 v[94:95], v228 offset:0
    s_waitcnt lgkmcnt(8)
    v_mfma_f32_16x16x32_bf16 v[44:47], v[64:67], v[144:147], v[44:47]
    ds_read_b64_tr_b16 v[48:49], v3 offset:53248
    v_mfma_f32_16x16x32_bf16 v[44:47], v[68:71], v[148:151], v[44:47]
    ds_read_b64_tr_b16 v[50:51], v7 offset:53248
    v_mfma_f32_16x16x32_bf16 v[44:47], v[72:75], v[152:155], v[44:47]
    ds_read_b64_tr_b16 v[52:53], v3 offset:57344
    v_mfma_f32_16x16x32_bf16 v[44:47], v[76:79], v[156:159], v[44:47]
    ds_read_b64_tr_b16 v[54:55], v7 offset:57344
    v_mfma_f32_16x16x32_bf16 v[28:31], v[76:79], v[140:143], v[28:31]
    ds_read_b64_tr_b16 v[56:57], v3 offset:61440
    v_mfma_f32_16x16x32_bf16 v[28:31], v[72:75], v[136:139], v[28:31]
    ds_read_b64_tr_b16 v[58:59], v7 offset:61440
    v_mfma_f32_16x16x32_bf16 v[28:31], v[68:71], v[132:135], v[28:31]
    ds_read_b64_tr_b16 v[60:61], v225 offset:0
    v_mfma_f32_16x16x32_bf16 v[28:31], v[64:67], v[128:131], v[28:31]
    ds_read_b64_tr_b16 v[62:63], v229 offset:0
    s_waitcnt vmcnt(8) lgkmcnt(8)
    v_mfma_f32_16x16x32_bf16 v[16:19], v[80:83], v[160:163], v[16:19]
    buffer_load_dwordx4 v[128:131], v252, s[52:55], s40 offen offset:0 sc1
    buffer_load_dwordx4 v[132:135], v252, s[52:55], s40 offen offset:1024 sc1
    v_mfma_f32_16x16x32_bf16 v[16:19], v[84:87], v[164:167], v[16:19]
    buffer_load_dwordx4 v[136:139], v252, s[52:55], s40 offen offset:2048 sc1
    v_mfma_f32_16x16x32_bf16 v[16:19], v[88:91], v[168:171], v[16:19]
    buffer_load_dwordx4 v[140:143], v252, s[52:55], s40 offen offset:3072 sc1
    ds_read_b64_tr_b16 v[64:65], v4 offset:53248
    v_mfma_f32_16x16x32_bf16 v[16:19], v[92:95], v[172:175], v[16:19]
    ds_read_b64_tr_b16 v[66:67], v8 offset:53248
    v_mfma_f32_16x16x32_bf16 v[32:35], v[92:95], v[188:191], v[32:35]
    ds_read_b64_tr_b16 v[68:69], v4 offset:57344
    ds_read_b64_tr_b16 v[70:71], v8 offset:57344
    v_mfma_f32_16x16x32_bf16 v[32:35], v[88:91], v[184:187], v[32:35]
    ds_read_b64_tr_b16 v[72:73], v4 offset:61440
    v_mfma_f32_16x16x32_bf16 v[32:35], v[84:87], v[180:183], v[32:35]
    ds_read_b64_tr_b16 v[74:75], v8 offset:61440
    ds_read_b64_tr_b16 v[76:77], v226 offset:0
    v_mfma_f32_16x16x32_bf16 v[32:35], v[80:83], v[176:179], v[32:35]
    ds_read_b64_tr_b16 v[78:79], v230 offset:0
    s_waitcnt lgkmcnt(8)
    v_mfma_f32_16x16x32_bf16 v[36:39], v[48:51], v[176:179], v[36:39]
    buffer_load_dwordx4 v[144:147], v15, s[52:55], s40 offen offset:0 sc1
    buffer_load_dwordx4 v[148:151], v15, s[52:55], s40 offen offset:1024 sc1
    v_mfma_f32_16x16x32_bf16 v[36:39], v[52:55], v[180:183], v[36:39]
    ds_read_b64_tr_b16 v[80:81], v5 offset:53248
    v_mfma_f32_16x16x32_bf16 v[36:39], v[56:59], v[184:187], v[36:39]
    ds_read_b64_tr_b16 v[82:83], v9 offset:53248
    v_mfma_f32_16x16x32_bf16 v[36:39], v[60:63], v[188:191], v[36:39]
    ds_read_b64_tr_b16 v[84:85], v5 offset:57344
    v_mfma_f32_16x16x32_bf16 v[20:23], v[60:63], v[172:175], v[20:23]
    ds_read_b64_tr_b16 v[86:87], v9 offset:57344
    ds_read_b64_tr_b16 v[88:89], v5 offset:61440
    v_mfma_f32_16x16x32_bf16 v[20:23], v[56:59], v[168:171], v[20:23]
    ds_read_b64_tr_b16 v[90:91], v9 offset:61440
    v_mfma_f32_16x16x32_bf16 v[20:23], v[52:55], v[164:167], v[20:23]
    ds_read_b64_tr_b16 v[92:93], v227 offset:0
    v_mfma_f32_16x16x32_bf16 v[20:23], v[48:51], v[160:163], v[20:23]
    ds_read_b64_tr_b16 v[94:95], v231 offset:0
    s_waitcnt lgkmcnt(8)
    v_mfma_f32_16x16x32_bf16 v[24:27], v[64:67], v[160:163], v[24:27]
    buffer_load_dwordx4 v[152:155], v15, s[52:55], s40 offen offset:2048 sc1
    buffer_load_dwordx4 v[156:159], v15, s[52:55], s40 offen offset:3072 sc1
    v_mfma_f32_16x16x32_bf16 v[24:27], v[68:71], v[164:167], v[24:27]
    ds_read_b64_tr_b16 v[48:49], v224 offset:4096
    v_mfma_f32_16x16x32_bf16 v[24:27], v[72:75], v[168:171], v[24:27]
    ds_read_b64_tr_b16 v[50:51], v228 offset:4096
    v_mfma_f32_16x16x32_bf16 v[24:27], v[76:79], v[172:175], v[24:27]
    ds_read_b64_tr_b16 v[52:53], v2 offset:0
    v_mfma_f32_16x16x32_bf16 v[40:43], v[76:79], v[188:191], v[40:43]
    ds_read_b64_tr_b16 v[54:55], v6 offset:0
    ds_read_b64_tr_b16 v[56:57], v2 offset:4096
    v_mfma_f32_16x16x32_bf16 v[40:43], v[72:75], v[184:187], v[40:43]
    ds_read_b64_tr_b16 v[58:59], v6 offset:4096
    v_mfma_f32_16x16x32_bf16 v[40:43], v[68:71], v[180:183], v[40:43]
    ds_read_b64_tr_b16 v[60:61], v2 offset:8192
    v_mfma_f32_16x16x32_bf16 v[40:43], v[64:67], v[176:179], v[40:43]
    ds_read_b64_tr_b16 v[62:63], v6 offset:8192
    s_waitcnt lgkmcnt(8)
    v_mfma_f32_16x16x32_bf16 v[44:47], v[80:83], v[176:179], v[44:47]
    ds_read_b64_tr_b16 v[64:65], v225 offset:4096
    v_mfma_f32_16x16x32_bf16 v[44:47], v[84:87], v[180:183], v[44:47]
    ds_read_b64_tr_b16 v[66:67], v229 offset:4096
    v_mfma_f32_16x16x32_bf16 v[44:47], v[88:91], v[184:187], v[44:47]
    ds_read_b64_tr_b16 v[68:69], v3 offset:0
    v_mfma_f32_16x16x32_bf16 v[44:47], v[92:95], v[188:191], v[44:47]
    ds_read_b64_tr_b16 v[70:71], v7 offset:0
    v_mfma_f32_16x16x32_bf16 v[28:31], v[92:95], v[172:175], v[28:31]
    ds_read_b64_tr_b16 v[72:73], v3 offset:4096
    v_mfma_f32_16x16x32_bf16 v[28:31], v[88:91], v[168:171], v[28:31]
    ds_read_b64_tr_b16 v[74:75], v7 offset:4096
    v_mfma_f32_16x16x32_bf16 v[28:31], v[84:87], v[164:167], v[28:31]
    ds_read_b64_tr_b16 v[76:77], v3 offset:8192
    v_mfma_f32_16x16x32_bf16 v[28:31], v[80:83], v[160:163], v[28:31]
    ds_read_b64_tr_b16 v[78:79], v7 offset:8192
    s_waitcnt vmcnt(8) lgkmcnt(8)
    v_mfma_f32_16x16x32_bf16 v[16:19], v[48:51], v[96:99], v[16:19]
    buffer_load_dwordx4 v[160:163], v252, s[52:55], s41 offen offset:0 sc1
    buffer_load_dwordx4 v[164:167], v252, s[52:55], s41 offen offset:1024 sc1
    v_mfma_f32_16x16x32_bf16 v[16:19], v[52:55], v[100:103], v[16:19]
    buffer_load_dwordx4 v[168:171], v252, s[52:55], s41 offen offset:2048 sc1
    v_mfma_f32_16x16x32_bf16 v[16:19], v[56:59], v[104:107], v[16:19]
    buffer_load_dwordx4 v[172:175], v252, s[52:55], s41 offen offset:3072 sc1
    ds_read_b64_tr_b16 v[80:81], v226 offset:4096
    v_mfma_f32_16x16x32_bf16 v[16:19], v[60:63], v[108:111], v[16:19]
    ds_read_b64_tr_b16 v[82:83], v230 offset:4096
    v_mfma_f32_16x16x32_bf16 v[32:35], v[60:63], v[124:127], v[32:35]
    ds_read_b64_tr_b16 v[84:85], v4 offset:0
    ds_read_b64_tr_b16 v[86:87], v8 offset:0
    v_mfma_f32_16x16x32_bf16 v[32:35], v[56:59], v[120:123], v[32:35]
    ds_read_b64_tr_b16 v[88:89], v4 offset:4096
    v_mfma_f32_16x16x32_bf16 v[32:35], v[52:55], v[116:119], v[32:35]
    ds_read_b64_tr_b16 v[90:91], v8 offset:4096
    ds_read_b64_tr_b16 v[92:93], v4 offset:8192
    v_mfma_f32_16x16x32_bf16 v[32:35], v[48:51], v[112:115], v[32:35]
    ds_read_b64_tr_b16 v[94:95], v8 offset:8192
    s_waitcnt lgkmcnt(8)
    v_mfma_f32_16x16x32_bf16 v[36:39], v[64:67], v[112:115], v[36:39]
    buffer_load_dwordx4 v[176:179], v15, s[52:55], s41 offen offset:0 sc1
    buffer_load_dwordx4 v[180:183], v15, s[52:55], s41 offen offset:1024 sc1
    v_mfma_f32_16x16x32_bf16 v[36:39], v[68:71], v[116:119], v[36:39]
    ds_read_b64_tr_b16 v[48:49], v227 offset:4096
    v_mfma_f32_16x16x32_bf16 v[36:39], v[72:75], v[120:123], v[36:39]
    ds_read_b64_tr_b16 v[50:51], v231 offset:4096
    v_mfma_f32_16x16x32_bf16 v[36:39], v[76:79], v[124:127], v[36:39]
    ds_read_b64_tr_b16 v[52:53], v5 offset:0
    v_mfma_f32_16x16x32_bf16 v[20:23], v[76:79], v[108:111], v[20:23]
    ds_read_b64_tr_b16 v[54:55], v9 offset:0
    ds_read_b64_tr_b16 v[56:57], v5 offset:4096
    v_mfma_f32_16x16x32_bf16 v[20:23], v[72:75], v[104:107], v[20:23]
    ds_read_b64_tr_b16 v[58:59], v9 offset:4096
    v_mfma_f32_16x16x32_bf16 v[20:23], v[68:71], v[100:103], v[20:23]
    ds_read_b64_tr_b16 v[60:61], v5 offset:8192
    v_mfma_f32_16x16x32_bf16 v[20:23], v[64:67], v[96:99], v[20:23]
    ds_read_b64_tr_b16 v[62:63], v9 offset:8192
    s_mov_b64 exec, 1
    ds_add_u32 v10, v11 offset:28
    s_mov_b64 exec, -1
    s_waitcnt lgkmcnt(9)
    v_mfma_f32_16x16x32_bf16 v[24:27], v[80:83], v[96:99], v[24:27]
    buffer_load_dwordx4 v[184:187], v15, s[52:55], s41 offen offset:2048 sc1
    buffer_load_dwordx4 v[188:191], v15, s[52:55], s41 offen offset:3072 sc1
    v_mfma_f32_16x16x32_bf16 v[24:27], v[84:87], v[100:103], v[24:27]
    ds_read_b64_tr_b16 v[64:65], v2 offset:12288
    v_mfma_f32_16x16x32_bf16 v[24:27], v[88:91], v[104:107], v[24:27]
    ds_read_b64_tr_b16 v[66:67], v6 offset:12288
    v_mfma_f32_16x16x32_bf16 v[24:27], v[92:95], v[108:111], v[24:27]
    ds_read_b64_tr_b16 v[68:69], v2 offset:16384
    v_mfma_f32_16x16x32_bf16 v[40:43], v[92:95], v[124:127], v[40:43]
    ds_read_b64_tr_b16 v[70:71], v6 offset:16384
    ds_read_b64_tr_b16 v[72:73], v2 offset:20480
    v_mfma_f32_16x16x32_bf16 v[40:43], v[88:91], v[120:123], v[40:43]
    ds_read_b64_tr_b16 v[74:75], v6 offset:20480
    v_mfma_f32_16x16x32_bf16 v[40:43], v[84:87], v[116:119], v[40:43]
    ds_read_b64_tr_b16 v[76:77], v224 offset:8192
    v_mfma_f32_16x16x32_bf16 v[40:43], v[80:83], v[112:115], v[40:43]
    ds_read_b64_tr_b16 v[78:79], v228 offset:8192
    s_waitcnt lgkmcnt(9)
    v_mfma_f32_16x16x32_bf16 v[44:47], v[48:51], v[112:115], v[44:47]
    ds_read_b64_tr_b16 v[80:81], v3 offset:12288
    v_mfma_f32_16x16x32_bf16 v[44:47], v[52:55], v[116:119], v[44:47]
    ds_read_b64_tr_b16 v[82:83], v7 offset:12288
    v_mfma_f32_16x16x32_bf16 v[44:47], v[56:59], v[120:123], v[44:47]
    ds_read_b64_tr_b16 v[84:85], v3 offset:16384
    v_mfma_f32_16x16x32_bf16 v[44:47], v[60:63], v[124:127], v[44:47]
    ds_read_b64_tr_b16 v[86:87], v7 offset:16384
    v_mfma_f32_16x16x32_bf16 v[28:31], v[60:63], v[108:111], v[28:31]
    ds_read_b64_tr_b16 v[88:89], v3 offset:20480
    v_mfma_f32_16x16x32_bf16 v[28:31], v[56:59], v[104:107], v[28:31]
    ds_read_b64_tr_b16 v[90:91], v7 offset:20480
    v_mfma_f32_16x16x32_bf16 v[28:31], v[52:55], v[100:103], v[28:31]
    ds_read_b64_tr_b16 v[92:93], v225 offset:8192
    v_mfma_f32_16x16x32_bf16 v[28:31], v[48:51], v[96:99], v[28:31]
    ds_read_b64_tr_b16 v[94:95], v229 offset:8192
    s_waitcnt vmcnt(8) lgkmcnt(8)
    v_mfma_f32_16x16x32_bf16 v[16:19], v[64:67], v[128:131], v[16:19]
    buffer_load_dwordx4 v[96:99], v252, s[52:55], s42 offen offset:0 sc1
    buffer_load_dwordx4 v[100:103], v252, s[52:55], s42 offen offset:1024 sc1
    v_mfma_f32_16x16x32_bf16 v[16:19], v[68:71], v[132:135], v[16:19]
    buffer_load_dwordx4 v[104:107], v252, s[52:55], s42 offen offset:2048 sc1
    v_mfma_f32_16x16x32_bf16 v[16:19], v[72:75], v[136:139], v[16:19]
    buffer_load_dwordx4 v[108:111], v252, s[52:55], s42 offen offset:3072 sc1
    ds_read_b64_tr_b16 v[48:49], v4 offset:12288
    v_mfma_f32_16x16x32_bf16 v[16:19], v[76:79], v[140:143], v[16:19]
    ds_read_b64_tr_b16 v[50:51], v8 offset:12288
    v_mfma_f32_16x16x32_bf16 v[32:35], v[76:79], v[156:159], v[32:35]
    ds_read_b64_tr_b16 v[52:53], v4 offset:16384
    ds_read_b64_tr_b16 v[54:55], v8 offset:16384
    v_mfma_f32_16x16x32_bf16 v[32:35], v[72:75], v[152:155], v[32:35]
    ds_read_b64_tr_b16 v[56:57], v4 offset:20480
    v_mfma_f32_16x16x32_bf16 v[32:35], v[68:71], v[148:151], v[32:35]
    ds_read_b64_tr_b16 v[58:59], v8 offset:20480
    ds_read_b64_tr_b16 v[60:61], v226 offset:8192
    v_mfma_f32_16x16x32_bf16 v[32:35], v[64:67], v[144:147], v[32:35]
    ds_read_b64_tr_b16 v[62:63], v230 offset:8192
    s_waitcnt lgkmcnt(8)
    v_mfma_f32_16x16x32_bf16 v[36:39], v[80:83], v[144:147], v[36:39]
    buffer_load_dwordx4 v[112:115], v15, s[52:55], s42 offen offset:0 sc1
    buffer_load_dwordx4 v[116:119], v15, s[52:55], s42 offen offset:1024 sc1
    v_mfma_f32_16x16x32_bf16 v[36:39], v[84:87], v[148:151], v[36:39]
    ds_read_b64_tr_b16 v[64:65], v5 offset:12288
    v_mfma_f32_16x16x32_bf16 v[36:39], v[88:91], v[152:155], v[36:39]
    ds_read_b64_tr_b16 v[66:67], v9 offset:12288
    v_mfma_f32_16x16x32_bf16 v[36:39], v[92:95], v[156:159], v[36:39]
    ds_read_b64_tr_b16 v[68:69], v5 offset:16384
    v_mfma_f32_16x16x32_bf16 v[20:23], v[92:95], v[140:143], v[20:23]
    ds_read_b64_tr_b16 v[70:71], v9 offset:16384
    ds_read_b64_tr_b16 v[72:73], v5 offset:20480
    v_mfma_f32_16x16x32_bf16 v[20:23], v[88:91], v[136:139], v[20:23]
    ds_read_b64_tr_b16 v[74:75], v9 offset:20480
    v_mfma_f32_16x16x32_bf16 v[20:23], v[84:87], v[132:135], v[20:23]
    ds_read_b64_tr_b16 v[76:77], v227 offset:8192
    v_mfma_f32_16x16x32_bf16 v[20:23], v[80:83], v[128:131], v[20:23]
    ds_read_b64_tr_b16 v[78:79], v231 offset:8192
    s_waitcnt lgkmcnt(8)
    v_mfma_f32_16x16x32_bf16 v[24:27], v[48:51], v[128:131], v[24:27]
    buffer_load_dwordx4 v[120:123], v15, s[52:55], s42 offen offset:2048 sc1
    buffer_load_dwordx4 v[124:127], v15, s[52:55], s42 offen offset:3072 sc1
    v_mfma_f32_16x16x32_bf16 v[24:27], v[52:55], v[132:135], v[24:27]
    ds_read_b64_tr_b16 v[80:81], v224 offset:12288
    v_mfma_f32_16x16x32_bf16 v[24:27], v[56:59], v[136:139], v[24:27]
    ds_read_b64_tr_b16 v[82:83], v228 offset:12288
    v_mfma_f32_16x16x32_bf16 v[24:27], v[60:63], v[140:143], v[24:27]
    ds_read_b64_tr_b16 v[84:85], v224 offset:16384
    v_mfma_f32_16x16x32_bf16 v[40:43], v[60:63], v[156:159], v[40:43]
    ds_read_b64_tr_b16 v[86:87], v228 offset:16384
    ds_read_b64_tr_b16 v[88:89], v224 offset:20480
    v_mfma_f32_16x16x32_bf16 v[40:43], v[56:59], v[152:155], v[40:43]
    ds_read_b64_tr_b16 v[90:91], v228 offset:20480
    v_mfma_f32_16x16x32_bf16 v[40:43], v[52:55], v[148:151], v[40:43]
    ds_read_b64_tr_b16 v[92:93], v2 offset:24576
    v_mfma_f32_16x16x32_bf16 v[40:43], v[48:51], v[144:147], v[40:43]
    ds_read_b64_tr_b16 v[94:95], v6 offset:24576
    s_waitcnt lgkmcnt(8)
    v_mfma_f32_16x16x32_bf16 v[44:47], v[64:67], v[144:147], v[44:47]
    ds_read_b64_tr_b16 v[48:49], v225 offset:12288
    v_mfma_f32_16x16x32_bf16 v[44:47], v[68:71], v[148:151], v[44:47]
    ds_read_b64_tr_b16 v[50:51], v229 offset:12288
    v_mfma_f32_16x16x32_bf16 v[44:47], v[72:75], v[152:155], v[44:47]
    ds_read_b64_tr_b16 v[52:53], v225 offset:16384
    v_mfma_f32_16x16x32_bf16 v[44:47], v[76:79], v[156:159], v[44:47]
    ds_read_b64_tr_b16 v[54:55], v229 offset:16384
    v_mfma_f32_16x16x32_bf16 v[28:31], v[76:79], v[140:143], v[28:31]
    ds_read_b64_tr_b16 v[56:57], v225 offset:20480
    v_mfma_f32_16x16x32_bf16 v[28:31], v[72:75], v[136:139], v[28:31]
    ds_read_b64_tr_b16 v[58:59], v229 offset:20480
    v_mfma_f32_16x16x32_bf16 v[28:31], v[68:71], v[132:135], v[28:31]
    ds_read_b64_tr_b16 v[60:61], v3 offset:24576
    v_mfma_f32_16x16x32_bf16 v[28:31], v[64:67], v[128:131], v[28:31]
    ds_read_b64_tr_b16 v[62:63], v7 offset:24576
    s_waitcnt vmcnt(8) lgkmcnt(8)
    v_mfma_f32_16x16x32_bf16 v[16:19], v[80:83], v[160:163], v[16:19]
    buffer_load_dwordx4 v[128:131], v252, s[52:55], s43 offen offset:0 sc1
    buffer_load_dwordx4 v[132:135], v252, s[52:55], s43 offen offset:1024 sc1
    v_mfma_f32_16x16x32_bf16 v[16:19], v[84:87], v[164:167], v[16:19]
    buffer_load_dwordx4 v[136:139], v252, s[52:55], s43 offen offset:2048 sc1
    v_mfma_f32_16x16x32_bf16 v[16:19], v[88:91], v[168:171], v[16:19]
    buffer_load_dwordx4 v[140:143], v252, s[52:55], s43 offen offset:3072 sc1
    ds_read_b64_tr_b16 v[64:65], v226 offset:12288
    v_mfma_f32_16x16x32_bf16 v[16:19], v[92:95], v[172:175], v[16:19]
    ds_read_b64_tr_b16 v[66:67], v230 offset:12288
    v_mfma_f32_16x16x32_bf16 v[32:35], v[92:95], v[188:191], v[32:35]
    ds_read_b64_tr_b16 v[68:69], v226 offset:16384
    ds_read_b64_tr_b16 v[70:71], v230 offset:16384
    v_mfma_f32_16x16x32_bf16 v[32:35], v[88:91], v[184:187], v[32:35]
    ds_read_b64_tr_b16 v[72:73], v226 offset:20480
    v_mfma_f32_16x16x32_bf16 v[32:35], v[84:87], v[180:183], v[32:35]
    ds_read_b64_tr_b16 v[74:75], v230 offset:20480
    ds_read_b64_tr_b16 v[76:77], v4 offset:24576
    v_mfma_f32_16x16x32_bf16 v[32:35], v[80:83], v[176:179], v[32:35]
    ds_read_b64_tr_b16 v[78:79], v8 offset:24576
    s_mov_b64 exec, 1
    ds_add_u32 v10, v11 offset:40
    s_mov_b64 exec, -1
    s_waitcnt lgkmcnt(9)
    v_mfma_f32_16x16x32_bf16 v[36:39], v[48:51], v[176:179], v[36:39]
    buffer_load_dwordx4 v[144:147], v15, s[52:55], s43 offen offset:0 sc1
    buffer_load_dwordx4 v[148:151], v15, s[52:55], s43 offen offset:1024 sc1
    v_mfma_f32_16x16x32_bf16 v[36:39], v[52:55], v[180:183], v[36:39]
    ds_read_b32 v223, v10 offset:32
    v_mfma_f32_16x16x32_bf16 v[36:39], v[56:59], v[184:187], v[36:39]
    ds_read_b64_tr_b16 v[80:81], v227 offset:12288
    ds_read_b64_tr_b16 v[82:83], v231 offset:12288
    v_mfma_f32_16x16x32_bf16 v[36:39], v[60:63], v[188:191], v[36:39]
    ds_read_b64_tr_b16 v[84:85], v227 offset:16384
    v_mfma_f32_16x16x32_bf16 v[20:23], v[60:63], v[172:175], v[20:23]
    ds_read_b64_tr_b16 v[86:87], v231 offset:16384
    v_mfma_f32_16x16x32_bf16 v[20:23], v[56:59], v[168:171], v[20:23]
    ds_read_b64_tr_b16 v[88:89], v227 offset:20480
    ds_read_b64_tr_b16 v[90:91], v231 offset:20480
    v_mfma_f32_16x16x32_bf16 v[20:23], v[52:55], v[164:167], v[20:23]
    ds_read_b64_tr_b16 v[92:93], v5 offset:24576
    v_mfma_f32_16x16x32_bf16 v[20:23], v[48:51], v[160:163], v[20:23]
    ds_read_b64_tr_b16 v[94:95], v9 offset:24576
    s_waitcnt lgkmcnt(8)
    v_cmp_gt_u32 vcc, 4, v223
    s_cbranch_vccnz LB_w8
LB_g8:
    v_mfma_f32_16x16x32_bf16 v[24:27], v[64:67], v[160:163], v[24:27]
    buffer_load_dwordx4 v[152:155], v15, s[52:55], s43 offen offset:2048 sc1
    buffer_load_dwordx4 v[156:159], v15, s[52:55], s43 offen offset:3072 sc1
    v_mfma_f32_16x16x32_bf16 v[24:27], v[68:71], v[164:167], v[24:27]
    ds_read_b64_tr_b16 v[48:49], v2 offset:28672
    v_mfma_f32_16x16x32_bf16 v[24:27], v[72:75], v[168:171], v[24:27]
    ds_read_b64_tr_b16 v[50:51], v6 offset:28672
    v_mfma_f32_16x16x32_bf16 v[24:27], v[76:79], v[172:175], v[24:27]
    ds_read_b64_tr_b16 v[52:53], v2 offset:32768
    v_mfma_f32_16x16x32_bf16 v[40:43], v[76:79], v[188:191], v[40:43]
    ds_read_b64_tr_b16 v[54:55], v6 offset:32768
    ds_read_b64_tr_b16 v[56:57], v232 offset:0
    v_mfma_f32_16x16x32_bf16 v[40:43], v[72:75], v[184:187], v[40:43]
    ds_read_b64_tr_b16 v[58:59], v236 offset:0
    v_mfma_f32_16x16x32_bf16 v[40:43], v[68:71], v[180:183], v[40:43]
    ds_read_b64_tr_b16 v[60:61], v232 offset:4096
    v_mfma_f32_16x16x32_bf16 v[40:43], v[64:67], v[176:179], v[40:43]
    ds_read_b64_tr_b16 v[62:63], v236 offset:4096
    s_waitcnt lgkmcnt(8)
    v_mfma_f32_16x16x32_bf16 v[44:47], v[80:83], v[176:179], v[44:47]
    ds_read_b64_tr_b16 v[64:65], v3 offset:28672
    v_mfma_f32_16x16x32_bf16 v[44:47], v[84:87], v[180:183], v[44:47]
    ds_read_b64_tr_b16 v[66:67], v7 offset:28672
    v_mfma_f32_16x16x32_bf16 v[44:47], v[88:91], v[184:187], v[44:47]
    ds_read_b64_tr_b16 v[68:69], v3 offset:32768
    v_mfma_f32_16x16x32_bf16 v[44:47], v[92:95], v[188:191], v[44:47]
    ds_read_b64_tr_b16 v[70:71], v7 offset:32768
    v_mfma_f32_16x16x32_bf16 v[28:31], v[92:95], v[172:175], v[28:31]
    ds_read_b64_tr_b16 v[72:73], v233 offset:0
    v_mfma_f32_16x16x32_bf16 v[28:31], v[88:91], v[168:171], v[28:31]
    ds_read_b64_tr_b16 v[74:75], v237 offset:0
    v_mfma_f32_16x16x32_bf16 v[28:31], v[84:87], v[164:167], v[28:31]
    ds_read_b64_tr_b16 v[76:77], v233 offset:4096
    v_mfma_f32_16x16x32_bf16 v[28:31], v[80:83], v[160:163], v[28:31]
    ds_read_b64_tr_b16 v[78:79], v237 offset:4096
    s_waitcnt vmcnt(8) lgkmcnt(8)
    v_mfma_f32_16x16x32_bf16 v[16:19], v[48:51], v[96:99], v[16:19]
    ds_read_b64_tr_b16 v[80:81], v4 offset:28672
    v_mfma_f32_16x16x32_bf16 v[16:19], v[52:55], v[100:103], v[16:19]
    ds_read_b64_tr_b16 v[82:83], v8 offset:28672
    v_mfma_f32_16x16x32_bf16 v[16:19], v[56:59], v[104:107], v[16:19]
    ds_read_b64_tr_b16 v[84:85], v4 offset:32768
    v_mfma_f32_16x16x32_bf16 v[16:19], v[60:63], v[108:111], v[16:19]
    ds_read_b64_tr_b16 v[86:87], v8 offset:32768
    v_mfma_f32_16x16x32_bf16 v[32:35], v[60:63], v[124:127], v[32:35]
    ds_read_b64_tr_b16 v[88:89], v234 offset:0
    v_mfma_f32_16x16x32_bf16 v[32:35], v[56:59], v[120:123], v[32:35]
    ds_read_b64_tr_b16 v[90:91], v238 offset:0
    v_mfma_f32_16x16x32_bf16 v[32:35], v[52:55], v[116:119], v[32:35]
    ds_read_b64_tr_b16 v[92:93], v234 offset:4096
    v_mfma_f32_16x16x32_bf16 v[32:35], v[48:51], v[112:115], v[32:35]
    ds_read_b64_tr_b16 v[94:95], v238 offset:4096
    s_waitcnt lgkmcnt(8)
    v_mfma_f32_16x16x32_bf16 v[36:39], v[64:67], v[112:115], v[36:39]
    ds_read_b64_tr_b16 v[48:49], v5 offset:28672
    v_mfma_f32_16x16x32_bf16 v[36:39], v[68:71], v[116:119], v[36:39]
    ds_read_b64_tr_b16 v[50:51], v9 offset:28672
    v_mfma_f32_16x16x32_bf16 v[36:39], v[72:75], v[120:123], v[36:39]
    ds_read_b64_tr_b16 v[52:53], v5 offset:32768
    v_mfma_f32_16x16x32_bf16 v[36:39], v[76:79], v[124:127], v[36:39]
    ds_read_b64_tr_b16 v[54:55], v9 offset:32768
    v_mfma_f32_16x16x32_bf16 v[20:23], v[76:79], v[108:111], v[20:23]
    ds_read_b64_tr_b16 v[56:57], v235 offset:0
    v_mfma_f32_16x16x32_bf16 v[20:23], v[72:75], v[104:107], v[20:23]
    ds_read_b64_tr_b16 v[58:59], v239 offset:0
    v_mfma_f32_16x16x32_bf16 v[20:23], v[68:71], v[100:103], v[20:23]
    ds_read_b64_tr_b16 v[60:61], v235 offset:4096
    v_mfma_f32_16x16x32_bf16 v[20:23], v[64:67], v[96:99], v[20:23]
    ds_read_b64_tr_b16 v[62:63], v239 offset:4096
    s_waitcnt lgkmcnt(8)
    v_mfma_f32_16x16x32_bf16 v[24:27], v[80:83], v[96:99], v[24:27]
    ds_read_b64_tr_b16 v[64:65], v232 offset:8192
    v_mfma_f32_16x16x32_bf16 v[24:27], v[84:87], v[100:103], v[24:27]
    ds_read_b64_tr_b16 v[66:67], v236 offset:8192
    v_mfma_f32_16x16x32_bf16 v[24:27], v[88:91], v[104:107], v[24:27]
    ds_read_b64_tr_b16 v[68:69], v232 offset:12288
    v_mfma_f32_16x16x32_bf16 v[24:27], v[92:95], v[108:111], v[24:27]
    ds_read_b64_tr_b16 v[70:71], v236 offset:12288
    v_mfma_f32_16x16x32_bf16 v[40:43], v[92:95], v[124:127], v[40:43]
    ds_read_b64_tr_b16 v[72:73], v232 offset:16384
    v_mfma_f32_16x16x32_bf16 v[40:43], v[88:91], v[120:123], v[40:43]
    ds_read_b64_tr_b16 v[74:75], v236 offset:16384
    v_mfma_f32_16x16x32_bf16 v[40:43], v[84:87], v[116:119], v[40:43]
    ds_read_b64_tr_b16 v[76:77], v232 offset:20480
    v_mfma_f32_16x16x32_bf16 v[40:43], v[80:83], v[112:115], v[40:43]
    ds_read_b64_tr_b16 v[78:79], v236 offset:20480
    s_waitcnt lgkmcnt(8)
    v_mfma_f32_16x16x32_bf16 v[44:47], v[48:51], v[112:115], v[44:47]
    ds_read_b64_tr_b16 v[80:81], v233 offset:8192
    v_mfma_f32_16x16x32_bf16 v[44:47], v[52:55], v[116:119], v[44:47]
    ds_read_b64_tr_b16 v[82:83], v237 offset:8192
    v_mfma_f32_16x16x32_bf16 v[44:47], v[56:59], v[120:123], v[44:47]
    ds_read_b64_tr_b16 v[84:85], v233 offset:12288
    v_mfma_f32_16x16x32_bf16 v[44:47], v[60:63], v[124:127], v[44:47]
    ds_read_b64_tr_b16 v[86:87], v237 offset:12288
    v_mfma_f32_16x16x32_bf16 v[28:31], v[60:63], v[108:111], v[28:31]
    ds_read_b64_tr_b16 v[88:89], v233 offset:16384
    v_mfma_f32_16x16x32_bf16 v[28:31], v[56:59], v[104:107], v[28:31]
    ds_read_b64_tr_b16 v[90:91], v237 offset:16384
    v_mfma_f32_16x16x32_bf16 v[28:31], v[52:55], v[100:103], v[28:31]
    ds_read_b64_tr_b16 v[92:93], v233 offset:20480
    v_mfma_f32_16x16x32_bf16 v[28:31], v[48:51], v[96:99], v[28:31]
    ds_read_b64_tr_b16 v[94:95], v237 offset:20480
    s_waitcnt vmcnt(0) lgkmcnt(8)
    v_mfma_f32_16x16x32_bf16 v[16:19], v[64:67], v[128:131], v[16:19]
    ds_read_b32 v223, v10 offset:40
    ds_read_b64_tr_b16 v[48:49], v234 offset:8192
    v_mfma_f32_16x16x32_bf16 v[16:19], v[68:71], v[132:135], v[16:19]
    ds_read_b64_tr_b16 v[50:51], v238 offset:8192
    v_mfma_f32_16x16x32_bf16 v[16:19], v[72:75], v[136:139], v[16:19]
    ds_read_b64_tr_b16 v[52:53], v234 offset:12288
    v_mfma_f32_16x16x32_bf16 v[16:19], v[76:79], v[140:143], v[16:19]
    ds_read_b64_tr_b16 v[54:55], v238 offset:12288
    v_mfma_f32_16x16x32_bf16 v[32:35], v[76:79], v[156:159], v[32:35]
    ds_read_b64_tr_b16 v[56:57], v234 offset:16384
    v_mfma_f32_16x16x32_bf16 v[32:35], v[72:75], v[152:155], v[32:35]
    ds_read_b64_tr_b16 v[58:59], v238 offset:16384
    v_mfma_f32_16x16x32_bf16 v[32:35], v[68:71], v[148:151], v[32:35]
    ds_read_b64_tr_b16 v[60:61], v234 offset:20480
    v_mfma_f32_16x16x32_bf16 v[32:35], v[64:67], v[144:147], v[32:35]
    ds_read_b64_tr_b16 v[62:63], v238 offset:20480
    s_waitcnt lgkmcnt(9)
    v_mfma_f32_16x16x32_bf16 v[36:39], v[80:83], v[144:147], v[36:39]
    ds_read_b64_tr_b16 v[64:65], v235 offset:8192
    v_mfma_f32_16x16x32_bf16 v[36:39], v[84:87], v[148:151], v[36:39]
    ds_read_b64_tr_b16 v[66:67], v239 offset:8192
    v_mfma_f32_16x16x32_bf16 v[36:39], v[88:91], v[152:155], v[36:39]
    ds_read_b64_tr_b16 v[68:69], v235 offset:12288
    v_mfma_f32_16x16x32_bf16 v[36:39], v[92:95], v[156:159], v[36:39]
    ds_read_b64_tr_b16 v[70:71], v239 offset:12288
    v_mfma_f32_16x16x32_bf16 v[20:23], v[92:95], v[140:143], v[20:23]
    ds_read_b64_tr_b16 v[72:73], v235 offset:16384
    v_mfma_f32_16x16x32_bf16 v[20:23], v[88:91], v[136:139], v[20:23]
    ds_read_b64_tr_b16 v[74:75], v239 offset:16384
    v_mfma_f32_16x16x32_bf16 v[20:23], v[84:87], v[132:135], v[20:23]
    ds_read_b64_tr_b16 v[76:77], v235 offset:20480
    v_mfma_f32_16x16x32_bf16 v[20:23], v[80:83], v[128:131], v[20:23]
    ds_read_b64_tr_b16 v[78:79], v239 offset:20480
    s_waitcnt lgkmcnt(14)
    v_cmp_gt_u32 vcc, 4, v223
    s_cbranch_vccnz LB_w7
LB_g7:
    v_mfma_f32_16x16x32_bf16 v[24:27], v[48:51], v[128:131], v[24:27]
    s_nop 1
    v_cvt_pk_bf16_f32 v200, v32, v33
    s_waitcnt lgkmcnt(12)
    v_mfma_f32_16x16x32_bf16 v[24:27], v[52:55], v[132:135], v[24:27]
    v_cvt_pk_bf16_f32 v201, v34, v35
    v_cvt_pk_bf16_f32 v202, v36, v37
    s_waitcnt lgkmcnt(10)
    v_mfma_f32_16x16x32_bf16 v[24:27], v[56:59], v[136:139], v[24:27]
    v_cvt_pk_bf16_f32 v203, v38, v39
    v_permlane16_swap_b32 v200, v202
    s_waitcnt lgkmcnt(8)
    v_mfma_f32_16x16x32_bf16 v[24:27], v[60:63], v[140:143], v[24:27]
    v_permlane16_swap_b32 v201, v203
    ds_write_b128 v248, v[200:203] offset:2048
    v_mfma_f32_16x16x32_bf16 v[40:43], v[60:63], v[156:159], v[40:43]
    v_cvt_pk_bf16_f32 v192, v16, v17
    v_cvt_pk_bf16_f32 v193, v18, v19
    v_mfma_f32_16x16x32_bf16 v[40:43], v[56:59], v[152:155], v[40:43]
    v_cvt_pk_bf16_f32 v194, v20, v21
    v_cvt_pk_bf16_f32 v195, v22, v23
    v_mfma_f32_16x16x32_bf16 v[40:43], v[52:55], v[148:151], v[40:43]
    v_permlane16_swap_b32 v192, v194
    v_permlane16_swap_b32 v193, v195
    v_mfma_f32_16x16x32_bf16 v[40:43], v[48:51], v[144:147], v[40:43]
    ds_write_b128 v248, v[192:195] offset:0
    v_cvt_pk_bf16_f32 v196, v24, v25
    s_waitcnt lgkmcnt(8)
    v_mfma_f32_16x16x32_bf16 v[44:47], v[64:67], v[144:147], v[44:47]
    v_cvt_pk_bf16_f32 v197, v26, v27
    s_nop 0
    s_waitcnt lgkmcnt(6)
    v_mfma_f32_16x16x32_bf16 v[44:47], v[68:71], v[148:151], v[44:47]
    s_nop 1
    s_waitcnt lgkmcnt(4)
    v_mfma_f32_16x16x32_bf16 v[44:47], v[72:75], v[152:155], v[44:47]
    v_cvt_pk_bf16_f32 v204, v40, v41
    v_cvt_pk_bf16_f32 v205, v42, v43
    s_waitcnt lgkmcnt(2)
    v_mfma_f32_16x16x32_bf16 v[44:47], v[76:79], v[156:159], v[44:47]
    s_nop 1
    v_mfma_f32_16x16x32_bf16 v[28:31], v[76:79], v[140:143], v[28:31]
    s_nop 1
    v_mfma_f32_16x16x32_bf16 v[28:31], v[72:75], v[136:139], v[28:31]
    s_nop 1
    v_mfma_f32_16x16x32_bf16 v[28:31], v[68:71], v[132:135], v[28:31]
    v_cvt_pk_bf16_f32 v206, v44, v45
    v_cvt_pk_bf16_f32 v207, v46, v47
    v_mfma_f32_16x16x32_bf16 v[28:31], v[64:67], v[128:131], v[28:31]
    v_permlane16_swap_b32 v204, v206
    v_permlane16_swap_b32 v205, v207
    ds_write_b128 v249, v[204:207] offset:2048
    ds_read_b128 v[184:187], v250 offset:2048
    ds_read_b128 v[188:191], v250 offset:3072
    s_nop 2
    v_cvt_pk_bf16_f32 v198, v28, v29
    v_cvt_pk_bf16_f32 v199, v30, v31
    s_nop 0
    v_permlane16_swap_b32 v196, v198
    v_permlane16_swap_b32 v197, v199
    ds_write_b128 v249, v[196:199] offset:0
    ds_read_b128 v[176:179], v250 offset:0
    ds_read_b128 v[180:183], v250 offset:1024
    s_mov_b32 s95, 65536
    s_waitcnt lgkmcnt(4)
    buffer_store_dwordx4 v[184:187], v246, s[60:63], s95 offen nt sc1
    s_mov_b32 s95, 98304
    s_waitcnt lgkmcnt(3)
    buffer_store_dwordx4 v[188:191], v246, s[60:63], s95 offen nt sc1
    s_mov_b32 s95, 0
    s_waitcnt lgkmcnt(1)
    buffer_store_dwordx4 v[176:179], v246, s[60:63], s95 offen nt sc1
    s_mov_b32 s95, 32768
    s_waitcnt lgkmcnt(0)
    buffer_store_dwordx4 v[180:183], v246, s[60:63], s95 offen nt sc1
    s_endpgm
LA_slow:
    s_mov_b32 s79, 0
LA_slow1:
    s_mov_b64 exec, vcc
    s_sleep 8
    buffer_load_dword v136, v33, s[68:71], 0 offen sc1
    buffer_load_dword v137, v34, s[52:55], 0 offen sc1
    s_add_u32 s79, s79, 1
    s_cmp_gt_u32 s79, 200000
    s_waitcnt vmcnt(0)
    s_cbranch_scc1 LA_back
    v_cmp_ne_u32 vcc, v136, v137
    v_cmp_gt_u32 s[80:81], s96, v136
    s_nop 0
    s_or_b64 vcc, vcc, s[80:81]
    s_cbranch_vccnz LA_slow1
    s_branch LA_back
LB_tag:
    s_mov_b64 exec, 0xffff
    s_waitcnt vmcnt(0)
    v_lshrrev_b32 v251, v0, v251
    v_and_b32 v251, 1, v251
    v_cmp_eq_u32 vcc, 0, v251
    s_nop 1
    s_or_b32 s83, vcc_lo, 0x10000
    s_mov_b64 exec, 1
    v_mov_b32 v251, s83
    buffer_store_dword v251, v220, s[68:71], s98 offen sc1
    s_mov_b64 exec, -1
    s_branch LB_tagb
LB_slow:
    s_mov_b32 s79, 0
LB_pt:
    buffer_load_dword v222, v220, s[68:71], s98 offen sc1
    s_add_u32 s79, s79, 1
    s_cmp_gt_u32 s79, 200000
    s_cbranch_scc1 LB_pt_x
    s_waitcnt vmcnt(0)
    v_cmp_gt_u32 vcc, 4096, v222
    s_cbranch_vccz LB_pt_x
    s_mov_b64 exec, vcc
    s_sleep 8
    s_branch LB_pt
LB_pt_x:
    s_waitcnt vmcnt(0)
    s_branch LB_back
LB_w1:
    s_branch LB_s1_in
LB_s1:
    s_sleep 1
LB_s1_in:
    ds_read_b32 v223, v10 offset:0
    ds_read_b64 v[204:205], v218
    ds_read_b64 v[206:207], v219
    s_waitcnt lgkmcnt(0)
    v_readfirstlane_b32 s78, v223
    s_nop 0
    s_cmp_ge_u32 s78, 4
    s_cbranch_scc0 LB_s1
    s_branch LB_g1
LB_w6:
    s_branch LB_s6_in
LB_s6:
    s_sleep 1
LB_s6_in:
    ds_read_b32 v223, v10 offset:24
    ds_read_b64 v[224:225], v218 offset:1024
    ds_read_b64 v[234:235], v219 offset:1024
    s_waitcnt lgkmcnt(0)
    v_readfirstlane_b32 s78, v223
    s_nop 0
    s_cmp_ge_u32 s78, 4
    s_cbranch_scc0 LB_s6
    s_branch LB_g6
LB_w4:
    s_branch LB_s4_in
LB_s4:
    s_sleep 1
LB_s4_in:
    ds_read_b32 v222, v10 offset:16
    s_waitcnt lgkmcnt(0)
    v_readfirstlane_b32 s78, v222
    s_nop 0
    s_cmp_ge_u32 s78, 4
    s_cbranch_scc0 LB_s4
    s_branch LB_g4
LB_w8:
    s_branch LB_s8_in
LB_s8:
    s_sleep 1
LB_s8_in:
    ds_read_b32 v223, v10 offset:32
    s_waitcnt lgkmcnt(0)
    v_readfirstlane_b32 s78, v223
    s_nop 0
    s_cmp_ge_u32 s78, 4
    s_cbranch_scc0 LB_s8
    s_branch LB_g8
LB_w7:
    s_branch LB_s7_in
LB_s7:
    s_sleep 1
LB_s7_in:
    ds_read_b32 v223, v10 offset:40
    s_waitcnt lgkmcnt(0)
    v_readfirstlane_b32 s78, v223
    s_nop 0
    s_cmp_ge_u32 s78, 4
    s_cbranch_scc0 LB_s7
    s_branch LB_g7
L_end:
    s_endpgm
.section .rodata,"a"
.p2align 6
.amdhsa_kernel concat_heads__ssm_conv_h3__sliding_local_dilated__prompt_kernel
  .amdhsa_next_free_vgpr 256
  .amdhsa_next_free_sgpr 102
  .amdhsa_accum_offset 256
  .amdhsa_group_segment_fixed_size 0
  .amdhsa_kernarg_size 96
  .amdhsa_user_sgpr_count 2
  .amdhsa_user_sgpr_kernarg_segment_ptr 1
  .amdhsa_system_sgpr_workgroup_id_x 1
.end_amdhsa_kernel
```

```asm
; @launch grid=(256,1,1) block=(512,1,1) lds=163840
.amdgcn_target "amdgcn-amd-amdhsa--gfx950"
.text
.globl concat_heads__ssm_conv_h3__sliding_local_dilated__prompt_kernel
.p2align 8
.type concat_heads__ssm_conv_h3__sliding_local_dilated__prompt_kernel,@function
concat_heads__ssm_conv_h3__sliding_local_dilated__prompt_kernel:
    s_cmp_ge_u32 s2, 256
    s_cbranch_scc1 L_end
    s_load_dwordx2 s[28:29], s[0:1], 48
    s_load_dwordx2 s[32:33], s[0:1], 56
    s_load_dwordx8 s[4:11], s[0:1], 0
    s_load_dwordx4 s[12:15], s[0:1], 32
    s_load_dwordx8 s[20:27], s[0:1], 64
    v_lshrrev_b32 v1, 6, v0
    v_and_b32 v0, 63, v0
    v_readfirstlane_b32 s3, v1
    s_nop 0
    s_cmp_lg_u32 s3, 4
    s_cbranch_scc1 L_nopf
    s_getpc_b64 s[80:81]
L_pc:
    s_bfe_u32 s78, s2, 0x40003
    v_lshl_add_u32 v1, v0, 4, s78
    v_lshlrev_b32 v1, 7, v1
    v_cmp_gt_u32 vcc, L_end-L_pc, v1
    s_nop 0
    s_and_saveexec_b64 s[82:83], vcc
    global_load_dword v222, v1, s[80:81]
    s_mov_b64 exec, -1
L_nopf:
    s_and_b32 s78, s2, 7
    s_lshr_b32 s79, s2, 3
    s_lshl_b32 s78, s78, 2
    s_lshr_b32 s78, 0x75643120, s78
    s_and_b32 s78, s78, 7
    s_and_b32 s80, s78, 1
    s_lshl_b32 s80, s80, 3
    s_lshr_b32 s81, s78, 1
    s_lshl_b32 s81, s81, 2
    s_and_b32 s72, s79, 7
    s_add_u32 s72, s72, s80
    s_lshr_b32 s73, s79, 3
    s_xor_b32 s73, s73, 3
    s_add_u32 s73, s73, s81
    s_cmp_ge_u32 s3, 4
    s_cbranch_scc1 L_B
    v_lshrrev_b32 v5, 3, v0
    v_and_b32 v6, 7, v0
    v_lshrrev_b32 v7, 4, v0
    s_lshl_b32 s79, s72, 7
    s_lshl_b32 s80, s3, 5
    s_add_u32 s81, s79, s80
    v_xor_b32 v8, v7, v6
    v_lshlrev_b32 v8, 4, v8
    v_add_u32 v240, s81, v5
    v_lshl_add_u32 v240, v240, 11, v8
    v_xor_b32 v241, 64, v240
    v_add_u32 v241, 15360, v241
    v_add_u32 v242, 30720, v240
    v_add_u32 v243, 30720, v241
    s_lshl_b32 s87, s3, 12
    s_add_u32 s87, s87, 75776
    s_and_b32 s98, s73, 12
    s_and_b32 s78, s72, 8
    s_add_u32 s98, s98, s78
    s_add_u32 s101, s72, s73
    s_and_b32 s101, s101, 3
    s_lshl_b32 s78, s101, 2
    s_lshr_b32 s97, 0x101, s78
    s_add_u32 s97, s97, s98
    s_and_b32 s97, s97, 15
    s_mov_b32 m0, s87
    s_lshl_b32 s97, s97, 7
    s_mov_b32 s30, 0x400000
    s_mov_b32 s31, 0x20000
    s_waitcnt lgkmcnt(0)
    buffer_load_dwordx4 v240, s[28:31], s97 offen offset:0  lds
    s_and_b32 s78, s3, 1
    s_lshl_b32 s78, s78, 2
    s_lshl_b32 s80, s3, 3
    v_and_b32 v8, 1, v7
    v_lshl_or_b32 v8, v8, 1, s78
    v_xor_b32 v8, v8, v6
    buffer_load_dwordx4 v241, s[28:31], s97 offen offset:1024  lds
    v_lshlrev_b32 v8, 4, v8
    v_add_u32 v244, s80, v5
    v_mul_u32_u24 v244, 6144, v244
    s_lshl_b32 s82, s73, 7
    v_add3_u32 v244, v244, v8, s82
    buffer_load_dwordx4 v242, s[28:31], s97 offen offset:2048  lds
    v_add_u32 v245, 1024, v244
    v_add_u32 v246, 2048, v244
    s_bfe_u32 s62, s72, 0x10002
    s_mul_i32 s78, s62, 12288
    s_mul_i32 s80, s3, 3072
    s_add_u32 s60, s80, s78
    buffer_load_dwordx4 v243, s[28:31], s97 offen offset:3072  lds
    s_sub_u32 s61, s80, s78
    s_mul_i32 s62, s62, 196608
    s_sub_u32 s63, 196608, s62
    s_mov_b32 s34, 0x600000
    s_mov_b32 s35, 0x20000
    s_mul_i32 s16, s97, 3072
    s_add_u32 m0, s60, 0
    s_add_u32 s99, s16, s62
    buffer_load_dwordx4 v244, s[32:35], s99 offen offset:0  lds
    s_lshl_b32 s78, s3, 1
    s_lshl_b32 s80, s3, 2
    s_add_u32 s79, s79, s80
    s_sub_u32 s79, s79, 16
    v_add_u32 v8, s78, v7
    buffer_load_dwordx4 v245, s[32:35], s99 offen offset:1024  lds
    v_xor_b32 v8, v8, v6
    v_and_b32 v8, 7, v8
    v_lshlrev_b32 v8, 4, v8
    v_add_u32 v3, s79, v5
    buffer_load_dwordx4 v246, s[32:35], s99 offen offset:2048  lds
    v_lshl_add_u32 v3, v3, 11, v8
    s_lshl_b32 s86, s3, 10
    s_lshl_b32 s88, s3, 9
    s_add_u32 s88, s88, 73728
    s_add_u32 m0, s88, 0
    s_mov_b64 exec, 0xffffffff
    buffer_load_dwordx4 v3, s[28:31], s97 offen offset:0  lds
    s_mov_b64 exec, -1
    s_add_u32 m0, s61, 12288
    s_add_u32 s16, s16, s63
    buffer_load_dwordx4 v244, s[32:35], s16 offen offset:0  lds
    buffer_load_dwordx4 v245, s[32:35], s16 offen offset:1024  lds
    buffer_load_dwordx4 v246, s[32:35], s16 offen offset:2048  lds
    s_mov_b32 s0, 0x76583240
    s_mov_b32 s1, 0xfedba9c
    s_cmp_eq_u32 s101, 1
    s_cselect_b32 s0, 0x76943251, s0
    s_cselect_b32 s1, 0xfecbda8, s1
    s_cmp_eq_u32 s101, 2
    s_cselect_b32 s0, 0x7a543602, s0
    s_cselect_b32 s1, 0xfdceb98, s1
    s_cmp_eq_u32 s101, 3
    s_cselect_b32 s0, 0xb6547213, s0
    s_cselect_b32 s1, 0xedfca98, s1
    s_and_b32 s78, s73, 7
    s_cmp_lg_u32 s78, 3
    s_cbranch_scc1 LA_nb
    s_cmp_eq_u32 s101, 2
    s_cselect_b32 s0, 0x87654302, s0
    s_cselect_b32 s1, 0xfdceba9, s1
    s_cmp_eq_u32 s101, 3
    s_cselect_b32 s0, 0x87654213, s0
    s_cselect_b32 s1, 0xedfcba9, s1
LA_nb:
    s_add_u32 s79, s72, s73
    s_add_u32 s78, s72, 5
    s_and_b32 s78, s78, 7
    s_lshl_b32 s78, s78, 1
    s_and_b32 s75, s79, 1
    s_add_u32 s78, s78, s75
    s_andn2_b32 s79, 2, s79
    s_lshl_b32 s79, s79, 3
    s_add_u32 s78, s78, s79
    s_and_b32 s76, s78, 3
    s_and_b32 s79, s73, 12
    s_add_u32 s76, s76, s79
    s_lshr_b32 s74, s78, 4
    s_add_u32 s74, s74, s79
    s_and_b32 s79, s72, 8
    s_lshr_b32 s77, s78, 2
    s_add_u32 s77, s77, s79
    s_lshr_b32 s79, s79, 2
    s_add_u32 s74, s74, s79
    s_xor_b32 s74, s74, 6
    s_and_b32 s75, s78, 15
    s_add_u32 s97, s98, s0
    s_lshr_b64 s[0:1], s[0:1], 4
    s_and_b32 s97, s97, 15
    s_add_u32 m0, s87, 18432
    s_lshl_b32 s97, s97, 7
    buffer_load_dwordx4 v240, s[28:31], s97 offen offset:0  lds
    s_mov_b32 s36, s6
    s_mov_b32 s37, s7
    s_mov_b32 s38, 0x400000
    s_mov_b32 s39, 0x20000
    s_mov_b32 s40, s8
    s_mov_b32 s41, s9
    s_mov_b32 s42, 0x400000
    s_mov_b32 s43, 0x20000
    s_mov_b32 s44, s10
    s_mov_b32 s45, s11
    s_mov_b32 s46, 0x2000
    s_mov_b32 s47, 0x20000
    v_lshlrev_b32 v15, 4, v0
    v_and_b32 v7, 7, v0
    s_lshl_b32 s79, s74, 7
    v_lshl_add_u32 v7, v7, 4, s79
    s_lshl_b32 s78, s75, 7
    s_lshl_b32 s80, s3, 3
    s_add_u32 s80, s80, s78
    v_lshrrev_b32 v5, 3, v0
    s_and_b32 s79, s3, 1
    v_xor_b32 v5, s79, v5
    v_add_u32 v5, s80, v5
    v_lshl_add_u32 v10, v5, 11, v7
    s_xor_b32 s80, s3, 1
    s_add_u32 s80, s78, s80
    s_sub_u32 s80, s80, 4
    s_lshl_b32 s80, s80, 11
    v_add_u32 v11, s80, v7
    s_mov_b32 s52, s26
    s_mov_b32 s53, s27
    s_mov_b32 s54, 0x1800000
    s_mov_b32 s55, 0x20000
    v_and_b32 v7, 7, v0
    s_lshl_b32 s79, s74, 7
    v_lshl_add_u32 v7, v7, 4, s79
    s_lshl_b32 s78, s75, 7
    v_bfe_u32 v5, v0, 3, 2
    v_lshrrev_b32 v6, 5, v0
    s_lshl_b32 s80, s3, 5
    v_lshlrev_b32 v8, 3, v5
    v_lshl_add_u32 v8, v6, 2, v8
    v_add_u32 v8, s80, v8
    v_and_b32 v35, 7, v0
    v_lshl_add_u32 v16, v35, 1, v6
    v_lshlrev_b32 v232, 5, v16
    v_lshlrev_b32 v16, 3, v16
    v_lshl_add_u32 v16, v5, 10, v16
    v_and_b32 v231, 1, v5
    v_lshl_add_u32 v16, v231, 7, v16
    s_lshl_b32 s79, s3, 12
    s_add_u32 s79, s79, 129024
    v_add_u32 v16, s79, v16
    v_xor_b32 v231, 128, v16
    v_lshrrev_b32 v35, 2, v35
    v_lshl_add_u32 v35, v35, 4, v232
    v_add_u32 v35, 162816, v35
    v_add_u32 v8, s78, v8
    v_lshl_add_u32 v9, v8, 11, v7
    v_lshl_add_u32 v13, v8, 12, v7
    v_bfe_u32 v8, v0, 2, 1
    v_lshlrev_b32 v8, 1, v8
    v_add_u32 v8, v8, v6
    v_lshlrev_b32 v8, 16, v8
    v_lshl_add_u32 v8, v5, 6, v8
    v_and_b32 v7, 3, v0
    v_lshl_add_u32 v8, v7, 4, v8
    s_add_u32 s78, s78, s80
    s_lshl_b32 s78, s78, 3
    s_lshl_b32 s79, s74, 18
    s_add_u32 s78, s78, s79
    v_add_u32 v12, s78, v8
    s_mov_b32 s48, s12
    s_mov_b32 s49, s13
    s_mov_b32 s50, 0x400000
    s_mov_b32 s51, 0x20000
    s_mov_b32 s56, s4
    s_mov_b32 s57, s5
    s_mov_b32 s58, 0x400000
    s_mov_b32 s59, 0x20000
    s_mov_b32 s64, s20
    s_mov_b32 s65, s21
    s_mov_b32 s66, 0x200000
    s_mov_b32 s67, 0x20000
    s_lshl_b32 s91, s74, 4
    s_add_u32 s91, s91, s75
    s_lshr_b32 s78, s91, 3
    s_lshl_b32 s78, s78, 5
    s_and_b32 s79, s91, 7
    s_add_u32 s78, s78, s79
    s_lshl_b32 s79, s3, 3
    s_add_u32 s90, s78, s79
    s_lshl_b32 s91, s91, 14
    s_mov_b32 s96, 4096
    s_mul_i32 s94, s3, 8320
    s_add_u32 s94, s94, 129024
    v_mov_b32 v229, 0
    s_mov_b64 s[4:5], s[64:65]
    s_mov_b32 s6, 0x0
    s_mov_b32 s7, 0x20000
    v_mov_b32 v228, 0x40000000
    s_bitcmp1_b32 s73, 2
    s_cbranch_scc1 LA_nh0
    s_mov_b64 s[4:5], s[28:29]
    s_mov_b32 s6, 0x400000
    v_mov_b32 v229, 0x40000000
    s_and_b32 s78, s73, 3
    s_cmp_eq_u32 s78, 3
    s_cbranch_scc1 LA_nh0
    s_and_b32 s79, s101, 2
    s_add_u32 s78, s72, 1
    s_add_u32 s78, s78, s79
    s_and_b32 s78, s78, 3
    s_bfe_u32 s80, s72, 0x10002
    s_and_b32 s81, s101, 1
    s_lshl_b32 s81, s81, 2
    s_add_u32 s81, s81, s79
    s_lshl_b32 s82, s78, 1
    s_cmp_lt_u32 s78, 2
    s_cselect_b32 s79, 12, 24
    s_cselect_b32 s82, s82, 0
    s_cselect_b32 s83, 6, 7
    s_add_u32 s81, s81, s83
    s_add_u32 s80, s80, s82
    s_lshl_b32 s80, s80, 2
    s_add_u32 s80, s80, s3
    s_mul_i32 s80, s80, s79
    s_add_u32 s82, s81, s78
    s_add_u32 s81, s81, s98
    s_and_b32 s81, s81, 15
    s_mul_i32 s81, s81, 192
    s_add_u32 s80, s80, s81
    s_or_b32 s81, s73, 3
    s_lshl_b32 s81, s81, 7
    v_add_u32 v5, s80, v0
    v_lshl_add_u32 v5, v5, 11, s81
    v_cmp_gt_u32 vcc, s79, v0
    s_nop 1
    v_cndmask_b32 v228, v228, v5, vcc
    s_cmp_ge_u32 s78, 2
    s_cbranch_scc1 LA_nh0
    s_add_u32 s82, s82, s98
    s_and_b32 s82, s82, 15
    s_lshl_b32 s78, s82, 7
    s_lshl_b32 s79, s72, 7
    s_mul_i32 s80, s3, 36
    s_add_u32 s79, s79, s80
    s_sub_u32 s79, s79, 16
    v_add_u32 v5, s79, v0
    v_lshl_add_u32 v5, v5, 11, s78
    v_cmp_gt_u32 vcc, 36, v0
    s_nop 1
    v_cndmask_b32 v229, v229, v5, vcc
LA_nh0:
    buffer_load_dwordx4 v241, s[28:31], s97 offen offset:1024  lds
    buffer_load_dwordx4 v242, s[28:31], s97 offen offset:2048  lds
    buffer_load_dwordx4 v243, s[28:31], s97 offen offset:3072  lds
    s_add_u32 m0, s88, 18432
    s_mov_b64 exec, 0xffffffff
    buffer_load_dwordx4 v3, s[28:31], s97 offen offset:0  lds
    s_mov_b64 exec, -1
    s_mul_i32 s16, s97, 3072
    s_add_u32 m0, s60, 24576
    s_add_u32 s99, s16, s62
    buffer_load_dwordx4 v244, s[32:35], s99 offen offset:0  lds
    buffer_load_dwordx4 v245, s[32:35], s99 offen offset:1024  lds
    buffer_load_dwordx4 v246, s[32:35], s99 offen offset:2048  lds
    s_add_u32 m0, s61, 36864
    s_add_u32 s16, s16, s63
    buffer_load_dwordx4 v244, s[32:35], s16 offen offset:0  lds
    buffer_load_dwordx4 v245, s[32:35], s16 offen offset:1024  lds
    buffer_load_dwordx4 v246, s[32:35], s16 offen offset:2048  lds
    s_waitcnt vmcnt(11)
    s_barrier
    s_add_u32 s97, s98, s0
    s_lshr_b64 s[0:1], s[0:1], 4
    s_and_b32 s97, s97, 15
    s_add_u32 m0, s87, 36864
    s_lshl_b32 s97, s97, 7
    buffer_load_dwordx4 v240, s[28:31], s97 offen offset:0  lds
    buffer_load_dwordx4 v241, s[28:31], s97 offen offset:1024  lds
    s_cmp_eq_u32 s101, 1
    s_cbranch_scc1 LA_c1
    s_cmp_eq_u32 s101, 2
    s_cbranch_scc1 LA_c2
    s_cmp_eq_u32 s101, 3
    s_cbranch_scc1 LA_c3
LA_c0:
    s_waitcnt vmcnt(8)
    s_barrier
    buffer_load_dwordx4 v242, s[28:31], s97 offen offset:2048  lds
    buffer_load_dwordx4 v243, s[28:31], s97 offen offset:3072  lds
    s_add_u32 m0, s88, 36864
    s_mov_b64 exec, 0xffffffff
    buffer_load_dwordx4 v3, s[28:31], s97 offen offset:0  lds
    s_mov_b64 exec, -1
    s_mul_i32 s16, s97, 3072
    s_add_u32 m0, s60, 49152
    s_add_u32 s99, s16, s62
    buffer_load_dwordx4 v244, s[32:35], s99 offen offset:0  lds
    buffer_load_dwordx4 v245, s[32:35], s99 offen offset:1024  lds
    buffer_load_dwordx4 v246, s[32:35], s99 offen offset:2048  lds
    s_add_u32 m0, s61, 61440
    s_add_u32 s16, s16, s63
    buffer_load_dwordx4 v244, s[32:35], s16 offen offset:0  lds
    buffer_load_dwordx4 v245, s[32:35], s16 offen offset:1024  lds
    buffer_load_dwordx4 v246, s[32:35], s16 offen offset:2048  lds
    s_add_u32 s97, s98, s0
    s_lshr_b64 s[0:1], s[0:1], 4
    s_and_b32 s97, s97, 15
    s_add_u32 m0, s87, 0
    s_lshl_b32 s97, s97, 7
    buffer_load_dwordx4 v240, s[28:31], s97 offen offset:0  lds
    buffer_load_dwordx4 v241, s[28:31], s97 offen offset:1024  lds
    buffer_load_dwordx4 v242, s[28:31], s97 offen offset:2048  lds
    buffer_load_dwordx4 v243, s[28:31], s97 offen offset:3072  lds
    s_add_u32 m0, s88, 0
    s_mov_b64 exec, 0xffffffff
    buffer_load_dwordx4 v3, s[28:31], s97 offen offset:0  lds
    s_mov_b64 exec, -1
    s_waitcnt vmcnt(11)
    s_barrier
    s_mul_i32 s16, s97, 3072
    s_add_u32 m0, s60, 0
    s_add_u32 s99, s16, s62
    buffer_load_dwordx4 v244, s[32:35], s99 offen offset:0  lds
    buffer_load_dwordx4 v245, s[32:35], s99 offen offset:1024  lds
    buffer_load_dwordx4 v246, s[32:35], s99 offen offset:2048  lds
    s_add_u32 m0, s61, 12288
    s_add_u32 s16, s16, s63
    buffer_load_dwordx4 v244, s[32:35], s16 offen offset:0  lds
    buffer_load_dwordx4 v245, s[32:35], s16 offen offset:1024  lds
    buffer_load_dwordx4 v246, s[32:35], s16 offen offset:2048  lds
    s_add_u32 m0, s86, 129536
    s_mov_b32 s89, 0
    buffer_load_dwordx4 v10, s[36:39], s89 offen nt lds
    s_add_u32 m0, s86, 145920
    s_mov_b32 s89, 0
    buffer_load_dwordx4 v10, s[40:43], s89 offen nt lds
    s_add_u32 m0, s86, 133632
    s_mov_b32 s89, 65536
    buffer_load_dwordx4 v10, s[36:39], s89 offen nt lds
    s_add_u32 m0, s86, 150016
    s_mov_b32 s89, 65536
    buffer_load_dwordx4 v10, s[40:43], s89 offen nt lds
    s_add_u32 m0, s86, 137728
    s_mov_b32 s89, 131072
    buffer_load_dwordx4 v10, s[36:39], s89 offen nt lds
    s_add_u32 m0, s86, 154112
    s_mov_b32 s89, 131072
    buffer_load_dwordx4 v10, s[40:43], s89 offen nt lds
    s_add_u32 m0, s86, 141824
    s_mov_b32 s89, 196608
    buffer_load_dwordx4 v10, s[36:39], s89 offen nt lds
    s_add_u32 m0, s86, 158208
    s_mov_b32 s89, 196608
    buffer_load_dwordx4 v10, s[40:43], s89 offen nt lds
    s_mov_b64 exec, 0xff
    s_lshl_b32 s82, s3, 7
    s_add_u32 m0, s82, 129024
    s_mov_b32 s89, 0
    buffer_load_dwordx4 v11, s[36:39], s89 offen nt lds
    s_lshl_b32 s83, s74, 9
    s_add_u32 s83, s83, s82
    s_and_b32 s89, s3, 2
    s_lshl_b32 s89, s89, 3
    s_add_u32 s82, s82, s89
    s_add_u32 m0, s82, 162816
    s_add_u32 s89, s83, 0
    buffer_load_dwordx4 v15, s[44:47], s89 offen  lds
    s_mov_b64 exec, -1
    s_add_u32 s97, s98, s0
    s_lshr_b64 s[0:1], s[0:1], 4
    s_and_b32 s97, s97, 15
    s_add_u32 m0, s87, 18432
    s_lshl_b32 s97, s97, 7
    buffer_load_dwordx4 v240, s[28:31], s97 offen offset:0  lds
    buffer_load_dwordx4 v241, s[28:31], s97 offen offset:1024  lds
    buffer_load_dwordx4 v242, s[28:31], s97 offen offset:2048  lds
    buffer_load_dwordx4 v243, s[28:31], s97 offen offset:3072  lds
    s_add_u32 m0, s88, 18432
    s_mov_b64 exec, 0xffffffff
    buffer_load_dwordx4 v3, s[28:31], s97 offen offset:0  lds
    s_mov_b64 exec, -1
    s_waitcnt vmcnt(21)
    s_barrier
    s_mul_i32 s16, s97, 3072
    s_add_u32 m0, s60, 24576
    s_add_u32 s99, s16, s62
    buffer_load_dwordx4 v244, s[32:35], s99 offen offset:0  lds
    buffer_load_dwordx4 v245, s[32:35], s99 offen offset:1024  lds
    buffer_load_dwordx4 v246, s[32:35], s99 offen offset:2048  lds
    s_add_u32 m0, s61, 36864
    s_add_u32 s16, s16, s63
    buffer_load_dwordx4 v244, s[32:35], s16 offen offset:0  lds
    buffer_load_dwordx4 v245, s[32:35], s16 offen offset:1024  lds
    buffer_load_dwordx4 v246, s[32:35], s16 offen offset:2048  lds
    buffer_load_dword v230, v229, s[4:7], 0 offen
    buffer_load_dword v230, v228, s[32:35], 0 offen
    s_add_u32 s97, s98, s0
    s_lshr_b64 s[0:1], s[0:1], 4
    s_and_b32 s97, s97, 15
    s_add_u32 m0, s87, 36864
    s_lshl_b32 s97, s97, 7
    buffer_load_dwordx4 v240, s[28:31], s97 offen offset:0  lds
    buffer_load_dwordx4 v241, s[28:31], s97 offen offset:1024  lds
    buffer_load_dwordx4 v242, s[28:31], s97 offen offset:2048  lds
    buffer_load_dwordx4 v243, s[28:31], s97 offen offset:3072  lds
    s_add_u32 m0, s88, 36864
    s_mov_b64 exec, 0xffffffff
    buffer_load_dwordx4 v3, s[28:31], s97 offen offset:0  lds
    s_mov_b64 exec, -1
    s_waitcnt vmcnt(13)
    s_barrier
    s_mul_i32 s16, s97, 3072
    s_add_u32 m0, s60, 49152
    s_add_u32 s99, s16, s62
    buffer_load_dwordx4 v244, s[32:35], s99 offen offset:0  lds
    ds_read_b128 v[84:87], v35 offset:0
    ds_read_b128 v[88:91], v35 offset:16
    buffer_load_dwordx4 v245, s[32:35], s99 offen offset:1024  lds
    ds_read_b64 v[40:41], v16 offset:0
    ds_read_b64 v[42:43], v231 offset:256
    buffer_load_dwordx4 v246, s[32:35], s99 offen offset:2048  lds
    ds_read_b64 v[44:45], v16 offset:256
    ds_read_b64 v[46:47], v16 offset:512
    s_add_u32 m0, s61, 61440
    s_add_u32 s16, s16, s63
    buffer_load_dwordx4 v244, s[32:35], s16 offen offset:0  lds
    ds_read_b64 v[48:49], v231 offset:512
    ds_read_b64 v[50:51], v16 offset:768
    buffer_load_dwordx4 v245, s[32:35], s16 offen offset:1024  lds
    ds_read_b64 v[52:53], v231 offset:768
    ds_read_b64 v[54:55], v16 offset:1024
    buffer_load_dwordx4 v246, s[32:35], s16 offen offset:2048  lds
    ds_read_b64 v[56:57], v231 offset:1024
    ds_read_b64 v[58:59], v16 offset:1280
    s_add_u32 s97, s98, s0
    s_lshr_b64 s[0:1], s[0:1], 4
    s_and_b32 s97, s97, 15
    s_add_u32 m0, s87, 0
    s_lshl_b32 s97, s97, 7
    buffer_load_dwordx4 v240, s[28:31], s97 offen offset:0  lds
    ds_read_b64 v[60:61], v231 offset:1280
    ds_read_b64 v[68:69], v16 offset:16896
    buffer_load_dwordx4 v241, s[28:31], s97 offen offset:1024  lds
    ds_read_b64 v[70:71], v231 offset:16896
    ds_read_b64 v[72:73], v16 offset:17152
    buffer_load_dwordx4 v242, s[28:31], s97 offen offset:2048  lds
    ds_read_b64 v[74:75], v231 offset:17152
    ds_read_b64 v[76:77], v16 offset:17408
    buffer_load_dwordx4 v243, s[28:31], s97 offen offset:3072  lds
    ds_read_b64 v[78:79], v231 offset:17408
    ds_read_b64 v[80:81], v16 offset:17664
    s_add_u32 m0, s88, 0
    s_mov_b64 exec, 0xffffffff
    buffer_load_dwordx4 v3, s[28:31], s97 offen offset:0  lds
    s_mov_b64 exec, -1
    ds_read_b64 v[82:83], v231 offset:17664
    s_waitcnt vmcnt(11)
    s_waitcnt lgkmcnt(0)
    s_barrier
    s_mul_i32 s16, s97, 3072
    s_add_u32 m0, s60, 0
    s_add_u32 s99, s16, s62
    buffer_load_dwordx4 v244, s[32:35], s99 offen offset:0  lds
    v_lshlrev_b32 v160, 16, v40
    v_lshlrev_b32 v161, 16, v42
    v_lshlrev_b32 v162, 16, v44
    v_lshlrev_b32 v163, 16, v46
    v_lshlrev_b32 v164, 16, v48
    buffer_load_dwordx4 v245, s[32:35], s99 offen offset:1024  lds
    v_lshlrev_b32 v165, 16, v50
    v_lshlrev_b32 v166, 16, v52
    v_lshlrev_b32 v167, 16, v54
    v_lshlrev_b32 v168, 16, v56
    v_lshlrev_b32 v169, 16, v58
    buffer_load_dwordx4 v246, s[32:35], s99 offen offset:2048  lds
    v_lshlrev_b32 v170, 16, v60
    v_lshlrev_b32 v172, 16, v84
    v_and_b32 v173, 0xffff0000, v84
    v_lshlrev_b32 v174, 16, v85
    v_and_b32 v175, 0xffff0000, v85
    s_add_u32 m0, s61, 12288
    s_add_u32 s16, s16, s63
    buffer_load_dwordx4 v244, s[32:35], s16 offen offset:0  lds
    v_lshlrev_b32 v176, 16, v68
    v_lshlrev_b32 v177, 16, v70
    v_lshlrev_b32 v178, 16, v72
    v_lshlrev_b32 v179, 16, v74
    v_lshlrev_b32 v180, 16, v76
    buffer_load_dwordx4 v245, s[32:35], s16 offen offset:1024  lds
    v_lshlrev_b32 v181, 16, v78
    v_lshlrev_b32 v182, 16, v80
    v_lshlrev_b32 v183, 16, v82
    v_mul_f32 v184, v160, v175
    v_mul_f32 v185, v161, v175
    buffer_load_dwordx4 v246, s[32:35], s16 offen offset:2048  lds
    v_mul_f32 v186, v162, v175
    v_mul_f32 v187, v163, v175
    v_mul_f32 v188, v164, v175
    v_mul_f32 v189, v165, v175
    v_mul_f32 v190, v166, v175
    s_add_u32 s97, s98, s0
    s_lshr_b64 s[0:1], s[0:1], 4
    s_and_b32 s97, s97, 15
    s_add_u32 m0, s87, 18432
    s_lshl_b32 s97, s97, 7
    buffer_load_dwordx4 v240, s[28:31], s97 offen offset:0  lds
    v_mul_f32 v191, v167, v175
    v_fmac_f32 v184, v161, v174
    v_fmac_f32 v185, v162, v174
    v_fmac_f32 v186, v163, v174
    v_fmac_f32 v187, v164, v174
    buffer_load_dwordx4 v241, s[28:31], s97 offen offset:1024  lds
    v_fmac_f32 v188, v165, v174
    v_fmac_f32 v189, v166, v174
    v_fmac_f32 v190, v167, v174
    v_fmac_f32 v191, v168, v174
    v_fmac_f32 v184, v162, v173
    buffer_load_dwordx4 v242, s[28:31], s97 offen offset:2048  lds
    v_fmac_f32 v185, v163, v173
    v_fmac_f32 v186, v164, v173
    v_fmac_f32 v187, v165, v173
    v_fmac_f32 v188, v166, v173
    v_fmac_f32 v189, v167, v173
    buffer_load_dwordx4 v243, s[28:31], s97 offen offset:3072  lds
    v_fmac_f32 v190, v168, v173
    v_fmac_f32 v191, v169, v173
    v_fmac_f32 v184, v163, v172
    v_fmac_f32 v185, v164, v172
    v_fmac_f32 v186, v165, v172
    s_add_u32 m0, s88, 18432
    s_mov_b64 exec, 0xffffffff
    buffer_load_dwordx4 v3, s[28:31], s97 offen offset:0  lds
    s_mov_b64 exec, -1
    v_fmac_f32 v187, v166, v172
    v_fmac_f32 v188, v167, v172
    v_fmac_f32 v189, v168, v172
    v_fmac_f32 v190, v169, v172
    v_fmac_f32 v191, v170, v172
    v_mul_f32 v184, v184, v176
    v_mul_f32 v185, v185, v177
    v_mul_f32 v186, v186, v178
    v_mul_f32 v187, v187, v179
    v_mul_f32 v188, v188, v180
    v_mul_f32 v189, v189, v181
    v_mul_f32 v190, v190, v182
    v_mul_f32 v191, v191, v183
    v_cvt_pk_bf16_f32 v100, v191, v190
    v_cvt_pk_bf16_f32 v101, v189, v188
    v_cvt_pk_bf16_f32 v102, v187, v186
    v_cvt_pk_bf16_f32 v103, v185, v184
    s_mov_b32 s89, 0
    buffer_store_dwordx4 v[100:103], v12, s[52:55], s89 offen sc1
    v_and_b32 v160, 0xffff0000, v40
    v_and_b32 v161, 0xffff0000, v42
    v_and_b32 v162, 0xffff0000, v44
    v_and_b32 v163, 0xffff0000, v46
    v_and_b32 v164, 0xffff0000, v48
    v_and_b32 v165, 0xffff0000, v50
    v_and_b32 v166, 0xffff0000, v52
    v_and_b32 v167, 0xffff0000, v54
    v_and_b32 v168, 0xffff0000, v56
    v_and_b32 v169, 0xffff0000, v58
    v_and_b32 v170, 0xffff0000, v60
    v_lshlrev_b32 v172, 16, v86
    v_and_b32 v173, 0xffff0000, v86
    v_lshlrev_b32 v174, 16, v87
    v_and_b32 v175, 0xffff0000, v87
    v_and_b32 v176, 0xffff0000, v68
    v_and_b32 v177, 0xffff0000, v70
    v_and_b32 v178, 0xffff0000, v72
    v_and_b32 v179, 0xffff0000, v74
    v_and_b32 v180, 0xffff0000, v76
    v_and_b32 v181, 0xffff0000, v78
    v_and_b32 v182, 0xffff0000, v80
    v_and_b32 v183, 0xffff0000, v82
    s_waitcnt vmcnt(12)
    s_barrier
    s_mul_i32 s16, s97, 3072
    s_add_u32 m0, s60, 24576
    s_add_u32 s99, s16, s62
    buffer_load_dwordx4 v244, s[32:35], s99 offen offset:0  lds
    v_mul_f32 v184, v160, v175
    v_mul_f32 v185, v161, v175
    v_mul_f32 v186, v162, v175
    v_mul_f32 v187, v163, v175
    v_mul_f32 v188, v164, v175
    buffer_load_dwordx4 v245, s[32:35], s99 offen offset:1024  lds
    v_mul_f32 v189, v165, v175
    v_mul_f32 v190, v166, v175
    v_mul_f32 v191, v167, v175
    v_fmac_f32 v184, v161, v174
    v_fmac_f32 v185, v162, v174
    buffer_load_dwordx4 v246, s[32:35], s99 offen offset:2048  lds
    v_fmac_f32 v186, v163, v174
    v_fmac_f32 v187, v164, v174
    v_fmac_f32 v188, v165, v174
    v_fmac_f32 v189, v166, v174
    v_fmac_f32 v190, v167, v174
    s_add_u32 m0, s61, 36864
    s_add_u32 s16, s16, s63
    buffer_load_dwordx4 v244, s[32:35], s16 offen offset:0  lds
    v_fmac_f32 v191, v168, v174
    v_fmac_f32 v184, v162, v173
    v_fmac_f32 v185, v163, v173
    v_fmac_f32 v186, v164, v173
    v_fmac_f32 v187, v165, v173
    buffer_load_dwordx4 v245, s[32:35], s16 offen offset:1024  lds
    v_fmac_f32 v188, v166, v173
    v_fmac_f32 v189, v167, v173
    v_fmac_f32 v190, v168, v173
    v_fmac_f32 v191, v169, v173
    v_fmac_f32 v184, v163, v172
    buffer_load_dwordx4 v246, s[32:35], s16 offen offset:2048  lds
    v_fmac_f32 v185, v164, v172
    v_fmac_f32 v186, v165, v172
    v_fmac_f32 v187, v166, v172
    v_fmac_f32 v188, v167, v172
    v_fmac_f32 v189, v168, v172
    s_add_u32 s97, s98, s0
    s_lshr_b64 s[0:1], s[0:1], 4
    s_and_b32 s97, s97, 15
    s_add_u32 m0, s87, 36864
    s_lshl_b32 s97, s97, 7
    buffer_load_dwordx4 v240, s[28:31], s97 offen offset:0  lds
    v_fmac_f32 v190, v169, v172
    v_fmac_f32 v191, v170, v172
    v_mul_f32 v184, v184, v176
    v_mul_f32 v185, v185, v177
    v_mul_f32 v186, v186, v178
    buffer_load_dwordx4 v241, s[28:31], s97 offen offset:1024  lds
    v_mul_f32 v187, v187, v179
    v_mul_f32 v188, v188, v180
    v_mul_f32 v189, v189, v181
    v_mul_f32 v190, v190, v182
    v_mul_f32 v191, v191, v183
    buffer_load_dwordx4 v242, s[28:31], s97 offen offset:2048  lds
    v_cvt_pk_bf16_f32 v104, v191, v190
    v_cvt_pk_bf16_f32 v105, v189, v188
    v_cvt_pk_bf16_f32 v106, v187, v186
    v_cvt_pk_bf16_f32 v107, v185, v184
    s_mov_b32 s89, 16384
    buffer_store_dwordx4 v[104:107], v12, s[52:55], s89 offen sc1
    buffer_load_dwordx4 v243, s[28:31], s97 offen offset:3072  lds
    v_lshlrev_b32 v160, 16, v41
    v_lshlrev_b32 v161, 16, v43
    v_lshlrev_b32 v162, 16, v45
    v_lshlrev_b32 v163, 16, v47
    v_lshlrev_b32 v164, 16, v49
    s_add_u32 m0, s88, 36864
    s_mov_b64 exec, 0xffffffff
    buffer_load_dwordx4 v3, s[28:31], s97 offen offset:0  lds
    s_mov_b64 exec, -1
    v_lshlrev_b32 v165, 16, v51
    v_lshlrev_b32 v166, 16, v53
    v_lshlrev_b32 v167, 16, v55
    v_lshlrev_b32 v168, 16, v57
    v_lshlrev_b32 v169, 16, v59
    v_lshlrev_b32 v170, 16, v61
    v_lshlrev_b32 v172, 16, v88
    v_and_b32 v173, 0xffff0000, v88
    v_lshlrev_b32 v174, 16, v89
    v_and_b32 v175, 0xffff0000, v89
    v_lshlrev_b32 v176, 16, v69
    v_lshlrev_b32 v177, 16, v71
    v_lshlrev_b32 v178, 16, v73
    v_lshlrev_b32 v179, 16, v75
    v_lshlrev_b32 v180, 16, v77
    v_lshlrev_b32 v181, 16, v79
    v_lshlrev_b32 v182, 16, v81
    v_lshlrev_b32 v183, 16, v83
    v_mul_f32 v184, v160, v175
    v_mul_f32 v185, v161, v175
    v_mul_f32 v186, v162, v175
    v_mul_f32 v187, v163, v175
    v_mul_f32 v188, v164, v175
    v_mul_f32 v189, v165, v175
    v_mul_f32 v190, v166, v175
    v_mul_f32 v191, v167, v175
    v_fmac_f32 v184, v161, v174
    v_fmac_f32 v185, v162, v174
    v_fmac_f32 v186, v163, v174
    v_fmac_f32 v187, v164, v174
    v_fmac_f32 v188, v165, v174
    v_fmac_f32 v189, v166, v174
    v_fmac_f32 v190, v167, v174
    v_fmac_f32 v191, v168, v174
    v_fmac_f32 v184, v162, v173
    v_fmac_f32 v185, v163, v173
    v_fmac_f32 v186, v164, v173
    v_fmac_f32 v187, v165, v173
    v_fmac_f32 v188, v166, v173
    v_fmac_f32 v189, v167, v173
    v_fmac_f32 v190, v168, v173
    s_waitcnt vmcnt(13)
    s_barrier
    s_mul_i32 s16, s97, 3072
    s_add_u32 m0, s60, 49152
    s_add_u32 s99, s16, s62
    buffer_load_dwordx4 v244, s[32:35], s99 offen offset:0  lds
    v_fmac_f32 v191, v169, v173
    v_fmac_f32 v184, v163, v172
    v_fmac_f32 v185, v164, v172
    v_fmac_f32 v186, v165, v172
    v_fmac_f32 v187, v166, v172
    buffer_load_dwordx4 v245, s[32:35], s99 offen offset:1024  lds
    v_fmac_f32 v188, v167, v172
    v_fmac_f32 v189, v168, v172
    v_fmac_f32 v190, v169, v172
    v_fmac_f32 v191, v170, v172
    v_mul_f32 v184, v184, v176
    buffer_load_dwordx4 v246, s[32:35], s99 offen offset:2048  lds
    v_mul_f32 v185, v185, v177
    v_mul_f32 v186, v186, v178
    v_mul_f32 v187, v187, v179
    v_mul_f32 v188, v188, v180
    v_mul_f32 v189, v189, v181
    s_add_u32 m0, s61, 61440
    s_add_u32 s16, s16, s63
    buffer_load_dwordx4 v244, s[32:35], s16 offen offset:0  lds
    v_mul_f32 v190, v190, v182
    v_mul_f32 v191, v191, v183
    v_cvt_pk_bf16_f32 v108, v191, v190
    v_cvt_pk_bf16_f32 v109, v189, v188
    v_cvt_pk_bf16_f32 v110, v187, v186
    buffer_load_dwordx4 v245, s[32:35], s16 offen offset:1024  lds
    v_cvt_pk_bf16_f32 v111, v185, v184
    s_mov_b32 s89, 32768
    buffer_store_dwordx4 v[108:111], v12, s[52:55], s89 offen sc1
    v_and_b32 v160, 0xffff0000, v41
    v_and_b32 v161, 0xffff0000, v43
    v_and_b32 v162, 0xffff0000, v45
    buffer_load_dwordx4 v246, s[32:35], s16 offen offset:2048  lds
    v_and_b32 v163, 0xffff0000, v47
    v_and_b32 v164, 0xffff0000, v49
    v_and_b32 v165, 0xffff0000, v51
    v_and_b32 v166, 0xffff0000, v53
    v_and_b32 v167, 0xffff0000, v55
    s_add_u32 s97, s98, s0
    s_lshr_b64 s[0:1], s[0:1], 4
    s_and_b32 s97, s97, 15
    s_add_u32 m0, s87, 0
    s_lshl_b32 s97, s97, 7
    buffer_load_dwordx4 v240, s[28:31], s97 offen offset:0  lds
    v_and_b32 v168, 0xffff0000, v57
    v_and_b32 v169, 0xffff0000, v59
    v_and_b32 v170, 0xffff0000, v61
    v_lshlrev_b32 v172, 16, v90
    v_and_b32 v173, 0xffff0000, v90
    buffer_load_dwordx4 v241, s[28:31], s97 offen offset:1024  lds
    v_lshlrev_b32 v174, 16, v91
    v_and_b32 v175, 0xffff0000, v91
    v_and_b32 v176, 0xffff0000, v69
    v_and_b32 v177, 0xffff0000, v71
    v_and_b32 v178, 0xffff0000, v73
    buffer_load_dwordx4 v242, s[28:31], s97 offen offset:2048  lds
    v_and_b32 v179, 0xffff0000, v75
    v_and_b32 v180, 0xffff0000, v77
    v_and_b32 v181, 0xffff0000, v79
    v_and_b32 v182, 0xffff0000, v81
    v_and_b32 v183, 0xffff0000, v83
    buffer_load_dwordx4 v243, s[28:31], s97 offen offset:3072  lds
    v_mul_f32 v184, v160, v175
    v_mul_f32 v185, v161, v175
    v_mul_f32 v186, v162, v175
    v_mul_f32 v187, v163, v175
    v_mul_f32 v188, v164, v175
    s_add_u32 m0, s88, 0
    s_mov_b64 exec, 0xffffffff
    buffer_load_dwordx4 v3, s[28:31], s97 offen offset:0  lds
    s_mov_b64 exec, -1
    v_mul_f32 v189, v165, v175
    v_mul_f32 v190, v166, v175
    v_mul_f32 v191, v167, v175
    v_fmac_f32 v184, v161, v174
    v_fmac_f32 v185, v162, v174
    v_fmac_f32 v186, v163, v174
    v_fmac_f32 v187, v164, v174
    v_fmac_f32 v188, v165, v174
    v_fmac_f32 v189, v166, v174
    v_fmac_f32 v190, v167, v174
    v_fmac_f32 v191, v168, v174
    v_fmac_f32 v184, v162, v173
    v_fmac_f32 v185, v163, v173
    v_fmac_f32 v186, v164, v173
    v_fmac_f32 v187, v165, v173
    v_fmac_f32 v188, v166, v173
    v_fmac_f32 v189, v167, v173
    v_fmac_f32 v190, v168, v173
    v_fmac_f32 v191, v169, v173
    v_fmac_f32 v184, v163, v172
    v_fmac_f32 v185, v164, v172
    v_fmac_f32 v186, v165, v172
    v_fmac_f32 v187, v166, v172
    v_fmac_f32 v188, v167, v172
    v_fmac_f32 v189, v168, v172
    v_fmac_f32 v190, v169, v172
    v_fmac_f32 v191, v170, v172
    v_mul_f32 v184, v184, v176
    v_mul_f32 v185, v185, v177
    v_mul_f32 v186, v186, v178
    v_mul_f32 v187, v187, v179
    v_mul_f32 v188, v188, v180
    v_mul_f32 v189, v189, v181
    v_mul_f32 v190, v190, v182
    v_mul_f32 v191, v191, v183
    v_cvt_pk_bf16_f32 v112, v191, v190
    v_cvt_pk_bf16_f32 v113, v189, v188
    v_cvt_pk_bf16_f32 v114, v187, v186
    v_cvt_pk_bf16_f32 v115, v185, v184
    s_mov_b32 s89, 49152
    buffer_store_dwordx4 v[112:115], v12, s[52:55], s89 offen sc1
    s_waitcnt vmcnt(13)
    s_barrier
    s_mul_i32 s16, s97, 3072
    s_add_u32 m0, s60, 0
    s_add_u32 s99, s16, s62
    buffer_load_dwordx4 v244, s[32:35], s99 offen offset:0  lds
    buffer_load_dwordx4 v245, s[32:35], s99 offen offset:1024  lds
    buffer_load_dwordx4 v246, s[32:35], s99 offen offset:2048  lds
    s_add_u32 m0, s61, 12288
    s_add_u32 s16, s16, s63
    buffer_load_dwordx4 v244, s[32:35], s16 offen offset:0  lds
    buffer_load_dwordx4 v245, s[32:35], s16 offen offset:1024  lds
    buffer_load_dwordx4 v246, s[32:35], s16 offen offset:2048  lds
    s_add_u32 s97, s98, s0
    s_lshr_b64 s[0:1], s[0:1], 4
    s_and_b32 s97, s97, 15
    s_add_u32 m0, s87, 18432
    s_lshl_b32 s97, s97, 7
    buffer_load_dwordx4 v240, s[28:31], s97 offen offset:0  lds
    buffer_load_dwordx4 v241, s[28:31], s97 offen offset:1024  lds
    buffer_load_dwordx4 v242, s[28:31], s97 offen offset:2048  lds
    buffer_load_dwordx4 v243, s[28:31], s97 offen offset:3072  lds
    s_add_u32 m0, s88, 18432
    s_mov_b64 exec, 0xffffffff
    buffer_load_dwordx4 v3, s[28:31], s97 offen offset:0  lds
    s_mov_b64 exec, -1
    s_waitcnt vmcnt(12)
    s_barrier
    s_mul_i32 s16, s97, 3072
    s_add_u32 m0, s60, 24576
    s_add_u32 s99, s16, s62
    buffer_load_dwordx4 v244, s[32:35], s99 offen offset:0  lds
    s_mov_b32 s68, s24
    s_mov_b32 s69, s25
    s_mov_b32 s70, 0x100
    s_mov_b32 s71, 0x20000
    buffer_load_dwordx4 v245, s[32:35], s99 offen offset:1024  lds
    v_lshrrev_b32 v6, 5, v0
    v_and_b32 v7, 3, v0
    s_lshr_b32 s78, s90, 1
    s_lshl_b32 s78, s78, 2
    buffer_load_dwordx4 v246, s[32:35], s99 offen offset:2048  lds
    s_load_dword s92, s[14:15], s78
    v_bfe_u32 v5, v0, 2, 2
    v_lshlrev_b32 v5, 1, v5
    s_add_u32 m0, s61, 36864
    s_add_u32 s16, s16, s63
    buffer_load_dwordx4 v244, s[32:35], s16 offen offset:0  lds
    v_lshl_add_u32 v5, v6, 3, v5
    v_bfe_u32 v8, v0, 4, 1
    v_add_u32 v5, v5, v8
    s_and_b32 s78, s3, 1
    buffer_load_dwordx4 v245, s[32:35], s16 offen offset:1024  lds
    s_lshl_b32 s78, s78, 1
    v_add_u32 v8, s78, v6
    v_xor_b32 v8, v8, v7
    v_lshlrev_b32 v8, 4, v8
    buffer_load_dwordx4 v246, s[32:35], s16 offen offset:2048  lds
    v_lshl_add_u32 v5, v5, 6, v8
    v_add_u32 v14, s86, v5
    v_mov_b32 v18, 162304
    s_add_u32 s97, s98, s0
    s_lshr_b64 s[0:1], s[0:1], 4
    s_and_b32 s97, s97, 15
    s_add_u32 m0, s87, 36864
    s_lshl_b32 s97, s97, 7
    buffer_load_dwordx4 v240, s[28:31], s97 offen offset:0  lds
    v_mov_b32 v19, 1
    v_and_b32 v5, 3, v0
    s_lshl_b32 s78, s74, 4
    s_add_u32 s78, s78, s3
    buffer_load_dwordx4 v241, s[28:31], s97 offen offset:1024  lds
    v_lshl_add_u32 v6, v5, 2, s78
    s_lshr_b32 s78, s76, 3
    s_lshl_b32 s79, s3, 1
    s_add_u32 s78, s78, s79
    buffer_load_dwordx4 v242, s[28:31], s97 offen offset:2048  lds
    s_xor_b32 s78, s78, 3
    s_lshl_b32 s78, s78, 5
    s_add_u32 s79, s76, 5
    buffer_load_dwordx4 v243, s[28:31], s97 offen offset:3072  lds
    s_and_b32 s79, s79, 7
    s_lshl_b32 s79, s79, 1
    s_add_u32 s78, s78, s79
    v_mul_u32_u24 v7, 9, v5
    s_add_u32 m0, s88, 36864
    s_mov_b64 exec, 0xffffffff
    buffer_load_dwordx4 v3, s[28:31], s97 offen offset:0  lds
    s_mov_b64 exec, -1
    v_and_b32 v7, 17, v7
    v_add_u32 v7, s78, v7
    v_and_b32 v8, 4, v0
    s_waitcnt vmcnt(11)
    s_barrier
    s_mul_i32 s16, s97, 3072
    s_add_u32 m0, s60, 49152
    s_add_u32 s99, s16, s62
    buffer_load_dwordx4 v244, s[32:35], s99 offen offset:0  lds
    v_cmp_eq_u32 vcc, 0, v8
    s_nop 1
    v_cndmask_b32 v6, v7, v6, vcc
    v_and_b32 v33, 0xf0, v6
    buffer_load_dwordx4 v245, s[32:35], s99 offen offset:1024  lds
    v_lshlrev_b32 v34, 8, v6
    v_add_u32 v34, 12582912, v34
    v_and_b32 v5, 15, v0
    buffer_load_dwordx4 v246, s[32:35], s99 offen offset:2048  lds
    v_lshrrev_b32 v6, 4, v0
    v_add_u32 v7, 9, v5
    s_add_u32 m0, s61, 61440
    s_add_u32 s16, s16, s63
    buffer_load_dwordx4 v244, s[32:35], s16 offen offset:0  lds
    v_and_b32 v8, 1, v7
    v_mul_u32_u24 v8, 4160, v8
    v_lshrrev_b32 v7, 1, v7
    buffer_load_dwordx4 v245, s[32:35], s16 offen offset:1024  lds
    v_lshl_add_u32 v8, v7, 2, v8
    v_lshlrev_b32 v7, 4, v6
    v_sub_u32 v8, v8, v7
    buffer_load_dwordx4 v246, s[32:35], s16 offen offset:2048  lds
    s_add_u32 s78, s94, 32
    v_add_u32 v21, s78, v8
    s_add_u32 m0, s94, 32
    s_lshl_b32 s89, s90, 12
    buffer_load_dwordx4 v15, s[48:51], s89 offen offset:0 nt lds
    v_add_u32 v22, 1024, v21
    v_add_u32 v23, 2048, v21
    v_add_u32 v24, 3072, v21
    s_add_u32 m0, s94, 32
    s_lshl_b32 s89, s90, 12
    buffer_load_dwordx4 v15, s[48:51], s89 offen offset:1024 nt lds
    v_lshl_add_u32 v7, v5, 1, v6
    v_add_u32 v7, 30, v7
    v_and_b32 v8, 1, v7
    s_add_u32 m0, s94, 32
    s_lshl_b32 s89, s90, 12
    buffer_load_dwordx4 v15, s[48:51], s89 offen offset:2048 nt lds
    v_bfe_u32 v136, v7, 1, 2
    v_lshl_add_u32 v136, v8, 2, v136
    s_add_u32 m0, s94, 32
    s_lshl_b32 s89, s90, 12
    buffer_load_dwordx4 v15, s[48:51], s89 offen offset:3072 nt lds
    v_lshlrev_b32 v136, 6, v136
    v_lshrrev_b32 v7, 3, v7
    v_lshl_add_u32 v136, v7, 9, v136
    s_add_u32 s97, s98, s0
    s_lshr_b64 s[0:1], s[0:1], 4
    s_and_b32 s97, s97, 15
    s_add_u32 m0, s87, 0
    s_lshl_b32 s97, s97, 7
    buffer_load_dwordx4 v240, s[28:31], s97 offen offset:0  lds
    v_bitop3_b32 v8, v7, 3, s3 bitop3:0x6a
    v_lshl_add_u32 v25, v8, 4, v136
    v_add_u32 v25, 92160, v25
    buffer_load_dwordx4 v241, s[28:31], s97 offen offset:1024  lds
    v_subrev_u32 v7, 1, v7
    v_bitop3_b32 v8, v7, 3, s3 bitop3:0x6a
    buffer_load_dwordx4 v242, s[28:31], s97 offen offset:2048  lds
    v_lshl_add_u32 v27, v8, 4, v136
    v_add_u32 v27, 91648, v27
    v_subrev_u32 v7, 1, v7
    buffer_load_dwordx4 v243, s[28:31], s97 offen offset:3072  lds
    v_bitop3_b32 v8, v7, 3, s3 bitop3:0x6a
    v_lshl_add_u32 v29, v8, 4, v136
    v_add_u32 v29, 91136, v29
    s_add_u32 m0, s88, 0
    s_mov_b64 exec, 0xffffffff
    buffer_load_dwordx4 v3, s[28:31], s97 offen offset:0  lds
    s_mov_b64 exec, -1
    v_subrev_u32 v7, 1, v7
    v_bitop3_b32 v8, v7, 3, s3 bitop3:0x6a
    s_waitcnt vmcnt(15)
    s_barrier
    s_mul_i32 s16, s97, 3072
    s_add_u32 m0, s60, 0
    s_add_u32 s99, s16, s62
    buffer_load_dwordx4 v244, s[32:35], s99 offen offset:0  lds
    v_lshl_add_u32 v31, v8, 4, v136
    v_add_u32 v31, 90624, v31
    v_lshl_add_u32 v7, v5, 1, v6
    v_add_u32 v7, 26, v7
    buffer_load_dwordx4 v245, s[32:35], s99 offen offset:1024  lds
    v_and_b32 v8, 1, v7
    v_bfe_u32 v136, v7, 1, 2
    v_lshl_add_u32 v136, v8, 2, v136
    v_lshlrev_b32 v136, 6, v136
    buffer_load_dwordx4 v246, s[32:35], s99 offen offset:2048  lds
    v_lshrrev_b32 v7, 3, v7
    v_lshl_add_u32 v136, v7, 9, v136
    v_bitop3_b32 v8, v7, 3, s3 bitop3:0x6a
    s_add_u32 m0, s61, 12288
    s_add_u32 s16, s16, s63
    buffer_load_dwordx4 v244, s[32:35], s16 offen offset:0  lds
    v_lshl_add_u32 v26, v8, 4, v136
    v_add_u32 v26, 92160, v26
    v_subrev_u32 v7, 1, v7
    v_bitop3_b32 v8, v7, 3, s3 bitop3:0x6a
    buffer_load_dwordx4 v245, s[32:35], s16 offen offset:1024  lds
    v_lshl_add_u32 v28, v8, 4, v136
    v_add_u32 v28, 91648, v28
    v_subrev_u32 v7, 1, v7
    v_bitop3_b32 v8, v7, 3, s3 bitop3:0x6a
    buffer_load_dwordx4 v246, s[32:35], s16 offen offset:2048  lds
    v_lshl_add_u32 v30, v8, 4, v136
    v_add_u32 v30, 91136, v30
    v_subrev_u32 v7, 1, v7
    s_add_u32 s97, s98, s0
    s_lshr_b64 s[0:1], s[0:1], 4
    s_and_b32 s97, s97, 15
    s_add_u32 m0, s87, 18432
    s_lshl_b32 s97, s97, 7
    buffer_load_dwordx4 v240, s[28:31], s97 offen offset:0  lds
    v_bitop3_b32 v8, v7, 3, s3 bitop3:0x6a
    v_lshl_add_u32 v32, v8, 4, v136
    v_add_u32 v32, 90624, v32
    v_lshrrev_b32 v7, 1, v6
    buffer_load_dwordx4 v241, s[28:31], s97 offen offset:1024  lds
    v_lshl_add_u32 v7, v5, 1, v7
    v_add_u32 v7, 32, v7
    v_and_b32 v8, 1, v7
    v_bfe_u32 v136, v7, 1, 2
    buffer_load_dwordx4 v242, s[28:31], s97 offen offset:2048  lds
    v_lshl_add_u32 v136, v8, 2, v136
    v_lshlrev_b32 v136, 6, v136
    v_lshrrev_b32 v7, 3, v7
    buffer_load_dwordx4 v243, s[28:31], s97 offen offset:3072  lds
    v_lshl_add_u32 v136, v7, 9, v136
    v_bitop3_b32 v8, v7, 3, s3 bitop3:0x6a
    v_lshl_add_u32 v20, v8, 4, v136
    v_add_u32 v20, 92160, v20
    s_add_u32 m0, s88, 18432
    s_mov_b64 exec, 0xffffffff
    buffer_load_dwordx4 v3, s[28:31], s97 offen offset:0  lds
    s_mov_b64 exec, -1
    v_and_b32 v8, 1, v6
    v_xor_b32 v8, 1, v8
    v_lshl_add_u32 v20, v8, 3, v20
    s_waitcnt vmcnt(11)
    s_barrier
    s_mul_i32 s16, s97, 3072
    s_add_u32 m0, s60, 24576
    s_add_u32 s99, s16, s62
    buffer_load_dwordx4 v244, s[32:35], s99 offen offset:0  lds
    s_waitcnt lgkmcnt(0)
    s_and_b32 s78, s92, 0xffff0000
    s_lshl_b32 s92, s92, 16
    buffer_load_dwordx4 v245, s[32:35], s99 offen offset:1024  lds
    s_bitcmp1_b32 s90, 0
    s_cselect_b32 s92, s78, s92
    v_lshlrev_b32 v7, 3, v6
    v_sub_u32 v7, v7, v5
    buffer_load_dwordx4 v246, s[32:35], s99 offen offset:2048  lds
    v_subrev_u32 v7, 9, v7
    v_and_b32 v8, 1, v7
    v_xor_b32 v8, 1, v8
    s_add_u32 m0, s61, 36864
    s_add_u32 s16, s16, s63
    buffer_load_dwordx4 v244, s[32:35], s16 offen offset:0  lds
    v_lshlrev_b32 v8, 4, v8
    v_lshrrev_b32 v8, v8, s92
    v_ashrrev_i32 v7, 1, v7
    buffer_load_dwordx4 v245, s[32:35], s16 offen offset:1024  lds
    v_cmp_eq_u32 vcc, 0, v7
    s_nop 1
    v_cndmask_b32 v236, 0, v8, vcc
    v_cmp_eq_u32 vcc, 1, v7
    buffer_load_dwordx4 v246, s[32:35], s16 offen offset:2048  lds
    s_nop 0
    v_cndmask_b32 v237, 0, v8, vcc
    v_cmp_eq_u32 vcc, 2, v7
    s_nop 1
    v_cndmask_b32 v238, 0, v8, vcc
    s_add_u32 s97, s98, s0
    s_lshr_b64 s[0:1], s[0:1], 4
    s_and_b32 s97, s97, 15
    s_add_u32 m0, s87, 36864
    s_lshl_b32 s97, s97, 7
    buffer_load_dwordx4 v240, s[28:31], s97 offen offset:0  lds
    v_cmp_eq_u32 vcc, 3, v7
    s_nop 1
    v_cndmask_b32 v239, 0, v8, vcc
    s_and_b32 s78, s77, 7
    s_mov_b32 s95, 0x76543210
    s_and_b32 s78, s76, 3
    s_mul_i32 s78, s78, 0x22222222
    s_add_u32 s95, s95, s78
    s_bfe_u32 s17, s95, 0x30000
    s_lshl_b32 s17, s17, 18
    s_bfe_u32 s18, s95, 0x30004
    s_lshl_b32 s18, s18, 18
    s_bfe_u32 s100, s95, 0x3001c
    s_lshl_b32 s100, s100, 18
    s_bfe_u32 s95, s95, 0x30018
    s_lshl_b32 s95, s95, 18
    buffer_load_dwordx4 v241, s[28:31], s97 offen offset:1024  lds
    v_lshrrev_b32 v136, 4, v0
    v_lshlrev_b32 v136, 1, v136
    v_and_b32 v137, 7, v0
    buffer_load_dwordx4 v242, s[28:31], s97 offen offset:2048  lds
    v_xor_b32 v136, v136, v137
    v_lshlrev_b32 v136, 4, v136
    v_lshrrev_b32 v137, 3, v0
    buffer_load_dwordx4 v243, s[28:31], s97 offen offset:3072  lds
    v_lshl_add_u32 v136, v137, 11, v136
    s_lshl_b32 s78, s77, 7
    s_lshl_b32 s79, s3, 14
    s_add_u32 m0, s88, 36864
    s_mov_b64 exec, 0xffffffff
    buffer_load_dwordx4 v3, s[28:31], s97 offen offset:0  lds
    s_mov_b64 exec, -1
    s_add_u32 s78, s78, s79
    v_add_u32 v17, s78, v136
    s_waitcnt vmcnt(11)
    s_barrier
    s_mul_i32 s16, s97, 3072
    s_add_u32 m0, s60, 49152
    s_add_u32 s99, s16, s62
    buffer_load_dwordx4 v244, s[32:35], s99 offen offset:0  lds
    v_add_u32 v5, s94, v15
    ds_read_b128 v[140:143], v5 offset:32
    ds_read_b32 v156, v5 offset:48
    ds_read_b128 v[144:147], v5 offset:1056
    buffer_load_dwordx4 v245, s[32:35], s99 offen offset:1024  lds
    ds_read_b32 v157, v5 offset:1072
    ds_read_b128 v[148:151], v5 offset:2080
    ds_read_b32 v158, v5 offset:2096
    ds_read_b128 v[152:155], v5 offset:3104
    buffer_load_dwordx4 v246, s[32:35], s99 offen offset:2048  lds
    ds_read_b32 v159, v5 offset:3120
    v_lshrrev_b32 v6, 3, v0
    v_mul_u32_u24 v6, 4160, v6
    s_add_u32 m0, s61, 61440
    s_add_u32 s16, s16, s63
    buffer_load_dwordx4 v244, s[32:35], s16 offen offset:0  lds
    v_and_b32 v7, 7, v0
    v_lshl_add_u32 v6, v7, 2, v6
    v_add_u32 v6, s94, v6
    v_mov_b32 v7, 0
    buffer_load_dwordx4 v245, s[32:35], s16 offen offset:1024  lds
    s_waitcnt lgkmcnt(0)
    v_readfirstlane_b32 s93, v140
    s_nop 0
    s_lshl_b32 s93, s93, 16
    s_nop 1
    v_writelane_b32 v7, s93, 15
    buffer_load_dwordx4 v246, s[32:35], s16 offen offset:2048  lds
    v_alignbit_b32 v140, v141, v140, 16
    v_alignbit_b32 v141, v142, v141, 16
    v_alignbit_b32 v142, v143, v142, 16
    s_add_u32 s97, s98, s0
    s_lshr_b64 s[0:1], s[0:1], 4
    s_and_b32 s97, s97, 15
    s_add_u32 m0, s87, 0
    s_lshl_b32 s97, s97, 7
    buffer_load_dwordx4 v240, s[28:31], s97 offen offset:0  lds
    v_alignbit_b32 v143, v156, v143, 16
    v_alignbit_b32 v144, v145, v144, 16
    v_alignbit_b32 v145, v146, v145, 16
    v_alignbit_b32 v146, v147, v146, 16
    buffer_load_dwordx4 v241, s[28:31], s97 offen offset:1024  lds
    v_alignbit_b32 v147, v157, v147, 16
    v_alignbit_b32 v148, v149, v148, 16
    v_alignbit_b32 v149, v150, v149, 16
    v_alignbit_b32 v150, v151, v150, 16
    buffer_load_dwordx4 v242, s[28:31], s97 offen offset:2048  lds
    v_alignbit_b32 v151, v158, v151, 16
    v_alignbit_b32 v152, v153, v152, 16
    v_alignbit_b32 v153, v154, v153, 16
    buffer_load_dwordx4 v243, s[28:31], s97 offen offset:3072  lds
    v_alignbit_b32 v154, v155, v154, 16
    v_alignbit_b32 v155, v159, v155, 16
    v_lshlrev_b32 v8, 3, v0
    s_add_u32 s78, s88, 18432
    s_add_u32 m0, s88, 0
    s_mov_b64 exec, 0xffffffff
    buffer_load_dwordx4 v3, s[28:31], s97 offen offset:0  lds
    s_mov_b64 exec, -1
    v_add_u32 v8, s78, v8
    v_mov_b32 v156, 0
    v_mov_b32 v157, 0
    s_waitcnt vmcnt(11)
    s_barrier
    s_mul_i32 s16, s97, 3072
    s_add_u32 m0, s60, 0
    s_add_u32 s99, s16, s62
    buffer_load_dwordx4 v244, s[32:35], s99 offen offset:0  lds
    buffer_load_dwordx4 v245, s[32:35], s99 offen offset:1024  lds
    buffer_load_dwordx4 v246, s[32:35], s99 offen offset:2048  lds
    s_add_u32 m0, s61, 12288
    s_add_u32 s16, s16, s63
    buffer_load_dwordx4 v244, s[32:35], s16 offen offset:0  lds
    buffer_load_dwordx4 v245, s[32:35], s16 offen offset:1024  lds
    buffer_load_dwordx4 v246, s[32:35], s16 offen offset:2048  lds
    s_mov_b64 exec, 0xff
    buffer_load_dword v136, v33, s[68:71], 0 offen sc1
    buffer_load_dword v137, v34, s[52:55], 0 offen sc1
    s_mov_b64 exec, -1
    buffer_load_dwordx4 v[212:215], v9, s[56:59], 0 offen offset:0 nt
    buffer_load_dwordx4 v[216:219], v9, s[56:59], 0 offen offset:2048 nt
    buffer_load_dwordx4 v[220:223], v9, s[56:59], s96 offen offset:0 nt
    buffer_load_dwordx4 v[224:227], v9, s[56:59], s96 offen offset:2048 nt
    s_waitcnt vmcnt(12)
    s_waitcnt vmcnt(6)
    s_barrier
    s_waitcnt vmcnt(4)
    s_branch LA_j
LA_c1:
    s_waitcnt vmcnt(8)
    s_barrier
    buffer_load_dwordx4 v242, s[28:31], s97 offen offset:2048  lds
    buffer_load_dwordx4 v243, s[28:31], s97 offen offset:3072  lds
    s_add_u32 m0, s88, 36864
    s_mov_b64 exec, 0xffffffff
    buffer_load_dwordx4 v3, s[28:31], s97 offen offset:0  lds
    s_mov_b64 exec, -1
    s_mul_i32 s16, s97, 3072
    s_add_u32 m0, s60, 49152
    s_add_u32 s99, s16, s62
    buffer_load_dwordx4 v244, s[32:35], s99 offen offset:0  lds
    buffer_load_dwordx4 v245, s[32:35], s99 offen offset:1024  lds
    buffer_load_dwordx4 v246, s[32:35], s99 offen offset:2048  lds
    s_add_u32 m0, s61, 61440
    s_add_u32 s16, s16, s63
    buffer_load_dwordx4 v244, s[32:35], s16 offen offset:0  lds
    buffer_load_dwordx4 v245, s[32:35], s16 offen offset:1024  lds
    buffer_load_dwordx4 v246, s[32:35], s16 offen offset:2048  lds
    s_add_u32 s97, s98, s0
    s_lshr_b64 s[0:1], s[0:1], 4
    s_and_b32 s97, s97, 15
    s_add_u32 m0, s87, 0
    s_lshl_b32 s97, s97, 7
    buffer_load_dwordx4 v240, s[28:31], s97 offen offset:0  lds
    buffer_load_dwordx4 v241, s[28:31], s97 offen offset:1024  lds
    buffer_load_dwordx4 v242, s[28:31], s97 offen offset:2048  lds
    buffer_load_dwordx4 v243, s[28:31], s97 offen offset:3072  lds
    s_add_u32 m0, s88, 0
    s_mov_b64 exec, 0xffffffff
    buffer_load_dwordx4 v3, s[28:31], s97 offen offset:0  lds
    s_mov_b64 exec, -1
    s_waitcnt vmcnt(11)
    s_barrier
    s_mul_i32 s16, s97, 3072
    s_add_u32 m0, s60, 0
    s_add_u32 s99, s16, s62
    buffer_load_dwordx4 v244, s[32:35], s99 offen offset:0  lds
    buffer_load_dwordx4 v245, s[32:35], s99 offen offset:1024  lds
    buffer_load_dwordx4 v246, s[32:35], s99 offen offset:2048  lds
    s_add_u32 m0, s61, 12288
    s_add_u32 s16, s16, s63
    buffer_load_dwordx4 v244, s[32:35], s16 offen offset:0  lds
    buffer_load_dwordx4 v245, s[32:35], s16 offen offset:1024  lds
    buffer_load_dwordx4 v246, s[32:35], s16 offen offset:2048  lds
    s_add_u32 m0, s86, 129536
    s_mov_b32 s89, 0
    buffer_load_dwordx4 v10, s[36:39], s89 offen nt lds
    s_add_u32 m0, s86, 145920
    s_mov_b32 s89, 0
    buffer_load_dwordx4 v10, s[40:43], s89 offen nt lds
    s_add_u32 m0, s86, 133632
    s_mov_b32 s89, 65536
    buffer_load_dwordx4 v10, s[36:39], s89 offen nt lds
    s_add_u32 m0, s86, 150016
    s_mov_b32 s89, 65536
    buffer_load_dwordx4 v10, s[40:43], s89 offen nt lds
    s_add_u32 m0, s86, 137728
    s_mov_b32 s89, 131072
    buffer_load_dwordx4 v10, s[36:39], s89 offen nt lds
    s_add_u32 m0, s86, 154112
    s_mov_b32 s89, 131072
    buffer_load_dwordx4 v10, s[40:43], s89 offen nt lds
    s_add_u32 m0, s86, 141824
    s_mov_b32 s89, 196608
    buffer_load_dwordx4 v10, s[36:39], s89 offen nt lds
    s_add_u32 m0, s86, 158208
    s_mov_b32 s89, 196608
    buffer_load_dwordx4 v10, s[40:43], s89 offen nt lds
    s_mov_b64 exec, 0xff
    s_lshl_b32 s82, s3, 7
    s_add_u32 m0, s82, 129024
    s_mov_b32 s89, 0
    buffer_load_dwordx4 v11, s[36:39], s89 offen nt lds
    s_lshl_b32 s83, s74, 9
    s_add_u32 s83, s83, s82
    s_and_b32 s89, s3, 2
    s_lshl_b32 s89, s89, 3
    s_add_u32 s82, s82, s89
    s_add_u32 m0, s82, 162816
    s_add_u32 s89, s83, 0
    buffer_load_dwordx4 v15, s[44:47], s89 offen  lds
    s_mov_b64 exec, -1
    s_add_u32 s97, s98, s0
    s_lshr_b64 s[0:1], s[0:1], 4
    s_and_b32 s97, s97, 15
    s_add_u32 m0, s87, 18432
    s_lshl_b32 s97, s97, 7
    buffer_load_dwordx4 v240, s[28:31], s97 offen offset:0  lds
    buffer_load_dwordx4 v241, s[28:31], s97 offen offset:1024  lds
    buffer_load_dwordx4 v242, s[28:31], s97 offen offset:2048  lds
    buffer_load_dwordx4 v243, s[28:31], s97 offen offset:3072  lds
    s_add_u32 m0, s88, 18432
    s_mov_b64 exec, 0xffffffff
    buffer_load_dwordx4 v3, s[28:31], s97 offen offset:0  lds
    s_mov_b64 exec, -1
    s_waitcnt vmcnt(21)
    s_barrier
    s_mul_i32 s16, s97, 3072
    s_add_u32 m0, s60, 24576
    s_add_u32 s99, s16, s62
    buffer_load_dwordx4 v244, s[32:35], s99 offen offset:0  lds
    buffer_load_dwordx4 v245, s[32:35], s99 offen offset:1024  lds
    buffer_load_dwordx4 v246, s[32:35], s99 offen offset:2048  lds
    s_add_u32 m0, s61, 36864
    s_add_u32 s16, s16, s63
    buffer_load_dwordx4 v244, s[32:35], s16 offen offset:0  lds
    buffer_load_dwordx4 v245, s[32:35], s16 offen offset:1024  lds
    buffer_load_dwordx4 v246, s[32:35], s16 offen offset:2048  lds
    s_add_u32 s97, s98, s0
    s_lshr_b64 s[0:1], s[0:1], 4
    s_and_b32 s97, s97, 15
    s_add_u32 m0, s87, 36864
    s_lshl_b32 s97, s97, 7
    buffer_load_dwordx4 v240, s[28:31], s97 offen offset:0  lds
    buffer_load_dwordx4 v241, s[28:31], s97 offen offset:1024  lds
    buffer_load_dwordx4 v242, s[28:31], s97 offen offset:2048  lds
    buffer_load_dwordx4 v243, s[28:31], s97 offen offset:3072  lds
    s_add_u32 m0, s88, 36864
    s_mov_b64 exec, 0xffffffff
    buffer_load_dwordx4 v3, s[28:31], s97 offen offset:0  lds
    s_mov_b64 exec, -1
    s_waitcnt vmcnt(11)
    s_barrier
    s_mul_i32 s16, s97, 3072
    s_add_u32 m0, s60, 49152
    s_add_u32 s99, s16, s62
    buffer_load_dwordx4 v244, s[32:35], s99 offen offset:0  lds
    ds_read_b128 v[84:87], v35 offset:0
    ds_read_b128 v[88:91], v35 offset:16
    buffer_load_dwordx4 v245, s[32:35], s99 offen offset:1024  lds
    ds_read_b64 v[40:41], v16 offset:0
    ds_read_b64 v[42:43], v231 offset:256
    buffer_load_dwordx4 v246, s[32:35], s99 offen offset:2048  lds
    ds_read_b64 v[44:45], v16 offset:256
    s_add_u32 m0, s61, 61440
    s_add_u32 s16, s16, s63
    buffer_load_dwordx4 v244, s[32:35], s16 offen offset:0  lds
    ds_read_b64 v[46:47], v16 offset:512
    ds_read_b64 v[48:49], v231 offset:512
    buffer_load_dwordx4 v245, s[32:35], s16 offen offset:1024  lds
    ds_read_b64 v[50:51], v16 offset:768
    ds_read_b64 v[52:53], v231 offset:768
    buffer_load_dwordx4 v246, s[32:35], s16 offen offset:2048  lds
    ds_read_b64 v[54:55], v16 offset:1024
    buffer_load_dword v230, v229, s[4:7], 0 offen
    ds_read_b64 v[56:57], v231 offset:1024
    ds_read_b64 v[58:59], v16 offset:1280
    buffer_load_dword v230, v228, s[32:35], 0 offen
    ds_read_b64 v[60:61], v231 offset:1280
    s_add_u32 s97, s98, s0
    s_lshr_b64 s[0:1], s[0:1], 4
    s_and_b32 s97, s97, 15
    s_add_u32 m0, s87, 0
    s_lshl_b32 s97, s97, 7
    buffer_load_dwordx4 v240, s[28:31], s97 offen offset:0  lds
    ds_read_b64 v[68:69], v16 offset:16896
    ds_read_b64 v[70:71], v231 offset:16896
    buffer_load_dwordx4 v241, s[28:31], s97 offen offset:1024  lds
    ds_read_b64 v[72:73], v16 offset:17152
    ds_read_b64 v[74:75], v231 offset:17152
    buffer_load_dwordx4 v242, s[28:31], s97 offen offset:2048  lds
    ds_read_b64 v[76:77], v16 offset:17408
    buffer_load_dwordx4 v243, s[28:31], s97 offen offset:3072  lds
    ds_read_b64 v[78:79], v231 offset:17408
    ds_read_b64 v[80:81], v16 offset:17664
    s_add_u32 m0, s88, 0
    s_mov_b64 exec, 0xffffffff
    buffer_load_dwordx4 v3, s[28:31], s97 offen offset:0  lds
    s_mov_b64 exec, -1
    ds_read_b64 v[82:83], v231 offset:17664
    s_waitcnt vmcnt(13)
    s_waitcnt lgkmcnt(0)
    s_barrier
    s_mul_i32 s16, s97, 3072
    s_add_u32 m0, s60, 0
    s_add_u32 s99, s16, s62
    buffer_load_dwordx4 v244, s[32:35], s99 offen offset:0  lds
    v_lshlrev_b32 v160, 16, v40
    v_lshlrev_b32 v161, 16, v42
    v_lshlrev_b32 v162, 16, v44
    v_lshlrev_b32 v163, 16, v46
    v_lshlrev_b32 v164, 16, v48
    buffer_load_dwordx4 v245, s[32:35], s99 offen offset:1024  lds
    v_lshlrev_b32 v165, 16, v50
    v_lshlrev_b32 v166, 16, v52
    v_lshlrev_b32 v167, 16, v54
    v_lshlrev_b32 v168, 16, v56
    v_lshlrev_b32 v169, 16, v58
    buffer_load_dwordx4 v246, s[32:35], s99 offen offset:2048  lds
    v_lshlrev_b32 v170, 16, v60
    v_lshlrev_b32 v172, 16, v84
    v_and_b32 v173, 0xffff0000, v84
    v_lshlrev_b32 v174, 16, v85
    v_and_b32 v175, 0xffff0000, v85
    s_add_u32 m0, s61, 12288
    s_add_u32 s16, s16, s63
    buffer_load_dwordx4 v244, s[32:35], s16 offen offset:0  lds
    v_lshlrev_b32 v176, 16, v68
    v_lshlrev_b32 v177, 16, v70
    v_lshlrev_b32 v178, 16, v72
    v_lshlrev_b32 v179, 16, v74
    v_lshlrev_b32 v180, 16, v76
    buffer_load_dwordx4 v245, s[32:35], s16 offen offset:1024  lds
    v_lshlrev_b32 v181, 16, v78
    v_lshlrev_b32 v182, 16, v80
    v_lshlrev_b32 v183, 16, v82
    v_mul_f32 v184, v160, v175
    v_mul_f32 v185, v161, v175
    buffer_load_dwordx4 v246, s[32:35], s16 offen offset:2048  lds
    v_mul_f32 v186, v162, v175
    v_mul_f32 v187, v163, v175
    v_mul_f32 v188, v164, v175
    v_mul_f32 v189, v165, v175
    v_mul_f32 v190, v166, v175
    s_add_u32 s97, s98, s0
    s_lshr_b64 s[0:1], s[0:1], 4
    s_and_b32 s97, s97, 15
    s_add_u32 m0, s87, 18432
    s_lshl_b32 s97, s97, 7
    buffer_load_dwordx4 v240, s[28:31], s97 offen offset:0  lds
    v_mul_f32 v191, v167, v175
    v_fmac_f32 v184, v161, v174
    v_fmac_f32 v185, v162, v174
    v_fmac_f32 v186, v163, v174
    v_fmac_f32 v187, v164, v174
    buffer_load_dwordx4 v241, s[28:31], s97 offen offset:1024  lds
    v_fmac_f32 v188, v165, v174
    v_fmac_f32 v189, v166, v174
    v_fmac_f32 v190, v167, v174
    v_fmac_f32 v191, v168, v174
    v_fmac_f32 v184, v162, v173
    buffer_load_dwordx4 v242, s[28:31], s97 offen offset:2048  lds
    v_fmac_f32 v185, v163, v173
    v_fmac_f32 v186, v164, v173
    v_fmac_f32 v187, v165, v173
    v_fmac_f32 v188, v166, v173
    v_fmac_f32 v189, v167, v173
    buffer_load_dwordx4 v243, s[28:31], s97 offen offset:3072  lds
    v_fmac_f32 v190, v168, v173
    v_fmac_f32 v191, v169, v173
    v_fmac_f32 v184, v163, v172
    v_fmac_f32 v185, v164, v172
    v_fmac_f32 v186, v165, v172
    s_add_u32 m0, s88, 18432
    s_mov_b64 exec, 0xffffffff
    buffer_load_dwordx4 v3, s[28:31], s97 offen offset:0  lds
    s_mov_b64 exec, -1
    v_fmac_f32 v187, v166, v172
    v_fmac_f32 v188, v167, v172
    v_fmac_f32 v189, v168, v172
    v_fmac_f32 v190, v169, v172
    v_fmac_f32 v191, v170, v172
    v_mul_f32 v184, v184, v176
    v_mul_f32 v185, v185, v177
    v_mul_f32 v186, v186, v178
    v_mul_f32 v187, v187, v179
    v_mul_f32 v188, v188, v180
    v_mul_f32 v189, v189, v181
    v_mul_f32 v190, v190, v182
    v_mul_f32 v191, v191, v183
    v_cvt_pk_bf16_f32 v100, v191, v190
    v_cvt_pk_bf16_f32 v101, v189, v188
    v_cvt_pk_bf16_f32 v102, v187, v186
    v_cvt_pk_bf16_f32 v103, v185, v184
    s_mov_b32 s89, 0
    buffer_store_dwordx4 v[100:103], v12, s[52:55], s89 offen sc1
    v_and_b32 v160, 0xffff0000, v40
    v_and_b32 v161, 0xffff0000, v42
    v_and_b32 v162, 0xffff0000, v44
    v_and_b32 v163, 0xffff0000, v46
    v_and_b32 v164, 0xffff0000, v48
    v_and_b32 v165, 0xffff0000, v50
    v_and_b32 v166, 0xffff0000, v52
    v_and_b32 v167, 0xffff0000, v54
    v_and_b32 v168, 0xffff0000, v56
    v_and_b32 v169, 0xffff0000, v58
    v_and_b32 v170, 0xffff0000, v60
    v_lshlrev_b32 v172, 16, v86
    v_and_b32 v173, 0xffff0000, v86
    v_lshlrev_b32 v174, 16, v87
    v_and_b32 v175, 0xffff0000, v87
    v_and_b32 v176, 0xffff0000, v68
    v_and_b32 v177, 0xffff0000, v70
    v_and_b32 v178, 0xffff0000, v72
    v_and_b32 v179, 0xffff0000, v74
    v_and_b32 v180, 0xffff0000, v76
    v_and_b32 v181, 0xffff0000, v78
    v_and_b32 v182, 0xffff0000, v80
    v_and_b32 v183, 0xffff0000, v82
    s_waitcnt vmcnt(12)
    s_barrier
    s_mul_i32 s16, s97, 3072
    s_add_u32 m0, s60, 24576
    s_add_u32 s99, s16, s62
    buffer_load_dwordx4 v244, s[32:35], s99 offen offset:0  lds
    v_mul_f32 v184, v160, v175
    v_mul_f32 v185, v161, v175
    v_mul_f32 v186, v162, v175
    v_mul_f32 v187, v163, v175
    v_mul_f32 v188, v164, v175
    buffer_load_dwordx4 v245, s[32:35], s99 offen offset:1024  lds
    v_mul_f32 v189, v165, v175
    v_mul_f32 v190, v166, v175
    v_mul_f32 v191, v167, v175
    v_fmac_f32 v184, v161, v174
    v_fmac_f32 v185, v162, v174
    buffer_load_dwordx4 v246, s[32:35], s99 offen offset:2048  lds
    v_fmac_f32 v186, v163, v174
    v_fmac_f32 v187, v164, v174
    v_fmac_f32 v188, v165, v174
    v_fmac_f32 v189, v166, v174
    v_fmac_f32 v190, v167, v174
    s_add_u32 m0, s61, 36864
    s_add_u32 s16, s16, s63
    buffer_load_dwordx4 v244, s[32:35], s16 offen offset:0  lds
    v_fmac_f32 v191, v168, v174
    v_fmac_f32 v184, v162, v173
    v_fmac_f32 v185, v163, v173
    v_fmac_f32 v186, v164, v173
    v_fmac_f32 v187, v165, v173
    buffer_load_dwordx4 v245, s[32:35], s16 offen offset:1024  lds
    v_fmac_f32 v188, v166, v173
    v_fmac_f32 v189, v167, v173
    v_fmac_f32 v190, v168, v173
    v_fmac_f32 v191, v169, v173
    v_fmac_f32 v184, v163, v172
    buffer_load_dwordx4 v246, s[32:35], s16 offen offset:2048  lds
    v_fmac_f32 v185, v164, v172
    v_fmac_f32 v186, v165, v172
    v_fmac_f32 v187, v166, v172
    v_fmac_f32 v188, v167, v172
    v_fmac_f32 v189, v168, v172
    s_add_u32 s97, s98, s0
    s_lshr_b64 s[0:1], s[0:1], 4
    s_and_b32 s97, s97, 15
    s_add_u32 m0, s87, 36864
    s_lshl_b32 s97, s97, 7
    buffer_load_dwordx4 v240, s[28:31], s97 offen offset:0  lds
    v_fmac_f32 v190, v169, v172
    v_fmac_f32 v191, v170, v172
    v_mul_f32 v184, v184, v176
    v_mul_f32 v185, v185, v177
    v_mul_f32 v186, v186, v178
    buffer_load_dwordx4 v241, s[28:31], s97 offen offset:1024  lds
    v_mul_f32 v187, v187, v179
    v_mul_f32 v188, v188, v180
    v_mul_f32 v189, v189, v181
    v_mul_f32 v190, v190, v182
    v_mul_f32 v191, v191, v183
    buffer_load_dwordx4 v242, s[28:31], s97 offen offset:2048  lds
    v_cvt_pk_bf16_f32 v104, v191, v190
    v_cvt_pk_bf16_f32 v105, v189, v188
    v_cvt_pk_bf16_f32 v106, v187, v186
    v_cvt_pk_bf16_f32 v107, v185, v184
    s_mov_b32 s89, 16384
    buffer_store_dwordx4 v[104:107], v12, s[52:55], s89 offen sc1
    buffer_load_dwordx4 v243, s[28:31], s97 offen offset:3072  lds
    v_lshlrev_b32 v160, 16, v41
    v_lshlrev_b32 v161, 16, v43
    v_lshlrev_b32 v162, 16, v45
    v_lshlrev_b32 v163, 16, v47
    v_lshlrev_b32 v164, 16, v49
    s_add_u32 m0, s88, 36864
    s_mov_b64 exec, 0xffffffff
    buffer_load_dwordx4 v3, s[28:31], s97 offen offset:0  lds
    s_mov_b64 exec, -1
    v_lshlrev_b32 v165, 16, v51
    v_lshlrev_b32 v166, 16, v53
    v_lshlrev_b32 v167, 16, v55
    v_lshlrev_b32 v168, 16, v57
    v_lshlrev_b32 v169, 16, v59
    v_lshlrev_b32 v170, 16, v61
    v_lshlrev_b32 v172, 16, v88
    v_and_b32 v173, 0xffff0000, v88
    v_lshlrev_b32 v174, 16, v89
    v_and_b32 v175, 0xffff0000, v89
    v_lshlrev_b32 v176, 16, v69
    v_lshlrev_b32 v177, 16, v71
    v_lshlrev_b32 v178, 16, v73
    v_lshlrev_b32 v179, 16, v75
    v_lshlrev_b32 v180, 16, v77
    v_lshlrev_b32 v181, 16, v79
    v_lshlrev_b32 v182, 16, v81
    v_lshlrev_b32 v183, 16, v83
    v_mul_f32 v184, v160, v175
    v_mul_f32 v185, v161, v175
    v_mul_f32 v186, v162, v175
    v_mul_f32 v187, v163, v175
    v_mul_f32 v188, v164, v175
    v_mul_f32 v189, v165, v175
    v_mul_f32 v190, v166, v175
    v_mul_f32 v191, v167, v175
    v_fmac_f32 v184, v161, v174
    v_fmac_f32 v185, v162, v174
    v_fmac_f32 v186, v163, v174
    v_fmac_f32 v187, v164, v174
    v_fmac_f32 v188, v165, v174
    v_fmac_f32 v189, v166, v174
    v_fmac_f32 v190, v167, v174
    v_fmac_f32 v191, v168, v174
    v_fmac_f32 v184, v162, v173
    v_fmac_f32 v185, v163, v173
    v_fmac_f32 v186, v164, v173
    v_fmac_f32 v187, v165, v173
    v_fmac_f32 v188, v166, v173
    v_fmac_f32 v189, v167, v173
    v_fmac_f32 v190, v168, v173
    s_waitcnt vmcnt(13)
    s_barrier
    s_mul_i32 s16, s97, 3072
    s_add_u32 m0, s60, 49152
    s_add_u32 s99, s16, s62
    buffer_load_dwordx4 v244, s[32:35], s99 offen offset:0  lds
    v_fmac_f32 v191, v169, v173
    v_fmac_f32 v184, v163, v172
    v_fmac_f32 v185, v164, v172
    v_fmac_f32 v186, v165, v172
    v_fmac_f32 v187, v166, v172
    buffer_load_dwordx4 v245, s[32:35], s99 offen offset:1024  lds
    v_fmac_f32 v188, v167, v172
    v_fmac_f32 v189, v168, v172
    v_fmac_f32 v190, v169, v172
    v_fmac_f32 v191, v170, v172
    v_mul_f32 v184, v184, v176
    buffer_load_dwordx4 v246, s[32:35], s99 offen offset:2048  lds
    v_mul_f32 v185, v185, v177
    v_mul_f32 v186, v186, v178
    v_mul_f32 v187, v187, v179
    v_mul_f32 v188, v188, v180
    v_mul_f32 v189, v189, v181
    s_add_u32 m0, s61, 61440
    s_add_u32 s16, s16, s63
    buffer_load_dwordx4 v244, s[32:35], s16 offen offset:0  lds
    v_mul_f32 v190, v190, v182
    v_mul_f32 v191, v191, v183
    v_cvt_pk_bf16_f32 v108, v191, v190
    v_cvt_pk_bf16_f32 v109, v189, v188
    v_cvt_pk_bf16_f32 v110, v187, v186
    buffer_load_dwordx4 v245, s[32:35], s16 offen offset:1024  lds
    v_cvt_pk_bf16_f32 v111, v185, v184
    s_mov_b32 s89, 32768
    buffer_store_dwordx4 v[108:111], v12, s[52:55], s89 offen sc1
    v_and_b32 v160, 0xffff0000, v41
    v_and_b32 v161, 0xffff0000, v43
    v_and_b32 v162, 0xffff0000, v45
    buffer_load_dwordx4 v246, s[32:35], s16 offen offset:2048  lds
    v_and_b32 v163, 0xffff0000, v47
    v_and_b32 v164, 0xffff0000, v49
    v_and_b32 v165, 0xffff0000, v51
    v_and_b32 v166, 0xffff0000, v53
    v_and_b32 v167, 0xffff0000, v55
    s_add_u32 s97, s98, s0
    s_lshr_b64 s[0:1], s[0:1], 4
    s_and_b32 s97, s97, 15
    s_add_u32 m0, s87, 0
    s_lshl_b32 s97, s97, 7
    buffer_load_dwordx4 v240, s[28:31], s97 offen offset:0  lds
    v_and_b32 v168, 0xffff0000, v57
    v_and_b32 v169, 0xffff0000, v59
    v_and_b32 v170, 0xffff0000, v61
    v_lshlrev_b32 v172, 16, v90
    v_and_b32 v173, 0xffff0000, v90
    buffer_load_dwordx4 v241, s[28:31], s97 offen offset:1024  lds
    v_lshlrev_b32 v174, 16, v91
    v_and_b32 v175, 0xffff0000, v91
    v_and_b32 v176, 0xffff0000, v69
    v_and_b32 v177, 0xffff0000, v71
    v_and_b32 v178, 0xffff0000, v73
    buffer_load_dwordx4 v242, s[28:31], s97 offen offset:2048  lds
    v_and_b32 v179, 0xffff0000, v75
    v_and_b32 v180, 0xffff0000, v77
    v_and_b32 v181, 0xffff0000, v79
    v_and_b32 v182, 0xffff0000, v81
    v_and_b32 v183, 0xffff0000, v83
    buffer_load_dwordx4 v243, s[28:31], s97 offen offset:3072  lds
    v_mul_f32 v184, v160, v175
    v_mul_f32 v185, v161, v175
    v_mul_f32 v186, v162, v175
    v_mul_f32 v187, v163, v175
    v_mul_f32 v188, v164, v175
    s_add_u32 m0, s88, 0
    s_mov_b64 exec, 0xffffffff
    buffer_load_dwordx4 v3, s[28:31], s97 offen offset:0  lds
    s_mov_b64 exec, -1
    v_mul_f32 v189, v165, v175
    v_mul_f32 v190, v166, v175
    v_mul_f32 v191, v167, v175
    v_fmac_f32 v184, v161, v174
    v_fmac_f32 v185, v162, v174
    v_fmac_f32 v186, v163, v174
    v_fmac_f32 v187, v164, v174
    v_fmac_f32 v188, v165, v174
    v_fmac_f32 v189, v166, v174
    v_fmac_f32 v190, v167, v174
    v_fmac_f32 v191, v168, v174
    v_fmac_f32 v184, v162, v173
    v_fmac_f32 v185, v163, v173
    v_fmac_f32 v186, v164, v173
    v_fmac_f32 v187, v165, v173
    v_fmac_f32 v188, v166, v173
    v_fmac_f32 v189, v167, v173
    v_fmac_f32 v190, v168, v173
    v_fmac_f32 v191, v169, v173
    v_fmac_f32 v184, v163, v172
    v_fmac_f32 v185, v164, v172
    v_fmac_f32 v186, v165, v172
    v_fmac_f32 v187, v166, v172
    v_fmac_f32 v188, v167, v172
    v_fmac_f32 v189, v168, v172
    v_fmac_f32 v190, v169, v172
    v_fmac_f32 v191, v170, v172
    v_mul_f32 v184, v184, v176
    v_mul_f32 v185, v185, v177
    v_mul_f32 v186, v186, v178
    v_mul_f32 v187, v187, v179
    v_mul_f32 v188, v188, v180
    v_mul_f32 v189, v189, v181
    v_mul_f32 v190, v190, v182
    v_mul_f32 v191, v191, v183
    v_cvt_pk_bf16_f32 v112, v191, v190
    v_cvt_pk_bf16_f32 v113, v189, v188
    v_cvt_pk_bf16_f32 v114, v187, v186
    v_cvt_pk_bf16_f32 v115, v185, v184
    s_mov_b32 s89, 49152
    buffer_store_dwordx4 v[112:115], v12, s[52:55], s89 offen sc1
    s_waitcnt vmcnt(13)
    s_barrier
    s_mul_i32 s16, s97, 3072
    s_add_u32 m0, s60, 0
    s_add_u32 s99, s16, s62
    buffer_load_dwordx4 v244, s[32:35], s99 offen offset:0  lds
    buffer_load_dwordx4 v245, s[32:35], s99 offen offset:1024  lds
    buffer_load_dwordx4 v246, s[32:35], s99 offen offset:2048  lds
    s_add_u32 m0, s61, 12288
    s_add_u32 s16, s16, s63
    buffer_load_dwordx4 v244, s[32:35], s16 offen offset:0  lds
    buffer_load_dwordx4 v245, s[32:35], s16 offen offset:1024  lds
    buffer_load_dwordx4 v246, s[32:35], s16 offen offset:2048  lds
    s_add_u32 s97, s98, s0
    s_lshr_b64 s[0:1], s[0:1], 4
    s_and_b32 s97, s97, 15
    s_add_u32 m0, s87, 18432
    s_lshl_b32 s97, s97, 7
    buffer_load_dwordx4 v240, s[28:31], s97 offen offset:0  lds
    buffer_load_dwordx4 v241, s[28:31], s97 offen offset:1024  lds
    buffer_load_dwordx4 v242, s[28:31], s97 offen offset:2048  lds
    buffer_load_dwordx4 v243, s[28:31], s97 offen offset:3072  lds
    s_add_u32 m0, s88, 18432
    s_mov_b64 exec, 0xffffffff
    buffer_load_dwordx4 v3, s[28:31], s97 offen offset:0  lds
    s_mov_b64 exec, -1
    s_waitcnt vmcnt(12)
    s_barrier
    s_mul_i32 s16, s97, 3072
    s_add_u32 m0, s60, 24576
    s_add_u32 s99, s16, s62
    buffer_load_dwordx4 v244, s[32:35], s99 offen offset:0  lds
    s_mov_b32 s68, s24
    s_mov_b32 s69, s25
    s_mov_b32 s70, 0x100
    s_mov_b32 s71, 0x20000
    buffer_load_dwordx4 v245, s[32:35], s99 offen offset:1024  lds
    v_lshrrev_b32 v6, 5, v0
    v_and_b32 v7, 3, v0
    s_lshr_b32 s78, s90, 1
    s_lshl_b32 s78, s78, 2
    buffer_load_dwordx4 v246, s[32:35], s99 offen offset:2048  lds
    s_load_dword s92, s[14:15], s78
    v_bfe_u32 v5, v0, 2, 2
    v_lshlrev_b32 v5, 1, v5
    s_add_u32 m0, s61, 36864
    s_add_u32 s16, s16, s63
    buffer_load_dwordx4 v244, s[32:35], s16 offen offset:0  lds
    v_lshl_add_u32 v5, v6, 3, v5
    v_bfe_u32 v8, v0, 4, 1
    v_add_u32 v5, v5, v8
    s_and_b32 s78, s3, 1
    buffer_load_dwordx4 v245, s[32:35], s16 offen offset:1024  lds
    s_lshl_b32 s78, s78, 1
    v_add_u32 v8, s78, v6
    v_xor_b32 v8, v8, v7
    v_lshlrev_b32 v8, 4, v8
    buffer_load_dwordx4 v246, s[32:35], s16 offen offset:2048  lds
    v_lshl_add_u32 v5, v5, 6, v8
    v_add_u32 v14, s86, v5
    v_mov_b32 v18, 162304
    s_add_u32 s97, s98, s0
    s_lshr_b64 s[0:1], s[0:1], 4
    s_and_b32 s97, s97, 15
    s_add_u32 m0, s87, 36864
    s_lshl_b32 s97, s97, 7
    buffer_load_dwordx4 v240, s[28:31], s97 offen offset:0  lds
    v_mov_b32 v19, 1
    v_and_b32 v5, 3, v0
    s_lshl_b32 s78, s74, 4
    s_add_u32 s78, s78, s3
    buffer_load_dwordx4 v241, s[28:31], s97 offen offset:1024  lds
    v_lshl_add_u32 v6, v5, 2, s78
    s_lshr_b32 s78, s76, 3
    s_lshl_b32 s79, s3, 1
    s_add_u32 s78, s78, s79
    buffer_load_dwordx4 v242, s[28:31], s97 offen offset:2048  lds
    s_xor_b32 s78, s78, 3
    s_lshl_b32 s78, s78, 5
    s_add_u32 s79, s76, 5
    buffer_load_dwordx4 v243, s[28:31], s97 offen offset:3072  lds
    s_and_b32 s79, s79, 7
    s_lshl_b32 s79, s79, 1
    s_add_u32 s78, s78, s79
    v_mul_u32_u24 v7, 9, v5
    s_add_u32 m0, s88, 36864
    s_mov_b64 exec, 0xffffffff
    buffer_load_dwordx4 v3, s[28:31], s97 offen offset:0  lds
    s_mov_b64 exec, -1
    v_and_b32 v7, 17, v7
    v_add_u32 v7, s78, v7
    v_and_b32 v8, 4, v0
    s_waitcnt vmcnt(11)
    s_barrier
    s_mul_i32 s16, s97, 3072
    s_add_u32 m0, s60, 49152
    s_add_u32 s99, s16, s62
    buffer_load_dwordx4 v244, s[32:35], s99 offen offset:0  lds
    v_cmp_eq_u32 vcc, 0, v8
    s_nop 1
    v_cndmask_b32 v6, v7, v6, vcc
    v_and_b32 v33, 0xf0, v6
    buffer_load_dwordx4 v245, s[32:35], s99 offen offset:1024  lds
    v_lshlrev_b32 v34, 8, v6
    v_add_u32 v34, 12582912, v34
    v_and_b32 v5, 15, v0
    buffer_load_dwordx4 v246, s[32:35], s99 offen offset:2048  lds
    v_lshrrev_b32 v6, 4, v0
    v_add_u32 v7, 9, v5
    s_add_u32 m0, s61, 61440
    s_add_u32 s16, s16, s63
    buffer_load_dwordx4 v244, s[32:35], s16 offen offset:0  lds
    v_and_b32 v8, 1, v7
    v_mul_u32_u24 v8, 4160, v8
    v_lshrrev_b32 v7, 1, v7
    buffer_load_dwordx4 v245, s[32:35], s16 offen offset:1024  lds
    v_lshl_add_u32 v8, v7, 2, v8
    v_lshlrev_b32 v7, 4, v6
    v_sub_u32 v8, v8, v7
    buffer_load_dwordx4 v246, s[32:35], s16 offen offset:2048  lds
    s_add_u32 s78, s94, 32
    v_add_u32 v21, s78, v8
    s_add_u32 m0, s94, 32
    s_lshl_b32 s89, s90, 12
    buffer_load_dwordx4 v15, s[48:51], s89 offen offset:0 nt lds
    v_add_u32 v22, 1024, v21
    v_add_u32 v23, 2048, v21
    v_add_u32 v24, 3072, v21
    s_add_u32 m0, s94, 32
    s_lshl_b32 s89, s90, 12
    buffer_load_dwordx4 v15, s[48:51], s89 offen offset:1024 nt lds
    v_lshl_add_u32 v7, v5, 1, v6
    v_add_u32 v7, 30, v7
    v_and_b32 v8, 1, v7
    s_add_u32 m0, s94, 32
    s_lshl_b32 s89, s90, 12
    buffer_load_dwordx4 v15, s[48:51], s89 offen offset:2048 nt lds
    v_bfe_u32 v136, v7, 1, 2
    v_lshl_add_u32 v136, v8, 2, v136
    s_add_u32 m0, s94, 32
    s_lshl_b32 s89, s90, 12
    buffer_load_dwordx4 v15, s[48:51], s89 offen offset:3072 nt lds
    v_lshlrev_b32 v136, 6, v136
    v_lshrrev_b32 v7, 3, v7
    v_lshl_add_u32 v136, v7, 9, v136
    s_add_u32 s97, s98, s0
    s_lshr_b64 s[0:1], s[0:1], 4
    s_and_b32 s97, s97, 15
    s_add_u32 m0, s87, 0
    s_lshl_b32 s97, s97, 7
    buffer_load_dwordx4 v240, s[28:31], s97 offen offset:0  lds
    v_bitop3_b32 v8, v7, 3, s3 bitop3:0x6a
    v_lshl_add_u32 v25, v8, 4, v136
    v_add_u32 v25, 92160, v25
    buffer_load_dwordx4 v241, s[28:31], s97 offen offset:1024  lds
    v_subrev_u32 v7, 1, v7
    v_bitop3_b32 v8, v7, 3, s3 bitop3:0x6a
    buffer_load_dwordx4 v242, s[28:31], s97 offen offset:2048  lds
    v_lshl_add_u32 v27, v8, 4, v136
    v_add_u32 v27, 91648, v27
    v_subrev_u32 v7, 1, v7
    buffer_load_dwordx4 v243, s[28:31], s97 offen offset:3072  lds
    v_bitop3_b32 v8, v7, 3, s3 bitop3:0x6a
    v_lshl_add_u32 v29, v8, 4, v136
    v_add_u32 v29, 91136, v29
    s_add_u32 m0, s88, 0
    s_mov_b64 exec, 0xffffffff
    buffer_load_dwordx4 v3, s[28:31], s97 offen offset:0  lds
    s_mov_b64 exec, -1
    v_subrev_u32 v7, 1, v7
    v_bitop3_b32 v8, v7, 3, s3 bitop3:0x6a
    s_waitcnt vmcnt(15)
    s_barrier
    s_mul_i32 s16, s97, 3072
    s_add_u32 m0, s60, 0
    s_add_u32 s99, s16, s62
    buffer_load_dwordx4 v244, s[32:35], s99 offen offset:0  lds
    v_lshl_add_u32 v31, v8, 4, v136
    v_add_u32 v31, 90624, v31
    v_lshl_add_u32 v7, v5, 1, v6
    v_add_u32 v7, 26, v7
    buffer_load_dwordx4 v245, s[32:35], s99 offen offset:1024  lds
    v_and_b32 v8, 1, v7
    v_bfe_u32 v136, v7, 1, 2
    v_lshl_add_u32 v136, v8, 2, v136
    v_lshlrev_b32 v136, 6, v136
    buffer_load_dwordx4 v246, s[32:35], s99 offen offset:2048  lds
    v_lshrrev_b32 v7, 3, v7
    v_lshl_add_u32 v136, v7, 9, v136
    v_bitop3_b32 v8, v7, 3, s3 bitop3:0x6a
    s_add_u32 m0, s61, 12288
    s_add_u32 s16, s16, s63
    buffer_load_dwordx4 v244, s[32:35], s16 offen offset:0  lds
    v_lshl_add_u32 v26, v8, 4, v136
    v_add_u32 v26, 92160, v26
    v_subrev_u32 v7, 1, v7
    v_bitop3_b32 v8, v7, 3, s3 bitop3:0x6a
    buffer_load_dwordx4 v245, s[32:35], s16 offen offset:1024  lds
    v_lshl_add_u32 v28, v8, 4, v136
    v_add_u32 v28, 91648, v28
    v_subrev_u32 v7, 1, v7
    v_bitop3_b32 v8, v7, 3, s3 bitop3:0x6a
    buffer_load_dwordx4 v246, s[32:35], s16 offen offset:2048  lds
    v_lshl_add_u32 v30, v8, 4, v136
    v_add_u32 v30, 91136, v30
    v_subrev_u32 v7, 1, v7
    s_add_u32 s97, s98, s0
    s_lshr_b64 s[0:1], s[0:1], 4
    s_and_b32 s97, s97, 15
    s_add_u32 m0, s87, 18432
    s_lshl_b32 s97, s97, 7
    buffer_load_dwordx4 v240, s[28:31], s97 offen offset:0  lds
    v_bitop3_b32 v8, v7, 3, s3 bitop3:0x6a
    v_lshl_add_u32 v32, v8, 4, v136
    v_add_u32 v32, 90624, v32
    v_lshrrev_b32 v7, 1, v6
    buffer_load_dwordx4 v241, s[28:31], s97 offen offset:1024  lds
    v_lshl_add_u32 v7, v5, 1, v7
    v_add_u32 v7, 32, v7
    v_and_b32 v8, 1, v7
    v_bfe_u32 v136, v7, 1, 2
    buffer_load_dwordx4 v242, s[28:31], s97 offen offset:2048  lds
    v_lshl_add_u32 v136, v8, 2, v136
    v_lshlrev_b32 v136, 6, v136
    v_lshrrev_b32 v7, 3, v7
    buffer_load_dwordx4 v243, s[28:31], s97 offen offset:3072  lds
    v_lshl_add_u32 v136, v7, 9, v136
    v_bitop3_b32 v8, v7, 3, s3 bitop3:0x6a
    v_lshl_add_u32 v20, v8, 4, v136
    v_add_u32 v20, 92160, v20
    s_add_u32 m0, s88, 18432
    s_mov_b64 exec, 0xffffffff
    buffer_load_dwordx4 v3, s[28:31], s97 offen offset:0  lds
    s_mov_b64 exec, -1
    v_and_b32 v8, 1, v6
    v_xor_b32 v8, 1, v8
    v_lshl_add_u32 v20, v8, 3, v20
    s_waitcnt vmcnt(11)
    s_barrier
    s_mul_i32 s16, s97, 3072
    s_add_u32 m0, s60, 24576
    s_add_u32 s99, s16, s62
    buffer_load_dwordx4 v244, s[32:35], s99 offen offset:0  lds
    s_waitcnt lgkmcnt(0)
    s_and_b32 s78, s92, 0xffff0000
    s_lshl_b32 s92, s92, 16
    buffer_load_dwordx4 v245, s[32:35], s99 offen offset:1024  lds
    s_bitcmp1_b32 s90, 0
    s_cselect_b32 s92, s78, s92
    v_lshlrev_b32 v7, 3, v6
    v_sub_u32 v7, v7, v5
    buffer_load_dwordx4 v246, s[32:35], s99 offen offset:2048  lds
    v_subrev_u32 v7, 9, v7
    v_and_b32 v8, 1, v7
    v_xor_b32 v8, 1, v8
    s_add_u32 m0, s61, 36864
    s_add_u32 s16, s16, s63
    buffer_load_dwordx4 v244, s[32:35], s16 offen offset:0  lds
    v_lshlrev_b32 v8, 4, v8
    v_lshrrev_b32 v8, v8, s92
    v_ashrrev_i32 v7, 1, v7
    buffer_load_dwordx4 v245, s[32:35], s16 offen offset:1024  lds
    v_cmp_eq_u32 vcc, 0, v7
    s_nop 1
    v_cndmask_b32 v236, 0, v8, vcc
    v_cmp_eq_u32 vcc, 1, v7
    buffer_load_dwordx4 v246, s[32:35], s16 offen offset:2048  lds
    s_nop 0
    v_cndmask_b32 v237, 0, v8, vcc
    v_cmp_eq_u32 vcc, 2, v7
    s_nop 1
    v_cndmask_b32 v238, 0, v8, vcc
    s_add_u32 s97, s98, s0
    s_lshr_b64 s[0:1], s[0:1], 4
    s_and_b32 s97, s97, 15
    s_add_u32 m0, s87, 36864
    s_lshl_b32 s97, s97, 7
    buffer_load_dwordx4 v240, s[28:31], s97 offen offset:0  lds
    v_cmp_eq_u32 vcc, 3, v7
    s_nop 1
    v_cndmask_b32 v239, 0, v8, vcc
    s_and_b32 s78, s77, 7
    s_mov_b32 s95, 0x76543210
    s_and_b32 s78, s76, 3
    s_mul_i32 s78, s78, 0x22222222
    s_add_u32 s95, s95, s78
    s_bfe_u32 s17, s95, 0x30000
    s_lshl_b32 s17, s17, 18
    s_bfe_u32 s18, s95, 0x30004
    s_lshl_b32 s18, s18, 18
    s_bfe_u32 s100, s95, 0x3001c
    s_lshl_b32 s100, s100, 18
    s_bfe_u32 s95, s95, 0x30018
    s_lshl_b32 s95, s95, 18
    buffer_load_dwordx4 v241, s[28:31], s97 offen offset:1024  lds
    v_lshrrev_b32 v136, 4, v0
    v_lshlrev_b32 v136, 1, v136
    v_and_b32 v137, 7, v0
    buffer_load_dwordx4 v242, s[28:31], s97 offen offset:2048  lds
    v_xor_b32 v136, v136, v137
    v_lshlrev_b32 v136, 4, v136
    v_lshrrev_b32 v137, 3, v0
    buffer_load_dwordx4 v243, s[28:31], s97 offen offset:3072  lds
    v_lshl_add_u32 v136, v137, 11, v136
    s_lshl_b32 s78, s77, 7
    s_lshl_b32 s79, s3, 14
    s_add_u32 m0, s88, 36864
    s_mov_b64 exec, 0xffffffff
    buffer_load_dwordx4 v3, s[28:31], s97 offen offset:0  lds
    s_mov_b64 exec, -1
    s_add_u32 s78, s78, s79
    v_add_u32 v17, s78, v136
    s_waitcnt vmcnt(11)
    s_barrier
    s_mul_i32 s16, s97, 3072
    s_add_u32 m0, s60, 49152
    s_add_u32 s99, s16, s62
    buffer_load_dwordx4 v244, s[32:35], s99 offen offset:0  lds
    v_add_u32 v5, s94, v15
    ds_read_b128 v[140:143], v5 offset:32
    ds_read_b32 v156, v5 offset:48
    ds_read_b128 v[144:147], v5 offset:1056
    buffer_load_dwordx4 v245, s[32:35], s99 offen offset:1024  lds
    ds_read_b32 v157, v5 offset:1072
    ds_read_b128 v[148:151], v5 offset:2080
    ds_read_b32 v158, v5 offset:2096
    ds_read_b128 v[152:155], v5 offset:3104
    buffer_load_dwordx4 v246, s[32:35], s99 offen offset:2048  lds
    ds_read_b32 v159, v5 offset:3120
    v_lshrrev_b32 v6, 3, v0
    v_mul_u32_u24 v6, 4160, v6
    s_add_u32 m0, s61, 61440
    s_add_u32 s16, s16, s63
    buffer_load_dwordx4 v244, s[32:35], s16 offen offset:0  lds
    v_and_b32 v7, 7, v0
    v_lshl_add_u32 v6, v7, 2, v6
    v_add_u32 v6, s94, v6
    v_mov_b32 v7, 0
    buffer_load_dwordx4 v245, s[32:35], s16 offen offset:1024  lds
    s_waitcnt lgkmcnt(0)
    v_readfirstlane_b32 s93, v140
    s_nop 0
    s_lshl_b32 s93, s93, 16
    s_nop 1
    v_writelane_b32 v7, s93, 15
    buffer_load_dwordx4 v246, s[32:35], s16 offen offset:2048  lds
    v_alignbit_b32 v140, v141, v140, 16
    v_alignbit_b32 v141, v142, v141, 16
    v_alignbit_b32 v142, v143, v142, 16
    s_add_u32 s97, s98, s0
    s_lshr_b64 s[0:1], s[0:1], 4
    s_and_b32 s97, s97, 15
    s_add_u32 m0, s87, 0
    s_lshl_b32 s97, s97, 7
    buffer_load_dwordx4 v240, s[28:31], s97 offen offset:0  lds
    v_alignbit_b32 v143, v156, v143, 16
    v_alignbit_b32 v144, v145, v144, 16
    v_alignbit_b32 v145, v146, v145, 16
    v_alignbit_b32 v146, v147, v146, 16
    buffer_load_dwordx4 v241, s[28:31], s97 offen offset:1024  lds
    v_alignbit_b32 v147, v157, v147, 16
    v_alignbit_b32 v148, v149, v148, 16
    v_alignbit_b32 v149, v150, v149, 16
    v_alignbit_b32 v150, v151, v150, 16
    buffer_load_dwordx4 v242, s[28:31], s97 offen offset:2048  lds
    v_alignbit_b32 v151, v158, v151, 16
    v_alignbit_b32 v152, v153, v152, 16
    v_alignbit_b32 v153, v154, v153, 16
    buffer_load_dwordx4 v243, s[28:31], s97 offen offset:3072  lds
    v_alignbit_b32 v154, v155, v154, 16
    v_alignbit_b32 v155, v159, v155, 16
    v_lshlrev_b32 v8, 3, v0
    s_add_u32 s78, s88, 18432
    s_add_u32 m0, s88, 0
    s_mov_b64 exec, 0xffffffff
    buffer_load_dwordx4 v3, s[28:31], s97 offen offset:0  lds
    s_mov_b64 exec, -1
    v_add_u32 v8, s78, v8
    v_mov_b32 v156, 0
    v_mov_b32 v157, 0
    s_waitcnt vmcnt(11)
    s_barrier
    s_mul_i32 s16, s97, 3072
    s_add_u32 m0, s60, 0
    s_add_u32 s99, s16, s62
    buffer_load_dwordx4 v244, s[32:35], s99 offen offset:0  lds
    buffer_load_dwordx4 v245, s[32:35], s99 offen offset:1024  lds
    buffer_load_dwordx4 v246, s[32:35], s99 offen offset:2048  lds
    s_add_u32 m0, s61, 12288
    s_add_u32 s16, s16, s63
    buffer_load_dwordx4 v244, s[32:35], s16 offen offset:0  lds
    buffer_load_dwordx4 v245, s[32:35], s16 offen offset:1024  lds
    buffer_load_dwordx4 v246, s[32:35], s16 offen offset:2048  lds
    s_mov_b64 exec, 0xff
    buffer_load_dword v136, v33, s[68:71], 0 offen sc1
    buffer_load_dword v137, v34, s[52:55], 0 offen sc1
    s_mov_b64 exec, -1
    buffer_load_dwordx4 v[212:215], v9, s[56:59], 0 offen offset:0 nt
    buffer_load_dwordx4 v[216:219], v9, s[56:59], 0 offen offset:2048 nt
    buffer_load_dwordx4 v[220:223], v9, s[56:59], s96 offen offset:0 nt
    buffer_load_dwordx4 v[224:227], v9, s[56:59], s96 offen offset:2048 nt
    s_waitcnt vmcnt(12)
    s_waitcnt vmcnt(6)
    s_barrier
    s_waitcnt vmcnt(4)
    s_branch LA_j
LA_c2:
    s_waitcnt vmcnt(8)
    s_barrier
    buffer_load_dwordx4 v242, s[28:31], s97 offen offset:2048  lds
    buffer_load_dwordx4 v243, s[28:31], s97 offen offset:3072  lds
    s_add_u32 m0, s88, 36864
    s_mov_b64 exec, 0xffffffff
    buffer_load_dwordx4 v3, s[28:31], s97 offen offset:0  lds
    s_mov_b64 exec, -1
    s_mul_i32 s16, s97, 3072
    s_add_u32 m0, s60, 49152
    s_add_u32 s99, s16, s62
    buffer_load_dwordx4 v244, s[32:35], s99 offen offset:0  lds
    buffer_load_dwordx4 v245, s[32:35], s99 offen offset:1024  lds
    buffer_load_dwordx4 v246, s[32:35], s99 offen offset:2048  lds
    s_add_u32 m0, s61, 61440
    s_add_u32 s16, s16, s63
    buffer_load_dwordx4 v244, s[32:35], s16 offen offset:0  lds
    buffer_load_dwordx4 v245, s[32:35], s16 offen offset:1024  lds
    buffer_load_dwordx4 v246, s[32:35], s16 offen offset:2048  lds
    s_add_u32 s97, s98, s0
    s_lshr_b64 s[0:1], s[0:1], 4
    s_and_b32 s97, s97, 15
    s_add_u32 m0, s87, 0
    s_lshl_b32 s97, s97, 7
    buffer_load_dwordx4 v240, s[28:31], s97 offen offset:0  lds
    buffer_load_dwordx4 v241, s[28:31], s97 offen offset:1024  lds
    buffer_load_dwordx4 v242, s[28:31], s97 offen offset:2048  lds
    buffer_load_dwordx4 v243, s[28:31], s97 offen offset:3072  lds
    s_add_u32 m0, s88, 0
    s_mov_b64 exec, 0xffffffff
    buffer_load_dwordx4 v3, s[28:31], s97 offen offset:0  lds
    s_mov_b64 exec, -1
    s_waitcnt vmcnt(11)
    s_barrier
    s_mul_i32 s16, s97, 3072
    s_add_u32 m0, s60, 0
    s_add_u32 s99, s16, s62
    buffer_load_dwordx4 v244, s[32:35], s99 offen offset:0  lds
    buffer_load_dwordx4 v245, s[32:35], s99 offen offset:1024  lds
    buffer_load_dwordx4 v246, s[32:35], s99 offen offset:2048  lds
    s_add_u32 m0, s61, 12288
    s_add_u32 s16, s16, s63
    buffer_load_dwordx4 v244, s[32:35], s16 offen offset:0  lds
    buffer_load_dwordx4 v245, s[32:35], s16 offen offset:1024  lds
    buffer_load_dwordx4 v246, s[32:35], s16 offen offset:2048  lds
    s_add_u32 s97, s98, s0
    s_lshr_b64 s[0:1], s[0:1], 4
    s_and_b32 s97, s97, 15
    s_add_u32 m0, s87, 18432
    s_lshl_b32 s97, s97, 7
    buffer_load_dwordx4 v240, s[28:31], s97 offen offset:0  lds
    buffer_load_dwordx4 v241, s[28:31], s97 offen offset:1024  lds
    buffer_load_dwordx4 v242, s[28:31], s97 offen offset:2048  lds
    buffer_load_dwordx4 v243, s[28:31], s97 offen offset:3072  lds
    s_add_u32 m0, s88, 18432
    s_mov_b64 exec, 0xffffffff
    buffer_load_dwordx4 v3, s[28:31], s97 offen offset:0  lds
    s_mov_b64 exec, -1
    s_waitcnt vmcnt(11)
    s_barrier
    s_mul_i32 s16, s97, 3072
    s_add_u32 m0, s60, 24576
    s_add_u32 s99, s16, s62
    buffer_load_dwordx4 v244, s[32:35], s99 offen offset:0  lds
    buffer_load_dwordx4 v245, s[32:35], s99 offen offset:1024  lds
    buffer_load_dwordx4 v246, s[32:35], s99 offen offset:2048  lds
    s_add_u32 m0, s61, 36864
    s_add_u32 s16, s16, s63
    buffer_load_dwordx4 v244, s[32:35], s16 offen offset:0  lds
    buffer_load_dwordx4 v245, s[32:35], s16 offen offset:1024  lds
    buffer_load_dwordx4 v246, s[32:35], s16 offen offset:2048  lds
    s_add_u32 m0, s86, 129536
    s_mov_b32 s89, 0
    buffer_load_dwordx4 v10, s[36:39], s89 offen nt lds
    s_add_u32 m0, s86, 145920
    s_mov_b32 s89, 0
    buffer_load_dwordx4 v10, s[40:43], s89 offen nt lds
    s_add_u32 m0, s86, 133632
    s_mov_b32 s89, 65536
    buffer_load_dwordx4 v10, s[36:39], s89 offen nt lds
    s_add_u32 m0, s86, 150016
    s_mov_b32 s89, 65536
    buffer_load_dwordx4 v10, s[40:43], s89 offen nt lds
    s_add_u32 m0, s86, 137728
    s_mov_b32 s89, 131072
    buffer_load_dwordx4 v10, s[36:39], s89 offen nt lds
    s_add_u32 m0, s86, 154112
    s_mov_b32 s89, 131072
    buffer_load_dwordx4 v10, s[40:43], s89 offen nt lds
    s_add_u32 m0, s86, 141824
    s_mov_b32 s89, 196608
    buffer_load_dwordx4 v10, s[36:39], s89 offen nt lds
    s_add_u32 m0, s86, 158208
    s_mov_b32 s89, 196608
    buffer_load_dwordx4 v10, s[40:43], s89 offen nt lds
    s_mov_b64 exec, 0xff
    s_lshl_b32 s82, s3, 7
    s_add_u32 m0, s82, 129024
    s_mov_b32 s89, 0
    buffer_load_dwordx4 v11, s[36:39], s89 offen nt lds
    s_lshl_b32 s83, s74, 9
    s_add_u32 s83, s83, s82
    s_and_b32 s89, s3, 2
    s_lshl_b32 s89, s89, 3
    s_add_u32 s82, s82, s89
    s_add_u32 m0, s82, 162816
    s_add_u32 s89, s83, 0
    buffer_load_dwordx4 v15, s[44:47], s89 offen  lds
    s_mov_b64 exec, -1
    s_add_u32 s97, s98, s0
    s_lshr_b64 s[0:1], s[0:1], 4
    s_and_b32 s97, s97, 15
    s_add_u32 m0, s87, 36864
    s_lshl_b32 s97, s97, 7
    buffer_load_dwordx4 v240, s[28:31], s97 offen offset:0  lds
    buffer_load_dwordx4 v241, s[28:31], s97 offen offset:1024  lds
    buffer_load_dwordx4 v242, s[28:31], s97 offen offset:2048  lds
    buffer_load_dwordx4 v243, s[28:31], s97 offen offset:3072  lds
    s_add_u32 m0, s88, 36864
    s_mov_b64 exec, 0xffffffff
    buffer_load_dwordx4 v3, s[28:31], s97 offen offset:0  lds
    s_mov_b64 exec, -1
    s_waitcnt vmcnt(21)
    s_barrier
    s_mul_i32 s16, s97, 3072
    s_add_u32 m0, s60, 49152
    s_add_u32 s99, s16, s62
    buffer_load_dwordx4 v244, s[32:35], s99 offen offset:0  lds
    buffer_load_dwordx4 v245, s[32:35], s99 offen offset:1024  lds
    buffer_load_dwordx4 v246, s[32:35], s99 offen offset:2048  lds
    s_add_u32 m0, s61, 61440
    s_add_u32 s16, s16, s63
    buffer_load_dwordx4 v244, s[32:35], s16 offen offset:0  lds
    buffer_load_dwordx4 v245, s[32:35], s16 offen offset:1024  lds
    buffer_load_dwordx4 v246, s[32:35], s16 offen offset:2048  lds
    s_add_u32 s97, s98, s0
    s_lshr_b64 s[0:1], s[0:1], 4
    s_and_b32 s97, s97, 15
    s_add_u32 m0, s87, 0
    s_lshl_b32 s97, s97, 7
    buffer_load_dwordx4 v240, s[28:31], s97 offen offset:0  lds
    buffer_load_dwordx4 v241, s[28:31], s97 offen offset:1024  lds
    buffer_load_dwordx4 v242, s[28:31], s97 offen offset:2048  lds
    buffer_load_dwordx4 v243, s[28:31], s97 offen offset:3072  lds
    s_add_u32 m0, s88, 0
    s_mov_b64 exec, 0xffffffff
    buffer_load_dwordx4 v3, s[28:31], s97 offen offset:0  lds
    s_mov_b64 exec, -1
    s_waitcnt vmcnt(11)
    s_barrier
    s_mul_i32 s16, s97, 3072
    s_add_u32 m0, s60, 0
    s_add_u32 s99, s16, s62
    buffer_load_dwordx4 v244, s[32:35], s99 offen offset:0  lds
    ds_read_b128 v[84:87], v35 offset:0
    ds_read_b128 v[88:91], v35 offset:16
    buffer_load_dwordx4 v245, s[32:35], s99 offen offset:1024  lds
    ds_read_b64 v[40:41], v16 offset:0
    ds_read_b64 v[42:43], v231 offset:256
    buffer_load_dwordx4 v246, s[32:35], s99 offen offset:2048  lds
    ds_read_b64 v[44:45], v16 offset:256
    ds_read_b64 v[46:47], v16 offset:512
    s_add_u32 m0, s61, 12288
    s_add_u32 s16, s16, s63
    buffer_load_dwordx4 v244, s[32:35], s16 offen offset:0  lds
    ds_read_b64 v[48:49], v231 offset:512
    ds_read_b64 v[50:51], v16 offset:768
    buffer_load_dwordx4 v245, s[32:35], s16 offen offset:1024  lds
    ds_read_b64 v[52:53], v231 offset:768
    ds_read_b64 v[54:55], v16 offset:1024
    buffer_load_dwordx4 v246, s[32:35], s16 offen offset:2048  lds
    ds_read_b64 v[56:57], v231 offset:1024
    ds_read_b64 v[58:59], v16 offset:1280
    s_add_u32 s97, s98, s0
    s_lshr_b64 s[0:1], s[0:1], 4
    s_and_b32 s97, s97, 15
    s_add_u32 m0, s87, 18432
    s_lshl_b32 s97, s97, 7
    buffer_load_dwordx4 v240, s[28:31], s97 offen offset:0  lds
    ds_read_b64 v[60:61], v231 offset:1280
    ds_read_b64 v[68:69], v16 offset:16896
    buffer_load_dwordx4 v241, s[28:31], s97 offen offset:1024  lds
    ds_read_b64 v[70:71], v231 offset:16896
    ds_read_b64 v[72:73], v16 offset:17152
    buffer_load_dwordx4 v242, s[28:31], s97 offen offset:2048  lds
    ds_read_b64 v[74:75], v231 offset:17152
    ds_read_b64 v[76:77], v16 offset:17408
    buffer_load_dwordx4 v243, s[28:31], s97 offen offset:3072  lds
    ds_read_b64 v[78:79], v231 offset:17408
    ds_read_b64 v[80:81], v16 offset:17664
    s_add_u32 m0, s88, 18432
    s_mov_b64 exec, 0xffffffff
    buffer_load_dwordx4 v3, s[28:31], s97 offen offset:0  lds
    s_mov_b64 exec, -1
    ds_read_b64 v[82:83], v231 offset:17664
    s_waitcnt vmcnt(11)
    s_waitcnt lgkmcnt(0)
    s_barrier
    s_mul_i32 s16, s97, 3072
    s_add_u32 m0, s60, 24576
    s_add_u32 s99, s16, s62
    buffer_load_dwordx4 v244, s[32:35], s99 offen offset:0  lds
    v_lshlrev_b32 v160, 16, v40
    v_lshlrev_b32 v161, 16, v42
    v_lshlrev_b32 v162, 16, v44
    v_lshlrev_b32 v163, 16, v46
    v_lshlrev_b32 v164, 16, v48
    buffer_load_dwordx4 v245, s[32:35], s99 offen offset:1024  lds
    v_lshlrev_b32 v165, 16, v50
    v_lshlrev_b32 v166, 16, v52
    v_lshlrev_b32 v167, 16, v54
    v_lshlrev_b32 v168, 16, v56
    v_lshlrev_b32 v169, 16, v58
    buffer_load_dwordx4 v246, s[32:35], s99 offen offset:2048  lds
    v_lshlrev_b32 v170, 16, v60
    v_lshlrev_b32 v172, 16, v84
    v_and_b32 v173, 0xffff0000, v84
    v_lshlrev_b32 v174, 16, v85
    v_and_b32 v175, 0xffff0000, v85
    s_add_u32 m0, s61, 36864
    s_add_u32 s16, s16, s63
    buffer_load_dwordx4 v244, s[32:35], s16 offen offset:0  lds
    v_lshlrev_b32 v176, 16, v68
    v_lshlrev_b32 v177, 16, v70
    v_lshlrev_b32 v178, 16, v72
    v_lshlrev_b32 v179, 16, v74
    v_lshlrev_b32 v180, 16, v76
    buffer_load_dwordx4 v245, s[32:35], s16 offen offset:1024  lds
    v_lshlrev_b32 v181, 16, v78
    v_lshlrev_b32 v182, 16, v80
    v_lshlrev_b32 v183, 16, v82
    v_mul_f32 v184, v160, v175
    v_mul_f32 v185, v161, v175
    buffer_load_dwordx4 v246, s[32:35], s16 offen offset:2048  lds
    v_mul_f32 v186, v162, v175
    v_mul_f32 v187, v163, v175
    v_mul_f32 v188, v164, v175
    v_mul_f32 v189, v165, v175
    v_mul_f32 v190, v166, v175
    s_add_u32 s97, s98, s0
    s_lshr_b64 s[0:1], s[0:1], 4
    s_and_b32 s97, s97, 15
    s_add_u32 m0, s87, 36864
    s_lshl_b32 s97, s97, 7
    buffer_load_dwordx4 v240, s[28:31], s97 offen offset:0  lds
    v_mul_f32 v191, v167, v175
    v_fmac_f32 v184, v161, v174
    v_fmac_f32 v185, v162, v174
    v_fmac_f32 v186, v163, v174
    v_fmac_f32 v187, v164, v174
    buffer_load_dwordx4 v241, s[28:31], s97 offen offset:1024  lds
    v_fmac_f32 v188, v165, v174
    v_fmac_f32 v189, v166, v174
    v_fmac_f32 v190, v167, v174
    v_fmac_f32 v191, v168, v174
    v_fmac_f32 v184, v162, v173
    buffer_load_dwordx4 v242, s[28:31], s97 offen offset:2048  lds
    v_fmac_f32 v185, v163, v173
    v_fmac_f32 v186, v164, v173
    v_fmac_f32 v187, v165, v173
    v_fmac_f32 v188, v166, v173
    v_fmac_f32 v189, v167, v173
    buffer_load_dwordx4 v243, s[28:31], s97 offen offset:3072  lds
    v_fmac_f32 v190, v168, v173
    v_fmac_f32 v191, v169, v173
    v_fmac_f32 v184, v163, v172
    v_fmac_f32 v185, v164, v172
    v_fmac_f32 v186, v165, v172
    s_add_u32 m0, s88, 36864
    s_mov_b64 exec, 0xffffffff
    buffer_load_dwordx4 v3, s[28:31], s97 offen offset:0  lds
    s_mov_b64 exec, -1
    v_fmac_f32 v187, v166, v172
    v_fmac_f32 v188, v167, v172
    v_fmac_f32 v189, v168, v172
    v_fmac_f32 v190, v169, v172
    v_fmac_f32 v191, v170, v172
    v_mul_f32 v184, v184, v176
    v_mul_f32 v185, v185, v177
    v_mul_f32 v186, v186, v178
    v_mul_f32 v187, v187, v179
    v_mul_f32 v188, v188, v180
    v_mul_f32 v189, v189, v181
    v_mul_f32 v190, v190, v182
    v_mul_f32 v191, v191, v183
    v_cvt_pk_bf16_f32 v100, v191, v190
    v_cvt_pk_bf16_f32 v101, v189, v188
    v_cvt_pk_bf16_f32 v102, v187, v186
    v_cvt_pk_bf16_f32 v103, v185, v184
    s_mov_b32 s89, 0
    buffer_store_dwordx4 v[100:103], v12, s[52:55], s89 offen sc1
    v_and_b32 v160, 0xffff0000, v40
    v_and_b32 v161, 0xffff0000, v42
    v_and_b32 v162, 0xffff0000, v44
    v_and_b32 v163, 0xffff0000, v46
    v_and_b32 v164, 0xffff0000, v48
    v_and_b32 v165, 0xffff0000, v50
    v_and_b32 v166, 0xffff0000, v52
    v_and_b32 v167, 0xffff0000, v54
    v_and_b32 v168, 0xffff0000, v56
    v_and_b32 v169, 0xffff0000, v58
    v_and_b32 v170, 0xffff0000, v60
    v_lshlrev_b32 v172, 16, v86
    v_and_b32 v173, 0xffff0000, v86
    v_lshlrev_b32 v174, 16, v87
    v_and_b32 v175, 0xffff0000, v87
    v_and_b32 v176, 0xffff0000, v68
    v_and_b32 v177, 0xffff0000, v70
    v_and_b32 v178, 0xffff0000, v72
    v_and_b32 v179, 0xffff0000, v74
    v_and_b32 v180, 0xffff0000, v76
    v_and_b32 v181, 0xffff0000, v78
    v_and_b32 v182, 0xffff0000, v80
    v_and_b32 v183, 0xffff0000, v82
    s_waitcnt vmcnt(12)
    s_barrier
    s_mul_i32 s16, s97, 3072
    s_add_u32 m0, s60, 49152
    s_add_u32 s99, s16, s62
    buffer_load_dwordx4 v244, s[32:35], s99 offen offset:0  lds
    v_mul_f32 v184, v160, v175
    v_mul_f32 v185, v161, v175
    v_mul_f32 v186, v162, v175
    v_mul_f32 v187, v163, v175
    v_mul_f32 v188, v164, v175
    buffer_load_dwordx4 v245, s[32:35], s99 offen offset:1024  lds
    v_mul_f32 v189, v165, v175
    v_mul_f32 v190, v166, v175
    v_mul_f32 v191, v167, v175
    v_fmac_f32 v184, v161, v174
    v_fmac_f32 v185, v162, v174
    buffer_load_dwordx4 v246, s[32:35], s99 offen offset:2048  lds
    v_fmac_f32 v186, v163, v174
    v_fmac_f32 v187, v164, v174
    v_fmac_f32 v188, v165, v174
    v_fmac_f32 v189, v166, v174
    v_fmac_f32 v190, v167, v174
    s_add_u32 m0, s61, 61440
    s_add_u32 s16, s16, s63
    buffer_load_dwordx4 v244, s[32:35], s16 offen offset:0  lds
    v_fmac_f32 v191, v168, v174
    v_fmac_f32 v184, v162, v173
    v_fmac_f32 v185, v163, v173
    v_fmac_f32 v186, v164, v173
    v_fmac_f32 v187, v165, v173
    buffer_load_dwordx4 v245, s[32:35], s16 offen offset:1024  lds
    v_fmac_f32 v188, v166, v173
    v_fmac_f32 v189, v167, v173
    v_fmac_f32 v190, v168, v173
    v_fmac_f32 v191, v169, v173
    v_fmac_f32 v184, v163, v172
    buffer_load_dwordx4 v246, s[32:35], s16 offen offset:2048  lds
    v_fmac_f32 v185, v164, v172
    v_fmac_f32 v186, v165, v172
    v_fmac_f32 v187, v166, v172
    v_fmac_f32 v188, v167, v172
    v_fmac_f32 v189, v168, v172
    s_add_u32 s97, s98, s0
    s_lshr_b64 s[0:1], s[0:1], 4
    s_and_b32 s97, s97, 15
    s_add_u32 m0, s87, 0
    s_lshl_b32 s97, s97, 7
    buffer_load_dwordx4 v240, s[28:31], s97 offen offset:0  lds
    v_fmac_f32 v190, v169, v172
    v_fmac_f32 v191, v170, v172
    v_mul_f32 v184, v184, v176
    v_mul_f32 v185, v185, v177
    v_mul_f32 v186, v186, v178
    buffer_load_dwordx4 v241, s[28:31], s97 offen offset:1024  lds
    v_mul_f32 v187, v187, v179
    v_mul_f32 v188, v188, v180
    v_mul_f32 v189, v189, v181
    v_mul_f32 v190, v190, v182
    v_mul_f32 v191, v191, v183
    buffer_load_dwordx4 v242, s[28:31], s97 offen offset:2048  lds
    v_cvt_pk_bf16_f32 v104, v191, v190
    v_cvt_pk_bf16_f32 v105, v189, v188
    v_cvt_pk_bf16_f32 v106, v187, v186
    v_cvt_pk_bf16_f32 v107, v185, v184
    s_mov_b32 s89, 16384
    buffer_store_dwordx4 v[104:107], v12, s[52:55], s89 offen sc1
    buffer_load_dwordx4 v243, s[28:31], s97 offen offset:3072  lds
    v_lshlrev_b32 v160, 16, v41
    v_lshlrev_b32 v161, 16, v43
    v_lshlrev_b32 v162, 16, v45
    v_lshlrev_b32 v163, 16, v47
    v_lshlrev_b32 v164, 16, v49
    s_add_u32 m0, s88, 0
    s_mov_b64 exec, 0xffffffff
    buffer_load_dwordx4 v3, s[28:31], s97 offen offset:0  lds
    s_mov_b64 exec, -1
    v_lshlrev_b32 v165, 16, v51
    v_lshlrev_b32 v166, 16, v53
    v_lshlrev_b32 v167, 16, v55
    v_lshlrev_b32 v168, 16, v57
    v_lshlrev_b32 v169, 16, v59
    v_lshlrev_b32 v170, 16, v61
    v_lshlrev_b32 v172, 16, v88
    v_and_b32 v173, 0xffff0000, v88
    v_lshlrev_b32 v174, 16, v89
    v_and_b32 v175, 0xffff0000, v89
    v_lshlrev_b32 v176, 16, v69
    v_lshlrev_b32 v177, 16, v71
    v_lshlrev_b32 v178, 16, v73
    v_lshlrev_b32 v179, 16, v75
    v_lshlrev_b32 v180, 16, v77
    v_lshlrev_b32 v181, 16, v79
    v_lshlrev_b32 v182, 16, v81
    v_lshlrev_b32 v183, 16, v83
    v_mul_f32 v184, v160, v175
    v_mul_f32 v185, v161, v175
    v_mul_f32 v186, v162, v175
    v_mul_f32 v187, v163, v175
    v_mul_f32 v188, v164, v175
    v_mul_f32 v189, v165, v175
    v_mul_f32 v190, v166, v175
    v_mul_f32 v191, v167, v175
    v_fmac_f32 v184, v161, v174
    v_fmac_f32 v185, v162, v174
    v_fmac_f32 v186, v163, v174
    v_fmac_f32 v187, v164, v174
    v_fmac_f32 v188, v165, v174
    v_fmac_f32 v189, v166, v174
    v_fmac_f32 v190, v167, v174
    v_fmac_f32 v191, v168, v174
    v_fmac_f32 v184, v162, v173
    v_fmac_f32 v185, v163, v173
    v_fmac_f32 v186, v164, v173
    v_fmac_f32 v187, v165, v173
    v_fmac_f32 v188, v166, v173
    v_fmac_f32 v189, v167, v173
    v_fmac_f32 v190, v168, v173
    s_waitcnt vmcnt(13)
    s_barrier
    s_mul_i32 s16, s97, 3072
    s_add_u32 m0, s60, 0
    s_add_u32 s99, s16, s62
    buffer_load_dwordx4 v244, s[32:35], s99 offen offset:0  lds
    v_fmac_f32 v191, v169, v173
    v_fmac_f32 v184, v163, v172
    v_fmac_f32 v185, v164, v172
    v_fmac_f32 v186, v165, v172
    v_fmac_f32 v187, v166, v172
    buffer_load_dwordx4 v245, s[32:35], s99 offen offset:1024  lds
    v_fmac_f32 v188, v167, v172
    v_fmac_f32 v189, v168, v172
    v_fmac_f32 v190, v169, v172
    v_fmac_f32 v191, v170, v172
    v_mul_f32 v184, v184, v176
    buffer_load_dwordx4 v246, s[32:35], s99 offen offset:2048  lds
    v_mul_f32 v185, v185, v177
    v_mul_f32 v186, v186, v178
    v_mul_f32 v187, v187, v179
    v_mul_f32 v188, v188, v180
    v_mul_f32 v189, v189, v181
    s_add_u32 m0, s61, 12288
    s_add_u32 s16, s16, s63
    buffer_load_dwordx4 v244, s[32:35], s16 offen offset:0  lds
    v_mul_f32 v190, v190, v182
    v_mul_f32 v191, v191, v183
    v_cvt_pk_bf16_f32 v108, v191, v190
    v_cvt_pk_bf16_f32 v109, v189, v188
    v_cvt_pk_bf16_f32 v110, v187, v186
    buffer_load_dwordx4 v245, s[32:35], s16 offen offset:1024  lds
    v_cvt_pk_bf16_f32 v111, v185, v184
    s_mov_b32 s89, 32768
    buffer_store_dwordx4 v[108:111], v12, s[52:55], s89 offen sc1
    v_and_b32 v160, 0xffff0000, v41
    v_and_b32 v161, 0xffff0000, v43
    v_and_b32 v162, 0xffff0000, v45
    buffer_load_dwordx4 v246, s[32:35], s16 offen offset:2048  lds
    v_and_b32 v163, 0xffff0000, v47
    v_and_b32 v164, 0xffff0000, v49
    v_and_b32 v165, 0xffff0000, v51
    v_and_b32 v166, 0xffff0000, v53
    v_and_b32 v167, 0xffff0000, v55
    s_add_u32 s97, s98, s0
    s_lshr_b64 s[0:1], s[0:1], 4
    s_and_b32 s97, s97, 15
    s_add_u32 m0, s87, 18432
    s_lshl_b32 s97, s97, 7
    buffer_load_dwordx4 v240, s[28:31], s97 offen offset:0  lds
    v_and_b32 v168, 0xffff0000, v57
    v_and_b32 v169, 0xffff0000, v59
    v_and_b32 v170, 0xffff0000, v61
    v_lshlrev_b32 v172, 16, v90
    v_and_b32 v173, 0xffff0000, v90
    buffer_load_dwordx4 v241, s[28:31], s97 offen offset:1024  lds
    v_lshlrev_b32 v174, 16, v91
    v_and_b32 v175, 0xffff0000, v91
    v_and_b32 v176, 0xffff0000, v69
    v_and_b32 v177, 0xffff0000, v71
    v_and_b32 v178, 0xffff0000, v73
    buffer_load_dwordx4 v242, s[28:31], s97 offen offset:2048  lds
    v_and_b32 v179, 0xffff0000, v75
    v_and_b32 v180, 0xffff0000, v77
    v_and_b32 v181, 0xffff0000, v79
    v_and_b32 v182, 0xffff0000, v81
    v_and_b32 v183, 0xffff0000, v83
    buffer_load_dwordx4 v243, s[28:31], s97 offen offset:3072  lds
    v_mul_f32 v184, v160, v175
    v_mul_f32 v185, v161, v175
    v_mul_f32 v186, v162, v175
    v_mul_f32 v187, v163, v175
    v_mul_f32 v188, v164, v175
    s_add_u32 m0, s88, 18432
    s_mov_b64 exec, 0xffffffff
    buffer_load_dwordx4 v3, s[28:31], s97 offen offset:0  lds
    s_mov_b64 exec, -1
    v_mul_f32 v189, v165, v175
    v_mul_f32 v190, v166, v175
    v_mul_f32 v191, v167, v175
    v_fmac_f32 v184, v161, v174
    v_fmac_f32 v185, v162, v174
    v_fmac_f32 v186, v163, v174
    v_fmac_f32 v187, v164, v174
    v_fmac_f32 v188, v165, v174
    v_fmac_f32 v189, v166, v174
    v_fmac_f32 v190, v167, v174
    v_fmac_f32 v191, v168, v174
    v_fmac_f32 v184, v162, v173
    v_fmac_f32 v185, v163, v173
    v_fmac_f32 v186, v164, v173
    v_fmac_f32 v187, v165, v173
    v_fmac_f32 v188, v166, v173
    v_fmac_f32 v189, v167, v173
    v_fmac_f32 v190, v168, v173
    v_fmac_f32 v191, v169, v173
    v_fmac_f32 v184, v163, v172
    v_fmac_f32 v185, v164, v172
    v_fmac_f32 v186, v165, v172
    v_fmac_f32 v187, v166, v172
    v_fmac_f32 v188, v167, v172
    v_fmac_f32 v189, v168, v172
    v_fmac_f32 v190, v169, v172
    v_fmac_f32 v191, v170, v172
    v_mul_f32 v184, v184, v176
    v_mul_f32 v185, v185, v177
    v_mul_f32 v186, v186, v178
    v_mul_f32 v187, v187, v179
    v_mul_f32 v188, v188, v180
    v_mul_f32 v189, v189, v181
    v_mul_f32 v190, v190, v182
    v_mul_f32 v191, v191, v183
    v_cvt_pk_bf16_f32 v112, v191, v190
    v_cvt_pk_bf16_f32 v113, v189, v188
    v_cvt_pk_bf16_f32 v114, v187, v186
    v_cvt_pk_bf16_f32 v115, v185, v184
    s_mov_b32 s89, 49152
    buffer_store_dwordx4 v[112:115], v12, s[52:55], s89 offen sc1
    s_waitcnt vmcnt(13)
    s_barrier
    s_mul_i32 s16, s97, 3072
    s_add_u32 m0, s60, 24576
    s_add_u32 s99, s16, s62
    buffer_load_dwordx4 v244, s[32:35], s99 offen offset:0  lds
    s_mov_b32 s68, s24
    s_mov_b32 s69, s25
    s_mov_b32 s70, 0x100
    s_mov_b32 s71, 0x20000
    buffer_load_dwordx4 v245, s[32:35], s99 offen offset:1024  lds
    v_lshrrev_b32 v6, 5, v0
    v_and_b32 v7, 3, v0
    s_lshr_b32 s78, s90, 1
    s_lshl_b32 s78, s78, 2
    buffer_load_dwordx4 v246, s[32:35], s99 offen offset:2048  lds
    s_load_dword s92, s[14:15], s78
    v_bfe_u32 v5, v0, 2, 2
    v_lshlrev_b32 v5, 1, v5
    s_add_u32 m0, s61, 36864
    s_add_u32 s16, s16, s63
    buffer_load_dwordx4 v244, s[32:35], s16 offen offset:0  lds
    v_lshl_add_u32 v5, v6, 3, v5
    v_bfe_u32 v8, v0, 4, 1
    v_add_u32 v5, v5, v8
    s_and_b32 s78, s3, 1
    buffer_load_dwordx4 v245, s[32:35], s16 offen offset:1024  lds
    s_lshl_b32 s78, s78, 1
    v_add_u32 v8, s78, v6
    v_xor_b32 v8, v8, v7
    v_lshlrev_b32 v8, 4, v8
    buffer_load_dwordx4 v246, s[32:35], s16 offen offset:2048  lds
    v_lshl_add_u32 v5, v5, 6, v8
    v_add_u32 v14, s86, v5
    v_mov_b32 v18, 162304
    s_add_u32 s97, s98, s0
    s_lshr_b64 s[0:1], s[0:1], 4
    s_and_b32 s97, s97, 15
    s_add_u32 m0, s87, 36864
    s_lshl_b32 s97, s97, 7
    buffer_load_dwordx4 v240, s[28:31], s97 offen offset:0  lds
    v_mov_b32 v19, 1
    v_and_b32 v5, 3, v0
    s_lshl_b32 s78, s74, 4
    s_add_u32 s78, s78, s3
    buffer_load_dwordx4 v241, s[28:31], s97 offen offset:1024  lds
    v_lshl_add_u32 v6, v5, 2, s78
    s_lshr_b32 s78, s76, 3
    s_lshl_b32 s79, s3, 1
    s_add_u32 s78, s78, s79
    buffer_load_dwordx4 v242, s[28:31], s97 offen offset:2048  lds
    s_xor_b32 s78, s78, 3
    s_lshl_b32 s78, s78, 5
    s_add_u32 s79, s76, 5
    buffer_load_dwordx4 v243, s[28:31], s97 offen offset:3072  lds
    s_and_b32 s79, s79, 7
    s_lshl_b32 s79, s79, 1
    s_add_u32 s78, s78, s79
    v_mul_u32_u24 v7, 9, v5
    s_add_u32 m0, s88, 36864
    s_mov_b64 exec, 0xffffffff
    buffer_load_dwordx4 v3, s[28:31], s97 offen offset:0  lds
    s_mov_b64 exec, -1
    v_and_b32 v7, 17, v7
    v_add_u32 v7, s78, v7
    v_and_b32 v8, 4, v0
    s_waitcnt vmcnt(12)
    s_waitcnt vmcnt(11)
    s_barrier
    s_mul_i32 s16, s97, 3072
    s_add_u32 m0, s60, 49152
    s_add_u32 s99, s16, s62
    buffer_load_dwordx4 v244, s[32:35], s99 offen offset:0  lds
    v_cmp_eq_u32 vcc, 0, v8
    s_nop 1
    v_cndmask_b32 v6, v7, v6, vcc
    v_and_b32 v33, 0xf0, v6
    v_lshlrev_b32 v34, 8, v6
    buffer_load_dwordx4 v245, s[32:35], s99 offen offset:1024  lds
    v_add_u32 v34, 12582912, v34
    v_and_b32 v5, 15, v0
    v_lshrrev_b32 v6, 4, v0
    v_add_u32 v7, 9, v5
    buffer_load_dwordx4 v246, s[32:35], s99 offen offset:2048  lds
    v_and_b32 v8, 1, v7
    v_mul_u32_u24 v8, 4160, v8
    v_lshrrev_b32 v7, 1, v7
    s_add_u32 m0, s61, 61440
    s_add_u32 s16, s16, s63
    buffer_load_dwordx4 v244, s[32:35], s16 offen offset:0  lds
    v_lshl_add_u32 v8, v7, 2, v8
    v_lshlrev_b32 v7, 4, v6
    v_sub_u32 v8, v8, v7
    s_add_u32 s78, s94, 32
    buffer_load_dwordx4 v245, s[32:35], s16 offen offset:1024  lds
    v_add_u32 v21, s78, v8
    v_add_u32 v22, 1024, v21
    v_add_u32 v23, 2048, v21
    v_add_u32 v24, 3072, v21
    buffer_load_dwordx4 v246, s[32:35], s16 offen offset:2048  lds
    v_lshl_add_u32 v7, v5, 1, v6
    v_add_u32 v7, 30, v7
    v_and_b32 v8, 1, v7
    s_add_u32 s97, s98, s0
    s_lshr_b64 s[0:1], s[0:1], 4
    s_and_b32 s97, s97, 15
    s_add_u32 m0, s87, 0
    s_lshl_b32 s97, s97, 7
    buffer_load_dwordx4 v240, s[28:31], s97 offen offset:0  lds
    v_bfe_u32 v136, v7, 1, 2
    v_lshl_add_u32 v136, v8, 2, v136
    v_lshlrev_b32 v136, 6, v136
    v_lshrrev_b32 v7, 3, v7
    buffer_load_dwordx4 v241, s[28:31], s97 offen offset:1024  lds
    v_lshl_add_u32 v136, v7, 9, v136
    v_bitop3_b32 v8, v7, 3, s3 bitop3:0x6a
    v_lshl_add_u32 v25, v8, 4, v136
    v_add_u32 v25, 92160, v25
    buffer_load_dwordx4 v242, s[28:31], s97 offen offset:2048  lds
    v_subrev_u32 v7, 1, v7
    v_bitop3_b32 v8, v7, 3, s3 bitop3:0x6a
    v_lshl_add_u32 v27, v8, 4, v136
    buffer_load_dwordx4 v243, s[28:31], s97 offen offset:3072  lds
    v_add_u32 v27, 91648, v27
    v_subrev_u32 v7, 1, v7
    v_bitop3_b32 v8, v7, 3, s3 bitop3:0x6a
    v_lshl_add_u32 v29, v8, 4, v136
    s_add_u32 m0, s88, 0
    s_mov_b64 exec, 0xffffffff
    buffer_load_dwordx4 v3, s[28:31], s97 offen offset:0  lds
    s_mov_b64 exec, -1
    v_add_u32 v29, 91136, v29
    v_subrev_u32 v7, 1, v7
    v_bitop3_b32 v8, v7, 3, s3 bitop3:0x6a
    s_waitcnt vmcnt(11)
    s_barrier
    s_mul_i32 s16, s97, 3072
    s_add_u32 m0, s60, 0
    s_add_u32 s99, s16, s62
    buffer_load_dwordx4 v244, s[32:35], s99 offen offset:0  lds
    v_lshl_add_u32 v31, v8, 4, v136
    v_add_u32 v31, 90624, v31
    v_lshl_add_u32 v7, v5, 1, v6
    buffer_load_dwordx4 v245, s[32:35], s99 offen offset:1024  lds
    v_add_u32 v7, 26, v7
    v_and_b32 v8, 1, v7
    v_bfe_u32 v136, v7, 1, 2
    buffer_load_dwordx4 v246, s[32:35], s99 offen offset:2048  lds
    v_lshl_add_u32 v136, v8, 2, v136
    v_lshlrev_b32 v136, 6, v136
    s_add_u32 m0, s61, 12288
    s_add_u32 s16, s16, s63
    buffer_load_dwordx4 v244, s[32:35], s16 offen offset:0  lds
    v_lshrrev_b32 v7, 3, v7
    v_lshl_add_u32 v136, v7, 9, v136
    v_bitop3_b32 v8, v7, 3, s3 bitop3:0x6a
    buffer_load_dwordx4 v245, s[32:35], s16 offen offset:1024  lds
    v_lshl_add_u32 v26, v8, 4, v136
    v_add_u32 v26, 92160, v26
    v_subrev_u32 v7, 1, v7
    buffer_load_dwordx4 v246, s[32:35], s16 offen offset:2048  lds
    v_bitop3_b32 v8, v7, 3, s3 bitop3:0x6a
    v_lshl_add_u32 v28, v8, 4, v136
    s_add_u32 m0, s94, 32
    s_lshl_b32 s89, s90, 12
    buffer_load_dwordx4 v15, s[48:51], s89 offen offset:0 nt lds
    v_add_u32 v28, 91648, v28
    v_subrev_u32 v7, 1, v7
    v_bitop3_b32 v8, v7, 3, s3 bitop3:0x6a
    s_add_u32 m0, s94, 32
    s_lshl_b32 s89, s90, 12
    buffer_load_dwordx4 v15, s[48:51], s89 offen offset:1024 nt lds
    v_lshl_add_u32 v30, v8, 4, v136
    v_add_u32 v30, 91136, v30
    v_subrev_u32 v7, 1, v7
    s_add_u32 m0, s94, 32
    s_lshl_b32 s89, s90, 12
    buffer_load_dwordx4 v15, s[48:51], s89 offen offset:2048 nt lds
    v_bitop3_b32 v8, v7, 3, s3 bitop3:0x6a
    v_lshl_add_u32 v32, v8, 4, v136
    s_add_u32 m0, s94, 32
    s_lshl_b32 s89, s90, 12
    buffer_load_dwordx4 v15, s[48:51], s89 offen offset:3072 nt lds
    v_add_u32 v32, 90624, v32
    v_lshrrev_b32 v7, 1, v6
    v_lshl_add_u32 v7, v5, 1, v7
    s_add_u32 s97, s98, s0
    s_lshr_b64 s[0:1], s[0:1], 4
    s_and_b32 s97, s97, 15
    s_add_u32 m0, s87, 18432
    s_lshl_b32 s97, s97, 7
    buffer_load_dwordx4 v240, s[28:31], s97 offen offset:0  lds
    v_add_u32 v7, 32, v7
    v_and_b32 v8, 1, v7
    v_bfe_u32 v136, v7, 1, 2
    buffer_load_dwordx4 v241, s[28:31], s97 offen offset:1024  lds
    v_lshl_add_u32 v136, v8, 2, v136
    v_lshlrev_b32 v136, 6, v136
    buffer_load_dwordx4 v242, s[28:31], s97 offen offset:2048  lds
    v_lshrrev_b32 v7, 3, v7
    v_lshl_add_u32 v136, v7, 9, v136
    v_bitop3_b32 v8, v7, 3, s3 bitop3:0x6a
    buffer_load_dwordx4 v243, s[28:31], s97 offen offset:3072  lds
    v_lshl_add_u32 v20, v8, 4, v136
    v_add_u32 v20, 92160, v20
    v_and_b32 v8, 1, v6
    s_add_u32 m0, s88, 18432
    s_mov_b64 exec, 0xffffffff
    buffer_load_dwordx4 v3, s[28:31], s97 offen offset:0  lds
    s_mov_b64 exec, -1
    v_xor_b32 v8, 1, v8
    v_lshl_add_u32 v20, v8, 3, v20
    s_waitcnt vmcnt(15)
    s_barrier
    s_mul_i32 s16, s97, 3072
    s_add_u32 m0, s60, 24576
    s_add_u32 s99, s16, s62
    buffer_load_dwordx4 v244, s[32:35], s99 offen offset:0  lds
    s_waitcnt lgkmcnt(0)
    s_and_b32 s78, s92, 0xffff0000
    s_lshl_b32 s92, s92, 16
    buffer_load_dwordx4 v245, s[32:35], s99 offen offset:1024  lds
    s_bitcmp1_b32 s90, 0
    s_cselect_b32 s92, s78, s92
    v_lshlrev_b32 v7, 3, v6
    v_sub_u32 v7, v7, v5
    buffer_load_dwordx4 v246, s[32:35], s99 offen offset:2048  lds
    v_subrev_u32 v7, 9, v7
    v_and_b32 v8, 1, v7
    v_xor_b32 v8, 1, v8
    s_add_u32 m0, s61, 36864
    s_add_u32 s16, s16, s63
    buffer_load_dwordx4 v244, s[32:35], s16 offen offset:0  lds
    v_lshlrev_b32 v8, 4, v8
    v_lshrrev_b32 v8, v8, s92
    v_ashrrev_i32 v7, 1, v7
    buffer_load_dwordx4 v245, s[32:35], s16 offen offset:1024  lds
    v_cmp_eq_u32 vcc, 0, v7
    s_nop 1
    v_cndmask_b32 v236, 0, v8, vcc
    v_cmp_eq_u32 vcc, 1, v7
    buffer_load_dwordx4 v246, s[32:35], s16 offen offset:2048  lds
    s_nop 0
    v_cndmask_b32 v237, 0, v8, vcc
    v_cmp_eq_u32 vcc, 2, v7
    s_nop 1
    v_cndmask_b32 v238, 0, v8, vcc
    s_add_u32 s97, s98, s0
    s_lshr_b64 s[0:1], s[0:1], 4
    s_and_b32 s97, s97, 15
    s_add_u32 m0, s87, 36864
    s_lshl_b32 s97, s97, 7
    buffer_load_dwordx4 v240, s[28:31], s97 offen offset:0  lds
    v_cmp_eq_u32 vcc, 3, v7
    s_nop 1
    v_cndmask_b32 v239, 0, v8, vcc
    s_and_b32 s78, s77, 7
    s_mov_b32 s95, 0x76543210
    s_and_b32 s78, s76, 3
    s_mul_i32 s78, s78, 0x22222222
    s_add_u32 s95, s95, s78
    s_bfe_u32 s17, s95, 0x30000
    s_lshl_b32 s17, s17, 18
    s_bfe_u32 s18, s95, 0x30004
    s_lshl_b32 s18, s18, 18
    s_bfe_u32 s100, s95, 0x3001c
    s_lshl_b32 s100, s100, 18
    s_bfe_u32 s95, s95, 0x30018
    s_lshl_b32 s95, s95, 18
    buffer_load_dwordx4 v241, s[28:31], s97 offen offset:1024  lds
    v_lshrrev_b32 v136, 4, v0
    v_lshlrev_b32 v136, 1, v136
    v_and_b32 v137, 7, v0
    buffer_load_dwordx4 v242, s[28:31], s97 offen offset:2048  lds
    v_xor_b32 v136, v136, v137
    v_lshlrev_b32 v136, 4, v136
    v_lshrrev_b32 v137, 3, v0
    buffer_load_dwordx4 v243, s[28:31], s97 offen offset:3072  lds
    v_lshl_add_u32 v136, v137, 11, v136
    s_lshl_b32 s78, s77, 7
    s_lshl_b32 s79, s3, 14
    s_add_u32 m0, s88, 36864
    s_mov_b64 exec, 0xffffffff
    buffer_load_dwordx4 v3, s[28:31], s97 offen offset:0  lds
    s_mov_b64 exec, -1
    s_add_u32 s78, s78, s79
    v_add_u32 v17, s78, v136
    s_waitcnt vmcnt(11)
    s_barrier
    s_mul_i32 s16, s97, 3072
    s_add_u32 m0, s60, 49152
    s_add_u32 s99, s16, s62
    buffer_load_dwordx4 v244, s[32:35], s99 offen offset:0  lds
    v_add_u32 v5, s94, v15
    ds_read_b128 v[140:143], v5 offset:32
    ds_read_b32 v156, v5 offset:48
    ds_read_b128 v[144:147], v5 offset:1056
    buffer_load_dwordx4 v245, s[32:35], s99 offen offset:1024  lds
    ds_read_b32 v157, v5 offset:1072
    ds_read_b128 v[148:151], v5 offset:2080
    ds_read_b32 v158, v5 offset:2096
    ds_read_b128 v[152:155], v5 offset:3104
    buffer_load_dwordx4 v246, s[32:35], s99 offen offset:2048  lds
    ds_read_b32 v159, v5 offset:3120
    v_lshrrev_b32 v6, 3, v0
    v_mul_u32_u24 v6, 4160, v6
    s_add_u32 m0, s61, 61440
    s_add_u32 s16, s16, s63
    buffer_load_dwordx4 v244, s[32:35], s16 offen offset:0  lds
    v_and_b32 v7, 7, v0
    v_lshl_add_u32 v6, v7, 2, v6
    v_add_u32 v6, s94, v6
    v_mov_b32 v7, 0
    buffer_load_dwordx4 v245, s[32:35], s16 offen offset:1024  lds
    s_waitcnt lgkmcnt(0)
    v_readfirstlane_b32 s93, v140
    s_nop 0
    s_lshl_b32 s93, s93, 16
    s_nop 1
    v_writelane_b32 v7, s93, 15
    buffer_load_dwordx4 v246, s[32:35], s16 offen offset:2048  lds
    v_alignbit_b32 v140, v141, v140, 16
    v_alignbit_b32 v141, v142, v141, 16
    v_alignbit_b32 v142, v143, v142, 16
    s_add_u32 s97, s98, s0
    s_lshr_b64 s[0:1], s[0:1], 4
    s_and_b32 s97, s97, 15
    s_add_u32 m0, s87, 0
    s_lshl_b32 s97, s97, 7
    buffer_load_dwordx4 v240, s[28:31], s97 offen offset:0  lds
    v_alignbit_b32 v143, v156, v143, 16
    v_alignbit_b32 v144, v145, v144, 16
    v_alignbit_b32 v145, v146, v145, 16
    v_alignbit_b32 v146, v147, v146, 16
    buffer_load_dwordx4 v241, s[28:31], s97 offen offset:1024  lds
    v_alignbit_b32 v147, v157, v147, 16
    v_alignbit_b32 v148, v149, v148, 16
    v_alignbit_b32 v149, v150, v149, 16
    v_alignbit_b32 v150, v151, v150, 16
    buffer_load_dwordx4 v242, s[28:31], s97 offen offset:2048  lds
    v_alignbit_b32 v151, v158, v151, 16
    v_alignbit_b32 v152, v153, v152, 16
    v_alignbit_b32 v153, v154, v153, 16
    buffer_load_dwordx4 v243, s[28:31], s97 offen offset:3072  lds
    v_alignbit_b32 v154, v155, v154, 16
    v_alignbit_b32 v155, v159, v155, 16
    v_lshlrev_b32 v8, 3, v0
    s_add_u32 s78, s88, 18432
    s_add_u32 m0, s88, 0
    s_mov_b64 exec, 0xffffffff
    buffer_load_dwordx4 v3, s[28:31], s97 offen offset:0  lds
    s_mov_b64 exec, -1
    v_add_u32 v8, s78, v8
    v_mov_b32 v156, 0
    v_mov_b32 v157, 0
    s_waitcnt vmcnt(11)
    s_barrier
    s_mul_i32 s16, s97, 3072
    s_add_u32 m0, s60, 0
    s_add_u32 s99, s16, s62
    buffer_load_dwordx4 v244, s[32:35], s99 offen offset:0  lds
    buffer_load_dwordx4 v245, s[32:35], s99 offen offset:1024  lds
    buffer_load_dwordx4 v246, s[32:35], s99 offen offset:2048  lds
    s_add_u32 m0, s61, 12288
    s_add_u32 s16, s16, s63
    buffer_load_dwordx4 v244, s[32:35], s16 offen offset:0  lds
    buffer_load_dwordx4 v245, s[32:35], s16 offen offset:1024  lds
    buffer_load_dwordx4 v246, s[32:35], s16 offen offset:2048  lds
    s_mov_b64 exec, 0xff
    buffer_load_dword v136, v33, s[68:71], 0 offen sc1
    buffer_load_dword v137, v34, s[52:55], 0 offen sc1
    s_mov_b64 exec, -1
    buffer_load_dwordx4 v[212:215], v9, s[56:59], 0 offen offset:0 nt
    buffer_load_dwordx4 v[216:219], v9, s[56:59], 0 offen offset:2048 nt
    buffer_load_dwordx4 v[220:223], v9, s[56:59], s96 offen offset:0 nt
    buffer_load_dwordx4 v[224:227], v9, s[56:59], s96 offen offset:2048 nt
    s_waitcnt vmcnt(12)
    s_waitcnt vmcnt(6)
    s_barrier
    s_waitcnt vmcnt(4)
    s_branch LA_j
LA_c3:
    s_waitcnt vmcnt(8)
    s_barrier
    buffer_load_dwordx4 v242, s[28:31], s97 offen offset:2048  lds
    buffer_load_dwordx4 v243, s[28:31], s97 offen offset:3072  lds
    s_add_u32 m0, s88, 36864
    s_mov_b64 exec, 0xffffffff
    buffer_load_dwordx4 v3, s[28:31], s97 offen offset:0  lds
    s_mov_b64 exec, -1
    s_mul_i32 s16, s97, 3072
    s_add_u32 m0, s60, 49152
    s_add_u32 s99, s16, s62
    buffer_load_dwordx4 v244, s[32:35], s99 offen offset:0  lds
    buffer_load_dwordx4 v245, s[32:35], s99 offen offset:1024  lds
    buffer_load_dwordx4 v246, s[32:35], s99 offen offset:2048  lds
    s_add_u32 m0, s61, 61440
    s_add_u32 s16, s16, s63
    buffer_load_dwordx4 v244, s[32:35], s16 offen offset:0  lds
    buffer_load_dwordx4 v245, s[32:35], s16 offen offset:1024  lds
    buffer_load_dwordx4 v246, s[32:35], s16 offen offset:2048  lds
    s_add_u32 s97, s98, s0
    s_lshr_b64 s[0:1], s[0:1], 4
    s_and_b32 s97, s97, 15
    s_add_u32 m0, s87, 0
    s_lshl_b32 s97, s97, 7
    buffer_load_dwordx4 v240, s[28:31], s97 offen offset:0  lds
    buffer_load_dwordx4 v241, s[28:31], s97 offen offset:1024  lds
    buffer_load_dwordx4 v242, s[28:31], s97 offen offset:2048  lds
    buffer_load_dwordx4 v243, s[28:31], s97 offen offset:3072  lds
    s_add_u32 m0, s88, 0
    s_mov_b64 exec, 0xffffffff
    buffer_load_dwordx4 v3, s[28:31], s97 offen offset:0  lds
    s_mov_b64 exec, -1
    s_waitcnt vmcnt(11)
    s_barrier
    s_mul_i32 s16, s97, 3072
    s_add_u32 m0, s60, 0
    s_add_u32 s99, s16, s62
    buffer_load_dwordx4 v244, s[32:35], s99 offen offset:0  lds
    buffer_load_dwordx4 v245, s[32:35], s99 offen offset:1024  lds
    buffer_load_dwordx4 v246, s[32:35], s99 offen offset:2048  lds
    s_add_u32 m0, s61, 12288
    s_add_u32 s16, s16, s63
    buffer_load_dwordx4 v244, s[32:35], s16 offen offset:0  lds
    buffer_load_dwordx4 v245, s[32:35], s16 offen offset:1024  lds
    buffer_load_dwordx4 v246, s[32:35], s16 offen offset:2048  lds
    s_add_u32 s97, s98, s0
    s_lshr_b64 s[0:1], s[0:1], 4
    s_and_b32 s97, s97, 15
    s_add_u32 m0, s87, 18432
    s_lshl_b32 s97, s97, 7
    buffer_load_dwordx4 v240, s[28:31], s97 offen offset:0  lds
    buffer_load_dwordx4 v241, s[28:31], s97 offen offset:1024  lds
    buffer_load_dwordx4 v242, s[28:31], s97 offen offset:2048  lds
    buffer_load_dwordx4 v243, s[28:31], s97 offen offset:3072  lds
    s_add_u32 m0, s88, 18432
    s_mov_b64 exec, 0xffffffff
    buffer_load_dwordx4 v3, s[28:31], s97 offen offset:0  lds
    s_mov_b64 exec, -1
    s_waitcnt vmcnt(11)
    s_barrier
    s_mul_i32 s16, s97, 3072
    s_add_u32 m0, s60, 24576
    s_add_u32 s99, s16, s62
    buffer_load_dwordx4 v244, s[32:35], s99 offen offset:0  lds
    buffer_load_dwordx4 v245, s[32:35], s99 offen offset:1024  lds
    buffer_load_dwordx4 v246, s[32:35], s99 offen offset:2048  lds
    s_add_u32 m0, s61, 36864
    s_add_u32 s16, s16, s63
    buffer_load_dwordx4 v244, s[32:35], s16 offen offset:0  lds
    buffer_load_dwordx4 v245, s[32:35], s16 offen offset:1024  lds
    buffer_load_dwordx4 v246, s[32:35], s16 offen offset:2048  lds
    s_add_u32 m0, s86, 129536
    s_mov_b32 s89, 0
    buffer_load_dwordx4 v10, s[36:39], s89 offen nt lds
    s_add_u32 m0, s86, 145920
    s_mov_b32 s89, 0
    buffer_load_dwordx4 v10, s[40:43], s89 offen nt lds
    s_add_u32 m0, s86, 133632
    s_mov_b32 s89, 65536
    buffer_load_dwordx4 v10, s[36:39], s89 offen nt lds
    s_add_u32 m0, s86, 150016
    s_mov_b32 s89, 65536
    buffer_load_dwordx4 v10, s[40:43], s89 offen nt lds
    s_add_u32 m0, s86, 137728
    s_mov_b32 s89, 131072
    buffer_load_dwordx4 v10, s[36:39], s89 offen nt lds
    s_add_u32 m0, s86, 154112
    s_mov_b32 s89, 131072
    buffer_load_dwordx4 v10, s[40:43], s89 offen nt lds
    s_add_u32 m0, s86, 141824
    s_mov_b32 s89, 196608
    buffer_load_dwordx4 v10, s[36:39], s89 offen nt lds
    s_add_u32 m0, s86, 158208
    s_mov_b32 s89, 196608
    buffer_load_dwordx4 v10, s[40:43], s89 offen nt lds
    s_mov_b64 exec, 0xff
    s_lshl_b32 s82, s3, 7
    s_add_u32 m0, s82, 129024
    s_mov_b32 s89, 0
    buffer_load_dwordx4 v11, s[36:39], s89 offen nt lds
    s_lshl_b32 s83, s74, 9
    s_add_u32 s83, s83, s82
    s_and_b32 s89, s3, 2
    s_lshl_b32 s89, s89, 3
    s_add_u32 s82, s82, s89
    s_add_u32 m0, s82, 162816
    s_add_u32 s89, s83, 0
    buffer_load_dwordx4 v15, s[44:47], s89 offen  lds
    s_mov_b64 exec, -1
    s_add_u32 s97, s98, s0
    s_lshr_b64 s[0:1], s[0:1], 4
    s_and_b32 s97, s97, 15
    s_add_u32 m0, s87, 36864
    s_lshl_b32 s97, s97, 7
    buffer_load_dwordx4 v240, s[28:31], s97 offen offset:0  lds
    buffer_load_dwordx4 v241, s[28:31], s97 offen offset:1024  lds
    buffer_load_dwordx4 v242, s[28:31], s97 offen offset:2048  lds
    buffer_load_dwordx4 v243, s[28:31], s97 offen offset:3072  lds
    s_add_u32 m0, s88, 36864
    s_mov_b64 exec, 0xffffffff
    buffer_load_dwordx4 v3, s[28:31], s97 offen offset:0  lds
    s_mov_b64 exec, -1
    s_waitcnt vmcnt(21)
    s_barrier
    s_mul_i32 s16, s97, 3072
    s_add_u32 m0, s60, 49152
    s_add_u32 s99, s16, s62
    buffer_load_dwordx4 v244, s[32:35], s99 offen offset:0  lds
    buffer_load_dwordx4 v245, s[32:35], s99 offen offset:1024  lds
    buffer_load_dwordx4 v246, s[32:35], s99 offen offset:2048  lds
    s_add_u32 m0, s61, 61440
    s_add_u32 s16, s16, s63
    buffer_load_dwordx4 v244, s[32:35], s16 offen offset:0  lds
    buffer_load_dwordx4 v245, s[32:35], s16 offen offset:1024  lds
    buffer_load_dwordx4 v246, s[32:35], s16 offen offset:2048  lds
    s_add_u32 s97, s98, s0
    s_lshr_b64 s[0:1], s[0:1], 4
    s_and_b32 s97, s97, 15
    s_add_u32 m0, s87, 0
    s_lshl_b32 s97, s97, 7
    buffer_load_dwordx4 v240, s[28:31], s97 offen offset:0  lds
    buffer_load_dwordx4 v241, s[28:31], s97 offen offset:1024  lds
    buffer_load_dwordx4 v242, s[28:31], s97 offen offset:2048  lds
    buffer_load_dwordx4 v243, s[28:31], s97 offen offset:3072  lds
    s_add_u32 m0, s88, 0
    s_mov_b64 exec, 0xffffffff
    buffer_load_dwordx4 v3, s[28:31], s97 offen offset:0  lds
    s_mov_b64 exec, -1
    s_waitcnt vmcnt(11)
    s_barrier
    s_mul_i32 s16, s97, 3072
    s_add_u32 m0, s60, 0
    s_add_u32 s99, s16, s62
    buffer_load_dwordx4 v244, s[32:35], s99 offen offset:0  lds
    ds_read_b128 v[84:87], v35 offset:0
    ds_read_b128 v[88:91], v35 offset:16
    buffer_load_dwordx4 v245, s[32:35], s99 offen offset:1024  lds
    ds_read_b64 v[40:41], v16 offset:0
    ds_read_b64 v[42:43], v231 offset:256
    buffer_load_dwordx4 v246, s[32:35], s99 offen offset:2048  lds
    ds_read_b64 v[44:45], v16 offset:256
    ds_read_b64 v[46:47], v16 offset:512
    s_add_u32 m0, s61, 12288
    s_add_u32 s16, s16, s63
    buffer_load_dwordx4 v244, s[32:35], s16 offen offset:0  lds
    ds_read_b64 v[48:49], v231 offset:512
    ds_read_b64 v[50:51], v16 offset:768
    buffer_load_dwordx4 v245, s[32:35], s16 offen offset:1024  lds
    ds_read_b64 v[52:53], v231 offset:768
    ds_read_b64 v[54:55], v16 offset:1024
    buffer_load_dwordx4 v246, s[32:35], s16 offen offset:2048  lds
    ds_read_b64 v[56:57], v231 offset:1024
    ds_read_b64 v[58:59], v16 offset:1280
    s_add_u32 s97, s98, s0
    s_lshr_b64 s[0:1], s[0:1], 4
    s_and_b32 s97, s97, 15
    s_add_u32 m0, s87, 18432
    s_lshl_b32 s97, s97, 7
    buffer_load_dwordx4 v240, s[28:31], s97 offen offset:0  lds
    ds_read_b64 v[60:61], v231 offset:1280
    ds_read_b64 v[68:69], v16 offset:16896
    buffer_load_dwordx4 v241, s[28:31], s97 offen offset:1024  lds
    ds_read_b64 v[70:71], v231 offset:16896
    ds_read_b64 v[72:73], v16 offset:17152
    buffer_load_dwordx4 v242, s[28:31], s97 offen offset:2048  lds
    ds_read_b64 v[74:75], v231 offset:17152
    ds_read_b64 v[76:77], v16 offset:17408
    buffer_load_dwordx4 v243, s[28:31], s97 offen offset:3072  lds
    ds_read_b64 v[78:79], v231 offset:17408
    ds_read_b64 v[80:81], v16 offset:17664
    s_add_u32 m0, s88, 18432
    s_mov_b64 exec, 0xffffffff
    buffer_load_dwordx4 v3, s[28:31], s97 offen offset:0  lds
    s_mov_b64 exec, -1
    ds_read_b64 v[82:83], v231 offset:17664
    s_waitcnt vmcnt(11)
    s_waitcnt lgkmcnt(0)
    s_barrier
    s_mul_i32 s16, s97, 3072
    s_add_u32 m0, s60, 24576
    s_add_u32 s99, s16, s62
    buffer_load_dwordx4 v244, s[32:35], s99 offen offset:0  lds
    v_lshlrev_b32 v160, 16, v40
    v_lshlrev_b32 v161, 16, v42
    v_lshlrev_b32 v162, 16, v44
    v_lshlrev_b32 v163, 16, v46
    v_lshlrev_b32 v164, 16, v48
    buffer_load_dwordx4 v245, s[32:35], s99 offen offset:1024  lds
    v_lshlrev_b32 v165, 16, v50
    v_lshlrev_b32 v166, 16, v52
    v_lshlrev_b32 v167, 16, v54
    v_lshlrev_b32 v168, 16, v56
    v_lshlrev_b32 v169, 16, v58
    buffer_load_dwordx4 v246, s[32:35], s99 offen offset:2048  lds
    v_lshlrev_b32 v170, 16, v60
    v_lshlrev_b32 v172, 16, v84
    v_and_b32 v173, 0xffff0000, v84
    v_lshlrev_b32 v174, 16, v85
    v_and_b32 v175, 0xffff0000, v85
    s_add_u32 m0, s61, 36864
    s_add_u32 s16, s16, s63
    buffer_load_dwordx4 v244, s[32:35], s16 offen offset:0  lds
    v_lshlrev_b32 v176, 16, v68
    v_lshlrev_b32 v177, 16, v70
    v_lshlrev_b32 v178, 16, v72
    v_lshlrev_b32 v179, 16, v74
    v_lshlrev_b32 v180, 16, v76
    buffer_load_dwordx4 v245, s[32:35], s16 offen offset:1024  lds
    v_lshlrev_b32 v181, 16, v78
    v_lshlrev_b32 v182, 16, v80
    v_lshlrev_b32 v183, 16, v82
    v_mul_f32 v184, v160, v175
    v_mul_f32 v185, v161, v175
    buffer_load_dwordx4 v246, s[32:35], s16 offen offset:2048  lds
    v_mul_f32 v186, v162, v175
    v_mul_f32 v187, v163, v175
    v_mul_f32 v188, v164, v175
    v_mul_f32 v189, v165, v175
    v_mul_f32 v190, v166, v175
    s_add_u32 s97, s98, s0
    s_lshr_b64 s[0:1], s[0:1], 4
    s_and_b32 s97, s97, 15
    s_add_u32 m0, s87, 36864
    s_lshl_b32 s97, s97, 7
    buffer_load_dwordx4 v240, s[28:31], s97 offen offset:0  lds
    v_mul_f32 v191, v167, v175
    v_fmac_f32 v184, v161, v174
    v_fmac_f32 v185, v162, v174
    v_fmac_f32 v186, v163, v174
    v_fmac_f32 v187, v164, v174
    buffer_load_dwordx4 v241, s[28:31], s97 offen offset:1024  lds
    v_fmac_f32 v188, v165, v174
    v_fmac_f32 v189, v166, v174
    v_fmac_f32 v190, v167, v174
    v_fmac_f32 v191, v168, v174
    v_fmac_f32 v184, v162, v173
    buffer_load_dwordx4 v242, s[28:31], s97 offen offset:2048  lds
    v_fmac_f32 v185, v163, v173
    v_fmac_f32 v186, v164, v173
    v_fmac_f32 v187, v165, v173
    v_fmac_f32 v188, v166, v173
    v_fmac_f32 v189, v167, v173
    buffer_load_dwordx4 v243, s[28:31], s97 offen offset:3072  lds
    v_fmac_f32 v190, v168, v173
    v_fmac_f32 v191, v169, v173
    v_fmac_f32 v184, v163, v172
    v_fmac_f32 v185, v164, v172
    v_fmac_f32 v186, v165, v172
    s_add_u32 m0, s88, 36864
    s_mov_b64 exec, 0xffffffff
    buffer_load_dwordx4 v3, s[28:31], s97 offen offset:0  lds
    s_mov_b64 exec, -1
    v_fmac_f32 v187, v166, v172
    v_fmac_f32 v188, v167, v172
    v_fmac_f32 v189, v168, v172
    v_fmac_f32 v190, v169, v172
    v_fmac_f32 v191, v170, v172
    v_mul_f32 v184, v184, v176
    v_mul_f32 v185, v185, v177
    v_mul_f32 v186, v186, v178
    v_mul_f32 v187, v187, v179
    v_mul_f32 v188, v188, v180
    v_mul_f32 v189, v189, v181
    v_mul_f32 v190, v190, v182
    v_mul_f32 v191, v191, v183
    v_cvt_pk_bf16_f32 v100, v191, v190
    v_cvt_pk_bf16_f32 v101, v189, v188
    v_cvt_pk_bf16_f32 v102, v187, v186
    v_cvt_pk_bf16_f32 v103, v185, v184
    s_mov_b32 s89, 0
    buffer_store_dwordx4 v[100:103], v12, s[52:55], s89 offen sc1
    v_and_b32 v160, 0xffff0000, v40
    v_and_b32 v161, 0xffff0000, v42
    v_and_b32 v162, 0xffff0000, v44
    v_and_b32 v163, 0xffff0000, v46
    v_and_b32 v164, 0xffff0000, v48
    v_and_b32 v165, 0xffff0000, v50
    v_and_b32 v166, 0xffff0000, v52
    v_and_b32 v167, 0xffff0000, v54
    v_and_b32 v168, 0xffff0000, v56
    v_and_b32 v169, 0xffff0000, v58
    v_and_b32 v170, 0xffff0000, v60
    v_lshlrev_b32 v172, 16, v86
    v_and_b32 v173, 0xffff0000, v86
    v_lshlrev_b32 v174, 16, v87
    v_and_b32 v175, 0xffff0000, v87
    v_and_b32 v176, 0xffff0000, v68
    v_and_b32 v177, 0xffff0000, v70
    v_and_b32 v178, 0xffff0000, v72
    v_and_b32 v179, 0xffff0000, v74
    v_and_b32 v180, 0xffff0000, v76
    v_and_b32 v181, 0xffff0000, v78
    v_and_b32 v182, 0xffff0000, v80
    v_and_b32 v183, 0xffff0000, v82
    s_waitcnt vmcnt(12)
    s_barrier
    s_mul_i32 s16, s97, 3072
    s_add_u32 m0, s60, 49152
    s_add_u32 s99, s16, s62
    buffer_load_dwordx4 v244, s[32:35], s99 offen offset:0  lds
    v_mul_f32 v184, v160, v175
    v_mul_f32 v185, v161, v175
    v_mul_f32 v186, v162, v175
    v_mul_f32 v187, v163, v175
    v_mul_f32 v188, v164, v175
    buffer_load_dwordx4 v245, s[32:35], s99 offen offset:1024  lds
    v_mul_f32 v189, v165, v175
    v_mul_f32 v190, v166, v175
    v_mul_f32 v191, v167, v175
    v_fmac_f32 v184, v161, v174
    v_fmac_f32 v185, v162, v174
    buffer_load_dwordx4 v246, s[32:35], s99 offen offset:2048  lds
    v_fmac_f32 v186, v163, v174
    v_fmac_f32 v187, v164, v174
    v_fmac_f32 v188, v165, v174
    v_fmac_f32 v189, v166, v174
    v_fmac_f32 v190, v167, v174
    s_add_u32 m0, s61, 61440
    s_add_u32 s16, s16, s63
    buffer_load_dwordx4 v244, s[32:35], s16 offen offset:0  lds
    v_fmac_f32 v191, v168, v174
    v_fmac_f32 v184, v162, v173
    v_fmac_f32 v185, v163, v173
    v_fmac_f32 v186, v164, v173
    v_fmac_f32 v187, v165, v173
    buffer_load_dwordx4 v245, s[32:35], s16 offen offset:1024  lds
    v_fmac_f32 v188, v166, v173
    v_fmac_f32 v189, v167, v173
    v_fmac_f32 v190, v168, v173
    v_fmac_f32 v191, v169, v173
    v_fmac_f32 v184, v163, v172
    buffer_load_dwordx4 v246, s[32:35], s16 offen offset:2048  lds
    v_fmac_f32 v185, v164, v172
    v_fmac_f32 v186, v165, v172
    v_fmac_f32 v187, v166, v172
    v_fmac_f32 v188, v167, v172
    v_fmac_f32 v189, v168, v172
    s_add_u32 s97, s98, s0
    s_lshr_b64 s[0:1], s[0:1], 4
    s_and_b32 s97, s97, 15
    s_add_u32 m0, s87, 0
    s_lshl_b32 s97, s97, 7
    buffer_load_dwordx4 v240, s[28:31], s97 offen offset:0  lds
    v_fmac_f32 v190, v169, v172
    v_fmac_f32 v191, v170, v172
    v_mul_f32 v184, v184, v176
    v_mul_f32 v185, v185, v177
    v_mul_f32 v186, v186, v178
    buffer_load_dwordx4 v241, s[28:31], s97 offen offset:1024  lds
    v_mul_f32 v187, v187, v179
    v_mul_f32 v188, v188, v180
    v_mul_f32 v189, v189, v181
    v_mul_f32 v190, v190, v182
    v_mul_f32 v191, v191, v183
    buffer_load_dwordx4 v242, s[28:31], s97 offen offset:2048  lds
    v_cvt_pk_bf16_f32 v104, v191, v190
    v_cvt_pk_bf16_f32 v105, v189, v188
    v_cvt_pk_bf16_f32 v106, v187, v186
    v_cvt_pk_bf16_f32 v107, v185, v184
    s_mov_b32 s89, 16384
    buffer_store_dwordx4 v[104:107], v12, s[52:55], s89 offen sc1
    buffer_load_dwordx4 v243, s[28:31], s97 offen offset:3072  lds
    v_lshlrev_b32 v160, 16, v41
    v_lshlrev_b32 v161, 16, v43
    v_lshlrev_b32 v162, 16, v45
    v_lshlrev_b32 v163, 16, v47
    v_lshlrev_b32 v164, 16, v49
    s_add_u32 m0, s88, 0
    s_mov_b64 exec, 0xffffffff
    buffer_load_dwordx4 v3, s[28:31], s97 offen offset:0  lds
    s_mov_b64 exec, -1
    v_lshlrev_b32 v165, 16, v51
    v_lshlrev_b32 v166, 16, v53
    v_lshlrev_b32 v167, 16, v55
    v_lshlrev_b32 v168, 16, v57
    v_lshlrev_b32 v169, 16, v59
    v_lshlrev_b32 v170, 16, v61
    v_lshlrev_b32 v172, 16, v88
    v_and_b32 v173, 0xffff0000, v88
    v_lshlrev_b32 v174, 16, v89
    v_and_b32 v175, 0xffff0000, v89
    v_lshlrev_b32 v176, 16, v69
    v_lshlrev_b32 v177, 16, v71
    v_lshlrev_b32 v178, 16, v73
    v_lshlrev_b32 v179, 16, v75
    v_lshlrev_b32 v180, 16, v77
    v_lshlrev_b32 v181, 16, v79
    v_lshlrev_b32 v182, 16, v81
    v_lshlrev_b32 v183, 16, v83
    v_mul_f32 v184, v160, v175
    v_mul_f32 v185, v161, v175
    v_mul_f32 v186, v162, v175
    v_mul_f32 v187, v163, v175
    v_mul_f32 v188, v164, v175
    v_mul_f32 v189, v165, v175
    v_mul_f32 v190, v166, v175
    v_mul_f32 v191, v167, v175
    v_fmac_f32 v184, v161, v174
    v_fmac_f32 v185, v162, v174
    v_fmac_f32 v186, v163, v174
    v_fmac_f32 v187, v164, v174
    v_fmac_f32 v188, v165, v174
    v_fmac_f32 v189, v166, v174
    v_fmac_f32 v190, v167, v174
    v_fmac_f32 v191, v168, v174
    v_fmac_f32 v184, v162, v173
    v_fmac_f32 v185, v163, v173
    v_fmac_f32 v186, v164, v173
    v_fmac_f32 v187, v165, v173
    v_fmac_f32 v188, v166, v173
    v_fmac_f32 v189, v167, v173
    v_fmac_f32 v190, v168, v173
    s_waitcnt vmcnt(13)
    s_barrier
    s_mul_i32 s16, s97, 3072
    s_add_u32 m0, s60, 0
    s_add_u32 s99, s16, s62
    buffer_load_dwordx4 v244, s[32:35], s99 offen offset:0  lds
    v_fmac_f32 v191, v169, v173
    v_fmac_f32 v184, v163, v172
    v_fmac_f32 v185, v164, v172
    v_fmac_f32 v186, v165, v172
    v_fmac_f32 v187, v166, v172
    buffer_load_dwordx4 v245, s[32:35], s99 offen offset:1024  lds
    v_fmac_f32 v188, v167, v172
    v_fmac_f32 v189, v168, v172
    v_fmac_f32 v190, v169, v172
    v_fmac_f32 v191, v170, v172
    v_mul_f32 v184, v184, v176
    buffer_load_dwordx4 v246, s[32:35], s99 offen offset:2048  lds
    v_mul_f32 v185, v185, v177
    v_mul_f32 v186, v186, v178
    v_mul_f32 v187, v187, v179
    v_mul_f32 v188, v188, v180
    v_mul_f32 v189, v189, v181
    s_add_u32 m0, s61, 12288
    s_add_u32 s16, s16, s63
    buffer_load_dwordx4 v244, s[32:35], s16 offen offset:0  lds
    v_mul_f32 v190, v190, v182
    v_mul_f32 v191, v191, v183
    v_cvt_pk_bf16_f32 v108, v191, v190
    v_cvt_pk_bf16_f32 v109, v189, v188
    v_cvt_pk_bf16_f32 v110, v187, v186
    buffer_load_dwordx4 v245, s[32:35], s16 offen offset:1024  lds
    v_cvt_pk_bf16_f32 v111, v185, v184
    s_mov_b32 s89, 32768
    buffer_store_dwordx4 v[108:111], v12, s[52:55], s89 offen sc1
    v_and_b32 v160, 0xffff0000, v41
    v_and_b32 v161, 0xffff0000, v43
    v_and_b32 v162, 0xffff0000, v45
    buffer_load_dwordx4 v246, s[32:35], s16 offen offset:2048  lds
    v_and_b32 v163, 0xffff0000, v47
    v_and_b32 v164, 0xffff0000, v49
    v_and_b32 v165, 0xffff0000, v51
    v_and_b32 v166, 0xffff0000, v53
    v_and_b32 v167, 0xffff0000, v55
    s_add_u32 s97, s98, s0
    s_lshr_b64 s[0:1], s[0:1], 4
    s_and_b32 s97, s97, 15
    s_add_u32 m0, s87, 18432
    s_lshl_b32 s97, s97, 7
    buffer_load_dwordx4 v240, s[28:31], s97 offen offset:0  lds
    v_and_b32 v168, 0xffff0000, v57
    v_and_b32 v169, 0xffff0000, v59
    v_and_b32 v170, 0xffff0000, v61
    v_lshlrev_b32 v172, 16, v90
    v_and_b32 v173, 0xffff0000, v90
    buffer_load_dwordx4 v241, s[28:31], s97 offen offset:1024  lds
    v_lshlrev_b32 v174, 16, v91
    v_and_b32 v175, 0xffff0000, v91
    v_and_b32 v176, 0xffff0000, v69
    v_and_b32 v177, 0xffff0000, v71
    v_and_b32 v178, 0xffff0000, v73
    buffer_load_dwordx4 v242, s[28:31], s97 offen offset:2048  lds
    v_and_b32 v179, 0xffff0000, v75
    v_and_b32 v180, 0xffff0000, v77
    v_and_b32 v181, 0xffff0000, v79
    v_and_b32 v182, 0xffff0000, v81
    v_and_b32 v183, 0xffff0000, v83
    buffer_load_dwordx4 v243, s[28:31], s97 offen offset:3072  lds
    v_mul_f32 v184, v160, v175
    v_mul_f32 v185, v161, v175
    v_mul_f32 v186, v162, v175
    v_mul_f32 v187, v163, v175
    v_mul_f32 v188, v164, v175
    s_add_u32 m0, s88, 18432
    s_mov_b64 exec, 0xffffffff
    buffer_load_dwordx4 v3, s[28:31], s97 offen offset:0  lds
    s_mov_b64 exec, -1
    v_mul_f32 v189, v165, v175
    v_mul_f32 v190, v166, v175
    v_mul_f32 v191, v167, v175
    v_fmac_f32 v184, v161, v174
    v_fmac_f32 v185, v162, v174
    v_fmac_f32 v186, v163, v174
    v_fmac_f32 v187, v164, v174
    v_fmac_f32 v188, v165, v174
    v_fmac_f32 v189, v166, v174
    v_fmac_f32 v190, v167, v174
    v_fmac_f32 v191, v168, v174
    v_fmac_f32 v184, v162, v173
    v_fmac_f32 v185, v163, v173
    v_fmac_f32 v186, v164, v173
    v_fmac_f32 v187, v165, v173
    v_fmac_f32 v188, v166, v173
    v_fmac_f32 v189, v167, v173
    v_fmac_f32 v190, v168, v173
    v_fmac_f32 v191, v169, v173
    v_fmac_f32 v184, v163, v172
    v_fmac_f32 v185, v164, v172
    v_fmac_f32 v186, v165, v172
    v_fmac_f32 v187, v166, v172
    v_fmac_f32 v188, v167, v172
    v_fmac_f32 v189, v168, v172
    v_fmac_f32 v190, v169, v172
    v_fmac_f32 v191, v170, v172
    v_mul_f32 v184, v184, v176
    v_mul_f32 v185, v185, v177
    v_mul_f32 v186, v186, v178
    v_mul_f32 v187, v187, v179
    v_mul_f32 v188, v188, v180
    v_mul_f32 v189, v189, v181
    v_mul_f32 v190, v190, v182
    v_mul_f32 v191, v191, v183
    v_cvt_pk_bf16_f32 v112, v191, v190
    v_cvt_pk_bf16_f32 v113, v189, v188
    v_cvt_pk_bf16_f32 v114, v187, v186
    v_cvt_pk_bf16_f32 v115, v185, v184
    s_mov_b32 s89, 49152
    buffer_store_dwordx4 v[112:115], v12, s[52:55], s89 offen sc1
    s_waitcnt vmcnt(13)
    s_barrier
    s_mul_i32 s16, s97, 3072
    s_add_u32 m0, s60, 24576
    s_add_u32 s99, s16, s62
    buffer_load_dwordx4 v244, s[32:35], s99 offen offset:0  lds
    s_mov_b32 s68, s24
    s_mov_b32 s69, s25
    s_mov_b32 s70, 0x100
    s_mov_b32 s71, 0x20000
    buffer_load_dwordx4 v245, s[32:35], s99 offen offset:1024  lds
    v_lshrrev_b32 v6, 5, v0
    v_and_b32 v7, 3, v0
    s_lshr_b32 s78, s90, 1
    s_lshl_b32 s78, s78, 2
    buffer_load_dwordx4 v246, s[32:35], s99 offen offset:2048  lds
    s_load_dword s92, s[14:15], s78
    v_bfe_u32 v5, v0, 2, 2
    v_lshlrev_b32 v5, 1, v5
    s_add_u32 m0, s61, 36864
    s_add_u32 s16, s16, s63
    buffer_load_dwordx4 v244, s[32:35], s16 offen offset:0  lds
    v_lshl_add_u32 v5, v6, 3, v5
    v_bfe_u32 v8, v0, 4, 1
    v_add_u32 v5, v5, v8
    s_and_b32 s78, s3, 1
    buffer_load_dwordx4 v245, s[32:35], s16 offen offset:1024  lds
    s_lshl_b32 s78, s78, 1
    v_add_u32 v8, s78, v6
    v_xor_b32 v8, v8, v7
    v_lshlrev_b32 v8, 4, v8
    buffer_load_dwordx4 v246, s[32:35], s16 offen offset:2048  lds
    v_lshl_add_u32 v5, v5, 6, v8
    v_add_u32 v14, s86, v5
    v_mov_b32 v18, 162304
    s_add_u32 s97, s98, s0
    s_lshr_b64 s[0:1], s[0:1], 4
    s_and_b32 s97, s97, 15
    s_add_u32 m0, s87, 36864
    s_lshl_b32 s97, s97, 7
    buffer_load_dwordx4 v240, s[28:31], s97 offen offset:0  lds
    v_mov_b32 v19, 1
    v_and_b32 v5, 3, v0
    s_lshl_b32 s78, s74, 4
    s_add_u32 s78, s78, s3
    buffer_load_dwordx4 v241, s[28:31], s97 offen offset:1024  lds
    v_lshl_add_u32 v6, v5, 2, s78
    s_lshr_b32 s78, s76, 3
    s_lshl_b32 s79, s3, 1
    s_add_u32 s78, s78, s79
    buffer_load_dwordx4 v242, s[28:31], s97 offen offset:2048  lds
    s_xor_b32 s78, s78, 3
    s_lshl_b32 s78, s78, 5
    s_add_u32 s79, s76, 5
    buffer_load_dwordx4 v243, s[28:31], s97 offen offset:3072  lds
    s_and_b32 s79, s79, 7
    s_lshl_b32 s79, s79, 1
    s_add_u32 s78, s78, s79
    v_mul_u32_u24 v7, 9, v5
    s_add_u32 m0, s88, 36864
    s_mov_b64 exec, 0xffffffff
    buffer_load_dwordx4 v3, s[28:31], s97 offen offset:0  lds
    s_mov_b64 exec, -1
    v_and_b32 v7, 17, v7
    v_add_u32 v7, s78, v7
    v_and_b32 v8, 4, v0
    s_waitcnt vmcnt(12)
    s_waitcnt vmcnt(11)
    s_barrier
    s_mul_i32 s16, s97, 3072
    s_add_u32 m0, s60, 49152
    s_add_u32 s99, s16, s62
    buffer_load_dwordx4 v244, s[32:35], s99 offen offset:0  lds
    v_cmp_eq_u32 vcc, 0, v8
    s_nop 1
    v_cndmask_b32 v6, v7, v6, vcc
    v_and_b32 v33, 0xf0, v6
    v_lshlrev_b32 v34, 8, v6
    buffer_load_dwordx4 v245, s[32:35], s99 offen offset:1024  lds
    v_add_u32 v34, 12582912, v34
    v_and_b32 v5, 15, v0
    v_lshrrev_b32 v6, 4, v0
    v_add_u32 v7, 9, v5
    buffer_load_dwordx4 v246, s[32:35], s99 offen offset:2048  lds
    v_and_b32 v8, 1, v7
    v_mul_u32_u24 v8, 4160, v8
    v_lshrrev_b32 v7, 1, v7
    s_add_u32 m0, s61, 61440
    s_add_u32 s16, s16, s63
    buffer_load_dwordx4 v244, s[32:35], s16 offen offset:0  lds
    v_lshl_add_u32 v8, v7, 2, v8
    v_lshlrev_b32 v7, 4, v6
    v_sub_u32 v8, v8, v7
    s_add_u32 s78, s94, 32
    buffer_load_dwordx4 v245, s[32:35], s16 offen offset:1024  lds
    v_add_u32 v21, s78, v8
    v_add_u32 v22, 1024, v21
    v_add_u32 v23, 2048, v21
    v_add_u32 v24, 3072, v21
    buffer_load_dwordx4 v246, s[32:35], s16 offen offset:2048  lds
    v_lshl_add_u32 v7, v5, 1, v6
    v_add_u32 v7, 30, v7
    v_and_b32 v8, 1, v7
    s_add_u32 s97, s98, s0
    s_lshr_b64 s[0:1], s[0:1], 4
    s_and_b32 s97, s97, 15
    s_add_u32 m0, s87, 0
    s_lshl_b32 s97, s97, 7
    buffer_load_dwordx4 v240, s[28:31], s97 offen offset:0  lds
    v_bfe_u32 v136, v7, 1, 2
    v_lshl_add_u32 v136, v8, 2, v136
    v_lshlrev_b32 v136, 6, v136
    v_lshrrev_b32 v7, 3, v7
    buffer_load_dwordx4 v241, s[28:31], s97 offen offset:1024  lds
    v_lshl_add_u32 v136, v7, 9, v136
    v_bitop3_b32 v8, v7, 3, s3 bitop3:0x6a
    v_lshl_add_u32 v25, v8, 4, v136
    v_add_u32 v25, 92160, v25
    buffer_load_dwordx4 v242, s[28:31], s97 offen offset:2048  lds
    v_subrev_u32 v7, 1, v7
    v_bitop3_b32 v8, v7, 3, s3 bitop3:0x6a
    v_lshl_add_u32 v27, v8, 4, v136
    buffer_load_dwordx4 v243, s[28:31], s97 offen offset:3072  lds
    v_add_u32 v27, 91648, v27
    v_subrev_u32 v7, 1, v7
    v_bitop3_b32 v8, v7, 3, s3 bitop3:0x6a
    v_lshl_add_u32 v29, v8, 4, v136
    s_add_u32 m0, s88, 0
    s_mov_b64 exec, 0xffffffff
    buffer_load_dwordx4 v3, s[28:31], s97 offen offset:0  lds
    s_mov_b64 exec, -1
    v_add_u32 v29, 91136, v29
    v_subrev_u32 v7, 1, v7
    v_bitop3_b32 v8, v7, 3, s3 bitop3:0x6a
    s_waitcnt vmcnt(11)
    s_barrier
    s_mul_i32 s16, s97, 3072
    s_add_u32 m0, s60, 0
    s_add_u32 s99, s16, s62
    buffer_load_dwordx4 v244, s[32:35], s99 offen offset:0  lds
    v_lshl_add_u32 v31, v8, 4, v136
    v_add_u32 v31, 90624, v31
    v_lshl_add_u32 v7, v5, 1, v6
    buffer_load_dwordx4 v245, s[32:35], s99 offen offset:1024  lds
    v_add_u32 v7, 26, v7
    v_and_b32 v8, 1, v7
    v_bfe_u32 v136, v7, 1, 2
    buffer_load_dwordx4 v246, s[32:35], s99 offen offset:2048  lds
    v_lshl_add_u32 v136, v8, 2, v136
    v_lshlrev_b32 v136, 6, v136
    s_add_u32 m0, s61, 12288
    s_add_u32 s16, s16, s63
    buffer_load_dwordx4 v244, s[32:35], s16 offen offset:0  lds
    v_lshrrev_b32 v7, 3, v7
    v_lshl_add_u32 v136, v7, 9, v136
    v_bitop3_b32 v8, v7, 3, s3 bitop3:0x6a
    buffer_load_dwordx4 v245, s[32:35], s16 offen offset:1024  lds
    v_lshl_add_u32 v26, v8, 4, v136
    v_add_u32 v26, 92160, v26
    v_subrev_u32 v7, 1, v7
    buffer_load_dwordx4 v246, s[32:35], s16 offen offset:2048  lds
    v_bitop3_b32 v8, v7, 3, s3 bitop3:0x6a
    v_lshl_add_u32 v28, v8, 4, v136
    s_add_u32 m0, s94, 32
    s_lshl_b32 s89, s90, 12
    buffer_load_dwordx4 v15, s[48:51], s89 offen offset:0 nt lds
    v_add_u32 v28, 91648, v28
    v_subrev_u32 v7, 1, v7
    v_bitop3_b32 v8, v7, 3, s3 bitop3:0x6a
    s_add_u32 m0, s94, 32
    s_lshl_b32 s89, s90, 12
    buffer_load_dwordx4 v15, s[48:51], s89 offen offset:1024 nt lds
    v_lshl_add_u32 v30, v8, 4, v136
    v_add_u32 v30, 91136, v30
    v_subrev_u32 v7, 1, v7
    s_add_u32 m0, s94, 32
    s_lshl_b32 s89, s90, 12
    buffer_load_dwordx4 v15, s[48:51], s89 offen offset:2048 nt lds
    v_bitop3_b32 v8, v7, 3, s3 bitop3:0x6a
    v_lshl_add_u32 v32, v8, 4, v136
    s_add_u32 m0, s94, 32
    s_lshl_b32 s89, s90, 12
    buffer_load_dwordx4 v15, s[48:51], s89 offen offset:3072 nt lds
    v_add_u32 v32, 90624, v32
    v_lshrrev_b32 v7, 1, v6
    v_lshl_add_u32 v7, v5, 1, v7
    s_add_u32 s97, s98, s0
    s_lshr_b64 s[0:1], s[0:1], 4
    s_and_b32 s97, s97, 15
    s_add_u32 m0, s87, 18432
    s_lshl_b32 s97, s97, 7
    buffer_load_dwordx4 v240, s[28:31], s97 offen offset:0  lds
    v_add_u32 v7, 32, v7
    v_and_b32 v8, 1, v7
    v_bfe_u32 v136, v7, 1, 2
    buffer_load_dwordx4 v241, s[28:31], s97 offen offset:1024  lds
    v_lshl_add_u32 v136, v8, 2, v136
    v_lshlrev_b32 v136, 6, v136
    buffer_load_dwordx4 v242, s[28:31], s97 offen offset:2048  lds
    v_lshrrev_b32 v7, 3, v7
    v_lshl_add_u32 v136, v7, 9, v136
    v_bitop3_b32 v8, v7, 3, s3 bitop3:0x6a
    buffer_load_dwordx4 v243, s[28:31], s97 offen offset:3072  lds
    v_lshl_add_u32 v20, v8, 4, v136
    v_add_u32 v20, 92160, v20
    v_and_b32 v8, 1, v6
    s_add_u32 m0, s88, 18432
    s_mov_b64 exec, 0xffffffff
    buffer_load_dwordx4 v3, s[28:31], s97 offen offset:0  lds
    s_mov_b64 exec, -1
    v_xor_b32 v8, 1, v8
    v_lshl_add_u32 v20, v8, 3, v20
    s_waitcnt vmcnt(15)
    s_barrier
    s_mul_i32 s16, s97, 3072
    s_add_u32 m0, s60, 24576
    s_add_u32 s99, s16, s62
    buffer_load_dwordx4 v244, s[32:35], s99 offen offset:0  lds
    s_waitcnt lgkmcnt(0)
    s_and_b32 s78, s92, 0xffff0000
    s_lshl_b32 s92, s92, 16
    buffer_load_dwordx4 v245, s[32:35], s99 offen offset:1024  lds
    s_bitcmp1_b32 s90, 0
    s_cselect_b32 s92, s78, s92
    v_lshlrev_b32 v7, 3, v6
    v_sub_u32 v7, v7, v5
    buffer_load_dwordx4 v246, s[32:35], s99 offen offset:2048  lds
    v_subrev_u32 v7, 9, v7
    v_and_b32 v8, 1, v7
    v_xor_b32 v8, 1, v8
    s_add_u32 m0, s61, 36864
    s_add_u32 s16, s16, s63
    buffer_load_dwordx4 v244, s[32:35], s16 offen offset:0  lds
    v_lshlrev_b32 v8, 4, v8
    v_lshrrev_b32 v8, v8, s92
    v_ashrrev_i32 v7, 1, v7
    buffer_load_dwordx4 v245, s[32:35], s16 offen offset:1024  lds
    v_cmp_eq_u32 vcc, 0, v7
    s_nop 1
    v_cndmask_b32 v236, 0, v8, vcc
    v_cmp_eq_u32 vcc, 1, v7
    buffer_load_dwordx4 v246, s[32:35], s16 offen offset:2048  lds
    s_nop 0
    v_cndmask_b32 v237, 0, v8, vcc
    v_cmp_eq_u32 vcc, 2, v7
    s_nop 1
    v_cndmask_b32 v238, 0, v8, vcc
    s_add_u32 s97, s98, s0
    s_lshr_b64 s[0:1], s[0:1], 4
    s_and_b32 s97, s97, 15
    s_add_u32 m0, s87, 36864
    s_lshl_b32 s97, s97, 7
    buffer_load_dwordx4 v240, s[28:31], s97 offen offset:0  lds
    v_cmp_eq_u32 vcc, 3, v7
    s_nop 1
    v_cndmask_b32 v239, 0, v8, vcc
    s_and_b32 s78, s77, 7
    s_mov_b32 s95, 0x76543210
    s_and_b32 s78, s76, 3
    s_mul_i32 s78, s78, 0x22222222
    s_add_u32 s95, s95, s78
    s_bfe_u32 s17, s95, 0x30000
    s_lshl_b32 s17, s17, 18
    s_bfe_u32 s18, s95, 0x30004
    s_lshl_b32 s18, s18, 18
    s_bfe_u32 s100, s95, 0x3001c
    s_lshl_b32 s100, s100, 18
    s_bfe_u32 s95, s95, 0x30018
    s_lshl_b32 s95, s95, 18
    buffer_load_dwordx4 v241, s[28:31], s97 offen offset:1024  lds
    v_lshrrev_b32 v136, 4, v0
    v_lshlrev_b32 v136, 1, v136
    v_and_b32 v137, 7, v0
    buffer_load_dwordx4 v242, s[28:31], s97 offen offset:2048  lds
    v_xor_b32 v136, v136, v137
    v_lshlrev_b32 v136, 4, v136
    v_lshrrev_b32 v137, 3, v0
    buffer_load_dwordx4 v243, s[28:31], s97 offen offset:3072  lds
    v_lshl_add_u32 v136, v137, 11, v136
    s_lshl_b32 s78, s77, 7
    s_lshl_b32 s79, s3, 14
    s_add_u32 m0, s88, 36864
    s_mov_b64 exec, 0xffffffff
    buffer_load_dwordx4 v3, s[28:31], s97 offen offset:0  lds
    s_mov_b64 exec, -1
    s_add_u32 s78, s78, s79
    v_add_u32 v17, s78, v136
    s_waitcnt vmcnt(11)
    s_barrier
    s_mul_i32 s16, s97, 3072
    s_add_u32 m0, s60, 49152
    s_add_u32 s99, s16, s62
    buffer_load_dwordx4 v244, s[32:35], s99 offen offset:0  lds
    v_add_u32 v5, s94, v15
    ds_read_b128 v[140:143], v5 offset:32
    ds_read_b32 v156, v5 offset:48
    ds_read_b128 v[144:147], v5 offset:1056
    buffer_load_dwordx4 v245, s[32:35], s99 offen offset:1024  lds
    ds_read_b32 v157, v5 offset:1072
    ds_read_b128 v[148:151], v5 offset:2080
    ds_read_b32 v158, v5 offset:2096
    ds_read_b128 v[152:155], v5 offset:3104
    buffer_load_dwordx4 v246, s[32:35], s99 offen offset:2048  lds
    ds_read_b32 v159, v5 offset:3120
    v_lshrrev_b32 v6, 3, v0
    v_mul_u32_u24 v6, 4160, v6
    s_add_u32 m0, s61, 61440
    s_add_u32 s16, s16, s63
    buffer_load_dwordx4 v244, s[32:35], s16 offen offset:0  lds
    v_and_b32 v7, 7, v0
    v_lshl_add_u32 v6, v7, 2, v6
    v_add_u32 v6, s94, v6
    v_mov_b32 v7, 0
    buffer_load_dwordx4 v245, s[32:35], s16 offen offset:1024  lds
    s_waitcnt lgkmcnt(0)
    v_readfirstlane_b32 s93, v140
    s_nop 0
    s_lshl_b32 s93, s93, 16
    s_nop 1
    v_writelane_b32 v7, s93, 15
    buffer_load_dwordx4 v246, s[32:35], s16 offen offset:2048  lds
    v_alignbit_b32 v140, v141, v140, 16
    v_alignbit_b32 v141, v142, v141, 16
    v_alignbit_b32 v142, v143, v142, 16
    s_add_u32 s97, s98, s0
    s_lshr_b64 s[0:1], s[0:1], 4
    s_and_b32 s97, s97, 15
    s_add_u32 m0, s87, 0
    s_lshl_b32 s97, s97, 7
    buffer_load_dwordx4 v240, s[28:31], s97 offen offset:0  lds
    v_alignbit_b32 v143, v156, v143, 16
    v_alignbit_b32 v144, v145, v144, 16
    v_alignbit_b32 v145, v146, v145, 16
    v_alignbit_b32 v146, v147, v146, 16
    buffer_load_dwordx4 v241, s[28:31], s97 offen offset:1024  lds
    v_alignbit_b32 v147, v157, v147, 16
    v_alignbit_b32 v148, v149, v148, 16
    v_alignbit_b32 v149, v150, v149, 16
    v_alignbit_b32 v150, v151, v150, 16
    buffer_load_dwordx4 v242, s[28:31], s97 offen offset:2048  lds
    v_alignbit_b32 v151, v158, v151, 16
    v_alignbit_b32 v152, v153, v152, 16
    v_alignbit_b32 v153, v154, v153, 16
    buffer_load_dwordx4 v243, s[28:31], s97 offen offset:3072  lds
    v_alignbit_b32 v154, v155, v154, 16
    v_alignbit_b32 v155, v159, v155, 16
    v_lshlrev_b32 v8, 3, v0
    s_add_u32 s78, s88, 18432
    s_add_u32 m0, s88, 0
    s_mov_b64 exec, 0xffffffff
    buffer_load_dwordx4 v3, s[28:31], s97 offen offset:0  lds
    s_mov_b64 exec, -1
    v_add_u32 v8, s78, v8
    v_mov_b32 v156, 0
    v_mov_b32 v157, 0
    s_waitcnt vmcnt(11)
    s_barrier
    s_mul_i32 s16, s97, 3072
    s_add_u32 m0, s60, 0
    s_add_u32 s99, s16, s62
    buffer_load_dwordx4 v244, s[32:35], s99 offen offset:0  lds
    buffer_load_dwordx4 v245, s[32:35], s99 offen offset:1024  lds
    buffer_load_dwordx4 v246, s[32:35], s99 offen offset:2048  lds
    s_add_u32 m0, s61, 12288
    s_add_u32 s16, s16, s63
    buffer_load_dwordx4 v244, s[32:35], s16 offen offset:0  lds
    buffer_load_dwordx4 v245, s[32:35], s16 offen offset:1024  lds
    buffer_load_dwordx4 v246, s[32:35], s16 offen offset:2048  lds
    s_mov_b64 exec, 0xff
    buffer_load_dword v136, v33, s[68:71], 0 offen sc1
    buffer_load_dword v137, v34, s[52:55], 0 offen sc1
    s_mov_b64 exec, -1
    buffer_load_dwordx4 v[212:215], v9, s[56:59], 0 offen offset:0 nt
    buffer_load_dwordx4 v[216:219], v9, s[56:59], 0 offen offset:2048 nt
    buffer_load_dwordx4 v[220:223], v9, s[56:59], s96 offen offset:0 nt
    buffer_load_dwordx4 v[224:227], v9, s[56:59], s96 offen offset:2048 nt
    s_waitcnt vmcnt(12)
    s_waitcnt vmcnt(6)
    s_barrier
    s_waitcnt vmcnt(4)
LA_j:
    s_mov_b64 exec, 0xff
    v_cmp_ne_u32 vcc, v136, v137
    v_cmp_gt_u32 s[80:81], s96, v136
    s_nop 0
    s_or_b64 vcc, vcc, s[80:81]
    s_cbranch_vccnz LA_slow
LA_back:
    s_mov_b64 exec, -1
    s_add_u32 m0, s86, 94208
    s_add_u32 s89, s91, 0
    buffer_load_dwordx4 v14, s[52:55], s89 offen sc1 lds
    s_add_u32 m0, s86, 98304
    s_add_u32 s89, s91, 4096
    buffer_load_dwordx4 v14, s[52:55], s89 offen sc1 lds
    s_add_u32 m0, s86, 102400
    s_add_u32 s89, s91, 8192
    buffer_load_dwordx4 v14, s[52:55], s89 offen sc1 lds
    s_add_u32 m0, s86, 106496
    s_add_u32 s89, s91, 12288
    buffer_load_dwordx4 v14, s[52:55], s89 offen sc1 lds
    s_mov_b64 exec, 0xffff
    ds_write_b32 v6, v7
    s_mov_b64 exec, -1
    ds_write_b128 v5, v[140:143] offset:4192
    ds_write_b128 v5, v[144:147] offset:5216
    ds_write_b128 v5, v[148:151] offset:6240
    ds_write_b128 v5, v[152:155] offset:7264
    ds_write_b64 v8, v[156:157]
    s_add_u32 s89, s95, 131072
    buffer_load_dwordx4 v[228:231], v17, s[64:67], s89 offen
    s_add_u32 s89, s95, 196608
    buffer_load_dwordx4 v[232:235], v17, s[64:67], s89 offen
    s_add_u32 s89, s100, 0
    buffer_load_dwordx4 v[240:243], v17, s[64:67], s89 offen
    s_add_u32 s89, s100, 65536
    buffer_load_dwordx4 v[244:247], v17, s[64:67], s89 offen
    s_add_u32 s89, s100, 131072
    buffer_load_dwordx4 v[248:251], v17, s[64:67], s89 offen
    s_add_u32 s89, s100, 196608
    buffer_load_dwordx4 v[196:199], v17, s[64:67], s89 offen
    ds_read2_b32 v[68:69], v21 offset0:0 offset1:1
    ds_read2_b32 v[70:71], v21 offset0:2 offset1:3
    ds_read2_b32 v[72:73], v21 offset0:128 offset1:129
    ds_read2_b32 v[74:75], v21 offset0:130 offset1:131
    ds_read2_b32 v[76:77], v22 offset0:0 offset1:1
    ds_read2_b32 v[78:79], v22 offset0:2 offset1:3
    ds_read2_b32 v[80:81], v22 offset0:128 offset1:129
    ds_read2_b32 v[82:83], v22 offset0:130 offset1:131
    ds_read2_b32 v[84:85], v23 offset0:0 offset1:1
    ds_read2_b32 v[86:87], v23 offset0:2 offset1:3
    ds_read2_b32 v[88:89], v23 offset0:128 offset1:129
    ds_read2_b32 v[90:91], v23 offset0:130 offset1:131
    ds_read2_b32 v[92:93], v24 offset0:0 offset1:1
    ds_read2_b32 v[94:95], v24 offset0:2 offset1:3
    ds_read2_b32 v[96:97], v24 offset0:128 offset1:129
    ds_read2_b32 v[98:99], v24 offset0:130 offset1:131
    s_waitcnt vmcnt(6)
    s_mov_b64 exec, 1
    ds_add_u32 v18, v19 offset:20
    s_mov_b64 exec, -1
    s_branch LA_s5_in
LA_s5:
    s_sleep 1
LA_s5_in:
    ds_read_b32 v6, v18 offset:20
    s_waitcnt lgkmcnt(0)
    v_readfirstlane_b32 s78, v6
    s_nop 0
    s_cmp_ge_u32 s78, 4
    s_cbranch_scc0 LA_s5
    s_mov_b64 exec, 1
    ds_add_u32 v18, v19 offset:8
    s_mov_b64 exec, -1
    ds_read_b128 v[100:103], v25 offset:0
    ds_read_b128 v[104:107], v25 offset:2048
    ds_read_b128 v[108:111], v25 offset:4096
    ds_read_b128 v[112:115], v25 offset:6144
    ds_read_b128 v[116:119], v25 offset:8192
    ds_read_b128 v[120:123], v25 offset:10240
    ds_read_b128 v[124:127], v25 offset:12288
    ds_read_b128 v[128:131], v25 offset:14336
    s_setprio 2
    s_waitcnt lgkmcnt(7)
    v_mfma_f32_16x16x32_bf16 v[36:39], v[236:239], v[100:103], 0
    ds_read2_b32 v[132:133], v21 offset0:16 offset1:17
    v_mfma_f32_16x16x32_bf16 v[36:39], v[68:71], v[100:103], v[36:39]
    ds_read2_b32 v[134:135], v21 offset0:18 offset1:19
    s_waitcnt lgkmcnt(8)
    v_mfma_f32_16x16x32_bf16 v[40:43], v[236:239], v[104:107], 0
    v_mfma_f32_16x16x32_bf16 v[40:43], v[68:71], v[104:107], v[40:43]
    ds_read_b128 v[164:167], v26 offset:0
    v_mfma_f32_16x16x32_bf16 v[40:43], v[72:75], v[100:103], v[40:43]
    s_waitcnt lgkmcnt(8)
    v_mfma_f32_16x16x32_bf16 v[44:47], v[236:239], v[108:111], 0
    ds_read2_b32 v[136:137], v21 offset0:144 offset1:145
    v_mfma_f32_16x16x32_bf16 v[44:47], v[68:71], v[108:111], v[44:47]
    ds_read2_b32 v[138:139], v21 offset0:146 offset1:147
    v_mfma_f32_16x16x32_bf16 v[44:47], v[72:75], v[104:107], v[44:47]
    v_mfma_f32_16x16x32_bf16 v[44:47], v[76:79], v[100:103], v[44:47]
    ds_read_b128 v[168:171], v26 offset:2048
    s_waitcnt lgkmcnt(10)
    v_mfma_f32_16x16x32_bf16 v[48:51], v[236:239], v[112:115], 0
    v_mfma_f32_16x16x32_bf16 v[48:51], v[68:71], v[112:115], v[48:51]
    ds_read2_b32 v[140:141], v22 offset0:16 offset1:17
    v_mfma_f32_16x16x32_bf16 v[48:51], v[72:75], v[108:111], v[48:51]
    ds_read2_b32 v[142:143], v22 offset0:18 offset1:19
    v_mfma_f32_16x16x32_bf16 v[48:51], v[76:79], v[104:107], v[48:51]
    v_mfma_f32_16x16x32_bf16 v[48:51], v[80:83], v[100:103], v[48:51]
    ds_read_b128 v[172:175], v26 offset:4096
    s_waitcnt lgkmcnt(12)
    v_mfma_f32_16x16x32_bf16 v[52:55], v[236:239], v[116:119], 0
    v_mfma_f32_16x16x32_bf16 v[52:55], v[68:71], v[116:119], v[52:55]
    ds_read2_b32 v[144:145], v22 offset0:144 offset1:145
    v_mfma_f32_16x16x32_bf16 v[52:55], v[72:75], v[112:115], v[52:55]
    ds_read2_b32 v[146:147], v22 offset0:146 offset1:147
    v_mfma_f32_16x16x32_bf16 v[52:55], v[76:79], v[108:111], v[52:55]
    v_mfma_f32_16x16x32_bf16 v[52:55], v[80:83], v[104:107], v[52:55]
    ds_read_b128 v[176:179], v26 offset:6144
    v_mfma_f32_16x16x32_bf16 v[52:55], v[84:87], v[100:103], v[52:55]
    s_waitcnt lgkmcnt(14)
    v_mfma_f32_16x16x32_bf16 v[56:59], v[236:239], v[120:123], 0
    ds_read2_b32 v[148:149], v23 offset0:16 offset1:17
    v_mfma_f32_16x16x32_bf16 v[56:59], v[68:71], v[120:123], v[56:59]
    ds_read2_b32 v[150:151], v23 offset0:18 offset1:19
    v_mfma_f32_16x16x32_bf16 v[56:59], v[72:75], v[116:119], v[56:59]
    v_mfma_f32_16x16x32_bf16 v[56:59], v[76:79], v[112:115], v[56:59]
    ds_read_b128 v[180:183], v26 offset:8192
    v_mfma_f32_16x16x32_bf16 v[56:59], v[80:83], v[108:111], v[56:59]
    v_mfma_f32_16x16x32_bf16 v[56:59], v[84:87], v[104:107], v[56:59]
    ds_read2_b32 v[152:153], v23 offset0:144 offset1:145
    v_mfma_f32_16x16x32_bf16 v[56:59], v[88:91], v[100:103], v[56:59]
    ds_read2_b32 v[154:155], v23 offset0:146 offset1:147
    s_waitcnt lgkmcnt(14)
    v_mfma_f32_16x16x32_bf16 v[60:63], v[236:239], v[124:127], 0
    v_mfma_f32_16x16x32_bf16 v[60:63], v[68:71], v[124:127], v[60:63]
    ds_read_b128 v[184:187], v26 offset:10240
    v_mfma_f32_16x16x32_bf16 v[60:63], v[72:75], v[120:123], v[60:63]
    v_mfma_f32_16x16x32_bf16 v[60:63], v[76:79], v[116:119], v[60:63]
    ds_read2_b32 v[156:157], v24 offset0:16 offset1:17
    v_mfma_f32_16x16x32_bf16 v[60:63], v[80:83], v[112:115], v[60:63]
    ds_read2_b32 v[158:159], v24 offset0:18 offset1:19
    v_mfma_f32_16x16x32_bf16 v[60:63], v[84:87], v[108:111], v[60:63]
    v_mfma_f32_16x16x32_bf16 v[60:63], v[88:91], v[104:107], v[60:63]
    ds_read_b128 v[188:191], v26 offset:12288
    v_mfma_f32_16x16x32_bf16 v[60:63], v[92:95], v[100:103], v[60:63]
    v_mfma_f32_16x16x32_bf16 v[64:67], v[236:239], v[128:131], 0
    ds_read2_b32 v[160:161], v24 offset0:144 offset1:145
    v_mfma_f32_16x16x32_bf16 v[64:67], v[68:71], v[128:131], v[64:67]
    ds_read2_b32 v[162:163], v24 offset0:146 offset1:147
    v_mfma_f32_16x16x32_bf16 v[64:67], v[72:75], v[124:127], v[64:67]
    v_mfma_f32_16x16x32_bf16 v[64:67], v[76:79], v[120:123], v[64:67]
    ds_read_b128 v[192:195], v26 offset:14336
    v_mfma_f32_16x16x32_bf16 v[64:67], v[80:83], v[116:119], v[64:67]
    v_mfma_f32_16x16x32_bf16 v[64:67], v[84:87], v[112:115], v[64:67]
    v_mfma_f32_16x16x32_bf16 v[64:67], v[88:91], v[108:111], v[64:67]
    v_mfma_f32_16x16x32_bf16 v[64:67], v[92:95], v[104:107], v[64:67]
    v_mfma_f32_16x16x32_bf16 v[64:67], v[96:99], v[100:103], v[64:67]
    v_mfma_f32_16x16x32_bf16 v[36:39], v[132:135], v[164:167], v[36:39]
    ds_read2_b32 v[68:69], v21 offset0:32 offset1:33
    s_waitcnt lgkmcnt(14)
    v_mfma_f32_16x16x32_bf16 v[40:43], v[136:139], v[164:167], v[40:43]
    ds_read2_b32 v[70:71], v21 offset0:34 offset1:35
    v_mfma_f32_16x16x32_bf16 v[40:43], v[132:135], v[168:171], v[40:43]
    ds_read_b128 v[100:103], v27 offset:0
    v_mfma_f32_16x16x32_bf16 v[44:47], v[132:135], v[172:175], v[44:47]
    v_mfma_f32_16x16x32_bf16 v[44:47], v[136:139], v[168:171], v[44:47]
    ds_read2_b32 v[72:73], v21 offset0:160 offset1:161
    v_mfma_f32_16x16x32_bf16 v[44:47], v[140:143], v[164:167], v[44:47]
    ds_read2_b32 v[74:75], v21 offset0:162 offset1:163
    v_mfma_f32_16x16x32_bf16 v[48:51], v[144:147], v[164:167], v[48:51]
    ds_read_b128 v[104:107], v27 offset:2048
    v_mfma_f32_16x16x32_bf16 v[48:51], v[140:143], v[168:171], v[48:51]
    v_mfma_f32_16x16x32_bf16 v[48:51], v[136:139], v[172:175], v[48:51]
    ds_read2_b32 v[76:77], v22 offset0:32 offset1:33
    s_waitcnt lgkmcnt(14)
    v_mfma_f32_16x16x32_bf16 v[48:51], v[132:135], v[176:179], v[48:51]
    ds_read2_b32 v[78:79], v22 offset0:34 offset1:35
    v_mfma_f32_16x16x32_bf16 v[52:55], v[132:135], v[180:183], v[52:55]
    ds_read_b128 v[108:111], v27 offset:4096
    v_mfma_f32_16x16x32_bf16 v[52:55], v[136:139], v[176:179], v[52:55]
    v_mfma_f32_16x16x32_bf16 v[52:55], v[140:143], v[172:175], v[52:55]
    ds_read2_b32 v[80:81], v22 offset0:160 offset1:161
    v_mfma_f32_16x16x32_bf16 v[52:55], v[144:147], v[168:171], v[52:55]
    ds_read2_b32 v[82:83], v22 offset0:162 offset1:163
    v_mfma_f32_16x16x32_bf16 v[52:55], v[148:151], v[164:167], v[52:55]
    ds_read_b128 v[112:115], v27 offset:6144
    v_mfma_f32_16x16x32_bf16 v[56:59], v[152:155], v[164:167], v[56:59]
    v_mfma_f32_16x16x32_bf16 v[56:59], v[148:151], v[168:171], v[56:59]
    ds_read2_b32 v[84:85], v23 offset0:32 offset1:33
    v_mfma_f32_16x16x32_bf16 v[56:59], v[144:147], v[172:175], v[56:59]
    ds_read2_b32 v[86:87], v23 offset0:34 offset1:35
    v_mfma_f32_16x16x32_bf16 v[56:59], v[140:143], v[176:179], v[56:59]
    ds_read_b128 v[116:119], v27 offset:8192
    v_mfma_f32_16x16x32_bf16 v[56:59], v[136:139], v[180:183], v[56:59]
    s_waitcnt lgkmcnt(14)
    v_mfma_f32_16x16x32_bf16 v[56:59], v[132:135], v[184:187], v[56:59]
    ds_read2_b32 v[88:89], v23 offset0:160 offset1:161
    v_mfma_f32_16x16x32_bf16 v[60:63], v[132:135], v[188:191], v[60:63]
    ds_read2_b32 v[90:91], v23 offset0:162 offset1:163
    v_mfma_f32_16x16x32_bf16 v[60:63], v[136:139], v[184:187], v[60:63]
    ds_read_b128 v[120:123], v27 offset:10240
    v_mfma_f32_16x16x32_bf16 v[60:63], v[140:143], v[180:183], v[60:63]
    v_mfma_f32_16x16x32_bf16 v[60:63], v[144:147], v[176:179], v[60:63]
    ds_read2_b32 v[92:93], v24 offset0:32 offset1:33
    v_mfma_f32_16x16x32_bf16 v[60:63], v[148:151], v[172:175], v[60:63]
    ds_read2_b32 v[94:95], v24 offset0:34 offset1:35
    v_mfma_f32_16x16x32_bf16 v[60:63], v[152:155], v[168:171], v[60:63]
    ds_read_b128 v[124:127], v27 offset:12288
    v_mfma_f32_16x16x32_bf16 v[60:63], v[156:159], v[164:167], v[60:63]
    v_mfma_f32_16x16x32_bf16 v[64:67], v[160:163], v[164:167], v[64:67]
    ds_read2_b32 v[96:97], v24 offset0:160 offset1:161
    v_mfma_f32_16x16x32_bf16 v[64:67], v[156:159], v[168:171], v[64:67]
    ds_read2_b32 v[98:99], v24 offset0:162 offset1:163
    v_mfma_f32_16x16x32_bf16 v[64:67], v[152:155], v[172:175], v[64:67]
    ds_read_b128 v[128:131], v27 offset:14336
    v_mfma_f32_16x16x32_bf16 v[64:67], v[148:151], v[176:179], v[64:67]
    v_mfma_f32_16x16x32_bf16 v[64:67], v[144:147], v[180:183], v[64:67]
    v_mfma_f32_16x16x32_bf16 v[64:67], v[140:143], v[184:187], v[64:67]
    v_mfma_f32_16x16x32_bf16 v[64:67], v[136:139], v[188:191], v[64:67]
    v_mfma_f32_16x16x32_bf16 v[64:67], v[132:135], v[192:195], v[64:67]
    s_waitcnt lgkmcnt(14)
    v_mfma_f32_16x16x32_bf16 v[36:39], v[68:71], v[100:103], v[36:39]
    ds_read2_b32 v[132:133], v21 offset0:48 offset1:49
    v_mfma_f32_16x16x32_bf16 v[40:43], v[72:75], v[100:103], v[40:43]
    ds_read2_b32 v[134:135], v21 offset0:50 offset1:51
    v_mfma_f32_16x16x32_bf16 v[40:43], v[68:71], v[104:107], v[40:43]
    ds_read_b128 v[164:167], v28 offset:0
    v_mfma_f32_16x16x32_bf16 v[44:47], v[68:71], v[108:111], v[44:47]
    v_mfma_f32_16x16x32_bf16 v[44:47], v[72:75], v[104:107], v[44:47]
    ds_read2_b32 v[136:137], v21 offset0:176 offset1:177
    v_mfma_f32_16x16x32_bf16 v[44:47], v[76:79], v[100:103], v[44:47]
    ds_read2_b32 v[138:139], v21 offset0:178 offset1:179
    s_waitcnt lgkmcnt(14)
    v_mfma_f32_16x16x32_bf16 v[48:51], v[80:83], v[100:103], v[48:51]
    ds_read_b128 v[168:171], v28 offset:2048
    v_mfma_f32_16x16x32_bf16 v[48:51], v[76:79], v[104:107], v[48:51]
    v_mfma_f32_16x16x32_bf16 v[48:51], v[72:75], v[108:111], v[48:51]
    ds_read2_b32 v[140:141], v22 offset0:48 offset1:49
    v_mfma_f32_16x16x32_bf16 v[48:51], v[68:71], v[112:115], v[48:51]
    ds_read2_b32 v[142:143], v22 offset0:50 offset1:51
    v_mfma_f32_16x16x32_bf16 v[52:55], v[68:71], v[116:119], v[52:55]
    ds_read_b128 v[172:175], v28 offset:4096
    v_mfma_f32_16x16x32_bf16 v[52:55], v[72:75], v[112:115], v[52:55]
    v_mfma_f32_16x16x32_bf16 v[52:55], v[76:79], v[108:111], v[52:55]
    ds_read2_b32 v[144:145], v22 offset0:176 offset1:177
    v_mfma_f32_16x16x32_bf16 v[52:55], v[80:83], v[104:107], v[52:55]
    ds_read2_b32 v[146:147], v22 offset0:178 offset1:179
    v_mfma_f32_16x16x32_bf16 v[52:55], v[84:87], v[100:103], v[52:55]
    ds_read_b128 v[176:179], v28 offset:6144
    s_waitcnt lgkmcnt(14)
    v_mfma_f32_16x16x32_bf16 v[56:59], v[88:91], v[100:103], v[56:59]
    v_mfma_f32_16x16x32_bf16 v[56:59], v[84:87], v[104:107], v[56:59]
    ds_read2_b32 v[148:149], v23 offset0:48 offset1:49
    v_mfma_f32_16x16x32_bf16 v[56:59], v[80:83], v[108:111], v[56:59]
    ds_read2_b32 v[150:151], v23 offset0:50 offset1:51
    v_mfma_f32_16x16x32_bf16 v[56:59], v[76:79], v[112:115], v[56:59]
    ds_read_b128 v[180:183], v28 offset:8192
    v_mfma_f32_16x16x32_bf16 v[56:59], v[72:75], v[116:119], v[56:59]
    v_mfma_f32_16x16x32_bf16 v[56:59], v[68:71], v[120:123], v[56:59]
    ds_read2_b32 v[152:153], v23 offset0:176 offset1:177
    v_mfma_f32_16x16x32_bf16 v[60:63], v[68:71], v[124:127], v[60:63]
    ds_read2_b32 v[154:155], v23 offset0:178 offset1:179
    v_mfma_f32_16x16x32_bf16 v[60:63], v[72:75], v[120:123], v[60:63]
    ds_read_b128 v[184:187], v28 offset:10240
    v_mfma_f32_16x16x32_bf16 v[60:63], v[76:79], v[116:119], v[60:63]
    v_mfma_f32_16x16x32_bf16 v[60:63], v[80:83], v[112:115], v[60:63]
    ds_read2_b32 v[156:157], v24 offset0:48 offset1:49
    v_mfma_f32_16x16x32_bf16 v[60:63], v[84:87], v[108:111], v[60:63]
    ds_read2_b32 v[158:159], v24 offset0:50 offset1:51
    v_mfma_f32_16x16x32_bf16 v[60:63], v[88:91], v[104:107], v[60:63]
    ds_read_b128 v[188:191], v28 offset:12288
    v_mfma_f32_16x16x32_bf16 v[60:63], v[92:95], v[100:103], v[60:63]
    s_waitcnt lgkmcnt(14)
    v_mfma_f32_16x16x32_bf16 v[64:67], v[96:99], v[100:103], v[64:67]
    ds_read2_b32 v[160:161], v24 offset0:176 offset1:177
    v_mfma_f32_16x16x32_bf16 v[64:67], v[92:95], v[104:107], v[64:67]
    ds_read2_b32 v[162:163], v24 offset0:178 offset1:179
    v_mfma_f32_16x16x32_bf16 v[64:67], v[88:91], v[108:111], v[64:67]
    ds_read_b128 v[192:195], v28 offset:14336
    v_mfma_f32_16x16x32_bf16 v[64:67], v[84:87], v[112:115], v[64:67]
    v_mfma_f32_16x16x32_bf16 v[64:67], v[80:83], v[116:119], v[64:67]
    v_mfma_f32_16x16x32_bf16 v[64:67], v[76:79], v[120:123], v[64:67]
    v_mfma_f32_16x16x32_bf16 v[64:67], v[72:75], v[124:127], v[64:67]
    v_mfma_f32_16x16x32_bf16 v[64:67], v[68:71], v[128:131], v[64:67]
    v_mfma_f32_16x16x32_bf16 v[36:39], v[132:135], v[164:167], v[36:39]
    ds_read2_b32 v[68:69], v21 offset0:64 offset1:65
    v_mfma_f32_16x16x32_bf16 v[40:43], v[136:139], v[164:167], v[40:43]
    ds_read2_b32 v[70:71], v21 offset0:66 offset1:67
    v_mfma_f32_16x16x32_bf16 v[40:43], v[132:135], v[168:171], v[40:43]
    ds_read_b128 v[100:103], v29 offset:0
    s_waitcnt lgkmcnt(14)
    v_mfma_f32_16x16x32_bf16 v[44:47], v[132:135], v[172:175], v[44:47]
    v_mfma_f32_16x16x32_bf16 v[44:47], v[136:139], v[168:171], v[44:47]
    ds_read2_b32 v[72:73], v21 offset0:192 offset1:193
    v_mfma_f32_16x16x32_bf16 v[44:47], v[140:143], v[164:167], v[44:47]
    ds_read2_b32 v[74:75], v21 offset0:194 offset1:195
    v_mfma_f32_16x16x32_bf16 v[48:51], v[144:147], v[164:167], v[48:51]
    ds_read_b128 v[104:107], v29 offset:2048
    v_mfma_f32_16x16x32_bf16 v[48:51], v[140:143], v[168:171], v[48:51]
    v_mfma_f32_16x16x32_bf16 v[48:51], v[136:139], v[172:175], v[48:51]
    ds_read2_b32 v[76:77], v22 offset0:64 offset1:65
    v_mfma_f32_16x16x32_bf16 v[48:51], v[132:135], v[176:179], v[48:51]
    ds_read2_b32 v[78:79], v22 offset0:66 offset1:67
    s_waitcnt lgkmcnt(14)
    v_mfma_f32_16x16x32_bf16 v[52:55], v[132:135], v[180:183], v[52:55]
    ds_read_b128 v[108:111], v29 offset:4096
    v_mfma_f32_16x16x32_bf16 v[52:55], v[136:139], v[176:179], v[52:55]
    v_mfma_f32_16x16x32_bf16 v[52:55], v[140:143], v[172:175], v[52:55]
    ds_read2_b32 v[80:81], v22 offset0:192 offset1:193
    v_mfma_f32_16x16x32_bf16 v[52:55], v[144:147], v[168:171], v[52:55]
    ds_read2_b32 v[82:83], v22 offset0:194 offset1:195
    v_mfma_f32_16x16x32_bf16 v[52:55], v[148:151], v[164:167], v[52:55]
    ds_read_b128 v[112:115], v29 offset:6144
    v_mfma_f32_16x16x32_bf16 v[56:59], v[152:155], v[164:167], v[56:59]
    v_mfma_f32_16x16x32_bf16 v[56:59], v[148:151], v[168:171], v[56:59]
    ds_read2_b32 v[84:85], v23 offset0:64 offset1:65
    v_mfma_f32_16x16x32_bf16 v[56:59], v[144:147], v[172:175], v[56:59]
    ds_read2_b32 v[86:87], v23 offset0:66 offset1:67
    v_mfma_f32_16x16x32_bf16 v[56:59], v[140:143], v[176:179], v[56:59]
    ds_read_b128 v[116:119], v29 offset:8192
    v_mfma_f32_16x16x32_bf16 v[56:59], v[136:139], v[180:183], v[56:59]
    v_mfma_f32_16x16x32_bf16 v[56:59], v[132:135], v[184:187], v[56:59]
    ds_read2_b32 v[88:89], v23 offset0:192 offset1:193
    s_waitcnt lgkmcnt(14)
    v_mfma_f32_16x16x32_bf16 v[60:63], v[132:135], v[188:191], v[60:63]
    ds_read2_b32 v[90:91], v23 offset0:194 offset1:195
    v_mfma_f32_16x16x32_bf16 v[60:63], v[136:139], v[184:187], v[60:63]
    ds_read_b128 v[120:123], v29 offset:10240
    v_mfma_f32_16x16x32_bf16 v[60:63], v[140:143], v[180:183], v[60:63]
    v_mfma_f32_16x16x32_bf16 v[60:63], v[144:147], v[176:179], v[60:63]
    ds_read2_b32 v[92:93], v24 offset0:64 offset1:65
    v_mfma_f32_16x16x32_bf16 v[60:63], v[148:151], v[172:175], v[60:63]
    ds_read2_b32 v[94:95], v24 offset0:66 offset1:67
    v_mfma_f32_16x16x32_bf16 v[60:63], v[152:155], v[168:171], v[60:63]
    ds_read_b128 v[124:127], v29 offset:12288
    v_mfma_f32_16x16x32_bf16 v[60:63], v[156:159], v[164:167], v[60:63]
    v_mfma_f32_16x16x32_bf16 v[64:67], v[160:163], v[164:167], v[64:67]
    ds_read2_b32 v[96:97], v24 offset0:192 offset1:193
    v_mfma_f32_16x16x32_bf16 v[64:67], v[156:159], v[168:171], v[64:67]
    ds_read2_b32 v[98:99], v24 offset0:194 offset1:195
    v_mfma_f32_16x16x32_bf16 v[64:67], v[152:155], v[172:175], v[64:67]
    ds_read_b128 v[128:131], v29 offset:14336
    v_mfma_f32_16x16x32_bf16 v[64:67], v[148:151], v[176:179], v[64:67]
    v_mfma_f32_16x16x32_bf16 v[64:67], v[144:147], v[180:183], v[64:67]
    v_mfma_f32_16x16x32_bf16 v[64:67], v[140:143], v[184:187], v[64:67]
    v_mfma_f32_16x16x32_bf16 v[64:67], v[136:139], v[188:191], v[64:67]
    v_mfma_f32_16x16x32_bf16 v[64:67], v[132:135], v[192:195], v[64:67]
    s_waitcnt lgkmcnt(14)
    v_mfma_f32_16x16x32_bf16 v[36:39], v[68:71], v[100:103], v[36:39]
    ds_read2_b32 v[132:133], v21 offset0:80 offset1:81
    v_mfma_f32_16x16x32_bf16 v[40:43], v[72:75], v[100:103], v[40:43]
    ds_read2_b32 v[134:135], v21 offset0:82 offset1:83
    v_mfma_f32_16x16x32_bf16 v[40:43], v[68:71], v[104:107], v[40:43]
    ds_read_b128 v[164:167], v30 offset:0
    v_mfma_f32_16x16x32_bf16 v[44:47], v[68:71], v[108:111], v[44:47]
    v_mfma_f32_16x16x32_bf16 v[44:47], v[72:75], v[104:107], v[44:47]
    ds_read2_b32 v[136:137], v21 offset0:208 offset1:209
    v_mfma_f32_16x16x32_bf16 v[44:47], v[76:79], v[100:103], v[44:47]
    ds_read2_b32 v[138:139], v21 offset0:210 offset1:211
    s_waitcnt lgkmcnt(14)
    v_mfma_f32_16x16x32_bf16 v[48:51], v[80:83], v[100:103], v[48:51]
    ds_read_b128 v[168:171], v30 offset:2048
    v_mfma_f32_16x16x32_bf16 v[48:51], v[76:79], v[104:107], v[48:51]
    v_mfma_f32_16x16x32_bf16 v[48:51], v[72:75], v[108:111], v[48:51]
    ds_read2_b32 v[140:141], v22 offset0:80 offset1:81
    v_mfma_f32_16x16x32_bf16 v[48:51], v[68:71], v[112:115], v[48:51]
    ds_read2_b32 v[142:143], v22 offset0:82 offset1:83
    v_mfma_f32_16x16x32_bf16 v[52:55], v[68:71], v[116:119], v[52:55]
    ds_read_b128 v[172:175], v30 offset:4096
    v_mfma_f32_16x16x32_bf16 v[52:55], v[72:75], v[112:115], v[52:55]
    v_mfma_f32_16x16x32_bf16 v[52:55], v[76:79], v[108:111], v[52:55]
    ds_read2_b32 v[144:145], v22 offset0:208 offset1:209
    v_mfma_f32_16x16x32_bf16 v[52:55], v[80:83], v[104:107], v[52:55]
    ds_read2_b32 v[146:147], v22 offset0:210 offset1:211
    v_mfma_f32_16x16x32_bf16 v[52:55], v[84:87], v[100:103], v[52:55]
    ds_read_b128 v[176:179], v30 offset:6144
    s_waitcnt lgkmcnt(14)
    v_mfma_f32_16x16x32_bf16 v[56:59], v[88:91], v[100:103], v[56:59]
    v_mfma_f32_16x16x32_bf16 v[56:59], v[84:87], v[104:107], v[56:59]
    ds_read2_b32 v[148:149], v23 offset0:80 offset1:81
    v_mfma_f32_16x16x32_bf16 v[56:59], v[80:83], v[108:111], v[56:59]
    ds_read2_b32 v[150:151], v23 offset0:82 offset1:83
    v_mfma_f32_16x16x32_bf16 v[56:59], v[76:79], v[112:115], v[56:59]
    ds_read_b128 v[180:183], v30 offset:8192
    v_mfma_f32_16x16x32_bf16 v[56:59], v[72:75], v[116:119], v[56:59]
    v_mfma_f32_16x16x32_bf16 v[56:59], v[68:71], v[120:123], v[56:59]
    ds_read2_b32 v[152:153], v23 offset0:208 offset1:209
    v_mfma_f32_16x16x32_bf16 v[60:63], v[68:71], v[124:127], v[60:63]
    ds_read2_b32 v[154:155], v23 offset0:210 offset1:211
    v_mfma_f32_16x16x32_bf16 v[60:63], v[72:75], v[120:123], v[60:63]
    ds_read_b128 v[184:187], v30 offset:10240
    v_mfma_f32_16x16x32_bf16 v[60:63], v[76:79], v[116:119], v[60:63]
    v_mfma_f32_16x16x32_bf16 v[60:63], v[80:83], v[112:115], v[60:63]
    ds_read2_b32 v[156:157], v24 offset0:80 offset1:81
    v_mfma_f32_16x16x32_bf16 v[60:63], v[84:87], v[108:111], v[60:63]
    ds_read2_b32 v[158:159], v24 offset0:82 offset1:83
    v_mfma_f32_16x16x32_bf16 v[60:63], v[88:91], v[104:107], v[60:63]
    ds_read_b128 v[188:191], v30 offset:12288
    v_mfma_f32_16x16x32_bf16 v[60:63], v[92:95], v[100:103], v[60:63]
    s_waitcnt lgkmcnt(14)
    v_mfma_f32_16x16x32_bf16 v[64:67], v[96:99], v[100:103], v[64:67]
    ds_read2_b32 v[160:161], v24 offset0:208 offset1:209
    v_mfma_f32_16x16x32_bf16 v[64:67], v[92:95], v[104:107], v[64:67]
    ds_read2_b32 v[162:163], v24 offset0:210 offset1:211
    v_mfma_f32_16x16x32_bf16 v[64:67], v[88:91], v[108:111], v[64:67]
    ds_read_b128 v[192:195], v30 offset:14336
    v_mfma_f32_16x16x32_bf16 v[64:67], v[84:87], v[112:115], v[64:67]
    v_mfma_f32_16x16x32_bf16 v[64:67], v[80:83], v[116:119], v[64:67]
    v_mfma_f32_16x16x32_bf16 v[64:67], v[76:79], v[120:123], v[64:67]
    v_mfma_f32_16x16x32_bf16 v[64:67], v[72:75], v[124:127], v[64:67]
    v_mfma_f32_16x16x32_bf16 v[64:67], v[68:71], v[128:131], v[64:67]
    v_mfma_f32_16x16x32_bf16 v[36:39], v[132:135], v[164:167], v[36:39]
    ds_read2_b32 v[68:69], v21 offset0:96 offset1:97
    v_mfma_f32_16x16x32_bf16 v[40:43], v[136:139], v[164:167], v[40:43]
    ds_read2_b32 v[70:71], v21 offset0:98 offset1:99
    v_mfma_f32_16x16x32_bf16 v[40:43], v[132:135], v[168:171], v[40:43]
    ds_read_b128 v[100:103], v31 offset:0
    s_waitcnt lgkmcnt(14)
    v_mfma_f32_16x16x32_bf16 v[44:47], v[132:135], v[172:175], v[44:47]
    v_mfma_f32_16x16x32_bf16 v[44:47], v[136:139], v[168:171], v[44:47]
    ds_read2_b32 v[72:73], v21 offset0:224 offset1:225
    v_mfma_f32_16x16x32_bf16 v[44:47], v[140:143], v[164:167], v[44:47]
    ds_read2_b32 v[74:75], v21 offset0:226 offset1:227
    v_mfma_f32_16x16x32_bf16 v[48:51], v[144:147], v[164:167], v[48:51]
    ds_read_b128 v[104:107], v31 offset:2048
    v_mfma_f32_16x16x32_bf16 v[48:51], v[140:143], v[168:171], v[48:51]
    v_mfma_f32_16x16x32_bf16 v[48:51], v[136:139], v[172:175], v[48:51]
    ds_read2_b32 v[76:77], v22 offset0:96 offset1:97
    v_mfma_f32_16x16x32_bf16 v[48:51], v[132:135], v[176:179], v[48:51]
    ds_read2_b32 v[78:79], v22 offset0:98 offset1:99
    s_waitcnt lgkmcnt(14)
    v_mfma_f32_16x16x32_bf16 v[52:55], v[132:135], v[180:183], v[52:55]
    ds_read_b128 v[108:111], v31 offset:4096
    v_mfma_f32_16x16x32_bf16 v[52:55], v[136:139], v[176:179], v[52:55]
    v_mfma_f32_16x16x32_bf16 v[52:55], v[140:143], v[172:175], v[52:55]
    ds_read2_b32 v[80:81], v22 offset0:224 offset1:225
    v_mfma_f32_16x16x32_bf16 v[52:55], v[144:147], v[168:171], v[52:55]
    ds_read2_b32 v[82:83], v22 offset0:226 offset1:227
    v_mfma_f32_16x16x32_bf16 v[52:55], v[148:151], v[164:167], v[52:55]
    ds_read_b128 v[112:115], v31 offset:6144
    v_mfma_f32_16x16x32_bf16 v[56:59], v[152:155], v[164:167], v[56:59]
    v_mfma_f32_16x16x32_bf16 v[56:59], v[148:151], v[168:171], v[56:59]
    ds_read2_b32 v[84:85], v23 offset0:96 offset1:97
    v_mfma_f32_16x16x32_bf16 v[56:59], v[144:147], v[172:175], v[56:59]
    ds_read2_b32 v[86:87], v23 offset0:98 offset1:99
    v_mfma_f32_16x16x32_bf16 v[56:59], v[140:143], v[176:179], v[56:59]
    ds_read_b128 v[116:119], v31 offset:8192
    v_mfma_f32_16x16x32_bf16 v[56:59], v[136:139], v[180:183], v[56:59]
    v_mfma_f32_16x16x32_bf16 v[56:59], v[132:135], v[184:187], v[56:59]
    ds_read2_b32 v[88:89], v23 offset0:224 offset1:225
    s_waitcnt lgkmcnt(14)
    v_mfma_f32_16x16x32_bf16 v[60:63], v[132:135], v[188:191], v[60:63]
    ds_read2_b32 v[90:91], v23 offset0:226 offset1:227
    v_mfma_f32_16x16x32_bf16 v[60:63], v[136:139], v[184:187], v[60:63]
    ds_read_b128 v[120:123], v31 offset:10240
    v_mfma_f32_16x16x32_bf16 v[60:63], v[140:143], v[180:183], v[60:63]
    v_mfma_f32_16x16x32_bf16 v[60:63], v[144:147], v[176:179], v[60:63]
    ds_read2_b32 v[92:93], v24 offset0:96 offset1:97
    v_mfma_f32_16x16x32_bf16 v[60:63], v[148:151], v[172:175], v[60:63]
    ds_read2_b32 v[94:95], v24 offset0:98 offset1:99
    v_mfma_f32_16x16x32_bf16 v[60:63], v[152:155], v[168:171], v[60:63]
    ds_read_b128 v[124:127], v31 offset:12288
    v_mfma_f32_16x16x32_bf16 v[60:63], v[156:159], v[164:167], v[60:63]
    v_mfma_f32_16x16x32_bf16 v[64:67], v[160:163], v[164:167], v[64:67]
    ds_read2_b32 v[96:97], v24 offset0:224 offset1:225
    v_mfma_f32_16x16x32_bf16 v[64:67], v[156:159], v[168:171], v[64:67]
    ds_read2_b32 v[98:99], v24 offset0:226 offset1:227
    v_mfma_f32_16x16x32_bf16 v[64:67], v[152:155], v[172:175], v[64:67]
    ds_read_b128 v[128:131], v31 offset:14336
    v_mfma_f32_16x16x32_bf16 v[64:67], v[148:151], v[176:179], v[64:67]
    v_mfma_f32_16x16x32_bf16 v[64:67], v[144:147], v[180:183], v[64:67]
    v_mfma_f32_16x16x32_bf16 v[64:67], v[140:143], v[184:187], v[64:67]
    v_mfma_f32_16x16x32_bf16 v[64:67], v[136:139], v[188:191], v[64:67]
    v_mfma_f32_16x16x32_bf16 v[64:67], v[132:135], v[192:195], v[64:67]
    s_waitcnt lgkmcnt(14)
    v_mfma_f32_16x16x32_bf16 v[36:39], v[68:71], v[100:103], v[36:39]
    ds_read2_b32 v[132:133], v21 offset0:112 offset1:113
    v_mfma_f32_16x16x32_bf16 v[40:43], v[72:75], v[100:103], v[40:43]
    ds_read2_b32 v[134:135], v21 offset0:114 offset1:115
    v_mfma_f32_16x16x32_bf16 v[40:43], v[68:71], v[104:107], v[40:43]
    ds_read_b128 v[164:167], v32 offset:0
    v_mfma_f32_16x16x32_bf16 v[44:47], v[68:71], v[108:111], v[44:47]
    v_mfma_f32_16x16x32_bf16 v[44:47], v[72:75], v[104:107], v[44:47]
    ds_read2_b32 v[136:137], v21 offset0:240 offset1:241
    v_mfma_f32_16x16x32_bf16 v[44:47], v[76:79], v[100:103], v[44:47]
    ds_read2_b32 v[138:139], v21 offset0:242 offset1:243
    s_waitcnt lgkmcnt(14)
    v_mfma_f32_16x16x32_bf16 v[48:51], v[80:83], v[100:103], v[48:51]
    ds_read_b128 v[168:171], v32 offset:2048
    v_mfma_f32_16x16x32_bf16 v[48:51], v[76:79], v[104:107], v[48:51]
    v_mfma_f32_16x16x32_bf16 v[48:51], v[72:75], v[108:111], v[48:51]
    ds_read2_b32 v[140:141], v22 offset0:112 offset1:113
    v_mfma_f32_16x16x32_bf16 v[48:51], v[68:71], v[112:115], v[48:51]
    ds_read2_b32 v[142:143], v22 offset0:114 offset1:115
    v_mfma_f32_16x16x32_bf16 v[52:55], v[68:71], v[116:119], v[52:55]
    ds_read_b128 v[172:175], v32 offset:4096
    v_mfma_f32_16x16x32_bf16 v[52:55], v[72:75], v[112:115], v[52:55]
    v_mfma_f32_16x16x32_bf16 v[52:55], v[76:79], v[108:111], v[52:55]
    ds_read2_b32 v[144:145], v22 offset0:240 offset1:241
    v_mfma_f32_16x16x32_bf16 v[52:55], v[80:83], v[104:107], v[52:55]
    ds_read2_b32 v[146:147], v22 offset0:242 offset1:243
    v_mfma_f32_16x16x32_bf16 v[52:55], v[84:87], v[100:103], v[52:55]
    ds_read_b128 v[176:179], v32 offset:6144
    s_waitcnt lgkmcnt(14)
    v_mfma_f32_16x16x32_bf16 v[56:59], v[88:91], v[100:103], v[56:59]
    v_mfma_f32_16x16x32_bf16 v[56:59], v[84:87], v[104:107], v[56:59]
    ds_read2_b32 v[148:149], v23 offset0:112 offset1:113
    v_mfma_f32_16x16x32_bf16 v[56:59], v[80:83], v[108:111], v[56:59]
    ds_read2_b32 v[150:151], v23 offset0:114 offset1:115
    v_mfma_f32_16x16x32_bf16 v[56:59], v[76:79], v[112:115], v[56:59]
    ds_read_b128 v[180:183], v32 offset:8192
    v_mfma_f32_16x16x32_bf16 v[56:59], v[72:75], v[116:119], v[56:59]
    v_mfma_f32_16x16x32_bf16 v[56:59], v[68:71], v[120:123], v[56:59]
    ds_read2_b32 v[152:153], v23 offset0:240 offset1:241
    v_mfma_f32_16x16x32_bf16 v[60:63], v[68:71], v[124:127], v[60:63]
    ds_read2_b32 v[154:155], v23 offset0:242 offset1:243
    v_mfma_f32_16x16x32_bf16 v[60:63], v[72:75], v[120:123], v[60:63]
    ds_read_b128 v[184:187], v32 offset:10240
    v_mfma_f32_16x16x32_bf16 v[60:63], v[76:79], v[116:119], v[60:63]
    v_mfma_f32_16x16x32_bf16 v[60:63], v[80:83], v[112:115], v[60:63]
    ds_read2_b32 v[156:157], v24 offset0:112 offset1:113
    v_mfma_f32_16x16x32_bf16 v[60:63], v[84:87], v[108:111], v[60:63]
    ds_read2_b32 v[158:159], v24 offset0:114 offset1:115
    v_mfma_f32_16x16x32_bf16 v[60:63], v[88:91], v[104:107], v[60:63]
    ds_read_b128 v[188:191], v32 offset:12288
    v_mfma_f32_16x16x32_bf16 v[60:63], v[92:95], v[100:103], v[60:63]
    s_waitcnt lgkmcnt(14)
    v_mfma_f32_16x16x32_bf16 v[64:67], v[96:99], v[100:103], v[64:67]
    ds_read2_b32 v[160:161], v24 offset0:240 offset1:241
    v_mfma_f32_16x16x32_bf16 v[64:67], v[92:95], v[104:107], v[64:67]
    ds_read2_b32 v[162:163], v24 offset0:242 offset1:243
    v_mfma_f32_16x16x32_bf16 v[64:67], v[88:91], v[108:111], v[64:67]
    ds_read_b128 v[192:195], v32 offset:14336
    v_mfma_f32_16x16x32_bf16 v[64:67], v[84:87], v[112:115], v[64:67]
    v_mfma_f32_16x16x32_bf16 v[64:67], v[80:83], v[116:119], v[64:67]
    v_mfma_f32_16x16x32_bf16 v[64:67], v[76:79], v[120:123], v[64:67]
    v_mfma_f32_16x16x32_bf16 v[64:67], v[72:75], v[124:127], v[64:67]
    v_mfma_f32_16x16x32_bf16 v[64:67], v[68:71], v[128:131], v[64:67]
    v_mfma_f32_16x16x32_bf16 v[36:39], v[132:135], v[164:167], v[36:39]
    v_mfma_f32_16x16x32_bf16 v[40:43], v[136:139], v[164:167], v[40:43]
    v_mfma_f32_16x16x32_bf16 v[40:43], v[132:135], v[168:171], v[40:43]
    s_waitcnt lgkmcnt(14)
    v_mfma_f32_16x16x32_bf16 v[44:47], v[132:135], v[172:175], v[44:47]
    v_mfma_f32_16x16x32_bf16 v[44:47], v[136:139], v[168:171], v[44:47]
    v_mfma_f32_16x16x32_bf16 v[44:47], v[140:143], v[164:167], v[44:47]
    s_waitcnt lgkmcnt(13)
    v_mfma_f32_16x16x32_bf16 v[48:51], v[144:147], v[164:167], v[48:51]
    v_mfma_f32_16x16x32_bf16 v[48:51], v[140:143], v[168:171], v[48:51]
    s_waitcnt lgkmcnt(0)
    v_cvt_pk_bf16_f32 v68, v39, v38
    v_cvt_pk_bf16_f32 v69, v37, v36
    v_mfma_f32_16x16x32_bf16 v[48:51], v[136:139], v[172:175], v[48:51]
    ds_write_b64 v20, v[68:69] offset:0
    v_cvt_pk_bf16_f32 v70, v43, v42
    v_mfma_f32_16x16x32_bf16 v[48:51], v[132:135], v[176:179], v[48:51]
    v_cvt_pk_bf16_f32 v71, v41, v40
    ds_write_b64 v20, v[70:71] offset:2048
    v_mfma_f32_16x16x32_bf16 v[52:55], v[132:135], v[180:183], v[52:55]
    v_mfma_f32_16x16x32_bf16 v[52:55], v[136:139], v[176:179], v[52:55]
    v_cvt_pk_bf16_f32 v72, v47, v46
    v_cvt_pk_bf16_f32 v73, v45, v44
    v_mfma_f32_16x16x32_bf16 v[52:55], v[140:143], v[172:175], v[52:55]
    ds_write_b64 v20, v[72:73] offset:4096
    v_mfma_f32_16x16x32_bf16 v[52:55], v[144:147], v[168:171], v[52:55]
    v_mfma_f32_16x16x32_bf16 v[52:55], v[148:151], v[164:167], v[52:55]
    v_mfma_f32_16x16x32_bf16 v[56:59], v[152:155], v[164:167], v[56:59]
    v_cvt_pk_bf16_f32 v74, v51, v50
    v_cvt_pk_bf16_f32 v75, v49, v48
    v_mfma_f32_16x16x32_bf16 v[56:59], v[148:151], v[168:171], v[56:59]
    ds_write_b64 v20, v[74:75] offset:6144
    v_mfma_f32_16x16x32_bf16 v[56:59], v[144:147], v[172:175], v[56:59]
    v_mfma_f32_16x16x32_bf16 v[56:59], v[140:143], v[176:179], v[56:59]
    v_mfma_f32_16x16x32_bf16 v[56:59], v[136:139], v[180:183], v[56:59]
    v_mfma_f32_16x16x32_bf16 v[56:59], v[132:135], v[184:187], v[56:59]
    v_cvt_pk_bf16_f32 v76, v55, v54
    v_cvt_pk_bf16_f32 v77, v53, v52
    v_mfma_f32_16x16x32_bf16 v[60:63], v[132:135], v[188:191], v[60:63]
    ds_write_b64 v20, v[76:77] offset:8192
    v_mfma_f32_16x16x32_bf16 v[60:63], v[136:139], v[184:187], v[60:63]
    v_mfma_f32_16x16x32_bf16 v[60:63], v[140:143], v[180:183], v[60:63]
    v_mfma_f32_16x16x32_bf16 v[60:63], v[144:147], v[176:179], v[60:63]
    v_mfma_f32_16x16x32_bf16 v[60:63], v[148:151], v[172:175], v[60:63]
    v_mfma_f32_16x16x32_bf16 v[60:63], v[152:155], v[168:171], v[60:63]
    v_cvt_pk_bf16_f32 v78, v59, v58
    v_cvt_pk_bf16_f32 v79, v57, v56
    v_mfma_f32_16x16x32_bf16 v[60:63], v[156:159], v[164:167], v[60:63]
    ds_write_b64 v20, v[78:79] offset:10240
    v_mfma_f32_16x16x32_bf16 v[64:67], v[160:163], v[164:167], v[64:67]
    v_mfma_f32_16x16x32_bf16 v[64:67], v[156:159], v[168:171], v[64:67]
    v_mfma_f32_16x16x32_bf16 v[64:67], v[152:155], v[172:175], v[64:67]
    v_mfma_f32_16x16x32_bf16 v[64:67], v[148:151], v[176:179], v[64:67]
    v_mfma_f32_16x16x32_bf16 v[64:67], v[144:147], v[180:183], v[64:67]
    v_mfma_f32_16x16x32_bf16 v[64:67], v[140:143], v[184:187], v[64:67]
    s_nop 0
    v_cvt_pk_bf16_f32 v80, v63, v62
    v_cvt_pk_bf16_f32 v81, v61, v60
    v_mfma_f32_16x16x32_bf16 v[64:67], v[136:139], v[188:191], v[64:67]
    ds_write_b64 v20, v[80:81] offset:12288
    v_mfma_f32_16x16x32_bf16 v[64:67], v[132:135], v[192:195], v[64:67]
    s_nop 7
    v_cvt_pk_bf16_f32 v82, v67, v66
    v_cvt_pk_bf16_f32 v83, v65, v64
    ds_write_b64 v20, v[82:83] offset:14336
    s_mov_b64 exec, 1
    ds_add_u32 v18, v19 offset:12
    s_mov_b64 exec, -1
    s_add_u32 s80, s86, 94208
    v_add_u32 v5, s80, v15
    s_branch LA_s3_in
LA_s3:
    s_sleep 1
LA_s3_in:
    ds_read_b32 v6, v18 offset:12
    ds_read_b128 v[84:87], v5 offset:0
    ds_read_b128 v[88:91], v5 offset:4096
    ds_read_b128 v[92:95], v5 offset:8192
    ds_read_b128 v[96:99], v5 offset:12288
    s_waitcnt lgkmcnt(0)
    v_readfirstlane_b32 s78, v6
    s_nop 0
    s_cmp_ge_u32 s78, 4
    s_cbranch_scc0 LA_s3
    s_add_u32 s89, s91, 4194304
    buffer_store_dwordx4 v[84:87], v14, s[52:55], s89 offen sc1
    s_add_u32 s89, s91, 4198400
    buffer_store_dwordx4 v[88:91], v14, s[52:55], s89 offen sc1
    s_add_u32 s89, s91, 4202496
    buffer_store_dwordx4 v[92:95], v14, s[52:55], s89 offen sc1
    s_add_u32 s89, s91, 4206592
    buffer_store_dwordx4 v[96:99], v14, s[52:55], s89 offen sc1
    s_add_u32 s80, s86, 129024
    v_add_u32 v5, s80, v15
    s_waitcnt vmcnt(9)
    ds_write_b128 v5, v[228:231] offset:0
    s_waitcnt vmcnt(8)
    ds_write_b128 v5, v[232:235] offset:4096
    s_waitcnt vmcnt(7)
    ds_write_b128 v5, v[240:243] offset:8192
    s_waitcnt vmcnt(6)
    ds_write_b128 v5, v[244:247] offset:12288
    s_waitcnt vmcnt(5)
    ds_write_b128 v5, v[248:251] offset:16384
    s_waitcnt vmcnt(4)
    ds_write_b128 v5, v[196:199] offset:20480
    s_mov_b64 exec, 1
    ds_add_u32 v18, v19 offset:32
    s_mov_b64 exec, -1
    s_setprio 0
    s_mov_b32 s60, s22
    s_mov_b32 s61, s23
    s_mov_b32 s62, 0x800000
    s_mov_b32 s63, 0x20000
    s_lshr_b32 s81, s91, 4
    s_lshl_b32 s82, s3, 8
    s_add_u32 s81, s81, s82
    s_add_u32 s81, s81, 12648448
    s_lshl_b32 s80, s74, 14
    s_and_b32 s82, s75, 3
    s_lshl_b32 s82, s82, 8
    s_add_u32 s80, s80, s82
    s_add_u32 s80, s80, 12648448
    v_mov_b32 v5, 0
    v_lshlrev_b32 v7, 10, v0
    v_lshlrev_b32 v132, 16, v212
    v_and_b32 v133, 0xffff0000, v212
    v_lshlrev_b32 v134, 16, v213
    v_and_b32 v135, 0xffff0000, v213
    v_lshlrev_b32 v136, 16, v214
    v_and_b32 v137, 0xffff0000, v214
    v_lshlrev_b32 v138, 16, v215
    v_and_b32 v139, 0xffff0000, v215
    v_lshlrev_b32 v140, 16, v216
    v_and_b32 v141, 0xffff0000, v216
    v_lshlrev_b32 v142, 16, v217
    v_and_b32 v143, 0xffff0000, v217
    v_lshlrev_b32 v144, 16, v218
    v_and_b32 v145, 0xffff0000, v218
    v_lshlrev_b32 v146, 16, v219
    v_and_b32 v147, 0xffff0000, v219
    v_lshlrev_b32 v148, 16, v220
    v_and_b32 v149, 0xffff0000, v220
    v_lshlrev_b32 v150, 16, v221
    v_and_b32 v151, 0xffff0000, v221
    v_lshlrev_b32 v152, 16, v222
    v_and_b32 v153, 0xffff0000, v222
    v_lshlrev_b32 v154, 16, v223
    v_and_b32 v155, 0xffff0000, v223
    v_lshlrev_b32 v156, 16, v224
    v_and_b32 v157, 0xffff0000, v224
    v_lshlrev_b32 v158, 16, v225
    v_and_b32 v159, 0xffff0000, v225
    v_lshlrev_b32 v160, 16, v226
    v_and_b32 v161, 0xffff0000, v226
    v_lshlrev_b32 v162, 16, v227
    v_and_b32 v163, 0xffff0000, v227
    s_waitcnt vmcnt(0)
    s_mov_b64 exec, 1
    buffer_store_dword v19, v5, s[52:55], s81 offen sc1
    s_mov_b64 exec, 0xffff
    s_waitcnt vmcnt(0)
    s_branch LA_s7a_in
LA_s7a:
    s_sleep 1
LA_s7a_in:
    ds_read_b32 v6, v18 offset:28
    s_waitcnt lgkmcnt(0)
    v_readfirstlane_b32 s78, v6
    s_nop 0
    s_cmp_ge_u32 s78, 4
    s_cbranch_scc0 LA_s7a
    s_setprio 2
    s_mov_b32 s79, 0
LA_py:
    buffer_load_dword v6, v7, s[52:55], s80 offen sc1
    s_add_u32 s79, s79, 1
    s_cmp_gt_u32 s79, 200000
    s_cbranch_scc1 LA_py_x
    s_waitcnt vmcnt(0)
    v_cmp_ne_u32 vcc, 1, v6
    s_cbranch_vccz LA_py_x
    s_mov_b64 exec, vcc
    s_sleep 8
    s_branch LA_py
LA_py_x:
    s_waitcnt vmcnt(0)
    s_mov_b64 exec, -1
    s_mov_b32 s89, 4194304
    buffer_load_dwordx4 v[100:103], v12, s[52:55], s89 offen sc1
    s_mov_b32 s89, 4210688
    buffer_load_dwordx4 v[104:107], v12, s[52:55], s89 offen sc1
    s_mov_b32 s89, 4227072
    buffer_load_dwordx4 v[108:111], v12, s[52:55], s89 offen sc1
    s_mov_b32 s89, 4243456
    buffer_load_dwordx4 v[112:115], v12, s[52:55], s89 offen sc1
    s_waitcnt vmcnt(3)
    v_permlane32_swap_b32 v102, v100
    v_permlane32_swap_b32 v103, v101
    s_waitcnt vmcnt(2)
    v_permlane32_swap_b32 v106, v104
    v_permlane32_swap_b32 v107, v105
    s_waitcnt vmcnt(1)
    v_permlane32_swap_b32 v110, v108
    v_permlane32_swap_b32 v111, v109
    s_waitcnt vmcnt(0)
    v_permlane32_swap_b32 v114, v112
    v_permlane32_swap_b32 v115, v113
    v_and_b32 v68, 0xffff0000, v103
    v_and_b32 v69, 0xffff0000, v107
    v_and_b32 v70, 0xffff0000, v111
    v_and_b32 v71, 0xffff0000, v115
    v_and_b32 v72, 0xffff0000, v101
    v_and_b32 v73, 0xffff0000, v105
    v_and_b32 v74, 0xffff0000, v109
    v_and_b32 v75, 0xffff0000, v113
    v_mul_f32 v68, v68, v132
    v_mul_f32 v69, v69, v133
    v_mul_f32 v70, v70, v134
    v_mul_f32 v71, v71, v135
    v_mul_f32 v72, v72, v136
    v_mul_f32 v73, v73, v137
    v_mul_f32 v74, v74, v138
    v_mul_f32 v75, v75, v139
    v_cvt_pk_bf16_f32 v36, v68, v69
    v_cvt_pk_bf16_f32 v37, v70, v71
    v_cvt_pk_bf16_f32 v38, v72, v73
    v_cvt_pk_bf16_f32 v39, v74, v75
    s_mov_b32 s89, 0
    buffer_store_dwordx4 v[36:39], v13, s[60:63], s89 offen nt sc1
    v_lshlrev_b32 v68, 16, v103
    v_lshlrev_b32 v69, 16, v107
    v_lshlrev_b32 v70, 16, v111
    v_lshlrev_b32 v71, 16, v115
    v_lshlrev_b32 v72, 16, v101
    v_lshlrev_b32 v73, 16, v105
    v_lshlrev_b32 v74, 16, v109
    v_lshlrev_b32 v75, 16, v113
    v_mul_f32 v68, v68, v140
    v_mul_f32 v69, v69, v141
    v_mul_f32 v70, v70, v142
    v_mul_f32 v71, v71, v143
    v_mul_f32 v72, v72, v144
    v_mul_f32 v73, v73, v145
    v_mul_f32 v74, v74, v146
    v_mul_f32 v75, v75, v147
    v_cvt_pk_bf16_f32 v40, v68, v69
    v_cvt_pk_bf16_f32 v41, v70, v71
    v_cvt_pk_bf16_f32 v42, v72, v73
    v_cvt_pk_bf16_f32 v43, v74, v75
    s_mov_b32 s89, 4096
    buffer_store_dwordx4 v[40:43], v13, s[60:63], s89 offen nt sc1
    v_and_b32 v68, 0xffff0000, v102
    v_and_b32 v69, 0xffff0000, v106
    v_and_b32 v70, 0xffff0000, v110
    v_and_b32 v71, 0xffff0000, v114
    v_and_b32 v72, 0xffff0000, v100
    v_and_b32 v73, 0xffff0000, v104
    v_and_b32 v74, 0xffff0000, v108
    v_and_b32 v75, 0xffff0000, v112
    v_mul_f32 v68, v68, v148
    v_mul_f32 v69, v69, v149
    v_mul_f32 v70, v70, v150
    v_mul_f32 v71, v71, v151
    v_mul_f32 v72, v72, v152
    v_mul_f32 v73, v73, v153
    v_mul_f32 v74, v74, v154
    v_mul_f32 v75, v75, v155
    v_cvt_pk_bf16_f32 v44, v68, v69
    v_cvt_pk_bf16_f32 v45, v70, v71
    v_cvt_pk_bf16_f32 v46, v72, v73
    v_cvt_pk_bf16_f32 v47, v74, v75
    s_mov_b32 s89, 8192
    buffer_store_dwordx4 v[44:47], v13, s[60:63], s89 offen nt sc1
    v_lshlrev_b32 v68, 16, v102
    v_lshlrev_b32 v69, 16, v106
    v_lshlrev_b32 v70, 16, v110
    v_lshlrev_b32 v71, 16, v114
    v_lshlrev_b32 v72, 16, v100
    v_lshlrev_b32 v73, 16, v104
    v_lshlrev_b32 v74, 16, v108
    v_lshlrev_b32 v75, 16, v112
    v_mul_f32 v68, v68, v156
    v_mul_f32 v69, v69, v157
    v_mul_f32 v70, v70, v158
    v_mul_f32 v71, v71, v159
    v_mul_f32 v72, v72, v160
    v_mul_f32 v73, v73, v161
    v_mul_f32 v74, v74, v162
    v_mul_f32 v75, v75, v163
    v_cvt_pk_bf16_f32 v48, v68, v69
    v_cvt_pk_bf16_f32 v49, v70, v71
    v_cvt_pk_bf16_f32 v50, v72, v73
    v_cvt_pk_bf16_f32 v51, v74, v75
    s_mov_b32 s89, 12288
    buffer_store_dwordx4 v[48:51], v13, s[60:63], s89 offen nt sc1
    s_endpgm
L_B:
    s_setprio 3
    s_and_b32 s3, s3, 3
    s_add_u32 s79, s72, s73
    s_add_u32 s78, s72, 5
    s_and_b32 s78, s78, 7
    s_lshl_b32 s78, s78, 1
    s_and_b32 s75, s79, 1
    s_add_u32 s78, s78, s75
    s_andn2_b32 s79, 2, s79
    s_lshl_b32 s79, s79, 3
    s_add_u32 s78, s78, s79
    s_and_b32 s76, s78, 3
    s_and_b32 s79, s73, 12
    s_add_u32 s76, s76, s79
    s_lshr_b32 s74, s78, 4
    s_add_u32 s74, s74, s79
    s_and_b32 s79, s72, 8
    s_lshr_b32 s77, s78, 2
    s_add_u32 s77, s77, s79
    s_lshr_b32 s79, s79, 2
    s_add_u32 s74, s74, s79
    s_xor_b32 s74, s74, 6
    s_and_b32 s75, s78, 15
    s_lshr_b32 s86, s3, 1
    s_and_b32 s87, s3, 1
    v_mov_b32 v10, 162304
    v_mov_b32 v11, 1
    v_lshlrev_b32 v12, 4, v0
    v_lshl_add_u32 v13, v0, 2, v10
    v_mov_b32 v14, 0
    ds_write_b32 v13, v14
    s_lshl_b32 s78, s74, 4
    s_add_u32 s78, s78, s75
    s_lshl_b32 s96, s78, 8
    s_add_u32 s96, s96, 12582912
    s_lshl_b32 s78, s78, 2
    s_add_u32 s78, s78, s3
    s_lshl_b32 s78, s78, 8
    s_add_u32 s80, s78, 12648448
    s_lshl_b32 s81, s72, 1
    s_add_u32 s81, s81, s86
    s_lshl_b32 s97, s81, 4
    s_add_u32 s97, s97, s73
    s_lshl_b32 s97, s97, 8
    s_add_u32 s97, s97, 12910464
    v_mov_b32 v15, s80
    v_mov_b32 v223, s97
    v_cmp_gt_u32 vcc, 8, v0
    s_nop 1
    v_cndmask_b32 v15, v223, v15, vcc
    v_add_u32 v221, v15, v12
    s_lshl_b32 s78, s87, 2
    s_add_u32 s78, s78, 128
    s_add_u32 s97, s97, s78
    s_lshl_b32 s82, s73, 1
    s_add_u32 s82, s82, s87
    s_lshl_b32 s78, s81, 7
    s_add_u32 s78, s78, s82
    s_lshl_b32 s94, s78, 10
    s_add_u32 s94, s94, 16777216
    v_mov_b32 v212, 0
    v_mov_b32 v213, 0
    v_mov_b32 v214, 0
    v_mov_b32 v215, 0
    v_mov_b32 v220, 0
    s_waitcnt lgkmcnt(0)
    s_mov_b32 s52, s26
    s_mov_b32 s53, s27
    s_mov_b32 s54, 0x1800000
    s_mov_b32 s55, 0x20000
    s_mov_b32 s68, s24
    s_mov_b32 s69, s25
    s_mov_b32 s70, 0x100
    s_mov_b32 s71, 0x20000
    s_lshl_b32 s98, s74, 4
    s_or_b32 s78, s75, s3
    s_cmp_lg_u32 s78, 0
    s_cbranch_scc1 LB_notag
    s_mov_b64 exec, 0xffff
    v_lshlrev_b32 v15, 8, v0
    buffer_load_dword v251, v15, s[52:55], s96 offen sc1
LB_notag:
    s_lshl_b32 s78, s87, 3
    s_lshr_b32 exec_lo, 0xffff, s78
    s_mov_b32 exec_hi, 0
    buffer_store_dwordx4 v[212:215], v221, s[52:55], 0 offen sc1
    s_mov_b64 exec, -1
    v_and_b32 v13, 15, v0
    v_lshrrev_b32 v14, 4, v0
    v_lshrrev_b32 v15, 1, v13
    v_xor_b32 v15, v15, v14
    v_lshlrev_b32 v15, 4, v15
    v_lshl_add_u32 v15, v13, 7, v15
    v_add_u32 v2, 73728, v15
    v_xor_b32 v3, 64, v2
    s_lshl_b32 s78, s86, 13
    s_add_u32 s78, s78, 2048
    v_add_u32 v4, s78, v2
    v_add_u32 v5, s78, v3
    v_bfe_u32 v15, v0, 3, 2
    s_lshl_b32 s78, s87, 1
    s_add_u32 s78, s78, s86
    v_xor_b32 v15, s78, v15
    v_lshlrev_b32 v15, 5, v15
    v_and_b32 v223, 3, v0
    v_lshl_add_u32 v15, v223, 3, v15
    v_bfe_u32 v223, v0, 2, 2
    v_lshl_add_u32 v15, v223, 7, v15
    v_mul_u32_u24 v223, 3072, v14
    v_add_u32 v6, v223, v15
    v_xor_b32 v7, 32, v6
    s_mov_b32 s60, s22
    s_mov_b32 s61, s23
    s_mov_b32 s62, 0x800000
    s_mov_b32 s63, 0x20000
    v_and_b32 v15, 1, v13
    v_cmp_eq_u32 s[88:89], 1, v15
    v_lshl_add_u32 v15, v14, 2, v15
    v_cmp_le_u32 s[90:91], v15, v13
    v_add_u32 v15, 2, v15
    v_cmp_le_u32 s[92:93], v15, v13
    v_mov_b32 v212, 0x0c0c0c0c
    v_mov_b32 v15, 0xc0c0100
    v_mov_b32 v223, 0x1000c0c
    v_cndmask_b32 v15, v15, v223, s[88:89]
    v_cndmask_b32 v208, v15, v212, s[90:91]
    v_cndmask_b32 v210, v212, v15, s[90:91]
    v_mov_b32 v15, 0xc0c0302
    v_mov_b32 v223, 0x3020c0c
    v_cndmask_b32 v15, v15, v223, s[88:89]
    v_cndmask_b32 v209, v15, v212, s[92:93]
    v_cndmask_b32 v211, v212, v15, s[92:93]
    s_or_b32 s78, s72, s86
    s_cmp_eq_u32 s78, 0
    s_cselect_b32 s78, 0xf149f2ca, 0
    v_mov_b32 v212, s78
    v_mov_b32 v213, s78
    v_mov_b32 v214, s78
    v_mov_b32 v215, s78
    s_lshl_b32 s78, s87, 12
    s_add_u32 s78, s78, 24576
    s_lshl_b32 s79, s86, 9
    s_add_u32 s79, s79, s78
    v_lshlrev_b32 v15, 3, v0
    v_add_u32 v216, s79, v15
    s_lshl_b32 s80, s86, 11
    v_add_u32 v218, s80, v216
    v_xor_b32 v219, 512, v218
    s_add_u32 s78, s78, 2048
    s_cmp_eq_u32 s86, 0
    s_cselect_b32 s78, s78, 32768
    v_add_u32 v217, s78, v15
    v_bfe_u32 v14, v0, 3, 2
    v_lshlrev_b32 v14, 5, v14
    v_and_b32 v15, 3, v0
    v_lshl_add_u32 v14, v15, 3, v14
    v_lshrrev_b32 v15, 2, v0
    v_lshl_add_u32 v14, v15, 7, v14
    s_lshl_b32 s78, s86, 11
    v_add_u32 v244, s78, v14
    s_mov_b32 s64, s20
    s_mov_b32 s65, s21
    s_mov_b32 s66, 0x200000
    s_mov_b32 s67, 0x20000
    v_lshrrev_b32 v14, 4, v0
    v_lshlrev_b32 v14, 1, v14
    v_and_b32 v15, 7, v0
    v_xor_b32 v14, v14, v15
    v_lshlrev_b32 v14, 4, v14
    v_lshrrev_b32 v15, 3, v0
    v_lshl_add_u32 v14, v15, 11, v14
    s_lshl_b32 s78, s77, 7
    s_lshl_b32 s79, s3, 14
    s_add_u32 s78, s78, s79
    v_add_u32 v245, s78, v14
    v_and_b32 v14, 15, v0
    s_lshl_b32 s78, s76, 2
    s_add_u32 s78, s78, s3
    s_lshl_b32 s79, s78, 5
    v_add_u32 v14, s79, v14
    v_lshlrev_b32 v14, 12, v14
    v_bfe_u32 v15, v0, 4, 1
    v_lshl_add_u32 v14, v15, 5, v14
    v_lshrrev_b32 v15, 5, v0
    v_lshl_add_u32 v14, v15, 4, v14
    s_lshl_b32 s79, s77, 7
    s_add_u32 s79, s79, 2048
    v_add_u32 v246, s79, v14
    s_lshl_b32 s28, s78, 16
    s_add_u32 s28, s28, 16777216
    s_lshl_b32 s30, s76, 1
    s_add_u32 s30, s30, s86
    s_lshl_b32 s30, s30, 12
    s_add_u32 s30, s30, 12910592
    v_lshrrev_b32 v15, 1, v0
    v_lshlrev_b32 v15, 8, v15
    v_and_b32 v14, 1, v0
    v_lshl_add_u32 v247, v14, 2, v15
    s_and_b32 s78, s77, 7
    s_mov_b32 s79, 0x76543210
    s_and_b32 s78, s76, 3
    s_mul_i32 s78, s78, 0x22222222
    s_add_u32 s79, s79, s78
    s_bfe_u32 s78, s79, 0x30000
    s_lshl_b32 s44, s78, 18
    s_lshl_b32 s78, s78, 12
    s_add_u32 s36, s78, s28
    s_bfe_u32 s78, s79, 0x30004
    s_lshl_b32 s45, s78, 18
    s_lshl_b32 s78, s78, 12
    s_add_u32 s37, s78, s28
    s_bfe_u32 s78, s79, 0x30008
    s_lshl_b32 s46, s78, 18
    s_lshl_b32 s78, s78, 12
    s_add_u32 s38, s78, s28
    s_bfe_u32 s78, s79, 0x3000c
    s_lshl_b32 s47, s78, 18
    s_lshl_b32 s78, s78, 12
    s_add_u32 s39, s78, s28
    s_bfe_u32 s78, s79, 0x30010
    s_lshl_b32 s48, s78, 18
    s_lshl_b32 s78, s78, 12
    s_add_u32 s40, s78, s28
    s_bfe_u32 s78, s79, 0x30014
    s_lshl_b32 s49, s78, 18
    s_lshl_b32 s78, s78, 12
    s_add_u32 s41, s78, s28
    s_bfe_u32 s78, s79, 0x30018
    s_lshl_b32 s50, s78, 18
    s_lshl_b32 s78, s78, 12
    s_add_u32 s42, s78, s28
    s_bfe_u32 s78, s79, 0x3001c
    s_lshl_b32 s51, s78, 18
    s_lshl_b32 s78, s78, 12
    s_add_u32 s43, s78, s28
    s_lshl_b32 s34, s3, 10
    v_mov_b32 v252, v12
    v_bfe_u32 v14, v0, 4, 1
    v_lshrrev_b32 v15, 5, v0
    v_lshl_add_u32 v14, v14, 1, v15
    v_and_b32 v15, 7, v0
    v_xor_b32 v14, v14, v15
    v_lshlrev_b32 v14, 4, v14
    v_and_b32 v223, 15, v0
    v_lshl_add_u32 v14, v223, 7, v14
    s_lshl_b32 s78, s3, 12
    v_add_u32 v248, s78, v14
    v_xor_b32 v249, 64, v248
    v_add_u32 v250, s78, v12
    v_lshrrev_b32 v14, 3, v0
    v_xor_b32 v15, v15, v14
    v_lshlrev_b32 v15, 4, v15
    v_lshl_add_u32 v14, v14, 12, v15
    s_lshl_b32 s78, s76, 2
    s_add_u32 s78, s78, s3
    s_lshl_b32 s78, s78, 17
    s_lshl_b32 s79, s77, 7
    s_add_u32 s78, s78, s79
    s_add_u32 s78, s78, 2048
    v_add_u32 v246, s78, v14
    s_waitcnt lgkmcnt(0)
    s_barrier
    ds_read_b64_tr_b16 v[200:201], v6 offset:1024
    ds_read_b64_tr_b16 v[202:203], v6 offset:1536
    ds_read_b64_tr_b16 v[204:205], v6 offset:13312
    ds_read_b64_tr_b16 v[206:207], v6 offset:13824
    ds_read_b128 v[152:155], v2 offset:0
    ds_read_b128 v[156:159], v3 offset:0
    ds_read_b128 v[144:147], v4 offset:6144
    ds_read_b128 v[148:151], v5 offset:6144
    ds_read_b128 v[136:139], v4 offset:4096
    ds_read_b128 v[140:143], v5 offset:4096
    ds_read_b128 v[128:131], v4 offset:2048
    ds_read_b128 v[132:135], v5 offset:2048
    ds_read_b128 v[120:123], v4 offset:0
    ds_read_b128 v[124:127], v5 offset:0
    ds_read_b64_tr_b16 v[224:225], v7 offset:1024
    ds_read_b64_tr_b16 v[226:227], v7 offset:1536
    ds_read_b64_tr_b16 v[228:229], v7 offset:13312
    ds_read_b64_tr_b16 v[230:231], v7 offset:13824
    s_waitcnt lgkmcnt(13)
    v_mfma_f32_16x16x32_bf16 v[112:115], v[200:203], v[152:155], 0
    ds_read_b64_tr_b16 v[232:233], v6 offset:0
    s_waitcnt lgkmcnt(13)
    v_mfma_f32_16x16x32_bf16 v[112:115], v[204:207], v[156:159], v[112:115]
    ds_read_b64_tr_b16 v[234:235], v6 offset:512
    s_waitcnt lgkmcnt(12)
    v_mfma_f32_16x16x32_bf16 v[72:75], v[204:207], v[148:151], 0
    ds_read_b64_tr_b16 v[236:237], v6 offset:12288
    v_mfma_f32_16x16x32_bf16 v[72:75], v[200:203], v[144:147], v[72:75]
    ds_read_b64_tr_b16 v[238:239], v6 offset:12800
    s_waitcnt lgkmcnt(13)
    v_mfma_f32_16x16x32_bf16 v[64:67], v[200:203], v[136:139], 0
    s_waitcnt lgkmcnt(12)
    v_mfma_f32_16x16x32_bf16 v[64:67], v[204:207], v[140:143], v[64:67]
    s_waitcnt lgkmcnt(10)
    v_mfma_f32_16x16x32_bf16 v[56:59], v[204:207], v[132:135], 0
    v_mfma_f32_16x16x32_bf16 v[56:59], v[200:203], v[128:131], v[56:59]
    s_waitcnt lgkmcnt(9)
    v_mfma_f32_16x16x32_bf16 v[48:51], v[200:203], v[120:123], 0
    s_waitcnt lgkmcnt(8)
    v_mfma_f32_16x16x32_bf16 v[48:51], v[204:207], v[124:127], v[48:51]
    s_waitcnt lgkmcnt(4)
    v_mfma_f32_16x16x32_bf16 v[52:55], v[228:231], v[124:127], 0
    ds_read_b64_tr_b16 v[200:201], v7 offset:0
    v_mfma_f32_16x16x32_bf16 v[52:55], v[224:227], v[120:123], v[52:55]
    ds_read_b64_tr_b16 v[202:203], v7 offset:512
    v_mfma_f32_16x16x32_bf16 v[60:63], v[224:227], v[128:131], 0
    ds_read_b64_tr_b16 v[204:205], v7 offset:12288
    v_mfma_f32_16x16x32_bf16 v[60:63], v[228:231], v[132:135], v[60:63]
    ds_read_b64_tr_b16 v[206:207], v7 offset:12800
    v_mfma_f32_16x16x32_bf16 v[68:71], v[228:231], v[140:143], 0
    v_mfma_f32_16x16x32_bf16 v[68:71], v[224:227], v[136:139], v[68:71]
    v_mfma_f32_16x16x32_bf16 v[76:79], v[224:227], v[144:147], 0
    v_mfma_f32_16x16x32_bf16 v[76:79], v[228:231], v[148:151], v[76:79]
    s_barrier
    s_waitcnt lgkmcnt(4)
    v_mfma_f32_16x16x32_bf16 v[40:43], v[236:239], v[148:151], 0
    ds_read_b64_tr_b16 v[224:225], v6 offset:2048
    ds_read_b64_tr_b16 v[226:227], v6 offset:2560
    v_mfma_f32_16x16x32_bf16 v[40:43], v[232:235], v[144:147], v[40:43]
    ds_read_b64_tr_b16 v[228:229], v6 offset:14336
    ds_read_b64_tr_b16 v[230:231], v6 offset:14848
    v_mfma_f32_16x16x32_bf16 v[32:35], v[232:235], v[136:139], 0
    ds_read_b128 v[192:195], v2 offset:18432
    ds_read_b128 v[196:199], v3 offset:18432
    v_mfma_f32_16x16x32_bf16 v[32:35], v[236:239], v[140:143], v[32:35]
    ds_read_b128 v[184:187], v4 offset:24576
    ds_read_b128 v[188:191], v5 offset:24576
    v_mfma_f32_16x16x32_bf16 v[24:27], v[236:239], v[132:135], 0
    ds_read_b128 v[176:179], v4 offset:22528
    v_mfma_f32_16x16x32_bf16 v[24:27], v[232:235], v[128:131], v[24:27]
    v_mfma_f32_16x16x32_bf16 v[16:19], v[232:235], v[120:123], 0
    v_mfma_f32_16x16x32_bf16 v[16:19], v[236:239], v[124:127], v[16:19]
    s_waitcnt lgkmcnt(9)
    v_mfma_f32_16x16x32_bf16 v[20:23], v[204:207], v[124:127], 0
    ds_read_b64_tr_b16 v[232:233], v7 offset:2048
    ds_read_b64_tr_b16 v[234:235], v7 offset:2560
    v_mfma_f32_16x16x32_bf16 v[20:23], v[200:203], v[120:123], v[20:23]
    ds_read_b64_tr_b16 v[236:237], v7 offset:14336
    ds_read_b64_tr_b16 v[238:239], v7 offset:14848
    v_mfma_f32_16x16x32_bf16 v[28:31], v[200:203], v[128:131], 0
    ds_read_b128 v[180:183], v5 offset:22528
    ds_read_b128 v[168:171], v4 offset:20480
    v_mfma_f32_16x16x32_bf16 v[28:31], v[204:207], v[132:135], v[28:31]
    ds_read_b128 v[172:175], v5 offset:20480
    ds_read_b128 v[160:163], v4 offset:18432
    v_mfma_f32_16x16x32_bf16 v[36:39], v[204:207], v[140:143], 0
    ds_read_b128 v[164:167], v5 offset:18432
    v_mfma_f32_16x16x32_bf16 v[36:39], v[200:203], v[136:139], v[36:39]
    v_mfma_f32_16x16x32_bf16 v[44:47], v[200:203], v[144:147], 0
    v_mfma_f32_16x16x32_bf16 v[44:47], v[204:207], v[148:151], v[44:47]
    s_waitcnt lgkmcnt(14)
    v_mfma_f32_16x16x32_bf16 v[116:119], v[156:159], v[228:231], 0
    v_mfma_f32_16x16x32_bf16 v[116:119], v[152:155], v[224:227], v[116:119]
    v_mfma_f32_16x16x32_bf16 v[104:107], v[144:147], v[224:227], 0
    v_mfma_f32_16x16x32_bf16 v[104:107], v[148:151], v[228:231], v[104:107]
    v_mfma_f32_16x16x32_bf16 v[96:99], v[140:143], v[228:231], 0
    s_waitcnt vmcnt(0) lgkmcnt(0)
    s_barrier
    s_or_b32 s78, s75, s3
    s_cbranch_scc0 LB_tag
LB_tagb:
    v_mfma_f32_16x16x32_bf16 v[96:99], v[136:139], v[224:227], v[96:99]
    ds_read_b64_tr_b16 v[200:201], v6 offset:25600
    v_mfma_f32_16x16x32_bf16 v[88:91], v[128:131], v[224:227], 0
    ds_read_b64_tr_b16 v[202:203], v6 offset:26112
    v_mfma_f32_16x16x32_bf16 v[88:91], v[132:135], v[228:231], v[88:91]
    ds_read_b64_tr_b16 v[204:205], v6 offset:37888
    v_mfma_f32_16x16x32_bf16 v[80:83], v[124:127], v[228:231], 0
    ds_read_b64_tr_b16 v[206:207], v6 offset:38400
    v_mfma_f32_16x16x32_bf16 v[80:83], v[120:123], v[224:227], v[80:83]
    v_mfma_f32_16x16x32_bf16 v[84:87], v[120:123], v[232:235], 0
    ds_read_b64_tr_b16 v[224:225], v7 offset:25600
    v_mfma_f32_16x16x32_bf16 v[84:87], v[124:127], v[236:239], v[84:87]
    ds_read_b64_tr_b16 v[226:227], v7 offset:26112
    v_mfma_f32_16x16x32_bf16 v[92:95], v[132:135], v[236:239], 0
    ds_read_b64_tr_b16 v[228:229], v7 offset:37888
    v_mfma_f32_16x16x32_bf16 v[92:95], v[128:131], v[232:235], v[92:95]
    ds_read_b64_tr_b16 v[230:231], v7 offset:38400
    v_mfma_f32_16x16x32_bf16 v[100:103], v[136:139], v[232:235], 0
    v_mfma_f32_16x16x32_bf16 v[100:103], v[140:143], v[236:239], v[100:103]
    v_mfma_f32_16x16x32_bf16 v[108:111], v[148:151], v[236:239], 0
    v_mfma_f32_16x16x32_bf16 v[108:111], v[144:147], v[232:235], v[108:111]
    s_waitcnt lgkmcnt(4)
    v_mfma_f32_16x16x32_bf16 v[112:115], v[200:203], v[192:195], v[112:115]
    ds_read_b64_tr_b16 v[232:233], v6 offset:24576
    v_mfma_f32_16x16x32_bf16 v[112:115], v[204:207], v[196:199], v[112:115]
    ds_read_b64_tr_b16 v[234:235], v6 offset:25088
    v_mfma_f32_16x16x32_bf16 v[72:75], v[204:207], v[188:191], v[72:75]
    ds_read_b64_tr_b16 v[236:237], v6 offset:36864
    v_mfma_f32_16x16x32_bf16 v[72:75], v[200:203], v[184:187], v[72:75]
    ds_read_b64_tr_b16 v[238:239], v6 offset:37376
    v_mfma_f32_16x16x32_bf16 v[64:67], v[200:203], v[176:179], v[64:67]
    ds_read_b128 v[152:155], v2 offset:36864
    v_mfma_f32_16x16x32_bf16 v[64:67], v[204:207], v[180:183], v[64:67]
    ds_read_b128 v[156:159], v3 offset:36864
    v_mfma_f32_16x16x32_bf16 v[56:59], v[204:207], v[172:175], v[56:59]
    ds_read_b128 v[144:147], v4 offset:43008
    v_mfma_f32_16x16x32_bf16 v[56:59], v[200:203], v[168:171], v[56:59]
    ds_read_b128 v[148:151], v5 offset:43008
    v_mfma_f32_16x16x32_bf16 v[48:51], v[200:203], v[160:163], v[48:51]
    v_mfma_f32_16x16x32_bf16 v[48:51], v[204:207], v[164:167], v[48:51]
    s_waitcnt lgkmcnt(8)
    v_mfma_f32_16x16x32_bf16 v[52:55], v[228:231], v[164:167], v[52:55]
    ds_read_b64_tr_b16 v[200:201], v7 offset:24576
    v_mfma_f32_16x16x32_bf16 v[52:55], v[224:227], v[160:163], v[52:55]
    ds_read_b64_tr_b16 v[202:203], v7 offset:25088
    v_mfma_f32_16x16x32_bf16 v[60:63], v[224:227], v[168:171], v[60:63]
    ds_read_b64_tr_b16 v[204:205], v7 offset:36864
    v_mfma_f32_16x16x32_bf16 v[60:63], v[228:231], v[172:175], v[60:63]
    ds_read_b64_tr_b16 v[206:207], v7 offset:37376
    v_mfma_f32_16x16x32_bf16 v[68:71], v[228:231], v[180:183], v[68:71]
    ds_read_b128 v[136:139], v4 offset:40960
    v_mfma_f32_16x16x32_bf16 v[68:71], v[224:227], v[176:179], v[68:71]
    ds_read_b128 v[140:143], v5 offset:40960
    v_mfma_f32_16x16x32_bf16 v[76:79], v[224:227], v[184:187], v[76:79]
    ds_read_b128 v[128:131], v4 offset:38912
    v_mfma_f32_16x16x32_bf16 v[76:79], v[228:231], v[188:191], v[76:79]
    s_waitcnt lgkmcnt(11)
    v_mfma_f32_16x16x32_bf16 v[40:43], v[236:239], v[188:191], v[40:43]
    ds_read_b64_tr_b16 v[224:225], v6 offset:26624
    v_mfma_f32_16x16x32_bf16 v[40:43], v[232:235], v[184:187], v[40:43]
    ds_read_b64_tr_b16 v[226:227], v6 offset:27136
    v_mfma_f32_16x16x32_bf16 v[32:35], v[232:235], v[176:179], v[32:35]
    ds_read_b64_tr_b16 v[228:229], v6 offset:38912
    v_mfma_f32_16x16x32_bf16 v[32:35], v[236:239], v[180:183], v[32:35]
    ds_read_b64_tr_b16 v[230:231], v6 offset:39424
    v_mfma_f32_16x16x32_bf16 v[24:27], v[236:239], v[172:175], v[24:27]
    ds_read_b128 v[132:135], v5 offset:38912
    v_mfma_f32_16x16x32_bf16 v[24:27], v[232:235], v[168:171], v[24:27]
    ds_read_b128 v[120:123], v4 offset:36864
    v_mfma_f32_16x16x32_bf16 v[16:19], v[232:235], v[160:163], v[16:19]
    ds_read_b128 v[124:127], v5 offset:36864
    v_mfma_f32_16x16x32_bf16 v[16:19], v[236:239], v[164:167], v[16:19]
    s_waitcnt lgkmcnt(10)
    v_mfma_f32_16x16x32_bf16 v[20:23], v[204:207], v[164:167], v[20:23]
    ds_read_b64_tr_b16 v[232:233], v7 offset:26624
    v_mfma_f32_16x16x32_bf16 v[20:23], v[200:203], v[160:163], v[20:23]
    ds_read_b64_tr_b16 v[234:235], v7 offset:27136
    v_mfma_f32_16x16x32_bf16 v[28:31], v[200:203], v[168:171], v[28:31]
    ds_read_b64_tr_b16 v[236:237], v7 offset:38912
    v_mfma_f32_16x16x32_bf16 v[28:31], v[204:207], v[172:175], v[28:31]
    ds_read_b64_tr_b16 v[238:239], v7 offset:39424
    v_mfma_f32_16x16x32_bf16 v[36:39], v[204:207], v[180:183], v[36:39]
    v_mfma_f32_16x16x32_bf16 v[36:39], v[200:203], v[176:179], v[36:39]
    v_mfma_f32_16x16x32_bf16 v[44:47], v[200:203], v[184:187], v[44:47]
    v_mfma_f32_16x16x32_bf16 v[44:47], v[204:207], v[188:191], v[44:47]
    s_waitcnt lgkmcnt(7)
    v_mfma_f32_16x16x32_bf16 v[116:119], v[196:199], v[228:231], v[116:119]
    v_mfma_f32_16x16x32_bf16 v[116:119], v[192:195], v[224:227], v[116:119]
    v_mfma_f32_16x16x32_bf16 v[104:107], v[184:187], v[224:227], v[104:107]
    v_mfma_f32_16x16x32_bf16 v[104:107], v[188:191], v[228:231], v[104:107]
    v_mfma_f32_16x16x32_bf16 v[96:99], v[180:183], v[228:231], v[96:99]
    s_waitcnt lgkmcnt(0)
    s_barrier
    v_mfma_f32_16x16x32_bf16 v[96:99], v[176:179], v[224:227], v[96:99]
    ds_read_b64_tr_b16 v[200:201], v6 offset:50176
    v_mfma_f32_16x16x32_bf16 v[88:91], v[168:171], v[224:227], v[88:91]
    ds_read_b64_tr_b16 v[202:203], v6 offset:50688
    v_mfma_f32_16x16x32_bf16 v[88:91], v[172:175], v[228:231], v[88:91]
    ds_read_b64_tr_b16 v[204:205], v6 offset:62464
    v_mfma_f32_16x16x32_bf16 v[80:83], v[164:167], v[228:231], v[80:83]
    ds_read_b64_tr_b16 v[206:207], v6 offset:62976
    v_mfma_f32_16x16x32_bf16 v[80:83], v[160:163], v[224:227], v[80:83]
    v_mfma_f32_16x16x32_bf16 v[84:87], v[160:163], v[232:235], v[84:87]
    ds_read_b64_tr_b16 v[224:225], v7 offset:50176
    v_mfma_f32_16x16x32_bf16 v[84:87], v[164:167], v[236:239], v[84:87]
    ds_read_b64_tr_b16 v[226:227], v7 offset:50688
    v_mfma_f32_16x16x32_bf16 v[92:95], v[172:175], v[236:239], v[92:95]
    ds_read_b64_tr_b16 v[228:229], v7 offset:62464
    v_mfma_f32_16x16x32_bf16 v[92:95], v[168:171], v[232:235], v[92:95]
    ds_read_b64_tr_b16 v[230:231], v7 offset:62976
    v_mfma_f32_16x16x32_bf16 v[100:103], v[176:179], v[232:235], v[100:103]
    v_mfma_f32_16x16x32_bf16 v[100:103], v[180:183], v[236:239], v[100:103]
    v_mfma_f32_16x16x32_bf16 v[108:111], v[188:191], v[236:239], v[108:111]
    v_mfma_f32_16x16x32_bf16 v[108:111], v[184:187], v[232:235], v[108:111]
    s_waitcnt lgkmcnt(4)
    v_mfma_f32_16x16x32_bf16 v[112:115], v[200:203], v[152:155], v[112:115]
    ds_read_b64_tr_b16 v[232:233], v6 offset:49152
    v_mfma_f32_16x16x32_bf16 v[112:115], v[204:207], v[156:159], v[112:115]
    ds_read_b64_tr_b16 v[234:235], v6 offset:49664
    v_mfma_f32_16x16x32_bf16 v[72:75], v[204:207], v[148:151], v[72:75]
    ds_read_b64_tr_b16 v[236:237], v6 offset:61440
    v_mfma_f32_16x16x32_bf16 v[72:75], v[200:203], v[144:147], v[72:75]
    ds_read_b64_tr_b16 v[238:239], v6 offset:61952
    v_mfma_f32_16x16x32_bf16 v[64:67], v[200:203], v[136:139], v[64:67]
    ds_read_b128 v[192:195], v2 offset:0
    v_mfma_f32_16x16x32_bf16 v[64:67], v[204:207], v[140:143], v[64:67]
    ds_read_b128 v[196:199], v3 offset:0
    v_mfma_f32_16x16x32_bf16 v[56:59], v[204:207], v[132:135], v[56:59]
    ds_read_b128 v[184:187], v4 offset:6144
    v_mfma_f32_16x16x32_bf16 v[56:59], v[200:203], v[128:131], v[56:59]
    ds_read_b128 v[188:191], v5 offset:6144
    v_mfma_f32_16x16x32_bf16 v[48:51], v[200:203], v[120:123], v[48:51]
    v_mfma_f32_16x16x32_bf16 v[48:51], v[204:207], v[124:127], v[48:51]
    s_waitcnt lgkmcnt(8)
    v_mfma_f32_16x16x32_bf16 v[52:55], v[228:231], v[124:127], v[52:55]
    ds_read_b64_tr_b16 v[200:201], v7 offset:49152
    v_mfma_f32_16x16x32_bf16 v[52:55], v[224:227], v[120:123], v[52:55]
    ds_read_b64_tr_b16 v[202:203], v7 offset:49664
    v_mfma_f32_16x16x32_bf16 v[60:63], v[224:227], v[128:131], v[60:63]
    ds_read_b64_tr_b16 v[204:205], v7 offset:61440
    v_mfma_f32_16x16x32_bf16 v[60:63], v[228:231], v[132:135], v[60:63]
    ds_read_b64_tr_b16 v[206:207], v7 offset:61952
    v_mfma_f32_16x16x32_bf16 v[68:71], v[228:231], v[140:143], v[68:71]
    ds_read_b128 v[176:179], v4 offset:4096
    v_mfma_f32_16x16x32_bf16 v[68:71], v[224:227], v[136:139], v[68:71]
    ds_read_b128 v[180:183], v5 offset:4096
    v_mfma_f32_16x16x32_bf16 v[76:79], v[224:227], v[144:147], v[76:79]
    ds_read_b128 v[168:171], v4 offset:2048
    v_mfma_f32_16x16x32_bf16 v[76:79], v[228:231], v[148:151], v[76:79]
    s_waitcnt lgkmcnt(11)
    v_mfma_f32_16x16x32_bf16 v[40:43], v[236:239], v[148:151], v[40:43]
    ds_read_b64_tr_b16 v[224:225], v6 offset:51200
    v_mfma_f32_16x16x32_bf16 v[40:43], v[232:235], v[144:147], v[40:43]
    ds_read_b64_tr_b16 v[226:227], v6 offset:51712
    v_mfma_f32_16x16x32_bf16 v[32:35], v[232:235], v[136:139], v[32:35]
    ds_read_b64_tr_b16 v[228:229], v6 offset:63488
    v_mfma_f32_16x16x32_bf16 v[32:35], v[236:239], v[140:143], v[32:35]
    ds_read_b64_tr_b16 v[230:231], v6 offset:64000
    v_mfma_f32_16x16x32_bf16 v[24:27], v[236:239], v[132:135], v[24:27]
    ds_read_b128 v[172:175], v5 offset:2048
    v_mfma_f32_16x16x32_bf16 v[24:27], v[232:235], v[128:131], v[24:27]
    ds_read_b128 v[160:163], v4 offset:0
    v_mfma_f32_16x16x32_bf16 v[16:19], v[232:235], v[120:123], v[16:19]
    ds_read_b128 v[164:167], v5 offset:0
    v_mfma_f32_16x16x32_bf16 v[16:19], v[236:239], v[124:127], v[16:19]
    s_waitcnt lgkmcnt(10)
    v_mfma_f32_16x16x32_bf16 v[20:23], v[204:207], v[124:127], v[20:23]
    ds_read_b64_tr_b16 v[232:233], v7 offset:51200
    v_mfma_f32_16x16x32_bf16 v[20:23], v[200:203], v[120:123], v[20:23]
    ds_read_b64_tr_b16 v[234:235], v7 offset:51712
    v_mfma_f32_16x16x32_bf16 v[28:31], v[200:203], v[128:131], v[28:31]
    ds_read_b64_tr_b16 v[236:237], v7 offset:63488
    v_mfma_f32_16x16x32_bf16 v[28:31], v[204:207], v[132:135], v[28:31]
    ds_read_b64_tr_b16 v[238:239], v7 offset:64000
    v_mfma_f32_16x16x32_bf16 v[36:39], v[204:207], v[140:143], v[36:39]
    v_mfma_f32_16x16x32_bf16 v[36:39], v[200:203], v[136:139], v[36:39]
    v_mfma_f32_16x16x32_bf16 v[44:47], v[200:203], v[144:147], v[44:47]
    v_mfma_f32_16x16x32_bf16 v[44:47], v[204:207], v[148:151], v[44:47]
    s_waitcnt lgkmcnt(7)
    v_mfma_f32_16x16x32_bf16 v[116:119], v[156:159], v[228:231], v[116:119]
    v_mfma_f32_16x16x32_bf16 v[116:119], v[152:155], v[224:227], v[116:119]
    v_mfma_f32_16x16x32_bf16 v[104:107], v[144:147], v[224:227], v[104:107]
    v_mfma_f32_16x16x32_bf16 v[104:107], v[148:151], v[228:231], v[104:107]
    v_mfma_f32_16x16x32_bf16 v[96:99], v[140:143], v[228:231], v[96:99]
    s_waitcnt lgkmcnt(0)
    s_barrier
    v_mfma_f32_16x16x32_bf16 v[96:99], v[136:139], v[224:227], v[96:99]
    ds_read_b64_tr_b16 v[200:201], v6 offset:1024
    v_mfma_f32_16x16x32_bf16 v[88:91], v[128:131], v[224:227], v[88:91]
    ds_read_b64_tr_b16 v[202:203], v6 offset:1536
    v_mfma_f32_16x16x32_bf16 v[88:91], v[132:135], v[228:231], v[88:91]
    ds_read_b64_tr_b16 v[204:205], v6 offset:13312
    v_mfma_f32_16x16x32_bf16 v[80:83], v[124:127], v[228:231], v[80:83]
    ds_read_b64_tr_b16 v[206:207], v6 offset:13824
    v_mfma_f32_16x16x32_bf16 v[80:83], v[120:123], v[224:227], v[80:83]
    v_mfma_f32_16x16x32_bf16 v[84:87], v[120:123], v[232:235], v[84:87]
    ds_read_b64_tr_b16 v[224:225], v7 offset:1024
    v_mfma_f32_16x16x32_bf16 v[84:87], v[124:127], v[236:239], v[84:87]
    ds_read_b64_tr_b16 v[226:227], v7 offset:1536
    v_mfma_f32_16x16x32_bf16 v[92:95], v[132:135], v[236:239], v[92:95]
    ds_read_b64_tr_b16 v[228:229], v7 offset:13312
    v_mfma_f32_16x16x32_bf16 v[92:95], v[128:131], v[232:235], v[92:95]
    ds_read_b64_tr_b16 v[230:231], v7 offset:13824
    v_mfma_f32_16x16x32_bf16 v[100:103], v[136:139], v[232:235], v[100:103]
    v_mfma_f32_16x16x32_bf16 v[100:103], v[140:143], v[236:239], v[100:103]
    v_mfma_f32_16x16x32_bf16 v[108:111], v[148:151], v[236:239], v[108:111]
    v_mfma_f32_16x16x32_bf16 v[108:111], v[144:147], v[232:235], v[108:111]
    s_waitcnt lgkmcnt(4)
    v_mfma_f32_16x16x32_bf16 v[112:115], v[200:203], v[192:195], v[112:115]
    ds_read_b64_tr_b16 v[232:233], v6 offset:0
    v_mfma_f32_16x16x32_bf16 v[112:115], v[204:207], v[196:199], v[112:115]
    ds_read_b64_tr_b16 v[234:235], v6 offset:512
    v_mfma_f32_16x16x32_bf16 v[72:75], v[204:207], v[188:191], v[72:75]
    ds_read_b64_tr_b16 v[236:237], v6 offset:12288
    v_mfma_f32_16x16x32_bf16 v[72:75], v[200:203], v[184:187], v[72:75]
    ds_read_b64_tr_b16 v[238:239], v6 offset:12800
    v_mfma_f32_16x16x32_bf16 v[64:67], v[200:203], v[176:179], v[64:67]
    ds_read_b128 v[152:155], v2 offset:18432
    v_mfma_f32_16x16x32_bf16 v[64:67], v[204:207], v[180:183], v[64:67]
    ds_read_b128 v[156:159], v3 offset:18432
    v_mfma_f32_16x16x32_bf16 v[56:59], v[204:207], v[172:175], v[56:59]
    ds_read_b128 v[144:147], v4 offset:24576
    v_mfma_f32_16x16x32_bf16 v[56:59], v[200:203], v[168:171], v[56:59]
    ds_read_b128 v[148:151], v5 offset:24576
    v_mfma_f32_16x16x32_bf16 v[48:51], v[200:203], v[160:163], v[48:51]
    v_mfma_f32_16x16x32_bf16 v[48:51], v[204:207], v[164:167], v[48:51]
    s_waitcnt lgkmcnt(8)
    v_mfma_f32_16x16x32_bf16 v[52:55], v[228:231], v[164:167], v[52:55]
    ds_read_b64_tr_b16 v[200:201], v7 offset:0
    v_mfma_f32_16x16x32_bf16 v[52:55], v[224:227], v[160:163], v[52:55]
    ds_read_b64_tr_b16 v[202:203], v7 offset:512
    v_mfma_f32_16x16x32_bf16 v[60:63], v[224:227], v[168:171], v[60:63]
    ds_read_b64_tr_b16 v[204:205], v7 offset:12288
    v_mfma_f32_16x16x32_bf16 v[60:63], v[228:231], v[172:175], v[60:63]
    ds_read_b64_tr_b16 v[206:207], v7 offset:12800
    v_mfma_f32_16x16x32_bf16 v[68:71], v[228:231], v[180:183], v[68:71]
    ds_read_b128 v[136:139], v4 offset:22528
    v_mfma_f32_16x16x32_bf16 v[68:71], v[224:227], v[176:179], v[68:71]
    ds_read_b128 v[140:143], v5 offset:22528
    v_mfma_f32_16x16x32_bf16 v[76:79], v[224:227], v[184:187], v[76:79]
    ds_read_b128 v[128:131], v4 offset:20480
    v_mfma_f32_16x16x32_bf16 v[76:79], v[228:231], v[188:191], v[76:79]
    s_waitcnt lgkmcnt(11)
    v_mfma_f32_16x16x32_bf16 v[40:43], v[236:239], v[188:191], v[40:43]
    ds_read_b64_tr_b16 v[224:225], v6 offset:2048
    v_mfma_f32_16x16x32_bf16 v[40:43], v[232:235], v[184:187], v[40:43]
    ds_read_b64_tr_b16 v[226:227], v6 offset:2560
    v_mfma_f32_16x16x32_bf16 v[32:35], v[232:235], v[176:179], v[32:35]
    ds_read_b64_tr_b16 v[228:229], v6 offset:14336
    v_mfma_f32_16x16x32_bf16 v[32:35], v[236:239], v[180:183], v[32:35]
    ds_read_b64_tr_b16 v[230:231], v6 offset:14848
    v_mfma_f32_16x16x32_bf16 v[24:27], v[236:239], v[172:175], v[24:27]
    ds_read_b128 v[132:135], v5 offset:20480
    v_mfma_f32_16x16x32_bf16 v[24:27], v[232:235], v[168:171], v[24:27]
    ds_read_b128 v[120:123], v4 offset:18432
    v_mfma_f32_16x16x32_bf16 v[16:19], v[232:235], v[160:163], v[16:19]
    ds_read_b128 v[124:127], v5 offset:18432
    v_mfma_f32_16x16x32_bf16 v[16:19], v[236:239], v[164:167], v[16:19]
    s_waitcnt lgkmcnt(10)
    v_mfma_f32_16x16x32_bf16 v[20:23], v[204:207], v[164:167], v[20:23]
    ds_read_b64_tr_b16 v[232:233], v7 offset:2048
    v_mfma_f32_16x16x32_bf16 v[20:23], v[200:203], v[160:163], v[20:23]
    ds_read_b64_tr_b16 v[234:235], v7 offset:2560
    v_mfma_f32_16x16x32_bf16 v[28:31], v[200:203], v[168:171], v[28:31]
    ds_read_b64_tr_b16 v[236:237], v7 offset:14336
    v_mfma_f32_16x16x32_bf16 v[28:31], v[204:207], v[172:175], v[28:31]
    ds_read_b64_tr_b16 v[238:239], v7 offset:14848
    v_mfma_f32_16x16x32_bf16 v[36:39], v[204:207], v[180:183], v[36:39]
    v_mfma_f32_16x16x32_bf16 v[36:39], v[200:203], v[176:179], v[36:39]
    v_mfma_f32_16x16x32_bf16 v[44:47], v[200:203], v[184:187], v[44:47]
    v_mfma_f32_16x16x32_bf16 v[44:47], v[204:207], v[188:191], v[44:47]
    s_waitcnt lgkmcnt(7)
    v_mfma_f32_16x16x32_bf16 v[116:119], v[196:199], v[228:231], v[116:119]
    v_mfma_f32_16x16x32_bf16 v[116:119], v[192:195], v[224:227], v[116:119]
    v_mfma_f32_16x16x32_bf16 v[104:107], v[184:187], v[224:227], v[104:107]
    v_mfma_f32_16x16x32_bf16 v[104:107], v[188:191], v[228:231], v[104:107]
    v_mfma_f32_16x16x32_bf16 v[96:99], v[180:183], v[228:231], v[96:99]
    s_waitcnt lgkmcnt(0)
    s_barrier
    v_mfma_f32_16x16x32_bf16 v[96:99], v[176:179], v[224:227], v[96:99]
    ds_read_b64_tr_b16 v[200:201], v6 offset:25600
    v_mfma_f32_16x16x32_bf16 v[88:91], v[168:171], v[224:227], v[88:91]
    ds_read_b64_tr_b16 v[202:203], v6 offset:26112
    v_mfma_f32_16x16x32_bf16 v[88:91], v[172:175], v[228:231], v[88:91]
    ds_read_b64_tr_b16 v[204:205], v6 offset:37888
    v_mfma_f32_16x16x32_bf16 v[80:83], v[164:167], v[228:231], v[80:83]
    ds_read_b64_tr_b16 v[206:207], v6 offset:38400
    v_mfma_f32_16x16x32_bf16 v[80:83], v[160:163], v[224:227], v[80:83]
    v_mfma_f32_16x16x32_bf16 v[84:87], v[160:163], v[232:235], v[84:87]
    ds_read_b64_tr_b16 v[224:225], v7 offset:25600
    v_mfma_f32_16x16x32_bf16 v[84:87], v[164:167], v[236:239], v[84:87]
    ds_read_b64_tr_b16 v[226:227], v7 offset:26112
    v_mfma_f32_16x16x32_bf16 v[92:95], v[172:175], v[236:239], v[92:95]
    ds_read_b64_tr_b16 v[228:229], v7 offset:37888
    v_mfma_f32_16x16x32_bf16 v[92:95], v[168:171], v[232:235], v[92:95]
    ds_read_b64_tr_b16 v[230:231], v7 offset:38400
    v_mfma_f32_16x16x32_bf16 v[100:103], v[176:179], v[232:235], v[100:103]
    v_mfma_f32_16x16x32_bf16 v[100:103], v[180:183], v[236:239], v[100:103]
    v_mfma_f32_16x16x32_bf16 v[108:111], v[188:191], v[236:239], v[108:111]
    v_mfma_f32_16x16x32_bf16 v[108:111], v[184:187], v[232:235], v[108:111]
    s_waitcnt lgkmcnt(4)
    v_mfma_f32_16x16x32_bf16 v[112:115], v[200:203], v[152:155], v[112:115]
    ds_read_b64_tr_b16 v[232:233], v6 offset:24576
    v_mfma_f32_16x16x32_bf16 v[112:115], v[204:207], v[156:159], v[112:115]
    ds_read_b64_tr_b16 v[234:235], v6 offset:25088
    v_mfma_f32_16x16x32_bf16 v[72:75], v[204:207], v[148:151], v[72:75]
    ds_read_b64_tr_b16 v[236:237], v6 offset:36864
    v_mfma_f32_16x16x32_bf16 v[72:75], v[200:203], v[144:147], v[72:75]
    ds_read_b64_tr_b16 v[238:239], v6 offset:37376
    v_mfma_f32_16x16x32_bf16 v[64:67], v[200:203], v[136:139], v[64:67]
    ds_read_b128 v[192:195], v2 offset:36864
    v_mfma_f32_16x16x32_bf16 v[64:67], v[204:207], v[140:143], v[64:67]
    ds_read_b128 v[196:199], v3 offset:36864
    v_mfma_f32_16x16x32_bf16 v[56:59], v[204:207], v[132:135], v[56:59]
    ds_read_b128 v[184:187], v4 offset:43008
    v_mfma_f32_16x16x32_bf16 v[56:59], v[200:203], v[128:131], v[56:59]
    ds_read_b128 v[188:191], v5 offset:43008
    v_mfma_f32_16x16x32_bf16 v[48:51], v[200:203], v[120:123], v[48:51]
    v_mfma_f32_16x16x32_bf16 v[48:51], v[204:207], v[124:127], v[48:51]
    s_waitcnt lgkmcnt(8)
    v_mfma_f32_16x16x32_bf16 v[52:55], v[228:231], v[124:127], v[52:55]
    ds_read_b64_tr_b16 v[200:201], v7 offset:24576
    v_mfma_f32_16x16x32_bf16 v[52:55], v[224:227], v[120:123], v[52:55]
    ds_read_b64_tr_b16 v[202:203], v7 offset:25088
    v_mfma_f32_16x16x32_bf16 v[60:63], v[224:227], v[128:131], v[60:63]
    ds_read_b64_tr_b16 v[204:205], v7 offset:36864
    v_mfma_f32_16x16x32_bf16 v[60:63], v[228:231], v[132:135], v[60:63]
    ds_read_b64_tr_b16 v[206:207], v7 offset:37376
    v_mfma_f32_16x16x32_bf16 v[68:71], v[228:231], v[140:143], v[68:71]
    ds_read_b128 v[176:179], v4 offset:40960
    v_mfma_f32_16x16x32_bf16 v[68:71], v[224:227], v[136:139], v[68:71]
    ds_read_b128 v[180:183], v5 offset:40960
    v_mfma_f32_16x16x32_bf16 v[76:79], v[224:227], v[144:147], v[76:79]
    ds_read_b128 v[168:171], v4 offset:38912
    v_mfma_f32_16x16x32_bf16 v[76:79], v[228:231], v[148:151], v[76:79]
    s_waitcnt lgkmcnt(11)
    v_mfma_f32_16x16x32_bf16 v[40:43], v[236:239], v[148:151], v[40:43]
    ds_read_b64_tr_b16 v[224:225], v6 offset:26624
    v_mfma_f32_16x16x32_bf16 v[40:43], v[232:235], v[144:147], v[40:43]
    ds_read_b64_tr_b16 v[226:227], v6 offset:27136
    v_mfma_f32_16x16x32_bf16 v[32:35], v[232:235], v[136:139], v[32:35]
    ds_read_b64_tr_b16 v[228:229], v6 offset:38912
    v_mfma_f32_16x16x32_bf16 v[32:35], v[236:239], v[140:143], v[32:35]
    ds_read_b64_tr_b16 v[230:231], v6 offset:39424
    v_mfma_f32_16x16x32_bf16 v[24:27], v[236:239], v[132:135], v[24:27]
    ds_read_b128 v[172:175], v5 offset:38912
    v_mfma_f32_16x16x32_bf16 v[24:27], v[232:235], v[128:131], v[24:27]
    ds_read_b128 v[160:163], v4 offset:36864
    v_mfma_f32_16x16x32_bf16 v[16:19], v[232:235], v[120:123], v[16:19]
    ds_read_b128 v[164:167], v5 offset:36864
    v_mfma_f32_16x16x32_bf16 v[16:19], v[236:239], v[124:127], v[16:19]
    s_waitcnt lgkmcnt(10)
    v_mfma_f32_16x16x32_bf16 v[20:23], v[204:207], v[124:127], v[20:23]
    ds_read_b64_tr_b16 v[232:233], v7 offset:26624
    v_mfma_f32_16x16x32_bf16 v[20:23], v[200:203], v[120:123], v[20:23]
    ds_read_b64_tr_b16 v[234:235], v7 offset:27136
    v_mfma_f32_16x16x32_bf16 v[28:31], v[200:203], v[128:131], v[28:31]
    ds_read_b64_tr_b16 v[236:237], v7 offset:38912
    v_mfma_f32_16x16x32_bf16 v[28:31], v[204:207], v[132:135], v[28:31]
    ds_read_b64_tr_b16 v[238:239], v7 offset:39424
    v_mfma_f32_16x16x32_bf16 v[36:39], v[204:207], v[140:143], v[36:39]
    v_mfma_f32_16x16x32_bf16 v[36:39], v[200:203], v[136:139], v[36:39]
    v_mfma_f32_16x16x32_bf16 v[44:47], v[200:203], v[144:147], v[44:47]
    v_mfma_f32_16x16x32_bf16 v[44:47], v[204:207], v[148:151], v[44:47]
    s_waitcnt lgkmcnt(7)
    v_mfma_f32_16x16x32_bf16 v[116:119], v[156:159], v[228:231], v[116:119]
    v_mfma_f32_16x16x32_bf16 v[116:119], v[152:155], v[224:227], v[116:119]
    v_mfma_f32_16x16x32_bf16 v[104:107], v[144:147], v[224:227], v[104:107]
    v_mfma_f32_16x16x32_bf16 v[104:107], v[148:151], v[228:231], v[104:107]
    v_mfma_f32_16x16x32_bf16 v[96:99], v[140:143], v[228:231], v[96:99]
    s_waitcnt lgkmcnt(0)
    s_barrier
    v_mfma_f32_16x16x32_bf16 v[96:99], v[136:139], v[224:227], v[96:99]
    ds_read_b64_tr_b16 v[200:201], v6 offset:50176
    v_mfma_f32_16x16x32_bf16 v[88:91], v[128:131], v[224:227], v[88:91]
    ds_read_b64_tr_b16 v[202:203], v6 offset:50688
    v_mfma_f32_16x16x32_bf16 v[88:91], v[132:135], v[228:231], v[88:91]
    ds_read_b64_tr_b16 v[204:205], v6 offset:62464
    v_mfma_f32_16x16x32_bf16 v[80:83], v[124:127], v[228:231], v[80:83]
    ds_read_b64_tr_b16 v[206:207], v6 offset:62976
    v_mfma_f32_16x16x32_bf16 v[80:83], v[120:123], v[224:227], v[80:83]
    v_mfma_f32_16x16x32_bf16 v[84:87], v[120:123], v[232:235], v[84:87]
    ds_read_b64_tr_b16 v[224:225], v7 offset:50176
    v_mfma_f32_16x16x32_bf16 v[84:87], v[124:127], v[236:239], v[84:87]
    ds_read_b64_tr_b16 v[226:227], v7 offset:50688
    v_mfma_f32_16x16x32_bf16 v[92:95], v[132:135], v[236:239], v[92:95]
    ds_read_b64_tr_b16 v[228:229], v7 offset:62464
    v_mfma_f32_16x16x32_bf16 v[92:95], v[128:131], v[232:235], v[92:95]
    ds_read_b64_tr_b16 v[230:231], v7 offset:62976
    v_mfma_f32_16x16x32_bf16 v[100:103], v[136:139], v[232:235], v[100:103]
    v_mfma_f32_16x16x32_bf16 v[100:103], v[140:143], v[236:239], v[100:103]
    v_mfma_f32_16x16x32_bf16 v[108:111], v[148:151], v[236:239], v[108:111]
    v_mfma_f32_16x16x32_bf16 v[108:111], v[144:147], v[232:235], v[108:111]
    s_waitcnt lgkmcnt(4)
    v_mfma_f32_16x16x32_bf16 v[112:115], v[200:203], v[192:195], v[112:115]
    ds_read_b64_tr_b16 v[232:233], v6 offset:49152
    v_mfma_f32_16x16x32_bf16 v[112:115], v[204:207], v[196:199], v[112:115]
    ds_read_b64_tr_b16 v[234:235], v6 offset:49664
    v_mfma_f32_16x16x32_bf16 v[72:75], v[204:207], v[188:191], v[72:75]
    ds_read_b64_tr_b16 v[236:237], v6 offset:61440
    v_mfma_f32_16x16x32_bf16 v[72:75], v[200:203], v[184:187], v[72:75]
    ds_read_b64_tr_b16 v[238:239], v6 offset:61952
    v_mfma_f32_16x16x32_bf16 v[64:67], v[200:203], v[176:179], v[64:67]
    ds_read_b128 v[152:155], v2 offset:0
    v_mfma_f32_16x16x32_bf16 v[64:67], v[204:207], v[180:183], v[64:67]
    ds_read_b128 v[156:159], v3 offset:0
    v_mfma_f32_16x16x32_bf16 v[56:59], v[204:207], v[172:175], v[56:59]
    ds_read_b128 v[144:147], v4 offset:6144
    v_mfma_f32_16x16x32_bf16 v[56:59], v[200:203], v[168:171], v[56:59]
    ds_read_b128 v[148:151], v5 offset:6144
    v_mfma_f32_16x16x32_bf16 v[48:51], v[200:203], v[160:163], v[48:51]
    v_mfma_f32_16x16x32_bf16 v[48:51], v[204:207], v[164:167], v[48:51]
    s_waitcnt lgkmcnt(8)
    v_mfma_f32_16x16x32_bf16 v[52:55], v[228:231], v[164:167], v[52:55]
    ds_read_b64_tr_b16 v[200:201], v7 offset:49152
    v_mfma_f32_16x16x32_bf16 v[52:55], v[224:227], v[160:163], v[52:55]
    ds_read_b64_tr_b16 v[202:203], v7 offset:49664
    v_mfma_f32_16x16x32_bf16 v[60:63], v[224:227], v[168:171], v[60:63]
    ds_read_b64_tr_b16 v[204:205], v7 offset:61440
    v_mfma_f32_16x16x32_bf16 v[60:63], v[228:231], v[172:175], v[60:63]
    ds_read_b64_tr_b16 v[206:207], v7 offset:61952
    v_mfma_f32_16x16x32_bf16 v[68:71], v[228:231], v[180:183], v[68:71]
    ds_read_b128 v[136:139], v4 offset:4096
    v_mfma_f32_16x16x32_bf16 v[68:71], v[224:227], v[176:179], v[68:71]
    ds_read_b128 v[140:143], v5 offset:4096
    v_mfma_f32_16x16x32_bf16 v[76:79], v[224:227], v[184:187], v[76:79]
    ds_read_b128 v[128:131], v4 offset:2048
    v_mfma_f32_16x16x32_bf16 v[76:79], v[228:231], v[188:191], v[76:79]
    s_waitcnt lgkmcnt(11)
    v_mfma_f32_16x16x32_bf16 v[40:43], v[236:239], v[188:191], v[40:43]
    ds_read_b64_tr_b16 v[224:225], v6 offset:51200
    v_mfma_f32_16x16x32_bf16 v[40:43], v[232:235], v[184:187], v[40:43]
    ds_read_b64_tr_b16 v[226:227], v6 offset:51712
    v_mfma_f32_16x16x32_bf16 v[32:35], v[232:235], v[176:179], v[32:35]
    ds_read_b64_tr_b16 v[228:229], v6 offset:63488
    v_mfma_f32_16x16x32_bf16 v[32:35], v[236:239], v[180:183], v[32:35]
    ds_read_b64_tr_b16 v[230:231], v6 offset:64000
    v_mfma_f32_16x16x32_bf16 v[24:27], v[236:239], v[172:175], v[24:27]
    ds_read_b128 v[132:135], v5 offset:2048
    v_mfma_f32_16x16x32_bf16 v[24:27], v[232:235], v[168:171], v[24:27]
    ds_read_b128 v[120:123], v4 offset:0
    v_mfma_f32_16x16x32_bf16 v[16:19], v[232:235], v[160:163], v[16:19]
    ds_read_b128 v[124:127], v5 offset:0
    v_mfma_f32_16x16x32_bf16 v[16:19], v[236:239], v[164:167], v[16:19]
    s_waitcnt lgkmcnt(10)
    v_mfma_f32_16x16x32_bf16 v[20:23], v[204:207], v[164:167], v[20:23]
    ds_read_b64_tr_b16 v[232:233], v7 offset:51200
    v_mfma_f32_16x16x32_bf16 v[20:23], v[200:203], v[160:163], v[20:23]
    ds_read_b64_tr_b16 v[234:235], v7 offset:51712
    v_mfma_f32_16x16x32_bf16 v[28:31], v[200:203], v[168:171], v[28:31]
    ds_read_b64_tr_b16 v[236:237], v7 offset:63488
    v_mfma_f32_16x16x32_bf16 v[28:31], v[204:207], v[172:175], v[28:31]
    ds_read_b64_tr_b16 v[238:239], v7 offset:64000
    v_mfma_f32_16x16x32_bf16 v[36:39], v[204:207], v[180:183], v[36:39]
    v_mfma_f32_16x16x32_bf16 v[36:39], v[200:203], v[176:179], v[36:39]
    v_mfma_f32_16x16x32_bf16 v[44:47], v[200:203], v[184:187], v[44:47]
    v_mfma_f32_16x16x32_bf16 v[44:47], v[204:207], v[188:191], v[44:47]
    s_waitcnt lgkmcnt(7)
    v_mfma_f32_16x16x32_bf16 v[116:119], v[196:199], v[228:231], v[116:119]
    v_mfma_f32_16x16x32_bf16 v[116:119], v[192:195], v[224:227], v[116:119]
    v_mfma_f32_16x16x32_bf16 v[104:107], v[184:187], v[224:227], v[104:107]
    v_mfma_f32_16x16x32_bf16 v[104:107], v[188:191], v[228:231], v[104:107]
    v_mfma_f32_16x16x32_bf16 v[96:99], v[180:183], v[228:231], v[96:99]
    s_waitcnt lgkmcnt(0)
    s_barrier
    v_mfma_f32_16x16x32_bf16 v[96:99], v[176:179], v[224:227], v[96:99]
    ds_read_b64_tr_b16 v[200:201], v6 offset:1024
    v_mfma_f32_16x16x32_bf16 v[88:91], v[168:171], v[224:227], v[88:91]
    ds_read_b64_tr_b16 v[202:203], v6 offset:1536
    v_mfma_f32_16x16x32_bf16 v[88:91], v[172:175], v[228:231], v[88:91]
    ds_read_b64_tr_b16 v[204:205], v6 offset:13312
    v_mfma_f32_16x16x32_bf16 v[80:83], v[164:167], v[228:231], v[80:83]
    ds_read_b64_tr_b16 v[206:207], v6 offset:13824
    v_mfma_f32_16x16x32_bf16 v[80:83], v[160:163], v[224:227], v[80:83]
    v_mfma_f32_16x16x32_bf16 v[84:87], v[160:163], v[232:235], v[84:87]
    ds_read_b64_tr_b16 v[224:225], v7 offset:1024
    v_mfma_f32_16x16x32_bf16 v[84:87], v[164:167], v[236:239], v[84:87]
    ds_read_b64_tr_b16 v[226:227], v7 offset:1536
    v_mfma_f32_16x16x32_bf16 v[92:95], v[172:175], v[236:239], v[92:95]
    ds_read_b64_tr_b16 v[228:229], v7 offset:13312
    v_mfma_f32_16x16x32_bf16 v[92:95], v[168:171], v[232:235], v[92:95]
    ds_read_b64_tr_b16 v[230:231], v7 offset:13824
    v_mfma_f32_16x16x32_bf16 v[100:103], v[176:179], v[232:235], v[100:103]
    v_mfma_f32_16x16x32_bf16 v[100:103], v[180:183], v[236:239], v[100:103]
    v_mfma_f32_16x16x32_bf16 v[108:111], v[188:191], v[236:239], v[108:111]
    v_mfma_f32_16x16x32_bf16 v[108:111], v[184:187], v[232:235], v[108:111]
    s_waitcnt lgkmcnt(4)
    v_mfma_f32_16x16x32_bf16 v[112:115], v[200:203], v[152:155], v[112:115]
    ds_read_b64_tr_b16 v[232:233], v6 offset:0
    v_mfma_f32_16x16x32_bf16 v[112:115], v[204:207], v[156:159], v[112:115]
    ds_read_b64_tr_b16 v[234:235], v6 offset:512
    v_mfma_f32_16x16x32_bf16 v[72:75], v[204:207], v[148:151], v[72:75]
    ds_read_b64_tr_b16 v[236:237], v6 offset:12288
    v_mfma_f32_16x16x32_bf16 v[72:75], v[200:203], v[144:147], v[72:75]
    ds_read_b64_tr_b16 v[238:239], v6 offset:12800
    v_mfma_f32_16x16x32_bf16 v[64:67], v[200:203], v[136:139], v[64:67]
    ds_read_b128 v[192:195], v2 offset:18432
    v_mfma_f32_16x16x32_bf16 v[64:67], v[204:207], v[140:143], v[64:67]
    ds_read_b128 v[196:199], v3 offset:18432
    v_mfma_f32_16x16x32_bf16 v[56:59], v[204:207], v[132:135], v[56:59]
    ds_read_b128 v[184:187], v4 offset:24576
    v_mfma_f32_16x16x32_bf16 v[56:59], v[200:203], v[128:131], v[56:59]
    ds_read_b128 v[188:191], v5 offset:24576
    v_mfma_f32_16x16x32_bf16 v[48:51], v[200:203], v[120:123], v[48:51]
    v_mfma_f32_16x16x32_bf16 v[48:51], v[204:207], v[124:127], v[48:51]
    s_waitcnt lgkmcnt(8)
    v_mfma_f32_16x16x32_bf16 v[52:55], v[228:231], v[124:127], v[52:55]
    ds_read_b64_tr_b16 v[200:201], v7 offset:0
    v_mfma_f32_16x16x32_bf16 v[52:55], v[224:227], v[120:123], v[52:55]
    ds_read_b64_tr_b16 v[202:203], v7 offset:512
    v_mfma_f32_16x16x32_bf16 v[60:63], v[224:227], v[128:131], v[60:63]
    ds_read_b64_tr_b16 v[204:205], v7 offset:12288
    v_mfma_f32_16x16x32_bf16 v[60:63], v[228:231], v[132:135], v[60:63]
    ds_read_b64_tr_b16 v[206:207], v7 offset:12800
    v_mfma_f32_16x16x32_bf16 v[68:71], v[228:231], v[140:143], v[68:71]
    ds_read_b128 v[176:179], v4 offset:22528
    v_mfma_f32_16x16x32_bf16 v[68:71], v[224:227], v[136:139], v[68:71]
    ds_read_b128 v[180:183], v5 offset:22528
    v_mfma_f32_16x16x32_bf16 v[76:79], v[224:227], v[144:147], v[76:79]
    ds_read_b128 v[168:171], v4 offset:20480
    v_mfma_f32_16x16x32_bf16 v[76:79], v[228:231], v[148:151], v[76:79]
    s_waitcnt lgkmcnt(11)
    v_mfma_f32_16x16x32_bf16 v[40:43], v[236:239], v[148:151], v[40:43]
    ds_read_b64_tr_b16 v[224:225], v6 offset:2048
    v_mfma_f32_16x16x32_bf16 v[40:43], v[232:235], v[144:147], v[40:43]
    ds_read_b64_tr_b16 v[226:227], v6 offset:2560
    v_mfma_f32_16x16x32_bf16 v[32:35], v[232:235], v[136:139], v[32:35]
    ds_read_b64_tr_b16 v[228:229], v6 offset:14336
    v_mfma_f32_16x16x32_bf16 v[32:35], v[236:239], v[140:143], v[32:35]
    ds_read_b64_tr_b16 v[230:231], v6 offset:14848
    v_mfma_f32_16x16x32_bf16 v[24:27], v[236:239], v[132:135], v[24:27]
    ds_read_b128 v[172:175], v5 offset:20480
    v_mfma_f32_16x16x32_bf16 v[24:27], v[232:235], v[128:131], v[24:27]
    ds_read_b128 v[160:163], v4 offset:18432
    v_mfma_f32_16x16x32_bf16 v[16:19], v[232:235], v[120:123], v[16:19]
    ds_read_b128 v[164:167], v5 offset:18432
    v_mfma_f32_16x16x32_bf16 v[16:19], v[236:239], v[124:127], v[16:19]
    s_waitcnt lgkmcnt(10)
    v_mfma_f32_16x16x32_bf16 v[20:23], v[204:207], v[124:127], v[20:23]
    ds_read_b64_tr_b16 v[232:233], v7 offset:2048
    v_mfma_f32_16x16x32_bf16 v[20:23], v[200:203], v[120:123], v[20:23]
    ds_read_b64_tr_b16 v[234:235], v7 offset:2560
    v_mfma_f32_16x16x32_bf16 v[28:31], v[200:203], v[128:131], v[28:31]
    ds_read_b64_tr_b16 v[236:237], v7 offset:14336
    v_mfma_f32_16x16x32_bf16 v[28:31], v[204:207], v[132:135], v[28:31]
    ds_read_b64_tr_b16 v[238:239], v7 offset:14848
    v_mfma_f32_16x16x32_bf16 v[36:39], v[204:207], v[140:143], v[36:39]
    buffer_load_dword v222, v220, s[68:71], s98 offen sc1
    v_mfma_f32_16x16x32_bf16 v[36:39], v[200:203], v[136:139], v[36:39]
    v_mfma_f32_16x16x32_bf16 v[44:47], v[200:203], v[144:147], v[44:47]
    v_mfma_f32_16x16x32_bf16 v[44:47], v[204:207], v[148:151], v[44:47]
    s_waitcnt lgkmcnt(7)
    v_mfma_f32_16x16x32_bf16 v[116:119], v[156:159], v[228:231], v[116:119]
    v_mfma_f32_16x16x32_bf16 v[116:119], v[152:155], v[224:227], v[116:119]
    v_mfma_f32_16x16x32_bf16 v[104:107], v[144:147], v[224:227], v[104:107]
    v_mfma_f32_16x16x32_bf16 v[104:107], v[148:151], v[228:231], v[104:107]
    v_mfma_f32_16x16x32_bf16 v[96:99], v[140:143], v[228:231], v[96:99]
    s_waitcnt lgkmcnt(0)
    s_barrier
    v_mfma_f32_16x16x32_bf16 v[96:99], v[136:139], v[224:227], v[96:99]
    ds_read_b64_tr_b16 v[200:201], v6 offset:25600
    v_mfma_f32_16x16x32_bf16 v[88:91], v[128:131], v[224:227], v[88:91]
    ds_read_b64_tr_b16 v[202:203], v6 offset:26112
    v_mfma_f32_16x16x32_bf16 v[88:91], v[132:135], v[228:231], v[88:91]
    ds_read_b64_tr_b16 v[204:205], v6 offset:37888
    v_mfma_f32_16x16x32_bf16 v[80:83], v[124:127], v[228:231], v[80:83]
    ds_read_b64_tr_b16 v[206:207], v6 offset:38400
    v_mfma_f32_16x16x32_bf16 v[80:83], v[120:123], v[224:227], v[80:83]
    v_mfma_f32_16x16x32_bf16 v[84:87], v[120:123], v[232:235], v[84:87]
    ds_read_b64_tr_b16 v[224:225], v7 offset:25600
    v_mfma_f32_16x16x32_bf16 v[84:87], v[124:127], v[236:239], v[84:87]
    ds_read_b64_tr_b16 v[226:227], v7 offset:26112
    v_mfma_f32_16x16x32_bf16 v[92:95], v[132:135], v[236:239], v[92:95]
    ds_read_b64_tr_b16 v[228:229], v7 offset:37888
    v_mfma_f32_16x16x32_bf16 v[92:95], v[128:131], v[232:235], v[92:95]
    ds_read_b64_tr_b16 v[230:231], v7 offset:38400
    v_mfma_f32_16x16x32_bf16 v[100:103], v[136:139], v[232:235], v[100:103]
    v_mfma_f32_16x16x32_bf16 v[100:103], v[140:143], v[236:239], v[100:103]
    v_mfma_f32_16x16x32_bf16 v[108:111], v[148:151], v[236:239], v[108:111]
    v_mfma_f32_16x16x32_bf16 v[108:111], v[144:147], v[232:235], v[108:111]
    s_waitcnt lgkmcnt(4)
    v_mfma_f32_16x16x32_bf16 v[112:115], v[200:203], v[192:195], v[112:115]
    ds_read_b64_tr_b16 v[232:233], v6 offset:24576
    v_mfma_f32_16x16x32_bf16 v[112:115], v[204:207], v[196:199], v[112:115]
    ds_read_b64_tr_b16 v[234:235], v6 offset:25088
    v_mfma_f32_16x16x32_bf16 v[72:75], v[204:207], v[188:191], v[72:75]
    ds_read_b64_tr_b16 v[236:237], v6 offset:36864
    v_mfma_f32_16x16x32_bf16 v[72:75], v[200:203], v[184:187], v[72:75]
    ds_read_b64_tr_b16 v[238:239], v6 offset:37376
    v_mfma_f32_16x16x32_bf16 v[64:67], v[200:203], v[176:179], v[64:67]
    ds_read_b128 v[152:155], v2 offset:36864
    v_mfma_f32_16x16x32_bf16 v[64:67], v[204:207], v[180:183], v[64:67]
    ds_read_b128 v[156:159], v3 offset:36864
    v_mfma_f32_16x16x32_bf16 v[56:59], v[204:207], v[172:175], v[56:59]
    ds_read_b128 v[144:147], v4 offset:43008
    v_mfma_f32_16x16x32_bf16 v[56:59], v[200:203], v[168:171], v[56:59]
    ds_read_b128 v[148:151], v5 offset:43008
    v_mfma_f32_16x16x32_bf16 v[48:51], v[200:203], v[160:163], v[48:51]
    v_mfma_f32_16x16x32_bf16 v[48:51], v[204:207], v[164:167], v[48:51]
    s_waitcnt lgkmcnt(8)
    v_mfma_f32_16x16x32_bf16 v[52:55], v[228:231], v[164:167], v[52:55]
    ds_read_b64_tr_b16 v[200:201], v7 offset:24576
    v_mfma_f32_16x16x32_bf16 v[52:55], v[224:227], v[160:163], v[52:55]
    ds_read_b64_tr_b16 v[202:203], v7 offset:25088
    v_mfma_f32_16x16x32_bf16 v[60:63], v[224:227], v[168:171], v[60:63]
    ds_read_b64_tr_b16 v[204:205], v7 offset:36864
    v_mfma_f32_16x16x32_bf16 v[60:63], v[228:231], v[172:175], v[60:63]
    ds_read_b64_tr_b16 v[206:207], v7 offset:37376
    v_mfma_f32_16x16x32_bf16 v[68:71], v[228:231], v[180:183], v[68:71]
    ds_read_b128 v[136:139], v4 offset:40960
    v_mfma_f32_16x16x32_bf16 v[68:71], v[224:227], v[176:179], v[68:71]
    ds_read_b128 v[140:143], v5 offset:40960
    v_mfma_f32_16x16x32_bf16 v[76:79], v[224:227], v[184:187], v[76:79]
    ds_read_b128 v[128:131], v4 offset:38912
    v_mfma_f32_16x16x32_bf16 v[76:79], v[228:231], v[188:191], v[76:79]
    s_waitcnt lgkmcnt(11)
    v_mfma_f32_16x16x32_bf16 v[40:43], v[236:239], v[188:191], v[40:43]
    ds_read_b64_tr_b16 v[224:225], v6 offset:26624
    v_mfma_f32_16x16x32_bf16 v[40:43], v[232:235], v[184:187], v[40:43]
    ds_read_b64_tr_b16 v[226:227], v6 offset:27136
    v_mfma_f32_16x16x32_bf16 v[32:35], v[232:235], v[176:179], v[32:35]
    ds_read_b64_tr_b16 v[228:229], v6 offset:38912
    v_mfma_f32_16x16x32_bf16 v[32:35], v[236:239], v[180:183], v[32:35]
    ds_read_b64_tr_b16 v[230:231], v6 offset:39424
    v_mfma_f32_16x16x32_bf16 v[24:27], v[236:239], v[172:175], v[24:27]
    ds_read_b128 v[132:135], v5 offset:38912
    v_mfma_f32_16x16x32_bf16 v[24:27], v[232:235], v[168:171], v[24:27]
    ds_read_b128 v[120:123], v4 offset:36864
    v_mfma_f32_16x16x32_bf16 v[16:19], v[232:235], v[160:163], v[16:19]
    ds_read_b128 v[124:127], v5 offset:36864
    v_mfma_f32_16x16x32_bf16 v[16:19], v[236:239], v[164:167], v[16:19]
    s_waitcnt lgkmcnt(10)
    v_mfma_f32_16x16x32_bf16 v[20:23], v[204:207], v[164:167], v[20:23]
    ds_read_b64_tr_b16 v[232:233], v7 offset:26624
    v_mfma_f32_16x16x32_bf16 v[20:23], v[200:203], v[160:163], v[20:23]
    ds_read_b64_tr_b16 v[234:235], v7 offset:27136
    v_mfma_f32_16x16x32_bf16 v[28:31], v[200:203], v[168:171], v[28:31]
    ds_read_b64_tr_b16 v[236:237], v7 offset:38912
    v_mfma_f32_16x16x32_bf16 v[28:31], v[204:207], v[172:175], v[28:31]
    ds_read_b64_tr_b16 v[238:239], v7 offset:39424
    v_mfma_f32_16x16x32_bf16 v[36:39], v[204:207], v[180:183], v[36:39]
    v_mfma_f32_16x16x32_bf16 v[36:39], v[200:203], v[176:179], v[36:39]
    v_mfma_f32_16x16x32_bf16 v[44:47], v[200:203], v[184:187], v[44:47]
    v_mfma_f32_16x16x32_bf16 v[44:47], v[204:207], v[188:191], v[44:47]
    s_waitcnt lgkmcnt(7)
    v_mfma_f32_16x16x32_bf16 v[116:119], v[196:199], v[228:231], v[116:119]
    v_mfma_f32_16x16x32_bf16 v[116:119], v[192:195], v[224:227], v[116:119]
    v_mfma_f32_16x16x32_bf16 v[104:107], v[184:187], v[224:227], v[104:107]
    v_mfma_f32_16x16x32_bf16 v[104:107], v[188:191], v[228:231], v[104:107]
    v_mfma_f32_16x16x32_bf16 v[96:99], v[180:183], v[228:231], v[96:99]
    s_waitcnt lgkmcnt(0)
    s_barrier
    v_mfma_f32_16x16x32_bf16 v[96:99], v[176:179], v[224:227], v[96:99]
    ds_read_b64_tr_b16 v[200:201], v6 offset:50176
    v_mfma_f32_16x16x32_bf16 v[88:91], v[168:171], v[224:227], v[88:91]
    ds_read_b64_tr_b16 v[202:203], v6 offset:50688
    v_mfma_f32_16x16x32_bf16 v[88:91], v[172:175], v[228:231], v[88:91]
    ds_read_b64_tr_b16 v[204:205], v6 offset:62464
    v_mfma_f32_16x16x32_bf16 v[80:83], v[164:167], v[228:231], v[80:83]
    ds_read_b64_tr_b16 v[206:207], v6 offset:62976
    v_mfma_f32_16x16x32_bf16 v[80:83], v[160:163], v[224:227], v[80:83]
    v_mfma_f32_16x16x32_bf16 v[84:87], v[160:163], v[232:235], v[84:87]
    ds_read_b64_tr_b16 v[224:225], v7 offset:50176
    v_mfma_f32_16x16x32_bf16 v[84:87], v[164:167], v[236:239], v[84:87]
    ds_read_b64_tr_b16 v[226:227], v7 offset:50688
    v_mfma_f32_16x16x32_bf16 v[92:95], v[172:175], v[236:239], v[92:95]
    ds_read_b64_tr_b16 v[228:229], v7 offset:62464
    v_mfma_f32_16x16x32_bf16 v[92:95], v[168:171], v[232:235], v[92:95]
    ds_read_b64_tr_b16 v[230:231], v7 offset:62976
    v_mfma_f32_16x16x32_bf16 v[100:103], v[176:179], v[232:235], v[100:103]
    v_mfma_f32_16x16x32_bf16 v[100:103], v[180:183], v[236:239], v[100:103]
    v_mfma_f32_16x16x32_bf16 v[108:111], v[188:191], v[236:239], v[108:111]
    v_mfma_f32_16x16x32_bf16 v[108:111], v[184:187], v[232:235], v[108:111]
    s_waitcnt lgkmcnt(4)
    v_mfma_f32_16x16x32_bf16 v[112:115], v[200:203], v[152:155], v[112:115]
    ds_read_b64_tr_b16 v[232:233], v6 offset:49152
    v_mfma_f32_16x16x32_bf16 v[112:115], v[204:207], v[156:159], v[112:115]
    ds_read_b64_tr_b16 v[234:235], v6 offset:49664
    v_mfma_f32_16x16x32_bf16 v[72:75], v[204:207], v[148:151], v[72:75]
    ds_read_b64_tr_b16 v[236:237], v6 offset:61440
    v_mfma_f32_16x16x32_bf16 v[72:75], v[200:203], v[144:147], v[72:75]
    ds_read_b64_tr_b16 v[238:239], v6 offset:61952
    v_mfma_f32_16x16x32_bf16 v[64:67], v[200:203], v[136:139], v[64:67]
    ds_read_b128 v[192:195], v2 offset:0
    v_mfma_f32_16x16x32_bf16 v[64:67], v[204:207], v[140:143], v[64:67]
    ds_read_b128 v[196:199], v3 offset:0
    v_mfma_f32_16x16x32_bf16 v[56:59], v[204:207], v[132:135], v[56:59]
    ds_read_b128 v[184:187], v4 offset:6144
    v_mfma_f32_16x16x32_bf16 v[56:59], v[200:203], v[128:131], v[56:59]
    ds_read_b128 v[188:191], v5 offset:6144
    v_mfma_f32_16x16x32_bf16 v[48:51], v[200:203], v[120:123], v[48:51]
    v_mfma_f32_16x16x32_bf16 v[48:51], v[204:207], v[124:127], v[48:51]
    s_waitcnt lgkmcnt(8)
    v_mfma_f32_16x16x32_bf16 v[52:55], v[228:231], v[124:127], v[52:55]
    ds_read_b64_tr_b16 v[200:201], v7 offset:49152
    v_mfma_f32_16x16x32_bf16 v[52:55], v[224:227], v[120:123], v[52:55]
    ds_read_b64_tr_b16 v[202:203], v7 offset:49664
    v_mfma_f32_16x16x32_bf16 v[60:63], v[224:227], v[128:131], v[60:63]
    ds_read_b64_tr_b16 v[204:205], v7 offset:61440
    v_mfma_f32_16x16x32_bf16 v[60:63], v[228:231], v[132:135], v[60:63]
    ds_read_b64_tr_b16 v[206:207], v7 offset:61952
    v_mfma_f32_16x16x32_bf16 v[68:71], v[228:231], v[140:143], v[68:71]
    ds_read_b128 v[176:179], v4 offset:4096
    v_mfma_f32_16x16x32_bf16 v[68:71], v[224:227], v[136:139], v[68:71]
    ds_read_b128 v[180:183], v5 offset:4096
    v_mfma_f32_16x16x32_bf16 v[76:79], v[224:227], v[144:147], v[76:79]
    ds_read_b128 v[168:171], v4 offset:2048
    v_mfma_f32_16x16x32_bf16 v[76:79], v[228:231], v[148:151], v[76:79]
    s_waitcnt lgkmcnt(11)
    v_mfma_f32_16x16x32_bf16 v[40:43], v[236:239], v[148:151], v[40:43]
    ds_read_b64_tr_b16 v[224:225], v6 offset:51200
    v_mfma_f32_16x16x32_bf16 v[40:43], v[232:235], v[144:147], v[40:43]
    ds_read_b64_tr_b16 v[226:227], v6 offset:51712
    v_mfma_f32_16x16x32_bf16 v[32:35], v[232:235], v[136:139], v[32:35]
    ds_read_b64_tr_b16 v[228:229], v6 offset:63488
    v_mfma_f32_16x16x32_bf16 v[32:35], v[236:239], v[140:143], v[32:35]
    ds_read_b64_tr_b16 v[230:231], v6 offset:64000
    v_mfma_f32_16x16x32_bf16 v[24:27], v[236:239], v[132:135], v[24:27]
    ds_read_b128 v[172:175], v5 offset:2048
    v_mfma_f32_16x16x32_bf16 v[24:27], v[232:235], v[128:131], v[24:27]
    ds_read_b128 v[160:163], v4 offset:0
    v_mfma_f32_16x16x32_bf16 v[16:19], v[232:235], v[120:123], v[16:19]
    ds_read_b128 v[164:167], v5 offset:0
    v_mfma_f32_16x16x32_bf16 v[16:19], v[236:239], v[124:127], v[16:19]
    s_waitcnt lgkmcnt(10)
    v_mfma_f32_16x16x32_bf16 v[20:23], v[204:207], v[124:127], v[20:23]
    ds_read_b64_tr_b16 v[232:233], v7 offset:51200
    v_mfma_f32_16x16x32_bf16 v[20:23], v[200:203], v[120:123], v[20:23]
    ds_read_b64_tr_b16 v[234:235], v7 offset:51712
    v_mfma_f32_16x16x32_bf16 v[28:31], v[200:203], v[128:131], v[28:31]
    ds_read_b64_tr_b16 v[236:237], v7 offset:63488
    v_mfma_f32_16x16x32_bf16 v[28:31], v[204:207], v[132:135], v[28:31]
    ds_read_b64_tr_b16 v[238:239], v7 offset:64000
    v_mfma_f32_16x16x32_bf16 v[36:39], v[204:207], v[140:143], v[36:39]
    v_mfma_f32_16x16x32_bf16 v[36:39], v[200:203], v[136:139], v[36:39]
    v_mfma_f32_16x16x32_bf16 v[44:47], v[200:203], v[144:147], v[44:47]
    v_mfma_f32_16x16x32_bf16 v[44:47], v[204:207], v[148:151], v[44:47]
    s_waitcnt lgkmcnt(7)
    v_mfma_f32_16x16x32_bf16 v[116:119], v[156:159], v[228:231], v[116:119]
    v_mfma_f32_16x16x32_bf16 v[116:119], v[152:155], v[224:227], v[116:119]
    v_mfma_f32_16x16x32_bf16 v[104:107], v[144:147], v[224:227], v[104:107]
    v_mfma_f32_16x16x32_bf16 v[104:107], v[148:151], v[228:231], v[104:107]
    v_mfma_f32_16x16x32_bf16 v[96:99], v[140:143], v[228:231], v[96:99]
    s_waitcnt lgkmcnt(0)
    s_barrier
    s_cmp_lg_u32 s3, 0
    s_cbranch_scc1 LB_sk
    s_waitcnt vmcnt(0)
    v_cmp_eq_u32 vcc, 0, v222
    s_cbranch_vccnz LB_slow
LB_back:
    s_mov_b64 exec, 1
    buffer_store_dword v222, v220, s[52:55], s96 offen sc1
    s_mov_b64 exec, -1
LB_sk:
    v_mfma_f32_16x16x32_bf16 v[96:99], v[136:139], v[224:227], v[96:99]
    ds_read_b64_tr_b16 v[200:201], v6 offset:1024
    v_mfma_f32_16x16x32_bf16 v[88:91], v[128:131], v[224:227], v[88:91]
    ds_read_b64_tr_b16 v[202:203], v6 offset:1536
    v_mfma_f32_16x16x32_bf16 v[88:91], v[132:135], v[228:231], v[88:91]
    ds_read_b64_tr_b16 v[204:205], v6 offset:13312
    v_mfma_f32_16x16x32_bf16 v[80:83], v[124:127], v[228:231], v[80:83]
    ds_read_b64_tr_b16 v[206:207], v6 offset:13824
    v_mfma_f32_16x16x32_bf16 v[80:83], v[120:123], v[224:227], v[80:83]
    v_mfma_f32_16x16x32_bf16 v[84:87], v[120:123], v[232:235], v[84:87]
    ds_read_b64_tr_b16 v[224:225], v7 offset:1024
    v_mfma_f32_16x16x32_bf16 v[84:87], v[124:127], v[236:239], v[84:87]
    ds_read_b64_tr_b16 v[226:227], v7 offset:1536
    v_mfma_f32_16x16x32_bf16 v[92:95], v[132:135], v[236:239], v[92:95]
    ds_read_b64_tr_b16 v[228:229], v7 offset:13312
    v_mfma_f32_16x16x32_bf16 v[92:95], v[128:131], v[232:235], v[92:95]
    ds_read_b64_tr_b16 v[230:231], v7 offset:13824
    v_mfma_f32_16x16x32_bf16 v[100:103], v[136:139], v[232:235], v[100:103]
    v_mfma_f32_16x16x32_bf16 v[100:103], v[140:143], v[236:239], v[100:103]
    v_mfma_f32_16x16x32_bf16 v[108:111], v[148:151], v[236:239], v[108:111]
    v_mfma_f32_16x16x32_bf16 v[108:111], v[144:147], v[232:235], v[108:111]
    s_waitcnt lgkmcnt(4)
    v_mfma_f32_16x16x32_bf16 v[112:115], v[200:203], v[192:195], v[112:115]
    ds_read_b64_tr_b16 v[232:233], v6 offset:0
    v_mfma_f32_16x16x32_bf16 v[112:115], v[204:207], v[196:199], v[112:115]
    ds_read_b64_tr_b16 v[234:235], v6 offset:512
    v_mfma_f32_16x16x32_bf16 v[72:75], v[204:207], v[188:191], v[72:75]
    ds_read_b64_tr_b16 v[236:237], v6 offset:12288
    v_mfma_f32_16x16x32_bf16 v[72:75], v[200:203], v[184:187], v[72:75]
    ds_read_b64_tr_b16 v[238:239], v6 offset:12800
    v_mfma_f32_16x16x32_bf16 v[64:67], v[200:203], v[176:179], v[64:67]
    ds_read_b128 v[152:155], v2 offset:18432
    v_mfma_f32_16x16x32_bf16 v[64:67], v[204:207], v[180:183], v[64:67]
    ds_read_b128 v[156:159], v3 offset:18432
    v_mfma_f32_16x16x32_bf16 v[56:59], v[204:207], v[172:175], v[56:59]
    ds_read_b128 v[144:147], v4 offset:24576
    v_mfma_f32_16x16x32_bf16 v[56:59], v[200:203], v[168:171], v[56:59]
    ds_read_b128 v[148:151], v5 offset:24576
    v_mfma_f32_16x16x32_bf16 v[48:51], v[200:203], v[160:163], v[48:51]
    v_mfma_f32_16x16x32_bf16 v[48:51], v[204:207], v[164:167], v[48:51]
    s_waitcnt lgkmcnt(8)
    v_mfma_f32_16x16x32_bf16 v[52:55], v[228:231], v[164:167], v[52:55]
    ds_read_b64_tr_b16 v[200:201], v7 offset:0
    v_mfma_f32_16x16x32_bf16 v[52:55], v[224:227], v[160:163], v[52:55]
    ds_read_b64_tr_b16 v[202:203], v7 offset:512
    v_mfma_f32_16x16x32_bf16 v[60:63], v[224:227], v[168:171], v[60:63]
    ds_read_b64_tr_b16 v[204:205], v7 offset:12288
    v_mfma_f32_16x16x32_bf16 v[60:63], v[228:231], v[172:175], v[60:63]
    ds_read_b64_tr_b16 v[206:207], v7 offset:12800
    v_mfma_f32_16x16x32_bf16 v[68:71], v[228:231], v[180:183], v[68:71]
    ds_read_b128 v[136:139], v4 offset:22528
    v_mfma_f32_16x16x32_bf16 v[68:71], v[224:227], v[176:179], v[68:71]
    ds_read_b128 v[140:143], v5 offset:22528
    v_mfma_f32_16x16x32_bf16 v[76:79], v[224:227], v[184:187], v[76:79]
    ds_read_b128 v[128:131], v4 offset:20480
    v_mfma_f32_16x16x32_bf16 v[76:79], v[228:231], v[188:191], v[76:79]
    s_waitcnt lgkmcnt(11)
    v_mfma_f32_16x16x32_bf16 v[40:43], v[236:239], v[188:191], v[40:43]
    ds_read_b64_tr_b16 v[224:225], v6 offset:2048
    v_mfma_f32_16x16x32_bf16 v[40:43], v[232:235], v[184:187], v[40:43]
    ds_read_b64_tr_b16 v[226:227], v6 offset:2560
    v_mfma_f32_16x16x32_bf16 v[32:35], v[232:235], v[176:179], v[32:35]
    ds_read_b64_tr_b16 v[228:229], v6 offset:14336
    v_mfma_f32_16x16x32_bf16 v[32:35], v[236:239], v[180:183], v[32:35]
    ds_read_b64_tr_b16 v[230:231], v6 offset:14848
    v_mfma_f32_16x16x32_bf16 v[24:27], v[236:239], v[172:175], v[24:27]
    ds_read_b128 v[132:135], v5 offset:20480
    v_mfma_f32_16x16x32_bf16 v[24:27], v[232:235], v[168:171], v[24:27]
    ds_read_b128 v[120:123], v4 offset:18432
    v_mfma_f32_16x16x32_bf16 v[16:19], v[232:235], v[160:163], v[16:19]
    ds_read_b128 v[124:127], v5 offset:18432
    v_mfma_f32_16x16x32_bf16 v[16:19], v[236:239], v[164:167], v[16:19]
    s_waitcnt lgkmcnt(10)
    v_mfma_f32_16x16x32_bf16 v[20:23], v[204:207], v[164:167], v[20:23]
    ds_read_b64_tr_b16 v[232:233], v7 offset:2048
    v_mfma_f32_16x16x32_bf16 v[20:23], v[200:203], v[160:163], v[20:23]
    ds_read_b64_tr_b16 v[234:235], v7 offset:2560
    v_mfma_f32_16x16x32_bf16 v[28:31], v[200:203], v[168:171], v[28:31]
    ds_read_b64_tr_b16 v[236:237], v7 offset:14336
    v_mfma_f32_16x16x32_bf16 v[28:31], v[204:207], v[172:175], v[28:31]
    ds_read_b64_tr_b16 v[238:239], v7 offset:14848
    v_mfma_f32_16x16x32_bf16 v[36:39], v[204:207], v[180:183], v[36:39]
    v_mfma_f32_16x16x32_bf16 v[36:39], v[200:203], v[176:179], v[36:39]
    v_mfma_f32_16x16x32_bf16 v[44:47], v[200:203], v[184:187], v[44:47]
    v_mfma_f32_16x16x32_bf16 v[44:47], v[204:207], v[188:191], v[44:47]
    s_waitcnt lgkmcnt(7)
    v_mfma_f32_16x16x32_bf16 v[116:119], v[196:199], v[228:231], v[116:119]
    v_mfma_f32_16x16x32_bf16 v[116:119], v[192:195], v[224:227], v[116:119]
    v_mfma_f32_16x16x32_bf16 v[104:107], v[184:187], v[224:227], v[104:107]
    v_mfma_f32_16x16x32_bf16 v[104:107], v[188:191], v[228:231], v[104:107]
    v_mfma_f32_16x16x32_bf16 v[96:99], v[180:183], v[228:231], v[96:99]
    s_waitcnt lgkmcnt(0)
    s_barrier
    v_mfma_f32_16x16x32_bf16 v[96:99], v[176:179], v[224:227], v[96:99]
    ds_read_b64_tr_b16 v[200:201], v6 offset:25600
    v_mfma_f32_16x16x32_bf16 v[88:91], v[168:171], v[224:227], v[88:91]
    ds_read_b64_tr_b16 v[202:203], v6 offset:26112
    v_mfma_f32_16x16x32_bf16 v[88:91], v[172:175], v[228:231], v[88:91]
    ds_read_b64_tr_b16 v[204:205], v6 offset:37888
    v_mfma_f32_16x16x32_bf16 v[80:83], v[164:167], v[228:231], v[80:83]
    ds_read_b64_tr_b16 v[206:207], v6 offset:38400
    v_mfma_f32_16x16x32_bf16 v[80:83], v[160:163], v[224:227], v[80:83]
    v_mfma_f32_16x16x32_bf16 v[84:87], v[160:163], v[232:235], v[84:87]
    ds_read_b64_tr_b16 v[224:225], v7 offset:25600
    v_mfma_f32_16x16x32_bf16 v[84:87], v[164:167], v[236:239], v[84:87]
    ds_read_b64_tr_b16 v[226:227], v7 offset:26112
    v_mfma_f32_16x16x32_bf16 v[92:95], v[172:175], v[236:239], v[92:95]
    ds_read_b64_tr_b16 v[228:229], v7 offset:37888
    v_mfma_f32_16x16x32_bf16 v[92:95], v[168:171], v[232:235], v[92:95]
    ds_read_b64_tr_b16 v[230:231], v7 offset:38400
    v_mfma_f32_16x16x32_bf16 v[100:103], v[176:179], v[232:235], v[100:103]
    v_mfma_f32_16x16x32_bf16 v[100:103], v[180:183], v[236:239], v[100:103]
    v_mfma_f32_16x16x32_bf16 v[108:111], v[188:191], v[236:239], v[108:111]
    v_mfma_f32_16x16x32_bf16 v[108:111], v[184:187], v[232:235], v[108:111]
    s_waitcnt lgkmcnt(4)
    v_mfma_f32_16x16x32_bf16 v[112:115], v[200:203], v[152:155], v[112:115]
    ds_read_b64_tr_b16 v[232:233], v6 offset:24576
    v_mfma_f32_16x16x32_bf16 v[112:115], v[204:207], v[156:159], v[112:115]
    ds_read_b64_tr_b16 v[234:235], v6 offset:25088
    v_mfma_f32_16x16x32_bf16 v[72:75], v[204:207], v[148:151], v[72:75]
    ds_read_b64_tr_b16 v[236:237], v6 offset:36864
    v_mfma_f32_16x16x32_bf16 v[72:75], v[200:203], v[144:147], v[72:75]
    ds_read_b64_tr_b16 v[238:239], v6 offset:37376
    v_mfma_f32_16x16x32_bf16 v[64:67], v[200:203], v[136:139], v[64:67]
    ds_read_b128 v[192:195], v2 offset:36864
    v_mfma_f32_16x16x32_bf16 v[64:67], v[204:207], v[140:143], v[64:67]
    ds_read_b128 v[196:199], v3 offset:36864
    v_mfma_f32_16x16x32_bf16 v[56:59], v[204:207], v[132:135], v[56:59]
    ds_read_b128 v[184:187], v4 offset:43008
    v_mfma_f32_16x16x32_bf16 v[56:59], v[200:203], v[128:131], v[56:59]
    ds_read_b128 v[188:191], v5 offset:43008
    v_mfma_f32_16x16x32_bf16 v[48:51], v[200:203], v[120:123], v[48:51]
    v_mfma_f32_16x16x32_bf16 v[48:51], v[204:207], v[124:127], v[48:51]
    s_waitcnt lgkmcnt(8)
    v_mfma_f32_16x16x32_bf16 v[52:55], v[228:231], v[124:127], v[52:55]
    ds_read_b64_tr_b16 v[200:201], v7 offset:24576
    v_mfma_f32_16x16x32_bf16 v[52:55], v[224:227], v[120:123], v[52:55]
    ds_read_b64_tr_b16 v[202:203], v7 offset:25088
    v_mfma_f32_16x16x32_bf16 v[60:63], v[224:227], v[128:131], v[60:63]
    ds_read_b64_tr_b16 v[204:205], v7 offset:36864
    v_mfma_f32_16x16x32_bf16 v[60:63], v[228:231], v[132:135], v[60:63]
    ds_read_b64_tr_b16 v[206:207], v7 offset:37376
    v_mfma_f32_16x16x32_bf16 v[68:71], v[228:231], v[140:143], v[68:71]
    ds_read_b128 v[176:179], v4 offset:40960
    v_mfma_f32_16x16x32_bf16 v[68:71], v[224:227], v[136:139], v[68:71]
    ds_read_b128 v[180:183], v5 offset:40960
    v_mfma_f32_16x16x32_bf16 v[76:79], v[224:227], v[144:147], v[76:79]
    ds_read_b128 v[168:171], v4 offset:38912
    v_mfma_f32_16x16x32_bf16 v[76:79], v[228:231], v[148:151], v[76:79]
    s_waitcnt lgkmcnt(11)
    v_mfma_f32_16x16x32_bf16 v[40:43], v[236:239], v[148:151], v[40:43]
    ds_read_b64_tr_b16 v[224:225], v6 offset:26624
    v_mfma_f32_16x16x32_bf16 v[40:43], v[232:235], v[144:147], v[40:43]
    ds_read_b64_tr_b16 v[226:227], v6 offset:27136
    v_mfma_f32_16x16x32_bf16 v[32:35], v[232:235], v[136:139], v[32:35]
    ds_read_b64_tr_b16 v[228:229], v6 offset:38912
    v_mfma_f32_16x16x32_bf16 v[32:35], v[236:239], v[140:143], v[32:35]
    ds_read_b64_tr_b16 v[230:231], v6 offset:39424
    v_mfma_f32_16x16x32_bf16 v[24:27], v[236:239], v[132:135], v[24:27]
    ds_read_b128 v[172:175], v5 offset:38912
    v_mfma_f32_16x16x32_bf16 v[24:27], v[232:235], v[128:131], v[24:27]
    ds_read_b128 v[160:163], v4 offset:36864
    v_mfma_f32_16x16x32_bf16 v[16:19], v[232:235], v[120:123], v[16:19]
    ds_read_b128 v[164:167], v5 offset:36864
    v_mfma_f32_16x16x32_bf16 v[16:19], v[236:239], v[124:127], v[16:19]
    s_waitcnt lgkmcnt(10)
    v_mfma_f32_16x16x32_bf16 v[20:23], v[204:207], v[124:127], v[20:23]
    ds_read_b64_tr_b16 v[232:233], v7 offset:26624
    v_mfma_f32_16x16x32_bf16 v[20:23], v[200:203], v[120:123], v[20:23]
    ds_read_b64_tr_b16 v[234:235], v7 offset:27136
    v_mfma_f32_16x16x32_bf16 v[28:31], v[200:203], v[128:131], v[28:31]
    ds_read_b64_tr_b16 v[236:237], v7 offset:38912
    v_mfma_f32_16x16x32_bf16 v[28:31], v[204:207], v[132:135], v[28:31]
    ds_read_b64_tr_b16 v[238:239], v7 offset:39424
    v_mfma_f32_16x16x32_bf16 v[36:39], v[204:207], v[140:143], v[36:39]
    v_mfma_f32_16x16x32_bf16 v[36:39], v[200:203], v[136:139], v[36:39]
    v_mfma_f32_16x16x32_bf16 v[44:47], v[200:203], v[144:147], v[44:47]
    v_mfma_f32_16x16x32_bf16 v[44:47], v[204:207], v[148:151], v[44:47]
    s_waitcnt lgkmcnt(7)
    v_mfma_f32_16x16x32_bf16 v[116:119], v[156:159], v[228:231], v[116:119]
    v_mfma_f32_16x16x32_bf16 v[116:119], v[152:155], v[224:227], v[116:119]
    v_mfma_f32_16x16x32_bf16 v[104:107], v[144:147], v[224:227], v[104:107]
    v_mfma_f32_16x16x32_bf16 v[104:107], v[148:151], v[228:231], v[104:107]
    v_mfma_f32_16x16x32_bf16 v[96:99], v[140:143], v[228:231], v[96:99]
    s_waitcnt lgkmcnt(0)
    s_barrier
    v_mfma_f32_16x16x32_bf16 v[96:99], v[136:139], v[224:227], v[96:99]
    ds_read_b64_tr_b16 v[200:201], v6 offset:50176
    v_mfma_f32_16x16x32_bf16 v[88:91], v[128:131], v[224:227], v[88:91]
    ds_read_b64_tr_b16 v[202:203], v6 offset:50688
    v_mfma_f32_16x16x32_bf16 v[88:91], v[132:135], v[228:231], v[88:91]
    ds_read_b64_tr_b16 v[204:205], v6 offset:62464
    v_mfma_f32_16x16x32_bf16 v[80:83], v[124:127], v[228:231], v[80:83]
    ds_read_b64_tr_b16 v[206:207], v6 offset:62976
    v_mfma_f32_16x16x32_bf16 v[80:83], v[120:123], v[224:227], v[80:83]
    v_mfma_f32_16x16x32_bf16 v[84:87], v[120:123], v[232:235], v[84:87]
    ds_read_b64_tr_b16 v[224:225], v7 offset:50176
    v_mfma_f32_16x16x32_bf16 v[84:87], v[124:127], v[236:239], v[84:87]
    ds_read_b64_tr_b16 v[226:227], v7 offset:50688
    v_mfma_f32_16x16x32_bf16 v[92:95], v[132:135], v[236:239], v[92:95]
    ds_read_b64_tr_b16 v[228:229], v7 offset:62464
    v_mfma_f32_16x16x32_bf16 v[92:95], v[128:131], v[232:235], v[92:95]
    ds_read_b64_tr_b16 v[230:231], v7 offset:62976
    v_mfma_f32_16x16x32_bf16 v[100:103], v[136:139], v[232:235], v[100:103]
    v_mfma_f32_16x16x32_bf16 v[100:103], v[140:143], v[236:239], v[100:103]
    v_mfma_f32_16x16x32_bf16 v[108:111], v[148:151], v[236:239], v[108:111]
    v_mfma_f32_16x16x32_bf16 v[108:111], v[144:147], v[232:235], v[108:111]
    s_waitcnt lgkmcnt(4)
    v_mfma_f32_16x16x32_bf16 v[112:115], v[200:203], v[192:195], v[112:115]
    ds_read_b64_tr_b16 v[232:233], v6 offset:49152
    v_mfma_f32_16x16x32_bf16 v[112:115], v[204:207], v[196:199], v[112:115]
    ds_read_b64_tr_b16 v[234:235], v6 offset:49664
    v_mfma_f32_16x16x32_bf16 v[72:75], v[204:207], v[188:191], v[72:75]
    ds_read_b64_tr_b16 v[236:237], v6 offset:61440
    v_mfma_f32_16x16x32_bf16 v[72:75], v[200:203], v[184:187], v[72:75]
    ds_read_b64_tr_b16 v[238:239], v6 offset:61952
    v_mfma_f32_16x16x32_bf16 v[64:67], v[200:203], v[176:179], v[64:67]
    ds_read_b128 v[152:155], v2 offset:0
    v_mfma_f32_16x16x32_bf16 v[64:67], v[204:207], v[180:183], v[64:67]
    ds_read_b128 v[156:159], v3 offset:0
    v_mfma_f32_16x16x32_bf16 v[56:59], v[204:207], v[172:175], v[56:59]
    ds_read_b128 v[144:147], v4 offset:6144
    v_mfma_f32_16x16x32_bf16 v[56:59], v[200:203], v[168:171], v[56:59]
    ds_read_b128 v[148:151], v5 offset:6144
    v_mfma_f32_16x16x32_bf16 v[48:51], v[200:203], v[160:163], v[48:51]
    v_mfma_f32_16x16x32_bf16 v[48:51], v[204:207], v[164:167], v[48:51]
    s_waitcnt lgkmcnt(8)
    v_mfma_f32_16x16x32_bf16 v[52:55], v[228:231], v[164:167], v[52:55]
    ds_read_b64_tr_b16 v[200:201], v7 offset:49152
    v_mfma_f32_16x16x32_bf16 v[52:55], v[224:227], v[160:163], v[52:55]
    ds_read_b64_tr_b16 v[202:203], v7 offset:49664
    v_mfma_f32_16x16x32_bf16 v[60:63], v[224:227], v[168:171], v[60:63]
    ds_read_b64_tr_b16 v[204:205], v7 offset:61440
    v_mfma_f32_16x16x32_bf16 v[60:63], v[228:231], v[172:175], v[60:63]
    ds_read_b64_tr_b16 v[206:207], v7 offset:61952
    v_mfma_f32_16x16x32_bf16 v[68:71], v[228:231], v[180:183], v[68:71]
    ds_read_b128 v[136:139], v4 offset:4096
    v_mfma_f32_16x16x32_bf16 v[68:71], v[224:227], v[176:179], v[68:71]
    ds_read_b128 v[140:143], v5 offset:4096
    v_mfma_f32_16x16x32_bf16 v[76:79], v[224:227], v[184:187], v[76:79]
    ds_read_b128 v[128:131], v4 offset:2048
    v_mfma_f32_16x16x32_bf16 v[76:79], v[228:231], v[188:191], v[76:79]
    s_waitcnt lgkmcnt(11)
    v_mfma_f32_16x16x32_bf16 v[40:43], v[236:239], v[188:191], v[40:43]
    ds_read_b64_tr_b16 v[224:225], v6 offset:51200
    v_mfma_f32_16x16x32_bf16 v[40:43], v[232:235], v[184:187], v[40:43]
    ds_read_b64_tr_b16 v[226:227], v6 offset:51712
    v_mfma_f32_16x16x32_bf16 v[32:35], v[232:235], v[176:179], v[32:35]
    ds_read_b64_tr_b16 v[228:229], v6 offset:63488
    v_mfma_f32_16x16x32_bf16 v[32:35], v[236:239], v[180:183], v[32:35]
    ds_read_b64_tr_b16 v[230:231], v6 offset:64000
    v_mfma_f32_16x16x32_bf16 v[24:27], v[236:239], v[172:175], v[24:27]
    ds_read_b128 v[132:135], v5 offset:2048
    v_mfma_f32_16x16x32_bf16 v[24:27], v[232:235], v[168:171], v[24:27]
    ds_read_b128 v[120:123], v4 offset:0
    v_mfma_f32_16x16x32_bf16 v[16:19], v[232:235], v[160:163], v[16:19]
    ds_read_b128 v[124:127], v5 offset:0
    v_mfma_f32_16x16x32_bf16 v[16:19], v[236:239], v[164:167], v[16:19]
    s_waitcnt lgkmcnt(10)
    v_mfma_f32_16x16x32_bf16 v[20:23], v[204:207], v[164:167], v[20:23]
    ds_read_b64_tr_b16 v[232:233], v7 offset:51200
    v_mfma_f32_16x16x32_bf16 v[20:23], v[200:203], v[160:163], v[20:23]
    ds_read_b64_tr_b16 v[234:235], v7 offset:51712
    v_mfma_f32_16x16x32_bf16 v[28:31], v[200:203], v[168:171], v[28:31]
    ds_read_b64_tr_b16 v[236:237], v7 offset:63488
    v_mfma_f32_16x16x32_bf16 v[28:31], v[204:207], v[172:175], v[28:31]
    ds_read_b64_tr_b16 v[238:239], v7 offset:64000
    v_mfma_f32_16x16x32_bf16 v[36:39], v[204:207], v[180:183], v[36:39]
    v_mfma_f32_16x16x32_bf16 v[36:39], v[200:203], v[176:179], v[36:39]
    v_mfma_f32_16x16x32_bf16 v[44:47], v[200:203], v[184:187], v[44:47]
    v_mfma_f32_16x16x32_bf16 v[44:47], v[204:207], v[188:191], v[44:47]
    s_waitcnt lgkmcnt(7)
    v_mfma_f32_16x16x32_bf16 v[116:119], v[196:199], v[228:231], v[116:119]
    v_mfma_f32_16x16x32_bf16 v[116:119], v[192:195], v[224:227], v[116:119]
    v_mfma_f32_16x16x32_bf16 v[104:107], v[184:187], v[224:227], v[104:107]
    v_mfma_f32_16x16x32_bf16 v[104:107], v[188:191], v[228:231], v[104:107]
    v_mfma_f32_16x16x32_bf16 v[96:99], v[180:183], v[228:231], v[96:99]
    s_waitcnt lgkmcnt(0)
    s_barrier
    v_mfma_f32_16x16x32_bf16 v[96:99], v[176:179], v[224:227], v[96:99]
    ds_read_b64_tr_b16 v[200:201], v6 offset:1024
    v_mfma_f32_16x16x32_bf16 v[88:91], v[168:171], v[224:227], v[88:91]
    ds_read_b64_tr_b16 v[202:203], v6 offset:1536
    v_mfma_f32_16x16x32_bf16 v[88:91], v[172:175], v[228:231], v[88:91]
    ds_read_b64_tr_b16 v[204:205], v6 offset:13312
    v_mfma_f32_16x16x32_bf16 v[80:83], v[164:167], v[228:231], v[80:83]
    ds_read_b64_tr_b16 v[206:207], v6 offset:13824
    v_mfma_f32_16x16x32_bf16 v[80:83], v[160:163], v[224:227], v[80:83]
    v_mfma_f32_16x16x32_bf16 v[84:87], v[160:163], v[232:235], v[84:87]
    ds_read_b64_tr_b16 v[224:225], v7 offset:1024
    v_mfma_f32_16x16x32_bf16 v[84:87], v[164:167], v[236:239], v[84:87]
    ds_read_b64_tr_b16 v[226:227], v7 offset:1536
    v_mfma_f32_16x16x32_bf16 v[92:95], v[172:175], v[236:239], v[92:95]
    ds_read_b64_tr_b16 v[228:229], v7 offset:13312
    v_mfma_f32_16x16x32_bf16 v[92:95], v[168:171], v[232:235], v[92:95]
    ds_read_b64_tr_b16 v[230:231], v7 offset:13824
    v_mfma_f32_16x16x32_bf16 v[100:103], v[176:179], v[232:235], v[100:103]
    v_mfma_f32_16x16x32_bf16 v[100:103], v[180:183], v[236:239], v[100:103]
    v_mfma_f32_16x16x32_bf16 v[108:111], v[188:191], v[236:239], v[108:111]
    v_mfma_f32_16x16x32_bf16 v[108:111], v[184:187], v[232:235], v[108:111]
    s_waitcnt lgkmcnt(4)
    v_mfma_f32_16x16x32_bf16 v[112:115], v[200:203], v[152:155], v[112:115]
    ds_read_b64_tr_b16 v[232:233], v6 offset:0
    v_mfma_f32_16x16x32_bf16 v[112:115], v[204:207], v[156:159], v[112:115]
    ds_read_b64_tr_b16 v[234:235], v6 offset:512
    v_mfma_f32_16x16x32_bf16 v[72:75], v[204:207], v[148:151], v[72:75]
    ds_read_b64_tr_b16 v[236:237], v6 offset:12288
    v_mfma_f32_16x16x32_bf16 v[72:75], v[200:203], v[144:147], v[72:75]
    ds_read_b64_tr_b16 v[238:239], v6 offset:12800
    v_mfma_f32_16x16x32_bf16 v[64:67], v[200:203], v[136:139], v[64:67]
    ds_read_b128 v[192:195], v2 offset:18432
    v_mfma_f32_16x16x32_bf16 v[64:67], v[204:207], v[140:143], v[64:67]
    ds_read_b128 v[196:199], v3 offset:18432
    v_mfma_f32_16x16x32_bf16 v[56:59], v[204:207], v[132:135], v[56:59]
    ds_read_b128 v[184:187], v4 offset:24576
    v_mfma_f32_16x16x32_bf16 v[56:59], v[200:203], v[128:131], v[56:59]
    ds_read_b128 v[188:191], v5 offset:24576
    v_mfma_f32_16x16x32_bf16 v[48:51], v[200:203], v[120:123], v[48:51]
    v_mfma_f32_16x16x32_bf16 v[48:51], v[204:207], v[124:127], v[48:51]
    s_waitcnt lgkmcnt(8)
    v_mfma_f32_16x16x32_bf16 v[52:55], v[228:231], v[124:127], v[52:55]
    ds_read_b64_tr_b16 v[200:201], v7 offset:0
    v_mfma_f32_16x16x32_bf16 v[52:55], v[224:227], v[120:123], v[52:55]
    ds_read_b64_tr_b16 v[202:203], v7 offset:512
    v_mfma_f32_16x16x32_bf16 v[60:63], v[224:227], v[128:131], v[60:63]
    ds_read_b64_tr_b16 v[204:205], v7 offset:12288
    v_mfma_f32_16x16x32_bf16 v[60:63], v[228:231], v[132:135], v[60:63]
    ds_read_b64_tr_b16 v[206:207], v7 offset:12800
    v_mfma_f32_16x16x32_bf16 v[68:71], v[228:231], v[140:143], v[68:71]
    ds_read_b128 v[176:179], v4 offset:22528
    v_mfma_f32_16x16x32_bf16 v[68:71], v[224:227], v[136:139], v[68:71]
    ds_read_b128 v[180:183], v5 offset:22528
    v_mfma_f32_16x16x32_bf16 v[76:79], v[224:227], v[144:147], v[76:79]
    ds_read_b128 v[168:171], v4 offset:20480
    v_mfma_f32_16x16x32_bf16 v[76:79], v[228:231], v[148:151], v[76:79]
    s_waitcnt lgkmcnt(11)
    v_mfma_f32_16x16x32_bf16 v[40:43], v[236:239], v[148:151], v[40:43]
    ds_read_b64_tr_b16 v[224:225], v6 offset:2048
    v_mfma_f32_16x16x32_bf16 v[40:43], v[232:235], v[144:147], v[40:43]
    ds_read_b64_tr_b16 v[226:227], v6 offset:2560
    v_mfma_f32_16x16x32_bf16 v[32:35], v[232:235], v[136:139], v[32:35]
    ds_read_b64_tr_b16 v[228:229], v6 offset:14336
    v_mfma_f32_16x16x32_bf16 v[32:35], v[236:239], v[140:143], v[32:35]
    ds_read_b64_tr_b16 v[230:231], v6 offset:14848
    v_mfma_f32_16x16x32_bf16 v[24:27], v[236:239], v[132:135], v[24:27]
    ds_read_b128 v[172:175], v5 offset:20480
    v_mfma_f32_16x16x32_bf16 v[24:27], v[232:235], v[128:131], v[24:27]
    ds_read_b128 v[160:163], v4 offset:18432
    v_mfma_f32_16x16x32_bf16 v[16:19], v[232:235], v[120:123], v[16:19]
    ds_read_b128 v[164:167], v5 offset:18432
    v_mfma_f32_16x16x32_bf16 v[16:19], v[236:239], v[124:127], v[16:19]
    s_waitcnt lgkmcnt(10)
    v_mfma_f32_16x16x32_bf16 v[20:23], v[204:207], v[124:127], v[20:23]
    ds_read_b64_tr_b16 v[232:233], v7 offset:2048
    v_mfma_f32_16x16x32_bf16 v[20:23], v[200:203], v[120:123], v[20:23]
    ds_read_b64_tr_b16 v[234:235], v7 offset:2560
    v_mfma_f32_16x16x32_bf16 v[28:31], v[200:203], v[128:131], v[28:31]
    ds_read_b64_tr_b16 v[236:237], v7 offset:14336
    v_mfma_f32_16x16x32_bf16 v[28:31], v[204:207], v[132:135], v[28:31]
    ds_read_b64_tr_b16 v[238:239], v7 offset:14848
    v_mfma_f32_16x16x32_bf16 v[36:39], v[204:207], v[140:143], v[36:39]
    v_mfma_f32_16x16x32_bf16 v[36:39], v[200:203], v[136:139], v[36:39]
    v_mfma_f32_16x16x32_bf16 v[44:47], v[200:203], v[144:147], v[44:47]
    v_mfma_f32_16x16x32_bf16 v[44:47], v[204:207], v[148:151], v[44:47]
    s_waitcnt lgkmcnt(7)
    v_mfma_f32_16x16x32_bf16 v[116:119], v[156:159], v[228:231], v[116:119]
    v_mfma_f32_16x16x32_bf16 v[116:119], v[152:155], v[224:227], v[116:119]
    v_mfma_f32_16x16x32_bf16 v[104:107], v[144:147], v[224:227], v[104:107]
    v_mfma_f32_16x16x32_bf16 v[104:107], v[148:151], v[228:231], v[104:107]
    v_mfma_f32_16x16x32_bf16 v[96:99], v[140:143], v[228:231], v[96:99]
    s_waitcnt lgkmcnt(0)
    s_barrier
    v_mfma_f32_16x16x32_bf16 v[96:99], v[136:139], v[224:227], v[96:99]
    ds_read_b64_tr_b16 v[200:201], v6 offset:25600
    v_mfma_f32_16x16x32_bf16 v[88:91], v[128:131], v[224:227], v[88:91]
    ds_read_b64_tr_b16 v[202:203], v6 offset:26112
    v_mfma_f32_16x16x32_bf16 v[88:91], v[132:135], v[228:231], v[88:91]
    ds_read_b64_tr_b16 v[204:205], v6 offset:37888
    v_mfma_f32_16x16x32_bf16 v[80:83], v[124:127], v[228:231], v[80:83]
    ds_read_b64_tr_b16 v[206:207], v6 offset:38400
    v_mfma_f32_16x16x32_bf16 v[80:83], v[120:123], v[224:227], v[80:83]
    v_mfma_f32_16x16x32_bf16 v[84:87], v[120:123], v[232:235], v[84:87]
    ds_read_b64_tr_b16 v[224:225], v7 offset:25600
    v_mfma_f32_16x16x32_bf16 v[84:87], v[124:127], v[236:239], v[84:87]
    ds_read_b64_tr_b16 v[226:227], v7 offset:26112
    v_mfma_f32_16x16x32_bf16 v[92:95], v[132:135], v[236:239], v[92:95]
    ds_read_b64_tr_b16 v[228:229], v7 offset:37888
    v_mfma_f32_16x16x32_bf16 v[92:95], v[128:131], v[232:235], v[92:95]
    ds_read_b64_tr_b16 v[230:231], v7 offset:38400
    v_mfma_f32_16x16x32_bf16 v[100:103], v[136:139], v[232:235], v[100:103]
    v_mfma_f32_16x16x32_bf16 v[100:103], v[140:143], v[236:239], v[100:103]
    v_mfma_f32_16x16x32_bf16 v[108:111], v[148:151], v[236:239], v[108:111]
    v_mfma_f32_16x16x32_bf16 v[108:111], v[144:147], v[232:235], v[108:111]
    s_waitcnt lgkmcnt(4)
    v_mfma_f32_16x16x32_bf16 v[112:115], v[200:203], v[192:195], v[112:115]
    ds_read_b64_tr_b16 v[232:233], v6 offset:24576
    v_mfma_f32_16x16x32_bf16 v[112:115], v[204:207], v[196:199], v[112:115]
    ds_read_b64_tr_b16 v[234:235], v6 offset:25088
    v_mfma_f32_16x16x32_bf16 v[72:75], v[204:207], v[188:191], v[72:75]
    ds_read_b64_tr_b16 v[236:237], v6 offset:36864
    v_mfma_f32_16x16x32_bf16 v[72:75], v[200:203], v[184:187], v[72:75]
    ds_read_b64_tr_b16 v[238:239], v6 offset:37376
    v_mfma_f32_16x16x32_bf16 v[64:67], v[200:203], v[176:179], v[64:67]
    ds_read_b128 v[152:155], v2 offset:36864
    v_mfma_f32_16x16x32_bf16 v[64:67], v[204:207], v[180:183], v[64:67]
    ds_read_b128 v[156:159], v3 offset:36864
    v_mfma_f32_16x16x32_bf16 v[56:59], v[204:207], v[172:175], v[56:59]
    ds_read_b128 v[144:147], v4 offset:43008
    v_mfma_f32_16x16x32_bf16 v[56:59], v[200:203], v[168:171], v[56:59]
    ds_read_b128 v[148:151], v5 offset:43008
    v_mfma_f32_16x16x32_bf16 v[48:51], v[200:203], v[160:163], v[48:51]
    v_mfma_f32_16x16x32_bf16 v[48:51], v[204:207], v[164:167], v[48:51]
    s_waitcnt lgkmcnt(8)
    v_mfma_f32_16x16x32_bf16 v[52:55], v[228:231], v[164:167], v[52:55]
    ds_read_b64_tr_b16 v[200:201], v7 offset:24576
    v_mfma_f32_16x16x32_bf16 v[52:55], v[224:227], v[160:163], v[52:55]
    ds_read_b64_tr_b16 v[202:203], v7 offset:25088
    v_mfma_f32_16x16x32_bf16 v[60:63], v[224:227], v[168:171], v[60:63]
    ds_read_b64_tr_b16 v[204:205], v7 offset:36864
    v_mfma_f32_16x16x32_bf16 v[60:63], v[228:231], v[172:175], v[60:63]
    ds_read_b64_tr_b16 v[206:207], v7 offset:37376
    v_mfma_f32_16x16x32_bf16 v[68:71], v[228:231], v[180:183], v[68:71]
    ds_read_b128 v[136:139], v4 offset:40960
    v_mfma_f32_16x16x32_bf16 v[68:71], v[224:227], v[176:179], v[68:71]
    ds_read_b128 v[140:143], v5 offset:40960
    v_mfma_f32_16x16x32_bf16 v[76:79], v[224:227], v[184:187], v[76:79]
    ds_read_b128 v[128:131], v4 offset:38912
    v_mfma_f32_16x16x32_bf16 v[76:79], v[228:231], v[188:191], v[76:79]
    s_waitcnt lgkmcnt(11)
    v_mfma_f32_16x16x32_bf16 v[40:43], v[236:239], v[188:191], v[40:43]
    ds_read_b64_tr_b16 v[224:225], v6 offset:26624
    v_mfma_f32_16x16x32_bf16 v[40:43], v[232:235], v[184:187], v[40:43]
    ds_read_b64_tr_b16 v[226:227], v6 offset:27136
    v_mfma_f32_16x16x32_bf16 v[32:35], v[232:235], v[176:179], v[32:35]
    ds_read_b64_tr_b16 v[228:229], v6 offset:38912
    v_mfma_f32_16x16x32_bf16 v[32:35], v[236:239], v[180:183], v[32:35]
    ds_read_b64_tr_b16 v[230:231], v6 offset:39424
    v_mfma_f32_16x16x32_bf16 v[24:27], v[236:239], v[172:175], v[24:27]
    ds_read_b128 v[132:135], v5 offset:38912
    v_mfma_f32_16x16x32_bf16 v[24:27], v[232:235], v[168:171], v[24:27]
    ds_read_b128 v[120:123], v4 offset:36864
    v_mfma_f32_16x16x32_bf16 v[16:19], v[232:235], v[160:163], v[16:19]
    ds_read_b128 v[124:127], v5 offset:36864
    v_mfma_f32_16x16x32_bf16 v[16:19], v[236:239], v[164:167], v[16:19]
    s_waitcnt lgkmcnt(10)
    v_mfma_f32_16x16x32_bf16 v[20:23], v[204:207], v[164:167], v[20:23]
    ds_read_b64_tr_b16 v[232:233], v7 offset:26624
    v_mfma_f32_16x16x32_bf16 v[20:23], v[200:203], v[160:163], v[20:23]
    ds_read_b64_tr_b16 v[234:235], v7 offset:27136
    v_mfma_f32_16x16x32_bf16 v[28:31], v[200:203], v[168:171], v[28:31]
    ds_read_b64_tr_b16 v[236:237], v7 offset:38912
    v_mfma_f32_16x16x32_bf16 v[28:31], v[204:207], v[172:175], v[28:31]
    ds_read_b64_tr_b16 v[238:239], v7 offset:39424
    v_mfma_f32_16x16x32_bf16 v[36:39], v[204:207], v[180:183], v[36:39]
    v_mfma_f32_16x16x32_bf16 v[36:39], v[200:203], v[176:179], v[36:39]
    v_mfma_f32_16x16x32_bf16 v[44:47], v[200:203], v[184:187], v[44:47]
    v_mfma_f32_16x16x32_bf16 v[44:47], v[204:207], v[188:191], v[44:47]
    s_waitcnt lgkmcnt(7)
    v_mfma_f32_16x16x32_bf16 v[116:119], v[196:199], v[228:231], v[116:119]
    v_mfma_f32_16x16x32_bf16 v[116:119], v[192:195], v[224:227], v[116:119]
    v_mfma_f32_16x16x32_bf16 v[104:107], v[184:187], v[224:227], v[104:107]
    v_mfma_f32_16x16x32_bf16 v[104:107], v[188:191], v[228:231], v[104:107]
    v_mfma_f32_16x16x32_bf16 v[96:99], v[180:183], v[228:231], v[96:99]
    s_waitcnt lgkmcnt(0)
    s_barrier
    v_mfma_f32_16x16x32_bf16 v[96:99], v[176:179], v[224:227], v[96:99]
    ds_read_b64_tr_b16 v[200:201], v6 offset:50176
    v_mfma_f32_16x16x32_bf16 v[88:91], v[168:171], v[224:227], v[88:91]
    ds_read_b64_tr_b16 v[202:203], v6 offset:50688
    v_mfma_f32_16x16x32_bf16 v[88:91], v[172:175], v[228:231], v[88:91]
    ds_read_b64_tr_b16 v[204:205], v6 offset:62464
    v_mfma_f32_16x16x32_bf16 v[80:83], v[164:167], v[228:231], v[80:83]
    ds_read_b64_tr_b16 v[206:207], v6 offset:62976
    v_mfma_f32_16x16x32_bf16 v[80:83], v[160:163], v[224:227], v[80:83]
    v_mfma_f32_16x16x32_bf16 v[84:87], v[160:163], v[232:235], v[84:87]
    ds_read_b64_tr_b16 v[224:225], v7 offset:50176
    v_mfma_f32_16x16x32_bf16 v[84:87], v[164:167], v[236:239], v[84:87]
    ds_read_b64_tr_b16 v[226:227], v7 offset:50688
    v_mfma_f32_16x16x32_bf16 v[92:95], v[172:175], v[236:239], v[92:95]
    ds_read_b64_tr_b16 v[228:229], v7 offset:62464
    v_mfma_f32_16x16x32_bf16 v[92:95], v[168:171], v[232:235], v[92:95]
    ds_read_b64_tr_b16 v[230:231], v7 offset:62976
    v_mfma_f32_16x16x32_bf16 v[100:103], v[176:179], v[232:235], v[100:103]
    v_mfma_f32_16x16x32_bf16 v[100:103], v[180:183], v[236:239], v[100:103]
    v_mfma_f32_16x16x32_bf16 v[108:111], v[188:191], v[236:239], v[108:111]
    v_mfma_f32_16x16x32_bf16 v[108:111], v[184:187], v[232:235], v[108:111]
    s_waitcnt lgkmcnt(4)
    v_mfma_f32_16x16x32_bf16 v[112:115], v[200:203], v[152:155], v[112:115]
    ds_read_b64_tr_b16 v[232:233], v6 offset:49152
    v_mfma_f32_16x16x32_bf16 v[112:115], v[204:207], v[156:159], v[112:115]
    ds_read_b64_tr_b16 v[234:235], v6 offset:49664
    v_mfma_f32_16x16x32_bf16 v[72:75], v[204:207], v[148:151], v[72:75]
    ds_read_b64_tr_b16 v[236:237], v6 offset:61440
    v_mfma_f32_16x16x32_bf16 v[72:75], v[200:203], v[144:147], v[72:75]
    ds_read_b64_tr_b16 v[238:239], v6 offset:61952
    v_mfma_f32_16x16x32_bf16 v[64:67], v[200:203], v[136:139], v[64:67]
    v_mfma_f32_16x16x32_bf16 v[64:67], v[204:207], v[140:143], v[64:67]
    v_mfma_f32_16x16x32_bf16 v[56:59], v[204:207], v[132:135], v[56:59]
    v_mfma_f32_16x16x32_bf16 v[56:59], v[200:203], v[128:131], v[56:59]
    v_mfma_f32_16x16x32_bf16 v[48:51], v[200:203], v[120:123], v[48:51]
    v_mfma_f32_16x16x32_bf16 v[48:51], v[204:207], v[124:127], v[48:51]
    s_waitcnt lgkmcnt(4)
    v_mfma_f32_16x16x32_bf16 v[52:55], v[228:231], v[124:127], v[52:55]
    ds_read_b64_tr_b16 v[200:201], v7 offset:49152
    v_mfma_f32_16x16x32_bf16 v[52:55], v[224:227], v[120:123], v[52:55]
    ds_read_b64_tr_b16 v[202:203], v7 offset:49664
    v_mfma_f32_16x16x32_bf16 v[60:63], v[224:227], v[128:131], v[60:63]
    ds_read_b64_tr_b16 v[204:205], v7 offset:61440
    v_mfma_f32_16x16x32_bf16 v[60:63], v[228:231], v[132:135], v[60:63]
    ds_read_b64_tr_b16 v[206:207], v7 offset:61952
    v_mfma_f32_16x16x32_bf16 v[68:71], v[228:231], v[140:143], v[68:71]
    v_mfma_f32_16x16x32_bf16 v[68:71], v[224:227], v[136:139], v[68:71]
    v_mfma_f32_16x16x32_bf16 v[76:79], v[224:227], v[144:147], v[76:79]
    v_mfma_f32_16x16x32_bf16 v[76:79], v[228:231], v[148:151], v[76:79]
    s_waitcnt lgkmcnt(4)
    v_mfma_f32_16x16x32_bf16 v[40:43], v[236:239], v[148:151], v[40:43]
    ds_read_b64_tr_b16 v[224:225], v6 offset:51200
    ds_read_b64_tr_b16 v[226:227], v6 offset:51712
    v_mfma_f32_16x16x32_bf16 v[40:43], v[232:235], v[144:147], v[40:43]
    ds_read_b64_tr_b16 v[228:229], v6 offset:63488
    ds_read_b64_tr_b16 v[230:231], v6 offset:64000
    v_mfma_f32_16x16x32_bf16 v[32:35], v[232:235], v[136:139], v[32:35]
    ds_read_b128 v[192:195], v2 offset:0
    ds_read_b128 v[196:199], v3 offset:0
    v_mfma_f32_16x16x32_bf16 v[32:35], v[236:239], v[140:143], v[32:35]
    ds_read_b128 v[184:187], v4 offset:6144
    ds_read_b128 v[188:191], v5 offset:6144
    v_mfma_f32_16x16x32_bf16 v[24:27], v[236:239], v[132:135], v[24:27]
    v_mfma_f32_16x16x32_bf16 v[24:27], v[232:235], v[128:131], v[24:27]
    v_mfma_f32_16x16x32_bf16 v[16:19], v[232:235], v[120:123], v[16:19]
    v_mfma_f32_16x16x32_bf16 v[16:19], v[236:239], v[124:127], v[16:19]
    s_waitcnt lgkmcnt(8)
    v_mfma_f32_16x16x32_bf16 v[20:23], v[204:207], v[124:127], v[20:23]
    ds_read_b64_tr_b16 v[232:233], v7 offset:51200
    v_mfma_f32_16x16x32_bf16 v[20:23], v[200:203], v[120:123], v[20:23]
    ds_read_b64_tr_b16 v[234:235], v7 offset:51712
    v_mfma_f32_16x16x32_bf16 v[28:31], v[200:203], v[128:131], v[28:31]
    ds_read_b64_tr_b16 v[236:237], v7 offset:63488
    v_mfma_f32_16x16x32_bf16 v[28:31], v[204:207], v[132:135], v[28:31]
    ds_read_b64_tr_b16 v[238:239], v7 offset:64000
    v_mfma_f32_16x16x32_bf16 v[36:39], v[204:207], v[140:143], v[36:39]
    ds_read_b128 v[176:179], v4 offset:4096
    v_mfma_f32_16x16x32_bf16 v[36:39], v[200:203], v[136:139], v[36:39]
    ds_read_b128 v[180:183], v5 offset:4096
    v_mfma_f32_16x16x32_bf16 v[44:47], v[200:203], v[144:147], v[44:47]
    ds_read_b128 v[168:171], v4 offset:2048
    v_mfma_f32_16x16x32_bf16 v[44:47], v[204:207], v[148:151], v[44:47]
    s_waitcnt lgkmcnt(11)
    v_mfma_f32_16x16x32_bf16 v[116:119], v[156:159], v[228:231], v[116:119]
    ds_read_b64_tr_b16 v[200:201], v6 offset:1024
    v_mfma_f32_16x16x32_bf16 v[116:119], v[152:155], v[224:227], v[116:119]
    ds_read_b64_tr_b16 v[202:203], v6 offset:1536
    v_mfma_f32_16x16x32_bf16 v[104:107], v[144:147], v[224:227], v[104:107]
    ds_read_b64_tr_b16 v[204:205], v6 offset:13312
    v_mfma_f32_16x16x32_bf16 v[104:107], v[148:151], v[228:231], v[104:107]
    ds_read_b64_tr_b16 v[206:207], v6 offset:13824
    v_mfma_f32_16x16x32_bf16 v[96:99], v[140:143], v[228:231], v[96:99]
    ds_read_b128 v[172:175], v5 offset:2048
    v_mfma_f32_16x16x32_bf16 v[96:99], v[136:139], v[224:227], v[96:99]
    ds_read_b128 v[160:163], v4 offset:0
    v_mfma_f32_16x16x32_bf16 v[88:91], v[128:131], v[224:227], v[88:91]
    ds_read_b128 v[164:167], v5 offset:0
    v_mfma_f32_16x16x32_bf16 v[88:91], v[132:135], v[228:231], v[88:91]
    v_mfma_f32_16x16x32_bf16 v[80:83], v[124:127], v[228:231], v[80:83]
    v_mfma_f32_16x16x32_bf16 v[80:83], v[120:123], v[224:227], v[80:83]
    s_waitcnt lgkmcnt(10)
    v_mfma_f32_16x16x32_bf16 v[84:87], v[120:123], v[232:235], v[84:87]
    ds_read_b64_tr_b16 v[224:225], v7 offset:1024
    v_mfma_f32_16x16x32_bf16 v[84:87], v[124:127], v[236:239], v[84:87]
    ds_read_b64_tr_b16 v[226:227], v7 offset:1536
    v_mfma_f32_16x16x32_bf16 v[92:95], v[132:135], v[236:239], v[92:95]
    ds_read_b64_tr_b16 v[228:229], v7 offset:13312
    v_mfma_f32_16x16x32_bf16 v[92:95], v[128:131], v[232:235], v[92:95]
    ds_read_b64_tr_b16 v[230:231], v7 offset:13824
    v_mfma_f32_16x16x32_bf16 v[100:103], v[136:139], v[232:235], v[100:103]
    v_mfma_f32_16x16x32_bf16 v[100:103], v[140:143], v[236:239], v[100:103]
    v_mfma_f32_16x16x32_bf16 v[108:111], v[148:151], v[236:239], v[108:111]
    v_mfma_f32_16x16x32_bf16 v[108:111], v[144:147], v[232:235], v[108:111]
    s_waitcnt lgkmcnt(9)
    v_mfma_f32_16x16x32_bf16 v[112:115], v[200:203], v[192:195], v[112:115]
    ds_read_b64_tr_b16 v[120:121], v6 offset:0
    ds_read_b64_tr_b16 v[122:123], v6 offset:512
    s_waitcnt lgkmcnt(9)
    v_mfma_f32_16x16x32_bf16 v[112:115], v[204:207], v[196:199], v[112:115]
    ds_read_b64_tr_b16 v[124:125], v6 offset:12288
    ds_read_b64_tr_b16 v[126:127], v6 offset:12800
    v_mfma_f32_16x16x32_bf16 v[72:75], v[204:207], v[188:191], v[72:75]
    ds_read_b64_tr_b16 v[128:129], v7 offset:0
    ds_read_b64_tr_b16 v[130:131], v7 offset:512
    v_mfma_f32_16x16x32_bf16 v[72:75], v[200:203], v[184:187], v[72:75]
    ds_read_b64_tr_b16 v[132:133], v7 offset:12288
    ds_read_b64_tr_b16 v[134:135], v7 offset:12800
    v_mfma_f32_16x16x32_bf16 v[64:67], v[200:203], v[176:179], v[64:67]
    ds_read_b64_tr_b16 v[136:137], v6 offset:2048
    ds_read_b64_tr_b16 v[138:139], v6 offset:2560
    v_mfma_f32_16x16x32_bf16 v[64:67], v[204:207], v[180:183], v[64:67]
    ds_read_b64_tr_b16 v[140:141], v6 offset:14336
    ds_read_b64_tr_b16 v[142:143], v6 offset:14848
    s_waitcnt lgkmcnt(14)
    v_mfma_f32_16x16x32_bf16 v[56:59], v[204:207], v[172:175], v[56:59]
    ds_read_b64_tr_b16 v[144:145], v7 offset:2048
    ds_read_b64_tr_b16 v[146:147], v7 offset:2560
    v_mfma_f32_16x16x32_bf16 v[56:59], v[200:203], v[168:171], v[56:59]
    ds_read_b64_tr_b16 v[148:149], v7 offset:14336
    ds_read_b64_tr_b16 v[150:151], v7 offset:14848
    v_mfma_f32_16x16x32_bf16 v[48:51], v[200:203], v[160:163], v[48:51]
    v_cvt_pk_bf16_f32 v72, v72, v73
    v_cvt_pk_bf16_f32 v73, v74, v75
    v_mfma_f32_16x16x32_bf16 v[48:51], v[204:207], v[164:167], v[48:51]
    v_cvt_pk_bf16_f32 v64, v64, v65
    v_cvt_pk_bf16_f32 v65, v66, v67
    s_waitcnt lgkmcnt(14)
    v_mfma_f32_16x16x32_bf16 v[76:79], v[228:231], v[188:191], v[76:79]
    v_cvt_pk_bf16_f32 v56, v56, v57
    v_cvt_pk_bf16_f32 v57, v58, v59
    v_mfma_f32_16x16x32_bf16 v[76:79], v[224:227], v[184:187], v[76:79]
    v_cvt_pk_bf16_f32 v200, v112, v113
    v_cvt_pk_bf16_f32 v201, v114, v115
    v_mfma_f32_16x16x32_bf16 v[68:71], v[224:227], v[176:179], v[68:71]
    ds_write_b64 v216, v[200:201]
    ds_write_b64 v217, v[72:73]
    v_mfma_f32_16x16x32_bf16 v[68:71], v[228:231], v[180:183], v[68:71]
    v_cvt_pk_bf16_f32 v48, v48, v49
    v_cvt_pk_bf16_f32 v49, v50, v51
    v_mfma_f32_16x16x32_bf16 v[60:63], v[228:231], v[172:175], v[60:63]
    v_cvt_pk_bf16_f32 v74, v76, v77
    v_cvt_pk_bf16_f32 v75, v78, v79
    v_mfma_f32_16x16x32_bf16 v[60:63], v[224:227], v[168:171], v[60:63]
    ds_write_b64 v217, v[74:75] offset:512
    s_mov_b64 exec, 1
    ds_add_u32 v10, v11 offset:0
    s_mov_b64 exec, -1
    v_mfma_f32_16x16x32_bf16 v[52:55], v[224:227], v[160:163], v[52:55]
    v_cvt_pk_bf16_f32 v66, v68, v69
    v_cvt_pk_bf16_f32 v67, v70, v71
    v_mfma_f32_16x16x32_bf16 v[52:55], v[228:231], v[164:167], v[52:55]
    v_cvt_pk_bf16_f32 v58, v60, v61
    v_cvt_pk_bf16_f32 v59, v62, v63
    s_waitcnt lgkmcnt(14)
    v_mfma_f32_16x16x32_bf16 v[40:43], v[124:127], v[188:191], v[40:43]
    s_nop 1
    v_mfma_f32_16x16x32_bf16 v[40:43], v[120:123], v[184:187], v[40:43]
    s_nop 1
    v_mfma_f32_16x16x32_bf16 v[32:35], v[120:123], v[176:179], v[32:35]
    v_cvt_pk_bf16_f32 v50, v52, v53
    v_cvt_pk_bf16_f32 v51, v54, v55
    v_mfma_f32_16x16x32_bf16 v[32:35], v[124:127], v[180:183], v[32:35]
    s_nop 1
    v_mfma_f32_16x16x32_bf16 v[24:27], v[124:127], v[172:175], v[24:27]
    v_cvt_pk_bf16_f32 v40, v40, v41
    v_cvt_pk_bf16_f32 v41, v42, v43
    v_mfma_f32_16x16x32_bf16 v[24:27], v[120:123], v[168:171], v[24:27]
    s_nop 1
    v_mfma_f32_16x16x32_bf16 v[16:19], v[120:123], v[160:163], v[16:19]
    v_cvt_pk_bf16_f32 v32, v32, v33
    v_cvt_pk_bf16_f32 v33, v34, v35
    v_mfma_f32_16x16x32_bf16 v[16:19], v[124:127], v[164:167], v[16:19]
    s_nop 1
    s_waitcnt lgkmcnt(12)
    v_mfma_f32_16x16x32_bf16 v[44:47], v[132:135], v[188:191], v[44:47]
    v_cvt_pk_bf16_f32 v24, v24, v25
    v_cvt_pk_bf16_f32 v25, v26, v27
    v_mfma_f32_16x16x32_bf16 v[44:47], v[128:131], v[184:187], v[44:47]
    s_nop 1
    v_mfma_f32_16x16x32_bf16 v[36:39], v[128:131], v[176:179], v[36:39]
    v_cvt_pk_bf16_f32 v16, v16, v17
    v_cvt_pk_bf16_f32 v17, v18, v19
    v_mfma_f32_16x16x32_bf16 v[36:39], v[132:135], v[180:183], v[36:39]
    ds_read_b32 v223, v10 offset:0
    ds_read_b64 v[204:205], v218
    v_mfma_f32_16x16x32_bf16 v[28:31], v[132:135], v[172:175], v[28:31]
    ds_read_b64 v[206:207], v219
    v_cvt_pk_bf16_f32 v42, v44, v45
    v_mfma_f32_16x16x32_bf16 v[28:31], v[128:131], v[168:171], v[28:31]
    v_cvt_pk_bf16_f32 v43, v46, v47
    s_nop 0
    v_mfma_f32_16x16x32_bf16 v[20:23], v[128:131], v[160:163], v[20:23]
    v_cvt_pk_bf16_f32 v34, v36, v37
    v_cvt_pk_bf16_f32 v35, v38, v39
    v_mfma_f32_16x16x32_bf16 v[20:23], v[132:135], v[164:167], v[20:23]
    s_nop 1
    s_waitcnt lgkmcnt(11)
    v_mfma_f32_16x16x32_bf16 v[116:119], v[196:199], v[140:143], v[116:119]
    v_cvt_pk_bf16_f32 v26, v28, v29
    v_cvt_pk_bf16_f32 v27, v30, v31
    v_mfma_f32_16x16x32_bf16 v[116:119], v[192:195], v[136:139], v[116:119]
    s_nop 1
    v_mfma_f32_16x16x32_bf16 v[104:107], v[184:187], v[136:139], v[104:107]
    v_cvt_pk_bf16_f32 v18, v20, v21
    v_cvt_pk_bf16_f32 v19, v22, v23
    v_mfma_f32_16x16x32_bf16 v[104:107], v[188:191], v[140:143], v[104:107]
    s_nop 1
    v_mfma_f32_16x16x32_bf16 v[44:47], v[72:75], v[40:43], 0
    v_cvt_pk_bf16_f32 v202, v116, v117
    v_cvt_pk_bf16_f32 v203, v118, v119
    v_mfma_f32_16x16x32_bf16 v[76:79], v[64:67], v[40:43], 0
    s_nop 1
    v_mfma_f32_16x16x32_bf16 v[36:39], v[64:67], v[32:35], 0
    v_cvt_pk_bf16_f32 v232, v104, v105
    v_cvt_pk_bf16_f32 v233, v106, v107
    v_mfma_f32_16x16x32_bf16 v[68:71], v[56:59], v[32:35], 0
    ds_write_b64 v216, v[202:203] offset:1024
    ds_write_b64 v217, v[232:233] offset:1024
    v_mfma_f32_16x16x32_bf16 v[96:99], v[180:183], v[140:143], v[96:99]
    s_waitcnt lgkmcnt(4)
    v_cmp_gt_u32 vcc, 4, v223
    s_cbranch_vccnz LB_w1
LB_g1:
    v_mfma_f32_16x16x32_bf16 v[96:99], v[176:179], v[136:139], v[96:99]
    v_cndmask_b32 v124, v44, v45, s[88:89]
    v_cndmask_b32 v125, v76, v77, s[88:89]
    v_mfma_f32_16x16x32_bf16 v[28:31], v[56:59], v[24:27], 0
    v_cndmask_b32 v158, v125, v124, s[90:91]
    v_cndmask_b32 v126, v46, v47, s[88:89]
    v_mfma_f32_16x16x32_bf16 v[60:63], v[48:51], v[24:27], 0
    v_cndmask_b32 v127, v78, v79, s[88:89]
    v_cndmask_b32 v159, v127, v126, s[92:93]
    v_mfma_f32_16x16x32_bf16 v[20:23], v[48:51], v[16:19], 0
    v_max_f32 v123, v158, v159
    v_cndmask_b32 v124, v36, v37, s[88:89]
    v_mfma_f32_16x16x32_bf16 v[88:91], v[168:171], v[136:139], v[88:91]
    v_cndmask_b32 v125, v68, v69, s[88:89]
    v_cndmask_b32 v156, v125, v124, s[90:91]
    v_mfma_f32_16x16x32_bf16 v[88:91], v[172:175], v[140:143], v[88:91]
    v_cndmask_b32 v126, v38, v39, s[88:89]
    v_cndmask_b32 v127, v70, v71, s[88:89]
    s_waitcnt lgkmcnt(2)
    v_mfma_f32_16x16x32_bf16 v[52:55], v[204:207], v[16:19], v[212:215]
    v_cndmask_b32 v157, v127, v126, s[92:93]
    v_max_f32 v122, v156, v157
    v_mfma_f32_16x16x32_bf16 v[80:83], v[164:167], v[140:143], v[80:83]
    v_cndmask_b32 v124, v28, v29, s[88:89]
    v_cndmask_b32 v125, v60, v61, s[88:89]
    v_mfma_f32_16x16x32_bf16 v[80:83], v[160:163], v[136:139], v[80:83]
    v_cndmask_b32 v154, v125, v124, s[90:91]
    v_cndmask_b32 v126, v30, v31, s[88:89]
    v_mfma_f32_16x16x32_bf16 v[108:111], v[184:187], v[144:147], v[108:111]
    v_cndmask_b32 v127, v62, v63, s[88:89]
    v_cndmask_b32 v155, v127, v126, s[92:93]
    v_mfma_f32_16x16x32_bf16 v[108:111], v[188:191], v[148:151], v[108:111]
    v_max_f32 v121, v154, v155
    s_nop 0
    v_mfma_f32_16x16x32_bf16 v[100:103], v[180:183], v[148:151], v[100:103]
    s_nop 1
    v_mfma_f32_16x16x32_bf16 v[100:103], v[176:179], v[144:147], v[100:103]
    s_nop 1
    v_mfma_f32_16x16x32_bf16 v[92:95], v[168:171], v[144:147], v[92:95]
    v_cvt_pk_bf16_f32 v242, v108, v109
    v_cvt_pk_bf16_f32 v243, v110, v111
    v_mfma_f32_16x16x32_bf16 v[92:95], v[172:175], v[148:151], v[92:95]
    ds_write_b64 v217, v[242:243] offset:1536
    s_mov_b64 exec, 1
    ds_add_u32 v10, v11 offset:24
    s_mov_b64 exec, -1
    v_mfma_f32_16x16x32_bf16 v[84:87], v[164:167], v[148:151], v[84:87]
    v_cndmask_b32 v124, v20, v21, s[88:89]
    v_cndmask_b32 v125, v52, v53, s[88:89]
    v_mfma_f32_16x16x32_bf16 v[84:87], v[160:163], v[144:147], v[84:87]
    v_cndmask_b32 v152, v125, v124, s[90:91]
    v_cndmask_b32 v126, v22, v23, s[88:89]
    v_cndmask_b32 v127, v54, v55, s[88:89]
    v_cndmask_b32 v153, v127, v126, s[92:93]
    v_max_f32 v120, v152, v153
    s_mov_b32 s80, 0x3e8293ee
    s_add_u32 m0, s34, 36864
    s_add_u32 s35, s44, 0
    buffer_load_dwordx4 v245, s[64:67], s35 offen  lds
    v_cvt_pk_bf16_f32 v230, v96, v97
    v_permlane32_swap_b32 v122, v123
    v_permlane32_swap_b32 v120, v121
    v_max_f32 v122, v122, v123
    v_max_f32 v120, v120, v121
    v_cvt_pk_bf16_f32 v231, v98, v99
    v_cvt_pk_bf16_f32 v240, v100, v101
    v_permlane16_swap_b32 v120, v122
    v_max_f32 v120, v120, v122
    v_mul_f32 v120, s80, v120
    v_mov_b32 v122, v120
    v_cvt_pk_bf16_f32 v241, v102, v103
    v_cvt_pk_bf16_f32 v228, v88, v89
    v_permlane16_swap_b32 v120, v122
    s_add_u32 m0, s34, 40960
    s_add_u32 s35, s44, 65536
    buffer_load_dwordx4 v245, s[64:67], s35 offen  lds
    v_mov_b32 v121, v120
    v_mov_b32 v123, v122
    v_cvt_pk_bf16_f32 v229, v90, v91
    v_permlane32_swap_b32 v120, v121
    v_permlane32_swap_b32 v122, v123
    v_fma_f32 v152, v152, s80, -v120
    v_fma_f32 v153, v153, s80, -v120
    v_fma_f32 v154, v154, s80, -v121
    v_fma_f32 v155, v155, s80, -v121
    v_fma_f32 v156, v156, s80, -v122
    v_fma_f32 v157, v157, s80, -v122
    v_fma_f32 v158, v158, s80, -v123
    v_fma_f32 v159, v159, s80, -v123
    ds_read_b32 v223, v10 offset:24
    s_add_u32 m0, s34, 45056
    s_add_u32 s35, s44, 131072
    buffer_load_dwordx4 v245, s[64:67], s35 offen  lds
    ds_read_b64 v[224:225], v218 offset:1024
    ds_read_b64 v[234:235], v219 offset:1024
    v_exp_f32 v152, v152
    v_exp_f32 v153, v153
    v_exp_f32 v154, v154
    v_exp_f32 v155, v155
    v_exp_f32 v156, v156
    v_exp_f32 v157, v157
    v_exp_f32 v158, v158
    v_exp_f32 v159, v159
    v_add_f32 v120, v152, v153
    v_add_f32 v121, v154, v155
    v_add_f32 v122, v156, v157
    v_add_f32 v123, v158, v159
    s_add_u32 m0, s34, 110592
    s_add_u32 s35, s44, 196608
    buffer_load_dwordx4 v245, s[64:67], s35 offen  lds
    v_cvt_pk_bf16_f32 v238, v92, v93
    v_permlane32_swap_b32 v122, v123
    v_permlane32_swap_b32 v120, v121
    v_add_f32 v122, v122, v123
    v_add_f32 v120, v120, v121
    v_cvt_pk_bf16_f32 v239, v94, v95
    v_cvt_pk_bf16_f32 v226, v80, v81
    v_permlane16_swap_b32 v120, v122
    v_add_f32 v120, v120, v122
    v_rcp_f32 v120, v120
    s_nop 0
    v_mov_b32 v122, v120
    v_cvt_pk_bf16_f32 v227, v82, v83
    v_cvt_pk_bf16_f32 v236, v84, v85
    v_permlane16_swap_b32 v120, v122
    s_add_u32 m0, s34, 114688
    s_add_u32 s35, s45, 0
    buffer_load_dwordx4 v245, s[64:67], s35 offen  lds
    v_mov_b32 v121, v120
    v_mov_b32 v123, v122
    v_cvt_pk_bf16_f32 v237, v86, v87
    v_permlane32_swap_b32 v120, v121
    v_permlane32_swap_b32 v122, v123
    s_waitcnt lgkmcnt(2)
    v_cmp_gt_u32 vcc, 4, v223
    s_cbranch_vccnz LB_w6
LB_g6:
    v_mul_f32 v152, v152, v120
    v_mul_f32 v153, v153, v120
    v_cvt_pk_bf16_f32 v152, v152, v153
    v_perm_b32 v160, v152, v152, v208
    v_perm_b32 v161, v152, v152, v209
    v_perm_b32 v162, v152, v152, v210
    v_perm_b32 v163, v152, v152, v211
    v_mul_f32 v154, v154, v121
    s_add_u32 m0, s34, 118784
    s_add_u32 s35, s45, 65536
    buffer_load_dwordx4 v245, s[64:67], s35 offen  lds
    v_mul_f32 v155, v155, v121
    v_cvt_pk_bf16_f32 v154, v154, v155
    v_perm_b32 v164, v154, v154, v208
    v_perm_b32 v165, v154, v154, v209
    v_perm_b32 v166, v154, v154, v210
    v_perm_b32 v167, v154, v154, v211
    s_waitcnt lgkmcnt(1)
    v_mfma_f32_16x16x32_bf16 v[16:19], v[224:227], v[160:163], 0
    s_waitcnt lgkmcnt(0)
    v_mfma_f32_16x16x32_bf16 v[20:23], v[234:237], v[160:163], 0
    v_mul_f32 v156, v156, v122
    v_mul_f32 v157, v157, v122
    v_cvt_pk_bf16_f32 v156, v156, v157
    v_perm_b32 v168, v156, v156, v208
    v_perm_b32 v169, v156, v156, v209
    v_perm_b32 v170, v156, v156, v210
    s_add_u32 m0, s34, 122880
    s_add_u32 s35, s45, 131072
    buffer_load_dwordx4 v245, s[64:67], s35 offen  lds
    v_perm_b32 v171, v156, v156, v211
    v_mfma_f32_16x16x32_bf16 v[24:27], v[226:229], v[164:167], 0
    v_mfma_f32_16x16x32_bf16 v[28:31], v[236:239], v[164:167], 0
    v_mul_f32 v158, v158, v123
    v_mul_f32 v159, v159, v123
    v_cvt_pk_bf16_f32 v158, v158, v159
    v_perm_b32 v172, v158, v158, v208
    v_perm_b32 v173, v158, v158, v209
    v_perm_b32 v174, v158, v158, v210
    v_perm_b32 v175, v158, v158, v211
    v_mfma_f32_16x16x32_bf16 v[32:35], v[228:231], v[168:171], 0
    v_mfma_f32_16x16x32_bf16 v[36:39], v[238:241], v[168:171], 0
    v_mfma_f32_16x16x32_bf16 v[40:43], v[230:233], v[172:175], 0
    v_mfma_f32_16x16x32_bf16 v[44:47], v[240:243], v[172:175], 0
    v_cvt_pk_bf16_f32 v80, v16, v17
    v_cvt_pk_bf16_f32 v81, v18, v19
    v_cvt_pk_bf16_f32 v82, v20, v21
    v_cvt_pk_bf16_f32 v83, v22, v23
    s_add_u32 s95, s94, 0
    buffer_store_dwordx4 v[80:83], v252, s[52:55], s95 offen sc1
    v_cvt_pk_bf16_f32 v84, v24, v25
    v_cvt_pk_bf16_f32 v85, v26, v27
    v_cvt_pk_bf16_f32 v86, v28, v29
    v_cvt_pk_bf16_f32 v87, v30, v31
    s_add_u32 s95, s94, 32768
    buffer_store_dwordx4 v[84:87], v252, s[52:55], s95 offen sc1
    v_cvt_pk_bf16_f32 v88, v32, v33
    v_cvt_pk_bf16_f32 v89, v34, v35
    v_cvt_pk_bf16_f32 v90, v36, v37
    v_cvt_pk_bf16_f32 v91, v38, v39
    s_add_u32 s95, s94, 65536
    buffer_store_dwordx4 v[88:91], v252, s[52:55], s95 offen sc1
    v_cvt_pk_bf16_f32 v92, v40, v41
    v_cvt_pk_bf16_f32 v93, v42, v43
    v_cvt_pk_bf16_f32 v94, v44, v45
    v_cvt_pk_bf16_f32 v95, v46, v47
    s_add_u32 s95, s94, 98304
    buffer_store_dwordx4 v[92:95], v252, s[52:55], s95 offen sc1
    s_add_u32 m0, s34, 49152
    s_add_u32 s35, s45, 196608
    buffer_load_dwordx4 v245, s[64:67], s35 offen  lds
    v_xor_b32 v2, 0, v244
    v_xor_b32 v3, 32, v244
    v_xor_b32 v4, 64, v244
    v_xor_b32 v5, 96, v244
    s_add_u32 m0, s34, 53248
    s_add_u32 s35, s46, 0
    buffer_load_dwordx4 v245, s[64:67], s35 offen  lds
    v_xor_b32 v6, 2048, v244
    v_xor_b32 v7, 2080, v244
    v_xor_b32 v8, 2112, v244
    v_xor_b32 v9, 2144, v244
    s_waitcnt vmcnt(7)
    s_mov_b64 exec, 1
    ds_add_u32 v10, v11 offset:8
    s_mov_b64 exec, -1
    s_add_u32 m0, s34, 57344
    s_add_u32 s35, s46, 65536
    buffer_load_dwordx4 v245, s[64:67], s35 offen  lds
    v_add_u32 v224, 65536, v2
    v_add_u32 v225, 65536, v3
    v_add_u32 v226, 65536, v4
    v_add_u32 v227, 65536, v5
    v_add_u32 v228, 65536, v6
    v_add_u32 v229, 65536, v7
    s_add_u32 m0, s34, 61440
    s_add_u32 s35, s46, 131072
    buffer_load_dwordx4 v245, s[64:67], s35 offen  lds
    v_add_u32 v230, 65536, v8
    v_add_u32 v231, 65536, v9
    v_add_u32 v15, 32768, v252
    v_add_u32 v232, 129024, v2
    v_add_u32 v233, 129024, v3
    v_add_u32 v234, 129024, v4
    s_add_u32 m0, s34, 65536
    s_add_u32 s35, s46, 196608
    buffer_load_dwordx4 v245, s[64:67], s35 offen  lds
    v_add_u32 v235, 129024, v5
    v_add_u32 v236, 129024, v6
    v_add_u32 v237, 129024, v7
    v_add_u32 v238, 129024, v8
    v_add_u32 v239, 129024, v9
    s_waitcnt vmcnt(5)
    s_mov_b64 exec, 1
    buffer_store_dword v11, v220, s[52:55], s97 offen sc1
    s_mov_b64 exec, -1
    s_branch LB_s2_in
LB_s2:
    s_sleep 1
LB_s2_in:
    ds_read_b32 v14, v10 offset:8
    s_waitcnt lgkmcnt(0)
    v_readfirstlane_b32 s78, v14
    s_nop 0
    s_cmp_ge_u32 s78, 8
    s_cbranch_scc0 LB_s2
    s_add_u32 m0, s34, 69632
    s_add_u32 s35, s47, 0
    buffer_load_dwordx4 v245, s[64:67], s35 offen  lds
    ds_read_b64_tr_b16 v[48:49], v2 offset:36864
    ds_read_b64_tr_b16 v[50:51], v6 offset:36864
    s_add_u32 m0, s34, 0
    s_add_u32 s35, s47, 65536
    buffer_load_dwordx4 v245, s[64:67], s35 offen  lds
    ds_read_b64_tr_b16 v[52:53], v2 offset:40960
    s_add_u32 m0, s34, 4096
    s_add_u32 s35, s47, 131072
    buffer_load_dwordx4 v245, s[64:67], s35 offen  lds
    ds_read_b64_tr_b16 v[54:55], v6 offset:40960
    s_add_u32 m0, s34, 8192
    s_add_u32 s35, s47, 196608
    buffer_load_dwordx4 v245, s[64:67], s35 offen  lds
    ds_read_b64_tr_b16 v[56:57], v2 offset:45056
    s_add_u32 m0, s34, 12288
    s_add_u32 s35, s48, 0
    buffer_load_dwordx4 v245, s[64:67], s35 offen  lds
    ds_read_b64_tr_b16 v[58:59], v6 offset:45056
    s_add_u32 m0, s34, 16384
    s_add_u32 s35, s48, 65536
    buffer_load_dwordx4 v245, s[64:67], s35 offen  lds
    ds_read_b64_tr_b16 v[60:61], v224 offset:45056
    s_add_u32 m0, s34, 20480
    s_add_u32 s35, s48, 131072
    buffer_load_dwordx4 v245, s[64:67], s35 offen  lds
    ds_read_b64_tr_b16 v[62:63], v228 offset:45056
    s_add_u32 m0, s34, 73728
    s_add_u32 s35, s48, 196608
    buffer_load_dwordx4 v245, s[64:67], s35 offen  lds
    ds_read_b64_tr_b16 v[64:65], v3 offset:36864
    ds_read_b64_tr_b16 v[66:67], v7 offset:36864
    s_add_u32 m0, s34, 77824
    s_add_u32 s35, s49, 0
    buffer_load_dwordx4 v245, s[64:67], s35 offen  lds
    ds_read_b64_tr_b16 v[68:69], v3 offset:40960
    s_add_u32 m0, s34, 81920
    s_add_u32 s35, s49, 65536
    buffer_load_dwordx4 v245, s[64:67], s35 offen  lds
    ds_read_b64_tr_b16 v[70:71], v7 offset:40960
    s_add_u32 m0, s34, 86016
    s_add_u32 s35, s49, 131072
    buffer_load_dwordx4 v245, s[64:67], s35 offen  lds
    ds_read_b64_tr_b16 v[72:73], v3 offset:45056
    s_add_u32 m0, s34, 24576
    s_add_u32 s35, s49, 196608
    buffer_load_dwordx4 v245, s[64:67], s35 offen  lds
    ds_read_b64_tr_b16 v[74:75], v7 offset:45056
    s_add_u32 m0, s34, 28672
    s_add_u32 s35, s50, 0
    buffer_load_dwordx4 v245, s[64:67], s35 offen  lds
    ds_read_b64_tr_b16 v[76:77], v225 offset:45056
    s_add_u32 m0, s34, 32768
    s_add_u32 s35, s50, 65536
    buffer_load_dwordx4 v245, s[64:67], s35 offen  lds
    ds_read_b64_tr_b16 v[78:79], v229 offset:45056
    s_waitcnt vmcnt(0)
    s_mov_b64 exec, 1
    ds_add_u32 v10, v11 offset:16
    s_mov_b64 exec, -1
    s_mov_b64 exec, 0xffffffff
    s_mov_b32 s79, 0
LB_po:
    buffer_load_dword v14, v247, s[52:55], s30 offen sc1
    s_add_u32 s79, s79, 1
    s_cmp_gt_u32 s79, 200000
    s_cbranch_scc1 LB_po_x
    s_waitcnt vmcnt(0)
    v_cmp_ne_u32 vcc, 1, v14
    s_cbranch_vccz LB_po_x
    s_mov_b64 exec, vcc
    s_sleep 4
    s_branch LB_po
LB_po_x:
    s_waitcnt vmcnt(0)
    s_mov_b64 exec, -1
    ds_read_b32 v222, v10 offset:16
    buffer_load_dwordx4 v[96:99], v252, s[52:55], s36 offen offset:0 sc1
    buffer_load_dwordx4 v[100:103], v252, s[52:55], s36 offen offset:1024 sc1
    buffer_load_dwordx4 v[104:107], v252, s[52:55], s36 offen offset:2048 sc1
    buffer_load_dwordx4 v[108:111], v252, s[52:55], s36 offen offset:3072 sc1
    buffer_load_dwordx4 v[112:115], v15, s[52:55], s36 offen offset:0 sc1
    buffer_load_dwordx4 v[116:119], v15, s[52:55], s36 offen offset:1024 sc1
    buffer_load_dwordx4 v[120:123], v15, s[52:55], s36 offen offset:2048 sc1
    buffer_load_dwordx4 v[124:127], v15, s[52:55], s36 offen offset:3072 sc1
    buffer_load_dwordx4 v[128:131], v252, s[52:55], s37 offen offset:0 sc1
    buffer_load_dwordx4 v[132:135], v252, s[52:55], s37 offen offset:1024 sc1
    s_setprio 1
    s_waitcnt lgkmcnt(0)
    v_cmp_gt_u32 vcc, 4, v222
    s_cbranch_vccnz LB_w4
LB_g4:
    s_waitcnt vmcnt(9)
    v_mfma_f32_16x16x32_bf16 v[16:19], v[48:51], v[96:99], 0
    buffer_load_dwordx4 v[136:139], v252, s[52:55], s37 offen offset:2048 sc1
    buffer_load_dwordx4 v[140:143], v252, s[52:55], s37 offen offset:3072 sc1
    s_waitcnt vmcnt(10)
    v_mfma_f32_16x16x32_bf16 v[16:19], v[52:55], v[100:103], v[16:19]
    buffer_load_dwordx4 v[144:147], v15, s[52:55], s37 offen offset:0 sc1
    s_waitcnt vmcnt(10)
    v_mfma_f32_16x16x32_bf16 v[16:19], v[56:59], v[104:107], v[16:19]
    buffer_load_dwordx4 v[148:151], v15, s[52:55], s37 offen offset:1024 sc1
    ds_read_b64_tr_b16 v[80:81], v4 offset:36864
    s_waitcnt vmcnt(10)
    v_mfma_f32_16x16x32_bf16 v[16:19], v[60:63], v[108:111], v[16:19]
    ds_read_b64_tr_b16 v[82:83], v8 offset:36864
    s_waitcnt vmcnt(6)
    v_mfma_f32_16x16x32_bf16 v[32:35], v[60:63], v[124:127], 0
    ds_read_b64_tr_b16 v[84:85], v4 offset:40960
    ds_read_b64_tr_b16 v[86:87], v8 offset:40960
    v_mfma_f32_16x16x32_bf16 v[32:35], v[56:59], v[120:123], v[32:35]
    ds_read_b64_tr_b16 v[88:89], v4 offset:45056
    v_mfma_f32_16x16x32_bf16 v[32:35], v[52:55], v[116:119], v[32:35]
    ds_read_b64_tr_b16 v[90:91], v8 offset:45056
    ds_read_b64_tr_b16 v[92:93], v226 offset:45056
    v_mfma_f32_16x16x32_bf16 v[32:35], v[48:51], v[112:115], v[32:35]
    ds_read_b64_tr_b16 v[94:95], v230 offset:45056
    v_mfma_f32_16x16x32_bf16 v[36:39], v[64:67], v[112:115], 0
    buffer_load_dwordx4 v[152:155], v15, s[52:55], s37 offen offset:2048 sc1
    buffer_load_dwordx4 v[156:159], v15, s[52:55], s37 offen offset:3072 sc1
    v_mfma_f32_16x16x32_bf16 v[36:39], v[68:71], v[116:119], v[36:39]
    buffer_load_dwordx4 v[160:163], v252, s[52:55], s38 offen offset:0 sc1
    v_mfma_f32_16x16x32_bf16 v[36:39], v[72:75], v[120:123], v[36:39]
    buffer_load_dwordx4 v[164:167], v252, s[52:55], s38 offen offset:1024 sc1
    ds_read_b64_tr_b16 v[48:49], v5 offset:36864
    v_mfma_f32_16x16x32_bf16 v[36:39], v[76:79], v[124:127], v[36:39]
    ds_read_b64_tr_b16 v[50:51], v9 offset:36864
    v_mfma_f32_16x16x32_bf16 v[20:23], v[76:79], v[108:111], 0
    ds_read_b64_tr_b16 v[52:53], v5 offset:40960
    ds_read_b64_tr_b16 v[54:55], v9 offset:40960
    v_mfma_f32_16x16x32_bf16 v[20:23], v[72:75], v[104:107], v[20:23]
    ds_read_b64_tr_b16 v[56:57], v5 offset:45056
    v_mfma_f32_16x16x32_bf16 v[20:23], v[68:71], v[100:103], v[20:23]
    ds_read_b64_tr_b16 v[58:59], v9 offset:45056
    ds_read_b64_tr_b16 v[60:61], v227 offset:45056
    v_mfma_f32_16x16x32_bf16 v[20:23], v[64:67], v[96:99], v[20:23]
    ds_read_b64_tr_b16 v[62:63], v231 offset:45056
    s_waitcnt lgkmcnt(14)
    v_mfma_f32_16x16x32_bf16 v[24:27], v[80:83], v[96:99], 0
    buffer_load_dwordx4 v[168:171], v252, s[52:55], s38 offen offset:2048 sc1
    buffer_load_dwordx4 v[172:175], v252, s[52:55], s38 offen offset:3072 sc1
    s_waitcnt lgkmcnt(12)
    v_mfma_f32_16x16x32_bf16 v[24:27], v[84:87], v[100:103], v[24:27]
    buffer_load_dwordx4 v[176:179], v15, s[52:55], s38 offen offset:0 sc1
    s_waitcnt lgkmcnt(10)
    v_mfma_f32_16x16x32_bf16 v[24:27], v[88:91], v[104:107], v[24:27]
    buffer_load_dwordx4 v[180:183], v15, s[52:55], s38 offen offset:1024 sc1
    ds_read_b64_tr_b16 v[64:65], v224 offset:49152
    s_waitcnt lgkmcnt(9)
    v_mfma_f32_16x16x32_bf16 v[24:27], v[92:95], v[108:111], v[24:27]
    ds_read_b64_tr_b16 v[66:67], v228 offset:49152
    v_mfma_f32_16x16x32_bf16 v[40:43], v[92:95], v[124:127], 0
    ds_read_b64_tr_b16 v[68:69], v224 offset:53248
    ds_read_b64_tr_b16 v[70:71], v228 offset:53248
    v_mfma_f32_16x16x32_bf16 v[40:43], v[88:91], v[120:123], v[40:43]
    ds_read_b64_tr_b16 v[72:73], v224 offset:57344
    v_mfma_f32_16x16x32_bf16 v[40:43], v[84:87], v[116:119], v[40:43]
    ds_read_b64_tr_b16 v[74:75], v228 offset:57344
    ds_read_b64_tr_b16 v[76:77], v2 offset:49152
    v_mfma_f32_16x16x32_bf16 v[40:43], v[80:83], v[112:115], v[40:43]
    ds_read_b64_tr_b16 v[78:79], v6 offset:49152
    s_waitcnt lgkmcnt(14)
    v_mfma_f32_16x16x32_bf16 v[44:47], v[48:51], v[112:115], 0
    buffer_load_dwordx4 v[184:187], v15, s[52:55], s38 offen offset:2048 sc1
    buffer_load_dwordx4 v[188:191], v15, s[52:55], s38 offen offset:3072 sc1
    s_waitcnt lgkmcnt(12)
    v_mfma_f32_16x16x32_bf16 v[44:47], v[52:55], v[116:119], v[44:47]
    ds_read_b64_tr_b16 v[80:81], v225 offset:49152
    s_waitcnt lgkmcnt(11)
    v_mfma_f32_16x16x32_bf16 v[44:47], v[56:59], v[120:123], v[44:47]
    ds_read_b64_tr_b16 v[82:83], v229 offset:49152
    s_waitcnt lgkmcnt(10)
    v_mfma_f32_16x16x32_bf16 v[44:47], v[60:63], v[124:127], v[44:47]
    ds_read_b64_tr_b16 v[84:85], v225 offset:53248
    v_mfma_f32_16x16x32_bf16 v[28:31], v[60:63], v[108:111], 0
    ds_read_b64_tr_b16 v[86:87], v229 offset:53248
    ds_read_b64_tr_b16 v[88:89], v225 offset:57344
    v_mfma_f32_16x16x32_bf16 v[28:31], v[56:59], v[104:107], v[28:31]
    ds_read_b64_tr_b16 v[90:91], v229 offset:57344
    v_mfma_f32_16x16x32_bf16 v[28:31], v[52:55], v[100:103], v[28:31]
    ds_read_b64_tr_b16 v[92:93], v3 offset:49152
    v_mfma_f32_16x16x32_bf16 v[28:31], v[48:51], v[96:99], v[28:31]
    ds_read_b64_tr_b16 v[94:95], v7 offset:49152
    s_waitcnt vmcnt(8) lgkmcnt(8)
    v_mfma_f32_16x16x32_bf16 v[16:19], v[64:67], v[128:131], v[16:19]
    buffer_load_dwordx4 v[96:99], v252, s[52:55], s39 offen offset:0 sc1
    buffer_load_dwordx4 v[100:103], v252, s[52:55], s39 offen offset:1024 sc1
    v_mfma_f32_16x16x32_bf16 v[16:19], v[68:71], v[132:135], v[16:19]
    buffer_load_dwordx4 v[104:107], v252, s[52:55], s39 offen offset:2048 sc1
    v_mfma_f32_16x16x32_bf16 v[16:19], v[72:75], v[136:139], v[16:19]
    buffer_load_dwordx4 v[108:111], v252, s[52:55], s39 offen offset:3072 sc1
    ds_read_b64_tr_b16 v[48:49], v226 offset:49152
    v_mfma_f32_16x16x32_bf16 v[16:19], v[76:79], v[140:143], v[16:19]
    ds_read_b64_tr_b16 v[50:51], v230 offset:49152
    v_mfma_f32_16x16x32_bf16 v[32:35], v[76:79], v[156:159], v[32:35]
    ds_read_b64_tr_b16 v[52:53], v226 offset:53248
    ds_read_b64_tr_b16 v[54:55], v230 offset:53248
    v_mfma_f32_16x16x32_bf16 v[32:35], v[72:75], v[152:155], v[32:35]
    ds_read_b64_tr_b16 v[56:57], v226 offset:57344
    v_mfma_f32_16x16x32_bf16 v[32:35], v[68:71], v[148:151], v[32:35]
    ds_read_b64_tr_b16 v[58:59], v230 offset:57344
    ds_read_b64_tr_b16 v[60:61], v4 offset:49152
    v_mfma_f32_16x16x32_bf16 v[32:35], v[64:67], v[144:147], v[32:35]
    ds_read_b64_tr_b16 v[62:63], v8 offset:49152
    s_waitcnt lgkmcnt(8)
    v_mfma_f32_16x16x32_bf16 v[36:39], v[80:83], v[144:147], v[36:39]
    buffer_load_dwordx4 v[112:115], v15, s[52:55], s39 offen offset:0 sc1
    buffer_load_dwordx4 v[116:119], v15, s[52:55], s39 offen offset:1024 sc1
    v_mfma_f32_16x16x32_bf16 v[36:39], v[84:87], v[148:151], v[36:39]
    ds_read_b64_tr_b16 v[64:65], v227 offset:49152
    v_mfma_f32_16x16x32_bf16 v[36:39], v[88:91], v[152:155], v[36:39]
    ds_read_b64_tr_b16 v[66:67], v231 offset:49152
    v_mfma_f32_16x16x32_bf16 v[36:39], v[92:95], v[156:159], v[36:39]
    ds_read_b64_tr_b16 v[68:69], v227 offset:53248
    v_mfma_f32_16x16x32_bf16 v[20:23], v[92:95], v[140:143], v[20:23]
    ds_read_b64_tr_b16 v[70:71], v231 offset:53248
    ds_read_b64_tr_b16 v[72:73], v227 offset:57344
    v_mfma_f32_16x16x32_bf16 v[20:23], v[88:91], v[136:139], v[20:23]
    ds_read_b64_tr_b16 v[74:75], v231 offset:57344
    v_mfma_f32_16x16x32_bf16 v[20:23], v[84:87], v[132:135], v[20:23]
    ds_read_b64_tr_b16 v[76:77], v5 offset:49152
    v_mfma_f32_16x16x32_bf16 v[20:23], v[80:83], v[128:131], v[20:23]
    ds_read_b64_tr_b16 v[78:79], v9 offset:49152
    s_waitcnt lgkmcnt(8)
    v_mfma_f32_16x16x32_bf16 v[24:27], v[48:51], v[128:131], v[24:27]
    buffer_load_dwordx4 v[120:123], v15, s[52:55], s39 offen offset:2048 sc1
    buffer_load_dwordx4 v[124:127], v15, s[52:55], s39 offen offset:3072 sc1
    v_mfma_f32_16x16x32_bf16 v[24:27], v[52:55], v[132:135], v[24:27]
    ds_read_b64_tr_b16 v[80:81], v2 offset:53248
    v_mfma_f32_16x16x32_bf16 v[24:27], v[56:59], v[136:139], v[24:27]
    ds_read_b64_tr_b16 v[82:83], v6 offset:53248
    v_mfma_f32_16x16x32_bf16 v[24:27], v[60:63], v[140:143], v[24:27]
    ds_read_b64_tr_b16 v[84:85], v2 offset:57344
    v_mfma_f32_16x16x32_bf16 v[40:43], v[60:63], v[156:159], v[40:43]
    ds_read_b64_tr_b16 v[86:87], v6 offset:57344
    ds_read_b64_tr_b16 v[88:89], v2 offset:61440
    v_mfma_f32_16x16x32_bf16 v[40:43], v[56:59], v[152:155], v[40:43]
    ds_read_b64_tr_b16 v[90:91], v6 offset:61440
    v_mfma_f32_16x16x32_bf16 v[40:43], v[52:55], v[148:151], v[40:43]
    ds_read_b64_tr_b16 v[92:93], v224 offset:0
    v_mfma_f32_16x16x32_bf16 v[40:43], v[48:51], v[144:147], v[40:43]
    ds_read_b64_tr_b16 v[94:95], v228 offset:0
    s_waitcnt lgkmcnt(8)
    v_mfma_f32_16x16x32_bf16 v[44:47], v[64:67], v[144:147], v[44:47]
    ds_read_b64_tr_b16 v[48:49], v3 offset:53248
    v_mfma_f32_16x16x32_bf16 v[44:47], v[68:71], v[148:151], v[44:47]
    ds_read_b64_tr_b16 v[50:51], v7 offset:53248
    v_mfma_f32_16x16x32_bf16 v[44:47], v[72:75], v[152:155], v[44:47]
    ds_read_b64_tr_b16 v[52:53], v3 offset:57344
    v_mfma_f32_16x16x32_bf16 v[44:47], v[76:79], v[156:159], v[44:47]
    ds_read_b64_tr_b16 v[54:55], v7 offset:57344
    v_mfma_f32_16x16x32_bf16 v[28:31], v[76:79], v[140:143], v[28:31]
    ds_read_b64_tr_b16 v[56:57], v3 offset:61440
    v_mfma_f32_16x16x32_bf16 v[28:31], v[72:75], v[136:139], v[28:31]
    ds_read_b64_tr_b16 v[58:59], v7 offset:61440
    v_mfma_f32_16x16x32_bf16 v[28:31], v[68:71], v[132:135], v[28:31]
    ds_read_b64_tr_b16 v[60:61], v225 offset:0
    v_mfma_f32_16x16x32_bf16 v[28:31], v[64:67], v[128:131], v[28:31]
    ds_read_b64_tr_b16 v[62:63], v229 offset:0
    s_waitcnt vmcnt(8) lgkmcnt(8)
    v_mfma_f32_16x16x32_bf16 v[16:19], v[80:83], v[160:163], v[16:19]
    buffer_load_dwordx4 v[128:131], v252, s[52:55], s40 offen offset:0 sc1
    buffer_load_dwordx4 v[132:135], v252, s[52:55], s40 offen offset:1024 sc1
    v_mfma_f32_16x16x32_bf16 v[16:19], v[84:87], v[164:167], v[16:19]
    buffer_load_dwordx4 v[136:139], v252, s[52:55], s40 offen offset:2048 sc1
    v_mfma_f32_16x16x32_bf16 v[16:19], v[88:91], v[168:171], v[16:19]
    buffer_load_dwordx4 v[140:143], v252, s[52:55], s40 offen offset:3072 sc1
    ds_read_b64_tr_b16 v[64:65], v4 offset:53248
    v_mfma_f32_16x16x32_bf16 v[16:19], v[92:95], v[172:175], v[16:19]
    ds_read_b64_tr_b16 v[66:67], v8 offset:53248
    v_mfma_f32_16x16x32_bf16 v[32:35], v[92:95], v[188:191], v[32:35]
    ds_read_b64_tr_b16 v[68:69], v4 offset:57344
    ds_read_b64_tr_b16 v[70:71], v8 offset:57344
    v_mfma_f32_16x16x32_bf16 v[32:35], v[88:91], v[184:187], v[32:35]
    ds_read_b64_tr_b16 v[72:73], v4 offset:61440
    v_mfma_f32_16x16x32_bf16 v[32:35], v[84:87], v[180:183], v[32:35]
    ds_read_b64_tr_b16 v[74:75], v8 offset:61440
    ds_read_b64_tr_b16 v[76:77], v226 offset:0
    v_mfma_f32_16x16x32_bf16 v[32:35], v[80:83], v[176:179], v[32:35]
    ds_read_b64_tr_b16 v[78:79], v230 offset:0
    s_waitcnt lgkmcnt(8)
    v_mfma_f32_16x16x32_bf16 v[36:39], v[48:51], v[176:179], v[36:39]
    buffer_load_dwordx4 v[144:147], v15, s[52:55], s40 offen offset:0 sc1
    buffer_load_dwordx4 v[148:151], v15, s[52:55], s40 offen offset:1024 sc1
    v_mfma_f32_16x16x32_bf16 v[36:39], v[52:55], v[180:183], v[36:39]
    ds_read_b64_tr_b16 v[80:81], v5 offset:53248
    v_mfma_f32_16x16x32_bf16 v[36:39], v[56:59], v[184:187], v[36:39]
    ds_read_b64_tr_b16 v[82:83], v9 offset:53248
    v_mfma_f32_16x16x32_bf16 v[36:39], v[60:63], v[188:191], v[36:39]
    ds_read_b64_tr_b16 v[84:85], v5 offset:57344
    v_mfma_f32_16x16x32_bf16 v[20:23], v[60:63], v[172:175], v[20:23]
    ds_read_b64_tr_b16 v[86:87], v9 offset:57344
    ds_read_b64_tr_b16 v[88:89], v5 offset:61440
    v_mfma_f32_16x16x32_bf16 v[20:23], v[56:59], v[168:171], v[20:23]
    ds_read_b64_tr_b16 v[90:91], v9 offset:61440
    v_mfma_f32_16x16x32_bf16 v[20:23], v[52:55], v[164:167], v[20:23]
    ds_read_b64_tr_b16 v[92:93], v227 offset:0
    v_mfma_f32_16x16x32_bf16 v[20:23], v[48:51], v[160:163], v[20:23]
    ds_read_b64_tr_b16 v[94:95], v231 offset:0
    s_waitcnt lgkmcnt(8)
    v_mfma_f32_16x16x32_bf16 v[24:27], v[64:67], v[160:163], v[24:27]
    buffer_load_dwordx4 v[152:155], v15, s[52:55], s40 offen offset:2048 sc1
    buffer_load_dwordx4 v[156:159], v15, s[52:55], s40 offen offset:3072 sc1
    v_mfma_f32_16x16x32_bf16 v[24:27], v[68:71], v[164:167], v[24:27]
    ds_read_b64_tr_b16 v[48:49], v224 offset:4096
    v_mfma_f32_16x16x32_bf16 v[24:27], v[72:75], v[168:171], v[24:27]
    ds_read_b64_tr_b16 v[50:51], v228 offset:4096
    v_mfma_f32_16x16x32_bf16 v[24:27], v[76:79], v[172:175], v[24:27]
    ds_read_b64_tr_b16 v[52:53], v2 offset:0
    v_mfma_f32_16x16x32_bf16 v[40:43], v[76:79], v[188:191], v[40:43]
    ds_read_b64_tr_b16 v[54:55], v6 offset:0
    ds_read_b64_tr_b16 v[56:57], v2 offset:4096
    v_mfma_f32_16x16x32_bf16 v[40:43], v[72:75], v[184:187], v[40:43]
    ds_read_b64_tr_b16 v[58:59], v6 offset:4096
    v_mfma_f32_16x16x32_bf16 v[40:43], v[68:71], v[180:183], v[40:43]
    ds_read_b64_tr_b16 v[60:61], v2 offset:8192
    v_mfma_f32_16x16x32_bf16 v[40:43], v[64:67], v[176:179], v[40:43]
    ds_read_b64_tr_b16 v[62:63], v6 offset:8192
    s_waitcnt lgkmcnt(8)
    v_mfma_f32_16x16x32_bf16 v[44:47], v[80:83], v[176:179], v[44:47]
    ds_read_b64_tr_b16 v[64:65], v225 offset:4096
    v_mfma_f32_16x16x32_bf16 v[44:47], v[84:87], v[180:183], v[44:47]
    ds_read_b64_tr_b16 v[66:67], v229 offset:4096
    v_mfma_f32_16x16x32_bf16 v[44:47], v[88:91], v[184:187], v[44:47]
    ds_read_b64_tr_b16 v[68:69], v3 offset:0
    v_mfma_f32_16x16x32_bf16 v[44:47], v[92:95], v[188:191], v[44:47]
    ds_read_b64_tr_b16 v[70:71], v7 offset:0
    v_mfma_f32_16x16x32_bf16 v[28:31], v[92:95], v[172:175], v[28:31]
    ds_read_b64_tr_b16 v[72:73], v3 offset:4096
    v_mfma_f32_16x16x32_bf16 v[28:31], v[88:91], v[168:171], v[28:31]
    ds_read_b64_tr_b16 v[74:75], v7 offset:4096
    v_mfma_f32_16x16x32_bf16 v[28:31], v[84:87], v[164:167], v[28:31]
    ds_read_b64_tr_b16 v[76:77], v3 offset:8192
    v_mfma_f32_16x16x32_bf16 v[28:31], v[80:83], v[160:163], v[28:31]
    ds_read_b64_tr_b16 v[78:79], v7 offset:8192
    s_waitcnt vmcnt(8) lgkmcnt(8)
    v_mfma_f32_16x16x32_bf16 v[16:19], v[48:51], v[96:99], v[16:19]
    buffer_load_dwordx4 v[160:163], v252, s[52:55], s41 offen offset:0 sc1
    buffer_load_dwordx4 v[164:167], v252, s[52:55], s41 offen offset:1024 sc1
    v_mfma_f32_16x16x32_bf16 v[16:19], v[52:55], v[100:103], v[16:19]
    buffer_load_dwordx4 v[168:171], v252, s[52:55], s41 offen offset:2048 sc1
    v_mfma_f32_16x16x32_bf16 v[16:19], v[56:59], v[104:107], v[16:19]
    buffer_load_dwordx4 v[172:175], v252, s[52:55], s41 offen offset:3072 sc1
    ds_read_b64_tr_b16 v[80:81], v226 offset:4096
    v_mfma_f32_16x16x32_bf16 v[16:19], v[60:63], v[108:111], v[16:19]
    ds_read_b64_tr_b16 v[82:83], v230 offset:4096
    v_mfma_f32_16x16x32_bf16 v[32:35], v[60:63], v[124:127], v[32:35]
    ds_read_b64_tr_b16 v[84:85], v4 offset:0
    ds_read_b64_tr_b16 v[86:87], v8 offset:0
    v_mfma_f32_16x16x32_bf16 v[32:35], v[56:59], v[120:123], v[32:35]
    ds_read_b64_tr_b16 v[88:89], v4 offset:4096
    v_mfma_f32_16x16x32_bf16 v[32:35], v[52:55], v[116:119], v[32:35]
    ds_read_b64_tr_b16 v[90:91], v8 offset:4096
    ds_read_b64_tr_b16 v[92:93], v4 offset:8192
    v_mfma_f32_16x16x32_bf16 v[32:35], v[48:51], v[112:115], v[32:35]
    ds_read_b64_tr_b16 v[94:95], v8 offset:8192
    s_waitcnt lgkmcnt(8)
    v_mfma_f32_16x16x32_bf16 v[36:39], v[64:67], v[112:115], v[36:39]
    buffer_load_dwordx4 v[176:179], v15, s[52:55], s41 offen offset:0 sc1
    buffer_load_dwordx4 v[180:183], v15, s[52:55], s41 offen offset:1024 sc1
    v_mfma_f32_16x16x32_bf16 v[36:39], v[68:71], v[116:119], v[36:39]
    ds_read_b64_tr_b16 v[48:49], v227 offset:4096
    v_mfma_f32_16x16x32_bf16 v[36:39], v[72:75], v[120:123], v[36:39]
    ds_read_b64_tr_b16 v[50:51], v231 offset:4096
    v_mfma_f32_16x16x32_bf16 v[36:39], v[76:79], v[124:127], v[36:39]
    ds_read_b64_tr_b16 v[52:53], v5 offset:0
    v_mfma_f32_16x16x32_bf16 v[20:23], v[76:79], v[108:111], v[20:23]
    ds_read_b64_tr_b16 v[54:55], v9 offset:0
    ds_read_b64_tr_b16 v[56:57], v5 offset:4096
    v_mfma_f32_16x16x32_bf16 v[20:23], v[72:75], v[104:107], v[20:23]
    ds_read_b64_tr_b16 v[58:59], v9 offset:4096
    v_mfma_f32_16x16x32_bf16 v[20:23], v[68:71], v[100:103], v[20:23]
    ds_read_b64_tr_b16 v[60:61], v5 offset:8192
    v_mfma_f32_16x16x32_bf16 v[20:23], v[64:67], v[96:99], v[20:23]
    ds_read_b64_tr_b16 v[62:63], v9 offset:8192
    s_mov_b64 exec, 1
    ds_add_u32 v10, v11 offset:28
    s_mov_b64 exec, -1
    s_waitcnt lgkmcnt(9)
    v_mfma_f32_16x16x32_bf16 v[24:27], v[80:83], v[96:99], v[24:27]
    buffer_load_dwordx4 v[184:187], v15, s[52:55], s41 offen offset:2048 sc1
    buffer_load_dwordx4 v[188:191], v15, s[52:55], s41 offen offset:3072 sc1
    v_mfma_f32_16x16x32_bf16 v[24:27], v[84:87], v[100:103], v[24:27]
    ds_read_b64_tr_b16 v[64:65], v2 offset:12288
    v_mfma_f32_16x16x32_bf16 v[24:27], v[88:91], v[104:107], v[24:27]
    ds_read_b64_tr_b16 v[66:67], v6 offset:12288
    v_mfma_f32_16x16x32_bf16 v[24:27], v[92:95], v[108:111], v[24:27]
    ds_read_b64_tr_b16 v[68:69], v2 offset:16384
    v_mfma_f32_16x16x32_bf16 v[40:43], v[92:95], v[124:127], v[40:43]
    ds_read_b64_tr_b16 v[70:71], v6 offset:16384
    ds_read_b64_tr_b16 v[72:73], v2 offset:20480
    v_mfma_f32_16x16x32_bf16 v[40:43], v[88:91], v[120:123], v[40:43]
    ds_read_b64_tr_b16 v[74:75], v6 offset:20480
    v_mfma_f32_16x16x32_bf16 v[40:43], v[84:87], v[116:119], v[40:43]
    ds_read_b64_tr_b16 v[76:77], v224 offset:8192
    v_mfma_f32_16x16x32_bf16 v[40:43], v[80:83], v[112:115], v[40:43]
    ds_read_b64_tr_b16 v[78:79], v228 offset:8192
    s_waitcnt lgkmcnt(9)
    v_mfma_f32_16x16x32_bf16 v[44:47], v[48:51], v[112:115], v[44:47]
    ds_read_b64_tr_b16 v[80:81], v3 offset:12288
    v_mfma_f32_16x16x32_bf16 v[44:47], v[52:55], v[116:119], v[44:47]
    ds_read_b64_tr_b16 v[82:83], v7 offset:12288
    v_mfma_f32_16x16x32_bf16 v[44:47], v[56:59], v[120:123], v[44:47]
    ds_read_b64_tr_b16 v[84:85], v3 offset:16384
    v_mfma_f32_16x16x32_bf16 v[44:47], v[60:63], v[124:127], v[44:47]
    ds_read_b64_tr_b16 v[86:87], v7 offset:16384
    v_mfma_f32_16x16x32_bf16 v[28:31], v[60:63], v[108:111], v[28:31]
    ds_read_b64_tr_b16 v[88:89], v3 offset:20480
    v_mfma_f32_16x16x32_bf16 v[28:31], v[56:59], v[104:107], v[28:31]
    ds_read_b64_tr_b16 v[90:91], v7 offset:20480
    v_mfma_f32_16x16x32_bf16 v[28:31], v[52:55], v[100:103], v[28:31]
    ds_read_b64_tr_b16 v[92:93], v225 offset:8192
    v_mfma_f32_16x16x32_bf16 v[28:31], v[48:51], v[96:99], v[28:31]
    ds_read_b64_tr_b16 v[94:95], v229 offset:8192
    s_waitcnt vmcnt(8) lgkmcnt(8)
    v_mfma_f32_16x16x32_bf16 v[16:19], v[64:67], v[128:131], v[16:19]
    buffer_load_dwordx4 v[96:99], v252, s[52:55], s42 offen offset:0 sc1
    buffer_load_dwordx4 v[100:103], v252, s[52:55], s42 offen offset:1024 sc1
    v_mfma_f32_16x16x32_bf16 v[16:19], v[68:71], v[132:135], v[16:19]
    buffer_load_dwordx4 v[104:107], v252, s[52:55], s42 offen offset:2048 sc1
    v_mfma_f32_16x16x32_bf16 v[16:19], v[72:75], v[136:139], v[16:19]
    buffer_load_dwordx4 v[108:111], v252, s[52:55], s42 offen offset:3072 sc1
    ds_read_b64_tr_b16 v[48:49], v4 offset:12288
    v_mfma_f32_16x16x32_bf16 v[16:19], v[76:79], v[140:143], v[16:19]
    ds_read_b64_tr_b16 v[50:51], v8 offset:12288
    v_mfma_f32_16x16x32_bf16 v[32:35], v[76:79], v[156:159], v[32:35]
    ds_read_b64_tr_b16 v[52:53], v4 offset:16384
    ds_read_b64_tr_b16 v[54:55], v8 offset:16384
    v_mfma_f32_16x16x32_bf16 v[32:35], v[72:75], v[152:155], v[32:35]
    ds_read_b64_tr_b16 v[56:57], v4 offset:20480
    v_mfma_f32_16x16x32_bf16 v[32:35], v[68:71], v[148:151], v[32:35]
    ds_read_b64_tr_b16 v[58:59], v8 offset:20480
    ds_read_b64_tr_b16 v[60:61], v226 offset:8192
    v_mfma_f32_16x16x32_bf16 v[32:35], v[64:67], v[144:147], v[32:35]
    ds_read_b64_tr_b16 v[62:63], v230 offset:8192
    s_waitcnt lgkmcnt(8)
    v_mfma_f32_16x16x32_bf16 v[36:39], v[80:83], v[144:147], v[36:39]
    buffer_load_dwordx4 v[112:115], v15, s[52:55], s42 offen offset:0 sc1
    buffer_load_dwordx4 v[116:119], v15, s[52:55], s42 offen offset:1024 sc1
    v_mfma_f32_16x16x32_bf16 v[36:39], v[84:87], v[148:151], v[36:39]
    ds_read_b64_tr_b16 v[64:65], v5 offset:12288
    v_mfma_f32_16x16x32_bf16 v[36:39], v[88:91], v[152:155], v[36:39]
    ds_read_b64_tr_b16 v[66:67], v9 offset:12288
    v_mfma_f32_16x16x32_bf16 v[36:39], v[92:95], v[156:159], v[36:39]
    ds_read_b64_tr_b16 v[68:69], v5 offset:16384
    v_mfma_f32_16x16x32_bf16 v[20:23], v[92:95], v[140:143], v[20:23]
    ds_read_b64_tr_b16 v[70:71], v9 offset:16384
    ds_read_b64_tr_b16 v[72:73], v5 offset:20480
    v_mfma_f32_16x16x32_bf16 v[20:23], v[88:91], v[136:139], v[20:23]
    ds_read_b64_tr_b16 v[74:75], v9 offset:20480
    v_mfma_f32_16x16x32_bf16 v[20:23], v[84:87], v[132:135], v[20:23]
    ds_read_b64_tr_b16 v[76:77], v227 offset:8192
    v_mfma_f32_16x16x32_bf16 v[20:23], v[80:83], v[128:131], v[20:23]
    ds_read_b64_tr_b16 v[78:79], v231 offset:8192
    s_waitcnt lgkmcnt(8)
    v_mfma_f32_16x16x32_bf16 v[24:27], v[48:51], v[128:131], v[24:27]
    buffer_load_dwordx4 v[120:123], v15, s[52:55], s42 offen offset:2048 sc1
    buffer_load_dwordx4 v[124:127], v15, s[52:55], s42 offen offset:3072 sc1
    v_mfma_f32_16x16x32_bf16 v[24:27], v[52:55], v[132:135], v[24:27]
    ds_read_b64_tr_b16 v[80:81], v224 offset:12288
    v_mfma_f32_16x16x32_bf16 v[24:27], v[56:59], v[136:139], v[24:27]
    ds_read_b64_tr_b16 v[82:83], v228 offset:12288
    v_mfma_f32_16x16x32_bf16 v[24:27], v[60:63], v[140:143], v[24:27]
    ds_read_b64_tr_b16 v[84:85], v224 offset:16384
    v_mfma_f32_16x16x32_bf16 v[40:43], v[60:63], v[156:159], v[40:43]
    ds_read_b64_tr_b16 v[86:87], v228 offset:16384
    ds_read_b64_tr_b16 v[88:89], v224 offset:20480
    v_mfma_f32_16x16x32_bf16 v[40:43], v[56:59], v[152:155], v[40:43]
    ds_read_b64_tr_b16 v[90:91], v228 offset:20480
    v_mfma_f32_16x16x32_bf16 v[40:43], v[52:55], v[148:151], v[40:43]
    ds_read_b64_tr_b16 v[92:93], v2 offset:24576
    v_mfma_f32_16x16x32_bf16 v[40:43], v[48:51], v[144:147], v[40:43]
    ds_read_b64_tr_b16 v[94:95], v6 offset:24576
    s_waitcnt lgkmcnt(8)
    v_mfma_f32_16x16x32_bf16 v[44:47], v[64:67], v[144:147], v[44:47]
    ds_read_b64_tr_b16 v[48:49], v225 offset:12288
    v_mfma_f32_16x16x32_bf16 v[44:47], v[68:71], v[148:151], v[44:47]
    ds_read_b64_tr_b16 v[50:51], v229 offset:12288
    v_mfma_f32_16x16x32_bf16 v[44:47], v[72:75], v[152:155], v[44:47]
    ds_read_b64_tr_b16 v[52:53], v225 offset:16384
    v_mfma_f32_16x16x32_bf16 v[44:47], v[76:79], v[156:159], v[44:47]
    ds_read_b64_tr_b16 v[54:55], v229 offset:16384
    v_mfma_f32_16x16x32_bf16 v[28:31], v[76:79], v[140:143], v[28:31]
    ds_read_b64_tr_b16 v[56:57], v225 offset:20480
    v_mfma_f32_16x16x32_bf16 v[28:31], v[72:75], v[136:139], v[28:31]
    ds_read_b64_tr_b16 v[58:59], v229 offset:20480
    v_mfma_f32_16x16x32_bf16 v[28:31], v[68:71], v[132:135], v[28:31]
    ds_read_b64_tr_b16 v[60:61], v3 offset:24576
    v_mfma_f32_16x16x32_bf16 v[28:31], v[64:67], v[128:131], v[28:31]
    ds_read_b64_tr_b16 v[62:63], v7 offset:24576
    s_waitcnt vmcnt(8) lgkmcnt(8)
    v_mfma_f32_16x16x32_bf16 v[16:19], v[80:83], v[160:163], v[16:19]
    buffer_load_dwordx4 v[128:131], v252, s[52:55], s43 offen offset:0 sc1
    buffer_load_dwordx4 v[132:135], v252, s[52:55], s43 offen offset:1024 sc1
    v_mfma_f32_16x16x32_bf16 v[16:19], v[84:87], v[164:167], v[16:19]
    buffer_load_dwordx4 v[136:139], v252, s[52:55], s43 offen offset:2048 sc1
    v_mfma_f32_16x16x32_bf16 v[16:19], v[88:91], v[168:171], v[16:19]
    buffer_load_dwordx4 v[140:143], v252, s[52:55], s43 offen offset:3072 sc1
    ds_read_b64_tr_b16 v[64:65], v226 offset:12288
    v_mfma_f32_16x16x32_bf16 v[16:19], v[92:95], v[172:175], v[16:19]
    ds_read_b64_tr_b16 v[66:67], v230 offset:12288
    v_mfma_f32_16x16x32_bf16 v[32:35], v[92:95], v[188:191], v[32:35]
    ds_read_b64_tr_b16 v[68:69], v226 offset:16384
    ds_read_b64_tr_b16 v[70:71], v230 offset:16384
    v_mfma_f32_16x16x32_bf16 v[32:35], v[88:91], v[184:187], v[32:35]
    ds_read_b64_tr_b16 v[72:73], v226 offset:20480
    v_mfma_f32_16x16x32_bf16 v[32:35], v[84:87], v[180:183], v[32:35]
    ds_read_b64_tr_b16 v[74:75], v230 offset:20480
    ds_read_b64_tr_b16 v[76:77], v4 offset:24576
    v_mfma_f32_16x16x32_bf16 v[32:35], v[80:83], v[176:179], v[32:35]
    ds_read_b64_tr_b16 v[78:79], v8 offset:24576
    s_mov_b64 exec, 1
    ds_add_u32 v10, v11 offset:40
    s_mov_b64 exec, -1
    s_waitcnt lgkmcnt(9)
    v_mfma_f32_16x16x32_bf16 v[36:39], v[48:51], v[176:179], v[36:39]
    buffer_load_dwordx4 v[144:147], v15, s[52:55], s43 offen offset:0 sc1
    buffer_load_dwordx4 v[148:151], v15, s[52:55], s43 offen offset:1024 sc1
    v_mfma_f32_16x16x32_bf16 v[36:39], v[52:55], v[180:183], v[36:39]
    ds_read_b32 v223, v10 offset:32
    v_mfma_f32_16x16x32_bf16 v[36:39], v[56:59], v[184:187], v[36:39]
    ds_read_b64_tr_b16 v[80:81], v227 offset:12288
    ds_read_b64_tr_b16 v[82:83], v231 offset:12288
    v_mfma_f32_16x16x32_bf16 v[36:39], v[60:63], v[188:191], v[36:39]
    ds_read_b64_tr_b16 v[84:85], v227 offset:16384
    v_mfma_f32_16x16x32_bf16 v[20:23], v[60:63], v[172:175], v[20:23]
    ds_read_b64_tr_b16 v[86:87], v231 offset:16384
    v_mfma_f32_16x16x32_bf16 v[20:23], v[56:59], v[168:171], v[20:23]
    ds_read_b64_tr_b16 v[88:89], v227 offset:20480
    ds_read_b64_tr_b16 v[90:91], v231 offset:20480
    v_mfma_f32_16x16x32_bf16 v[20:23], v[52:55], v[164:167], v[20:23]
    ds_read_b64_tr_b16 v[92:93], v5 offset:24576
    v_mfma_f32_16x16x32_bf16 v[20:23], v[48:51], v[160:163], v[20:23]
    ds_read_b64_tr_b16 v[94:95], v9 offset:24576
    s_waitcnt lgkmcnt(8)
    v_cmp_gt_u32 vcc, 4, v223
    s_cbranch_vccnz LB_w8
LB_g8:
    v_mfma_f32_16x16x32_bf16 v[24:27], v[64:67], v[160:163], v[24:27]
    buffer_load_dwordx4 v[152:155], v15, s[52:55], s43 offen offset:2048 sc1
    buffer_load_dwordx4 v[156:159], v15, s[52:55], s43 offen offset:3072 sc1
    v_mfma_f32_16x16x32_bf16 v[24:27], v[68:71], v[164:167], v[24:27]
    ds_read_b64_tr_b16 v[48:49], v2 offset:28672
    v_mfma_f32_16x16x32_bf16 v[24:27], v[72:75], v[168:171], v[24:27]
    ds_read_b64_tr_b16 v[50:51], v6 offset:28672
    v_mfma_f32_16x16x32_bf16 v[24:27], v[76:79], v[172:175], v[24:27]
    ds_read_b64_tr_b16 v[52:53], v2 offset:32768
    v_mfma_f32_16x16x32_bf16 v[40:43], v[76:79], v[188:191], v[40:43]
    ds_read_b64_tr_b16 v[54:55], v6 offset:32768
    ds_read_b64_tr_b16 v[56:57], v232 offset:0
    v_mfma_f32_16x16x32_bf16 v[40:43], v[72:75], v[184:187], v[40:43]
    ds_read_b64_tr_b16 v[58:59], v236 offset:0
    v_mfma_f32_16x16x32_bf16 v[40:43], v[68:71], v[180:183], v[40:43]
    ds_read_b64_tr_b16 v[60:61], v232 offset:4096
    v_mfma_f32_16x16x32_bf16 v[40:43], v[64:67], v[176:179], v[40:43]
    ds_read_b64_tr_b16 v[62:63], v236 offset:4096
    s_waitcnt lgkmcnt(8)
    v_mfma_f32_16x16x32_bf16 v[44:47], v[80:83], v[176:179], v[44:47]
    ds_read_b64_tr_b16 v[64:65], v3 offset:28672
    v_mfma_f32_16x16x32_bf16 v[44:47], v[84:87], v[180:183], v[44:47]
    ds_read_b64_tr_b16 v[66:67], v7 offset:28672
    v_mfma_f32_16x16x32_bf16 v[44:47], v[88:91], v[184:187], v[44:47]
    ds_read_b64_tr_b16 v[68:69], v3 offset:32768
    v_mfma_f32_16x16x32_bf16 v[44:47], v[92:95], v[188:191], v[44:47]
    ds_read_b64_tr_b16 v[70:71], v7 offset:32768
    v_mfma_f32_16x16x32_bf16 v[28:31], v[92:95], v[172:175], v[28:31]
    ds_read_b64_tr_b16 v[72:73], v233 offset:0
    v_mfma_f32_16x16x32_bf16 v[28:31], v[88:91], v[168:171], v[28:31]
    ds_read_b64_tr_b16 v[74:75], v237 offset:0
    v_mfma_f32_16x16x32_bf16 v[28:31], v[84:87], v[164:167], v[28:31]
    ds_read_b64_tr_b16 v[76:77], v233 offset:4096
    v_mfma_f32_16x16x32_bf16 v[28:31], v[80:83], v[160:163], v[28:31]
    ds_read_b64_tr_b16 v[78:79], v237 offset:4096
    s_waitcnt vmcnt(8) lgkmcnt(8)
    v_mfma_f32_16x16x32_bf16 v[16:19], v[48:51], v[96:99], v[16:19]
    ds_read_b64_tr_b16 v[80:81], v4 offset:28672
    v_mfma_f32_16x16x32_bf16 v[16:19], v[52:55], v[100:103], v[16:19]
    ds_read_b64_tr_b16 v[82:83], v8 offset:28672
    v_mfma_f32_16x16x32_bf16 v[16:19], v[56:59], v[104:107], v[16:19]
    ds_read_b64_tr_b16 v[84:85], v4 offset:32768
    v_mfma_f32_16x16x32_bf16 v[16:19], v[60:63], v[108:111], v[16:19]
    ds_read_b64_tr_b16 v[86:87], v8 offset:32768
    v_mfma_f32_16x16x32_bf16 v[32:35], v[60:63], v[124:127], v[32:35]
    ds_read_b64_tr_b16 v[88:89], v234 offset:0
    v_mfma_f32_16x16x32_bf16 v[32:35], v[56:59], v[120:123], v[32:35]
    ds_read_b64_tr_b16 v[90:91], v238 offset:0
    v_mfma_f32_16x16x32_bf16 v[32:35], v[52:55], v[116:119], v[32:35]
    ds_read_b64_tr_b16 v[92:93], v234 offset:4096
    v_mfma_f32_16x16x32_bf16 v[32:35], v[48:51], v[112:115], v[32:35]
    ds_read_b64_tr_b16 v[94:95], v238 offset:4096
    s_waitcnt lgkmcnt(8)
    v_mfma_f32_16x16x32_bf16 v[36:39], v[64:67], v[112:115], v[36:39]
    ds_read_b64_tr_b16 v[48:49], v5 offset:28672
    v_mfma_f32_16x16x32_bf16 v[36:39], v[68:71], v[116:119], v[36:39]
    ds_read_b64_tr_b16 v[50:51], v9 offset:28672
    v_mfma_f32_16x16x32_bf16 v[36:39], v[72:75], v[120:123], v[36:39]
    ds_read_b64_tr_b16 v[52:53], v5 offset:32768
    v_mfma_f32_16x16x32_bf16 v[36:39], v[76:79], v[124:127], v[36:39]
    ds_read_b64_tr_b16 v[54:55], v9 offset:32768
    v_mfma_f32_16x16x32_bf16 v[20:23], v[76:79], v[108:111], v[20:23]
    ds_read_b64_tr_b16 v[56:57], v235 offset:0
    v_mfma_f32_16x16x32_bf16 v[20:23], v[72:75], v[104:107], v[20:23]
    ds_read_b64_tr_b16 v[58:59], v239 offset:0
    v_mfma_f32_16x16x32_bf16 v[20:23], v[68:71], v[100:103], v[20:23]
    ds_read_b64_tr_b16 v[60:61], v235 offset:4096
    v_mfma_f32_16x16x32_bf16 v[20:23], v[64:67], v[96:99], v[20:23]
    ds_read_b64_tr_b16 v[62:63], v239 offset:4096
    s_waitcnt lgkmcnt(8)
    v_mfma_f32_16x16x32_bf16 v[24:27], v[80:83], v[96:99], v[24:27]
    ds_read_b64_tr_b16 v[64:65], v232 offset:8192
    v_mfma_f32_16x16x32_bf16 v[24:27], v[84:87], v[100:103], v[24:27]
    ds_read_b64_tr_b16 v[66:67], v236 offset:8192
    v_mfma_f32_16x16x32_bf16 v[24:27], v[88:91], v[104:107], v[24:27]
    ds_read_b64_tr_b16 v[68:69], v232 offset:12288
    v_mfma_f32_16x16x32_bf16 v[24:27], v[92:95], v[108:111], v[24:27]
    ds_read_b64_tr_b16 v[70:71], v236 offset:12288
    v_mfma_f32_16x16x32_bf16 v[40:43], v[92:95], v[124:127], v[40:43]
    ds_read_b64_tr_b16 v[72:73], v232 offset:16384
    v_mfma_f32_16x16x32_bf16 v[40:43], v[88:91], v[120:123], v[40:43]
    ds_read_b64_tr_b16 v[74:75], v236 offset:16384
    v_mfma_f32_16x16x32_bf16 v[40:43], v[84:87], v[116:119], v[40:43]
    ds_read_b64_tr_b16 v[76:77], v232 offset:20480
    v_mfma_f32_16x16x32_bf16 v[40:43], v[80:83], v[112:115], v[40:43]
    ds_read_b64_tr_b16 v[78:79], v236 offset:20480
    s_waitcnt lgkmcnt(8)
    v_mfma_f32_16x16x32_bf16 v[44:47], v[48:51], v[112:115], v[44:47]
    ds_read_b64_tr_b16 v[80:81], v233 offset:8192
    v_mfma_f32_16x16x32_bf16 v[44:47], v[52:55], v[116:119], v[44:47]
    ds_read_b64_tr_b16 v[82:83], v237 offset:8192
    v_mfma_f32_16x16x32_bf16 v[44:47], v[56:59], v[120:123], v[44:47]
    ds_read_b64_tr_b16 v[84:85], v233 offset:12288
    v_mfma_f32_16x16x32_bf16 v[44:47], v[60:63], v[124:127], v[44:47]
    ds_read_b64_tr_b16 v[86:87], v237 offset:12288
    v_mfma_f32_16x16x32_bf16 v[28:31], v[60:63], v[108:111], v[28:31]
    ds_read_b64_tr_b16 v[88:89], v233 offset:16384
    v_mfma_f32_16x16x32_bf16 v[28:31], v[56:59], v[104:107], v[28:31]
    ds_read_b64_tr_b16 v[90:91], v237 offset:16384
    v_mfma_f32_16x16x32_bf16 v[28:31], v[52:55], v[100:103], v[28:31]
    ds_read_b64_tr_b16 v[92:93], v233 offset:20480
    v_mfma_f32_16x16x32_bf16 v[28:31], v[48:51], v[96:99], v[28:31]
    ds_read_b64_tr_b16 v[94:95], v237 offset:20480
    s_waitcnt vmcnt(0) lgkmcnt(8)
    v_mfma_f32_16x16x32_bf16 v[16:19], v[64:67], v[128:131], v[16:19]
    ds_read_b32 v223, v10 offset:40
    ds_read_b64_tr_b16 v[48:49], v234 offset:8192
    v_mfma_f32_16x16x32_bf16 v[16:19], v[68:71], v[132:135], v[16:19]
    ds_read_b64_tr_b16 v[50:51], v238 offset:8192
    v_mfma_f32_16x16x32_bf16 v[16:19], v[72:75], v[136:139], v[16:19]
    ds_read_b64_tr_b16 v[52:53], v234 offset:12288
    v_mfma_f32_16x16x32_bf16 v[16:19], v[76:79], v[140:143], v[16:19]
    ds_read_b64_tr_b16 v[54:55], v238 offset:12288
    v_mfma_f32_16x16x32_bf16 v[32:35], v[76:79], v[156:159], v[32:35]
    ds_read_b64_tr_b16 v[56:57], v234 offset:16384
    v_mfma_f32_16x16x32_bf16 v[32:35], v[72:75], v[152:155], v[32:35]
    ds_read_b64_tr_b16 v[58:59], v238 offset:16384
    v_mfma_f32_16x16x32_bf16 v[32:35], v[68:71], v[148:151], v[32:35]
    ds_read_b64_tr_b16 v[60:61], v234 offset:20480
    v_mfma_f32_16x16x32_bf16 v[32:35], v[64:67], v[144:147], v[32:35]
    ds_read_b64_tr_b16 v[62:63], v238 offset:20480
    s_waitcnt lgkmcnt(9)
    v_mfma_f32_16x16x32_bf16 v[36:39], v[80:83], v[144:147], v[36:39]
    ds_read_b64_tr_b16 v[64:65], v235 offset:8192
    v_mfma_f32_16x16x32_bf16 v[36:39], v[84:87], v[148:151], v[36:39]
    ds_read_b64_tr_b16 v[66:67], v239 offset:8192
    v_mfma_f32_16x16x32_bf16 v[36:39], v[88:91], v[152:155], v[36:39]
    ds_read_b64_tr_b16 v[68:69], v235 offset:12288
    v_mfma_f32_16x16x32_bf16 v[36:39], v[92:95], v[156:159], v[36:39]
    ds_read_b64_tr_b16 v[70:71], v239 offset:12288
    v_mfma_f32_16x16x32_bf16 v[20:23], v[92:95], v[140:143], v[20:23]
    ds_read_b64_tr_b16 v[72:73], v235 offset:16384
    v_mfma_f32_16x16x32_bf16 v[20:23], v[88:91], v[136:139], v[20:23]
    ds_read_b64_tr_b16 v[74:75], v239 offset:16384
    v_mfma_f32_16x16x32_bf16 v[20:23], v[84:87], v[132:135], v[20:23]
    ds_read_b64_tr_b16 v[76:77], v235 offset:20480
    v_mfma_f32_16x16x32_bf16 v[20:23], v[80:83], v[128:131], v[20:23]
    ds_read_b64_tr_b16 v[78:79], v239 offset:20480
    s_waitcnt lgkmcnt(14)
    v_cmp_gt_u32 vcc, 4, v223
    s_cbranch_vccnz LB_w7
LB_g7:
    v_mfma_f32_16x16x32_bf16 v[24:27], v[48:51], v[128:131], v[24:27]
    s_nop 1
    v_cvt_pk_bf16_f32 v200, v32, v33
    s_waitcnt lgkmcnt(12)
    v_mfma_f32_16x16x32_bf16 v[24:27], v[52:55], v[132:135], v[24:27]
    v_cvt_pk_bf16_f32 v201, v34, v35
    v_cvt_pk_bf16_f32 v202, v36, v37
    s_waitcnt lgkmcnt(10)
    v_mfma_f32_16x16x32_bf16 v[24:27], v[56:59], v[136:139], v[24:27]
    v_cvt_pk_bf16_f32 v203, v38, v39
    v_permlane16_swap_b32 v200, v202
    s_waitcnt lgkmcnt(8)
    v_mfma_f32_16x16x32_bf16 v[24:27], v[60:63], v[140:143], v[24:27]
    v_permlane16_swap_b32 v201, v203
    ds_write_b128 v248, v[200:203] offset:2048
    v_mfma_f32_16x16x32_bf16 v[40:43], v[60:63], v[156:159], v[40:43]
    v_cvt_pk_bf16_f32 v192, v16, v17
    v_cvt_pk_bf16_f32 v193, v18, v19
    v_mfma_f32_16x16x32_bf16 v[40:43], v[56:59], v[152:155], v[40:43]
    v_cvt_pk_bf16_f32 v194, v20, v21
    v_cvt_pk_bf16_f32 v195, v22, v23
    v_mfma_f32_16x16x32_bf16 v[40:43], v[52:55], v[148:151], v[40:43]
    v_permlane16_swap_b32 v192, v194
    v_permlane16_swap_b32 v193, v195
    v_mfma_f32_16x16x32_bf16 v[40:43], v[48:51], v[144:147], v[40:43]
    ds_write_b128 v248, v[192:195] offset:0
    v_cvt_pk_bf16_f32 v196, v24, v25
    s_waitcnt lgkmcnt(8)
    v_mfma_f32_16x16x32_bf16 v[44:47], v[64:67], v[144:147], v[44:47]
    v_cvt_pk_bf16_f32 v197, v26, v27
    s_nop 0
    s_waitcnt lgkmcnt(6)
    v_mfma_f32_16x16x32_bf16 v[44:47], v[68:71], v[148:151], v[44:47]
    s_nop 1
    s_waitcnt lgkmcnt(4)
    v_mfma_f32_16x16x32_bf16 v[44:47], v[72:75], v[152:155], v[44:47]
    v_cvt_pk_bf16_f32 v204, v40, v41
    v_cvt_pk_bf16_f32 v205, v42, v43
    s_waitcnt lgkmcnt(2)
    v_mfma_f32_16x16x32_bf16 v[44:47], v[76:79], v[156:159], v[44:47]
    s_nop 1
    v_mfma_f32_16x16x32_bf16 v[28:31], v[76:79], v[140:143], v[28:31]
    s_nop 1
    v_mfma_f32_16x16x32_bf16 v[28:31], v[72:75], v[136:139], v[28:31]
    s_nop 1
    v_mfma_f32_16x16x32_bf16 v[28:31], v[68:71], v[132:135], v[28:31]
    v_cvt_pk_bf16_f32 v206, v44, v45
    v_cvt_pk_bf16_f32 v207, v46, v47
    v_mfma_f32_16x16x32_bf16 v[28:31], v[64:67], v[128:131], v[28:31]
    v_permlane16_swap_b32 v204, v206
    v_permlane16_swap_b32 v205, v207
    ds_write_b128 v249, v[204:207] offset:2048
    ds_read_b128 v[184:187], v250 offset:2048
    ds_read_b128 v[188:191], v250 offset:3072
    s_nop 2
    v_cvt_pk_bf16_f32 v198, v28, v29
    v_cvt_pk_bf16_f32 v199, v30, v31
    s_nop 0
    v_permlane16_swap_b32 v196, v198
    v_permlane16_swap_b32 v197, v199
    ds_write_b128 v249, v[196:199] offset:0
    ds_read_b128 v[176:179], v250 offset:0
    ds_read_b128 v[180:183], v250 offset:1024
    s_mov_b32 s95, 65536
    s_waitcnt lgkmcnt(4)
    buffer_store_dwordx4 v[184:187], v246, s[60:63], s95 offen nt sc1
    s_mov_b32 s95, 98304
    s_waitcnt lgkmcnt(3)
    buffer_store_dwordx4 v[188:191], v246, s[60:63], s95 offen nt sc1
    s_mov_b32 s95, 0
    s_waitcnt lgkmcnt(1)
    buffer_store_dwordx4 v[176:179], v246, s[60:63], s95 offen nt sc1
    s_mov_b32 s95, 32768
    s_waitcnt lgkmcnt(0)
    buffer_store_dwordx4 v[180:183], v246, s[60:63], s95 offen nt sc1
    s_endpgm
LA_slow:
    s_mov_b32 s79, 0
LA_slow1:
    s_mov_b64 exec, vcc
    s_sleep 8
    buffer_load_dword v136, v33, s[68:71], 0 offen sc1
    buffer_load_dword v137, v34, s[52:55], 0 offen sc1
    s_add_u32 s79, s79, 1
    s_cmp_gt_u32 s79, 200000
    s_waitcnt vmcnt(0)
    s_cbranch_scc1 LA_back
    v_cmp_ne_u32 vcc, v136, v137
    v_cmp_gt_u32 s[80:81], s96, v136
    s_nop 0
    s_or_b64 vcc, vcc, s[80:81]
    s_cbranch_vccnz LA_slow1
    s_branch LA_back
LB_tag:
    s_mov_b64 exec, 0xffff
    s_waitcnt vmcnt(0)
    v_lshrrev_b32 v251, v0, v251
    v_and_b32 v251, 1, v251
    v_cmp_eq_u32 vcc, 0, v251
    s_nop 1
    s_or_b32 s83, vcc_lo, 0x10000
    s_mov_b64 exec, 1
    v_mov_b32 v251, s83
    buffer_store_dword v251, v220, s[68:71], s98 offen sc1
    s_mov_b64 exec, -1
    s_branch LB_tagb
LB_slow:
    s_mov_b32 s79, 0
LB_pt:
    buffer_load_dword v222, v220, s[68:71], s98 offen sc1
    s_add_u32 s79, s79, 1
    s_cmp_gt_u32 s79, 200000
    s_cbranch_scc1 LB_pt_x
    s_waitcnt vmcnt(0)
    v_cmp_gt_u32 vcc, 4096, v222
    s_cbranch_vccz LB_pt_x
    s_mov_b64 exec, vcc
    s_sleep 8
    s_branch LB_pt
LB_pt_x:
    s_waitcnt vmcnt(0)
    s_branch LB_back
LB_w1:
    s_branch LB_s1_in
LB_s1:
    s_sleep 1
LB_s1_in:
    ds_read_b32 v223, v10 offset:0
    ds_read_b64 v[204:205], v218
    ds_read_b64 v[206:207], v219
    s_waitcnt lgkmcnt(0)
    v_readfirstlane_b32 s78, v223
    s_nop 0
    s_cmp_ge_u32 s78, 4
    s_cbranch_scc0 LB_s1
    s_branch LB_g1
LB_w6:
    s_branch LB_s6_in
LB_s6:
    s_sleep 1
LB_s6_in:
    ds_read_b32 v223, v10 offset:24
    ds_read_b64 v[224:225], v218 offset:1024
    ds_read_b64 v[234:235], v219 offset:1024
    s_waitcnt lgkmcnt(0)
    v_readfirstlane_b32 s78, v223
    s_nop 0
    s_cmp_ge_u32 s78, 4
    s_cbranch_scc0 LB_s6
    s_branch LB_g6
LB_w4:
    s_branch LB_s4_in
LB_s4:
    s_sleep 1
LB_s4_in:
    ds_read_b32 v222, v10 offset:16
    s_waitcnt lgkmcnt(0)
    v_readfirstlane_b32 s78, v222
    s_nop 0
    s_cmp_ge_u32 s78, 4
    s_cbranch_scc0 LB_s4
    s_branch LB_g4
LB_w8:
    s_branch LB_s8_in
LB_s8:
    s_sleep 1
LB_s8_in:
    ds_read_b32 v223, v10 offset:32
    s_waitcnt lgkmcnt(0)
    v_readfirstlane_b32 s78, v223
    s_nop 0
    s_cmp_ge_u32 s78, 4
    s_cbranch_scc0 LB_s8
    s_branch LB_g8
LB_w7:
    s_branch LB_s7_in
LB_s7:
    s_sleep 1
LB_s7_in:
    ds_read_b32 v223, v10 offset:40
    s_waitcnt lgkmcnt(0)
    v_readfirstlane_b32 s78, v223
    s_nop 0
    s_cmp_ge_u32 s78, 4
    s_cbranch_scc0 LB_s7
    s_branch LB_g7
L_end:
    s_endpgm
.section .rodata,"a"
.p2align 6
.amdhsa_kernel concat_heads__ssm_conv_h3__sliding_local_dilated__prompt_kernel
  .amdhsa_next_free_vgpr 256
  .amdhsa_next_free_sgpr 102
  .amdhsa_accum_offset 256
  .amdhsa_group_segment_fixed_size 0
  .amdhsa_kernarg_size 96
  .amdhsa_user_sgpr_count 2
  .amdhsa_user_sgpr_kernarg_segment_ptr 1
  .amdhsa_system_sgpr_workgroup_id_x 1
.end_amdhsa_kernel
```

```asm
; @launch grid=(256,1,1) block=(512,1,1) lds=163840
.amdgcn_target "amdgcn-amd-amdhsa--gfx950"
.text
.globl concat_heads__ssm_conv_h3__sliding_local_dilated__prompt_kernel
.p2align 8
.type concat_heads__ssm_conv_h3__sliding_local_dilated__prompt_kernel,@function
concat_heads__ssm_conv_h3__sliding_local_dilated__prompt_kernel:
    s_cmp_ge_u32 s2, 256
    s_cbranch_scc1 L_end
    s_load_dwordx2 s[28:29], s[0:1], 48
    s_load_dwordx2 s[32:33], s[0:1], 56
    s_load_dwordx8 s[4:11], s[0:1], 0
    s_load_dwordx4 s[12:15], s[0:1], 32
    s_load_dwordx8 s[20:27], s[0:1], 64
    v_lshrrev_b32 v1, 6, v0
    v_and_b32 v0, 63, v0
    v_readfirstlane_b32 s3, v1
    s_nop 0
    s_cmp_lg_u32 s3, 4
    s_cbranch_scc1 L_nopf
    s_getpc_b64 s[80:81]
L_pc:
    s_bfe_u32 s78, s2, 0x40003
    v_lshl_add_u32 v1, v0, 4, s78
    v_lshlrev_b32 v1, 7, v1
    v_cmp_gt_u32 vcc, L_end-L_pc, v1
    s_nop 0
    s_and_saveexec_b64 s[82:83], vcc
    global_load_dword v222, v1, s[80:81]
    s_mov_b64 exec, -1
L_nopf:
    s_and_b32 s78, s2, 7
    s_lshr_b32 s79, s2, 3
    s_lshl_b32 s78, s78, 2
    s_lshr_b32 s78, 0x75643120, s78
    s_and_b32 s78, s78, 7
    s_and_b32 s80, s78, 1
    s_lshl_b32 s80, s80, 3
    s_lshr_b32 s81, s78, 1
    s_lshl_b32 s81, s81, 2
    s_and_b32 s72, s79, 7
    s_add_u32 s72, s72, s80
    s_lshr_b32 s73, s79, 3
    s_xor_b32 s73, s73, 3
    s_add_u32 s73, s73, s81
    s_cmp_ge_u32 s3, 4
    s_cbranch_scc1 L_B
    v_lshrrev_b32 v5, 3, v0
    v_and_b32 v6, 7, v0
    v_lshrrev_b32 v7, 4, v0
    s_lshl_b32 s79, s72, 7
    s_lshl_b32 s80, s3, 5
    s_add_u32 s81, s79, s80
    v_xor_b32 v8, v7, v6
    v_lshlrev_b32 v8, 4, v8
    v_add_u32 v240, s81, v5
    v_lshl_add_u32 v240, v240, 11, v8
    v_xor_b32 v241, 64, v240
    v_add_u32 v241, 15360, v241
    v_add_u32 v242, 30720, v240
    v_add_u32 v243, 30720, v241
    s_lshl_b32 s87, s3, 12
    s_add_u32 s87, s87, 75776
    s_and_b32 s98, s73, 12
    s_and_b32 s78, s72, 8
    s_add_u32 s98, s98, s78
    s_add_u32 s101, s72, s73
    s_and_b32 s101, s101, 3
    s_lshl_b32 s78, s101, 2
    s_lshr_b32 s97, 0x101, s78
    s_add_u32 s97, s97, s98
    s_and_b32 s97, s97, 15
    s_mov_b32 m0, s87
    s_lshl_b32 s97, s97, 7
    s_mov_b32 s30, 0x400000
    s_mov_b32 s31, 0x20000
    s_waitcnt lgkmcnt(0)
    buffer_load_dwordx4 v240, s[28:31], s97 offen offset:0 lds
    s_and_b32 s78, s3, 1
    s_lshl_b32 s78, s78, 2
    s_lshl_b32 s80, s3, 3
    v_and_b32 v8, 1, v7
    v_lshl_or_b32 v8, v8, 1, s78
    v_xor_b32 v8, v8, v6
    buffer_load_dwordx4 v241, s[28:31], s97 offen offset:1024 lds
    v_lshlrev_b32 v8, 4, v8
    v_add_u32 v244, s80, v5
    v_mul_u32_u24 v244, 6144, v244
    s_lshl_b32 s82, s73, 7
    v_add3_u32 v244, v244, v8, s82
    buffer_load_dwordx4 v242, s[28:31], s97 offen offset:2048 lds
    v_add_u32 v245, 1024, v244
    v_add_u32 v246, 2048, v244
    s_bfe_u32 s62, s72, 0x10002
    s_mul_i32 s78, s62, 12288
    s_mul_i32 s80, s3, 3072
    s_add_u32 s60, s80, s78
    buffer_load_dwordx4 v243, s[28:31], s97 offen offset:3072 lds
    s_sub_u32 s61, s80, s78
    s_mul_i32 s62, s62, 196608
    s_sub_u32 s63, 196608, s62
    s_mov_b32 s34, 0x600000
    s_mov_b32 s35, 0x20000
    s_mul_i32 s16, s97, 3072
    s_add_u32 m0, s60, 0
    s_add_u32 s99, s16, s62
    buffer_load_dwordx4 v244, s[32:35], s99 offen offset:0 lds
    buffer_load_dwordx4 v245, s[32:35], s99 offen offset:1024 lds
    buffer_load_dwordx4 v246, s[32:35], s99 offen offset:2048 lds
    s_add_u32 m0, s61, 12288
    s_add_u32 s16, s16, s63
    buffer_load_dwordx4 v244, s[32:35], s16 offen offset:0 lds
    buffer_load_dwordx4 v245, s[32:35], s16 offen offset:1024 lds
    buffer_load_dwordx4 v246, s[32:35], s16 offen offset:2048 lds
    s_lshl_b32 s86, s3, 10
    s_mov_b32 s0, 0x76583240
    s_mov_b32 s1, 0xfedba9c
    s_cmp_eq_u32 s101, 1
    s_cselect_b32 s0, 0x76943251, s0
    s_cselect_b32 s1, 0xfecbda8, s1
    s_cmp_eq_u32 s101, 2
    s_cselect_b32 s0, 0x7a543602, s0
    s_cselect_b32 s1, 0xfdceb98, s1
    s_cmp_eq_u32 s101, 3
    s_cselect_b32 s0, 0xb6547213, s0
    s_cselect_b32 s1, 0xedfca98, s1
    s_and_b32 s78, s73, 7
    s_cmp_lg_u32 s78, 3
    s_cbranch_scc1 LA_nb
    s_cmp_eq_u32 s101, 2
    s_cselect_b32 s0, 0x87654302, s0
    s_cselect_b32 s1, 0xfdceba9, s1
    s_cmp_eq_u32 s101, 3
    s_cselect_b32 s0, 0x87654213, s0
    s_cselect_b32 s1, 0xedfcba9, s1
LA_nb:
    s_add_u32 s79, s72, s73
    s_add_u32 s78, s72, 5
    s_and_b32 s78, s78, 7
    s_lshl_b32 s78, s78, 1
    s_and_b32 s75, s79, 1
    s_add_u32 s78, s78, s75
    s_andn2_b32 s79, 2, s79
    s_lshl_b32 s79, s79, 3
    s_add_u32 s78, s78, s79
    s_and_b32 s76, s78, 3
    s_and_b32 s79, s73, 12
    s_add_u32 s76, s76, s79
    s_lshr_b32 s74, s78, 4
    s_add_u32 s74, s74, s79
    s_and_b32 s79, s72, 8
    s_lshr_b32 s77, s78, 2
    s_add_u32 s77, s77, s79
    s_lshr_b32 s79, s79, 2
    s_add_u32 s74, s74, s79
    s_xor_b32 s74, s74, 6
    s_and_b32 s75, s78, 15
    s_add_u32 s97, s98, s0
    s_lshr_b64 s[0:1], s[0:1], 4
    s_and_b32 s97, s97, 15
    s_add_u32 m0, s87, 18432
    s_lshl_b32 s97, s97, 7
    buffer_load_dwordx4 v240, s[28:31], s97 offen offset:0 lds
    s_mov_b32 s36, s6
    s_mov_b32 s37, s7
    s_mov_b32 s38, 0x400000
    s_mov_b32 s39, 0x20000
    s_mov_b32 s40, s8
    s_mov_b32 s41, s9
    s_mov_b32 s42, 0x400000
    s_mov_b32 s43, 0x20000
    s_mov_b32 s44, s10
    s_mov_b32 s45, s11
    s_mov_b32 s46, 0x2000
    s_mov_b32 s47, 0x20000
    s_mov_b32 s52, s26
    s_mov_b32 s53, s27
    s_mov_b32 s54, 0x1000000
    s_mov_b32 s55, 0x20000
    v_lshlrev_b32 v15, 4, v0
    v_and_b32 v7, 7, v0
    s_lshl_b32 s79, s74, 7
    v_lshl_add_u32 v7, v7, 4, s79
    s_lshl_b32 s78, s75, 7
    s_lshl_b32 s80, s3, 3
    s_add_u32 s80, s80, s78
    v_lshrrev_b32 v5, 3, v0
    s_and_b32 s79, s3, 1
    v_xor_b32 v5, s79, v5
    v_add_u32 v5, s80, v5
    v_lshl_add_u32 v10, v5, 11, v7
    s_xor_b32 s80, s3, 1
    s_add_u32 s80, s78, s80
    s_sub_u32 s80, s80, 4
    s_lshl_b32 s80, s80, 11
    v_add_u32 v11, s80, v7
    v_bfe_u32 v5, v0, 3, 2
    v_lshrrev_b32 v6, 5, v0
    s_lshl_b32 s80, s3, 5
    v_lshlrev_b32 v8, 3, v5
    v_lshl_add_u32 v8, v6, 2, v8
    v_add_u32 v8, s80, v8
    v_and_b32 v14, 7, v0
    v_lshl_add_u32 v16, v14, 1, v6
    v_lshlrev_b32 v232, 5, v16
    v_lshlrev_b32 v16, 3, v16
    v_lshl_add_u32 v16, v5, 10, v16
    v_and_b32 v231, 1, v5
    v_lshl_add_u32 v16, v231, 7, v16
    s_lshl_b32 s79, s3, 12
    s_add_u32 s79, s79, 129024
    v_add_u32 v16, s79, v16
    v_xor_b32 v231, 128, v16
    v_lshrrev_b32 v14, 2, v14
    v_lshl_add_u32 v14, v14, 4, v232
    v_add_u32 v14, 162816, v14
    v_add_u32 v8, s78, v8
    v_lshl_add_u32 v9, v8, 11, v7
    v_lshl_add_u32 v13, v8, 12, v7
    v_bfe_u32 v8, v0, 2, 1
    v_lshlrev_b32 v8, 1, v8
    v_add_u32 v8, v8, v6
    v_lshlrev_b32 v8, 16, v8
    v_lshl_add_u32 v8, v5, 6, v8
    v_and_b32 v7, 3, v0
    v_lshl_add_u32 v8, v7, 4, v8
    s_add_u32 s78, s78, s80
    s_lshl_b32 s78, s78, 3
    s_lshl_b32 s79, s74, 18
    s_add_u32 s78, s78, s79
    v_add_u32 v12, s78, v8
    s_mov_b32 s48, s12
    s_mov_b32 s49, s13
    s_mov_b32 s50, 0x400000
    s_mov_b32 s51, 0x20000
    s_mov_b32 s56, s4
    s_mov_b32 s57, s5
    s_mov_b32 s58, 0x400000
    s_mov_b32 s59, 0x20000
    s_mov_b32 s64, s20
    s_mov_b32 s65, s21
    s_mov_b32 s66, 0x200000
    s_mov_b32 s67, 0x20000
    s_lshl_b32 s91, s74, 4
    s_add_u32 s91, s91, s75
    s_lshr_b32 s78, s91, 3
    s_lshl_b32 s78, s78, 5
    s_and_b32 s79, s91, 7
    s_add_u32 s78, s78, s79
    s_lshl_b32 s79, s3, 3
    s_add_u32 s90, s78, s79
    s_lshl_b32 s91, s91, 14
    s_mov_b32 s96, 4096
    s_mul_i32 s94, s3, 8320
    s_add_u32 s94, s94, 129024
    v_mov_b32 v228, 0x40000000
    v_mov_b32 v229, 0x40000000
    s_and_b32 s78, s73, 7
    s_cmp_ge_u32 s78, 3
    s_cbranch_scc1 LA_nh
    s_and_b32 s79, s101, 2
    s_add_u32 s78, s72, 1
    s_add_u32 s78, s78, s79
    s_and_b32 s78, s78, 3
    s_bfe_u32 s80, s72, 0x10002
    s_and_b32 s81, s101, 1
    s_lshl_b32 s81, s81, 2
    s_add_u32 s81, s81, s79
    s_lshl_b32 s82, s78, 1
    s_cmp_lt_u32 s78, 2
    s_cselect_b32 s79, 12, 24
    s_cselect_b32 s82, s82, 0
    s_cselect_b32 s83, 6, 7
    s_add_u32 s81, s81, s83
    s_add_u32 s80, s80, s82
    s_lshl_b32 s80, s80, 2
    s_add_u32 s80, s80, s3
    s_mul_i32 s80, s80, s79
    s_add_u32 s82, s81, s78
    s_add_u32 s81, s81, s98
    s_and_b32 s81, s81, 15
    s_mul_i32 s81, s81, 192
    s_add_u32 s80, s80, s81
    s_or_b32 s81, s73, 3
    s_lshl_b32 s81, s81, 7
    v_add_u32 v5, s80, v0
    v_lshl_add_u32 v5, v5, 11, s81
    v_cmp_gt_u32 vcc, s79, v0
    s_nop 1
    v_cndmask_b32 v228, v228, v5, vcc
    s_cmp_ge_u32 s78, 2
    s_cbranch_scc1 LA_nh
    s_add_u32 s82, s82, s98
    s_and_b32 s82, s82, 15
    s_lshl_b32 s78, s82, 7
    s_lshl_b32 s79, s72, 7
    s_lshl_b32 s80, s3, 5
    s_add_u32 s79, s79, s80
    v_add_u32 v5, s79, v0
    v_lshl_add_u32 v5, v5, 11, s78
    v_cmp_gt_u32 vcc, 32, v0
    s_nop 1
    v_cndmask_b32 v229, v229, v5, vcc
LA_nh:
    buffer_load_dwordx4 v241, s[28:31], s97 offen offset:1024 lds
    buffer_load_dwordx4 v242, s[28:31], s97 offen offset:2048 lds
    buffer_load_dwordx4 v243, s[28:31], s97 offen offset:3072 lds
    s_mul_i32 s16, s97, 3072
    s_add_u32 m0, s60, 24576
    s_add_u32 s99, s16, s62
    buffer_load_dwordx4 v244, s[32:35], s99 offen offset:0 lds
    buffer_load_dwordx4 v245, s[32:35], s99 offen offset:1024 lds
    buffer_load_dwordx4 v246, s[32:35], s99 offen offset:2048 lds
    s_add_u32 m0, s61, 36864
    s_add_u32 s16, s16, s63
    buffer_load_dwordx4 v244, s[32:35], s16 offen offset:0 lds
    s_waitcnt vmcnt(8)
    s_barrier
    buffer_load_dwordx4 v245, s[32:35], s16 offen offset:1024 lds
    buffer_load_dwordx4 v246, s[32:35], s16 offen offset:2048 lds
    s_add_u32 s97, s98, s0
    s_lshr_b64 s[0:1], s[0:1], 4
    s_and_b32 s97, s97, 15
    s_add_u32 m0, s87, 36864
    s_lshl_b32 s97, s97, 7
    buffer_load_dwordx4 v240, s[28:31], s97 offen offset:0 lds
    buffer_load_dwordx4 v241, s[28:31], s97 offen offset:1024 lds
    buffer_load_dwordx4 v242, s[28:31], s97 offen offset:2048 lds
    buffer_load_dwordx4 v243, s[28:31], s97 offen offset:3072 lds
    s_cmp_eq_u32 s101, 1
    s_cbranch_scc1 LA_c1
    s_cmp_eq_u32 s101, 2
    s_cbranch_scc1 LA_c2
    s_cmp_eq_u32 s101, 3
    s_cbranch_scc1 LA_c3
LA_c0:
    s_waitcnt vmcnt(10)
    s_barrier
    s_mul_i32 s16, s97, 3072
    s_add_u32 m0, s60, 49152
    s_add_u32 s99, s16, s62
    buffer_load_dwordx4 v244, s[32:35], s99 offen offset:0 lds
    buffer_load_dwordx4 v245, s[32:35], s99 offen offset:1024 lds
    buffer_load_dwordx4 v246, s[32:35], s99 offen offset:2048 lds
    s_add_u32 m0, s61, 61440
    s_add_u32 s16, s16, s63
    buffer_load_dwordx4 v244, s[32:35], s16 offen offset:0 lds
    buffer_load_dwordx4 v245, s[32:35], s16 offen offset:1024 lds
    buffer_load_dwordx4 v246, s[32:35], s16 offen offset:2048 lds
    s_add_u32 s97, s98, s0
    s_lshr_b64 s[0:1], s[0:1], 4
    s_and_b32 s97, s97, 15
    s_add_u32 m0, s87, 0
    s_lshl_b32 s97, s97, 7
    buffer_load_dwordx4 v240, s[28:31], s97 offen offset:0 lds
    buffer_load_dwordx4 v241, s[28:31], s97 offen offset:1024 lds
    buffer_load_dwordx4 v242, s[28:31], s97 offen offset:2048 lds
    buffer_load_dwordx4 v243, s[28:31], s97 offen offset:3072 lds
    s_waitcnt vmcnt(10)
    s_barrier
    s_mul_i32 s16, s97, 3072
    s_add_u32 m0, s60, 0
    s_add_u32 s99, s16, s62
    buffer_load_dwordx4 v244, s[32:35], s99 offen offset:0 lds
    buffer_load_dwordx4 v245, s[32:35], s99 offen offset:1024 lds
    buffer_load_dwordx4 v246, s[32:35], s99 offen offset:2048 lds
    s_add_u32 m0, s61, 12288
    s_add_u32 s16, s16, s63
    buffer_load_dwordx4 v244, s[32:35], s16 offen offset:0 lds
    buffer_load_dwordx4 v245, s[32:35], s16 offen offset:1024 lds
    buffer_load_dwordx4 v246, s[32:35], s16 offen offset:2048 lds
    s_add_u32 m0, s86, 129536
    s_mov_b32 s89, 0
    buffer_load_dwordx4 v10, s[36:39], s89 offen nt lds
    s_add_u32 m0, s86, 145920
    s_mov_b32 s89, 0
    buffer_load_dwordx4 v10, s[40:43], s89 offen nt lds
    s_add_u32 m0, s86, 133632
    s_mov_b32 s89, 65536
    buffer_load_dwordx4 v10, s[36:39], s89 offen nt lds
    s_add_u32 m0, s86, 150016
    s_mov_b32 s89, 65536
    buffer_load_dwordx4 v10, s[40:43], s89 offen nt lds
    s_add_u32 m0, s86, 137728
    s_mov_b32 s89, 131072
    buffer_load_dwordx4 v10, s[36:39], s89 offen nt lds
    s_add_u32 m0, s86, 154112
    s_mov_b32 s89, 131072
    buffer_load_dwordx4 v10, s[40:43], s89 offen nt lds
    s_add_u32 m0, s86, 141824
    s_mov_b32 s89, 196608
    buffer_load_dwordx4 v10, s[36:39], s89 offen nt lds
    s_add_u32 m0, s86, 158208
    s_mov_b32 s89, 196608
    buffer_load_dwordx4 v10, s[40:43], s89 offen nt lds
    s_mov_b64 exec, 0xff
    s_lshl_b32 s82, s3, 7
    s_add_u32 m0, s82, 129024
    s_mov_b32 s89, 0
    buffer_load_dwordx4 v11, s[36:39], s89 offen nt lds
    s_lshl_b32 s83, s74, 9
    s_add_u32 s83, s83, s82
    s_and_b32 s89, s3, 2
    s_lshl_b32 s89, s89, 3
    s_add_u32 s82, s82, s89
    s_add_u32 m0, s82, 162816
    s_add_u32 s89, s83, 0
    buffer_load_dwordx4 v15, s[44:47], s89 offen  lds
    s_mov_b64 exec, -1
    s_add_u32 s97, s98, s0
    s_lshr_b64 s[0:1], s[0:1], 4
    s_and_b32 s97, s97, 15
    s_add_u32 m0, s87, 18432
    s_lshl_b32 s97, s97, 7
    buffer_load_dwordx4 v240, s[28:31], s97 offen offset:0 lds
    buffer_load_dwordx4 v241, s[28:31], s97 offen offset:1024 lds
    buffer_load_dwordx4 v242, s[28:31], s97 offen offset:2048 lds
    buffer_load_dwordx4 v243, s[28:31], s97 offen offset:3072 lds
    s_waitcnt vmcnt(20)
    s_barrier
    s_mul_i32 s16, s97, 3072
    s_add_u32 m0, s60, 24576
    s_add_u32 s99, s16, s62
    buffer_load_dwordx4 v244, s[32:35], s99 offen offset:0 lds
    buffer_load_dwordx4 v245, s[32:35], s99 offen offset:1024 lds
    buffer_load_dwordx4 v246, s[32:35], s99 offen offset:2048 lds
    s_add_u32 m0, s61, 36864
    s_add_u32 s16, s16, s63
    buffer_load_dwordx4 v244, s[32:35], s16 offen offset:0 lds
    buffer_load_dwordx4 v245, s[32:35], s16 offen offset:1024 lds
    buffer_load_dwordx4 v246, s[32:35], s16 offen offset:2048 lds
    buffer_load_dword v230, v229, s[28:31], 0 offen
    buffer_load_dword v230, v228, s[32:35], 0 offen
    s_add_u32 s97, s98, s0
    s_lshr_b64 s[0:1], s[0:1], 4
    s_and_b32 s97, s97, 15
    s_add_u32 m0, s87, 36864
    s_lshl_b32 s97, s97, 7
    buffer_load_dwordx4 v240, s[28:31], s97 offen offset:0 lds
    buffer_load_dwordx4 v241, s[28:31], s97 offen offset:1024 lds
    buffer_load_dwordx4 v242, s[28:31], s97 offen offset:2048 lds
    buffer_load_dwordx4 v243, s[28:31], s97 offen offset:3072 lds
    s_waitcnt vmcnt(12)
    s_barrier
    s_mul_i32 s16, s97, 3072
    s_add_u32 m0, s60, 49152
    s_add_u32 s99, s16, s62
    buffer_load_dwordx4 v244, s[32:35], s99 offen offset:0 lds
    ds_read_b128 v[84:87], v14 offset:0
    ds_read_b128 v[88:91], v14 offset:16
    ds_read_b64 v[40:41], v16 offset:0
    buffer_load_dwordx4 v245, s[32:35], s99 offen offset:1024 lds
    ds_read_b64 v[42:43], v231 offset:256
    ds_read_b64 v[44:45], v16 offset:256
    buffer_load_dwordx4 v246, s[32:35], s99 offen offset:2048 lds
    ds_read_b64 v[46:47], v16 offset:512
    ds_read_b64 v[48:49], v231 offset:512
    s_add_u32 m0, s61, 61440
    s_add_u32 s16, s16, s63
    buffer_load_dwordx4 v244, s[32:35], s16 offen offset:0 lds
    ds_read_b64 v[50:51], v16 offset:768
    ds_read_b64 v[52:53], v231 offset:768
    buffer_load_dwordx4 v245, s[32:35], s16 offen offset:1024 lds
    ds_read_b64 v[54:55], v16 offset:1024
    ds_read_b64 v[56:57], v231 offset:1024
    buffer_load_dwordx4 v246, s[32:35], s16 offen offset:2048 lds
    ds_read_b64 v[58:59], v16 offset:1280
    ds_read_b64 v[60:61], v231 offset:1280
    s_add_u32 s97, s98, s0
    s_lshr_b64 s[0:1], s[0:1], 4
    s_and_b32 s97, s97, 15
    s_add_u32 m0, s87, 0
    s_lshl_b32 s97, s97, 7
    buffer_load_dwordx4 v240, s[28:31], s97 offen offset:0 lds
    ds_read_b64 v[68:69], v16 offset:16896
    ds_read_b64 v[70:71], v231 offset:16896
    buffer_load_dwordx4 v241, s[28:31], s97 offen offset:1024 lds
    ds_read_b64 v[72:73], v16 offset:17152
    ds_read_b64 v[74:75], v231 offset:17152
    buffer_load_dwordx4 v242, s[28:31], s97 offen offset:2048 lds
    ds_read_b64 v[76:77], v16 offset:17408
    ds_read_b64 v[78:79], v231 offset:17408
    buffer_load_dwordx4 v243, s[28:31], s97 offen offset:3072 lds
    ds_read_b64 v[80:81], v16 offset:17664
    ds_read_b64 v[82:83], v231 offset:17664
    s_waitcnt vmcnt(10)
    s_waitcnt lgkmcnt(0)
    s_barrier
    s_mul_i32 s16, s97, 3072
    s_add_u32 m0, s60, 0
    s_add_u32 s99, s16, s62
    buffer_load_dwordx4 v244, s[32:35], s99 offen offset:0 lds
    v_lshlrev_b32 v160, 16, v40
    v_lshlrev_b32 v161, 16, v42
    v_lshlrev_b32 v162, 16, v44
    v_lshlrev_b32 v163, 16, v46
    v_lshlrev_b32 v164, 16, v48
    buffer_load_dwordx4 v245, s[32:35], s99 offen offset:1024 lds
    v_lshlrev_b32 v165, 16, v50
    v_lshlrev_b32 v166, 16, v52
    v_lshlrev_b32 v167, 16, v54
    v_lshlrev_b32 v168, 16, v56
    v_lshlrev_b32 v169, 16, v58
    buffer_load_dwordx4 v246, s[32:35], s99 offen offset:2048 lds
    v_lshlrev_b32 v170, 16, v60
    v_lshlrev_b32 v172, 16, v84
    v_and_b32 v173, 0xffff0000, v84
    v_lshlrev_b32 v174, 16, v85
    v_and_b32 v175, 0xffff0000, v85
    s_add_u32 m0, s61, 12288
    s_add_u32 s16, s16, s63
    buffer_load_dwordx4 v244, s[32:35], s16 offen offset:0 lds
    v_lshlrev_b32 v176, 16, v68
    v_lshlrev_b32 v177, 16, v70
    v_lshlrev_b32 v178, 16, v72
    v_lshlrev_b32 v179, 16, v74
    v_lshlrev_b32 v180, 16, v76
    buffer_load_dwordx4 v245, s[32:35], s16 offen offset:1024 lds
    v_lshlrev_b32 v181, 16, v78
    v_lshlrev_b32 v182, 16, v80
    v_lshlrev_b32 v183, 16, v82
    v_mul_f32 v184, v160, v175
    v_mul_f32 v185, v161, v175
    buffer_load_dwordx4 v246, s[32:35], s16 offen offset:2048 lds
    v_mul_f32 v186, v162, v175
    v_mul_f32 v187, v163, v175
    v_mul_f32 v188, v164, v175
    v_mul_f32 v189, v165, v175
    v_mul_f32 v190, v166, v175
    s_lshl_b32 s88, s72, 1
    s_lshr_b32 s89, s3, 1
    s_add_u32 s88, s88, s89
    s_lshl_b32 s88, s88, 4
    s_add_u32 s88, s88, s73
    s_lshl_b32 s88, s88, 1
    s_and_b32 s89, s3, 1
    s_add_u32 s88, s88, s89
    s_lshl_b32 s88, s88, 11
    s_add_u32 s88, s88, 14680064
    v_mov_b32 v192, -1
    v_mov_b32 v193, -1
    v_mov_b32 v194, -1
    v_mov_b32 v195, -1
    buffer_store_dwordx4 v[192:195], v15, s[52:55], s88 offen offset:0 sc1
    v_mul_f32 v191, v167, v175
    v_fmac_f32 v184, v161, v174
    v_fmac_f32 v185, v162, v174
    v_fmac_f32 v186, v163, v174
    v_fmac_f32 v187, v164, v174
    buffer_store_dwordx4 v[192:195], v15, s[52:55], s88 offen offset:1024 sc1
    v_fmac_f32 v188, v165, v174
    v_fmac_f32 v189, v166, v174
    v_fmac_f32 v190, v167, v174
    v_fmac_f32 v191, v168, v174
    v_fmac_f32 v184, v162, v173
    s_add_u32 s97, s98, s0
    s_lshr_b64 s[0:1], s[0:1], 4
    s_and_b32 s97, s97, 15
    s_add_u32 m0, s87, 18432
    s_lshl_b32 s97, s97, 7
    buffer_load_dwordx4 v240, s[28:31], s97 offen offset:0 lds
    v_fmac_f32 v185, v163, v173
    v_fmac_f32 v186, v164, v173
    v_fmac_f32 v187, v165, v173
    v_fmac_f32 v188, v166, v173
    v_fmac_f32 v189, v167, v173
    buffer_load_dwordx4 v241, s[28:31], s97 offen offset:1024 lds
    v_fmac_f32 v190, v168, v173
    v_fmac_f32 v191, v169, v173
    v_fmac_f32 v184, v163, v172
    v_fmac_f32 v185, v164, v172
    v_fmac_f32 v186, v165, v172
    buffer_load_dwordx4 v242, s[28:31], s97 offen offset:2048 lds
    v_fmac_f32 v187, v166, v172
    v_fmac_f32 v188, v167, v172
    v_fmac_f32 v189, v168, v172
    v_fmac_f32 v190, v169, v172
    v_fmac_f32 v191, v170, v172
    buffer_load_dwordx4 v243, s[28:31], s97 offen offset:3072 lds
    v_mul_f32 v184, v184, v176
    v_mul_f32 v185, v185, v177
    v_mul_f32 v186, v186, v178
    v_mul_f32 v187, v187, v179
    v_mul_f32 v188, v188, v180
    v_mul_f32 v189, v189, v181
    v_mul_f32 v190, v190, v182
    v_mul_f32 v191, v191, v183
    v_cvt_pk_bf16_f32 v100, v191, v190
    v_cvt_pk_bf16_f32 v101, v189, v188
    v_cvt_pk_bf16_f32 v102, v187, v186
    v_cvt_pk_bf16_f32 v103, v185, v184
    s_mov_b32 s89, 0
    buffer_store_dwordx4 v[100:103], v12, s[52:55], s89 offen sc1
    v_and_b32 v160, 0xffff0000, v40
    v_and_b32 v161, 0xffff0000, v42
    v_and_b32 v162, 0xffff0000, v44
    v_and_b32 v163, 0xffff0000, v46
    v_and_b32 v164, 0xffff0000, v48
    v_and_b32 v165, 0xffff0000, v50
    v_and_b32 v166, 0xffff0000, v52
    v_and_b32 v167, 0xffff0000, v54
    v_and_b32 v168, 0xffff0000, v56
    v_and_b32 v169, 0xffff0000, v58
    v_and_b32 v170, 0xffff0000, v60
    v_lshlrev_b32 v172, 16, v86
    v_and_b32 v173, 0xffff0000, v86
    v_lshlrev_b32 v174, 16, v87
    v_and_b32 v175, 0xffff0000, v87
    v_and_b32 v176, 0xffff0000, v68
    v_and_b32 v177, 0xffff0000, v70
    v_and_b32 v178, 0xffff0000, v72
    v_and_b32 v179, 0xffff0000, v74
    v_and_b32 v180, 0xffff0000, v76
    v_and_b32 v181, 0xffff0000, v78
    v_and_b32 v182, 0xffff0000, v80
    v_and_b32 v183, 0xffff0000, v82
    s_waitcnt vmcnt(13)
    s_barrier
    s_mul_i32 s16, s97, 3072
    s_add_u32 m0, s60, 24576
    s_add_u32 s99, s16, s62
    buffer_load_dwordx4 v244, s[32:35], s99 offen offset:0 lds
    v_mul_f32 v184, v160, v175
    v_mul_f32 v185, v161, v175
    v_mul_f32 v186, v162, v175
    v_mul_f32 v187, v163, v175
    v_mul_f32 v188, v164, v175
    buffer_load_dwordx4 v245, s[32:35], s99 offen offset:1024 lds
    v_mul_f32 v189, v165, v175
    v_mul_f32 v190, v166, v175
    v_mul_f32 v191, v167, v175
    v_fmac_f32 v184, v161, v174
    v_fmac_f32 v185, v162, v174
    buffer_load_dwordx4 v246, s[32:35], s99 offen offset:2048 lds
    v_fmac_f32 v186, v163, v174
    v_fmac_f32 v187, v164, v174
    v_fmac_f32 v188, v165, v174
    v_fmac_f32 v189, v166, v174
    v_fmac_f32 v190, v167, v174
    s_add_u32 m0, s61, 36864
    s_add_u32 s16, s16, s63
    buffer_load_dwordx4 v244, s[32:35], s16 offen offset:0 lds
    v_fmac_f32 v191, v168, v174
    v_fmac_f32 v184, v162, v173
    v_fmac_f32 v185, v163, v173
    v_fmac_f32 v186, v164, v173
    v_fmac_f32 v187, v165, v173
    buffer_load_dwordx4 v245, s[32:35], s16 offen offset:1024 lds
    v_fmac_f32 v188, v166, v173
    v_fmac_f32 v189, v167, v173
    v_fmac_f32 v190, v168, v173
    v_fmac_f32 v191, v169, v173
    v_fmac_f32 v184, v163, v172
    buffer_load_dwordx4 v246, s[32:35], s16 offen offset:2048 lds
    v_fmac_f32 v185, v164, v172
    v_fmac_f32 v186, v165, v172
    v_fmac_f32 v187, v166, v172
    v_fmac_f32 v188, v167, v172
    v_fmac_f32 v189, v168, v172
    s_add_u32 s97, s98, s0
    s_lshr_b64 s[0:1], s[0:1], 4
    s_and_b32 s97, s97, 15
    s_add_u32 m0, s87, 36864
    s_lshl_b32 s97, s97, 7
    buffer_load_dwordx4 v240, s[28:31], s97 offen offset:0 lds
    v_fmac_f32 v190, v169, v172
    v_fmac_f32 v191, v170, v172
    v_mul_f32 v184, v184, v176
    v_mul_f32 v185, v185, v177
    v_mul_f32 v186, v186, v178
    buffer_load_dwordx4 v241, s[28:31], s97 offen offset:1024 lds
    v_mul_f32 v187, v187, v179
    v_mul_f32 v188, v188, v180
    v_mul_f32 v189, v189, v181
    v_mul_f32 v190, v190, v182
    v_mul_f32 v191, v191, v183
    buffer_load_dwordx4 v242, s[28:31], s97 offen offset:2048 lds
    v_cvt_pk_bf16_f32 v104, v191, v190
    v_cvt_pk_bf16_f32 v105, v189, v188
    v_cvt_pk_bf16_f32 v106, v187, v186
    v_cvt_pk_bf16_f32 v107, v185, v184
    s_mov_b32 s89, 16384
    buffer_store_dwordx4 v[104:107], v12, s[52:55], s89 offen sc1
    buffer_load_dwordx4 v243, s[28:31], s97 offen offset:3072 lds
    v_lshlrev_b32 v160, 16, v41
    v_lshlrev_b32 v161, 16, v43
    v_lshlrev_b32 v162, 16, v45
    v_lshlrev_b32 v163, 16, v47
    v_lshlrev_b32 v164, 16, v49
    v_lshlrev_b32 v165, 16, v51
    v_lshlrev_b32 v166, 16, v53
    v_lshlrev_b32 v167, 16, v55
    v_lshlrev_b32 v168, 16, v57
    v_lshlrev_b32 v169, 16, v59
    v_lshlrev_b32 v170, 16, v61
    v_lshlrev_b32 v172, 16, v88
    v_and_b32 v173, 0xffff0000, v88
    v_lshlrev_b32 v174, 16, v89
    v_and_b32 v175, 0xffff0000, v89
    v_lshlrev_b32 v176, 16, v69
    v_lshlrev_b32 v177, 16, v71
    v_lshlrev_b32 v178, 16, v73
    v_lshlrev_b32 v179, 16, v75
    v_lshlrev_b32 v180, 16, v77
    v_lshlrev_b32 v181, 16, v79
    v_lshlrev_b32 v182, 16, v81
    v_lshlrev_b32 v183, 16, v83
    v_mul_f32 v184, v160, v175
    v_mul_f32 v185, v161, v175
    v_mul_f32 v186, v162, v175
    v_mul_f32 v187, v163, v175
    v_mul_f32 v188, v164, v175
    v_mul_f32 v189, v165, v175
    v_mul_f32 v190, v166, v175
    v_mul_f32 v191, v167, v175
    v_fmac_f32 v184, v161, v174
    v_fmac_f32 v185, v162, v174
    v_fmac_f32 v186, v163, v174
    v_fmac_f32 v187, v164, v174
    v_fmac_f32 v188, v165, v174
    v_fmac_f32 v189, v166, v174
    v_fmac_f32 v190, v167, v174
    v_fmac_f32 v191, v168, v174
    v_fmac_f32 v184, v162, v173
    v_fmac_f32 v185, v163, v173
    v_fmac_f32 v186, v164, v173
    v_fmac_f32 v187, v165, v173
    v_fmac_f32 v188, v166, v173
    v_fmac_f32 v189, v167, v173
    v_fmac_f32 v190, v168, v173
    s_waitcnt vmcnt(12)
    s_barrier
    s_mul_i32 s16, s97, 3072
    s_add_u32 m0, s60, 49152
    s_add_u32 s99, s16, s62
    buffer_load_dwordx4 v244, s[32:35], s99 offen offset:0 lds
    v_fmac_f32 v191, v169, v173
    v_fmac_f32 v184, v163, v172
    v_fmac_f32 v185, v164, v172
    v_fmac_f32 v186, v165, v172
    v_fmac_f32 v187, v166, v172
    buffer_load_dwordx4 v245, s[32:35], s99 offen offset:1024 lds
    v_fmac_f32 v188, v167, v172
    v_fmac_f32 v189, v168, v172
    v_fmac_f32 v190, v169, v172
    v_fmac_f32 v191, v170, v172
    v_mul_f32 v184, v184, v176
    buffer_load_dwordx4 v246, s[32:35], s99 offen offset:2048 lds
    v_mul_f32 v185, v185, v177
    v_mul_f32 v186, v186, v178
    v_mul_f32 v187, v187, v179
    v_mul_f32 v188, v188, v180
    v_mul_f32 v189, v189, v181
    s_add_u32 m0, s61, 61440
    s_add_u32 s16, s16, s63
    buffer_load_dwordx4 v244, s[32:35], s16 offen offset:0 lds
    v_mul_f32 v190, v190, v182
    v_mul_f32 v191, v191, v183
    v_cvt_pk_bf16_f32 v108, v191, v190
    v_cvt_pk_bf16_f32 v109, v189, v188
    v_cvt_pk_bf16_f32 v110, v187, v186
    buffer_load_dwordx4 v245, s[32:35], s16 offen offset:1024 lds
    v_cvt_pk_bf16_f32 v111, v185, v184
    s_mov_b32 s89, 32768
    buffer_store_dwordx4 v[108:111], v12, s[52:55], s89 offen sc1
    v_and_b32 v160, 0xffff0000, v41
    v_and_b32 v161, 0xffff0000, v43
    v_and_b32 v162, 0xffff0000, v45
    buffer_load_dwordx4 v246, s[32:35], s16 offen offset:2048 lds
    v_and_b32 v163, 0xffff0000, v47
    v_and_b32 v164, 0xffff0000, v49
    v_and_b32 v165, 0xffff0000, v51
    v_and_b32 v166, 0xffff0000, v53
    v_and_b32 v167, 0xffff0000, v55
    s_add_u32 s97, s98, s0
    s_lshr_b64 s[0:1], s[0:1], 4
    s_and_b32 s97, s97, 15
    s_add_u32 m0, s87, 0
    s_lshl_b32 s97, s97, 7
    buffer_load_dwordx4 v240, s[28:31], s97 offen offset:0 lds
    v_and_b32 v168, 0xffff0000, v57
    v_and_b32 v169, 0xffff0000, v59
    v_and_b32 v170, 0xffff0000, v61
    v_lshlrev_b32 v172, 16, v90
    v_and_b32 v173, 0xffff0000, v90
    buffer_load_dwordx4 v241, s[28:31], s97 offen offset:1024 lds
    v_lshlrev_b32 v174, 16, v91
    v_and_b32 v175, 0xffff0000, v91
    v_and_b32 v176, 0xffff0000, v69
    v_and_b32 v177, 0xffff0000, v71
    v_and_b32 v178, 0xffff0000, v73
    buffer_load_dwordx4 v242, s[28:31], s97 offen offset:2048 lds
    v_and_b32 v179, 0xffff0000, v75
    v_and_b32 v180, 0xffff0000, v77
    v_and_b32 v181, 0xffff0000, v79
    v_and_b32 v182, 0xffff0000, v81
    v_and_b32 v183, 0xffff0000, v83
    buffer_load_dwordx4 v243, s[28:31], s97 offen offset:3072 lds
    v_mul_f32 v184, v160, v175
    v_mul_f32 v185, v161, v175
    v_mul_f32 v186, v162, v175
    v_mul_f32 v187, v163, v175
    v_mul_f32 v188, v164, v175
    v_mul_f32 v189, v165, v175
    v_mul_f32 v190, v166, v175
    v_mul_f32 v191, v167, v175
    v_fmac_f32 v184, v161, v174
    v_fmac_f32 v185, v162, v174
    v_fmac_f32 v186, v163, v174
    v_fmac_f32 v187, v164, v174
    v_fmac_f32 v188, v165, v174
    v_fmac_f32 v189, v166, v174
    v_fmac_f32 v190, v167, v174
    v_fmac_f32 v191, v168, v174
    v_fmac_f32 v184, v162, v173
    v_fmac_f32 v185, v163, v173
    v_fmac_f32 v186, v164, v173
    v_fmac_f32 v187, v165, v173
    v_fmac_f32 v188, v166, v173
    v_fmac_f32 v189, v167, v173
    v_fmac_f32 v190, v168, v173
    v_fmac_f32 v191, v169, v173
    v_fmac_f32 v184, v163, v172
    v_fmac_f32 v185, v164, v172
    v_fmac_f32 v186, v165, v172
    v_fmac_f32 v187, v166, v172
    v_fmac_f32 v188, v167, v172
    v_fmac_f32 v189, v168, v172
    v_fmac_f32 v190, v169, v172
    v_fmac_f32 v191, v170, v172
    v_mul_f32 v184, v184, v176
    v_mul_f32 v185, v185, v177
    v_mul_f32 v186, v186, v178
    v_mul_f32 v187, v187, v179
    v_mul_f32 v188, v188, v180
    v_mul_f32 v189, v189, v181
    v_mul_f32 v190, v190, v182
    v_mul_f32 v191, v191, v183
    v_cvt_pk_bf16_f32 v112, v191, v190
    v_cvt_pk_bf16_f32 v113, v189, v188
    v_cvt_pk_bf16_f32 v114, v187, v186
    v_cvt_pk_bf16_f32 v115, v185, v184
    s_mov_b32 s89, 49152
    buffer_store_dwordx4 v[112:115], v12, s[52:55], s89 offen sc1
    s_waitcnt vmcnt(12)
    s_barrier
    s_mul_i32 s16, s97, 3072
    s_add_u32 m0, s60, 0
    s_add_u32 s99, s16, s62
    buffer_load_dwordx4 v244, s[32:35], s99 offen offset:0 lds
    buffer_load_dwordx4 v245, s[32:35], s99 offen offset:1024 lds
    buffer_load_dwordx4 v246, s[32:35], s99 offen offset:2048 lds
    s_add_u32 m0, s61, 12288
    s_add_u32 s16, s16, s63
    buffer_load_dwordx4 v244, s[32:35], s16 offen offset:0 lds
    buffer_load_dwordx4 v245, s[32:35], s16 offen offset:1024 lds
    buffer_load_dwordx4 v246, s[32:35], s16 offen offset:2048 lds
    s_add_u32 s97, s98, s0
    s_lshr_b64 s[0:1], s[0:1], 4
    s_and_b32 s97, s97, 15
    s_add_u32 m0, s87, 18432
    s_lshl_b32 s97, s97, 7
    buffer_load_dwordx4 v240, s[28:31], s97 offen offset:0 lds
    buffer_load_dwordx4 v241, s[28:31], s97 offen offset:1024 lds
    buffer_load_dwordx4 v242, s[28:31], s97 offen offset:2048 lds
    buffer_load_dwordx4 v243, s[28:31], s97 offen offset:3072 lds
    s_waitcnt vmcnt(11)
    s_barrier
    s_mul_i32 s16, s97, 3072
    s_add_u32 m0, s60, 24576
    s_add_u32 s99, s16, s62
    buffer_load_dwordx4 v244, s[32:35], s99 offen offset:0 lds
    s_mov_b32 s68, s24
    s_mov_b32 s69, s25
    s_mov_b32 s70, 0x100
    s_mov_b32 s71, 0x20000
    v_lshrrev_b32 v6, 5, v0
    buffer_load_dwordx4 v245, s[32:35], s99 offen offset:1024 lds
    v_and_b32 v7, 3, v0
    s_lshr_b32 s78, s90, 1
    s_lshl_b32 s78, s78, 2
    s_load_dword s92, s[14:15], s78
    v_bfe_u32 v5, v0, 2, 2
    buffer_load_dwordx4 v246, s[32:35], s99 offen offset:2048 lds
    v_lshlrev_b32 v5, 1, v5
    v_lshl_add_u32 v5, v6, 3, v5
    v_bfe_u32 v8, v0, 4, 1
    v_add_u32 v5, v5, v8
    s_add_u32 m0, s61, 36864
    s_add_u32 s16, s16, s63
    buffer_load_dwordx4 v244, s[32:35], s16 offen offset:0 lds
    s_and_b32 s78, s3, 1
    s_lshl_b32 s78, s78, 1
    v_add_u32 v8, s78, v6
    v_xor_b32 v8, v8, v7
    v_lshlrev_b32 v8, 4, v8
    buffer_load_dwordx4 v245, s[32:35], s16 offen offset:1024 lds
    v_lshl_add_u32 v5, v5, 6, v8
    v_add_u32 v35, s86, v5
    v_mov_b32 v18, 162304
    v_mov_b32 v19, 1
    buffer_load_dwordx4 v246, s[32:35], s16 offen offset:2048 lds
    v_and_b32 v5, 3, v0
    s_lshl_b32 s78, s74, 4
    s_add_u32 s78, s78, s3
    v_lshl_add_u32 v6, v5, 2, s78
    s_lshr_b32 s78, s76, 3
    s_add_u32 s97, s98, s0
    s_lshr_b64 s[0:1], s[0:1], 4
    s_and_b32 s97, s97, 15
    s_add_u32 m0, s87, 36864
    s_lshl_b32 s97, s97, 7
    buffer_load_dwordx4 v240, s[28:31], s97 offen offset:0 lds
    s_lshl_b32 s79, s3, 1
    s_add_u32 s78, s78, s79
    s_xor_b32 s78, s78, 3
    s_lshl_b32 s78, s78, 5
    s_add_u32 s79, s76, 5
    buffer_load_dwordx4 v241, s[28:31], s97 offen offset:1024 lds
    s_and_b32 s79, s79, 7
    s_lshl_b32 s79, s79, 1
    s_add_u32 s78, s78, s79
    v_mul_u32_u24 v7, 9, v5
    buffer_load_dwordx4 v242, s[28:31], s97 offen offset:2048 lds
    v_and_b32 v7, 17, v7
    v_add_u32 v7, s78, v7
    v_and_b32 v8, 4, v0
    v_cmp_eq_u32 vcc, 0, v8
    s_nop 1
    v_cndmask_b32 v6, v7, v6, vcc
    buffer_load_dwordx4 v243, s[28:31], s97 offen offset:3072 lds
    s_max_u32 s81, s72, 1
    s_sub_u32 s81, s81, 1
    s_add_u32 s79, s81, s73
    s_add_u32 s78, s81, 5
    s_waitcnt vmcnt(10)
    s_barrier
    s_mul_i32 s16, s97, 3072
    s_add_u32 m0, s60, 49152
    s_add_u32 s99, s16, s62
    buffer_load_dwordx4 v244, s[32:35], s99 offen offset:0 lds
    s_and_b32 s78, s78, 7
    s_lshl_b32 s78, s78, 1
    s_and_b32 s80, s79, 1
    s_add_u32 s78, s78, s80
    buffer_load_dwordx4 v245, s[32:35], s99 offen offset:1024 lds
    s_andn2_b32 s79, 2, s79
    s_lshl_b32 s79, s79, 3
    s_add_u32 s78, s78, s79
    buffer_load_dwordx4 v246, s[32:35], s99 offen offset:2048 lds
    s_lshr_b32 s81, s81, 3
    s_lshr_b32 s79, s73, 2
    s_lshl_b32 s79, s79, 1
    s_add_u32 m0, s61, 61440
    s_add_u32 s16, s16, s63
    buffer_load_dwordx4 v244, s[32:35], s16 offen offset:0 lds
    s_add_u32 s79, s79, s81
    s_xor_b32 s79, s79, 3
    s_lshl_b32 s79, s79, 5
    s_add_u32 s78, s78, s79
    buffer_load_dwordx4 v245, s[32:35], s16 offen offset:1024 lds
    v_writelane_b32 v6, s78, 8
    v_and_b32 v33, 0xf0, v6
    v_lshlrev_b32 v34, 8, v6
    buffer_load_dwordx4 v246, s[32:35], s16 offen offset:2048 lds
    v_add_u32 v34, 12582912, v34
    v_and_b32 v5, 15, v0
    v_lshrrev_b32 v6, 4, v0
    s_add_u32 m0, s94, 32
    s_lshl_b32 s89, s90, 12
    buffer_load_dwordx4 v15, s[48:51], s89 offen offset:0 nt lds
    v_add_u32 v7, 9, v5
    v_and_b32 v8, 1, v7
    v_mul_u32_u24 v8, 4160, v8
    s_add_u32 m0, s94, 32
    s_lshl_b32 s89, s90, 12
    buffer_load_dwordx4 v15, s[48:51], s89 offen offset:1024 nt lds
    v_lshrrev_b32 v7, 1, v7
    v_lshl_add_u32 v8, v7, 2, v8
    v_lshlrev_b32 v7, 4, v6
    v_sub_u32 v8, v8, v7
    s_add_u32 m0, s94, 32
    s_lshl_b32 s89, s90, 12
    buffer_load_dwordx4 v15, s[48:51], s89 offen offset:2048 nt lds
    s_add_u32 s78, s94, 32
    v_add_u32 v21, s78, v8
    v_add_u32 v22, 1024, v21
    s_add_u32 m0, s94, 32
    s_lshl_b32 s89, s90, 12
    buffer_load_dwordx4 v15, s[48:51], s89 offen offset:3072 nt lds
    v_add_u32 v23, 2048, v21
    v_add_u32 v24, 3072, v21
    v_lshl_add_u32 v7, v5, 1, v6
    s_add_u32 s97, s98, s0
    s_lshr_b64 s[0:1], s[0:1], 4
    s_and_b32 s97, s97, 15
    s_add_u32 m0, s87, 0
    s_lshl_b32 s97, s97, 7
    buffer_load_dwordx4 v240, s[28:31], s97 offen offset:0 lds
    v_add_u32 v7, 30, v7
    v_and_b32 v8, 1, v7
    v_bfe_u32 v136, v7, 1, 2
    v_lshl_add_u32 v136, v8, 2, v136
    buffer_load_dwordx4 v241, s[28:31], s97 offen offset:1024 lds
    v_lshlrev_b32 v136, 6, v136
    v_lshrrev_b32 v7, 3, v7
    v_lshl_add_u32 v136, v7, 9, v136
    buffer_load_dwordx4 v242, s[28:31], s97 offen offset:2048 lds
    v_bitop3_b32 v8, v7, 3, s3 bitop3:0x6a
    v_lshl_add_u32 v25, v8, 4, v136
    v_add_u32 v25, 92160, v25
    buffer_load_dwordx4 v243, s[28:31], s97 offen offset:3072 lds
    v_subrev_u32 v7, 1, v7
    v_bitop3_b32 v8, v7, 3, s3 bitop3:0x6a
    v_lshl_add_u32 v27, v8, 4, v136
    s_waitcnt vmcnt(14)
    s_barrier
    s_mul_i32 s16, s97, 3072
    s_add_u32 m0, s60, 0
    s_add_u32 s99, s16, s62
    buffer_load_dwordx4 v244, s[32:35], s99 offen offset:0 lds
    v_add_u32 v27, 91648, v27
    v_subrev_u32 v7, 1, v7
    v_bitop3_b32 v8, v7, 3, s3 bitop3:0x6a
    v_lshl_add_u32 v29, v8, 4, v136
    v_add_u32 v29, 91136, v29
    buffer_load_dwordx4 v245, s[32:35], s99 offen offset:1024 lds
    v_subrev_u32 v7, 1, v7
    v_bitop3_b32 v8, v7, 3, s3 bitop3:0x6a
    v_lshl_add_u32 v31, v8, 4, v136
    v_add_u32 v31, 90624, v31
    v_lshl_add_u32 v7, v5, 1, v6
    buffer_load_dwordx4 v246, s[32:35], s99 offen offset:2048 lds
    v_add_u32 v7, 26, v7
    v_and_b32 v8, 1, v7
    v_bfe_u32 v136, v7, 1, 2
    v_lshl_add_u32 v136, v8, 2, v136
    s_add_u32 m0, s61, 12288
    s_add_u32 s16, s16, s63
    buffer_load_dwordx4 v244, s[32:35], s16 offen offset:0 lds
    v_lshlrev_b32 v136, 6, v136
    v_lshrrev_b32 v7, 3, v7
    v_lshl_add_u32 v136, v7, 9, v136
    v_bitop3_b32 v8, v7, 3, s3 bitop3:0x6a
    v_lshl_add_u32 v26, v8, 4, v136
    buffer_load_dwordx4 v245, s[32:35], s16 offen offset:1024 lds
    v_add_u32 v26, 92160, v26
    v_subrev_u32 v7, 1, v7
    v_bitop3_b32 v8, v7, 3, s3 bitop3:0x6a
    v_lshl_add_u32 v28, v8, 4, v136
    buffer_load_dwordx4 v246, s[32:35], s16 offen offset:2048 lds
    v_add_u32 v28, 91648, v28
    v_subrev_u32 v7, 1, v7
    v_bitop3_b32 v8, v7, 3, s3 bitop3:0x6a
    v_lshl_add_u32 v30, v8, 4, v136
    v_add_u32 v30, 91136, v30
    s_add_u32 s97, s98, s0
    s_lshr_b64 s[0:1], s[0:1], 4
    s_and_b32 s97, s97, 15
    s_add_u32 m0, s87, 18432
    s_lshl_b32 s97, s97, 7
    buffer_load_dwordx4 v240, s[28:31], s97 offen offset:0 lds
    v_subrev_u32 v7, 1, v7
    v_bitop3_b32 v8, v7, 3, s3 bitop3:0x6a
    v_lshl_add_u32 v32, v8, 4, v136
    v_add_u32 v32, 90624, v32
    v_lshrrev_b32 v7, 1, v6
    buffer_load_dwordx4 v241, s[28:31], s97 offen offset:1024 lds
    v_lshl_add_u32 v7, v5, 1, v7
    v_add_u32 v7, 32, v7
    v_and_b32 v8, 1, v7
    v_bfe_u32 v136, v7, 1, 2
    buffer_load_dwordx4 v242, s[28:31], s97 offen offset:2048 lds
    v_lshl_add_u32 v136, v8, 2, v136
    v_lshlrev_b32 v136, 6, v136
    v_lshrrev_b32 v7, 3, v7
    v_lshl_add_u32 v136, v7, 9, v136
    v_bitop3_b32 v8, v7, 3, s3 bitop3:0x6a
    buffer_load_dwordx4 v243, s[28:31], s97 offen offset:3072 lds
    v_lshl_add_u32 v20, v8, 4, v136
    v_add_u32 v20, 92160, v20
    v_and_b32 v8, 1, v6
    v_xor_b32 v8, 1, v8
    s_waitcnt vmcnt(10)
    s_barrier
    s_mul_i32 s16, s97, 3072
    s_add_u32 m0, s60, 24576
    s_add_u32 s99, s16, s62
    buffer_load_dwordx4 v244, s[32:35], s99 offen offset:0 lds
    v_lshl_add_u32 v20, v8, 3, v20
    s_waitcnt lgkmcnt(0)
    s_and_b32 s78, s92, 0xffff0000
    s_lshl_b32 s92, s92, 16
    buffer_load_dwordx4 v245, s[32:35], s99 offen offset:1024 lds
    s_bitcmp1_b32 s90, 0
    s_cselect_b32 s92, s78, s92
    v_lshlrev_b32 v7, 3, v6
    v_sub_u32 v7, v7, v5
    v_subrev_u32 v7, 9, v7
    buffer_load_dwordx4 v246, s[32:35], s99 offen offset:2048 lds
    v_and_b32 v8, 1, v7
    v_xor_b32 v8, 1, v8
    v_lshlrev_b32 v8, 4, v8
    v_lshrrev_b32 v8, v8, s92
    s_add_u32 m0, s61, 36864
    s_add_u32 s16, s16, s63
    buffer_load_dwordx4 v244, s[32:35], s16 offen offset:0 lds
    v_ashrrev_i32 v7, 1, v7
    v_cmp_eq_u32 vcc, 0, v7
    s_nop 1
    v_cndmask_b32 v236, 0, v8, vcc
    v_cmp_eq_u32 vcc, 1, v7
    buffer_load_dwordx4 v245, s[32:35], s16 offen offset:1024 lds
    s_nop 0
    v_cndmask_b32 v237, 0, v8, vcc
    v_cmp_eq_u32 vcc, 2, v7
    s_nop 1
    v_cndmask_b32 v238, 0, v8, vcc
    v_cmp_eq_u32 vcc, 3, v7
    buffer_load_dwordx4 v246, s[32:35], s16 offen offset:2048 lds
    s_nop 0
    v_cndmask_b32 v239, 0, v8, vcc
    s_and_b32 s95, s76, 3
    s_mul_i32 s95, s95, 0x22222222
    s_add_u32 s95, s95, 0x76543210
    s_add_u32 s97, s98, s0
    s_lshr_b64 s[0:1], s[0:1], 4
    s_and_b32 s97, s97, 15
    s_add_u32 m0, s87, 36864
    s_lshl_b32 s97, s97, 7
    buffer_load_dwordx4 v240, s[28:31], s97 offen offset:0 lds
    s_bfe_u32 s100, s95, 0x3001c
    s_lshl_b32 s100, s100, 18
    s_bfe_u32 s95, s95, 0x30018
    s_lshl_b32 s95, s95, 18
    buffer_load_dwordx4 v241, s[28:31], s97 offen offset:1024 lds
    v_lshrrev_b32 v136, 4, v0
    v_lshlrev_b32 v136, 1, v136
    v_and_b32 v137, 7, v0
    v_xor_b32 v136, v136, v137
    buffer_load_dwordx4 v242, s[28:31], s97 offen offset:2048 lds
    v_lshlrev_b32 v136, 4, v136
    v_lshrrev_b32 v137, 3, v0
    v_lshl_add_u32 v136, v137, 11, v136
    s_lshl_b32 s78, s77, 7
    buffer_load_dwordx4 v243, s[28:31], s97 offen offset:3072 lds
    s_lshl_b32 s79, s3, 14
    s_add_u32 s78, s78, s79
    v_add_u32 v17, s78, v136
    s_waitcnt vmcnt(10)
    s_barrier
    s_mul_i32 s16, s97, 3072
    s_add_u32 m0, s60, 49152
    s_add_u32 s99, s16, s62
    buffer_load_dwordx4 v244, s[32:35], s99 offen offset:0 lds
    v_add_u32 v5, s94, v15
    ds_read_b128 v[140:143], v5 offset:32
    ds_read_b32 v156, v5 offset:48
    ds_read_b128 v[144:147], v5 offset:1056
    buffer_load_dwordx4 v245, s[32:35], s99 offen offset:1024 lds
    ds_read_b32 v157, v5 offset:1072
    ds_read_b128 v[148:151], v5 offset:2080
    ds_read_b32 v158, v5 offset:2096
    buffer_load_dwordx4 v246, s[32:35], s99 offen offset:2048 lds
    ds_read_b128 v[152:155], v5 offset:3104
    ds_read_b32 v159, v5 offset:3120
    v_lshrrev_b32 v6, 3, v0
    v_mul_u32_u24 v6, 4160, v6
    s_add_u32 m0, s61, 61440
    s_add_u32 s16, s16, s63
    buffer_load_dwordx4 v244, s[32:35], s16 offen offset:0 lds
    v_and_b32 v7, 7, v0
    v_lshl_add_u32 v6, v7, 2, v6
    v_add_u32 v6, s94, v6
    buffer_load_dwordx4 v245, s[32:35], s16 offen offset:1024 lds
    v_mov_b32 v7, 0
    s_waitcnt lgkmcnt(0)
    v_readfirstlane_b32 s93, v140
    s_nop 0
    s_lshl_b32 s93, s93, 16
    buffer_load_dwordx4 v246, s[32:35], s16 offen offset:2048 lds
    s_nop 0
    v_writelane_b32 v7, s93, 15
    v_alignbit_b32 v140, v141, v140, 16
    v_alignbit_b32 v141, v142, v141, 16
    s_add_u32 s97, s98, s0
    s_lshr_b64 s[0:1], s[0:1], 4
    s_and_b32 s97, s97, 15
    s_add_u32 m0, s87, 0
    s_lshl_b32 s97, s97, 7
    buffer_load_dwordx4 v240, s[28:31], s97 offen offset:0 lds
    v_alignbit_b32 v142, v143, v142, 16
    v_alignbit_b32 v143, v156, v143, 16
    v_alignbit_b32 v144, v145, v144, 16
    v_alignbit_b32 v145, v146, v145, 16
    buffer_load_dwordx4 v241, s[28:31], s97 offen offset:1024 lds
    v_alignbit_b32 v146, v147, v146, 16
    v_alignbit_b32 v147, v157, v147, 16
    v_alignbit_b32 v148, v149, v148, 16
    buffer_load_dwordx4 v242, s[28:31], s97 offen offset:2048 lds
    v_alignbit_b32 v149, v150, v149, 16
    v_alignbit_b32 v150, v151, v150, 16
    v_alignbit_b32 v151, v158, v151, 16
    v_alignbit_b32 v152, v153, v152, 16
    buffer_load_dwordx4 v243, s[28:31], s97 offen offset:3072 lds
    v_alignbit_b32 v153, v154, v153, 16
    v_alignbit_b32 v154, v155, v154, 16
    v_alignbit_b32 v155, v159, v155, 16
    s_waitcnt vmcnt(10)
    s_barrier
    s_mul_i32 s16, s97, 3072
    s_add_u32 m0, s60, 0
    s_add_u32 s99, s16, s62
    buffer_load_dwordx4 v244, s[32:35], s99 offen offset:0 lds
    buffer_load_dwordx4 v245, s[32:35], s99 offen offset:1024 lds
    buffer_load_dwordx4 v246, s[32:35], s99 offen offset:2048 lds
    s_add_u32 m0, s61, 12288
    s_add_u32 s16, s16, s63
    buffer_load_dwordx4 v244, s[32:35], s16 offen offset:0 lds
    buffer_load_dwordx4 v245, s[32:35], s16 offen offset:1024 lds
    buffer_load_dwordx4 v246, s[32:35], s16 offen offset:2048 lds
    s_mov_b64 exec, 0x1ff
    buffer_load_dword v136, v33, s[68:71], 0 offen sc1
    buffer_load_dword v137, v34, s[52:55], 0 offen sc1
    s_mov_b64 exec, -1
    buffer_load_dwordx4 v[212:215], v9, s[56:59], 0 offen offset:0 nt
    buffer_load_dwordx4 v[216:219], v9, s[56:59], 0 offen offset:2048 nt
    buffer_load_dwordx4 v[220:223], v9, s[56:59], s96 offen offset:0 nt
    buffer_load_dwordx4 v[224:227], v9, s[56:59], s96 offen offset:2048 nt
    s_waitcnt vmcnt(12)
    s_waitcnt vmcnt(6)
    s_barrier
    s_waitcnt vmcnt(4)
    s_branch LA_j
LA_c1:
    s_waitcnt vmcnt(10)
    s_barrier
    s_mul_i32 s16, s97, 3072
    s_add_u32 m0, s60, 49152
    s_add_u32 s99, s16, s62
    buffer_load_dwordx4 v244, s[32:35], s99 offen offset:0 lds
    buffer_load_dwordx4 v245, s[32:35], s99 offen offset:1024 lds
    buffer_load_dwordx4 v246, s[32:35], s99 offen offset:2048 lds
    s_add_u32 m0, s61, 61440
    s_add_u32 s16, s16, s63
    buffer_load_dwordx4 v244, s[32:35], s16 offen offset:0 lds
    buffer_load_dwordx4 v245, s[32:35], s16 offen offset:1024 lds
    buffer_load_dwordx4 v246, s[32:35], s16 offen offset:2048 lds
    s_add_u32 s97, s98, s0
    s_lshr_b64 s[0:1], s[0:1], 4
    s_and_b32 s97, s97, 15
    s_add_u32 m0, s87, 0
    s_lshl_b32 s97, s97, 7
    buffer_load_dwordx4 v240, s[28:31], s97 offen offset:0 lds
    buffer_load_dwordx4 v241, s[28:31], s97 offen offset:1024 lds
    buffer_load_dwordx4 v242, s[28:31], s97 offen offset:2048 lds
    buffer_load_dwordx4 v243, s[28:31], s97 offen offset:3072 lds
    s_waitcnt vmcnt(10)
    s_barrier
    s_mul_i32 s16, s97, 3072
    s_add_u32 m0, s60, 0
    s_add_u32 s99, s16, s62
    buffer_load_dwordx4 v244, s[32:35], s99 offen offset:0 lds
    buffer_load_dwordx4 v245, s[32:35], s99 offen offset:1024 lds
    buffer_load_dwordx4 v246, s[32:35], s99 offen offset:2048 lds
    s_add_u32 m0, s61, 12288
    s_add_u32 s16, s16, s63
    buffer_load_dwordx4 v244, s[32:35], s16 offen offset:0 lds
    buffer_load_dwordx4 v245, s[32:35], s16 offen offset:1024 lds
    buffer_load_dwordx4 v246, s[32:35], s16 offen offset:2048 lds
    s_add_u32 m0, s86, 129536
    s_mov_b32 s89, 0
    buffer_load_dwordx4 v10, s[36:39], s89 offen nt lds
    s_add_u32 m0, s86, 145920
    s_mov_b32 s89, 0
    buffer_load_dwordx4 v10, s[40:43], s89 offen nt lds
    s_add_u32 m0, s86, 133632
    s_mov_b32 s89, 65536
    buffer_load_dwordx4 v10, s[36:39], s89 offen nt lds
    s_add_u32 m0, s86, 150016
    s_mov_b32 s89, 65536
    buffer_load_dwordx4 v10, s[40:43], s89 offen nt lds
    s_add_u32 m0, s86, 137728
    s_mov_b32 s89, 131072
    buffer_load_dwordx4 v10, s[36:39], s89 offen nt lds
    s_add_u32 m0, s86, 154112
    s_mov_b32 s89, 131072
    buffer_load_dwordx4 v10, s[40:43], s89 offen nt lds
    s_add_u32 m0, s86, 141824
    s_mov_b32 s89, 196608
    buffer_load_dwordx4 v10, s[36:39], s89 offen nt lds
    s_add_u32 m0, s86, 158208
    s_mov_b32 s89, 196608
    buffer_load_dwordx4 v10, s[40:43], s89 offen nt lds
    s_mov_b64 exec, 0xff
    s_lshl_b32 s82, s3, 7
    s_add_u32 m0, s82, 129024
    s_mov_b32 s89, 0
    buffer_load_dwordx4 v11, s[36:39], s89 offen nt lds
    s_lshl_b32 s83, s74, 9
    s_add_u32 s83, s83, s82
    s_and_b32 s89, s3, 2
    s_lshl_b32 s89, s89, 3
    s_add_u32 s82, s82, s89
    s_add_u32 m0, s82, 162816
    s_add_u32 s89, s83, 0
    buffer_load_dwordx4 v15, s[44:47], s89 offen  lds
    s_mov_b64 exec, -1
    s_add_u32 s97, s98, s0
    s_lshr_b64 s[0:1], s[0:1], 4
    s_and_b32 s97, s97, 15
    s_add_u32 m0, s87, 18432
    s_lshl_b32 s97, s97, 7
    buffer_load_dwordx4 v240, s[28:31], s97 offen offset:0 lds
    buffer_load_dwordx4 v241, s[28:31], s97 offen offset:1024 lds
    buffer_load_dwordx4 v242, s[28:31], s97 offen offset:2048 lds
    buffer_load_dwordx4 v243, s[28:31], s97 offen offset:3072 lds
    s_waitcnt vmcnt(20)
    s_barrier
    s_mul_i32 s16, s97, 3072
    s_add_u32 m0, s60, 24576
    s_add_u32 s99, s16, s62
    buffer_load_dwordx4 v244, s[32:35], s99 offen offset:0 lds
    buffer_load_dwordx4 v245, s[32:35], s99 offen offset:1024 lds
    buffer_load_dwordx4 v246, s[32:35], s99 offen offset:2048 lds
    s_add_u32 m0, s61, 36864
    s_add_u32 s16, s16, s63
    buffer_load_dwordx4 v244, s[32:35], s16 offen offset:0 lds
    buffer_load_dwordx4 v245, s[32:35], s16 offen offset:1024 lds
    buffer_load_dwordx4 v246, s[32:35], s16 offen offset:2048 lds
    s_add_u32 s97, s98, s0
    s_lshr_b64 s[0:1], s[0:1], 4
    s_and_b32 s97, s97, 15
    s_add_u32 m0, s87, 36864
    s_lshl_b32 s97, s97, 7
    buffer_load_dwordx4 v240, s[28:31], s97 offen offset:0 lds
    buffer_load_dwordx4 v241, s[28:31], s97 offen offset:1024 lds
    buffer_load_dwordx4 v242, s[28:31], s97 offen offset:2048 lds
    buffer_load_dwordx4 v243, s[28:31], s97 offen offset:3072 lds
    s_waitcnt vmcnt(10)
    s_barrier
    s_mul_i32 s16, s97, 3072
    s_add_u32 m0, s60, 49152
    s_add_u32 s99, s16, s62
    buffer_load_dwordx4 v244, s[32:35], s99 offen offset:0 lds
    ds_read_b128 v[84:87], v14 offset:0
    ds_read_b128 v[88:91], v14 offset:16
    buffer_load_dwordx4 v245, s[32:35], s99 offen offset:1024 lds
    ds_read_b64 v[40:41], v16 offset:0
    ds_read_b64 v[42:43], v231 offset:256
    buffer_load_dwordx4 v246, s[32:35], s99 offen offset:2048 lds
    ds_read_b64 v[44:45], v16 offset:256
    ds_read_b64 v[46:47], v16 offset:512
    s_add_u32 m0, s61, 61440
    s_add_u32 s16, s16, s63
    buffer_load_dwordx4 v244, s[32:35], s16 offen offset:0 lds
    ds_read_b64 v[48:49], v231 offset:512
    buffer_load_dwordx4 v245, s[32:35], s16 offen offset:1024 lds
    ds_read_b64 v[50:51], v16 offset:768
    ds_read_b64 v[52:53], v231 offset:768
    buffer_load_dwordx4 v246, s[32:35], s16 offen offset:2048 lds
    ds_read_b64 v[54:55], v16 offset:1024
    ds_read_b64 v[56:57], v231 offset:1024
    buffer_load_dword v230, v229, s[28:31], 0 offen
    ds_read_b64 v[58:59], v16 offset:1280
    ds_read_b64 v[60:61], v231 offset:1280
    buffer_load_dword v230, v228, s[32:35], 0 offen
    ds_read_b64 v[68:69], v16 offset:16896
    s_add_u32 s97, s98, s0
    s_lshr_b64 s[0:1], s[0:1], 4
    s_and_b32 s97, s97, 15
    s_add_u32 m0, s87, 0
    s_lshl_b32 s97, s97, 7
    buffer_load_dwordx4 v240, s[28:31], s97 offen offset:0 lds
    ds_read_b64 v[70:71], v231 offset:16896
    ds_read_b64 v[72:73], v16 offset:17152
    buffer_load_dwordx4 v241, s[28:31], s97 offen offset:1024 lds
    ds_read_b64 v[74:75], v231 offset:17152
    ds_read_b64 v[76:77], v16 offset:17408
    buffer_load_dwordx4 v242, s[28:31], s97 offen offset:2048 lds
    ds_read_b64 v[78:79], v231 offset:17408
    ds_read_b64 v[80:81], v16 offset:17664
    buffer_load_dwordx4 v243, s[28:31], s97 offen offset:3072 lds
    ds_read_b64 v[82:83], v231 offset:17664
    s_waitcnt vmcnt(12)
    s_waitcnt lgkmcnt(0)
    s_barrier
    s_mul_i32 s16, s97, 3072
    s_add_u32 m0, s60, 0
    s_add_u32 s99, s16, s62
    buffer_load_dwordx4 v244, s[32:35], s99 offen offset:0 lds
    v_lshlrev_b32 v160, 16, v40
    v_lshlrev_b32 v161, 16, v42
    v_lshlrev_b32 v162, 16, v44
    v_lshlrev_b32 v163, 16, v46
    v_lshlrev_b32 v164, 16, v48
    buffer_load_dwordx4 v245, s[32:35], s99 offen offset:1024 lds
    v_lshlrev_b32 v165, 16, v50
    v_lshlrev_b32 v166, 16, v52
    v_lshlrev_b32 v167, 16, v54
    v_lshlrev_b32 v168, 16, v56
    v_lshlrev_b32 v169, 16, v58
    buffer_load_dwordx4 v246, s[32:35], s99 offen offset:2048 lds
    v_lshlrev_b32 v170, 16, v60
    v_lshlrev_b32 v172, 16, v84
    v_and_b32 v173, 0xffff0000, v84
    v_lshlrev_b32 v174, 16, v85
    v_and_b32 v175, 0xffff0000, v85
    s_add_u32 m0, s61, 12288
    s_add_u32 s16, s16, s63
    buffer_load_dwordx4 v244, s[32:35], s16 offen offset:0 lds
    v_lshlrev_b32 v176, 16, v68
    v_lshlrev_b32 v177, 16, v70
    v_lshlrev_b32 v178, 16, v72
    v_lshlrev_b32 v179, 16, v74
    v_lshlrev_b32 v180, 16, v76
    buffer_load_dwordx4 v245, s[32:35], s16 offen offset:1024 lds
    v_lshlrev_b32 v181, 16, v78
    v_lshlrev_b32 v182, 16, v80
    v_lshlrev_b32 v183, 16, v82
    v_mul_f32 v184, v160, v175
    v_mul_f32 v185, v161, v175
    buffer_load_dwordx4 v246, s[32:35], s16 offen offset:2048 lds
    v_mul_f32 v186, v162, v175
    v_mul_f32 v187, v163, v175
    v_mul_f32 v188, v164, v175
    v_mul_f32 v189, v165, v175
    v_mul_f32 v190, v166, v175
    s_lshl_b32 s88, s72, 1
    s_lshr_b32 s89, s3, 1
    s_add_u32 s88, s88, s89
    s_lshl_b32 s88, s88, 4
    s_add_u32 s88, s88, s73
    s_lshl_b32 s88, s88, 1
    s_and_b32 s89, s3, 1
    s_add_u32 s88, s88, s89
    s_lshl_b32 s88, s88, 11
    s_add_u32 s88, s88, 14680064
    v_mov_b32 v192, -1
    v_mov_b32 v193, -1
    v_mov_b32 v194, -1
    v_mov_b32 v195, -1
    buffer_store_dwordx4 v[192:195], v15, s[52:55], s88 offen offset:0 sc1
    v_mul_f32 v191, v167, v175
    v_fmac_f32 v184, v161, v174
    v_fmac_f32 v185, v162, v174
    v_fmac_f32 v186, v163, v174
    v_fmac_f32 v187, v164, v174
    buffer_store_dwordx4 v[192:195], v15, s[52:55], s88 offen offset:1024 sc1
    v_fmac_f32 v188, v165, v174
    v_fmac_f32 v189, v166, v174
    v_fmac_f32 v190, v167, v174
    v_fmac_f32 v191, v168, v174
    v_fmac_f32 v184, v162, v173
    s_add_u32 s97, s98, s0
    s_lshr_b64 s[0:1], s[0:1], 4
    s_and_b32 s97, s97, 15
    s_add_u32 m0, s87, 18432
    s_lshl_b32 s97, s97, 7
    buffer_load_dwordx4 v240, s[28:31], s97 offen offset:0 lds
    v_fmac_f32 v185, v163, v173
    v_fmac_f32 v186, v164, v173
    v_fmac_f32 v187, v165, v173
    v_fmac_f32 v188, v166, v173
    v_fmac_f32 v189, v167, v173
    buffer_load_dwordx4 v241, s[28:31], s97 offen offset:1024 lds
    v_fmac_f32 v190, v168, v173
    v_fmac_f32 v191, v169, v173
    v_fmac_f32 v184, v163, v172
    v_fmac_f32 v185, v164, v172
    v_fmac_f32 v186, v165, v172
    buffer_load_dwordx4 v242, s[28:31], s97 offen offset:2048 lds
    v_fmac_f32 v187, v166, v172
    v_fmac_f32 v188, v167, v172
    v_fmac_f32 v189, v168, v172
    v_fmac_f32 v190, v169, v172
    v_fmac_f32 v191, v170, v172
    buffer_load_dwordx4 v243, s[28:31], s97 offen offset:3072 lds
    v_mul_f32 v184, v184, v176
    v_mul_f32 v185, v185, v177
    v_mul_f32 v186, v186, v178
    v_mul_f32 v187, v187, v179
    v_mul_f32 v188, v188, v180
    v_mul_f32 v189, v189, v181
    v_mul_f32 v190, v190, v182
    v_mul_f32 v191, v191, v183
    v_cvt_pk_bf16_f32 v100, v191, v190
    v_cvt_pk_bf16_f32 v101, v189, v188
    v_cvt_pk_bf16_f32 v102, v187, v186
    v_cvt_pk_bf16_f32 v103, v185, v184
    s_mov_b32 s89, 0
    buffer_store_dwordx4 v[100:103], v12, s[52:55], s89 offen sc1
    v_and_b32 v160, 0xffff0000, v40
    v_and_b32 v161, 0xffff0000, v42
    v_and_b32 v162, 0xffff0000, v44
    v_and_b32 v163, 0xffff0000, v46
    v_and_b32 v164, 0xffff0000, v48
    v_and_b32 v165, 0xffff0000, v50
    v_and_b32 v166, 0xffff0000, v52
    v_and_b32 v167, 0xffff0000, v54
    v_and_b32 v168, 0xffff0000, v56
    v_and_b32 v169, 0xffff0000, v58
    v_and_b32 v170, 0xffff0000, v60
    v_lshlrev_b32 v172, 16, v86
    v_and_b32 v173, 0xffff0000, v86
    v_lshlrev_b32 v174, 16, v87
    v_and_b32 v175, 0xffff0000, v87
    v_and_b32 v176, 0xffff0000, v68
    v_and_b32 v177, 0xffff0000, v70
    v_and_b32 v178, 0xffff0000, v72
    v_and_b32 v179, 0xffff0000, v74
    v_and_b32 v180, 0xffff0000, v76
    v_and_b32 v181, 0xffff0000, v78
    v_and_b32 v182, 0xffff0000, v80
    v_and_b32 v183, 0xffff0000, v82
    s_waitcnt vmcnt(13)
    s_barrier
    s_mul_i32 s16, s97, 3072
    s_add_u32 m0, s60, 24576
    s_add_u32 s99, s16, s62
    buffer_load_dwordx4 v244, s[32:35], s99 offen offset:0 lds
    v_mul_f32 v184, v160, v175
    v_mul_f32 v185, v161, v175
    v_mul_f32 v186, v162, v175
    v_mul_f32 v187, v163, v175
    v_mul_f32 v188, v164, v175
    buffer_load_dwordx4 v245, s[32:35], s99 offen offset:1024 lds
    v_mul_f32 v189, v165, v175
    v_mul_f32 v190, v166, v175
    v_mul_f32 v191, v167, v175
    v_fmac_f32 v184, v161, v174
    v_fmac_f32 v185, v162, v174
    buffer_load_dwordx4 v246, s[32:35], s99 offen offset:2048 lds
    v_fmac_f32 v186, v163, v174
    v_fmac_f32 v187, v164, v174
    v_fmac_f32 v188, v165, v174
    v_fmac_f32 v189, v166, v174
    v_fmac_f32 v190, v167, v174
    s_add_u32 m0, s61, 36864
    s_add_u32 s16, s16, s63
    buffer_load_dwordx4 v244, s[32:35], s16 offen offset:0 lds
    v_fmac_f32 v191, v168, v174
    v_fmac_f32 v184, v162, v173
    v_fmac_f32 v185, v163, v173
    v_fmac_f32 v186, v164, v173
    v_fmac_f32 v187, v165, v173
    buffer_load_dwordx4 v245, s[32:35], s16 offen offset:1024 lds
    v_fmac_f32 v188, v166, v173
    v_fmac_f32 v189, v167, v173
    v_fmac_f32 v190, v168, v173
    v_fmac_f32 v191, v169, v173
    v_fmac_f32 v184, v163, v172
    buffer_load_dwordx4 v246, s[32:35], s16 offen offset:2048 lds
    v_fmac_f32 v185, v164, v172
    v_fmac_f32 v186, v165, v172
    v_fmac_f32 v187, v166, v172
    v_fmac_f32 v188, v167, v172
    v_fmac_f32 v189, v168, v172
    s_add_u32 s97, s98, s0
    s_lshr_b64 s[0:1], s[0:1], 4
    s_and_b32 s97, s97, 15
    s_add_u32 m0, s87, 36864
    s_lshl_b32 s97, s97, 7
    buffer_load_dwordx4 v240, s[28:31], s97 offen offset:0 lds
    v_fmac_f32 v190, v169, v172
    v_fmac_f32 v191, v170, v172
    v_mul_f32 v184, v184, v176
    v_mul_f32 v185, v185, v177
    v_mul_f32 v186, v186, v178
    buffer_load_dwordx4 v241, s[28:31], s97 offen offset:1024 lds
    v_mul_f32 v187, v187, v179
    v_mul_f32 v188, v188, v180
    v_mul_f32 v189, v189, v181
    v_mul_f32 v190, v190, v182
    v_mul_f32 v191, v191, v183
    buffer_load_dwordx4 v242, s[28:31], s97 offen offset:2048 lds
    v_cvt_pk_bf16_f32 v104, v191, v190
    v_cvt_pk_bf16_f32 v105, v189, v188
    v_cvt_pk_bf16_f32 v106, v187, v186
    v_cvt_pk_bf16_f32 v107, v185, v184
    s_mov_b32 s89, 16384
    buffer_store_dwordx4 v[104:107], v12, s[52:55], s89 offen sc1
    buffer_load_dwordx4 v243, s[28:31], s97 offen offset:3072 lds
    v_lshlrev_b32 v160, 16, v41
    v_lshlrev_b32 v161, 16, v43
    v_lshlrev_b32 v162, 16, v45
    v_lshlrev_b32 v163, 16, v47
    v_lshlrev_b32 v164, 16, v49
    v_lshlrev_b32 v165, 16, v51
    v_lshlrev_b32 v166, 16, v53
    v_lshlrev_b32 v167, 16, v55
    v_lshlrev_b32 v168, 16, v57
    v_lshlrev_b32 v169, 16, v59
    v_lshlrev_b32 v170, 16, v61
    v_lshlrev_b32 v172, 16, v88
    v_and_b32 v173, 0xffff0000, v88
    v_lshlrev_b32 v174, 16, v89
    v_and_b32 v175, 0xffff0000, v89
    v_lshlrev_b32 v176, 16, v69
    v_lshlrev_b32 v177, 16, v71
    v_lshlrev_b32 v178, 16, v73
    v_lshlrev_b32 v179, 16, v75
    v_lshlrev_b32 v180, 16, v77
    v_lshlrev_b32 v181, 16, v79
    v_lshlrev_b32 v182, 16, v81
    v_lshlrev_b32 v183, 16, v83
    v_mul_f32 v184, v160, v175
    v_mul_f32 v185, v161, v175
    v_mul_f32 v186, v162, v175
    v_mul_f32 v187, v163, v175
    v_mul_f32 v188, v164, v175
    v_mul_f32 v189, v165, v175
    v_mul_f32 v190, v166, v175
    v_mul_f32 v191, v167, v175
    v_fmac_f32 v184, v161, v174
    v_fmac_f32 v185, v162, v174
    v_fmac_f32 v186, v163, v174
    v_fmac_f32 v187, v164, v174
    v_fmac_f32 v188, v165, v174
    v_fmac_f32 v189, v166, v174
    v_fmac_f32 v190, v167, v174
    v_fmac_f32 v191, v168, v174
    v_fmac_f32 v184, v162, v173
    v_fmac_f32 v185, v163, v173
    v_fmac_f32 v186, v164, v173
    v_fmac_f32 v187, v165, v173
    v_fmac_f32 v188, v166, v173
    v_fmac_f32 v189, v167, v173
    v_fmac_f32 v190, v168, v173
    s_waitcnt vmcnt(12)
    s_barrier
    s_mul_i32 s16, s97, 3072
    s_add_u32 m0, s60, 49152
    s_add_u32 s99, s16, s62
    buffer_load_dwordx4 v244, s[32:35], s99 offen offset:0 lds
    v_fmac_f32 v191, v169, v173
    v_fmac_f32 v184, v163, v172
    v_fmac_f32 v185, v164, v172
    v_fmac_f32 v186, v165, v172
    v_fmac_f32 v187, v166, v172
    buffer_load_dwordx4 v245, s[32:35], s99 offen offset:1024 lds
    v_fmac_f32 v188, v167, v172
    v_fmac_f32 v189, v168, v172
    v_fmac_f32 v190, v169, v172
    v_fmac_f32 v191, v170, v172
    v_mul_f32 v184, v184, v176
    buffer_load_dwordx4 v246, s[32:35], s99 offen offset:2048 lds
    v_mul_f32 v185, v185, v177
    v_mul_f32 v186, v186, v178
    v_mul_f32 v187, v187, v179
    v_mul_f32 v188, v188, v180
    v_mul_f32 v189, v189, v181
    s_add_u32 m0, s61, 61440
    s_add_u32 s16, s16, s63
    buffer_load_dwordx4 v244, s[32:35], s16 offen offset:0 lds
    v_mul_f32 v190, v190, v182
    v_mul_f32 v191, v191, v183
    v_cvt_pk_bf16_f32 v108, v191, v190
    v_cvt_pk_bf16_f32 v109, v189, v188
    v_cvt_pk_bf16_f32 v110, v187, v186
    buffer_load_dwordx4 v245, s[32:35], s16 offen offset:1024 lds
    v_cvt_pk_bf16_f32 v111, v185, v184
    s_mov_b32 s89, 32768
    buffer_store_dwordx4 v[108:111], v12, s[52:55], s89 offen sc1
    v_and_b32 v160, 0xffff0000, v41
    v_and_b32 v161, 0xffff0000, v43
    v_and_b32 v162, 0xffff0000, v45
    buffer_load_dwordx4 v246, s[32:35], s16 offen offset:2048 lds
    v_and_b32 v163, 0xffff0000, v47
    v_and_b32 v164, 0xffff0000, v49
    v_and_b32 v165, 0xffff0000, v51
    v_and_b32 v166, 0xffff0000, v53
    v_and_b32 v167, 0xffff0000, v55
    s_add_u32 s97, s98, s0
    s_lshr_b64 s[0:1], s[0:1], 4
    s_and_b32 s97, s97, 15
    s_add_u32 m0, s87, 0
    s_lshl_b32 s97, s97, 7
    buffer_load_dwordx4 v240, s[28:31], s97 offen offset:0 lds
    v_and_b32 v168, 0xffff0000, v57
    v_and_b32 v169, 0xffff0000, v59
    v_and_b32 v170, 0xffff0000, v61
    v_lshlrev_b32 v172, 16, v90
    v_and_b32 v173, 0xffff0000, v90
    buffer_load_dwordx4 v241, s[28:31], s97 offen offset:1024 lds
    v_lshlrev_b32 v174, 16, v91
    v_and_b32 v175, 0xffff0000, v91
    v_and_b32 v176, 0xffff0000, v69
    v_and_b32 v177, 0xffff0000, v71
    v_and_b32 v178, 0xffff0000, v73
    buffer_load_dwordx4 v242, s[28:31], s97 offen offset:2048 lds
    v_and_b32 v179, 0xffff0000, v75
    v_and_b32 v180, 0xffff0000, v77
    v_and_b32 v181, 0xffff0000, v79
    v_and_b32 v182, 0xffff0000, v81
    v_and_b32 v183, 0xffff0000, v83
    buffer_load_dwordx4 v243, s[28:31], s97 offen offset:3072 lds
    v_mul_f32 v184, v160, v175
    v_mul_f32 v185, v161, v175
    v_mul_f32 v186, v162, v175
    v_mul_f32 v187, v163, v175
    v_mul_f32 v188, v164, v175
    v_mul_f32 v189, v165, v175
    v_mul_f32 v190, v166, v175
    v_mul_f32 v191, v167, v175
    v_fmac_f32 v184, v161, v174
    v_fmac_f32 v185, v162, v174
    v_fmac_f32 v186, v163, v174
    v_fmac_f32 v187, v164, v174
    v_fmac_f32 v188, v165, v174
    v_fmac_f32 v189, v166, v174
    v_fmac_f32 v190, v167, v174
    v_fmac_f32 v191, v168, v174
    v_fmac_f32 v184, v162, v173
    v_fmac_f32 v185, v163, v173
    v_fmac_f32 v186, v164, v173
    v_fmac_f32 v187, v165, v173
    v_fmac_f32 v188, v166, v173
    v_fmac_f32 v189, v167, v173
    v_fmac_f32 v190, v168, v173
    v_fmac_f32 v191, v169, v173
    v_fmac_f32 v184, v163, v172
    v_fmac_f32 v185, v164, v172
    v_fmac_f32 v186, v165, v172
    v_fmac_f32 v187, v166, v172
    v_fmac_f32 v188, v167, v172
    v_fmac_f32 v189, v168, v172
    v_fmac_f32 v190, v169, v172
    v_fmac_f32 v191, v170, v172
    v_mul_f32 v184, v184, v176
    v_mul_f32 v185, v185, v177
    v_mul_f32 v186, v186, v178
    v_mul_f32 v187, v187, v179
    v_mul_f32 v188, v188, v180
    v_mul_f32 v189, v189, v181
    v_mul_f32 v190, v190, v182
    v_mul_f32 v191, v191, v183
    v_cvt_pk_bf16_f32 v112, v191, v190
    v_cvt_pk_bf16_f32 v113, v189, v188
    v_cvt_pk_bf16_f32 v114, v187, v186
    v_cvt_pk_bf16_f32 v115, v185, v184
    s_mov_b32 s89, 49152
    buffer_store_dwordx4 v[112:115], v12, s[52:55], s89 offen sc1
    s_waitcnt vmcnt(12)
    s_barrier
    s_mul_i32 s16, s97, 3072
    s_add_u32 m0, s60, 0
    s_add_u32 s99, s16, s62
    buffer_load_dwordx4 v244, s[32:35], s99 offen offset:0 lds
    buffer_load_dwordx4 v245, s[32:35], s99 offen offset:1024 lds
    buffer_load_dwordx4 v246, s[32:35], s99 offen offset:2048 lds
    s_add_u32 m0, s61, 12288
    s_add_u32 s16, s16, s63
    buffer_load_dwordx4 v244, s[32:35], s16 offen offset:0 lds
    buffer_load_dwordx4 v245, s[32:35], s16 offen offset:1024 lds
    buffer_load_dwordx4 v246, s[32:35], s16 offen offset:2048 lds
    s_add_u32 s97, s98, s0
    s_lshr_b64 s[0:1], s[0:1], 4
    s_and_b32 s97, s97, 15
    s_add_u32 m0, s87, 18432
    s_lshl_b32 s97, s97, 7
    buffer_load_dwordx4 v240, s[28:31], s97 offen offset:0 lds
    buffer_load_dwordx4 v241, s[28:31], s97 offen offset:1024 lds
    buffer_load_dwordx4 v242, s[28:31], s97 offen offset:2048 lds
    buffer_load_dwordx4 v243, s[28:31], s97 offen offset:3072 lds
    s_waitcnt vmcnt(11)
    s_barrier
    s_mul_i32 s16, s97, 3072
    s_add_u32 m0, s60, 24576
    s_add_u32 s99, s16, s62
    buffer_load_dwordx4 v244, s[32:35], s99 offen offset:0 lds
    s_mov_b32 s68, s24
    s_mov_b32 s69, s25
    s_mov_b32 s70, 0x100
    s_mov_b32 s71, 0x20000
    v_lshrrev_b32 v6, 5, v0
    buffer_load_dwordx4 v245, s[32:35], s99 offen offset:1024 lds
    v_and_b32 v7, 3, v0
    s_lshr_b32 s78, s90, 1
    s_lshl_b32 s78, s78, 2
    s_load_dword s92, s[14:15], s78
    v_bfe_u32 v5, v0, 2, 2
    buffer_load_dwordx4 v246, s[32:35], s99 offen offset:2048 lds
    v_lshlrev_b32 v5, 1, v5
    v_lshl_add_u32 v5, v6, 3, v5
    v_bfe_u32 v8, v0, 4, 1
    v_add_u32 v5, v5, v8
    s_add_u32 m0, s61, 36864
    s_add_u32 s16, s16, s63
    buffer_load_dwordx4 v244, s[32:35], s16 offen offset:0 lds
    s_and_b32 s78, s3, 1
    s_lshl_b32 s78, s78, 1
    v_add_u32 v8, s78, v6
    v_xor_b32 v8, v8, v7
    v_lshlrev_b32 v8, 4, v8
    buffer_load_dwordx4 v245, s[32:35], s16 offen offset:1024 lds
    v_lshl_add_u32 v5, v5, 6, v8
    v_add_u32 v35, s86, v5
    v_mov_b32 v18, 162304
    v_mov_b32 v19, 1
    buffer_load_dwordx4 v246, s[32:35], s16 offen offset:2048 lds
    v_and_b32 v5, 3, v0
    s_lshl_b32 s78, s74, 4
    s_add_u32 s78, s78, s3
    v_lshl_add_u32 v6, v5, 2, s78
    s_lshr_b32 s78, s76, 3
    s_add_u32 s97, s98, s0
    s_lshr_b64 s[0:1], s[0:1], 4
    s_and_b32 s97, s97, 15
    s_add_u32 m0, s87, 36864
    s_lshl_b32 s97, s97, 7
    buffer_load_dwordx4 v240, s[28:31], s97 offen offset:0 lds
    s_lshl_b32 s79, s3, 1
    s_add_u32 s78, s78, s79
    s_xor_b32 s78, s78, 3
    s_lshl_b32 s78, s78, 5
    s_add_u32 s79, s76, 5
    buffer_load_dwordx4 v241, s[28:31], s97 offen offset:1024 lds
    s_and_b32 s79, s79, 7
    s_lshl_b32 s79, s79, 1
    s_add_u32 s78, s78, s79
    v_mul_u32_u24 v7, 9, v5
    buffer_load_dwordx4 v242, s[28:31], s97 offen offset:2048 lds
    v_and_b32 v7, 17, v7
    v_add_u32 v7, s78, v7
    v_and_b32 v8, 4, v0
    v_cmp_eq_u32 vcc, 0, v8
    s_nop 1
    v_cndmask_b32 v6, v7, v6, vcc
    buffer_load_dwordx4 v243, s[28:31], s97 offen offset:3072 lds
    s_max_u32 s81, s72, 1
    s_sub_u32 s81, s81, 1
    s_add_u32 s79, s81, s73
    s_add_u32 s78, s81, 5
    s_waitcnt vmcnt(10)
    s_barrier
    s_mul_i32 s16, s97, 3072
    s_add_u32 m0, s60, 49152
    s_add_u32 s99, s16, s62
    buffer_load_dwordx4 v244, s[32:35], s99 offen offset:0 lds
    s_and_b32 s78, s78, 7
    s_lshl_b32 s78, s78, 1
    s_and_b32 s80, s79, 1
    s_add_u32 s78, s78, s80
    buffer_load_dwordx4 v245, s[32:35], s99 offen offset:1024 lds
    s_andn2_b32 s79, 2, s79
    s_lshl_b32 s79, s79, 3
    s_add_u32 s78, s78, s79
    buffer_load_dwordx4 v246, s[32:35], s99 offen offset:2048 lds
    s_lshr_b32 s81, s81, 3
    s_lshr_b32 s79, s73, 2
    s_lshl_b32 s79, s79, 1
    s_add_u32 m0, s61, 61440
    s_add_u32 s16, s16, s63
    buffer_load_dwordx4 v244, s[32:35], s16 offen offset:0 lds
    s_add_u32 s79, s79, s81
    s_xor_b32 s79, s79, 3
    s_lshl_b32 s79, s79, 5
    s_add_u32 s78, s78, s79
    buffer_load_dwordx4 v245, s[32:35], s16 offen offset:1024 lds
    v_writelane_b32 v6, s78, 8
    v_and_b32 v33, 0xf0, v6
    v_lshlrev_b32 v34, 8, v6
    buffer_load_dwordx4 v246, s[32:35], s16 offen offset:2048 lds
    v_add_u32 v34, 12582912, v34
    v_and_b32 v5, 15, v0
    v_lshrrev_b32 v6, 4, v0
    s_add_u32 m0, s94, 32
    s_lshl_b32 s89, s90, 12
    buffer_load_dwordx4 v15, s[48:51], s89 offen offset:0 nt lds
    v_add_u32 v7, 9, v5
    v_and_b32 v8, 1, v7
    v_mul_u32_u24 v8, 4160, v8
    s_add_u32 m0, s94, 32
    s_lshl_b32 s89, s90, 12
    buffer_load_dwordx4 v15, s[48:51], s89 offen offset:1024 nt lds
    v_lshrrev_b32 v7, 1, v7
    v_lshl_add_u32 v8, v7, 2, v8
    v_lshlrev_b32 v7, 4, v6
    v_sub_u32 v8, v8, v7
    s_add_u32 m0, s94, 32
    s_lshl_b32 s89, s90, 12
    buffer_load_dwordx4 v15, s[48:51], s89 offen offset:2048 nt lds
    s_add_u32 s78, s94, 32
    v_add_u32 v21, s78, v8
    v_add_u32 v22, 1024, v21
    s_add_u32 m0, s94, 32
    s_lshl_b32 s89, s90, 12
    buffer_load_dwordx4 v15, s[48:51], s89 offen offset:3072 nt lds
    v_add_u32 v23, 2048, v21
    v_add_u32 v24, 3072, v21
    v_lshl_add_u32 v7, v5, 1, v6
    s_add_u32 s97, s98, s0
    s_lshr_b64 s[0:1], s[0:1], 4
    s_and_b32 s97, s97, 15
    s_add_u32 m0, s87, 0
    s_lshl_b32 s97, s97, 7
    buffer_load_dwordx4 v240, s[28:31], s97 offen offset:0 lds
    v_add_u32 v7, 30, v7
    v_and_b32 v8, 1, v7
    v_bfe_u32 v136, v7, 1, 2
    v_lshl_add_u32 v136, v8, 2, v136
    buffer_load_dwordx4 v241, s[28:31], s97 offen offset:1024 lds
    v_lshlrev_b32 v136, 6, v136
    v_lshrrev_b32 v7, 3, v7
    v_lshl_add_u32 v136, v7, 9, v136
    buffer_load_dwordx4 v242, s[28:31], s97 offen offset:2048 lds
    v_bitop3_b32 v8, v7, 3, s3 bitop3:0x6a
    v_lshl_add_u32 v25, v8, 4, v136
    v_add_u32 v25, 92160, v25
    buffer_load_dwordx4 v243, s[28:31], s97 offen offset:3072 lds
    v_subrev_u32 v7, 1, v7
    v_bitop3_b32 v8, v7, 3, s3 bitop3:0x6a
    v_lshl_add_u32 v27, v8, 4, v136
    s_waitcnt vmcnt(14)
    s_barrier
    s_mul_i32 s16, s97, 3072
    s_add_u32 m0, s60, 0
    s_add_u32 s99, s16, s62
    buffer_load_dwordx4 v244, s[32:35], s99 offen offset:0 lds
    v_add_u32 v27, 91648, v27
    v_subrev_u32 v7, 1, v7
    v_bitop3_b32 v8, v7, 3, s3 bitop3:0x6a
    v_lshl_add_u32 v29, v8, 4, v136
    v_add_u32 v29, 91136, v29
    buffer_load_dwordx4 v245, s[32:35], s99 offen offset:1024 lds
    v_subrev_u32 v7, 1, v7
    v_bitop3_b32 v8, v7, 3, s3 bitop3:0x6a
    v_lshl_add_u32 v31, v8, 4, v136
    v_add_u32 v31, 90624, v31
    v_lshl_add_u32 v7, v5, 1, v6
    buffer_load_dwordx4 v246, s[32:35], s99 offen offset:2048 lds
    v_add_u32 v7, 26, v7
    v_and_b32 v8, 1, v7
    v_bfe_u32 v136, v7, 1, 2
    v_lshl_add_u32 v136, v8, 2, v136
    s_add_u32 m0, s61, 12288
    s_add_u32 s16, s16, s63
    buffer_load_dwordx4 v244, s[32:35], s16 offen offset:0 lds
    v_lshlrev_b32 v136, 6, v136
    v_lshrrev_b32 v7, 3, v7
    v_lshl_add_u32 v136, v7, 9, v136
    v_bitop3_b32 v8, v7, 3, s3 bitop3:0x6a
    v_lshl_add_u32 v26, v8, 4, v136
    buffer_load_dwordx4 v245, s[32:35], s16 offen offset:1024 lds
    v_add_u32 v26, 92160, v26
    v_subrev_u32 v7, 1, v7
    v_bitop3_b32 v8, v7, 3, s3 bitop3:0x6a
    v_lshl_add_u32 v28, v8, 4, v136
    buffer_load_dwordx4 v246, s[32:35], s16 offen offset:2048 lds
    v_add_u32 v28, 91648, v28
    v_subrev_u32 v7, 1, v7
    v_bitop3_b32 v8, v7, 3, s3 bitop3:0x6a
    v_lshl_add_u32 v30, v8, 4, v136
    v_add_u32 v30, 91136, v30
    s_add_u32 s97, s98, s0
    s_lshr_b64 s[0:1], s[0:1], 4
    s_and_b32 s97, s97, 15
    s_add_u32 m0, s87, 18432
    s_lshl_b32 s97, s97, 7
    buffer_load_dwordx4 v240, s[28:31], s97 offen offset:0 lds
    v_subrev_u32 v7, 1, v7
    v_bitop3_b32 v8, v7, 3, s3 bitop3:0x6a
    v_lshl_add_u32 v32, v8, 4, v136
    v_add_u32 v32, 90624, v32
    v_lshrrev_b32 v7, 1, v6
    buffer_load_dwordx4 v241, s[28:31], s97 offen offset:1024 lds
    v_lshl_add_u32 v7, v5, 1, v7
    v_add_u32 v7, 32, v7
    v_and_b32 v8, 1, v7
    v_bfe_u32 v136, v7, 1, 2
    buffer_load_dwordx4 v242, s[28:31], s97 offen offset:2048 lds
    v_lshl_add_u32 v136, v8, 2, v136
    v_lshlrev_b32 v136, 6, v136
    v_lshrrev_b32 v7, 3, v7
    v_lshl_add_u32 v136, v7, 9, v136
    v_bitop3_b32 v8, v7, 3, s3 bitop3:0x6a
    buffer_load_dwordx4 v243, s[28:31], s97 offen offset:3072 lds
    v_lshl_add_u32 v20, v8, 4, v136
    v_add_u32 v20, 92160, v20
    v_and_b32 v8, 1, v6
    v_xor_b32 v8, 1, v8
    s_waitcnt vmcnt(10)
    s_barrier
    s_mul_i32 s16, s97, 3072
    s_add_u32 m0, s60, 24576
    s_add_u32 s99, s16, s62
    buffer_load_dwordx4 v244, s[32:35], s99 offen offset:0 lds
    v_lshl_add_u32 v20, v8, 3, v20
    s_waitcnt lgkmcnt(0)
    s_and_b32 s78, s92, 0xffff0000
    s_lshl_b32 s92, s92, 16
    buffer_load_dwordx4 v245, s[32:35], s99 offen offset:1024 lds
    s_bitcmp1_b32 s90, 0
    s_cselect_b32 s92, s78, s92
    v_lshlrev_b32 v7, 3, v6
    v_sub_u32 v7, v7, v5
    v_subrev_u32 v7, 9, v7
    buffer_load_dwordx4 v246, s[32:35], s99 offen offset:2048 lds
    v_and_b32 v8, 1, v7
    v_xor_b32 v8, 1, v8
    v_lshlrev_b32 v8, 4, v8
    v_lshrrev_b32 v8, v8, s92
    s_add_u32 m0, s61, 36864
    s_add_u32 s16, s16, s63
    buffer_load_dwordx4 v244, s[32:35], s16 offen offset:0 lds
    v_ashrrev_i32 v7, 1, v7
    v_cmp_eq_u32 vcc, 0, v7
    s_nop 1
    v_cndmask_b32 v236, 0, v8, vcc
    v_cmp_eq_u32 vcc, 1, v7
    buffer_load_dwordx4 v245, s[32:35], s16 offen offset:1024 lds
    s_nop 0
    v_cndmask_b32 v237, 0, v8, vcc
    v_cmp_eq_u32 vcc, 2, v7
    s_nop 1
    v_cndmask_b32 v238, 0, v8, vcc
    v_cmp_eq_u32 vcc, 3, v7
    buffer_load_dwordx4 v246, s[32:35], s16 offen offset:2048 lds
    s_nop 0
    v_cndmask_b32 v239, 0, v8, vcc
    s_and_b32 s95, s76, 3
    s_mul_i32 s95, s95, 0x22222222
    s_add_u32 s95, s95, 0x76543210
    s_add_u32 s97, s98, s0
    s_lshr_b64 s[0:1], s[0:1], 4
    s_and_b32 s97, s97, 15
    s_add_u32 m0, s87, 36864
    s_lshl_b32 s97, s97, 7
    buffer_load_dwordx4 v240, s[28:31], s97 offen offset:0 lds
    s_bfe_u32 s100, s95, 0x3001c
    s_lshl_b32 s100, s100, 18
    s_bfe_u32 s95, s95, 0x30018
    s_lshl_b32 s95, s95, 18
    buffer_load_dwordx4 v241, s[28:31], s97 offen offset:1024 lds
    v_lshrrev_b32 v136, 4, v0
    v_lshlrev_b32 v136, 1, v136
    v_and_b32 v137, 7, v0
    v_xor_b32 v136, v136, v137
    buffer_load_dwordx4 v242, s[28:31], s97 offen offset:2048 lds
    v_lshlrev_b32 v136, 4, v136
    v_lshrrev_b32 v137, 3, v0
    v_lshl_add_u32 v136, v137, 11, v136
    s_lshl_b32 s78, s77, 7
    buffer_load_dwordx4 v243, s[28:31], s97 offen offset:3072 lds
    s_lshl_b32 s79, s3, 14
    s_add_u32 s78, s78, s79
    v_add_u32 v17, s78, v136
    s_waitcnt vmcnt(10)
    s_barrier
    s_mul_i32 s16, s97, 3072
    s_add_u32 m0, s60, 49152
    s_add_u32 s99, s16, s62
    buffer_load_dwordx4 v244, s[32:35], s99 offen offset:0 lds
    v_add_u32 v5, s94, v15
    ds_read_b128 v[140:143], v5 offset:32
    ds_read_b32 v156, v5 offset:48
    ds_read_b128 v[144:147], v5 offset:1056
    buffer_load_dwordx4 v245, s[32:35], s99 offen offset:1024 lds
    ds_read_b32 v157, v5 offset:1072
    ds_read_b128 v[148:151], v5 offset:2080
    ds_read_b32 v158, v5 offset:2096
    buffer_load_dwordx4 v246, s[32:35], s99 offen offset:2048 lds
    ds_read_b128 v[152:155], v5 offset:3104
    ds_read_b32 v159, v5 offset:3120
    v_lshrrev_b32 v6, 3, v0
    v_mul_u32_u24 v6, 4160, v6
    s_add_u32 m0, s61, 61440
    s_add_u32 s16, s16, s63
    buffer_load_dwordx4 v244, s[32:35], s16 offen offset:0 lds
    v_and_b32 v7, 7, v0
    v_lshl_add_u32 v6, v7, 2, v6
    v_add_u32 v6, s94, v6
    buffer_load_dwordx4 v245, s[32:35], s16 offen offset:1024 lds
    v_mov_b32 v7, 0
    s_waitcnt lgkmcnt(0)
    v_readfirstlane_b32 s93, v140
    s_nop 0
    s_lshl_b32 s93, s93, 16
    buffer_load_dwordx4 v246, s[32:35], s16 offen offset:2048 lds
    s_nop 0
    v_writelane_b32 v7, s93, 15
    v_alignbit_b32 v140, v141, v140, 16
    v_alignbit_b32 v141, v142, v141, 16
    s_add_u32 s97, s98, s0
    s_lshr_b64 s[0:1], s[0:1], 4
    s_and_b32 s97, s97, 15
    s_add_u32 m0, s87, 0
    s_lshl_b32 s97, s97, 7
    buffer_load_dwordx4 v240, s[28:31], s97 offen offset:0 lds
    v_alignbit_b32 v142, v143, v142, 16
    v_alignbit_b32 v143, v156, v143, 16
    v_alignbit_b32 v144, v145, v144, 16
    v_alignbit_b32 v145, v146, v145, 16
    buffer_load_dwordx4 v241, s[28:31], s97 offen offset:1024 lds
    v_alignbit_b32 v146, v147, v146, 16
    v_alignbit_b32 v147, v157, v147, 16
    v_alignbit_b32 v148, v149, v148, 16
    buffer_load_dwordx4 v242, s[28:31], s97 offen offset:2048 lds
    v_alignbit_b32 v149, v150, v149, 16
    v_alignbit_b32 v150, v151, v150, 16
    v_alignbit_b32 v151, v158, v151, 16
    v_alignbit_b32 v152, v153, v152, 16
    buffer_load_dwordx4 v243, s[28:31], s97 offen offset:3072 lds
    v_alignbit_b32 v153, v154, v153, 16
    v_alignbit_b32 v154, v155, v154, 16
    v_alignbit_b32 v155, v159, v155, 16
    s_waitcnt vmcnt(10)
    s_barrier
    s_mul_i32 s16, s97, 3072
    s_add_u32 m0, s60, 0
    s_add_u32 s99, s16, s62
    buffer_load_dwordx4 v244, s[32:35], s99 offen offset:0 lds
    buffer_load_dwordx4 v245, s[32:35], s99 offen offset:1024 lds
    buffer_load_dwordx4 v246, s[32:35], s99 offen offset:2048 lds
    s_add_u32 m0, s61, 12288
    s_add_u32 s16, s16, s63
    buffer_load_dwordx4 v244, s[32:35], s16 offen offset:0 lds
    buffer_load_dwordx4 v245, s[32:35], s16 offen offset:1024 lds
    buffer_load_dwordx4 v246, s[32:35], s16 offen offset:2048 lds
    s_mov_b64 exec, 0x1ff
    buffer_load_dword v136, v33, s[68:71], 0 offen sc1
    buffer_load_dword v137, v34, s[52:55], 0 offen sc1
    s_mov_b64 exec, -1
    buffer_load_dwordx4 v[212:215], v9, s[56:59], 0 offen offset:0 nt
    buffer_load_dwordx4 v[216:219], v9, s[56:59], 0 offen offset:2048 nt
    buffer_load_dwordx4 v[220:223], v9, s[56:59], s96 offen offset:0 nt
    buffer_load_dwordx4 v[224:227], v9, s[56:59], s96 offen offset:2048 nt
    s_waitcnt vmcnt(12)
    s_waitcnt vmcnt(6)
    s_barrier
    s_waitcnt vmcnt(4)
    s_branch LA_j
LA_c2:
    s_waitcnt vmcnt(10)
    s_barrier
    s_mul_i32 s16, s97, 3072
    s_add_u32 m0, s60, 49152
    s_add_u32 s99, s16, s62
    buffer_load_dwordx4 v244, s[32:35], s99 offen offset:0 lds
    buffer_load_dwordx4 v245, s[32:35], s99 offen offset:1024 lds
    buffer_load_dwordx4 v246, s[32:35], s99 offen offset:2048 lds
    s_add_u32 m0, s61, 61440
    s_add_u32 s16, s16, s63
    buffer_load_dwordx4 v244, s[32:35], s16 offen offset:0 lds
    buffer_load_dwordx4 v245, s[32:35], s16 offen offset:1024 lds
    buffer_load_dwordx4 v246, s[32:35], s16 offen offset:2048 lds
    s_add_u32 s97, s98, s0
    s_lshr_b64 s[0:1], s[0:1], 4
    s_and_b32 s97, s97, 15
    s_add_u32 m0, s87, 0
    s_lshl_b32 s97, s97, 7
    buffer_load_dwordx4 v240, s[28:31], s97 offen offset:0 lds
    buffer_load_dwordx4 v241, s[28:31], s97 offen offset:1024 lds
    buffer_load_dwordx4 v242, s[28:31], s97 offen offset:2048 lds
    buffer_load_dwordx4 v243, s[28:31], s97 offen offset:3072 lds
    s_waitcnt vmcnt(10)
    s_barrier
    s_mul_i32 s16, s97, 3072
    s_add_u32 m0, s60, 0
    s_add_u32 s99, s16, s62
    buffer_load_dwordx4 v244, s[32:35], s99 offen offset:0 lds
    buffer_load_dwordx4 v245, s[32:35], s99 offen offset:1024 lds
    buffer_load_dwordx4 v246, s[32:35], s99 offen offset:2048 lds
    s_add_u32 m0, s61, 12288
    s_add_u32 s16, s16, s63
    buffer_load_dwordx4 v244, s[32:35], s16 offen offset:0 lds
    buffer_load_dwordx4 v245, s[32:35], s16 offen offset:1024 lds
    buffer_load_dwordx4 v246, s[32:35], s16 offen offset:2048 lds
    s_add_u32 s97, s98, s0
    s_lshr_b64 s[0:1], s[0:1], 4
    s_and_b32 s97, s97, 15
    s_add_u32 m0, s87, 18432
    s_lshl_b32 s97, s97, 7
    buffer_load_dwordx4 v240, s[28:31], s97 offen offset:0 lds
    buffer_load_dwordx4 v241, s[28:31], s97 offen offset:1024 lds
    buffer_load_dwordx4 v242, s[28:31], s97 offen offset:2048 lds
    buffer_load_dwordx4 v243, s[28:31], s97 offen offset:3072 lds
    s_waitcnt vmcnt(10)
    s_barrier
    s_mul_i32 s16, s97, 3072
    s_add_u32 m0, s60, 24576
    s_add_u32 s99, s16, s62
    buffer_load_dwordx4 v244, s[32:35], s99 offen offset:0 lds
    buffer_load_dwordx4 v245, s[32:35], s99 offen offset:1024 lds
    buffer_load_dwordx4 v246, s[32:35], s99 offen offset:2048 lds
    s_add_u32 m0, s61, 36864
    s_add_u32 s16, s16, s63
    buffer_load_dwordx4 v244, s[32:35], s16 offen offset:0 lds
    buffer_load_dwordx4 v245, s[32:35], s16 offen offset:1024 lds
    buffer_load_dwordx4 v246, s[32:35], s16 offen offset:2048 lds
    s_add_u32 m0, s86, 129536
    s_mov_b32 s89, 0
    buffer_load_dwordx4 v10, s[36:39], s89 offen nt lds
    s_add_u32 m0, s86, 145920
    s_mov_b32 s89, 0
    buffer_load_dwordx4 v10, s[40:43], s89 offen nt lds
    s_add_u32 m0, s86, 133632
    s_mov_b32 s89, 65536
    buffer_load_dwordx4 v10, s[36:39], s89 offen nt lds
    s_add_u32 m0, s86, 150016
    s_mov_b32 s89, 65536
    buffer_load_dwordx4 v10, s[40:43], s89 offen nt lds
    s_add_u32 m0, s86, 137728
    s_mov_b32 s89, 131072
    buffer_load_dwordx4 v10, s[36:39], s89 offen nt lds
    s_add_u32 m0, s86, 154112
    s_mov_b32 s89, 131072
    buffer_load_dwordx4 v10, s[40:43], s89 offen nt lds
    s_add_u32 m0, s86, 141824
    s_mov_b32 s89, 196608
    buffer_load_dwordx4 v10, s[36:39], s89 offen nt lds
    s_add_u32 m0, s86, 158208
    s_mov_b32 s89, 196608
    buffer_load_dwordx4 v10, s[40:43], s89 offen nt lds
    s_mov_b64 exec, 0xff
    s_lshl_b32 s82, s3, 7
    s_add_u32 m0, s82, 129024
    s_mov_b32 s89, 0
    buffer_load_dwordx4 v11, s[36:39], s89 offen nt lds
    s_lshl_b32 s83, s74, 9
    s_add_u32 s83, s83, s82
    s_and_b32 s89, s3, 2
    s_lshl_b32 s89, s89, 3
    s_add_u32 s82, s82, s89
    s_add_u32 m0, s82, 162816
    s_add_u32 s89, s83, 0
    buffer_load_dwordx4 v15, s[44:47], s89 offen  lds
    s_mov_b64 exec, -1
    s_add_u32 s97, s98, s0
    s_lshr_b64 s[0:1], s[0:1], 4
    s_and_b32 s97, s97, 15
    s_add_u32 m0, s87, 36864
    s_lshl_b32 s97, s97, 7
    buffer_load_dwordx4 v240, s[28:31], s97 offen offset:0 lds
    buffer_load_dwordx4 v241, s[28:31], s97 offen offset:1024 lds
    buffer_load_dwordx4 v242, s[28:31], s97 offen offset:2048 lds
    buffer_load_dwordx4 v243, s[28:31], s97 offen offset:3072 lds
    s_waitcnt vmcnt(20)
    s_barrier
    s_mul_i32 s16, s97, 3072
    s_add_u32 m0, s60, 49152
    s_add_u32 s99, s16, s62
    buffer_load_dwordx4 v244, s[32:35], s99 offen offset:0 lds
    buffer_load_dwordx4 v245, s[32:35], s99 offen offset:1024 lds
    buffer_load_dwordx4 v246, s[32:35], s99 offen offset:2048 lds
    s_add_u32 m0, s61, 61440
    s_add_u32 s16, s16, s63
    buffer_load_dwordx4 v244, s[32:35], s16 offen offset:0 lds
    buffer_load_dwordx4 v245, s[32:35], s16 offen offset:1024 lds
    buffer_load_dwordx4 v246, s[32:35], s16 offen offset:2048 lds
    s_add_u32 s97, s98, s0
    s_lshr_b64 s[0:1], s[0:1], 4
    s_and_b32 s97, s97, 15
    s_add_u32 m0, s87, 0
    s_lshl_b32 s97, s97, 7
    buffer_load_dwordx4 v240, s[28:31], s97 offen offset:0 lds
    buffer_load_dwordx4 v241, s[28:31], s97 offen offset:1024 lds
    buffer_load_dwordx4 v242, s[28:31], s97 offen offset:2048 lds
    buffer_load_dwordx4 v243, s[28:31], s97 offen offset:3072 lds
    s_waitcnt vmcnt(10)
    s_barrier
    s_mul_i32 s16, s97, 3072
    s_add_u32 m0, s60, 0
    s_add_u32 s99, s16, s62
    buffer_load_dwordx4 v244, s[32:35], s99 offen offset:0 lds
    ds_read_b128 v[84:87], v14 offset:0
    ds_read_b128 v[88:91], v14 offset:16
    ds_read_b64 v[40:41], v16 offset:0
    buffer_load_dwordx4 v245, s[32:35], s99 offen offset:1024 lds
    ds_read_b64 v[42:43], v231 offset:256
    ds_read_b64 v[44:45], v16 offset:256
    buffer_load_dwordx4 v246, s[32:35], s99 offen offset:2048 lds
    ds_read_b64 v[46:47], v16 offset:512
    ds_read_b64 v[48:49], v231 offset:512
    s_add_u32 m0, s61, 12288
    s_add_u32 s16, s16, s63
    buffer_load_dwordx4 v244, s[32:35], s16 offen offset:0 lds
    ds_read_b64 v[50:51], v16 offset:768
    ds_read_b64 v[52:53], v231 offset:768
    buffer_load_dwordx4 v245, s[32:35], s16 offen offset:1024 lds
    ds_read_b64 v[54:55], v16 offset:1024
    ds_read_b64 v[56:57], v231 offset:1024
    buffer_load_dwordx4 v246, s[32:35], s16 offen offset:2048 lds
    ds_read_b64 v[58:59], v16 offset:1280
    ds_read_b64 v[60:61], v231 offset:1280
    s_add_u32 s97, s98, s0
    s_lshr_b64 s[0:1], s[0:1], 4
    s_and_b32 s97, s97, 15
    s_add_u32 m0, s87, 18432
    s_lshl_b32 s97, s97, 7
    buffer_load_dwordx4 v240, s[28:31], s97 offen offset:0 lds
    ds_read_b64 v[68:69], v16 offset:16896
    ds_read_b64 v[70:71], v231 offset:16896
    buffer_load_dwordx4 v241, s[28:31], s97 offen offset:1024 lds
    ds_read_b64 v[72:73], v16 offset:17152
    ds_read_b64 v[74:75], v231 offset:17152
    buffer_load_dwordx4 v242, s[28:31], s97 offen offset:2048 lds
    ds_read_b64 v[76:77], v16 offset:17408
    ds_read_b64 v[78:79], v231 offset:17408
    buffer_load_dwordx4 v243, s[28:31], s97 offen offset:3072 lds
    ds_read_b64 v[80:81], v16 offset:17664
    ds_read_b64 v[82:83], v231 offset:17664
    s_waitcnt vmcnt(10)
    s_waitcnt lgkmcnt(0)
    s_barrier
    s_mul_i32 s16, s97, 3072
    s_add_u32 m0, s60, 24576
    s_add_u32 s99, s16, s62
    buffer_load_dwordx4 v244, s[32:35], s99 offen offset:0 lds
    v_lshlrev_b32 v160, 16, v40
    v_lshlrev_b32 v161, 16, v42
    v_lshlrev_b32 v162, 16, v44
    v_lshlrev_b32 v163, 16, v46
    v_lshlrev_b32 v164, 16, v48
    buffer_load_dwordx4 v245, s[32:35], s99 offen offset:1024 lds
    v_lshlrev_b32 v165, 16, v50
    v_lshlrev_b32 v166, 16, v52
    v_lshlrev_b32 v167, 16, v54
    v_lshlrev_b32 v168, 16, v56
    v_lshlrev_b32 v169, 16, v58
    buffer_load_dwordx4 v246, s[32:35], s99 offen offset:2048 lds
    v_lshlrev_b32 v170, 16, v60
    v_lshlrev_b32 v172, 16, v84
    v_and_b32 v173, 0xffff0000, v84
    v_lshlrev_b32 v174, 16, v85
    v_and_b32 v175, 0xffff0000, v85
    s_add_u32 m0, s61, 36864
    s_add_u32 s16, s16, s63
    buffer_load_dwordx4 v244, s[32:35], s16 offen offset:0 lds
    v_lshlrev_b32 v176, 16, v68
    v_lshlrev_b32 v177, 16, v70
    v_lshlrev_b32 v178, 16, v72
    v_lshlrev_b32 v179, 16, v74
    v_lshlrev_b32 v180, 16, v76
    buffer_load_dwordx4 v245, s[32:35], s16 offen offset:1024 lds
    v_lshlrev_b32 v181, 16, v78
    v_lshlrev_b32 v182, 16, v80
    v_lshlrev_b32 v183, 16, v82
    v_mul_f32 v184, v160, v175
    v_mul_f32 v185, v161, v175
    buffer_load_dwordx4 v246, s[32:35], s16 offen offset:2048 lds
    v_mul_f32 v186, v162, v175
    v_mul_f32 v187, v163, v175
    v_mul_f32 v188, v164, v175
    v_mul_f32 v189, v165, v175
    v_mul_f32 v190, v166, v175
    s_lshl_b32 s88, s72, 1
    s_lshr_b32 s89, s3, 1
    s_add_u32 s88, s88, s89
    s_lshl_b32 s88, s88, 4
    s_add_u32 s88, s88, s73
    s_lshl_b32 s88, s88, 1
    s_and_b32 s89, s3, 1
    s_add_u32 s88, s88, s89
    s_lshl_b32 s88, s88, 11
    s_add_u32 s88, s88, 14680064
    v_mov_b32 v192, -1
    v_mov_b32 v193, -1
    v_mov_b32 v194, -1
    v_mov_b32 v195, -1
    buffer_store_dwordx4 v[192:195], v15, s[52:55], s88 offen offset:0 sc1
    v_mul_f32 v191, v167, v175
    v_fmac_f32 v184, v161, v174
    v_fmac_f32 v185, v162, v174
    v_fmac_f32 v186, v163, v174
    v_fmac_f32 v187, v164, v174
    buffer_store_dwordx4 v[192:195], v15, s[52:55], s88 offen offset:1024 sc1
    v_fmac_f32 v188, v165, v174
    v_fmac_f32 v189, v166, v174
    v_fmac_f32 v190, v167, v174
    v_fmac_f32 v191, v168, v174
    v_fmac_f32 v184, v162, v173
    s_add_u32 s97, s98, s0
    s_lshr_b64 s[0:1], s[0:1], 4
    s_and_b32 s97, s97, 15
    s_add_u32 m0, s87, 36864
    s_lshl_b32 s97, s97, 7
    buffer_load_dwordx4 v240, s[28:31], s97 offen offset:0 lds
    v_fmac_f32 v185, v163, v173
    v_fmac_f32 v186, v164, v173
    v_fmac_f32 v187, v165, v173
    v_fmac_f32 v188, v166, v173
    v_fmac_f32 v189, v167, v173
    buffer_load_dwordx4 v241, s[28:31], s97 offen offset:1024 lds
    v_fmac_f32 v190, v168, v173
    v_fmac_f32 v191, v169, v173
    v_fmac_f32 v184, v163, v172
    v_fmac_f32 v185, v164, v172
    v_fmac_f32 v186, v165, v172
    buffer_load_dwordx4 v242, s[28:31], s97 offen offset:2048 lds
    v_fmac_f32 v187, v166, v172
    v_fmac_f32 v188, v167, v172
    v_fmac_f32 v189, v168, v172
    v_fmac_f32 v190, v169, v172
    v_fmac_f32 v191, v170, v172
    buffer_load_dwordx4 v243, s[28:31], s97 offen offset:3072 lds
    v_mul_f32 v184, v184, v176
    v_mul_f32 v185, v185, v177
    v_mul_f32 v186, v186, v178
    v_mul_f32 v187, v187, v179
    v_mul_f32 v188, v188, v180
    v_mul_f32 v189, v189, v181
    v_mul_f32 v190, v190, v182
    v_mul_f32 v191, v191, v183
    v_cvt_pk_bf16_f32 v100, v191, v190
    v_cvt_pk_bf16_f32 v101, v189, v188
    v_cvt_pk_bf16_f32 v102, v187, v186
    v_cvt_pk_bf16_f32 v103, v185, v184
    s_mov_b32 s89, 0
    buffer_store_dwordx4 v[100:103], v12, s[52:55], s89 offen sc1
    v_and_b32 v160, 0xffff0000, v40
    v_and_b32 v161, 0xffff0000, v42
    v_and_b32 v162, 0xffff0000, v44
    v_and_b32 v163, 0xffff0000, v46
    v_and_b32 v164, 0xffff0000, v48
    v_and_b32 v165, 0xffff0000, v50
    v_and_b32 v166, 0xffff0000, v52
    v_and_b32 v167, 0xffff0000, v54
    v_and_b32 v168, 0xffff0000, v56
    v_and_b32 v169, 0xffff0000, v58
    v_and_b32 v170, 0xffff0000, v60
    v_lshlrev_b32 v172, 16, v86
    v_and_b32 v173, 0xffff0000, v86
    v_lshlrev_b32 v174, 16, v87
    v_and_b32 v175, 0xffff0000, v87
    v_and_b32 v176, 0xffff0000, v68
    v_and_b32 v177, 0xffff0000, v70
    v_and_b32 v178, 0xffff0000, v72
    v_and_b32 v179, 0xffff0000, v74
    v_and_b32 v180, 0xffff0000, v76
    v_and_b32 v181, 0xffff0000, v78
    v_and_b32 v182, 0xffff0000, v80
    v_and_b32 v183, 0xffff0000, v82
    s_waitcnt vmcnt(13)
    s_barrier
    s_mul_i32 s16, s97, 3072
    s_add_u32 m0, s60, 49152
    s_add_u32 s99, s16, s62
    buffer_load_dwordx4 v244, s[32:35], s99 offen offset:0 lds
    v_mul_f32 v184, v160, v175
    v_mul_f32 v185, v161, v175
    v_mul_f32 v186, v162, v175
    v_mul_f32 v187, v163, v175
    v_mul_f32 v188, v164, v175
    buffer_load_dwordx4 v245, s[32:35], s99 offen offset:1024 lds
    v_mul_f32 v189, v165, v175
    v_mul_f32 v190, v166, v175
    v_mul_f32 v191, v167, v175
    v_fmac_f32 v184, v161, v174
    v_fmac_f32 v185, v162, v174
    buffer_load_dwordx4 v246, s[32:35], s99 offen offset:2048 lds
    v_fmac_f32 v186, v163, v174
    v_fmac_f32 v187, v164, v174
    v_fmac_f32 v188, v165, v174
    v_fmac_f32 v189, v166, v174
    v_fmac_f32 v190, v167, v174
    s_add_u32 m0, s61, 61440
    s_add_u32 s16, s16, s63
    buffer_load_dwordx4 v244, s[32:35], s16 offen offset:0 lds
    v_fmac_f32 v191, v168, v174
    v_fmac_f32 v184, v162, v173
    v_fmac_f32 v185, v163, v173
    v_fmac_f32 v186, v164, v173
    v_fmac_f32 v187, v165, v173
    buffer_load_dwordx4 v245, s[32:35], s16 offen offset:1024 lds
    v_fmac_f32 v188, v166, v173
    v_fmac_f32 v189, v167, v173
    v_fmac_f32 v190, v168, v173
    v_fmac_f32 v191, v169, v173
    v_fmac_f32 v184, v163, v172
    buffer_load_dwordx4 v246, s[32:35], s16 offen offset:2048 lds
    v_fmac_f32 v185, v164, v172
    v_fmac_f32 v186, v165, v172
    v_fmac_f32 v187, v166, v172
    v_fmac_f32 v188, v167, v172
    v_fmac_f32 v189, v168, v172
    s_add_u32 s97, s98, s0
    s_lshr_b64 s[0:1], s[0:1], 4
    s_and_b32 s97, s97, 15
    s_add_u32 m0, s87, 0
    s_lshl_b32 s97, s97, 7
    buffer_load_dwordx4 v240, s[28:31], s97 offen offset:0 lds
    v_fmac_f32 v190, v169, v172
    v_fmac_f32 v191, v170, v172
    v_mul_f32 v184, v184, v176
    v_mul_f32 v185, v185, v177
    v_mul_f32 v186, v186, v178
    buffer_load_dwordx4 v241, s[28:31], s97 offen offset:1024 lds
    v_mul_f32 v187, v187, v179
    v_mul_f32 v188, v188, v180
    v_mul_f32 v189, v189, v181
    v_mul_f32 v190, v190, v182
    v_mul_f32 v191, v191, v183
    buffer_load_dwordx4 v242, s[28:31], s97 offen offset:2048 lds
    v_cvt_pk_bf16_f32 v104, v191, v190
    v_cvt_pk_bf16_f32 v105, v189, v188
    v_cvt_pk_bf16_f32 v106, v187, v186
    v_cvt_pk_bf16_f32 v107, v185, v184
    s_mov_b32 s89, 16384
    buffer_store_dwordx4 v[104:107], v12, s[52:55], s89 offen sc1
    buffer_load_dwordx4 v243, s[28:31], s97 offen offset:3072 lds
    v_lshlrev_b32 v160, 16, v41
    v_lshlrev_b32 v161, 16, v43
    v_lshlrev_b32 v162, 16, v45
    v_lshlrev_b32 v163, 16, v47
    v_lshlrev_b32 v164, 16, v49
    v_lshlrev_b32 v165, 16, v51
    v_lshlrev_b32 v166, 16, v53
    v_lshlrev_b32 v167, 16, v55
    v_lshlrev_b32 v168, 16, v57
    v_lshlrev_b32 v169, 16, v59
    v_lshlrev_b32 v170, 16, v61
    v_lshlrev_b32 v172, 16, v88
    v_and_b32 v173, 0xffff0000, v88
    v_lshlrev_b32 v174, 16, v89
    v_and_b32 v175, 0xffff0000, v89
    v_lshlrev_b32 v176, 16, v69
    v_lshlrev_b32 v177, 16, v71
    v_lshlrev_b32 v178, 16, v73
    v_lshlrev_b32 v179, 16, v75
    v_lshlrev_b32 v180, 16, v77
    v_lshlrev_b32 v181, 16, v79
    v_lshlrev_b32 v182, 16, v81
    v_lshlrev_b32 v183, 16, v83
    v_mul_f32 v184, v160, v175
    v_mul_f32 v185, v161, v175
    v_mul_f32 v186, v162, v175
    v_mul_f32 v187, v163, v175
    v_mul_f32 v188, v164, v175
    v_mul_f32 v189, v165, v175
    v_mul_f32 v190, v166, v175
    v_mul_f32 v191, v167, v175
    v_fmac_f32 v184, v161, v174
    v_fmac_f32 v185, v162, v174
    v_fmac_f32 v186, v163, v174
    v_fmac_f32 v187, v164, v174
    v_fmac_f32 v188, v165, v174
    v_fmac_f32 v189, v166, v174
    v_fmac_f32 v190, v167, v174
    v_fmac_f32 v191, v168, v174
    v_fmac_f32 v184, v162, v173
    v_fmac_f32 v185, v163, v173
    v_fmac_f32 v186, v164, v173
    v_fmac_f32 v187, v165, v173
    v_fmac_f32 v188, v166, v173
    v_fmac_f32 v189, v167, v173
    v_fmac_f32 v190, v168, v173
    s_waitcnt vmcnt(12)
    s_barrier
    s_mul_i32 s16, s97, 3072
    s_add_u32 m0, s60, 0
    s_add_u32 s99, s16, s62
    buffer_load_dwordx4 v244, s[32:35], s99 offen offset:0 lds
    v_fmac_f32 v191, v169, v173
    v_fmac_f32 v184, v163, v172
    v_fmac_f32 v185, v164, v172
    v_fmac_f32 v186, v165, v172
    v_fmac_f32 v187, v166, v172
    buffer_load_dwordx4 v245, s[32:35], s99 offen offset:1024 lds
    v_fmac_f32 v188, v167, v172
    v_fmac_f32 v189, v168, v172
    v_fmac_f32 v190, v169, v172
    v_fmac_f32 v191, v170, v172
    v_mul_f32 v184, v184, v176
    buffer_load_dwordx4 v246, s[32:35], s99 offen offset:2048 lds
    v_mul_f32 v185, v185, v177
    v_mul_f32 v186, v186, v178
    v_mul_f32 v187, v187, v179
    v_mul_f32 v188, v188, v180
    v_mul_f32 v189, v189, v181
    s_add_u32 m0, s61, 12288
    s_add_u32 s16, s16, s63
    buffer_load_dwordx4 v244, s[32:35], s16 offen offset:0 lds
    v_mul_f32 v190, v190, v182
    v_mul_f32 v191, v191, v183
    v_cvt_pk_bf16_f32 v108, v191, v190
    v_cvt_pk_bf16_f32 v109, v189, v188
    v_cvt_pk_bf16_f32 v110, v187, v186
    buffer_load_dwordx4 v245, s[32:35], s16 offen offset:1024 lds
    v_cvt_pk_bf16_f32 v111, v185, v184
    s_mov_b32 s89, 32768
    buffer_store_dwordx4 v[108:111], v12, s[52:55], s89 offen sc1
    v_and_b32 v160, 0xffff0000, v41
    v_and_b32 v161, 0xffff0000, v43
    v_and_b32 v162, 0xffff0000, v45
    buffer_load_dwordx4 v246, s[32:35], s16 offen offset:2048 lds
    v_and_b32 v163, 0xffff0000, v47
    v_and_b32 v164, 0xffff0000, v49
    v_and_b32 v165, 0xffff0000, v51
    v_and_b32 v166, 0xffff0000, v53
    v_and_b32 v167, 0xffff0000, v55
    s_add_u32 s97, s98, s0
    s_lshr_b64 s[0:1], s[0:1], 4
    s_and_b32 s97, s97, 15
    s_add_u32 m0, s87, 18432
    s_lshl_b32 s97, s97, 7
    buffer_load_dwordx4 v240, s[28:31], s97 offen offset:0 lds
    v_and_b32 v168, 0xffff0000, v57
    v_and_b32 v169, 0xffff0000, v59
    v_and_b32 v170, 0xffff0000, v61
    v_lshlrev_b32 v172, 16, v90
    v_and_b32 v173, 0xffff0000, v90
    buffer_load_dwordx4 v241, s[28:31], s97 offen offset:1024 lds
    v_lshlrev_b32 v174, 16, v91
    v_and_b32 v175, 0xffff0000, v91
    v_and_b32 v176, 0xffff0000, v69
    v_and_b32 v177, 0xffff0000, v71
    v_and_b32 v178, 0xffff0000, v73
    buffer_load_dwordx4 v242, s[28:31], s97 offen offset:2048 lds
    v_and_b32 v179, 0xffff0000, v75
    v_and_b32 v180, 0xffff0000, v77
    v_and_b32 v181, 0xffff0000, v79
    v_and_b32 v182, 0xffff0000, v81
    v_and_b32 v183, 0xffff0000, v83
    buffer_load_dwordx4 v243, s[28:31], s97 offen offset:3072 lds
    v_mul_f32 v184, v160, v175
    v_mul_f32 v185, v161, v175
    v_mul_f32 v186, v162, v175
    v_mul_f32 v187, v163, v175
    v_mul_f32 v188, v164, v175
    v_mul_f32 v189, v165, v175
    v_mul_f32 v190, v166, v175
    v_mul_f32 v191, v167, v175
    v_fmac_f32 v184, v161, v174
    v_fmac_f32 v185, v162, v174
    v_fmac_f32 v186, v163, v174
    v_fmac_f32 v187, v164, v174
    v_fmac_f32 v188, v165, v174
    v_fmac_f32 v189, v166, v174
    v_fmac_f32 v190, v167, v174
    v_fmac_f32 v191, v168, v174
    v_fmac_f32 v184, v162, v173
    v_fmac_f32 v185, v163, v173
    v_fmac_f32 v186, v164, v173
    v_fmac_f32 v187, v165, v173
    v_fmac_f32 v188, v166, v173
    v_fmac_f32 v189, v167, v173
    v_fmac_f32 v190, v168, v173
    v_fmac_f32 v191, v169, v173
    v_fmac_f32 v184, v163, v172
    v_fmac_f32 v185, v164, v172
    v_fmac_f32 v186, v165, v172
    v_fmac_f32 v187, v166, v172
    v_fmac_f32 v188, v167, v172
    v_fmac_f32 v189, v168, v172
    v_fmac_f32 v190, v169, v172
    v_fmac_f32 v191, v170, v172
    v_mul_f32 v184, v184, v176
    v_mul_f32 v185, v185, v177
    v_mul_f32 v186, v186, v178
    v_mul_f32 v187, v187, v179
    v_mul_f32 v188, v188, v180
    v_mul_f32 v189, v189, v181
    v_mul_f32 v190, v190, v182
    v_mul_f32 v191, v191, v183
    v_cvt_pk_bf16_f32 v112, v191, v190
    v_cvt_pk_bf16_f32 v113, v189, v188
    v_cvt_pk_bf16_f32 v114, v187, v186
    v_cvt_pk_bf16_f32 v115, v185, v184
    s_mov_b32 s89, 49152
    buffer_store_dwordx4 v[112:115], v12, s[52:55], s89 offen sc1
    s_waitcnt vmcnt(12)
    s_barrier
    s_mul_i32 s16, s97, 3072
    s_add_u32 m0, s60, 24576
    s_add_u32 s99, s16, s62
    buffer_load_dwordx4 v244, s[32:35], s99 offen offset:0 lds
    s_mov_b32 s68, s24
    s_mov_b32 s69, s25
    s_mov_b32 s70, 0x100
    s_mov_b32 s71, 0x20000
    v_lshrrev_b32 v6, 5, v0
    buffer_load_dwordx4 v245, s[32:35], s99 offen offset:1024 lds
    v_and_b32 v7, 3, v0
    s_lshr_b32 s78, s90, 1
    s_lshl_b32 s78, s78, 2
    s_load_dword s92, s[14:15], s78
    v_bfe_u32 v5, v0, 2, 2
    buffer_load_dwordx4 v246, s[32:35], s99 offen offset:2048 lds
    v_lshlrev_b32 v5, 1, v5
    v_lshl_add_u32 v5, v6, 3, v5
    v_bfe_u32 v8, v0, 4, 1
    v_add_u32 v5, v5, v8
    s_add_u32 m0, s61, 36864
    s_add_u32 s16, s16, s63
    buffer_load_dwordx4 v244, s[32:35], s16 offen offset:0 lds
    s_and_b32 s78, s3, 1
    s_lshl_b32 s78, s78, 1
    v_add_u32 v8, s78, v6
    v_xor_b32 v8, v8, v7
    v_lshlrev_b32 v8, 4, v8
    buffer_load_dwordx4 v245, s[32:35], s16 offen offset:1024 lds
    v_lshl_add_u32 v5, v5, 6, v8
    v_add_u32 v35, s86, v5
    v_mov_b32 v18, 162304
    v_mov_b32 v19, 1
    buffer_load_dwordx4 v246, s[32:35], s16 offen offset:2048 lds
    v_and_b32 v5, 3, v0
    s_lshl_b32 s78, s74, 4
    s_add_u32 s78, s78, s3
    v_lshl_add_u32 v6, v5, 2, s78
    s_lshr_b32 s78, s76, 3
    s_add_u32 s97, s98, s0
    s_lshr_b64 s[0:1], s[0:1], 4
    s_and_b32 s97, s97, 15
    s_add_u32 m0, s87, 36864
    s_lshl_b32 s97, s97, 7
    buffer_load_dwordx4 v240, s[28:31], s97 offen offset:0 lds
    s_lshl_b32 s79, s3, 1
    s_add_u32 s78, s78, s79
    s_xor_b32 s78, s78, 3
    s_lshl_b32 s78, s78, 5
    s_add_u32 s79, s76, 5
    buffer_load_dwordx4 v241, s[28:31], s97 offen offset:1024 lds
    s_and_b32 s79, s79, 7
    s_lshl_b32 s79, s79, 1
    s_add_u32 s78, s78, s79
    v_mul_u32_u24 v7, 9, v5
    buffer_load_dwordx4 v242, s[28:31], s97 offen offset:2048 lds
    v_and_b32 v7, 17, v7
    v_add_u32 v7, s78, v7
    v_and_b32 v8, 4, v0
    v_cmp_eq_u32 vcc, 0, v8
    s_nop 1
    v_cndmask_b32 v6, v7, v6, vcc
    buffer_load_dwordx4 v243, s[28:31], s97 offen offset:3072 lds
    s_max_u32 s81, s72, 1
    s_sub_u32 s81, s81, 1
    s_add_u32 s79, s81, s73
    s_add_u32 s78, s81, 5
    s_waitcnt vmcnt(11)
    s_waitcnt vmcnt(10)
    s_barrier
    s_mul_i32 s16, s97, 3072
    s_add_u32 m0, s60, 49152
    s_add_u32 s99, s16, s62
    buffer_load_dwordx4 v244, s[32:35], s99 offen offset:0 lds
    s_and_b32 s78, s78, 7
    s_lshl_b32 s78, s78, 1
    s_and_b32 s80, s79, 1
    s_add_u32 s78, s78, s80
    s_andn2_b32 s79, 2, s79
    buffer_load_dwordx4 v245, s[32:35], s99 offen offset:1024 lds
    s_lshl_b32 s79, s79, 3
    s_add_u32 s78, s78, s79
    s_lshr_b32 s81, s81, 3
    s_lshr_b32 s79, s73, 2
    s_lshl_b32 s79, s79, 1
    buffer_load_dwordx4 v246, s[32:35], s99 offen offset:2048 lds
    s_add_u32 s79, s79, s81
    s_xor_b32 s79, s79, 3
    s_lshl_b32 s79, s79, 5
    s_add_u32 s78, s78, s79
    s_add_u32 m0, s61, 61440
    s_add_u32 s16, s16, s63
    buffer_load_dwordx4 v244, s[32:35], s16 offen offset:0 lds
    v_writelane_b32 v6, s78, 8
    v_and_b32 v33, 0xf0, v6
    v_lshlrev_b32 v34, 8, v6
    v_add_u32 v34, 12582912, v34
    v_and_b32 v5, 15, v0
    buffer_load_dwordx4 v245, s[32:35], s16 offen offset:1024 lds
    v_lshrrev_b32 v6, 4, v0
    v_add_u32 v7, 9, v5
    v_and_b32 v8, 1, v7
    v_mul_u32_u24 v8, 4160, v8
    buffer_load_dwordx4 v246, s[32:35], s16 offen offset:2048 lds
    v_lshrrev_b32 v7, 1, v7
    v_lshl_add_u32 v8, v7, 2, v8
    v_lshlrev_b32 v7, 4, v6
    v_sub_u32 v8, v8, v7
    s_add_u32 s78, s94, 32
    s_add_u32 s97, s98, s0
    s_lshr_b64 s[0:1], s[0:1], 4
    s_and_b32 s97, s97, 15
    s_add_u32 m0, s87, 0
    s_lshl_b32 s97, s97, 7
    buffer_load_dwordx4 v240, s[28:31], s97 offen offset:0 lds
    v_add_u32 v21, s78, v8
    v_add_u32 v22, 1024, v21
    v_add_u32 v23, 2048, v21
    v_add_u32 v24, 3072, v21
    v_lshl_add_u32 v7, v5, 1, v6
    buffer_load_dwordx4 v241, s[28:31], s97 offen offset:1024 lds
    v_add_u32 v7, 30, v7
    v_and_b32 v8, 1, v7
    v_bfe_u32 v136, v7, 1, 2
    v_lshl_add_u32 v136, v8, 2, v136
    buffer_load_dwordx4 v242, s[28:31], s97 offen offset:2048 lds
    v_lshlrev_b32 v136, 6, v136
    v_lshrrev_b32 v7, 3, v7
    v_lshl_add_u32 v136, v7, 9, v136
    v_bitop3_b32 v8, v7, 3, s3 bitop3:0x6a
    v_lshl_add_u32 v25, v8, 4, v136
    buffer_load_dwordx4 v243, s[28:31], s97 offen offset:3072 lds
    v_add_u32 v25, 92160, v25
    v_subrev_u32 v7, 1, v7
    v_bitop3_b32 v8, v7, 3, s3 bitop3:0x6a
    v_lshl_add_u32 v27, v8, 4, v136
    s_waitcnt vmcnt(10)
    s_barrier
    s_mul_i32 s16, s97, 3072
    s_add_u32 m0, s60, 0
    s_add_u32 s99, s16, s62
    buffer_load_dwordx4 v244, s[32:35], s99 offen offset:0 lds
    v_add_u32 v27, 91648, v27
    v_subrev_u32 v7, 1, v7
    v_bitop3_b32 v8, v7, 3, s3 bitop3:0x6a
    v_lshl_add_u32 v29, v8, 4, v136
    buffer_load_dwordx4 v245, s[32:35], s99 offen offset:1024 lds
    v_add_u32 v29, 91136, v29
    v_subrev_u32 v7, 1, v7
    v_bitop3_b32 v8, v7, 3, s3 bitop3:0x6a
    buffer_load_dwordx4 v246, s[32:35], s99 offen offset:2048 lds
    v_lshl_add_u32 v31, v8, 4, v136
    v_add_u32 v31, 90624, v31
    v_lshl_add_u32 v7, v5, 1, v6
    s_add_u32 m0, s61, 12288
    s_add_u32 s16, s16, s63
    buffer_load_dwordx4 v244, s[32:35], s16 offen offset:0 lds
    v_add_u32 v7, 26, v7
    v_and_b32 v8, 1, v7
    v_bfe_u32 v136, v7, 1, 2
    v_lshl_add_u32 v136, v8, 2, v136
    buffer_load_dwordx4 v245, s[32:35], s16 offen offset:1024 lds
    v_lshlrev_b32 v136, 6, v136
    v_lshrrev_b32 v7, 3, v7
    v_lshl_add_u32 v136, v7, 9, v136
    buffer_load_dwordx4 v246, s[32:35], s16 offen offset:2048 lds
    v_bitop3_b32 v8, v7, 3, s3 bitop3:0x6a
    v_lshl_add_u32 v26, v8, 4, v136
    v_add_u32 v26, 92160, v26
    s_add_u32 m0, s94, 32
    s_lshl_b32 s89, s90, 12
    buffer_load_dwordx4 v15, s[48:51], s89 offen offset:0 nt lds
    v_subrev_u32 v7, 1, v7
    v_bitop3_b32 v8, v7, 3, s3 bitop3:0x6a
    v_lshl_add_u32 v28, v8, 4, v136
    s_add_u32 m0, s94, 32
    s_lshl_b32 s89, s90, 12
    buffer_load_dwordx4 v15, s[48:51], s89 offen offset:1024 nt lds
    v_add_u32 v28, 91648, v28
    v_subrev_u32 v7, 1, v7
    v_bitop3_b32 v8, v7, 3, s3 bitop3:0x6a
    v_lshl_add_u32 v30, v8, 4, v136
    s_add_u32 m0, s94, 32
    s_lshl_b32 s89, s90, 12
    buffer_load_dwordx4 v15, s[48:51], s89 offen offset:2048 nt lds
    v_add_u32 v30, 91136, v30
    v_subrev_u32 v7, 1, v7
    v_bitop3_b32 v8, v7, 3, s3 bitop3:0x6a
    s_add_u32 m0, s94, 32
    s_lshl_b32 s89, s90, 12
    buffer_load_dwordx4 v15, s[48:51], s89 offen offset:3072 nt lds
    v_lshl_add_u32 v32, v8, 4, v136
    v_add_u32 v32, 90624, v32
    v_lshrrev_b32 v7, 1, v6
    s_add_u32 s97, s98, s0
    s_lshr_b64 s[0:1], s[0:1], 4
    s_and_b32 s97, s97, 15
    s_add_u32 m0, s87, 18432
    s_lshl_b32 s97, s97, 7
    buffer_load_dwordx4 v240, s[28:31], s97 offen offset:0 lds
    v_lshl_add_u32 v7, v5, 1, v7
    v_add_u32 v7, 32, v7
    v_and_b32 v8, 1, v7
    v_bfe_u32 v136, v7, 1, 2
    buffer_load_dwordx4 v241, s[28:31], s97 offen offset:1024 lds
    v_lshl_add_u32 v136, v8, 2, v136
    v_lshlrev_b32 v136, 6, v136
    v_lshrrev_b32 v7, 3, v7
    buffer_load_dwordx4 v242, s[28:31], s97 offen offset:2048 lds
    v_lshl_add_u32 v136, v7, 9, v136
    v_bitop3_b32 v8, v7, 3, s3 bitop3:0x6a
    v_lshl_add_u32 v20, v8, 4, v136
    buffer_load_dwordx4 v243, s[28:31], s97 offen offset:3072 lds
    v_add_u32 v20, 92160, v20
    v_and_b32 v8, 1, v6
    v_xor_b32 v8, 1, v8
    s_waitcnt vmcnt(14)
    s_barrier
    s_mul_i32 s16, s97, 3072
    s_add_u32 m0, s60, 24576
    s_add_u32 s99, s16, s62
    buffer_load_dwordx4 v244, s[32:35], s99 offen offset:0 lds
    v_lshl_add_u32 v20, v8, 3, v20
    s_waitcnt lgkmcnt(0)
    s_and_b32 s78, s92, 0xffff0000
    s_lshl_b32 s92, s92, 16
    buffer_load_dwordx4 v245, s[32:35], s99 offen offset:1024 lds
    s_bitcmp1_b32 s90, 0
    s_cselect_b32 s92, s78, s92
    v_lshlrev_b32 v7, 3, v6
    v_sub_u32 v7, v7, v5
    v_subrev_u32 v7, 9, v7
    buffer_load_dwordx4 v246, s[32:35], s99 offen offset:2048 lds
    v_and_b32 v8, 1, v7
    v_xor_b32 v8, 1, v8
    v_lshlrev_b32 v8, 4, v8
    v_lshrrev_b32 v8, v8, s92
    s_add_u32 m0, s61, 36864
    s_add_u32 s16, s16, s63
    buffer_load_dwordx4 v244, s[32:35], s16 offen offset:0 lds
    v_ashrrev_i32 v7, 1, v7
    v_cmp_eq_u32 vcc, 0, v7
    s_nop 1
    v_cndmask_b32 v236, 0, v8, vcc
    v_cmp_eq_u32 vcc, 1, v7
    buffer_load_dwordx4 v245, s[32:35], s16 offen offset:1024 lds
    s_nop 0
    v_cndmask_b32 v237, 0, v8, vcc
    v_cmp_eq_u32 vcc, 2, v7
    s_nop 1
    v_cndmask_b32 v238, 0, v8, vcc
    v_cmp_eq_u32 vcc, 3, v7
    buffer_load_dwordx4 v246, s[32:35], s16 offen offset:2048 lds
    s_nop 0
    v_cndmask_b32 v239, 0, v8, vcc
    s_and_b32 s95, s76, 3
    s_mul_i32 s95, s95, 0x22222222
    s_add_u32 s95, s95, 0x76543210
    s_add_u32 s97, s98, s0
    s_lshr_b64 s[0:1], s[0:1], 4
    s_and_b32 s97, s97, 15
    s_add_u32 m0, s87, 36864
    s_lshl_b32 s97, s97, 7
    buffer_load_dwordx4 v240, s[28:31], s97 offen offset:0 lds
    s_bfe_u32 s100, s95, 0x3001c
    s_lshl_b32 s100, s100, 18
    s_bfe_u32 s95, s95, 0x30018
    s_lshl_b32 s95, s95, 18
    buffer_load_dwordx4 v241, s[28:31], s97 offen offset:1024 lds
    v_lshrrev_b32 v136, 4, v0
    v_lshlrev_b32 v136, 1, v136
    v_and_b32 v137, 7, v0
    v_xor_b32 v136, v136, v137
    buffer_load_dwordx4 v242, s[28:31], s97 offen offset:2048 lds
    v_lshlrev_b32 v136, 4, v136
    v_lshrrev_b32 v137, 3, v0
    v_lshl_add_u32 v136, v137, 11, v136
    s_lshl_b32 s78, s77, 7
    buffer_load_dwordx4 v243, s[28:31], s97 offen offset:3072 lds
    s_lshl_b32 s79, s3, 14
    s_add_u32 s78, s78, s79
    v_add_u32 v17, s78, v136
    s_waitcnt vmcnt(10)
    s_barrier
    s_mul_i32 s16, s97, 3072
    s_add_u32 m0, s60, 49152
    s_add_u32 s99, s16, s62
    buffer_load_dwordx4 v244, s[32:35], s99 offen offset:0 lds
    v_add_u32 v5, s94, v15
    ds_read_b128 v[140:143], v5 offset:32
    ds_read_b32 v156, v5 offset:48
    ds_read_b128 v[144:147], v5 offset:1056
    buffer_load_dwordx4 v245, s[32:35], s99 offen offset:1024 lds
    ds_read_b32 v157, v5 offset:1072
    ds_read_b128 v[148:151], v5 offset:2080
    ds_read_b32 v158, v5 offset:2096
    buffer_load_dwordx4 v246, s[32:35], s99 offen offset:2048 lds
    ds_read_b128 v[152:155], v5 offset:3104
    ds_read_b32 v159, v5 offset:3120
    v_lshrrev_b32 v6, 3, v0
    v_mul_u32_u24 v6, 4160, v6
    s_add_u32 m0, s61, 61440
    s_add_u32 s16, s16, s63
    buffer_load_dwordx4 v244, s[32:35], s16 offen offset:0 lds
    v_and_b32 v7, 7, v0
    v_lshl_add_u32 v6, v7, 2, v6
    v_add_u32 v6, s94, v6
    buffer_load_dwordx4 v245, s[32:35], s16 offen offset:1024 lds
    v_mov_b32 v7, 0
    s_waitcnt lgkmcnt(0)
    v_readfirstlane_b32 s93, v140
    s_nop 0
    s_lshl_b32 s93, s93, 16
    buffer_load_dwordx4 v246, s[32:35], s16 offen offset:2048 lds
    s_nop 0
    v_writelane_b32 v7, s93, 15
    v_alignbit_b32 v140, v141, v140, 16
    v_alignbit_b32 v141, v142, v141, 16
    s_add_u32 s97, s98, s0
    s_lshr_b64 s[0:1], s[0:1], 4
    s_and_b32 s97, s97, 15
    s_add_u32 m0, s87, 0
    s_lshl_b32 s97, s97, 7
    buffer_load_dwordx4 v240, s[28:31], s97 offen offset:0 lds
    v_alignbit_b32 v142, v143, v142, 16
    v_alignbit_b32 v143, v156, v143, 16
    v_alignbit_b32 v144, v145, v144, 16
    v_alignbit_b32 v145, v146, v145, 16
    buffer_load_dwordx4 v241, s[28:31], s97 offen offset:1024 lds
    v_alignbit_b32 v146, v147, v146, 16
    v_alignbit_b32 v147, v157, v147, 16
    v_alignbit_b32 v148, v149, v148, 16
    buffer_load_dwordx4 v242, s[28:31], s97 offen offset:2048 lds
    v_alignbit_b32 v149, v150, v149, 16
    v_alignbit_b32 v150, v151, v150, 16
    v_alignbit_b32 v151, v158, v151, 16
    v_alignbit_b32 v152, v153, v152, 16
    buffer_load_dwordx4 v243, s[28:31], s97 offen offset:3072 lds
    v_alignbit_b32 v153, v154, v153, 16
    v_alignbit_b32 v154, v155, v154, 16
    v_alignbit_b32 v155, v159, v155, 16
    s_waitcnt vmcnt(10)
    s_barrier
    s_mul_i32 s16, s97, 3072
    s_add_u32 m0, s60, 0
    s_add_u32 s99, s16, s62
    buffer_load_dwordx4 v244, s[32:35], s99 offen offset:0 lds
    buffer_load_dwordx4 v245, s[32:35], s99 offen offset:1024 lds
    buffer_load_dwordx4 v246, s[32:35], s99 offen offset:2048 lds
    s_add_u32 m0, s61, 12288
    s_add_u32 s16, s16, s63
    buffer_load_dwordx4 v244, s[32:35], s16 offen offset:0 lds
    buffer_load_dwordx4 v245, s[32:35], s16 offen offset:1024 lds
    buffer_load_dwordx4 v246, s[32:35], s16 offen offset:2048 lds
    s_mov_b64 exec, 0x1ff
    buffer_load_dword v136, v33, s[68:71], 0 offen sc1
    buffer_load_dword v137, v34, s[52:55], 0 offen sc1
    s_mov_b64 exec, -1
    buffer_load_dwordx4 v[212:215], v9, s[56:59], 0 offen offset:0 nt
    buffer_load_dwordx4 v[216:219], v9, s[56:59], 0 offen offset:2048 nt
    buffer_load_dwordx4 v[220:223], v9, s[56:59], s96 offen offset:0 nt
    buffer_load_dwordx4 v[224:227], v9, s[56:59], s96 offen offset:2048 nt
    s_waitcnt vmcnt(12)
    s_waitcnt vmcnt(6)
    s_barrier
    s_waitcnt vmcnt(4)
    s_branch LA_j
LA_c3:
    s_waitcnt vmcnt(10)
    s_barrier
    s_mul_i32 s16, s97, 3072
    s_add_u32 m0, s60, 49152
    s_add_u32 s99, s16, s62
    buffer_load_dwordx4 v244, s[32:35], s99 offen offset:0 lds
    buffer_load_dwordx4 v245, s[32:35], s99 offen offset:1024 lds
    buffer_load_dwordx4 v246, s[32:35], s99 offen offset:2048 lds
    s_add_u32 m0, s61, 61440
    s_add_u32 s16, s16, s63
    buffer_load_dwordx4 v244, s[32:35], s16 offen offset:0 lds
    buffer_load_dwordx4 v245, s[32:35], s16 offen offset:1024 lds
    buffer_load_dwordx4 v246, s[32:35], s16 offen offset:2048 lds
    s_add_u32 s97, s98, s0
    s_lshr_b64 s[0:1], s[0:1], 4
    s_and_b32 s97, s97, 15
    s_add_u32 m0, s87, 0
    s_lshl_b32 s97, s97, 7
    buffer_load_dwordx4 v240, s[28:31], s97 offen offset:0 lds
    buffer_load_dwordx4 v241, s[28:31], s97 offen offset:1024 lds
    buffer_load_dwordx4 v242, s[28:31], s97 offen offset:2048 lds
    buffer_load_dwordx4 v243, s[28:31], s97 offen offset:3072 lds
    s_waitcnt vmcnt(10)
    s_barrier
    s_mul_i32 s16, s97, 3072
    s_add_u32 m0, s60, 0
    s_add_u32 s99, s16, s62
    buffer_load_dwordx4 v244, s[32:35], s99 offen offset:0 lds
    buffer_load_dwordx4 v245, s[32:35], s99 offen offset:1024 lds
    buffer_load_dwordx4 v246, s[32:35], s99 offen offset:2048 lds
    s_add_u32 m0, s61, 12288
    s_add_u32 s16, s16, s63
    buffer_load_dwordx4 v244, s[32:35], s16 offen offset:0 lds
    buffer_load_dwordx4 v245, s[32:35], s16 offen offset:1024 lds
    buffer_load_dwordx4 v246, s[32:35], s16 offen offset:2048 lds
    s_add_u32 s97, s98, s0
    s_lshr_b64 s[0:1], s[0:1], 4
    s_and_b32 s97, s97, 15
    s_add_u32 m0, s87, 18432
    s_lshl_b32 s97, s97, 7
    buffer_load_dwordx4 v240, s[28:31], s97 offen offset:0 lds
    buffer_load_dwordx4 v241, s[28:31], s97 offen offset:1024 lds
    buffer_load_dwordx4 v242, s[28:31], s97 offen offset:2048 lds
    buffer_load_dwordx4 v243, s[28:31], s97 offen offset:3072 lds
    s_waitcnt vmcnt(10)
    s_barrier
    s_mul_i32 s16, s97, 3072
    s_add_u32 m0, s60, 24576
    s_add_u32 s99, s16, s62
    buffer_load_dwordx4 v244, s[32:35], s99 offen offset:0 lds
    buffer_load_dwordx4 v245, s[32:35], s99 offen offset:1024 lds
    buffer_load_dwordx4 v246, s[32:35], s99 offen offset:2048 lds
    s_add_u32 m0, s61, 36864
    s_add_u32 s16, s16, s63
    buffer_load_dwordx4 v244, s[32:35], s16 offen offset:0 lds
    buffer_load_dwordx4 v245, s[32:35], s16 offen offset:1024 lds
    buffer_load_dwordx4 v246, s[32:35], s16 offen offset:2048 lds
    s_add_u32 m0, s86, 129536
    s_mov_b32 s89, 0
    buffer_load_dwordx4 v10, s[36:39], s89 offen nt lds
    s_add_u32 m0, s86, 145920
    s_mov_b32 s89, 0
    buffer_load_dwordx4 v10, s[40:43], s89 offen nt lds
    s_add_u32 m0, s86, 133632
    s_mov_b32 s89, 65536
    buffer_load_dwordx4 v10, s[36:39], s89 offen nt lds
    s_add_u32 m0, s86, 150016
    s_mov_b32 s89, 65536
    buffer_load_dwordx4 v10, s[40:43], s89 offen nt lds
    s_add_u32 m0, s86, 137728
    s_mov_b32 s89, 131072
    buffer_load_dwordx4 v10, s[36:39], s89 offen nt lds
    s_add_u32 m0, s86, 154112
    s_mov_b32 s89, 131072
    buffer_load_dwordx4 v10, s[40:43], s89 offen nt lds
    s_add_u32 m0, s86, 141824
    s_mov_b32 s89, 196608
    buffer_load_dwordx4 v10, s[36:39], s89 offen nt lds
    s_add_u32 m0, s86, 158208
    s_mov_b32 s89, 196608
    buffer_load_dwordx4 v10, s[40:43], s89 offen nt lds
    s_mov_b64 exec, 0xff
    s_lshl_b32 s82, s3, 7
    s_add_u32 m0, s82, 129024
    s_mov_b32 s89, 0
    buffer_load_dwordx4 v11, s[36:39], s89 offen nt lds
    s_lshl_b32 s83, s74, 9
    s_add_u32 s83, s83, s82
    s_and_b32 s89, s3, 2
    s_lshl_b32 s89, s89, 3
    s_add_u32 s82, s82, s89
    s_add_u32 m0, s82, 162816
    s_add_u32 s89, s83, 0
    buffer_load_dwordx4 v15, s[44:47], s89 offen  lds
    s_mov_b64 exec, -1
    s_add_u32 s97, s98, s0
    s_lshr_b64 s[0:1], s[0:1], 4
    s_and_b32 s97, s97, 15
    s_add_u32 m0, s87, 36864
    s_lshl_b32 s97, s97, 7
    buffer_load_dwordx4 v240, s[28:31], s97 offen offset:0 lds
    buffer_load_dwordx4 v241, s[28:31], s97 offen offset:1024 lds
    buffer_load_dwordx4 v242, s[28:31], s97 offen offset:2048 lds
    buffer_load_dwordx4 v243, s[28:31], s97 offen offset:3072 lds
    s_waitcnt vmcnt(20)
    s_barrier
    s_mul_i32 s16, s97, 3072
    s_add_u32 m0, s60, 49152
    s_add_u32 s99, s16, s62
    buffer_load_dwordx4 v244, s[32:35], s99 offen offset:0 lds
    buffer_load_dwordx4 v245, s[32:35], s99 offen offset:1024 lds
    buffer_load_dwordx4 v246, s[32:35], s99 offen offset:2048 lds
    s_add_u32 m0, s61, 61440
    s_add_u32 s16, s16, s63
    buffer_load_dwordx4 v244, s[32:35], s16 offen offset:0 lds
    buffer_load_dwordx4 v245, s[32:35], s16 offen offset:1024 lds
    buffer_load_dwordx4 v246, s[32:35], s16 offen offset:2048 lds
    s_add_u32 s97, s98, s0
    s_lshr_b64 s[0:1], s[0:1], 4
    s_and_b32 s97, s97, 15
    s_add_u32 m0, s87, 0
    s_lshl_b32 s97, s97, 7
    buffer_load_dwordx4 v240, s[28:31], s97 offen offset:0 lds
    buffer_load_dwordx4 v241, s[28:31], s97 offen offset:1024 lds
    buffer_load_dwordx4 v242, s[28:31], s97 offen offset:2048 lds
    buffer_load_dwordx4 v243, s[28:31], s97 offen offset:3072 lds
    s_waitcnt vmcnt(10)
    s_barrier
    s_mul_i32 s16, s97, 3072
    s_add_u32 m0, s60, 0
    s_add_u32 s99, s16, s62
    buffer_load_dwordx4 v244, s[32:35], s99 offen offset:0 lds
    ds_read_b128 v[84:87], v14 offset:0
    ds_read_b128 v[88:91], v14 offset:16
    ds_read_b64 v[40:41], v16 offset:0
    buffer_load_dwordx4 v245, s[32:35], s99 offen offset:1024 lds
    ds_read_b64 v[42:43], v231 offset:256
    ds_read_b64 v[44:45], v16 offset:256
    buffer_load_dwordx4 v246, s[32:35], s99 offen offset:2048 lds
    ds_read_b64 v[46:47], v16 offset:512
    ds_read_b64 v[48:49], v231 offset:512
    s_add_u32 m0, s61, 12288
    s_add_u32 s16, s16, s63
    buffer_load_dwordx4 v244, s[32:35], s16 offen offset:0 lds
    ds_read_b64 v[50:51], v16 offset:768
    ds_read_b64 v[52:53], v231 offset:768
    buffer_load_dwordx4 v245, s[32:35], s16 offen offset:1024 lds
    ds_read_b64 v[54:55], v16 offset:1024
    ds_read_b64 v[56:57], v231 offset:1024
    buffer_load_dwordx4 v246, s[32:35], s16 offen offset:2048 lds
    ds_read_b64 v[58:59], v16 offset:1280
    ds_read_b64 v[60:61], v231 offset:1280
    s_add_u32 s97, s98, s0
    s_lshr_b64 s[0:1], s[0:1], 4
    s_and_b32 s97, s97, 15
    s_add_u32 m0, s87, 18432
    s_lshl_b32 s97, s97, 7
    buffer_load_dwordx4 v240, s[28:31], s97 offen offset:0 lds
    ds_read_b64 v[68:69], v16 offset:16896
    ds_read_b64 v[70:71], v231 offset:16896
    buffer_load_dwordx4 v241, s[28:31], s97 offen offset:1024 lds
    ds_read_b64 v[72:73], v16 offset:17152
    ds_read_b64 v[74:75], v231 offset:17152
    buffer_load_dwordx4 v242, s[28:31], s97 offen offset:2048 lds
    ds_read_b64 v[76:77], v16 offset:17408
    ds_read_b64 v[78:79], v231 offset:17408
    buffer_load_dwordx4 v243, s[28:31], s97 offen offset:3072 lds
    ds_read_b64 v[80:81], v16 offset:17664
    ds_read_b64 v[82:83], v231 offset:17664
    s_waitcnt vmcnt(10)
    s_waitcnt lgkmcnt(0)
    s_barrier
    s_mul_i32 s16, s97, 3072
    s_add_u32 m0, s60, 24576
    s_add_u32 s99, s16, s62
    buffer_load_dwordx4 v244, s[32:35], s99 offen offset:0 lds
    v_lshlrev_b32 v160, 16, v40
    v_lshlrev_b32 v161, 16, v42
    v_lshlrev_b32 v162, 16, v44
    v_lshlrev_b32 v163, 16, v46
    v_lshlrev_b32 v164, 16, v48
    buffer_load_dwordx4 v245, s[32:35], s99 offen offset:1024 lds
    v_lshlrev_b32 v165, 16, v50
    v_lshlrev_b32 v166, 16, v52
    v_lshlrev_b32 v167, 16, v54
    v_lshlrev_b32 v168, 16, v56
    v_lshlrev_b32 v169, 16, v58
    buffer_load_dwordx4 v246, s[32:35], s99 offen offset:2048 lds
    v_lshlrev_b32 v170, 16, v60
    v_lshlrev_b32 v172, 16, v84
    v_and_b32 v173, 0xffff0000, v84
    v_lshlrev_b32 v174, 16, v85
    v_and_b32 v175, 0xffff0000, v85
    s_add_u32 m0, s61, 36864
    s_add_u32 s16, s16, s63
    buffer_load_dwordx4 v244, s[32:35], s16 offen offset:0 lds
    v_lshlrev_b32 v176, 16, v68
    v_lshlrev_b32 v177, 16, v70
    v_lshlrev_b32 v178, 16, v72
    v_lshlrev_b32 v179, 16, v74
    v_lshlrev_b32 v180, 16, v76
    buffer_load_dwordx4 v245, s[32:35], s16 offen offset:1024 lds
    v_lshlrev_b32 v181, 16, v78
    v_lshlrev_b32 v182, 16, v80
    v_lshlrev_b32 v183, 16, v82
    v_mul_f32 v184, v160, v175
    v_mul_f32 v185, v161, v175
    buffer_load_dwordx4 v246, s[32:35], s16 offen offset:2048 lds
    v_mul_f32 v186, v162, v175
    v_mul_f32 v187, v163, v175
    v_mul_f32 v188, v164, v175
    v_mul_f32 v189, v165, v175
    v_mul_f32 v190, v166, v175
    s_lshl_b32 s88, s72, 1
    s_lshr_b32 s89, s3, 1
    s_add_u32 s88, s88, s89
    s_lshl_b32 s88, s88, 4
    s_add_u32 s88, s88, s73
    s_lshl_b32 s88, s88, 1
    s_and_b32 s89, s3, 1
    s_add_u32 s88, s88, s89
    s_lshl_b32 s88, s88, 11
    s_add_u32 s88, s88, 14680064
    v_mov_b32 v192, -1
    v_mov_b32 v193, -1
    v_mov_b32 v194, -1
    v_mov_b32 v195, -1
    buffer_store_dwordx4 v[192:195], v15, s[52:55], s88 offen offset:0 sc1
    v_mul_f32 v191, v167, v175
    v_fmac_f32 v184, v161, v174
    v_fmac_f32 v185, v162, v174
    v_fmac_f32 v186, v163, v174
    v_fmac_f32 v187, v164, v174
    buffer_store_dwordx4 v[192:195], v15, s[52:55], s88 offen offset:1024 sc1
    v_fmac_f32 v188, v165, v174
    v_fmac_f32 v189, v166, v174
    v_fmac_f32 v190, v167, v174
    v_fmac_f32 v191, v168, v174
    v_fmac_f32 v184, v162, v173
    s_add_u32 s97, s98, s0
    s_lshr_b64 s[0:1], s[0:1], 4
    s_and_b32 s97, s97, 15
    s_add_u32 m0, s87, 36864
    s_lshl_b32 s97, s97, 7
    buffer_load_dwordx4 v240, s[28:31], s97 offen offset:0 lds
    v_fmac_f32 v185, v163, v173
    v_fmac_f32 v186, v164, v173
    v_fmac_f32 v187, v165, v173
    v_fmac_f32 v188, v166, v173
    v_fmac_f32 v189, v167, v173
    buffer_load_dwordx4 v241, s[28:31], s97 offen offset:1024 lds
    v_fmac_f32 v190, v168, v173
    v_fmac_f32 v191, v169, v173
    v_fmac_f32 v184, v163, v172
    v_fmac_f32 v185, v164, v172
    v_fmac_f32 v186, v165, v172
    buffer_load_dwordx4 v242, s[28:31], s97 offen offset:2048 lds
    v_fmac_f32 v187, v166, v172
    v_fmac_f32 v188, v167, v172
    v_fmac_f32 v189, v168, v172
    v_fmac_f32 v190, v169, v172
    v_fmac_f32 v191, v170, v172
    buffer_load_dwordx4 v243, s[28:31], s97 offen offset:3072 lds
    v_mul_f32 v184, v184, v176
    v_mul_f32 v185, v185, v177
    v_mul_f32 v186, v186, v178
    v_mul_f32 v187, v187, v179
    v_mul_f32 v188, v188, v180
    v_mul_f32 v189, v189, v181
    v_mul_f32 v190, v190, v182
    v_mul_f32 v191, v191, v183
    v_cvt_pk_bf16_f32 v100, v191, v190
    v_cvt_pk_bf16_f32 v101, v189, v188
    v_cvt_pk_bf16_f32 v102, v187, v186
    v_cvt_pk_bf16_f32 v103, v185, v184
    s_mov_b32 s89, 0
    buffer_store_dwordx4 v[100:103], v12, s[52:55], s89 offen sc1
    v_and_b32 v160, 0xffff0000, v40
    v_and_b32 v161, 0xffff0000, v42
    v_and_b32 v162, 0xffff0000, v44
    v_and_b32 v163, 0xffff0000, v46
    v_and_b32 v164, 0xffff0000, v48
    v_and_b32 v165, 0xffff0000, v50
    v_and_b32 v166, 0xffff0000, v52
    v_and_b32 v167, 0xffff0000, v54
    v_and_b32 v168, 0xffff0000, v56
    v_and_b32 v169, 0xffff0000, v58
    v_and_b32 v170, 0xffff0000, v60
    v_lshlrev_b32 v172, 16, v86
    v_and_b32 v173, 0xffff0000, v86
    v_lshlrev_b32 v174, 16, v87
    v_and_b32 v175, 0xffff0000, v87
    v_and_b32 v176, 0xffff0000, v68
    v_and_b32 v177, 0xffff0000, v70
    v_and_b32 v178, 0xffff0000, v72
    v_and_b32 v179, 0xffff0000, v74
    v_and_b32 v180, 0xffff0000, v76
    v_and_b32 v181, 0xffff0000, v78
    v_and_b32 v182, 0xffff0000, v80
    v_and_b32 v183, 0xffff0000, v82
    s_waitcnt vmcnt(13)
    s_barrier
    s_mul_i32 s16, s97, 3072
    s_add_u32 m0, s60, 49152
    s_add_u32 s99, s16, s62
    buffer_load_dwordx4 v244, s[32:35], s99 offen offset:0 lds
    v_mul_f32 v184, v160, v175
    v_mul_f32 v185, v161, v175
    v_mul_f32 v186, v162, v175
    v_mul_f32 v187, v163, v175
    v_mul_f32 v188, v164, v175
    buffer_load_dwordx4 v245, s[32:35], s99 offen offset:1024 lds
    v_mul_f32 v189, v165, v175
    v_mul_f32 v190, v166, v175
    v_mul_f32 v191, v167, v175
    v_fmac_f32 v184, v161, v174
    v_fmac_f32 v185, v162, v174
    buffer_load_dwordx4 v246, s[32:35], s99 offen offset:2048 lds
    v_fmac_f32 v186, v163, v174
    v_fmac_f32 v187, v164, v174
    v_fmac_f32 v188, v165, v174
    v_fmac_f32 v189, v166, v174
    v_fmac_f32 v190, v167, v174
    s_add_u32 m0, s61, 61440
    s_add_u32 s16, s16, s63
    buffer_load_dwordx4 v244, s[32:35], s16 offen offset:0 lds
    v_fmac_f32 v191, v168, v174
    v_fmac_f32 v184, v162, v173
    v_fmac_f32 v185, v163, v173
    v_fmac_f32 v186, v164, v173
    v_fmac_f32 v187, v165, v173
    buffer_load_dwordx4 v245, s[32:35], s16 offen offset:1024 lds
    v_fmac_f32 v188, v166, v173
    v_fmac_f32 v189, v167, v173
    v_fmac_f32 v190, v168, v173
    v_fmac_f32 v191, v169, v173
    v_fmac_f32 v184, v163, v172
    buffer_load_dwordx4 v246, s[32:35], s16 offen offset:2048 lds
    v_fmac_f32 v185, v164, v172
    v_fmac_f32 v186, v165, v172
    v_fmac_f32 v187, v166, v172
    v_fmac_f32 v188, v167, v172
    v_fmac_f32 v189, v168, v172
    s_add_u32 s97, s98, s0
    s_lshr_b64 s[0:1], s[0:1], 4
    s_and_b32 s97, s97, 15
    s_add_u32 m0, s87, 0
    s_lshl_b32 s97, s97, 7
    buffer_load_dwordx4 v240, s[28:31], s97 offen offset:0 lds
    v_fmac_f32 v190, v169, v172
    v_fmac_f32 v191, v170, v172
    v_mul_f32 v184, v184, v176
    v_mul_f32 v185, v185, v177
    v_mul_f32 v186, v186, v178
    buffer_load_dwordx4 v241, s[28:31], s97 offen offset:1024 lds
    v_mul_f32 v187, v187, v179
    v_mul_f32 v188, v188, v180
    v_mul_f32 v189, v189, v181
    v_mul_f32 v190, v190, v182
    v_mul_f32 v191, v191, v183
    buffer_load_dwordx4 v242, s[28:31], s97 offen offset:2048 lds
    v_cvt_pk_bf16_f32 v104, v191, v190
    v_cvt_pk_bf16_f32 v105, v189, v188
    v_cvt_pk_bf16_f32 v106, v187, v186
    v_cvt_pk_bf16_f32 v107, v185, v184
    s_mov_b32 s89, 16384
    buffer_store_dwordx4 v[104:107], v12, s[52:55], s89 offen sc1
    buffer_load_dwordx4 v243, s[28:31], s97 offen offset:3072 lds
    v_lshlrev_b32 v160, 16, v41
    v_lshlrev_b32 v161, 16, v43
    v_lshlrev_b32 v162, 16, v45
    v_lshlrev_b32 v163, 16, v47
    v_lshlrev_b32 v164, 16, v49
    v_lshlrev_b32 v165, 16, v51
    v_lshlrev_b32 v166, 16, v53
    v_lshlrev_b32 v167, 16, v55
    v_lshlrev_b32 v168, 16, v57
    v_lshlrev_b32 v169, 16, v59
    v_lshlrev_b32 v170, 16, v61
    v_lshlrev_b32 v172, 16, v88
    v_and_b32 v173, 0xffff0000, v88
    v_lshlrev_b32 v174, 16, v89
    v_and_b32 v175, 0xffff0000, v89
    v_lshlrev_b32 v176, 16, v69
    v_lshlrev_b32 v177, 16, v71
    v_lshlrev_b32 v178, 16, v73
    v_lshlrev_b32 v179, 16, v75
    v_lshlrev_b32 v180, 16, v77
    v_lshlrev_b32 v181, 16, v79
    v_lshlrev_b32 v182, 16, v81
    v_lshlrev_b32 v183, 16, v83
    v_mul_f32 v184, v160, v175
    v_mul_f32 v185, v161, v175
    v_mul_f32 v186, v162, v175
    v_mul_f32 v187, v163, v175
    v_mul_f32 v188, v164, v175
    v_mul_f32 v189, v165, v175
    v_mul_f32 v190, v166, v175
    v_mul_f32 v191, v167, v175
    v_fmac_f32 v184, v161, v174
    v_fmac_f32 v185, v162, v174
    v_fmac_f32 v186, v163, v174
    v_fmac_f32 v187, v164, v174
    v_fmac_f32 v188, v165, v174
    v_fmac_f32 v189, v166, v174
    v_fmac_f32 v190, v167, v174
    v_fmac_f32 v191, v168, v174
    v_fmac_f32 v184, v162, v173
    v_fmac_f32 v185, v163, v173
    v_fmac_f32 v186, v164, v173
    v_fmac_f32 v187, v165, v173
    v_fmac_f32 v188, v166, v173
    v_fmac_f32 v189, v167, v173
    v_fmac_f32 v190, v168, v173
    s_waitcnt vmcnt(12)
    s_barrier
    s_mul_i32 s16, s97, 3072
    s_add_u32 m0, s60, 0
    s_add_u32 s99, s16, s62
    buffer_load_dwordx4 v244, s[32:35], s99 offen offset:0 lds
    v_fmac_f32 v191, v169, v173
    v_fmac_f32 v184, v163, v172
    v_fmac_f32 v185, v164, v172
    v_fmac_f32 v186, v165, v172
    v_fmac_f32 v187, v166, v172
    buffer_load_dwordx4 v245, s[32:35], s99 offen offset:1024 lds
    v_fmac_f32 v188, v167, v172
    v_fmac_f32 v189, v168, v172
    v_fmac_f32 v190, v169, v172
    v_fmac_f32 v191, v170, v172
    v_mul_f32 v184, v184, v176
    buffer_load_dwordx4 v246, s[32:35], s99 offen offset:2048 lds
    v_mul_f32 v185, v185, v177
    v_mul_f32 v186, v186, v178
    v_mul_f32 v187, v187, v179
    v_mul_f32 v188, v188, v180
    v_mul_f32 v189, v189, v181
    s_add_u32 m0, s61, 12288
    s_add_u32 s16, s16, s63
    buffer_load_dwordx4 v244, s[32:35], s16 offen offset:0 lds
    v_mul_f32 v190, v190, v182
    v_mul_f32 v191, v191, v183
    v_cvt_pk_bf16_f32 v108, v191, v190
    v_cvt_pk_bf16_f32 v109, v189, v188
    v_cvt_pk_bf16_f32 v110, v187, v186
    buffer_load_dwordx4 v245, s[32:35], s16 offen offset:1024 lds
    v_cvt_pk_bf16_f32 v111, v185, v184
    s_mov_b32 s89, 32768
    buffer_store_dwordx4 v[108:111], v12, s[52:55], s89 offen sc1
    v_and_b32 v160, 0xffff0000, v41
    v_and_b32 v161, 0xffff0000, v43
    v_and_b32 v162, 0xffff0000, v45
    buffer_load_dwordx4 v246, s[32:35], s16 offen offset:2048 lds
    v_and_b32 v163, 0xffff0000, v47
    v_and_b32 v164, 0xffff0000, v49
    v_and_b32 v165, 0xffff0000, v51
    v_and_b32 v166, 0xffff0000, v53
    v_and_b32 v167, 0xffff0000, v55
    s_add_u32 s97, s98, s0
    s_lshr_b64 s[0:1], s[0:1], 4
    s_and_b32 s97, s97, 15
    s_add_u32 m0, s87, 18432
    s_lshl_b32 s97, s97, 7
    buffer_load_dwordx4 v240, s[28:31], s97 offen offset:0 lds
    v_and_b32 v168, 0xffff0000, v57
    v_and_b32 v169, 0xffff0000, v59
    v_and_b32 v170, 0xffff0000, v61
    v_lshlrev_b32 v172, 16, v90
    v_and_b32 v173, 0xffff0000, v90
    buffer_load_dwordx4 v241, s[28:31], s97 offen offset:1024 lds
    v_lshlrev_b32 v174, 16, v91
    v_and_b32 v175, 0xffff0000, v91
    v_and_b32 v176, 0xffff0000, v69
    v_and_b32 v177, 0xffff0000, v71
    v_and_b32 v178, 0xffff0000, v73
    buffer_load_dwordx4 v242, s[28:31], s97 offen offset:2048 lds
    v_and_b32 v179, 0xffff0000, v75
    v_and_b32 v180, 0xffff0000, v77
    v_and_b32 v181, 0xffff0000, v79
    v_and_b32 v182, 0xffff0000, v81
    v_and_b32 v183, 0xffff0000, v83
    buffer_load_dwordx4 v243, s[28:31], s97 offen offset:3072 lds
    v_mul_f32 v184, v160, v175
    v_mul_f32 v185, v161, v175
    v_mul_f32 v186, v162, v175
    v_mul_f32 v187, v163, v175
    v_mul_f32 v188, v164, v175
    v_mul_f32 v189, v165, v175
    v_mul_f32 v190, v166, v175
    v_mul_f32 v191, v167, v175
    v_fmac_f32 v184, v161, v174
    v_fmac_f32 v185, v162, v174
    v_fmac_f32 v186, v163, v174
    v_fmac_f32 v187, v164, v174
    v_fmac_f32 v188, v165, v174
    v_fmac_f32 v189, v166, v174
    v_fmac_f32 v190, v167, v174
    v_fmac_f32 v191, v168, v174
    v_fmac_f32 v184, v162, v173
    v_fmac_f32 v185, v163, v173
    v_fmac_f32 v186, v164, v173
    v_fmac_f32 v187, v165, v173
    v_fmac_f32 v188, v166, v173
    v_fmac_f32 v189, v167, v173
    v_fmac_f32 v190, v168, v173
    v_fmac_f32 v191, v169, v173
    v_fmac_f32 v184, v163, v172
    v_fmac_f32 v185, v164, v172
    v_fmac_f32 v186, v165, v172
    v_fmac_f32 v187, v166, v172
    v_fmac_f32 v188, v167, v172
    v_fmac_f32 v189, v168, v172
    v_fmac_f32 v190, v169, v172
    v_fmac_f32 v191, v170, v172
    v_mul_f32 v184, v184, v176
    v_mul_f32 v185, v185, v177
    v_mul_f32 v186, v186, v178
    v_mul_f32 v187, v187, v179
    v_mul_f32 v188, v188, v180
    v_mul_f32 v189, v189, v181
    v_mul_f32 v190, v190, v182
    v_mul_f32 v191, v191, v183
    v_cvt_pk_bf16_f32 v112, v191, v190
    v_cvt_pk_bf16_f32 v113, v189, v188
    v_cvt_pk_bf16_f32 v114, v187, v186
    v_cvt_pk_bf16_f32 v115, v185, v184
    s_mov_b32 s89, 49152
    buffer_store_dwordx4 v[112:115], v12, s[52:55], s89 offen sc1
    s_waitcnt vmcnt(12)
    s_barrier
    s_mul_i32 s16, s97, 3072
    s_add_u32 m0, s60, 24576
    s_add_u32 s99, s16, s62
    buffer_load_dwordx4 v244, s[32:35], s99 offen offset:0 lds
    s_mov_b32 s68, s24
    s_mov_b32 s69, s25
    s_mov_b32 s70, 0x100
    s_mov_b32 s71, 0x20000
    v_lshrrev_b32 v6, 5, v0
    buffer_load_dwordx4 v245, s[32:35], s99 offen offset:1024 lds
    v_and_b32 v7, 3, v0
    s_lshr_b32 s78, s90, 1
    s_lshl_b32 s78, s78, 2
    s_load_dword s92, s[14:15], s78
    v_bfe_u32 v5, v0, 2, 2
    buffer_load_dwordx4 v246, s[32:35], s99 offen offset:2048 lds
    v_lshlrev_b32 v5, 1, v5
    v_lshl_add_u32 v5, v6, 3, v5
    v_bfe_u32 v8, v0, 4, 1
    v_add_u32 v5, v5, v8
    s_add_u32 m0, s61, 36864
    s_add_u32 s16, s16, s63
    buffer_load_dwordx4 v244, s[32:35], s16 offen offset:0 lds
    s_and_b32 s78, s3, 1
    s_lshl_b32 s78, s78, 1
    v_add_u32 v8, s78, v6
    v_xor_b32 v8, v8, v7
    v_lshlrev_b32 v8, 4, v8
    buffer_load_dwordx4 v245, s[32:35], s16 offen offset:1024 lds
    v_lshl_add_u32 v5, v5, 6, v8
    v_add_u32 v35, s86, v5
    v_mov_b32 v18, 162304
    v_mov_b32 v19, 1
    buffer_load_dwordx4 v246, s[32:35], s16 offen offset:2048 lds
    v_and_b32 v5, 3, v0
    s_lshl_b32 s78, s74, 4
    s_add_u32 s78, s78, s3
    v_lshl_add_u32 v6, v5, 2, s78
    s_lshr_b32 s78, s76, 3
    s_add_u32 s97, s98, s0
    s_lshr_b64 s[0:1], s[0:1], 4
    s_and_b32 s97, s97, 15
    s_add_u32 m0, s87, 36864
    s_lshl_b32 s97, s97, 7
    buffer_load_dwordx4 v240, s[28:31], s97 offen offset:0 lds
    s_lshl_b32 s79, s3, 1
    s_add_u32 s78, s78, s79
    s_xor_b32 s78, s78, 3
    s_lshl_b32 s78, s78, 5
    s_add_u32 s79, s76, 5
    buffer_load_dwordx4 v241, s[28:31], s97 offen offset:1024 lds
    s_and_b32 s79, s79, 7
    s_lshl_b32 s79, s79, 1
    s_add_u32 s78, s78, s79
    v_mul_u32_u24 v7, 9, v5
    buffer_load_dwordx4 v242, s[28:31], s97 offen offset:2048 lds
    v_and_b32 v7, 17, v7
    v_add_u32 v7, s78, v7
    v_and_b32 v8, 4, v0
    v_cmp_eq_u32 vcc, 0, v8
    s_nop 1
    v_cndmask_b32 v6, v7, v6, vcc
    buffer_load_dwordx4 v243, s[28:31], s97 offen offset:3072 lds
    s_max_u32 s81, s72, 1
    s_sub_u32 s81, s81, 1
    s_add_u32 s79, s81, s73
    s_add_u32 s78, s81, 5
    s_waitcnt vmcnt(11)
    s_waitcnt vmcnt(10)
    s_barrier
    s_mul_i32 s16, s97, 3072
    s_add_u32 m0, s60, 49152
    s_add_u32 s99, s16, s62
    buffer_load_dwordx4 v244, s[32:35], s99 offen offset:0 lds
    s_and_b32 s78, s78, 7
    s_lshl_b32 s78, s78, 1
    s_and_b32 s80, s79, 1
    s_add_u32 s78, s78, s80
    s_andn2_b32 s79, 2, s79
    buffer_load_dwordx4 v245, s[32:35], s99 offen offset:1024 lds
    s_lshl_b32 s79, s79, 3
    s_add_u32 s78, s78, s79
    s_lshr_b32 s81, s81, 3
    s_lshr_b32 s79, s73, 2
    s_lshl_b32 s79, s79, 1
    buffer_load_dwordx4 v246, s[32:35], s99 offen offset:2048 lds
    s_add_u32 s79, s79, s81
    s_xor_b32 s79, s79, 3
    s_lshl_b32 s79, s79, 5
    s_add_u32 s78, s78, s79
    s_add_u32 m0, s61, 61440
    s_add_u32 s16, s16, s63
    buffer_load_dwordx4 v244, s[32:35], s16 offen offset:0 lds
    v_writelane_b32 v6, s78, 8
    v_and_b32 v33, 0xf0, v6
    v_lshlrev_b32 v34, 8, v6
    v_add_u32 v34, 12582912, v34
    v_and_b32 v5, 15, v0
    buffer_load_dwordx4 v245, s[32:35], s16 offen offset:1024 lds
    v_lshrrev_b32 v6, 4, v0
    v_add_u32 v7, 9, v5
    v_and_b32 v8, 1, v7
    v_mul_u32_u24 v8, 4160, v8
    buffer_load_dwordx4 v246, s[32:35], s16 offen offset:2048 lds
    v_lshrrev_b32 v7, 1, v7
    v_lshl_add_u32 v8, v7, 2, v8
    v_lshlrev_b32 v7, 4, v6
    v_sub_u32 v8, v8, v7
    s_add_u32 s78, s94, 32
    s_add_u32 s97, s98, s0
    s_lshr_b64 s[0:1], s[0:1], 4
    s_and_b32 s97, s97, 15
    s_add_u32 m0, s87, 0
    s_lshl_b32 s97, s97, 7
    buffer_load_dwordx4 v240, s[28:31], s97 offen offset:0 lds
    v_add_u32 v21, s78, v8
    v_add_u32 v22, 1024, v21
    v_add_u32 v23, 2048, v21
    v_add_u32 v24, 3072, v21
    v_lshl_add_u32 v7, v5, 1, v6
    buffer_load_dwordx4 v241, s[28:31], s97 offen offset:1024 lds
    v_add_u32 v7, 30, v7
    v_and_b32 v8, 1, v7
    v_bfe_u32 v136, v7, 1, 2
    v_lshl_add_u32 v136, v8, 2, v136
    buffer_load_dwordx4 v242, s[28:31], s97 offen offset:2048 lds
    v_lshlrev_b32 v136, 6, v136
    v_lshrrev_b32 v7, 3, v7
    v_lshl_add_u32 v136, v7, 9, v136
    v_bitop3_b32 v8, v7, 3, s3 bitop3:0x6a
    v_lshl_add_u32 v25, v8, 4, v136
    buffer_load_dwordx4 v243, s[28:31], s97 offen offset:3072 lds
    v_add_u32 v25, 92160, v25
    v_subrev_u32 v7, 1, v7
    v_bitop3_b32 v8, v7, 3, s3 bitop3:0x6a
    v_lshl_add_u32 v27, v8, 4, v136
    s_waitcnt vmcnt(10)
    s_barrier
    s_mul_i32 s16, s97, 3072
    s_add_u32 m0, s60, 0
    s_add_u32 s99, s16, s62
    buffer_load_dwordx4 v244, s[32:35], s99 offen offset:0 lds
    v_add_u32 v27, 91648, v27
    v_subrev_u32 v7, 1, v7
    v_bitop3_b32 v8, v7, 3, s3 bitop3:0x6a
    v_lshl_add_u32 v29, v8, 4, v136
    buffer_load_dwordx4 v245, s[32:35], s99 offen offset:1024 lds
    v_add_u32 v29, 91136, v29
    v_subrev_u32 v7, 1, v7
    v_bitop3_b32 v8, v7, 3, s3 bitop3:0x6a
    buffer_load_dwordx4 v246, s[32:35], s99 offen offset:2048 lds
    v_lshl_add_u32 v31, v8, 4, v136
    v_add_u32 v31, 90624, v31
    v_lshl_add_u32 v7, v5, 1, v6
    s_add_u32 m0, s61, 12288
    s_add_u32 s16, s16, s63
    buffer_load_dwordx4 v244, s[32:35], s16 offen offset:0 lds
    v_add_u32 v7, 26, v7
    v_and_b32 v8, 1, v7
    v_bfe_u32 v136, v7, 1, 2
    v_lshl_add_u32 v136, v8, 2, v136
    buffer_load_dwordx4 v245, s[32:35], s16 offen offset:1024 lds
    v_lshlrev_b32 v136, 6, v136
    v_lshrrev_b32 v7, 3, v7
    v_lshl_add_u32 v136, v7, 9, v136
    buffer_load_dwordx4 v246, s[32:35], s16 offen offset:2048 lds
    v_bitop3_b32 v8, v7, 3, s3 bitop3:0x6a
    v_lshl_add_u32 v26, v8, 4, v136
    v_add_u32 v26, 92160, v26
    s_add_u32 m0, s94, 32
    s_lshl_b32 s89, s90, 12
    buffer_load_dwordx4 v15, s[48:51], s89 offen offset:0 nt lds
    v_subrev_u32 v7, 1, v7
    v_bitop3_b32 v8, v7, 3, s3 bitop3:0x6a
    v_lshl_add_u32 v28, v8, 4, v136
    s_add_u32 m0, s94, 32
    s_lshl_b32 s89, s90, 12
    buffer_load_dwordx4 v15, s[48:51], s89 offen offset:1024 nt lds
    v_add_u32 v28, 91648, v28
    v_subrev_u32 v7, 1, v7
    v_bitop3_b32 v8, v7, 3, s3 bitop3:0x6a
    v_lshl_add_u32 v30, v8, 4, v136
    s_add_u32 m0, s94, 32
    s_lshl_b32 s89, s90, 12
    buffer_load_dwordx4 v15, s[48:51], s89 offen offset:2048 nt lds
    v_add_u32 v30, 91136, v30
    v_subrev_u32 v7, 1, v7
    v_bitop3_b32 v8, v7, 3, s3 bitop3:0x6a
    s_add_u32 m0, s94, 32
    s_lshl_b32 s89, s90, 12
    buffer_load_dwordx4 v15, s[48:51], s89 offen offset:3072 nt lds
    v_lshl_add_u32 v32, v8, 4, v136
    v_add_u32 v32, 90624, v32
    v_lshrrev_b32 v7, 1, v6
    s_add_u32 s97, s98, s0
    s_lshr_b64 s[0:1], s[0:1], 4
    s_and_b32 s97, s97, 15
    s_add_u32 m0, s87, 18432
    s_lshl_b32 s97, s97, 7
    buffer_load_dwordx4 v240, s[28:31], s97 offen offset:0 lds
    v_lshl_add_u32 v7, v5, 1, v7
    v_add_u32 v7, 32, v7
    v_and_b32 v8, 1, v7
    v_bfe_u32 v136, v7, 1, 2
    buffer_load_dwordx4 v241, s[28:31], s97 offen offset:1024 lds
    v_lshl_add_u32 v136, v8, 2, v136
    v_lshlrev_b32 v136, 6, v136
    v_lshrrev_b32 v7, 3, v7
    buffer_load_dwordx4 v242, s[28:31], s97 offen offset:2048 lds
    v_lshl_add_u32 v136, v7, 9, v136
    v_bitop3_b32 v8, v7, 3, s3 bitop3:0x6a
    v_lshl_add_u32 v20, v8, 4, v136
    buffer_load_dwordx4 v243, s[28:31], s97 offen offset:3072 lds
    v_add_u32 v20, 92160, v20
    v_and_b32 v8, 1, v6
    v_xor_b32 v8, 1, v8
    s_waitcnt vmcnt(14)
    s_barrier
    s_mul_i32 s16, s97, 3072
    s_add_u32 m0, s60, 24576
    s_add_u32 s99, s16, s62
    buffer_load_dwordx4 v244, s[32:35], s99 offen offset:0 lds
    v_lshl_add_u32 v20, v8, 3, v20
    s_waitcnt lgkmcnt(0)
    s_and_b32 s78, s92, 0xffff0000
    s_lshl_b32 s92, s92, 16
    buffer_load_dwordx4 v245, s[32:35], s99 offen offset:1024 lds
    s_bitcmp1_b32 s90, 0
    s_cselect_b32 s92, s78, s92
    v_lshlrev_b32 v7, 3, v6
    v_sub_u32 v7, v7, v5
    v_subrev_u32 v7, 9, v7
    buffer_load_dwordx4 v246, s[32:35], s99 offen offset:2048 lds
    v_and_b32 v8, 1, v7
    v_xor_b32 v8, 1, v8
    v_lshlrev_b32 v8, 4, v8
    v_lshrrev_b32 v8, v8, s92
    s_add_u32 m0, s61, 36864
    s_add_u32 s16, s16, s63
    buffer_load_dwordx4 v244, s[32:35], s16 offen offset:0 lds
    v_ashrrev_i32 v7, 1, v7
    v_cmp_eq_u32 vcc, 0, v7
    s_nop 1
    v_cndmask_b32 v236, 0, v8, vcc
    v_cmp_eq_u32 vcc, 1, v7
    buffer_load_dwordx4 v245, s[32:35], s16 offen offset:1024 lds
    s_nop 0
    v_cndmask_b32 v237, 0, v8, vcc
    v_cmp_eq_u32 vcc, 2, v7
    s_nop 1
    v_cndmask_b32 v238, 0, v8, vcc
    v_cmp_eq_u32 vcc, 3, v7
    buffer_load_dwordx4 v246, s[32:35], s16 offen offset:2048 lds
    s_nop 0
    v_cndmask_b32 v239, 0, v8, vcc
    s_and_b32 s95, s76, 3
    s_mul_i32 s95, s95, 0x22222222
    s_add_u32 s95, s95, 0x76543210
    s_add_u32 s97, s98, s0
    s_lshr_b64 s[0:1], s[0:1], 4
    s_and_b32 s97, s97, 15
    s_add_u32 m0, s87, 36864
    s_lshl_b32 s97, s97, 7
    buffer_load_dwordx4 v240, s[28:31], s97 offen offset:0 lds
    s_bfe_u32 s100, s95, 0x3001c
    s_lshl_b32 s100, s100, 18
    s_bfe_u32 s95, s95, 0x30018
    s_lshl_b32 s95, s95, 18
    buffer_load_dwordx4 v241, s[28:31], s97 offen offset:1024 lds
    v_lshrrev_b32 v136, 4, v0
    v_lshlrev_b32 v136, 1, v136
    v_and_b32 v137, 7, v0
    v_xor_b32 v136, v136, v137
    buffer_load_dwordx4 v242, s[28:31], s97 offen offset:2048 lds
    v_lshlrev_b32 v136, 4, v136
    v_lshrrev_b32 v137, 3, v0
    v_lshl_add_u32 v136, v137, 11, v136
    s_lshl_b32 s78, s77, 7
    buffer_load_dwordx4 v243, s[28:31], s97 offen offset:3072 lds
    s_lshl_b32 s79, s3, 14
    s_add_u32 s78, s78, s79
    v_add_u32 v17, s78, v136
    s_waitcnt vmcnt(10)
    s_barrier
    s_mul_i32 s16, s97, 3072
    s_add_u32 m0, s60, 49152
    s_add_u32 s99, s16, s62
    buffer_load_dwordx4 v244, s[32:35], s99 offen offset:0 lds
    v_add_u32 v5, s94, v15
    ds_read_b128 v[140:143], v5 offset:32
    ds_read_b32 v156, v5 offset:48
    ds_read_b128 v[144:147], v5 offset:1056
    buffer_load_dwordx4 v245, s[32:35], s99 offen offset:1024 lds
    ds_read_b32 v157, v5 offset:1072
    ds_read_b128 v[148:151], v5 offset:2080
    ds_read_b32 v158, v5 offset:2096
    buffer_load_dwordx4 v246, s[32:35], s99 offen offset:2048 lds
    ds_read_b128 v[152:155], v5 offset:3104
    ds_read_b32 v159, v5 offset:3120
    v_lshrrev_b32 v6, 3, v0
    v_mul_u32_u24 v6, 4160, v6
    s_add_u32 m0, s61, 61440
    s_add_u32 s16, s16, s63
    buffer_load_dwordx4 v244, s[32:35], s16 offen offset:0 lds
    v_and_b32 v7, 7, v0
    v_lshl_add_u32 v6, v7, 2, v6
    v_add_u32 v6, s94, v6
    buffer_load_dwordx4 v245, s[32:35], s16 offen offset:1024 lds
    v_mov_b32 v7, 0
    s_waitcnt lgkmcnt(0)
    v_readfirstlane_b32 s93, v140
    s_nop 0
    s_lshl_b32 s93, s93, 16
    buffer_load_dwordx4 v246, s[32:35], s16 offen offset:2048 lds
    s_nop 0
    v_writelane_b32 v7, s93, 15
    v_alignbit_b32 v140, v141, v140, 16
    v_alignbit_b32 v141, v142, v141, 16
    s_add_u32 s97, s98, s0
    s_lshr_b64 s[0:1], s[0:1], 4
    s_and_b32 s97, s97, 15
    s_add_u32 m0, s87, 0
    s_lshl_b32 s97, s97, 7
    buffer_load_dwordx4 v240, s[28:31], s97 offen offset:0 lds
    v_alignbit_b32 v142, v143, v142, 16
    v_alignbit_b32 v143, v156, v143, 16
    v_alignbit_b32 v144, v145, v144, 16
    v_alignbit_b32 v145, v146, v145, 16
    buffer_load_dwordx4 v241, s[28:31], s97 offen offset:1024 lds
    v_alignbit_b32 v146, v147, v146, 16
    v_alignbit_b32 v147, v157, v147, 16
    v_alignbit_b32 v148, v149, v148, 16
    buffer_load_dwordx4 v242, s[28:31], s97 offen offset:2048 lds
    v_alignbit_b32 v149, v150, v149, 16
    v_alignbit_b32 v150, v151, v150, 16
    v_alignbit_b32 v151, v158, v151, 16
    v_alignbit_b32 v152, v153, v152, 16
    buffer_load_dwordx4 v243, s[28:31], s97 offen offset:3072 lds
    v_alignbit_b32 v153, v154, v153, 16
    v_alignbit_b32 v154, v155, v154, 16
    v_alignbit_b32 v155, v159, v155, 16
    s_waitcnt vmcnt(10)
    s_barrier
    s_mul_i32 s16, s97, 3072
    s_add_u32 m0, s60, 0
    s_add_u32 s99, s16, s62
    buffer_load_dwordx4 v244, s[32:35], s99 offen offset:0 lds
    buffer_load_dwordx4 v245, s[32:35], s99 offen offset:1024 lds
    buffer_load_dwordx4 v246, s[32:35], s99 offen offset:2048 lds
    s_add_u32 m0, s61, 12288
    s_add_u32 s16, s16, s63
    buffer_load_dwordx4 v244, s[32:35], s16 offen offset:0 lds
    buffer_load_dwordx4 v245, s[32:35], s16 offen offset:1024 lds
    buffer_load_dwordx4 v246, s[32:35], s16 offen offset:2048 lds
    s_mov_b64 exec, 0x1ff
    buffer_load_dword v136, v33, s[68:71], 0 offen sc1
    buffer_load_dword v137, v34, s[52:55], 0 offen sc1
    s_mov_b64 exec, -1
    buffer_load_dwordx4 v[212:215], v9, s[56:59], 0 offen offset:0 nt
    buffer_load_dwordx4 v[216:219], v9, s[56:59], 0 offen offset:2048 nt
    buffer_load_dwordx4 v[220:223], v9, s[56:59], s96 offen offset:0 nt
    buffer_load_dwordx4 v[224:227], v9, s[56:59], s96 offen offset:2048 nt
    s_waitcnt vmcnt(12)
    s_waitcnt vmcnt(6)
    s_barrier
    s_waitcnt vmcnt(4)
LA_j:
    s_mov_b64 exec, 0x1ff
    v_cmp_ne_u32 vcc, v136, v137
    v_cmp_gt_u32 s[80:81], s96, v136
    s_nop 0
    s_or_b64 vcc, vcc, s[80:81]
    s_cbranch_vccnz LA_slow
LA_back:
    s_mov_b64 exec, 1
    ds_add_u32 v18, v19 offset:0
    s_mov_b64 exec, -1
    s_add_u32 m0, s86, 94208
    s_add_u32 s89, s91, 0
    buffer_load_dwordx4 v35, s[52:55], s89 offen sc1 lds
    s_add_u32 m0, s86, 98304
    s_add_u32 s89, s91, 4096
    buffer_load_dwordx4 v35, s[52:55], s89 offen sc1 lds
    s_add_u32 m0, s86, 102400
    s_add_u32 s89, s91, 8192
    buffer_load_dwordx4 v35, s[52:55], s89 offen sc1 lds
    s_add_u32 m0, s86, 106496
    s_add_u32 s89, s91, 12288
    buffer_load_dwordx4 v35, s[52:55], s89 offen sc1 lds
    s_mov_b64 exec, 0xffff
    ds_write_b32 v6, v7
    s_mov_b64 exec, -1
    ds_write_b128 v5, v[140:143] offset:4192
    ds_write_b128 v5, v[144:147] offset:5216
    ds_write_b128 v5, v[148:151] offset:6240
    ds_write_b128 v5, v[152:155] offset:7264
    ds_read2_b32 v[68:69], v21 offset0:0 offset1:1
    ds_read2_b32 v[70:71], v21 offset0:2 offset1:3
    ds_read2_b32 v[72:73], v21 offset0:128 offset1:129
    ds_read2_b32 v[74:75], v21 offset0:130 offset1:131
    ds_read2_b32 v[76:77], v22 offset0:0 offset1:1
    ds_read2_b32 v[78:79], v22 offset0:2 offset1:3
    ds_read2_b32 v[80:81], v22 offset0:128 offset1:129
    ds_read2_b32 v[82:83], v22 offset0:130 offset1:131
    ds_read2_b32 v[84:85], v23 offset0:0 offset1:1
    ds_read2_b32 v[86:87], v23 offset0:2 offset1:3
    ds_read2_b32 v[88:89], v23 offset0:128 offset1:129
    ds_read2_b32 v[90:91], v23 offset0:130 offset1:131
    ds_read2_b32 v[92:93], v24 offset0:0 offset1:1
    ds_read2_b32 v[94:95], v24 offset0:2 offset1:3
    ds_read2_b32 v[96:97], v24 offset0:128 offset1:129
    ds_read2_b32 v[98:99], v24 offset0:130 offset1:131
    s_waitcnt vmcnt(0)
    s_mov_b64 exec, 1
    ds_add_u32 v18, v19 offset:20
    s_mov_b64 exec, -1
    s_branch LA_s5_in
LA_s5:
    s_sleep 1
LA_s5_in:
    ds_read_b32 v6, v18 offset:20
    s_waitcnt lgkmcnt(0)
    v_readfirstlane_b32 s78, v6
    s_nop 0
    s_cmp_ge_u32 s78, 4
    s_cbranch_scc0 LA_s5
    ds_read_b128 v[100:103], v25 offset:0
    ds_read_b128 v[104:107], v25 offset:2048
    ds_read_b128 v[108:111], v25 offset:4096
    ds_read_b128 v[112:115], v25 offset:6144
    ds_read_b128 v[116:119], v25 offset:8192
    ds_read_b128 v[120:123], v25 offset:10240
    ds_read_b128 v[124:127], v25 offset:12288
    ds_read_b128 v[128:131], v25 offset:14336
    s_setprio 2
    s_waitcnt lgkmcnt(7)
    v_mfma_f32_16x16x32_bf16 v[36:39], v[236:239], v[100:103], 0
    ds_read2_b32 v[132:133], v21 offset0:16 offset1:17
    v_mfma_f32_16x16x32_bf16 v[36:39], v[68:71], v[100:103], v[36:39]
    ds_read2_b32 v[134:135], v21 offset0:18 offset1:19
    s_waitcnt lgkmcnt(8)
    v_mfma_f32_16x16x32_bf16 v[40:43], v[236:239], v[104:107], 0
    v_mfma_f32_16x16x32_bf16 v[40:43], v[68:71], v[104:107], v[40:43]
    ds_read_b128 v[164:167], v26 offset:0
    v_mfma_f32_16x16x32_bf16 v[40:43], v[72:75], v[100:103], v[40:43]
    s_waitcnt lgkmcnt(8)
    v_mfma_f32_16x16x32_bf16 v[44:47], v[236:239], v[108:111], 0
    ds_read2_b32 v[136:137], v21 offset0:144 offset1:145
    v_mfma_f32_16x16x32_bf16 v[44:47], v[68:71], v[108:111], v[44:47]
    ds_read2_b32 v[138:139], v21 offset0:146 offset1:147
    v_mfma_f32_16x16x32_bf16 v[44:47], v[72:75], v[104:107], v[44:47]
    v_mfma_f32_16x16x32_bf16 v[44:47], v[76:79], v[100:103], v[44:47]
    ds_read_b128 v[168:171], v26 offset:2048
    s_waitcnt lgkmcnt(10)
    v_mfma_f32_16x16x32_bf16 v[48:51], v[236:239], v[112:115], 0
    v_mfma_f32_16x16x32_bf16 v[48:51], v[68:71], v[112:115], v[48:51]
    ds_read2_b32 v[140:141], v22 offset0:16 offset1:17
    v_mfma_f32_16x16x32_bf16 v[48:51], v[72:75], v[108:111], v[48:51]
    ds_read2_b32 v[142:143], v22 offset0:18 offset1:19
    v_mfma_f32_16x16x32_bf16 v[48:51], v[76:79], v[104:107], v[48:51]
    v_mfma_f32_16x16x32_bf16 v[48:51], v[80:83], v[100:103], v[48:51]
    ds_read_b128 v[172:175], v26 offset:4096
    s_waitcnt lgkmcnt(12)
    v_mfma_f32_16x16x32_bf16 v[52:55], v[236:239], v[116:119], 0
    v_mfma_f32_16x16x32_bf16 v[52:55], v[68:71], v[116:119], v[52:55]
    ds_read2_b32 v[144:145], v22 offset0:144 offset1:145
    v_mfma_f32_16x16x32_bf16 v[52:55], v[72:75], v[112:115], v[52:55]
    ds_read2_b32 v[146:147], v22 offset0:146 offset1:147
    v_mfma_f32_16x16x32_bf16 v[52:55], v[76:79], v[108:111], v[52:55]
    v_mfma_f32_16x16x32_bf16 v[52:55], v[80:83], v[104:107], v[52:55]
    ds_read_b128 v[176:179], v26 offset:6144
    v_mfma_f32_16x16x32_bf16 v[52:55], v[84:87], v[100:103], v[52:55]
    s_waitcnt lgkmcnt(14)
    v_mfma_f32_16x16x32_bf16 v[56:59], v[236:239], v[120:123], 0
    ds_read2_b32 v[148:149], v23 offset0:16 offset1:17
    v_mfma_f32_16x16x32_bf16 v[56:59], v[68:71], v[120:123], v[56:59]
    ds_read2_b32 v[150:151], v23 offset0:18 offset1:19
    v_mfma_f32_16x16x32_bf16 v[56:59], v[72:75], v[116:119], v[56:59]
    v_mfma_f32_16x16x32_bf16 v[56:59], v[76:79], v[112:115], v[56:59]
    ds_read_b128 v[180:183], v26 offset:8192
    v_mfma_f32_16x16x32_bf16 v[56:59], v[80:83], v[108:111], v[56:59]
    v_mfma_f32_16x16x32_bf16 v[56:59], v[84:87], v[104:107], v[56:59]
    ds_read2_b32 v[152:153], v23 offset0:144 offset1:145
    v_mfma_f32_16x16x32_bf16 v[56:59], v[88:91], v[100:103], v[56:59]
    ds_read2_b32 v[154:155], v23 offset0:146 offset1:147
    s_waitcnt lgkmcnt(14)
    v_mfma_f32_16x16x32_bf16 v[60:63], v[236:239], v[124:127], 0
    v_mfma_f32_16x16x32_bf16 v[60:63], v[68:71], v[124:127], v[60:63]
    ds_read_b128 v[184:187], v26 offset:10240
    v_mfma_f32_16x16x32_bf16 v[60:63], v[72:75], v[120:123], v[60:63]
    v_mfma_f32_16x16x32_bf16 v[60:63], v[76:79], v[116:119], v[60:63]
    ds_read2_b32 v[156:157], v24 offset0:16 offset1:17
    v_mfma_f32_16x16x32_bf16 v[60:63], v[80:83], v[112:115], v[60:63]
    ds_read2_b32 v[158:159], v24 offset0:18 offset1:19
    v_mfma_f32_16x16x32_bf16 v[60:63], v[84:87], v[108:111], v[60:63]
    v_mfma_f32_16x16x32_bf16 v[60:63], v[88:91], v[104:107], v[60:63]
    ds_read_b128 v[188:191], v26 offset:12288
    v_mfma_f32_16x16x32_bf16 v[60:63], v[92:95], v[100:103], v[60:63]
    v_mfma_f32_16x16x32_bf16 v[64:67], v[236:239], v[128:131], 0
    ds_read2_b32 v[160:161], v24 offset0:144 offset1:145
    v_mfma_f32_16x16x32_bf16 v[64:67], v[68:71], v[128:131], v[64:67]
    ds_read2_b32 v[162:163], v24 offset0:146 offset1:147
    v_mfma_f32_16x16x32_bf16 v[64:67], v[72:75], v[124:127], v[64:67]
    v_mfma_f32_16x16x32_bf16 v[64:67], v[76:79], v[120:123], v[64:67]
    ds_read_b128 v[192:195], v26 offset:14336
    v_mfma_f32_16x16x32_bf16 v[64:67], v[80:83], v[116:119], v[64:67]
    v_mfma_f32_16x16x32_bf16 v[64:67], v[84:87], v[112:115], v[64:67]
    v_mfma_f32_16x16x32_bf16 v[64:67], v[88:91], v[108:111], v[64:67]
    v_mfma_f32_16x16x32_bf16 v[64:67], v[92:95], v[104:107], v[64:67]
    v_mfma_f32_16x16x32_bf16 v[64:67], v[96:99], v[100:103], v[64:67]
    v_mfma_f32_16x16x32_bf16 v[36:39], v[132:135], v[164:167], v[36:39]
    ds_read2_b32 v[68:69], v21 offset0:32 offset1:33
    s_waitcnt lgkmcnt(14)
    v_mfma_f32_16x16x32_bf16 v[40:43], v[136:139], v[164:167], v[40:43]
    ds_read2_b32 v[70:71], v21 offset0:34 offset1:35
    v_mfma_f32_16x16x32_bf16 v[40:43], v[132:135], v[168:171], v[40:43]
    ds_read_b128 v[100:103], v27 offset:0
    v_mfma_f32_16x16x32_bf16 v[44:47], v[132:135], v[172:175], v[44:47]
    v_mfma_f32_16x16x32_bf16 v[44:47], v[136:139], v[168:171], v[44:47]
    ds_read2_b32 v[72:73], v21 offset0:160 offset1:161
    v_mfma_f32_16x16x32_bf16 v[44:47], v[140:143], v[164:167], v[44:47]
    ds_read2_b32 v[74:75], v21 offset0:162 offset1:163
    v_mfma_f32_16x16x32_bf16 v[48:51], v[144:147], v[164:167], v[48:51]
    ds_read_b128 v[104:107], v27 offset:2048
    v_mfma_f32_16x16x32_bf16 v[48:51], v[140:143], v[168:171], v[48:51]
    v_mfma_f32_16x16x32_bf16 v[48:51], v[136:139], v[172:175], v[48:51]
    ds_read2_b32 v[76:77], v22 offset0:32 offset1:33
    s_waitcnt lgkmcnt(14)
    v_mfma_f32_16x16x32_bf16 v[48:51], v[132:135], v[176:179], v[48:51]
    ds_read2_b32 v[78:79], v22 offset0:34 offset1:35
    v_mfma_f32_16x16x32_bf16 v[52:55], v[132:135], v[180:183], v[52:55]
    ds_read_b128 v[108:111], v27 offset:4096
    v_mfma_f32_16x16x32_bf16 v[52:55], v[136:139], v[176:179], v[52:55]
    v_mfma_f32_16x16x32_bf16 v[52:55], v[140:143], v[172:175], v[52:55]
    ds_read2_b32 v[80:81], v22 offset0:160 offset1:161
    v_mfma_f32_16x16x32_bf16 v[52:55], v[144:147], v[168:171], v[52:55]
    ds_read2_b32 v[82:83], v22 offset0:162 offset1:163
    v_mfma_f32_16x16x32_bf16 v[52:55], v[148:151], v[164:167], v[52:55]
    ds_read_b128 v[112:115], v27 offset:6144
    v_mfma_f32_16x16x32_bf16 v[56:59], v[152:155], v[164:167], v[56:59]
    v_mfma_f32_16x16x32_bf16 v[56:59], v[148:151], v[168:171], v[56:59]
    ds_read2_b32 v[84:85], v23 offset0:32 offset1:33
    v_mfma_f32_16x16x32_bf16 v[56:59], v[144:147], v[172:175], v[56:59]
    ds_read2_b32 v[86:87], v23 offset0:34 offset1:35
    v_mfma_f32_16x16x32_bf16 v[56:59], v[140:143], v[176:179], v[56:59]
    ds_read_b128 v[116:119], v27 offset:8192
    v_mfma_f32_16x16x32_bf16 v[56:59], v[136:139], v[180:183], v[56:59]
    s_waitcnt lgkmcnt(14)
    v_mfma_f32_16x16x32_bf16 v[56:59], v[132:135], v[184:187], v[56:59]
    ds_read2_b32 v[88:89], v23 offset0:160 offset1:161
    v_mfma_f32_16x16x32_bf16 v[60:63], v[132:135], v[188:191], v[60:63]
    ds_read2_b32 v[90:91], v23 offset0:162 offset1:163
    v_mfma_f32_16x16x32_bf16 v[60:63], v[136:139], v[184:187], v[60:63]
    ds_read_b128 v[120:123], v27 offset:10240
    v_mfma_f32_16x16x32_bf16 v[60:63], v[140:143], v[180:183], v[60:63]
    v_mfma_f32_16x16x32_bf16 v[60:63], v[144:147], v[176:179], v[60:63]
    ds_read2_b32 v[92:93], v24 offset0:32 offset1:33
    v_mfma_f32_16x16x32_bf16 v[60:63], v[148:151], v[172:175], v[60:63]
    ds_read2_b32 v[94:95], v24 offset0:34 offset1:35
    v_mfma_f32_16x16x32_bf16 v[60:63], v[152:155], v[168:171], v[60:63]
    ds_read_b128 v[124:127], v27 offset:12288
    v_mfma_f32_16x16x32_bf16 v[60:63], v[156:159], v[164:167], v[60:63]
    v_mfma_f32_16x16x32_bf16 v[64:67], v[160:163], v[164:167], v[64:67]
    ds_read2_b32 v[96:97], v24 offset0:160 offset1:161
    v_mfma_f32_16x16x32_bf16 v[64:67], v[156:159], v[168:171], v[64:67]
    ds_read2_b32 v[98:99], v24 offset0:162 offset1:163
    v_mfma_f32_16x16x32_bf16 v[64:67], v[152:155], v[172:175], v[64:67]
    ds_read_b128 v[128:131], v27 offset:14336
    v_mfma_f32_16x16x32_bf16 v[64:67], v[148:151], v[176:179], v[64:67]
    v_mfma_f32_16x16x32_bf16 v[64:67], v[144:147], v[180:183], v[64:67]
    v_mfma_f32_16x16x32_bf16 v[64:67], v[140:143], v[184:187], v[64:67]
    v_mfma_f32_16x16x32_bf16 v[64:67], v[136:139], v[188:191], v[64:67]
    v_mfma_f32_16x16x32_bf16 v[64:67], v[132:135], v[192:195], v[64:67]
    s_waitcnt lgkmcnt(14)
    v_mfma_f32_16x16x32_bf16 v[36:39], v[68:71], v[100:103], v[36:39]
    ds_read2_b32 v[132:133], v21 offset0:48 offset1:49
    v_mfma_f32_16x16x32_bf16 v[40:43], v[72:75], v[100:103], v[40:43]
    ds_read2_b32 v[134:135], v21 offset0:50 offset1:51
    v_mfma_f32_16x16x32_bf16 v[40:43], v[68:71], v[104:107], v[40:43]
    ds_read_b128 v[164:167], v28 offset:0
    v_mfma_f32_16x16x32_bf16 v[44:47], v[68:71], v[108:111], v[44:47]
    v_mfma_f32_16x16x32_bf16 v[44:47], v[72:75], v[104:107], v[44:47]
    ds_read2_b32 v[136:137], v21 offset0:176 offset1:177
    v_mfma_f32_16x16x32_bf16 v[44:47], v[76:79], v[100:103], v[44:47]
    ds_read2_b32 v[138:139], v21 offset0:178 offset1:179
    s_waitcnt lgkmcnt(14)
    v_mfma_f32_16x16x32_bf16 v[48:51], v[80:83], v[100:103], v[48:51]
    ds_read_b128 v[168:171], v28 offset:2048
    v_mfma_f32_16x16x32_bf16 v[48:51], v[76:79], v[104:107], v[48:51]
    v_mfma_f32_16x16x32_bf16 v[48:51], v[72:75], v[108:111], v[48:51]
    ds_read2_b32 v[140:141], v22 offset0:48 offset1:49
    v_mfma_f32_16x16x32_bf16 v[48:51], v[68:71], v[112:115], v[48:51]
    ds_read2_b32 v[142:143], v22 offset0:50 offset1:51
    v_mfma_f32_16x16x32_bf16 v[52:55], v[68:71], v[116:119], v[52:55]
    ds_read_b128 v[172:175], v28 offset:4096
    v_mfma_f32_16x16x32_bf16 v[52:55], v[72:75], v[112:115], v[52:55]
    v_mfma_f32_16x16x32_bf16 v[52:55], v[76:79], v[108:111], v[52:55]
    ds_read2_b32 v[144:145], v22 offset0:176 offset1:177
    v_mfma_f32_16x16x32_bf16 v[52:55], v[80:83], v[104:107], v[52:55]
    ds_read2_b32 v[146:147], v22 offset0:178 offset1:179
    v_mfma_f32_16x16x32_bf16 v[52:55], v[84:87], v[100:103], v[52:55]
    ds_read_b128 v[176:179], v28 offset:6144
    s_waitcnt lgkmcnt(14)
    v_mfma_f32_16x16x32_bf16 v[56:59], v[88:91], v[100:103], v[56:59]
    v_mfma_f32_16x16x32_bf16 v[56:59], v[84:87], v[104:107], v[56:59]
    ds_read2_b32 v[148:149], v23 offset0:48 offset1:49
    v_mfma_f32_16x16x32_bf16 v[56:59], v[80:83], v[108:111], v[56:59]
    ds_read2_b32 v[150:151], v23 offset0:50 offset1:51
    v_mfma_f32_16x16x32_bf16 v[56:59], v[76:79], v[112:115], v[56:59]
    ds_read_b128 v[180:183], v28 offset:8192
    v_mfma_f32_16x16x32_bf16 v[56:59], v[72:75], v[116:119], v[56:59]
    v_mfma_f32_16x16x32_bf16 v[56:59], v[68:71], v[120:123], v[56:59]
    ds_read2_b32 v[152:153], v23 offset0:176 offset1:177
    v_mfma_f32_16x16x32_bf16 v[60:63], v[68:71], v[124:127], v[60:63]
    ds_read2_b32 v[154:155], v23 offset0:178 offset1:179
    v_mfma_f32_16x16x32_bf16 v[60:63], v[72:75], v[120:123], v[60:63]
    ds_read_b128 v[184:187], v28 offset:10240
    v_mfma_f32_16x16x32_bf16 v[60:63], v[76:79], v[116:119], v[60:63]
    v_mfma_f32_16x16x32_bf16 v[60:63], v[80:83], v[112:115], v[60:63]
    ds_read2_b32 v[156:157], v24 offset0:48 offset1:49
    v_mfma_f32_16x16x32_bf16 v[60:63], v[84:87], v[108:111], v[60:63]
    ds_read2_b32 v[158:159], v24 offset0:50 offset1:51
    v_mfma_f32_16x16x32_bf16 v[60:63], v[88:91], v[104:107], v[60:63]
    ds_read_b128 v[188:191], v28 offset:12288
    v_mfma_f32_16x16x32_bf16 v[60:63], v[92:95], v[100:103], v[60:63]
    s_waitcnt lgkmcnt(14)
    v_mfma_f32_16x16x32_bf16 v[64:67], v[96:99], v[100:103], v[64:67]
    ds_read2_b32 v[160:161], v24 offset0:176 offset1:177
    v_mfma_f32_16x16x32_bf16 v[64:67], v[92:95], v[104:107], v[64:67]
    ds_read2_b32 v[162:163], v24 offset0:178 offset1:179
    v_mfma_f32_16x16x32_bf16 v[64:67], v[88:91], v[108:111], v[64:67]
    ds_read_b128 v[192:195], v28 offset:14336
    v_mfma_f32_16x16x32_bf16 v[64:67], v[84:87], v[112:115], v[64:67]
    v_mfma_f32_16x16x32_bf16 v[64:67], v[80:83], v[116:119], v[64:67]
    v_mfma_f32_16x16x32_bf16 v[64:67], v[76:79], v[120:123], v[64:67]
    v_mfma_f32_16x16x32_bf16 v[64:67], v[72:75], v[124:127], v[64:67]
    v_mfma_f32_16x16x32_bf16 v[64:67], v[68:71], v[128:131], v[64:67]
    v_mfma_f32_16x16x32_bf16 v[36:39], v[132:135], v[164:167], v[36:39]
    ds_read2_b32 v[68:69], v21 offset0:64 offset1:65
    v_mfma_f32_16x16x32_bf16 v[40:43], v[136:139], v[164:167], v[40:43]
    ds_read2_b32 v[70:71], v21 offset0:66 offset1:67
    v_mfma_f32_16x16x32_bf16 v[40:43], v[132:135], v[168:171], v[40:43]
    ds_read_b128 v[100:103], v29 offset:0
    s_waitcnt lgkmcnt(14)
    v_mfma_f32_16x16x32_bf16 v[44:47], v[132:135], v[172:175], v[44:47]
    v_mfma_f32_16x16x32_bf16 v[44:47], v[136:139], v[168:171], v[44:47]
    ds_read2_b32 v[72:73], v21 offset0:192 offset1:193
    v_mfma_f32_16x16x32_bf16 v[44:47], v[140:143], v[164:167], v[44:47]
    ds_read2_b32 v[74:75], v21 offset0:194 offset1:195
    v_mfma_f32_16x16x32_bf16 v[48:51], v[144:147], v[164:167], v[48:51]
    ds_read_b128 v[104:107], v29 offset:2048
    v_mfma_f32_16x16x32_bf16 v[48:51], v[140:143], v[168:171], v[48:51]
    v_mfma_f32_16x16x32_bf16 v[48:51], v[136:139], v[172:175], v[48:51]
    ds_read2_b32 v[76:77], v22 offset0:64 offset1:65
    v_mfma_f32_16x16x32_bf16 v[48:51], v[132:135], v[176:179], v[48:51]
    ds_read2_b32 v[78:79], v22 offset0:66 offset1:67
    s_waitcnt lgkmcnt(14)
    v_mfma_f32_16x16x32_bf16 v[52:55], v[132:135], v[180:183], v[52:55]
    ds_read_b128 v[108:111], v29 offset:4096
    v_mfma_f32_16x16x32_bf16 v[52:55], v[136:139], v[176:179], v[52:55]
    v_mfma_f32_16x16x32_bf16 v[52:55], v[140:143], v[172:175], v[52:55]
    ds_read2_b32 v[80:81], v22 offset0:192 offset1:193
    v_mfma_f32_16x16x32_bf16 v[52:55], v[144:147], v[168:171], v[52:55]
    ds_read2_b32 v[82:83], v22 offset0:194 offset1:195
    v_mfma_f32_16x16x32_bf16 v[52:55], v[148:151], v[164:167], v[52:55]
    ds_read_b128 v[112:115], v29 offset:6144
    v_mfma_f32_16x16x32_bf16 v[56:59], v[152:155], v[164:167], v[56:59]
    v_mfma_f32_16x16x32_bf16 v[56:59], v[148:151], v[168:171], v[56:59]
    ds_read2_b32 v[84:85], v23 offset0:64 offset1:65
    v_mfma_f32_16x16x32_bf16 v[56:59], v[144:147], v[172:175], v[56:59]
    ds_read2_b32 v[86:87], v23 offset0:66 offset1:67
    v_mfma_f32_16x16x32_bf16 v[56:59], v[140:143], v[176:179], v[56:59]
    ds_read_b128 v[116:119], v29 offset:8192
    v_mfma_f32_16x16x32_bf16 v[56:59], v[136:139], v[180:183], v[56:59]
    v_mfma_f32_16x16x32_bf16 v[56:59], v[132:135], v[184:187], v[56:59]
    ds_read2_b32 v[88:89], v23 offset0:192 offset1:193
    s_waitcnt lgkmcnt(14)
    v_mfma_f32_16x16x32_bf16 v[60:63], v[132:135], v[188:191], v[60:63]
    ds_read2_b32 v[90:91], v23 offset0:194 offset1:195
    v_mfma_f32_16x16x32_bf16 v[60:63], v[136:139], v[184:187], v[60:63]
    ds_read_b128 v[120:123], v29 offset:10240
    v_mfma_f32_16x16x32_bf16 v[60:63], v[140:143], v[180:183], v[60:63]
    v_mfma_f32_16x16x32_bf16 v[60:63], v[144:147], v[176:179], v[60:63]
    ds_read2_b32 v[92:93], v24 offset0:64 offset1:65
    v_mfma_f32_16x16x32_bf16 v[60:63], v[148:151], v[172:175], v[60:63]
    ds_read2_b32 v[94:95], v24 offset0:66 offset1:67
    v_mfma_f32_16x16x32_bf16 v[60:63], v[152:155], v[168:171], v[60:63]
    ds_read_b128 v[124:127], v29 offset:12288
    v_mfma_f32_16x16x32_bf16 v[60:63], v[156:159], v[164:167], v[60:63]
    v_mfma_f32_16x16x32_bf16 v[64:67], v[160:163], v[164:167], v[64:67]
    ds_read2_b32 v[96:97], v24 offset0:192 offset1:193
    v_mfma_f32_16x16x32_bf16 v[64:67], v[156:159], v[168:171], v[64:67]
    ds_read2_b32 v[98:99], v24 offset0:194 offset1:195
    v_mfma_f32_16x16x32_bf16 v[64:67], v[152:155], v[172:175], v[64:67]
    ds_read_b128 v[128:131], v29 offset:14336
    v_mfma_f32_16x16x32_bf16 v[64:67], v[148:151], v[176:179], v[64:67]
    v_mfma_f32_16x16x32_bf16 v[64:67], v[144:147], v[180:183], v[64:67]
    v_mfma_f32_16x16x32_bf16 v[64:67], v[140:143], v[184:187], v[64:67]
    v_mfma_f32_16x16x32_bf16 v[64:67], v[136:139], v[188:191], v[64:67]
    v_mfma_f32_16x16x32_bf16 v[64:67], v[132:135], v[192:195], v[64:67]
    s_waitcnt lgkmcnt(14)
    v_mfma_f32_16x16x32_bf16 v[36:39], v[68:71], v[100:103], v[36:39]
    ds_read2_b32 v[132:133], v21 offset0:80 offset1:81
    v_mfma_f32_16x16x32_bf16 v[40:43], v[72:75], v[100:103], v[40:43]
    ds_read2_b32 v[134:135], v21 offset0:82 offset1:83
    v_mfma_f32_16x16x32_bf16 v[40:43], v[68:71], v[104:107], v[40:43]
    ds_read_b128 v[164:167], v30 offset:0
    v_mfma_f32_16x16x32_bf16 v[44:47], v[68:71], v[108:111], v[44:47]
    v_mfma_f32_16x16x32_bf16 v[44:47], v[72:75], v[104:107], v[44:47]
    ds_read2_b32 v[136:137], v21 offset0:208 offset1:209
    v_mfma_f32_16x16x32_bf16 v[44:47], v[76:79], v[100:103], v[44:47]
    ds_read2_b32 v[138:139], v21 offset0:210 offset1:211
    s_waitcnt lgkmcnt(14)
    v_mfma_f32_16x16x32_bf16 v[48:51], v[80:83], v[100:103], v[48:51]
    ds_read_b128 v[168:171], v30 offset:2048
    v_mfma_f32_16x16x32_bf16 v[48:51], v[76:79], v[104:107], v[48:51]
    v_mfma_f32_16x16x32_bf16 v[48:51], v[72:75], v[108:111], v[48:51]
    ds_read2_b32 v[140:141], v22 offset0:80 offset1:81
    v_mfma_f32_16x16x32_bf16 v[48:51], v[68:71], v[112:115], v[48:51]
    ds_read2_b32 v[142:143], v22 offset0:82 offset1:83
    v_mfma_f32_16x16x32_bf16 v[52:55], v[68:71], v[116:119], v[52:55]
    ds_read_b128 v[172:175], v30 offset:4096
    v_mfma_f32_16x16x32_bf16 v[52:55], v[72:75], v[112:115], v[52:55]
    v_mfma_f32_16x16x32_bf16 v[52:55], v[76:79], v[108:111], v[52:55]
    ds_read2_b32 v[144:145], v22 offset0:208 offset1:209
    v_mfma_f32_16x16x32_bf16 v[52:55], v[80:83], v[104:107], v[52:55]
    ds_read2_b32 v[146:147], v22 offset0:210 offset1:211
    v_mfma_f32_16x16x32_bf16 v[52:55], v[84:87], v[100:103], v[52:55]
    ds_read_b128 v[176:179], v30 offset:6144
    s_waitcnt lgkmcnt(14)
    v_mfma_f32_16x16x32_bf16 v[56:59], v[88:91], v[100:103], v[56:59]
    v_mfma_f32_16x16x32_bf16 v[56:59], v[84:87], v[104:107], v[56:59]
    ds_read2_b32 v[148:149], v23 offset0:80 offset1:81
    v_mfma_f32_16x16x32_bf16 v[56:59], v[80:83], v[108:111], v[56:59]
    ds_read2_b32 v[150:151], v23 offset0:82 offset1:83
    v_mfma_f32_16x16x32_bf16 v[56:59], v[76:79], v[112:115], v[56:59]
    ds_read_b128 v[180:183], v30 offset:8192
    v_mfma_f32_16x16x32_bf16 v[56:59], v[72:75], v[116:119], v[56:59]
    v_mfma_f32_16x16x32_bf16 v[56:59], v[68:71], v[120:123], v[56:59]
    ds_read2_b32 v[152:153], v23 offset0:208 offset1:209
    v_mfma_f32_16x16x32_bf16 v[60:63], v[68:71], v[124:127], v[60:63]
    ds_read2_b32 v[154:155], v23 offset0:210 offset1:211
    v_mfma_f32_16x16x32_bf16 v[60:63], v[72:75], v[120:123], v[60:63]
    ds_read_b128 v[184:187], v30 offset:10240
    v_mfma_f32_16x16x32_bf16 v[60:63], v[76:79], v[116:119], v[60:63]
    v_mfma_f32_16x16x32_bf16 v[60:63], v[80:83], v[112:115], v[60:63]
    ds_read2_b32 v[156:157], v24 offset0:80 offset1:81
    v_mfma_f32_16x16x32_bf16 v[60:63], v[84:87], v[108:111], v[60:63]
    ds_read2_b32 v[158:159], v24 offset0:82 offset1:83
    v_mfma_f32_16x16x32_bf16 v[60:63], v[88:91], v[104:107], v[60:63]
    ds_read_b128 v[188:191], v30 offset:12288
    v_mfma_f32_16x16x32_bf16 v[60:63], v[92:95], v[100:103], v[60:63]
    s_waitcnt lgkmcnt(14)
    v_mfma_f32_16x16x32_bf16 v[64:67], v[96:99], v[100:103], v[64:67]
    ds_read2_b32 v[160:161], v24 offset0:208 offset1:209
    v_mfma_f32_16x16x32_bf16 v[64:67], v[92:95], v[104:107], v[64:67]
    ds_read2_b32 v[162:163], v24 offset0:210 offset1:211
    v_mfma_f32_16x16x32_bf16 v[64:67], v[88:91], v[108:111], v[64:67]
    ds_read_b128 v[192:195], v30 offset:14336
    v_mfma_f32_16x16x32_bf16 v[64:67], v[84:87], v[112:115], v[64:67]
    v_mfma_f32_16x16x32_bf16 v[64:67], v[80:83], v[116:119], v[64:67]
    v_mfma_f32_16x16x32_bf16 v[64:67], v[76:79], v[120:123], v[64:67]
    v_mfma_f32_16x16x32_bf16 v[64:67], v[72:75], v[124:127], v[64:67]
    v_mfma_f32_16x16x32_bf16 v[64:67], v[68:71], v[128:131], v[64:67]
    v_mfma_f32_16x16x32_bf16 v[36:39], v[132:135], v[164:167], v[36:39]
    ds_read2_b32 v[68:69], v21 offset0:96 offset1:97
    v_mfma_f32_16x16x32_bf16 v[40:43], v[136:139], v[164:167], v[40:43]
    ds_read2_b32 v[70:71], v21 offset0:98 offset1:99
    v_mfma_f32_16x16x32_bf16 v[40:43], v[132:135], v[168:171], v[40:43]
    ds_read_b128 v[100:103], v31 offset:0
    s_waitcnt lgkmcnt(14)
    v_mfma_f32_16x16x32_bf16 v[44:47], v[132:135], v[172:175], v[44:47]
    v_mfma_f32_16x16x32_bf16 v[44:47], v[136:139], v[168:171], v[44:47]
    ds_read2_b32 v[72:73], v21 offset0:224 offset1:225
    v_mfma_f32_16x16x32_bf16 v[44:47], v[140:143], v[164:167], v[44:47]
    ds_read2_b32 v[74:75], v21 offset0:226 offset1:227
    v_mfma_f32_16x16x32_bf16 v[48:51], v[144:147], v[164:167], v[48:51]
    ds_read_b128 v[104:107], v31 offset:2048
    v_mfma_f32_16x16x32_bf16 v[48:51], v[140:143], v[168:171], v[48:51]
    v_mfma_f32_16x16x32_bf16 v[48:51], v[136:139], v[172:175], v[48:51]
    ds_read2_b32 v[76:77], v22 offset0:96 offset1:97
    v_mfma_f32_16x16x32_bf16 v[48:51], v[132:135], v[176:179], v[48:51]
    ds_read2_b32 v[78:79], v22 offset0:98 offset1:99
    s_waitcnt lgkmcnt(14)
    v_mfma_f32_16x16x32_bf16 v[52:55], v[132:135], v[180:183], v[52:55]
    ds_read_b128 v[108:111], v31 offset:4096
    v_mfma_f32_16x16x32_bf16 v[52:55], v[136:139], v[176:179], v[52:55]
    v_mfma_f32_16x16x32_bf16 v[52:55], v[140:143], v[172:175], v[52:55]
    ds_read2_b32 v[80:81], v22 offset0:224 offset1:225
    v_mfma_f32_16x16x32_bf16 v[52:55], v[144:147], v[168:171], v[52:55]
    ds_read2_b32 v[82:83], v22 offset0:226 offset1:227
    v_mfma_f32_16x16x32_bf16 v[52:55], v[148:151], v[164:167], v[52:55]
    ds_read_b128 v[112:115], v31 offset:6144
    v_mfma_f32_16x16x32_bf16 v[56:59], v[152:155], v[164:167], v[56:59]
    v_mfma_f32_16x16x32_bf16 v[56:59], v[148:151], v[168:171], v[56:59]
    ds_read2_b32 v[84:85], v23 offset0:96 offset1:97
    v_mfma_f32_16x16x32_bf16 v[56:59], v[144:147], v[172:175], v[56:59]
    ds_read2_b32 v[86:87], v23 offset0:98 offset1:99
    v_mfma_f32_16x16x32_bf16 v[56:59], v[140:143], v[176:179], v[56:59]
    ds_read_b128 v[116:119], v31 offset:8192
    v_mfma_f32_16x16x32_bf16 v[56:59], v[136:139], v[180:183], v[56:59]
    v_mfma_f32_16x16x32_bf16 v[56:59], v[132:135], v[184:187], v[56:59]
    ds_read2_b32 v[88:89], v23 offset0:224 offset1:225
    s_waitcnt lgkmcnt(14)
    v_mfma_f32_16x16x32_bf16 v[60:63], v[132:135], v[188:191], v[60:63]
    ds_read2_b32 v[90:91], v23 offset0:226 offset1:227
    v_mfma_f32_16x16x32_bf16 v[60:63], v[136:139], v[184:187], v[60:63]
    ds_read_b128 v[120:123], v31 offset:10240
    v_mfma_f32_16x16x32_bf16 v[60:63], v[140:143], v[180:183], v[60:63]
    v_mfma_f32_16x16x32_bf16 v[60:63], v[144:147], v[176:179], v[60:63]
    ds_read2_b32 v[92:93], v24 offset0:96 offset1:97
    v_mfma_f32_16x16x32_bf16 v[60:63], v[148:151], v[172:175], v[60:63]
    ds_read2_b32 v[94:95], v24 offset0:98 offset1:99
    v_mfma_f32_16x16x32_bf16 v[60:63], v[152:155], v[168:171], v[60:63]
    ds_read_b128 v[124:127], v31 offset:12288
    v_mfma_f32_16x16x32_bf16 v[60:63], v[156:159], v[164:167], v[60:63]
    v_mfma_f32_16x16x32_bf16 v[64:67], v[160:163], v[164:167], v[64:67]
    ds_read2_b32 v[96:97], v24 offset0:224 offset1:225
    v_mfma_f32_16x16x32_bf16 v[64:67], v[156:159], v[168:171], v[64:67]
    ds_read2_b32 v[98:99], v24 offset0:226 offset1:227
    v_mfma_f32_16x16x32_bf16 v[64:67], v[152:155], v[172:175], v[64:67]
    ds_read_b128 v[128:131], v31 offset:14336
    v_mfma_f32_16x16x32_bf16 v[64:67], v[148:151], v[176:179], v[64:67]
    v_mfma_f32_16x16x32_bf16 v[64:67], v[144:147], v[180:183], v[64:67]
    v_mfma_f32_16x16x32_bf16 v[64:67], v[140:143], v[184:187], v[64:67]
    v_mfma_f32_16x16x32_bf16 v[64:67], v[136:139], v[188:191], v[64:67]
    v_mfma_f32_16x16x32_bf16 v[64:67], v[132:135], v[192:195], v[64:67]
    s_waitcnt lgkmcnt(14)
    v_mfma_f32_16x16x32_bf16 v[36:39], v[68:71], v[100:103], v[36:39]
    s_add_u32 s89, s95, 131072
    buffer_load_dwordx4 v[228:231], v17, s[64:67], s89 offen
    ds_read2_b32 v[132:133], v21 offset0:112 offset1:113
    v_mfma_f32_16x16x32_bf16 v[40:43], v[72:75], v[100:103], v[40:43]
    ds_read2_b32 v[134:135], v21 offset0:114 offset1:115
    v_mfma_f32_16x16x32_bf16 v[40:43], v[68:71], v[104:107], v[40:43]
    ds_read_b128 v[164:167], v32 offset:0
    v_mfma_f32_16x16x32_bf16 v[44:47], v[68:71], v[108:111], v[44:47]
    v_mfma_f32_16x16x32_bf16 v[44:47], v[72:75], v[104:107], v[44:47]
    ds_read2_b32 v[136:137], v21 offset0:240 offset1:241
    v_mfma_f32_16x16x32_bf16 v[44:47], v[76:79], v[100:103], v[44:47]
    ds_read2_b32 v[138:139], v21 offset0:242 offset1:243
    s_add_u32 s89, s95, 196608
    buffer_load_dwordx4 v[232:235], v17, s[64:67], s89 offen
    s_waitcnt lgkmcnt(14)
    v_mfma_f32_16x16x32_bf16 v[48:51], v[80:83], v[100:103], v[48:51]
    ds_read_b128 v[168:171], v32 offset:2048
    v_mfma_f32_16x16x32_bf16 v[48:51], v[76:79], v[104:107], v[48:51]
    v_mfma_f32_16x16x32_bf16 v[48:51], v[72:75], v[108:111], v[48:51]
    ds_read2_b32 v[140:141], v22 offset0:112 offset1:113
    v_mfma_f32_16x16x32_bf16 v[48:51], v[68:71], v[112:115], v[48:51]
    ds_read2_b32 v[142:143], v22 offset0:114 offset1:115
    v_mfma_f32_16x16x32_bf16 v[52:55], v[68:71], v[116:119], v[52:55]
    ds_read_b128 v[172:175], v32 offset:4096
    v_mfma_f32_16x16x32_bf16 v[52:55], v[72:75], v[112:115], v[52:55]
    s_add_u32 s89, s100, 0
    buffer_load_dwordx4 v[240:243], v17, s[64:67], s89 offen
    v_mfma_f32_16x16x32_bf16 v[52:55], v[76:79], v[108:111], v[52:55]
    ds_read2_b32 v[144:145], v22 offset0:240 offset1:241
    v_mfma_f32_16x16x32_bf16 v[52:55], v[80:83], v[104:107], v[52:55]
    ds_read2_b32 v[146:147], v22 offset0:242 offset1:243
    v_mfma_f32_16x16x32_bf16 v[52:55], v[84:87], v[100:103], v[52:55]
    ds_read_b128 v[176:179], v32 offset:6144
    s_waitcnt lgkmcnt(14)
    v_mfma_f32_16x16x32_bf16 v[56:59], v[88:91], v[100:103], v[56:59]
    v_mfma_f32_16x16x32_bf16 v[56:59], v[84:87], v[104:107], v[56:59]
    ds_read2_b32 v[148:149], v23 offset0:112 offset1:113
    v_mfma_f32_16x16x32_bf16 v[56:59], v[80:83], v[108:111], v[56:59]
    s_add_u32 s89, s100, 65536
    buffer_load_dwordx4 v[244:247], v17, s[64:67], s89 offen
    ds_read2_b32 v[150:151], v23 offset0:114 offset1:115
    v_mfma_f32_16x16x32_bf16 v[56:59], v[76:79], v[112:115], v[56:59]
    ds_read_b128 v[180:183], v32 offset:8192
    v_mfma_f32_16x16x32_bf16 v[56:59], v[72:75], v[116:119], v[56:59]
    v_mfma_f32_16x16x32_bf16 v[56:59], v[68:71], v[120:123], v[56:59]
    ds_read2_b32 v[152:153], v23 offset0:240 offset1:241
    v_mfma_f32_16x16x32_bf16 v[60:63], v[68:71], v[124:127], v[60:63]
    ds_read2_b32 v[154:155], v23 offset0:242 offset1:243
    v_mfma_f32_16x16x32_bf16 v[60:63], v[72:75], v[120:123], v[60:63]
    ds_read_b128 v[184:187], v32 offset:10240
    s_add_u32 s89, s100, 131072
    buffer_load_dwordx4 v[248:251], v17, s[64:67], s89 offen
    v_mfma_f32_16x16x32_bf16 v[60:63], v[76:79], v[116:119], v[60:63]
    v_mfma_f32_16x16x32_bf16 v[60:63], v[80:83], v[112:115], v[60:63]
    ds_read2_b32 v[156:157], v24 offset0:112 offset1:113
    v_mfma_f32_16x16x32_bf16 v[60:63], v[84:87], v[108:111], v[60:63]
    ds_read2_b32 v[158:159], v24 offset0:114 offset1:115
    v_mfma_f32_16x16x32_bf16 v[60:63], v[88:91], v[104:107], v[60:63]
    ds_read_b128 v[188:191], v32 offset:12288
    v_mfma_f32_16x16x32_bf16 v[60:63], v[92:95], v[100:103], v[60:63]
    s_waitcnt lgkmcnt(14)
    v_mfma_f32_16x16x32_bf16 v[64:67], v[96:99], v[100:103], v[64:67]
    ds_read2_b32 v[160:161], v24 offset0:240 offset1:241
    s_add_u32 s89, s100, 196608
    buffer_load_dwordx4 v[196:199], v17, s[64:67], s89 offen
    v_mfma_f32_16x16x32_bf16 v[64:67], v[92:95], v[104:107], v[64:67]
    ds_read2_b32 v[162:163], v24 offset0:242 offset1:243
    v_mfma_f32_16x16x32_bf16 v[64:67], v[88:91], v[108:111], v[64:67]
    ds_read_b128 v[192:195], v32 offset:14336
    v_mfma_f32_16x16x32_bf16 v[64:67], v[84:87], v[112:115], v[64:67]
    v_mfma_f32_16x16x32_bf16 v[64:67], v[80:83], v[116:119], v[64:67]
    v_mfma_f32_16x16x32_bf16 v[64:67], v[76:79], v[120:123], v[64:67]
    v_mfma_f32_16x16x32_bf16 v[64:67], v[72:75], v[124:127], v[64:67]
    v_mfma_f32_16x16x32_bf16 v[64:67], v[68:71], v[128:131], v[64:67]
    v_mfma_f32_16x16x32_bf16 v[36:39], v[132:135], v[164:167], v[36:39]
    v_mfma_f32_16x16x32_bf16 v[40:43], v[136:139], v[164:167], v[40:43]
    v_mfma_f32_16x16x32_bf16 v[40:43], v[132:135], v[168:171], v[40:43]
    s_waitcnt lgkmcnt(14)
    v_mfma_f32_16x16x32_bf16 v[44:47], v[132:135], v[172:175], v[44:47]
    v_mfma_f32_16x16x32_bf16 v[44:47], v[136:139], v[168:171], v[44:47]
    v_mfma_f32_16x16x32_bf16 v[44:47], v[140:143], v[164:167], v[44:47]
    s_waitcnt lgkmcnt(13)
    v_mfma_f32_16x16x32_bf16 v[48:51], v[144:147], v[164:167], v[48:51]
    v_mfma_f32_16x16x32_bf16 v[48:51], v[140:143], v[168:171], v[48:51]
    s_waitcnt lgkmcnt(0)
    v_cvt_pk_bf16_f32 v68, v39, v38
    v_cvt_pk_bf16_f32 v69, v37, v36
    v_mfma_f32_16x16x32_bf16 v[48:51], v[136:139], v[172:175], v[48:51]
    ds_write_b64 v20, v[68:69] offset:0
    v_cvt_pk_bf16_f32 v70, v43, v42
    v_mfma_f32_16x16x32_bf16 v[48:51], v[132:135], v[176:179], v[48:51]
    v_cvt_pk_bf16_f32 v71, v41, v40
    ds_write_b64 v20, v[70:71] offset:2048
    v_mfma_f32_16x16x32_bf16 v[52:55], v[132:135], v[180:183], v[52:55]
    v_mfma_f32_16x16x32_bf16 v[52:55], v[136:139], v[176:179], v[52:55]
    v_cvt_pk_bf16_f32 v72, v47, v46
    v_cvt_pk_bf16_f32 v73, v45, v44
    v_mfma_f32_16x16x32_bf16 v[52:55], v[140:143], v[172:175], v[52:55]
    ds_write_b64 v20, v[72:73] offset:4096
    v_mfma_f32_16x16x32_bf16 v[52:55], v[144:147], v[168:171], v[52:55]
    v_mfma_f32_16x16x32_bf16 v[52:55], v[148:151], v[164:167], v[52:55]
    v_mfma_f32_16x16x32_bf16 v[56:59], v[152:155], v[164:167], v[56:59]
    v_cvt_pk_bf16_f32 v74, v51, v50
    v_cvt_pk_bf16_f32 v75, v49, v48
    v_mfma_f32_16x16x32_bf16 v[56:59], v[148:151], v[168:171], v[56:59]
    ds_write_b64 v20, v[74:75] offset:6144
    v_mfma_f32_16x16x32_bf16 v[56:59], v[144:147], v[172:175], v[56:59]
    v_mfma_f32_16x16x32_bf16 v[56:59], v[140:143], v[176:179], v[56:59]
    v_mfma_f32_16x16x32_bf16 v[56:59], v[136:139], v[180:183], v[56:59]
    v_mfma_f32_16x16x32_bf16 v[56:59], v[132:135], v[184:187], v[56:59]
    v_cvt_pk_bf16_f32 v76, v55, v54
    v_cvt_pk_bf16_f32 v77, v53, v52
    v_mfma_f32_16x16x32_bf16 v[60:63], v[132:135], v[188:191], v[60:63]
    ds_write_b64 v20, v[76:77] offset:8192
    v_mfma_f32_16x16x32_bf16 v[60:63], v[136:139], v[184:187], v[60:63]
    v_mfma_f32_16x16x32_bf16 v[60:63], v[140:143], v[180:183], v[60:63]
    v_mfma_f32_16x16x32_bf16 v[60:63], v[144:147], v[176:179], v[60:63]
    v_mfma_f32_16x16x32_bf16 v[60:63], v[148:151], v[172:175], v[60:63]
    v_mfma_f32_16x16x32_bf16 v[60:63], v[152:155], v[168:171], v[60:63]
    v_cvt_pk_bf16_f32 v78, v59, v58
    v_cvt_pk_bf16_f32 v79, v57, v56
    v_mfma_f32_16x16x32_bf16 v[60:63], v[156:159], v[164:167], v[60:63]
    ds_write_b64 v20, v[78:79] offset:10240
    v_mfma_f32_16x16x32_bf16 v[64:67], v[160:163], v[164:167], v[64:67]
    v_mfma_f32_16x16x32_bf16 v[64:67], v[156:159], v[168:171], v[64:67]
    v_mfma_f32_16x16x32_bf16 v[64:67], v[152:155], v[172:175], v[64:67]
    v_mfma_f32_16x16x32_bf16 v[64:67], v[148:151], v[176:179], v[64:67]
    v_mfma_f32_16x16x32_bf16 v[64:67], v[144:147], v[180:183], v[64:67]
    v_mfma_f32_16x16x32_bf16 v[64:67], v[140:143], v[184:187], v[64:67]
    s_nop 0
    v_cvt_pk_bf16_f32 v80, v63, v62
    v_cvt_pk_bf16_f32 v81, v61, v60
    v_mfma_f32_16x16x32_bf16 v[64:67], v[136:139], v[188:191], v[64:67]
    ds_write_b64 v20, v[80:81] offset:12288
    v_mfma_f32_16x16x32_bf16 v[64:67], v[132:135], v[192:195], v[64:67]
    s_nop 7
    v_cvt_pk_bf16_f32 v82, v67, v66
    v_cvt_pk_bf16_f32 v83, v65, v64
    ds_write_b64 v20, v[82:83] offset:14336
    s_mov_b64 exec, 1
    ds_add_u32 v18, v19 offset:12
    s_mov_b64 exec, -1
    s_add_u32 s80, s86, 94208
    v_add_u32 v5, s80, v15
    s_branch LA_s3_in
LA_s3:
    s_sleep 1
LA_s3_in:
    ds_read_b32 v6, v18 offset:12
    ds_read_b128 v[84:87], v5 offset:0
    ds_read_b128 v[88:91], v5 offset:4096
    ds_read_b128 v[92:95], v5 offset:8192
    ds_read_b128 v[96:99], v5 offset:12288
    s_waitcnt lgkmcnt(0)
    v_readfirstlane_b32 s78, v6
    s_nop 0
    s_cmp_ge_u32 s78, 4
    s_cbranch_scc0 LA_s3
    s_add_u32 s89, s91, 4194304
    buffer_store_dwordx4 v[84:87], v35, s[52:55], s89 offen sc1
    s_add_u32 s89, s91, 4198400
    buffer_store_dwordx4 v[88:91], v35, s[52:55], s89 offen sc1
    s_add_u32 s89, s91, 4202496
    buffer_store_dwordx4 v[92:95], v35, s[52:55], s89 offen sc1
    s_add_u32 s89, s91, 4206592
    buffer_store_dwordx4 v[96:99], v35, s[52:55], s89 offen sc1
    s_add_u32 s83, s86, 129024
    v_add_u32 v8, s83, v15
    s_waitcnt vmcnt(9)
    ds_write_b128 v8, v[228:231] offset:0
    s_waitcnt vmcnt(8)
    ds_write_b128 v8, v[232:235] offset:4096
    s_waitcnt vmcnt(7)
    ds_write_b128 v8, v[240:243] offset:8192
    s_waitcnt vmcnt(6)
    ds_write_b128 v8, v[244:247] offset:12288
    s_waitcnt vmcnt(5)
    ds_write_b128 v8, v[248:251] offset:16384
    s_waitcnt vmcnt(4)
    ds_write_b128 v8, v[196:199] offset:20480
    s_mov_b64 exec, 1
    ds_add_u32 v18, v19 offset:32
    s_mov_b64 exec, -1
    s_setprio 0
    s_mov_b32 s60, s22
    s_mov_b32 s61, s23
    s_mov_b32 s62, 0x800000
    s_mov_b32 s63, 0x20000
    s_lshr_b32 s81, s91, 4
    s_lshl_b32 s82, s3, 8
    s_add_u32 s81, s81, s82
    s_add_u32 s81, s81, 12648448
    s_lshl_b32 s80, s74, 14
    s_and_b32 s82, s75, 3
    s_lshl_b32 s82, s82, 8
    s_add_u32 s80, s80, s82
    s_add_u32 s80, s80, 12648448
    v_mov_b32 v5, 0
    v_lshlrev_b32 v7, 10, v0
    v_lshlrev_b32 v132, 16, v212
    v_and_b32 v133, 0xffff0000, v212
    v_lshlrev_b32 v134, 16, v213
    v_and_b32 v135, 0xffff0000, v213
    v_lshlrev_b32 v136, 16, v214
    v_and_b32 v137, 0xffff0000, v214
    v_lshlrev_b32 v138, 16, v215
    v_and_b32 v139, 0xffff0000, v215
    v_lshlrev_b32 v140, 16, v216
    v_and_b32 v141, 0xffff0000, v216
    v_lshlrev_b32 v142, 16, v217
    v_and_b32 v143, 0xffff0000, v217
    v_lshlrev_b32 v144, 16, v218
    v_and_b32 v145, 0xffff0000, v218
    v_lshlrev_b32 v146, 16, v219
    v_and_b32 v147, 0xffff0000, v219
    v_lshlrev_b32 v148, 16, v220
    v_and_b32 v149, 0xffff0000, v220
    v_lshlrev_b32 v150, 16, v221
    v_and_b32 v151, 0xffff0000, v221
    v_lshlrev_b32 v152, 16, v222
    v_and_b32 v153, 0xffff0000, v222
    v_lshlrev_b32 v154, 16, v223
    v_and_b32 v155, 0xffff0000, v223
    v_lshlrev_b32 v156, 16, v224
    v_and_b32 v157, 0xffff0000, v224
    v_lshlrev_b32 v158, 16, v225
    v_and_b32 v159, 0xffff0000, v225
    v_lshlrev_b32 v160, 16, v226
    v_and_b32 v161, 0xffff0000, v226
    v_lshlrev_b32 v162, 16, v227
    v_and_b32 v163, 0xffff0000, v227
    s_waitcnt vmcnt(0)
    s_mov_b64 exec, 1
    buffer_store_dword v19, v5, s[52:55], s81 offen sc1
    s_mov_b64 exec, 0xffff
    s_waitcnt vmcnt(0)
    s_branch LA_s7_in
LA_s7:
    s_sleep 1
LA_s7_in:
    ds_read_b32 v6, v18 offset:28
    s_waitcnt lgkmcnt(0)
    v_readfirstlane_b32 s78, v6
    s_nop 0
    s_cmp_ge_u32 s78, 4
    s_cbranch_scc0 LA_s7
    s_setprio 2
    s_mov_b32 s79, 0
LA_py:
    buffer_load_dword v6, v7, s[52:55], s80 offen sc1
    s_add_u32 s79, s79, 1
    s_cmp_gt_u32 s79, 200000
    s_cbranch_scc1 LA_py_x
    s_waitcnt vmcnt(0)
    v_cmp_ne_u32 vcc, 1, v6
    s_cbranch_vccz LA_py_x
    s_mov_b64 exec, vcc
    s_sleep 8
    s_branch LA_py
LA_py_x:
    s_waitcnt vmcnt(0)
    s_mov_b64 exec, -1
    s_mov_b32 s89, 4194304
    buffer_load_dwordx4 v[100:103], v12, s[52:55], s89 offen sc1
    s_mov_b32 s89, 4210688
    buffer_load_dwordx4 v[104:107], v12, s[52:55], s89 offen sc1
    s_mov_b32 s89, 4227072
    buffer_load_dwordx4 v[108:111], v12, s[52:55], s89 offen sc1
    s_mov_b32 s89, 4243456
    buffer_load_dwordx4 v[112:115], v12, s[52:55], s89 offen sc1
    s_waitcnt vmcnt(3)
    v_permlane32_swap_b32 v102, v100
    v_permlane32_swap_b32 v103, v101
    s_waitcnt vmcnt(2)
    v_permlane32_swap_b32 v106, v104
    v_permlane32_swap_b32 v107, v105
    s_waitcnt vmcnt(1)
    v_permlane32_swap_b32 v110, v108
    v_permlane32_swap_b32 v111, v109
    s_waitcnt vmcnt(0)
    v_permlane32_swap_b32 v114, v112
    v_permlane32_swap_b32 v115, v113
    v_and_b32 v68, 0xffff0000, v103
    v_and_b32 v69, 0xffff0000, v107
    v_and_b32 v70, 0xffff0000, v111
    v_and_b32 v71, 0xffff0000, v115
    v_and_b32 v72, 0xffff0000, v101
    v_and_b32 v73, 0xffff0000, v105
    v_and_b32 v74, 0xffff0000, v109
    v_and_b32 v75, 0xffff0000, v113
    v_mul_f32 v68, v68, v132
    v_mul_f32 v69, v69, v133
    v_mul_f32 v70, v70, v134
    v_mul_f32 v71, v71, v135
    v_mul_f32 v72, v72, v136
    v_mul_f32 v73, v73, v137
    v_mul_f32 v74, v74, v138
    v_mul_f32 v75, v75, v139
    v_cvt_pk_bf16_f32 v36, v68, v69
    v_cvt_pk_bf16_f32 v37, v70, v71
    v_cvt_pk_bf16_f32 v38, v72, v73
    v_cvt_pk_bf16_f32 v39, v74, v75
    s_mov_b32 s89, 0
    buffer_store_dwordx4 v[36:39], v13, s[60:63], s89 offen nt sc1
    v_lshlrev_b32 v68, 16, v103
    v_lshlrev_b32 v69, 16, v107
    v_lshlrev_b32 v70, 16, v111
    v_lshlrev_b32 v71, 16, v115
    v_lshlrev_b32 v72, 16, v101
    v_lshlrev_b32 v73, 16, v105
    v_lshlrev_b32 v74, 16, v109
    v_lshlrev_b32 v75, 16, v113
    v_mul_f32 v68, v68, v140
    v_mul_f32 v69, v69, v141
    v_mul_f32 v70, v70, v142
    v_mul_f32 v71, v71, v143
    v_mul_f32 v72, v72, v144
    v_mul_f32 v73, v73, v145
    v_mul_f32 v74, v74, v146
    v_mul_f32 v75, v75, v147
    v_cvt_pk_bf16_f32 v40, v68, v69
    v_cvt_pk_bf16_f32 v41, v70, v71
    v_cvt_pk_bf16_f32 v42, v72, v73
    v_cvt_pk_bf16_f32 v43, v74, v75
    s_mov_b32 s89, 4096
    buffer_store_dwordx4 v[40:43], v13, s[60:63], s89 offen nt sc1
    v_and_b32 v68, 0xffff0000, v102
    v_and_b32 v69, 0xffff0000, v106
    v_and_b32 v70, 0xffff0000, v110
    v_and_b32 v71, 0xffff0000, v114
    v_and_b32 v72, 0xffff0000, v100
    v_and_b32 v73, 0xffff0000, v104
    v_and_b32 v74, 0xffff0000, v108
    v_and_b32 v75, 0xffff0000, v112
    v_mul_f32 v68, v68, v148
    v_mul_f32 v69, v69, v149
    v_mul_f32 v70, v70, v150
    v_mul_f32 v71, v71, v151
    v_mul_f32 v72, v72, v152
    v_mul_f32 v73, v73, v153
    v_mul_f32 v74, v74, v154
    v_mul_f32 v75, v75, v155
    v_cvt_pk_bf16_f32 v44, v68, v69
    v_cvt_pk_bf16_f32 v45, v70, v71
    v_cvt_pk_bf16_f32 v46, v72, v73
    v_cvt_pk_bf16_f32 v47, v74, v75
    s_mov_b32 s89, 8192
    buffer_store_dwordx4 v[44:47], v13, s[60:63], s89 offen nt sc1
    v_lshlrev_b32 v68, 16, v102
    v_lshlrev_b32 v69, 16, v106
    v_lshlrev_b32 v70, 16, v110
    v_lshlrev_b32 v71, 16, v114
    v_lshlrev_b32 v72, 16, v100
    v_lshlrev_b32 v73, 16, v104
    v_lshlrev_b32 v74, 16, v108
    v_lshlrev_b32 v75, 16, v112
    v_mul_f32 v68, v68, v156
    v_mul_f32 v69, v69, v157
    v_mul_f32 v70, v70, v158
    v_mul_f32 v71, v71, v159
    v_mul_f32 v72, v72, v160
    v_mul_f32 v73, v73, v161
    v_mul_f32 v74, v74, v162
    v_mul_f32 v75, v75, v163
    v_cvt_pk_bf16_f32 v48, v68, v69
    v_cvt_pk_bf16_f32 v49, v70, v71
    v_cvt_pk_bf16_f32 v50, v72, v73
    v_cvt_pk_bf16_f32 v51, v74, v75
    s_mov_b32 s89, 12288
    buffer_store_dwordx4 v[48:51], v13, s[60:63], s89 offen nt sc1
    s_endpgm
L_B:
    s_setprio 3
    s_and_b32 s3, s3, 3
    s_add_u32 s79, s72, s73
    s_add_u32 s78, s72, 5
    s_and_b32 s78, s78, 7
    s_lshl_b32 s78, s78, 1
    s_and_b32 s75, s79, 1
    s_add_u32 s78, s78, s75
    s_andn2_b32 s79, 2, s79
    s_lshl_b32 s79, s79, 3
    s_add_u32 s78, s78, s79
    s_and_b32 s76, s78, 3
    s_and_b32 s79, s73, 12
    s_add_u32 s76, s76, s79
    s_lshr_b32 s74, s78, 4
    s_add_u32 s74, s74, s79
    s_and_b32 s79, s72, 8
    s_lshr_b32 s77, s78, 2
    s_add_u32 s77, s77, s79
    s_lshr_b32 s79, s79, 2
    s_add_u32 s74, s74, s79
    s_xor_b32 s74, s74, 6
    s_and_b32 s75, s78, 15
    s_lshr_b32 s86, s3, 1
    s_and_b32 s87, s3, 1
    v_mov_b32 v10, 162304
    v_mov_b32 v11, 1
    v_lshlrev_b32 v12, 4, v0
    v_lshlrev_b32 v216, 3, v0
    v_mov_b32 v212, 0
    v_mov_b32 v213, 0
    v_mov_b32 v214, 0
    v_mov_b32 v215, 0
    v_lshl_add_u32 v13, v0, 2, v10
    ds_write_b32 v13, v212
    s_lshl_b32 s78, s3, 9
    s_add_u32 s78, s78, 92160
    v_add_u32 v13, s78, v216
    ds_write_b64 v13, v[212:213]
    s_lshl_b32 s78, s74, 4
    s_add_u32 s78, s78, s75
    s_lshl_b32 s96, s78, 8
    s_add_u32 s96, s96, 12582912
    s_lshl_b32 s78, s78, 2
    s_add_u32 s78, s78, s3
    s_lshl_b32 s78, s78, 8
    s_add_u32 s80, s78, 12648448
    s_lshl_b32 s81, s72, 1
    s_add_u32 s81, s81, s86
    s_lshl_b32 s97, s81, 4
    s_add_u32 s97, s97, s73
    s_lshl_b32 s97, s97, 8
    s_add_u32 s97, s97, 12910464
    v_mov_b32 v15, s80
    v_mov_b32 v223, s97
    v_cmp_gt_u32 vcc, 8, v0
    s_nop 1
    v_cndmask_b32 v15, v223, v15, vcc
    v_add_u32 v221, v15, v12
    s_lshl_b32 s78, s87, 2
    s_add_u32 s78, s78, 128
    s_add_u32 s97, s97, s78
    s_lshl_b32 s82, s73, 1
    s_add_u32 s82, s82, s87
    s_lshl_b32 s78, s81, 7
    s_add_u32 s78, s78, s82
    s_lshl_b32 s94, s78, 10
    s_add_u32 s94, s94, 8388608
    v_mov_b32 v220, 0
    s_waitcnt lgkmcnt(0)
    s_mov_b32 s52, s26
    s_mov_b32 s53, s27
    s_mov_b32 s54, 0x1000000
    s_mov_b32 s55, 0x20000
    s_mov_b32 s68, s24
    s_mov_b32 s69, s25
    s_mov_b32 s70, 0x100
    s_mov_b32 s71, 0x20000
    s_lshl_b32 s98, s74, 4
    s_or_b32 s78, s75, s3
    s_cmp_lg_u32 s78, 0
    s_cbranch_scc1 LB_notag
    s_mov_b64 exec, 0xffff
    v_lshlrev_b32 v15, 8, v0
    buffer_load_dword v251, v15, s[52:55], s96 offen sc1
LB_notag:
    s_lshl_b32 s78, s87, 3
    s_lshr_b32 exec_lo, 0xffff, s78
    s_mov_b32 exec_hi, 0
    buffer_store_dwordx4 v[212:215], v221, s[52:55], 0 offen sc1
    s_mov_b64 exec, -1
    v_and_b32 v13, 15, v0
    v_lshrrev_b32 v14, 4, v0
    v_lshrrev_b32 v15, 1, v13
    v_xor_b32 v15, v15, v14
    v_lshlrev_b32 v15, 4, v15
    v_lshl_add_u32 v15, v13, 7, v15
    s_lshl_b32 s78, s86, 13
    s_add_u32 s78, s78, 75776
    v_add_u32 v4, s78, v15
    v_xor_b32 v5, 64, v4
    v_bfe_u32 v15, v0, 3, 2
    s_lshl_b32 s78, s87, 1
    v_xor_b32 v15, s78, v15
    v_lshlrev_b32 v15, 5, v15
    v_and_b32 v223, 3, v0
    v_lshl_add_u32 v15, v223, 3, v15
    v_bfe_u32 v223, v0, 2, 2
    v_lshl_add_u32 v15, v223, 7, v15
    v_mul_u32_u24 v223, 3072, v14
    v_add_u32 v6, v223, v15
    v_xor_b32 v7, 32, v6
    s_mov_b32 s60, s22
    s_mov_b32 s61, s23
    s_mov_b32 s62, 0x800000
    s_mov_b32 s63, 0x20000
    s_mov_b32 s64, s20
    s_mov_b32 s65, s21
    s_mov_b32 s66, 0x200000
    s_mov_b32 s67, 0x20000
    v_and_b32 v15, 1, v13
    v_cmp_eq_u32 s[88:89], 1, v15
    v_lshl_add_u32 v15, v14, 2, v15
    v_cmp_le_u32 s[90:91], v15, v13
    v_add_u32 v15, 2, v15
    v_cmp_le_u32 s[92:93], v15, v13
    v_mov_b32 v212, 0x0c0c0c0c
    v_mov_b32 v15, 0xc0c0100
    v_mov_b32 v223, 0x1000c0c
    v_cndmask_b32 v15, v15, v223, s[88:89]
    v_cndmask_b32 v208, v15, v212, s[90:91]
    v_cndmask_b32 v210, v212, v15, s[90:91]
    v_mov_b32 v15, 0xc0c0302
    v_mov_b32 v223, 0x3020c0c
    v_cndmask_b32 v15, v15, v223, s[88:89]
    v_cndmask_b32 v209, v15, v212, s[92:93]
    v_cndmask_b32 v211, v212, v15, s[92:93]
    s_lshl_b32 s99, s72, 1
    s_lshr_b32 s78, s3, 1
    s_add_u32 s99, s99, s78
    s_lshl_b32 s99, s99, 4
    s_add_u32 s99, s99, s73
    s_lshl_b32 s99, s99, 1
    s_and_b32 s78, s3, 1
    s_add_u32 s99, s99, s78
    s_lshl_b32 s99, s99, 11
    s_add_u32 s99, s99, 14680064
    s_sub_u32 s100, s99, 65536
    s_or_b32 s78, s72, s86
    s_cmp_eq_u32 s78, 0
    s_cselect_b32 s78, 0xf149f2ca, 0
    s_cselect_b32 s79, 0x40000000, 0
    v_mov_b32 v212, s78
    v_mov_b32 v213, s78
    v_mov_b32 v214, s78
    v_mov_b32 v215, s78
    v_or_b32 v217, s79, v12
    v_or_b32 v218, s79, v216
    v_bfe_u32 v14, v0, 3, 2
    v_lshlrev_b32 v14, 5, v14
    v_and_b32 v15, 3, v0
    v_lshl_add_u32 v14, v15, 3, v14
    v_lshrrev_b32 v15, 2, v0
    v_lshl_add_u32 v244, v15, 7, v14
    v_lshrrev_b32 v14, 4, v0
    v_lshlrev_b32 v14, 1, v14
    v_and_b32 v15, 7, v0
    v_xor_b32 v14, v14, v15
    v_lshlrev_b32 v14, 4, v14
    v_lshrrev_b32 v15, 3, v0
    v_lshl_add_u32 v14, v15, 11, v14
    s_lshl_b32 s78, s77, 7
    s_lshl_b32 s79, s3, 14
    s_add_u32 s78, s78, s79
    v_add_u32 v245, s78, v14
    s_lshl_b32 s80, s76, 2
    s_add_u32 s80, s80, s3
    s_lshl_b32 s28, s80, 16
    s_add_u32 s28, s28, 8388608
    s_lshl_b32 s30, s76, 1
    s_add_u32 s30, s30, s86
    s_lshl_b32 s30, s30, 12
    s_add_u32 s30, s30, 12910592
    v_lshrrev_b32 v15, 1, v0
    v_lshlrev_b32 v15, 8, v15
    v_and_b32 v14, 1, v0
    v_lshl_add_u32 v247, v14, 2, v15
    s_and_b32 s79, s76, 3
    s_mul_i32 s79, s79, 0x22222222
    s_add_u32 s79, s79, 0x76543210
    s_bfe_u32 s78, s79, 0x30000
    s_lshl_b32 s44, s78, 18
    s_lshl_b32 s78, s78, 12
    s_add_u32 s36, s78, s28
    s_bfe_u32 s78, s79, 0x30004
    s_lshl_b32 s45, s78, 18
    s_lshl_b32 s78, s78, 12
    s_add_u32 s37, s78, s28
    s_bfe_u32 s78, s79, 0x30008
    s_lshl_b32 s46, s78, 18
    s_lshl_b32 s78, s78, 12
    s_add_u32 s38, s78, s28
    s_bfe_u32 s78, s79, 0x3000c
    s_lshl_b32 s47, s78, 18
    s_lshl_b32 s78, s78, 12
    s_add_u32 s39, s78, s28
    s_bfe_u32 s78, s79, 0x30010
    s_lshl_b32 s48, s78, 18
    s_lshl_b32 s78, s78, 12
    s_add_u32 s40, s78, s28
    s_bfe_u32 s78, s79, 0x30014
    s_lshl_b32 s49, s78, 18
    s_lshl_b32 s78, s78, 12
    s_add_u32 s41, s78, s28
    s_bfe_u32 s78, s79, 0x30018
    s_lshl_b32 s50, s78, 18
    s_lshl_b32 s78, s78, 12
    s_add_u32 s42, s78, s28
    s_bfe_u32 s78, s79, 0x3001c
    s_lshl_b32 s51, s78, 18
    s_lshl_b32 s78, s78, 12
    s_add_u32 s43, s78, s28
    s_lshl_b32 s34, s3, 10
    v_bfe_u32 v14, v0, 4, 1
    v_lshrrev_b32 v15, 5, v0
    v_lshl_add_u32 v14, v14, 1, v15
    v_and_b32 v15, 7, v0
    v_xor_b32 v14, v14, v15
    v_lshlrev_b32 v14, 4, v14
    v_and_b32 v223, 15, v0
    v_lshl_add_u32 v14, v223, 7, v14
    s_lshl_b32 s78, s3, 12
    v_add_u32 v248, s78, v14
    v_xor_b32 v249, 64, v248
    v_add_u32 v250, s78, v12
    v_lshrrev_b32 v14, 3, v0
    v_xor_b32 v15, v15, v14
    v_lshlrev_b32 v15, 4, v15
    v_lshl_add_u32 v14, v14, 12, v15
    s_lshl_b32 s78, s80, 17
    s_lshl_b32 s79, s77, 7
    s_add_u32 s78, s78, s79
    s_add_u32 s78, s78, 2048
    v_add_u32 v246, s78, v14
    s_waitcnt lgkmcnt(0)
    s_barrier
    ds_read_b64_tr_b16 v[184:185], v6 offset:1024
    ds_read_b64_tr_b16 v[186:187], v6 offset:1536
    ds_read_b64_tr_b16 v[188:189], v6 offset:13312
    ds_read_b64_tr_b16 v[190:191], v6 offset:13824
    ds_read_b128 v[144:147], v4 offset:6144
    ds_read_b128 v[148:151], v5 offset:6144
    ds_read_b128 v[136:139], v4 offset:4096
    ds_read_b128 v[140:143], v5 offset:4096
    ds_read_b128 v[128:131], v4 offset:2048
    ds_read_b128 v[132:135], v5 offset:2048
    ds_read_b128 v[120:123], v4 offset:0
    ds_read_b128 v[124:127], v5 offset:0
    ds_read_b64_tr_b16 v[192:193], v7 offset:1024
    ds_read_b64_tr_b16 v[194:195], v7 offset:1536
    ds_read_b64_tr_b16 v[196:197], v7 offset:13312
    ds_read_b64_tr_b16 v[198:199], v7 offset:13824
    s_waitcnt lgkmcnt(11)
    v_mfma_f32_16x16x32_bf16 v[72:75], v[184:187], v[144:147], 0
    ds_read_b64_tr_b16 v[200:201], v6 offset:0
    s_waitcnt lgkmcnt(11)
    v_mfma_f32_16x16x32_bf16 v[72:75], v[188:191], v[148:151], v[72:75]
    ds_read_b64_tr_b16 v[202:203], v6 offset:512
    s_waitcnt lgkmcnt(10)
    v_mfma_f32_16x16x32_bf16 v[64:67], v[188:191], v[140:143], 0
    ds_read_b64_tr_b16 v[204:205], v6 offset:12288
    v_mfma_f32_16x16x32_bf16 v[64:67], v[184:187], v[136:139], v[64:67]
    ds_read_b64_tr_b16 v[206:207], v6 offset:12800
    s_waitcnt lgkmcnt(11)
    v_mfma_f32_16x16x32_bf16 v[56:59], v[184:187], v[128:131], 0
    s_waitcnt lgkmcnt(10)
    v_mfma_f32_16x16x32_bf16 v[56:59], v[188:191], v[132:135], v[56:59]
    s_waitcnt lgkmcnt(8)
    v_mfma_f32_16x16x32_bf16 v[48:51], v[188:191], v[124:127], 0
    v_mfma_f32_16x16x32_bf16 v[48:51], v[184:187], v[120:123], v[48:51]
    s_waitcnt lgkmcnt(4)
    v_mfma_f32_16x16x32_bf16 v[52:55], v[192:195], v[120:123], 0
    ds_read_b64_tr_b16 v[184:185], v7 offset:0
    v_mfma_f32_16x16x32_bf16 v[52:55], v[196:199], v[124:127], v[52:55]
    ds_read_b64_tr_b16 v[186:187], v7 offset:512
    v_mfma_f32_16x16x32_bf16 v[60:63], v[196:199], v[132:135], 0
    ds_read_b64_tr_b16 v[188:189], v7 offset:12288
    v_mfma_f32_16x16x32_bf16 v[60:63], v[192:195], v[128:131], v[60:63]
    ds_read_b64_tr_b16 v[190:191], v7 offset:12800
    v_mfma_f32_16x16x32_bf16 v[68:71], v[192:195], v[136:139], 0
    v_mfma_f32_16x16x32_bf16 v[68:71], v[196:199], v[140:143], v[68:71]
    v_mfma_f32_16x16x32_bf16 v[76:79], v[196:199], v[148:151], 0
    v_mfma_f32_16x16x32_bf16 v[76:79], v[192:195], v[144:147], v[76:79]
    s_barrier
    s_waitcnt lgkmcnt(4)
    v_mfma_f32_16x16x32_bf16 v[40:43], v[200:203], v[144:147], 0
    ds_read_b64_tr_b16 v[192:193], v6 offset:2048
    ds_read_b64_tr_b16 v[194:195], v6 offset:2560
    v_mfma_f32_16x16x32_bf16 v[40:43], v[204:207], v[148:151], v[40:43]
    ds_read_b64_tr_b16 v[196:197], v6 offset:14336
    ds_read_b64_tr_b16 v[198:199], v6 offset:14848
    v_mfma_f32_16x16x32_bf16 v[32:35], v[204:207], v[140:143], 0
    ds_read_b128 v[176:179], v4 offset:24576
    ds_read_b128 v[180:183], v5 offset:24576
    v_mfma_f32_16x16x32_bf16 v[32:35], v[200:203], v[136:139], v[32:35]
    ds_read_b128 v[168:171], v4 offset:22528
    ds_read_b128 v[172:175], v5 offset:22528
    v_mfma_f32_16x16x32_bf16 v[24:27], v[200:203], v[128:131], 0
    v_mfma_f32_16x16x32_bf16 v[24:27], v[204:207], v[132:135], v[24:27]
    v_mfma_f32_16x16x32_bf16 v[16:19], v[204:207], v[124:127], 0
    v_mfma_f32_16x16x32_bf16 v[16:19], v[200:203], v[120:123], v[16:19]
    s_waitcnt lgkmcnt(8)
    v_mfma_f32_16x16x32_bf16 v[20:23], v[184:187], v[120:123], 0
    ds_read_b64_tr_b16 v[200:201], v7 offset:2048
    ds_read_b64_tr_b16 v[202:203], v7 offset:2560
    v_mfma_f32_16x16x32_bf16 v[20:23], v[188:191], v[124:127], v[20:23]
    ds_read_b64_tr_b16 v[204:205], v7 offset:14336
    ds_read_b64_tr_b16 v[206:207], v7 offset:14848
    v_mfma_f32_16x16x32_bf16 v[28:31], v[188:191], v[132:135], 0
    ds_read_b128 v[160:163], v4 offset:20480
    ds_read_b128 v[164:167], v5 offset:20480
    v_mfma_f32_16x16x32_bf16 v[28:31], v[184:187], v[128:131], v[28:31]
    ds_read_b128 v[152:155], v4 offset:18432
    ds_read_b128 v[156:159], v5 offset:18432
    v_mfma_f32_16x16x32_bf16 v[36:39], v[184:187], v[136:139], 0
    v_mfma_f32_16x16x32_bf16 v[36:39], v[188:191], v[140:143], v[36:39]
    v_mfma_f32_16x16x32_bf16 v[44:47], v[188:191], v[148:151], 0
    v_mfma_f32_16x16x32_bf16 v[44:47], v[184:187], v[144:147], v[44:47]
    s_waitcnt lgkmcnt(12)
    v_mfma_f32_16x16x32_bf16 v[104:107], v[144:147], v[192:195], 0
    v_mfma_f32_16x16x32_bf16 v[104:107], v[148:151], v[196:199], v[104:107]
    v_mfma_f32_16x16x32_bf16 v[96:99], v[140:143], v[196:199], 0
    v_mfma_f32_16x16x32_bf16 v[96:99], v[136:139], v[192:195], v[96:99]
    s_waitcnt vmcnt(0) lgkmcnt(0)
    s_barrier
    s_or_b32 s78, s75, s3
    s_cbranch_scc0 LB_tag
LB_tagb:
    v_mfma_f32_16x16x32_bf16 v[88:91], v[128:131], v[192:195], 0
    ds_read_b64_tr_b16 v[184:185], v6 offset:25600
    v_mfma_f32_16x16x32_bf16 v[88:91], v[132:135], v[196:199], v[88:91]
    ds_read_b64_tr_b16 v[186:187], v6 offset:26112
    v_mfma_f32_16x16x32_bf16 v[80:83], v[124:127], v[196:199], 0
    ds_read_b64_tr_b16 v[188:189], v6 offset:37888
    v_mfma_f32_16x16x32_bf16 v[80:83], v[120:123], v[192:195], v[80:83]
    ds_read_b64_tr_b16 v[190:191], v6 offset:38400
    v_mfma_f32_16x16x32_bf16 v[84:87], v[120:123], v[200:203], 0
    ds_read_b64_tr_b16 v[192:193], v7 offset:25600
    v_mfma_f32_16x16x32_bf16 v[84:87], v[124:127], v[204:207], v[84:87]
    ds_read_b64_tr_b16 v[194:195], v7 offset:26112
    v_mfma_f32_16x16x32_bf16 v[92:95], v[132:135], v[204:207], 0
    ds_read_b64_tr_b16 v[196:197], v7 offset:37888
    v_mfma_f32_16x16x32_bf16 v[92:95], v[128:131], v[200:203], v[92:95]
    ds_read_b64_tr_b16 v[198:199], v7 offset:38400
    v_mfma_f32_16x16x32_bf16 v[100:103], v[136:139], v[200:203], 0
    v_mfma_f32_16x16x32_bf16 v[100:103], v[140:143], v[204:207], v[100:103]
    v_mfma_f32_16x16x32_bf16 v[108:111], v[148:151], v[204:207], 0
    v_mfma_f32_16x16x32_bf16 v[108:111], v[144:147], v[200:203], v[108:111]
    s_waitcnt lgkmcnt(4)
    v_mfma_f32_16x16x32_bf16 v[72:75], v[184:187], v[176:179], v[72:75]
    ds_read_b64_tr_b16 v[200:201], v6 offset:24576
    v_mfma_f32_16x16x32_bf16 v[72:75], v[188:191], v[180:183], v[72:75]
    ds_read_b64_tr_b16 v[202:203], v6 offset:25088
    v_mfma_f32_16x16x32_bf16 v[64:67], v[188:191], v[172:175], v[64:67]
    ds_read_b64_tr_b16 v[204:205], v6 offset:36864
    v_mfma_f32_16x16x32_bf16 v[64:67], v[184:187], v[168:171], v[64:67]
    ds_read_b64_tr_b16 v[206:207], v6 offset:37376
    v_mfma_f32_16x16x32_bf16 v[56:59], v[184:187], v[160:163], v[56:59]
    ds_read_b128 v[144:147], v4 offset:43008
    v_mfma_f32_16x16x32_bf16 v[56:59], v[188:191], v[164:167], v[56:59]
    ds_read_b128 v[148:151], v5 offset:43008
    v_mfma_f32_16x16x32_bf16 v[48:51], v[188:191], v[156:159], v[48:51]
    ds_read_b128 v[136:139], v4 offset:40960
    v_mfma_f32_16x16x32_bf16 v[48:51], v[184:187], v[152:155], v[48:51]
    s_waitcnt lgkmcnt(7)
    v_mfma_f32_16x16x32_bf16 v[52:55], v[192:195], v[152:155], v[52:55]
    ds_read_b64_tr_b16 v[184:185], v7 offset:24576
    v_mfma_f32_16x16x32_bf16 v[52:55], v[196:199], v[156:159], v[52:55]
    ds_read_b64_tr_b16 v[186:187], v7 offset:25088
    v_mfma_f32_16x16x32_bf16 v[60:63], v[196:199], v[164:167], v[60:63]
    ds_read_b64_tr_b16 v[188:189], v7 offset:36864
    v_mfma_f32_16x16x32_bf16 v[60:63], v[192:195], v[160:163], v[60:63]
    ds_read_b64_tr_b16 v[190:191], v7 offset:37376
    v_mfma_f32_16x16x32_bf16 v[68:71], v[192:195], v[168:171], v[68:71]
    ds_read_b128 v[140:143], v5 offset:40960
    v_mfma_f32_16x16x32_bf16 v[68:71], v[196:199], v[172:175], v[68:71]
    ds_read_b128 v[128:131], v4 offset:38912
    v_mfma_f32_16x16x32_bf16 v[76:79], v[196:199], v[180:183], v[76:79]
    ds_read_b128 v[132:135], v5 offset:38912
    v_mfma_f32_16x16x32_bf16 v[76:79], v[192:195], v[176:179], v[76:79]
    s_waitcnt lgkmcnt(10)
    v_mfma_f32_16x16x32_bf16 v[40:43], v[200:203], v[176:179], v[40:43]
    ds_read_b64_tr_b16 v[192:193], v6 offset:26624
    v_mfma_f32_16x16x32_bf16 v[40:43], v[204:207], v[180:183], v[40:43]
    ds_read_b64_tr_b16 v[194:195], v6 offset:27136
    v_mfma_f32_16x16x32_bf16 v[32:35], v[204:207], v[172:175], v[32:35]
    ds_read_b64_tr_b16 v[196:197], v6 offset:38912
    v_mfma_f32_16x16x32_bf16 v[32:35], v[200:203], v[168:171], v[32:35]
    ds_read_b64_tr_b16 v[198:199], v6 offset:39424
    v_mfma_f32_16x16x32_bf16 v[24:27], v[200:203], v[160:163], v[24:27]
    ds_read_b128 v[120:123], v4 offset:36864
    v_mfma_f32_16x16x32_bf16 v[24:27], v[204:207], v[164:167], v[24:27]
    ds_read_b128 v[124:127], v5 offset:36864
    v_mfma_f32_16x16x32_bf16 v[16:19], v[204:207], v[156:159], v[16:19]
    v_mfma_f32_16x16x32_bf16 v[16:19], v[200:203], v[152:155], v[16:19]
    s_waitcnt lgkmcnt(9)
    v_mfma_f32_16x16x32_bf16 v[20:23], v[184:187], v[152:155], v[20:23]
    ds_read_b64_tr_b16 v[200:201], v7 offset:26624
    v_mfma_f32_16x16x32_bf16 v[20:23], v[188:191], v[156:159], v[20:23]
    ds_read_b64_tr_b16 v[202:203], v7 offset:27136
    v_mfma_f32_16x16x32_bf16 v[28:31], v[188:191], v[164:167], v[28:31]
    ds_read_b64_tr_b16 v[204:205], v7 offset:38912
    v_mfma_f32_16x16x32_bf16 v[28:31], v[184:187], v[160:163], v[28:31]
    ds_read_b64_tr_b16 v[206:207], v7 offset:39424
    v_mfma_f32_16x16x32_bf16 v[36:39], v[184:187], v[168:171], v[36:39]
    v_mfma_f32_16x16x32_bf16 v[36:39], v[188:191], v[172:175], v[36:39]
    v_mfma_f32_16x16x32_bf16 v[44:47], v[188:191], v[180:183], v[44:47]
    v_mfma_f32_16x16x32_bf16 v[44:47], v[184:187], v[176:179], v[44:47]
    s_waitcnt lgkmcnt(6)
    v_mfma_f32_16x16x32_bf16 v[104:107], v[176:179], v[192:195], v[104:107]
    v_mfma_f32_16x16x32_bf16 v[104:107], v[180:183], v[196:199], v[104:107]
    v_mfma_f32_16x16x32_bf16 v[96:99], v[172:175], v[196:199], v[96:99]
    v_mfma_f32_16x16x32_bf16 v[96:99], v[168:171], v[192:195], v[96:99]
    s_waitcnt lgkmcnt(0)
    s_barrier
    v_mfma_f32_16x16x32_bf16 v[88:91], v[160:163], v[192:195], v[88:91]
    ds_read_b64_tr_b16 v[184:185], v6 offset:50176
    v_mfma_f32_16x16x32_bf16 v[88:91], v[164:167], v[196:199], v[88:91]
    ds_read_b64_tr_b16 v[186:187], v6 offset:50688
    v_mfma_f32_16x16x32_bf16 v[80:83], v[156:159], v[196:199], v[80:83]
    ds_read_b64_tr_b16 v[188:189], v6 offset:62464
    v_mfma_f32_16x16x32_bf16 v[80:83], v[152:155], v[192:195], v[80:83]
    ds_read_b64_tr_b16 v[190:191], v6 offset:62976
    v_mfma_f32_16x16x32_bf16 v[84:87], v[152:155], v[200:203], v[84:87]
    ds_read_b64_tr_b16 v[192:193], v7 offset:50176
    v_mfma_f32_16x16x32_bf16 v[84:87], v[156:159], v[204:207], v[84:87]
    ds_read_b64_tr_b16 v[194:195], v7 offset:50688
    v_mfma_f32_16x16x32_bf16 v[92:95], v[164:167], v[204:207], v[92:95]
    ds_read_b64_tr_b16 v[196:197], v7 offset:62464
    v_mfma_f32_16x16x32_bf16 v[92:95], v[160:163], v[200:203], v[92:95]
    ds_read_b64_tr_b16 v[198:199], v7 offset:62976
    v_mfma_f32_16x16x32_bf16 v[100:103], v[168:171], v[200:203], v[100:103]
    v_mfma_f32_16x16x32_bf16 v[100:103], v[172:175], v[204:207], v[100:103]
    v_mfma_f32_16x16x32_bf16 v[108:111], v[180:183], v[204:207], v[108:111]
    v_mfma_f32_16x16x32_bf16 v[108:111], v[176:179], v[200:203], v[108:111]
    s_waitcnt lgkmcnt(4)
    v_mfma_f32_16x16x32_bf16 v[72:75], v[184:187], v[144:147], v[72:75]
    ds_read_b64_tr_b16 v[200:201], v6 offset:49152
    v_mfma_f32_16x16x32_bf16 v[72:75], v[188:191], v[148:151], v[72:75]
    ds_read_b64_tr_b16 v[202:203], v6 offset:49664
    v_mfma_f32_16x16x32_bf16 v[64:67], v[188:191], v[140:143], v[64:67]
    ds_read_b64_tr_b16 v[204:205], v6 offset:61440
    v_mfma_f32_16x16x32_bf16 v[64:67], v[184:187], v[136:139], v[64:67]
    ds_read_b64_tr_b16 v[206:207], v6 offset:61952
    v_mfma_f32_16x16x32_bf16 v[56:59], v[184:187], v[128:131], v[56:59]
    ds_read_b128 v[176:179], v4 offset:6144
    v_mfma_f32_16x16x32_bf16 v[56:59], v[188:191], v[132:135], v[56:59]
    ds_read_b128 v[180:183], v5 offset:6144
    v_mfma_f32_16x16x32_bf16 v[48:51], v[188:191], v[124:127], v[48:51]
    ds_read_b128 v[168:171], v4 offset:4096
    v_mfma_f32_16x16x32_bf16 v[48:51], v[184:187], v[120:123], v[48:51]
    s_waitcnt lgkmcnt(7)
    v_mfma_f32_16x16x32_bf16 v[52:55], v[192:195], v[120:123], v[52:55]
    ds_read_b64_tr_b16 v[184:185], v7 offset:49152
    v_mfma_f32_16x16x32_bf16 v[52:55], v[196:199], v[124:127], v[52:55]
    ds_read_b64_tr_b16 v[186:187], v7 offset:49664
    v_mfma_f32_16x16x32_bf16 v[60:63], v[196:199], v[132:135], v[60:63]
    ds_read_b64_tr_b16 v[188:189], v7 offset:61440
    v_mfma_f32_16x16x32_bf16 v[60:63], v[192:195], v[128:131], v[60:63]
    ds_read_b64_tr_b16 v[190:191], v7 offset:61952
    v_mfma_f32_16x16x32_bf16 v[68:71], v[192:195], v[136:139], v[68:71]
    ds_read_b128 v[172:175], v5 offset:4096
    v_mfma_f32_16x16x32_bf16 v[68:71], v[196:199], v[140:143], v[68:71]
    ds_read_b128 v[160:163], v4 offset:2048
    v_mfma_f32_16x16x32_bf16 v[76:79], v[196:199], v[148:151], v[76:79]
    ds_read_b128 v[164:167], v5 offset:2048
    v_mfma_f32_16x16x32_bf16 v[76:79], v[192:195], v[144:147], v[76:79]
    s_waitcnt lgkmcnt(10)
    v_mfma_f32_16x16x32_bf16 v[40:43], v[200:203], v[144:147], v[40:43]
    ds_read_b64_tr_b16 v[192:193], v6 offset:51200
    v_mfma_f32_16x16x32_bf16 v[40:43], v[204:207], v[148:151], v[40:43]
    ds_read_b64_tr_b16 v[194:195], v6 offset:51712
    v_mfma_f32_16x16x32_bf16 v[32:35], v[204:207], v[140:143], v[32:35]
    ds_read_b64_tr_b16 v[196:197], v6 offset:63488
    v_mfma_f32_16x16x32_bf16 v[32:35], v[200:203], v[136:139], v[32:35]
    ds_read_b64_tr_b16 v[198:199], v6 offset:64000
    v_mfma_f32_16x16x32_bf16 v[24:27], v[200:203], v[128:131], v[24:27]
    ds_read_b128 v[152:155], v4 offset:0
    v_mfma_f32_16x16x32_bf16 v[24:27], v[204:207], v[132:135], v[24:27]
    ds_read_b128 v[156:159], v5 offset:0
    v_mfma_f32_16x16x32_bf16 v[16:19], v[204:207], v[124:127], v[16:19]
    v_mfma_f32_16x16x32_bf16 v[16:19], v[200:203], v[120:123], v[16:19]
    s_waitcnt lgkmcnt(9)
    v_mfma_f32_16x16x32_bf16 v[20:23], v[184:187], v[120:123], v[20:23]
    ds_read_b64_tr_b16 v[200:201], v7 offset:51200
    v_mfma_f32_16x16x32_bf16 v[20:23], v[188:191], v[124:127], v[20:23]
    ds_read_b64_tr_b16 v[202:203], v7 offset:51712
    v_mfma_f32_16x16x32_bf16 v[28:31], v[188:191], v[132:135], v[28:31]
    ds_read_b64_tr_b16 v[204:205], v7 offset:63488
    v_mfma_f32_16x16x32_bf16 v[28:31], v[184:187], v[128:131], v[28:31]
    ds_read_b64_tr_b16 v[206:207], v7 offset:64000
    v_mfma_f32_16x16x32_bf16 v[36:39], v[184:187], v[136:139], v[36:39]
    v_mfma_f32_16x16x32_bf16 v[36:39], v[188:191], v[140:143], v[36:39]
    v_mfma_f32_16x16x32_bf16 v[44:47], v[188:191], v[148:151], v[44:47]
    v_mfma_f32_16x16x32_bf16 v[44:47], v[184:187], v[144:147], v[44:47]
    s_waitcnt lgkmcnt(6)
    v_mfma_f32_16x16x32_bf16 v[104:107], v[144:147], v[192:195], v[104:107]
    v_mfma_f32_16x16x32_bf16 v[104:107], v[148:151], v[196:199], v[104:107]
    v_mfma_f32_16x16x32_bf16 v[96:99], v[140:143], v[196:199], v[96:99]
    v_mfma_f32_16x16x32_bf16 v[96:99], v[136:139], v[192:195], v[96:99]
    s_waitcnt lgkmcnt(0)
    s_barrier
    v_mfma_f32_16x16x32_bf16 v[88:91], v[128:131], v[192:195], v[88:91]
    ds_read_b64_tr_b16 v[184:185], v6 offset:1024
    v_mfma_f32_16x16x32_bf16 v[88:91], v[132:135], v[196:199], v[88:91]
    ds_read_b64_tr_b16 v[186:187], v6 offset:1536
    v_mfma_f32_16x16x32_bf16 v[80:83], v[124:127], v[196:199], v[80:83]
    ds_read_b64_tr_b16 v[188:189], v6 offset:13312
    v_mfma_f32_16x16x32_bf16 v[80:83], v[120:123], v[192:195], v[80:83]
    ds_read_b64_tr_b16 v[190:191], v6 offset:13824
    v_mfma_f32_16x16x32_bf16 v[84:87], v[120:123], v[200:203], v[84:87]
    ds_read_b64_tr_b16 v[192:193], v7 offset:1024
    v_mfma_f32_16x16x32_bf16 v[84:87], v[124:127], v[204:207], v[84:87]
    ds_read_b64_tr_b16 v[194:195], v7 offset:1536
    v_mfma_f32_16x16x32_bf16 v[92:95], v[132:135], v[204:207], v[92:95]
    ds_read_b64_tr_b16 v[196:197], v7 offset:13312
    v_mfma_f32_16x16x32_bf16 v[92:95], v[128:131], v[200:203], v[92:95]
    ds_read_b64_tr_b16 v[198:199], v7 offset:13824
    v_mfma_f32_16x16x32_bf16 v[100:103], v[136:139], v[200:203], v[100:103]
    v_mfma_f32_16x16x32_bf16 v[100:103], v[140:143], v[204:207], v[100:103]
    v_mfma_f32_16x16x32_bf16 v[108:111], v[148:151], v[204:207], v[108:111]
    v_mfma_f32_16x16x32_bf16 v[108:111], v[144:147], v[200:203], v[108:111]
    s_waitcnt lgkmcnt(4)
    v_mfma_f32_16x16x32_bf16 v[72:75], v[184:187], v[176:179], v[72:75]
    ds_read_b64_tr_b16 v[200:201], v6 offset:0
    v_mfma_f32_16x16x32_bf16 v[72:75], v[188:191], v[180:183], v[72:75]
    ds_read_b64_tr_b16 v[202:203], v6 offset:512
    v_mfma_f32_16x16x32_bf16 v[64:67], v[188:191], v[172:175], v[64:67]
    ds_read_b64_tr_b16 v[204:205], v6 offset:12288
    v_mfma_f32_16x16x32_bf16 v[64:67], v[184:187], v[168:171], v[64:67]
    ds_read_b64_tr_b16 v[206:207], v6 offset:12800
    v_mfma_f32_16x16x32_bf16 v[56:59], v[184:187], v[160:163], v[56:59]
    ds_read_b128 v[144:147], v4 offset:24576
    v_mfma_f32_16x16x32_bf16 v[56:59], v[188:191], v[164:167], v[56:59]
    ds_read_b128 v[148:151], v5 offset:24576
    v_mfma_f32_16x16x32_bf16 v[48:51], v[188:191], v[156:159], v[48:51]
    ds_read_b128 v[136:139], v4 offset:22528
    v_mfma_f32_16x16x32_bf16 v[48:51], v[184:187], v[152:155], v[48:51]
    s_waitcnt lgkmcnt(7)
    v_mfma_f32_16x16x32_bf16 v[52:55], v[192:195], v[152:155], v[52:55]
    ds_read_b64_tr_b16 v[184:185], v7 offset:0
    v_mfma_f32_16x16x32_bf16 v[52:55], v[196:199], v[156:159], v[52:55]
    ds_read_b64_tr_b16 v[186:187], v7 offset:512
    v_mfma_f32_16x16x32_bf16 v[60:63], v[196:199], v[164:167], v[60:63]
    ds_read_b64_tr_b16 v[188:189], v7 offset:12288
    v_mfma_f32_16x16x32_bf16 v[60:63], v[192:195], v[160:163], v[60:63]
    ds_read_b64_tr_b16 v[190:191], v7 offset:12800
    v_mfma_f32_16x16x32_bf16 v[68:71], v[192:195], v[168:171], v[68:71]
    ds_read_b128 v[140:143], v5 offset:22528
    v_mfma_f32_16x16x32_bf16 v[68:71], v[196:199], v[172:175], v[68:71]
    ds_read_b128 v[128:131], v4 offset:20480
    v_mfma_f32_16x16x32_bf16 v[76:79], v[196:199], v[180:183], v[76:79]
    ds_read_b128 v[132:135], v5 offset:20480
    v_mfma_f32_16x16x32_bf16 v[76:79], v[192:195], v[176:179], v[76:79]
    s_waitcnt lgkmcnt(10)
    v_mfma_f32_16x16x32_bf16 v[40:43], v[200:203], v[176:179], v[40:43]
    ds_read_b64_tr_b16 v[192:193], v6 offset:2048
    v_mfma_f32_16x16x32_bf16 v[40:43], v[204:207], v[180:183], v[40:43]
    ds_read_b64_tr_b16 v[194:195], v6 offset:2560
    v_mfma_f32_16x16x32_bf16 v[32:35], v[204:207], v[172:175], v[32:35]
    ds_read_b64_tr_b16 v[196:197], v6 offset:14336
    v_mfma_f32_16x16x32_bf16 v[32:35], v[200:203], v[168:171], v[32:35]
    ds_read_b64_tr_b16 v[198:199], v6 offset:14848
    v_mfma_f32_16x16x32_bf16 v[24:27], v[200:203], v[160:163], v[24:27]
    ds_read_b128 v[120:123], v4 offset:18432
    v_mfma_f32_16x16x32_bf16 v[24:27], v[204:207], v[164:167], v[24:27]
    ds_read_b128 v[124:127], v5 offset:18432
    v_mfma_f32_16x16x32_bf16 v[16:19], v[204:207], v[156:159], v[16:19]
    v_mfma_f32_16x16x32_bf16 v[16:19], v[200:203], v[152:155], v[16:19]
    s_waitcnt lgkmcnt(9)
    v_mfma_f32_16x16x32_bf16 v[20:23], v[184:187], v[152:155], v[20:23]
    ds_read_b64_tr_b16 v[200:201], v7 offset:2048
    v_mfma_f32_16x16x32_bf16 v[20:23], v[188:191], v[156:159], v[20:23]
    ds_read_b64_tr_b16 v[202:203], v7 offset:2560
    v_mfma_f32_16x16x32_bf16 v[28:31], v[188:191], v[164:167], v[28:31]
    ds_read_b64_tr_b16 v[204:205], v7 offset:14336
    v_mfma_f32_16x16x32_bf16 v[28:31], v[184:187], v[160:163], v[28:31]
    ds_read_b64_tr_b16 v[206:207], v7 offset:14848
    v_mfma_f32_16x16x32_bf16 v[36:39], v[184:187], v[168:171], v[36:39]
    v_mfma_f32_16x16x32_bf16 v[36:39], v[188:191], v[172:175], v[36:39]
    v_mfma_f32_16x16x32_bf16 v[44:47], v[188:191], v[180:183], v[44:47]
    v_mfma_f32_16x16x32_bf16 v[44:47], v[184:187], v[176:179], v[44:47]
    s_waitcnt lgkmcnt(6)
    v_mfma_f32_16x16x32_bf16 v[104:107], v[176:179], v[192:195], v[104:107]
    v_mfma_f32_16x16x32_bf16 v[104:107], v[180:183], v[196:199], v[104:107]
    v_mfma_f32_16x16x32_bf16 v[96:99], v[172:175], v[196:199], v[96:99]
    v_mfma_f32_16x16x32_bf16 v[96:99], v[168:171], v[192:195], v[96:99]
    s_waitcnt lgkmcnt(0)
    s_barrier
    v_mfma_f32_16x16x32_bf16 v[88:91], v[160:163], v[192:195], v[88:91]
    ds_read_b64_tr_b16 v[184:185], v6 offset:25600
    v_mfma_f32_16x16x32_bf16 v[88:91], v[164:167], v[196:199], v[88:91]
    ds_read_b64_tr_b16 v[186:187], v6 offset:26112
    v_mfma_f32_16x16x32_bf16 v[80:83], v[156:159], v[196:199], v[80:83]
    ds_read_b64_tr_b16 v[188:189], v6 offset:37888
    v_mfma_f32_16x16x32_bf16 v[80:83], v[152:155], v[192:195], v[80:83]
    ds_read_b64_tr_b16 v[190:191], v6 offset:38400
    v_mfma_f32_16x16x32_bf16 v[84:87], v[152:155], v[200:203], v[84:87]
    ds_read_b64_tr_b16 v[192:193], v7 offset:25600
    v_mfma_f32_16x16x32_bf16 v[84:87], v[156:159], v[204:207], v[84:87]
    ds_read_b64_tr_b16 v[194:195], v7 offset:26112
    v_mfma_f32_16x16x32_bf16 v[92:95], v[164:167], v[204:207], v[92:95]
    ds_read_b64_tr_b16 v[196:197], v7 offset:37888
    v_mfma_f32_16x16x32_bf16 v[92:95], v[160:163], v[200:203], v[92:95]
    ds_read_b64_tr_b16 v[198:199], v7 offset:38400
    v_mfma_f32_16x16x32_bf16 v[100:103], v[168:171], v[200:203], v[100:103]
    v_mfma_f32_16x16x32_bf16 v[100:103], v[172:175], v[204:207], v[100:103]
    v_mfma_f32_16x16x32_bf16 v[108:111], v[180:183], v[204:207], v[108:111]
    v_mfma_f32_16x16x32_bf16 v[108:111], v[176:179], v[200:203], v[108:111]
    s_waitcnt lgkmcnt(4)
    v_mfma_f32_16x16x32_bf16 v[72:75], v[184:187], v[144:147], v[72:75]
    ds_read_b64_tr_b16 v[200:201], v6 offset:24576
    v_mfma_f32_16x16x32_bf16 v[72:75], v[188:191], v[148:151], v[72:75]
    ds_read_b64_tr_b16 v[202:203], v6 offset:25088
    v_mfma_f32_16x16x32_bf16 v[64:67], v[188:191], v[140:143], v[64:67]
    ds_read_b64_tr_b16 v[204:205], v6 offset:36864
    v_mfma_f32_16x16x32_bf16 v[64:67], v[184:187], v[136:139], v[64:67]
    ds_read_b64_tr_b16 v[206:207], v6 offset:37376
    v_mfma_f32_16x16x32_bf16 v[56:59], v[184:187], v[128:131], v[56:59]
    ds_read_b128 v[176:179], v4 offset:43008
    v_mfma_f32_16x16x32_bf16 v[56:59], v[188:191], v[132:135], v[56:59]
    ds_read_b128 v[180:183], v5 offset:43008
    v_mfma_f32_16x16x32_bf16 v[48:51], v[188:191], v[124:127], v[48:51]
    ds_read_b128 v[168:171], v4 offset:40960
    v_mfma_f32_16x16x32_bf16 v[48:51], v[184:187], v[120:123], v[48:51]
    s_waitcnt lgkmcnt(7)
    v_mfma_f32_16x16x32_bf16 v[52:55], v[192:195], v[120:123], v[52:55]
    ds_read_b64_tr_b16 v[184:185], v7 offset:24576
    v_mfma_f32_16x16x32_bf16 v[52:55], v[196:199], v[124:127], v[52:55]
    ds_read_b64_tr_b16 v[186:187], v7 offset:25088
    v_mfma_f32_16x16x32_bf16 v[60:63], v[196:199], v[132:135], v[60:63]
    ds_read_b64_tr_b16 v[188:189], v7 offset:36864
    v_mfma_f32_16x16x32_bf16 v[60:63], v[192:195], v[128:131], v[60:63]
    ds_read_b64_tr_b16 v[190:191], v7 offset:37376
    v_mfma_f32_16x16x32_bf16 v[68:71], v[192:195], v[136:139], v[68:71]
    ds_read_b128 v[172:175], v5 offset:40960
    v_mfma_f32_16x16x32_bf16 v[68:71], v[196:199], v[140:143], v[68:71]
    ds_read_b128 v[160:163], v4 offset:38912
    v_mfma_f32_16x16x32_bf16 v[76:79], v[196:199], v[148:151], v[76:79]
    ds_read_b128 v[164:167], v5 offset:38912
    v_mfma_f32_16x16x32_bf16 v[76:79], v[192:195], v[144:147], v[76:79]
    s_waitcnt lgkmcnt(10)
    v_mfma_f32_16x16x32_bf16 v[40:43], v[200:203], v[144:147], v[40:43]
    ds_read_b64_tr_b16 v[192:193], v6 offset:26624
    v_mfma_f32_16x16x32_bf16 v[40:43], v[204:207], v[148:151], v[40:43]
    ds_read_b64_tr_b16 v[194:195], v6 offset:27136
    v_mfma_f32_16x16x32_bf16 v[32:35], v[204:207], v[140:143], v[32:35]
    ds_read_b64_tr_b16 v[196:197], v6 offset:38912
    v_mfma_f32_16x16x32_bf16 v[32:35], v[200:203], v[136:139], v[32:35]
    ds_read_b64_tr_b16 v[198:199], v6 offset:39424
    v_mfma_f32_16x16x32_bf16 v[24:27], v[200:203], v[128:131], v[24:27]
    ds_read_b128 v[152:155], v4 offset:36864
    v_mfma_f32_16x16x32_bf16 v[24:27], v[204:207], v[132:135], v[24:27]
    ds_read_b128 v[156:159], v5 offset:36864
    v_mfma_f32_16x16x32_bf16 v[16:19], v[204:207], v[124:127], v[16:19]
    v_mfma_f32_16x16x32_bf16 v[16:19], v[200:203], v[120:123], v[16:19]
    s_waitcnt lgkmcnt(9)
    v_mfma_f32_16x16x32_bf16 v[20:23], v[184:187], v[120:123], v[20:23]
    ds_read_b64_tr_b16 v[200:201], v7 offset:26624
    v_mfma_f32_16x16x32_bf16 v[20:23], v[188:191], v[124:127], v[20:23]
    ds_read_b64_tr_b16 v[202:203], v7 offset:27136
    v_mfma_f32_16x16x32_bf16 v[28:31], v[188:191], v[132:135], v[28:31]
    ds_read_b64_tr_b16 v[204:205], v7 offset:38912
    v_mfma_f32_16x16x32_bf16 v[28:31], v[184:187], v[128:131], v[28:31]
    ds_read_b64_tr_b16 v[206:207], v7 offset:39424
    v_mfma_f32_16x16x32_bf16 v[36:39], v[184:187], v[136:139], v[36:39]
    v_mfma_f32_16x16x32_bf16 v[36:39], v[188:191], v[140:143], v[36:39]
    v_mfma_f32_16x16x32_bf16 v[44:47], v[188:191], v[148:151], v[44:47]
    v_mfma_f32_16x16x32_bf16 v[44:47], v[184:187], v[144:147], v[44:47]
    s_waitcnt lgkmcnt(6)
    v_mfma_f32_16x16x32_bf16 v[104:107], v[144:147], v[192:195], v[104:107]
    v_mfma_f32_16x16x32_bf16 v[104:107], v[148:151], v[196:199], v[104:107]
    v_mfma_f32_16x16x32_bf16 v[96:99], v[140:143], v[196:199], v[96:99]
    v_mfma_f32_16x16x32_bf16 v[96:99], v[136:139], v[192:195], v[96:99]
    s_waitcnt lgkmcnt(0)
    s_barrier
    v_mfma_f32_16x16x32_bf16 v[88:91], v[128:131], v[192:195], v[88:91]
    ds_read_b64_tr_b16 v[184:185], v6 offset:50176
    v_mfma_f32_16x16x32_bf16 v[88:91], v[132:135], v[196:199], v[88:91]
    ds_read_b64_tr_b16 v[186:187], v6 offset:50688
    v_mfma_f32_16x16x32_bf16 v[80:83], v[124:127], v[196:199], v[80:83]
    ds_read_b64_tr_b16 v[188:189], v6 offset:62464
    v_mfma_f32_16x16x32_bf16 v[80:83], v[120:123], v[192:195], v[80:83]
    ds_read_b64_tr_b16 v[190:191], v6 offset:62976
    v_mfma_f32_16x16x32_bf16 v[84:87], v[120:123], v[200:203], v[84:87]
    ds_read_b64_tr_b16 v[192:193], v7 offset:50176
    v_mfma_f32_16x16x32_bf16 v[84:87], v[124:127], v[204:207], v[84:87]
    ds_read_b64_tr_b16 v[194:195], v7 offset:50688
    v_mfma_f32_16x16x32_bf16 v[92:95], v[132:135], v[204:207], v[92:95]
    ds_read_b64_tr_b16 v[196:197], v7 offset:62464
    v_mfma_f32_16x16x32_bf16 v[92:95], v[128:131], v[200:203], v[92:95]
    ds_read_b64_tr_b16 v[198:199], v7 offset:62976
    v_mfma_f32_16x16x32_bf16 v[100:103], v[136:139], v[200:203], v[100:103]
    v_mfma_f32_16x16x32_bf16 v[100:103], v[140:143], v[204:207], v[100:103]
    v_mfma_f32_16x16x32_bf16 v[108:111], v[148:151], v[204:207], v[108:111]
    v_mfma_f32_16x16x32_bf16 v[108:111], v[144:147], v[200:203], v[108:111]
    s_waitcnt lgkmcnt(4)
    v_mfma_f32_16x16x32_bf16 v[72:75], v[184:187], v[176:179], v[72:75]
    ds_read_b64_tr_b16 v[200:201], v6 offset:49152
    v_mfma_f32_16x16x32_bf16 v[72:75], v[188:191], v[180:183], v[72:75]
    ds_read_b64_tr_b16 v[202:203], v6 offset:49664
    v_mfma_f32_16x16x32_bf16 v[64:67], v[188:191], v[172:175], v[64:67]
    ds_read_b64_tr_b16 v[204:205], v6 offset:61440
    v_mfma_f32_16x16x32_bf16 v[64:67], v[184:187], v[168:171], v[64:67]
    ds_read_b64_tr_b16 v[206:207], v6 offset:61952
    v_mfma_f32_16x16x32_bf16 v[56:59], v[184:187], v[160:163], v[56:59]
    ds_read_b128 v[144:147], v4 offset:6144
    v_mfma_f32_16x16x32_bf16 v[56:59], v[188:191], v[164:167], v[56:59]
    ds_read_b128 v[148:151], v5 offset:6144
    v_mfma_f32_16x16x32_bf16 v[48:51], v[188:191], v[156:159], v[48:51]
    ds_read_b128 v[136:139], v4 offset:4096
    v_mfma_f32_16x16x32_bf16 v[48:51], v[184:187], v[152:155], v[48:51]
    s_waitcnt lgkmcnt(7)
    v_mfma_f32_16x16x32_bf16 v[52:55], v[192:195], v[152:155], v[52:55]
    ds_read_b64_tr_b16 v[184:185], v7 offset:49152
    v_mfma_f32_16x16x32_bf16 v[52:55], v[196:199], v[156:159], v[52:55]
    ds_read_b64_tr_b16 v[186:187], v7 offset:49664
    v_mfma_f32_16x16x32_bf16 v[60:63], v[196:199], v[164:167], v[60:63]
    ds_read_b64_tr_b16 v[188:189], v7 offset:61440
    v_mfma_f32_16x16x32_bf16 v[60:63], v[192:195], v[160:163], v[60:63]
    ds_read_b64_tr_b16 v[190:191], v7 offset:61952
    v_mfma_f32_16x16x32_bf16 v[68:71], v[192:195], v[168:171], v[68:71]
    ds_read_b128 v[140:143], v5 offset:4096
    v_mfma_f32_16x16x32_bf16 v[68:71], v[196:199], v[172:175], v[68:71]
    ds_read_b128 v[128:131], v4 offset:2048
    v_mfma_f32_16x16x32_bf16 v[76:79], v[196:199], v[180:183], v[76:79]
    ds_read_b128 v[132:135], v5 offset:2048
    v_mfma_f32_16x16x32_bf16 v[76:79], v[192:195], v[176:179], v[76:79]
    s_waitcnt lgkmcnt(10)
    v_mfma_f32_16x16x32_bf16 v[40:43], v[200:203], v[176:179], v[40:43]
    ds_read_b64_tr_b16 v[192:193], v6 offset:51200
    v_mfma_f32_16x16x32_bf16 v[40:43], v[204:207], v[180:183], v[40:43]
    ds_read_b64_tr_b16 v[194:195], v6 offset:51712
    v_mfma_f32_16x16x32_bf16 v[32:35], v[204:207], v[172:175], v[32:35]
    ds_read_b64_tr_b16 v[196:197], v6 offset:63488
    v_mfma_f32_16x16x32_bf16 v[32:35], v[200:203], v[168:171], v[32:35]
    ds_read_b64_tr_b16 v[198:199], v6 offset:64000
    v_mfma_f32_16x16x32_bf16 v[24:27], v[200:203], v[160:163], v[24:27]
    ds_read_b128 v[120:123], v4 offset:0
    v_mfma_f32_16x16x32_bf16 v[24:27], v[204:207], v[164:167], v[24:27]
    ds_read_b128 v[124:127], v5 offset:0
    v_mfma_f32_16x16x32_bf16 v[16:19], v[204:207], v[156:159], v[16:19]
    v_mfma_f32_16x16x32_bf16 v[16:19], v[200:203], v[152:155], v[16:19]
    s_waitcnt lgkmcnt(9)
    v_mfma_f32_16x16x32_bf16 v[20:23], v[184:187], v[152:155], v[20:23]
    ds_read_b64_tr_b16 v[200:201], v7 offset:51200
    v_mfma_f32_16x16x32_bf16 v[20:23], v[188:191], v[156:159], v[20:23]
    ds_read_b64_tr_b16 v[202:203], v7 offset:51712
    v_mfma_f32_16x16x32_bf16 v[28:31], v[188:191], v[164:167], v[28:31]
    ds_read_b64_tr_b16 v[204:205], v7 offset:63488
    v_mfma_f32_16x16x32_bf16 v[28:31], v[184:187], v[160:163], v[28:31]
    ds_read_b64_tr_b16 v[206:207], v7 offset:64000
    v_mfma_f32_16x16x32_bf16 v[36:39], v[184:187], v[168:171], v[36:39]
    v_mfma_f32_16x16x32_bf16 v[36:39], v[188:191], v[172:175], v[36:39]
    v_mfma_f32_16x16x32_bf16 v[44:47], v[188:191], v[180:183], v[44:47]
    v_mfma_f32_16x16x32_bf16 v[44:47], v[184:187], v[176:179], v[44:47]
    s_waitcnt lgkmcnt(6)
    v_mfma_f32_16x16x32_bf16 v[104:107], v[176:179], v[192:195], v[104:107]
    v_mfma_f32_16x16x32_bf16 v[104:107], v[180:183], v[196:199], v[104:107]
    v_mfma_f32_16x16x32_bf16 v[96:99], v[172:175], v[196:199], v[96:99]
    v_mfma_f32_16x16x32_bf16 v[96:99], v[168:171], v[192:195], v[96:99]
    s_waitcnt lgkmcnt(0)
    s_barrier
    v_mfma_f32_16x16x32_bf16 v[88:91], v[160:163], v[192:195], v[88:91]
    ds_read_b64_tr_b16 v[184:185], v6 offset:1024
    v_mfma_f32_16x16x32_bf16 v[88:91], v[164:167], v[196:199], v[88:91]
    ds_read_b64_tr_b16 v[186:187], v6 offset:1536
    v_mfma_f32_16x16x32_bf16 v[80:83], v[156:159], v[196:199], v[80:83]
    ds_read_b64_tr_b16 v[188:189], v6 offset:13312
    v_mfma_f32_16x16x32_bf16 v[80:83], v[152:155], v[192:195], v[80:83]
    ds_read_b64_tr_b16 v[190:191], v6 offset:13824
    v_mfma_f32_16x16x32_bf16 v[84:87], v[152:155], v[200:203], v[84:87]
    ds_read_b64_tr_b16 v[192:193], v7 offset:1024
    v_mfma_f32_16x16x32_bf16 v[84:87], v[156:159], v[204:207], v[84:87]
    ds_read_b64_tr_b16 v[194:195], v7 offset:1536
    v_mfma_f32_16x16x32_bf16 v[92:95], v[164:167], v[204:207], v[92:95]
    ds_read_b64_tr_b16 v[196:197], v7 offset:13312
    v_mfma_f32_16x16x32_bf16 v[92:95], v[160:163], v[200:203], v[92:95]
    ds_read_b64_tr_b16 v[198:199], v7 offset:13824
    v_mfma_f32_16x16x32_bf16 v[100:103], v[168:171], v[200:203], v[100:103]
    v_mfma_f32_16x16x32_bf16 v[100:103], v[172:175], v[204:207], v[100:103]
    v_mfma_f32_16x16x32_bf16 v[108:111], v[180:183], v[204:207], v[108:111]
    v_mfma_f32_16x16x32_bf16 v[108:111], v[176:179], v[200:203], v[108:111]
    s_waitcnt lgkmcnt(4)
    v_mfma_f32_16x16x32_bf16 v[72:75], v[184:187], v[144:147], v[72:75]
    ds_read_b64_tr_b16 v[200:201], v6 offset:0
    v_mfma_f32_16x16x32_bf16 v[72:75], v[188:191], v[148:151], v[72:75]
    ds_read_b64_tr_b16 v[202:203], v6 offset:512
    v_mfma_f32_16x16x32_bf16 v[64:67], v[188:191], v[140:143], v[64:67]
    ds_read_b64_tr_b16 v[204:205], v6 offset:12288
    v_mfma_f32_16x16x32_bf16 v[64:67], v[184:187], v[136:139], v[64:67]
    ds_read_b64_tr_b16 v[206:207], v6 offset:12800
    v_mfma_f32_16x16x32_bf16 v[56:59], v[184:187], v[128:131], v[56:59]
    ds_read_b128 v[176:179], v4 offset:24576
    v_mfma_f32_16x16x32_bf16 v[56:59], v[188:191], v[132:135], v[56:59]
    ds_read_b128 v[180:183], v5 offset:24576
    v_mfma_f32_16x16x32_bf16 v[48:51], v[188:191], v[124:127], v[48:51]
    ds_read_b128 v[168:171], v4 offset:22528
    v_mfma_f32_16x16x32_bf16 v[48:51], v[184:187], v[120:123], v[48:51]
    s_waitcnt lgkmcnt(7)
    v_mfma_f32_16x16x32_bf16 v[52:55], v[192:195], v[120:123], v[52:55]
    ds_read_b64_tr_b16 v[184:185], v7 offset:0
    v_mfma_f32_16x16x32_bf16 v[52:55], v[196:199], v[124:127], v[52:55]
    ds_read_b64_tr_b16 v[186:187], v7 offset:512
    v_mfma_f32_16x16x32_bf16 v[60:63], v[196:199], v[132:135], v[60:63]
    ds_read_b64_tr_b16 v[188:189], v7 offset:12288
    v_mfma_f32_16x16x32_bf16 v[60:63], v[192:195], v[128:131], v[60:63]
    ds_read_b64_tr_b16 v[190:191], v7 offset:12800
    v_mfma_f32_16x16x32_bf16 v[68:71], v[192:195], v[136:139], v[68:71]
    ds_read_b128 v[172:175], v5 offset:22528
    v_mfma_f32_16x16x32_bf16 v[68:71], v[196:199], v[140:143], v[68:71]
    ds_read_b128 v[160:163], v4 offset:20480
    v_mfma_f32_16x16x32_bf16 v[76:79], v[196:199], v[148:151], v[76:79]
    ds_read_b128 v[164:167], v5 offset:20480
    v_mfma_f32_16x16x32_bf16 v[76:79], v[192:195], v[144:147], v[76:79]
    s_waitcnt lgkmcnt(10)
    v_mfma_f32_16x16x32_bf16 v[40:43], v[200:203], v[144:147], v[40:43]
    ds_read_b64_tr_b16 v[192:193], v6 offset:2048
    v_mfma_f32_16x16x32_bf16 v[40:43], v[204:207], v[148:151], v[40:43]
    ds_read_b64_tr_b16 v[194:195], v6 offset:2560
    v_mfma_f32_16x16x32_bf16 v[32:35], v[204:207], v[140:143], v[32:35]
    ds_read_b64_tr_b16 v[196:197], v6 offset:14336
    v_mfma_f32_16x16x32_bf16 v[32:35], v[200:203], v[136:139], v[32:35]
    ds_read_b64_tr_b16 v[198:199], v6 offset:14848
    v_mfma_f32_16x16x32_bf16 v[24:27], v[200:203], v[128:131], v[24:27]
    ds_read_b128 v[152:155], v4 offset:18432
    v_mfma_f32_16x16x32_bf16 v[24:27], v[204:207], v[132:135], v[24:27]
    ds_read_b128 v[156:159], v5 offset:18432
    v_mfma_f32_16x16x32_bf16 v[16:19], v[204:207], v[124:127], v[16:19]
    v_mfma_f32_16x16x32_bf16 v[16:19], v[200:203], v[120:123], v[16:19]
    s_waitcnt lgkmcnt(9)
    v_mfma_f32_16x16x32_bf16 v[20:23], v[184:187], v[120:123], v[20:23]
    ds_read_b64_tr_b16 v[200:201], v7 offset:2048
    v_mfma_f32_16x16x32_bf16 v[20:23], v[188:191], v[124:127], v[20:23]
    ds_read_b64_tr_b16 v[202:203], v7 offset:2560
    v_mfma_f32_16x16x32_bf16 v[28:31], v[188:191], v[132:135], v[28:31]
    ds_read_b64_tr_b16 v[204:205], v7 offset:14336
    v_mfma_f32_16x16x32_bf16 v[28:31], v[184:187], v[128:131], v[28:31]
    ds_read_b64_tr_b16 v[206:207], v7 offset:14848
    v_mfma_f32_16x16x32_bf16 v[36:39], v[184:187], v[136:139], v[36:39]
    buffer_load_dword v222, v220, s[68:71], s98 offen sc1
    v_mfma_f32_16x16x32_bf16 v[36:39], v[188:191], v[140:143], v[36:39]
    v_mfma_f32_16x16x32_bf16 v[44:47], v[188:191], v[148:151], v[44:47]
    v_mfma_f32_16x16x32_bf16 v[44:47], v[184:187], v[144:147], v[44:47]
    s_waitcnt lgkmcnt(6)
    v_mfma_f32_16x16x32_bf16 v[104:107], v[144:147], v[192:195], v[104:107]
    v_mfma_f32_16x16x32_bf16 v[104:107], v[148:151], v[196:199], v[104:107]
    v_mfma_f32_16x16x32_bf16 v[96:99], v[140:143], v[196:199], v[96:99]
    v_mfma_f32_16x16x32_bf16 v[96:99], v[136:139], v[192:195], v[96:99]
    s_waitcnt lgkmcnt(0)
    s_barrier
    v_mfma_f32_16x16x32_bf16 v[88:91], v[128:131], v[192:195], v[88:91]
    ds_read_b64_tr_b16 v[184:185], v6 offset:25600
    v_mfma_f32_16x16x32_bf16 v[88:91], v[132:135], v[196:199], v[88:91]
    ds_read_b64_tr_b16 v[186:187], v6 offset:26112
    v_mfma_f32_16x16x32_bf16 v[80:83], v[124:127], v[196:199], v[80:83]
    ds_read_b64_tr_b16 v[188:189], v6 offset:37888
    v_mfma_f32_16x16x32_bf16 v[80:83], v[120:123], v[192:195], v[80:83]
    ds_read_b64_tr_b16 v[190:191], v6 offset:38400
    v_mfma_f32_16x16x32_bf16 v[84:87], v[120:123], v[200:203], v[84:87]
    ds_read_b64_tr_b16 v[192:193], v7 offset:25600
    v_mfma_f32_16x16x32_bf16 v[84:87], v[124:127], v[204:207], v[84:87]
    ds_read_b64_tr_b16 v[194:195], v7 offset:26112
    v_mfma_f32_16x16x32_bf16 v[92:95], v[132:135], v[204:207], v[92:95]
    ds_read_b64_tr_b16 v[196:197], v7 offset:37888
    v_mfma_f32_16x16x32_bf16 v[92:95], v[128:131], v[200:203], v[92:95]
    ds_read_b64_tr_b16 v[198:199], v7 offset:38400
    v_mfma_f32_16x16x32_bf16 v[100:103], v[136:139], v[200:203], v[100:103]
    v_mfma_f32_16x16x32_bf16 v[100:103], v[140:143], v[204:207], v[100:103]
    v_mfma_f32_16x16x32_bf16 v[108:111], v[148:151], v[204:207], v[108:111]
    v_mfma_f32_16x16x32_bf16 v[108:111], v[144:147], v[200:203], v[108:111]
    s_waitcnt lgkmcnt(4)
    v_mfma_f32_16x16x32_bf16 v[72:75], v[184:187], v[176:179], v[72:75]
    ds_read_b64_tr_b16 v[200:201], v6 offset:24576
    v_mfma_f32_16x16x32_bf16 v[72:75], v[188:191], v[180:183], v[72:75]
    ds_read_b64_tr_b16 v[202:203], v6 offset:25088
    v_mfma_f32_16x16x32_bf16 v[64:67], v[188:191], v[172:175], v[64:67]
    ds_read_b64_tr_b16 v[204:205], v6 offset:36864
    v_mfma_f32_16x16x32_bf16 v[64:67], v[184:187], v[168:171], v[64:67]
    ds_read_b64_tr_b16 v[206:207], v6 offset:37376
    v_mfma_f32_16x16x32_bf16 v[56:59], v[184:187], v[160:163], v[56:59]
    ds_read_b128 v[144:147], v4 offset:43008
    v_mfma_f32_16x16x32_bf16 v[56:59], v[188:191], v[164:167], v[56:59]
    ds_read_b128 v[148:151], v5 offset:43008
    v_mfma_f32_16x16x32_bf16 v[48:51], v[188:191], v[156:159], v[48:51]
    ds_read_b128 v[136:139], v4 offset:40960
    v_mfma_f32_16x16x32_bf16 v[48:51], v[184:187], v[152:155], v[48:51]
    s_waitcnt lgkmcnt(7)
    v_mfma_f32_16x16x32_bf16 v[52:55], v[192:195], v[152:155], v[52:55]
    ds_read_b64_tr_b16 v[184:185], v7 offset:24576
    v_mfma_f32_16x16x32_bf16 v[52:55], v[196:199], v[156:159], v[52:55]
    ds_read_b64_tr_b16 v[186:187], v7 offset:25088
    v_mfma_f32_16x16x32_bf16 v[60:63], v[196:199], v[164:167], v[60:63]
    ds_read_b64_tr_b16 v[188:189], v7 offset:36864
    v_mfma_f32_16x16x32_bf16 v[60:63], v[192:195], v[160:163], v[60:63]
    ds_read_b64_tr_b16 v[190:191], v7 offset:37376
    v_mfma_f32_16x16x32_bf16 v[68:71], v[192:195], v[168:171], v[68:71]
    ds_read_b128 v[140:143], v5 offset:40960
    v_mfma_f32_16x16x32_bf16 v[68:71], v[196:199], v[172:175], v[68:71]
    ds_read_b128 v[128:131], v4 offset:38912
    v_mfma_f32_16x16x32_bf16 v[76:79], v[196:199], v[180:183], v[76:79]
    ds_read_b128 v[132:135], v5 offset:38912
    v_mfma_f32_16x16x32_bf16 v[76:79], v[192:195], v[176:179], v[76:79]
    s_waitcnt lgkmcnt(10)
    v_mfma_f32_16x16x32_bf16 v[40:43], v[200:203], v[176:179], v[40:43]
    ds_read_b64_tr_b16 v[192:193], v6 offset:26624
    v_mfma_f32_16x16x32_bf16 v[40:43], v[204:207], v[180:183], v[40:43]
    ds_read_b64_tr_b16 v[194:195], v6 offset:27136
    v_mfma_f32_16x16x32_bf16 v[32:35], v[204:207], v[172:175], v[32:35]
    ds_read_b64_tr_b16 v[196:197], v6 offset:38912
    v_mfma_f32_16x16x32_bf16 v[32:35], v[200:203], v[168:171], v[32:35]
    ds_read_b64_tr_b16 v[198:199], v6 offset:39424
    v_mfma_f32_16x16x32_bf16 v[24:27], v[200:203], v[160:163], v[24:27]
    ds_read_b128 v[120:123], v4 offset:36864
    v_mfma_f32_16x16x32_bf16 v[24:27], v[204:207], v[164:167], v[24:27]
    ds_read_b128 v[124:127], v5 offset:36864
    v_mfma_f32_16x16x32_bf16 v[16:19], v[204:207], v[156:159], v[16:19]
    v_mfma_f32_16x16x32_bf16 v[16:19], v[200:203], v[152:155], v[16:19]
    s_waitcnt lgkmcnt(9)
    v_mfma_f32_16x16x32_bf16 v[20:23], v[184:187], v[152:155], v[20:23]
    ds_read_b64_tr_b16 v[200:201], v7 offset:26624
    v_mfma_f32_16x16x32_bf16 v[20:23], v[188:191], v[156:159], v[20:23]
    ds_read_b64_tr_b16 v[202:203], v7 offset:27136
    v_mfma_f32_16x16x32_bf16 v[28:31], v[188:191], v[164:167], v[28:31]
    ds_read_b64_tr_b16 v[204:205], v7 offset:38912
    v_mfma_f32_16x16x32_bf16 v[28:31], v[184:187], v[160:163], v[28:31]
    ds_read_b64_tr_b16 v[206:207], v7 offset:39424
    v_mfma_f32_16x16x32_bf16 v[36:39], v[184:187], v[168:171], v[36:39]
    v_mfma_f32_16x16x32_bf16 v[36:39], v[188:191], v[172:175], v[36:39]
    v_mfma_f32_16x16x32_bf16 v[44:47], v[188:191], v[180:183], v[44:47]
    v_mfma_f32_16x16x32_bf16 v[44:47], v[184:187], v[176:179], v[44:47]
    s_waitcnt lgkmcnt(6)
    v_mfma_f32_16x16x32_bf16 v[104:107], v[176:179], v[192:195], v[104:107]
    v_mfma_f32_16x16x32_bf16 v[104:107], v[180:183], v[196:199], v[104:107]
    v_mfma_f32_16x16x32_bf16 v[96:99], v[172:175], v[196:199], v[96:99]
    v_mfma_f32_16x16x32_bf16 v[96:99], v[168:171], v[192:195], v[96:99]
    s_waitcnt lgkmcnt(0)
    s_barrier
    v_mfma_f32_16x16x32_bf16 v[88:91], v[160:163], v[192:195], v[88:91]
    ds_read_b64_tr_b16 v[184:185], v6 offset:50176
    v_mfma_f32_16x16x32_bf16 v[88:91], v[164:167], v[196:199], v[88:91]
    ds_read_b64_tr_b16 v[186:187], v6 offset:50688
    v_mfma_f32_16x16x32_bf16 v[80:83], v[156:159], v[196:199], v[80:83]
    ds_read_b64_tr_b16 v[188:189], v6 offset:62464
    v_mfma_f32_16x16x32_bf16 v[80:83], v[152:155], v[192:195], v[80:83]
    ds_read_b64_tr_b16 v[190:191], v6 offset:62976
    v_mfma_f32_16x16x32_bf16 v[84:87], v[152:155], v[200:203], v[84:87]
    ds_read_b64_tr_b16 v[192:193], v7 offset:50176
    v_mfma_f32_16x16x32_bf16 v[84:87], v[156:159], v[204:207], v[84:87]
    ds_read_b64_tr_b16 v[194:195], v7 offset:50688
    v_mfma_f32_16x16x32_bf16 v[92:95], v[164:167], v[204:207], v[92:95]
    ds_read_b64_tr_b16 v[196:197], v7 offset:62464
    v_mfma_f32_16x16x32_bf16 v[92:95], v[160:163], v[200:203], v[92:95]
    ds_read_b64_tr_b16 v[198:199], v7 offset:62976
    v_mfma_f32_16x16x32_bf16 v[100:103], v[168:171], v[200:203], v[100:103]
    v_mfma_f32_16x16x32_bf16 v[100:103], v[172:175], v[204:207], v[100:103]
    v_mfma_f32_16x16x32_bf16 v[108:111], v[180:183], v[204:207], v[108:111]
    v_mfma_f32_16x16x32_bf16 v[108:111], v[176:179], v[200:203], v[108:111]
    s_waitcnt lgkmcnt(4)
    v_mfma_f32_16x16x32_bf16 v[72:75], v[184:187], v[144:147], v[72:75]
    ds_read_b64_tr_b16 v[200:201], v6 offset:49152
    v_mfma_f32_16x16x32_bf16 v[72:75], v[188:191], v[148:151], v[72:75]
    ds_read_b64_tr_b16 v[202:203], v6 offset:49664
    v_mfma_f32_16x16x32_bf16 v[64:67], v[188:191], v[140:143], v[64:67]
    ds_read_b64_tr_b16 v[204:205], v6 offset:61440
    v_mfma_f32_16x16x32_bf16 v[64:67], v[184:187], v[136:139], v[64:67]
    ds_read_b64_tr_b16 v[206:207], v6 offset:61952
    v_mfma_f32_16x16x32_bf16 v[56:59], v[184:187], v[128:131], v[56:59]
    ds_read_b128 v[176:179], v4 offset:6144
    v_mfma_f32_16x16x32_bf16 v[56:59], v[188:191], v[132:135], v[56:59]
    ds_read_b128 v[180:183], v5 offset:6144
    v_mfma_f32_16x16x32_bf16 v[48:51], v[188:191], v[124:127], v[48:51]
    ds_read_b128 v[168:171], v4 offset:4096
    v_mfma_f32_16x16x32_bf16 v[48:51], v[184:187], v[120:123], v[48:51]
    s_waitcnt lgkmcnt(7)
    v_mfma_f32_16x16x32_bf16 v[52:55], v[192:195], v[120:123], v[52:55]
    ds_read_b64_tr_b16 v[184:185], v7 offset:49152
    v_mfma_f32_16x16x32_bf16 v[52:55], v[196:199], v[124:127], v[52:55]
    ds_read_b64_tr_b16 v[186:187], v7 offset:49664
    v_mfma_f32_16x16x32_bf16 v[60:63], v[196:199], v[132:135], v[60:63]
    ds_read_b64_tr_b16 v[188:189], v7 offset:61440
    v_mfma_f32_16x16x32_bf16 v[60:63], v[192:195], v[128:131], v[60:63]
    ds_read_b64_tr_b16 v[190:191], v7 offset:61952
    v_mfma_f32_16x16x32_bf16 v[68:71], v[192:195], v[136:139], v[68:71]
    ds_read_b128 v[172:175], v5 offset:4096
    v_mfma_f32_16x16x32_bf16 v[68:71], v[196:199], v[140:143], v[68:71]
    ds_read_b128 v[160:163], v4 offset:2048
    v_mfma_f32_16x16x32_bf16 v[76:79], v[196:199], v[148:151], v[76:79]
    ds_read_b128 v[164:167], v5 offset:2048
    v_mfma_f32_16x16x32_bf16 v[76:79], v[192:195], v[144:147], v[76:79]
    s_waitcnt lgkmcnt(10)
    v_mfma_f32_16x16x32_bf16 v[40:43], v[200:203], v[144:147], v[40:43]
    ds_read_b64_tr_b16 v[192:193], v6 offset:51200
    v_mfma_f32_16x16x32_bf16 v[40:43], v[204:207], v[148:151], v[40:43]
    ds_read_b64_tr_b16 v[194:195], v6 offset:51712
    v_mfma_f32_16x16x32_bf16 v[32:35], v[204:207], v[140:143], v[32:35]
    ds_read_b64_tr_b16 v[196:197], v6 offset:63488
    v_mfma_f32_16x16x32_bf16 v[32:35], v[200:203], v[136:139], v[32:35]
    ds_read_b64_tr_b16 v[198:199], v6 offset:64000
    v_mfma_f32_16x16x32_bf16 v[24:27], v[200:203], v[128:131], v[24:27]
    ds_read_b128 v[152:155], v4 offset:0
    v_mfma_f32_16x16x32_bf16 v[24:27], v[204:207], v[132:135], v[24:27]
    ds_read_b128 v[156:159], v5 offset:0
    v_mfma_f32_16x16x32_bf16 v[16:19], v[204:207], v[124:127], v[16:19]
    v_mfma_f32_16x16x32_bf16 v[16:19], v[200:203], v[120:123], v[16:19]
    s_waitcnt lgkmcnt(9)
    v_mfma_f32_16x16x32_bf16 v[20:23], v[184:187], v[120:123], v[20:23]
    ds_read_b64_tr_b16 v[200:201], v7 offset:51200
    v_mfma_f32_16x16x32_bf16 v[20:23], v[188:191], v[124:127], v[20:23]
    ds_read_b64_tr_b16 v[202:203], v7 offset:51712
    v_mfma_f32_16x16x32_bf16 v[28:31], v[188:191], v[132:135], v[28:31]
    ds_read_b64_tr_b16 v[204:205], v7 offset:63488
    v_mfma_f32_16x16x32_bf16 v[28:31], v[184:187], v[128:131], v[28:31]
    ds_read_b64_tr_b16 v[206:207], v7 offset:64000
    v_mfma_f32_16x16x32_bf16 v[36:39], v[184:187], v[136:139], v[36:39]
    v_mfma_f32_16x16x32_bf16 v[36:39], v[188:191], v[140:143], v[36:39]
    v_mfma_f32_16x16x32_bf16 v[44:47], v[188:191], v[148:151], v[44:47]
    v_mfma_f32_16x16x32_bf16 v[44:47], v[184:187], v[144:147], v[44:47]
    s_waitcnt lgkmcnt(6)
    v_mfma_f32_16x16x32_bf16 v[104:107], v[144:147], v[192:195], v[104:107]
    v_mfma_f32_16x16x32_bf16 v[104:107], v[148:151], v[196:199], v[104:107]
    v_mfma_f32_16x16x32_bf16 v[96:99], v[140:143], v[196:199], v[96:99]
    v_mfma_f32_16x16x32_bf16 v[96:99], v[136:139], v[192:195], v[96:99]
    s_waitcnt lgkmcnt(0)
    s_barrier
    s_cmp_lg_u32 s3, 0
    s_cbranch_scc1 LB_sk
    s_waitcnt vmcnt(0)
    v_cmp_eq_u32 vcc, 0, v222
    s_cbranch_vccnz LB_slow
LB_back:
    s_mov_b64 exec, 1
    buffer_store_dword v222, v220, s[52:55], s96 offen sc1
    s_mov_b64 exec, -1
LB_sk:
    v_mfma_f32_16x16x32_bf16 v[88:91], v[128:131], v[192:195], v[88:91]
    ds_read_b64_tr_b16 v[184:185], v6 offset:1024
    v_mfma_f32_16x16x32_bf16 v[88:91], v[132:135], v[196:199], v[88:91]
    ds_read_b64_tr_b16 v[186:187], v6 offset:1536
    v_mfma_f32_16x16x32_bf16 v[80:83], v[124:127], v[196:199], v[80:83]
    ds_read_b64_tr_b16 v[188:189], v6 offset:13312
    v_mfma_f32_16x16x32_bf16 v[80:83], v[120:123], v[192:195], v[80:83]
    ds_read_b64_tr_b16 v[190:191], v6 offset:13824
    v_mfma_f32_16x16x32_bf16 v[84:87], v[120:123], v[200:203], v[84:87]
    ds_read_b64_tr_b16 v[192:193], v7 offset:1024
    v_mfma_f32_16x16x32_bf16 v[84:87], v[124:127], v[204:207], v[84:87]
    ds_read_b64_tr_b16 v[194:195], v7 offset:1536
    v_mfma_f32_16x16x32_bf16 v[92:95], v[132:135], v[204:207], v[92:95]
    ds_read_b64_tr_b16 v[196:197], v7 offset:13312
    v_mfma_f32_16x16x32_bf16 v[92:95], v[128:131], v[200:203], v[92:95]
    ds_read_b64_tr_b16 v[198:199], v7 offset:13824
    v_mfma_f32_16x16x32_bf16 v[100:103], v[136:139], v[200:203], v[100:103]
    v_mfma_f32_16x16x32_bf16 v[100:103], v[140:143], v[204:207], v[100:103]
    v_mfma_f32_16x16x32_bf16 v[108:111], v[148:151], v[204:207], v[108:111]
    v_mfma_f32_16x16x32_bf16 v[108:111], v[144:147], v[200:203], v[108:111]
    s_waitcnt lgkmcnt(4)
    v_mfma_f32_16x16x32_bf16 v[72:75], v[184:187], v[176:179], v[72:75]
    ds_read_b64_tr_b16 v[200:201], v6 offset:0
    v_mfma_f32_16x16x32_bf16 v[72:75], v[188:191], v[180:183], v[72:75]
    ds_read_b64_tr_b16 v[202:203], v6 offset:512
    v_mfma_f32_16x16x32_bf16 v[64:67], v[188:191], v[172:175], v[64:67]
    ds_read_b64_tr_b16 v[204:205], v6 offset:12288
    v_mfma_f32_16x16x32_bf16 v[64:67], v[184:187], v[168:171], v[64:67]
    ds_read_b64_tr_b16 v[206:207], v6 offset:12800
    v_mfma_f32_16x16x32_bf16 v[56:59], v[184:187], v[160:163], v[56:59]
    ds_read_b128 v[144:147], v4 offset:24576
    v_mfma_f32_16x16x32_bf16 v[56:59], v[188:191], v[164:167], v[56:59]
    ds_read_b128 v[148:151], v5 offset:24576
    v_mfma_f32_16x16x32_bf16 v[48:51], v[188:191], v[156:159], v[48:51]
    ds_read_b128 v[136:139], v4 offset:22528
    v_mfma_f32_16x16x32_bf16 v[48:51], v[184:187], v[152:155], v[48:51]
    s_waitcnt lgkmcnt(7)
    v_mfma_f32_16x16x32_bf16 v[52:55], v[192:195], v[152:155], v[52:55]
    ds_read_b64_tr_b16 v[184:185], v7 offset:0
    v_mfma_f32_16x16x32_bf16 v[52:55], v[196:199], v[156:159], v[52:55]
    ds_read_b64_tr_b16 v[186:187], v7 offset:512
    v_mfma_f32_16x16x32_bf16 v[60:63], v[196:199], v[164:167], v[60:63]
    ds_read_b64_tr_b16 v[188:189], v7 offset:12288
    v_mfma_f32_16x16x32_bf16 v[60:63], v[192:195], v[160:163], v[60:63]
    ds_read_b64_tr_b16 v[190:191], v7 offset:12800
    v_mfma_f32_16x16x32_bf16 v[68:71], v[192:195], v[168:171], v[68:71]
    ds_read_b128 v[140:143], v5 offset:22528
    v_mfma_f32_16x16x32_bf16 v[68:71], v[196:199], v[172:175], v[68:71]
    ds_read_b128 v[128:131], v4 offset:20480
    v_mfma_f32_16x16x32_bf16 v[76:79], v[196:199], v[180:183], v[76:79]
    ds_read_b128 v[132:135], v5 offset:20480
    v_mfma_f32_16x16x32_bf16 v[76:79], v[192:195], v[176:179], v[76:79]
    s_waitcnt lgkmcnt(10)
    v_mfma_f32_16x16x32_bf16 v[40:43], v[200:203], v[176:179], v[40:43]
    ds_read_b64_tr_b16 v[192:193], v6 offset:2048
    v_mfma_f32_16x16x32_bf16 v[40:43], v[204:207], v[180:183], v[40:43]
    ds_read_b64_tr_b16 v[194:195], v6 offset:2560
    v_mfma_f32_16x16x32_bf16 v[32:35], v[204:207], v[172:175], v[32:35]
    ds_read_b64_tr_b16 v[196:197], v6 offset:14336
    v_mfma_f32_16x16x32_bf16 v[32:35], v[200:203], v[168:171], v[32:35]
    ds_read_b64_tr_b16 v[198:199], v6 offset:14848
    v_mfma_f32_16x16x32_bf16 v[24:27], v[200:203], v[160:163], v[24:27]
    ds_read_b128 v[120:123], v4 offset:18432
    v_mfma_f32_16x16x32_bf16 v[24:27], v[204:207], v[164:167], v[24:27]
    ds_read_b128 v[124:127], v5 offset:18432
    v_mfma_f32_16x16x32_bf16 v[16:19], v[204:207], v[156:159], v[16:19]
    v_mfma_f32_16x16x32_bf16 v[16:19], v[200:203], v[152:155], v[16:19]
    s_waitcnt lgkmcnt(9)
    v_mfma_f32_16x16x32_bf16 v[20:23], v[184:187], v[152:155], v[20:23]
    ds_read_b64_tr_b16 v[200:201], v7 offset:2048
    v_mfma_f32_16x16x32_bf16 v[20:23], v[188:191], v[156:159], v[20:23]
    ds_read_b64_tr_b16 v[202:203], v7 offset:2560
    v_mfma_f32_16x16x32_bf16 v[28:31], v[188:191], v[164:167], v[28:31]
    ds_read_b64_tr_b16 v[204:205], v7 offset:14336
    v_mfma_f32_16x16x32_bf16 v[28:31], v[184:187], v[160:163], v[28:31]
    ds_read_b64_tr_b16 v[206:207], v7 offset:14848
    v_mfma_f32_16x16x32_bf16 v[36:39], v[184:187], v[168:171], v[36:39]
    v_mfma_f32_16x16x32_bf16 v[36:39], v[188:191], v[172:175], v[36:39]
    v_mfma_f32_16x16x32_bf16 v[44:47], v[188:191], v[180:183], v[44:47]
    v_mfma_f32_16x16x32_bf16 v[44:47], v[184:187], v[176:179], v[44:47]
    s_waitcnt lgkmcnt(6)
    v_mfma_f32_16x16x32_bf16 v[104:107], v[176:179], v[192:195], v[104:107]
    v_mfma_f32_16x16x32_bf16 v[104:107], v[180:183], v[196:199], v[104:107]
    v_mfma_f32_16x16x32_bf16 v[96:99], v[172:175], v[196:199], v[96:99]
    v_mfma_f32_16x16x32_bf16 v[96:99], v[168:171], v[192:195], v[96:99]
    s_waitcnt lgkmcnt(0)
    s_barrier
    v_mfma_f32_16x16x32_bf16 v[88:91], v[160:163], v[192:195], v[88:91]
    ds_read_b64_tr_b16 v[184:185], v6 offset:25600
    v_mfma_f32_16x16x32_bf16 v[88:91], v[164:167], v[196:199], v[88:91]
    ds_read_b64_tr_b16 v[186:187], v6 offset:26112
    v_mfma_f32_16x16x32_bf16 v[80:83], v[156:159], v[196:199], v[80:83]
    ds_read_b64_tr_b16 v[188:189], v6 offset:37888
    v_mfma_f32_16x16x32_bf16 v[80:83], v[152:155], v[192:195], v[80:83]
    ds_read_b64_tr_b16 v[190:191], v6 offset:38400
    v_mfma_f32_16x16x32_bf16 v[84:87], v[152:155], v[200:203], v[84:87]
    ds_read_b64_tr_b16 v[192:193], v7 offset:25600
    v_mfma_f32_16x16x32_bf16 v[84:87], v[156:159], v[204:207], v[84:87]
    ds_read_b64_tr_b16 v[194:195], v7 offset:26112
    v_mfma_f32_16x16x32_bf16 v[92:95], v[164:167], v[204:207], v[92:95]
    ds_read_b64_tr_b16 v[196:197], v7 offset:37888
    v_mfma_f32_16x16x32_bf16 v[92:95], v[160:163], v[200:203], v[92:95]
    ds_read_b64_tr_b16 v[198:199], v7 offset:38400
    v_mfma_f32_16x16x32_bf16 v[100:103], v[168:171], v[200:203], v[100:103]
    v_mfma_f32_16x16x32_bf16 v[100:103], v[172:175], v[204:207], v[100:103]
    v_mfma_f32_16x16x32_bf16 v[108:111], v[180:183], v[204:207], v[108:111]
    v_mfma_f32_16x16x32_bf16 v[108:111], v[176:179], v[200:203], v[108:111]
    s_waitcnt lgkmcnt(4)
    v_mfma_f32_16x16x32_bf16 v[72:75], v[184:187], v[144:147], v[72:75]
    ds_read_b64_tr_b16 v[200:201], v6 offset:24576
    v_mfma_f32_16x16x32_bf16 v[72:75], v[188:191], v[148:151], v[72:75]
    ds_read_b64_tr_b16 v[202:203], v6 offset:25088
    v_mfma_f32_16x16x32_bf16 v[64:67], v[188:191], v[140:143], v[64:67]
    ds_read_b64_tr_b16 v[204:205], v6 offset:36864
    v_mfma_f32_16x16x32_bf16 v[64:67], v[184:187], v[136:139], v[64:67]
    ds_read_b64_tr_b16 v[206:207], v6 offset:37376
    v_mfma_f32_16x16x32_bf16 v[56:59], v[184:187], v[128:131], v[56:59]
    ds_read_b128 v[176:179], v4 offset:43008
    v_mfma_f32_16x16x32_bf16 v[56:59], v[188:191], v[132:135], v[56:59]
    ds_read_b128 v[180:183], v5 offset:43008
    v_mfma_f32_16x16x32_bf16 v[48:51], v[188:191], v[124:127], v[48:51]
    ds_read_b128 v[168:171], v4 offset:40960
    v_mfma_f32_16x16x32_bf16 v[48:51], v[184:187], v[120:123], v[48:51]
    s_waitcnt lgkmcnt(7)
    v_mfma_f32_16x16x32_bf16 v[52:55], v[192:195], v[120:123], v[52:55]
    ds_read_b64_tr_b16 v[184:185], v7 offset:24576
    v_mfma_f32_16x16x32_bf16 v[52:55], v[196:199], v[124:127], v[52:55]
    ds_read_b64_tr_b16 v[186:187], v7 offset:25088
    v_mfma_f32_16x16x32_bf16 v[60:63], v[196:199], v[132:135], v[60:63]
    ds_read_b64_tr_b16 v[188:189], v7 offset:36864
    v_mfma_f32_16x16x32_bf16 v[60:63], v[192:195], v[128:131], v[60:63]
    ds_read_b64_tr_b16 v[190:191], v7 offset:37376
    v_mfma_f32_16x16x32_bf16 v[68:71], v[192:195], v[136:139], v[68:71]
    ds_read_b128 v[172:175], v5 offset:40960
    v_mfma_f32_16x16x32_bf16 v[68:71], v[196:199], v[140:143], v[68:71]
    ds_read_b128 v[160:163], v4 offset:38912
    v_mfma_f32_16x16x32_bf16 v[76:79], v[196:199], v[148:151], v[76:79]
    ds_read_b128 v[164:167], v5 offset:38912
    v_mfma_f32_16x16x32_bf16 v[76:79], v[192:195], v[144:147], v[76:79]
    s_waitcnt lgkmcnt(10)
    v_mfma_f32_16x16x32_bf16 v[40:43], v[200:203], v[144:147], v[40:43]
    ds_read_b64_tr_b16 v[192:193], v6 offset:26624
    v_mfma_f32_16x16x32_bf16 v[40:43], v[204:207], v[148:151], v[40:43]
    ds_read_b64_tr_b16 v[194:195], v6 offset:27136
    v_mfma_f32_16x16x32_bf16 v[32:35], v[204:207], v[140:143], v[32:35]
    ds_read_b64_tr_b16 v[196:197], v6 offset:38912
    v_mfma_f32_16x16x32_bf16 v[32:35], v[200:203], v[136:139], v[32:35]
    ds_read_b64_tr_b16 v[198:199], v6 offset:39424
    v_mfma_f32_16x16x32_bf16 v[24:27], v[200:203], v[128:131], v[24:27]
    ds_read_b128 v[152:155], v4 offset:36864
    v_mfma_f32_16x16x32_bf16 v[24:27], v[204:207], v[132:135], v[24:27]
    ds_read_b128 v[156:159], v5 offset:36864
    v_mfma_f32_16x16x32_bf16 v[16:19], v[204:207], v[124:127], v[16:19]
    v_mfma_f32_16x16x32_bf16 v[16:19], v[200:203], v[120:123], v[16:19]
    s_waitcnt lgkmcnt(9)
    v_mfma_f32_16x16x32_bf16 v[20:23], v[184:187], v[120:123], v[20:23]
    ds_read_b64_tr_b16 v[200:201], v7 offset:26624
    v_mfma_f32_16x16x32_bf16 v[20:23], v[188:191], v[124:127], v[20:23]
    ds_read_b64_tr_b16 v[202:203], v7 offset:27136
    v_mfma_f32_16x16x32_bf16 v[28:31], v[188:191], v[132:135], v[28:31]
    ds_read_b64_tr_b16 v[204:205], v7 offset:38912
    v_mfma_f32_16x16x32_bf16 v[28:31], v[184:187], v[128:131], v[28:31]
    ds_read_b64_tr_b16 v[206:207], v7 offset:39424
    v_mfma_f32_16x16x32_bf16 v[36:39], v[184:187], v[136:139], v[36:39]
    v_mfma_f32_16x16x32_bf16 v[36:39], v[188:191], v[140:143], v[36:39]
    v_mfma_f32_16x16x32_bf16 v[44:47], v[188:191], v[148:151], v[44:47]
    v_mfma_f32_16x16x32_bf16 v[44:47], v[184:187], v[144:147], v[44:47]
    s_waitcnt lgkmcnt(6)
    v_mfma_f32_16x16x32_bf16 v[104:107], v[144:147], v[192:195], v[104:107]
    v_mfma_f32_16x16x32_bf16 v[104:107], v[148:151], v[196:199], v[104:107]
    v_mfma_f32_16x16x32_bf16 v[96:99], v[140:143], v[196:199], v[96:99]
    v_mfma_f32_16x16x32_bf16 v[96:99], v[136:139], v[192:195], v[96:99]
    s_waitcnt lgkmcnt(0)
    s_barrier
    v_mfma_f32_16x16x32_bf16 v[88:91], v[128:131], v[192:195], v[88:91]
    ds_read_b64_tr_b16 v[184:185], v6 offset:50176
    v_mfma_f32_16x16x32_bf16 v[88:91], v[132:135], v[196:199], v[88:91]
    ds_read_b64_tr_b16 v[186:187], v6 offset:50688
    v_mfma_f32_16x16x32_bf16 v[80:83], v[124:127], v[196:199], v[80:83]
    ds_read_b64_tr_b16 v[188:189], v6 offset:62464
    v_mfma_f32_16x16x32_bf16 v[80:83], v[120:123], v[192:195], v[80:83]
    ds_read_b64_tr_b16 v[190:191], v6 offset:62976
    v_mfma_f32_16x16x32_bf16 v[84:87], v[120:123], v[200:203], v[84:87]
    ds_read_b64_tr_b16 v[192:193], v7 offset:50176
    v_mfma_f32_16x16x32_bf16 v[84:87], v[124:127], v[204:207], v[84:87]
    ds_read_b64_tr_b16 v[194:195], v7 offset:50688
    v_mfma_f32_16x16x32_bf16 v[92:95], v[132:135], v[204:207], v[92:95]
    ds_read_b64_tr_b16 v[196:197], v7 offset:62464
    v_mfma_f32_16x16x32_bf16 v[92:95], v[128:131], v[200:203], v[92:95]
    ds_read_b64_tr_b16 v[198:199], v7 offset:62976
    v_mfma_f32_16x16x32_bf16 v[100:103], v[136:139], v[200:203], v[100:103]
    v_mfma_f32_16x16x32_bf16 v[100:103], v[140:143], v[204:207], v[100:103]
    v_mfma_f32_16x16x32_bf16 v[108:111], v[148:151], v[204:207], v[108:111]
    v_mfma_f32_16x16x32_bf16 v[108:111], v[144:147], v[200:203], v[108:111]
    s_waitcnt lgkmcnt(4)
    v_mfma_f32_16x16x32_bf16 v[72:75], v[184:187], v[176:179], v[72:75]
    ds_read_b64_tr_b16 v[200:201], v6 offset:49152
    v_mfma_f32_16x16x32_bf16 v[72:75], v[188:191], v[180:183], v[72:75]
    ds_read_b64_tr_b16 v[202:203], v6 offset:49664
    v_mfma_f32_16x16x32_bf16 v[64:67], v[188:191], v[172:175], v[64:67]
    ds_read_b64_tr_b16 v[204:205], v6 offset:61440
    v_mfma_f32_16x16x32_bf16 v[64:67], v[184:187], v[168:171], v[64:67]
    ds_read_b64_tr_b16 v[206:207], v6 offset:61952
    v_mfma_f32_16x16x32_bf16 v[56:59], v[184:187], v[160:163], v[56:59]
    ds_read_b128 v[144:147], v4 offset:6144
    v_mfma_f32_16x16x32_bf16 v[56:59], v[188:191], v[164:167], v[56:59]
    ds_read_b128 v[148:151], v5 offset:6144
    v_mfma_f32_16x16x32_bf16 v[48:51], v[188:191], v[156:159], v[48:51]
    ds_read_b128 v[136:139], v4 offset:4096
    v_mfma_f32_16x16x32_bf16 v[48:51], v[184:187], v[152:155], v[48:51]
    s_waitcnt lgkmcnt(7)
    v_mfma_f32_16x16x32_bf16 v[52:55], v[192:195], v[152:155], v[52:55]
    ds_read_b64_tr_b16 v[184:185], v7 offset:49152
    v_mfma_f32_16x16x32_bf16 v[52:55], v[196:199], v[156:159], v[52:55]
    ds_read_b64_tr_b16 v[186:187], v7 offset:49664
    v_mfma_f32_16x16x32_bf16 v[60:63], v[196:199], v[164:167], v[60:63]
    ds_read_b64_tr_b16 v[188:189], v7 offset:61440
    v_mfma_f32_16x16x32_bf16 v[60:63], v[192:195], v[160:163], v[60:63]
    ds_read_b64_tr_b16 v[190:191], v7 offset:61952
    v_mfma_f32_16x16x32_bf16 v[68:71], v[192:195], v[168:171], v[68:71]
    ds_read_b128 v[140:143], v5 offset:4096
    v_mfma_f32_16x16x32_bf16 v[68:71], v[196:199], v[172:175], v[68:71]
    ds_read_b128 v[128:131], v4 offset:2048
    v_mfma_f32_16x16x32_bf16 v[76:79], v[196:199], v[180:183], v[76:79]
    ds_read_b128 v[132:135], v5 offset:2048
    v_mfma_f32_16x16x32_bf16 v[76:79], v[192:195], v[176:179], v[76:79]
    s_waitcnt lgkmcnt(10)
    v_mfma_f32_16x16x32_bf16 v[40:43], v[200:203], v[176:179], v[40:43]
    ds_read_b64_tr_b16 v[192:193], v6 offset:51200
    v_mfma_f32_16x16x32_bf16 v[40:43], v[204:207], v[180:183], v[40:43]
    ds_read_b64_tr_b16 v[194:195], v6 offset:51712
    v_mfma_f32_16x16x32_bf16 v[32:35], v[204:207], v[172:175], v[32:35]
    ds_read_b64_tr_b16 v[196:197], v6 offset:63488
    v_mfma_f32_16x16x32_bf16 v[32:35], v[200:203], v[168:171], v[32:35]
    ds_read_b64_tr_b16 v[198:199], v6 offset:64000
    v_mfma_f32_16x16x32_bf16 v[24:27], v[200:203], v[160:163], v[24:27]
    ds_read_b128 v[120:123], v4 offset:0
    v_mfma_f32_16x16x32_bf16 v[24:27], v[204:207], v[164:167], v[24:27]
    ds_read_b128 v[124:127], v5 offset:0
    v_mfma_f32_16x16x32_bf16 v[16:19], v[204:207], v[156:159], v[16:19]
    v_mfma_f32_16x16x32_bf16 v[16:19], v[200:203], v[152:155], v[16:19]
    s_waitcnt lgkmcnt(9)
    v_mfma_f32_16x16x32_bf16 v[20:23], v[184:187], v[152:155], v[20:23]
    ds_read_b64_tr_b16 v[200:201], v7 offset:51200
    v_mfma_f32_16x16x32_bf16 v[20:23], v[188:191], v[156:159], v[20:23]
    ds_read_b64_tr_b16 v[202:203], v7 offset:51712
    v_mfma_f32_16x16x32_bf16 v[28:31], v[188:191], v[164:167], v[28:31]
    ds_read_b64_tr_b16 v[204:205], v7 offset:63488
    v_mfma_f32_16x16x32_bf16 v[28:31], v[184:187], v[160:163], v[28:31]
    ds_read_b64_tr_b16 v[206:207], v7 offset:64000
    v_mfma_f32_16x16x32_bf16 v[36:39], v[184:187], v[168:171], v[36:39]
    v_mfma_f32_16x16x32_bf16 v[36:39], v[188:191], v[172:175], v[36:39]
    v_mfma_f32_16x16x32_bf16 v[44:47], v[188:191], v[180:183], v[44:47]
    v_mfma_f32_16x16x32_bf16 v[44:47], v[184:187], v[176:179], v[44:47]
    s_waitcnt lgkmcnt(6)
    v_mfma_f32_16x16x32_bf16 v[104:107], v[176:179], v[192:195], v[104:107]
    v_mfma_f32_16x16x32_bf16 v[104:107], v[180:183], v[196:199], v[104:107]
    v_mfma_f32_16x16x32_bf16 v[96:99], v[172:175], v[196:199], v[96:99]
    v_mfma_f32_16x16x32_bf16 v[96:99], v[168:171], v[192:195], v[96:99]
    s_waitcnt lgkmcnt(0)
    s_barrier
    v_mfma_f32_16x16x32_bf16 v[88:91], v[160:163], v[192:195], v[88:91]
    ds_read_b64_tr_b16 v[184:185], v6 offset:1024
    v_mfma_f32_16x16x32_bf16 v[88:91], v[164:167], v[196:199], v[88:91]
    ds_read_b64_tr_b16 v[186:187], v6 offset:1536
    v_mfma_f32_16x16x32_bf16 v[80:83], v[156:159], v[196:199], v[80:83]
    ds_read_b64_tr_b16 v[188:189], v6 offset:13312
    v_mfma_f32_16x16x32_bf16 v[80:83], v[152:155], v[192:195], v[80:83]
    ds_read_b64_tr_b16 v[190:191], v6 offset:13824
    v_mfma_f32_16x16x32_bf16 v[84:87], v[152:155], v[200:203], v[84:87]
    ds_read_b64_tr_b16 v[192:193], v7 offset:1024
    v_mfma_f32_16x16x32_bf16 v[84:87], v[156:159], v[204:207], v[84:87]
    ds_read_b64_tr_b16 v[194:195], v7 offset:1536
    v_mfma_f32_16x16x32_bf16 v[92:95], v[164:167], v[204:207], v[92:95]
    ds_read_b64_tr_b16 v[196:197], v7 offset:13312
    v_mfma_f32_16x16x32_bf16 v[92:95], v[160:163], v[200:203], v[92:95]
    ds_read_b64_tr_b16 v[198:199], v7 offset:13824
    v_mfma_f32_16x16x32_bf16 v[100:103], v[168:171], v[200:203], v[100:103]
    v_mfma_f32_16x16x32_bf16 v[100:103], v[172:175], v[204:207], v[100:103]
    v_mfma_f32_16x16x32_bf16 v[108:111], v[180:183], v[204:207], v[108:111]
    v_mfma_f32_16x16x32_bf16 v[108:111], v[176:179], v[200:203], v[108:111]
    s_waitcnt lgkmcnt(4)
    v_mfma_f32_16x16x32_bf16 v[72:75], v[184:187], v[144:147], v[72:75]
    ds_read_b64_tr_b16 v[200:201], v6 offset:0
    v_mfma_f32_16x16x32_bf16 v[72:75], v[188:191], v[148:151], v[72:75]
    ds_read_b64_tr_b16 v[202:203], v6 offset:512
    v_mfma_f32_16x16x32_bf16 v[64:67], v[188:191], v[140:143], v[64:67]
    ds_read_b64_tr_b16 v[204:205], v6 offset:12288
    v_mfma_f32_16x16x32_bf16 v[64:67], v[184:187], v[136:139], v[64:67]
    ds_read_b64_tr_b16 v[206:207], v6 offset:12800
    v_mfma_f32_16x16x32_bf16 v[56:59], v[184:187], v[128:131], v[56:59]
    ds_read_b128 v[176:179], v4 offset:24576
    v_mfma_f32_16x16x32_bf16 v[56:59], v[188:191], v[132:135], v[56:59]
    ds_read_b128 v[180:183], v5 offset:24576
    v_mfma_f32_16x16x32_bf16 v[48:51], v[188:191], v[124:127], v[48:51]
    ds_read_b128 v[168:171], v4 offset:22528
    v_mfma_f32_16x16x32_bf16 v[48:51], v[184:187], v[120:123], v[48:51]
    s_waitcnt lgkmcnt(7)
    v_mfma_f32_16x16x32_bf16 v[52:55], v[192:195], v[120:123], v[52:55]
    ds_read_b64_tr_b16 v[184:185], v7 offset:0
    v_mfma_f32_16x16x32_bf16 v[52:55], v[196:199], v[124:127], v[52:55]
    ds_read_b64_tr_b16 v[186:187], v7 offset:512
    v_mfma_f32_16x16x32_bf16 v[60:63], v[196:199], v[132:135], v[60:63]
    ds_read_b64_tr_b16 v[188:189], v7 offset:12288
    v_mfma_f32_16x16x32_bf16 v[60:63], v[192:195], v[128:131], v[60:63]
    ds_read_b64_tr_b16 v[190:191], v7 offset:12800
    v_mfma_f32_16x16x32_bf16 v[68:71], v[192:195], v[136:139], v[68:71]
    ds_read_b128 v[172:175], v5 offset:22528
    v_mfma_f32_16x16x32_bf16 v[68:71], v[196:199], v[140:143], v[68:71]
    ds_read_b128 v[160:163], v4 offset:20480
    v_mfma_f32_16x16x32_bf16 v[76:79], v[196:199], v[148:151], v[76:79]
    ds_read_b128 v[164:167], v5 offset:20480
    v_mfma_f32_16x16x32_bf16 v[76:79], v[192:195], v[144:147], v[76:79]
    s_waitcnt lgkmcnt(10)
    v_mfma_f32_16x16x32_bf16 v[40:43], v[200:203], v[144:147], v[40:43]
    ds_read_b64_tr_b16 v[192:193], v6 offset:2048
    v_mfma_f32_16x16x32_bf16 v[40:43], v[204:207], v[148:151], v[40:43]
    ds_read_b64_tr_b16 v[194:195], v6 offset:2560
    v_mfma_f32_16x16x32_bf16 v[32:35], v[204:207], v[140:143], v[32:35]
    ds_read_b64_tr_b16 v[196:197], v6 offset:14336
    v_mfma_f32_16x16x32_bf16 v[32:35], v[200:203], v[136:139], v[32:35]
    ds_read_b64_tr_b16 v[198:199], v6 offset:14848
    v_mfma_f32_16x16x32_bf16 v[24:27], v[200:203], v[128:131], v[24:27]
    ds_read_b128 v[152:155], v4 offset:18432
    v_mfma_f32_16x16x32_bf16 v[24:27], v[204:207], v[132:135], v[24:27]
    ds_read_b128 v[156:159], v5 offset:18432
    v_mfma_f32_16x16x32_bf16 v[16:19], v[204:207], v[124:127], v[16:19]
    v_mfma_f32_16x16x32_bf16 v[16:19], v[200:203], v[120:123], v[16:19]
    s_waitcnt lgkmcnt(9)
    v_mfma_f32_16x16x32_bf16 v[20:23], v[184:187], v[120:123], v[20:23]
    ds_read_b64_tr_b16 v[200:201], v7 offset:2048
    v_mfma_f32_16x16x32_bf16 v[20:23], v[188:191], v[124:127], v[20:23]
    ds_read_b64_tr_b16 v[202:203], v7 offset:2560
    v_mfma_f32_16x16x32_bf16 v[28:31], v[188:191], v[132:135], v[28:31]
    ds_read_b64_tr_b16 v[204:205], v7 offset:14336
    v_mfma_f32_16x16x32_bf16 v[28:31], v[184:187], v[128:131], v[28:31]
    ds_read_b64_tr_b16 v[206:207], v7 offset:14848
    v_mfma_f32_16x16x32_bf16 v[36:39], v[184:187], v[136:139], v[36:39]
    v_mfma_f32_16x16x32_bf16 v[36:39], v[188:191], v[140:143], v[36:39]
    v_mfma_f32_16x16x32_bf16 v[44:47], v[188:191], v[148:151], v[44:47]
    v_mfma_f32_16x16x32_bf16 v[44:47], v[184:187], v[144:147], v[44:47]
    s_waitcnt lgkmcnt(6)
    v_mfma_f32_16x16x32_bf16 v[104:107], v[144:147], v[192:195], v[104:107]
    v_mfma_f32_16x16x32_bf16 v[104:107], v[148:151], v[196:199], v[104:107]
    v_mfma_f32_16x16x32_bf16 v[96:99], v[140:143], v[196:199], v[96:99]
    v_mfma_f32_16x16x32_bf16 v[96:99], v[136:139], v[192:195], v[96:99]
    s_waitcnt lgkmcnt(0)
    s_barrier
    v_mfma_f32_16x16x32_bf16 v[88:91], v[128:131], v[192:195], v[88:91]
    ds_read_b64_tr_b16 v[184:185], v6 offset:25600
    v_mfma_f32_16x16x32_bf16 v[88:91], v[132:135], v[196:199], v[88:91]
    ds_read_b64_tr_b16 v[186:187], v6 offset:26112
    v_mfma_f32_16x16x32_bf16 v[80:83], v[124:127], v[196:199], v[80:83]
    ds_read_b64_tr_b16 v[188:189], v6 offset:37888
    v_mfma_f32_16x16x32_bf16 v[80:83], v[120:123], v[192:195], v[80:83]
    ds_read_b64_tr_b16 v[190:191], v6 offset:38400
    v_mfma_f32_16x16x32_bf16 v[84:87], v[120:123], v[200:203], v[84:87]
    ds_read_b64_tr_b16 v[192:193], v7 offset:25600
    v_mfma_f32_16x16x32_bf16 v[84:87], v[124:127], v[204:207], v[84:87]
    ds_read_b64_tr_b16 v[194:195], v7 offset:26112
    v_mfma_f32_16x16x32_bf16 v[92:95], v[132:135], v[204:207], v[92:95]
    ds_read_b64_tr_b16 v[196:197], v7 offset:37888
    v_mfma_f32_16x16x32_bf16 v[92:95], v[128:131], v[200:203], v[92:95]
    ds_read_b64_tr_b16 v[198:199], v7 offset:38400
    v_mfma_f32_16x16x32_bf16 v[100:103], v[136:139], v[200:203], v[100:103]
    v_mfma_f32_16x16x32_bf16 v[100:103], v[140:143], v[204:207], v[100:103]
    v_mfma_f32_16x16x32_bf16 v[108:111], v[148:151], v[204:207], v[108:111]
    v_mfma_f32_16x16x32_bf16 v[108:111], v[144:147], v[200:203], v[108:111]
    s_waitcnt lgkmcnt(4)
    v_mfma_f32_16x16x32_bf16 v[72:75], v[184:187], v[176:179], v[72:75]
    ds_read_b64_tr_b16 v[200:201], v6 offset:24576
    v_mfma_f32_16x16x32_bf16 v[72:75], v[188:191], v[180:183], v[72:75]
    ds_read_b64_tr_b16 v[202:203], v6 offset:25088
    v_mfma_f32_16x16x32_bf16 v[64:67], v[188:191], v[172:175], v[64:67]
    ds_read_b64_tr_b16 v[204:205], v6 offset:36864
    v_mfma_f32_16x16x32_bf16 v[64:67], v[184:187], v[168:171], v[64:67]
    ds_read_b64_tr_b16 v[206:207], v6 offset:37376
    v_mfma_f32_16x16x32_bf16 v[56:59], v[184:187], v[160:163], v[56:59]
    ds_read_b128 v[144:147], v4 offset:43008
    v_mfma_f32_16x16x32_bf16 v[56:59], v[188:191], v[164:167], v[56:59]
    ds_read_b128 v[148:151], v5 offset:43008
    v_mfma_f32_16x16x32_bf16 v[48:51], v[188:191], v[156:159], v[48:51]
    ds_read_b128 v[136:139], v4 offset:40960
    v_mfma_f32_16x16x32_bf16 v[48:51], v[184:187], v[152:155], v[48:51]
    s_waitcnt lgkmcnt(7)
    v_mfma_f32_16x16x32_bf16 v[52:55], v[192:195], v[152:155], v[52:55]
    ds_read_b64_tr_b16 v[184:185], v7 offset:24576
    v_mfma_f32_16x16x32_bf16 v[52:55], v[196:199], v[156:159], v[52:55]
    ds_read_b64_tr_b16 v[186:187], v7 offset:25088
    v_mfma_f32_16x16x32_bf16 v[60:63], v[196:199], v[164:167], v[60:63]
    ds_read_b64_tr_b16 v[188:189], v7 offset:36864
    v_mfma_f32_16x16x32_bf16 v[60:63], v[192:195], v[160:163], v[60:63]
    ds_read_b64_tr_b16 v[190:191], v7 offset:37376
    v_mfma_f32_16x16x32_bf16 v[68:71], v[192:195], v[168:171], v[68:71]
    ds_read_b128 v[140:143], v5 offset:40960
    v_mfma_f32_16x16x32_bf16 v[68:71], v[196:199], v[172:175], v[68:71]
    ds_read_b128 v[128:131], v4 offset:38912
    v_mfma_f32_16x16x32_bf16 v[76:79], v[196:199], v[180:183], v[76:79]
    ds_read_b128 v[132:135], v5 offset:38912
    v_mfma_f32_16x16x32_bf16 v[76:79], v[192:195], v[176:179], v[76:79]
    s_waitcnt lgkmcnt(10)
    v_mfma_f32_16x16x32_bf16 v[40:43], v[200:203], v[176:179], v[40:43]
    ds_read_b64_tr_b16 v[192:193], v6 offset:26624
    v_mfma_f32_16x16x32_bf16 v[40:43], v[204:207], v[180:183], v[40:43]
    ds_read_b64_tr_b16 v[194:195], v6 offset:27136
    v_mfma_f32_16x16x32_bf16 v[32:35], v[204:207], v[172:175], v[32:35]
    ds_read_b64_tr_b16 v[196:197], v6 offset:38912
    v_mfma_f32_16x16x32_bf16 v[32:35], v[200:203], v[168:171], v[32:35]
    ds_read_b64_tr_b16 v[198:199], v6 offset:39424
    v_mfma_f32_16x16x32_bf16 v[24:27], v[200:203], v[160:163], v[24:27]
    ds_read_b128 v[120:123], v4 offset:36864
    v_mfma_f32_16x16x32_bf16 v[24:27], v[204:207], v[164:167], v[24:27]
    ds_read_b128 v[124:127], v5 offset:36864
    v_mfma_f32_16x16x32_bf16 v[16:19], v[204:207], v[156:159], v[16:19]
    v_mfma_f32_16x16x32_bf16 v[16:19], v[200:203], v[152:155], v[16:19]
    s_waitcnt lgkmcnt(9)
    v_mfma_f32_16x16x32_bf16 v[20:23], v[184:187], v[152:155], v[20:23]
    ds_read_b64_tr_b16 v[200:201], v7 offset:26624
    v_mfma_f32_16x16x32_bf16 v[20:23], v[188:191], v[156:159], v[20:23]
    ds_read_b64_tr_b16 v[202:203], v7 offset:27136
    v_mfma_f32_16x16x32_bf16 v[28:31], v[188:191], v[164:167], v[28:31]
    ds_read_b64_tr_b16 v[204:205], v7 offset:38912
    v_mfma_f32_16x16x32_bf16 v[28:31], v[184:187], v[160:163], v[28:31]
    ds_read_b64_tr_b16 v[206:207], v7 offset:39424
    v_mfma_f32_16x16x32_bf16 v[36:39], v[184:187], v[168:171], v[36:39]
    v_mfma_f32_16x16x32_bf16 v[36:39], v[188:191], v[172:175], v[36:39]
    v_mfma_f32_16x16x32_bf16 v[44:47], v[188:191], v[180:183], v[44:47]
    v_mfma_f32_16x16x32_bf16 v[44:47], v[184:187], v[176:179], v[44:47]
    s_waitcnt lgkmcnt(6)
    v_mfma_f32_16x16x32_bf16 v[104:107], v[176:179], v[192:195], v[104:107]
    v_mfma_f32_16x16x32_bf16 v[104:107], v[180:183], v[196:199], v[104:107]
    v_mfma_f32_16x16x32_bf16 v[96:99], v[172:175], v[196:199], v[96:99]
    v_mfma_f32_16x16x32_bf16 v[96:99], v[168:171], v[192:195], v[96:99]
    s_waitcnt lgkmcnt(0)
    s_barrier
    v_mfma_f32_16x16x32_bf16 v[88:91], v[160:163], v[192:195], v[88:91]
    ds_read_b64_tr_b16 v[184:185], v6 offset:50176
    v_mfma_f32_16x16x32_bf16 v[88:91], v[164:167], v[196:199], v[88:91]
    ds_read_b64_tr_b16 v[186:187], v6 offset:50688
    v_mfma_f32_16x16x32_bf16 v[80:83], v[156:159], v[196:199], v[80:83]
    ds_read_b64_tr_b16 v[188:189], v6 offset:62464
    v_mfma_f32_16x16x32_bf16 v[80:83], v[152:155], v[192:195], v[80:83]
    ds_read_b64_tr_b16 v[190:191], v6 offset:62976
    v_mfma_f32_16x16x32_bf16 v[84:87], v[152:155], v[200:203], v[84:87]
    ds_read_b64_tr_b16 v[192:193], v7 offset:50176
    v_mfma_f32_16x16x32_bf16 v[84:87], v[156:159], v[204:207], v[84:87]
    ds_read_b64_tr_b16 v[194:195], v7 offset:50688
    v_mfma_f32_16x16x32_bf16 v[92:95], v[164:167], v[204:207], v[92:95]
    ds_read_b64_tr_b16 v[196:197], v7 offset:62464
    v_mfma_f32_16x16x32_bf16 v[92:95], v[160:163], v[200:203], v[92:95]
    ds_read_b64_tr_b16 v[198:199], v7 offset:62976
    v_mfma_f32_16x16x32_bf16 v[100:103], v[168:171], v[200:203], v[100:103]
    v_mfma_f32_16x16x32_bf16 v[100:103], v[172:175], v[204:207], v[100:103]
    v_mfma_f32_16x16x32_bf16 v[108:111], v[180:183], v[204:207], v[108:111]
    v_mfma_f32_16x16x32_bf16 v[108:111], v[176:179], v[200:203], v[108:111]
    s_waitcnt lgkmcnt(4)
    v_mfma_f32_16x16x32_bf16 v[72:75], v[184:187], v[144:147], v[72:75]
    ds_read_b64_tr_b16 v[200:201], v6 offset:49152
    v_mfma_f32_16x16x32_bf16 v[72:75], v[188:191], v[148:151], v[72:75]
    ds_read_b64_tr_b16 v[202:203], v6 offset:49664
    v_mfma_f32_16x16x32_bf16 v[64:67], v[188:191], v[140:143], v[64:67]
    ds_read_b64_tr_b16 v[204:205], v6 offset:61440
    v_mfma_f32_16x16x32_bf16 v[64:67], v[184:187], v[136:139], v[64:67]
    ds_read_b64_tr_b16 v[206:207], v6 offset:61952
    v_mfma_f32_16x16x32_bf16 v[56:59], v[184:187], v[128:131], v[56:59]
    v_mfma_f32_16x16x32_bf16 v[56:59], v[188:191], v[132:135], v[56:59]
    v_mfma_f32_16x16x32_bf16 v[48:51], v[188:191], v[124:127], v[48:51]
    v_mfma_f32_16x16x32_bf16 v[48:51], v[184:187], v[120:123], v[48:51]
    s_waitcnt lgkmcnt(4)
    v_mfma_f32_16x16x32_bf16 v[52:55], v[192:195], v[120:123], v[52:55]
    ds_read_b64_tr_b16 v[184:185], v7 offset:49152
    v_mfma_f32_16x16x32_bf16 v[52:55], v[196:199], v[124:127], v[52:55]
    ds_read_b64_tr_b16 v[186:187], v7 offset:49664
    v_mfma_f32_16x16x32_bf16 v[60:63], v[196:199], v[132:135], v[60:63]
    ds_read_b64_tr_b16 v[188:189], v7 offset:61440
    v_mfma_f32_16x16x32_bf16 v[60:63], v[192:195], v[128:131], v[60:63]
    ds_read_b64_tr_b16 v[190:191], v7 offset:61952
    v_mfma_f32_16x16x32_bf16 v[68:71], v[192:195], v[136:139], v[68:71]
    v_mfma_f32_16x16x32_bf16 v[68:71], v[196:199], v[140:143], v[68:71]
    v_mfma_f32_16x16x32_bf16 v[76:79], v[196:199], v[148:151], v[76:79]
    v_mfma_f32_16x16x32_bf16 v[76:79], v[192:195], v[144:147], v[76:79]
    s_waitcnt lgkmcnt(4)
    v_mfma_f32_16x16x32_bf16 v[40:43], v[200:203], v[144:147], v[40:43]
    ds_read_b64_tr_b16 v[192:193], v6 offset:51200
    v_mfma_f32_16x16x32_bf16 v[40:43], v[204:207], v[148:151], v[40:43]
    ds_read_b64_tr_b16 v[194:195], v6 offset:51712
    v_mfma_f32_16x16x32_bf16 v[32:35], v[204:207], v[140:143], v[32:35]
    ds_read_b64_tr_b16 v[196:197], v6 offset:63488
    v_mfma_f32_16x16x32_bf16 v[32:35], v[200:203], v[136:139], v[32:35]
    ds_read_b64_tr_b16 v[198:199], v6 offset:64000
    v_mfma_f32_16x16x32_bf16 v[24:27], v[200:203], v[128:131], v[24:27]
    ds_read_b128 v[176:179], v4 offset:6144
    v_mfma_f32_16x16x32_bf16 v[24:27], v[204:207], v[132:135], v[24:27]
    ds_read_b128 v[180:183], v5 offset:6144
    v_mfma_f32_16x16x32_bf16 v[16:19], v[204:207], v[124:127], v[16:19]
    ds_read_b128 v[168:171], v4 offset:4096
    v_mfma_f32_16x16x32_bf16 v[16:19], v[200:203], v[120:123], v[16:19]
    s_waitcnt lgkmcnt(7)
    v_mfma_f32_16x16x32_bf16 v[20:23], v[184:187], v[120:123], v[20:23]
    ds_read_b64_tr_b16 v[200:201], v7 offset:51200
    v_mfma_f32_16x16x32_bf16 v[20:23], v[188:191], v[124:127], v[20:23]
    ds_read_b64_tr_b16 v[202:203], v7 offset:51712
    v_mfma_f32_16x16x32_bf16 v[28:31], v[188:191], v[132:135], v[28:31]
    ds_read_b64_tr_b16 v[204:205], v7 offset:63488
    v_mfma_f32_16x16x32_bf16 v[28:31], v[184:187], v[128:131], v[28:31]
    ds_read_b64_tr_b16 v[206:207], v7 offset:64000
    v_mfma_f32_16x16x32_bf16 v[36:39], v[184:187], v[136:139], v[36:39]
    ds_read_b128 v[172:175], v5 offset:4096
    v_mfma_f32_16x16x32_bf16 v[36:39], v[188:191], v[140:143], v[36:39]
    ds_read_b128 v[160:163], v4 offset:2048
    v_mfma_f32_16x16x32_bf16 v[44:47], v[188:191], v[148:151], v[44:47]
    ds_read_b128 v[164:167], v5 offset:2048
    v_mfma_f32_16x16x32_bf16 v[44:47], v[184:187], v[144:147], v[44:47]
    s_waitcnt lgkmcnt(10)
    v_mfma_f32_16x16x32_bf16 v[104:107], v[144:147], v[192:195], v[104:107]
    ds_read_b64_tr_b16 v[184:185], v6 offset:1024
    v_mfma_f32_16x16x32_bf16 v[104:107], v[148:151], v[196:199], v[104:107]
    ds_read_b64_tr_b16 v[186:187], v6 offset:1536
    v_mfma_f32_16x16x32_bf16 v[96:99], v[140:143], v[196:199], v[96:99]
    ds_read_b64_tr_b16 v[188:189], v6 offset:13312
    v_mfma_f32_16x16x32_bf16 v[96:99], v[136:139], v[192:195], v[96:99]
    ds_read_b64_tr_b16 v[190:191], v6 offset:13824
    v_mfma_f32_16x16x32_bf16 v[88:91], v[128:131], v[192:195], v[88:91]
    ds_read_b128 v[152:155], v4 offset:0
    v_mfma_f32_16x16x32_bf16 v[88:91], v[132:135], v[196:199], v[88:91]
    ds_read_b128 v[156:159], v5 offset:0
    v_mfma_f32_16x16x32_bf16 v[80:83], v[124:127], v[196:199], v[80:83]
    v_mfma_f32_16x16x32_bf16 v[80:83], v[120:123], v[192:195], v[80:83]
    s_waitcnt lgkmcnt(9)
    v_mfma_f32_16x16x32_bf16 v[84:87], v[120:123], v[200:203], v[84:87]
    ds_read_b64_tr_b16 v[192:193], v7 offset:1024
    v_mfma_f32_16x16x32_bf16 v[84:87], v[124:127], v[204:207], v[84:87]
    ds_read_b64_tr_b16 v[194:195], v7 offset:1536
    v_mfma_f32_16x16x32_bf16 v[92:95], v[132:135], v[204:207], v[92:95]
    ds_read_b64_tr_b16 v[196:197], v7 offset:13312
    v_mfma_f32_16x16x32_bf16 v[92:95], v[128:131], v[200:203], v[92:95]
    ds_read_b64_tr_b16 v[198:199], v7 offset:13824
    v_mfma_f32_16x16x32_bf16 v[100:103], v[136:139], v[200:203], v[100:103]
    v_mfma_f32_16x16x32_bf16 v[100:103], v[140:143], v[204:207], v[100:103]
    v_mfma_f32_16x16x32_bf16 v[108:111], v[148:151], v[204:207], v[108:111]
    v_mfma_f32_16x16x32_bf16 v[108:111], v[144:147], v[200:203], v[108:111]
    s_waitcnt lgkmcnt(8)
    v_mfma_f32_16x16x32_bf16 v[72:75], v[184:187], v[176:179], v[72:75]
    ds_read_b64_tr_b16 v[136:137], v6 offset:2048
    ds_read_b64_tr_b16 v[138:139], v6 offset:2560
    s_waitcnt lgkmcnt(8)
    v_mfma_f32_16x16x32_bf16 v[72:75], v[188:191], v[180:183], v[72:75]
    ds_read_b64_tr_b16 v[140:141], v6 offset:14336
    ds_read_b64_tr_b16 v[142:143], v6 offset:14848
    s_waitcnt lgkmcnt(4)
    v_mfma_f32_16x16x32_bf16 v[76:79], v[196:199], v[180:183], v[76:79]
    ds_read_b64_tr_b16 v[144:145], v7 offset:2048
    ds_read_b64_tr_b16 v[146:147], v7 offset:2560
    v_mfma_f32_16x16x32_bf16 v[76:79], v[192:195], v[176:179], v[76:79]
    ds_read_b64_tr_b16 v[148:149], v7 offset:14336
    ds_read_b64_tr_b16 v[150:151], v7 offset:14848
    v_mfma_f32_16x16x32_bf16 v[68:71], v[192:195], v[168:171], v[68:71]
    ds_read_b64_tr_b16 v[120:121], v6 offset:0
    ds_read_b64_tr_b16 v[122:123], v6 offset:512
    v_mfma_f32_16x16x32_bf16 v[68:71], v[196:199], v[172:175], v[68:71]
    ds_read_b64_tr_b16 v[124:125], v6 offset:12288
    ds_read_b64_tr_b16 v[126:127], v6 offset:12800
    v_mfma_f32_16x16x32_bf16 v[64:67], v[188:191], v[172:175], v[64:67]
    v_cvt_pk_bf16_f32 v72, v72, v73
    v_cvt_pk_bf16_f32 v73, v74, v75
    v_mfma_f32_16x16x32_bf16 v[64:67], v[184:187], v[168:171], v[64:67]
    v_cvt_pk_bf16_f32 v74, v76, v77
    v_cvt_pk_bf16_f32 v75, v78, v79
    buffer_store_dwordx4 v[72:75], v12, s[52:55], s99 offen sc1
    ds_read_b64_tr_b16 v[128:129], v7 offset:0
    ds_read_b64_tr_b16 v[130:131], v7 offset:512
    s_waitcnt lgkmcnt(12)
    v_mfma_f32_16x16x32_bf16 v[104:107], v[176:179], v[136:139], v[104:107]
    ds_read_b64_tr_b16 v[132:133], v7 offset:12288
    ds_read_b64_tr_b16 v[134:135], v7 offset:12800
    s_waitcnt lgkmcnt(12)
    v_mfma_f32_16x16x32_bf16 v[104:107], v[180:183], v[140:143], v[104:107]
    s_mov_b64 exec, 1
    ds_add_u32 v10, v11 offset:0
    s_mov_b64 exec, -1
    s_waitcnt lgkmcnt(9)
    v_mfma_f32_16x16x32_bf16 v[108:111], v[180:183], v[148:151], v[108:111]
    v_mfma_f32_16x16x32_bf16 v[108:111], v[176:179], v[144:147], v[108:111]
    s_nop 1
    v_mfma_f32_16x16x32_bf16 v[56:59], v[184:187], v[160:163], v[56:59]
    v_cvt_pk_bf16_f32 v232, v104, v105
    v_cvt_pk_bf16_f32 v233, v106, v107
    v_mfma_f32_16x16x32_bf16 v[56:59], v[188:191], v[164:167], v[56:59]
    s_nop 1
    v_mfma_f32_16x16x32_bf16 v[60:63], v[196:199], v[164:167], v[60:63]
    v_cvt_pk_bf16_f32 v242, v108, v109
    v_cvt_pk_bf16_f32 v243, v110, v111
    v_mfma_f32_16x16x32_bf16 v[60:63], v[192:195], v[160:163], v[60:63]
    buffer_store_dwordx2 v[232:233], v216, s[52:55], s99 offen offset:1024 sc1
    buffer_store_dwordx2 v[242:243], v216, s[52:55], s99 offen offset:1536 sc1
    v_mfma_f32_16x16x32_bf16 v[52:55], v[192:195], v[152:155], v[52:55]
    v_cvt_pk_bf16_f32 v64, v64, v65
    v_cvt_pk_bf16_f32 v65, v66, v67
    v_mfma_f32_16x16x32_bf16 v[52:55], v[196:199], v[156:159], v[52:55]
    v_cvt_pk_bf16_f32 v66, v68, v69
    v_cvt_pk_bf16_f32 v67, v70, v71
    v_mfma_f32_16x16x32_bf16 v[48:51], v[188:191], v[156:159], v[48:51]
    v_cvt_pk_bf16_f32 v56, v56, v57
    v_cvt_pk_bf16_f32 v57, v58, v59
    v_mfma_f32_16x16x32_bf16 v[48:51], v[184:187], v[152:155], v[48:51]
    v_cvt_pk_bf16_f32 v58, v60, v61
    v_cvt_pk_bf16_f32 v59, v62, v63
    s_waitcnt lgkmcnt(7)
    v_mfma_f32_16x16x32_bf16 v[40:43], v[120:123], v[176:179], v[40:43]
    s_nop 1
    s_waitcnt lgkmcnt(5)
    v_mfma_f32_16x16x32_bf16 v[40:43], v[124:127], v[180:183], v[40:43]
    s_nop 1
    s_waitcnt lgkmcnt(1)
    v_mfma_f32_16x16x32_bf16 v[44:47], v[132:135], v[180:183], v[44:47]
    v_cvt_pk_bf16_f32 v48, v48, v49
    v_cvt_pk_bf16_f32 v49, v50, v51
    v_mfma_f32_16x16x32_bf16 v[44:47], v[128:131], v[176:179], v[44:47]
    v_cvt_pk_bf16_f32 v50, v52, v53
    v_cvt_pk_bf16_f32 v51, v54, v55
    v_mfma_f32_16x16x32_bf16 v[36:39], v[128:131], v[168:171], v[36:39]
    v_cvt_pk_bf16_f32 v40, v40, v41
    v_cvt_pk_bf16_f32 v41, v42, v43
    v_mfma_f32_16x16x32_bf16 v[36:39], v[132:135], v[172:175], v[36:39]
    s_nop 1
    v_mfma_f32_16x16x32_bf16 v[32:35], v[124:127], v[172:175], v[32:35]
    v_cvt_pk_bf16_f32 v42, v44, v45
    v_cvt_pk_bf16_f32 v43, v46, v47
    v_mfma_f32_16x16x32_bf16 v[32:35], v[120:123], v[168:171], v[32:35]
    s_nop 1
    v_mfma_f32_16x16x32_bf16 v[24:27], v[120:123], v[160:163], v[24:27]
    s_nop 1
    v_mfma_f32_16x16x32_bf16 v[24:27], v[124:127], v[164:167], v[24:27]
    s_nop 1
    v_mfma_f32_16x16x32_bf16 v[28:31], v[132:135], v[164:167], v[28:31]
    v_cvt_pk_bf16_f32 v32, v32, v33
    v_cvt_pk_bf16_f32 v33, v34, v35
    v_mfma_f32_16x16x32_bf16 v[28:31], v[128:131], v[160:163], v[28:31]
    v_cvt_pk_bf16_f32 v34, v36, v37
    v_cvt_pk_bf16_f32 v35, v38, v39
    v_mfma_f32_16x16x32_bf16 v[20:23], v[128:131], v[152:155], v[20:23]
    v_cvt_pk_bf16_f32 v24, v24, v25
    v_cvt_pk_bf16_f32 v25, v26, v27
    v_mfma_f32_16x16x32_bf16 v[20:23], v[132:135], v[156:159], v[20:23]
    s_nop 1
    v_mfma_f32_16x16x32_bf16 v[16:19], v[124:127], v[156:159], v[16:19]
    v_cvt_pk_bf16_f32 v26, v28, v29
    v_cvt_pk_bf16_f32 v27, v30, v31
    v_mfma_f32_16x16x32_bf16 v[16:19], v[120:123], v[152:155], v[16:19]
    s_nop 1
    v_mfma_f32_16x16x32_bf16 v[44:47], v[72:75], v[40:43], 0
    s_nop 1
    v_mfma_f32_16x16x32_bf16 v[76:79], v[64:67], v[40:43], 0
    s_nop 1
    v_mfma_f32_16x16x32_bf16 v[36:39], v[64:67], v[32:35], 0
    v_cvt_pk_bf16_f32 v16, v16, v17
    v_cvt_pk_bf16_f32 v17, v18, v19
    v_mfma_f32_16x16x32_bf16 v[68:71], v[56:59], v[32:35], 0
    v_cvt_pk_bf16_f32 v18, v20, v21
    v_cvt_pk_bf16_f32 v19, v22, v23
    v_mfma_f32_16x16x32_bf16 v[28:31], v[56:59], v[24:27], 0
    ds_read_b32 v223, v10 offset:0
    v_cndmask_b32 v184, v44, v45, s[88:89]
    v_mfma_f32_16x16x32_bf16 v[60:63], v[48:51], v[24:27], 0
    v_cndmask_b32 v185, v76, v77, s[88:89]
    v_cndmask_b32 v206, v185, v184, s[90:91]
    v_mfma_f32_16x16x32_bf16 v[100:103], v[168:171], v[144:147], v[100:103]
    v_cndmask_b32 v186, v46, v47, s[88:89]
    v_cndmask_b32 v187, v78, v79, s[88:89]
    v_mfma_f32_16x16x32_bf16 v[100:103], v[172:175], v[148:151], v[100:103]
    v_cndmask_b32 v207, v187, v186, s[92:93]
    v_max_f32 v119, v206, v207
    v_mfma_f32_16x16x32_bf16 v[20:23], v[48:51], v[16:19], 0
    v_cndmask_b32 v184, v36, v37, s[88:89]
    v_cndmask_b32 v185, v68, v69, s[88:89]
    v_mfma_f32_16x16x32_bf16 v[96:99], v[172:175], v[140:143], v[96:99]
    v_cndmask_b32 v204, v185, v184, s[90:91]
    v_cndmask_b32 v186, v38, v39, s[88:89]
    v_mfma_f32_16x16x32_bf16 v[96:99], v[168:171], v[136:139], v[96:99]
    v_cndmask_b32 v187, v70, v71, s[88:89]
    v_cndmask_b32 v205, v187, v186, s[92:93]
    v_mfma_f32_16x16x32_bf16 v[88:91], v[160:163], v[136:139], v[88:91]
    v_max_f32 v118, v204, v205
    v_mfma_f32_16x16x32_bf16 v[88:91], v[164:167], v[140:143], v[88:91]
    v_mfma_f32_16x16x32_bf16 v[92:95], v[164:167], v[148:151], v[92:95]
    v_mfma_f32_16x16x32_bf16 v[92:95], v[160:163], v[144:147], v[92:95]
    s_waitcnt lgkmcnt(0)
    v_cmp_gt_u32 vcc, 8, v223
    s_cbranch_vccnz LB_w1
LB_g1:
    v_mfma_f32_16x16x32_bf16 v[84:87], v[152:155], v[144:147], v[84:87]
    buffer_load_dwordx4 v[112:115], v217, s[52:55], s100 offen sc1
    buffer_load_dwordx2 v[224:225], v218, s[52:55], s100 offen offset:1024 sc1
    v_mfma_f32_16x16x32_bf16 v[84:87], v[156:159], v[148:151], v[84:87]
    buffer_load_dwordx2 v[234:235], v218, s[52:55], s100 offen offset:1536 sc1
    v_cndmask_b32 v184, v28, v29, s[88:89]
    v_mfma_f32_16x16x32_bf16 v[80:83], v[156:159], v[140:143], v[80:83]
    v_cndmask_b32 v185, v60, v61, s[88:89]
    v_cndmask_b32 v202, v185, v184, s[90:91]
    v_mfma_f32_16x16x32_bf16 v[80:83], v[152:155], v[136:139], v[80:83]
    v_cndmask_b32 v186, v30, v31, s[88:89]
    v_cndmask_b32 v187, v62, v63, s[88:89]
    v_cndmask_b32 v203, v187, v186, s[92:93]
    v_max_f32 v117, v202, v203
    s_add_u32 m0, s34, 0
    s_add_u32 s35, s44, 0
    buffer_load_dwordx4 v245, s[64:67], s35 offen lds
    v_cvt_pk_bf16_f32 v230, v96, v97
    v_cvt_pk_bf16_f32 v231, v98, v99
    v_cvt_pk_bf16_f32 v240, v100, v101
    v_cvt_pk_bf16_f32 v241, v102, v103
    v_cvt_pk_bf16_f32 v228, v88, v89
    s_add_u32 m0, s34, 4096
    s_add_u32 s35, s44, 65536
    buffer_load_dwordx4 v245, s[64:67], s35 offen lds
    v_cvt_pk_bf16_f32 v229, v90, v91
    v_cvt_pk_bf16_f32 v238, v92, v93
    v_cvt_pk_bf16_f32 v239, v94, v95
    v_cvt_pk_bf16_f32 v226, v80, v81
    v_cvt_pk_bf16_f32 v227, v82, v83
    s_add_u32 m0, s34, 8192
    s_add_u32 s35, s44, 131072
    buffer_load_dwordx4 v245, s[64:67], s35 offen lds
    v_cvt_pk_bf16_f32 v236, v84, v85
    v_cvt_pk_bf16_f32 v237, v86, v87
    v_xor_b32 v2, 0, v244
    v_xor_b32 v3, 32, v244
    v_xor_b32 v4, 64, v244
    s_add_u32 m0, s34, 12288
    s_add_u32 s35, s44, 196608
    buffer_load_dwordx4 v245, s[64:67], s35 offen lds
    v_xor_b32 v5, 96, v244
    v_xor_b32 v6, 2048, v244
    v_xor_b32 v7, 2080, v244
    v_xor_b32 v8, 2112, v244
    v_xor_b32 v9, 2144, v244
    s_waitcnt vmcnt(4)
    v_max3_u32 v223, v112, v113, v114
    v_max3_u32 v14, v115, v224, v225
    v_max3_u32 v223, v223, v234, v235
    v_max_u32 v223, v223, v14
    v_cmp_eq_u32 vcc, -1, v223
    s_cbranch_vccnz LB_we
LB_ge:
    v_mfma_f32_16x16x32_bf16 v[52:55], v[112:115], v[16:19], v[212:215]
    s_mov_b32 s80, 0x3e8293ee
    v_cndmask_b32 v184, v20, v21, s[88:89]
    s_nop 5
    v_cndmask_b32 v185, v52, v53, s[88:89]
    v_cndmask_b32 v200, v185, v184, s[90:91]
    v_cndmask_b32 v186, v22, v23, s[88:89]
    v_cndmask_b32 v187, v54, v55, s[88:89]
    v_cndmask_b32 v201, v187, v186, s[92:93]
    v_max_f32 v116, v200, v201
    v_permlane32_swap_b32 v118, v119
    s_nop 0
    v_permlane32_swap_b32 v116, v117
    v_max_f32 v118, v118, v119
    v_max_f32 v116, v116, v117
    s_nop 1
    v_permlane16_swap_b32 v116, v118
    v_max_f32 v116, v116, v118
    v_mul_f32 v116, s80, v116
    v_mov_b32 v118, v116
    s_nop 1
    v_permlane16_swap_b32 v116, v118
    v_mov_b32 v117, v116
    v_mov_b32 v119, v118
    s_nop 0
    v_permlane32_swap_b32 v116, v117
    v_permlane32_swap_b32 v118, v119
    v_fma_f32 v200, v200, s80, -v116
    v_fma_f32 v201, v201, s80, -v116
    v_fma_f32 v202, v202, s80, -v117
    v_fma_f32 v203, v203, s80, -v117
    v_fma_f32 v204, v204, s80, -v118
    v_fma_f32 v205, v205, s80, -v118
    v_fma_f32 v206, v206, s80, -v119
    v_fma_f32 v207, v207, s80, -v119
    v_exp_f32 v200, v200
    v_exp_f32 v201, v201
    v_exp_f32 v202, v202
    v_exp_f32 v203, v203
    v_exp_f32 v204, v204
    v_exp_f32 v205, v205
    v_exp_f32 v206, v206
    v_exp_f32 v207, v207
    v_add_f32 v116, v200, v201
    v_add_f32 v117, v202, v203
    v_add_f32 v118, v204, v205
    v_add_f32 v119, v206, v207
    s_nop 1
    v_permlane32_swap_b32 v118, v119
    v_permlane32_swap_b32 v116, v117
    v_add_f32 v118, v118, v119
    v_add_f32 v116, v116, v117
    s_nop 1
    v_permlane16_swap_b32 v116, v118
    v_add_f32 v116, v116, v118
    v_rcp_f32 v116, v116
    s_nop 0
    v_mov_b32 v118, v116
    s_nop 1
    v_permlane16_swap_b32 v116, v118
    v_mov_b32 v117, v116
    v_mov_b32 v119, v118
    s_nop 0
    v_permlane32_swap_b32 v116, v117
    v_permlane32_swap_b32 v118, v119
    v_mul_f32 v200, v200, v116
    v_mul_f32 v201, v201, v116
    v_cvt_pk_bf16_f32 v200, v200, v201
    v_perm_b32 v160, v200, v200, v208
    v_perm_b32 v161, v200, v200, v209
    v_perm_b32 v162, v200, v200, v210
    v_perm_b32 v163, v200, v200, v211
    v_mul_f32 v202, v202, v117
    v_mul_f32 v203, v203, v117
    v_mfma_f32_16x16x32_bf16 v[16:19], v[224:227], v[160:163], 0
    v_cvt_pk_bf16_f32 v202, v202, v203
    v_mfma_f32_16x16x32_bf16 v[20:23], v[234:237], v[160:163], 0
    v_perm_b32 v164, v202, v202, v208
    v_perm_b32 v165, v202, v202, v209
    v_perm_b32 v166, v202, v202, v210
    v_perm_b32 v167, v202, v202, v211
    v_mul_f32 v204, v204, v118
    v_mul_f32 v205, v205, v118
    v_mfma_f32_16x16x32_bf16 v[24:27], v[226:229], v[164:167], 0
    v_cvt_pk_bf16_f32 v204, v204, v205
    v_mfma_f32_16x16x32_bf16 v[28:31], v[236:239], v[164:167], 0
    v_perm_b32 v168, v204, v204, v208
    v_perm_b32 v169, v204, v204, v209
    v_perm_b32 v170, v204, v204, v210
    v_perm_b32 v171, v204, v204, v211
    v_cvt_pk_bf16_f32 v80, v16, v17
    v_cvt_pk_bf16_f32 v81, v18, v19
    v_mfma_f32_16x16x32_bf16 v[32:35], v[228:231], v[168:171], 0
    v_cvt_pk_bf16_f32 v82, v20, v21
    v_mfma_f32_16x16x32_bf16 v[36:39], v[238:241], v[168:171], 0
    v_cvt_pk_bf16_f32 v83, v22, v23
    s_add_u32 s95, s94, 0
    buffer_store_dwordx4 v[80:83], v12, s[52:55], s95 offen sc1
    v_mul_f32 v206, v206, v119
    v_mul_f32 v207, v207, v119
    v_cvt_pk_bf16_f32 v206, v206, v207
    v_perm_b32 v172, v206, v206, v208
    v_perm_b32 v173, v206, v206, v209
    v_perm_b32 v174, v206, v206, v210
    v_perm_b32 v175, v206, v206, v211
    v_cvt_pk_bf16_f32 v84, v24, v25
    v_cvt_pk_bf16_f32 v85, v26, v27
    v_mfma_f32_16x16x32_bf16 v[40:43], v[230:233], v[172:175], 0
    v_cvt_pk_bf16_f32 v86, v28, v29
    v_mfma_f32_16x16x32_bf16 v[44:47], v[240:243], v[172:175], 0
    v_cvt_pk_bf16_f32 v87, v30, v31
    s_add_u32 s95, s94, 32768
    buffer_store_dwordx4 v[84:87], v12, s[52:55], s95 offen sc1
    v_cvt_pk_bf16_f32 v88, v32, v33
    v_cvt_pk_bf16_f32 v89, v34, v35
    v_cvt_pk_bf16_f32 v90, v36, v37
    v_cvt_pk_bf16_f32 v91, v38, v39
    s_add_u32 s95, s94, 65536
    buffer_store_dwordx4 v[88:91], v12, s[52:55], s95 offen sc1
    v_cvt_pk_bf16_f32 v92, v40, v41
    v_cvt_pk_bf16_f32 v93, v42, v43
    v_cvt_pk_bf16_f32 v94, v44, v45
    v_cvt_pk_bf16_f32 v95, v46, v47
    s_add_u32 s95, s94, 98304
    buffer_store_dwordx4 v[92:95], v12, s[52:55], s95 offen sc1
    s_waitcnt vmcnt(4)
    s_mov_b64 exec, 1
    ds_add_u32 v10, v11 offset:8
    s_mov_b64 exec, -1
    s_add_u32 m0, s34, 16384
    s_add_u32 s35, s45, 0
    buffer_load_dwordx4 v245, s[64:67], s35 offen lds
    v_add_u32 v224, 65536, v2
    v_add_u32 v225, 65536, v3
    v_add_u32 v226, 65536, v4
    v_add_u32 v227, 65536, v5
    s_add_u32 m0, s34, 20480
    s_add_u32 s35, s45, 65536
    buffer_load_dwordx4 v245, s[64:67], s35 offen lds
    v_add_u32 v228, 65536, v6
    v_add_u32 v229, 65536, v7
    v_add_u32 v230, 65536, v8
    s_add_u32 m0, s34, 24576
    s_add_u32 s35, s45, 131072
    buffer_load_dwordx4 v245, s[64:67], s35 offen lds
    v_add_u32 v231, 65536, v9
    v_add_u32 v15, 32768, v12
    v_add_u32 v232, 129024, v2
    v_add_u32 v233, 129024, v3
    s_add_u32 m0, s34, 28672
    s_add_u32 s35, s45, 196608
    buffer_load_dwordx4 v245, s[64:67], s35 offen lds
    v_add_u32 v234, 129024, v4
    v_add_u32 v235, 129024, v5
    v_add_u32 v236, 129024, v6
    s_add_u32 m0, s34, 32768
    s_add_u32 s35, s46, 0
    buffer_load_dwordx4 v245, s[64:67], s35 offen lds
    v_add_u32 v237, 129024, v7
    v_add_u32 v238, 129024, v8
    v_add_u32 v239, 129024, v9
    ds_read_b32 v223, v10 offset:8
    s_waitcnt vmcnt(5)
    s_mov_b64 exec, 1
    buffer_store_dword v11, v220, s[52:55], s97 offen sc1
    s_mov_b64 exec, -1
    s_waitcnt lgkmcnt(0)
    v_cmp_gt_u32 vcc, 4, v223
    s_cbranch_vccnz LB_w2
LB_g2:
    s_add_u32 m0, s34, 36864
    s_add_u32 s35, s46, 65536
    buffer_load_dwordx4 v245, s[64:67], s35 offen lds
    ds_read_b64_tr_b16 v[48:49], v2 offset:0
    s_add_u32 m0, s34, 40960
    s_add_u32 s35, s46, 131072
    buffer_load_dwordx4 v245, s[64:67], s35 offen lds
    ds_read_b64_tr_b16 v[50:51], v6 offset:0
    s_add_u32 m0, s34, 45056
    s_add_u32 s35, s46, 196608
    buffer_load_dwordx4 v245, s[64:67], s35 offen lds
    ds_read_b64_tr_b16 v[52:53], v2 offset:4096
    s_add_u32 m0, s34, 49152
    s_add_u32 s35, s47, 0
    buffer_load_dwordx4 v245, s[64:67], s35 offen lds
    ds_read_b64_tr_b16 v[54:55], v6 offset:4096
    s_add_u32 m0, s34, 53248
    s_add_u32 s35, s47, 65536
    buffer_load_dwordx4 v245, s[64:67], s35 offen lds
    ds_read_b64_tr_b16 v[56:57], v2 offset:8192
    s_add_u32 m0, s34, 57344
    s_add_u32 s35, s47, 131072
    buffer_load_dwordx4 v245, s[64:67], s35 offen lds
    ds_read_b64_tr_b16 v[58:59], v6 offset:8192
    s_add_u32 m0, s34, 61440
    s_add_u32 s35, s47, 196608
    buffer_load_dwordx4 v245, s[64:67], s35 offen lds
    ds_read_b64_tr_b16 v[60:61], v2 offset:12288
    s_add_u32 m0, s34, 65536
    s_add_u32 s35, s48, 0
    buffer_load_dwordx4 v245, s[64:67], s35 offen lds
    ds_read_b64_tr_b16 v[62:63], v6 offset:12288
    s_add_u32 m0, s34, 69632
    s_add_u32 s35, s48, 65536
    buffer_load_dwordx4 v245, s[64:67], s35 offen lds
    ds_read_b64_tr_b16 v[64:65], v3 offset:0
    s_add_u32 m0, s34, 73728
    s_add_u32 s35, s48, 131072
    buffer_load_dwordx4 v245, s[64:67], s35 offen lds
    ds_read_b64_tr_b16 v[66:67], v7 offset:0
    s_add_u32 m0, s34, 77824
    s_add_u32 s35, s48, 196608
    buffer_load_dwordx4 v245, s[64:67], s35 offen lds
    ds_read_b64_tr_b16 v[68:69], v3 offset:4096
    s_add_u32 m0, s34, 81920
    s_add_u32 s35, s49, 0
    buffer_load_dwordx4 v245, s[64:67], s35 offen lds
    ds_read_b64_tr_b16 v[70:71], v7 offset:4096
    s_add_u32 m0, s34, 86016
    s_add_u32 s35, s49, 65536
    buffer_load_dwordx4 v245, s[64:67], s35 offen lds
    ds_read_b64_tr_b16 v[72:73], v3 offset:8192
    s_add_u32 m0, s34, 110592
    s_add_u32 s35, s49, 131072
    buffer_load_dwordx4 v245, s[64:67], s35 offen lds
    ds_read_b64_tr_b16 v[74:75], v7 offset:8192
    s_add_u32 m0, s34, 114688
    s_add_u32 s35, s49, 196608
    buffer_load_dwordx4 v245, s[64:67], s35 offen lds
    ds_read_b64_tr_b16 v[76:77], v3 offset:12288
    s_add_u32 m0, s34, 118784
    s_add_u32 s35, s50, 0
    buffer_load_dwordx4 v245, s[64:67], s35 offen lds
    ds_read_b64_tr_b16 v[78:79], v7 offset:12288
    s_add_u32 m0, s34, 122880
    s_add_u32 s35, s50, 65536
    buffer_load_dwordx4 v245, s[64:67], s35 offen lds
    s_waitcnt vmcnt(0)
    s_mov_b64 exec, 1
    ds_add_u32 v10, v11 offset:16
    s_mov_b64 exec, -1
    s_mov_b64 exec, 0xffffffff
    s_mov_b32 s79, 0
LB_po:
    buffer_load_dword v14, v247, s[52:55], s30 offen sc1
    s_add_u32 s79, s79, 1
    s_cmp_gt_u32 s79, 200000
    s_cbranch_scc1 LB_po_x
    s_waitcnt vmcnt(0)
    v_cmp_ne_u32 vcc, 1, v14
    s_cbranch_vccz LB_po_x
    s_mov_b64 exec, vcc
    s_sleep 4
    s_branch LB_po
LB_po_x:
    s_waitcnt vmcnt(0)
    s_mov_b64 exec, -1
    ds_read_b32 v222, v10 offset:16
    buffer_load_dwordx4 v[96:99], v12, s[52:55], s36 offen offset:0 sc1
    buffer_load_dwordx4 v[100:103], v12, s[52:55], s36 offen offset:1024 sc1
    buffer_load_dwordx4 v[104:107], v12, s[52:55], s36 offen offset:2048 sc1
    buffer_load_dwordx4 v[108:111], v12, s[52:55], s36 offen offset:3072 sc1
    buffer_load_dwordx4 v[112:115], v15, s[52:55], s36 offen offset:0 sc1
    buffer_load_dwordx4 v[116:119], v15, s[52:55], s36 offen offset:1024 sc1
    buffer_load_dwordx4 v[120:123], v15, s[52:55], s36 offen offset:2048 sc1
    buffer_load_dwordx4 v[124:127], v15, s[52:55], s36 offen offset:3072 sc1
    buffer_load_dwordx4 v[128:131], v12, s[52:55], s37 offen offset:0 sc1
    buffer_load_dwordx4 v[132:135], v12, s[52:55], s37 offen offset:1024 sc1
    s_setprio 1
    s_waitcnt lgkmcnt(0)
    v_cmp_gt_u32 vcc, 4, v222
    s_cbranch_vccnz LB_w4
LB_g4:
    s_waitcnt vmcnt(9)
    v_mfma_f32_16x16x32_bf16 v[16:19], v[48:51], v[96:99], 0
    buffer_load_dwordx4 v[136:139], v12, s[52:55], s37 offen offset:2048 sc1
    buffer_load_dwordx4 v[140:143], v12, s[52:55], s37 offen offset:3072 sc1
    s_waitcnt vmcnt(10)
    v_mfma_f32_16x16x32_bf16 v[16:19], v[52:55], v[100:103], v[16:19]
    buffer_load_dwordx4 v[144:147], v15, s[52:55], s37 offen offset:0 sc1
    s_waitcnt vmcnt(10)
    v_mfma_f32_16x16x32_bf16 v[16:19], v[56:59], v[104:107], v[16:19]
    buffer_load_dwordx4 v[148:151], v15, s[52:55], s37 offen offset:1024 sc1
    ds_read_b64_tr_b16 v[80:81], v4 offset:0
    s_waitcnt vmcnt(10)
    v_mfma_f32_16x16x32_bf16 v[16:19], v[60:63], v[108:111], v[16:19]
    ds_read_b64_tr_b16 v[82:83], v8 offset:0
    s_waitcnt vmcnt(6)
    v_mfma_f32_16x16x32_bf16 v[32:35], v[60:63], v[124:127], 0
    ds_read_b64_tr_b16 v[84:85], v4 offset:4096
    ds_read_b64_tr_b16 v[86:87], v8 offset:4096
    v_mfma_f32_16x16x32_bf16 v[32:35], v[56:59], v[120:123], v[32:35]
    ds_read_b64_tr_b16 v[88:89], v4 offset:8192
    v_mfma_f32_16x16x32_bf16 v[32:35], v[52:55], v[116:119], v[32:35]
    ds_read_b64_tr_b16 v[90:91], v8 offset:8192
    ds_read_b64_tr_b16 v[92:93], v4 offset:12288
    v_mfma_f32_16x16x32_bf16 v[32:35], v[48:51], v[112:115], v[32:35]
    ds_read_b64_tr_b16 v[94:95], v8 offset:12288
    v_mfma_f32_16x16x32_bf16 v[36:39], v[64:67], v[112:115], 0
    buffer_load_dwordx4 v[152:155], v15, s[52:55], s37 offen offset:2048 sc1
    buffer_load_dwordx4 v[156:159], v15, s[52:55], s37 offen offset:3072 sc1
    v_mfma_f32_16x16x32_bf16 v[36:39], v[68:71], v[116:119], v[36:39]
    buffer_load_dwordx4 v[160:163], v12, s[52:55], s38 offen offset:0 sc1
    v_mfma_f32_16x16x32_bf16 v[36:39], v[72:75], v[120:123], v[36:39]
    buffer_load_dwordx4 v[164:167], v12, s[52:55], s38 offen offset:1024 sc1
    ds_read_b64_tr_b16 v[48:49], v5 offset:0
    v_mfma_f32_16x16x32_bf16 v[36:39], v[76:79], v[124:127], v[36:39]
    ds_read_b64_tr_b16 v[50:51], v9 offset:0
    v_mfma_f32_16x16x32_bf16 v[20:23], v[76:79], v[108:111], 0
    ds_read_b64_tr_b16 v[52:53], v5 offset:4096
    ds_read_b64_tr_b16 v[54:55], v9 offset:4096
    v_mfma_f32_16x16x32_bf16 v[20:23], v[72:75], v[104:107], v[20:23]
    ds_read_b64_tr_b16 v[56:57], v5 offset:8192
    v_mfma_f32_16x16x32_bf16 v[20:23], v[68:71], v[100:103], v[20:23]
    ds_read_b64_tr_b16 v[58:59], v9 offset:8192
    ds_read_b64_tr_b16 v[60:61], v5 offset:12288
    v_mfma_f32_16x16x32_bf16 v[20:23], v[64:67], v[96:99], v[20:23]
    ds_read_b64_tr_b16 v[62:63], v9 offset:12288
    s_waitcnt lgkmcnt(14)
    v_mfma_f32_16x16x32_bf16 v[24:27], v[80:83], v[96:99], 0
    buffer_load_dwordx4 v[168:171], v12, s[52:55], s38 offen offset:2048 sc1
    buffer_load_dwordx4 v[172:175], v12, s[52:55], s38 offen offset:3072 sc1
    s_waitcnt lgkmcnt(12)
    v_mfma_f32_16x16x32_bf16 v[24:27], v[84:87], v[100:103], v[24:27]
    buffer_load_dwordx4 v[176:179], v15, s[52:55], s38 offen offset:0 sc1
    s_waitcnt lgkmcnt(10)
    v_mfma_f32_16x16x32_bf16 v[24:27], v[88:91], v[104:107], v[24:27]
    buffer_load_dwordx4 v[180:183], v15, s[52:55], s38 offen offset:1024 sc1
    ds_read_b64_tr_b16 v[64:65], v2 offset:16384
    s_waitcnt lgkmcnt(9)
    v_mfma_f32_16x16x32_bf16 v[24:27], v[92:95], v[108:111], v[24:27]
    ds_read_b64_tr_b16 v[66:67], v6 offset:16384
    v_mfma_f32_16x16x32_bf16 v[40:43], v[92:95], v[124:127], 0
    ds_read_b64_tr_b16 v[68:69], v2 offset:20480
    ds_read_b64_tr_b16 v[70:71], v6 offset:20480
    v_mfma_f32_16x16x32_bf16 v[40:43], v[88:91], v[120:123], v[40:43]
    ds_read_b64_tr_b16 v[72:73], v2 offset:24576
    v_mfma_f32_16x16x32_bf16 v[40:43], v[84:87], v[116:119], v[40:43]
    ds_read_b64_tr_b16 v[74:75], v6 offset:24576
    ds_read_b64_tr_b16 v[76:77], v2 offset:28672
    v_mfma_f32_16x16x32_bf16 v[40:43], v[80:83], v[112:115], v[40:43]
    ds_read_b64_tr_b16 v[78:79], v6 offset:28672
    s_waitcnt lgkmcnt(14)
    v_mfma_f32_16x16x32_bf16 v[44:47], v[48:51], v[112:115], 0
    buffer_load_dwordx4 v[184:187], v15, s[52:55], s38 offen offset:2048 sc1
    buffer_load_dwordx4 v[188:191], v15, s[52:55], s38 offen offset:3072 sc1
    s_waitcnt lgkmcnt(12)
    v_mfma_f32_16x16x32_bf16 v[44:47], v[52:55], v[116:119], v[44:47]
    ds_read_b64_tr_b16 v[80:81], v3 offset:16384
    s_waitcnt lgkmcnt(11)
    v_mfma_f32_16x16x32_bf16 v[44:47], v[56:59], v[120:123], v[44:47]
    ds_read_b64_tr_b16 v[82:83], v7 offset:16384
    s_waitcnt lgkmcnt(10)
    v_mfma_f32_16x16x32_bf16 v[44:47], v[60:63], v[124:127], v[44:47]
    ds_read_b64_tr_b16 v[84:85], v3 offset:20480
    v_mfma_f32_16x16x32_bf16 v[28:31], v[60:63], v[108:111], 0
    ds_read_b64_tr_b16 v[86:87], v7 offset:20480
    ds_read_b64_tr_b16 v[88:89], v3 offset:24576
    v_mfma_f32_16x16x32_bf16 v[28:31], v[56:59], v[104:107], v[28:31]
    ds_read_b64_tr_b16 v[90:91], v7 offset:24576
    v_mfma_f32_16x16x32_bf16 v[28:31], v[52:55], v[100:103], v[28:31]
    ds_read_b64_tr_b16 v[92:93], v3 offset:28672
    v_mfma_f32_16x16x32_bf16 v[28:31], v[48:51], v[96:99], v[28:31]
    ds_read_b64_tr_b16 v[94:95], v7 offset:28672
    s_waitcnt vmcnt(8) lgkmcnt(8)
    v_mfma_f32_16x16x32_bf16 v[16:19], v[64:67], v[128:131], v[16:19]
    buffer_load_dwordx4 v[96:99], v12, s[52:55], s39 offen offset:0 sc1
    buffer_load_dwordx4 v[100:103], v12, s[52:55], s39 offen offset:1024 sc1
    v_mfma_f32_16x16x32_bf16 v[16:19], v[68:71], v[132:135], v[16:19]
    buffer_load_dwordx4 v[104:107], v12, s[52:55], s39 offen offset:2048 sc1
    v_mfma_f32_16x16x32_bf16 v[16:19], v[72:75], v[136:139], v[16:19]
    buffer_load_dwordx4 v[108:111], v12, s[52:55], s39 offen offset:3072 sc1
    ds_read_b64_tr_b16 v[48:49], v4 offset:16384
    v_mfma_f32_16x16x32_bf16 v[16:19], v[76:79], v[140:143], v[16:19]
    ds_read_b64_tr_b16 v[50:51], v8 offset:16384
    v_mfma_f32_16x16x32_bf16 v[32:35], v[76:79], v[156:159], v[32:35]
    ds_read_b64_tr_b16 v[52:53], v4 offset:20480
    ds_read_b64_tr_b16 v[54:55], v8 offset:20480
    v_mfma_f32_16x16x32_bf16 v[32:35], v[72:75], v[152:155], v[32:35]
    ds_read_b64_tr_b16 v[56:57], v4 offset:24576
    v_mfma_f32_16x16x32_bf16 v[32:35], v[68:71], v[148:151], v[32:35]
    ds_read_b64_tr_b16 v[58:59], v8 offset:24576
    ds_read_b64_tr_b16 v[60:61], v4 offset:28672
    v_mfma_f32_16x16x32_bf16 v[32:35], v[64:67], v[144:147], v[32:35]
    ds_read_b64_tr_b16 v[62:63], v8 offset:28672
    s_waitcnt lgkmcnt(8)
    v_mfma_f32_16x16x32_bf16 v[36:39], v[80:83], v[144:147], v[36:39]
    buffer_load_dwordx4 v[112:115], v15, s[52:55], s39 offen offset:0 sc1
    buffer_load_dwordx4 v[116:119], v15, s[52:55], s39 offen offset:1024 sc1
    v_mfma_f32_16x16x32_bf16 v[36:39], v[84:87], v[148:151], v[36:39]
    ds_read_b64_tr_b16 v[64:65], v5 offset:16384
    v_mfma_f32_16x16x32_bf16 v[36:39], v[88:91], v[152:155], v[36:39]
    ds_read_b64_tr_b16 v[66:67], v9 offset:16384
    v_mfma_f32_16x16x32_bf16 v[36:39], v[92:95], v[156:159], v[36:39]
    ds_read_b64_tr_b16 v[68:69], v5 offset:20480
    v_mfma_f32_16x16x32_bf16 v[20:23], v[92:95], v[140:143], v[20:23]
    ds_read_b64_tr_b16 v[70:71], v9 offset:20480
    ds_read_b64_tr_b16 v[72:73], v5 offset:24576
    v_mfma_f32_16x16x32_bf16 v[20:23], v[88:91], v[136:139], v[20:23]
    ds_read_b64_tr_b16 v[74:75], v9 offset:24576
    v_mfma_f32_16x16x32_bf16 v[20:23], v[84:87], v[132:135], v[20:23]
    ds_read_b64_tr_b16 v[76:77], v5 offset:28672
    v_mfma_f32_16x16x32_bf16 v[20:23], v[80:83], v[128:131], v[20:23]
    ds_read_b64_tr_b16 v[78:79], v9 offset:28672
    s_waitcnt lgkmcnt(8)
    v_mfma_f32_16x16x32_bf16 v[24:27], v[48:51], v[128:131], v[24:27]
    buffer_load_dwordx4 v[120:123], v15, s[52:55], s39 offen offset:2048 sc1
    buffer_load_dwordx4 v[124:127], v15, s[52:55], s39 offen offset:3072 sc1
    v_mfma_f32_16x16x32_bf16 v[24:27], v[52:55], v[132:135], v[24:27]
    ds_read_b64_tr_b16 v[80:81], v2 offset:32768
    v_mfma_f32_16x16x32_bf16 v[24:27], v[56:59], v[136:139], v[24:27]
    ds_read_b64_tr_b16 v[82:83], v6 offset:32768
    v_mfma_f32_16x16x32_bf16 v[24:27], v[60:63], v[140:143], v[24:27]
    ds_read_b64_tr_b16 v[84:85], v2 offset:36864
    v_mfma_f32_16x16x32_bf16 v[40:43], v[60:63], v[156:159], v[40:43]
    ds_read_b64_tr_b16 v[86:87], v6 offset:36864
    ds_read_b64_tr_b16 v[88:89], v2 offset:40960
    v_mfma_f32_16x16x32_bf16 v[40:43], v[56:59], v[152:155], v[40:43]
    ds_read_b64_tr_b16 v[90:91], v6 offset:40960
    v_mfma_f32_16x16x32_bf16 v[40:43], v[52:55], v[148:151], v[40:43]
    ds_read_b64_tr_b16 v[92:93], v2 offset:45056
    v_mfma_f32_16x16x32_bf16 v[40:43], v[48:51], v[144:147], v[40:43]
    ds_read_b64_tr_b16 v[94:95], v6 offset:45056
    s_waitcnt lgkmcnt(8)
    v_mfma_f32_16x16x32_bf16 v[44:47], v[64:67], v[144:147], v[44:47]
    ds_read_b64_tr_b16 v[48:49], v3 offset:32768
    v_mfma_f32_16x16x32_bf16 v[44:47], v[68:71], v[148:151], v[44:47]
    ds_read_b64_tr_b16 v[50:51], v7 offset:32768
    v_mfma_f32_16x16x32_bf16 v[44:47], v[72:75], v[152:155], v[44:47]
    ds_read_b64_tr_b16 v[52:53], v3 offset:36864
    v_mfma_f32_16x16x32_bf16 v[44:47], v[76:79], v[156:159], v[44:47]
    ds_read_b64_tr_b16 v[54:55], v7 offset:36864
    v_mfma_f32_16x16x32_bf16 v[28:31], v[76:79], v[140:143], v[28:31]
    ds_read_b64_tr_b16 v[56:57], v3 offset:40960
    v_mfma_f32_16x16x32_bf16 v[28:31], v[72:75], v[136:139], v[28:31]
    ds_read_b64_tr_b16 v[58:59], v7 offset:40960
    v_mfma_f32_16x16x32_bf16 v[28:31], v[68:71], v[132:135], v[28:31]
    ds_read_b64_tr_b16 v[60:61], v3 offset:45056
    v_mfma_f32_16x16x32_bf16 v[28:31], v[64:67], v[128:131], v[28:31]
    ds_read_b64_tr_b16 v[62:63], v7 offset:45056
    s_waitcnt vmcnt(8) lgkmcnt(8)
    v_mfma_f32_16x16x32_bf16 v[16:19], v[80:83], v[160:163], v[16:19]
    buffer_load_dwordx4 v[128:131], v12, s[52:55], s40 offen offset:0 sc1
    buffer_load_dwordx4 v[132:135], v12, s[52:55], s40 offen offset:1024 sc1
    v_mfma_f32_16x16x32_bf16 v[16:19], v[84:87], v[164:167], v[16:19]
    buffer_load_dwordx4 v[136:139], v12, s[52:55], s40 offen offset:2048 sc1
    v_mfma_f32_16x16x32_bf16 v[16:19], v[88:91], v[168:171], v[16:19]
    buffer_load_dwordx4 v[140:143], v12, s[52:55], s40 offen offset:3072 sc1
    ds_read_b64_tr_b16 v[64:65], v4 offset:32768
    v_mfma_f32_16x16x32_bf16 v[16:19], v[92:95], v[172:175], v[16:19]
    ds_read_b64_tr_b16 v[66:67], v8 offset:32768
    v_mfma_f32_16x16x32_bf16 v[32:35], v[92:95], v[188:191], v[32:35]
    ds_read_b64_tr_b16 v[68:69], v4 offset:36864
    ds_read_b64_tr_b16 v[70:71], v8 offset:36864
    v_mfma_f32_16x16x32_bf16 v[32:35], v[88:91], v[184:187], v[32:35]
    ds_read_b64_tr_b16 v[72:73], v4 offset:40960
    v_mfma_f32_16x16x32_bf16 v[32:35], v[84:87], v[180:183], v[32:35]
    ds_read_b64_tr_b16 v[74:75], v8 offset:40960
    ds_read_b64_tr_b16 v[76:77], v4 offset:45056
    v_mfma_f32_16x16x32_bf16 v[32:35], v[80:83], v[176:179], v[32:35]
    ds_read_b64_tr_b16 v[78:79], v8 offset:45056
    s_waitcnt lgkmcnt(8)
    v_mfma_f32_16x16x32_bf16 v[36:39], v[48:51], v[176:179], v[36:39]
    buffer_load_dwordx4 v[144:147], v15, s[52:55], s40 offen offset:0 sc1
    buffer_load_dwordx4 v[148:151], v15, s[52:55], s40 offen offset:1024 sc1
    v_mfma_f32_16x16x32_bf16 v[36:39], v[52:55], v[180:183], v[36:39]
    ds_read_b64_tr_b16 v[80:81], v5 offset:32768
    v_mfma_f32_16x16x32_bf16 v[36:39], v[56:59], v[184:187], v[36:39]
    ds_read_b64_tr_b16 v[82:83], v9 offset:32768
    v_mfma_f32_16x16x32_bf16 v[36:39], v[60:63], v[188:191], v[36:39]
    ds_read_b64_tr_b16 v[84:85], v5 offset:36864
    v_mfma_f32_16x16x32_bf16 v[20:23], v[60:63], v[172:175], v[20:23]
    ds_read_b64_tr_b16 v[86:87], v9 offset:36864
    ds_read_b64_tr_b16 v[88:89], v5 offset:40960
    v_mfma_f32_16x16x32_bf16 v[20:23], v[56:59], v[168:171], v[20:23]
    ds_read_b64_tr_b16 v[90:91], v9 offset:40960
    v_mfma_f32_16x16x32_bf16 v[20:23], v[52:55], v[164:167], v[20:23]
    ds_read_b64_tr_b16 v[92:93], v5 offset:45056
    v_mfma_f32_16x16x32_bf16 v[20:23], v[48:51], v[160:163], v[20:23]
    ds_read_b64_tr_b16 v[94:95], v9 offset:45056
    s_waitcnt lgkmcnt(8)
    v_mfma_f32_16x16x32_bf16 v[24:27], v[64:67], v[160:163], v[24:27]
    buffer_load_dwordx4 v[152:155], v15, s[52:55], s40 offen offset:2048 sc1
    buffer_load_dwordx4 v[156:159], v15, s[52:55], s40 offen offset:3072 sc1
    v_mfma_f32_16x16x32_bf16 v[24:27], v[68:71], v[164:167], v[24:27]
    ds_read_b64_tr_b16 v[48:49], v2 offset:49152
    v_mfma_f32_16x16x32_bf16 v[24:27], v[72:75], v[168:171], v[24:27]
    ds_read_b64_tr_b16 v[50:51], v6 offset:49152
    v_mfma_f32_16x16x32_bf16 v[24:27], v[76:79], v[172:175], v[24:27]
    ds_read_b64_tr_b16 v[52:53], v2 offset:53248
    v_mfma_f32_16x16x32_bf16 v[40:43], v[76:79], v[188:191], v[40:43]
    ds_read_b64_tr_b16 v[54:55], v6 offset:53248
    ds_read_b64_tr_b16 v[56:57], v2 offset:57344
    v_mfma_f32_16x16x32_bf16 v[40:43], v[72:75], v[184:187], v[40:43]
    ds_read_b64_tr_b16 v[58:59], v6 offset:57344
    v_mfma_f32_16x16x32_bf16 v[40:43], v[68:71], v[180:183], v[40:43]
    ds_read_b64_tr_b16 v[60:61], v2 offset:61440
    v_mfma_f32_16x16x32_bf16 v[40:43], v[64:67], v[176:179], v[40:43]
    ds_read_b64_tr_b16 v[62:63], v6 offset:61440
    s_waitcnt lgkmcnt(8)
    v_mfma_f32_16x16x32_bf16 v[44:47], v[80:83], v[176:179], v[44:47]
    ds_read_b64_tr_b16 v[64:65], v3 offset:49152
    v_mfma_f32_16x16x32_bf16 v[44:47], v[84:87], v[180:183], v[44:47]
    ds_read_b64_tr_b16 v[66:67], v7 offset:49152
    v_mfma_f32_16x16x32_bf16 v[44:47], v[88:91], v[184:187], v[44:47]
    ds_read_b64_tr_b16 v[68:69], v3 offset:53248
    v_mfma_f32_16x16x32_bf16 v[44:47], v[92:95], v[188:191], v[44:47]
    ds_read_b64_tr_b16 v[70:71], v7 offset:53248
    v_mfma_f32_16x16x32_bf16 v[28:31], v[92:95], v[172:175], v[28:31]
    ds_read_b64_tr_b16 v[72:73], v3 offset:57344
    v_mfma_f32_16x16x32_bf16 v[28:31], v[88:91], v[168:171], v[28:31]
    ds_read_b64_tr_b16 v[74:75], v7 offset:57344
    v_mfma_f32_16x16x32_bf16 v[28:31], v[84:87], v[164:167], v[28:31]
    ds_read_b64_tr_b16 v[76:77], v3 offset:61440
    v_mfma_f32_16x16x32_bf16 v[28:31], v[80:83], v[160:163], v[28:31]
    ds_read_b64_tr_b16 v[78:79], v7 offset:61440
    s_waitcnt vmcnt(8) lgkmcnt(8)
    v_mfma_f32_16x16x32_bf16 v[16:19], v[48:51], v[96:99], v[16:19]
    buffer_load_dwordx4 v[160:163], v12, s[52:55], s41 offen offset:0 sc1
    buffer_load_dwordx4 v[164:167], v12, s[52:55], s41 offen offset:1024 sc1
    v_mfma_f32_16x16x32_bf16 v[16:19], v[52:55], v[100:103], v[16:19]
    buffer_load_dwordx4 v[168:171], v12, s[52:55], s41 offen offset:2048 sc1
    v_mfma_f32_16x16x32_bf16 v[16:19], v[56:59], v[104:107], v[16:19]
    buffer_load_dwordx4 v[172:175], v12, s[52:55], s41 offen offset:3072 sc1
    ds_read_b64_tr_b16 v[80:81], v4 offset:49152
    v_mfma_f32_16x16x32_bf16 v[16:19], v[60:63], v[108:111], v[16:19]
    ds_read_b64_tr_b16 v[82:83], v8 offset:49152
    v_mfma_f32_16x16x32_bf16 v[32:35], v[60:63], v[124:127], v[32:35]
    ds_read_b64_tr_b16 v[84:85], v4 offset:53248
    ds_read_b64_tr_b16 v[86:87], v8 offset:53248
    v_mfma_f32_16x16x32_bf16 v[32:35], v[56:59], v[120:123], v[32:35]
    ds_read_b64_tr_b16 v[88:89], v4 offset:57344
    v_mfma_f32_16x16x32_bf16 v[32:35], v[52:55], v[116:119], v[32:35]
    ds_read_b64_tr_b16 v[90:91], v8 offset:57344
    ds_read_b64_tr_b16 v[92:93], v4 offset:61440
    v_mfma_f32_16x16x32_bf16 v[32:35], v[48:51], v[112:115], v[32:35]
    ds_read_b64_tr_b16 v[94:95], v8 offset:61440
    s_waitcnt lgkmcnt(8)
    v_mfma_f32_16x16x32_bf16 v[36:39], v[64:67], v[112:115], v[36:39]
    buffer_load_dwordx4 v[176:179], v15, s[52:55], s41 offen offset:0 sc1
    buffer_load_dwordx4 v[180:183], v15, s[52:55], s41 offen offset:1024 sc1
    v_mfma_f32_16x16x32_bf16 v[36:39], v[68:71], v[116:119], v[36:39]
    ds_read_b64_tr_b16 v[48:49], v5 offset:49152
    v_mfma_f32_16x16x32_bf16 v[36:39], v[72:75], v[120:123], v[36:39]
    ds_read_b64_tr_b16 v[50:51], v9 offset:49152
    v_mfma_f32_16x16x32_bf16 v[36:39], v[76:79], v[124:127], v[36:39]
    ds_read_b64_tr_b16 v[52:53], v5 offset:53248
    v_mfma_f32_16x16x32_bf16 v[20:23], v[76:79], v[108:111], v[20:23]
    ds_read_b64_tr_b16 v[54:55], v9 offset:53248
    ds_read_b64_tr_b16 v[56:57], v5 offset:57344
    v_mfma_f32_16x16x32_bf16 v[20:23], v[72:75], v[104:107], v[20:23]
    ds_read_b64_tr_b16 v[58:59], v9 offset:57344
    v_mfma_f32_16x16x32_bf16 v[20:23], v[68:71], v[100:103], v[20:23]
    ds_read_b64_tr_b16 v[60:61], v5 offset:61440
    v_mfma_f32_16x16x32_bf16 v[20:23], v[64:67], v[96:99], v[20:23]
    ds_read_b64_tr_b16 v[62:63], v9 offset:61440
    s_mov_b64 exec, 1
    ds_add_u32 v10, v11 offset:28
    s_mov_b64 exec, -1
    s_waitcnt lgkmcnt(9)
    v_mfma_f32_16x16x32_bf16 v[24:27], v[80:83], v[96:99], v[24:27]
    buffer_load_dwordx4 v[184:187], v15, s[52:55], s41 offen offset:2048 sc1
    buffer_load_dwordx4 v[188:191], v15, s[52:55], s41 offen offset:3072 sc1
    v_mfma_f32_16x16x32_bf16 v[24:27], v[84:87], v[100:103], v[24:27]
    ds_read_b64_tr_b16 v[64:65], v224 offset:0
    v_mfma_f32_16x16x32_bf16 v[24:27], v[88:91], v[104:107], v[24:27]
    ds_read_b64_tr_b16 v[66:67], v228 offset:0
    v_mfma_f32_16x16x32_bf16 v[24:27], v[92:95], v[108:111], v[24:27]
    ds_read_b64_tr_b16 v[68:69], v224 offset:4096
    v_mfma_f32_16x16x32_bf16 v[40:43], v[92:95], v[124:127], v[40:43]
    ds_read_b64_tr_b16 v[70:71], v228 offset:4096
    ds_read_b64_tr_b16 v[72:73], v224 offset:8192
    v_mfma_f32_16x16x32_bf16 v[40:43], v[88:91], v[120:123], v[40:43]
    ds_read_b64_tr_b16 v[74:75], v228 offset:8192
    v_mfma_f32_16x16x32_bf16 v[40:43], v[84:87], v[116:119], v[40:43]
    ds_read_b64_tr_b16 v[76:77], v224 offset:12288
    v_mfma_f32_16x16x32_bf16 v[40:43], v[80:83], v[112:115], v[40:43]
    ds_read_b64_tr_b16 v[78:79], v228 offset:12288
    s_waitcnt lgkmcnt(9)
    v_mfma_f32_16x16x32_bf16 v[44:47], v[48:51], v[112:115], v[44:47]
    ds_read_b64_tr_b16 v[80:81], v225 offset:0
    v_mfma_f32_16x16x32_bf16 v[44:47], v[52:55], v[116:119], v[44:47]
    ds_read_b64_tr_b16 v[82:83], v229 offset:0
    v_mfma_f32_16x16x32_bf16 v[44:47], v[56:59], v[120:123], v[44:47]
    ds_read_b64_tr_b16 v[84:85], v225 offset:4096
    v_mfma_f32_16x16x32_bf16 v[44:47], v[60:63], v[124:127], v[44:47]
    ds_read_b64_tr_b16 v[86:87], v229 offset:4096
    v_mfma_f32_16x16x32_bf16 v[28:31], v[60:63], v[108:111], v[28:31]
    ds_read_b64_tr_b16 v[88:89], v225 offset:8192
    v_mfma_f32_16x16x32_bf16 v[28:31], v[56:59], v[104:107], v[28:31]
    ds_read_b64_tr_b16 v[90:91], v229 offset:8192
    v_mfma_f32_16x16x32_bf16 v[28:31], v[52:55], v[100:103], v[28:31]
    ds_read_b64_tr_b16 v[92:93], v225 offset:12288
    v_mfma_f32_16x16x32_bf16 v[28:31], v[48:51], v[96:99], v[28:31]
    ds_read_b64_tr_b16 v[94:95], v229 offset:12288
    s_waitcnt vmcnt(8) lgkmcnt(8)
    v_mfma_f32_16x16x32_bf16 v[16:19], v[64:67], v[128:131], v[16:19]
    buffer_load_dwordx4 v[96:99], v12, s[52:55], s42 offen offset:0 sc1
    buffer_load_dwordx4 v[100:103], v12, s[52:55], s42 offen offset:1024 sc1
    v_mfma_f32_16x16x32_bf16 v[16:19], v[68:71], v[132:135], v[16:19]
    buffer_load_dwordx4 v[104:107], v12, s[52:55], s42 offen offset:2048 sc1
    v_mfma_f32_16x16x32_bf16 v[16:19], v[72:75], v[136:139], v[16:19]
    buffer_load_dwordx4 v[108:111], v12, s[52:55], s42 offen offset:3072 sc1
    ds_read_b64_tr_b16 v[48:49], v226 offset:0
    v_mfma_f32_16x16x32_bf16 v[16:19], v[76:79], v[140:143], v[16:19]
    ds_read_b64_tr_b16 v[50:51], v230 offset:0
    v_mfma_f32_16x16x32_bf16 v[32:35], v[76:79], v[156:159], v[32:35]
    ds_read_b64_tr_b16 v[52:53], v226 offset:4096
    ds_read_b64_tr_b16 v[54:55], v230 offset:4096
    v_mfma_f32_16x16x32_bf16 v[32:35], v[72:75], v[152:155], v[32:35]
    ds_read_b64_tr_b16 v[56:57], v226 offset:8192
    v_mfma_f32_16x16x32_bf16 v[32:35], v[68:71], v[148:151], v[32:35]
    ds_read_b64_tr_b16 v[58:59], v230 offset:8192
    ds_read_b64_tr_b16 v[60:61], v226 offset:12288
    v_mfma_f32_16x16x32_bf16 v[32:35], v[64:67], v[144:147], v[32:35]
    ds_read_b64_tr_b16 v[62:63], v230 offset:12288
    s_waitcnt lgkmcnt(8)
    v_mfma_f32_16x16x32_bf16 v[36:39], v[80:83], v[144:147], v[36:39]
    buffer_load_dwordx4 v[112:115], v15, s[52:55], s42 offen offset:0 sc1
    buffer_load_dwordx4 v[116:119], v15, s[52:55], s42 offen offset:1024 sc1
    v_mfma_f32_16x16x32_bf16 v[36:39], v[84:87], v[148:151], v[36:39]
    ds_read_b64_tr_b16 v[64:65], v227 offset:0
    v_mfma_f32_16x16x32_bf16 v[36:39], v[88:91], v[152:155], v[36:39]
    ds_read_b64_tr_b16 v[66:67], v231 offset:0
    v_mfma_f32_16x16x32_bf16 v[36:39], v[92:95], v[156:159], v[36:39]
    ds_read_b64_tr_b16 v[68:69], v227 offset:4096
    v_mfma_f32_16x16x32_bf16 v[20:23], v[92:95], v[140:143], v[20:23]
    ds_read_b64_tr_b16 v[70:71], v231 offset:4096
    ds_read_b64_tr_b16 v[72:73], v227 offset:8192
    v_mfma_f32_16x16x32_bf16 v[20:23], v[88:91], v[136:139], v[20:23]
    ds_read_b64_tr_b16 v[74:75], v231 offset:8192
    v_mfma_f32_16x16x32_bf16 v[20:23], v[84:87], v[132:135], v[20:23]
    ds_read_b64_tr_b16 v[76:77], v227 offset:12288
    v_mfma_f32_16x16x32_bf16 v[20:23], v[80:83], v[128:131], v[20:23]
    ds_read_b64_tr_b16 v[78:79], v231 offset:12288
    s_waitcnt lgkmcnt(8)
    v_mfma_f32_16x16x32_bf16 v[24:27], v[48:51], v[128:131], v[24:27]
    buffer_load_dwordx4 v[120:123], v15, s[52:55], s42 offen offset:2048 sc1
    buffer_load_dwordx4 v[124:127], v15, s[52:55], s42 offen offset:3072 sc1
    v_mfma_f32_16x16x32_bf16 v[24:27], v[52:55], v[132:135], v[24:27]
    ds_read_b64_tr_b16 v[80:81], v224 offset:16384
    v_mfma_f32_16x16x32_bf16 v[24:27], v[56:59], v[136:139], v[24:27]
    ds_read_b64_tr_b16 v[82:83], v228 offset:16384
    v_mfma_f32_16x16x32_bf16 v[24:27], v[60:63], v[140:143], v[24:27]
    ds_read_b64_tr_b16 v[84:85], v224 offset:20480
    v_mfma_f32_16x16x32_bf16 v[40:43], v[60:63], v[156:159], v[40:43]
    ds_read_b64_tr_b16 v[86:87], v228 offset:20480
    ds_read_b64_tr_b16 v[88:89], v224 offset:45056
    v_mfma_f32_16x16x32_bf16 v[40:43], v[56:59], v[152:155], v[40:43]
    ds_read_b64_tr_b16 v[90:91], v228 offset:45056
    v_mfma_f32_16x16x32_bf16 v[40:43], v[52:55], v[148:151], v[40:43]
    ds_read_b64_tr_b16 v[92:93], v224 offset:49152
    v_mfma_f32_16x16x32_bf16 v[40:43], v[48:51], v[144:147], v[40:43]
    ds_read_b64_tr_b16 v[94:95], v228 offset:49152
    s_waitcnt lgkmcnt(8)
    v_mfma_f32_16x16x32_bf16 v[44:47], v[64:67], v[144:147], v[44:47]
    ds_read_b64_tr_b16 v[48:49], v225 offset:16384
    v_mfma_f32_16x16x32_bf16 v[44:47], v[68:71], v[148:151], v[44:47]
    ds_read_b64_tr_b16 v[50:51], v229 offset:16384
    v_mfma_f32_16x16x32_bf16 v[44:47], v[72:75], v[152:155], v[44:47]
    ds_read_b64_tr_b16 v[52:53], v225 offset:20480
    v_mfma_f32_16x16x32_bf16 v[44:47], v[76:79], v[156:159], v[44:47]
    ds_read_b64_tr_b16 v[54:55], v229 offset:20480
    v_mfma_f32_16x16x32_bf16 v[28:31], v[76:79], v[140:143], v[28:31]
    ds_read_b64_tr_b16 v[56:57], v225 offset:45056
    v_mfma_f32_16x16x32_bf16 v[28:31], v[72:75], v[136:139], v[28:31]
    ds_read_b64_tr_b16 v[58:59], v229 offset:45056
    v_mfma_f32_16x16x32_bf16 v[28:31], v[68:71], v[132:135], v[28:31]
    ds_read_b64_tr_b16 v[60:61], v225 offset:49152
    v_mfma_f32_16x16x32_bf16 v[28:31], v[64:67], v[128:131], v[28:31]
    ds_read_b64_tr_b16 v[62:63], v229 offset:49152
    s_waitcnt vmcnt(8) lgkmcnt(8)
    v_mfma_f32_16x16x32_bf16 v[16:19], v[80:83], v[160:163], v[16:19]
    buffer_load_dwordx4 v[128:131], v12, s[52:55], s43 offen offset:0 sc1
    buffer_load_dwordx4 v[132:135], v12, s[52:55], s43 offen offset:1024 sc1
    v_mfma_f32_16x16x32_bf16 v[16:19], v[84:87], v[164:167], v[16:19]
    buffer_load_dwordx4 v[136:139], v12, s[52:55], s43 offen offset:2048 sc1
    v_mfma_f32_16x16x32_bf16 v[16:19], v[88:91], v[168:171], v[16:19]
    buffer_load_dwordx4 v[140:143], v12, s[52:55], s43 offen offset:3072 sc1
    ds_read_b64_tr_b16 v[64:65], v226 offset:16384
    v_mfma_f32_16x16x32_bf16 v[16:19], v[92:95], v[172:175], v[16:19]
    ds_read_b64_tr_b16 v[66:67], v230 offset:16384
    v_mfma_f32_16x16x32_bf16 v[32:35], v[92:95], v[188:191], v[32:35]
    ds_read_b64_tr_b16 v[68:69], v226 offset:20480
    ds_read_b64_tr_b16 v[70:71], v230 offset:20480
    v_mfma_f32_16x16x32_bf16 v[32:35], v[88:91], v[184:187], v[32:35]
    ds_read_b64_tr_b16 v[72:73], v226 offset:45056
    v_mfma_f32_16x16x32_bf16 v[32:35], v[84:87], v[180:183], v[32:35]
    ds_read_b64_tr_b16 v[74:75], v230 offset:45056
    ds_read_b64_tr_b16 v[76:77], v226 offset:49152
    v_mfma_f32_16x16x32_bf16 v[32:35], v[80:83], v[176:179], v[32:35]
    ds_read_b64_tr_b16 v[78:79], v230 offset:49152
    s_waitcnt lgkmcnt(8)
    v_mfma_f32_16x16x32_bf16 v[36:39], v[48:51], v[176:179], v[36:39]
    buffer_load_dwordx4 v[144:147], v15, s[52:55], s43 offen offset:0 sc1
    buffer_load_dwordx4 v[148:151], v15, s[52:55], s43 offen offset:1024 sc1
    v_mfma_f32_16x16x32_bf16 v[36:39], v[52:55], v[180:183], v[36:39]
    ds_read_b32 v223, v10 offset:32
    v_mfma_f32_16x16x32_bf16 v[36:39], v[56:59], v[184:187], v[36:39]
    ds_read_b64_tr_b16 v[80:81], v227 offset:16384
    ds_read_b64_tr_b16 v[82:83], v231 offset:16384
    v_mfma_f32_16x16x32_bf16 v[36:39], v[60:63], v[188:191], v[36:39]
    ds_read_b64_tr_b16 v[84:85], v227 offset:20480
    v_mfma_f32_16x16x32_bf16 v[20:23], v[60:63], v[172:175], v[20:23]
    ds_read_b64_tr_b16 v[86:87], v231 offset:20480
    v_mfma_f32_16x16x32_bf16 v[20:23], v[56:59], v[168:171], v[20:23]
    ds_read_b64_tr_b16 v[88:89], v227 offset:45056
    ds_read_b64_tr_b16 v[90:91], v231 offset:45056
    v_mfma_f32_16x16x32_bf16 v[20:23], v[52:55], v[164:167], v[20:23]
    ds_read_b64_tr_b16 v[92:93], v227 offset:49152
    v_mfma_f32_16x16x32_bf16 v[20:23], v[48:51], v[160:163], v[20:23]
    ds_read_b64_tr_b16 v[94:95], v231 offset:49152
    s_waitcnt lgkmcnt(8)
    v_cmp_gt_u32 vcc, 4, v223
    s_cbranch_vccnz LB_w8
LB_g8:
    v_mfma_f32_16x16x32_bf16 v[24:27], v[64:67], v[160:163], v[24:27]
    buffer_load_dwordx4 v[152:155], v15, s[52:55], s43 offen offset:2048 sc1
    buffer_load_dwordx4 v[156:159], v15, s[52:55], s43 offen offset:3072 sc1
    v_mfma_f32_16x16x32_bf16 v[24:27], v[68:71], v[164:167], v[24:27]
    ds_read_b64_tr_b16 v[48:49], v224 offset:53248
    v_mfma_f32_16x16x32_bf16 v[24:27], v[72:75], v[168:171], v[24:27]
    ds_read_b64_tr_b16 v[50:51], v228 offset:53248
    v_mfma_f32_16x16x32_bf16 v[24:27], v[76:79], v[172:175], v[24:27]
    ds_read_b64_tr_b16 v[52:53], v224 offset:57344
    v_mfma_f32_16x16x32_bf16 v[40:43], v[76:79], v[188:191], v[40:43]
    ds_read_b64_tr_b16 v[54:55], v228 offset:57344
    ds_read_b64_tr_b16 v[56:57], v232 offset:0
    v_mfma_f32_16x16x32_bf16 v[40:43], v[72:75], v[184:187], v[40:43]
    ds_read_b64_tr_b16 v[58:59], v236 offset:0
    v_mfma_f32_16x16x32_bf16 v[40:43], v[68:71], v[180:183], v[40:43]
    ds_read_b64_tr_b16 v[60:61], v232 offset:4096
    v_mfma_f32_16x16x32_bf16 v[40:43], v[64:67], v[176:179], v[40:43]
    ds_read_b64_tr_b16 v[62:63], v236 offset:4096
    s_waitcnt lgkmcnt(8)
    v_mfma_f32_16x16x32_bf16 v[44:47], v[80:83], v[176:179], v[44:47]
    ds_read_b64_tr_b16 v[64:65], v225 offset:53248
    v_mfma_f32_16x16x32_bf16 v[44:47], v[84:87], v[180:183], v[44:47]
    ds_read_b64_tr_b16 v[66:67], v229 offset:53248
    v_mfma_f32_16x16x32_bf16 v[44:47], v[88:91], v[184:187], v[44:47]
    ds_read_b64_tr_b16 v[68:69], v225 offset:57344
    v_mfma_f32_16x16x32_bf16 v[44:47], v[92:95], v[188:191], v[44:47]
    ds_read_b64_tr_b16 v[70:71], v229 offset:57344
    v_mfma_f32_16x16x32_bf16 v[28:31], v[92:95], v[172:175], v[28:31]
    ds_read_b64_tr_b16 v[72:73], v233 offset:0
    v_mfma_f32_16x16x32_bf16 v[28:31], v[88:91], v[168:171], v[28:31]
    ds_read_b64_tr_b16 v[74:75], v237 offset:0
    v_mfma_f32_16x16x32_bf16 v[28:31], v[84:87], v[164:167], v[28:31]
    ds_read_b64_tr_b16 v[76:77], v233 offset:4096
    v_mfma_f32_16x16x32_bf16 v[28:31], v[80:83], v[160:163], v[28:31]
    ds_read_b64_tr_b16 v[78:79], v237 offset:4096
    s_waitcnt vmcnt(8) lgkmcnt(8)
    v_mfma_f32_16x16x32_bf16 v[16:19], v[48:51], v[96:99], v[16:19]
    ds_read_b64_tr_b16 v[80:81], v226 offset:53248
    v_mfma_f32_16x16x32_bf16 v[16:19], v[52:55], v[100:103], v[16:19]
    ds_read_b64_tr_b16 v[82:83], v230 offset:53248
    v_mfma_f32_16x16x32_bf16 v[16:19], v[56:59], v[104:107], v[16:19]
    ds_read_b64_tr_b16 v[84:85], v226 offset:57344
    v_mfma_f32_16x16x32_bf16 v[16:19], v[60:63], v[108:111], v[16:19]
    ds_read_b64_tr_b16 v[86:87], v230 offset:57344
    v_mfma_f32_16x16x32_bf16 v[32:35], v[60:63], v[124:127], v[32:35]
    ds_read_b64_tr_b16 v[88:89], v234 offset:0
    v_mfma_f32_16x16x32_bf16 v[32:35], v[56:59], v[120:123], v[32:35]
    ds_read_b64_tr_b16 v[90:91], v238 offset:0
    v_mfma_f32_16x16x32_bf16 v[32:35], v[52:55], v[116:119], v[32:35]
    ds_read_b64_tr_b16 v[92:93], v234 offset:4096
    v_mfma_f32_16x16x32_bf16 v[32:35], v[48:51], v[112:115], v[32:35]
    ds_read_b64_tr_b16 v[94:95], v238 offset:4096
    s_waitcnt lgkmcnt(8)
    v_mfma_f32_16x16x32_bf16 v[36:39], v[64:67], v[112:115], v[36:39]
    ds_read_b64_tr_b16 v[48:49], v227 offset:53248
    v_mfma_f32_16x16x32_bf16 v[36:39], v[68:71], v[116:119], v[36:39]
    ds_read_b64_tr_b16 v[50:51], v231 offset:53248
    v_mfma_f32_16x16x32_bf16 v[36:39], v[72:75], v[120:123], v[36:39]
    ds_read_b64_tr_b16 v[52:53], v227 offset:57344
    v_mfma_f32_16x16x32_bf16 v[36:39], v[76:79], v[124:127], v[36:39]
    ds_read_b64_tr_b16 v[54:55], v231 offset:57344
    v_mfma_f32_16x16x32_bf16 v[20:23], v[76:79], v[108:111], v[20:23]
    ds_read_b64_tr_b16 v[56:57], v235 offset:0
    v_mfma_f32_16x16x32_bf16 v[20:23], v[72:75], v[104:107], v[20:23]
    ds_read_b64_tr_b16 v[58:59], v239 offset:0
    v_mfma_f32_16x16x32_bf16 v[20:23], v[68:71], v[100:103], v[20:23]
    ds_read_b64_tr_b16 v[60:61], v235 offset:4096
    v_mfma_f32_16x16x32_bf16 v[20:23], v[64:67], v[96:99], v[20:23]
    ds_read_b64_tr_b16 v[62:63], v239 offset:4096
    s_waitcnt lgkmcnt(8)
    v_mfma_f32_16x16x32_bf16 v[24:27], v[80:83], v[96:99], v[24:27]
    ds_read_b64_tr_b16 v[64:65], v232 offset:8192
    v_mfma_f32_16x16x32_bf16 v[24:27], v[84:87], v[100:103], v[24:27]
    ds_read_b64_tr_b16 v[66:67], v236 offset:8192
    v_mfma_f32_16x16x32_bf16 v[24:27], v[88:91], v[104:107], v[24:27]
    ds_read_b64_tr_b16 v[68:69], v232 offset:12288
    v_mfma_f32_16x16x32_bf16 v[24:27], v[92:95], v[108:111], v[24:27]
    ds_read_b64_tr_b16 v[70:71], v236 offset:12288
    v_mfma_f32_16x16x32_bf16 v[40:43], v[92:95], v[124:127], v[40:43]
    ds_read_b64_tr_b16 v[72:73], v232 offset:16384
    v_mfma_f32_16x16x32_bf16 v[40:43], v[88:91], v[120:123], v[40:43]
    ds_read_b64_tr_b16 v[74:75], v236 offset:16384
    v_mfma_f32_16x16x32_bf16 v[40:43], v[84:87], v[116:119], v[40:43]
    ds_read_b64_tr_b16 v[76:77], v232 offset:20480
    v_mfma_f32_16x16x32_bf16 v[40:43], v[80:83], v[112:115], v[40:43]
    ds_read_b64_tr_b16 v[78:79], v236 offset:20480
    s_waitcnt lgkmcnt(8)
    v_mfma_f32_16x16x32_bf16 v[44:47], v[48:51], v[112:115], v[44:47]
    ds_read_b64_tr_b16 v[80:81], v233 offset:8192
    v_mfma_f32_16x16x32_bf16 v[44:47], v[52:55], v[116:119], v[44:47]
    ds_read_b64_tr_b16 v[82:83], v237 offset:8192
    v_mfma_f32_16x16x32_bf16 v[44:47], v[56:59], v[120:123], v[44:47]
    ds_read_b64_tr_b16 v[84:85], v233 offset:12288
    v_mfma_f32_16x16x32_bf16 v[44:47], v[60:63], v[124:127], v[44:47]
    ds_read_b64_tr_b16 v[86:87], v237 offset:12288
    v_mfma_f32_16x16x32_bf16 v[28:31], v[60:63], v[108:111], v[28:31]
    ds_read_b64_tr_b16 v[88:89], v233 offset:16384
    v_mfma_f32_16x16x32_bf16 v[28:31], v[56:59], v[104:107], v[28:31]
    ds_read_b64_tr_b16 v[90:91], v237 offset:16384
    v_mfma_f32_16x16x32_bf16 v[28:31], v[52:55], v[100:103], v[28:31]
    ds_read_b64_tr_b16 v[92:93], v233 offset:20480
    v_mfma_f32_16x16x32_bf16 v[28:31], v[48:51], v[96:99], v[28:31]
    ds_read_b64_tr_b16 v[94:95], v237 offset:20480
    s_waitcnt vmcnt(0) lgkmcnt(8)
    v_mfma_f32_16x16x32_bf16 v[16:19], v[64:67], v[128:131], v[16:19]
    ds_read_b32 v223, v10 offset:28
    ds_read_b64_tr_b16 v[48:49], v234 offset:8192
    v_mfma_f32_16x16x32_bf16 v[16:19], v[68:71], v[132:135], v[16:19]
    ds_read_b64_tr_b16 v[50:51], v238 offset:8192
    v_mfma_f32_16x16x32_bf16 v[16:19], v[72:75], v[136:139], v[16:19]
    ds_read_b64_tr_b16 v[52:53], v234 offset:12288
    v_mfma_f32_16x16x32_bf16 v[16:19], v[76:79], v[140:143], v[16:19]
    ds_read_b64_tr_b16 v[54:55], v238 offset:12288
    v_mfma_f32_16x16x32_bf16 v[32:35], v[76:79], v[156:159], v[32:35]
    ds_read_b64_tr_b16 v[56:57], v234 offset:16384
    v_mfma_f32_16x16x32_bf16 v[32:35], v[72:75], v[152:155], v[32:35]
    ds_read_b64_tr_b16 v[58:59], v238 offset:16384
    v_mfma_f32_16x16x32_bf16 v[32:35], v[68:71], v[148:151], v[32:35]
    ds_read_b64_tr_b16 v[60:61], v234 offset:20480
    v_mfma_f32_16x16x32_bf16 v[32:35], v[64:67], v[144:147], v[32:35]
    ds_read_b64_tr_b16 v[62:63], v238 offset:20480
    s_waitcnt lgkmcnt(9)
    v_mfma_f32_16x16x32_bf16 v[36:39], v[80:83], v[144:147], v[36:39]
    ds_read_b64_tr_b16 v[64:65], v235 offset:8192
    v_mfma_f32_16x16x32_bf16 v[36:39], v[84:87], v[148:151], v[36:39]
    ds_read_b64_tr_b16 v[66:67], v239 offset:8192
    v_mfma_f32_16x16x32_bf16 v[36:39], v[88:91], v[152:155], v[36:39]
    ds_read_b64_tr_b16 v[68:69], v235 offset:12288
    v_mfma_f32_16x16x32_bf16 v[36:39], v[92:95], v[156:159], v[36:39]
    ds_read_b64_tr_b16 v[70:71], v239 offset:12288
    v_mfma_f32_16x16x32_bf16 v[20:23], v[92:95], v[140:143], v[20:23]
    ds_read_b64_tr_b16 v[72:73], v235 offset:16384
    v_mfma_f32_16x16x32_bf16 v[20:23], v[88:91], v[136:139], v[20:23]
    ds_read_b64_tr_b16 v[74:75], v239 offset:16384
    v_mfma_f32_16x16x32_bf16 v[20:23], v[84:87], v[132:135], v[20:23]
    ds_read_b64_tr_b16 v[76:77], v235 offset:20480
    v_mfma_f32_16x16x32_bf16 v[20:23], v[80:83], v[128:131], v[20:23]
    ds_read_b64_tr_b16 v[78:79], v239 offset:20480
    s_waitcnt lgkmcnt(14)
    v_cmp_gt_u32 vcc, 4, v223
    s_cbranch_vccnz LB_w7
LB_g7:
    v_mfma_f32_16x16x32_bf16 v[24:27], v[48:51], v[128:131], v[24:27]
    s_nop 1
    v_cvt_pk_bf16_f32 v200, v32, v33
    s_waitcnt lgkmcnt(12)
    v_mfma_f32_16x16x32_bf16 v[24:27], v[52:55], v[132:135], v[24:27]
    v_cvt_pk_bf16_f32 v201, v34, v35
    v_cvt_pk_bf16_f32 v202, v36, v37
    s_waitcnt lgkmcnt(10)
    v_mfma_f32_16x16x32_bf16 v[24:27], v[56:59], v[136:139], v[24:27]
    v_cvt_pk_bf16_f32 v203, v38, v39
    v_permlane16_swap_b32 v200, v202
    s_waitcnt lgkmcnt(8)
    v_mfma_f32_16x16x32_bf16 v[24:27], v[60:63], v[140:143], v[24:27]
    v_permlane16_swap_b32 v201, v203
    ds_write_b128 v248, v[200:203] offset:2048
    v_mfma_f32_16x16x32_bf16 v[40:43], v[60:63], v[156:159], v[40:43]
    v_cvt_pk_bf16_f32 v192, v16, v17
    v_cvt_pk_bf16_f32 v193, v18, v19
    v_mfma_f32_16x16x32_bf16 v[40:43], v[56:59], v[152:155], v[40:43]
    v_cvt_pk_bf16_f32 v194, v20, v21
    v_cvt_pk_bf16_f32 v195, v22, v23
    v_mfma_f32_16x16x32_bf16 v[40:43], v[52:55], v[148:151], v[40:43]
    v_permlane16_swap_b32 v192, v194
    v_permlane16_swap_b32 v193, v195
    v_mfma_f32_16x16x32_bf16 v[40:43], v[48:51], v[144:147], v[40:43]
    ds_write_b128 v248, v[192:195] offset:0
    v_cvt_pk_bf16_f32 v196, v24, v25
    s_waitcnt lgkmcnt(8)
    v_mfma_f32_16x16x32_bf16 v[44:47], v[64:67], v[144:147], v[44:47]
    v_cvt_pk_bf16_f32 v197, v26, v27
    s_nop 0
    s_waitcnt lgkmcnt(6)
    v_mfma_f32_16x16x32_bf16 v[44:47], v[68:71], v[148:151], v[44:47]
    s_nop 1
    s_waitcnt lgkmcnt(4)
    v_mfma_f32_16x16x32_bf16 v[44:47], v[72:75], v[152:155], v[44:47]
    v_cvt_pk_bf16_f32 v204, v40, v41
    v_cvt_pk_bf16_f32 v205, v42, v43
    s_waitcnt lgkmcnt(2)
    v_mfma_f32_16x16x32_bf16 v[44:47], v[76:79], v[156:159], v[44:47]
    s_nop 1
    v_mfma_f32_16x16x32_bf16 v[28:31], v[76:79], v[140:143], v[28:31]
    s_nop 1
    v_mfma_f32_16x16x32_bf16 v[28:31], v[72:75], v[136:139], v[28:31]
    s_nop 1
    v_mfma_f32_16x16x32_bf16 v[28:31], v[68:71], v[132:135], v[28:31]
    v_cvt_pk_bf16_f32 v206, v44, v45
    v_cvt_pk_bf16_f32 v207, v46, v47
    v_mfma_f32_16x16x32_bf16 v[28:31], v[64:67], v[128:131], v[28:31]
    v_permlane16_swap_b32 v204, v206
    v_permlane16_swap_b32 v205, v207
    ds_write_b128 v249, v[204:207] offset:2048
    ds_read_b128 v[184:187], v250 offset:2048
    ds_read_b128 v[188:191], v250 offset:3072
    s_nop 2
    v_cvt_pk_bf16_f32 v198, v28, v29
    v_cvt_pk_bf16_f32 v199, v30, v31
    s_nop 0
    v_permlane16_swap_b32 v196, v198
    v_permlane16_swap_b32 v197, v199
    ds_write_b128 v249, v[196:199] offset:0
    ds_read_b128 v[176:179], v250 offset:0
    ds_read_b128 v[180:183], v250 offset:1024
    s_mov_b32 s95, 65536
    s_waitcnt lgkmcnt(4)
    buffer_store_dwordx4 v[184:187], v246, s[60:63], s95 offen nt sc1
    s_mov_b32 s95, 98304
    s_waitcnt lgkmcnt(3)
    buffer_store_dwordx4 v[188:191], v246, s[60:63], s95 offen nt sc1
    s_mov_b32 s95, 0
    s_waitcnt lgkmcnt(1)
    buffer_store_dwordx4 v[176:179], v246, s[60:63], s95 offen nt sc1
    s_mov_b32 s95, 32768
    s_waitcnt lgkmcnt(0)
    buffer_store_dwordx4 v[180:183], v246, s[60:63], s95 offen nt sc1
    s_endpgm
LA_slow:
    s_mov_b32 s79, 0
LA_slow1:
    s_mov_b64 exec, vcc
    s_sleep 8
    buffer_load_dword v136, v33, s[68:71], 0 offen sc1
    buffer_load_dword v137, v34, s[52:55], 0 offen sc1
    s_add_u32 s79, s79, 1
    s_cmp_gt_u32 s79, 200000
    s_waitcnt vmcnt(0)
    s_cbranch_scc1 LA_back
    v_cmp_ne_u32 vcc, v136, v137
    v_cmp_gt_u32 s[80:81], s96, v136
    s_nop 0
    s_or_b64 vcc, vcc, s[80:81]
    s_cbranch_vccnz LA_slow1
    s_branch LA_back
LB_tag:
    s_mov_b64 exec, 0xffff
    v_lshrrev_b32 v251, v0, v251
    v_and_b32 v251, 1, v251
    v_cmp_eq_u32 vcc, 0, v251
    s_nop 1
    s_or_b32 s83, vcc_lo, 0x10000
    s_mov_b64 exec, 1
    v_mov_b32 v251, s83
    buffer_store_dword v251, v220, s[68:71], s98 offen sc1
    s_mov_b64 exec, -1
    s_branch LB_tagb
LB_slow:
    s_mov_b32 s79, 0
LB_pt:
    buffer_load_dword v222, v220, s[68:71], s98 offen sc1
    s_add_u32 s79, s79, 1
    s_cmp_gt_u32 s79, 200000
    s_cbranch_scc1 LB_pt_x
    s_waitcnt vmcnt(0)
    v_cmp_gt_u32 vcc, 4096, v222
    s_cbranch_vccz LB_pt_x
    s_mov_b64 exec, vcc
    s_sleep 8
    s_branch LB_pt
LB_pt_x:
    s_waitcnt vmcnt(0)
    s_branch LB_back
LB_w1:
    s_branch LB_s1_in
LB_s1:
    s_sleep 1
LB_s1_in:
    ds_read_b32 v223, v10 offset:0
    s_waitcnt lgkmcnt(0)
    v_readfirstlane_b32 s78, v223
    s_nop 0
    s_cmp_ge_u32 s78, 8
    s_cbranch_scc0 LB_s1
    s_branch LB_g1
LB_we:
    s_mov_b32 s79, 0
LB_we1:
    buffer_load_dwordx4 v[112:115], v217, s[52:55], s100 offen sc1
    buffer_load_dwordx2 v[224:225], v218, s[52:55], s100 offen offset:1024 sc1
    buffer_load_dwordx2 v[234:235], v218, s[52:55], s100 offen offset:1536 sc1
    s_add_u32 s79, s79, 1
    s_cmp_gt_u32 s79, 200000
    s_waitcnt vmcnt(0)
    s_cbranch_scc1 LB_ge
    v_max3_u32 v223, v112, v113, v114
    v_max3_u32 v14, v115, v224, v225
    v_max3_u32 v223, v223, v234, v235
    v_max_u32 v223, v223, v14
    v_cmp_eq_u32 vcc, -1, v223
    s_cbranch_vccz LB_ge
    s_sleep 2
    s_branch LB_we1
LB_w2:
    s_branch LB_s2_in
LB_s2:
    s_sleep 1
LB_s2_in:
    ds_read_b32 v223, v10 offset:8
    s_waitcnt lgkmcnt(0)
    v_readfirstlane_b32 s78, v223
    s_nop 0
    s_cmp_ge_u32 s78, 4
    s_cbranch_scc0 LB_s2
    s_branch LB_g2
LB_w4:
    s_branch LB_s4_in
LB_s4:
    s_sleep 1
LB_s4_in:
    ds_read_b32 v222, v10 offset:16
    s_waitcnt lgkmcnt(0)
    v_readfirstlane_b32 s78, v222
    s_nop 0
    s_cmp_ge_u32 s78, 4
    s_cbranch_scc0 LB_s4
    s_branch LB_g4
LB_w8:
    s_branch LB_s8_in
LB_s8:
    s_sleep 1
LB_s8_in:
    ds_read_b32 v223, v10 offset:32
    s_waitcnt lgkmcnt(0)
    v_readfirstlane_b32 s78, v223
    s_nop 0
    s_cmp_ge_u32 s78, 4
    s_cbranch_scc0 LB_s8
    s_branch LB_g8
LB_w7:
    s_branch LB_s7_in
LB_s7:
    s_sleep 1
LB_s7_in:
    ds_read_b32 v223, v10 offset:28
    s_waitcnt lgkmcnt(0)
    v_readfirstlane_b32 s78, v223
    s_nop 0
    s_cmp_ge_u32 s78, 4
    s_cbranch_scc0 LB_s7
    s_branch LB_g7
L_end:
    s_endpgm
.section .rodata,"a"
.p2align 6
.amdhsa_kernel concat_heads__ssm_conv_h3__sliding_local_dilated__prompt_kernel
  .amdhsa_next_free_vgpr 256
  .amdhsa_next_free_sgpr 102
  .amdhsa_accum_offset 256
  .amdhsa_group_segment_fixed_size 0
  .amdhsa_kernarg_size 96
  .amdhsa_user_sgpr_count 2
  .amdhsa_user_sgpr_kernarg_segment_ptr 1
  .amdhsa_system_sgpr_workgroup_id_x 1
.end_amdhsa_kernel
```
